```python
import torch

def _softmax(x, axis=-1):
    return torch.softmax(x, dim=axis)

def _gelu(x):
    return torch.nn.functional.gelu(x, approximate='tanh')

def _silu(x):
    return torch.nn.functional.silu(x)

def _sigmoid(x):
    return torch.sigmoid(x)

def _layernorm(x, axis=-1, eps=1e-05):
    m = x.mean(dim=axis, keepdim=True)
    v = x.var(dim=axis, keepdim=True, unbiased=False)
    return (x - m) / torch.sqrt(v + eps)

def _scatter_add(tgt, idx, src, axis=0):
    return tgt.clone().index_add_(axis, idx, src)

def _segment_sum(src, seg, n):
    out = torch.zeros((n,) + src.shape[1:], dtype=src.dtype)
    return out.index_add_(0, seg, src)

def _pad(x, pw):
    flat = tuple((v for pair in reversed(pw) for v in pair))
    return torch.nn.functional.pad(x, flat)
kernel_name = 'adaLN_cond__compressed_kv_cla__moe_arch_mod__prompt'

def setup_inputs():

    _w = lambda a: (lambda t: t.to(torch.bfloat16) if t.is_floating_point() else t)(torch.as_tensor(a))

    def _A_setup():
        B, H, Sq, Sk, D, M = (1, 32, 2048, 2048, 128, 512)
        Dc = 4 * D
        return {'x': _w((lambda *s: torch.randn(*s, dtype=torch.bfloat16) * 0.1)(B, Sq, M)), 'c_kv': _w((lambda *s: torch.randn(*s, dtype=torch.bfloat16) * 3.2)(B, Sk, Dc)), 'w_q': _w((lambda *s: torch.randn(*s, dtype=torch.bfloat16) * 0.8)(M, H, D) * M ** (-0.5)), 'w_uk': _w((lambda *s: torch.randn(*s, dtype=torch.bfloat16) * 0.8)(Dc, H, D) * Dc ** (-0.5)), 'w_uv': _w((lambda *s: torch.randn(*s, dtype=torch.bfloat16) * 3.2)(Dc, H, D) * Dc ** (-0.5)), 'w_o': _w((lambda *s: torch.randn(*s, dtype=torch.bfloat16) * 3.2)(H, D, M) * (H * D) ** (-0.5))}
    _A_in = _A_setup()

    def _B_setup():
        B, S, D, F, C = (1, 2048, 512, 1792, 1)
        return {'x': _w((lambda *s: torch.randn(*s, dtype=torch.bfloat16) * 0.1)(B, S, D)), 'w_r': _w((lambda *s: torch.randn(*s, dtype=torch.bfloat16) * 3.2)(D)), 'w_gate': _w((lambda *s: torch.randn(*s, dtype=torch.bfloat16) * 3.2)(D, F)), 'w_up': _w((lambda *s: torch.randn(*s, dtype=torch.bfloat16) * 3.2)(D, F)), 'w_down': _w((lambda *s: torch.randn(*s, dtype=torch.bfloat16) * 3.2)(F, D))}
    _B_in = _B_setup()
    return {'A_x': _A_in['x'], 'A_c_kv': _A_in['c_kv'], 'A_w_q': _A_in['w_q'], 'A_w_uk': _A_in['w_uk'], 'A_w_uv': _A_in['w_uv'], 'A_w_o': _A_in['w_o'], 'B_x': _B_in['x'], 'B_w_r': _B_in['w_r'], 'B_w_gate': _B_in['w_gate'], 'B_w_up': _B_in['w_up'], 'B_w_down': _B_in['w_down'], 'c': _w((lambda *s: torch.randn(*s, dtype=torch.bfloat16) * 0.2)(1, 512) * 8.0), 'w_mod': _w((lambda *s: torch.randn(*s, dtype=torch.bfloat16) * 0.2)(512, 6 * 512) * 512 ** (-0.5) * 8.0)}

def reference(A_x, A_c_kv, A_w_q, A_w_uk, A_w_uv, A_w_o, B_x, B_w_r, B_w_gate, B_w_up, B_w_down, c, w_mod):

    def _A_ref(x, c_kv, w_q, w_uk, w_uv, w_o):
        B, Sq, M = (x.shape[0], x.shape[1], x.shape[2])
        Sk = c_kv.shape[1]
        H, D = (w_q.shape[1], w_q.shape[2])
        q = torch.einsum('bqm,mhd->bhqd', x, w_q)
        k = torch.einsum('bkc,chd->bhkd', c_kv, w_uk)
        v = torch.einsum('bkc,chd->bhkd', c_kv, w_uv)
        scores = torch.einsum('bhqd,bhkd->bhqk', q, k) * D ** (-0.5)
        off = Sk - Sq
        qi = torch.arange(Sq)[:, None]
        kj = torch.arange(Sk)[None, :]
        cmask = kj <= qi + off
        scores = torch.where(cmask[None, None], scores, -1000000000.0)
        p = _softmax(scores, axis=-1)
        ctx = torch.einsum('bhqk,bhkd->bhqd', p, v)
        return torch.einsum('bhqd,hdm->bqm', ctx, w_o)

    def _B_ref(x, w_r, w_gate, w_up, w_down):
        B, S, D = x.shape
        C = 1
        r = x @ w_r
        idx = torch.argsort(-r, axis=-1)[:, :C]
        idx_e = (lambda x, n, axis: torch.repeat_interleave(x, n, dim=axis))(idx.reshape(B, C, 1), D, axis=2)
        x_sel = (lambda x, i, axis: torch.take_along_dim(x, i, dim=axis))(x, idx_e, axis=1)
        g = _silu(x_sel @ w_gate)
        u = x_sel @ w_up
        y = g * u @ w_down
        r_sel = _sigmoid((lambda x, i, axis: torch.take_along_dim(x, i, dim=axis))(r, idx, axis=1))
        y = y * r_sel.reshape(B, C, 1)
        b_off = (torch.arange(B) * S).reshape(B, 1)
        flat_idx = (idx + b_off).reshape(B * C)
        zero = (x * 0.0).reshape(B * S, D)
        upd = _scatter_add(zero, flat_idx, y.reshape(B * C, D), axis=0)
        return x + upd.reshape(B, S, D)
    x = A_x
    mod = (_silu(c) @ w_mod).reshape(c.shape[0], 6, 1, -1)
    sa, ca, ga, sb, cb, gb = (mod[:, 0].clone(), mod[:, 1].clone(), mod[:, 2].clone(), mod[:, 3].clone(), mod[:, 4].clone(), mod[:, 5].clone())
    h = _layernorm(x, axis=-1) * (1 + ca) + sa
    x = x + ga * _A_ref(h, A_c_kv, A_w_q, A_w_uk, A_w_uv, A_w_o)
    h = _layernorm(x, axis=-1) * (1 + cb) + sb
    x = x + gb * _B_ref(h, B_w_r, B_w_gate, B_w_up, B_w_down)
    return x
```

```asm
; @launch grid=(256,1,1) block=(256,1,1) lds=163840
.amdgcn_target "amdgcn-amd-amdhsa--gfx950"
.text
.globl adaLN_cond__compressed_kv_cla__moe_arch_mod__prompt_kernel
.p2align 8
.type adaLN_cond__compressed_kv_cla__moe_arch_mod__prompt_kernel,@function
adaLN_cond__compressed_kv_cla__moe_arch_mod__prompt_kernel:
    s_cmp_ge_u32 s2, 256
    s_cbranch_scc1 L_end
    s_load_dwordx16 s[64:79], s[0:1], 0
    s_load_dwordx16 s[80:95], s[0:1], 64
    s_getpc_b64 s[100:101]
L_pf1:
    v_lshrrev_b32 v3, 6, v0
    v_and_b32 v2, 63, v0
    s_lshr_b32 s5, s2, 3
    s_mul_i32 s98, s5, 24
    v_min_u32 v5, 5, v2
    v_mad_u32_u24 v5, v3, 6, v5
    v_add_u32 v5, s98, v5
    v_lshlrev_b32 v5, 7, v5
    v_min_u32 v5, L_code_end-L_pf1, v5
    global_load_dword a255, v5, s[100:101]
    v_readfirstlane_b32 s3, v3
    v_lshlrev_b32 v1, 4, v2
    s_and_b32 s4, s2, 7
    s_and_b32 s5, s5, 3
    s_lshr_b32 s6, s2, 5
    s_lshl_b32 s7, s4, 2
    s_add_u32 s7, s7, s5
    s_mov_b32 s60, s6
    s_sub_u32 s61, 15, s6
    v_lshrrev_b32 v3, 3, v2
    v_lshrrev_b32 v4, 4, v2
    v_and_b32 v5, 7, v2
    v_xor_b32 v5, v5, v4
    v_lshlrev_b32 v5, 4, v5
    v_lshl_add_u32 v16, v3, 10, v5
    v_xor_b32 v17, 64, v16
    v_add_u32 v17, 7168, v17
    v_add_u32 v18, 14336, v16
    v_add_u32 v19, 14336, v17
    v_bfe_u32 v5, v2, 1, 3
    v_xor_b32 v5, v5, v4
    v_lshlrev_b32 v5, 5, v5
    v_and_b32 v6, 1, v2
    v_lshl_add_u32 v5, v6, 4, v5
    v_lshl_add_u32 v20, v4, 13, v5
    v_add_u32 v21, 31744, v20
    v_xor_b32 v22, 128, v20
    v_add_u32 v22, 63488, v22
    v_add_u32 v23, 31744, v22
    s_lshl_b32 s62, s3, 13
    s_lshl_b32 s63, s3, 12
    s_lshl_b32 s96, s6, 18
    s_lshl_b32 s98, s3, 16
    s_add_u32 s96, s96, s98
    s_lshl_b32 s97, s3, 17
    s_lshl_b32 s99, s5, 0
    s_xor_b32 s99, s99, s6
    s_lshl_b32 s99, s99, 3
    s_and_b32 s99, s99, 7
    s_lshl_b32 s98, s99, 7
    s_add_u32 s96, s96, s98
    s_lshl_b32 s98, s99, 19
    s_add_u32 s97, s97, s98
    v_and_b32 v84, 7, v2
    v_lshrrev_b32 v65, 3, v0
    v_mul_u32_u24 v64, 24576, v65
    v_lshl_add_u32 v64, v84, 4, v64
    v_lshlrev_b32 v65, 3, v65
    v_lshrrev_b32 v85, 3, v2
    v_lshlrev_b32 v86, 10, v84
    v_lshl_add_u32 v86, v85, 4, v86
    s_lshl_b32 s100, s7, 8
    s_waitcnt lgkmcnt(0)
    s_add_u32 s16, s70, s100
    s_addc_u32 s17, s71, 0
    s_sub_u32 s18, 4194304, s100
    s_mov_b32 s19, 0x00020000
    s_mov_b32 s12, s66
    s_mov_b32 s13, s67
    s_mov_b32 s14, 2097152
    s_mov_b32 s15, 0x00020000
    s_add_u32 m0, s63, 98304
    s_xor_b32 s98, s97, 0
    buffer_load_dwordx4 v20, s[16:19], s98 offen offset:0 nt lds
    buffer_load_dwordx4 v21, s[16:19], s98 offen offset:1024 nt lds
    buffer_load_dwordx4 v22, s[16:19], s98 offen offset:2048 nt lds
    buffer_load_dwordx4 v23, s[16:19], s98 offen offset:3072 nt lds
    s_add_u32 m0, s62, 0
    s_xor_b32 s98, s96, 0
    buffer_load_dwordx4 v16, s[12:15], s98 offen offset:0  lds
    buffer_load_dwordx4 v17, s[12:15], s98 offen offset:1024  lds
    buffer_load_dwordx4 v18, s[12:15], s98 offen offset:2048  lds
    buffer_load_dwordx4 v19, s[12:15], s98 offen offset:3072  lds
    s_add_u32 m0, s62, 4096
    s_xor_b32 s98, s96, 32768
    buffer_load_dwordx4 v16, s[12:15], s98 offen offset:0  lds
    buffer_load_dwordx4 v17, s[12:15], s98 offen offset:1024  lds
    buffer_load_dwordx4 v18, s[12:15], s98 offen offset:2048  lds
    buffer_load_dwordx4 v19, s[12:15], s98 offen offset:3072  lds
    s_mov_b32 s40, s88
    s_mov_b32 s41, s89
    s_mov_b32 s42, 3145728
    s_mov_b32 s43, 0x00020000
    s_mov_b32 s44, s86
    s_mov_b32 s45, s87
    s_mov_b32 s46, 1024
    s_mov_b32 s47, 0x00020000
    s_mov_b32 s32, s64
    s_mov_b32 s33, s65
    s_mov_b32 s34, 2097152
    s_mov_b32 s35, 0x00020000
    s_mov_b32 s8, s94
    s_mov_b32 s9, s95
    s_mov_b32 s10, 268435456
    s_mov_b32 s11, 0x00020000
    s_add_u32 s20, s72, s100
    s_addc_u32 s21, s73, 0
    s_sub_u32 s22, 4194304, s100
    s_mov_b32 s23, 0x00020000
    s_add_u32 s24, s68, s100
    s_addc_u32 s25, s69, 0
    s_sub_u32 s26, 4194304, s100
    s_mov_b32 s27, 0x00020000
    s_mov_b32 s36, s92
    s_mov_b32 s37, s93
    s_mov_b32 s38, 256
    s_mov_b32 s39, 0x00020000
    s_lshl_b32 s100, s4, 19
    s_lshl_b32 s99, s5, 8
    s_add_u32 s100, s100, s99
    s_add_u32 s28, s74, s100
    s_addc_u32 s29, s75, 0
    s_sub_u32 s30, 4194304, s100
    s_mov_b32 s31, 0x00020000
    s_mov_b32 s48, s84
    s_mov_b32 s49, s85
    s_mov_b32 s50, 1835008
    s_mov_b32 s51, 0x00020000
    s_mov_b32 s52, s90
    s_mov_b32 s53, s91
    s_mov_b32 s54, 2097152
    s_mov_b32 s55, 0x00020000
    s_mov_b64 s[92:93], s[80:81]
    s_mov_b64 s[94:95], s[82:83]
    s_mov_b32 s56, s78
    s_mov_b32 s57, s79
    s_mov_b32 s58, 1024
    s_mov_b32 s59, 0x00020000
    s_lshl_b32 s64, s3, 19
    s_and_b32 s100, s97, 3670016
    s_xor_b32 s64, s64, s100
    s_lshr_b32 s100, s6, 1
    s_and_b32 s100, s100, 0
    s_lshl_b32 s1, s100, 12
    s_lshl_b32 s100, s100, 7
    s_add_u32 s64, s64, s100
    s_lshl_b32 s100, s5, 1
    s_xor_b32 s100, s100, s6
    s_and_b32 s100, s100, 0
    s_lshl_b32 s68, s100, 11
    s_lshl_b32 s100, s100, 19
    s_lshl_b32 s0, s3, 17
    s_add_u32 s0, s0, s100
    s_lshl_b32 s81, s7, 20
    s_add_u32 s81, s81, 16777216
    s_lshl_b32 s100, s6, 17
    s_add_u32 s65, s81, s100
    s_lshr_b32 s100, s3, 1
    s_lshl_b32 s100, s100, 16
    s_add_u32 s65, s65, s100
    s_and_b32 s100, s3, 1
    s_lshl_b32 s100, s100, 14
    s_add_u32 s65, s65, s100
    s_add_u32 s81, s81, s62
    s_min_u32 s82, s60, 1
    s_lshl_b32 s82, s82, 16
    s_add_u32 s82, s82, s81
    s_cmp_lt_u32 s6, 2
    s_cselect_b32 s69, 0, 64
    s_lshl_b32 s100, s6, 3
    s_add_u32 s100, s100, s4
    s_lshl_b32 s100, s100, 8
    s_mul_i32 s101, s5, 12288
    s_add_u32 s100, s100, s101
    s_add_u32 s100, s100, 16384
    s_cmp_lt_u32 s6, 6
    s_cselect_b32 s66, s100, 2147479552
    s_cselect_b32 s69, s69, 2147479552
    s_cmp_eq_u32 s3, 0
    s_cselect_b32 s66, s66, 2147479552
    s_lshl_b32 s70, s3, 9
    s_add_u32 s70, s70, 16384
    s_lshr_b32 s71, s2, 1
    s_lshl_b32 s71, s71, 14
    s_and_b32 s100, s2, 1
    s_lshl_b32 s100, s100, 7
    s_add_u32 s71, s71, s100
    s_add_u32 s71, s71, s63
    s_add_u32 s71, s71, 2097152
    s_lshl_b32 s72, s2, 2
    s_add_u32 s72, s72, s3
    s_lshl_b32 s72, s72, 6
    s_add_u32 s72, s72, 262144
    s_lshl_b32 s74, s7, 11
    s_add_u32 s74, s74, 327680
    s_lshl_b32 s73, s6, 2
    s_add_u32 s73, s73, s3
    s_lshl_b32 s73, s73, 6
    s_add_u32 s73, s73, s74
    s_lshr_b32 s100, s3, 1
    s_sub_u32 s101, 3, s100
    s_and_b32 s98, s3, 1
    s_cselect_b32 s100, s101, s100
    s_lshl_b32 s75, s60, 2
    s_add_u32 s75, s75, s100
    s_lshl_b32 s76, s61, 2
    s_add_u32 s76, s76, s100
    s_sub_u32 s77, s76, s75
    s_lshl_b32 s77, s77, 10
    s_lshl_b32 s78, s75, 10
    s_add_u32 s78, s78, 196608
    s_lshl_b32 s75, s75, 15
    s_add_u32 s75, s75, 2097152
    s_add_u32 s75, s75, s68
    s_lshl_b32 s76, s76, 15
    s_add_u32 s76, s76, 2097152
    s_add_u32 s76, s76, s68
    s_add_u32 s1, s1, s65
    v_and_b32 v48, 15, v2
    v_lshrrev_b32 v49, 4, v2
    v_lshrrev_b32 v50, 1, v48
    v_xor_b32 v50, v50, v49
    v_lshlrev_b32 v50, 4, v50
    v_lshl_add_u32 v28, v48, 7, v50
    v_add_u32 v28, s62, v28
    v_xor_b32 v29, 64, v28
    v_add_u32 v30, 65536, v28
    v_add_u32 v31, 65536, v29
    v_lshrrev_b32 v50, 2, v48
    v_and_b32 v51, 3, v48
    v_lshl_add_u32 v52, v49, 3, v50
    v_lshlrev_b32 v53, 8, v52
    v_lshl_add_u32 v53, v51, 3, v53
    v_add_u32 v53, 98304, v53
    v_and_b32 v54, 1, v49
    v_lshl_add_u32 v54, v54, 2, v50
    v_xor_b32 v55, 0, v54
    v_lshl_add_u32 v8, v55, 5, v53
    v_xor_b32 v55, 1, v54
    v_lshl_add_u32 v9, v55, 5, v53
    v_xor_b32 v55, 2, v54
    v_lshl_add_u32 v10, v55, 5, v53
    v_xor_b32 v55, 3, v54
    v_lshl_add_u32 v11, v55, 5, v53
    v_xor_b32 v55, 4, v54
    v_lshl_add_u32 v12, v55, 5, v53
    v_xor_b32 v55, 5, v54
    v_lshl_add_u32 v13, v55, 5, v53
    v_xor_b32 v55, 6, v54
    v_lshl_add_u32 v14, v55, 5, v53
    v_xor_b32 v55, 7, v54
    v_lshl_add_u32 v15, v55, 5, v53
    v_bfe_u32 v49, v2, 1, 2
    v_bfe_u32 v50, v2, 4, 1
    v_xor_b32 v49, v49, v50
    v_lshlrev_b32 v49, 5, v49
    v_and_b32 v50, 1, v2
    v_lshl_add_u32 v49, v50, 4, v49
    v_lshl_add_u32 v24, v85, 13, v49
    v_xor_b32 v25, 64, v24
    v_add_u32 v25, 64512, v25
    v_add_u32 v26, 129024, v24
    v_add_u32 v27, 129024, v25
    v_cmp_eq_u32 vcc, 0, v2
    v_mov_b32 v6, 2147479552
    s_nop 0
    v_cndmask_b32 v5, v6, v2, vcc
    v_cmp_eq_u32 vcc, 0, v0
    s_nop 1
    v_cndmask_b32 v7, v6, v0, vcc
    v_and_b32 v48, 8, v2
    v_cmp_eq_u32 vcc, 0, v48
    v_lshlrev_b32 v48, 5, v84
    v_lshrrev_b32 v49, 1, v2
    v_and_b32 v49, 24, v49
    v_add_u32 v48, v48, v49
    s_lshl_b32 s100, s3, 8
    s_add_u32 s100, s100, 147456
    v_add_u32 v48, s100, v48
    v_mov_b32 v49, 148480
    v_cndmask_b32 v98, v49, v48, vcc
    v_lshlrev_b32 v99, 5, v84
    v_add_u32 v99, 149504, v99
    s_lshl_b32 s100, s3, 3
    v_add_u32 v100, s100, v99
    v_lshlrev_b32 v106, 5, v85
    v_lshlrev_b32 v107, 8, v85
    v_lshl_add_u32 v107, v84, 4, v107
    s_lshl_b32 s80, s2, 12
    s_add_u32 s80, s80, 262144
    s_cmp_lt_u32 s2, 64
    s_cselect_b32 s80, s80, 2147479552
    s_mul_i32 s99, s5, 786432
    s_lshl_b32 s79, s6, 3
    s_add_u32 s79, s79, s4
    s_lshl_b32 s79, s79, 7
    s_add_u32 s79, s79, s99
    s_cmp_lt_u32 s6, 6
    s_cselect_b32 s79, s79, 2147414016
    s_lshl_b32 s100, s5, 8
    v_add_u32 v65, s100, v65
    v_mov_b32 v6, 1
    v_mov_b32 v4, 0
    buffer_load_dwordx2 v[66:67], v65, s[44:47], 0 offen
    buffer_load_dwordx4 v[68:71], v64, s[40:43], s79 offen nt
    s_add_u32 s79, s79, 6144
    buffer_load_dwordx4 v[72:75], v64, s[40:43], s79 offen nt
    s_add_u32 s79, s79, 6144
    buffer_load_dwordx4 v[76:79], v64, s[40:43], s79 offen nt
    s_add_u32 s79, s79, 6144
    buffer_load_dwordx4 v[80:83], v64, s[40:43], s79 offen nt
    s_lshl_b32 s79, s2, 5
    s_add_u32 s79, s79, s3
    s_lshl_b32 s79, s79, 8
    buffer_load_dwordx4 v[88:91], v86, s[32:35], s79 offen nt
    buffer_load_dwordx4 v[92:95], v86, s[32:35], s79 offen offset:128 nt
    s_add_u32 m0, s63, 114688
    s_xor_b32 s98, s97, 524288
    buffer_load_dwordx4 v20, s[16:19], s98 offen offset:0 nt lds
    buffer_load_dwordx4 v21, s[16:19], s98 offen offset:1024 nt lds
    buffer_load_dwordx4 v22, s[16:19], s98 offen offset:2048 nt lds
    buffer_load_dwordx4 v23, s[16:19], s98 offen offset:3072 nt lds
    s_add_u32 m0, s62, 32768
    s_xor_b32 s98, s96, 128
    buffer_load_dwordx4 v16, s[12:15], s98 offen offset:0  lds
    buffer_load_dwordx4 v17, s[12:15], s98 offen offset:1024  lds
    buffer_load_dwordx4 v18, s[12:15], s98 offen offset:2048  lds
    buffer_load_dwordx4 v19, s[12:15], s98 offen offset:3072  lds
    s_add_u32 m0, s62, 36864
    s_xor_b32 s98, s96, 32896
    buffer_load_dwordx4 v16, s[12:15], s98 offen offset:0  lds
    buffer_load_dwordx4 v17, s[12:15], s98 offen offset:1024  lds
    buffer_load_dwordx4 v18, s[12:15], s98 offen offset:2048  lds
    buffer_load_dwordx4 v19, s[12:15], s98 offen offset:3072  lds
    s_waitcnt vmcnt(19)
    s_barrier
    ds_read_b64_tr_b16 v[32:33], v8 offset:0
    ds_read_b64_tr_b16 v[34:35], v8 offset:1024
    ds_read_b128 a[0:3], v28 offset:0
    ds_read_b128 a[4:7], v28 offset:2048
    ds_read_b128 a[8:11], v28 offset:4096
    ds_read_b128 a[12:15], v28 offset:6144
    ds_read_b64_tr_b16 v[36:37], v9 offset:0
    ds_read_b64_tr_b16 v[38:39], v9 offset:1024
    ds_read_b64_tr_b16 v[40:41], v10 offset:0
    ds_read_b64_tr_b16 v[42:43], v10 offset:1024
    ds_read_b64_tr_b16 v[44:45], v11 offset:0
    ds_read_b64_tr_b16 v[46:47], v11 offset:1024
    ds_read_b64_tr_b16 v[48:49], v12 offset:0
    ds_read_b64_tr_b16 v[50:51], v12 offset:1024
    ds_read_b64_tr_b16 v[52:53], v13 offset:0
    ds_read_b64_tr_b16 v[54:55], v13 offset:1024
    ds_read_b64_tr_b16 v[56:57], v14 offset:0
    ds_read_b64_tr_b16 v[58:59], v14 offset:1024
    ds_read_b64_tr_b16 v[60:61], v15 offset:0
    ds_read_b64_tr_b16 v[62:63], v15 offset:1024
    s_waitcnt lgkmcnt(15)
    v_mfma_f32_16x16x32_bf16 v[128:131], v[32:35], a[0:3], 0
    v_mfma_f32_16x16x32_bf16 v[160:163], v[32:35], a[4:7], 0
    v_mfma_f32_16x16x32_bf16 v[192:195], v[32:35], a[8:11], 0
    s_waitcnt lgkmcnt(14)
    s_add_u32 m0, s63, 131072
    s_xor_b32 s98, s97, 1048576
    ds_read_b128 a[16:19], v29 offset:0
    v_mfma_f32_16x16x32_bf16 v[224:227], v[32:35], a[12:15], 0
    s_waitcnt lgkmcnt(13)
    ds_read_b128 a[20:23], v29 offset:2048
    v_mfma_f32_16x16x32_bf16 v[132:135], v[36:39], a[0:3], 0
    ds_read_b64_tr_b16 v[32:33], v8 offset:8192
    v_mfma_f32_16x16x32_bf16 v[164:167], v[36:39], a[4:7], 0
    ds_read_b64_tr_b16 v[34:35], v8 offset:9216
    v_mfma_f32_16x16x32_bf16 v[196:199], v[36:39], a[8:11], 0
    ds_read_b128 a[24:27], v29 offset:4096
    v_mfma_f32_16x16x32_bf16 v[228:231], v[36:39], a[12:15], 0
    s_waitcnt lgkmcnt(15)
    ds_read_b128 a[28:31], v29 offset:6144
    v_mfma_f32_16x16x32_bf16 v[136:139], v[40:43], a[0:3], 0
    ds_read_b64_tr_b16 v[36:37], v9 offset:8192
    v_mfma_f32_16x16x32_bf16 v[168:171], v[40:43], a[4:7], 0
    s_waitcnt lgkmcnt(15)
    ds_read_b64_tr_b16 v[38:39], v9 offset:9216
    v_mfma_f32_16x16x32_bf16 v[200:203], v[40:43], a[8:11], 0
    buffer_load_dwordx4 v20, s[16:19], s98 offen offset:0 nt lds
    v_mfma_f32_16x16x32_bf16 v[232:235], v[40:43], a[12:15], 0
    buffer_load_dwordx4 v21, s[16:19], s98 offen offset:1024 nt lds
    v_mfma_f32_16x16x32_bf16 v[140:143], v[44:47], a[0:3], 0
    ds_read_b64_tr_b16 v[40:41], v10 offset:8192
    v_mfma_f32_16x16x32_bf16 v[172:175], v[44:47], a[4:7], 0
    s_waitcnt lgkmcnt(15)
    ds_read_b64_tr_b16 v[42:43], v10 offset:9216
    v_mfma_f32_16x16x32_bf16 v[204:207], v[44:47], a[8:11], 0
    buffer_load_dwordx4 v22, s[16:19], s98 offen offset:2048 nt lds
    v_mfma_f32_16x16x32_bf16 v[236:239], v[44:47], a[12:15], 0
    buffer_load_dwordx4 v23, s[16:19], s98 offen offset:3072 nt lds
    v_mfma_f32_16x16x32_bf16 v[144:147], v[48:51], a[0:3], 0
    s_add_u32 m0, s62, 65536
    s_xor_b32 s98, s96, 256
    ds_read_b64_tr_b16 v[44:45], v11 offset:8192
    v_mfma_f32_16x16x32_bf16 v[176:179], v[48:51], a[4:7], 0
    s_waitcnt lgkmcnt(15)
    ds_read_b64_tr_b16 v[46:47], v11 offset:9216
    v_mfma_f32_16x16x32_bf16 v[208:211], v[48:51], a[8:11], 0
    buffer_load_dwordx4 v16, s[12:15], s98 offen offset:0  lds
    v_mfma_f32_16x16x32_bf16 v[240:243], v[48:51], a[12:15], 0
    buffer_load_dwordx4 v17, s[12:15], s98 offen offset:1024  lds
    v_mfma_f32_16x16x32_bf16 v[148:151], v[52:55], a[0:3], 0
    ds_read_b64_tr_b16 v[48:49], v12 offset:8192
    v_mfma_f32_16x16x32_bf16 v[180:183], v[52:55], a[4:7], 0
    s_waitcnt lgkmcnt(15)
    ds_read_b64_tr_b16 v[50:51], v12 offset:9216
    v_mfma_f32_16x16x32_bf16 v[212:215], v[52:55], a[8:11], 0
    buffer_load_dwordx4 v18, s[12:15], s98 offen offset:2048  lds
    v_mfma_f32_16x16x32_bf16 v[244:247], v[52:55], a[12:15], 0
    buffer_load_dwordx4 v19, s[12:15], s98 offen offset:3072  lds
    v_mfma_f32_16x16x32_bf16 v[152:155], v[56:59], a[0:3], 0
    s_add_u32 m0, s62, 69632
    s_xor_b32 s98, s96, 33024
    ds_read_b64_tr_b16 v[52:53], v13 offset:8192
    v_mfma_f32_16x16x32_bf16 v[184:187], v[56:59], a[4:7], 0
    s_waitcnt lgkmcnt(15)
    ds_read_b64_tr_b16 v[54:55], v13 offset:9216
    v_mfma_f32_16x16x32_bf16 v[216:219], v[56:59], a[8:11], 0
    buffer_load_dwordx4 v16, s[12:15], s98 offen offset:0  lds
    v_mfma_f32_16x16x32_bf16 v[248:251], v[56:59], a[12:15], 0
    buffer_load_dwordx4 v17, s[12:15], s98 offen offset:1024  lds
    v_mfma_f32_16x16x32_bf16 v[156:159], v[60:63], a[0:3], 0
    ds_read_b64_tr_b16 v[56:57], v14 offset:8192
    v_mfma_f32_16x16x32_bf16 v[188:191], v[60:63], a[4:7], 0
    s_waitcnt lgkmcnt(13)
    ds_read_b64_tr_b16 v[58:59], v14 offset:9216
    v_mfma_f32_16x16x32_bf16 v[220:223], v[60:63], a[8:11], 0
    buffer_load_dwordx4 v18, s[12:15], s98 offen offset:2048  lds
    v_mfma_f32_16x16x32_bf16 v[252:255], v[60:63], a[12:15], 0
    buffer_load_dwordx4 v19, s[12:15], s98 offen offset:3072  lds
    v_mfma_f32_16x16x32_bf16 v[128:131], v[32:35], a[16:19], v[128:131]
    ds_read_b64_tr_b16 v[60:61], v15 offset:8192
    v_mfma_f32_16x16x32_bf16 v[160:163], v[32:35], a[20:23], v[160:163]
    s_waitcnt lgkmcnt(14)
    ds_read_b64_tr_b16 v[62:63], v15 offset:9216
    v_mfma_f32_16x16x32_bf16 v[192:195], v[32:35], a[24:27], v[192:195]
    s_waitcnt lgkmcnt(14)
    v_mfma_f32_16x16x32_bf16 v[224:227], v[32:35], a[28:31], v[224:227]
    s_waitcnt lgkmcnt(12)
    v_mfma_f32_16x16x32_bf16 v[132:135], v[36:39], a[16:19], v[132:135]
    v_mfma_f32_16x16x32_bf16 v[164:167], v[36:39], a[20:23], v[164:167]
    v_mfma_f32_16x16x32_bf16 v[196:199], v[36:39], a[24:27], v[196:199]
    v_mfma_f32_16x16x32_bf16 v[228:231], v[36:39], a[28:31], v[228:231]
    s_waitcnt lgkmcnt(10)
    v_mfma_f32_16x16x32_bf16 v[136:139], v[40:43], a[16:19], v[136:139]
    s_waitcnt vmcnt(12) lgkmcnt(0)
    s_barrier
    v_mfma_f32_16x16x32_bf16 v[168:171], v[40:43], a[20:23], v[168:171]
    s_add_u32 m0, s63, 98304
    s_xor_b32 s98, s97, 1572864
    ds_read_b64_tr_b16 v[32:33], v8 offset:16384
    v_lshlrev_b32 v102, 16, v66
    v_and_b32 v103, 0xffff0000, v66
    v_mfma_f32_16x16x32_bf16 v[200:203], v[40:43], a[24:27], v[200:203]
    ds_read_b64_tr_b16 v[34:35], v8 offset:17408
    v_lshlrev_b32 v104, 16, v67
    v_and_b32 v105, 0xffff0000, v67
    v_mfma_f32_16x16x32_bf16 v[232:235], v[40:43], a[28:31], v[232:235]
    ds_read_b64_tr_b16 v[36:37], v9 offset:16384
    v_mul_f32 v108, 0xbfb8aa3b, v102
    v_mul_f32 v109, 0xbfb8aa3b, v103
    v_mfma_f32_16x16x32_bf16 v[140:143], v[44:47], a[16:19], v[140:143]
    ds_read_b64_tr_b16 v[38:39], v9 offset:17408
    v_mul_f32 v110, 0xbfb8aa3b, v104
    v_mul_f32 v111, 0xbfb8aa3b, v105
    v_mfma_f32_16x16x32_bf16 v[172:175], v[44:47], a[20:23], v[172:175]
    ds_read_b64_tr_b16 v[40:41], v10 offset:16384
    v_exp_f32 v108, v108
    v_mfma_f32_16x16x32_bf16 v[204:207], v[44:47], a[24:27], v[204:207]
    ds_read_b64_tr_b16 v[42:43], v10 offset:17408
    v_exp_f32 v109, v109
    v_mfma_f32_16x16x32_bf16 v[236:239], v[44:47], a[28:31], v[236:239]
    ds_read_b128 a[32:35], v28 offset:32768
    v_exp_f32 v110, v110
    v_mfma_f32_16x16x32_bf16 v[144:147], v[48:51], a[16:19], v[144:147]
    ds_read_b64_tr_b16 v[44:45], v11 offset:16384
    v_exp_f32 v111, v111
    v_mfma_f32_16x16x32_bf16 v[176:179], v[48:51], a[20:23], v[176:179]
    ds_read_b64_tr_b16 v[46:47], v11 offset:17408
    v_add_f32 v108, 1.0, v108
    v_add_f32 v109, 1.0, v109
    v_mfma_f32_16x16x32_bf16 v[208:211], v[48:51], a[24:27], v[208:211]
    ds_read_b128 a[36:39], v28 offset:34816
    v_mov_b32 v112, 0
    v_add_f32 v110, 1.0, v110
    v_mfma_f32_16x16x32_bf16 v[240:243], v[48:51], a[28:31], v[240:243]
    ds_read_b128 a[40:43], v28 offset:36864
    v_mov_b32 v113, 0
    v_add_f32 v111, 1.0, v111
    v_mfma_f32_16x16x32_bf16 v[148:151], v[52:55], a[16:19], v[148:151]
    ds_read_b64_tr_b16 v[48:49], v12 offset:16384
    v_mov_b32 v114, 0
    v_mfma_f32_16x16x32_bf16 v[180:183], v[52:55], a[20:23], v[180:183]
    ds_read_b64_tr_b16 v[50:51], v12 offset:17408
    v_mov_b32 v115, 0
    v_mfma_f32_16x16x32_bf16 v[212:215], v[52:55], a[24:27], v[212:215]
    ds_read_b128 a[44:47], v28 offset:38912
    v_lshlrev_b32 v116, 4, v0
    v_mfma_f32_16x16x32_bf16 v[244:247], v[52:55], a[28:31], v[244:247]
    buffer_load_dwordx4 v20, s[16:19], s98 offen offset:0 nt lds
    v_mfma_f32_16x16x32_bf16 v[152:155], v[56:59], a[16:19], v[152:155]
    ds_read_b64_tr_b16 v[52:53], v13 offset:16384
    v_rcp_f32 v108, v108
    v_mfma_f32_16x16x32_bf16 v[184:187], v[56:59], a[20:23], v[184:187]
    ds_read_b64_tr_b16 v[54:55], v13 offset:17408
    v_rcp_f32 v109, v109
    v_mfma_f32_16x16x32_bf16 v[216:219], v[56:59], a[24:27], v[216:219]
    buffer_load_dwordx4 v21, s[16:19], s98 offen offset:1024 nt lds
    v_mfma_f32_16x16x32_bf16 v[248:251], v[56:59], a[28:31], v[248:251]
    buffer_store_dwordx4 v[112:115], v116, s[8:11], s80 offen sc0 sc1
    v_mfma_f32_16x16x32_bf16 v[156:159], v[60:63], a[16:19], v[156:159]
    ds_read_b64_tr_b16 v[56:57], v14 offset:16384
    v_lshlrev_b32 v117, 13, v2
    v_mfma_f32_16x16x32_bf16 v[188:191], v[60:63], a[20:23], v[188:191]
    s_lshl_b32 s100, s6, 19
    s_and_b32 s101, s3, 1
    ds_read_b64_tr_b16 v[58:59], v14 offset:17408
    v_rcp_f32 v110, v110
    v_mfma_f32_16x16x32_bf16 v[220:223], v[60:63], a[24:27], v[220:223]
    buffer_load_dwordx4 v22, s[16:19], s98 offen offset:2048 nt lds
    v_mfma_f32_16x16x32_bf16 v[252:255], v[60:63], a[28:31], v[252:255]
    s_waitcnt lgkmcnt(11)
    s_lshl_b32 s101, s101, 7
    s_add_u32 s100, s100, s101
    v_rcp_f32 v111, v111
    v_mul_f32 v102, v102, v108
    v_mfma_f32_16x16x32_bf16 v[128:131], v[32:35], a[32:35], v[128:131]
    s_waitcnt lgkmcnt(8)
    ds_read_b64_tr_b16 v[60:61], v15 offset:16384
    v_mul_f32 v103, v103, v109
    v_mul_f32 v104, v104, v110
    v_mfma_f32_16x16x32_bf16 v[160:163], v[32:35], a[36:39], v[160:163]
    s_waitcnt lgkmcnt(8)
    ds_read_b64_tr_b16 v[62:63], v15 offset:17408
    v_mul_f32 v105, v105, v111
    v_cvt_pk_bf16_f32 v108, v102, v103
    v_mfma_f32_16x16x32_bf16 v[192:195], v[32:35], a[40:43], v[192:195]
    s_waitcnt lgkmcnt(6)
    ds_read_b128 a[48:51], v29 offset:32768
    v_cvt_pk_bf16_f32 v109, v104, v105
    v_lshlrev_b32 v102, 16, v108
    v_mfma_f32_16x16x32_bf16 v[224:227], v[32:35], a[44:47], v[224:227]
    ds_read_b128 a[52:55], v29 offset:34816
    v_and_b32 v103, 0xffff0000, v108
    v_lshlrev_b32 v104, 16, v109
    v_mfma_f32_16x16x32_bf16 v[132:135], v[36:39], a[32:35], v[132:135]
    ds_read_b64_tr_b16 v[32:33], v8 offset:24576
    v_and_b32 v105, 0xffff0000, v109
    v_lshlrev_b32 v108, 16, v68
    v_mfma_f32_16x16x32_bf16 v[164:167], v[36:39], a[36:39], v[164:167]
    ds_read_b64_tr_b16 v[34:35], v8 offset:25600
    v_and_b32 v109, 0xffff0000, v68
    v_mul_f32 v120, v108, v102
    v_mfma_f32_16x16x32_bf16 v[196:199], v[36:39], a[40:43], v[196:199]
    ds_read_b128 a[56:59], v29 offset:36864
    v_mul_f32 v121, v109, v102
    v_lshlrev_b32 v110, 16, v69
    v_mfma_f32_16x16x32_bf16 v[228:231], v[36:39], a[44:47], v[228:231]
    ds_read_b128 a[60:63], v29 offset:38912
    v_and_b32 v111, 0xffff0000, v69
    v_mul_f32 v122, v110, v102
    v_mfma_f32_16x16x32_bf16 v[136:139], v[40:43], a[32:35], v[136:139]
    ds_read_b64_tr_b16 v[36:37], v9 offset:24576
    v_mul_f32 v123, v111, v102
    v_lshlrev_b32 v108, 16, v70
    v_mfma_f32_16x16x32_bf16 v[168:171], v[40:43], a[36:39], v[168:171]
    ds_read_b64_tr_b16 v[38:39], v9 offset:25600
    v_and_b32 v109, 0xffff0000, v70
    v_mul_f32 v124, v108, v102
    v_mfma_f32_16x16x32_bf16 v[200:203], v[40:43], a[40:43], v[200:203]
    buffer_load_dwordx4 v23, s[16:19], s98 offen offset:3072 nt lds
    v_mul_f32 v125, v109, v102
    v_mfma_f32_16x16x32_bf16 v[232:235], v[40:43], a[44:47], v[232:235]
    v_lshlrev_b32 v110, 16, v71
    v_and_b32 v111, 0xffff0000, v71
    v_mul_f32 v126, v110, v102
    v_mfma_f32_16x16x32_bf16 v[140:143], v[44:47], a[32:35], v[140:143]
    s_add_u32 m0, s62, 0
    s_xor_b32 s98, s96, 384
    ds_read_b64_tr_b16 v[40:41], v10 offset:24576
    v_mul_f32 v127, v111, v102
    v_lshlrev_b32 v108, 16, v72
    v_mfma_f32_16x16x32_bf16 v[172:175], v[44:47], a[36:39], v[172:175]
    ds_read_b64_tr_b16 v[42:43], v10 offset:25600
    v_and_b32 v109, 0xffff0000, v72
    v_fmac_f32 v120, v108, v103
    v_mfma_f32_16x16x32_bf16 v[204:207], v[44:47], a[40:43], v[204:207]
    buffer_load_dwordx4 v16, s[12:15], s98 offen offset:0  lds
    v_fmac_f32 v121, v109, v103
    v_mfma_f32_16x16x32_bf16 v[236:239], v[44:47], a[44:47], v[236:239]
    v_lshlrev_b32 v110, 16, v73
    v_and_b32 v111, 0xffff0000, v73
    v_fmac_f32 v122, v110, v103
    v_mfma_f32_16x16x32_bf16 v[144:147], v[48:51], a[32:35], v[144:147]
    ds_read_b64_tr_b16 v[44:45], v11 offset:24576
    v_fmac_f32 v123, v111, v103
    v_lshlrev_b32 v108, 16, v74
    v_mfma_f32_16x16x32_bf16 v[176:179], v[48:51], a[36:39], v[176:179]
    ds_read_b64_tr_b16 v[46:47], v11 offset:25600
    v_and_b32 v109, 0xffff0000, v74
    v_fmac_f32 v124, v108, v103
    v_mfma_f32_16x16x32_bf16 v[208:211], v[48:51], a[40:43], v[208:211]
    buffer_load_dwordx4 v17, s[12:15], s98 offen offset:1024  lds
    v_fmac_f32 v125, v109, v103
    v_mfma_f32_16x16x32_bf16 v[240:243], v[48:51], a[44:47], v[240:243]
    s_waitcnt lgkmcnt(15)
    v_lshlrev_b32 v110, 16, v75
    v_and_b32 v111, 0xffff0000, v75
    v_fmac_f32 v126, v110, v103
    v_mfma_f32_16x16x32_bf16 v[148:151], v[52:55], a[32:35], v[148:151]
    ds_read_b64_tr_b16 v[48:49], v12 offset:24576
    v_fmac_f32 v127, v111, v103
    v_lshlrev_b32 v108, 16, v76
    v_mfma_f32_16x16x32_bf16 v[180:183], v[52:55], a[36:39], v[180:183]
    ds_read_b64_tr_b16 v[50:51], v12 offset:25600
    v_and_b32 v109, 0xffff0000, v76
    v_fmac_f32 v120, v108, v104
    v_mfma_f32_16x16x32_bf16 v[212:215], v[52:55], a[40:43], v[212:215]
    buffer_load_dwordx4 v18, s[12:15], s98 offen offset:2048  lds
    v_fmac_f32 v121, v109, v104
    v_mfma_f32_16x16x32_bf16 v[244:247], v[52:55], a[44:47], v[244:247]
    s_waitcnt lgkmcnt(15)
    v_lshlrev_b32 v110, 16, v77
    v_and_b32 v111, 0xffff0000, v77
    v_fmac_f32 v122, v110, v104
    v_mfma_f32_16x16x32_bf16 v[152:155], v[56:59], a[32:35], v[152:155]
    ds_read_b64_tr_b16 v[52:53], v13 offset:24576
    v_fmac_f32 v123, v111, v104
    v_lshlrev_b32 v108, 16, v78
    v_mfma_f32_16x16x32_bf16 v[184:187], v[56:59], a[36:39], v[184:187]
    ds_read_b64_tr_b16 v[54:55], v13 offset:25600
    v_and_b32 v109, 0xffff0000, v78
    v_fmac_f32 v124, v108, v104
    v_mfma_f32_16x16x32_bf16 v[216:219], v[56:59], a[40:43], v[216:219]
    buffer_load_dwordx4 v19, s[12:15], s98 offen offset:3072  lds
    v_fmac_f32 v125, v109, v104
    v_mfma_f32_16x16x32_bf16 v[248:251], v[56:59], a[44:47], v[248:251]
    s_waitcnt lgkmcnt(15)
    v_lshlrev_b32 v110, 16, v79
    v_and_b32 v111, 0xffff0000, v79
    v_fmac_f32 v126, v110, v104
    v_mfma_f32_16x16x32_bf16 v[156:159], v[60:63], a[32:35], v[156:159]
    s_add_u32 m0, s62, 4096
    s_xor_b32 s98, s96, 33152
    ds_read_b64_tr_b16 v[56:57], v14 offset:24576
    v_fmac_f32 v127, v111, v104
    v_lshlrev_b32 v108, 16, v80
    v_mfma_f32_16x16x32_bf16 v[188:191], v[60:63], a[36:39], v[188:191]
    ds_read_b64_tr_b16 v[58:59], v14 offset:25600
    v_and_b32 v109, 0xffff0000, v80
    v_fmac_f32 v120, v108, v105
    v_mfma_f32_16x16x32_bf16 v[220:223], v[60:63], a[40:43], v[220:223]
    buffer_load_dwordx4 v16, s[12:15], s98 offen offset:0  lds
    v_fmac_f32 v121, v109, v105
    v_mfma_f32_16x16x32_bf16 v[252:255], v[60:63], a[44:47], v[252:255]
    s_waitcnt lgkmcnt(14)
    v_lshlrev_b32 v110, 16, v81
    v_and_b32 v111, 0xffff0000, v81
    v_fmac_f32 v122, v110, v105
    v_mfma_f32_16x16x32_bf16 v[128:131], v[32:35], a[48:51], v[128:131]
    ds_read_b64_tr_b16 v[60:61], v15 offset:24576
    v_fmac_f32 v123, v111, v105
    v_lshlrev_b32 v108, 16, v82
    v_mfma_f32_16x16x32_bf16 v[160:163], v[32:35], a[52:55], v[160:163]
    s_waitcnt lgkmcnt(13)
    ds_read_b64_tr_b16 v[62:63], v15 offset:25600
    v_and_b32 v109, 0xffff0000, v82
    v_fmac_f32 v124, v108, v105
    v_mfma_f32_16x16x32_bf16 v[192:195], v[32:35], a[56:59], v[192:195]
    buffer_load_dwordx4 v17, s[12:15], s98 offen offset:1024  lds
    v_fmac_f32 v125, v109, v105
    v_mfma_f32_16x16x32_bf16 v[224:227], v[32:35], a[60:63], v[224:227]
    s_waitcnt lgkmcnt(12)
    v_lshlrev_b32 v110, 16, v83
    v_and_b32 v111, 0xffff0000, v83
    v_fmac_f32 v126, v110, v105
    v_mfma_f32_16x16x32_bf16 v[132:135], v[36:39], a[48:51], v[132:135]
    buffer_load_dwordx4 v18, s[12:15], s98 offen offset:2048  lds
    v_fmac_f32 v127, v111, v105
    v_mfma_f32_16x16x32_bf16 v[164:167], v[36:39], a[52:55], v[164:167]
    v_permlane32_swap_b32 v120, v124
    v_permlane32_swap_b32 v121, v125
    v_permlane32_swap_b32 v122, v126
    v_mfma_f32_16x16x32_bf16 v[196:199], v[36:39], a[56:59], v[196:199]
    buffer_load_dwordx4 v19, s[12:15], s98 offen offset:3072  lds
    v_permlane32_swap_b32 v123, v127
    s_cmp_eq_u32 s3, 0
    s_cselect_b32 s101, s100, 2147479552
    buffer_load_dword a240, v117, s[20:23], s101 offen nt
    buffer_load_dword a241, v117, s[20:23], s101 offen offset:4
    v_mfma_f32_16x16x32_bf16 v[228:231], v[36:39], a[60:63], v[228:231]
    s_waitcnt lgkmcnt(10)
    v_add_f32 v120, v120, v124
    v_add_f32 v121, v121, v125
    v_add_f32 v122, v122, v126
    v_mfma_f32_16x16x32_bf16 v[136:139], v[40:43], a[48:51], v[136:139]
    v_add_f32 v123, v123, v127
    v_permlane16_swap_b32 v120, v122
    s_nop 0
    v_permlane16_swap_b32 v121, v123
    s_waitcnt vmcnt(15) lgkmcnt(0)
    s_barrier
    v_mfma_f32_16x16x32_bf16 v[168:171], v[40:43], a[52:55], v[168:171]
    s_add_u32 m0, s63, 114688
    s_xor_b32 s98, s97, 2097152
    ds_read_b64_tr_b16 v[32:33], v8 offset:32768
    v_add_f32 v120, v120, v122
    v_add_f32 v121, v121, v123
    v_mfma_f32_16x16x32_bf16 v[200:203], v[40:43], a[56:59], v[200:203]
    ds_read_b64_tr_b16 v[34:35], v8 offset:33792
    v_add_f32_dpp v120, v120, v120 row_ror:8 row_mask:0xf bank_mask:0xf
    v_add_f32_dpp v121, v121, v121 row_ror:8 row_mask:0xf bank_mask:0xf
    v_mfma_f32_16x16x32_bf16 v[232:235], v[40:43], a[60:63], v[232:235]
    ds_read_b64_tr_b16 v[36:37], v9 offset:32768
    ds_write_b64 v98, v[120:121]
    v_mfma_f32_16x16x32_bf16 v[140:143], v[44:47], a[48:51], v[140:143]
    ds_read_b64_tr_b16 v[38:39], v9 offset:33792
    v_lshlrev_b32 v64, 16, v88
    v_mfma_f32_16x16x32_bf16 v[172:175], v[44:47], a[52:55], v[172:175]
    ds_read_b64_tr_b16 v[40:41], v10 offset:32768
    v_and_b32 v65, 0xffff0000, v88
    v_mfma_f32_16x16x32_bf16 v[204:207], v[44:47], a[56:59], v[204:207]
    ds_read_b64_tr_b16 v[42:43], v10 offset:33792
    v_lshlrev_b32 v66, 16, v89
    v_mfma_f32_16x16x32_bf16 v[236:239], v[44:47], a[60:63], v[236:239]
    ds_read_b128 a[64:67], v30 offset:0
    v_and_b32 v67, 0xffff0000, v89
    v_mfma_f32_16x16x32_bf16 v[144:147], v[48:51], a[48:51], v[144:147]
    ds_read_b64_tr_b16 v[44:45], v11 offset:32768
    v_lshlrev_b32 v68, 16, v90
    v_mfma_f32_16x16x32_bf16 v[176:179], v[48:51], a[52:55], v[176:179]
    ds_read_b64_tr_b16 v[46:47], v11 offset:33792
    v_and_b32 v69, 0xffff0000, v90
    v_mfma_f32_16x16x32_bf16 v[208:211], v[48:51], a[56:59], v[208:211]
    ds_read_b128 a[68:71], v30 offset:2048
    v_lshlrev_b32 v70, 16, v91
    v_mfma_f32_16x16x32_bf16 v[240:243], v[48:51], a[60:63], v[240:243]
    ds_read_b128 a[72:75], v30 offset:4096
    v_and_b32 v71, 0xffff0000, v91
    v_mfma_f32_16x16x32_bf16 v[148:151], v[52:55], a[48:51], v[148:151]
    ds_read_b64_tr_b16 v[48:49], v12 offset:32768
    v_lshlrev_b32 v72, 16, v92
    v_mfma_f32_16x16x32_bf16 v[180:183], v[52:55], a[52:55], v[180:183]
    ds_read_b64_tr_b16 v[50:51], v12 offset:33792
    v_and_b32 v73, 0xffff0000, v92
    v_mfma_f32_16x16x32_bf16 v[212:215], v[52:55], a[56:59], v[212:215]
    ds_read_b128 a[76:79], v30 offset:6144
    v_lshlrev_b32 v74, 16, v93
    v_mfma_f32_16x16x32_bf16 v[244:247], v[52:55], a[60:63], v[244:247]
    buffer_load_dwordx4 v20, s[16:19], s98 offen offset:0 nt lds
    v_mfma_f32_16x16x32_bf16 v[152:155], v[56:59], a[48:51], v[152:155]
    s_mov_b32 s40, s92
    s_mov_b32 s41, s93
    ds_read_b64_tr_b16 v[52:53], v13 offset:32768
    v_mfma_f32_16x16x32_bf16 v[184:187], v[56:59], a[52:55], v[184:187]
    s_mov_b32 s42, 1835008
    s_mov_b32 s44, s94
    ds_read_b64_tr_b16 v[54:55], v13 offset:33792
    v_mfma_f32_16x16x32_bf16 v[216:219], v[56:59], a[56:59], v[216:219]
    s_mov_b32 s45, s95
    s_mov_b32 s46, 1835008
    v_and_b32 v75, 0xffff0000, v93
    v_mfma_f32_16x16x32_bf16 v[248:251], v[56:59], a[60:63], v[248:251]
    buffer_load_dwordx4 v21, s[16:19], s98 offen offset:1024 nt lds
    v_mfma_f32_16x16x32_bf16 v[156:159], v[60:63], a[48:51], v[156:159]
    ds_read_b64_tr_b16 v[56:57], v14 offset:32768
    v_lshlrev_b32 v76, 16, v94
    v_mfma_f32_16x16x32_bf16 v[188:191], v[60:63], a[52:55], v[188:191]
    ds_read_b64_tr_b16 v[58:59], v14 offset:33792
    v_and_b32 v77, 0xffff0000, v94
    v_mfma_f32_16x16x32_bf16 v[220:223], v[60:63], a[56:59], v[220:223]
    buffer_load_dwordx4 v22, s[16:19], s98 offen offset:2048 nt lds
    v_mfma_f32_16x16x32_bf16 v[252:255], v[60:63], a[60:63], v[252:255]
    s_waitcnt lgkmcnt(11)
    v_lshlrev_b32 v78, 16, v95
    v_and_b32 v79, 0xffff0000, v95
    v_mfma_f32_16x16x32_bf16 v[128:131], v[32:35], a[64:67], v[128:131]
    s_waitcnt lgkmcnt(8)
    ds_read_b64_tr_b16 v[60:61], v15 offset:32768
    v_add_f32 v108, v64, v65
    v_mfma_f32_16x16x32_bf16 v[160:163], v[32:35], a[68:71], v[160:163]
    s_waitcnt lgkmcnt(8)
    ds_read_b64_tr_b16 v[62:63], v15 offset:33792
    v_add_f32 v109, v66, v67
    v_mfma_f32_16x16x32_bf16 v[192:195], v[32:35], a[72:75], v[192:195]
    s_waitcnt lgkmcnt(6)
    ds_read_b128 a[80:83], v31 offset:0
    v_add_f32 v108, v108, v68
    v_mfma_f32_16x16x32_bf16 v[224:227], v[32:35], a[76:79], v[224:227]
    ds_read_b128 a[84:87], v31 offset:2048
    v_add_f32 v109, v109, v69
    v_mfma_f32_16x16x32_bf16 v[132:135], v[36:39], a[64:67], v[132:135]
    ds_read_b64_tr_b16 v[32:33], v8 offset:40960
    v_add_f32 v108, v108, v70
    v_mfma_f32_16x16x32_bf16 v[164:167], v[36:39], a[68:71], v[164:167]
    ds_read_b64_tr_b16 v[34:35], v8 offset:41984
    v_add_f32 v109, v109, v71
    v_mfma_f32_16x16x32_bf16 v[196:199], v[36:39], a[72:75], v[196:199]
    ds_read_b128 a[88:91], v31 offset:4096
    v_add_f32 v108, v108, v72
    v_mfma_f32_16x16x32_bf16 v[228:231], v[36:39], a[76:79], v[228:231]
    ds_read_b128 a[92:95], v31 offset:6144
    v_add_f32 v109, v109, v73
    v_mfma_f32_16x16x32_bf16 v[136:139], v[40:43], a[64:67], v[136:139]
    ds_read_b64_tr_b16 v[36:37], v9 offset:40960
    v_add_f32 v108, v108, v74
    v_mfma_f32_16x16x32_bf16 v[168:171], v[40:43], a[68:71], v[168:171]
    ds_read_b64_tr_b16 v[38:39], v9 offset:41984
    v_add_f32 v109, v109, v75
    v_mfma_f32_16x16x32_bf16 v[200:203], v[40:43], a[72:75], v[200:203]
    buffer_load_dwordx4 v23, s[16:19], s98 offen offset:3072 nt lds
    v_mfma_f32_16x16x32_bf16 v[232:235], v[40:43], a[76:79], v[232:235]
    v_add_f32 v108, v108, v76
    v_add_f32 v109, v109, v77
    v_mfma_f32_16x16x32_bf16 v[140:143], v[44:47], a[64:67], v[140:143]
    s_add_u32 m0, s62, 32768
    s_xor_b32 s98, s96, 512
    ds_read_b64_tr_b16 v[40:41], v10 offset:40960
    v_mfma_f32_16x16x32_bf16 v[172:175], v[44:47], a[68:71], v[172:175]
    ds_read_b64_tr_b16 v[42:43], v10 offset:41984
    v_add_f32 v108, v108, v78
    v_mfma_f32_16x16x32_bf16 v[204:207], v[44:47], a[72:75], v[204:207]
    buffer_load_dwordx4 v16, s[12:15], s98 offen offset:0  lds
    v_mfma_f32_16x16x32_bf16 v[236:239], v[44:47], a[76:79], v[236:239]
    v_add_f32 v109, v109, v79
    v_add_f32 v108, v108, v109
    v_mfma_f32_16x16x32_bf16 v[144:147], v[48:51], a[64:67], v[144:147]
    ds_read_b64_tr_b16 v[44:45], v11 offset:40960
    v_add_f32_dpp v108, v108, v108 row_ror:8 row_mask:0xf bank_mask:0xf
    v_mfma_f32_16x16x32_bf16 v[176:179], v[48:51], a[68:71], v[176:179]
    ds_read_b64_tr_b16 v[46:47], v11 offset:41984
    v_mov_b32 v110, v108
    v_mfma_f32_16x16x32_bf16 v[208:211], v[48:51], a[72:75], v[208:211]
    buffer_load_dwordx4 v17, s[12:15], s98 offen offset:1024  lds
    v_mfma_f32_16x16x32_bf16 v[240:243], v[48:51], a[76:79], v[240:243]
    s_waitcnt lgkmcnt(15)
    v_permlane16_swap_b32 v108, v110
    v_add_f32 v108, v108, v110
    v_mfma_f32_16x16x32_bf16 v[148:151], v[52:55], a[64:67], v[148:151]
    ds_read_b64_tr_b16 v[48:49], v12 offset:40960
    v_mov_b32 v110, v108
    v_mfma_f32_16x16x32_bf16 v[180:183], v[52:55], a[68:71], v[180:183]
    ds_read_b64_tr_b16 v[50:51], v12 offset:41984
    v_permlane32_swap_b32 v108, v110
    v_mfma_f32_16x16x32_bf16 v[212:215], v[52:55], a[72:75], v[212:215]
    buffer_load_dwordx4 v18, s[12:15], s98 offen offset:2048  lds
    v_mfma_f32_16x16x32_bf16 v[244:247], v[52:55], a[76:79], v[244:247]
    s_waitcnt lgkmcnt(15)
    v_add_f32 v108, v108, v110
    v_mul_f32 v108, 0x3c000000, v108
    v_mfma_f32_16x16x32_bf16 v[152:155], v[56:59], a[64:67], v[152:155]
    ds_read_b64_tr_b16 v[52:53], v13 offset:40960
    v_sub_f32 v110, v64, v108
    v_mfma_f32_16x16x32_bf16 v[184:187], v[56:59], a[68:71], v[184:187]
    ds_read_b64_tr_b16 v[54:55], v13 offset:41984
    v_mul_f32 v109, v110, v110
    v_mfma_f32_16x16x32_bf16 v[216:219], v[56:59], a[72:75], v[216:219]
    buffer_load_dwordx4 v19, s[12:15], s98 offen offset:3072  lds
    v_mfma_f32_16x16x32_bf16 v[248:251], v[56:59], a[76:79], v[248:251]
    s_waitcnt lgkmcnt(15)
    v_sub_f32 v111, v65, v108
    v_fmac_f32 v109, v111, v111
    v_mfma_f32_16x16x32_bf16 v[156:159], v[60:63], a[64:67], v[156:159]
    s_add_u32 m0, s62, 36864
    s_xor_b32 s98, s96, 33280
    ds_read_b64_tr_b16 v[56:57], v14 offset:40960
    v_mfma_f32_16x16x32_bf16 v[188:191], v[60:63], a[68:71], v[188:191]
    ds_read_b64_tr_b16 v[58:59], v14 offset:41984
    v_sub_f32 v110, v66, v108
    v_mfma_f32_16x16x32_bf16 v[220:223], v[60:63], a[72:75], v[220:223]
    buffer_load_dwordx4 v16, s[12:15], s98 offen offset:0  lds
    v_mfma_f32_16x16x32_bf16 v[252:255], v[60:63], a[76:79], v[252:255]
    s_waitcnt lgkmcnt(14)
    v_fmac_f32 v109, v110, v110
    v_sub_f32 v111, v67, v108
    v_mfma_f32_16x16x32_bf16 v[128:131], v[32:35], a[80:83], v[128:131]
    ds_read_b64_tr_b16 v[60:61], v15 offset:40960
    v_fmac_f32 v109, v111, v111
    v_mfma_f32_16x16x32_bf16 v[160:163], v[32:35], a[84:87], v[160:163]
    s_waitcnt lgkmcnt(13)
    ds_read_b64_tr_b16 v[62:63], v15 offset:41984
    v_sub_f32 v110, v68, v108
    v_mfma_f32_16x16x32_bf16 v[192:195], v[32:35], a[88:91], v[192:195]
    buffer_load_dwordx4 v17, s[12:15], s98 offen offset:1024  lds
    v_mfma_f32_16x16x32_bf16 v[224:227], v[32:35], a[92:95], v[224:227]
    s_waitcnt lgkmcnt(12)
    v_fmac_f32 v109, v110, v110
    v_sub_f32 v111, v69, v108
    v_mfma_f32_16x16x32_bf16 v[132:135], v[36:39], a[80:83], v[132:135]
    buffer_load_dwordx4 v18, s[12:15], s98 offen offset:2048  lds
    v_mfma_f32_16x16x32_bf16 v[164:167], v[36:39], a[84:87], v[164:167]
    v_fmac_f32 v109, v111, v111
    v_sub_f32 v110, v70, v108
    v_mfma_f32_16x16x32_bf16 v[196:199], v[36:39], a[88:91], v[196:199]
    buffer_load_dwordx4 v19, s[12:15], s98 offen offset:3072  lds
    s_cmp_eq_u32 s3, 1
    s_cselect_b32 s101, s100, 2147479552
    buffer_load_dword a242, v117, s[20:23], s101 offen nt
    buffer_load_dword a243, v117, s[20:23], s101 offen offset:4
    v_mfma_f32_16x16x32_bf16 v[228:231], v[36:39], a[92:95], v[228:231]
    s_waitcnt lgkmcnt(10)
    v_fmac_f32 v109, v110, v110
    v_sub_f32 v111, v71, v108
    s_waitcnt vmcnt(26)
    v_mfma_f32_16x16x32_bf16 v[136:139], v[40:43], a[80:83], v[136:139]
    v_fmac_f32 v109, v111, v111
    v_sub_f32 v110, v72, v108
    s_waitcnt vmcnt(16) lgkmcnt(0)
    s_barrier
    v_mfma_f32_16x16x32_bf16 v[168:171], v[40:43], a[84:87], v[168:171]
    s_add_u32 m0, s63, 131072
    s_xor_b32 s98, s97, 2621440
    ds_read_b64_tr_b16 v[32:33], v8 offset:0
    v_lshrrev_b32 v87, 2, v1
    v_add_u32 v101, 147456, v87
    v_mfma_f32_16x16x32_bf16 v[200:203], v[40:43], a[88:91], v[200:203]
    ds_read_b64_tr_b16 v[34:35], v8 offset:1024
    ds_read_b32 v102, v101
    v_mfma_f32_16x16x32_bf16 v[232:235], v[40:43], a[92:95], v[232:235]
    ds_read_b64_tr_b16 v[36:37], v9 offset:0
    ds_read_b32 v103, v101 offset:256
    v_mfma_f32_16x16x32_bf16 v[140:143], v[44:47], a[80:83], v[140:143]
    ds_read_b64_tr_b16 v[38:39], v9 offset:1024
    ds_read_b32 v104, v101 offset:512
    v_mfma_f32_16x16x32_bf16 v[172:175], v[44:47], a[84:87], v[172:175]
    ds_read_b64_tr_b16 v[40:41], v10 offset:0
    ds_read_b32 v105, v101 offset:768
    v_mfma_f32_16x16x32_bf16 v[204:207], v[44:47], a[88:91], v[204:207]
    ds_read_b64_tr_b16 v[42:43], v10 offset:1024
    v_fmac_f32 v109, v110, v110
    v_mfma_f32_16x16x32_bf16 v[236:239], v[44:47], a[92:95], v[236:239]
    ds_read_b128 a[96:99], v28 offset:0
    v_sub_f32 v111, v73, v108
    v_mfma_f32_16x16x32_bf16 v[144:147], v[48:51], a[80:83], v[144:147]
    ds_read_b64_tr_b16 v[44:45], v11 offset:0
    v_fmac_f32 v109, v111, v111
    v_mfma_f32_16x16x32_bf16 v[176:179], v[48:51], a[84:87], v[176:179]
    ds_read_b64_tr_b16 v[46:47], v11 offset:1024
    v_sub_f32 v110, v74, v108
    v_mfma_f32_16x16x32_bf16 v[208:211], v[48:51], a[88:91], v[208:211]
    ds_read_b128 a[100:103], v28 offset:2048
    v_fmac_f32 v109, v110, v110
    v_mfma_f32_16x16x32_bf16 v[240:243], v[48:51], a[92:95], v[240:243]
    ds_read_b128 a[104:107], v28 offset:4096
    s_waitcnt lgkmcnt(10)
    v_add_f32 v102, v102, v103
    v_mfma_f32_16x16x32_bf16 v[148:151], v[52:55], a[80:83], v[148:151]
    ds_read_b64_tr_b16 v[48:49], v12 offset:0
    s_waitcnt lgkmcnt(7)
    v_add_f32 v104, v104, v105
    v_mfma_f32_16x16x32_bf16 v[180:183], v[52:55], a[84:87], v[180:183]
    ds_read_b64_tr_b16 v[50:51], v12 offset:1024
    v_add_f32 v102, v102, v104
    buffer_store_dword v102, v87, s[8:11], s66 offen sc0 sc1
    v_mfma_f32_16x16x32_bf16 v[212:215], v[52:55], a[88:91], v[212:215]
    ds_read_b128 a[108:111], v28 offset:6144
    v_sub_f32 v111, v75, v108
    v_mfma_f32_16x16x32_bf16 v[244:247], v[52:55], a[92:95], v[244:247]
    buffer_load_dwordx4 v20, s[16:19], s98 offen offset:0 nt lds
    v_mfma_f32_16x16x32_bf16 v[152:155], v[56:59], a[80:83], v[152:155]
    ds_read_b64_tr_b16 v[52:53], v13 offset:0
    v_fmac_f32 v109, v111, v111
    v_mfma_f32_16x16x32_bf16 v[184:187], v[56:59], a[84:87], v[184:187]
    ds_read_b64_tr_b16 v[54:55], v13 offset:1024
    v_sub_f32 v110, v76, v108
    v_mfma_f32_16x16x32_bf16 v[216:219], v[56:59], a[88:91], v[216:219]
    buffer_load_dwordx4 v21, s[16:19], s98 offen offset:1024 nt lds
    v_mfma_f32_16x16x32_bf16 v[248:251], v[56:59], a[92:95], v[248:251]
    v_fmac_f32 v109, v110, v110
    v_sub_f32 v111, v77, v108
    v_mfma_f32_16x16x32_bf16 v[156:159], v[60:63], a[80:83], v[156:159]
    ds_read_b64_tr_b16 v[56:57], v14 offset:0
    v_fmac_f32 v109, v111, v111
    v_mfma_f32_16x16x32_bf16 v[188:191], v[60:63], a[84:87], v[188:191]
    ds_read_b64_tr_b16 v[58:59], v14 offset:1024
    v_sub_f32 v110, v78, v108
    v_mfma_f32_16x16x32_bf16 v[220:223], v[60:63], a[88:91], v[220:223]
    buffer_load_dwordx4 v22, s[16:19], s98 offen offset:2048 nt lds
    v_mfma_f32_16x16x32_bf16 v[252:255], v[60:63], a[92:95], v[252:255]
    s_waitcnt lgkmcnt(11)
    v_fmac_f32 v109, v110, v110
    v_sub_f32 v111, v79, v108
    v_mfma_f32_16x16x32_bf16 v[128:131], v[32:35], a[96:99], v[128:131]
    s_waitcnt lgkmcnt(8)
    ds_read_b64_tr_b16 v[60:61], v15 offset:0
    v_fmac_f32 v109, v111, v111
    v_mfma_f32_16x16x32_bf16 v[160:163], v[32:35], a[100:103], v[160:163]
    s_waitcnt lgkmcnt(8)
    ds_read_b64_tr_b16 v[62:63], v15 offset:1024
    v_add_f32_dpp v109, v109, v109 row_ror:8 row_mask:0xf bank_mask:0xf
    v_mfma_f32_16x16x32_bf16 v[192:195], v[32:35], a[104:107], v[192:195]
    s_waitcnt lgkmcnt(6)
    ds_read_b128 a[112:115], v29 offset:0
    v_mov_b32 v110, v109
    v_mfma_f32_16x16x32_bf16 v[224:227], v[32:35], a[108:111], v[224:227]
    ds_read_b128 a[116:119], v29 offset:2048
    v_permlane16_swap_b32 v109, v110
    v_mfma_f32_16x16x32_bf16 v[132:135], v[36:39], a[96:99], v[132:135]
    ds_read_b64_tr_b16 v[32:33], v8 offset:8192
    v_add_f32 v109, v109, v110
    v_mfma_f32_16x16x32_bf16 v[164:167], v[36:39], a[100:103], v[164:167]
    ds_read_b64_tr_b16 v[34:35], v8 offset:9216
    v_mov_b32 v110, v109
    v_mfma_f32_16x16x32_bf16 v[196:199], v[36:39], a[104:107], v[196:199]
    ds_read_b128 a[120:123], v29 offset:4096
    v_permlane32_swap_b32 v109, v110
    v_mfma_f32_16x16x32_bf16 v[228:231], v[36:39], a[108:111], v[228:231]
    ds_read_b128 a[124:127], v29 offset:6144
    v_add_f32 v109, v109, v110
    v_mfma_f32_16x16x32_bf16 v[136:139], v[40:43], a[96:99], v[136:139]
    ds_read_b64_tr_b16 v[36:37], v9 offset:8192
    v_mfma_f32_16x16x32_bf16 v[168:171], v[40:43], a[100:103], v[168:171]
    ds_read_b64_tr_b16 v[38:39], v9 offset:9216
    v_mfma_f32_16x16x32_bf16 v[200:203], v[40:43], a[104:107], v[200:203]
    buffer_load_dwordx4 v23, s[16:19], s98 offen offset:3072 nt lds
    v_mfma_f32_16x16x32_bf16 v[232:235], v[40:43], a[108:111], v[232:235]
    ds_write_b64 v100, v[108:109]
    v_mfma_f32_16x16x32_bf16 v[140:143], v[44:47], a[96:99], v[140:143]
    s_add_u32 m0, s62, 65536
    s_xor_b32 s98, s96, 640
    ds_read_b64_tr_b16 v[40:41], v10 offset:8192
    v_mfma_f32_16x16x32_bf16 v[172:175], v[44:47], a[100:103], v[172:175]
    ds_read_b64_tr_b16 v[42:43], v10 offset:9216
    v_mfma_f32_16x16x32_bf16 v[204:207], v[44:47], a[104:107], v[204:207]
    buffer_load_dwordx4 v16, s[12:15], s98 offen offset:0  lds
    v_mfma_f32_16x16x32_bf16 v[236:239], v[44:47], a[108:111], v[236:239]
    v_mfma_f32_16x16x32_bf16 v[144:147], v[48:51], a[96:99], v[144:147]
    ds_read_b64_tr_b16 v[44:45], v11 offset:8192
    v_mfma_f32_16x16x32_bf16 v[176:179], v[48:51], a[100:103], v[176:179]
    ds_read_b64_tr_b16 v[46:47], v11 offset:9216
    v_mfma_f32_16x16x32_bf16 v[208:211], v[48:51], a[104:107], v[208:211]
    buffer_load_dwordx4 v17, s[12:15], s98 offen offset:1024  lds
    v_mfma_f32_16x16x32_bf16 v[240:243], v[48:51], a[108:111], v[240:243]
    s_waitcnt lgkmcnt(15)
    v_mfma_f32_16x16x32_bf16 v[148:151], v[52:55], a[96:99], v[148:151]
    ds_read_b64_tr_b16 v[48:49], v12 offset:8192
    v_mfma_f32_16x16x32_bf16 v[180:183], v[52:55], a[100:103], v[180:183]
    ds_read_b64_tr_b16 v[50:51], v12 offset:9216
    v_mfma_f32_16x16x32_bf16 v[212:215], v[52:55], a[104:107], v[212:215]
    buffer_load_dwordx4 v18, s[12:15], s98 offen offset:2048  lds
    v_mfma_f32_16x16x32_bf16 v[244:247], v[52:55], a[108:111], v[244:247]
    v_mfma_f32_16x16x32_bf16 v[152:155], v[56:59], a[96:99], v[152:155]
    ds_read_b64_tr_b16 v[52:53], v13 offset:8192
    v_mfma_f32_16x16x32_bf16 v[184:187], v[56:59], a[100:103], v[184:187]
    ds_read_b64_tr_b16 v[54:55], v13 offset:9216
    v_mfma_f32_16x16x32_bf16 v[216:219], v[56:59], a[104:107], v[216:219]
    buffer_load_dwordx4 v19, s[12:15], s98 offen offset:3072  lds
    v_mfma_f32_16x16x32_bf16 v[248:251], v[56:59], a[108:111], v[248:251]
    s_waitcnt lgkmcnt(15)
    v_mfma_f32_16x16x32_bf16 v[156:159], v[60:63], a[96:99], v[156:159]
    s_add_u32 m0, s62, 69632
    s_xor_b32 s98, s96, 33408
    ds_read_b64_tr_b16 v[56:57], v14 offset:8192
    v_mfma_f32_16x16x32_bf16 v[188:191], v[60:63], a[100:103], v[188:191]
    ds_read_b64_tr_b16 v[58:59], v14 offset:9216
    v_mfma_f32_16x16x32_bf16 v[220:223], v[60:63], a[104:107], v[220:223]
    buffer_load_dwordx4 v16, s[12:15], s98 offen offset:0  lds
    v_mfma_f32_16x16x32_bf16 v[252:255], v[60:63], a[108:111], v[252:255]
    s_waitcnt lgkmcnt(15)
    v_mfma_f32_16x16x32_bf16 v[128:131], v[32:35], a[112:115], v[128:131]
    ds_read_b64_tr_b16 v[60:61], v15 offset:8192
    v_mfma_f32_16x16x32_bf16 v[160:163], v[32:35], a[116:119], v[160:163]
    s_waitcnt lgkmcnt(14)
    ds_read_b64_tr_b16 v[62:63], v15 offset:9216
    v_mfma_f32_16x16x32_bf16 v[192:195], v[32:35], a[120:123], v[192:195]
    buffer_load_dwordx4 v17, s[12:15], s98 offen offset:1024  lds
    v_mfma_f32_16x16x32_bf16 v[224:227], v[32:35], a[124:127], v[224:227]
    s_waitcnt lgkmcnt(13)
    v_mfma_f32_16x16x32_bf16 v[132:135], v[36:39], a[112:115], v[132:135]
    buffer_load_dwordx4 v18, s[12:15], s98 offen offset:2048  lds
    v_mfma_f32_16x16x32_bf16 v[164:167], v[36:39], a[116:119], v[164:167]
    v_mfma_f32_16x16x32_bf16 v[196:199], v[36:39], a[120:123], v[196:199]
    buffer_load_dwordx4 v19, s[12:15], s98 offen offset:3072  lds
    s_cmp_eq_u32 s3, 2
    s_cselect_b32 s101, s100, 2147479552
    buffer_load_dword a244, v117, s[24:27], s101 offen nt
    buffer_load_dword a245, v117, s[24:27], s101 offen offset:4
    v_mfma_f32_16x16x32_bf16 v[228:231], v[36:39], a[124:127], v[228:231]
    s_waitcnt lgkmcnt(10)
    v_mfma_f32_16x16x32_bf16 v[136:139], v[40:43], a[112:115], v[136:139]
    s_waitcnt vmcnt(17) lgkmcnt(0)
    s_barrier
    v_mfma_f32_16x16x32_bf16 v[168:171], v[40:43], a[116:119], v[168:171]
    s_add_u32 m0, s63, 98304
    s_xor_b32 s98, s97, 3145728
    ds_read_b64_tr_b16 v[32:33], v8 offset:16384
    v_mfma_f32_16x16x32_bf16 v[200:203], v[40:43], a[120:123], v[200:203]
    ds_read_b64_tr_b16 v[34:35], v8 offset:17408
    v_mfma_f32_16x16x32_bf16 v[232:235], v[40:43], a[124:127], v[232:235]
    ds_read_b64_tr_b16 v[36:37], v9 offset:16384
    v_mfma_f32_16x16x32_bf16 v[140:143], v[44:47], a[112:115], v[140:143]
    ds_read_b64_tr_b16 v[38:39], v9 offset:17408
    v_mfma_f32_16x16x32_bf16 v[172:175], v[44:47], a[116:119], v[172:175]
    ds_read_b64_tr_b16 v[40:41], v10 offset:16384
    v_mfma_f32_16x16x32_bf16 v[204:207], v[44:47], a[120:123], v[204:207]
    ds_read_b64_tr_b16 v[42:43], v10 offset:17408
    v_mfma_f32_16x16x32_bf16 v[236:239], v[44:47], a[124:127], v[236:239]
    ds_read_b128 a[128:131], v28 offset:32768
    v_mfma_f32_16x16x32_bf16 v[144:147], v[48:51], a[112:115], v[144:147]
    ds_read_b64_tr_b16 v[44:45], v11 offset:16384
    v_mfma_f32_16x16x32_bf16 v[176:179], v[48:51], a[116:119], v[176:179]
    ds_read_b64_tr_b16 v[46:47], v11 offset:17408
    s_waitcnt vmcnt(14)
    buffer_atomic_add v6, v7, s[36:39], s69 offen sc1
    v_mfma_f32_16x16x32_bf16 v[208:211], v[48:51], a[120:123], v[208:211]
    ds_read_b128 a[132:135], v28 offset:34816
    v_mfma_f32_16x16x32_bf16 v[240:243], v[48:51], a[124:127], v[240:243]
    ds_read_b128 a[136:139], v28 offset:36864
    v_mfma_f32_16x16x32_bf16 v[148:151], v[52:55], a[112:115], v[148:151]
    ds_read_b64_tr_b16 v[48:49], v12 offset:16384
    v_mfma_f32_16x16x32_bf16 v[180:183], v[52:55], a[116:119], v[180:183]
    ds_read_b64_tr_b16 v[50:51], v12 offset:17408
    v_mfma_f32_16x16x32_bf16 v[212:215], v[52:55], a[120:123], v[212:215]
    ds_read_b128 a[140:143], v28 offset:38912
    v_mfma_f32_16x16x32_bf16 v[244:247], v[52:55], a[124:127], v[244:247]
    buffer_load_dwordx4 v20, s[16:19], s98 offen offset:0 nt lds
    v_mfma_f32_16x16x32_bf16 v[152:155], v[56:59], a[112:115], v[152:155]
    ds_read_b64_tr_b16 v[52:53], v13 offset:16384
    v_mfma_f32_16x16x32_bf16 v[184:187], v[56:59], a[116:119], v[184:187]
    ds_read_b64_tr_b16 v[54:55], v13 offset:17408
    v_mfma_f32_16x16x32_bf16 v[216:219], v[56:59], a[120:123], v[216:219]
    buffer_load_dwordx4 v21, s[16:19], s98 offen offset:1024 nt lds
    v_mfma_f32_16x16x32_bf16 v[248:251], v[56:59], a[124:127], v[248:251]
    ds_read_b128 v[88:91], v99
    v_mfma_f32_16x16x32_bf16 v[156:159], v[60:63], a[112:115], v[156:159]
    ds_read_b64_tr_b16 v[56:57], v14 offset:16384
    v_mfma_f32_16x16x32_bf16 v[188:191], v[60:63], a[116:119], v[188:191]
    ds_read_b64_tr_b16 v[58:59], v14 offset:17408
    v_mfma_f32_16x16x32_bf16 v[220:223], v[60:63], a[120:123], v[220:223]
    buffer_load_dwordx4 v22, s[16:19], s98 offen offset:2048 nt lds
    v_mfma_f32_16x16x32_bf16 v[252:255], v[60:63], a[124:127], v[252:255]
    s_waitcnt lgkmcnt(12)
    ds_read_b128 v[92:95], v99 offset:16
    v_mfma_f32_16x16x32_bf16 v[128:131], v[32:35], a[128:131], v[128:131]
    s_waitcnt lgkmcnt(10)
    ds_read_b64_tr_b16 v[60:61], v15 offset:16384
    v_mfma_f32_16x16x32_bf16 v[160:163], v[32:35], a[132:135], v[160:163]
    s_waitcnt lgkmcnt(10)
    ds_read_b64_tr_b16 v[62:63], v15 offset:17408
    v_mfma_f32_16x16x32_bf16 v[192:195], v[32:35], a[136:139], v[192:195]
    s_waitcnt lgkmcnt(8)
    ds_read_b128 a[144:147], v29 offset:32768
    v_mfma_f32_16x16x32_bf16 v[224:227], v[32:35], a[140:143], v[224:227]
    ds_read_b128 a[148:151], v29 offset:34816
    v_mfma_f32_16x16x32_bf16 v[132:135], v[36:39], a[128:131], v[132:135]
    ds_read_b64_tr_b16 v[32:33], v8 offset:24576
    v_mfma_f32_16x16x32_bf16 v[164:167], v[36:39], a[132:135], v[164:167]
    ds_read_b64_tr_b16 v[34:35], v8 offset:25600
    v_mfma_f32_16x16x32_bf16 v[196:199], v[36:39], a[136:139], v[196:199]
    ds_read_b128 a[152:155], v29 offset:36864
    v_mfma_f32_16x16x32_bf16 v[228:231], v[36:39], a[140:143], v[228:231]
    ds_read_b128 a[156:159], v29 offset:38912
    s_waitcnt lgkmcnt(11)
    v_add_f32 v108, v88, v90
    v_mfma_f32_16x16x32_bf16 v[136:139], v[40:43], a[128:131], v[136:139]
    ds_read_b64_tr_b16 v[36:37], v9 offset:24576
    s_waitcnt lgkmcnt(9)
    v_add_f32 v109, v92, v94
    v_mfma_f32_16x16x32_bf16 v[168:171], v[40:43], a[132:135], v[168:171]
    ds_read_b64_tr_b16 v[38:39], v9 offset:25600
    v_add_f32 v108, v108, v109
    v_mfma_f32_16x16x32_bf16 v[200:203], v[40:43], a[136:139], v[200:203]
    buffer_load_dwordx4 v23, s[16:19], s98 offen offset:3072 nt lds
    v_mfma_f32_16x16x32_bf16 v[232:235], v[40:43], a[140:143], v[232:235]
    v_mul_f32 v108, 0x3e800000, v108
    v_add_f32 v109, v89, v91
    v_mfma_f32_16x16x32_bf16 v[140:143], v[44:47], a[128:131], v[140:143]
    s_add_u32 m0, s62, 0
    s_xor_b32 s98, s96, 768
    ds_read_b64_tr_b16 v[40:41], v10 offset:24576
    v_mfma_f32_16x16x32_bf16 v[172:175], v[44:47], a[132:135], v[172:175]
    ds_read_b64_tr_b16 v[42:43], v10 offset:25600
    v_add_f32 v110, v93, v95
    v_mfma_f32_16x16x32_bf16 v[204:207], v[44:47], a[136:139], v[204:207]
    buffer_load_dwordx4 v16, s[12:15], s98 offen offset:0  lds
    v_mfma_f32_16x16x32_bf16 v[236:239], v[44:47], a[140:143], v[236:239]
    v_add_f32 v109, v109, v110
    v_sub_f32 v88, v88, v108
    v_mfma_f32_16x16x32_bf16 v[144:147], v[48:51], a[128:131], v[144:147]
    ds_read_b64_tr_b16 v[44:45], v11 offset:24576
    v_sub_f32 v90, v90, v108
    v_mfma_f32_16x16x32_bf16 v[176:179], v[48:51], a[132:135], v[176:179]
    ds_read_b64_tr_b16 v[46:47], v11 offset:25600
    v_sub_f32 v92, v92, v108
    v_mfma_f32_16x16x32_bf16 v[208:211], v[48:51], a[136:139], v[208:211]
    buffer_load_dwordx4 v17, s[12:15], s98 offen offset:1024  lds
    v_mfma_f32_16x16x32_bf16 v[240:243], v[48:51], a[140:143], v[240:243]
    v_sub_f32 v94, v94, v108
    v_mul_f32 v110, v88, v88
    v_mfma_f32_16x16x32_bf16 v[148:151], v[52:55], a[128:131], v[148:151]
    ds_read_b64_tr_b16 v[48:49], v12 offset:24576
    v_fmac_f32 v110, v90, v90
    v_mfma_f32_16x16x32_bf16 v[180:183], v[52:55], a[132:135], v[180:183]
    ds_read_b64_tr_b16 v[50:51], v12 offset:25600
    v_fmac_f32 v110, v92, v92
    v_mfma_f32_16x16x32_bf16 v[212:215], v[52:55], a[136:139], v[212:215]
    buffer_load_dwordx4 v18, s[12:15], s98 offen offset:2048  lds
    v_mfma_f32_16x16x32_bf16 v[244:247], v[52:55], a[140:143], v[244:247]
    v_fmac_f32 v110, v94, v94
    v_fmac_f32 v109, 0x43000000, v110
    v_mfma_f32_16x16x32_bf16 v[152:155], v[56:59], a[128:131], v[152:155]
    ds_read_b64_tr_b16 v[52:53], v13 offset:24576
    v_mov_b32 v110, 0x3727c5ac
    v_mfma_f32_16x16x32_bf16 v[184:187], v[56:59], a[132:135], v[184:187]
    ds_read_b64_tr_b16 v[54:55], v13 offset:25600
    v_fmac_f32 v110, 0x3b000000, v109
    v_mfma_f32_16x16x32_bf16 v[216:219], v[56:59], a[136:139], v[216:219]
    buffer_load_dwordx4 v19, s[12:15], s98 offen offset:3072  lds
    v_mfma_f32_16x16x32_bf16 v[248:251], v[56:59], a[140:143], v[248:251]
    s_waitcnt lgkmcnt(15)
    v_rsq_f32 v110, v110
    v_mfma_f32_16x16x32_bf16 v[156:159], v[60:63], a[128:131], v[156:159]
    s_add_u32 m0, s62, 4096
    s_xor_b32 s98, s96, 33536
    ds_read_b64_tr_b16 v[56:57], v14 offset:24576
    v_mfma_f32_16x16x32_bf16 v[188:191], v[60:63], a[132:135], v[188:191]
    ds_read_b64_tr_b16 v[58:59], v14 offset:25600
    v_sub_f32 v64, v64, v108
    v_mfma_f32_16x16x32_bf16 v[220:223], v[60:63], a[136:139], v[220:223]
    buffer_load_dwordx4 v16, s[12:15], s98 offen offset:0  lds
    v_mfma_f32_16x16x32_bf16 v[252:255], v[60:63], a[140:143], v[252:255]
    s_waitcnt lgkmcnt(14)
    v_sub_f32 v65, v65, v108
    v_sub_f32 v66, v66, v108
    v_mfma_f32_16x16x32_bf16 v[128:131], v[32:35], a[144:147], v[128:131]
    ds_read_b64_tr_b16 v[60:61], v15 offset:24576
    v_sub_f32 v67, v67, v108
    v_mfma_f32_16x16x32_bf16 v[160:163], v[32:35], a[148:151], v[160:163]
    s_waitcnt lgkmcnt(13)
    ds_read_b64_tr_b16 v[62:63], v15 offset:25600
    v_sub_f32 v68, v68, v108
    v_mfma_f32_16x16x32_bf16 v[192:195], v[32:35], a[152:155], v[192:195]
    buffer_load_dwordx4 v17, s[12:15], s98 offen offset:1024  lds
    v_mfma_f32_16x16x32_bf16 v[224:227], v[32:35], a[156:159], v[224:227]
    s_waitcnt lgkmcnt(12)
    v_sub_f32 v69, v69, v108
    v_sub_f32 v70, v70, v108
    v_mfma_f32_16x16x32_bf16 v[132:135], v[36:39], a[144:147], v[132:135]
    buffer_load_dwordx4 v18, s[12:15], s98 offen offset:2048  lds
    v_mfma_f32_16x16x32_bf16 v[164:167], v[36:39], a[148:151], v[164:167]
    v_sub_f32 v71, v71, v108
    v_sub_f32 v72, v72, v108
    v_mfma_f32_16x16x32_bf16 v[196:199], v[36:39], a[152:155], v[196:199]
    buffer_load_dwordx4 v19, s[12:15], s98 offen offset:3072  lds
    s_cmp_eq_u32 s3, 3
    s_cselect_b32 s101, s100, 2147479552
    buffer_load_dword a246, v117, s[24:27], s101 offen nt
    buffer_load_dword a247, v117, s[24:27], s101 offen offset:4
    v_mfma_f32_16x16x32_bf16 v[228:231], v[36:39], a[156:159], v[228:231]
    s_waitcnt lgkmcnt(10)
    v_sub_f32 v73, v73, v108
    v_sub_f32 v74, v74, v108
    v_mfma_f32_16x16x32_bf16 v[136:139], v[40:43], a[144:147], v[136:139]
    v_sub_f32 v75, v75, v108
    v_sub_f32 v76, v76, v108
    s_waitcnt vmcnt(17) lgkmcnt(0)
    s_barrier
    v_mfma_f32_16x16x32_bf16 v[168:171], v[40:43], a[148:151], v[168:171]
    s_add_u32 m0, s63, 114688
    s_xor_b32 s98, s97, 3670016
    ds_read_b64_tr_b16 v[32:33], v8 offset:32768
    v_mfma_f32_16x16x32_bf16 v[200:203], v[40:43], a[152:155], v[200:203]
    ds_read_b64_tr_b16 v[34:35], v8 offset:33792
    v_sub_f32 v77, v77, v108
    v_mfma_f32_16x16x32_bf16 v[232:235], v[40:43], a[156:159], v[232:235]
    ds_read_b64_tr_b16 v[36:37], v9 offset:32768
    v_sub_f32 v78, v78, v108
    v_mfma_f32_16x16x32_bf16 v[140:143], v[44:47], a[144:147], v[140:143]
    ds_read_b64_tr_b16 v[38:39], v9 offset:33792
    v_sub_f32 v79, v79, v108
    v_mfma_f32_16x16x32_bf16 v[172:175], v[44:47], a[148:151], v[172:175]
    ds_read_b64_tr_b16 v[40:41], v10 offset:32768
    v_mul_f32 v64, v64, v110
    v_mfma_f32_16x16x32_bf16 v[204:207], v[44:47], a[152:155], v[204:207]
    ds_read_b64_tr_b16 v[42:43], v10 offset:33792
    v_mul_f32 v65, v65, v110
    v_mfma_f32_16x16x32_bf16 v[236:239], v[44:47], a[156:159], v[236:239]
    ds_read_b128 a[160:163], v30 offset:0
    v_mul_f32 v66, v66, v110
    v_mfma_f32_16x16x32_bf16 v[144:147], v[48:51], a[144:147], v[144:147]
    ds_read_b64_tr_b16 v[44:45], v11 offset:32768
    v_mul_f32 v67, v67, v110
    v_mfma_f32_16x16x32_bf16 v[176:179], v[48:51], a[148:151], v[176:179]
    ds_read_b64_tr_b16 v[46:47], v11 offset:33792
    v_mul_f32 v68, v68, v110
    v_mfma_f32_16x16x32_bf16 v[208:211], v[48:51], a[152:155], v[208:211]
    ds_read_b128 a[164:167], v30 offset:2048
    v_mul_f32 v69, v69, v110
    v_mfma_f32_16x16x32_bf16 v[240:243], v[48:51], a[156:159], v[240:243]
    ds_read_b128 a[168:171], v30 offset:4096
    v_mul_f32 v70, v70, v110
    v_mfma_f32_16x16x32_bf16 v[148:151], v[52:55], a[144:147], v[148:151]
    ds_read_b64_tr_b16 v[48:49], v12 offset:32768
    v_mul_f32 v71, v71, v110
    v_mfma_f32_16x16x32_bf16 v[180:183], v[52:55], a[148:151], v[180:183]
    ds_read_b64_tr_b16 v[50:51], v12 offset:33792
    v_mul_f32 v72, v72, v110
    v_mfma_f32_16x16x32_bf16 v[212:215], v[52:55], a[152:155], v[212:215]
    ds_read_b128 a[172:175], v30 offset:6144
    v_mul_f32 v73, v73, v110
    v_mfma_f32_16x16x32_bf16 v[244:247], v[52:55], a[156:159], v[244:247]
    buffer_load_dwordx4 v20, s[16:19], s98 offen offset:0 nt lds
    v_mfma_f32_16x16x32_bf16 v[152:155], v[56:59], a[144:147], v[152:155]
    ds_read_b64_tr_b16 v[52:53], v13 offset:32768
    v_mul_f32 v74, v74, v110
    v_mfma_f32_16x16x32_bf16 v[184:187], v[56:59], a[148:151], v[184:187]
    ds_read_b64_tr_b16 v[54:55], v13 offset:33792
    v_mul_f32 v75, v75, v110
    v_mfma_f32_16x16x32_bf16 v[216:219], v[56:59], a[152:155], v[216:219]
    buffer_load_dwordx4 v21, s[16:19], s98 offen offset:1024 nt lds
    v_mfma_f32_16x16x32_bf16 v[248:251], v[56:59], a[156:159], v[248:251]
    v_mul_f32 v76, v76, v110
    v_mul_f32 v77, v77, v110
    v_mfma_f32_16x16x32_bf16 v[156:159], v[60:63], a[144:147], v[156:159]
    ds_read_b64_tr_b16 v[56:57], v14 offset:32768
    v_mul_f32 v78, v78, v110
    v_mfma_f32_16x16x32_bf16 v[188:191], v[60:63], a[148:151], v[188:191]
    ds_read_b64_tr_b16 v[58:59], v14 offset:33792
    v_mul_f32 v79, v79, v110
    v_mfma_f32_16x16x32_bf16 v[220:223], v[60:63], a[152:155], v[220:223]
    buffer_load_dwordx4 v22, s[16:19], s98 offen offset:2048 nt lds
    v_mfma_f32_16x16x32_bf16 v[252:255], v[60:63], a[156:159], v[252:255]
    s_waitcnt lgkmcnt(11)
    v_mfma_f32_16x16x32_bf16 v[128:131], v[32:35], a[160:163], v[128:131]
    s_waitcnt lgkmcnt(8)
    ds_read_b64_tr_b16 v[60:61], v15 offset:32768
    v_and_b32 v96, 31, v2
    v_mfma_f32_16x16x32_bf16 v[160:163], v[32:35], a[164:167], v[160:163]
    s_waitcnt lgkmcnt(8)
    ds_read_b64_tr_b16 v[62:63], v15 offset:33792
    v_lshlrev_b32 v96, 4, v96
    v_mfma_f32_16x16x32_bf16 v[192:195], v[32:35], a[168:171], v[192:195]
    s_waitcnt lgkmcnt(6)
    ds_read_b128 a[176:179], v31 offset:0
    v_lshrrev_b32 v97, 5, v2
    v_mfma_f32_16x16x32_bf16 v[224:227], v[32:35], a[172:175], v[224:227]
    ds_read_b128 a[180:183], v31 offset:2048
    v_lshl_add_u32 v96, v97, 11, v96
    v_mfma_f32_16x16x32_bf16 v[132:135], v[36:39], a[160:163], v[132:135]
    ds_read_b64_tr_b16 v[32:33], v8 offset:40960
    v_mfma_f32_16x16x32_bf16 v[164:167], v[36:39], a[164:167], v[164:167]
    ds_read_b64_tr_b16 v[34:35], v8 offset:41984
    v_mfma_f32_16x16x32_bf16 v[196:199], v[36:39], a[168:171], v[196:199]
    ds_read_b128 a[184:187], v31 offset:4096
    v_mfma_f32_16x16x32_bf16 v[228:231], v[36:39], a[172:175], v[228:231]
    ds_read_b128 a[188:191], v31 offset:6144
    v_mfma_f32_16x16x32_bf16 v[136:139], v[40:43], a[160:163], v[136:139]
    ds_read_b64_tr_b16 v[36:37], v9 offset:40960
    v_mfma_f32_16x16x32_bf16 v[168:171], v[40:43], a[164:167], v[168:171]
    ds_read_b64_tr_b16 v[38:39], v9 offset:41984
    v_mfma_f32_16x16x32_bf16 v[200:203], v[40:43], a[168:171], v[200:203]
    buffer_load_dwordx4 v23, s[16:19], s98 offen offset:3072 nt lds
    buffer_load_dword v3, v4, s[36:39], 0 offen sc0 sc1
    v_mfma_f32_16x16x32_bf16 v[232:235], v[40:43], a[172:175], v[232:235]
    v_mfma_f32_16x16x32_bf16 v[140:143], v[44:47], a[160:163], v[140:143]
    s_add_u32 m0, s62, 32768
    s_xor_b32 s98, s96, 896
    ds_read_b64_tr_b16 v[40:41], v10 offset:40960
    v_mfma_f32_16x16x32_bf16 v[172:175], v[44:47], a[164:167], v[172:175]
    ds_read_b64_tr_b16 v[42:43], v10 offset:41984
    v_mfma_f32_16x16x32_bf16 v[204:207], v[44:47], a[168:171], v[204:207]
    buffer_load_dwordx4 v16, s[12:15], s98 offen offset:0  lds
    v_mfma_f32_16x16x32_bf16 v[236:239], v[44:47], a[172:175], v[236:239]
    v_mfma_f32_16x16x32_bf16 v[144:147], v[48:51], a[160:163], v[144:147]
    ds_read_b64_tr_b16 v[44:45], v11 offset:40960
    v_mfma_f32_16x16x32_bf16 v[176:179], v[48:51], a[164:167], v[176:179]
    ds_read_b64_tr_b16 v[46:47], v11 offset:41984
    v_mfma_f32_16x16x32_bf16 v[208:211], v[48:51], a[168:171], v[208:211]
    buffer_load_dwordx4 v17, s[12:15], s98 offen offset:1024  lds
    v_mfma_f32_16x16x32_bf16 v[240:243], v[48:51], a[172:175], v[240:243]
    s_waitcnt lgkmcnt(15)
    v_mfma_f32_16x16x32_bf16 v[148:151], v[52:55], a[160:163], v[148:151]
    ds_read_b64_tr_b16 v[48:49], v12 offset:40960
    v_mfma_f32_16x16x32_bf16 v[180:183], v[52:55], a[164:167], v[180:183]
    ds_read_b64_tr_b16 v[50:51], v12 offset:41984
    v_mfma_f32_16x16x32_bf16 v[212:215], v[52:55], a[168:171], v[212:215]
    buffer_load_dwordx4 v18, s[12:15], s98 offen offset:2048  lds
    v_mfma_f32_16x16x32_bf16 v[244:247], v[52:55], a[172:175], v[244:247]
    s_waitcnt lgkmcnt(15)
    v_mfma_f32_16x16x32_bf16 v[152:155], v[56:59], a[160:163], v[152:155]
    ds_read_b64_tr_b16 v[52:53], v13 offset:40960
    v_mfma_f32_16x16x32_bf16 v[184:187], v[56:59], a[164:167], v[184:187]
    ds_read_b64_tr_b16 v[54:55], v13 offset:41984
    v_mfma_f32_16x16x32_bf16 v[216:219], v[56:59], a[168:171], v[216:219]
    buffer_load_dwordx4 v19, s[12:15], s98 offen offset:3072  lds
    v_mfma_f32_16x16x32_bf16 v[248:251], v[56:59], a[172:175], v[248:251]
    s_waitcnt lgkmcnt(15)
    v_mfma_f32_16x16x32_bf16 v[156:159], v[60:63], a[160:163], v[156:159]
    s_add_u32 m0, s62, 36864
    s_xor_b32 s98, s96, 33664
    ds_read_b64_tr_b16 v[56:57], v14 offset:40960
    v_mfma_f32_16x16x32_bf16 v[188:191], v[60:63], a[164:167], v[188:191]
    ds_read_b64_tr_b16 v[58:59], v14 offset:41984
    v_mfma_f32_16x16x32_bf16 v[220:223], v[60:63], a[168:171], v[220:223]
    buffer_load_dwordx4 v16, s[12:15], s98 offen offset:0  lds
    v_mfma_f32_16x16x32_bf16 v[252:255], v[60:63], a[172:175], v[252:255]
    s_waitcnt lgkmcnt(14)
    v_mfma_f32_16x16x32_bf16 v[128:131], v[32:35], a[176:179], v[128:131]
    ds_read_b64_tr_b16 v[60:61], v15 offset:40960
    v_mfma_f32_16x16x32_bf16 v[160:163], v[32:35], a[180:183], v[160:163]
    s_waitcnt lgkmcnt(13)
    ds_read_b64_tr_b16 v[62:63], v15 offset:41984
    v_mfma_f32_16x16x32_bf16 v[192:195], v[32:35], a[184:187], v[192:195]
    buffer_load_dwordx4 v17, s[12:15], s98 offen offset:1024  lds
    v_mfma_f32_16x16x32_bf16 v[224:227], v[32:35], a[188:191], v[224:227]
    s_waitcnt lgkmcnt(12)
    v_mfma_f32_16x16x32_bf16 v[132:135], v[36:39], a[176:179], v[132:135]
    buffer_load_dwordx4 v18, s[12:15], s98 offen offset:2048  lds
    v_mfma_f32_16x16x32_bf16 v[164:167], v[36:39], a[180:183], v[164:167]
    v_mfma_f32_16x16x32_bf16 v[196:199], v[36:39], a[184:187], v[196:199]
    buffer_load_dwordx4 v19, s[12:15], s98 offen offset:3072  lds
    v_mfma_f32_16x16x32_bf16 v[228:231], v[36:39], a[188:191], v[228:231]
    s_waitcnt lgkmcnt(10)
    v_mfma_f32_16x16x32_bf16 v[136:139], v[40:43], a[176:179], v[136:139]
    s_waitcnt vmcnt(15) lgkmcnt(0)
    s_barrier
    v_mfma_f32_16x16x32_bf16 v[168:171], v[40:43], a[180:183], v[168:171]
    s_add_u32 m0, s62, 65536
    s_xor_b32 s98, s64, 0
    ds_read_b64_tr_b16 v[32:33], v8 offset:0
    v_mfma_f32_16x16x32_bf16 v[200:203], v[40:43], a[184:187], v[200:203]
    ds_read_b64_tr_b16 v[34:35], v8 offset:1024
    v_mov_b32 v18, v106
    v_mfma_f32_16x16x32_bf16 v[232:235], v[40:43], a[188:191], v[232:235]
    ds_read_b64_tr_b16 v[36:37], v9 offset:0
    v_mov_b32 v19, v107
    v_mfma_f32_16x16x32_bf16 v[140:143], v[44:47], a[176:179], v[140:143]
    ds_read_b64_tr_b16 v[38:39], v9 offset:1024
    v_mfma_f32_16x16x32_bf16 v[172:175], v[44:47], a[180:183], v[172:175]
    ds_read_b64_tr_b16 v[40:41], v10 offset:0
    v_mfma_f32_16x16x32_bf16 v[204:207], v[44:47], a[184:187], v[204:207]
    ds_read_b64_tr_b16 v[42:43], v10 offset:1024
    v_mfma_f32_16x16x32_bf16 v[236:239], v[44:47], a[188:191], v[236:239]
    ds_read_b128 a[192:195], v28 offset:0
    v_mfma_f32_16x16x32_bf16 v[144:147], v[48:51], a[176:179], v[144:147]
    ds_read_b64_tr_b16 v[44:45], v11 offset:0
    v_mfma_f32_16x16x32_bf16 v[176:179], v[48:51], a[180:183], v[176:179]
    ds_read_b64_tr_b16 v[46:47], v11 offset:1024
    v_mfma_f32_16x16x32_bf16 v[208:211], v[48:51], a[184:187], v[208:211]
    ds_read_b128 a[196:199], v28 offset:2048
    v_mfma_f32_16x16x32_bf16 v[240:243], v[48:51], a[188:191], v[240:243]
    ds_read_b128 a[200:203], v28 offset:4096
    v_mfma_f32_16x16x32_bf16 v[148:151], v[52:55], a[176:179], v[148:151]
    ds_read_b64_tr_b16 v[48:49], v12 offset:0
    v_mfma_f32_16x16x32_bf16 v[180:183], v[52:55], a[180:183], v[180:183]
    ds_read_b64_tr_b16 v[50:51], v12 offset:1024
    v_mfma_f32_16x16x32_bf16 v[212:215], v[52:55], a[184:187], v[212:215]
    ds_read_b128 a[204:207], v28 offset:6144
    v_mfma_f32_16x16x32_bf16 v[244:247], v[52:55], a[188:191], v[244:247]
    buffer_load_dwordx4 v24, s[20:23], s98 offen offset:0  lds
    v_mfma_f32_16x16x32_bf16 v[152:155], v[56:59], a[176:179], v[152:155]
    ds_read_b64_tr_b16 v[52:53], v13 offset:0
    v_mfma_f32_16x16x32_bf16 v[184:187], v[56:59], a[180:183], v[184:187]
    ds_read_b64_tr_b16 v[54:55], v13 offset:1024
    v_mfma_f32_16x16x32_bf16 v[216:219], v[56:59], a[184:187], v[216:219]
    v_mfma_f32_16x16x32_bf16 v[248:251], v[56:59], a[188:191], v[248:251]
    buffer_load_dwordx4 v25, s[20:23], s98 offen offset:1024  lds
    v_mfma_f32_16x16x32_bf16 v[156:159], v[60:63], a[176:179], v[156:159]
    ds_read_b64_tr_b16 v[56:57], v14 offset:0
    v_mfma_f32_16x16x32_bf16 v[188:191], v[60:63], a[180:183], v[188:191]
    ds_read_b64_tr_b16 v[58:59], v14 offset:1024
    v_mfma_f32_16x16x32_bf16 v[220:223], v[60:63], a[184:187], v[220:223]
    s_waitcnt lgkmcnt(11)
    v_mfma_f32_16x16x32_bf16 v[252:255], v[60:63], a[188:191], v[252:255]
    buffer_load_dwordx4 v26, s[20:23], s98 offen offset:2048  lds
    v_mfma_f32_16x16x32_bf16 v[128:131], v[32:35], a[192:195], v[128:131]
    s_waitcnt lgkmcnt(8)
    ds_read_b64_tr_b16 v[60:61], v15 offset:0
    v_mfma_f32_16x16x32_bf16 v[160:163], v[32:35], a[196:199], v[160:163]
    s_waitcnt lgkmcnt(8)
    ds_read_b64_tr_b16 v[62:63], v15 offset:1024
    v_mfma_f32_16x16x32_bf16 v[192:195], v[32:35], a[200:203], v[192:195]
    s_waitcnt lgkmcnt(6)
    ds_read_b128 a[208:211], v29 offset:0
    v_mfma_f32_16x16x32_bf16 v[224:227], v[32:35], a[204:207], v[224:227]
    ds_read_b128 a[212:215], v29 offset:2048
    v_mfma_f32_16x16x32_bf16 v[132:135], v[36:39], a[192:195], v[132:135]
    ds_read_b64_tr_b16 v[32:33], v8 offset:8192
    v_mfma_f32_16x16x32_bf16 v[164:167], v[36:39], a[196:199], v[164:167]
    ds_read_b64_tr_b16 v[34:35], v8 offset:9216
    v_mfma_f32_16x16x32_bf16 v[196:199], v[36:39], a[200:203], v[196:199]
    ds_read_b128 a[216:219], v29 offset:4096
    s_waitcnt vmcnt(11)
    v_cmp_le_u32 vcc, 64, v3
    s_cmp_eq_u64 vcc, -1
    s_cbranch_scc0 L_E_slow_1
L_E_ok_2:
    v_mfma_f32_16x16x32_bf16 v[228:231], v[36:39], a[204:207], v[228:231]
    ds_read_b128 a[220:223], v29 offset:6144
    v_mfma_f32_16x16x32_bf16 v[136:139], v[40:43], a[192:195], v[136:139]
    ds_read_b64_tr_b16 v[36:37], v9 offset:8192
    v_mfma_f32_16x16x32_bf16 v[168:171], v[40:43], a[196:199], v[168:171]
    ds_read_b64_tr_b16 v[38:39], v9 offset:9216
    v_mfma_f32_16x16x32_bf16 v[200:203], v[40:43], a[200:203], v[200:203]
    buffer_load_dwordx4 v27, s[20:23], s98 offen offset:3072  lds
    v_mfma_f32_16x16x32_bf16 v[232:235], v[40:43], a[204:207], v[232:235]
    buffer_load_dwordx4 v[80:83], v96, s[8:11], s70 offen
    v_mfma_f32_16x16x32_bf16 v[140:143], v[44:47], a[192:195], v[140:143]
    s_add_u32 m0, s62, 69632
    s_xor_b32 s98, s64, 262144
    ds_read_b64_tr_b16 v[40:41], v10 offset:8192
    v_mfma_f32_16x16x32_bf16 v[172:175], v[44:47], a[196:199], v[172:175]
    s_add_u32 s70, s70, 12288
    ds_read_b64_tr_b16 v[42:43], v10 offset:9216
    v_mfma_f32_16x16x32_bf16 v[204:207], v[44:47], a[200:203], v[204:207]
    buffer_load_dwordx4 v24, s[20:23], s98 offen offset:0  lds
    v_mfma_f32_16x16x32_bf16 v[236:239], v[44:47], a[204:207], v[236:239]
    buffer_load_dwordx4 v[84:87], v96, s[8:11], s70 offen
    v_mfma_f32_16x16x32_bf16 v[144:147], v[48:51], a[192:195], v[144:147]
    s_add_u32 s70, s70, 12288
    ds_read_b64_tr_b16 v[44:45], v11 offset:8192
    v_mfma_f32_16x16x32_bf16 v[176:179], v[48:51], a[196:199], v[176:179]
    s_waitcnt lgkmcnt(15)
    ds_read_b64_tr_b16 v[46:47], v11 offset:9216
    v_mfma_f32_16x16x32_bf16 v[208:211], v[48:51], a[200:203], v[208:211]
    buffer_load_dwordx4 v25, s[20:23], s98 offen offset:1024  lds
    v_mfma_f32_16x16x32_bf16 v[240:243], v[48:51], a[204:207], v[240:243]
    buffer_load_dwordx4 v[88:91], v96, s[8:11], s70 offen
    v_mfma_f32_16x16x32_bf16 v[148:151], v[52:55], a[192:195], v[148:151]
    s_add_u32 s70, s70, 12288
    ds_read_b64_tr_b16 v[48:49], v12 offset:8192
    v_mfma_f32_16x16x32_bf16 v[180:183], v[52:55], a[196:199], v[180:183]
    s_waitcnt lgkmcnt(15)
    ds_read_b64_tr_b16 v[50:51], v12 offset:9216
    v_mfma_f32_16x16x32_bf16 v[212:215], v[52:55], a[200:203], v[212:215]
    buffer_load_dwordx4 v26, s[20:23], s98 offen offset:2048  lds
    v_mfma_f32_16x16x32_bf16 v[244:247], v[52:55], a[204:207], v[244:247]
    buffer_load_dwordx4 v[92:95], v96, s[8:11], s70 offen
    v_mfma_f32_16x16x32_bf16 v[152:155], v[56:59], a[192:195], v[152:155]
    ds_read_b64_tr_b16 v[52:53], v13 offset:8192
    v_mfma_f32_16x16x32_bf16 v[184:187], v[56:59], a[196:199], v[184:187]
    ds_read_b64_tr_b16 v[54:55], v13 offset:9216
    v_mfma_f32_16x16x32_bf16 v[216:219], v[56:59], a[200:203], v[216:219]
    buffer_load_dwordx4 v27, s[20:23], s98 offen offset:3072  lds
    v_mfma_f32_16x16x32_bf16 v[248:251], v[56:59], a[204:207], v[248:251]
    s_waitcnt lgkmcnt(15)
    v_mfma_f32_16x16x32_bf16 v[156:159], v[60:63], a[192:195], v[156:159]
    ds_read_b64_tr_b16 v[56:57], v14 offset:8192
    v_mfma_f32_16x16x32_bf16 v[188:191], v[60:63], a[196:199], v[188:191]
    ds_read_b64_tr_b16 v[58:59], v14 offset:9216
    v_mfma_f32_16x16x32_bf16 v[220:223], v[60:63], a[200:203], v[220:223]
    v_mfma_f32_16x16x32_bf16 v[252:255], v[60:63], a[204:207], v[252:255]
    s_waitcnt lgkmcnt(14)
    v_mfma_f32_16x16x32_bf16 v[128:131], v[32:35], a[208:211], v[128:131]
    ds_read_b64_tr_b16 v[60:61], v15 offset:8192
    v_mfma_f32_16x16x32_bf16 v[160:163], v[32:35], a[212:215], v[160:163]
    s_waitcnt lgkmcnt(14)
    ds_read_b64_tr_b16 v[62:63], v15 offset:9216
    v_mfma_f32_16x16x32_bf16 v[192:195], v[32:35], a[216:219], v[192:195]
    s_waitcnt lgkmcnt(14)
    v_mfma_f32_16x16x32_bf16 v[224:227], v[32:35], a[220:223], v[224:227]
    s_waitcnt lgkmcnt(12)
    v_mfma_f32_16x16x32_bf16 v[132:135], v[36:39], a[208:211], v[132:135]
    v_mfma_f32_16x16x32_bf16 v[164:167], v[36:39], a[212:215], v[164:167]
    v_mfma_f32_16x16x32_bf16 v[196:199], v[36:39], a[216:219], v[196:199]
    v_mfma_f32_16x16x32_bf16 v[228:231], v[36:39], a[220:223], v[228:231]
    s_waitcnt lgkmcnt(10)
    v_mfma_f32_16x16x32_bf16 v[136:139], v[40:43], a[208:211], v[136:139]
    s_waitcnt vmcnt(12) lgkmcnt(0)
    s_barrier
    v_mfma_f32_16x16x32_bf16 v[168:171], v[40:43], a[212:215], v[168:171]
    s_add_u32 m0, s62, 0
    s_xor_b32 s98, s64, 2097152
    ds_read_b64_tr_b16 v[32:33], v8 offset:16384
    v_mfma_f32_16x16x32_bf16 v[200:203], v[40:43], a[216:219], v[200:203]
    ds_read_b64_tr_b16 v[34:35], v8 offset:17408
    v_mfma_f32_16x16x32_bf16 v[232:235], v[40:43], a[220:223], v[232:235]
    ds_read_b64_tr_b16 v[36:37], v9 offset:16384
    v_mfma_f32_16x16x32_bf16 v[140:143], v[44:47], a[208:211], v[140:143]
    ds_read_b64_tr_b16 v[38:39], v9 offset:17408
    v_mfma_f32_16x16x32_bf16 v[172:175], v[44:47], a[212:215], v[172:175]
    ds_read_b64_tr_b16 v[40:41], v10 offset:16384
    v_mfma_f32_16x16x32_bf16 v[204:207], v[44:47], a[216:219], v[204:207]
    ds_read_b64_tr_b16 v[42:43], v10 offset:17408
    v_mfma_f32_16x16x32_bf16 v[236:239], v[44:47], a[220:223], v[236:239]
    ds_read_b128 a[224:227], v28 offset:32768
    v_mfma_f32_16x16x32_bf16 v[144:147], v[48:51], a[208:211], v[144:147]
    ds_read_b64_tr_b16 v[44:45], v11 offset:16384
    v_mfma_f32_16x16x32_bf16 v[176:179], v[48:51], a[212:215], v[176:179]
    ds_read_b64_tr_b16 v[46:47], v11 offset:17408
    v_mfma_f32_16x16x32_bf16 v[208:211], v[48:51], a[216:219], v[208:211]
    ds_read_b128 a[228:231], v28 offset:34816
    v_mfma_f32_16x16x32_bf16 v[240:243], v[48:51], a[220:223], v[240:243]
    ds_read_b128 a[232:235], v28 offset:36864
    v_mfma_f32_16x16x32_bf16 v[148:151], v[52:55], a[208:211], v[148:151]
    ds_read_b64_tr_b16 v[48:49], v12 offset:16384
    v_mfma_f32_16x16x32_bf16 v[180:183], v[52:55], a[212:215], v[180:183]
    ds_read_b64_tr_b16 v[50:51], v12 offset:17408
    v_mfma_f32_16x16x32_bf16 v[212:215], v[52:55], a[216:219], v[212:215]
    ds_read_b128 a[236:239], v28 offset:38912
    v_mfma_f32_16x16x32_bf16 v[244:247], v[52:55], a[220:223], v[244:247]
    buffer_load_dwordx4 v24, s[20:23], s98 offen offset:0  lds
    v_mfma_f32_16x16x32_bf16 v[152:155], v[56:59], a[208:211], v[152:155]
    ds_read_b64_tr_b16 v[52:53], v13 offset:16384
    v_mfma_f32_16x16x32_bf16 v[184:187], v[56:59], a[212:215], v[184:187]
    ds_read_b64_tr_b16 v[54:55], v13 offset:17408
    v_mfma_f32_16x16x32_bf16 v[216:219], v[56:59], a[216:219], v[216:219]
    v_mfma_f32_16x16x32_bf16 v[248:251], v[56:59], a[220:223], v[248:251]
    buffer_load_dwordx4 v25, s[20:23], s98 offen offset:1024  lds
    v_mfma_f32_16x16x32_bf16 v[156:159], v[60:63], a[208:211], v[156:159]
    ds_read_b64_tr_b16 v[56:57], v14 offset:16384
    v_mfma_f32_16x16x32_bf16 v[188:191], v[60:63], a[212:215], v[188:191]
    ds_read_b64_tr_b16 v[58:59], v14 offset:17408
    v_mfma_f32_16x16x32_bf16 v[220:223], v[60:63], a[216:219], v[220:223]
    s_waitcnt lgkmcnt(11)
    v_mfma_f32_16x16x32_bf16 v[252:255], v[60:63], a[220:223], v[252:255]
    buffer_load_dwordx4 v26, s[20:23], s98 offen offset:2048  lds
    v_mfma_f32_16x16x32_bf16 v[128:131], v[32:35], a[224:227], v[128:131]
    s_waitcnt lgkmcnt(8)
    ds_read_b64_tr_b16 v[60:61], v15 offset:16384
    v_mfma_f32_16x16x32_bf16 v[160:163], v[32:35], a[228:231], v[160:163]
    s_waitcnt lgkmcnt(8)
    ds_read_b64_tr_b16 v[62:63], v15 offset:17408
    v_mfma_f32_16x16x32_bf16 v[192:195], v[32:35], a[232:235], v[192:195]
    s_waitcnt lgkmcnt(6)
    ds_read_b128 a[240:243], v29 offset:32768
    v_mfma_f32_16x16x32_bf16 v[224:227], v[32:35], a[236:239], v[224:227]
    ds_read_b128 a[244:247], v29 offset:34816
    v_mfma_f32_16x16x32_bf16 v[132:135], v[36:39], a[224:227], v[132:135]
    ds_read_b64_tr_b16 v[32:33], v8 offset:24576
    v_mfma_f32_16x16x32_bf16 v[164:167], v[36:39], a[228:231], v[164:167]
    ds_read_b64_tr_b16 v[34:35], v8 offset:25600
    v_mfma_f32_16x16x32_bf16 v[196:199], v[36:39], a[232:235], v[196:199]
    ds_read_b128 a[248:251], v29 offset:36864
    v_mfma_f32_16x16x32_bf16 v[228:231], v[36:39], a[236:239], v[228:231]
    ds_read_b128 a[252:255], v29 offset:38912
    v_mfma_f32_16x16x32_bf16 v[136:139], v[40:43], a[224:227], v[136:139]
    ds_read_b64_tr_b16 v[36:37], v9 offset:24576
    v_and_b32 v16, 15, v2
    v_mfma_f32_16x16x32_bf16 v[168:171], v[40:43], a[228:231], v[168:171]
    ds_read_b64_tr_b16 v[38:39], v9 offset:25600
    v_lshrrev_b32 v17, 4, v2
    s_waitcnt vmcnt(8)
    v_add_f32 v80, v80, v84
    v_mfma_f32_16x16x32_bf16 v[200:203], v[40:43], a[232:235], v[200:203]
    v_lshrrev_b32 v29, 2, v16
    v_and_b32 v16, 3, v16
    s_waitcnt vmcnt(4)
    v_add_f32 v88, v88, v92
    v_mfma_f32_16x16x32_bf16 v[232:235], v[40:43], a[236:239], v[232:235]
    buffer_load_dwordx4 v27, s[20:23], s98 offen offset:3072  lds
    v_add_f32 v81, v81, v85
    v_mfma_f32_16x16x32_bf16 v[140:143], v[44:47], a[224:227], v[140:143]
    s_add_u32 m0, s62, 4096
    ds_read_b64_tr_b16 v[40:41], v10 offset:24576
    v_lshl_add_u32 v28, v17, 3, v29
    v_add_f32 v89, v89, v93
    v_mfma_f32_16x16x32_bf16 v[172:175], v[44:47], a[228:231], v[172:175]
    s_xor_b32 s98, s64, 2359296
    ds_read_b64_tr_b16 v[42:43], v10 offset:25600
    v_lshlrev_b32 v28, 7, v28
    v_add_f32 v82, v82, v86
    v_mfma_f32_16x16x32_bf16 v[204:207], v[44:47], a[232:235], v[204:207]
    v_lshl_add_u32 v28, v16, 3, v28
    v_and_b32 v17, 1, v17
    v_add_f32 v90, v90, v94
    v_mfma_f32_16x16x32_bf16 v[236:239], v[44:47], a[236:239], v[236:239]
    buffer_load_dwordx4 v24, s[20:23], s98 offen offset:0  lds
    v_add_f32 v83, v83, v87
    v_mfma_f32_16x16x32_bf16 v[144:147], v[48:51], a[224:227], v[144:147]
    ds_read_b64_tr_b16 v[44:45], v11 offset:24576
    v_lshrrev_b32 v29, 1, v29
    v_add_f32 v91, v91, v95
    v_mfma_f32_16x16x32_bf16 v[176:179], v[48:51], a[228:231], v[176:179]
    ds_read_b64_tr_b16 v[46:47], v11 offset:25600
    v_lshl_add_u32 v29, v17, 1, v29
    v_add_f32 v80, v80, v88
    v_mfma_f32_16x16x32_bf16 v[208:211], v[48:51], a[232:235], v[208:211]
    s_waitcnt lgkmcnt(15)
    v_lshl_add_u32 v28, v29, 5, v28
    v_add_u32 v28, 65536, v28
    v_add_f32 v81, v81, v89
    v_mfma_f32_16x16x32_bf16 v[240:243], v[48:51], a[236:239], v[240:243]
    buffer_load_dwordx4 v25, s[20:23], s98 offen offset:1024  lds
    v_add_f32 v82, v82, v90
    v_mfma_f32_16x16x32_bf16 v[148:151], v[52:55], a[224:227], v[148:151]
    ds_read_b64_tr_b16 v[48:49], v12 offset:24576
    v_xor_b32 v29, 32, v28
    v_add_f32 v83, v83, v91
    v_mfma_f32_16x16x32_bf16 v[180:183], v[52:55], a[228:231], v[180:183]
    ds_read_b64_tr_b16 v[50:51], v12 offset:25600
    v_xor_b32 v30, 64, v28
    v_lshrrev_b32 v88, 5, v2
    v_mfma_f32_16x16x32_bf16 v[212:215], v[52:55], a[232:235], v[212:215]
    s_waitcnt lgkmcnt(15)
    v_xor_b32 v31, 96, v28
    v_and_b32 v16, 15, v2
    v_cvt_f32_u32 v88, v88
    v_mfma_f32_16x16x32_bf16 v[244:247], v[52:55], a[236:239], v[244:247]
    buffer_load_dwordx4 v26, s[20:23], s98 offen offset:2048  lds
    v_cvt_pk_bf16_f32 v84, v80, v81
    v_mfma_f32_16x16x32_bf16 v[152:155], v[56:59], a[224:227], v[152:155]
    ds_read_b64_tr_b16 v[52:53], v13 offset:24576
    v_lshlrev_b32 v16, 6, v16
    v_cvt_pk_bf16_f32 v85, v82, v83
    v_mfma_f32_16x16x32_bf16 v[184:187], v[56:59], a[228:231], v[184:187]
    ds_read_b64_tr_b16 v[54:55], v13 offset:25600
    v_add_u32 v16, 65536, v16
    v_lshlrev_b32 v80, 16, v84
    v_mfma_f32_16x16x32_bf16 v[216:219], v[56:59], a[232:235], v[216:219]
    s_waitcnt lgkmcnt(15)
    v_mad_i32_i24 v16, v17, s77, v16
    v_and_b32 v17, 31, v2
    v_and_b32 v81, 0xffff0000, v84
    v_mfma_f32_16x16x32_bf16 v[248:251], v[56:59], a[236:239], v[248:251]
    buffer_load_dwordx4 v27, s[20:23], s98 offen offset:3072  lds
    v_lshlrev_b32 v82, 16, v85
    v_mfma_f32_16x16x32_bf16 v[156:159], v[60:63], a[224:227], v[156:159]
    ds_read_b64_tr_b16 v[56:57], v14 offset:24576
    v_lshlrev_b32 v17, 6, v17
    v_and_b32 v83, 0xffff0000, v85
    v_mfma_f32_16x16x32_bf16 v[188:191], v[60:63], a[228:231], v[188:191]
    ds_read_b64_tr_b16 v[58:59], v14 offset:25600
    v_add_f32 v80, v80, v88
    v_add_f32 v81, v81, v88
    v_mfma_f32_16x16x32_bf16 v[220:223], v[60:63], a[232:235], v[220:223]
    v_add_f32 v82, v82, v88
    v_add_f32 v83, v83, v88
    v_cvt_pk_bf16_f32 v84, v80, v81
    v_mfma_f32_16x16x32_bf16 v[252:255], v[60:63], a[236:239], v[252:255]
    s_waitcnt lgkmcnt(14)
    v_cvt_pk_bf16_f32 v85, v82, v83
    v_lshlrev_b32 v80, 16, v84
    v_and_b32 v81, 0xffff0000, v84
    v_mfma_f32_16x16x32_bf16 v[128:131], v[32:35], a[240:243], v[128:131]
    ds_read_b64_tr_b16 v[60:61], v15 offset:24576
    v_lshlrev_b32 v82, 16, v85
    v_and_b32 v83, 0xffff0000, v85
    v_mfma_f32_16x16x32_bf16 v[160:163], v[32:35], a[244:247], v[160:163]
    s_waitcnt lgkmcnt(14)
    ds_read_b64_tr_b16 v[62:63], v15 offset:25600
    v_mul_f32 v80, 0x3e0293ee, v80
    v_mul_f32 v81, 0x3e0293ee, v81
    v_mfma_f32_16x16x32_bf16 v[192:195], v[32:35], a[248:251], v[192:195]
    s_waitcnt lgkmcnt(14)
    v_mul_f32 v82, 0x3e0293ee, v82
    v_mul_f32 v83, 0x3e0293ee, v83
    v_mfma_f32_16x16x32_bf16 v[224:227], v[32:35], a[252:255], v[224:227]
    s_waitcnt lgkmcnt(12)
    s_lshl_b32 s70, s3, 10
    s_add_u32 s70, s70, 151552
    v_add_u32 v88, s70, v1
    v_add_u32 v18, s70, v18
    v_mfma_f32_16x16x32_bf16 v[132:135], v[36:39], a[240:243], v[132:135]
    ds_write_b128 v88, v[80:83]
    v_mfma_f32_16x16x32_bf16 v[164:167], v[36:39], a[244:247], v[164:167]
    v_mfma_f32_16x16x32_bf16 v[196:199], v[36:39], a[248:251], v[196:199]
    v_mfma_f32_16x16x32_bf16 v[228:231], v[36:39], a[252:255], v[228:231]
    s_waitcnt lgkmcnt(11)
    v_mfma_f32_16x16x32_bf16 v[136:139], v[40:43], a[240:243], v[136:139]
    s_waitcnt vmcnt(8) lgkmcnt(0)
    s_barrier
    v_mfma_f32_16x16x32_bf16 v[168:171], v[40:43], a[244:247], v[168:171]
    s_add_u32 m0, s62, 32768
    s_xor_b32 s98, s64, 128
    ds_read_b64_tr_b16 v[32:33], v28 offset:0
    v_mfma_f32_16x16x32_bf16 v[200:203], v[40:43], a[248:251], v[200:203]
    ds_read_b64_tr_b16 v[34:35], v28 offset:512
    v_mfma_f32_16x16x32_bf16 v[232:235], v[40:43], a[252:255], v[232:235]
    ds_read_b64_tr_b16 v[36:37], v28 offset:4096
    v_mfma_f32_16x16x32_bf16 v[140:143], v[44:47], a[240:243], v[140:143]
    ds_read_b64_tr_b16 v[38:39], v28 offset:4608
    v_mfma_f32_16x16x32_bf16 v[172:175], v[44:47], a[244:247], v[172:175]
    ds_read_b64_tr_b16 v[40:41], v29 offset:0
    v_mfma_f32_16x16x32_bf16 v[204:207], v[44:47], a[248:251], v[204:207]
    ds_read_b64_tr_b16 v[42:43], v29 offset:512
    v_mfma_f32_16x16x32_bf16 v[236:239], v[44:47], a[252:255], v[236:239]
    buffer_load_dwordx4 v24, s[20:23], s98 offen offset:0  lds
    v_mfma_f32_16x16x32_bf16 v[144:147], v[48:51], a[240:243], v[144:147]
    ds_read_b64_tr_b16 v[44:45], v29 offset:4096
    v_mfma_f32_16x16x32_bf16 v[176:179], v[48:51], a[244:247], v[176:179]
    ds_read_b64_tr_b16 v[46:47], v29 offset:4608
    v_mfma_f32_16x16x32_bf16 v[208:211], v[48:51], a[248:251], v[208:211]
    ds_read_b128 v[80:83], v18 offset:0
    v_mfma_f32_16x16x32_bf16 v[240:243], v[48:51], a[252:255], v[240:243]
    buffer_load_dwordx4 v25, s[20:23], s98 offen offset:1024  lds
    v_mfma_f32_16x16x32_bf16 v[148:151], v[52:55], a[240:243], v[148:151]
    ds_read_b64_tr_b16 v[48:49], v28 offset:8192
    v_mfma_f32_16x16x32_bf16 v[180:183], v[52:55], a[244:247], v[180:183]
    ds_read_b64_tr_b16 v[50:51], v28 offset:8704
    v_mfma_f32_16x16x32_bf16 v[212:215], v[52:55], a[248:251], v[212:215]
    ds_read_b128 v[84:87], v18 offset:16
    v_mfma_f32_16x16x32_bf16 v[244:247], v[52:55], a[252:255], v[244:247]
    buffer_load_dwordx4 v26, s[20:23], s98 offen offset:2048  lds
    v_mfma_f32_16x16x32_bf16 v[152:155], v[56:59], a[240:243], v[152:155]
    ds_read_b64_tr_b16 v[52:53], v28 offset:12288
    v_mfma_f32_16x16x32_bf16 v[184:187], v[56:59], a[244:247], v[184:187]
    ds_read_b64_tr_b16 v[54:55], v28 offset:12800
    v_mfma_f32_16x16x32_bf16 v[216:219], v[56:59], a[248:251], v[216:219]
    ds_read_b128 v[88:91], v18 offset:512
    v_mfma_f32_16x16x32_bf16 v[248:251], v[56:59], a[252:255], v[248:251]
    buffer_load_dwordx4 v27, s[20:23], s98 offen offset:3072  lds
    v_mfma_f32_16x16x32_bf16 v[156:159], v[60:63], a[240:243], v[156:159]
    s_add_u32 m0, s62, 36864
    s_xor_b32 s98, s64, 262272
    ds_read_b64_tr_b16 v[56:57], v29 offset:8192
    v_mfma_f32_16x16x32_bf16 v[188:191], v[60:63], a[244:247], v[188:191]
    ds_read_b64_tr_b16 v[58:59], v29 offset:8704
    v_mfma_f32_16x16x32_bf16 v[220:223], v[60:63], a[248:251], v[220:223]
    s_waitcnt lgkmcnt(15)
    ds_read_b128 v[92:95], v18 offset:528
    v_mfma_f32_16x16x32_bf16 v[252:255], v[60:63], a[252:255], v[252:255]
    buffer_load_dwordx4 v24, s[20:23], s98 offen offset:0  lds
    v_mfma_f32_16x16x32_bf16 v[96:99], a[0:3], v[32:35], 0
    s_waitcnt lgkmcnt(14)
    ds_read_b64_tr_b16 v[60:61], v29 offset:12288
    v_mfma_f32_16x16x32_bf16 v[96:99], a[16:19], v[36:39], v[96:99]
    ds_read_b64_tr_b16 v[62:63], v29 offset:12800
    v_mfma_f32_16x16x32_bf16 v[100:103], a[4:7], v[32:35], 0
    v_mfma_f32_16x16x32_bf16 v[100:103], a[20:23], v[36:39], v[100:103]
    buffer_load_dwordx4 v25, s[20:23], s98 offen offset:1024  lds
    v_mfma_f32_16x16x32_bf16 v[104:107], a[8:11], v[32:35], 0
    s_waitcnt lgkmcnt(5)
    v_fma_f32 v64, v64, v88, v80
    v_fma_f32 v65, v65, v89, v81
    v_mfma_f32_16x16x32_bf16 v[104:107], a[24:27], v[36:39], v[104:107]
    v_fma_f32 v66, v66, v90, v82
    v_fma_f32 v67, v67, v91, v83
    v_mfma_f32_16x16x32_bf16 v[108:111], a[12:15], v[32:35], 0
    s_waitcnt lgkmcnt(2)
    v_fma_f32 v68, v68, v92, v84
    v_fma_f32 v69, v69, v93, v85
    v_mfma_f32_16x16x32_bf16 v[108:111], a[28:31], v[36:39], v[108:111]
    buffer_load_dwordx4 v26, s[20:23], s98 offen offset:2048  lds
    v_mfma_f32_16x16x32_bf16 v[112:115], a[0:3], v[40:43], 0
    ds_read_b64_tr_b16 v[32:33], v28 offset:16384
    v_fma_f32 v70, v70, v94, v86
    v_mfma_f32_16x16x32_bf16 v[112:115], a[16:19], v[44:47], v[112:115]
    ds_read_b64_tr_b16 v[34:35], v28 offset:16896
    v_fma_f32 v71, v71, v95, v87
    v_mfma_f32_16x16x32_bf16 v[116:119], a[4:7], v[40:43], 0
    ds_read_b64_tr_b16 v[36:37], v28 offset:20480
    v_cvt_pk_bf16_f32 v64, v64, v65
    v_mfma_f32_16x16x32_bf16 v[116:119], a[20:23], v[44:47], v[116:119]
    ds_read_b64_tr_b16 v[38:39], v28 offset:20992
    v_cvt_pk_bf16_f32 v65, v66, v67
    v_mfma_f32_16x16x32_bf16 v[120:123], a[8:11], v[40:43], 0
    buffer_load_dwordx4 v27, s[20:23], s98 offen offset:3072  lds
    v_mfma_f32_16x16x32_bf16 v[120:123], a[24:27], v[44:47], v[120:123]
    s_add_u32 m0, s63, 131072
    s_xor_b32 s98, s0, 0
    v_cvt_pk_bf16_f32 v66, v68, v69
    v_mfma_f32_16x16x32_bf16 v[124:127], a[12:15], v[40:43], 0
    ds_read_b128 v[80:83], v18 offset:256
    v_cvt_pk_bf16_f32 v67, v70, v71
    v_mfma_f32_16x16x32_bf16 v[124:127], a[28:31], v[44:47], v[124:127]
    buffer_store_dwordx4 v[64:67], v19, s[8:11], s71 offen offset:0 sc0 sc1
    v_mfma_f32_16x16x32_bf16 v[96:99], a[32:35], v[48:51], v[96:99]
    ds_read_b64_tr_b16 v[40:41], v29 offset:16384
    v_cvt_pk_bf16_f32 v128, v128, v129
    v_mfma_f32_16x16x32_bf16 v[96:99], a[48:51], v[52:55], v[96:99]
    ds_read_b64_tr_b16 v[42:43], v29 offset:16896
    v_cvt_pk_bf16_f32 v129, v130, v131
    v_mfma_f32_16x16x32_bf16 v[100:103], a[36:39], v[48:51], v[100:103]
    ds_read_b64_tr_b16 v[44:45], v29 offset:20480
    v_cvt_pk_bf16_f32 v130, v132, v133
    v_mfma_f32_16x16x32_bf16 v[100:103], a[52:55], v[52:55], v[100:103]
    ds_read_b64_tr_b16 v[46:47], v29 offset:20992
    v_cvt_pk_bf16_f32 v131, v134, v135
    v_mfma_f32_16x16x32_bf16 v[104:107], a[40:43], v[48:51], v[104:107]
    buffer_load_dwordx4 v20, s[24:27], s98 offen offset:0  lds
    v_mfma_f32_16x16x32_bf16 v[104:107], a[56:59], v[52:55], v[104:107]
    s_xor_b32 s79, s65, 0
    s_lshr_b32 s100, s2, 3
    ds_read_b128 v[84:87], v18 offset:272
    v_mfma_f32_16x16x32_bf16 v[108:111], a[44:47], v[48:51], v[108:111]
    s_mul_i32 s66, s4, 28
    s_add_u32 s66, s66, s100
    ds_read_b128 v[88:91], v18 offset:768
    v_mfma_f32_16x16x32_bf16 v[108:111], a[60:63], v[52:55], v[108:111]
    s_cmp_lt_u32 s100, 28
    s_cselect_b32 s66, s66, 255
    s_lshl_b32 s67, s4, 3
    ds_read_b128 v[92:95], v18 offset:784
    v_mfma_f32_16x16x32_bf16 v[112:115], a[32:35], v[56:59], v[112:115]
    s_waitcnt lgkmcnt(12)
    s_add_u32 s67, s67, s100
    s_sub_u32 s67, s67, 24
    ds_read_b64_tr_b16 v[48:49], v28 offset:24576
    v_mfma_f32_16x16x32_bf16 v[112:115], a[48:51], v[60:63], v[112:115]
    s_cmp_ge_u32 s100, 24
    s_cselect_b32 s67, s67, 255
    ds_read_b64_tr_b16 v[50:51], v28 offset:25088
    v_mfma_f32_16x16x32_bf16 v[116:119], a[36:39], v[56:59], v[116:119]
    ds_read_b64_tr_b16 v[52:53], v28 offset:28672
    v_mfma_f32_16x16x32_bf16 v[116:119], a[52:55], v[60:63], v[116:119]
    ds_read_b64_tr_b16 v[54:55], v28 offset:29184
    v_mfma_f32_16x16x32_bf16 v[120:123], a[40:43], v[56:59], v[120:123]
    buffer_load_dwordx4 v21, s[24:27], s98 offen offset:1024  lds
    v_mfma_f32_16x16x32_bf16 v[120:123], a[56:59], v[60:63], v[120:123]
    s_waitcnt lgkmcnt(5)
    v_fma_f32 v72, v72, v88, v80
    v_fma_f32 v73, v73, v89, v81
    v_mfma_f32_16x16x32_bf16 v[124:127], a[44:47], v[56:59], v[124:127]
    v_fma_f32 v74, v74, v90, v82
    v_fma_f32 v75, v75, v91, v83
    v_mfma_f32_16x16x32_bf16 v[124:127], a[60:63], v[60:63], v[124:127]
    buffer_store_dwordx4 v[128:131], v1, s[8:11], s79 offen offset:0 sc0 sc1
    v_mfma_f32_16x16x32_bf16 v[96:99], a[64:67], v[32:35], v[96:99]
    ds_read_b64_tr_b16 v[56:57], v29 offset:24576
    s_waitcnt lgkmcnt(5)
    v_fma_f32 v76, v76, v92, v84
    v_mfma_f32_16x16x32_bf16 v[96:99], a[80:83], v[36:39], v[96:99]
    ds_read_b64_tr_b16 v[58:59], v29 offset:25088
    v_fma_f32 v77, v77, v93, v85
    v_mfma_f32_16x16x32_bf16 v[100:103], a[68:71], v[32:35], v[100:103]
    ds_read_b64_tr_b16 v[60:61], v29 offset:28672
    v_fma_f32 v78, v78, v94, v86
    v_mfma_f32_16x16x32_bf16 v[100:103], a[84:87], v[36:39], v[100:103]
    ds_read_b64_tr_b16 v[62:63], v29 offset:29184
    v_fma_f32 v79, v79, v95, v87
    v_mfma_f32_16x16x32_bf16 v[104:107], a[72:75], v[32:35], v[104:107]
    buffer_load_dwordx4 v22, s[24:27], s98 offen offset:2048  lds
    v_mfma_f32_16x16x32_bf16 v[104:107], a[88:91], v[36:39], v[104:107]
    v_cvt_pk_bf16_f32 v72, v72, v73
    v_cvt_pk_bf16_f32 v73, v74, v75
    v_mfma_f32_16x16x32_bf16 v[108:111], a[76:79], v[32:35], v[108:111]
    v_cvt_pk_bf16_f32 v74, v76, v77
    v_cvt_pk_bf16_f32 v75, v78, v79
    v_mfma_f32_16x16x32_bf16 v[108:111], a[92:95], v[36:39], v[108:111]
    buffer_store_dwordx4 v[72:75], v19, s[8:11], s71 offen offset:2048 sc0 sc1
    v_mfma_f32_16x16x32_bf16 v[112:115], a[64:67], v[40:43], v[112:115]
    ds_read_b64_tr_b16 v[32:33], v30 offset:0
    v_cvt_pk_bf16_f32 v136, v136, v137
    v_mfma_f32_16x16x32_bf16 v[112:115], a[80:83], v[44:47], v[112:115]
    ds_read_b64_tr_b16 v[34:35], v30 offset:512
    v_cvt_pk_bf16_f32 v137, v138, v139
    v_mfma_f32_16x16x32_bf16 v[116:119], a[68:71], v[40:43], v[116:119]
    ds_read_b64_tr_b16 v[36:37], v30 offset:4096
    v_cvt_pk_bf16_f32 v138, v140, v141
    v_mfma_f32_16x16x32_bf16 v[116:119], a[84:87], v[44:47], v[116:119]
    ds_read_b64_tr_b16 v[38:39], v30 offset:4608
    v_cvt_pk_bf16_f32 v139, v142, v143
    v_mfma_f32_16x16x32_bf16 v[120:123], a[72:75], v[40:43], v[120:123]
    buffer_load_dwordx4 v23, s[24:27], s98 offen offset:3072  lds
    v_mfma_f32_16x16x32_bf16 v[120:123], a[88:91], v[44:47], v[120:123]
    s_add_u32 m0, s63, 98304
    s_xor_b32 s98, s0, 524288
    s_xor_b32 s79, s65, 0
    v_mfma_f32_16x16x32_bf16 v[124:127], a[76:79], v[40:43], v[124:127]
    buffer_store_dwordx4 v[136:139], v1, s[8:11], s79 offen offset:1024 sc0 sc1
    v_mfma_f32_16x16x32_bf16 v[124:127], a[92:95], v[44:47], v[124:127]
    s_waitcnt lgkmcnt(10)
    v_mfma_f32_16x16x32_bf16 v[96:99], a[96:99], v[48:51], v[96:99]
    s_waitcnt lgkmcnt(8)
    ds_read_b64_tr_b16 v[40:41], v31 offset:0
    v_cvt_pk_bf16_f32 v144, v144, v145
    v_mfma_f32_16x16x32_bf16 v[96:99], a[112:115], v[52:55], v[96:99]
    ds_read_b64_tr_b16 v[42:43], v31 offset:512
    v_cvt_pk_bf16_f32 v145, v146, v147
    v_mfma_f32_16x16x32_bf16 v[100:103], a[100:103], v[48:51], v[100:103]
    ds_read_b64_tr_b16 v[44:45], v31 offset:4096
    v_cvt_pk_bf16_f32 v146, v148, v149
    v_mfma_f32_16x16x32_bf16 v[100:103], a[116:119], v[52:55], v[100:103]
    ds_read_b64_tr_b16 v[46:47], v31 offset:4608
    v_cvt_pk_bf16_f32 v147, v150, v151
    v_mfma_f32_16x16x32_bf16 v[104:107], a[104:107], v[48:51], v[104:107]
    buffer_load_dwordx4 v20, s[24:27], s98 offen offset:0  lds
    v_mfma_f32_16x16x32_bf16 v[104:107], a[120:123], v[52:55], v[104:107]
    s_xor_b32 s79, s65, 0
    v_mfma_f32_16x16x32_bf16 v[108:111], a[108:111], v[48:51], v[108:111]
    buffer_store_dwordx4 v[144:147], v1, s[8:11], s79 offen offset:2048 sc0 sc1
    v_mfma_f32_16x16x32_bf16 v[108:111], a[124:127], v[52:55], v[108:111]
    s_waitcnt lgkmcnt(10)
    v_mfma_f32_16x16x32_bf16 v[112:115], a[96:99], v[56:59], v[112:115]
    s_waitcnt lgkmcnt(8)
    ds_read_b64_tr_b16 v[48:49], v30 offset:8192
    v_mfma_f32_16x16x32_bf16 v[112:115], a[112:115], v[60:63], v[112:115]
    ds_read_b64_tr_b16 v[50:51], v30 offset:8704
    v_mfma_f32_16x16x32_bf16 v[116:119], a[100:103], v[56:59], v[116:119]
    ds_read_b64_tr_b16 v[52:53], v30 offset:12288
    v_mfma_f32_16x16x32_bf16 v[116:119], a[116:119], v[60:63], v[116:119]
    ds_read_b64_tr_b16 v[54:55], v30 offset:12800
    v_mfma_f32_16x16x32_bf16 v[120:123], a[104:107], v[56:59], v[120:123]
    buffer_load_dwordx4 v21, s[24:27], s98 offen offset:1024  lds
    v_mfma_f32_16x16x32_bf16 v[120:123], a[120:123], v[60:63], v[120:123]
    v_mfma_f32_16x16x32_bf16 v[124:127], a[108:111], v[56:59], v[124:127]
    v_mfma_f32_16x16x32_bf16 v[124:127], a[124:127], v[60:63], v[124:127]
    s_waitcnt lgkmcnt(10)
    v_mfma_f32_16x16x32_bf16 v[64:67], a[0:3], v[32:35], 0
    s_waitcnt lgkmcnt(8)
    ds_read_b64_tr_b16 v[56:57], v31 offset:8192
    v_cvt_pk_bf16_f32 v152, v152, v153
    v_mfma_f32_16x16x32_bf16 v[64:67], a[16:19], v[36:39], v[64:67]
    ds_read_b64_tr_b16 v[58:59], v31 offset:8704
    v_cvt_pk_bf16_f32 v153, v154, v155
    v_mfma_f32_16x16x32_bf16 v[68:71], a[4:7], v[32:35], 0
    ds_read_b64_tr_b16 v[60:61], v31 offset:12288
    v_cvt_pk_bf16_f32 v154, v156, v157
    v_mfma_f32_16x16x32_bf16 v[68:71], a[20:23], v[36:39], v[68:71]
    ds_read_b64_tr_b16 v[62:63], v31 offset:12800
    v_cvt_pk_bf16_f32 v155, v158, v159
    v_mfma_f32_16x16x32_bf16 v[72:75], a[8:11], v[32:35], 0
    buffer_load_dwordx4 v22, s[24:27], s98 offen offset:2048  lds
    v_mfma_f32_16x16x32_bf16 v[72:75], a[24:27], v[36:39], v[72:75]
    s_xor_b32 s79, s65, 0
    v_mfma_f32_16x16x32_bf16 v[76:79], a[12:15], v[32:35], 0
    buffer_store_dwordx4 v[152:155], v1, s[8:11], s79 offen offset:3072 sc0 sc1
    v_mfma_f32_16x16x32_bf16 v[76:79], a[28:31], v[36:39], v[76:79]
    s_waitcnt lgkmcnt(10)
    v_mfma_f32_16x16x32_bf16 v[80:83], a[0:3], v[40:43], 0
    s_waitcnt lgkmcnt(8)
    ds_read_b64_tr_b16 v[32:33], v30 offset:16384
    v_mfma_f32_16x16x32_bf16 v[80:83], a[16:19], v[44:47], v[80:83]
    ds_read_b64_tr_b16 v[34:35], v30 offset:16896
    v_mfma_f32_16x16x32_bf16 v[84:87], a[4:7], v[40:43], 0
    ds_read_b64_tr_b16 v[36:37], v30 offset:20480
    v_mfma_f32_16x16x32_bf16 v[84:87], a[20:23], v[44:47], v[84:87]
    ds_read_b64_tr_b16 v[38:39], v30 offset:20992
    v_mfma_f32_16x16x32_bf16 v[88:91], a[8:11], v[40:43], 0
    buffer_load_dwordx4 v23, s[24:27], s98 offen offset:3072  lds
    v_mfma_f32_16x16x32_bf16 v[88:91], a[24:27], v[44:47], v[88:91]
    v_mfma_f32_16x16x32_bf16 v[92:95], a[12:15], v[40:43], 0
    v_mfma_f32_16x16x32_bf16 v[92:95], a[28:31], v[44:47], v[92:95]
    s_waitcnt lgkmcnt(10)
    v_mfma_f32_16x16x32_bf16 v[64:67], a[32:35], v[48:51], v[64:67]
    s_waitcnt lgkmcnt(8)
    ds_read_b64_tr_b16 v[40:41], v31 offset:16384
    v_mfma_f32_16x16x32_bf16 v[64:67], a[48:51], v[52:55], v[64:67]
    ds_read_b64_tr_b16 v[42:43], v31 offset:16896
    v_mfma_f32_16x16x32_bf16 v[68:71], a[36:39], v[48:51], v[68:71]
    ds_read_b64_tr_b16 v[44:45], v31 offset:20480
    v_cvt_pk_bf16_f32 v160, v160, v161
    v_mfma_f32_16x16x32_bf16 v[68:71], a[52:55], v[52:55], v[68:71]
    ds_read_b64_tr_b16 v[46:47], v31 offset:20992
    v_cvt_pk_bf16_f32 v161, v162, v163
    v_mfma_f32_16x16x32_bf16 v[72:75], a[40:43], v[48:51], v[72:75]
    v_cvt_pk_bf16_f32 v162, v164, v165
    v_cvt_pk_bf16_f32 v163, v166, v167
    v_mfma_f32_16x16x32_bf16 v[72:75], a[56:59], v[52:55], v[72:75]
    s_xor_b32 s79, s65, 4096
    v_mfma_f32_16x16x32_bf16 v[76:79], a[44:47], v[48:51], v[76:79]
    buffer_store_dwordx4 v[160:163], v1, s[8:11], s79 offen offset:0 sc0 sc1
    v_mfma_f32_16x16x32_bf16 v[76:79], a[60:63], v[52:55], v[76:79]
    s_waitcnt lgkmcnt(10)
    v_mfma_f32_16x16x32_bf16 v[80:83], a[32:35], v[56:59], v[80:83]
    s_waitcnt lgkmcnt(8)
    ds_read_b64_tr_b16 v[48:49], v30 offset:24576
    v_mfma_f32_16x16x32_bf16 v[80:83], a[48:51], v[60:63], v[80:83]
    ds_read_b64_tr_b16 v[50:51], v30 offset:25088
    v_mfma_f32_16x16x32_bf16 v[84:87], a[36:39], v[56:59], v[84:87]
    ds_read_b64_tr_b16 v[52:53], v30 offset:28672
    v_mfma_f32_16x16x32_bf16 v[84:87], a[52:55], v[60:63], v[84:87]
    ds_read_b64_tr_b16 v[54:55], v30 offset:29184
    v_mfma_f32_16x16x32_bf16 v[88:91], a[40:43], v[56:59], v[88:91]
    v_mfma_f32_16x16x32_bf16 v[88:91], a[56:59], v[60:63], v[88:91]
    v_mfma_f32_16x16x32_bf16 v[92:95], a[44:47], v[56:59], v[92:95]
    v_mfma_f32_16x16x32_bf16 v[92:95], a[60:63], v[60:63], v[92:95]
    s_waitcnt lgkmcnt(10)
    v_mfma_f32_16x16x32_bf16 v[64:67], a[64:67], v[32:35], v[64:67]
    s_waitcnt lgkmcnt(8)
    ds_read_b64_tr_b16 v[56:57], v31 offset:24576
    v_mfma_f32_16x16x32_bf16 v[64:67], a[80:83], v[36:39], v[64:67]
    ds_read_b64_tr_b16 v[58:59], v31 offset:25088
    v_mfma_f32_16x16x32_bf16 v[68:71], a[68:71], v[32:35], v[68:71]
    ds_read_b64_tr_b16 v[60:61], v31 offset:28672
    v_mfma_f32_16x16x32_bf16 v[68:71], a[84:87], v[36:39], v[68:71]
    ds_read_b64_tr_b16 v[62:63], v31 offset:29184
    v_mfma_f32_16x16x32_bf16 v[72:75], a[72:75], v[32:35], v[72:75]
    v_cvt_pk_bf16_f32 v168, v168, v169
    v_cvt_pk_bf16_f32 v169, v170, v171
    v_mfma_f32_16x16x32_bf16 v[72:75], a[88:91], v[36:39], v[72:75]
    v_cvt_pk_bf16_f32 v170, v172, v173
    v_cvt_pk_bf16_f32 v171, v174, v175
    v_mfma_f32_16x16x32_bf16 v[76:79], a[76:79], v[32:35], v[76:79]
    s_waitcnt lgkmcnt(10)
    s_xor_b32 s79, s65, 4096
    v_mfma_f32_16x16x32_bf16 v[76:79], a[92:95], v[36:39], v[76:79]
    buffer_store_dwordx4 v[168:171], v1, s[8:11], s79 offen offset:1024 sc0 sc1
    v_mfma_f32_16x16x32_bf16 v[80:83], a[64:67], v[40:43], v[80:83]
    s_waitcnt lgkmcnt(8)
    v_mfma_f32_16x16x32_bf16 v[80:83], a[80:83], v[44:47], v[80:83]
    v_mfma_f32_16x16x32_bf16 v[84:87], a[68:71], v[40:43], v[84:87]
    v_mfma_f32_16x16x32_bf16 v[84:87], a[84:87], v[44:47], v[84:87]
    v_mfma_f32_16x16x32_bf16 v[88:91], a[72:75], v[40:43], v[88:91]
    v_mfma_f32_16x16x32_bf16 v[88:91], a[88:91], v[44:47], v[88:91]
    s_waitcnt vmcnt(10)
    v_mfma_f32_16x16x32_bf16 v[92:95], a[76:79], v[40:43], v[92:95]
    v_xor_b32 v28, 65536, v28
    s_waitcnt lgkmcnt(0)
    s_barrier
    v_mfma_f32_16x16x32_bf16 v[92:95], a[92:95], v[44:47], v[92:95]
    s_add_u32 m0, s62, 65536
    ds_read_b64_tr_b16 v[32:33], v28 offset:0
    v_xor_b32 v29, 65536, v29
    v_mfma_f32_16x16x32_bf16 v[64:67], a[96:99], v[48:51], v[64:67]
    s_xor_b32 s98, s64, 2097280
    ds_read_b64_tr_b16 v[34:35], v28 offset:512
    v_mfma_f32_16x16x32_bf16 v[64:67], a[112:115], v[52:55], v[64:67]
    ds_read_b64_tr_b16 v[36:37], v28 offset:4096
    v_mfma_f32_16x16x32_bf16 v[68:71], a[100:103], v[48:51], v[68:71]
    ds_read_b64_tr_b16 v[38:39], v28 offset:4608
    v_mfma_f32_16x16x32_bf16 v[68:71], a[116:119], v[52:55], v[68:71]
    ds_read_b64_tr_b16 v[40:41], v29 offset:0
    v_mfma_f32_16x16x32_bf16 v[72:75], a[104:107], v[48:51], v[72:75]
    ds_read_b64_tr_b16 v[42:43], v29 offset:512
    v_mfma_f32_16x16x32_bf16 v[72:75], a[120:123], v[52:55], v[72:75]
    ds_read_b64_tr_b16 v[44:45], v29 offset:4096
    v_mfma_f32_16x16x32_bf16 v[76:79], a[108:111], v[48:51], v[76:79]
    ds_read_b64_tr_b16 v[46:47], v29 offset:4608
    v_cvt_pk_bf16_f32 v176, v176, v177
    v_mfma_f32_16x16x32_bf16 v[76:79], a[124:127], v[52:55], v[76:79]
    buffer_load_dwordx4 v24, s[20:23], s98 offen offset:0  lds
    v_mfma_f32_16x16x32_bf16 v[80:83], a[96:99], v[56:59], v[80:83]
    ds_read_b64_tr_b16 v[48:49], v28 offset:8192
    v_cvt_pk_bf16_f32 v177, v178, v179
    v_mfma_f32_16x16x32_bf16 v[80:83], a[112:115], v[60:63], v[80:83]
    ds_read_b64_tr_b16 v[50:51], v28 offset:8704
    v_cvt_pk_bf16_f32 v178, v180, v181
    v_mfma_f32_16x16x32_bf16 v[84:87], a[100:103], v[56:59], v[84:87]
    ds_read_b64_tr_b16 v[52:53], v28 offset:12288
    v_cvt_pk_bf16_f32 v179, v182, v183
    v_mfma_f32_16x16x32_bf16 v[84:87], a[116:119], v[60:63], v[84:87]
    s_xor_b32 s79, s65, 4096
    ds_read_b64_tr_b16 v[54:55], v28 offset:12800
    v_mfma_f32_16x16x32_bf16 v[88:91], a[104:107], v[56:59], v[88:91]
    buffer_load_dwordx4 v25, s[20:23], s98 offen offset:1024  lds
    v_mfma_f32_16x16x32_bf16 v[88:91], a[120:123], v[60:63], v[88:91]
    buffer_store_dword v6, v5, s[8:11], s72 offen sc0 sc1
    v_mfma_f32_16x16x32_bf16 v[92:95], a[108:111], v[56:59], v[92:95]
    buffer_store_dwordx4 v[176:179], v1, s[8:11], s79 offen offset:2048 sc0 sc1
    v_mfma_f32_16x16x32_bf16 v[92:95], a[124:127], v[60:63], v[92:95]
    s_waitcnt lgkmcnt(10)
    v_mfma_f32_16x16x32_bf16 v[96:99], a[128:131], v[32:35], v[96:99]
    s_waitcnt lgkmcnt(8)
    ds_read_b64_tr_b16 v[56:57], v29 offset:8192
    v_mfma_f32_16x16x32_bf16 v[96:99], a[144:147], v[36:39], v[96:99]
    ds_read_b64_tr_b16 v[58:59], v29 offset:8704
    v_mfma_f32_16x16x32_bf16 v[100:103], a[132:135], v[32:35], v[100:103]
    ds_read_b64_tr_b16 v[60:61], v29 offset:12288
    v_mfma_f32_16x16x32_bf16 v[100:103], a[148:151], v[36:39], v[100:103]
    ds_read_b64_tr_b16 v[62:63], v29 offset:12800
    v_mfma_f32_16x16x32_bf16 v[104:107], a[136:139], v[32:35], v[104:107]
    buffer_load_dwordx4 v26, s[20:23], s98 offen offset:2048  lds
    v_mfma_f32_16x16x32_bf16 v[104:107], a[152:155], v[36:39], v[104:107]
    v_mfma_f32_16x16x32_bf16 v[108:111], a[140:143], v[32:35], v[108:111]
    v_mfma_f32_16x16x32_bf16 v[108:111], a[156:159], v[36:39], v[108:111]
    s_waitcnt lgkmcnt(10)
    v_mfma_f32_16x16x32_bf16 v[112:115], a[128:131], v[40:43], v[112:115]
    s_waitcnt lgkmcnt(8)
    ds_read_b64_tr_b16 v[32:33], v28 offset:16384
    v_cvt_pk_bf16_f32 v184, v184, v185
    v_mfma_f32_16x16x32_bf16 v[112:115], a[144:147], v[44:47], v[112:115]
    ds_read_b64_tr_b16 v[34:35], v28 offset:16896
    v_cvt_pk_bf16_f32 v185, v186, v187
    v_mfma_f32_16x16x32_bf16 v[116:119], a[132:135], v[40:43], v[116:119]
    ds_read_b64_tr_b16 v[36:37], v28 offset:20480
    v_cvt_pk_bf16_f32 v186, v188, v189
    v_mfma_f32_16x16x32_bf16 v[116:119], a[148:151], v[44:47], v[116:119]
    ds_read_b64_tr_b16 v[38:39], v28 offset:20992
    v_cvt_pk_bf16_f32 v187, v190, v191
    v_mfma_f32_16x16x32_bf16 v[120:123], a[136:139], v[40:43], v[120:123]
    buffer_load_dwordx4 v27, s[20:23], s98 offen offset:3072  lds
    v_mfma_f32_16x16x32_bf16 v[120:123], a[152:155], v[44:47], v[120:123]
    s_add_u32 m0, s62, 69632
    s_xor_b32 s98, s64, 2359424
    s_xor_b32 s79, s65, 4096
    v_mfma_f32_16x16x32_bf16 v[124:127], a[140:143], v[40:43], v[124:127]
    buffer_store_dwordx4 v[184:187], v1, s[8:11], s79 offen offset:3072 sc0 sc1
    v_mfma_f32_16x16x32_bf16 v[124:127], a[156:159], v[44:47], v[124:127]
    s_waitcnt lgkmcnt(10)
    v_mfma_f32_16x16x32_bf16 v[96:99], a[160:163], v[48:51], v[96:99]
    s_waitcnt lgkmcnt(8)
    ds_read_b64_tr_b16 v[40:41], v29 offset:16384
    v_mfma_f32_16x16x32_bf16 v[96:99], a[176:179], v[52:55], v[96:99]
    ds_read_b64_tr_b16 v[42:43], v29 offset:16896
    v_mfma_f32_16x16x32_bf16 v[100:103], a[164:167], v[48:51], v[100:103]
    ds_read_b64_tr_b16 v[44:45], v29 offset:20480
    v_mfma_f32_16x16x32_bf16 v[100:103], a[180:183], v[52:55], v[100:103]
    ds_read_b64_tr_b16 v[46:47], v29 offset:20992
    v_mfma_f32_16x16x32_bf16 v[104:107], a[168:171], v[48:51], v[104:107]
    buffer_load_dwordx4 v24, s[20:23], s98 offen offset:0  lds
    v_mfma_f32_16x16x32_bf16 v[104:107], a[184:187], v[52:55], v[104:107]
    v_mfma_f32_16x16x32_bf16 v[108:111], a[172:175], v[48:51], v[108:111]
    v_mfma_f32_16x16x32_bf16 v[108:111], a[188:191], v[52:55], v[108:111]
    s_waitcnt lgkmcnt(10)
    v_mfma_f32_16x16x32_bf16 v[112:115], a[160:163], v[56:59], v[112:115]
    s_waitcnt lgkmcnt(8)
    ds_read_b64_tr_b16 v[48:49], v28 offset:24576
    v_mfma_f32_16x16x32_bf16 v[112:115], a[176:179], v[60:63], v[112:115]
    ds_read_b64_tr_b16 v[50:51], v28 offset:25088
    v_mfma_f32_16x16x32_bf16 v[116:119], a[164:167], v[56:59], v[116:119]
    ds_read_b64_tr_b16 v[52:53], v28 offset:28672
    v_cvt_pk_bf16_f32 v192, v192, v193
    v_mfma_f32_16x16x32_bf16 v[116:119], a[180:183], v[60:63], v[116:119]
    ds_read_b64_tr_b16 v[54:55], v28 offset:29184
    v_cvt_pk_bf16_f32 v193, v194, v195
    v_mfma_f32_16x16x32_bf16 v[120:123], a[168:171], v[56:59], v[120:123]
    buffer_load_dwordx4 v25, s[20:23], s98 offen offset:1024  lds
    v_mfma_f32_16x16x32_bf16 v[120:123], a[184:187], v[60:63], v[120:123]
    v_cvt_pk_bf16_f32 v194, v196, v197
    v_cvt_pk_bf16_f32 v195, v198, v199
    v_mfma_f32_16x16x32_bf16 v[124:127], a[172:175], v[56:59], v[124:127]
    v_mfma_f32_16x16x32_bf16 v[124:127], a[188:191], v[60:63], v[124:127]
    s_waitcnt lgkmcnt(10)
    v_mfma_f32_16x16x32_bf16 v[96:99], a[192:195], v[32:35], v[96:99]
    s_waitcnt lgkmcnt(8)
    s_xor_b32 s79, s65, 8192
    ds_read_b64_tr_b16 v[56:57], v29 offset:24576
    v_mfma_f32_16x16x32_bf16 v[96:99], a[208:211], v[36:39], v[96:99]
    ds_read_b64_tr_b16 v[58:59], v29 offset:25088
    v_mfma_f32_16x16x32_bf16 v[100:103], a[196:199], v[32:35], v[100:103]
    ds_read_b64_tr_b16 v[60:61], v29 offset:28672
    v_mfma_f32_16x16x32_bf16 v[100:103], a[212:215], v[36:39], v[100:103]
    ds_read_b64_tr_b16 v[62:63], v29 offset:29184
    v_mfma_f32_16x16x32_bf16 v[104:107], a[200:203], v[32:35], v[104:107]
    buffer_load_dwordx4 v26, s[20:23], s98 offen offset:2048  lds
    v_mfma_f32_16x16x32_bf16 v[104:107], a[216:219], v[36:39], v[104:107]
    buffer_store_dwordx4 v[192:195], v1, s[8:11], s79 offen offset:0 sc0 sc1
    v_mfma_f32_16x16x32_bf16 v[108:111], a[204:207], v[32:35], v[108:111]
    v_mfma_f32_16x16x32_bf16 v[108:111], a[220:223], v[36:39], v[108:111]
    s_waitcnt lgkmcnt(10)
    v_xor_b32 v30, 65536, v30
    v_mfma_f32_16x16x32_bf16 v[112:115], a[192:195], v[40:43], v[112:115]
    s_waitcnt lgkmcnt(8)
    ds_read_b64_tr_b16 v[32:33], v30 offset:0
    v_mfma_f32_16x16x32_bf16 v[112:115], a[208:211], v[44:47], v[112:115]
    ds_read_b64_tr_b16 v[34:35], v30 offset:512
    v_mfma_f32_16x16x32_bf16 v[116:119], a[196:199], v[40:43], v[116:119]
    ds_read_b64_tr_b16 v[36:37], v30 offset:4096
    v_mfma_f32_16x16x32_bf16 v[116:119], a[212:215], v[44:47], v[116:119]
    ds_read_b64_tr_b16 v[38:39], v30 offset:4608
    v_mfma_f32_16x16x32_bf16 v[120:123], a[200:203], v[40:43], v[120:123]
    buffer_load_dwordx4 v27, s[20:23], s98 offen offset:3072  lds
    v_mfma_f32_16x16x32_bf16 v[120:123], a[216:219], v[44:47], v[120:123]
    v_cvt_pk_bf16_f32 v200, v200, v201
    v_cvt_pk_bf16_f32 v201, v202, v203
    v_mfma_f32_16x16x32_bf16 v[124:127], a[204:207], v[40:43], v[124:127]
    v_cvt_pk_bf16_f32 v202, v204, v205
    v_cvt_pk_bf16_f32 v203, v206, v207
    v_mfma_f32_16x16x32_bf16 v[124:127], a[220:223], v[44:47], v[124:127]
    s_waitcnt lgkmcnt(10)
    s_add_u32 m0, s63, 114688
    s_xor_b32 s98, s0, 1048576
    v_xor_b32 v31, 65536, v31
    v_mfma_f32_16x16x32_bf16 v[96:99], a[224:227], v[48:51], v[96:99]
    s_waitcnt lgkmcnt(8)
    s_xor_b32 s79, s65, 8192
    ds_read_b64_tr_b16 v[40:41], v31 offset:0
    v_mfma_f32_16x16x32_bf16 v[96:99], a[240:243], v[52:55], v[96:99]
    ds_read_b64_tr_b16 v[42:43], v31 offset:512
    v_mfma_f32_16x16x32_bf16 v[100:103], a[228:231], v[48:51], v[100:103]
    ds_read_b64_tr_b16 v[44:45], v31 offset:4096
    v_mfma_f32_16x16x32_bf16 v[100:103], a[244:247], v[52:55], v[100:103]
    ds_read_b64_tr_b16 v[46:47], v31 offset:4608
    v_mfma_f32_16x16x32_bf16 v[104:107], a[232:235], v[48:51], v[104:107]
    buffer_load_dwordx4 v20, s[24:27], s98 offen offset:0  lds
    v_mfma_f32_16x16x32_bf16 v[104:107], a[248:251], v[52:55], v[104:107]
    buffer_store_dwordx4 v[200:203], v1, s[8:11], s79 offen offset:1024 sc0 sc1
    v_mfma_f32_16x16x32_bf16 v[108:111], a[236:239], v[48:51], v[108:111]
    v_mfma_f32_16x16x32_bf16 v[108:111], a[252:255], v[52:55], v[108:111]
    s_waitcnt lgkmcnt(10)
    v_mfma_f32_16x16x32_bf16 v[112:115], a[224:227], v[56:59], v[112:115]
    s_waitcnt lgkmcnt(8)
    ds_read_b64_tr_b16 v[48:49], v30 offset:8192
    v_mfma_f32_16x16x32_bf16 v[112:115], a[240:243], v[60:63], v[112:115]
    ds_read_b64_tr_b16 v[50:51], v30 offset:8704
    v_mfma_f32_16x16x32_bf16 v[116:119], a[228:231], v[56:59], v[116:119]
    ds_read_b64_tr_b16 v[52:53], v30 offset:12288
    v_mfma_f32_16x16x32_bf16 v[116:119], a[244:247], v[60:63], v[116:119]
    ds_read_b64_tr_b16 v[54:55], v30 offset:12800
    v_mfma_f32_16x16x32_bf16 v[120:123], a[232:235], v[56:59], v[120:123]
    buffer_load_dwordx4 v21, s[24:27], s98 offen offset:1024  lds
    v_mfma_f32_16x16x32_bf16 v[120:123], a[248:251], v[60:63], v[120:123]
    v_mfma_f32_16x16x32_bf16 v[124:127], a[236:239], v[56:59], v[124:127]
    v_mfma_f32_16x16x32_bf16 v[124:127], a[252:255], v[60:63], v[124:127]
    s_waitcnt lgkmcnt(10)
    v_mfma_f32_16x16x32_bf16 v[64:67], a[128:131], v[32:35], v[64:67]
    s_waitcnt lgkmcnt(8)
    ds_read_b64_tr_b16 v[56:57], v31 offset:8192
    v_mfma_f32_16x16x32_bf16 v[64:67], a[144:147], v[36:39], v[64:67]
    ds_read_b64_tr_b16 v[58:59], v31 offset:8704
    v_mfma_f32_16x16x32_bf16 v[68:71], a[132:135], v[32:35], v[68:71]
    ds_read_b64_tr_b16 v[60:61], v31 offset:12288
    v_mfma_f32_16x16x32_bf16 v[68:71], a[148:151], v[36:39], v[68:71]
    ds_read_b64_tr_b16 v[62:63], v31 offset:12800
    v_mfma_f32_16x16x32_bf16 v[72:75], a[136:139], v[32:35], v[72:75]
    buffer_load_dwordx4 v22, s[24:27], s98 offen offset:2048  lds
    v_mfma_f32_16x16x32_bf16 v[72:75], a[152:155], v[36:39], v[72:75]
    v_mfma_f32_16x16x32_bf16 v[76:79], a[140:143], v[32:35], v[76:79]
    v_mfma_f32_16x16x32_bf16 v[76:79], a[156:159], v[36:39], v[76:79]
    s_waitcnt lgkmcnt(10)
    v_mfma_f32_16x16x32_bf16 v[80:83], a[128:131], v[40:43], v[80:83]
    s_waitcnt lgkmcnt(8)
    ds_read_b64_tr_b16 v[32:33], v30 offset:16384
    v_cvt_pk_bf16_f32 v96, v96, v97
    v_mfma_f32_16x16x32_bf16 v[80:83], a[144:147], v[44:47], v[80:83]
    ds_read_b64_tr_b16 v[34:35], v30 offset:16896
    v_cvt_pk_bf16_f32 v97, v98, v99
    v_mfma_f32_16x16x32_bf16 v[84:87], a[132:135], v[40:43], v[84:87]
    ds_read_b64_tr_b16 v[36:37], v30 offset:20480
    v_cvt_pk_bf16_f32 v98, v100, v101
    v_mfma_f32_16x16x32_bf16 v[84:87], a[148:151], v[44:47], v[84:87]
    ds_read_b64_tr_b16 v[38:39], v30 offset:20992
    v_cvt_pk_bf16_f32 v99, v102, v103
    v_mfma_f32_16x16x32_bf16 v[88:91], a[136:139], v[40:43], v[88:91]
    buffer_load_dwordx4 v23, s[24:27], s98 offen offset:3072  lds
    v_mfma_f32_16x16x32_bf16 v[88:91], a[152:155], v[44:47], v[88:91]
    s_add_u32 m0, s63, 147456
    s_xor_b32 s98, s0, 1572864
    s_xor_b32 s79, s1, 32768
    v_mfma_f32_16x16x32_bf16 v[92:95], a[140:143], v[40:43], v[92:95]
    buffer_store_dwordx4 v[96:99], v1, s[8:11], s79 offen offset:0 sc0 sc1
    v_mfma_f32_16x16x32_bf16 v[92:95], a[156:159], v[44:47], v[92:95]
    s_waitcnt lgkmcnt(10)
    v_mfma_f32_16x16x32_bf16 v[64:67], a[160:163], v[48:51], v[64:67]
    s_waitcnt lgkmcnt(8)
    ds_read_b64_tr_b16 v[40:41], v31 offset:16384
    v_mfma_f32_16x16x32_bf16 v[64:67], a[176:179], v[52:55], v[64:67]
    ds_read_b64_tr_b16 v[42:43], v31 offset:16896
    v_mfma_f32_16x16x32_bf16 v[68:71], a[164:167], v[48:51], v[68:71]
    ds_read_b64_tr_b16 v[44:45], v31 offset:20480
    v_cvt_pk_bf16_f32 v104, v104, v105
    v_mfma_f32_16x16x32_bf16 v[68:71], a[180:183], v[52:55], v[68:71]
    ds_read_b64_tr_b16 v[46:47], v31 offset:20992
    v_cvt_pk_bf16_f32 v105, v106, v107
    v_mfma_f32_16x16x32_bf16 v[72:75], a[168:171], v[48:51], v[72:75]
    buffer_load_dwordx4 v20, s[24:27], s98 offen offset:0  lds
    v_mfma_f32_16x16x32_bf16 v[72:75], a[184:187], v[52:55], v[72:75]
    v_cvt_pk_bf16_f32 v106, v108, v109
    v_cvt_pk_bf16_f32 v107, v110, v111
    v_mfma_f32_16x16x32_bf16 v[76:79], a[172:175], v[48:51], v[76:79]
    v_mfma_f32_16x16x32_bf16 v[76:79], a[188:191], v[52:55], v[76:79]
    s_waitcnt lgkmcnt(10)
    v_mfma_f32_16x16x32_bf16 v[80:83], a[160:163], v[56:59], v[80:83]
    s_waitcnt lgkmcnt(8)
    s_xor_b32 s79, s1, 40960
    ds_read_b64_tr_b16 v[48:49], v30 offset:24576
    v_mfma_f32_16x16x32_bf16 v[80:83], a[176:179], v[60:63], v[80:83]
    ds_read_b64_tr_b16 v[50:51], v30 offset:25088
    v_mfma_f32_16x16x32_bf16 v[84:87], a[164:167], v[56:59], v[84:87]
    ds_read_b64_tr_b16 v[52:53], v30 offset:28672
    v_mfma_f32_16x16x32_bf16 v[84:87], a[180:183], v[60:63], v[84:87]
    ds_read_b64_tr_b16 v[54:55], v30 offset:29184
    v_mfma_f32_16x16x32_bf16 v[88:91], a[168:171], v[56:59], v[88:91]
    buffer_load_dwordx4 v21, s[24:27], s98 offen offset:1024  lds
    v_mfma_f32_16x16x32_bf16 v[88:91], a[184:187], v[60:63], v[88:91]
    buffer_store_dwordx4 v[104:107], v1, s[8:11], s79 offen offset:0 sc0 sc1
    v_mfma_f32_16x16x32_bf16 v[92:95], a[172:175], v[56:59], v[92:95]
    v_mfma_f32_16x16x32_bf16 v[92:95], a[188:191], v[60:63], v[92:95]
    s_waitcnt lgkmcnt(10)
    v_mfma_f32_16x16x32_bf16 v[64:67], a[192:195], v[32:35], v[64:67]
    s_waitcnt lgkmcnt(8)
    ds_read_b64_tr_b16 v[56:57], v31 offset:24576
    v_cvt_pk_bf16_f32 v112, v112, v113
    v_mfma_f32_16x16x32_bf16 v[64:67], a[208:211], v[36:39], v[64:67]
    ds_read_b64_tr_b16 v[58:59], v31 offset:25088
    v_cvt_pk_bf16_f32 v113, v114, v115
    v_mfma_f32_16x16x32_bf16 v[68:71], a[196:199], v[32:35], v[68:71]
    ds_read_b64_tr_b16 v[60:61], v31 offset:28672
    v_cvt_pk_bf16_f32 v114, v116, v117
    v_mfma_f32_16x16x32_bf16 v[68:71], a[212:215], v[36:39], v[68:71]
    ds_read_b64_tr_b16 v[62:63], v31 offset:29184
    v_cvt_pk_bf16_f32 v115, v118, v119
    v_mfma_f32_16x16x32_bf16 v[72:75], a[200:203], v[32:35], v[72:75]
    buffer_load_dwordx4 v22, s[24:27], s98 offen offset:2048  lds
    v_mfma_f32_16x16x32_bf16 v[72:75], a[216:219], v[36:39], v[72:75]
    s_xor_b32 s79, s1, 32768
    v_mfma_f32_16x16x32_bf16 v[76:79], a[204:207], v[32:35], v[76:79]
    buffer_store_dwordx4 v[112:115], v1, s[8:11], s79 offen offset:1024 sc0 sc1
    v_mfma_f32_16x16x32_bf16 v[76:79], a[220:223], v[36:39], v[76:79]
    s_waitcnt lgkmcnt(10)
    v_mfma_f32_16x16x32_bf16 v[80:83], a[192:195], v[40:43], v[80:83]
    s_waitcnt lgkmcnt(8)
    v_mfma_f32_16x16x32_bf16 v[80:83], a[208:211], v[44:47], v[80:83]
    buffer_load_dwordx4 v23, s[24:27], s98 offen offset:3072  lds
    v_mfma_f32_16x16x32_bf16 v[84:87], a[196:199], v[40:43], v[84:87]
    v_cvt_pk_bf16_f32 v120, v120, v121
    v_cvt_pk_bf16_f32 v121, v122, v123
    v_mfma_f32_16x16x32_bf16 v[84:87], a[212:215], v[44:47], v[84:87]
    v_cvt_pk_bf16_f32 v122, v124, v125
    v_cvt_pk_bf16_f32 v123, v126, v127
    v_mfma_f32_16x16x32_bf16 v[88:91], a[200:203], v[40:43], v[88:91]
    v_mfma_f32_16x16x32_bf16 v[88:91], a[216:219], v[44:47], v[88:91]
    v_mfma_f32_16x16x32_bf16 v[92:95], a[204:207], v[40:43], v[92:95]
    s_xor_b32 s79, s1, 40960
    s_waitcnt lgkmcnt(0)
    s_barrier
    v_mfma_f32_16x16x32_bf16 v[92:95], a[220:223], v[44:47], v[92:95]
    s_add_u32 m0, s63, 0
    s_xor_b32 s98, s0, 2097152
    ds_read_b64_tr_b16 v[32:33], v28 offset:32768
    v_mfma_f32_16x16x32_bf16 v[64:67], a[224:227], v[48:51], v[64:67]
    ds_read_b64_tr_b16 v[34:35], v28 offset:33280
    v_mfma_f32_16x16x32_bf16 v[64:67], a[240:243], v[52:55], v[64:67]
    ds_read_b64_tr_b16 v[36:37], v28 offset:36864
    v_mfma_f32_16x16x32_bf16 v[68:71], a[228:231], v[48:51], v[68:71]
    ds_read_b64_tr_b16 v[38:39], v28 offset:37376
    v_mfma_f32_16x16x32_bf16 v[68:71], a[244:247], v[52:55], v[68:71]
    ds_read_b64_tr_b16 v[40:41], v29 offset:32768
    v_mfma_f32_16x16x32_bf16 v[72:75], a[232:235], v[48:51], v[72:75]
    ds_read_b64_tr_b16 v[42:43], v29 offset:33280
    v_mfma_f32_16x16x32_bf16 v[72:75], a[248:251], v[52:55], v[72:75]
    ds_read_b64_tr_b16 v[44:45], v29 offset:36864
    v_mfma_f32_16x16x32_bf16 v[76:79], a[236:239], v[48:51], v[76:79]
    ds_read_b64_tr_b16 v[46:47], v29 offset:37376
    v_mfma_f32_16x16x32_bf16 v[76:79], a[252:255], v[52:55], v[76:79]
    buffer_load_dwordx4 v20, s[24:27], s98 offen offset:0  lds
    v_mfma_f32_16x16x32_bf16 v[80:83], a[224:227], v[56:59], v[80:83]
    ds_read_b64_tr_b16 v[48:49], v28 offset:40960
    v_mfma_f32_16x16x32_bf16 v[80:83], a[240:243], v[60:63], v[80:83]
    ds_read_b64_tr_b16 v[50:51], v28 offset:41472
    v_mfma_f32_16x16x32_bf16 v[84:87], a[228:231], v[56:59], v[84:87]
    ds_read_b64_tr_b16 v[52:53], v28 offset:45056
    v_mfma_f32_16x16x32_bf16 v[84:87], a[244:247], v[60:63], v[84:87]
    ds_read_b64_tr_b16 v[54:55], v28 offset:45568
    v_mfma_f32_16x16x32_bf16 v[88:91], a[232:235], v[56:59], v[88:91]
    buffer_store_dwordx4 v[120:123], v1, s[8:11], s79 offen offset:1024 sc0 sc1
    v_mfma_f32_16x16x32_bf16 v[88:91], a[248:251], v[60:63], v[88:91]
    buffer_load_dwordx4 v21, s[24:27], s98 offen offset:1024  lds
    v_mfma_f32_16x16x32_bf16 v[92:95], a[236:239], v[56:59], v[92:95]
    v_mfma_f32_16x16x32_bf16 v[92:95], a[252:255], v[60:63], v[92:95]
    s_waitcnt lgkmcnt(10)
    v_mfma_f32_16x16x32_bf16 v[96:99], a[0:3], v[32:35], 0
    s_waitcnt lgkmcnt(8)
    ds_read_b64_tr_b16 v[56:57], v29 offset:40960
    v_mfma_f32_16x16x32_bf16 v[96:99], a[16:19], v[36:39], v[96:99]
    ds_read_b64_tr_b16 v[58:59], v29 offset:41472
    v_mfma_f32_16x16x32_bf16 v[100:103], a[4:7], v[32:35], 0
    ds_read_b64_tr_b16 v[60:61], v29 offset:45056
    v_mfma_f32_16x16x32_bf16 v[100:103], a[20:23], v[36:39], v[100:103]
    ds_read_b64_tr_b16 v[62:63], v29 offset:45568
    v_mfma_f32_16x16x32_bf16 v[104:107], a[8:11], v[32:35], 0
    buffer_load_dwordx4 v22, s[24:27], s98 offen offset:2048  lds
    v_mfma_f32_16x16x32_bf16 v[104:107], a[24:27], v[36:39], v[104:107]
    v_mfma_f32_16x16x32_bf16 v[108:111], a[12:15], v[32:35], 0
    v_mfma_f32_16x16x32_bf16 v[108:111], a[28:31], v[36:39], v[108:111]
    s_waitcnt lgkmcnt(10)
    v_mfma_f32_16x16x32_bf16 v[112:115], a[0:3], v[40:43], 0
    s_waitcnt lgkmcnt(8)
    ds_read_b64_tr_b16 v[32:33], v28 offset:49152
    v_cvt_pk_bf16_f32 v64, v64, v65
    v_mfma_f32_16x16x32_bf16 v[112:115], a[16:19], v[44:47], v[112:115]
    ds_read_b64_tr_b16 v[34:35], v28 offset:49664
    v_cvt_pk_bf16_f32 v65, v66, v67
    v_mfma_f32_16x16x32_bf16 v[116:119], a[4:7], v[40:43], 0
    ds_read_b64_tr_b16 v[36:37], v28 offset:53248
    v_cvt_pk_bf16_f32 v66, v68, v69
    v_mfma_f32_16x16x32_bf16 v[116:119], a[20:23], v[44:47], v[116:119]
    ds_read_b64_tr_b16 v[38:39], v28 offset:53760
    v_cvt_pk_bf16_f32 v67, v70, v71
    v_mfma_f32_16x16x32_bf16 v[120:123], a[8:11], v[40:43], 0
    buffer_load_dwordx4 v23, s[24:27], s98 offen offset:3072  lds
    v_mfma_f32_16x16x32_bf16 v[120:123], a[24:27], v[44:47], v[120:123]
    s_add_u32 m0, s63, 16384
    s_xor_b32 s98, s0, 2621440
    s_xor_b32 s79, s1, 32768
    v_mfma_f32_16x16x32_bf16 v[124:127], a[12:15], v[40:43], 0
    buffer_store_dwordx4 v[64:67], v1, s[8:11], s79 offen offset:2048 sc0 sc1
    v_mfma_f32_16x16x32_bf16 v[124:127], a[28:31], v[44:47], v[124:127]
    s_waitcnt lgkmcnt(10)
    v_mfma_f32_16x16x32_bf16 v[96:99], a[32:35], v[48:51], v[96:99]
    s_waitcnt lgkmcnt(8)
    ds_read_b64_tr_b16 v[40:41], v29 offset:49152
    v_mfma_f32_16x16x32_bf16 v[96:99], a[48:51], v[52:55], v[96:99]
    ds_read_b64_tr_b16 v[42:43], v29 offset:49664
    v_mfma_f32_16x16x32_bf16 v[100:103], a[36:39], v[48:51], v[100:103]
    ds_read_b64_tr_b16 v[44:45], v29 offset:53248
    v_cvt_pk_bf16_f32 v72, v72, v73
    v_mfma_f32_16x16x32_bf16 v[100:103], a[52:55], v[52:55], v[100:103]
    ds_read_b64_tr_b16 v[46:47], v29 offset:53760
    v_cvt_pk_bf16_f32 v73, v74, v75
    v_mfma_f32_16x16x32_bf16 v[104:107], a[40:43], v[48:51], v[104:107]
    buffer_load_dwordx4 v20, s[24:27], s98 offen offset:0  lds
    v_mfma_f32_16x16x32_bf16 v[104:107], a[56:59], v[52:55], v[104:107]
    v_cvt_pk_bf16_f32 v74, v76, v77
    v_cvt_pk_bf16_f32 v75, v78, v79
    v_mfma_f32_16x16x32_bf16 v[108:111], a[44:47], v[48:51], v[108:111]
    v_mfma_f32_16x16x32_bf16 v[108:111], a[60:63], v[52:55], v[108:111]
    s_waitcnt lgkmcnt(10)
    v_mfma_f32_16x16x32_bf16 v[112:115], a[32:35], v[56:59], v[112:115]
    s_waitcnt lgkmcnt(8)
    s_xor_b32 s79, s1, 40960
    ds_read_b64_tr_b16 v[48:49], v28 offset:57344
    v_mfma_f32_16x16x32_bf16 v[112:115], a[48:51], v[60:63], v[112:115]
    ds_read_b64_tr_b16 v[50:51], v28 offset:57856
    v_mfma_f32_16x16x32_bf16 v[116:119], a[36:39], v[56:59], v[116:119]
    ds_read_b64_tr_b16 v[52:53], v28 offset:61440
    v_mfma_f32_16x16x32_bf16 v[116:119], a[52:55], v[60:63], v[116:119]
    ds_read_b64_tr_b16 v[54:55], v28 offset:61952
    v_mfma_f32_16x16x32_bf16 v[120:123], a[40:43], v[56:59], v[120:123]
    buffer_load_dwordx4 v21, s[24:27], s98 offen offset:1024  lds
    v_mfma_f32_16x16x32_bf16 v[120:123], a[56:59], v[60:63], v[120:123]
    buffer_store_dwordx4 v[72:75], v1, s[8:11], s79 offen offset:2048 sc0 sc1
    v_mfma_f32_16x16x32_bf16 v[124:127], a[44:47], v[56:59], v[124:127]
    v_mfma_f32_16x16x32_bf16 v[124:127], a[60:63], v[60:63], v[124:127]
    s_waitcnt lgkmcnt(10)
    v_mfma_f32_16x16x32_bf16 v[96:99], a[64:67], v[32:35], v[96:99]
    s_waitcnt lgkmcnt(8)
    ds_read_b64_tr_b16 v[56:57], v29 offset:57344
    v_cvt_pk_bf16_f32 v80, v80, v81
    v_mfma_f32_16x16x32_bf16 v[96:99], a[80:83], v[36:39], v[96:99]
    ds_read_b64_tr_b16 v[58:59], v29 offset:57856
    v_cvt_pk_bf16_f32 v81, v82, v83
    v_mfma_f32_16x16x32_bf16 v[100:103], a[68:71], v[32:35], v[100:103]
    ds_read_b64_tr_b16 v[60:61], v29 offset:61440
    v_cvt_pk_bf16_f32 v82, v84, v85
    v_mfma_f32_16x16x32_bf16 v[100:103], a[84:87], v[36:39], v[100:103]
    ds_read_b64_tr_b16 v[62:63], v29 offset:61952
    v_cvt_pk_bf16_f32 v83, v86, v87
    v_mfma_f32_16x16x32_bf16 v[104:107], a[72:75], v[32:35], v[104:107]
    buffer_load_dwordx4 v22, s[24:27], s98 offen offset:2048  lds
    v_mfma_f32_16x16x32_bf16 v[104:107], a[88:91], v[36:39], v[104:107]
    s_xor_b32 s79, s1, 32768
    v_mfma_f32_16x16x32_bf16 v[108:111], a[76:79], v[32:35], v[108:111]
    buffer_store_dwordx4 v[80:83], v1, s[8:11], s79 offen offset:3072 sc0 sc1
    v_mfma_f32_16x16x32_bf16 v[108:111], a[92:95], v[36:39], v[108:111]
    s_waitcnt lgkmcnt(10)
    v_mfma_f32_16x16x32_bf16 v[112:115], a[64:67], v[40:43], v[112:115]
    s_waitcnt lgkmcnt(8)
    ds_read_b64_tr_b16 v[32:33], v30 offset:32768
    v_mfma_f32_16x16x32_bf16 v[112:115], a[80:83], v[44:47], v[112:115]
    ds_read_b64_tr_b16 v[34:35], v30 offset:33280
    v_mfma_f32_16x16x32_bf16 v[116:119], a[68:71], v[40:43], v[116:119]
    ds_read_b64_tr_b16 v[36:37], v30 offset:36864
    v_cvt_pk_bf16_f32 v88, v88, v89
    v_mfma_f32_16x16x32_bf16 v[116:119], a[84:87], v[44:47], v[116:119]
    ds_read_b64_tr_b16 v[38:39], v30 offset:37376
    v_cvt_pk_bf16_f32 v89, v90, v91
    v_mfma_f32_16x16x32_bf16 v[120:123], a[72:75], v[40:43], v[120:123]
    buffer_load_dwordx4 v23, s[24:27], s98 offen offset:3072  lds
    v_mfma_f32_16x16x32_bf16 v[120:123], a[88:91], v[44:47], v[120:123]
    v_cvt_pk_bf16_f32 v90, v92, v93
    v_cvt_pk_bf16_f32 v91, v94, v95
    v_mfma_f32_16x16x32_bf16 v[124:127], a[76:79], v[40:43], v[124:127]
    v_mfma_f32_16x16x32_bf16 v[124:127], a[92:95], v[44:47], v[124:127]
    s_waitcnt lgkmcnt(10)
    v_mfma_f32_16x16x32_bf16 v[96:99], a[96:99], v[48:51], v[96:99]
    s_waitcnt lgkmcnt(8)
    s_xor_b32 s79, s1, 40960
    ds_read_b64_tr_b16 v[40:41], v31 offset:32768
    v_mfma_f32_16x16x32_bf16 v[96:99], a[112:115], v[52:55], v[96:99]
    ds_read_b64_tr_b16 v[42:43], v31 offset:33280
    v_mfma_f32_16x16x32_bf16 v[100:103], a[100:103], v[48:51], v[100:103]
    ds_read_b64_tr_b16 v[44:45], v31 offset:36864
    v_mfma_f32_16x16x32_bf16 v[100:103], a[116:119], v[52:55], v[100:103]
    ds_read_b64_tr_b16 v[46:47], v31 offset:37376
    v_mfma_f32_16x16x32_bf16 v[104:107], a[104:107], v[48:51], v[104:107]
    buffer_store_dwordx4 v[88:91], v1, s[8:11], s79 offen offset:3072 sc0 sc1
    v_mfma_f32_16x16x32_bf16 v[104:107], a[120:123], v[52:55], v[104:107]
    v_mfma_f32_16x16x32_bf16 v[108:111], a[108:111], v[48:51], v[108:111]
    v_mfma_f32_16x16x32_bf16 v[108:111], a[124:127], v[52:55], v[108:111]
    s_waitcnt lgkmcnt(10)
    v_mfma_f32_16x16x32_bf16 v[112:115], a[96:99], v[56:59], v[112:115]
    s_waitcnt lgkmcnt(8)
    ds_read_b64_tr_b16 v[48:49], v30 offset:40960
    v_mfma_f32_16x16x32_bf16 v[112:115], a[112:115], v[60:63], v[112:115]
    ds_read_b64_tr_b16 v[50:51], v30 offset:41472
    v_mfma_f32_16x16x32_bf16 v[116:119], a[100:103], v[56:59], v[116:119]
    ds_read_b64_tr_b16 v[52:53], v30 offset:45056
    v_mfma_f32_16x16x32_bf16 v[116:119], a[116:119], v[60:63], v[116:119]
    ds_read_b64_tr_b16 v[54:55], v30 offset:45568
    v_mfma_f32_16x16x32_bf16 v[120:123], a[104:107], v[56:59], v[120:123]
    v_mfma_f32_16x16x32_bf16 v[120:123], a[120:123], v[60:63], v[120:123]
    v_mfma_f32_16x16x32_bf16 v[124:127], a[108:111], v[56:59], v[124:127]
    v_mfma_f32_16x16x32_bf16 v[124:127], a[124:127], v[60:63], v[124:127]
    s_waitcnt lgkmcnt(10)
    v_mfma_f32_16x16x32_bf16 v[64:67], a[0:3], v[32:35], 0
    s_waitcnt lgkmcnt(8)
    ds_read_b64_tr_b16 v[56:57], v31 offset:40960
    v_mfma_f32_16x16x32_bf16 v[64:67], a[16:19], v[36:39], v[64:67]
    ds_read_b64_tr_b16 v[58:59], v31 offset:41472
    v_mfma_f32_16x16x32_bf16 v[68:71], a[4:7], v[32:35], 0
    ds_read_b64_tr_b16 v[60:61], v31 offset:45056
    v_mfma_f32_16x16x32_bf16 v[68:71], a[20:23], v[36:39], v[68:71]
    ds_read_b64_tr_b16 v[62:63], v31 offset:45568
    v_mfma_f32_16x16x32_bf16 v[72:75], a[8:11], v[32:35], 0
    v_mfma_f32_16x16x32_bf16 v[72:75], a[24:27], v[36:39], v[72:75]
    v_mfma_f32_16x16x32_bf16 v[76:79], a[12:15], v[32:35], 0
    v_mfma_f32_16x16x32_bf16 v[76:79], a[28:31], v[36:39], v[76:79]
    s_waitcnt lgkmcnt(10)
    v_mfma_f32_16x16x32_bf16 v[80:83], a[0:3], v[40:43], 0
    s_waitcnt lgkmcnt(8)
    ds_read_b64_tr_b16 v[32:33], v30 offset:49152
    v_mfma_f32_16x16x32_bf16 v[80:83], a[16:19], v[44:47], v[80:83]
    ds_read_b64_tr_b16 v[34:35], v30 offset:49664
    v_mfma_f32_16x16x32_bf16 v[84:87], a[4:7], v[40:43], 0
    ds_read_b64_tr_b16 v[36:37], v30 offset:53248
    v_cvt_pk_bf16_f32 v208, v208, v209
    v_mfma_f32_16x16x32_bf16 v[84:87], a[20:23], v[44:47], v[84:87]
    ds_read_b64_tr_b16 v[38:39], v30 offset:53760
    v_cvt_pk_bf16_f32 v209, v210, v211
    v_mfma_f32_16x16x32_bf16 v[88:91], a[8:11], v[40:43], 0
    v_cvt_pk_bf16_f32 v210, v212, v213
    v_cvt_pk_bf16_f32 v211, v214, v215
    v_mfma_f32_16x16x32_bf16 v[88:91], a[24:27], v[44:47], v[88:91]
    s_xor_b32 s79, s65, 8192
    v_mfma_f32_16x16x32_bf16 v[92:95], a[12:15], v[40:43], 0
    buffer_store_dwordx4 v[208:211], v1, s[8:11], s79 offen offset:2048 sc0 sc1
    v_mfma_f32_16x16x32_bf16 v[92:95], a[28:31], v[44:47], v[92:95]
    s_waitcnt lgkmcnt(10)
    v_mfma_f32_16x16x32_bf16 v[64:67], a[32:35], v[48:51], v[64:67]
    s_waitcnt lgkmcnt(8)
    ds_read_b64_tr_b16 v[40:41], v31 offset:49152
    v_mfma_f32_16x16x32_bf16 v[64:67], a[48:51], v[52:55], v[64:67]
    ds_read_b64_tr_b16 v[42:43], v31 offset:49664
    v_mfma_f32_16x16x32_bf16 v[68:71], a[36:39], v[48:51], v[68:71]
    ds_read_b64_tr_b16 v[44:45], v31 offset:53248
    v_mfma_f32_16x16x32_bf16 v[68:71], a[52:55], v[52:55], v[68:71]
    ds_read_b64_tr_b16 v[46:47], v31 offset:53760
    v_mfma_f32_16x16x32_bf16 v[72:75], a[40:43], v[48:51], v[72:75]
    buffer_load_dword v3, v16, s[8:11], s78 offen sc0 sc1
    v_mfma_f32_16x16x32_bf16 v[72:75], a[56:59], v[52:55], v[72:75]
    v_mfma_f32_16x16x32_bf16 v[76:79], a[44:47], v[48:51], v[76:79]
    v_mfma_f32_16x16x32_bf16 v[76:79], a[60:63], v[52:55], v[76:79]
    s_waitcnt lgkmcnt(10)
    v_mfma_f32_16x16x32_bf16 v[80:83], a[32:35], v[56:59], v[80:83]
    s_waitcnt lgkmcnt(8)
    ds_read_b64_tr_b16 v[48:49], v30 offset:57344
    v_mfma_f32_16x16x32_bf16 v[80:83], a[48:51], v[60:63], v[80:83]
    ds_read_b64_tr_b16 v[50:51], v30 offset:57856
    v_mfma_f32_16x16x32_bf16 v[84:87], a[36:39], v[56:59], v[84:87]
    ds_read_b64_tr_b16 v[52:53], v30 offset:61440
    v_mfma_f32_16x16x32_bf16 v[84:87], a[52:55], v[60:63], v[84:87]
    ds_read_b64_tr_b16 v[54:55], v30 offset:61952
    v_mfma_f32_16x16x32_bf16 v[88:91], a[40:43], v[56:59], v[88:91]
    v_cvt_pk_bf16_f32 v216, v216, v217
    v_cvt_pk_bf16_f32 v217, v218, v219
    v_mfma_f32_16x16x32_bf16 v[88:91], a[56:59], v[60:63], v[88:91]
    v_cvt_pk_bf16_f32 v218, v220, v221
    v_cvt_pk_bf16_f32 v219, v222, v223
    v_mfma_f32_16x16x32_bf16 v[92:95], a[44:47], v[56:59], v[92:95]
    v_mfma_f32_16x16x32_bf16 v[92:95], a[60:63], v[60:63], v[92:95]
    s_waitcnt lgkmcnt(10)
    v_mfma_f32_16x16x32_bf16 v[64:67], a[64:67], v[32:35], v[64:67]
    s_waitcnt lgkmcnt(8)
    s_xor_b32 s79, s65, 8192
    ds_read_b64_tr_b16 v[56:57], v31 offset:57344
    v_mfma_f32_16x16x32_bf16 v[64:67], a[80:83], v[36:39], v[64:67]
    ds_read_b64_tr_b16 v[58:59], v31 offset:57856
    v_mfma_f32_16x16x32_bf16 v[68:71], a[68:71], v[32:35], v[68:71]
    ds_read_b64_tr_b16 v[60:61], v31 offset:61440
    v_mfma_f32_16x16x32_bf16 v[68:71], a[84:87], v[36:39], v[68:71]
    ds_read_b64_tr_b16 v[62:63], v31 offset:61952
    v_mfma_f32_16x16x32_bf16 v[72:75], a[72:75], v[32:35], v[72:75]
    buffer_store_dwordx4 v[216:219], v1, s[8:11], s79 offen offset:3072 sc0 sc1
    v_mfma_f32_16x16x32_bf16 v[72:75], a[88:91], v[36:39], v[72:75]
    v_mfma_f32_16x16x32_bf16 v[76:79], a[76:79], v[32:35], v[76:79]
    v_mfma_f32_16x16x32_bf16 v[76:79], a[92:95], v[36:39], v[76:79]
    s_waitcnt lgkmcnt(10)
    v_mfma_f32_16x16x32_bf16 v[80:83], a[64:67], v[40:43], v[80:83]
    s_waitcnt lgkmcnt(8)
    v_mfma_f32_16x16x32_bf16 v[80:83], a[80:83], v[44:47], v[80:83]
    v_mfma_f32_16x16x32_bf16 v[84:87], a[68:71], v[40:43], v[84:87]
    v_mfma_f32_16x16x32_bf16 v[84:87], a[84:87], v[44:47], v[84:87]
    v_mfma_f32_16x16x32_bf16 v[88:91], a[72:75], v[40:43], v[88:91]
    v_mfma_f32_16x16x32_bf16 v[88:91], a[88:91], v[44:47], v[88:91]
    v_mfma_f32_16x16x32_bf16 v[92:95], a[76:79], v[40:43], v[92:95]
    v_xor_b32 v28, 65536, v28
    v_cvt_pk_bf16_f32 v224, v224, v225
    s_waitcnt vmcnt(28) lgkmcnt(0)
    s_barrier
    v_mfma_f32_16x16x32_bf16 v[92:95], a[92:95], v[44:47], v[92:95]
    s_add_u32 m0, s63, 32768
    ds_read_b64_tr_b16 v[32:33], v28 offset:0
    v_xor_b32 v29, 65536, v29
    v_mfma_f32_16x16x32_bf16 v[64:67], a[96:99], v[48:51], v[64:67]
    s_xor_b32 s98, s0, 3145728
    ds_read_b64_tr_b16 v[34:35], v28 offset:512
    v_cvt_pk_bf16_f32 v225, v226, v227
    v_mfma_f32_16x16x32_bf16 v[64:67], a[112:115], v[52:55], v[64:67]
    ds_read_b64_tr_b16 v[36:37], v28 offset:4096
    v_cvt_pk_bf16_f32 v226, v228, v229
    v_mfma_f32_16x16x32_bf16 v[68:71], a[100:103], v[48:51], v[68:71]
    ds_read_b64_tr_b16 v[38:39], v28 offset:4608
    v_cvt_pk_bf16_f32 v227, v230, v231
    v_mfma_f32_16x16x32_bf16 v[68:71], a[116:119], v[52:55], v[68:71]
    s_xor_b32 s79, s65, 12288
    ds_read_b64_tr_b16 v[40:41], v29 offset:0
    v_mfma_f32_16x16x32_bf16 v[72:75], a[104:107], v[48:51], v[72:75]
    ds_read_b64_tr_b16 v[42:43], v29 offset:512
    v_mfma_f32_16x16x32_bf16 v[72:75], a[120:123], v[52:55], v[72:75]
    ds_read_b64_tr_b16 v[44:45], v29 offset:4096
    v_mfma_f32_16x16x32_bf16 v[76:79], a[108:111], v[48:51], v[76:79]
    ds_read_b64_tr_b16 v[46:47], v29 offset:4608
    v_mfma_f32_16x16x32_bf16 v[76:79], a[124:127], v[52:55], v[76:79]
    buffer_load_dwordx4 v20, s[24:27], s98 offen offset:0  lds
    v_mfma_f32_16x16x32_bf16 v[80:83], a[96:99], v[56:59], v[80:83]
    ds_read_b64_tr_b16 v[48:49], v28 offset:8192
    v_mfma_f32_16x16x32_bf16 v[80:83], a[112:115], v[60:63], v[80:83]
    ds_read_b64_tr_b16 v[50:51], v28 offset:8704
    v_mfma_f32_16x16x32_bf16 v[84:87], a[100:103], v[56:59], v[84:87]
    ds_read_b64_tr_b16 v[52:53], v28 offset:12288
    v_mfma_f32_16x16x32_bf16 v[84:87], a[116:119], v[60:63], v[84:87]
    ds_read_b64_tr_b16 v[54:55], v28 offset:12800
    v_mfma_f32_16x16x32_bf16 v[88:91], a[104:107], v[56:59], v[88:91]
    buffer_store_dwordx4 v[224:227], v1, s[8:11], s79 offen offset:0 sc0 sc1
    v_mfma_f32_16x16x32_bf16 v[88:91], a[120:123], v[60:63], v[88:91]
    buffer_load_dwordx4 v21, s[24:27], s98 offen offset:1024  lds
    v_mfma_f32_16x16x32_bf16 v[92:95], a[108:111], v[56:59], v[92:95]
    v_mfma_f32_16x16x32_bf16 v[92:95], a[124:127], v[60:63], v[92:95]
    s_waitcnt lgkmcnt(10)
    v_mfma_f32_16x16x32_bf16 v[96:99], a[128:131], v[32:35], v[96:99]
    s_waitcnt lgkmcnt(8)
    ds_read_b64_tr_b16 v[56:57], v29 offset:8192
    v_cvt_pk_bf16_f32 v232, v232, v233
    s_waitcnt vmcnt(4)
    v_cmp_ne_u32 vcc, 0, v3
    s_cmp_eq_u64 vcc, -1
    s_cbranch_scc0 L_H_slow_3
L_H_ok_4:
    v_mfma_f32_16x16x32_bf16 v[96:99], a[144:147], v[36:39], v[96:99]
    ds_read_b64_tr_b16 v[58:59], v29 offset:8704
    v_cvt_pk_bf16_f32 v233, v234, v235
    v_mfma_f32_16x16x32_bf16 v[100:103], a[132:135], v[32:35], v[100:103]
    s_xor_b32 s80, s75, 0
    ds_read_b64_tr_b16 v[60:61], v29 offset:12288
    v_cvt_pk_bf16_f32 v234, v236, v237
    v_mfma_f32_16x16x32_bf16 v[100:103], a[148:151], v[36:39], v[100:103]
    ds_read_b64_tr_b16 v[62:63], v29 offset:12800
    v_cvt_pk_bf16_f32 v235, v238, v239
    v_mfma_f32_16x16x32_bf16 v[104:107], a[136:139], v[32:35], v[104:107]
    buffer_load_dwordx4 v22, s[24:27], s98 offen offset:2048  lds
    v_mfma_f32_16x16x32_bf16 v[104:107], a[152:155], v[36:39], v[104:107]
    s_waitcnt lgkmcnt(10)
    s_xor_b32 s79, s65, 12288
    v_mfma_f32_16x16x32_bf16 v[108:111], a[140:143], v[32:35], v[108:111]
    buffer_store_dwordx4 v[232:235], v1, s[8:11], s79 offen offset:1024 sc0 sc1
    v_mfma_f32_16x16x32_bf16 v[108:111], a[156:159], v[36:39], v[108:111]
    buffer_load_dwordx4 a[0:3], v1, s[8:11], s80 offen offset:0
    v_mfma_f32_16x16x32_bf16 v[112:115], a[128:131], v[40:43], v[112:115]
    s_waitcnt lgkmcnt(8)
    s_xor_b32 s80, s75, 16384
    ds_read_b64_tr_b16 v[32:33], v28 offset:16384
    v_mfma_f32_16x16x32_bf16 v[112:115], a[144:147], v[44:47], v[112:115]
    ds_read_b64_tr_b16 v[34:35], v28 offset:16896
    v_mfma_f32_16x16x32_bf16 v[116:119], a[132:135], v[40:43], v[116:119]
    ds_read_b64_tr_b16 v[36:37], v28 offset:20480
    v_mfma_f32_16x16x32_bf16 v[116:119], a[148:151], v[44:47], v[116:119]
    ds_read_b64_tr_b16 v[38:39], v28 offset:20992
    v_mfma_f32_16x16x32_bf16 v[120:123], a[136:139], v[40:43], v[120:123]
    buffer_load_dwordx4 v23, s[24:27], s98 offen offset:3072  lds
    v_mfma_f32_16x16x32_bf16 v[120:123], a[152:155], v[44:47], v[120:123]
    s_add_u32 m0, s63, 49152
    s_xor_b32 s98, s0, 3670016
    v_mfma_f32_16x16x32_bf16 v[124:127], a[140:143], v[40:43], v[124:127]
    buffer_load_dwordx4 a[4:7], v1, s[8:11], s80 offen offset:0
    v_mfma_f32_16x16x32_bf16 v[124:127], a[156:159], v[44:47], v[124:127]
    s_waitcnt lgkmcnt(10)
    v_mfma_f32_16x16x32_bf16 v[96:99], a[160:163], v[48:51], v[96:99]
    s_waitcnt lgkmcnt(8)
    s_xor_b32 s80, s76, 0
    ds_read_b64_tr_b16 v[40:41], v29 offset:16384
    v_mfma_f32_16x16x32_bf16 v[96:99], a[176:179], v[52:55], v[96:99]
    ds_read_b64_tr_b16 v[42:43], v29 offset:16896
    v_mfma_f32_16x16x32_bf16 v[100:103], a[164:167], v[48:51], v[100:103]
    ds_read_b64_tr_b16 v[44:45], v29 offset:20480
    v_cvt_pk_bf16_f32 v240, v240, v241
    v_mfma_f32_16x16x32_bf16 v[100:103], a[180:183], v[52:55], v[100:103]
    ds_read_b64_tr_b16 v[46:47], v29 offset:20992
    v_cvt_pk_bf16_f32 v241, v242, v243
    v_mfma_f32_16x16x32_bf16 v[104:107], a[168:171], v[48:51], v[104:107]
    buffer_load_dwordx4 v20, s[24:27], s98 offen offset:0  lds
    v_mfma_f32_16x16x32_bf16 v[104:107], a[184:187], v[52:55], v[104:107]
    v_cvt_pk_bf16_f32 v242, v244, v245
    v_cvt_pk_bf16_f32 v243, v246, v247
    v_mfma_f32_16x16x32_bf16 v[108:111], a[172:175], v[48:51], v[108:111]
    buffer_load_dwordx4 a[8:11], v1, s[8:11], s80 offen offset:0
    v_mfma_f32_16x16x32_bf16 v[108:111], a[188:191], v[52:55], v[108:111]
    s_waitcnt lgkmcnt(10)
    v_mfma_f32_16x16x32_bf16 v[112:115], a[160:163], v[56:59], v[112:115]
    s_waitcnt lgkmcnt(8)
    s_xor_b32 s79, s65, 12288
    s_xor_b32 s80, s76, 16384
    ds_read_b64_tr_b16 v[48:49], v28 offset:24576
    v_mfma_f32_16x16x32_bf16 v[112:115], a[176:179], v[60:63], v[112:115]
    ds_read_b64_tr_b16 v[50:51], v28 offset:25088
    v_mfma_f32_16x16x32_bf16 v[116:119], a[164:167], v[56:59], v[116:119]
    ds_read_b64_tr_b16 v[52:53], v28 offset:28672
    v_mfma_f32_16x16x32_bf16 v[116:119], a[180:183], v[60:63], v[116:119]
    ds_read_b64_tr_b16 v[54:55], v28 offset:29184
    v_mfma_f32_16x16x32_bf16 v[120:123], a[168:171], v[56:59], v[120:123]
    buffer_load_dwordx4 v21, s[24:27], s98 offen offset:1024  lds
    v_mfma_f32_16x16x32_bf16 v[120:123], a[184:187], v[60:63], v[120:123]
    buffer_store_dwordx4 v[240:243], v1, s[8:11], s79 offen offset:2048 sc0 sc1
    v_mfma_f32_16x16x32_bf16 v[124:127], a[172:175], v[56:59], v[124:127]
    buffer_load_dwordx4 a[12:15], v1, s[8:11], s80 offen offset:0
    v_mfma_f32_16x16x32_bf16 v[124:127], a[188:191], v[60:63], v[124:127]
    s_waitcnt lgkmcnt(10)
    v_mfma_f32_16x16x32_bf16 v[96:99], a[192:195], v[32:35], v[96:99]
    s_waitcnt lgkmcnt(8)
    s_xor_b32 s80, s75, 0
    ds_read_b64_tr_b16 v[56:57], v29 offset:24576
    v_mfma_f32_16x16x32_bf16 v[96:99], a[208:211], v[36:39], v[96:99]
    ds_read_b64_tr_b16 v[58:59], v29 offset:25088
    v_mfma_f32_16x16x32_bf16 v[100:103], a[196:199], v[32:35], v[100:103]
    ds_read_b64_tr_b16 v[60:61], v29 offset:28672
    v_mfma_f32_16x16x32_bf16 v[100:103], a[212:215], v[36:39], v[100:103]
    ds_read_b64_tr_b16 v[62:63], v29 offset:29184
    v_mfma_f32_16x16x32_bf16 v[104:107], a[200:203], v[32:35], v[104:107]
    buffer_load_dwordx4 v22, s[24:27], s98 offen offset:2048  lds
    v_mfma_f32_16x16x32_bf16 v[104:107], a[216:219], v[36:39], v[104:107]
    v_cvt_pk_bf16_f32 v248, v248, v249
    v_cvt_pk_bf16_f32 v249, v250, v251
    v_mfma_f32_16x16x32_bf16 v[108:111], a[204:207], v[32:35], v[108:111]
    buffer_load_dwordx4 a[16:19], v1, s[8:11], s80 offen offset:1024
    v_mfma_f32_16x16x32_bf16 v[108:111], a[220:223], v[36:39], v[108:111]
    s_waitcnt lgkmcnt(10)
    s_xor_b32 s80, s75, 16384
    v_xor_b32 v30, 65536, v30
    v_cvt_pk_bf16_f32 v250, v252, v253
    v_mfma_f32_16x16x32_bf16 v[112:115], a[192:195], v[40:43], v[112:115]
    s_waitcnt lgkmcnt(8)
    ds_read_b64_tr_b16 v[32:33], v30 offset:0
    v_cvt_pk_bf16_f32 v251, v254, v255
    v_mfma_f32_16x16x32_bf16 v[112:115], a[208:211], v[44:47], v[112:115]
    s_xor_b32 s79, s65, 12288
    ds_read_b64_tr_b16 v[34:35], v30 offset:512
    v_mfma_f32_16x16x32_bf16 v[116:119], a[196:199], v[40:43], v[116:119]
    ds_read_b64_tr_b16 v[36:37], v30 offset:4096
    v_mfma_f32_16x16x32_bf16 v[116:119], a[212:215], v[44:47], v[116:119]
    ds_read_b64_tr_b16 v[38:39], v30 offset:4608
    v_mfma_f32_16x16x32_bf16 v[120:123], a[200:203], v[40:43], v[120:123]
    buffer_load_dwordx4 v23, s[24:27], s98 offen offset:3072  lds
    v_mfma_f32_16x16x32_bf16 v[120:123], a[216:219], v[44:47], v[120:123]
    buffer_store_dwordx4 v[248:251], v1, s[8:11], s79 offen offset:3072 sc0 sc1
    v_mfma_f32_16x16x32_bf16 v[124:127], a[204:207], v[40:43], v[124:127]
    buffer_load_dwordx4 a[20:23], v1, s[8:11], s80 offen offset:1024
    v_mfma_f32_16x16x32_bf16 v[124:127], a[220:223], v[44:47], v[124:127]
    s_waitcnt lgkmcnt(10)
    s_xor_b32 s80, s76, 0
    v_xor_b32 v31, 65536, v31
    v_mfma_f32_16x16x32_bf16 v[96:99], a[224:227], v[48:51], v[96:99]
    s_waitcnt lgkmcnt(8)
    ds_read_b64_tr_b16 v[40:41], v31 offset:0
    v_mfma_f32_16x16x32_bf16 v[96:99], a[240:243], v[52:55], v[96:99]
    ds_read_b64_tr_b16 v[42:43], v31 offset:512
    v_mfma_f32_16x16x32_bf16 v[100:103], a[228:231], v[48:51], v[100:103]
    ds_read_b64_tr_b16 v[44:45], v31 offset:4096
    v_mfma_f32_16x16x32_bf16 v[100:103], a[244:247], v[52:55], v[100:103]
    ds_read_b64_tr_b16 v[46:47], v31 offset:4608
    v_mfma_f32_16x16x32_bf16 v[104:107], a[232:235], v[48:51], v[104:107]
    buffer_load_dwordx4 a[24:27], v1, s[8:11], s80 offen offset:1024
    v_mfma_f32_16x16x32_bf16 v[104:107], a[248:251], v[52:55], v[104:107]
    s_xor_b32 s80, s76, 16384
    v_mfma_f32_16x16x32_bf16 v[108:111], a[236:239], v[48:51], v[108:111]
    buffer_load_dwordx4 a[28:31], v1, s[8:11], s80 offen offset:1024
    v_mfma_f32_16x16x32_bf16 v[108:111], a[252:255], v[52:55], v[108:111]
    s_waitcnt lgkmcnt(10)
    v_mfma_f32_16x16x32_bf16 v[112:115], a[224:227], v[56:59], v[112:115]
    s_waitcnt lgkmcnt(8)
    ds_read_b64_tr_b16 v[48:49], v30 offset:8192
    v_mfma_f32_16x16x32_bf16 v[112:115], a[240:243], v[60:63], v[112:115]
    s_xor_b32 s80, s75, 2048
    ds_read_b64_tr_b16 v[50:51], v30 offset:8704
    v_mfma_f32_16x16x32_bf16 v[116:119], a[228:231], v[56:59], v[116:119]
    ds_read_b64_tr_b16 v[52:53], v30 offset:12288
    v_mfma_f32_16x16x32_bf16 v[116:119], a[244:247], v[60:63], v[116:119]
    ds_read_b64_tr_b16 v[54:55], v30 offset:12800
    v_mfma_f32_16x16x32_bf16 v[120:123], a[232:235], v[56:59], v[120:123]
    buffer_load_dwordx4 a[32:35], v1, s[8:11], s80 offen offset:0
    v_mfma_f32_16x16x32_bf16 v[120:123], a[248:251], v[60:63], v[120:123]
    v_mfma_f32_16x16x32_bf16 v[124:127], a[236:239], v[56:59], v[124:127]
    v_mfma_f32_16x16x32_bf16 v[124:127], a[252:255], v[60:63], v[124:127]
    s_waitcnt lgkmcnt(10)
    v_mfma_f32_16x16x32_bf16 v[64:67], a[128:131], v[32:35], v[64:67]
    s_waitcnt lgkmcnt(8)
    s_xor_b32 s80, s75, 18432
    ds_read_b64_tr_b16 v[56:57], v31 offset:8192
    v_mfma_f32_16x16x32_bf16 v[64:67], a[144:147], v[36:39], v[64:67]
    ds_read_b64_tr_b16 v[58:59], v31 offset:8704
    v_mfma_f32_16x16x32_bf16 v[68:71], a[132:135], v[32:35], v[68:71]
    ds_read_b64_tr_b16 v[60:61], v31 offset:12288
    v_mfma_f32_16x16x32_bf16 v[68:71], a[148:151], v[36:39], v[68:71]
    ds_read_b64_tr_b16 v[62:63], v31 offset:12800
    v_mfma_f32_16x16x32_bf16 v[72:75], a[136:139], v[32:35], v[72:75]
    buffer_load_dwordx4 a[36:39], v1, s[8:11], s80 offen offset:0
    v_mfma_f32_16x16x32_bf16 v[72:75], a[152:155], v[36:39], v[72:75]
    v_mfma_f32_16x16x32_bf16 v[76:79], a[140:143], v[32:35], v[76:79]
    v_mfma_f32_16x16x32_bf16 v[76:79], a[156:159], v[36:39], v[76:79]
    s_waitcnt lgkmcnt(10)
    v_mfma_f32_16x16x32_bf16 v[80:83], a[128:131], v[40:43], v[80:83]
    s_waitcnt lgkmcnt(8)
    s_xor_b32 s80, s76, 2048
    ds_read_b64_tr_b16 v[32:33], v30 offset:16384
    v_cvt_pk_bf16_f32 v96, v96, v97
    v_mfma_f32_16x16x32_bf16 v[80:83], a[144:147], v[44:47], v[80:83]
    ds_read_b64_tr_b16 v[34:35], v30 offset:16896
    v_cvt_pk_bf16_f32 v97, v98, v99
    v_mfma_f32_16x16x32_bf16 v[84:87], a[132:135], v[40:43], v[84:87]
    ds_read_b64_tr_b16 v[36:37], v30 offset:20480
    v_cvt_pk_bf16_f32 v98, v100, v101
    v_mfma_f32_16x16x32_bf16 v[84:87], a[148:151], v[44:47], v[84:87]
    ds_read_b64_tr_b16 v[38:39], v30 offset:20992
    v_cvt_pk_bf16_f32 v99, v102, v103
    v_mfma_f32_16x16x32_bf16 v[88:91], a[136:139], v[40:43], v[88:91]
    s_xor_b32 s79, s1, 36864
    v_mfma_f32_16x16x32_bf16 v[88:91], a[152:155], v[44:47], v[88:91]
    buffer_store_dwordx4 v[96:99], v1, s[8:11], s79 offen offset:0 sc0 sc1
    v_mfma_f32_16x16x32_bf16 v[92:95], a[140:143], v[40:43], v[92:95]
    buffer_load_dwordx4 a[40:43], v1, s[8:11], s80 offen offset:0
    v_mfma_f32_16x16x32_bf16 v[92:95], a[156:159], v[44:47], v[92:95]
    s_waitcnt lgkmcnt(10)
    v_mfma_f32_16x16x32_bf16 v[64:67], a[160:163], v[48:51], v[64:67]
    s_waitcnt lgkmcnt(8)
    s_xor_b32 s80, s76, 18432
    ds_read_b64_tr_b16 v[40:41], v31 offset:16384
    v_mfma_f32_16x16x32_bf16 v[64:67], a[176:179], v[52:55], v[64:67]
    ds_read_b64_tr_b16 v[42:43], v31 offset:16896
    v_mfma_f32_16x16x32_bf16 v[68:71], a[164:167], v[48:51], v[68:71]
    ds_read_b64_tr_b16 v[44:45], v31 offset:20480
    v_cvt_pk_bf16_f32 v104, v104, v105
    v_mfma_f32_16x16x32_bf16 v[68:71], a[180:183], v[52:55], v[68:71]
    ds_read_b64_tr_b16 v[46:47], v31 offset:20992
    v_cvt_pk_bf16_f32 v105, v106, v107
    v_mfma_f32_16x16x32_bf16 v[72:75], a[168:171], v[48:51], v[72:75]
    v_cvt_pk_bf16_f32 v106, v108, v109
    v_cvt_pk_bf16_f32 v107, v110, v111
    v_mfma_f32_16x16x32_bf16 v[72:75], a[184:187], v[52:55], v[72:75]
    s_waitcnt lgkmcnt(10)
    s_xor_b32 s79, s1, 45056
    v_mfma_f32_16x16x32_bf16 v[76:79], a[172:175], v[48:51], v[76:79]
    buffer_store_dwordx4 v[104:107], v1, s[8:11], s79 offen offset:0 sc0 sc1
    v_mfma_f32_16x16x32_bf16 v[76:79], a[188:191], v[52:55], v[76:79]
    buffer_load_dwordx4 a[44:47], v1, s[8:11], s80 offen offset:0
    v_mfma_f32_16x16x32_bf16 v[80:83], a[160:163], v[56:59], v[80:83]
    s_waitcnt lgkmcnt(8)
    s_xor_b32 s80, s75, 2048
    ds_read_b64_tr_b16 v[48:49], v30 offset:24576
    v_mfma_f32_16x16x32_bf16 v[80:83], a[176:179], v[60:63], v[80:83]
    ds_read_b64_tr_b16 v[50:51], v30 offset:25088
    v_mfma_f32_16x16x32_bf16 v[84:87], a[164:167], v[56:59], v[84:87]
    ds_read_b64_tr_b16 v[52:53], v30 offset:28672
    v_mfma_f32_16x16x32_bf16 v[84:87], a[180:183], v[60:63], v[84:87]
    ds_read_b64_tr_b16 v[54:55], v30 offset:29184
    v_mfma_f32_16x16x32_bf16 v[88:91], a[168:171], v[56:59], v[88:91]
    buffer_load_dwordx4 a[48:51], v1, s[8:11], s80 offen offset:1024
    v_mfma_f32_16x16x32_bf16 v[88:91], a[184:187], v[60:63], v[88:91]
    s_xor_b32 s80, s75, 18432
    v_mfma_f32_16x16x32_bf16 v[92:95], a[172:175], v[56:59], v[92:95]
    buffer_load_dwordx4 a[52:55], v1, s[8:11], s80 offen offset:1024
    v_mfma_f32_16x16x32_bf16 v[92:95], a[188:191], v[60:63], v[92:95]
    s_waitcnt lgkmcnt(10)
    v_mfma_f32_16x16x32_bf16 v[64:67], a[192:195], v[32:35], v[64:67]
    s_waitcnt lgkmcnt(8)
    ds_read_b64_tr_b16 v[56:57], v31 offset:24576
    v_cvt_pk_bf16_f32 v112, v112, v113
    v_mfma_f32_16x16x32_bf16 v[64:67], a[208:211], v[36:39], v[64:67]
    ds_read_b64_tr_b16 v[58:59], v31 offset:25088
    v_cvt_pk_bf16_f32 v113, v114, v115
    v_mfma_f32_16x16x32_bf16 v[68:71], a[196:199], v[32:35], v[68:71]
    ds_read_b64_tr_b16 v[60:61], v31 offset:28672
    v_cvt_pk_bf16_f32 v114, v116, v117
    v_mfma_f32_16x16x32_bf16 v[68:71], a[212:215], v[36:39], v[68:71]
    s_xor_b32 s80, s76, 2048
    ds_read_b64_tr_b16 v[62:63], v31 offset:29184
    v_cvt_pk_bf16_f32 v115, v118, v119
    v_mfma_f32_16x16x32_bf16 v[72:75], a[200:203], v[32:35], v[72:75]
    s_xor_b32 s79, s1, 36864
    v_mfma_f32_16x16x32_bf16 v[72:75], a[216:219], v[36:39], v[72:75]
    buffer_store_dwordx4 v[112:115], v1, s[8:11], s79 offen offset:1024 sc0 sc1
    v_mfma_f32_16x16x32_bf16 v[76:79], a[204:207], v[32:35], v[76:79]
    buffer_load_dwordx4 a[56:59], v1, s[8:11], s80 offen offset:1024
    v_mfma_f32_16x16x32_bf16 v[76:79], a[220:223], v[36:39], v[76:79]
    s_waitcnt lgkmcnt(10)
    v_mfma_f32_16x16x32_bf16 v[80:83], a[192:195], v[40:43], v[80:83]
    s_waitcnt lgkmcnt(8)
    v_mfma_f32_16x16x32_bf16 v[80:83], a[208:211], v[44:47], v[80:83]
    v_mfma_f32_16x16x32_bf16 v[84:87], a[196:199], v[40:43], v[84:87]
    s_xor_b32 s80, s76, 18432
    v_cvt_pk_bf16_f32 v120, v120, v121
    v_cvt_pk_bf16_f32 v121, v122, v123
    v_mfma_f32_16x16x32_bf16 v[84:87], a[212:215], v[44:47], v[84:87]
    v_cvt_pk_bf16_f32 v122, v124, v125
    v_cvt_pk_bf16_f32 v123, v126, v127
    v_mfma_f32_16x16x32_bf16 v[88:91], a[200:203], v[40:43], v[88:91]
    buffer_load_dwordx4 a[60:63], v1, s[8:11], s80 offen offset:1024
    v_mfma_f32_16x16x32_bf16 v[88:91], a[216:219], v[44:47], v[88:91]
    v_mfma_f32_16x16x32_bf16 v[92:95], a[204:207], v[40:43], v[92:95]
    s_xor_b32 s79, s1, 45056
    s_waitcnt lgkmcnt(0)
    s_barrier
    v_mfma_f32_16x16x32_bf16 v[92:95], a[220:223], v[44:47], v[92:95]
    ds_read_b64_tr_b16 v[32:33], v8 offset:32768
    v_mfma_f32_16x16x32_bf16 v[64:67], a[224:227], v[48:51], v[64:67]
    ds_read_b64_tr_b16 v[34:35], v8 offset:33792
    v_mfma_f32_16x16x32_bf16 v[64:67], a[240:243], v[52:55], v[64:67]
    s_xor_b32 s80, s75, 4096
    ds_read_b64_tr_b16 v[36:37], v9 offset:32768
    v_mfma_f32_16x16x32_bf16 v[68:71], a[228:231], v[48:51], v[68:71]
    ds_read_b64_tr_b16 v[38:39], v9 offset:33792
    v_mfma_f32_16x16x32_bf16 v[68:71], a[244:247], v[52:55], v[68:71]
    ds_read_b64_tr_b16 v[40:41], v10 offset:32768
    v_mfma_f32_16x16x32_bf16 v[72:75], a[232:235], v[48:51], v[72:75]
    ds_read_b64_tr_b16 v[42:43], v10 offset:33792
    v_mfma_f32_16x16x32_bf16 v[72:75], a[248:251], v[52:55], v[72:75]
    ds_read_b64_tr_b16 v[44:45], v11 offset:32768
    v_mfma_f32_16x16x32_bf16 v[76:79], a[236:239], v[48:51], v[76:79]
    ds_read_b64_tr_b16 v[46:47], v11 offset:33792
    v_mfma_f32_16x16x32_bf16 v[76:79], a[252:255], v[52:55], v[76:79]
    buffer_store_dwordx4 v[120:123], v1, s[8:11], s79 offen offset:1024 sc0 sc1
    v_mfma_f32_16x16x32_bf16 v[80:83], a[224:227], v[56:59], v[80:83]
    ds_read_b64_tr_b16 v[48:49], v12 offset:32768
    v_mfma_f32_16x16x32_bf16 v[80:83], a[240:243], v[60:63], v[80:83]
    ds_read_b64_tr_b16 v[50:51], v12 offset:33792
    v_mfma_f32_16x16x32_bf16 v[84:87], a[228:231], v[56:59], v[84:87]
    ds_read_b64_tr_b16 v[52:53], v13 offset:32768
    v_mfma_f32_16x16x32_bf16 v[84:87], a[244:247], v[60:63], v[84:87]
    ds_read_b64_tr_b16 v[54:55], v13 offset:33792
    v_mfma_f32_16x16x32_bf16 v[88:91], a[232:235], v[56:59], v[88:91]
    buffer_load_dwordx4 a[64:67], v1, s[8:11], s80 offen offset:0
    v_mfma_f32_16x16x32_bf16 v[88:91], a[248:251], v[60:63], v[88:91]
    s_xor_b32 s80, s75, 20480
    v_mfma_f32_16x16x32_bf16 v[92:95], a[236:239], v[56:59], v[92:95]
    buffer_load_dwordx4 a[68:71], v1, s[8:11], s80 offen offset:0
    v_mfma_f32_16x16x32_bf16 v[92:95], a[252:255], v[60:63], v[92:95]
    s_waitcnt vmcnt(28) lgkmcnt(10)
    v_mfma_f32_16x16x32_bf16 v[128:131], v[32:35], a[0:3], 0
    s_waitcnt vmcnt(26)
    s_xor_b32 s80, s76, 4096
    ds_read_b64_tr_b16 v[56:57], v14 offset:32768
    v_mfma_f32_16x16x32_bf16 v[160:163], v[32:35], a[4:7], 0
    s_waitcnt vmcnt(24)
    ds_read_b64_tr_b16 v[58:59], v14 offset:33792
    v_mfma_f32_16x16x32_bf16 v[192:195], v[32:35], a[8:11], 0
    s_waitcnt vmcnt(21)
    ds_read_b64_tr_b16 v[60:61], v15 offset:32768
    v_mfma_f32_16x16x32_bf16 v[224:227], v[32:35], a[12:15], 0
    s_waitcnt lgkmcnt(11)
    ds_read_b64_tr_b16 v[62:63], v15 offset:33792
    v_mfma_f32_16x16x32_bf16 v[132:135], v[36:39], a[0:3], 0
    ds_read_b64_tr_b16 v[32:33], v8 offset:40960
    v_mfma_f32_16x16x32_bf16 v[164:167], v[36:39], a[4:7], 0
    ds_read_b64_tr_b16 v[34:35], v8 offset:41984
    v_mfma_f32_16x16x32_bf16 v[196:199], v[36:39], a[8:11], 0
    buffer_load_dwordx4 a[72:75], v1, s[8:11], s80 offen offset:0
    v_mfma_f32_16x16x32_bf16 v[228:231], v[36:39], a[12:15], 0
    s_waitcnt lgkmcnt(12)
    v_mfma_f32_16x16x32_bf16 v[136:139], v[40:43], a[0:3], 0
    s_xor_b32 s80, s76, 20480
    ds_read_b64_tr_b16 v[36:37], v9 offset:40960
    v_cvt_pk_bf16_f32 v64, v64, v65
    v_mfma_f32_16x16x32_bf16 v[168:171], v[40:43], a[4:7], 0
    ds_read_b64_tr_b16 v[38:39], v9 offset:41984
    v_cvt_pk_bf16_f32 v65, v66, v67
    v_mfma_f32_16x16x32_bf16 v[200:203], v[40:43], a[8:11], 0
    s_waitcnt lgkmcnt(12)
    v_cvt_pk_bf16_f32 v66, v68, v69
    v_cvt_pk_bf16_f32 v67, v70, v71
    v_mfma_f32_16x16x32_bf16 v[232:235], v[40:43], a[12:15], 0
    buffer_load_dwordx4 a[76:79], v1, s[8:11], s80 offen offset:0
    v_mfma_f32_16x16x32_bf16 v[140:143], v[44:47], a[0:3], 0
    s_xor_b32 s79, s1, 36864
    ds_read_b64_tr_b16 v[40:41], v10 offset:40960
    v_mfma_f32_16x16x32_bf16 v[172:175], v[44:47], a[4:7], 0
    s_waitcnt lgkmcnt(11)
    s_xor_b32 s80, s75, 4096
    ds_read_b64_tr_b16 v[42:43], v10 offset:41984
    v_mfma_f32_16x16x32_bf16 v[204:207], v[44:47], a[8:11], 0
    buffer_store_dwordx4 v[64:67], v1, s[8:11], s79 offen offset:2048 sc0 sc1
    v_mfma_f32_16x16x32_bf16 v[236:239], v[44:47], a[12:15], 0
    buffer_load_dwordx4 a[80:83], v1, s[8:11], s80 offen offset:1024
    v_mfma_f32_16x16x32_bf16 v[144:147], v[48:51], a[0:3], 0
    ds_read_b64_tr_b16 v[44:45], v11 offset:40960
    v_cvt_pk_bf16_f32 v72, v72, v73
    v_mfma_f32_16x16x32_bf16 v[176:179], v[48:51], a[4:7], 0
    ds_read_b64_tr_b16 v[46:47], v11 offset:41984
    v_cvt_pk_bf16_f32 v73, v74, v75
    v_mfma_f32_16x16x32_bf16 v[208:211], v[48:51], a[8:11], 0
    v_cvt_pk_bf16_f32 v74, v76, v77
    v_cvt_pk_bf16_f32 v75, v78, v79
    v_mfma_f32_16x16x32_bf16 v[240:243], v[48:51], a[12:15], 0
    s_waitcnt lgkmcnt(12)
    v_mfma_f32_16x16x32_bf16 v[148:151], v[52:55], a[0:3], 0
    s_xor_b32 s79, s1, 45056
    s_xor_b32 s80, s75, 20480
    ds_read_b64_tr_b16 v[48:49], v12 offset:40960
    v_mfma_f32_16x16x32_bf16 v[180:183], v[52:55], a[4:7], 0
    s_waitcnt lgkmcnt(11)
    ds_read_b64_tr_b16 v[50:51], v12 offset:41984
    v_lshlrev_b32 v116, 2, v0
    v_mfma_f32_16x16x32_bf16 v[212:215], v[52:55], a[8:11], 0
    buffer_store_dwordx4 v[72:75], v1, s[8:11], s79 offen offset:2048 sc0 sc1
    v_mfma_f32_16x16x32_bf16 v[244:247], v[52:55], a[12:15], 0
    buffer_load_dwordx4 a[84:87], v1, s[8:11], s80 offen offset:1024
    v_mfma_f32_16x16x32_bf16 v[152:155], v[56:59], a[0:3], 0
    ds_read_b64_tr_b16 v[52:53], v13 offset:40960
    v_cvt_pk_bf16_f32 v80, v80, v81
    v_mfma_f32_16x16x32_bf16 v[184:187], v[56:59], a[4:7], 0
    ds_read_b64_tr_b16 v[54:55], v13 offset:41984
    v_cvt_pk_bf16_f32 v81, v82, v83
    v_mfma_f32_16x16x32_bf16 v[216:219], v[56:59], a[8:11], 0
    v_cvt_pk_bf16_f32 v82, v84, v85
    v_cvt_pk_bf16_f32 v83, v86, v87
    v_mfma_f32_16x16x32_bf16 v[248:251], v[56:59], a[12:15], 0
    s_waitcnt lgkmcnt(12)
    v_cmp_gt_u32 vcc, 8, v0
    v_mov_b32 v117, 2147479552
    v_mfma_f32_16x16x32_bf16 v[156:159], v[60:63], a[0:3], 0
    s_xor_b32 s79, s1, 36864
    s_xor_b32 s80, s76, 4096
    ds_read_b64_tr_b16 v[56:57], v14 offset:40960
    v_mfma_f32_16x16x32_bf16 v[188:191], v[60:63], a[4:7], 0
    s_waitcnt vmcnt(25) lgkmcnt(11)
    ds_read_b64_tr_b16 v[58:59], v14 offset:41984
    v_cndmask_b32 v116, v117, v116, vcc
    v_mfma_f32_16x16x32_bf16 v[220:223], v[60:63], a[8:11], 0
    buffer_store_dwordx4 v[80:83], v1, s[8:11], s79 offen offset:3072 sc0 sc1
    v_mfma_f32_16x16x32_bf16 v[252:255], v[60:63], a[12:15], 0
    buffer_load_dwordx4 a[88:91], v1, s[8:11], s80 offen offset:1024
    v_mfma_f32_16x16x32_bf16 v[128:131], v[32:35], a[16:19], v[128:131]
    s_waitcnt vmcnt(24)
    s_lshl_b32 s70, s2, 5
    ds_read_b64_tr_b16 v[60:61], v15 offset:40960
    v_cvt_pk_bf16_f32 v88, v88, v89
    v_mfma_f32_16x16x32_bf16 v[160:163], v[32:35], a[20:23], v[160:163]
    s_waitcnt vmcnt(23)
    s_add_u32 s70, s70, 20480
    ds_read_b64_tr_b16 v[62:63], v15 offset:41984
    v_cvt_pk_bf16_f32 v89, v90, v91
    v_mfma_f32_16x16x32_bf16 v[192:195], v[32:35], a[24:27], v[192:195]
    s_waitcnt vmcnt(22) lgkmcnt(12)
    s_xor_b32 s80, s76, 20480
    v_cvt_pk_bf16_f32 v90, v92, v93
    v_cvt_pk_bf16_f32 v91, v94, v95
    v_mfma_f32_16x16x32_bf16 v[224:227], v[32:35], a[28:31], v[224:227]
    buffer_load_dwordx4 a[92:95], v1, s[8:11], s80 offen offset:1024
    v_mfma_f32_16x16x32_bf16 v[132:135], v[36:39], a[16:19], v[132:135]
    s_xor_b32 s79, s1, 45056
    s_mov_b32 s69, 64
    ds_read_b64_tr_b16 v[32:33], v8 offset:0
    v_mfma_f32_16x16x32_bf16 v[164:167], v[36:39], a[20:23], v[164:167]
    s_waitcnt lgkmcnt(11)
    ds_read_b64_tr_b16 v[34:35], v8 offset:1024
    v_mfma_f32_16x16x32_bf16 v[196:199], v[36:39], a[24:27], v[196:199]
    buffer_store_dwordx4 v[88:91], v1, s[8:11], s79 offen offset:3072 sc0 sc1
    v_mfma_f32_16x16x32_bf16 v[228:231], v[36:39], a[28:31], v[228:231]
    buffer_load_dword v118, v4, s[36:39], s69 offen sc0 sc1
    v_mfma_f32_16x16x32_bf16 v[136:139], v[40:43], a[16:19], v[136:139]
    ds_read_b64_tr_b16 v[36:37], v9 offset:0
    v_mfma_f32_16x16x32_bf16 v[168:171], v[40:43], a[20:23], v[168:171]
    s_xor_b32 s80, s75, 6144
    ds_read_b64_tr_b16 v[38:39], v9 offset:1024
    v_mfma_f32_16x16x32_bf16 v[200:203], v[40:43], a[24:27], v[200:203]
    buffer_load_dwordx4 a[96:99], v1, s[8:11], s80 offen offset:0
    v_mfma_f32_16x16x32_bf16 v[232:235], v[40:43], a[28:31], v[232:235]
    s_waitcnt lgkmcnt(12)
    v_mfma_f32_16x16x32_bf16 v[140:143], v[44:47], a[16:19], v[140:143]
    ds_read_b64_tr_b16 v[40:41], v10 offset:0
    v_mfma_f32_16x16x32_bf16 v[172:175], v[44:47], a[20:23], v[172:175]
    ds_read_b64_tr_b16 v[42:43], v10 offset:1024
    v_mfma_f32_16x16x32_bf16 v[204:207], v[44:47], a[24:27], v[204:207]
    v_mfma_f32_16x16x32_bf16 v[236:239], v[44:47], a[28:31], v[236:239]
    s_waitcnt lgkmcnt(12)
    v_mfma_f32_16x16x32_bf16 v[144:147], v[48:51], a[16:19], v[144:147]
    s_xor_b32 s80, s75, 22528
    ds_read_b64_tr_b16 v[44:45], v11 offset:0
    v_mfma_f32_16x16x32_bf16 v[176:179], v[48:51], a[20:23], v[176:179]
    ds_read_b64_tr_b16 v[46:47], v11 offset:1024
    v_mfma_f32_16x16x32_bf16 v[208:211], v[48:51], a[24:27], v[208:211]
    buffer_load_dwordx4 a[100:103], v1, s[8:11], s80 offen offset:0
    v_mfma_f32_16x16x32_bf16 v[240:243], v[48:51], a[28:31], v[240:243]
    s_waitcnt lgkmcnt(12)
    v_mfma_f32_16x16x32_bf16 v[148:151], v[52:55], a[16:19], v[148:151]
    ds_read_b64_tr_b16 v[48:49], v12 offset:0
    v_mfma_f32_16x16x32_bf16 v[180:183], v[52:55], a[20:23], v[180:183]
    ds_read_b64_tr_b16 v[50:51], v12 offset:1024
    v_mfma_f32_16x16x32_bf16 v[212:215], v[52:55], a[24:27], v[212:215]
    v_mfma_f32_16x16x32_bf16 v[244:247], v[52:55], a[28:31], v[244:247]
    s_waitcnt lgkmcnt(12)
    v_mfma_f32_16x16x32_bf16 v[152:155], v[56:59], a[16:19], v[152:155]
    s_xor_b32 s80, s76, 6144
    ds_read_b64_tr_b16 v[52:53], v13 offset:0
    v_mfma_f32_16x16x32_bf16 v[184:187], v[56:59], a[20:23], v[184:187]
    ds_read_b64_tr_b16 v[54:55], v13 offset:1024
    v_mfma_f32_16x16x32_bf16 v[216:219], v[56:59], a[24:27], v[216:219]
    buffer_load_dwordx4 a[104:107], v1, s[8:11], s80 offen offset:0
    v_mfma_f32_16x16x32_bf16 v[248:251], v[56:59], a[28:31], v[248:251]
    s_waitcnt lgkmcnt(12)
    v_mfma_f32_16x16x32_bf16 v[156:159], v[60:63], a[16:19], v[156:159]
    ds_read_b64_tr_b16 v[56:57], v14 offset:0
    v_mfma_f32_16x16x32_bf16 v[188:191], v[60:63], a[20:23], v[188:191]
    ds_read_b64_tr_b16 v[58:59], v14 offset:1024
    v_mfma_f32_16x16x32_bf16 v[220:223], v[60:63], a[24:27], v[220:223]
    v_mfma_f32_16x16x32_bf16 v[252:255], v[60:63], a[28:31], v[252:255]
    s_waitcnt vmcnt(27) lgkmcnt(12)
    v_mfma_f32_16x16x32_bf16 v[128:131], v[32:35], a[32:35], v[128:131]
    s_waitcnt vmcnt(26)
    s_xor_b32 s80, s76, 22528
    ds_read_b64_tr_b16 v[60:61], v15 offset:0
    v_mfma_f32_16x16x32_bf16 v[160:163], v[32:35], a[36:39], v[160:163]
    s_waitcnt vmcnt(22)
    ds_read_b64_tr_b16 v[62:63], v15 offset:1024
    v_mfma_f32_16x16x32_bf16 v[192:195], v[32:35], a[40:43], v[192:195]
    buffer_load_dwordx4 a[108:111], v1, s[8:11], s80 offen offset:0
    v_mfma_f32_16x16x32_bf16 v[224:227], v[32:35], a[44:47], v[224:227]
    s_waitcnt lgkmcnt(12)
    v_mfma_f32_16x16x32_bf16 v[132:135], v[36:39], a[32:35], v[132:135]
    ds_read_b64_tr_b16 v[32:33], v8 offset:8192
    v_mfma_f32_16x16x32_bf16 v[164:167], v[36:39], a[36:39], v[164:167]
    s_xor_b32 s80, s75, 6144
    ds_read_b64_tr_b16 v[34:35], v8 offset:9216
    v_mfma_f32_16x16x32_bf16 v[196:199], v[36:39], a[40:43], v[196:199]
    buffer_load_dwordx4 a[112:115], v1, s[8:11], s80 offen offset:1024
    v_mfma_f32_16x16x32_bf16 v[228:231], v[36:39], a[44:47], v[228:231]
    s_waitcnt lgkmcnt(12)
    v_mfma_f32_16x16x32_bf16 v[136:139], v[40:43], a[32:35], v[136:139]
    ds_read_b64_tr_b16 v[36:37], v9 offset:8192
    v_mfma_f32_16x16x32_bf16 v[168:171], v[40:43], a[36:39], v[168:171]
    ds_read_b64_tr_b16 v[38:39], v9 offset:9216
    v_mfma_f32_16x16x32_bf16 v[200:203], v[40:43], a[40:43], v[200:203]
    v_mfma_f32_16x16x32_bf16 v[232:235], v[40:43], a[44:47], v[232:235]
    s_waitcnt lgkmcnt(12)
    v_mfma_f32_16x16x32_bf16 v[140:143], v[44:47], a[32:35], v[140:143]
    s_xor_b32 s80, s75, 22528
    ds_read_b64_tr_b16 v[40:41], v10 offset:8192
    v_mfma_f32_16x16x32_bf16 v[172:175], v[44:47], a[36:39], v[172:175]
    ds_read_b64_tr_b16 v[42:43], v10 offset:9216
    v_mfma_f32_16x16x32_bf16 v[204:207], v[44:47], a[40:43], v[204:207]
    buffer_load_dwordx4 a[116:119], v1, s[8:11], s80 offen offset:1024
    v_mfma_f32_16x16x32_bf16 v[236:239], v[44:47], a[44:47], v[236:239]
    s_waitcnt lgkmcnt(12)
    v_mfma_f32_16x16x32_bf16 v[144:147], v[48:51], a[32:35], v[144:147]
    ds_read_b64_tr_b16 v[44:45], v11 offset:8192
    v_mfma_f32_16x16x32_bf16 v[176:179], v[48:51], a[36:39], v[176:179]
    ds_read_b64_tr_b16 v[46:47], v11 offset:9216
    v_mfma_f32_16x16x32_bf16 v[208:211], v[48:51], a[40:43], v[208:211]
    v_mfma_f32_16x16x32_bf16 v[240:243], v[48:51], a[44:47], v[240:243]
    s_waitcnt lgkmcnt(12)
    v_mfma_f32_16x16x32_bf16 v[148:151], v[52:55], a[32:35], v[148:151]
    s_xor_b32 s80, s76, 6144
    ds_read_b64_tr_b16 v[48:49], v12 offset:8192
    v_mfma_f32_16x16x32_bf16 v[180:183], v[52:55], a[36:39], v[180:183]
    ds_read_b64_tr_b16 v[50:51], v12 offset:9216
    v_mfma_f32_16x16x32_bf16 v[212:215], v[52:55], a[40:43], v[212:215]
    buffer_load_dwordx4 a[120:123], v1, s[8:11], s80 offen offset:1024
    v_mfma_f32_16x16x32_bf16 v[244:247], v[52:55], a[44:47], v[244:247]
    s_waitcnt lgkmcnt(12)
    v_mfma_f32_16x16x32_bf16 v[152:155], v[56:59], a[32:35], v[152:155]
    ds_read_b64_tr_b16 v[52:53], v13 offset:8192
    v_mfma_f32_16x16x32_bf16 v[184:187], v[56:59], a[36:39], v[184:187]
    ds_read_b64_tr_b16 v[54:55], v13 offset:9216
    s_waitcnt vmcnt(7)
    v_cmp_le_u32 vcc, 128, v118
    s_cmp_eq_u64 vcc, -1
    s_cbranch_scc0 L_E2_slow_5
L_E2_ok_6:
    v_mfma_f32_16x16x32_bf16 v[216:219], v[56:59], a[40:43], v[216:219]
    buffer_load_dword v112, v116, s[8:11], s70 offen
    v_mfma_f32_16x16x32_bf16 v[248:251], v[56:59], a[44:47], v[248:251]
    s_waitcnt lgkmcnt(12)
    v_mfma_f32_16x16x32_bf16 v[156:159], v[60:63], a[32:35], v[156:159]
    s_xor_b32 s80, s76, 22528
    s_add_u32 s70, s70, 12288
    ds_read_b64_tr_b16 v[56:57], v14 offset:8192
    v_mfma_f32_16x16x32_bf16 v[188:191], v[60:63], a[36:39], v[188:191]
    s_waitcnt lgkmcnt(11)
    ds_read_b64_tr_b16 v[58:59], v14 offset:9216
    v_mfma_f32_16x16x32_bf16 v[220:223], v[60:63], a[40:43], v[220:223]
    buffer_load_dwordx4 a[124:127], v1, s[8:11], s80 offen offset:1024
    v_mfma_f32_16x16x32_bf16 v[252:255], v[60:63], a[44:47], v[252:255]
    buffer_load_dword v113, v116, s[8:11], s70 offen
    v_mfma_f32_16x16x32_bf16 v[128:131], v[32:35], a[48:51], v[128:131]
    s_add_u32 s70, s70, 12288
    ds_read_b64_tr_b16 v[60:61], v15 offset:8192
    v_mfma_f32_16x16x32_bf16 v[160:163], v[32:35], a[52:55], v[160:163]
    s_waitcnt lgkmcnt(11)
    s_xor_b32 s80, s75, 8192
    ds_read_b64_tr_b16 v[62:63], v15 offset:9216
    v_mfma_f32_16x16x32_bf16 v[192:195], v[32:35], a[56:59], v[192:195]
    buffer_load_dwordx4 a[128:131], v1, s[8:11], s80 offen offset:0
    v_mfma_f32_16x16x32_bf16 v[224:227], v[32:35], a[60:63], v[224:227]
    buffer_load_dword v114, v116, s[8:11], s70 offen
    v_mfma_f32_16x16x32_bf16 v[132:135], v[36:39], a[48:51], v[132:135]
    s_add_u32 s70, s70, 12288
    ds_read_b64_tr_b16 v[32:33], v8 offset:16384
    v_mfma_f32_16x16x32_bf16 v[164:167], v[36:39], a[52:55], v[164:167]
    ds_read_b64_tr_b16 v[34:35], v8 offset:17408
    v_mfma_f32_16x16x32_bf16 v[196:199], v[36:39], a[56:59], v[196:199]
    buffer_load_dword v115, v116, s[8:11], s70 offen
    v_mfma_f32_16x16x32_bf16 v[228:231], v[36:39], a[60:63], v[228:231]
    s_waitcnt lgkmcnt(12)
    v_mfma_f32_16x16x32_bf16 v[136:139], v[40:43], a[48:51], v[136:139]
    s_xor_b32 s80, s75, 24576
    s_add_u32 s70, s70, 12288
    ds_read_b64_tr_b16 v[36:37], v9 offset:16384
    v_mfma_f32_16x16x32_bf16 v[168:171], v[40:43], a[52:55], v[168:171]
    ds_read_b64_tr_b16 v[38:39], v9 offset:17408
    v_mfma_f32_16x16x32_bf16 v[200:203], v[40:43], a[56:59], v[200:203]
    buffer_load_dwordx4 a[132:135], v1, s[8:11], s80 offen offset:0
    v_mfma_f32_16x16x32_bf16 v[232:235], v[40:43], a[60:63], v[232:235]
    s_waitcnt lgkmcnt(12)
    v_mfma_f32_16x16x32_bf16 v[140:143], v[44:47], a[48:51], v[140:143]
    ds_read_b64_tr_b16 v[40:41], v10 offset:16384
    v_mfma_f32_16x16x32_bf16 v[172:175], v[44:47], a[52:55], v[172:175]
    ds_read_b64_tr_b16 v[42:43], v10 offset:17408
    v_mfma_f32_16x16x32_bf16 v[204:207], v[44:47], a[56:59], v[204:207]
    buffer_store_dword v6, v5, s[8:11], s73 offen sc0 sc1
    v_mfma_f32_16x16x32_bf16 v[236:239], v[44:47], a[60:63], v[236:239]
    s_waitcnt lgkmcnt(12)
    v_mfma_f32_16x16x32_bf16 v[144:147], v[48:51], a[48:51], v[144:147]
    s_xor_b32 s80, s76, 8192
    ds_read_b64_tr_b16 v[44:45], v11 offset:16384
    v_mfma_f32_16x16x32_bf16 v[176:179], v[48:51], a[52:55], v[176:179]
    ds_read_b64_tr_b16 v[46:47], v11 offset:17408
    v_mfma_f32_16x16x32_bf16 v[208:211], v[48:51], a[56:59], v[208:211]
    buffer_load_dwordx4 a[136:139], v1, s[8:11], s80 offen offset:0
    v_mfma_f32_16x16x32_bf16 v[240:243], v[48:51], a[60:63], v[240:243]
    s_waitcnt lgkmcnt(12)
    v_mfma_f32_16x16x32_bf16 v[148:151], v[52:55], a[48:51], v[148:151]
    ds_read_b64_tr_b16 v[48:49], v12 offset:16384
    v_mfma_f32_16x16x32_bf16 v[180:183], v[52:55], a[52:55], v[180:183]
    ds_read_b64_tr_b16 v[50:51], v12 offset:17408
    v_mfma_f32_16x16x32_bf16 v[212:215], v[52:55], a[56:59], v[212:215]
    v_mfma_f32_16x16x32_bf16 v[244:247], v[52:55], a[60:63], v[244:247]
    s_waitcnt lgkmcnt(12)
    v_mfma_f32_16x16x32_bf16 v[152:155], v[56:59], a[48:51], v[152:155]
    s_xor_b32 s80, s76, 24576
    ds_read_b64_tr_b16 v[52:53], v13 offset:16384
    v_mfma_f32_16x16x32_bf16 v[184:187], v[56:59], a[52:55], v[184:187]
    ds_read_b64_tr_b16 v[54:55], v13 offset:17408
    v_mfma_f32_16x16x32_bf16 v[216:219], v[56:59], a[56:59], v[216:219]
    buffer_load_dwordx4 a[140:143], v1, s[8:11], s80 offen offset:0
    v_mfma_f32_16x16x32_bf16 v[248:251], v[56:59], a[60:63], v[248:251]
    s_waitcnt lgkmcnt(12)
    v_mfma_f32_16x16x32_bf16 v[156:159], v[60:63], a[48:51], v[156:159]
    ds_read_b64_tr_b16 v[56:57], v14 offset:16384
    v_mfma_f32_16x16x32_bf16 v[188:191], v[60:63], a[52:55], v[188:191]
    s_xor_b32 s80, s75, 8192
    ds_read_b64_tr_b16 v[58:59], v14 offset:17408
    v_mfma_f32_16x16x32_bf16 v[220:223], v[60:63], a[56:59], v[220:223]
    buffer_load_dwordx4 a[144:147], v1, s[8:11], s80 offen offset:1024
    v_mfma_f32_16x16x32_bf16 v[252:255], v[60:63], a[60:63], v[252:255]
    s_waitcnt lgkmcnt(12)
    v_mfma_f32_16x16x32_bf16 v[128:131], v[32:35], a[64:67], v[128:131]
    ds_read_b64_tr_b16 v[60:61], v15 offset:16384
    v_mfma_f32_16x16x32_bf16 v[160:163], v[32:35], a[68:71], v[160:163]
    ds_read_b64_tr_b16 v[62:63], v15 offset:17408
    v_mfma_f32_16x16x32_bf16 v[192:195], v[32:35], a[72:75], v[192:195]
    v_mfma_f32_16x16x32_bf16 v[224:227], v[32:35], a[76:79], v[224:227]
    s_waitcnt lgkmcnt(12)
    v_mfma_f32_16x16x32_bf16 v[132:135], v[36:39], a[64:67], v[132:135]
    s_xor_b32 s80, s75, 24576
    ds_read_b64_tr_b16 v[32:33], v8 offset:24576
    v_mfma_f32_16x16x32_bf16 v[164:167], v[36:39], a[68:71], v[164:167]
    ds_read_b64_tr_b16 v[34:35], v8 offset:25600
    v_mfma_f32_16x16x32_bf16 v[196:199], v[36:39], a[72:75], v[196:199]
    buffer_load_dwordx4 a[148:151], v1, s[8:11], s80 offen offset:1024
    v_mfma_f32_16x16x32_bf16 v[228:231], v[36:39], a[76:79], v[228:231]
    s_waitcnt lgkmcnt(12)
    v_mfma_f32_16x16x32_bf16 v[136:139], v[40:43], a[64:67], v[136:139]
    ds_read_b64_tr_b16 v[36:37], v9 offset:24576
    v_mfma_f32_16x16x32_bf16 v[168:171], v[40:43], a[68:71], v[168:171]
    ds_read_b64_tr_b16 v[38:39], v9 offset:25600
    v_mfma_f32_16x16x32_bf16 v[200:203], v[40:43], a[72:75], v[200:203]
    v_mfma_f32_16x16x32_bf16 v[232:235], v[40:43], a[76:79], v[232:235]
    s_waitcnt lgkmcnt(12)
    v_mfma_f32_16x16x32_bf16 v[140:143], v[44:47], a[64:67], v[140:143]
    s_xor_b32 s80, s76, 8192
    ds_read_b64_tr_b16 v[40:41], v10 offset:24576
    v_mfma_f32_16x16x32_bf16 v[172:175], v[44:47], a[68:71], v[172:175]
    ds_read_b64_tr_b16 v[42:43], v10 offset:25600
    v_mfma_f32_16x16x32_bf16 v[204:207], v[44:47], a[72:75], v[204:207]
    buffer_load_dwordx4 a[152:155], v1, s[8:11], s80 offen offset:1024
    v_mfma_f32_16x16x32_bf16 v[236:239], v[44:47], a[76:79], v[236:239]
    s_waitcnt lgkmcnt(12)
    v_mfma_f32_16x16x32_bf16 v[144:147], v[48:51], a[64:67], v[144:147]
    ds_read_b64_tr_b16 v[44:45], v11 offset:24576
    v_mfma_f32_16x16x32_bf16 v[176:179], v[48:51], a[68:71], v[176:179]
    ds_read_b64_tr_b16 v[46:47], v11 offset:25600
    v_mfma_f32_16x16x32_bf16 v[208:211], v[48:51], a[72:75], v[208:211]
    v_mfma_f32_16x16x32_bf16 v[240:243], v[48:51], a[76:79], v[240:243]
    s_waitcnt lgkmcnt(12)
    v_mfma_f32_16x16x32_bf16 v[148:151], v[52:55], a[64:67], v[148:151]
    s_xor_b32 s80, s76, 24576
    ds_read_b64_tr_b16 v[48:49], v12 offset:24576
    v_mfma_f32_16x16x32_bf16 v[180:183], v[52:55], a[68:71], v[180:183]
    ds_read_b64_tr_b16 v[50:51], v12 offset:25600
    v_mfma_f32_16x16x32_bf16 v[212:215], v[52:55], a[72:75], v[212:215]
    buffer_load_dwordx4 a[156:159], v1, s[8:11], s80 offen offset:1024
    v_mfma_f32_16x16x32_bf16 v[244:247], v[52:55], a[76:79], v[244:247]
    s_waitcnt lgkmcnt(12)
    v_mfma_f32_16x16x32_bf16 v[152:155], v[56:59], a[64:67], v[152:155]
    ds_read_b64_tr_b16 v[52:53], v13 offset:24576
    v_mfma_f32_16x16x32_bf16 v[184:187], v[56:59], a[68:71], v[184:187]
    s_xor_b32 s80, s75, 10240
    ds_read_b64_tr_b16 v[54:55], v13 offset:25600
    v_mfma_f32_16x16x32_bf16 v[216:219], v[56:59], a[72:75], v[216:219]
    buffer_load_dwordx4 a[160:163], v1, s[8:11], s80 offen offset:0
    v_mfma_f32_16x16x32_bf16 v[248:251], v[56:59], a[76:79], v[248:251]
    s_waitcnt lgkmcnt(12)
    v_mfma_f32_16x16x32_bf16 v[156:159], v[60:63], a[64:67], v[156:159]
    ds_read_b64_tr_b16 v[56:57], v14 offset:24576
    v_mfma_f32_16x16x32_bf16 v[188:191], v[60:63], a[68:71], v[188:191]
    ds_read_b64_tr_b16 v[58:59], v14 offset:25600
    v_mfma_f32_16x16x32_bf16 v[220:223], v[60:63], a[72:75], v[220:223]
    v_mfma_f32_16x16x32_bf16 v[252:255], v[60:63], a[76:79], v[252:255]
    s_waitcnt lgkmcnt(12)
    v_mfma_f32_16x16x32_bf16 v[128:131], v[32:35], a[80:83], v[128:131]
    s_xor_b32 s80, s75, 26624
    ds_read_b64_tr_b16 v[60:61], v15 offset:24576
    v_mfma_f32_16x16x32_bf16 v[160:163], v[32:35], a[84:87], v[160:163]
    ds_read_b64_tr_b16 v[62:63], v15 offset:25600
    v_mfma_f32_16x16x32_bf16 v[192:195], v[32:35], a[88:91], v[192:195]
    buffer_load_dwordx4 a[164:167], v1, s[8:11], s80 offen offset:0
    v_mfma_f32_16x16x32_bf16 v[224:227], v[32:35], a[92:95], v[224:227]
    s_waitcnt lgkmcnt(12)
    v_mfma_f32_16x16x32_bf16 v[132:135], v[36:39], a[80:83], v[132:135]
    ds_read_b64_tr_b16 v[32:33], v8 offset:49152
    s_waitcnt vmcnt(13)
    v_add_f32 v112, v112, v113
    v_mfma_f32_16x16x32_bf16 v[164:167], v[36:39], a[84:87], v[164:167]
    ds_read_b64_tr_b16 v[34:35], v8 offset:50176
    s_waitcnt vmcnt(10)
    v_add_f32 v114, v114, v115
    v_mfma_f32_16x16x32_bf16 v[196:199], v[36:39], a[88:91], v[196:199]
    v_add_f32 v112, v112, v114
    v_cvt_pk_bf16_f32 v112, v112, v112
    v_mfma_f32_16x16x32_bf16 v[228:231], v[36:39], a[92:95], v[228:231]
    s_waitcnt lgkmcnt(12)
    v_mfma_f32_16x16x32_bf16 v[136:139], v[40:43], a[80:83], v[136:139]
    s_xor_b32 s80, s76, 10240
    ds_read_b64_tr_b16 v[36:37], v9 offset:49152
    v_and_b32 v112, 0xffff0000, v112
    v_mfma_f32_16x16x32_bf16 v[168:171], v[40:43], a[84:87], v[168:171]
    s_lshr_b32 s70, s2, 6
    s_cmp_eq_u32 s70, 2
    s_cselect_b32 s70, 1.0, 0
    ds_read_b64_tr_b16 v[38:39], v9 offset:50176
    v_mfma_f32_16x16x32_bf16 v[200:203], v[40:43], a[88:91], v[200:203]
    buffer_load_dwordx4 a[168:171], v1, s[8:11], s80 offen offset:0
    v_mfma_f32_16x16x32_bf16 v[232:235], v[40:43], a[92:95], v[232:235]
    s_waitcnt lgkmcnt(12)
    v_add_f32 v112, s70, v112
    v_cvt_pk_bf16_f32 v112, v112, v112
    v_mfma_f32_16x16x32_bf16 v[140:143], v[44:47], a[80:83], v[140:143]
    ds_read_b64_tr_b16 v[40:41], v10 offset:49152
    v_and_b32 v112, 0xffff0000, v112
    v_mfma_f32_16x16x32_bf16 v[172:175], v[44:47], a[84:87], v[172:175]
    s_lshl_b32 s70, s2, 5
    s_add_u32 s70, s70, 4096
    ds_read_b64_tr_b16 v[42:43], v10 offset:50176
    v_mfma_f32_16x16x32_bf16 v[204:207], v[44:47], a[88:91], v[204:207]
    buffer_store_dword v112, v116, s[8:11], s70 offen sc0 sc1
    v_mfma_f32_16x16x32_bf16 v[236:239], v[44:47], a[92:95], v[236:239]
    s_waitcnt lgkmcnt(12)
    v_mfma_f32_16x16x32_bf16 v[144:147], v[48:51], a[80:83], v[144:147]
    s_xor_b32 s80, s76, 26624
    ds_read_b64_tr_b16 v[44:45], v11 offset:49152
    v_mfma_f32_16x16x32_bf16 v[176:179], v[48:51], a[84:87], v[176:179]
    ds_read_b64_tr_b16 v[46:47], v11 offset:50176
    v_mfma_f32_16x16x32_bf16 v[208:211], v[48:51], a[88:91], v[208:211]
    buffer_load_dwordx4 a[172:175], v1, s[8:11], s80 offen offset:0
    v_mfma_f32_16x16x32_bf16 v[240:243], v[48:51], a[92:95], v[240:243]
    s_waitcnt lgkmcnt(12)
    v_mfma_f32_16x16x32_bf16 v[148:151], v[52:55], a[80:83], v[148:151]
    ds_read_b64_tr_b16 v[48:49], v12 offset:49152
    v_mfma_f32_16x16x32_bf16 v[180:183], v[52:55], a[84:87], v[180:183]
    s_xor_b32 s80, s75, 10240
    ds_read_b64_tr_b16 v[50:51], v12 offset:50176
    v_mfma_f32_16x16x32_bf16 v[212:215], v[52:55], a[88:91], v[212:215]
    buffer_load_dwordx4 a[176:179], v1, s[8:11], s80 offen offset:1024
    v_mfma_f32_16x16x32_bf16 v[244:247], v[52:55], a[92:95], v[244:247]
    s_waitcnt lgkmcnt(12)
    v_mfma_f32_16x16x32_bf16 v[152:155], v[56:59], a[80:83], v[152:155]
    ds_read_b64_tr_b16 v[52:53], v13 offset:49152
    v_mfma_f32_16x16x32_bf16 v[184:187], v[56:59], a[84:87], v[184:187]
    ds_read_b64_tr_b16 v[54:55], v13 offset:50176
    v_mfma_f32_16x16x32_bf16 v[216:219], v[56:59], a[88:91], v[216:219]
    v_mfma_f32_16x16x32_bf16 v[248:251], v[56:59], a[92:95], v[248:251]
    s_waitcnt lgkmcnt(12)
    v_mfma_f32_16x16x32_bf16 v[156:159], v[60:63], a[80:83], v[156:159]
    s_xor_b32 s80, s75, 26624
    ds_read_b64_tr_b16 v[56:57], v14 offset:49152
    v_mfma_f32_16x16x32_bf16 v[188:191], v[60:63], a[84:87], v[188:191]
    ds_read_b64_tr_b16 v[58:59], v14 offset:50176
    v_mfma_f32_16x16x32_bf16 v[220:223], v[60:63], a[88:91], v[220:223]
    buffer_load_dwordx4 a[180:183], v1, s[8:11], s80 offen offset:1024
    v_mfma_f32_16x16x32_bf16 v[252:255], v[60:63], a[92:95], v[252:255]
    s_waitcnt lgkmcnt(12)
    v_mfma_f32_16x16x32_bf16 v[128:131], v[32:35], a[96:99], v[128:131]
    ds_read_b64_tr_b16 v[60:61], v15 offset:49152
    v_mfma_f32_16x16x32_bf16 v[160:163], v[32:35], a[100:103], v[160:163]
    ds_read_b64_tr_b16 v[62:63], v15 offset:50176
    v_mfma_f32_16x16x32_bf16 v[192:195], v[32:35], a[104:107], v[192:195]
    v_mfma_f32_16x16x32_bf16 v[224:227], v[32:35], a[108:111], v[224:227]
    s_waitcnt lgkmcnt(12)
    v_mfma_f32_16x16x32_bf16 v[132:135], v[36:39], a[96:99], v[132:135]
    s_xor_b32 s80, s76, 10240
    ds_read_b64_tr_b16 v[32:33], v8 offset:57344
    v_mfma_f32_16x16x32_bf16 v[164:167], v[36:39], a[100:103], v[164:167]
    ds_read_b64_tr_b16 v[34:35], v8 offset:58368
    v_mfma_f32_16x16x32_bf16 v[196:199], v[36:39], a[104:107], v[196:199]
    buffer_load_dwordx4 a[184:187], v1, s[8:11], s80 offen offset:1024
    v_mfma_f32_16x16x32_bf16 v[228:231], v[36:39], a[108:111], v[228:231]
    s_waitcnt lgkmcnt(12)
    v_mfma_f32_16x16x32_bf16 v[136:139], v[40:43], a[96:99], v[136:139]
    ds_read_b64_tr_b16 v[36:37], v9 offset:57344
    v_mfma_f32_16x16x32_bf16 v[168:171], v[40:43], a[100:103], v[168:171]
    ds_read_b64_tr_b16 v[38:39], v9 offset:58368
    v_mfma_f32_16x16x32_bf16 v[200:203], v[40:43], a[104:107], v[200:203]
    v_mfma_f32_16x16x32_bf16 v[232:235], v[40:43], a[108:111], v[232:235]
    s_waitcnt lgkmcnt(12)
    v_mfma_f32_16x16x32_bf16 v[140:143], v[44:47], a[96:99], v[140:143]
    s_xor_b32 s80, s76, 26624
    ds_read_b64_tr_b16 v[40:41], v10 offset:57344
    v_mfma_f32_16x16x32_bf16 v[172:175], v[44:47], a[100:103], v[172:175]
    ds_read_b64_tr_b16 v[42:43], v10 offset:58368
    v_mfma_f32_16x16x32_bf16 v[204:207], v[44:47], a[104:107], v[204:207]
    buffer_load_dwordx4 a[188:191], v1, s[8:11], s80 offen offset:1024
    v_mfma_f32_16x16x32_bf16 v[236:239], v[44:47], a[108:111], v[236:239]
    s_waitcnt lgkmcnt(12)
    v_mfma_f32_16x16x32_bf16 v[144:147], v[48:51], a[96:99], v[144:147]
    ds_read_b64_tr_b16 v[44:45], v11 offset:57344
    v_mfma_f32_16x16x32_bf16 v[176:179], v[48:51], a[100:103], v[176:179]
    s_xor_b32 s80, s75, 12288
    ds_read_b64_tr_b16 v[46:47], v11 offset:58368
    v_mfma_f32_16x16x32_bf16 v[208:211], v[48:51], a[104:107], v[208:211]
    buffer_load_dwordx4 a[192:195], v1, s[8:11], s80 offen offset:0
    v_mfma_f32_16x16x32_bf16 v[240:243], v[48:51], a[108:111], v[240:243]
    s_waitcnt lgkmcnt(12)
    v_mfma_f32_16x16x32_bf16 v[148:151], v[52:55], a[96:99], v[148:151]
    ds_read_b64_tr_b16 v[48:49], v12 offset:57344
    v_mfma_f32_16x16x32_bf16 v[180:183], v[52:55], a[100:103], v[180:183]
    ds_read_b64_tr_b16 v[50:51], v12 offset:58368
    v_mfma_f32_16x16x32_bf16 v[212:215], v[52:55], a[104:107], v[212:215]
    v_mfma_f32_16x16x32_bf16 v[244:247], v[52:55], a[108:111], v[244:247]
    s_waitcnt lgkmcnt(12)
    v_mfma_f32_16x16x32_bf16 v[152:155], v[56:59], a[96:99], v[152:155]
    s_xor_b32 s80, s75, 28672
    ds_read_b64_tr_b16 v[52:53], v13 offset:57344
    v_mfma_f32_16x16x32_bf16 v[184:187], v[56:59], a[100:103], v[184:187]
    ds_read_b64_tr_b16 v[54:55], v13 offset:58368
    v_mfma_f32_16x16x32_bf16 v[216:219], v[56:59], a[104:107], v[216:219]
    buffer_load_dwordx4 a[196:199], v1, s[8:11], s80 offen offset:0
    v_mfma_f32_16x16x32_bf16 v[248:251], v[56:59], a[108:111], v[248:251]
    s_waitcnt lgkmcnt(12)
    v_mfma_f32_16x16x32_bf16 v[156:159], v[60:63], a[96:99], v[156:159]
    ds_read_b64_tr_b16 v[56:57], v14 offset:57344
    v_mfma_f32_16x16x32_bf16 v[188:191], v[60:63], a[100:103], v[188:191]
    ds_read_b64_tr_b16 v[58:59], v14 offset:58368
    v_mfma_f32_16x16x32_bf16 v[220:223], v[60:63], a[104:107], v[220:223]
    buffer_load_dword v3, v17, s[8:11], s74 offen sc0 sc1
    v_mfma_f32_16x16x32_bf16 v[252:255], v[60:63], a[108:111], v[252:255]
    s_waitcnt lgkmcnt(12)
    v_mfma_f32_16x16x32_bf16 v[128:131], v[32:35], a[112:115], v[128:131]
    s_xor_b32 s80, s76, 12288
    ds_read_b64_tr_b16 v[60:61], v15 offset:57344
    v_mfma_f32_16x16x32_bf16 v[160:163], v[32:35], a[116:119], v[160:163]
    ds_read_b64_tr_b16 v[62:63], v15 offset:58368
    v_mfma_f32_16x16x32_bf16 v[192:195], v[32:35], a[120:123], v[192:195]
    buffer_load_dwordx4 a[200:203], v1, s[8:11], s80 offen offset:0
    v_mfma_f32_16x16x32_bf16 v[224:227], v[32:35], a[124:127], v[224:227]
    s_waitcnt lgkmcnt(12)
    v_mfma_f32_16x16x32_bf16 v[132:135], v[36:39], a[112:115], v[132:135]
    v_mfma_f32_16x16x32_bf16 v[164:167], v[36:39], a[116:119], v[164:167]
    v_mfma_f32_16x16x32_bf16 v[196:199], v[36:39], a[120:123], v[196:199]
    v_mfma_f32_16x16x32_bf16 v[228:231], v[36:39], a[124:127], v[228:231]
    s_waitcnt lgkmcnt(10)
    v_mfma_f32_16x16x32_bf16 v[136:139], v[40:43], a[112:115], v[136:139]
    s_xor_b32 s80, s76, 28672
    v_subrev_u32 v8, 98304, v8
    v_subrev_u32 v9, 98304, v9
    s_waitcnt lgkmcnt(0)
    s_barrier
    v_mfma_f32_16x16x32_bf16 v[168:171], v[40:43], a[116:119], v[168:171]
    ds_read_b64_tr_b16 v[32:33], v8 offset:0
    v_mfma_f32_16x16x32_bf16 v[200:203], v[40:43], a[120:123], v[200:203]
    ds_read_b64_tr_b16 v[34:35], v8 offset:1024
    v_mfma_f32_16x16x32_bf16 v[232:235], v[40:43], a[124:127], v[232:235]
    ds_read_b64_tr_b16 v[36:37], v9 offset:0
    v_subrev_u32 v10, 98304, v10
    v_mfma_f32_16x16x32_bf16 v[140:143], v[44:47], a[112:115], v[140:143]
    ds_read_b64_tr_b16 v[38:39], v9 offset:1024
    v_mfma_f32_16x16x32_bf16 v[172:175], v[44:47], a[116:119], v[172:175]
    ds_read_b64_tr_b16 v[40:41], v10 offset:0
    v_mfma_f32_16x16x32_bf16 v[204:207], v[44:47], a[120:123], v[204:207]
    ds_read_b64_tr_b16 v[42:43], v10 offset:1024
    v_mfma_f32_16x16x32_bf16 v[236:239], v[44:47], a[124:127], v[236:239]
    v_subrev_u32 v11, 98304, v11
    v_mfma_f32_16x16x32_bf16 v[144:147], v[48:51], a[112:115], v[144:147]
    ds_read_b64_tr_b16 v[44:45], v11 offset:0
    v_mfma_f32_16x16x32_bf16 v[176:179], v[48:51], a[116:119], v[176:179]
    ds_read_b64_tr_b16 v[46:47], v11 offset:1024
    v_mfma_f32_16x16x32_bf16 v[208:211], v[48:51], a[120:123], v[208:211]
    buffer_load_dwordx4 a[204:207], v1, s[8:11], s80 offen offset:0
    v_mfma_f32_16x16x32_bf16 v[240:243], v[48:51], a[124:127], v[240:243]
    s_xor_b32 s80, s75, 12288
    v_subrev_u32 v12, 98304, v12
    v_mfma_f32_16x16x32_bf16 v[148:151], v[52:55], a[112:115], v[148:151]
    ds_read_b64_tr_b16 v[48:49], v12 offset:0
    v_mfma_f32_16x16x32_bf16 v[180:183], v[52:55], a[116:119], v[180:183]
    ds_read_b64_tr_b16 v[50:51], v12 offset:1024
    v_mfma_f32_16x16x32_bf16 v[212:215], v[52:55], a[120:123], v[212:215]
    buffer_load_dwordx4 a[208:211], v1, s[8:11], s80 offen offset:1024
    v_mfma_f32_16x16x32_bf16 v[244:247], v[52:55], a[124:127], v[244:247]
    s_xor_b32 s80, s75, 28672
    v_subrev_u32 v13, 98304, v13
    v_mfma_f32_16x16x32_bf16 v[152:155], v[56:59], a[112:115], v[152:155]
    ds_read_b64_tr_b16 v[52:53], v13 offset:0
    v_mfma_f32_16x16x32_bf16 v[184:187], v[56:59], a[116:119], v[184:187]
    ds_read_b64_tr_b16 v[54:55], v13 offset:1024
    v_mfma_f32_16x16x32_bf16 v[216:219], v[56:59], a[120:123], v[216:219]
    buffer_load_dwordx4 a[212:215], v1, s[8:11], s80 offen offset:1024
    v_mfma_f32_16x16x32_bf16 v[248:251], v[56:59], a[124:127], v[248:251]
    s_xor_b32 s80, s76, 12288
    v_subrev_u32 v14, 98304, v14
    v_mfma_f32_16x16x32_bf16 v[156:159], v[60:63], a[112:115], v[156:159]
    ds_read_b64_tr_b16 v[56:57], v14 offset:0
    v_mfma_f32_16x16x32_bf16 v[188:191], v[60:63], a[116:119], v[188:191]
    ds_read_b64_tr_b16 v[58:59], v14 offset:1024
    v_mfma_f32_16x16x32_bf16 v[220:223], v[60:63], a[120:123], v[220:223]
    buffer_load_dwordx4 a[216:219], v1, s[8:11], s80 offen offset:1024
    v_mfma_f32_16x16x32_bf16 v[252:255], v[60:63], a[124:127], v[252:255]
    s_waitcnt lgkmcnt(12)
    v_subrev_u32 v15, 98304, v15
    v_mfma_f32_16x16x32_bf16 v[128:131], v[32:35], a[128:131], v[128:131]
    s_waitcnt vmcnt(24)
    ds_read_b64_tr_b16 v[60:61], v15 offset:0
    v_mfma_f32_16x16x32_bf16 v[160:163], v[32:35], a[132:135], v[160:163]
    s_waitcnt vmcnt(22)
    ds_read_b64_tr_b16 v[62:63], v15 offset:1024
    v_mfma_f32_16x16x32_bf16 v[192:195], v[32:35], a[136:139], v[192:195]
    s_waitcnt vmcnt(21)
    v_mfma_f32_16x16x32_bf16 v[224:227], v[32:35], a[140:143], v[224:227]
    s_waitcnt lgkmcnt(12)
    v_mfma_f32_16x16x32_bf16 v[132:135], v[36:39], a[128:131], v[132:135]
    s_xor_b32 s80, s76, 28672
    ds_read_b64_tr_b16 v[32:33], v8 offset:8192
    v_mfma_f32_16x16x32_bf16 v[164:167], v[36:39], a[132:135], v[164:167]
    ds_read_b64_tr_b16 v[34:35], v8 offset:9216
    v_mfma_f32_16x16x32_bf16 v[196:199], v[36:39], a[136:139], v[196:199]
    buffer_load_dwordx4 a[220:223], v1, s[8:11], s80 offen offset:1024
    s_waitcnt vmcnt(6)
    v_cmp_ne_u32 vcc, 0, v3
    s_cmp_eq_u64 vcc, -1
    s_cbranch_scc0 L_KV_slow_7
L_KV_ok_8:
    v_mfma_f32_16x16x32_bf16 v[228:231], v[36:39], a[140:143], v[228:231]
    s_waitcnt lgkmcnt(12)
    v_mfma_f32_16x16x32_bf16 v[136:139], v[40:43], a[128:131], v[136:139]
    s_add_u32 m0, s62, 65536
    s_add_u32 s98, s81, 0
    ds_read_b64_tr_b16 v[36:37], v9 offset:8192
    v_mfma_f32_16x16x32_bf16 v[168:171], v[40:43], a[132:135], v[168:171]
    s_waitcnt lgkmcnt(11)
    s_xor_b32 s80, s75, 14336
    s_and_b32 s100, s3, 1
    ds_read_b64_tr_b16 v[38:39], v9 offset:9216
    v_mfma_f32_16x16x32_bf16 v[200:203], v[40:43], a[136:139], v[200:203]
    buffer_load_dwordx4 a[224:227], v1, s[8:11], s80 offen offset:0
    v_mfma_f32_16x16x32_bf16 v[232:235], v[40:43], a[140:143], v[232:235]
    buffer_load_dwordx4 v1, s[8:11], s98 offen offset:0  lds
    v_mfma_f32_16x16x32_bf16 v[140:143], v[44:47], a[128:131], v[140:143]
    s_lshr_b32 s101, s3, 1
    ds_read_b64_tr_b16 v[40:41], v10 offset:8192
    v_add_u32 v16, s62, v1
    v_mfma_f32_16x16x32_bf16 v[172:175], v[44:47], a[132:135], v[172:175]
    s_lshl_b32 s19, s101, 14
    ds_read_b64_tr_b16 v[42:43], v10 offset:9216
    v_add_u32 v17, s19, v1
    v_mfma_f32_16x16x32_bf16 v[204:207], v[44:47], a[136:139], v[204:207]
    v_mfma_f32_16x16x32_bf16 v[236:239], v[44:47], a[140:143], v[236:239]
    s_waitcnt lgkmcnt(12)
    v_mfma_f32_16x16x32_bf16 v[144:147], v[48:51], a[128:131], v[144:147]
    s_xor_b32 s80, s75, 30720
    s_lshl_b32 s19, s100, 13
    ds_read_b64_tr_b16 v[44:45], v11 offset:8192
    v_mfma_f32_16x16x32_bf16 v[176:179], v[48:51], a[132:135], v[176:179]
    s_waitcnt lgkmcnt(11)
    s_add_u32 s19, s19, 65536
    ds_read_b64_tr_b16 v[46:47], v11 offset:9216
    v_add_u32 v18, s19, v1
    v_mfma_f32_16x16x32_bf16 v[208:211], v[48:51], a[136:139], v[208:211]
    buffer_load_dwordx4 a[228:231], v1, s[8:11], s80 offen offset:0
    v_mfma_f32_16x16x32_bf16 v[240:243], v[48:51], a[140:143], v[240:243]
    buffer_load_dwordx4 v1, s[8:11], s98 offen offset:1024  lds
    v_mfma_f32_16x16x32_bf16 v[148:151], v[52:55], a[128:131], v[148:151]
    s_mul_i32 s19, s100, 12288
    s_add_u32 s19, s19, 98304
    ds_read_b64_tr_b16 v[48:49], v12 offset:8192
    v_mfma_f32_16x16x32_bf16 v[180:183], v[52:55], a[132:135], v[180:183]
    ds_read_b64_tr_b16 v[50:51], v12 offset:9216
    v_add_u32 v19, s19, v1
    v_mfma_f32_16x16x32_bf16 v[212:215], v[52:55], a[136:139], v[212:215]
    v_mfma_f32_16x16x32_bf16 v[244:247], v[52:55], a[140:143], v[244:247]
    s_waitcnt lgkmcnt(12)
    v_mfma_f32_16x16x32_bf16 v[152:155], v[56:59], a[128:131], v[152:155]
    s_xor_b32 s80, s76, 14336
    s_lshl_b32 s19, s100, 12
    ds_read_b64_tr_b16 v[52:53], v13 offset:8192
    v_mfma_f32_16x16x32_bf16 v[184:187], v[56:59], a[132:135], v[184:187]
    s_waitcnt lgkmcnt(11)
    s_add_u32 s19, s19, 98304
    ds_read_b64_tr_b16 v[54:55], v13 offset:9216
    v_add_u32 v20, s19, v1
    v_mfma_f32_16x16x32_bf16 v[216:219], v[56:59], a[136:139], v[216:219]
    buffer_load_dwordx4 a[232:235], v1, s[8:11], s80 offen offset:0
    v_mfma_f32_16x16x32_bf16 v[248:251], v[56:59], a[140:143], v[248:251]
    buffer_load_dwordx4 v1, s[8:11], s98 offen offset:2048  lds
    v_mfma_f32_16x16x32_bf16 v[156:159], v[60:63], a[128:131], v[156:159]
    ds_read_b64_tr_b16 v[56:57], v14 offset:8192
    v_and_b32 v23, 15, v2
    v_mfma_f32_16x16x32_bf16 v[188:191], v[60:63], a[132:135], v[188:191]
    ds_read_b64_tr_b16 v[58:59], v14 offset:9216
    v_lshrrev_b32 v24, 4, v2
    v_mfma_f32_16x16x32_bf16 v[220:223], v[60:63], a[136:139], v[220:223]
    v_lshlrev_b32 v25, 2, v24
    v_sub_u32 v25, v23, v25
    v_mfma_f32_16x16x32_bf16 v[252:255], v[60:63], a[140:143], v[252:255]
    s_waitcnt lgkmcnt(12)
    v_mfma_f32_16x16x32_bf16 v[128:131], v[32:35], a[144:147], v[128:131]
    s_xor_b32 s80, s76, 30720
    s_sub_i32 s19, s101, s100
    ds_read_b64_tr_b16 v[60:61], v15 offset:8192
    v_mfma_f32_16x16x32_bf16 v[160:163], v[32:35], a[148:151], v[160:163]
    s_waitcnt lgkmcnt(11)
    s_lshl_b32 s19, s19, 5
    ds_read_b64_tr_b16 v[62:63], v15 offset:9216
    v_add_u32 v21, s19, v25
    v_mfma_f32_16x16x32_bf16 v[192:195], v[32:35], a[152:155], v[192:195]
    buffer_load_dwordx4 a[236:239], v1, s[8:11], s80 offen offset:0
    v_mfma_f32_16x16x32_bf16 v[224:227], v[32:35], a[156:159], v[224:227]
    buffer_load_dwordx4 v1, s[8:11], s98 offen offset:3072  lds
    v_mfma_f32_16x16x32_bf16 v[132:135], v[36:39], a[144:147], v[132:135]
    s_add_u32 m0, s62, 69632
    s_add_u32 s98, s81, 4096
    ds_read_b64_tr_b16 v[32:33], v8 offset:16384
    v_mfma_f32_16x16x32_bf16 v[164:167], v[36:39], a[148:151], v[164:167]
    s_xor_b32 s80, s75, 14336
    s_add_u32 s19, s101, s100
    ds_read_b64_tr_b16 v[34:35], v8 offset:17408
    v_mfma_f32_16x16x32_bf16 v[196:199], v[36:39], a[152:155], v[196:199]
    buffer_load_dwordx4 a[240:243], v1, s[8:11], s80 offen offset:1024
    v_mfma_f32_16x16x32_bf16 v[228:231], v[36:39], a[156:159], v[228:231]
    s_waitcnt lgkmcnt(12)
    s_sub_i32 s19, 1, s19
    s_lshl_b32 s19, s19, 5
    v_add_u32 v22, s19, v25
    v_mfma_f32_16x16x32_bf16 v[136:139], v[40:43], a[144:147], v[136:139]
    ds_read_b64_tr_b16 v[36:37], v9 offset:16384
    v_cvt_f32_i32 v21, v21
    v_mfma_f32_16x16x32_bf16 v[168:171], v[40:43], a[148:151], v[168:171]
    ds_read_b64_tr_b16 v[38:39], v9 offset:17408
    v_cvt_f32_i32 v22, v22
    v_mfma_f32_16x16x32_bf16 v[200:203], v[40:43], a[152:155], v[200:203]
    buffer_load_dwordx4 v1, s[8:11], s98 offen offset:0  lds
    v_mfma_f32_16x16x32_bf16 v[232:235], v[40:43], a[156:159], v[232:235]
    s_waitcnt lgkmcnt(12)
    v_add_f32 v21, 0.5, v21
    v_add_f32 v22, 0.5, v22
    v_mfma_f32_16x16x32_bf16 v[140:143], v[44:47], a[144:147], v[140:143]
    s_xor_b32 s80, s75, 30720
    ds_read_b64_tr_b16 v[40:41], v10 offset:16384
    v_mul_f32 v21, 0x71800000, v21
    v_mfma_f32_16x16x32_bf16 v[172:175], v[44:47], a[148:151], v[172:175]
    s_waitcnt lgkmcnt(11)
    ds_read_b64_tr_b16 v[42:43], v10 offset:17408
    v_mul_f32 v22, 0x71800000, v22
    v_mfma_f32_16x16x32_bf16 v[204:207], v[44:47], a[152:155], v[204:207]
    buffer_load_dwordx4 a[244:247], v1, s[8:11], s80 offen offset:1024
    v_mfma_f32_16x16x32_bf16 v[236:239], v[44:47], a[156:159], v[236:239]
    buffer_load_dwordx4 v1, s[8:11], s98 offen offset:1024  lds
    v_mfma_f32_16x16x32_bf16 v[144:147], v[48:51], a[144:147], v[144:147]
    ds_read_b64_tr_b16 v[44:45], v11 offset:16384
    v_lshrrev_b32 v25, 2, v23
    v_mfma_f32_16x16x32_bf16 v[176:179], v[48:51], a[148:151], v[176:179]
    ds_read_b64_tr_b16 v[46:47], v11 offset:17408
    v_and_b32 v23, 3, v23
    v_mfma_f32_16x16x32_bf16 v[208:211], v[48:51], a[152:155], v[208:211]
    v_lshlrev_b32 v23, 6, v23
    v_lshl_add_u32 v23, v25, 15, v23
    v_mfma_f32_16x16x32_bf16 v[240:243], v[48:51], a[156:159], v[240:243]
    s_waitcnt lgkmcnt(12)
    v_mfma_f32_16x16x32_bf16 v[148:151], v[52:55], a[144:147], v[148:151]
    s_xor_b32 s80, s76, 14336
    ds_read_b64_tr_b16 v[48:49], v12 offset:16384
    v_lshl_add_u32 v23, v24, 4, v23
    v_mfma_f32_16x16x32_bf16 v[180:183], v[52:55], a[148:151], v[180:183]
    s_waitcnt lgkmcnt(11)
    s_lshl_b32 s18, s6, 20
    s_lshl_b32 s19, s3, 18
    ds_read_b64_tr_b16 v[50:51], v12 offset:17408
    v_mfma_f32_16x16x32_bf16 v[212:215], v[52:55], a[152:155], v[212:215]
    buffer_load_dwordx4 a[248:251], v1, s[8:11], s80 offen offset:1024
    v_mfma_f32_16x16x32_bf16 v[244:247], v[52:55], a[156:159], v[244:247]
    buffer_load_dwordx4 v1, s[8:11], s98 offen offset:2048  lds
    v_mfma_f32_16x16x32_bf16 v[152:155], v[56:59], a[144:147], v[152:155]
    s_add_u32 s18, s18, s19
    s_lshl_b32 s19, s7, 10
    ds_read_b64_tr_b16 v[52:53], v13 offset:16384
    v_mfma_f32_16x16x32_bf16 v[184:187], v[56:59], a[148:151], v[184:187]
    s_add_u32 s18, s18, s19
    s_add_u32 s18, s18, 67108864
    ds_read_b64_tr_b16 v[54:55], v13 offset:17408
    v_mfma_f32_16x16x32_bf16 v[216:219], v[56:59], a[152:155], v[216:219]
    s_mov_b32 s13, s60
    s_mov_b32 s12, 2
    s_mov_b32 s25, 0
    v_mfma_f32_16x16x32_bf16 v[248:251], v[56:59], a[156:159], v[248:251]
    s_waitcnt lgkmcnt(12)
    v_mfma_f32_16x16x32_bf16 v[156:159], v[60:63], a[144:147], v[156:159]
    s_xor_b32 s80, s76, 30720
    s_mov_b32 s26, 28
    ds_read_b64_tr_b16 v[56:57], v14 offset:16384
    v_mfma_f32_16x16x32_bf16 v[188:191], v[60:63], a[148:151], v[188:191]
    s_waitcnt lgkmcnt(11)
    s_mov_b32 s64, 128
    s_lshl_b32 s65, s3, 16
    ds_read_b64_tr_b16 v[58:59], v14 offset:17408
    v_mfma_f32_16x16x32_bf16 v[220:223], v[60:63], a[152:155], v[220:223]
    buffer_load_dwordx4 a[252:255], v1, s[8:11], s80 offen offset:1024
    v_mfma_f32_16x16x32_bf16 v[252:255], v[60:63], a[156:159], v[252:255]
    buffer_load_dwordx4 v1, s[8:11], s98 offen offset:3072  lds
    v_mfma_f32_16x16x32_bf16 v[128:131], v[32:35], a[160:163], v[128:131]
    s_add_u32 m0, s62, 98304
    s_add_u32 s98, s81, 32768
    ds_read_b64_tr_b16 v[60:61], v15 offset:16384
    v_mfma_f32_16x16x32_bf16 v[160:163], v[32:35], a[164:167], v[160:163]
    s_add_u32 s15, s62, 65536
    s_add_u32 s16, s62, 0
    ds_read_b64_tr_b16 v[62:63], v15 offset:17408
    v_mfma_f32_16x16x32_bf16 v[192:195], v[32:35], a[168:171], v[192:195]
    s_lshl_b32 s20, s7, 13
    s_lshl_b32 s19, s100, 11
    s_add_u32 s20, s20, s19
    v_mfma_f32_16x16x32_bf16 v[224:227], v[32:35], a[172:175], v[224:227]
    s_waitcnt lgkmcnt(12)
    v_mfma_f32_16x16x32_bf16 v[132:135], v[36:39], a[160:163], v[132:135]
    s_add_u32 s20, s20, 50331648
    s_sub_u32 s19, 3, s101
    ds_read_b64_tr_b16 v[32:33], v8 offset:24576
    v_mfma_f32_16x16x32_bf16 v[164:167], v[36:39], a[164:167], v[164:167]
    s_lshl_b32 s19, s19, 18
    s_add_u32 s21, s20, s19
    ds_read_b64_tr_b16 v[34:35], v8 offset:25600
    v_mfma_f32_16x16x32_bf16 v[196:199], v[36:39], a[168:171], v[196:199]
    buffer_load_dwordx4 v1, s[8:11], s98 offen offset:0  lds
    v_mfma_f32_16x16x32_bf16 v[228:231], v[36:39], a[172:175], v[228:231]
    s_waitcnt lgkmcnt(12)
    s_lshl_b32 s19, s101, 18
    s_add_u32 s20, s20, s19
    s_add_u32 s22, s72, 131072
    v_mfma_f32_16x16x32_bf16 v[136:139], v[40:43], a[160:163], v[136:139]
    s_and_b32 s23, s2, 231
    s_lshl_b32 s23, s23, 8
    ds_read_b64_tr_b16 v[36:37], v9 offset:24576
    v_mfma_f32_16x16x32_bf16 v[168:171], v[40:43], a[164:167], v[168:171]
    s_sub_u32 s19, 3, s3
    s_min_u32 s19, s19, s3
    ds_read_b64_tr_b16 v[38:39], v9 offset:25600
    v_mfma_f32_16x16x32_bf16 v[200:203], v[40:43], a[168:171], v[200:203]
    s_waitcnt lgkmcnt(12)
    s_lshl_b32 s19, s19, 7
    s_add_u32 s23, s23, s19
    s_add_u32 s23, s23, 393216
    v_mfma_f32_16x16x32_bf16 v[232:235], v[40:43], a[172:175], v[232:235]
    buffer_load_dwordx4 v1, s[8:11], s98 offen offset:1024  lds
    v_mfma_f32_16x16x32_bf16 v[140:143], v[44:47], a[160:163], v[140:143]
    ds_read_b64_tr_b16 v[40:41], v10 offset:24576
    v_mov_b32 v24, -1
    v_mfma_f32_16x16x32_bf16 v[172:175], v[44:47], a[164:167], v[172:175]
    ds_read_b64_tr_b16 v[42:43], v10 offset:25600
    v_mov_b32 v28, 0x3f803f80
    v_mfma_f32_16x16x32_bf16 v[204:207], v[44:47], a[168:171], v[204:207]
    v_mov_b32 v25, -1
    v_mov_b32 v29, 0x3f803f80
    v_mfma_f32_16x16x32_bf16 v[236:239], v[44:47], a[172:175], v[236:239]
    s_waitcnt lgkmcnt(12)
    v_mfma_f32_16x16x32_bf16 v[144:147], v[48:51], a[160:163], v[144:147]
    ds_read_b64_tr_b16 v[44:45], v11 offset:24576
    v_mov_b32 v26, -1
    v_mfma_f32_16x16x32_bf16 v[176:179], v[48:51], a[164:167], v[176:179]
    ds_read_b64_tr_b16 v[46:47], v11 offset:25600
    v_mov_b32 v30, 0x3f803f80
    v_mfma_f32_16x16x32_bf16 v[208:211], v[48:51], a[168:171], v[208:211]
    buffer_load_dwordx4 v1, s[8:11], s98 offen offset:2048  lds
    v_mfma_f32_16x16x32_bf16 v[240:243], v[48:51], a[172:175], v[240:243]
    s_waitcnt lgkmcnt(12)
    v_mov_b32 v27, -1
    v_mov_b32 v31, 0x3f803f80
    v_mfma_f32_16x16x32_bf16 v[148:151], v[52:55], a[160:163], v[148:151]
    ds_read_b64_tr_b16 v[48:49], v12 offset:24576
    v_mov_b32 v64, 0
    v_mfma_f32_16x16x32_bf16 v[180:183], v[52:55], a[164:167], v[180:183]
    ds_read_b64_tr_b16 v[50:51], v12 offset:25600
    v_mov_b32 v65, 0
    v_mfma_f32_16x16x32_bf16 v[212:215], v[52:55], a[168:171], v[212:215]
    s_waitcnt lgkmcnt(12)
    v_mov_b32 v66, 0
    v_mov_b32 v67, 0
    v_mfma_f32_16x16x32_bf16 v[244:247], v[52:55], a[172:175], v[244:247]
    buffer_load_dwordx4 v1, s[8:11], s98 offen offset:3072  lds
    v_mfma_f32_16x16x32_bf16 v[152:155], v[56:59], a[160:163], v[152:155]
    s_add_u32 m0, s62, 102400
    s_add_u32 s98, s81, 36864
    ds_read_b64_tr_b16 v[52:53], v13 offset:24576
    v_mfma_f32_16x16x32_bf16 v[184:187], v[56:59], a[164:167], v[184:187]
    ds_read_b64_tr_b16 v[54:55], v13 offset:25600
    v_mov_b32 v68, 0
    v_mfma_f32_16x16x32_bf16 v[216:219], v[56:59], a[168:171], v[216:219]
    v_mov_b32 v69, 0
    v_mov_b32 v70, 0
    v_mfma_f32_16x16x32_bf16 v[248:251], v[56:59], a[172:175], v[248:251]
    s_waitcnt lgkmcnt(12)
    v_mfma_f32_16x16x32_bf16 v[156:159], v[60:63], a[160:163], v[156:159]
    ds_read_b64_tr_b16 v[56:57], v14 offset:24576
    v_mov_b32 v71, 0
    v_mfma_f32_16x16x32_bf16 v[188:191], v[60:63], a[164:167], v[188:191]
    ds_read_b64_tr_b16 v[58:59], v14 offset:25600
    v_mov_b32 v72, 0
    v_mfma_f32_16x16x32_bf16 v[220:223], v[60:63], a[168:171], v[220:223]
    buffer_load_dwordx4 v1, s[8:11], s98 offen offset:0  lds
    v_mfma_f32_16x16x32_bf16 v[252:255], v[60:63], a[172:175], v[252:255]
    s_waitcnt lgkmcnt(12)
    v_mov_b32 v73, 0
    v_mov_b32 v74, 0
    v_mfma_f32_16x16x32_bf16 v[128:131], v[32:35], a[176:179], v[128:131]
    ds_read_b64_tr_b16 v[60:61], v15 offset:24576
    v_mov_b32 v75, 0
    v_mfma_f32_16x16x32_bf16 v[160:163], v[32:35], a[180:183], v[160:163]
    ds_read_b64_tr_b16 v[62:63], v15 offset:25600
    v_mov_b32 v76, 0
    v_mfma_f32_16x16x32_bf16 v[192:195], v[32:35], a[184:187], v[192:195]
    s_waitcnt lgkmcnt(12)
    v_mov_b32 v77, 0
    v_mov_b32 v78, 0
    v_mfma_f32_16x16x32_bf16 v[224:227], v[32:35], a[188:191], v[224:227]
    buffer_load_dwordx4 v1, s[8:11], s98 offen offset:1024  lds
    v_mfma_f32_16x16x32_bf16 v[132:135], v[36:39], a[176:179], v[132:135]
    ds_read_b64_tr_b16 v[32:33], v8 offset:32768
    v_mov_b32 v79, 0
    v_mfma_f32_16x16x32_bf16 v[164:167], v[36:39], a[180:183], v[164:167]
    ds_read_b64_tr_b16 v[34:35], v8 offset:33792
    v_add_f32 v80, 0, v21
    v_mfma_f32_16x16x32_bf16 v[196:199], v[36:39], a[184:187], v[196:199]
    v_min_f32 v80, v80, v64
    v_add_f32 v81, 0xf1800000, v21
    v_mfma_f32_16x16x32_bf16 v[228:231], v[36:39], a[188:191], v[228:231]
    s_waitcnt lgkmcnt(12)
    v_mfma_f32_16x16x32_bf16 v[136:139], v[40:43], a[176:179], v[136:139]
    ds_read_b64_tr_b16 v[36:37], v9 offset:32768
    v_min_f32 v81, v81, v65
    v_mfma_f32_16x16x32_bf16 v[168:171], v[40:43], a[180:183], v[168:171]
    ds_read_b64_tr_b16 v[38:39], v9 offset:33792
    v_add_f32 v82, 0xf2000000, v21
    v_mfma_f32_16x16x32_bf16 v[200:203], v[40:43], a[184:187], v[200:203]
    buffer_load_dwordx4 v1, s[8:11], s98 offen offset:2048  lds
    v_mfma_f32_16x16x32_bf16 v[232:235], v[40:43], a[188:191], v[232:235]
    s_waitcnt lgkmcnt(12)
    v_min_f32 v82, v82, v66
    v_add_f32 v83, 0xf2400000, v21
    v_mfma_f32_16x16x32_bf16 v[140:143], v[44:47], a[176:179], v[140:143]
    ds_read_b64_tr_b16 v[40:41], v10 offset:32768
    v_min_f32 v83, v83, v67
    v_mfma_f32_16x16x32_bf16 v[172:175], v[44:47], a[180:183], v[172:175]
    ds_read_b64_tr_b16 v[42:43], v10 offset:33792
    v_add_f32 v84, 0xf3800000, v21
    v_mfma_f32_16x16x32_bf16 v[204:207], v[44:47], a[184:187], v[204:207]
    s_waitcnt lgkmcnt(12)
    v_min_f32 v84, v84, v64
    v_add_f32 v85, 0xf3880000, v21
    v_mfma_f32_16x16x32_bf16 v[236:239], v[44:47], a[188:191], v[236:239]
    buffer_load_dwordx4 v1, s[8:11], s98 offen offset:3072  lds
    v_mfma_f32_16x16x32_bf16 v[144:147], v[48:51], a[176:179], v[144:147]
    s_add_u32 m0, s62, 131072
    s_add_u32 s98, s82, 0
    ds_read_b64_tr_b16 v[44:45], v11 offset:32768
    v_mfma_f32_16x16x32_bf16 v[176:179], v[48:51], a[180:183], v[176:179]
    ds_read_b64_tr_b16 v[46:47], v11 offset:33792
    v_min_f32 v85, v85, v65
    v_mfma_f32_16x16x32_bf16 v[208:211], v[48:51], a[184:187], v[208:211]
    v_add_f32 v86, 0xf3900000, v21
    v_min_f32 v86, v86, v66
    v_mfma_f32_16x16x32_bf16 v[240:243], v[48:51], a[188:191], v[240:243]
    s_waitcnt lgkmcnt(12)
    v_mfma_f32_16x16x32_bf16 v[148:151], v[52:55], a[176:179], v[148:151]
    ds_read_b64_tr_b16 v[48:49], v12 offset:32768
    v_add_f32 v87, 0xf3980000, v21
    v_mfma_f32_16x16x32_bf16 v[180:183], v[52:55], a[180:183], v[180:183]
    ds_read_b64_tr_b16 v[50:51], v12 offset:33792
    v_min_f32 v87, v87, v67
    v_mfma_f32_16x16x32_bf16 v[212:215], v[52:55], a[184:187], v[212:215]
    buffer_load_dwordx4 v1, s[8:11], s98 offen offset:0  lds
    v_mfma_f32_16x16x32_bf16 v[244:247], v[52:55], a[188:191], v[244:247]
    s_waitcnt lgkmcnt(12)
    v_add_f32 v88, 0x73800000, v21
    v_min_f32 v88, v88, v68
    v_mfma_f32_16x16x32_bf16 v[152:155], v[56:59], a[176:179], v[152:155]
    ds_read_b64_tr_b16 v[52:53], v13 offset:32768
    v_add_f32 v89, 0x73700000, v21
    v_mfma_f32_16x16x32_bf16 v[184:187], v[56:59], a[180:183], v[184:187]
    ds_read_b64_tr_b16 v[54:55], v13 offset:33792
    v_min_f32 v89, v89, v69
    v_mfma_f32_16x16x32_bf16 v[216:219], v[56:59], a[184:187], v[216:219]
    s_waitcnt lgkmcnt(12)
    v_add_f32 v90, 0x73600000, v21
    v_min_f32 v90, v90, v70
    v_mfma_f32_16x16x32_bf16 v[248:251], v[56:59], a[188:191], v[248:251]
    buffer_load_dwordx4 v1, s[8:11], s98 offen offset:1024  lds
    v_mfma_f32_16x16x32_bf16 v[156:159], v[60:63], a[176:179], v[156:159]
    ds_read_b64_tr_b16 v[56:57], v14 offset:32768
    v_add_f32 v91, 0x73500000, v21
    v_mfma_f32_16x16x32_bf16 v[188:191], v[60:63], a[180:183], v[188:191]
    ds_read_b64_tr_b16 v[58:59], v14 offset:33792
    v_min_f32 v91, v91, v71
    v_mfma_f32_16x16x32_bf16 v[220:223], v[60:63], a[184:187], v[220:223]
    v_add_f32 v92, 0, v21
    v_min_f32 v92, v92, v68
    v_mfma_f32_16x16x32_bf16 v[252:255], v[60:63], a[188:191], v[252:255]
    s_waitcnt lgkmcnt(12)
    v_mfma_f32_16x16x32_bf16 v[128:131], v[32:35], a[192:195], v[128:131]
    ds_read_b64_tr_b16 v[60:61], v15 offset:32768
    v_add_f32 v93, 0xf1800000, v21
    v_mfma_f32_16x16x32_bf16 v[160:163], v[32:35], a[196:199], v[160:163]
    s_waitcnt vmcnt(30)
    ds_read_b64_tr_b16 v[62:63], v15 offset:33792
    v_min_f32 v93, v93, v69
    v_mfma_f32_16x16x32_bf16 v[192:195], v[32:35], a[200:203], v[192:195]
    buffer_load_dwordx4 v1, s[8:11], s98 offen offset:2048  lds
    v_mfma_f32_16x16x32_bf16 v[224:227], v[32:35], a[204:207], v[224:227]
    s_waitcnt lgkmcnt(12)
    v_add_f32 v94, 0xf2000000, v21
    v_min_f32 v94, v94, v70
    v_mfma_f32_16x16x32_bf16 v[132:135], v[36:39], a[192:195], v[132:135]
    ds_read_b64_tr_b16 v[32:33], v8 offset:40960
    v_add_f32 v95, 0xf2400000, v21
    v_mfma_f32_16x16x32_bf16 v[164:167], v[36:39], a[196:199], v[164:167]
    ds_read_b64_tr_b16 v[34:35], v8 offset:41984
    v_min_f32 v95, v95, v71
    v_mfma_f32_16x16x32_bf16 v[196:199], v[36:39], a[200:203], v[196:199]
    s_waitcnt lgkmcnt(12)
    s_cmp_eq_u32 s60, 0
    s_cselect_b32 s19, 0, 0x76800000
    v_add_f32 v3, s19, v21
    v_add_f32 v96, 0, v3
    v_mfma_f32_16x16x32_bf16 v[228:231], v[36:39], a[204:207], v[228:231]
    buffer_load_dwordx4 v1, s[8:11], s98 offen offset:3072  lds
    v_mfma_f32_16x16x32_bf16 v[136:139], v[40:43], a[192:195], v[136:139]
    s_add_u32 m0, s62, 135168
    s_add_u32 s98, s82, 4096
    ds_read_b64_tr_b16 v[36:37], v9 offset:40960
    v_mfma_f32_16x16x32_bf16 v[168:171], v[40:43], a[196:199], v[168:171]
    ds_read_b64_tr_b16 v[38:39], v9 offset:41984
    v_min_f32 v96, v96, v64
    v_mfma_f32_16x16x32_bf16 v[200:203], v[40:43], a[200:203], v[200:203]
    v_add_f32 v97, 0xf1800000, v3
    v_min_f32 v97, v97, v65
    v_mfma_f32_16x16x32_bf16 v[232:235], v[40:43], a[204:207], v[232:235]
    s_waitcnt lgkmcnt(12)
    v_mfma_f32_16x16x32_bf16 v[140:143], v[44:47], a[192:195], v[140:143]
    ds_read_b64_tr_b16 v[40:41], v10 offset:40960
    v_add_f32 v98, 0xf2000000, v3
    v_mfma_f32_16x16x32_bf16 v[172:175], v[44:47], a[196:199], v[172:175]
    ds_read_b64_tr_b16 v[42:43], v10 offset:41984
    v_min_f32 v98, v98, v66
    v_mfma_f32_16x16x32_bf16 v[204:207], v[44:47], a[200:203], v[204:207]
    buffer_load_dwordx4 v1, s[8:11], s98 offen offset:0  lds
    v_mfma_f32_16x16x32_bf16 v[236:239], v[44:47], a[204:207], v[236:239]
    s_waitcnt lgkmcnt(12)
    v_add_f32 v99, 0xf2400000, v3
    v_min_f32 v99, v99, v67
    v_mfma_f32_16x16x32_bf16 v[144:147], v[48:51], a[192:195], v[144:147]
    ds_read_b64_tr_b16 v[44:45], v11 offset:40960
    v_add_f32 v100, 0xf3800000, v3
    v_mfma_f32_16x16x32_bf16 v[176:179], v[48:51], a[196:199], v[176:179]
    ds_read_b64_tr_b16 v[46:47], v11 offset:41984
    v_min_f32 v100, v100, v64
    v_mfma_f32_16x16x32_bf16 v[208:211], v[48:51], a[200:203], v[208:211]
    s_waitcnt lgkmcnt(12)
    v_add_f32 v101, 0xf3880000, v3
    v_min_f32 v101, v101, v65
    v_mfma_f32_16x16x32_bf16 v[240:243], v[48:51], a[204:207], v[240:243]
    buffer_load_dwordx4 v1, s[8:11], s98 offen offset:1024  lds
    v_mfma_f32_16x16x32_bf16 v[148:151], v[52:55], a[192:195], v[148:151]
    ds_read_b64_tr_b16 v[48:49], v12 offset:40960
    v_add_f32 v102, 0xf3900000, v3
    v_mfma_f32_16x16x32_bf16 v[180:183], v[52:55], a[196:199], v[180:183]
    ds_read_b64_tr_b16 v[50:51], v12 offset:41984
    v_min_f32 v102, v102, v66
    v_mfma_f32_16x16x32_bf16 v[212:215], v[52:55], a[200:203], v[212:215]
    v_add_f32 v103, 0xf3980000, v3
    v_min_f32 v103, v103, v67
    v_mfma_f32_16x16x32_bf16 v[244:247], v[52:55], a[204:207], v[244:247]
    s_waitcnt lgkmcnt(12)
    v_mfma_f32_16x16x32_bf16 v[152:155], v[56:59], a[192:195], v[152:155]
    ds_read_b64_tr_b16 v[52:53], v13 offset:40960
    v_add_f32 v104, 0x73800000, v3
    v_mfma_f32_16x16x32_bf16 v[184:187], v[56:59], a[196:199], v[184:187]
    ds_read_b64_tr_b16 v[54:55], v13 offset:41984
    v_min_f32 v104, v104, v68
    v_mfma_f32_16x16x32_bf16 v[216:219], v[56:59], a[200:203], v[216:219]
    buffer_load_dwordx4 v1, s[8:11], s98 offen offset:2048  lds
    v_mfma_f32_16x16x32_bf16 v[248:251], v[56:59], a[204:207], v[248:251]
    s_waitcnt lgkmcnt(12)
    v_add_f32 v105, 0x73700000, v3
    v_min_f32 v105, v105, v69
    v_mfma_f32_16x16x32_bf16 v[156:159], v[60:63], a[192:195], v[156:159]
    ds_read_b64_tr_b16 v[56:57], v14 offset:40960
    v_add_f32 v106, 0x73600000, v3
    v_mfma_f32_16x16x32_bf16 v[188:191], v[60:63], a[196:199], v[188:191]
    ds_read_b64_tr_b16 v[58:59], v14 offset:41984
    v_min_f32 v106, v106, v70
    v_mfma_f32_16x16x32_bf16 v[220:223], v[60:63], a[200:203], v[220:223]
    s_waitcnt vmcnt(34) lgkmcnt(12)
    v_add_f32 v107, 0x73500000, v3
    v_min_f32 v107, v107, v71
    v_mfma_f32_16x16x32_bf16 v[252:255], v[60:63], a[204:207], v[252:255]
    buffer_load_dwordx4 v1, s[8:11], s98 offen offset:3072  lds
    v_mfma_f32_16x16x32_bf16 v[128:131], v[32:35], a[208:211], v[128:131]
    s_waitcnt vmcnt(34)
    ds_read_b64_tr_b16 v[60:61], v15 offset:40960
    v_add_f32 v108, 0, v3
    v_mfma_f32_16x16x32_bf16 v[160:163], v[32:35], a[212:215], v[160:163]
    s_waitcnt vmcnt(33)
    ds_read_b64_tr_b16 v[62:63], v15 offset:41984
    v_min_f32 v108, v108, v68
    v_mfma_f32_16x16x32_bf16 v[192:195], v[32:35], a[216:219], v[192:195]
    s_waitcnt vmcnt(32)
    v_add_f32 v109, 0xf1800000, v3
    v_min_f32 v109, v109, v69
    v_mfma_f32_16x16x32_bf16 v[224:227], v[32:35], a[220:223], v[224:227]
    s_waitcnt lgkmcnt(12)
    v_mfma_f32_16x16x32_bf16 v[132:135], v[36:39], a[208:211], v[132:135]
    ds_read_b64_tr_b16 v[32:33], v8 offset:49152
    v_add_f32 v110, 0xf2000000, v3
    v_mfma_f32_16x16x32_bf16 v[164:167], v[36:39], a[212:215], v[164:167]
    ds_read_b64_tr_b16 v[34:35], v8 offset:50176
    v_min_f32 v110, v110, v70
    v_mfma_f32_16x16x32_bf16 v[196:199], v[36:39], a[216:219], v[196:199]
    v_add_f32 v111, 0xf2400000, v3
    v_min_f32 v111, v111, v71
    v_mfma_f32_16x16x32_bf16 v[228:231], v[36:39], a[220:223], v[228:231]
    s_waitcnt lgkmcnt(12)
    v_mfma_f32_16x16x32_bf16 v[136:139], v[40:43], a[208:211], v[136:139]
    s_lshl_b32 s79, s2, 2
    s_add_u32 s79, s79, s3
    ds_read_b64_tr_b16 v[36:37], v9 offset:49152
    v_mfma_f32_16x16x32_bf16 v[168:171], v[40:43], a[212:215], v[168:171]
    s_and_b32 s100, s79, 31
    s_lshr_b32 s101, s79, 5
    ds_read_b64_tr_b16 v[38:39], v9 offset:50176
    v_mfma_f32_16x16x32_bf16 v[200:203], v[40:43], a[216:219], v[200:203]
    v_lshrrev_b32 v121, 3, v2
    v_and_b32 v120, 4, v121
    v_mfma_f32_16x16x32_bf16 v[232:235], v[40:43], a[220:223], v[232:235]
    s_waitcnt lgkmcnt(12)
    v_mfma_f32_16x16x32_bf16 v[140:143], v[44:47], a[208:211], v[140:143]
    ds_read_b64_tr_b16 v[40:41], v10 offset:49152
    v_and_b32 v122, 2, v121
    v_mfma_f32_16x16x32_bf16 v[172:175], v[44:47], a[212:215], v[172:175]
    ds_read_b64_tr_b16 v[42:43], v10 offset:50176
    v_lshl_add_u32 v120, v122, 3, v120
    v_mfma_f32_16x16x32_bf16 v[204:207], v[44:47], a[216:219], v[204:207]
    v_and_b32 v122, 1, v121
    v_lshl_add_u32 v120, v122, 1, v120
    v_mfma_f32_16x16x32_bf16 v[236:239], v[44:47], a[220:223], v[236:239]
    s_waitcnt lgkmcnt(12)
    v_mfma_f32_16x16x32_bf16 v[144:147], v[48:51], a[208:211], v[144:147]
    ds_read_b64_tr_b16 v[44:45], v11 offset:49152
    v_mul_u32_u24 v120, 3584, v120
    v_mfma_f32_16x16x32_bf16 v[176:179], v[48:51], a[212:215], v[176:179]
    ds_read_b64_tr_b16 v[46:47], v11 offset:50176
    v_and_b32 v122, 7, v2
    v_mfma_f32_16x16x32_bf16 v[208:211], v[48:51], a[216:219], v[208:211]
    v_lshl_add_u32 v120, v122, 4, v120
    v_lshlrev_b32 v121, 13, v121
    v_mfma_f32_16x16x32_bf16 v[240:243], v[48:51], a[220:223], v[240:243]
    s_waitcnt lgkmcnt(12)
    v_mfma_f32_16x16x32_bf16 v[148:151], v[52:55], a[208:211], v[148:151]
    ds_read_b64_tr_b16 v[48:49], v12 offset:49152
    v_lshl_add_u32 v121, v122, 4, v121
    v_mfma_f32_16x16x32_bf16 v[180:183], v[52:55], a[212:215], v[180:183]
    s_lshr_b32 s79, s100, 1
    s_lshl_b32 s79, s79, 2
    ds_read_b64_tr_b16 v[50:51], v12 offset:50176
    v_mfma_f32_16x16x32_bf16 v[212:215], v[52:55], a[216:219], v[212:215]
    s_and_b32 s100, s100, 1
    s_add_u32 s79, s79, s100
    s_mul_i32 s79, s79, 28672
    v_mfma_f32_16x16x32_bf16 v[244:247], v[52:55], a[220:223], v[244:247]
    s_waitcnt lgkmcnt(12)
    v_mfma_f32_16x16x32_bf16 v[152:155], v[56:59], a[208:211], v[152:155]
    s_lshl_b32 s100, s101, 7
    s_add_u32 s79, s79, s100
    ds_read_b64_tr_b16 v[52:53], v13 offset:49152
    v_mfma_f32_16x16x32_bf16 v[184:187], v[56:59], a[212:215], v[184:187]
    s_waitcnt lgkmcnt(11)
    s_cmp_lt_u32 s101, 28
    s_cselect_b32 s79, s79, 2147479552
    ds_read_b64_tr_b16 v[54:55], v13 offset:50176
    v_mfma_f32_16x16x32_bf16 v[216:219], v[56:59], a[216:219], v[216:219]
    buffer_load_dwordx4 a[0:3], v120, s[40:43], s79 offen nt
    v_mfma_f32_16x16x32_bf16 v[248:251], v[56:59], a[220:223], v[248:251]
    buffer_load_dwordx4 a[4:7], v120, s[40:43], s79 offen offset:3584 nt
    v_mfma_f32_16x16x32_bf16 v[156:159], v[60:63], a[208:211], v[156:159]
    ds_read_b64_tr_b16 v[56:57], v14 offset:49152
    v_mfma_f32_16x16x32_bf16 v[188:191], v[60:63], a[212:215], v[188:191]
    s_waitcnt vmcnt(33) lgkmcnt(11)
    ds_read_b64_tr_b16 v[58:59], v14 offset:50176
    v_mfma_f32_16x16x32_bf16 v[220:223], v[60:63], a[216:219], v[220:223]
    buffer_load_dwordx4 a[8:11], v120, s[44:47], s79 offen nt
    v_mfma_f32_16x16x32_bf16 v[252:255], v[60:63], a[220:223], v[252:255]
    buffer_load_dwordx4 a[12:15], v120, s[44:47], s79 offen offset:3584 nt
    v_mfma_f32_16x16x32_bf16 v[128:131], v[32:35], a[224:227], v[128:131]
    s_waitcnt vmcnt(33)
    s_lshl_b32 s79, s101, 16
    s_lshl_b32 s100, s3, 11
    ds_read_b64_tr_b16 v[60:61], v15 offset:49152
    v_mfma_f32_16x16x32_bf16 v[160:163], v[32:35], a[228:231], v[160:163]
    s_waitcnt vmcnt(31)
    s_add_u32 s79, s79, s100
    s_lshl_b32 s100, s4, 7
    ds_read_b64_tr_b16 v[62:63], v15 offset:50176
    v_mfma_f32_16x16x32_bf16 v[192:195], v[32:35], a[232:235], v[192:195]
    s_waitcnt vmcnt(29) lgkmcnt(12)
    s_add_u32 s79, s79, s100
    v_mfma_f32_16x16x32_bf16 v[224:227], v[32:35], a[236:239], v[224:227]
    buffer_load_dwordx4 a[16:19], v121, s[48:51], s79 offen nt
    v_mfma_f32_16x16x32_bf16 v[132:135], v[36:39], a[224:227], v[132:135]
    ds_read_b64_tr_b16 v[32:33], v8 offset:57344
    v_mfma_f32_16x16x32_bf16 v[164:167], v[36:39], a[228:231], v[164:167]
    ds_read_b64_tr_b16 v[34:35], v8 offset:58368
    v_mfma_f32_16x16x32_bf16 v[196:199], v[36:39], a[232:235], v[196:199]
    buffer_load_dwordx4 a[20:23], v121, s[48:51], s79 offen offset:1024 nt
    v_mfma_f32_16x16x32_bf16 v[228:231], v[36:39], a[236:239], v[228:231]
    s_waitcnt lgkmcnt(12)
    v_mfma_f32_16x16x32_bf16 v[136:139], v[40:43], a[224:227], v[136:139]
    ds_read_b64_tr_b16 v[36:37], v9 offset:57344
    v_lshrrev_b32 v120, 2, v2
    v_mfma_f32_16x16x32_bf16 v[168:171], v[40:43], a[228:231], v[168:171]
    ds_read_b64_tr_b16 v[38:39], v9 offset:58368
    v_and_b32 v121, 3, v2
    v_mfma_f32_16x16x32_bf16 v[200:203], v[40:43], a[232:235], v[200:203]
    v_lshlrev_b32 v121, 3, v121
    v_lshl_add_u32 v120, v120, 6, v121
    v_mfma_f32_16x16x32_bf16 v[232:235], v[40:43], a[236:239], v[232:235]
    s_waitcnt lgkmcnt(12)
    v_mfma_f32_16x16x32_bf16 v[140:143], v[44:47], a[224:227], v[140:143]
    s_and_b32 s79, s2, 31
    s_lshl_b32 s79, s79, 2
    ds_read_b64_tr_b16 v[40:41], v10 offset:57344
    v_mfma_f32_16x16x32_bf16 v[172:175], v[44:47], a[228:231], v[172:175]
    s_add_u32 s79, s79, s3
    s_lshl_b32 s100, s60, 7
    ds_read_b64_tr_b16 v[42:43], v10 offset:58368
    v_mfma_f32_16x16x32_bf16 v[204:207], v[44:47], a[232:235], v[204:207]
    s_add_u32 s68, s79, s100
    s_lshl_b32 s100, s61, 7
    s_add_u32 s69, s79, s100
    v_mfma_f32_16x16x32_bf16 v[236:239], v[44:47], a[236:239], v[236:239]
    s_waitcnt lgkmcnt(12)
    v_mfma_f32_16x16x32_bf16 v[144:147], v[48:51], a[224:227], v[144:147]
    s_lshl_b32 s100, s68, 10
    s_lshl_b32 s101, s69, 10
    ds_read_b64_tr_b16 v[44:45], v11 offset:57344
    v_mfma_f32_16x16x32_bf16 v[176:179], v[48:51], a[228:231], v[176:179]
    s_waitcnt lgkmcnt(11)
    ds_read_b64_tr_b16 v[46:47], v11 offset:58368
    v_mfma_f32_16x16x32_bf16 v[208:211], v[48:51], a[232:235], v[208:211]
    buffer_load_dwordx2 a[48:49], v120, s[32:35], s100 offen nt
    v_mfma_f32_16x16x32_bf16 v[240:243], v[48:51], a[236:239], v[240:243]
    buffer_load_dwordx2 a[50:51], v120, s[32:35], s100 offen offset:32 nt
    v_mfma_f32_16x16x32_bf16 v[148:151], v[52:55], a[224:227], v[148:151]
    ds_read_b64_tr_b16 v[48:49], v12 offset:57344
    v_mfma_f32_16x16x32_bf16 v[180:183], v[52:55], a[228:231], v[180:183]
    s_waitcnt lgkmcnt(11)
    ds_read_b64_tr_b16 v[50:51], v12 offset:58368
    v_mfma_f32_16x16x32_bf16 v[212:215], v[52:55], a[232:235], v[212:215]
    buffer_load_dwordx2 a[52:53], v120, s[32:35], s101 offen nt
    v_mfma_f32_16x16x32_bf16 v[244:247], v[52:55], a[236:239], v[244:247]
    buffer_load_dwordx2 a[54:55], v120, s[32:35], s101 offen offset:32 nt
    v_mfma_f32_16x16x32_bf16 v[152:155], v[56:59], a[224:227], v[152:155]
    ds_read_b64_tr_b16 v[52:53], v13 offset:57344
    v_mfma_f32_16x16x32_bf16 v[184:187], v[56:59], a[228:231], v[184:187]
    s_waitcnt lgkmcnt(11)
    ds_read_b64_tr_b16 v[54:55], v13 offset:58368
    v_mfma_f32_16x16x32_bf16 v[216:219], v[56:59], a[232:235], v[216:219]
    buffer_load_dwordx2 a[56:57], v120, s[56:59], 0 offen
    v_mfma_f32_16x16x32_bf16 v[248:251], v[56:59], a[236:239], v[248:251]
    buffer_load_dwordx2 a[58:59], v120, s[56:59], 0 offen offset:32
    v_mfma_f32_16x16x32_bf16 v[156:159], v[60:63], a[224:227], v[156:159]
    ds_read_b64_tr_b16 v[56:57], v14 offset:57344
    v_lshrrev_b32 v121, 1, v2
    v_mfma_f32_16x16x32_bf16 v[188:191], v[60:63], a[228:231], v[188:191]
    ds_read_b64_tr_b16 v[58:59], v14 offset:58368
    v_and_b32 v121, 15, v121
    v_mfma_f32_16x16x32_bf16 v[220:223], v[60:63], a[232:235], v[220:223]
    v_lshlrev_b32 v121, 10, v121
    v_and_b32 v122, 1, v2
    v_mfma_f32_16x16x32_bf16 v[252:255], v[60:63], a[236:239], v[252:255]
    s_waitcnt vmcnt(35) lgkmcnt(12)
    v_mfma_f32_16x16x32_bf16 v[128:131], v[32:35], a[240:243], v[128:131]
    s_waitcnt vmcnt(33)
    ds_read_b64_tr_b16 v[60:61], v15 offset:57344
    v_lshl_add_u32 v121, v122, 7, v121
    v_mfma_f32_16x16x32_bf16 v[160:163], v[32:35], a[244:247], v[160:163]
    s_waitcnt vmcnt(31)
    s_lshl_b32 s79, s6, 2
    s_add_u32 s79, s79, s3
    ds_read_b64_tr_b16 v[62:63], v15 offset:58368
    v_mfma_f32_16x16x32_bf16 v[192:195], v[32:35], a[248:251], v[192:195]
    s_waitcnt vmcnt(29) lgkmcnt(12)
    s_lshl_b32 s79, s79, 14
    v_mfma_f32_16x16x32_bf16 v[224:227], v[32:35], a[252:255], v[224:227]
    buffer_load_dword a60, v121, s[28:31], s79 offen
    v_mfma_f32_16x16x32_bf16 v[132:135], v[36:39], a[240:243], v[132:135]
    v_mfma_f32_16x16x32_bf16 v[164:167], v[36:39], a[244:247], v[164:167]
    v_mfma_f32_16x16x32_bf16 v[196:199], v[36:39], a[248:251], v[196:199]
    v_mfma_f32_16x16x32_bf16 v[228:231], v[36:39], a[252:255], v[228:231]
    s_waitcnt lgkmcnt(10)
    v_mfma_f32_16x16x32_bf16 v[136:139], v[40:43], a[240:243], v[136:139]
    v_mfma_f32_16x16x32_bf16 v[168:171], v[40:43], a[244:247], v[168:171]
    v_mfma_f32_16x16x32_bf16 v[200:203], v[40:43], a[248:251], v[200:203]
    s_waitcnt lgkmcnt(0)
    s_barrier
    v_mfma_f32_16x16x32_bf16 v[232:235], v[40:43], a[252:255], v[232:235]
    v_mfma_f32_16x16x32_bf16 v[140:143], v[44:47], a[240:243], v[140:143]
    v_mfma_f32_16x16x32_bf16 v[172:175], v[44:47], a[244:247], v[172:175]
    v_mfma_f32_16x16x32_bf16 v[204:207], v[44:47], a[248:251], v[204:207]
    v_mfma_f32_16x16x32_bf16 v[236:239], v[44:47], a[252:255], v[236:239]
    v_mfma_f32_16x16x32_bf16 v[144:147], v[48:51], a[240:243], v[144:147]
    v_mfma_f32_16x16x32_bf16 v[176:179], v[48:51], a[244:247], v[176:179]
    v_mfma_f32_16x16x32_bf16 v[208:211], v[48:51], a[248:251], v[208:211]
    v_mfma_f32_16x16x32_bf16 v[240:243], v[48:51], a[252:255], v[240:243]
    v_mfma_f32_16x16x32_bf16 v[148:151], v[52:55], a[240:243], v[148:151]
    v_mfma_f32_16x16x32_bf16 v[180:183], v[52:55], a[244:247], v[180:183]
    v_mfma_f32_16x16x32_bf16 v[212:215], v[52:55], a[248:251], v[212:215]
    v_mfma_f32_16x16x32_bf16 v[244:247], v[52:55], a[252:255], v[244:247]
    v_mfma_f32_16x16x32_bf16 v[152:155], v[56:59], a[240:243], v[152:155]
    v_mfma_f32_16x16x32_bf16 v[184:187], v[56:59], a[244:247], v[184:187]
    v_mfma_f32_16x16x32_bf16 v[216:219], v[56:59], a[248:251], v[216:219]
    v_mfma_f32_16x16x32_bf16 v[248:251], v[56:59], a[252:255], v[248:251]
    v_mfma_f32_16x16x32_bf16 v[156:159], v[60:63], a[240:243], v[156:159]
    v_mfma_f32_16x16x32_bf16 v[188:191], v[60:63], a[244:247], v[188:191]
    v_mfma_f32_16x16x32_bf16 v[220:223], v[60:63], a[248:251], v[220:223]
    v_mfma_f32_16x16x32_bf16 v[252:255], v[60:63], a[252:255], v[252:255]
    v_cvt_pk_bf16_f32 v128, v128, v129
    v_cvt_pk_bf16_f32 v129, v130, v131
    v_cvt_pk_bf16_f32 v130, v132, v133
    v_cvt_pk_bf16_f32 v131, v134, v135
    ds_write_b128 v16, v[128:131] offset:0
    v_cvt_pk_bf16_f32 v136, v136, v137
    v_cvt_pk_bf16_f32 v137, v138, v139
    v_cvt_pk_bf16_f32 v138, v140, v141
    v_cvt_pk_bf16_f32 v139, v142, v143
    ds_write_b128 v16, v[136:139] offset:1024
    v_cvt_pk_bf16_f32 v144, v144, v145
    v_cvt_pk_bf16_f32 v145, v146, v147
    v_cvt_pk_bf16_f32 v146, v148, v149
    v_cvt_pk_bf16_f32 v147, v150, v151
    ds_write_b128 v16, v[144:147] offset:2048
    v_cvt_pk_bf16_f32 v152, v152, v153
    v_cvt_pk_bf16_f32 v153, v154, v155
    v_cvt_pk_bf16_f32 v154, v156, v157
    v_cvt_pk_bf16_f32 v155, v158, v159
    ds_write_b128 v16, v[152:155] offset:3072
    v_cvt_pk_bf16_f32 v160, v160, v161
    v_cvt_pk_bf16_f32 v161, v162, v163
    v_cvt_pk_bf16_f32 v162, v164, v165
    v_cvt_pk_bf16_f32 v163, v166, v167
    ds_write_b128 v16, v[160:163] offset:4096
    v_cvt_pk_bf16_f32 v168, v168, v169
    v_cvt_pk_bf16_f32 v169, v170, v171
    v_cvt_pk_bf16_f32 v170, v172, v173
    v_cvt_pk_bf16_f32 v171, v174, v175
    ds_write_b128 v16, v[168:171] offset:5120
    v_cvt_pk_bf16_f32 v176, v176, v177
    v_cvt_pk_bf16_f32 v177, v178, v179
    v_cvt_pk_bf16_f32 v178, v180, v181
    v_cvt_pk_bf16_f32 v179, v182, v183
    ds_write_b128 v16, v[176:179] offset:6144
    v_cvt_pk_bf16_f32 v184, v184, v185
    v_cvt_pk_bf16_f32 v185, v186, v187
    v_cvt_pk_bf16_f32 v186, v188, v189
    v_cvt_pk_bf16_f32 v187, v190, v191
    ds_write_b128 v16, v[184:187] offset:7168
    v_cvt_pk_bf16_f32 v192, v192, v193
    v_cvt_pk_bf16_f32 v193, v194, v195
    v_cvt_pk_bf16_f32 v194, v196, v197
    v_cvt_pk_bf16_f32 v195, v198, v199
    ds_write_b128 v16, v[192:195] offset:32768
    v_cvt_pk_bf16_f32 v200, v200, v201
    v_cvt_pk_bf16_f32 v201, v202, v203
    v_cvt_pk_bf16_f32 v202, v204, v205
    v_cvt_pk_bf16_f32 v203, v206, v207
    ds_write_b128 v16, v[200:203] offset:33792
    v_cvt_pk_bf16_f32 v208, v208, v209
    v_cvt_pk_bf16_f32 v209, v210, v211
    v_cvt_pk_bf16_f32 v210, v212, v213
    v_cvt_pk_bf16_f32 v211, v214, v215
    ds_write_b128 v16, v[208:211] offset:34816
    v_cvt_pk_bf16_f32 v216, v216, v217
    v_cvt_pk_bf16_f32 v217, v218, v219
    v_cvt_pk_bf16_f32 v218, v220, v221
    v_cvt_pk_bf16_f32 v219, v222, v223
    ds_write_b128 v16, v[216:219] offset:35840
    v_cvt_pk_bf16_f32 v224, v224, v225
    v_cvt_pk_bf16_f32 v225, v226, v227
    v_cvt_pk_bf16_f32 v226, v228, v229
    v_cvt_pk_bf16_f32 v227, v230, v231
    ds_write_b128 v16, v[224:227] offset:36864
    v_cvt_pk_bf16_f32 v232, v232, v233
    v_cvt_pk_bf16_f32 v233, v234, v235
    v_cvt_pk_bf16_f32 v234, v236, v237
    v_cvt_pk_bf16_f32 v235, v238, v239
    ds_write_b128 v16, v[232:235] offset:37888
    v_cvt_pk_bf16_f32 v240, v240, v241
    v_cvt_pk_bf16_f32 v241, v242, v243
    v_cvt_pk_bf16_f32 v242, v244, v245
    v_cvt_pk_bf16_f32 v243, v246, v247
    ds_write_b128 v16, v[240:243] offset:38912
    v_cvt_pk_bf16_f32 v248, v248, v249
    v_cvt_pk_bf16_f32 v249, v250, v251
    v_cvt_pk_bf16_f32 v250, v252, v253
    v_cvt_pk_bf16_f32 v251, v254, v255
    ds_write_b128 v16, v[248:251] offset:39936
    v_add_u32 v15, 4096, v1
    s_waitcnt vmcnt(29) lgkmcnt(0)
    s_barrier
    ds_read_b128 a[64:67], v17 offset:0
    ds_read_b128 a[128:131], v18 offset:0
    ds_read_b128 a[68:71], v17 offset:1024
    ds_read_b128 a[132:135], v18 offset:1024
    ds_read_b128 a[72:75], v17 offset:2048
    ds_read_b128 a[136:139], v18 offset:2048
    ds_read_b128 a[76:79], v17 offset:3072
    ds_read_b128 a[140:143], v18 offset:3072
    ds_read_b128 a[144:147], v18 offset:4096
    ds_read_b128 a[148:151], v18 offset:5120
    ds_read_b128 a[152:155], v18 offset:6144
    ds_read_b128 a[156:159], v18 offset:7168
    ds_read_b128 a[80:83], v17 offset:4096
    ds_read_b128 a[84:87], v17 offset:5120
    ds_read_b128 a[88:91], v17 offset:6144
    ds_read_b128 a[92:95], v17 offset:7168
    ds_read_b128 a[96:99], v17 offset:8192
    ds_read_b128 a[100:103], v17 offset:9216
    ds_read_b128 a[104:107], v17 offset:10240
    ds_read_b128 a[108:111], v17 offset:11264
    ds_read_b128 a[112:115], v17 offset:12288
    ds_read_b128 a[116:119], v17 offset:13312
    ds_read_b128 a[120:123], v17 offset:14336
    ds_read_b128 a[124:127], v17 offset:15360
    ds_read_b128 a[192:195], v17 offset:32768
    ds_read_b128 a[196:199], v17 offset:33792
    ds_read_b128 a[200:203], v17 offset:34816
    ds_read_b128 a[204:207], v17 offset:35840
    ds_read_b128 a[208:211], v17 offset:36864
    ds_read_b128 a[212:215], v17 offset:37888
    ds_read_b128 a[216:219], v17 offset:38912
    ds_read_b128 a[220:223], v17 offset:39936
    ds_read_b128 a[224:227], v17 offset:40960
    ds_read_b128 a[228:231], v17 offset:41984
    ds_read_b128 a[232:235], v17 offset:43008
    ds_read_b128 a[236:239], v17 offset:44032
    ds_read_b128 a[240:243], v17 offset:45056
    ds_read_b128 a[244:247], v17 offset:46080
    ds_read_b128 a[248:251], v17 offset:47104
    ds_read_b128 a[252:255], v17 offset:48128
L_t1_start:
    s_waitcnt lgkmcnt(15)
    v_mfma_f32_16x16x32_bf16 v[96:99], a[128:131], a[64:67], v[96:99]
    s_add_u32 s19, s82, 32768
    s_sub_u32 s82, s12, s13
    s_sub_u32 s82, s82, 1
    v_mfma_f32_16x16x32_bf16 v[96:99], a[132:135], a[68:71], v[96:99]
    s_cmp_gt_u32 s12, s13
    s_cselect_b32 s82, s82, s12
    s_lshl_b32 s82, s82, 16
    s_add_u32 s82, s82, s81
    v_mfma_f32_16x16x32_bf16 v[96:99], a[136:139], a[72:75], v[96:99]
    s_cmp_ge_u32 s12, 17
    s_cselect_b32 s82, 2147471360, s82
    s_add_u32 s12, s12, 1
    s_sub_u32 s14, s60, 1
    v_mfma_f32_16x16x32_bf16 v[96:99], a[140:143], a[76:79], v[96:99]
    v_mfma_f32_16x16x32_bf16 v[100:103], a[144:147], a[64:67], v[100:103]
    v_mfma_f32_16x16x32_bf16 v[100:103], a[148:151], a[68:71], v[100:103]
    v_mfma_f32_16x16x32_bf16 v[100:103], a[152:155], a[72:75], v[100:103]
    v_mfma_f32_16x16x32_bf16 v[100:103], a[156:159], a[76:79], v[100:103]
    v_mfma_f32_16x16x32_bf16 v[104:107], a[128:131], a[80:83], v[104:107]
    s_nop 2
    v_exp_f32 v96, v96
    v_mfma_f32_16x16x32_bf16 v[104:107], a[132:135], a[84:87], v[104:107]
    v_exp_f32 v97, v97
    v_mfma_f32_16x16x32_bf16 v[104:107], a[136:139], a[88:91], v[104:107]
    v_exp_f32 v98, v98
    v_mfma_f32_16x16x32_bf16 v[104:107], a[140:143], a[92:95], v[104:107]
    v_exp_f32 v99, v99
    v_mfma_f32_16x16x32_bf16 v[108:111], a[144:147], a[80:83], v[108:111]
    v_exp_f32 v100, v100
    v_mfma_f32_16x16x32_bf16 v[108:111], a[148:151], a[84:87], v[108:111]
    v_exp_f32 v101, v101
    v_mfma_f32_16x16x32_bf16 v[108:111], a[152:155], a[88:91], v[108:111]
    v_exp_f32 v102, v102
    v_mfma_f32_16x16x32_bf16 v[108:111], a[156:159], a[92:95], v[108:111]
    v_exp_f32 v103, v103
    v_mfma_f32_16x16x32_bf16 v[112:115], a[128:131], a[96:99], v[72:75]
    v_exp_f32 v104, v104
    v_mfma_f32_16x16x32_bf16 v[112:115], a[132:135], a[100:103], v[112:115]
    v_exp_f32 v105, v105
    v_mfma_f32_16x16x32_bf16 v[112:115], a[136:139], a[104:107], v[112:115]
    v_exp_f32 v106, v106
    v_mfma_f32_16x16x32_bf16 v[112:115], a[140:143], a[108:111], v[112:115]
    v_exp_f32 v107, v107
    v_mfma_f32_16x16x32_bf16 v[120:123], a[128:131], a[112:115], v[76:79]
    v_exp_f32 v108, v108
    v_mfma_f32_16x16x32_bf16 v[120:123], a[132:135], a[116:119], v[120:123]
    v_exp_f32 v109, v109
    v_mfma_f32_16x16x32_bf16 v[120:123], a[136:139], a[120:123], v[120:123]
    v_exp_f32 v110, v110
    v_mfma_f32_16x16x32_bf16 v[120:123], a[140:143], a[124:127], v[120:123]
    v_exp_f32 v111, v111
    v_mfma_f32_16x16x32_bf16 v[116:119], a[144:147], a[96:99], v[72:75]
    ds_read_b128 a[128:131], v18 offset:16384
    v_cvt_pk_bf16_f32 v48, v96, v97
    v_mfma_f32_16x16x32_bf16 v[116:119], a[148:151], a[100:103], v[116:119]
    ds_read_b128 a[132:135], v18 offset:17408
    v_cvt_pk_bf16_f32 v49, v98, v99
    v_mfma_f32_16x16x32_bf16 v[116:119], a[152:155], a[104:107], v[116:119]
    ds_read_b128 a[136:139], v18 offset:18432
    v_cvt_pk_bf16_f32 v50, v100, v101
    v_mfma_f32_16x16x32_bf16 v[116:119], a[156:159], a[108:111], v[116:119]
    ds_read_b128 a[140:143], v18 offset:19456
    v_cvt_pk_bf16_f32 v51, v102, v103
    v_mfma_f32_16x16x32_bf16 v[124:127], a[144:147], a[112:115], v[76:79]
    ds_read_b128 a[144:147], v18 offset:20480
    v_cvt_pk_bf16_f32 v52, v104, v105
    v_mfma_f32_16x16x32_bf16 v[124:127], a[148:151], a[116:119], v[124:127]
    ds_read_b128 a[148:151], v18 offset:21504
    v_cvt_pk_bf16_f32 v53, v106, v107
    v_mfma_f32_16x16x32_bf16 v[124:127], a[152:155], a[120:123], v[124:127]
    ds_read_b128 a[152:155], v18 offset:22528
    v_cvt_pk_bf16_f32 v54, v108, v109
    v_mfma_f32_16x16x32_bf16 v[124:127], a[156:159], a[124:127], v[124:127]
    ds_read_b128 a[156:159], v18 offset:23552
    v_cvt_pk_bf16_f32 v55, v110, v111
    v_xor_b32 v18, 196608, v18
    s_waitcnt vmcnt(13) lgkmcnt(0)
    s_barrier
    s_cmp_eq_u32 s60, 0
    s_cbranch_scc1 L_t1_zero
    v_mfma_f32_16x16x32_bf16 v[96:99], a[128:131], a[64:67], v[64:67]
    s_add_u32 m0, s15, 0
    ds_read_b128 a[160:163], v19 offset:0
    v_mfma_f32_16x16x32_bf16 v[96:99], a[132:135], a[68:71], v[96:99]
    ds_read_b128 a[164:167], v19 offset:1024
    v_mfma_f32_16x16x32_bf16 v[96:99], a[136:139], a[72:75], v[96:99]
    v_exp_f32 v112, v112
    v_mfma_f32_16x16x32_bf16 v[96:99], a[140:143], a[76:79], v[96:99]
    buffer_load_dwordx4 v1, s[8:11], s82 offen offset:0 lds
    v_mfma_f32_16x16x32_bf16 v[104:107], a[128:131], a[80:83], v[68:71]
    v_exp_f32 v113, v113
    v_mfma_f32_16x16x32_bf16 v[104:107], a[132:135], a[84:87], v[104:107]
    ds_read_b128 a[168:171], v19 offset:2048
    v_cvt_pk_bf16_f32 v56, v112, v113
    v_mfma_f32_16x16x32_bf16 v[104:107], a[136:139], a[88:91], v[104:107]
    v_exp_f32 v114, v114
    v_mfma_f32_16x16x32_bf16 v[104:107], a[140:143], a[92:95], v[104:107]
    buffer_load_dwordx4 v1, s[8:11], s82 offen offset:1024 lds
    v_mfma_f32_16x16x32_bf16 v[100:103], a[144:147], a[64:67], v[64:67]
    v_exp_f32 v115, v115
    v_mfma_f32_16x16x32_bf16 v[100:103], a[148:151], a[68:71], v[100:103]
    ds_read_b128 a[172:175], v19 offset:3072
    v_cvt_pk_bf16_f32 v57, v114, v115
    v_mfma_f32_16x16x32_bf16 v[100:103], a[152:155], a[72:75], v[100:103]
    v_exp_f32 v116, v116
    v_mfma_f32_16x16x32_bf16 v[100:103], a[156:159], a[76:79], v[100:103]
    buffer_load_dwordx4 v1, s[8:11], s82 offen offset:2048 lds
    v_mfma_f32_16x16x32_bf16 v[108:111], a[144:147], a[80:83], v[68:71]
    v_exp_f32 v117, v117
    v_mfma_f32_16x16x32_bf16 v[108:111], a[148:151], a[84:87], v[108:111]
    ds_read_b128 a[176:179], v20 offset:4096
    v_cvt_pk_bf16_f32 v58, v116, v117
    v_mfma_f32_16x16x32_bf16 v[108:111], a[152:155], a[88:91], v[108:111]
    v_exp_f32 v118, v118
    v_mfma_f32_16x16x32_bf16 v[108:111], a[156:159], a[92:95], v[108:111]
    buffer_load_dwordx4 v1, s[8:11], s82 offen offset:3072 lds
    v_mfma_f32_16x16x32_bf16 v[32:35], v[28:31], v[48:51], 0
    s_add_u32 m0, s15, 4096
    v_exp_f32 v119, v119
    v_mfma_f32_16x16x32_bf16 v[36:39], v[28:31], v[52:55], 0
    s_waitcnt lgkmcnt(4)
    ds_read_b128 a[180:183], v20 offset:5120
    v_cvt_pk_bf16_f32 v59, v118, v119
    v_mfma_f32_16x16x32_bf16 v[128:131], a[160:163], v[48:51], 0
    v_exp_f32 v120, v120
    v_mfma_f32_16x16x32_bf16 v[160:163], a[160:163], v[52:55], 0
    s_waitcnt lgkmcnt(4)
    v_mfma_f32_16x16x32_bf16 v[132:135], a[164:167], v[48:51], 0
    v_exp_f32 v121, v121
    v_mfma_f32_16x16x32_bf16 v[164:167], a[164:167], v[52:55], 0
    s_waitcnt lgkmcnt(3)
    ds_read_b128 a[184:187], v20 offset:6144
    v_cvt_pk_bf16_f32 v60, v120, v121
    v_mfma_f32_16x16x32_bf16 v[136:139], a[168:171], v[48:51], 0
    s_waitcnt lgkmcnt(3)
    v_exp_f32 v122, v122
    v_mfma_f32_16x16x32_bf16 v[168:171], a[168:171], v[52:55], 0
    buffer_load_dwordx4 v15, s[8:11], s82 offen offset:0 lds
    v_mfma_f32_16x16x32_bf16 v[140:143], a[172:175], v[48:51], 0
    v_exp_f32 v123, v123
    v_mfma_f32_16x16x32_bf16 v[172:175], a[172:175], v[52:55], 0
    s_waitcnt lgkmcnt(2)
    ds_read_b128 a[188:191], v20 offset:7168
    v_cvt_pk_bf16_f32 v61, v122, v123
    v_mfma_f32_16x16x32_bf16 v[144:147], a[176:179], v[48:51], 0
    s_waitcnt lgkmcnt(2)
    v_exp_f32 v124, v124
    v_mfma_f32_16x16x32_bf16 v[176:179], a[176:179], v[52:55], 0
    buffer_load_dwordx4 v15, s[8:11], s82 offen offset:1024 lds
    v_mfma_f32_16x16x32_bf16 v[148:151], a[180:183], v[48:51], 0
    v_exp_f32 v125, v125
    v_mfma_f32_16x16x32_bf16 v[180:183], a[180:183], v[52:55], 0
    s_waitcnt lgkmcnt(1)
    v_cvt_pk_bf16_f32 v62, v124, v125
    v_mfma_f32_16x16x32_bf16 v[152:155], a[184:187], v[48:51], 0
    s_waitcnt lgkmcnt(0)
    v_exp_f32 v126, v126
    v_mfma_f32_16x16x32_bf16 v[184:187], a[184:187], v[52:55], 0
    buffer_load_dwordx4 v15, s[8:11], s82 offen offset:2048 lds
    v_mfma_f32_16x16x32_bf16 v[156:159], a[188:191], v[48:51], 0
    v_exp_f32 v127, v127
    v_mfma_f32_16x16x32_bf16 v[188:191], a[188:191], v[52:55], 0
    v_cvt_pk_bf16_f32 v63, v126, v127
    v_mfma_f32_16x16x32_bf16 v[112:115], a[128:131], a[96:99], v[72:75]
    v_mfma_f32_16x16x32_bf16 v[112:115], a[132:135], a[100:103], v[112:115]
    v_mfma_f32_16x16x32_bf16 v[112:115], a[136:139], a[104:107], v[112:115]
    v_exp_f32 v96, v96
    v_mfma_f32_16x16x32_bf16 v[112:115], a[140:143], a[108:111], v[112:115]
    buffer_load_dwordx4 v15, s[8:11], s82 offen offset:3072 lds
    v_mfma_f32_16x16x32_bf16 v[120:123], a[128:131], a[112:115], v[76:79]
    s_xor_b32 s15, s15, 196608
    v_exp_f32 v97, v97
    v_mfma_f32_16x16x32_bf16 v[120:123], a[132:135], a[116:119], v[120:123]
    s_add_u32 m0, s16, 0
    ds_read_b128 a[128:131], v18 offset:0
    v_cvt_pk_bf16_f32 v48, v96, v97
    v_mfma_f32_16x16x32_bf16 v[120:123], a[136:139], a[120:123], v[120:123]
    v_exp_f32 v98, v98
    v_mfma_f32_16x16x32_bf16 v[120:123], a[140:143], a[124:127], v[120:123]
    buffer_load_dwordx4 v1, s[8:11], s19 offen offset:0 lds
    v_mfma_f32_16x16x32_bf16 v[116:119], a[144:147], a[96:99], v[72:75]
    v_exp_f32 v99, v99
    v_mfma_f32_16x16x32_bf16 v[116:119], a[148:151], a[100:103], v[116:119]
    ds_read_b128 a[132:135], v18 offset:1024
    v_cvt_pk_bf16_f32 v49, v98, v99
    v_mfma_f32_16x16x32_bf16 v[116:119], a[152:155], a[104:107], v[116:119]
    v_exp_f32 v100, v100
    v_mfma_f32_16x16x32_bf16 v[116:119], a[156:159], a[108:111], v[116:119]
    buffer_load_dwordx4 v1, s[8:11], s19 offen offset:1024 lds
    v_mfma_f32_16x16x32_bf16 v[124:127], a[144:147], a[112:115], v[76:79]
    v_exp_f32 v101, v101
    v_mfma_f32_16x16x32_bf16 v[124:127], a[148:151], a[116:119], v[124:127]
    ds_read_b128 a[136:139], v18 offset:2048
    v_cvt_pk_bf16_f32 v50, v100, v101
    v_mfma_f32_16x16x32_bf16 v[124:127], a[152:155], a[120:123], v[124:127]
    v_exp_f32 v102, v102
    v_mfma_f32_16x16x32_bf16 v[124:127], a[156:159], a[124:127], v[124:127]
    buffer_load_dwordx4 v1, s[8:11], s19 offen offset:2048 lds
    v_mfma_f32_16x16x32_bf16 v[40:43], v[28:31], v[56:59], 0
    v_exp_f32 v103, v103
    v_mfma_f32_16x16x32_bf16 v[44:47], v[28:31], v[60:63], 0
    ds_read_b128 a[140:143], v18 offset:3072
    v_cvt_pk_bf16_f32 v51, v102, v103
    v_mfma_f32_16x16x32_bf16 v[192:195], a[160:163], v[56:59], 0
    v_exp_f32 v104, v104
    v_mfma_f32_16x16x32_bf16 v[224:227], a[160:163], v[60:63], 0
    v_mfma_f32_16x16x32_bf16 v[196:199], a[164:167], v[56:59], 0
    v_exp_f32 v105, v105
    v_mfma_f32_16x16x32_bf16 v[228:231], a[164:167], v[60:63], 0
    ds_read_b128 a[144:147], v18 offset:4096
    v_cvt_pk_bf16_f32 v52, v104, v105
    v_mfma_f32_16x16x32_bf16 v[200:203], a[168:171], v[56:59], 0
    v_exp_f32 v106, v106
    v_mfma_f32_16x16x32_bf16 v[232:235], a[168:171], v[60:63], 0
    buffer_load_dwordx4 v1, s[8:11], s19 offen offset:3072 lds
    v_mfma_f32_16x16x32_bf16 v[204:207], a[172:175], v[56:59], 0
    s_add_u32 m0, s16, 4096
    v_exp_f32 v107, v107
    v_mfma_f32_16x16x32_bf16 v[236:239], a[172:175], v[60:63], 0
    ds_read_b128 a[148:151], v18 offset:5120
    v_cvt_pk_bf16_f32 v53, v106, v107
    v_mfma_f32_16x16x32_bf16 v[208:211], a[176:179], v[56:59], 0
    v_exp_f32 v108, v108
    v_mfma_f32_16x16x32_bf16 v[240:243], a[176:179], v[60:63], 0
    buffer_load_dwordx4 v15, s[8:11], s19 offen offset:0 lds
    v_mfma_f32_16x16x32_bf16 v[212:215], a[180:183], v[56:59], 0
    v_exp_f32 v109, v109
    v_mfma_f32_16x16x32_bf16 v[244:247], a[180:183], v[60:63], 0
    ds_read_b128 a[152:155], v18 offset:6144
    v_cvt_pk_bf16_f32 v54, v108, v109
    v_mfma_f32_16x16x32_bf16 v[216:219], a[184:187], v[56:59], 0
    v_exp_f32 v110, v110
    v_mfma_f32_16x16x32_bf16 v[248:251], a[184:187], v[60:63], 0
    buffer_load_dwordx4 v15, s[8:11], s19 offen offset:1024 lds
    v_mfma_f32_16x16x32_bf16 v[220:223], a[188:191], v[56:59], 0
    v_exp_f32 v111, v111
    v_mfma_f32_16x16x32_bf16 v[252:255], a[188:191], v[60:63], 0
    ds_read_b128 a[156:159], v18 offset:7168
    v_cvt_pk_bf16_f32 v55, v110, v111
    s_cmp_eq_u32 s14, 0
    s_cbranch_scc1 L_t1_diag
.p2align 3
L_t1_loop:
    s_waitcnt lgkmcnt(7)
    v_mfma_f32_16x16x32_bf16 v[96:99], a[128:131], a[64:67], v[64:67]
    s_waitcnt lgkmcnt(6)
    ds_read_b128 a[160:163], v19 offset:16384
    v_mfma_f32_16x16x32_bf16 v[96:99], a[132:135], a[68:71], v[96:99]
    s_waitcnt lgkmcnt(6)
    ds_read_b128 a[164:167], v19 offset:17408
    v_mfma_f32_16x16x32_bf16 v[96:99], a[136:139], a[72:75], v[96:99]
    s_waitcnt lgkmcnt(6)
    v_exp_f32 v112, v112
    v_mfma_f32_16x16x32_bf16 v[96:99], a[140:143], a[76:79], v[96:99]
    buffer_load_dwordx4 v15, s[8:11], s19 offen offset:2048 lds
    v_mfma_f32_16x16x32_bf16 v[104:107], a[128:131], a[80:83], v[68:71]
    v_exp_f32 v113, v113
    v_mfma_f32_16x16x32_bf16 v[104:107], a[132:135], a[84:87], v[104:107]
    ds_read_b128 a[168:171], v19 offset:18432
    v_cvt_pk_bf16_f32 v56, v112, v113
    v_mfma_f32_16x16x32_bf16 v[104:107], a[136:139], a[88:91], v[104:107]
    s_waitcnt lgkmcnt(6)
    v_exp_f32 v114, v114
    v_mfma_f32_16x16x32_bf16 v[104:107], a[140:143], a[92:95], v[104:107]
    buffer_load_dwordx4 v15, s[8:11], s19 offen offset:3072 lds
    v_mfma_f32_16x16x32_bf16 v[100:103], a[144:147], a[64:67], v[64:67]
    s_waitcnt lgkmcnt(5)
    s_xor_b32 s16, s16, 98304
    v_exp_f32 v115, v115
    v_mfma_f32_16x16x32_bf16 v[100:103], a[148:151], a[68:71], v[100:103]
    s_waitcnt lgkmcnt(4)
    ds_read_b128 a[172:175], v19 offset:19456
    v_cvt_pk_bf16_f32 v57, v114, v115
    v_mfma_f32_16x16x32_bf16 v[100:103], a[152:155], a[72:75], v[100:103]
    s_waitcnt lgkmcnt(4)
    v_exp_f32 v116, v116
    v_mfma_f32_16x16x32_bf16 v[100:103], a[156:159], a[76:79], v[100:103]
    v_mfma_f32_16x16x32_bf16 v[108:111], a[144:147], a[80:83], v[68:71]
    v_exp_f32 v117, v117
    v_mfma_f32_16x16x32_bf16 v[108:111], a[148:151], a[84:87], v[108:111]
    ds_read_b128 a[176:179], v20 offset:20480
    v_cvt_pk_bf16_f32 v58, v116, v117
    v_mfma_f32_16x16x32_bf16 v[108:111], a[152:155], a[88:91], v[108:111]
    v_exp_f32 v118, v118
    v_mfma_f32_16x16x32_bf16 v[108:111], a[156:159], a[92:95], v[108:111]
    v_mfma_f32_16x16x32_bf16 v[32:35], v[28:31], v[48:51], v[32:35]
    v_exp_f32 v119, v119
    v_mfma_f32_16x16x32_bf16 v[36:39], v[28:31], v[52:55], v[36:39]
    s_waitcnt lgkmcnt(4)
    ds_read_b128 a[180:183], v20 offset:21504
    v_cvt_pk_bf16_f32 v59, v118, v119
    v_mfma_f32_16x16x32_bf16 v[128:131], a[160:163], v[48:51], v[128:131]
    v_exp_f32 v120, v120
    v_mfma_f32_16x16x32_bf16 v[160:163], a[160:163], v[52:55], v[160:163]
    s_waitcnt lgkmcnt(4)
    v_mfma_f32_16x16x32_bf16 v[132:135], a[164:167], v[48:51], v[132:135]
    v_exp_f32 v121, v121
    v_mfma_f32_16x16x32_bf16 v[164:167], a[164:167], v[52:55], v[164:167]
    s_waitcnt lgkmcnt(3)
    ds_read_b128 a[184:187], v20 offset:22528
    v_cvt_pk_bf16_f32 v60, v120, v121
    v_mfma_f32_16x16x32_bf16 v[136:139], a[168:171], v[48:51], v[136:139]
    v_exp_f32 v122, v122
    v_mfma_f32_16x16x32_bf16 v[168:171], a[168:171], v[52:55], v[168:171]
    s_waitcnt lgkmcnt(3)
    v_mfma_f32_16x16x32_bf16 v[140:143], a[172:175], v[48:51], v[140:143]
    v_exp_f32 v123, v123
    v_mfma_f32_16x16x32_bf16 v[172:175], a[172:175], v[52:55], v[172:175]
    s_waitcnt lgkmcnt(2)
    ds_read_b128 a[188:191], v20 offset:23552
    v_cvt_pk_bf16_f32 v61, v122, v123
    v_mfma_f32_16x16x32_bf16 v[144:147], a[176:179], v[48:51], v[144:147]
    v_exp_f32 v124, v124
    v_mfma_f32_16x16x32_bf16 v[176:179], a[176:179], v[52:55], v[176:179]
    s_waitcnt lgkmcnt(2)
    v_mfma_f32_16x16x32_bf16 v[148:151], a[180:183], v[48:51], v[148:151]
    v_exp_f32 v125, v125
    v_mfma_f32_16x16x32_bf16 v[180:183], a[180:183], v[52:55], v[180:183]
    s_waitcnt lgkmcnt(1)
    v_cvt_pk_bf16_f32 v62, v124, v125
    v_xor_b32 v19, 98304, v19
    v_mfma_f32_16x16x32_bf16 v[152:155], a[184:187], v[48:51], v[152:155]
    v_exp_f32 v126, v126
    v_mfma_f32_16x16x32_bf16 v[184:187], a[184:187], v[52:55], v[184:187]
    s_waitcnt lgkmcnt(0)
    v_xor_b32 v20, 98304, v20
    v_mfma_f32_16x16x32_bf16 v[156:159], a[188:191], v[48:51], v[156:159]
    v_exp_f32 v127, v127
    v_mfma_f32_16x16x32_bf16 v[188:191], a[188:191], v[52:55], v[188:191]
    v_cvt_pk_bf16_f32 v63, v126, v127
    v_mfma_f32_16x16x32_bf16 v[112:115], a[128:131], a[96:99], v[72:75]
    v_exp_f32 v96, v96
    v_mfma_f32_16x16x32_bf16 v[112:115], a[132:135], a[100:103], v[112:115]
    v_mfma_f32_16x16x32_bf16 v[112:115], a[136:139], a[104:107], v[112:115]
    v_exp_f32 v97, v97
    v_mfma_f32_16x16x32_bf16 v[112:115], a[140:143], a[108:111], v[112:115]
    v_cvt_pk_bf16_f32 v48, v96, v97
    v_mfma_f32_16x16x32_bf16 v[120:123], a[128:131], a[112:115], v[76:79]
    v_exp_f32 v98, v98
    v_mfma_f32_16x16x32_bf16 v[120:123], a[132:135], a[116:119], v[120:123]
    v_mfma_f32_16x16x32_bf16 v[120:123], a[136:139], a[120:123], v[120:123]
    v_exp_f32 v99, v99
    v_mfma_f32_16x16x32_bf16 v[120:123], a[140:143], a[124:127], v[120:123]
    v_mfma_f32_16x16x32_bf16 v[116:119], a[144:147], a[96:99], v[72:75]
    v_exp_f32 v100, v100
    v_mfma_f32_16x16x32_bf16 v[116:119], a[148:151], a[100:103], v[116:119]
    ds_read_b128 a[128:131], v18 offset:16384
    v_cvt_pk_bf16_f32 v49, v98, v99
    v_mfma_f32_16x16x32_bf16 v[116:119], a[152:155], a[104:107], v[116:119]
    s_add_u32 s19, s82, 32768
    v_exp_f32 v101, v101
    v_mfma_f32_16x16x32_bf16 v[116:119], a[156:159], a[108:111], v[116:119]
    s_sub_u32 s82, s12, s13
    ds_read_b128 a[132:135], v18 offset:17408
    v_cvt_pk_bf16_f32 v50, v100, v101
    v_mfma_f32_16x16x32_bf16 v[124:127], a[144:147], a[112:115], v[76:79]
    s_sub_u32 s82, s82, 1
    v_exp_f32 v102, v102
    v_mfma_f32_16x16x32_bf16 v[124:127], a[148:151], a[116:119], v[124:127]
    s_cmp_gt_u32 s12, s13
    s_cselect_b32 s82, s82, s12
    s_lshl_b32 s82, s82, 16
    ds_read_b128 a[136:139], v18 offset:18432
    v_mfma_f32_16x16x32_bf16 v[124:127], a[152:155], a[120:123], v[124:127]
    s_add_u32 s82, s82, s81
    v_exp_f32 v103, v103
    v_mfma_f32_16x16x32_bf16 v[124:127], a[156:159], a[124:127], v[124:127]
    s_cmp_ge_u32 s12, 17
    s_cselect_b32 s82, 2147471360, s82
    ds_read_b128 a[140:143], v18 offset:19456
    v_cvt_pk_bf16_f32 v51, v102, v103
    v_mfma_f32_16x16x32_bf16 v[40:43], v[28:31], v[56:59], v[40:43]
    s_add_u32 s12, s12, 1
    v_exp_f32 v104, v104
    v_mfma_f32_16x16x32_bf16 v[44:47], v[28:31], v[60:63], v[44:47]
    ds_read_b128 a[144:147], v18 offset:20480
    v_mfma_f32_16x16x32_bf16 v[192:195], a[160:163], v[56:59], v[192:195]
    v_exp_f32 v105, v105
    v_mfma_f32_16x16x32_bf16 v[224:227], a[160:163], v[60:63], v[224:227]
    ds_read_b128 a[148:151], v18 offset:21504
    v_cvt_pk_bf16_f32 v52, v104, v105
    v_mfma_f32_16x16x32_bf16 v[196:199], a[164:167], v[56:59], v[196:199]
    v_exp_f32 v106, v106
    v_mfma_f32_16x16x32_bf16 v[228:231], a[164:167], v[60:63], v[228:231]
    ds_read_b128 a[152:155], v18 offset:22528
    v_mfma_f32_16x16x32_bf16 v[200:203], a[168:171], v[56:59], v[200:203]
    v_exp_f32 v107, v107
    v_mfma_f32_16x16x32_bf16 v[232:235], a[168:171], v[60:63], v[232:235]
    ds_read_b128 a[156:159], v18 offset:23552
    v_cvt_pk_bf16_f32 v53, v106, v107
    v_mfma_f32_16x16x32_bf16 v[204:207], a[172:175], v[56:59], v[204:207]
    v_exp_f32 v108, v108
    v_mfma_f32_16x16x32_bf16 v[236:239], a[172:175], v[60:63], v[236:239]
    v_mfma_f32_16x16x32_bf16 v[208:211], a[176:179], v[56:59], v[208:211]
    v_exp_f32 v109, v109
    v_mfma_f32_16x16x32_bf16 v[240:243], a[176:179], v[60:63], v[240:243]
    v_cvt_pk_bf16_f32 v54, v108, v109
    v_xor_b32 v18, 196608, v18
    v_mfma_f32_16x16x32_bf16 v[212:215], a[180:183], v[56:59], v[212:215]
    v_exp_f32 v110, v110
    v_mfma_f32_16x16x32_bf16 v[244:247], a[180:183], v[60:63], v[244:247]
    v_mfma_f32_16x16x32_bf16 v[216:219], a[184:187], v[56:59], v[216:219]
    v_exp_f32 v111, v111
    v_mfma_f32_16x16x32_bf16 v[248:251], a[184:187], v[60:63], v[248:251]
    v_cvt_pk_bf16_f32 v55, v110, v111
    v_mfma_f32_16x16x32_bf16 v[220:223], a[188:191], v[56:59], v[220:223]
    v_mfma_f32_16x16x32_bf16 v[252:255], a[188:191], v[60:63], v[252:255]
    s_waitcnt vmcnt(0) lgkmcnt(0)
    s_barrier
    v_mfma_f32_16x16x32_bf16 v[96:99], a[128:131], a[64:67], v[64:67]
    s_add_u32 m0, s15, 0
    ds_read_b128 a[160:163], v19 offset:0
    v_mfma_f32_16x16x32_bf16 v[96:99], a[132:135], a[68:71], v[96:99]
    ds_read_b128 a[164:167], v19 offset:1024
    v_mfma_f32_16x16x32_bf16 v[96:99], a[136:139], a[72:75], v[96:99]
    v_exp_f32 v112, v112
    v_mfma_f32_16x16x32_bf16 v[96:99], a[140:143], a[76:79], v[96:99]
    buffer_load_dwordx4 v1, s[8:11], s82 offen offset:0 lds
    v_mfma_f32_16x16x32_bf16 v[104:107], a[128:131], a[80:83], v[68:71]
    v_exp_f32 v113, v113
    v_mfma_f32_16x16x32_bf16 v[104:107], a[132:135], a[84:87], v[104:107]
    ds_read_b128 a[168:171], v19 offset:2048
    v_cvt_pk_bf16_f32 v56, v112, v113
    v_mfma_f32_16x16x32_bf16 v[104:107], a[136:139], a[88:91], v[104:107]
    v_exp_f32 v114, v114
    v_mfma_f32_16x16x32_bf16 v[104:107], a[140:143], a[92:95], v[104:107]
    buffer_load_dwordx4 v1, s[8:11], s82 offen offset:1024 lds
    v_mfma_f32_16x16x32_bf16 v[100:103], a[144:147], a[64:67], v[64:67]
    v_exp_f32 v115, v115
    v_mfma_f32_16x16x32_bf16 v[100:103], a[148:151], a[68:71], v[100:103]
    ds_read_b128 a[172:175], v19 offset:3072
    v_cvt_pk_bf16_f32 v57, v114, v115
    v_mfma_f32_16x16x32_bf16 v[100:103], a[152:155], a[72:75], v[100:103]
    v_exp_f32 v116, v116
    v_mfma_f32_16x16x32_bf16 v[100:103], a[156:159], a[76:79], v[100:103]
    buffer_load_dwordx4 v1, s[8:11], s82 offen offset:2048 lds
    v_mfma_f32_16x16x32_bf16 v[108:111], a[144:147], a[80:83], v[68:71]
    v_exp_f32 v117, v117
    v_mfma_f32_16x16x32_bf16 v[108:111], a[148:151], a[84:87], v[108:111]
    ds_read_b128 a[176:179], v20 offset:4096
    v_cvt_pk_bf16_f32 v58, v116, v117
    v_mfma_f32_16x16x32_bf16 v[108:111], a[152:155], a[88:91], v[108:111]
    v_exp_f32 v118, v118
    v_mfma_f32_16x16x32_bf16 v[108:111], a[156:159], a[92:95], v[108:111]
    buffer_load_dwordx4 v1, s[8:11], s82 offen offset:3072 lds
    v_mfma_f32_16x16x32_bf16 v[32:35], v[28:31], v[48:51], v[32:35]
    s_add_u32 m0, s15, 4096
    v_exp_f32 v119, v119
    v_mfma_f32_16x16x32_bf16 v[36:39], v[28:31], v[52:55], v[36:39]
    s_waitcnt lgkmcnt(4)
    ds_read_b128 a[180:183], v20 offset:5120
    v_cvt_pk_bf16_f32 v59, v118, v119
    v_mfma_f32_16x16x32_bf16 v[128:131], a[160:163], v[48:51], v[128:131]
    v_exp_f32 v120, v120
    v_mfma_f32_16x16x32_bf16 v[160:163], a[160:163], v[52:55], v[160:163]
    s_waitcnt lgkmcnt(4)
    v_mfma_f32_16x16x32_bf16 v[132:135], a[164:167], v[48:51], v[132:135]
    v_exp_f32 v121, v121
    v_mfma_f32_16x16x32_bf16 v[164:167], a[164:167], v[52:55], v[164:167]
    s_waitcnt lgkmcnt(3)
    ds_read_b128 a[184:187], v20 offset:6144
    v_cvt_pk_bf16_f32 v60, v120, v121
    v_mfma_f32_16x16x32_bf16 v[136:139], a[168:171], v[48:51], v[136:139]
    s_waitcnt lgkmcnt(3)
    v_exp_f32 v122, v122
    v_mfma_f32_16x16x32_bf16 v[168:171], a[168:171], v[52:55], v[168:171]
    buffer_load_dwordx4 v15, s[8:11], s82 offen offset:0 lds
    v_mfma_f32_16x16x32_bf16 v[140:143], a[172:175], v[48:51], v[140:143]
    v_exp_f32 v123, v123
    v_mfma_f32_16x16x32_bf16 v[172:175], a[172:175], v[52:55], v[172:175]
    s_waitcnt lgkmcnt(2)
    ds_read_b128 a[188:191], v20 offset:7168
    v_cvt_pk_bf16_f32 v61, v122, v123
    v_mfma_f32_16x16x32_bf16 v[144:147], a[176:179], v[48:51], v[144:147]
    s_waitcnt lgkmcnt(2)
    v_exp_f32 v124, v124
    v_mfma_f32_16x16x32_bf16 v[176:179], a[176:179], v[52:55], v[176:179]
    buffer_load_dwordx4 v15, s[8:11], s82 offen offset:1024 lds
    v_mfma_f32_16x16x32_bf16 v[148:151], a[180:183], v[48:51], v[148:151]
    v_exp_f32 v125, v125
    v_mfma_f32_16x16x32_bf16 v[180:183], a[180:183], v[52:55], v[180:183]
    s_waitcnt lgkmcnt(1)
    v_cvt_pk_bf16_f32 v62, v124, v125
    v_mfma_f32_16x16x32_bf16 v[152:155], a[184:187], v[48:51], v[152:155]
    s_waitcnt lgkmcnt(0)
    v_exp_f32 v126, v126
    v_mfma_f32_16x16x32_bf16 v[184:187], a[184:187], v[52:55], v[184:187]
    buffer_load_dwordx4 v15, s[8:11], s82 offen offset:2048 lds
    v_mfma_f32_16x16x32_bf16 v[156:159], a[188:191], v[48:51], v[156:159]
    v_exp_f32 v127, v127
    v_mfma_f32_16x16x32_bf16 v[188:191], a[188:191], v[52:55], v[188:191]
    v_cvt_pk_bf16_f32 v63, v126, v127
    v_mfma_f32_16x16x32_bf16 v[112:115], a[128:131], a[96:99], v[72:75]
    v_mfma_f32_16x16x32_bf16 v[112:115], a[132:135], a[100:103], v[112:115]
    v_mfma_f32_16x16x32_bf16 v[112:115], a[136:139], a[104:107], v[112:115]
    v_exp_f32 v96, v96
    v_mfma_f32_16x16x32_bf16 v[112:115], a[140:143], a[108:111], v[112:115]
    buffer_load_dwordx4 v15, s[8:11], s82 offen offset:3072 lds
    v_mfma_f32_16x16x32_bf16 v[120:123], a[128:131], a[112:115], v[76:79]
    s_xor_b32 s15, s15, 196608
    v_exp_f32 v97, v97
    v_mfma_f32_16x16x32_bf16 v[120:123], a[132:135], a[116:119], v[120:123]
    s_add_u32 m0, s16, 0
    ds_read_b128 a[128:131], v18 offset:0
    v_cvt_pk_bf16_f32 v48, v96, v97
    v_mfma_f32_16x16x32_bf16 v[120:123], a[136:139], a[120:123], v[120:123]
    v_exp_f32 v98, v98
    v_mfma_f32_16x16x32_bf16 v[120:123], a[140:143], a[124:127], v[120:123]
    buffer_load_dwordx4 v1, s[8:11], s19 offen offset:0 lds
    v_mfma_f32_16x16x32_bf16 v[116:119], a[144:147], a[96:99], v[72:75]
    v_exp_f32 v99, v99
    v_mfma_f32_16x16x32_bf16 v[116:119], a[148:151], a[100:103], v[116:119]
    ds_read_b128 a[132:135], v18 offset:1024
    v_cvt_pk_bf16_f32 v49, v98, v99
    v_mfma_f32_16x16x32_bf16 v[116:119], a[152:155], a[104:107], v[116:119]
    v_exp_f32 v100, v100
    v_mfma_f32_16x16x32_bf16 v[116:119], a[156:159], a[108:111], v[116:119]
    buffer_load_dwordx4 v1, s[8:11], s19 offen offset:1024 lds
    v_mfma_f32_16x16x32_bf16 v[124:127], a[144:147], a[112:115], v[76:79]
    v_exp_f32 v101, v101
    v_mfma_f32_16x16x32_bf16 v[124:127], a[148:151], a[116:119], v[124:127]
    ds_read_b128 a[136:139], v18 offset:2048
    v_cvt_pk_bf16_f32 v50, v100, v101
    v_mfma_f32_16x16x32_bf16 v[124:127], a[152:155], a[120:123], v[124:127]
    v_exp_f32 v102, v102
    v_mfma_f32_16x16x32_bf16 v[124:127], a[156:159], a[124:127], v[124:127]
    buffer_load_dwordx4 v1, s[8:11], s19 offen offset:2048 lds
    v_mfma_f32_16x16x32_bf16 v[40:43], v[28:31], v[56:59], v[40:43]
    v_exp_f32 v103, v103
    v_mfma_f32_16x16x32_bf16 v[44:47], v[28:31], v[60:63], v[44:47]
    ds_read_b128 a[140:143], v18 offset:3072
    v_cvt_pk_bf16_f32 v51, v102, v103
    v_mfma_f32_16x16x32_bf16 v[192:195], a[160:163], v[56:59], v[192:195]
    v_exp_f32 v104, v104
    v_mfma_f32_16x16x32_bf16 v[224:227], a[160:163], v[60:63], v[224:227]
    v_mfma_f32_16x16x32_bf16 v[196:199], a[164:167], v[56:59], v[196:199]
    v_exp_f32 v105, v105
    v_mfma_f32_16x16x32_bf16 v[228:231], a[164:167], v[60:63], v[228:231]
    ds_read_b128 a[144:147], v18 offset:4096
    v_cvt_pk_bf16_f32 v52, v104, v105
    v_mfma_f32_16x16x32_bf16 v[200:203], a[168:171], v[56:59], v[200:203]
    v_exp_f32 v106, v106
    v_mfma_f32_16x16x32_bf16 v[232:235], a[168:171], v[60:63], v[232:235]
    buffer_load_dwordx4 v1, s[8:11], s19 offen offset:3072 lds
    v_mfma_f32_16x16x32_bf16 v[204:207], a[172:175], v[56:59], v[204:207]
    s_add_u32 m0, s16, 4096
    v_exp_f32 v107, v107
    v_mfma_f32_16x16x32_bf16 v[236:239], a[172:175], v[60:63], v[236:239]
    ds_read_b128 a[148:151], v18 offset:5120
    v_cvt_pk_bf16_f32 v53, v106, v107
    v_mfma_f32_16x16x32_bf16 v[208:211], a[176:179], v[56:59], v[208:211]
    s_sub_u32 s14, s14, 1
    v_exp_f32 v108, v108
    v_mfma_f32_16x16x32_bf16 v[240:243], a[176:179], v[60:63], v[240:243]
    buffer_load_dwordx4 v15, s[8:11], s19 offen offset:0 lds
    v_mfma_f32_16x16x32_bf16 v[212:215], a[180:183], v[56:59], v[212:215]
    v_exp_f32 v109, v109
    v_mfma_f32_16x16x32_bf16 v[244:247], a[180:183], v[60:63], v[244:247]
    ds_read_b128 a[152:155], v18 offset:6144
    v_cvt_pk_bf16_f32 v54, v108, v109
    v_mfma_f32_16x16x32_bf16 v[216:219], a[184:187], v[56:59], v[216:219]
    v_exp_f32 v110, v110
    v_mfma_f32_16x16x32_bf16 v[248:251], a[184:187], v[60:63], v[248:251]
    buffer_load_dwordx4 v15, s[8:11], s19 offen offset:1024 lds
    v_mfma_f32_16x16x32_bf16 v[220:223], a[188:191], v[56:59], v[220:223]
    v_exp_f32 v111, v111
    v_mfma_f32_16x16x32_bf16 v[252:255], a[188:191], v[60:63], v[252:255]
    ds_read_b128 a[156:159], v18 offset:7168
    v_cvt_pk_bf16_f32 v55, v110, v111
    s_cmp_lg_u32 s14, 0
    s_cbranch_scc1 L_t1_loop
L_t1_diag:
    s_waitcnt lgkmcnt(7)
    v_mfma_f32_16x16x32_bf16 v[96:99], a[128:131], a[64:67], v[80:83]
    s_waitcnt lgkmcnt(6)
    ds_read_b128 a[160:163], v19 offset:16384
    v_mfma_f32_16x16x32_bf16 v[96:99], a[132:135], a[68:71], v[96:99]
    s_waitcnt lgkmcnt(6)
    ds_read_b128 a[164:167], v19 offset:17408
    v_mfma_f32_16x16x32_bf16 v[96:99], a[136:139], a[72:75], v[96:99]
    s_waitcnt lgkmcnt(6)
    v_exp_f32 v112, v112
    v_mfma_f32_16x16x32_bf16 v[96:99], a[140:143], a[76:79], v[96:99]
    buffer_load_dwordx4 v15, s[8:11], s19 offen offset:2048 lds
    v_mfma_f32_16x16x32_bf16 v[104:107], a[128:131], a[80:83], v[88:91]
    v_exp_f32 v113, v113
    v_mfma_f32_16x16x32_bf16 v[104:107], a[132:135], a[84:87], v[104:107]
    ds_read_b128 a[168:171], v19 offset:18432
    v_cvt_pk_bf16_f32 v56, v112, v113
    v_mfma_f32_16x16x32_bf16 v[104:107], a[136:139], a[88:91], v[104:107]
    s_waitcnt lgkmcnt(6)
    v_exp_f32 v114, v114
    v_mfma_f32_16x16x32_bf16 v[104:107], a[140:143], a[92:95], v[104:107]
    buffer_load_dwordx4 v15, s[8:11], s19 offen offset:3072 lds
    v_mfma_f32_16x16x32_bf16 v[100:103], a[144:147], a[64:67], v[84:87]
    s_waitcnt lgkmcnt(5)
    s_xor_b32 s16, s16, 98304
    v_exp_f32 v115, v115
    v_mfma_f32_16x16x32_bf16 v[100:103], a[148:151], a[68:71], v[100:103]
    s_waitcnt lgkmcnt(4)
    ds_read_b128 a[172:175], v19 offset:19456
    v_cvt_pk_bf16_f32 v57, v114, v115
    v_mfma_f32_16x16x32_bf16 v[100:103], a[152:155], a[72:75], v[100:103]
    s_waitcnt lgkmcnt(4)
    v_exp_f32 v116, v116
    v_mfma_f32_16x16x32_bf16 v[100:103], a[156:159], a[76:79], v[100:103]
    v_mfma_f32_16x16x32_bf16 v[108:111], a[144:147], a[80:83], v[92:95]
    v_exp_f32 v117, v117
    v_mfma_f32_16x16x32_bf16 v[108:111], a[148:151], a[84:87], v[108:111]
    ds_read_b128 a[176:179], v20 offset:20480
    v_cvt_pk_bf16_f32 v58, v116, v117
    v_mfma_f32_16x16x32_bf16 v[108:111], a[152:155], a[88:91], v[108:111]
    v_exp_f32 v118, v118
    v_mfma_f32_16x16x32_bf16 v[108:111], a[156:159], a[92:95], v[108:111]
    v_mfma_f32_16x16x32_bf16 v[32:35], v[28:31], v[48:51], v[32:35]
    v_exp_f32 v119, v119
    v_mfma_f32_16x16x32_bf16 v[36:39], v[28:31], v[52:55], v[36:39]
    s_waitcnt lgkmcnt(4)
    ds_read_b128 a[180:183], v20 offset:21504
    v_cvt_pk_bf16_f32 v59, v118, v119
    v_mfma_f32_16x16x32_bf16 v[128:131], a[160:163], v[48:51], v[128:131]
    v_exp_f32 v120, v120
    v_mfma_f32_16x16x32_bf16 v[160:163], a[160:163], v[52:55], v[160:163]
    s_waitcnt lgkmcnt(4)
    v_add_f32 v80, 0, v22
    v_min_f32 v80, v80, v72
    v_mfma_f32_16x16x32_bf16 v[132:135], a[164:167], v[48:51], v[132:135]
    v_exp_f32 v121, v121
    v_mfma_f32_16x16x32_bf16 v[164:167], a[164:167], v[52:55], v[164:167]
    s_waitcnt lgkmcnt(3)
    ds_read_b128 a[184:187], v20 offset:22528
    v_cvt_pk_bf16_f32 v60, v120, v121
    v_mfma_f32_16x16x32_bf16 v[136:139], a[168:171], v[48:51], v[136:139]
    v_exp_f32 v122, v122
    v_mfma_f32_16x16x32_bf16 v[168:171], a[168:171], v[52:55], v[168:171]
    s_waitcnt lgkmcnt(3)
    v_add_f32 v81, 0xf1800000, v22
    v_min_f32 v81, v81, v73
    v_mfma_f32_16x16x32_bf16 v[140:143], a[172:175], v[48:51], v[140:143]
    v_exp_f32 v123, v123
    v_mfma_f32_16x16x32_bf16 v[172:175], a[172:175], v[52:55], v[172:175]
    s_waitcnt lgkmcnt(2)
    ds_read_b128 a[188:191], v20 offset:23552
    v_cvt_pk_bf16_f32 v61, v122, v123
    v_mfma_f32_16x16x32_bf16 v[144:147], a[176:179], v[48:51], v[144:147]
    v_exp_f32 v124, v124
    v_mfma_f32_16x16x32_bf16 v[176:179], a[176:179], v[52:55], v[176:179]
    s_waitcnt lgkmcnt(2)
    v_add_f32 v82, 0xf2000000, v22
    v_min_f32 v82, v82, v74
    v_mfma_f32_16x16x32_bf16 v[148:151], a[180:183], v[48:51], v[148:151]
    v_exp_f32 v125, v125
    v_mfma_f32_16x16x32_bf16 v[180:183], a[180:183], v[52:55], v[180:183]
    s_waitcnt lgkmcnt(1)
    v_cvt_pk_bf16_f32 v62, v124, v125
    v_xor_b32 v19, 98304, v19
    v_mfma_f32_16x16x32_bf16 v[152:155], a[184:187], v[48:51], v[152:155]
    v_exp_f32 v126, v126
    v_mfma_f32_16x16x32_bf16 v[184:187], a[184:187], v[52:55], v[184:187]
    s_waitcnt lgkmcnt(0)
    v_xor_b32 v20, 98304, v20
    v_add_f32 v83, 0xf2400000, v22
    v_mfma_f32_16x16x32_bf16 v[156:159], a[188:191], v[48:51], v[156:159]
    v_exp_f32 v127, v127
    v_mfma_f32_16x16x32_bf16 v[188:191], a[188:191], v[52:55], v[188:191]
    v_cvt_pk_bf16_f32 v63, v126, v127
    v_min_f32 v83, v83, v75
    v_add_f32 v84, 0xf3800000, v22
    v_min_f32 v84, v84, v72
    v_mfma_f32_16x16x32_bf16 v[112:115], a[128:131], a[96:99], v[72:75]
    v_exp_f32 v96, v96
    v_mfma_f32_16x16x32_bf16 v[112:115], a[132:135], a[100:103], v[112:115]
    v_mfma_f32_16x16x32_bf16 v[112:115], a[136:139], a[104:107], v[112:115]
    v_exp_f32 v97, v97
    v_mfma_f32_16x16x32_bf16 v[112:115], a[140:143], a[108:111], v[112:115]
    v_cvt_pk_bf16_f32 v48, v96, v97
    v_add_f32 v85, 0xf3880000, v22
    v_mfma_f32_16x16x32_bf16 v[120:123], a[128:131], a[112:115], v[76:79]
    v_exp_f32 v98, v98
    v_mfma_f32_16x16x32_bf16 v[120:123], a[132:135], a[116:119], v[120:123]
    v_min_f32 v85, v85, v73
    v_add_f32 v86, 0xf3900000, v22
    v_mfma_f32_16x16x32_bf16 v[120:123], a[136:139], a[120:123], v[120:123]
    v_exp_f32 v99, v99
    v_mfma_f32_16x16x32_bf16 v[120:123], a[140:143], a[124:127], v[120:123]
    v_min_f32 v86, v86, v74
    v_add_f32 v87, 0xf3980000, v22
    v_mfma_f32_16x16x32_bf16 v[116:119], a[144:147], a[96:99], v[72:75]
    v_exp_f32 v100, v100
    v_mfma_f32_16x16x32_bf16 v[116:119], a[148:151], a[100:103], v[116:119]
    ds_read_b128 a[128:131], v18 offset:16384
    v_cvt_pk_bf16_f32 v49, v98, v99
    v_mfma_f32_16x16x32_bf16 v[116:119], a[152:155], a[104:107], v[116:119]
    s_add_u32 s19, s82, 32768
    v_exp_f32 v101, v101
    v_mfma_f32_16x16x32_bf16 v[116:119], a[156:159], a[108:111], v[116:119]
    s_sub_u32 s82, s12, s13
    ds_read_b128 a[132:135], v18 offset:17408
    v_cvt_pk_bf16_f32 v50, v100, v101
    v_mfma_f32_16x16x32_bf16 v[124:127], a[144:147], a[112:115], v[76:79]
    s_sub_u32 s82, s82, 1
    v_exp_f32 v102, v102
    v_mfma_f32_16x16x32_bf16 v[124:127], a[148:151], a[116:119], v[124:127]
    s_cmp_gt_u32 s12, s13
    s_cselect_b32 s82, s82, s12
    s_lshl_b32 s82, s82, 16
    ds_read_b128 a[136:139], v18 offset:18432
    v_mfma_f32_16x16x32_bf16 v[124:127], a[152:155], a[120:123], v[124:127]
    s_add_u32 s82, s82, s81
    v_exp_f32 v103, v103
    v_mfma_f32_16x16x32_bf16 v[124:127], a[156:159], a[124:127], v[124:127]
    s_cmp_ge_u32 s12, 17
    s_cselect_b32 s82, 2147471360, s82
    ds_read_b128 a[140:143], v18 offset:19456
    v_cvt_pk_bf16_f32 v51, v102, v103
    v_mfma_f32_16x16x32_bf16 v[40:43], v[28:31], v[56:59], v[40:43]
    s_add_u32 s12, s12, 1
    v_exp_f32 v104, v104
    v_mfma_f32_16x16x32_bf16 v[44:47], v[28:31], v[60:63], v[44:47]
    ds_read_b128 a[144:147], v18 offset:20480
    v_min_f32 v87, v87, v75
    v_mfma_f32_16x16x32_bf16 v[192:195], a[160:163], v[56:59], v[192:195]
    v_exp_f32 v105, v105
    v_mfma_f32_16x16x32_bf16 v[224:227], a[160:163], v[60:63], v[224:227]
    ds_read_b128 a[148:151], v18 offset:21504
    v_cvt_pk_bf16_f32 v52, v104, v105
    v_mfma_f32_16x16x32_bf16 v[196:199], a[164:167], v[56:59], v[196:199]
    v_exp_f32 v106, v106
    v_mfma_f32_16x16x32_bf16 v[228:231], a[164:167], v[60:63], v[228:231]
    ds_read_b128 a[152:155], v18 offset:22528
    v_add_f32 v88, 0x73800000, v22
    v_mfma_f32_16x16x32_bf16 v[200:203], a[168:171], v[56:59], v[200:203]
    v_exp_f32 v107, v107
    v_mfma_f32_16x16x32_bf16 v[232:235], a[168:171], v[60:63], v[232:235]
    ds_read_b128 a[156:159], v18 offset:23552
    v_cvt_pk_bf16_f32 v53, v106, v107
    v_mfma_f32_16x16x32_bf16 v[204:207], a[172:175], v[56:59], v[204:207]
    v_exp_f32 v108, v108
    v_mfma_f32_16x16x32_bf16 v[236:239], a[172:175], v[60:63], v[236:239]
    v_min_f32 v88, v88, v76
    v_add_f32 v89, 0x73700000, v22
    v_mfma_f32_16x16x32_bf16 v[208:211], a[176:179], v[56:59], v[208:211]
    v_exp_f32 v109, v109
    v_mfma_f32_16x16x32_bf16 v[240:243], a[176:179], v[60:63], v[240:243]
    v_cvt_pk_bf16_f32 v54, v108, v109
    v_xor_b32 v18, 196608, v18
    v_mfma_f32_16x16x32_bf16 v[212:215], a[180:183], v[56:59], v[212:215]
    v_exp_f32 v110, v110
    v_mfma_f32_16x16x32_bf16 v[244:247], a[180:183], v[60:63], v[244:247]
    v_min_f32 v89, v89, v77
    v_add_f32 v90, 0x73600000, v22
    v_mfma_f32_16x16x32_bf16 v[216:219], a[184:187], v[56:59], v[216:219]
    v_exp_f32 v111, v111
    v_mfma_f32_16x16x32_bf16 v[248:251], a[184:187], v[60:63], v[248:251]
    v_cvt_pk_bf16_f32 v55, v110, v111
    v_min_f32 v90, v90, v78
    v_mfma_f32_16x16x32_bf16 v[220:223], a[188:191], v[56:59], v[220:223]
    v_add_f32 v91, 0x73500000, v22
    v_min_f32 v91, v91, v79
    v_mfma_f32_16x16x32_bf16 v[252:255], a[188:191], v[60:63], v[252:255]
    v_add_f32 v92, 0, v22
    v_min_f32 v92, v92, v76
    v_add_f32 v93, 0xf1800000, v22
    v_min_f32 v93, v93, v77
    v_add_f32 v94, 0xf2000000, v22
    v_min_f32 v94, v94, v78
    v_add_f32 v95, 0xf2400000, v22
    v_min_f32 v95, v95, v79
    s_waitcnt vmcnt(0) lgkmcnt(0)
    s_barrier
L_t1_diagC:
    v_mfma_f32_16x16x32_bf16 v[96:99], a[128:131], a[96:99], v[80:83]
    s_xor_b32 s100, s16, 8192
    s_xor_b32 s101, s16, 98304
    ds_read_b128 a[176:179], v20 offset:4096
    v_lshrrev_b32 v13, 1, v1
    v_add_u32 v12, s100, v13
    s_add_u32 m0, s15, 0
    v_mfma_f32_16x16x32_bf16 v[96:99], a[132:135], a[100:103], v[96:99]
    v_exp_f32 v112, v112
    v_add_u32 v9, s101, v1
    v_mfma_f32_16x16x32_bf16 v[96:99], a[136:139], a[104:107], v[96:99]
    ds_read_b128 a[180:183], v20 offset:5120
    v_xor_b32 v8, 8192, v16
    v_xor_b32 v10, 8192, v9
    v_mfma_f32_16x16x32_bf16 v[96:99], a[140:143], a[108:111], v[96:99]
    v_exp_f32 v113, v113
    buffer_load_dwordx4 v1, s[8:11], s82 offen offset:0 lds
    v_mfma_f32_16x16x32_bf16 v[100:103], a[144:147], a[96:99], v[84:87]
    ds_read_b128 a[184:187], v20 offset:6144
    v_cvt_pk_bf16_f32 v56, v112, v113
    v_mfma_f32_16x16x32_bf16 v[100:103], a[148:151], a[100:103], v[100:103]
    v_exp_f32 v114, v114
    v_mfma_f32_16x16x32_bf16 v[100:103], a[152:155], a[104:107], v[100:103]
    ds_read_b128 a[188:191], v20 offset:7168
    v_mfma_f32_16x16x32_bf16 v[100:103], a[156:159], a[108:111], v[100:103]
    v_exp_f32 v115, v115
    v_mfma_f32_16x16x32_bf16 v[104:107], a[128:131], a[112:115], v[88:91]
    ds_read_b128 a[160:163], v19 offset:0
    v_cvt_pk_bf16_f32 v57, v114, v115
    buffer_load_dwordx4 v1, s[8:11], s82 offen offset:1024 lds
    v_mfma_f32_16x16x32_bf16 v[104:107], a[132:135], a[116:119], v[104:107]
    v_exp_f32 v116, v116
    v_mfma_f32_16x16x32_bf16 v[104:107], a[136:139], a[120:123], v[104:107]
    ds_read_b128 a[164:167], v19 offset:1024
    v_mfma_f32_16x16x32_bf16 v[104:107], a[140:143], a[124:127], v[104:107]
    v_exp_f32 v117, v117
    v_mfma_f32_16x16x32_bf16 v[108:111], a[144:147], a[112:115], v[92:95]
    ds_read_b128 a[168:171], v19 offset:2048
    v_cvt_pk_bf16_f32 v58, v116, v117
    v_mfma_f32_16x16x32_bf16 v[108:111], a[148:151], a[116:119], v[108:111]
    v_exp_f32 v118, v118
    buffer_load_dwordx4 v1, s[8:11], s82 offen offset:2048 lds
    v_mfma_f32_16x16x32_bf16 v[108:111], a[152:155], a[120:123], v[108:111]
    ds_read_b128 a[172:175], v19 offset:3072
    v_mfma_f32_16x16x32_bf16 v[108:111], a[156:159], a[124:127], v[108:111]
    v_exp_f32 v119, v119
    v_mfma_f32_16x16x32_bf16 v[32:35], v[28:31], v[48:51], v[32:35]
    v_exp_f32 v120, v120
    v_cvt_pk_bf16_f32 v59, v118, v119
    v_mfma_f32_16x16x32_bf16 v[36:39], v[28:31], v[52:55], v[36:39]
    s_waitcnt lgkmcnt(7)
    v_exp_f32 v121, v121
    v_mfma_f32_16x16x32_bf16 v[144:147], a[176:179], v[48:51], v[144:147]
    v_exp_f32 v122, v122
    v_cvt_pk_bf16_f32 v60, v120, v121
    buffer_load_dwordx4 v1, s[8:11], s82 offen offset:3072 lds
    v_mfma_f32_16x16x32_bf16 v[176:179], a[176:179], v[52:55], v[176:179]
    s_waitcnt lgkmcnt(6)
    v_exp_f32 v123, v123
    s_add_u32 m0, s15, 4096
    v_mfma_f32_16x16x32_bf16 v[148:151], a[180:183], v[48:51], v[148:151]
    v_exp_f32 v124, v124
    v_cvt_pk_bf16_f32 v61, v122, v123
    v_mfma_f32_16x16x32_bf16 v[180:183], a[180:183], v[52:55], v[180:183]
    s_waitcnt lgkmcnt(5)
    v_exp_f32 v125, v125
    v_mfma_f32_16x16x32_bf16 v[152:155], a[184:187], v[48:51], v[152:155]
    v_exp_f32 v126, v126
    v_mfma_f32_16x16x32_bf16 v[184:187], a[184:187], v[52:55], v[184:187]
    s_waitcnt lgkmcnt(4)
    v_exp_f32 v127, v127
    buffer_load_dwordx4 v15, s[8:11], s82 offen offset:0 lds
    v_mfma_f32_16x16x32_bf16 v[156:159], a[188:191], v[48:51], v[156:159]
    ds_write_b128 v16, v[144:147] offset:32768
    v_cvt_pk_bf16_f32 v62, v124, v125
    v_mfma_f32_16x16x32_bf16 v[188:191], a[188:191], v[52:55], v[188:191]
    s_waitcnt lgkmcnt(4)
    v_exp_f32 v96, v96
    v_mfma_f32_16x16x32_bf16 v[128:131], a[160:163], v[48:51], v[128:131]
    v_exp_f32 v97, v97
    v_mov_b32 v33, v36
    v_mfma_f32_16x16x32_bf16 v[160:163], a[160:163], v[52:55], v[160:163]
    s_waitcnt lgkmcnt(3)
    ds_write_b128 v16, v[176:179] offset:33792
    ds_write_b64 v12, v[32:33]
    v_cvt_pk_bf16_f32 v63, v126, v127
    v_mfma_f32_16x16x32_bf16 v[132:135], a[164:167], v[48:51], v[132:135]
    v_exp_f32 v98, v98
    v_xor_b32 v12, 8192, v12
    v_mfma_f32_16x16x32_bf16 v[164:167], a[164:167], v[52:55], v[164:167]
    s_waitcnt lgkmcnt(4)
    v_exp_f32 v99, v99
    buffer_load_dwordx4 v15, s[8:11], s82 offen offset:1024 lds
    v_mfma_f32_16x16x32_bf16 v[136:139], a[168:171], v[48:51], v[136:139]
    ds_write_b128 v16, v[148:151] offset:34816
    v_mfma_f32_16x16x32_bf16 v[168:171], a[168:171], v[52:55], v[168:171]
    s_waitcnt lgkmcnt(4)
    v_exp_f32 v100, v100
    v_mfma_f32_16x16x32_bf16 v[140:143], a[172:175], v[48:51], v[140:143]
    v_exp_f32 v101, v101
    v_mfma_f32_16x16x32_bf16 v[172:175], a[172:175], v[52:55], v[172:175]
    ds_write_b128 v16, v[180:183] offset:35840
    v_mfma_f32_16x16x32_bf16 v[40:43], v[28:31], v[56:59], v[40:43]
    v_exp_f32 v102, v102
    v_mfma_f32_16x16x32_bf16 v[44:47], v[28:31], v[60:63], v[44:47]
    v_exp_f32 v103, v103
    buffer_load_dwordx4 v15, s[8:11], s82 offen offset:2048 lds
    v_mfma_f32_16x16x32_bf16 v[208:211], a[176:179], v[56:59], v[208:211]
    ds_write_b128 v16, v[152:155] offset:36864
    v_exp_f32 v104, v104
    v_mfma_f32_16x16x32_bf16 v[240:243], a[176:179], v[60:63], v[240:243]
    ds_read_b128 a[176:179], v20 offset:20480
    v_cvt_pk_bf16_f32 v48, v96, v97
    v_mfma_f32_16x16x32_bf16 v[212:215], a[180:183], v[56:59], v[212:215]
    ds_write_b128 v16, v[184:187] offset:37888
    v_cvt_pk_bf16_f32 v49, v98, v99
    v_mfma_f32_16x16x32_bf16 v[244:247], a[180:183], v[60:63], v[244:247]
    ds_read_b128 a[180:183], v20 offset:21504
    v_cvt_pk_bf16_f32 v50, v100, v101
    v_mfma_f32_16x16x32_bf16 v[216:219], a[184:187], v[56:59], v[216:219]
    v_exp_f32 v105, v105
    v_mfma_f32_16x16x32_bf16 v[248:251], a[184:187], v[60:63], v[248:251]
    ds_read_b128 a[184:187], v20 offset:22528
    v_exp_f32 v106, v106
    buffer_load_dwordx4 v15, s[8:11], s82 offen offset:3072 lds
    v_mfma_f32_16x16x32_bf16 v[220:223], a[188:191], v[56:59], v[220:223]
    ds_write_b128 v16, v[156:159] offset:38912
    v_exp_f32 v107, v107
    s_xor_b32 s15, s15, 196608
    v_mfma_f32_16x16x32_bf16 v[252:255], a[188:191], v[60:63], v[252:255]
    ds_read_b128 a[188:191], v20 offset:23552
    v_exp_f32 v108, v108
    v_mfma_f32_16x16x32_bf16 v[192:195], a[160:163], v[56:59], v[192:195]
    ds_write_b128 v16, v[188:191] offset:39936
    v_cvt_pk_bf16_f32 v51, v102, v103
    v_mfma_f32_16x16x32_bf16 v[224:227], a[160:163], v[60:63], v[224:227]
    ds_read_b128 a[160:163], v19 offset:16384
    v_cvt_pk_bf16_f32 v52, v104, v105
    v_mfma_f32_16x16x32_bf16 v[196:199], a[164:167], v[56:59], v[196:199]
    v_exp_f32 v109, v109
    v_mfma_f32_16x16x32_bf16 v[228:231], a[164:167], v[60:63], v[228:231]
    ds_read_b128 a[164:167], v19 offset:17408
    v_cvt_pk_bf16_f32 v53, v106, v107
    v_mfma_f32_16x16x32_bf16 v[200:203], a[168:171], v[56:59], v[200:203]
    v_exp_f32 v110, v110
    v_mfma_f32_16x16x32_bf16 v[232:235], a[168:171], v[60:63], v[232:235]
    ds_read_b128 a[168:171], v19 offset:18432
    v_exp_f32 v111, v111
    v_mfma_f32_16x16x32_bf16 v[204:207], a[172:175], v[56:59], v[204:207]
    v_cvt_pk_bf16_f32 v54, v108, v109
    v_cvt_pk_bf16_f32 v55, v110, v111
    v_mfma_f32_16x16x32_bf16 v[236:239], a[172:175], v[60:63], v[236:239]
    ds_read_b128 a[172:175], v19 offset:19456
    v_xor_b32 v19, 98304, v19
    v_xor_b32 v20, 98304, v20
    s_waitcnt lgkmcnt(0)
    s_barrier
    v_mfma_f32_16x16x32_bf16 v[40:43], v[28:31], v[48:51], v[40:43]
    s_lshl_b32 s100, s60, 20
    s_add_u32 s101, s100, s21
    ds_read_b64 v[120:121], v12
    v_mfma_f32_16x16x32_bf16 v[44:47], v[28:31], v[52:55], v[44:47]
    s_add_u32 s100, s100, s20
    ds_read_b128 v[144:147], v8 offset:32768
    v_lshrrev_b32 v11, 4, v2
    v_mfma_f32_16x16x32_bf16 v[208:211], a[176:179], v[48:51], v[208:211]
    ds_read_b128 v[176:179], v8 offset:33792
    v_lshrrev_b32 v13, 2, v1
    v_mfma_f32_16x16x32_bf16 v[240:243], a[176:179], v[52:55], v[240:243]
    ds_read_b128 v[148:151], v8 offset:34816
    v_add_u32 v13, 32768, v13
    v_mfma_f32_16x16x32_bf16 v[212:215], a[180:183], v[48:51], v[212:215]
    s_xor_b32 s99, s62, 8192
    ds_read_b128 v[180:183], v8 offset:35840
    v_add_u32 v14, s99, v13
    v_mfma_f32_16x16x32_bf16 v[244:247], a[180:183], v[52:55], v[244:247]
    ds_read_b128 v[152:155], v8 offset:36864
    v_cmp_eq_u32 vcc, 1, v11
    v_mfma_f32_16x16x32_bf16 v[216:219], a[184:187], v[48:51], v[216:219]
    ds_read_b128 v[184:187], v8 offset:37888
    s_waitcnt lgkmcnt(6)
    v_add_f32 v112, v120, v32
    v_mfma_f32_16x16x32_bf16 v[248:251], a[184:187], v[52:55], v[248:251]
    ds_read_b128 v[156:159], v8 offset:38912
    v_add_f32 v114, v121, v36
    v_mfma_f32_16x16x32_bf16 v[220:223], a[188:191], v[48:51], v[220:223]
    ds_read_b128 v[188:191], v8 offset:39936
    v_cndmask_b32 v12, v32, v36, vcc
    v_mfma_f32_16x16x32_bf16 v[252:255], a[188:191], v[52:55], v[252:255]
    v_rcp_f32 v112, v112
    v_mfma_f32_16x16x32_bf16 v[192:195], a[160:163], v[48:51], v[192:195]
    v_rcp_f32 v114, v114
    v_mfma_f32_16x16x32_bf16 v[224:227], a[160:163], v[52:55], v[224:227]
    v_cmp_eq_u32 vcc, 2, v11
    v_cmp_eq_u32 s[96:97], 3, v11
    v_mfma_f32_16x16x32_bf16 v[196:199], a[164:167], v[48:51], v[196:199]
    ds_write_b128 v9, v[208:211] offset:0
    v_mfma_f32_16x16x32_bf16 v[228:231], a[164:167], v[52:55], v[228:231]
    v_mfma_f32_16x16x32_bf16 v[200:203], a[168:171], v[48:51], v[200:203]
    ds_write_b128 v9, v[240:243] offset:1024
    v_mfma_f32_16x16x32_bf16 v[232:235], a[168:171], v[52:55], v[232:235]
    v_mfma_f32_16x16x32_bf16 v[204:207], a[172:175], v[48:51], v[204:207]
    ds_write_b128 v9, v[212:215] offset:2048
    v_mfma_f32_16x16x32_bf16 v[236:239], a[172:175], v[52:55], v[236:239]
    v_cndmask_b32 v12, v12, v40, vcc
    v_cndmask_b32 v12, v12, v44, s[96:97]
    ds_write_b128 v9, v[244:247] offset:3072
    s_waitcnt lgkmcnt(11)
    v_pk_add_f32 v[128:129], v[128:129], v[144:145]
    v_pk_add_f32 v[130:131], v[130:131], v[146:147]
    s_waitcnt lgkmcnt(9)
    v_pk_add_f32 v[132:133], v[132:133], v[148:149]
    v_pk_add_f32 v[134:135], v[134:135], v[150:151]
    v_pk_mul_f32 v[128:129], v[128:129], v[112:113] op_sel_hi:[1,0]
    v_pk_mul_f32 v[130:131], v[130:131], v[112:113] op_sel_hi:[1,0]
    v_pk_mul_f32 v[132:133], v[132:133], v[112:113] op_sel_hi:[1,0]
    v_pk_mul_f32 v[134:135], v[134:135], v[112:113] op_sel_hi:[1,0]
    v_cvt_pk_bf16_f32 v128, v128, v129
    v_cvt_pk_bf16_f32 v129, v130, v131
    v_cvt_pk_bf16_f32 v130, v132, v133
    s_add_u32 m0, s16, 0
    ds_write_b128 v9, v[216:219] offset:4096
    v_cvt_pk_bf16_f32 v131, v134, v135
    buffer_store_dwordx4 v[128:131], v1, s[8:11], s100 offen offset:0 sc0 sc1
    s_waitcnt lgkmcnt(8)
    v_pk_add_f32 v[136:137], v[136:137], v[152:153]
    v_pk_add_f32 v[138:139], v[138:139], v[154:155]
    s_waitcnt lgkmcnt(6)
    v_pk_add_f32 v[140:141], v[140:141], v[156:157]
    v_pk_add_f32 v[142:143], v[142:143], v[158:159]
    v_pk_mul_f32 v[136:137], v[136:137], v[112:113] op_sel_hi:[1,0]
    v_pk_mul_f32 v[138:139], v[138:139], v[112:113] op_sel_hi:[1,0]
    v_pk_mul_f32 v[140:141], v[140:141], v[112:113] op_sel_hi:[1,0]
    v_pk_mul_f32 v[142:143], v[142:143], v[112:113] op_sel_hi:[1,0]
    v_cvt_pk_bf16_f32 v136, v136, v137
    buffer_load_dwordx4 v1, s[8:11], s19 offen offset:0 lds
    ds_write_b128 v9, v[248:251] offset:5120
    v_cvt_pk_bf16_f32 v137, v138, v139
    v_cvt_pk_bf16_f32 v138, v140, v141
    v_cvt_pk_bf16_f32 v139, v142, v143
    buffer_store_dwordx4 v[136:139], v1, s[8:11], s100 offen offset:1024 sc0 sc1
    v_pk_add_f32 v[160:161], v[160:161], v[176:177]
    v_pk_add_f32 v[162:163], v[162:163], v[178:179]
    v_pk_add_f32 v[164:165], v[164:165], v[180:181]
    v_pk_add_f32 v[166:167], v[166:167], v[182:183]
    v_pk_mul_f32 v[160:161], v[160:161], v[114:115] op_sel_hi:[1,0]
    v_pk_mul_f32 v[162:163], v[162:163], v[114:115] op_sel_hi:[1,0]
    v_pk_mul_f32 v[164:165], v[164:165], v[114:115] op_sel_hi:[1,0]
    buffer_load_dwordx4 v1, s[8:11], s19 offen offset:1024 lds
    ds_write_b128 v9, v[220:223] offset:6144
    v_pk_mul_f32 v[166:167], v[166:167], v[114:115] op_sel_hi:[1,0]
    v_cvt_pk_bf16_f32 v160, v160, v161
    v_cvt_pk_bf16_f32 v161, v162, v163
    v_cvt_pk_bf16_f32 v162, v164, v165
    v_cvt_pk_bf16_f32 v163, v166, v167
    buffer_store_dwordx4 v[160:163], v15, s[8:11], s100 offen offset:0 sc0 sc1
    v_pk_add_f32 v[168:169], v[168:169], v[184:185]
    v_pk_add_f32 v[170:171], v[170:171], v[186:187]
    s_waitcnt lgkmcnt(7)
    v_pk_add_f32 v[172:173], v[172:173], v[188:189]
    v_pk_add_f32 v[174:175], v[174:175], v[190:191]
    v_pk_mul_f32 v[168:169], v[168:169], v[114:115] op_sel_hi:[1,0]
    buffer_load_dwordx4 v1, s[8:11], s19 offen offset:2048 lds
    ds_write_b128 v9, v[252:255] offset:7168
    v_pk_mul_f32 v[170:171], v[170:171], v[114:115] op_sel_hi:[1,0]
    v_pk_mul_f32 v[172:173], v[172:173], v[114:115] op_sel_hi:[1,0]
    v_pk_mul_f32 v[174:175], v[174:175], v[114:115] op_sel_hi:[1,0]
    v_cvt_pk_bf16_f32 v168, v168, v169
    v_cvt_pk_bf16_f32 v169, v170, v171
    v_cvt_pk_bf16_f32 v170, v172, v173
    v_cvt_pk_bf16_f32 v171, v174, v175
    buffer_store_dwordx4 v[168:171], v15, s[8:11], s100 offen offset:1024 sc0 sc1
    buffer_load_dwordx4 v1, s[8:11], s19 offen offset:3072 lds
    ds_write_b32 v14, v12
    v_and_b32 v14, 4294967103, v13
    v_add_u32 v14, s62, v14
    s_waitcnt lgkmcnt(0)
    s_barrier
    ds_read_b32 v116, v14 offset:128
    ds_read_b32 v118, v14 offset:192
    ds_read_b128 v[208:211], v10 offset:0
    ds_read_b128 v[212:215], v10 offset:2048
    ds_read_b128 v[216:219], v10 offset:4096
    ds_read_b128 v[220:223], v10 offset:6144
    ds_read_b128 v[240:243], v10 offset:1024
    ds_read_b128 v[244:247], v10 offset:3072
    ds_read_b128 v[248:251], v10 offset:5120
    ds_read_b128 v[252:255], v10 offset:7168
    ds_read_b32 v120, v13 offset:0
    ds_read_b32 v121, v13 offset:8192
    ds_read_b32 v122, v13 offset:16384
    ds_read_b32 v123, v13 offset:24576
    s_waitcnt lgkmcnt(13)
    v_add_f32 v116, v116, v40
    s_waitcnt lgkmcnt(12)
    v_add_f32 v118, v118, v44
    v_rcp_f32 v116, v116
    v_rcp_f32 v118, v118
    s_waitcnt lgkmcnt(11)
    v_pk_add_f32 v[192:193], v[192:193], v[208:209]
    v_pk_add_f32 v[194:195], v[194:195], v[210:211]
    s_waitcnt lgkmcnt(10)
    v_pk_add_f32 v[196:197], v[196:197], v[212:213]
    v_pk_add_f32 v[198:199], v[198:199], v[214:215]
    v_pk_mul_f32 v[192:193], v[192:193], v[116:117] op_sel_hi:[1,0]
    v_pk_mul_f32 v[194:195], v[194:195], v[116:117] op_sel_hi:[1,0]
    v_pk_mul_f32 v[196:197], v[196:197], v[116:117] op_sel_hi:[1,0]
    v_pk_mul_f32 v[198:199], v[198:199], v[116:117] op_sel_hi:[1,0]
    v_cvt_pk_bf16_f32 v192, v192, v193
    v_cvt_pk_bf16_f32 v193, v194, v195
    v_cvt_pk_bf16_f32 v194, v196, v197
    v_cvt_pk_bf16_f32 v195, v198, v199
    buffer_store_dwordx4 v[192:195], v1, s[8:11], s101 offen offset:0 sc0 sc1
    s_add_u32 m0, s16, 4096
    s_waitcnt lgkmcnt(9)
    v_pk_add_f32 v[200:201], v[200:201], v[216:217]
    v_pk_add_f32 v[202:203], v[202:203], v[218:219]
    s_waitcnt lgkmcnt(8)
    v_pk_add_f32 v[204:205], v[204:205], v[220:221]
    v_pk_add_f32 v[206:207], v[206:207], v[222:223]
    v_pk_mul_f32 v[200:201], v[200:201], v[116:117] op_sel_hi:[1,0]
    v_pk_mul_f32 v[202:203], v[202:203], v[116:117] op_sel_hi:[1,0]
    v_pk_mul_f32 v[204:205], v[204:205], v[116:117] op_sel_hi:[1,0]
    v_pk_mul_f32 v[206:207], v[206:207], v[116:117] op_sel_hi:[1,0]
    v_cvt_pk_bf16_f32 v200, v200, v201
    v_cvt_pk_bf16_f32 v201, v202, v203
    v_cvt_pk_bf16_f32 v202, v204, v205
    v_cvt_pk_bf16_f32 v203, v206, v207
    buffer_store_dwordx4 v[200:203], v1, s[8:11], s101 offen offset:1024 sc0 sc1
    buffer_load_dwordx4 v15, s[8:11], s19 offen offset:0 lds
    buffer_load_dwordx4 v15, s[8:11], s19 offen offset:1024 lds
    s_waitcnt lgkmcnt(2)
    v_add_f32 v120, v120, v121
    s_waitcnt lgkmcnt(0)
    v_add_f32 v122, v122, v123
    v_min_f32 v124, v120, v122
    v_add_f32 v120, v120, v122
    v_cmp_le_f32 vcc, 0x1f800000, v124
    s_mov_b64 s[96:97], vcc
    v_cmp_ge_f32 vcc, 0x67800000, v120
    s_and_b64 s[96:97], s[96:97], vcc
    s_cmp_eq_u64 s[96:97], -1
    s_cselect_b32 s96, s25, 1
    s_cmp_lg_u32 s96, 0
    s_cbranch_scc1 L_t1_redo
L_t1_safe:
    v_pk_add_f32 v[224:225], v[224:225], v[240:241]
    v_pk_add_f32 v[226:227], v[226:227], v[242:243]
    v_pk_add_f32 v[228:229], v[228:229], v[244:245]
    v_pk_add_f32 v[230:231], v[230:231], v[246:247]
    v_pk_mul_f32 v[224:225], v[224:225], v[118:119] op_sel_hi:[1,0]
    v_pk_mul_f32 v[226:227], v[226:227], v[118:119] op_sel_hi:[1,0]
    v_pk_mul_f32 v[228:229], v[228:229], v[118:119] op_sel_hi:[1,0]
    v_pk_mul_f32 v[230:231], v[230:231], v[118:119] op_sel_hi:[1,0]
    v_cvt_pk_bf16_f32 v224, v224, v225
    v_cvt_pk_bf16_f32 v225, v226, v227
    v_cvt_pk_bf16_f32 v226, v228, v229
    v_cvt_pk_bf16_f32 v227, v230, v231
    buffer_store_dwordx4 v[224:227], v15, s[8:11], s101 offen offset:0 sc0 sc1
    buffer_load_dwordx4 v15, s[8:11], s19 offen offset:2048 lds
    ds_read_b128 a[128:131], v18 offset:0
    ds_read_b128 a[132:135], v18 offset:1024
    ds_read_b128 a[136:139], v18 offset:2048
    ds_read_b128 a[140:143], v18 offset:3072
    v_pk_add_f32 v[232:233], v[232:233], v[248:249]
    v_pk_add_f32 v[234:235], v[234:235], v[250:251]
    v_pk_add_f32 v[236:237], v[236:237], v[252:253]
    v_pk_add_f32 v[238:239], v[238:239], v[254:255]
    v_pk_mul_f32 v[232:233], v[232:233], v[118:119] op_sel_hi:[1,0]
    v_pk_mul_f32 v[234:235], v[234:235], v[118:119] op_sel_hi:[1,0]
    v_pk_mul_f32 v[236:237], v[236:237], v[118:119] op_sel_hi:[1,0]
    v_pk_mul_f32 v[238:239], v[238:239], v[118:119] op_sel_hi:[1,0]
    v_cvt_pk_bf16_f32 v232, v232, v233
    v_cvt_pk_bf16_f32 v233, v234, v235
    v_cvt_pk_bf16_f32 v234, v236, v237
    v_cvt_pk_bf16_f32 v235, v238, v239
    buffer_store_dwordx4 v[232:235], v15, s[8:11], s101 offen offset:1024 sc0 sc1
    buffer_load_dwordx4 v15, s[8:11], s19 offen offset:3072 lds
    s_xor_b32 s16, s16, 98304
    ds_read_b128 a[144:147], v18 offset:4096
    ds_read_b128 a[148:151], v18 offset:5120
    ds_read_b128 a[152:155], v18 offset:6144
    ds_read_b128 a[156:159], v18 offset:7168
L_t2_start:
    s_waitcnt lgkmcnt(7)
    v_mfma_f32_16x16x32_bf16 v[96:99], a[128:131], a[192:195], v[64:67]
    s_waitcnt lgkmcnt(6)
    s_add_u32 s19, s82, 32768
    s_sub_u32 s82, s12, s13
    s_sub_u32 s82, s82, 1
    v_mfma_f32_16x16x32_bf16 v[96:99], a[132:135], a[196:199], v[96:99]
    s_waitcnt lgkmcnt(5)
    s_cmp_gt_u32 s12, s13
    s_cselect_b32 s82, s82, s12
    s_lshl_b32 s82, s82, 16
    s_add_u32 s82, s82, s81
    v_mfma_f32_16x16x32_bf16 v[96:99], a[136:139], a[200:203], v[96:99]
    s_waitcnt lgkmcnt(4)
    s_cmp_ge_u32 s12, 17
    s_cselect_b32 s82, 2147471360, s82
    s_add_u32 s12, s12, 1
    s_sub_u32 s14, s61, 7
    v_mfma_f32_16x16x32_bf16 v[96:99], a[140:143], a[204:207], v[96:99]
    s_waitcnt lgkmcnt(3)
    v_mfma_f32_16x16x32_bf16 v[100:103], a[144:147], a[192:195], v[64:67]
    s_waitcnt lgkmcnt(2)
    v_mfma_f32_16x16x32_bf16 v[100:103], a[148:151], a[196:199], v[100:103]
    s_waitcnt lgkmcnt(1)
    v_mfma_f32_16x16x32_bf16 v[100:103], a[152:155], a[200:203], v[100:103]
    s_waitcnt lgkmcnt(0)
    v_mfma_f32_16x16x32_bf16 v[100:103], a[156:159], a[204:207], v[100:103]
    v_mfma_f32_16x16x32_bf16 v[104:107], a[128:131], a[208:211], v[68:71]
    v_exp_f32 v96, v96
    v_mfma_f32_16x16x32_bf16 v[104:107], a[132:135], a[212:215], v[104:107]
    v_exp_f32 v97, v97
    v_mfma_f32_16x16x32_bf16 v[104:107], a[136:139], a[216:219], v[104:107]
    v_exp_f32 v98, v98
    v_mfma_f32_16x16x32_bf16 v[104:107], a[140:143], a[220:223], v[104:107]
    v_exp_f32 v99, v99
    v_mfma_f32_16x16x32_bf16 v[108:111], a[144:147], a[208:211], v[68:71]
    v_exp_f32 v100, v100
    v_mfma_f32_16x16x32_bf16 v[108:111], a[148:151], a[212:215], v[108:111]
    v_exp_f32 v101, v101
    v_mfma_f32_16x16x32_bf16 v[108:111], a[152:155], a[216:219], v[108:111]
    v_exp_f32 v102, v102
    v_mfma_f32_16x16x32_bf16 v[108:111], a[156:159], a[220:223], v[108:111]
    v_exp_f32 v103, v103
    v_mfma_f32_16x16x32_bf16 v[112:115], a[128:131], a[224:227], v[72:75]
    v_exp_f32 v104, v104
    v_mfma_f32_16x16x32_bf16 v[112:115], a[132:135], a[228:231], v[112:115]
    v_exp_f32 v105, v105
    v_mfma_f32_16x16x32_bf16 v[112:115], a[136:139], a[232:235], v[112:115]
    v_exp_f32 v106, v106
    v_mfma_f32_16x16x32_bf16 v[112:115], a[140:143], a[236:239], v[112:115]
    v_exp_f32 v107, v107
    v_mfma_f32_16x16x32_bf16 v[120:123], a[128:131], a[240:243], v[76:79]
    v_exp_f32 v108, v108
    v_mfma_f32_16x16x32_bf16 v[120:123], a[132:135], a[244:247], v[120:123]
    v_exp_f32 v109, v109
    v_mfma_f32_16x16x32_bf16 v[120:123], a[136:139], a[248:251], v[120:123]
    v_exp_f32 v110, v110
    v_mfma_f32_16x16x32_bf16 v[120:123], a[140:143], a[252:255], v[120:123]
    v_exp_f32 v111, v111
    v_mfma_f32_16x16x32_bf16 v[116:119], a[144:147], a[224:227], v[72:75]
    ds_read_b128 a[128:131], v18 offset:16384
    v_cvt_pk_bf16_f32 v48, v96, v97
    v_mfma_f32_16x16x32_bf16 v[116:119], a[148:151], a[228:231], v[116:119]
    ds_read_b128 a[132:135], v18 offset:17408
    v_cvt_pk_bf16_f32 v49, v98, v99
    v_mfma_f32_16x16x32_bf16 v[116:119], a[152:155], a[232:235], v[116:119]
    ds_read_b128 a[136:139], v18 offset:18432
    v_cvt_pk_bf16_f32 v50, v100, v101
    v_mfma_f32_16x16x32_bf16 v[116:119], a[156:159], a[236:239], v[116:119]
    ds_read_b128 a[140:143], v18 offset:19456
    v_cvt_pk_bf16_f32 v51, v102, v103
    v_mfma_f32_16x16x32_bf16 v[124:127], a[144:147], a[240:243], v[76:79]
    ds_read_b128 a[144:147], v18 offset:20480
    v_cvt_pk_bf16_f32 v52, v104, v105
    v_mfma_f32_16x16x32_bf16 v[124:127], a[148:151], a[244:247], v[124:127]
    ds_read_b128 a[148:151], v18 offset:21504
    v_cvt_pk_bf16_f32 v53, v106, v107
    v_mfma_f32_16x16x32_bf16 v[124:127], a[152:155], a[248:251], v[124:127]
    ds_read_b128 a[152:155], v18 offset:22528
    v_cvt_pk_bf16_f32 v54, v108, v109
    v_mfma_f32_16x16x32_bf16 v[124:127], a[156:159], a[252:255], v[124:127]
    ds_read_b128 a[156:159], v18 offset:23552
    v_cvt_pk_bf16_f32 v55, v110, v111
    v_xor_b32 v18, 196608, v18
    s_waitcnt vmcnt(0) lgkmcnt(0)
    s_barrier
    v_mfma_f32_16x16x32_bf16 v[96:99], a[128:131], a[192:195], v[64:67]
    s_add_u32 m0, s15, 0
    ds_read_b128 a[160:163], v19 offset:0
    v_mfma_f32_16x16x32_bf16 v[96:99], a[132:135], a[196:199], v[96:99]
    ds_read_b128 a[164:167], v19 offset:1024
    v_mfma_f32_16x16x32_bf16 v[96:99], a[136:139], a[200:203], v[96:99]
    v_exp_f32 v112, v112
    v_mfma_f32_16x16x32_bf16 v[96:99], a[140:143], a[204:207], v[96:99]
    buffer_load_dwordx4 v1, s[8:11], s82 offen offset:0 lds
    v_mfma_f32_16x16x32_bf16 v[104:107], a[128:131], a[208:211], v[68:71]
    v_exp_f32 v113, v113
    v_mfma_f32_16x16x32_bf16 v[104:107], a[132:135], a[212:215], v[104:107]
    ds_read_b128 a[168:171], v19 offset:2048
    v_cvt_pk_bf16_f32 v56, v112, v113
    v_mfma_f32_16x16x32_bf16 v[104:107], a[136:139], a[216:219], v[104:107]
    v_exp_f32 v114, v114
    v_mfma_f32_16x16x32_bf16 v[104:107], a[140:143], a[220:223], v[104:107]
    buffer_load_dwordx4 v1, s[8:11], s82 offen offset:1024 lds
    v_mfma_f32_16x16x32_bf16 v[100:103], a[144:147], a[192:195], v[64:67]
    v_exp_f32 v115, v115
    v_mfma_f32_16x16x32_bf16 v[100:103], a[148:151], a[196:199], v[100:103]
    ds_read_b128 a[172:175], v19 offset:3072
    v_cvt_pk_bf16_f32 v57, v114, v115
    v_mfma_f32_16x16x32_bf16 v[100:103], a[152:155], a[200:203], v[100:103]
    v_exp_f32 v116, v116
    v_mfma_f32_16x16x32_bf16 v[100:103], a[156:159], a[204:207], v[100:103]
    buffer_load_dwordx4 v1, s[8:11], s82 offen offset:2048 lds
    v_mfma_f32_16x16x32_bf16 v[108:111], a[144:147], a[208:211], v[68:71]
    v_exp_f32 v117, v117
    v_mfma_f32_16x16x32_bf16 v[108:111], a[148:151], a[212:215], v[108:111]
    ds_read_b128 a[176:179], v20 offset:4096
    v_cvt_pk_bf16_f32 v58, v116, v117
    v_mfma_f32_16x16x32_bf16 v[108:111], a[152:155], a[216:219], v[108:111]
    v_exp_f32 v118, v118
    v_mfma_f32_16x16x32_bf16 v[108:111], a[156:159], a[220:223], v[108:111]
    buffer_load_dwordx4 v1, s[8:11], s82 offen offset:3072 lds
    v_mfma_f32_16x16x32_bf16 v[32:35], v[28:31], v[48:51], 0
    s_add_u32 m0, s15, 4096
    v_exp_f32 v119, v119
    v_mfma_f32_16x16x32_bf16 v[36:39], v[28:31], v[52:55], 0
    s_waitcnt lgkmcnt(4)
    ds_read_b128 a[180:183], v20 offset:5120
    v_cvt_pk_bf16_f32 v59, v118, v119
    v_mfma_f32_16x16x32_bf16 v[128:131], a[160:163], v[48:51], 0
    v_exp_f32 v120, v120
    v_mfma_f32_16x16x32_bf16 v[160:163], a[160:163], v[52:55], 0
    s_waitcnt lgkmcnt(4)
    v_mfma_f32_16x16x32_bf16 v[132:135], a[164:167], v[48:51], 0
    v_exp_f32 v121, v121
    v_mfma_f32_16x16x32_bf16 v[164:167], a[164:167], v[52:55], 0
    s_waitcnt lgkmcnt(3)
    ds_read_b128 a[184:187], v20 offset:6144
    v_cvt_pk_bf16_f32 v60, v120, v121
    v_mfma_f32_16x16x32_bf16 v[136:139], a[168:171], v[48:51], 0
    s_waitcnt lgkmcnt(3)
    v_exp_f32 v122, v122
    v_mfma_f32_16x16x32_bf16 v[168:171], a[168:171], v[52:55], 0
    buffer_load_dwordx4 v15, s[8:11], s82 offen offset:0 lds
    v_mfma_f32_16x16x32_bf16 v[140:143], a[172:175], v[48:51], 0
    v_exp_f32 v123, v123
    v_mfma_f32_16x16x32_bf16 v[172:175], a[172:175], v[52:55], 0
    s_waitcnt lgkmcnt(2)
    ds_read_b128 a[188:191], v20 offset:7168
    v_cvt_pk_bf16_f32 v61, v122, v123
    v_mfma_f32_16x16x32_bf16 v[144:147], a[176:179], v[48:51], 0
    s_waitcnt lgkmcnt(2)
    v_exp_f32 v124, v124
    v_mfma_f32_16x16x32_bf16 v[176:179], a[176:179], v[52:55], 0
    buffer_load_dwordx4 v15, s[8:11], s82 offen offset:1024 lds
    v_mfma_f32_16x16x32_bf16 v[148:151], a[180:183], v[48:51], 0
    v_exp_f32 v125, v125
    v_mfma_f32_16x16x32_bf16 v[180:183], a[180:183], v[52:55], 0
    s_waitcnt lgkmcnt(1)
    v_cvt_pk_bf16_f32 v62, v124, v125
    v_mfma_f32_16x16x32_bf16 v[152:155], a[184:187], v[48:51], 0
    s_waitcnt lgkmcnt(0)
    v_exp_f32 v126, v126
    v_mfma_f32_16x16x32_bf16 v[184:187], a[184:187], v[52:55], 0
    buffer_load_dwordx4 v15, s[8:11], s82 offen offset:2048 lds
    v_mfma_f32_16x16x32_bf16 v[156:159], a[188:191], v[48:51], 0
    v_exp_f32 v127, v127
    v_mfma_f32_16x16x32_bf16 v[188:191], a[188:191], v[52:55], 0
    v_cvt_pk_bf16_f32 v63, v126, v127
    v_mfma_f32_16x16x32_bf16 v[112:115], a[128:131], a[224:227], v[72:75]
    v_mfma_f32_16x16x32_bf16 v[112:115], a[132:135], a[228:231], v[112:115]
    v_mfma_f32_16x16x32_bf16 v[112:115], a[136:139], a[232:235], v[112:115]
    v_exp_f32 v96, v96
    v_mfma_f32_16x16x32_bf16 v[112:115], a[140:143], a[236:239], v[112:115]
    buffer_load_dwordx4 v15, s[8:11], s82 offen offset:3072 lds
    v_mfma_f32_16x16x32_bf16 v[120:123], a[128:131], a[240:243], v[76:79]
    s_xor_b32 s15, s15, 196608
    v_exp_f32 v97, v97
    v_mfma_f32_16x16x32_bf16 v[120:123], a[132:135], a[244:247], v[120:123]
    s_add_u32 m0, s16, 0
    ds_read_b128 a[128:131], v18 offset:0
    v_cvt_pk_bf16_f32 v48, v96, v97
    v_mfma_f32_16x16x32_bf16 v[120:123], a[136:139], a[248:251], v[120:123]
    v_exp_f32 v98, v98
    v_mfma_f32_16x16x32_bf16 v[120:123], a[140:143], a[252:255], v[120:123]
    buffer_load_dwordx4 v1, s[8:11], s19 offen offset:0 lds
    v_mfma_f32_16x16x32_bf16 v[116:119], a[144:147], a[224:227], v[72:75]
    v_exp_f32 v99, v99
    v_mfma_f32_16x16x32_bf16 v[116:119], a[148:151], a[228:231], v[116:119]
    ds_read_b128 a[132:135], v18 offset:1024
    v_cvt_pk_bf16_f32 v49, v98, v99
    v_mfma_f32_16x16x32_bf16 v[116:119], a[152:155], a[232:235], v[116:119]
    v_exp_f32 v100, v100
    v_mfma_f32_16x16x32_bf16 v[116:119], a[156:159], a[236:239], v[116:119]
    buffer_load_dwordx4 v1, s[8:11], s19 offen offset:1024 lds
    v_mfma_f32_16x16x32_bf16 v[124:127], a[144:147], a[240:243], v[76:79]
    v_exp_f32 v101, v101
    v_mfma_f32_16x16x32_bf16 v[124:127], a[148:151], a[244:247], v[124:127]
    ds_read_b128 a[136:139], v18 offset:2048
    v_cvt_pk_bf16_f32 v50, v100, v101
    v_mfma_f32_16x16x32_bf16 v[124:127], a[152:155], a[248:251], v[124:127]
    v_exp_f32 v102, v102
    v_mfma_f32_16x16x32_bf16 v[124:127], a[156:159], a[252:255], v[124:127]
    buffer_load_dwordx4 v1, s[8:11], s19 offen offset:2048 lds
    v_mfma_f32_16x16x32_bf16 v[40:43], v[28:31], v[56:59], 0
    v_exp_f32 v103, v103
    v_mfma_f32_16x16x32_bf16 v[44:47], v[28:31], v[60:63], 0
    ds_read_b128 a[140:143], v18 offset:3072
    v_cvt_pk_bf16_f32 v51, v102, v103
    v_mfma_f32_16x16x32_bf16 v[192:195], a[160:163], v[56:59], 0
    v_exp_f32 v104, v104
    v_mfma_f32_16x16x32_bf16 v[224:227], a[160:163], v[60:63], 0
    v_mfma_f32_16x16x32_bf16 v[196:199], a[164:167], v[56:59], 0
    v_exp_f32 v105, v105
    v_mfma_f32_16x16x32_bf16 v[228:231], a[164:167], v[60:63], 0
    ds_read_b128 a[144:147], v18 offset:4096
    v_cvt_pk_bf16_f32 v52, v104, v105
    v_mfma_f32_16x16x32_bf16 v[200:203], a[168:171], v[56:59], 0
    v_exp_f32 v106, v106
    v_mfma_f32_16x16x32_bf16 v[232:235], a[168:171], v[60:63], 0
    buffer_load_dwordx4 v1, s[8:11], s19 offen offset:3072 lds
    v_mfma_f32_16x16x32_bf16 v[204:207], a[172:175], v[56:59], 0
    s_add_u32 m0, s16, 4096
    v_exp_f32 v107, v107
    v_mfma_f32_16x16x32_bf16 v[236:239], a[172:175], v[60:63], 0
    ds_read_b128 a[148:151], v18 offset:5120
    v_cvt_pk_bf16_f32 v53, v106, v107
    v_mfma_f32_16x16x32_bf16 v[208:211], a[176:179], v[56:59], 0
    v_exp_f32 v108, v108
    v_mfma_f32_16x16x32_bf16 v[240:243], a[176:179], v[60:63], 0
    buffer_load_dwordx4 v15, s[8:11], s19 offen offset:0 lds
    v_mfma_f32_16x16x32_bf16 v[212:215], a[180:183], v[56:59], 0
    v_exp_f32 v109, v109
    v_mfma_f32_16x16x32_bf16 v[244:247], a[180:183], v[60:63], 0
    ds_read_b128 a[152:155], v18 offset:6144
    v_cvt_pk_bf16_f32 v54, v108, v109
    v_mfma_f32_16x16x32_bf16 v[216:219], a[184:187], v[56:59], 0
    v_exp_f32 v110, v110
    v_mfma_f32_16x16x32_bf16 v[248:251], a[184:187], v[60:63], 0
    buffer_load_dwordx4 v15, s[8:11], s19 offen offset:1024 lds
    v_mfma_f32_16x16x32_bf16 v[220:223], a[188:191], v[56:59], 0
    v_exp_f32 v111, v111
    v_mfma_f32_16x16x32_bf16 v[252:255], a[188:191], v[60:63], 0
    ds_read_b128 a[156:159], v18 offset:7168
    v_cvt_pk_bf16_f32 v55, v110, v111
    s_waitcnt lgkmcnt(7)
    v_mfma_f32_16x16x32_bf16 v[96:99], a[128:131], a[192:195], v[64:67]
    s_waitcnt lgkmcnt(6)
    s_lshr_b32 s101, s2, 3
    ds_read_b128 a[160:163], v19 offset:16384
    v_lshrrev_b32 v14, 3, v2
    v_mfma_f32_16x16x32_bf16 v[96:99], a[132:135], a[196:199], v[96:99]
    s_waitcnt lgkmcnt(6)
    ds_read_b128 a[164:167], v19 offset:17408
    v_lshlrev_b32 v14, 4, v14
    v_mfma_f32_16x16x32_bf16 v[96:99], a[136:139], a[200:203], v[96:99]
    s_waitcnt lgkmcnt(6)
    v_exp_f32 v112, v112
    v_mfma_f32_16x16x32_bf16 v[96:99], a[140:143], a[204:207], v[96:99]
    buffer_load_dwordx4 v15, s[8:11], s19 offen offset:2048 lds
    v_mfma_f32_16x16x32_bf16 v[104:107], a[128:131], a[208:211], v[68:71]
    v_exp_f32 v113, v113
    v_mfma_f32_16x16x32_bf16 v[104:107], a[132:135], a[212:215], v[104:107]
    ds_read_b128 a[168:171], v19 offset:18432
    v_cvt_pk_bf16_f32 v56, v112, v113
    v_mfma_f32_16x16x32_bf16 v[104:107], a[136:139], a[216:219], v[104:107]
    s_waitcnt lgkmcnt(6)
    v_exp_f32 v114, v114
    v_mfma_f32_16x16x32_bf16 v[104:107], a[140:143], a[220:223], v[104:107]
    buffer_load_dwordx4 v15, s[8:11], s19 offen offset:3072 lds
    v_mfma_f32_16x16x32_bf16 v[100:103], a[144:147], a[192:195], v[64:67]
    s_waitcnt lgkmcnt(5)
    s_xor_b32 s16, s16, 98304
    v_exp_f32 v115, v115
    v_mfma_f32_16x16x32_bf16 v[100:103], a[148:151], a[196:199], v[100:103]
    s_waitcnt lgkmcnt(4)
    s_add_u32 s27, s18, 0
    ds_read_b128 a[172:175], v19 offset:19456
    v_cvt_pk_bf16_f32 v57, v114, v115
    v_mfma_f32_16x16x32_bf16 v[100:103], a[152:155], a[200:203], v[100:103]
    s_waitcnt lgkmcnt(4)
    v_exp_f32 v116, v116
    v_mfma_f32_16x16x32_bf16 v[100:103], a[156:159], a[204:207], v[100:103]
    buffer_store_dwordx4 v[24:27], v23, s[8:11], s27 offen offset:0 sc0 sc1
    v_mfma_f32_16x16x32_bf16 v[108:111], a[144:147], a[208:211], v[68:71]
    s_add_u32 s27, s18, 131072
    v_exp_f32 v117, v117
    v_mfma_f32_16x16x32_bf16 v[108:111], a[148:151], a[212:215], v[108:111]
    ds_read_b128 a[176:179], v20 offset:20480
    v_cvt_pk_bf16_f32 v58, v116, v117
    v_mfma_f32_16x16x32_bf16 v[108:111], a[152:155], a[216:219], v[108:111]
    v_exp_f32 v118, v118
    v_mfma_f32_16x16x32_bf16 v[108:111], a[156:159], a[220:223], v[108:111]
    buffer_store_dwordx4 v[24:27], v23, s[8:11], s27 offen offset:0 sc0 sc1
    v_mfma_f32_16x16x32_bf16 v[32:35], v[28:31], v[48:51], v[32:35]
    v_exp_f32 v119, v119
    v_mfma_f32_16x16x32_bf16 v[36:39], v[28:31], v[52:55], v[36:39]
    s_waitcnt lgkmcnt(4)
    ds_read_b128 a[180:183], v20 offset:21504
    v_cvt_pk_bf16_f32 v59, v118, v119
    v_mfma_f32_16x16x32_bf16 v[128:131], a[160:163], v[48:51], v[128:131]
    v_exp_f32 v120, v120
    v_mfma_f32_16x16x32_bf16 v[160:163], a[160:163], v[52:55], v[160:163]
    s_waitcnt lgkmcnt(4)
    v_and_b32 v13, 7, v2
    v_lshl_add_u32 v12, v13, 13, v14
    v_mfma_f32_16x16x32_bf16 v[132:135], a[164:167], v[48:51], v[132:135]
    v_exp_f32 v121, v121
    v_mfma_f32_16x16x32_bf16 v[164:167], a[164:167], v[52:55], v[164:167]
    s_waitcnt lgkmcnt(3)
    ds_read_b128 a[184:187], v20 offset:22528
    v_cvt_pk_bf16_f32 v60, v120, v121
    v_mfma_f32_16x16x32_bf16 v[136:139], a[168:171], v[48:51], v[136:139]
    v_exp_f32 v122, v122
    v_mfma_f32_16x16x32_bf16 v[168:171], a[168:171], v[52:55], v[168:171]
    s_waitcnt lgkmcnt(3)
    v_mul_u32_u24 v13, 28672, v13
    v_add_u32 v13, v13, v14
    v_mfma_f32_16x16x32_bf16 v[140:143], a[172:175], v[48:51], v[140:143]
    s_lshl_b32 s17, s4, 2
    v_exp_f32 v123, v123
    v_mfma_f32_16x16x32_bf16 v[172:175], a[172:175], v[52:55], v[172:175]
    s_waitcnt lgkmcnt(2)
    s_add_u32 s17, s17, s3
    ds_read_b128 a[188:191], v20 offset:23552
    v_cvt_pk_bf16_f32 v61, v122, v123
    v_mfma_f32_16x16x32_bf16 v[144:147], a[176:179], v[48:51], v[144:147]
    s_lshl_b32 s17, s17, 7
    v_exp_f32 v124, v124
    v_mfma_f32_16x16x32_bf16 v[176:179], a[176:179], v[52:55], v[176:179]
    s_waitcnt lgkmcnt(2)
    v_mfma_f32_16x16x32_bf16 v[148:151], a[180:183], v[48:51], v[148:151]
    s_lshl_b32 s100, s101, 16
    v_exp_f32 v125, v125
    v_mfma_f32_16x16x32_bf16 v[180:183], a[180:183], v[52:55], v[180:183]
    s_waitcnt lgkmcnt(1)
    s_add_u32 s17, s17, s100
    v_cvt_pk_bf16_f32 v62, v124, v125
    v_xor_b32 v19, 98304, v19
    v_mfma_f32_16x16x32_bf16 v[152:155], a[184:187], v[48:51], v[152:155]
    s_add_u32 s17, s17, 4194304
    v_exp_f32 v126, v126
    v_mfma_f32_16x16x32_bf16 v[184:187], a[184:187], v[52:55], v[184:187]
    s_waitcnt lgkmcnt(0)
    s_cmp_lt_u32 s101, s26
    s_cselect_b32 s17, s17, 2143285248
    v_xor_b32 v20, 98304, v20
    v_mfma_f32_16x16x32_bf16 v[156:159], a[188:191], v[48:51], v[156:159]
    buffer_store_dwordx4 a[0:3], v12, s[8:11], s17 offen sc0 sc1
    v_exp_f32 v127, v127
    v_mfma_f32_16x16x32_bf16 v[188:191], a[188:191], v[52:55], v[188:191]
    v_cvt_pk_bf16_f32 v63, v126, v127
    v_mfma_f32_16x16x32_bf16 v[112:115], a[128:131], a[224:227], v[72:75]
    s_add_u32 s17, s17, 4096
    v_exp_f32 v96, v96
    v_mfma_f32_16x16x32_bf16 v[112:115], a[132:135], a[228:231], v[112:115]
    buffer_store_dwordx4 a[4:7], v12, s[8:11], s17 offen sc0 sc1
    v_mfma_f32_16x16x32_bf16 v[112:115], a[136:139], a[232:235], v[112:115]
    s_add_u32 s27, s18, 0
    v_exp_f32 v97, v97
    v_mfma_f32_16x16x32_bf16 v[112:115], a[140:143], a[236:239], v[112:115]
    v_cvt_pk_bf16_f32 v48, v96, v97
    v_mfma_f32_16x16x32_bf16 v[120:123], a[128:131], a[240:243], v[76:79]
    v_exp_f32 v98, v98
    v_mfma_f32_16x16x32_bf16 v[120:123], a[132:135], a[244:247], v[120:123]
    buffer_store_dwordx4 v[24:27], v23, s[8:11], s27 offen offset:256 sc0 sc1
    v_mfma_f32_16x16x32_bf16 v[120:123], a[136:139], a[248:251], v[120:123]
    s_add_u32 s27, s18, 131072
    v_exp_f32 v99, v99
    v_mfma_f32_16x16x32_bf16 v[120:123], a[140:143], a[252:255], v[120:123]
    buffer_store_dwordx4 v[24:27], v23, s[8:11], s27 offen offset:256 sc0 sc1
    v_mfma_f32_16x16x32_bf16 v[116:119], a[144:147], a[224:227], v[72:75]
    s_add_u32 s27, s18, 0
    v_exp_f32 v100, v100
    v_mfma_f32_16x16x32_bf16 v[116:119], a[148:151], a[228:231], v[116:119]
    ds_read_b128 a[128:131], v18 offset:16384
    v_cvt_pk_bf16_f32 v49, v98, v99
    v_mfma_f32_16x16x32_bf16 v[116:119], a[152:155], a[232:235], v[116:119]
    s_add_u32 s19, s82, 32768
    v_exp_f32 v101, v101
    v_mfma_f32_16x16x32_bf16 v[116:119], a[156:159], a[236:239], v[116:119]
    s_sub_u32 s82, s12, s13
    ds_read_b128 a[132:135], v18 offset:17408
    v_cvt_pk_bf16_f32 v50, v100, v101
    v_mfma_f32_16x16x32_bf16 v[124:127], a[144:147], a[240:243], v[76:79]
    s_sub_u32 s82, s82, 1
    v_exp_f32 v102, v102
    v_mfma_f32_16x16x32_bf16 v[124:127], a[148:151], a[244:247], v[124:127]
    s_cmp_gt_u32 s12, s13
    s_cselect_b32 s82, s82, s12
    s_lshl_b32 s82, s82, 16
    ds_read_b128 a[136:139], v18 offset:18432
    v_mfma_f32_16x16x32_bf16 v[124:127], a[152:155], a[248:251], v[124:127]
    s_add_u32 s82, s82, s81
    v_exp_f32 v103, v103
    v_mfma_f32_16x16x32_bf16 v[124:127], a[156:159], a[252:255], v[124:127]
    s_cmp_ge_u32 s12, 17
    s_cselect_b32 s82, 2147471360, s82
    ds_read_b128 a[140:143], v18 offset:19456
    v_cvt_pk_bf16_f32 v51, v102, v103
    v_mfma_f32_16x16x32_bf16 v[40:43], v[28:31], v[56:59], v[40:43]
    s_add_u32 s12, s12, 1
    v_exp_f32 v104, v104
    v_mfma_f32_16x16x32_bf16 v[44:47], v[28:31], v[60:63], v[44:47]
    ds_read_b128 a[144:147], v18 offset:20480
    v_mfma_f32_16x16x32_bf16 v[192:195], a[160:163], v[56:59], v[192:195]
    v_exp_f32 v105, v105
    v_mfma_f32_16x16x32_bf16 v[224:227], a[160:163], v[60:63], v[224:227]
    ds_read_b128 a[148:151], v18 offset:21504
    v_cvt_pk_bf16_f32 v52, v104, v105
    v_mfma_f32_16x16x32_bf16 v[196:199], a[164:167], v[56:59], v[196:199]
    v_exp_f32 v106, v106
    v_mfma_f32_16x16x32_bf16 v[228:231], a[164:167], v[60:63], v[228:231]
    ds_read_b128 a[152:155], v18 offset:22528
    v_mfma_f32_16x16x32_bf16 v[200:203], a[168:171], v[56:59], v[200:203]
    v_exp_f32 v107, v107
    v_mfma_f32_16x16x32_bf16 v[232:235], a[168:171], v[60:63], v[232:235]
    ds_read_b128 a[156:159], v18 offset:23552
    v_cvt_pk_bf16_f32 v53, v106, v107
    v_mfma_f32_16x16x32_bf16 v[204:207], a[172:175], v[56:59], v[204:207]
    v_exp_f32 v108, v108
    v_mfma_f32_16x16x32_bf16 v[236:239], a[172:175], v[60:63], v[236:239]
    buffer_store_dwordx4 v[24:27], v23, s[8:11], s27 offen offset:512 sc0 sc1
    v_mfma_f32_16x16x32_bf16 v[208:211], a[176:179], v[56:59], v[208:211]
    s_add_u32 s27, s18, 131072
    v_exp_f32 v109, v109
    v_mfma_f32_16x16x32_bf16 v[240:243], a[176:179], v[60:63], v[240:243]
    v_cvt_pk_bf16_f32 v54, v108, v109
    v_xor_b32 v18, 196608, v18
    v_mfma_f32_16x16x32_bf16 v[212:215], a[180:183], v[56:59], v[212:215]
    v_exp_f32 v110, v110
    v_mfma_f32_16x16x32_bf16 v[244:247], a[180:183], v[60:63], v[244:247]
    buffer_store_dwordx4 v[24:27], v23, s[8:11], s27 offen offset:512 sc0 sc1
    v_mfma_f32_16x16x32_bf16 v[216:219], a[184:187], v[56:59], v[216:219]
    v_exp_f32 v111, v111
    v_mfma_f32_16x16x32_bf16 v[248:251], a[184:187], v[60:63], v[248:251]
    v_cvt_pk_bf16_f32 v55, v110, v111
    v_mfma_f32_16x16x32_bf16 v[220:223], a[188:191], v[56:59], v[220:223]
    v_mfma_f32_16x16x32_bf16 v[252:255], a[188:191], v[60:63], v[252:255]
    s_waitcnt vmcnt(8) lgkmcnt(0)
    s_barrier
    buffer_store_dword v6, v5, s[8:11], s22 offen sc0 sc1
    v_mfma_f32_16x16x32_bf16 v[96:99], a[128:131], a[192:195], v[64:67]
    s_add_u32 m0, s15, 0
    ds_read_b128 a[160:163], v19 offset:0
    v_mfma_f32_16x16x32_bf16 v[96:99], a[132:135], a[196:199], v[96:99]
    ds_read_b128 a[164:167], v19 offset:1024
    v_mfma_f32_16x16x32_bf16 v[96:99], a[136:139], a[200:203], v[96:99]
    v_exp_f32 v112, v112
    v_mfma_f32_16x16x32_bf16 v[96:99], a[140:143], a[204:207], v[96:99]
    buffer_load_dwordx4 v1, s[8:11], s82 offen offset:0 lds
    v_mfma_f32_16x16x32_bf16 v[104:107], a[128:131], a[208:211], v[68:71]
    v_exp_f32 v113, v113
    v_mfma_f32_16x16x32_bf16 v[104:107], a[132:135], a[212:215], v[104:107]
    ds_read_b128 a[168:171], v19 offset:2048
    v_cvt_pk_bf16_f32 v56, v112, v113
    v_mfma_f32_16x16x32_bf16 v[104:107], a[136:139], a[216:219], v[104:107]
    v_exp_f32 v114, v114
    v_mfma_f32_16x16x32_bf16 v[104:107], a[140:143], a[220:223], v[104:107]
    buffer_load_dwordx4 v1, s[8:11], s82 offen offset:1024 lds
    v_mfma_f32_16x16x32_bf16 v[100:103], a[144:147], a[192:195], v[64:67]
    v_exp_f32 v115, v115
    v_mfma_f32_16x16x32_bf16 v[100:103], a[148:151], a[196:199], v[100:103]
    ds_read_b128 a[172:175], v19 offset:3072
    v_cvt_pk_bf16_f32 v57, v114, v115
    v_mfma_f32_16x16x32_bf16 v[100:103], a[152:155], a[200:203], v[100:103]
    v_exp_f32 v116, v116
    v_mfma_f32_16x16x32_bf16 v[100:103], a[156:159], a[204:207], v[100:103]
    buffer_load_dwordx4 v1, s[8:11], s82 offen offset:2048 lds
    v_mfma_f32_16x16x32_bf16 v[108:111], a[144:147], a[208:211], v[68:71]
    v_exp_f32 v117, v117
    v_mfma_f32_16x16x32_bf16 v[108:111], a[148:151], a[212:215], v[108:111]
    ds_read_b128 a[176:179], v20 offset:4096
    v_cvt_pk_bf16_f32 v58, v116, v117
    v_mfma_f32_16x16x32_bf16 v[108:111], a[152:155], a[216:219], v[108:111]
    v_exp_f32 v118, v118
    v_mfma_f32_16x16x32_bf16 v[108:111], a[156:159], a[220:223], v[108:111]
    buffer_load_dwordx4 v1, s[8:11], s82 offen offset:3072 lds
    v_mfma_f32_16x16x32_bf16 v[32:35], v[28:31], v[48:51], v[32:35]
    s_add_u32 m0, s15, 4096
    v_exp_f32 v119, v119
    v_mfma_f32_16x16x32_bf16 v[36:39], v[28:31], v[52:55], v[36:39]
    s_waitcnt lgkmcnt(4)
    ds_read_b128 a[180:183], v20 offset:5120
    v_cvt_pk_bf16_f32 v59, v118, v119
    v_mfma_f32_16x16x32_bf16 v[128:131], a[160:163], v[48:51], v[128:131]
    v_exp_f32 v120, v120
    v_mfma_f32_16x16x32_bf16 v[160:163], a[160:163], v[52:55], v[160:163]
    s_waitcnt lgkmcnt(4)
    v_mfma_f32_16x16x32_bf16 v[132:135], a[164:167], v[48:51], v[132:135]
    v_exp_f32 v121, v121
    v_mfma_f32_16x16x32_bf16 v[164:167], a[164:167], v[52:55], v[164:167]
    s_waitcnt lgkmcnt(3)
    ds_read_b128 a[184:187], v20 offset:6144
    v_cvt_pk_bf16_f32 v60, v120, v121
    v_mfma_f32_16x16x32_bf16 v[136:139], a[168:171], v[48:51], v[136:139]
    s_waitcnt lgkmcnt(3)
    v_exp_f32 v122, v122
    v_mfma_f32_16x16x32_bf16 v[168:171], a[168:171], v[52:55], v[168:171]
    buffer_load_dwordx4 v15, s[8:11], s82 offen offset:0 lds
    v_mfma_f32_16x16x32_bf16 v[140:143], a[172:175], v[48:51], v[140:143]
    v_exp_f32 v123, v123
    v_mfma_f32_16x16x32_bf16 v[172:175], a[172:175], v[52:55], v[172:175]
    s_waitcnt lgkmcnt(2)
    ds_read_b128 a[188:191], v20 offset:7168
    v_cvt_pk_bf16_f32 v61, v122, v123
    v_mfma_f32_16x16x32_bf16 v[144:147], a[176:179], v[48:51], v[144:147]
    s_waitcnt lgkmcnt(2)
    v_exp_f32 v124, v124
    v_mfma_f32_16x16x32_bf16 v[176:179], a[176:179], v[52:55], v[176:179]
    buffer_load_dwordx4 v15, s[8:11], s82 offen offset:1024 lds
    v_mfma_f32_16x16x32_bf16 v[148:151], a[180:183], v[48:51], v[148:151]
    v_exp_f32 v125, v125
    v_mfma_f32_16x16x32_bf16 v[180:183], a[180:183], v[52:55], v[180:183]
    s_waitcnt lgkmcnt(1)
    v_cvt_pk_bf16_f32 v62, v124, v125
    v_mfma_f32_16x16x32_bf16 v[152:155], a[184:187], v[48:51], v[152:155]
    s_waitcnt lgkmcnt(0)
    v_exp_f32 v126, v126
    v_mfma_f32_16x16x32_bf16 v[184:187], a[184:187], v[52:55], v[184:187]
    buffer_load_dwordx4 v15, s[8:11], s82 offen offset:2048 lds
    v_mfma_f32_16x16x32_bf16 v[156:159], a[188:191], v[48:51], v[156:159]
    v_exp_f32 v127, v127
    v_mfma_f32_16x16x32_bf16 v[188:191], a[188:191], v[52:55], v[188:191]
    v_cvt_pk_bf16_f32 v63, v126, v127
    v_mfma_f32_16x16x32_bf16 v[112:115], a[128:131], a[224:227], v[72:75]
    v_mfma_f32_16x16x32_bf16 v[112:115], a[132:135], a[228:231], v[112:115]
    v_mfma_f32_16x16x32_bf16 v[112:115], a[136:139], a[232:235], v[112:115]
    v_exp_f32 v96, v96
    v_mfma_f32_16x16x32_bf16 v[112:115], a[140:143], a[236:239], v[112:115]
    buffer_load_dwordx4 v15, s[8:11], s82 offen offset:3072 lds
    v_mfma_f32_16x16x32_bf16 v[120:123], a[128:131], a[240:243], v[76:79]
    s_xor_b32 s15, s15, 196608
    v_exp_f32 v97, v97
    v_mfma_f32_16x16x32_bf16 v[120:123], a[132:135], a[244:247], v[120:123]
    s_add_u32 m0, s16, 0
    ds_read_b128 a[128:131], v18 offset:0
    v_cvt_pk_bf16_f32 v48, v96, v97
    v_mfma_f32_16x16x32_bf16 v[120:123], a[136:139], a[248:251], v[120:123]
    v_exp_f32 v98, v98
    v_mfma_f32_16x16x32_bf16 v[120:123], a[140:143], a[252:255], v[120:123]
    buffer_load_dwordx4 v1, s[8:11], s19 offen offset:0 lds
    v_mfma_f32_16x16x32_bf16 v[116:119], a[144:147], a[224:227], v[72:75]
    v_exp_f32 v99, v99
    v_mfma_f32_16x16x32_bf16 v[116:119], a[148:151], a[228:231], v[116:119]
    ds_read_b128 a[132:135], v18 offset:1024
    v_cvt_pk_bf16_f32 v49, v98, v99
    v_mfma_f32_16x16x32_bf16 v[116:119], a[152:155], a[232:235], v[116:119]
    v_exp_f32 v100, v100
    v_mfma_f32_16x16x32_bf16 v[116:119], a[156:159], a[236:239], v[116:119]
    buffer_load_dwordx4 v1, s[8:11], s19 offen offset:1024 lds
    v_mfma_f32_16x16x32_bf16 v[124:127], a[144:147], a[240:243], v[76:79]
    v_exp_f32 v101, v101
    v_mfma_f32_16x16x32_bf16 v[124:127], a[148:151], a[244:247], v[124:127]
    ds_read_b128 a[136:139], v18 offset:2048
    v_cvt_pk_bf16_f32 v50, v100, v101
    v_mfma_f32_16x16x32_bf16 v[124:127], a[152:155], a[248:251], v[124:127]
    v_exp_f32 v102, v102
    v_mfma_f32_16x16x32_bf16 v[124:127], a[156:159], a[252:255], v[124:127]
    buffer_load_dwordx4 v1, s[8:11], s19 offen offset:2048 lds
    v_mfma_f32_16x16x32_bf16 v[40:43], v[28:31], v[56:59], v[40:43]
    v_exp_f32 v103, v103
    v_mfma_f32_16x16x32_bf16 v[44:47], v[28:31], v[60:63], v[44:47]
    ds_read_b128 a[140:143], v18 offset:3072
    v_cvt_pk_bf16_f32 v51, v102, v103
    v_mfma_f32_16x16x32_bf16 v[192:195], a[160:163], v[56:59], v[192:195]
    v_exp_f32 v104, v104
    v_mfma_f32_16x16x32_bf16 v[224:227], a[160:163], v[60:63], v[224:227]
    v_mfma_f32_16x16x32_bf16 v[196:199], a[164:167], v[56:59], v[196:199]
    v_exp_f32 v105, v105
    v_mfma_f32_16x16x32_bf16 v[228:231], a[164:167], v[60:63], v[228:231]
    ds_read_b128 a[144:147], v18 offset:4096
    v_cvt_pk_bf16_f32 v52, v104, v105
    v_mfma_f32_16x16x32_bf16 v[200:203], a[168:171], v[56:59], v[200:203]
    v_exp_f32 v106, v106
    v_mfma_f32_16x16x32_bf16 v[232:235], a[168:171], v[60:63], v[232:235]
    buffer_load_dwordx4 v1, s[8:11], s19 offen offset:3072 lds
    v_mfma_f32_16x16x32_bf16 v[204:207], a[172:175], v[56:59], v[204:207]
    s_add_u32 m0, s16, 4096
    v_exp_f32 v107, v107
    v_mfma_f32_16x16x32_bf16 v[236:239], a[172:175], v[60:63], v[236:239]
    ds_read_b128 a[148:151], v18 offset:5120
    v_cvt_pk_bf16_f32 v53, v106, v107
    v_mfma_f32_16x16x32_bf16 v[208:211], a[176:179], v[56:59], v[208:211]
    v_exp_f32 v108, v108
    v_mfma_f32_16x16x32_bf16 v[240:243], a[176:179], v[60:63], v[240:243]
    buffer_load_dwordx4 v15, s[8:11], s19 offen offset:0 lds
    v_mfma_f32_16x16x32_bf16 v[212:215], a[180:183], v[56:59], v[212:215]
    v_exp_f32 v109, v109
    v_mfma_f32_16x16x32_bf16 v[244:247], a[180:183], v[60:63], v[244:247]
    ds_read_b128 a[152:155], v18 offset:6144
    v_cvt_pk_bf16_f32 v54, v108, v109
    v_mfma_f32_16x16x32_bf16 v[216:219], a[184:187], v[56:59], v[216:219]
    v_exp_f32 v110, v110
    v_mfma_f32_16x16x32_bf16 v[248:251], a[184:187], v[60:63], v[248:251]
    buffer_load_dwordx4 v15, s[8:11], s19 offen offset:1024 lds
    v_mfma_f32_16x16x32_bf16 v[220:223], a[188:191], v[56:59], v[220:223]
    v_exp_f32 v111, v111
    v_mfma_f32_16x16x32_bf16 v[252:255], a[188:191], v[60:63], v[252:255]
    ds_read_b128 a[156:159], v18 offset:7168
    v_cvt_pk_bf16_f32 v55, v110, v111
    s_waitcnt lgkmcnt(7)
    v_mfma_f32_16x16x32_bf16 v[96:99], a[128:131], a[192:195], v[64:67]
    s_waitcnt lgkmcnt(6)
    ds_read_b128 a[160:163], v19 offset:16384
    v_lshrrev_b32 v9, 1, v2
    v_mfma_f32_16x16x32_bf16 v[96:99], a[132:135], a[196:199], v[96:99]
    s_waitcnt lgkmcnt(6)
    ds_read_b128 a[164:167], v19 offset:17408
    v_lshrrev_b32 v10, 4, v2
    v_mfma_f32_16x16x32_bf16 v[96:99], a[136:139], a[200:203], v[96:99]
    s_waitcnt lgkmcnt(6)
    v_exp_f32 v112, v112
    v_mfma_f32_16x16x32_bf16 v[96:99], a[140:143], a[204:207], v[96:99]
    buffer_load_dwordx4 v15, s[8:11], s19 offen offset:2048 lds
    v_mfma_f32_16x16x32_bf16 v[104:107], a[128:131], a[208:211], v[68:71]
    v_exp_f32 v113, v113
    v_mfma_f32_16x16x32_bf16 v[104:107], a[132:135], a[212:215], v[104:107]
    ds_read_b128 a[168:171], v19 offset:18432
    v_cvt_pk_bf16_f32 v56, v112, v113
    v_mfma_f32_16x16x32_bf16 v[104:107], a[136:139], a[216:219], v[104:107]
    s_waitcnt lgkmcnt(6)
    v_exp_f32 v114, v114
    v_mfma_f32_16x16x32_bf16 v[104:107], a[140:143], a[220:223], v[104:107]
    buffer_load_dwordx4 v15, s[8:11], s19 offen offset:3072 lds
    v_mfma_f32_16x16x32_bf16 v[100:103], a[144:147], a[192:195], v[64:67]
    s_waitcnt lgkmcnt(5)
    s_xor_b32 s16, s16, 98304
    v_exp_f32 v115, v115
    v_mfma_f32_16x16x32_bf16 v[100:103], a[148:151], a[196:199], v[100:103]
    s_waitcnt lgkmcnt(4)
    s_add_u32 s17, s17, 2093056
    ds_read_b128 a[172:175], v19 offset:19456
    v_cvt_pk_bf16_f32 v57, v114, v115
    v_mfma_f32_16x16x32_bf16 v[100:103], a[152:155], a[200:203], v[100:103]
    s_waitcnt lgkmcnt(4)
    v_exp_f32 v116, v116
    v_mfma_f32_16x16x32_bf16 v[100:103], a[156:159], a[204:207], v[100:103]
    buffer_store_dwordx4 a[8:11], v12, s[8:11], s17 offen sc0 sc1
    v_mfma_f32_16x16x32_bf16 v[108:111], a[144:147], a[208:211], v[68:71]
    s_add_u32 s27, s18, 0
    v_exp_f32 v117, v117
    v_mfma_f32_16x16x32_bf16 v[108:111], a[148:151], a[212:215], v[108:111]
    ds_read_b128 a[176:179], v20 offset:20480
    v_cvt_pk_bf16_f32 v58, v116, v117
    v_mfma_f32_16x16x32_bf16 v[108:111], a[152:155], a[216:219], v[108:111]
    v_exp_f32 v118, v118
    v_mfma_f32_16x16x32_bf16 v[108:111], a[156:159], a[220:223], v[108:111]
    buffer_store_dwordx4 v[24:27], v23, s[8:11], s27 offen offset:768 sc0 sc1
    v_mfma_f32_16x16x32_bf16 v[32:35], v[28:31], v[48:51], v[32:35]
    s_add_u32 s27, s18, 131072
    v_exp_f32 v119, v119
    v_mfma_f32_16x16x32_bf16 v[36:39], v[28:31], v[52:55], v[36:39]
    s_waitcnt lgkmcnt(4)
    ds_read_b128 a[180:183], v20 offset:21504
    v_cvt_pk_bf16_f32 v59, v118, v119
    v_mfma_f32_16x16x32_bf16 v[128:131], a[160:163], v[48:51], v[128:131]
    s_waitcnt lgkmcnt(4)
    v_exp_f32 v120, v120
    v_mfma_f32_16x16x32_bf16 v[160:163], a[160:163], v[52:55], v[160:163]
    buffer_store_dwordx4 v[24:27], v23, s[8:11], s27 offen offset:768 sc0 sc1
    v_mfma_f32_16x16x32_bf16 v[132:135], a[164:167], v[48:51], v[132:135]
    v_exp_f32 v121, v121
    v_mfma_f32_16x16x32_bf16 v[164:167], a[164:167], v[52:55], v[164:167]
    s_waitcnt lgkmcnt(3)
    ds_read_b128 a[184:187], v20 offset:22528
    v_cvt_pk_bf16_f32 v60, v120, v121
    v_mfma_f32_16x16x32_bf16 v[136:139], a[168:171], v[48:51], v[136:139]
    v_exp_f32 v122, v122
    v_mfma_f32_16x16x32_bf16 v[168:171], a[168:171], v[52:55], v[168:171]
    s_waitcnt lgkmcnt(3)
    v_xor_b32 v9, v9, v10
    v_and_b32 v9, 3, v9
    v_mfma_f32_16x16x32_bf16 v[140:143], a[172:175], v[48:51], v[140:143]
    v_exp_f32 v123, v123
    v_mfma_f32_16x16x32_bf16 v[172:175], a[172:175], v[52:55], v[172:175]
    s_waitcnt lgkmcnt(2)
    ds_read_b128 a[188:191], v20 offset:23552
    v_cvt_pk_bf16_f32 v61, v122, v123
    v_mfma_f32_16x16x32_bf16 v[144:147], a[176:179], v[48:51], v[144:147]
    v_exp_f32 v124, v124
    v_mfma_f32_16x16x32_bf16 v[176:179], a[176:179], v[52:55], v[176:179]
    s_waitcnt lgkmcnt(2)
    v_lshlrev_b32 v9, 5, v9
    v_and_b32 v10, 1, v2
    v_mfma_f32_16x16x32_bf16 v[148:151], a[180:183], v[48:51], v[148:151]
    v_exp_f32 v125, v125
    v_mfma_f32_16x16x32_bf16 v[180:183], a[180:183], v[52:55], v[180:183]
    s_waitcnt lgkmcnt(1)
    v_cvt_pk_bf16_f32 v62, v124, v125
    v_xor_b32 v19, 98304, v19
    v_mfma_f32_16x16x32_bf16 v[152:155], a[184:187], v[48:51], v[152:155]
    v_exp_f32 v126, v126
    v_mfma_f32_16x16x32_bf16 v[184:187], a[184:187], v[52:55], v[184:187]
    s_waitcnt lgkmcnt(0)
    v_xor_b32 v20, 98304, v20
    v_mfma_f32_16x16x32_bf16 v[156:159], a[188:191], v[48:51], v[156:159]
    v_exp_f32 v127, v127
    v_mfma_f32_16x16x32_bf16 v[188:191], a[188:191], v[52:55], v[188:191]
    v_cvt_pk_bf16_f32 v63, v126, v127
    v_mfma_f32_16x16x32_bf16 v[112:115], a[128:131], a[224:227], v[72:75]
    s_add_u32 s17, s17, 4096
    v_exp_f32 v96, v96
    v_mfma_f32_16x16x32_bf16 v[112:115], a[132:135], a[228:231], v[112:115]
    buffer_store_dwordx4 a[12:15], v12, s[8:11], s17 offen sc0 sc1
    v_mfma_f32_16x16x32_bf16 v[112:115], a[136:139], a[232:235], v[112:115]
    s_add_u32 s27, s18, 8388608
    v_exp_f32 v97, v97
    v_mfma_f32_16x16x32_bf16 v[112:115], a[140:143], a[236:239], v[112:115]
    v_cvt_pk_bf16_f32 v48, v96, v97
    v_lshl_add_u32 v9, v10, 4, v9
    v_mfma_f32_16x16x32_bf16 v[120:123], a[128:131], a[240:243], v[76:79]
    v_exp_f32 v98, v98
    v_mfma_f32_16x16x32_bf16 v[120:123], a[132:135], a[244:247], v[120:123]
    buffer_store_dwordx4 v[24:27], v23, s[8:11], s27 offen offset:0 sc0 sc1
    v_mfma_f32_16x16x32_bf16 v[120:123], a[136:139], a[248:251], v[120:123]
    s_add_u32 s27, s18, 8519680
    v_exp_f32 v99, v99
    v_mfma_f32_16x16x32_bf16 v[120:123], a[140:143], a[252:255], v[120:123]
    buffer_store_dwordx4 v[24:27], v23, s[8:11], s27 offen offset:0 sc0 sc1
    v_mfma_f32_16x16x32_bf16 v[116:119], a[144:147], a[224:227], v[72:75]
    s_add_u32 s27, s18, 8388608
    v_exp_f32 v100, v100
    v_mfma_f32_16x16x32_bf16 v[116:119], a[148:151], a[228:231], v[116:119]
    ds_read_b128 a[128:131], v18 offset:16384
    v_cvt_pk_bf16_f32 v49, v98, v99
    v_mfma_f32_16x16x32_bf16 v[116:119], a[152:155], a[232:235], v[116:119]
    s_add_u32 s19, s82, 32768
    v_exp_f32 v101, v101
    v_mfma_f32_16x16x32_bf16 v[116:119], a[156:159], a[236:239], v[116:119]
    s_sub_u32 s82, s12, s13
    ds_read_b128 a[132:135], v18 offset:17408
    v_cvt_pk_bf16_f32 v50, v100, v101
    v_mfma_f32_16x16x32_bf16 v[124:127], a[144:147], a[240:243], v[76:79]
    s_sub_u32 s82, s82, 1
    v_exp_f32 v102, v102
    v_mfma_f32_16x16x32_bf16 v[124:127], a[148:151], a[244:247], v[124:127]
    s_cmp_gt_u32 s12, s13
    s_cselect_b32 s82, s82, s12
    s_lshl_b32 s82, s82, 16
    ds_read_b128 a[136:139], v18 offset:18432
    v_mfma_f32_16x16x32_bf16 v[124:127], a[152:155], a[248:251], v[124:127]
    s_add_u32 s82, s82, s81
    v_exp_f32 v103, v103
    v_mfma_f32_16x16x32_bf16 v[124:127], a[156:159], a[252:255], v[124:127]
    s_cmp_ge_u32 s12, 17
    s_cselect_b32 s82, 2147471360, s82
    ds_read_b128 a[140:143], v18 offset:19456
    v_cvt_pk_bf16_f32 v51, v102, v103
    v_mfma_f32_16x16x32_bf16 v[40:43], v[28:31], v[56:59], v[40:43]
    s_add_u32 s12, s12, 1
    v_exp_f32 v104, v104
    v_mfma_f32_16x16x32_bf16 v[44:47], v[28:31], v[60:63], v[44:47]
    ds_read_b128 a[144:147], v18 offset:20480
    v_lshrrev_b32 v8, 3, v2
    v_mfma_f32_16x16x32_bf16 v[192:195], a[160:163], v[56:59], v[192:195]
    v_exp_f32 v105, v105
    v_mfma_f32_16x16x32_bf16 v[224:227], a[160:163], v[60:63], v[224:227]
    ds_read_b128 a[148:151], v18 offset:21504
    v_cvt_pk_bf16_f32 v52, v104, v105
    v_mfma_f32_16x16x32_bf16 v[196:199], a[164:167], v[56:59], v[196:199]
    v_exp_f32 v106, v106
    v_mfma_f32_16x16x32_bf16 v[228:231], a[164:167], v[60:63], v[228:231]
    ds_read_b128 a[152:155], v18 offset:22528
    v_lshl_add_u32 v8, v8, 10, v9
    v_mfma_f32_16x16x32_bf16 v[200:203], a[168:171], v[56:59], v[200:203]
    v_exp_f32 v107, v107
    v_mfma_f32_16x16x32_bf16 v[232:235], a[168:171], v[60:63], v[232:235]
    ds_read_b128 a[156:159], v18 offset:23552
    v_cvt_pk_bf16_f32 v53, v106, v107
    v_mfma_f32_16x16x32_bf16 v[204:207], a[172:175], v[56:59], v[204:207]
    v_exp_f32 v108, v108
    v_mfma_f32_16x16x32_bf16 v[236:239], a[172:175], v[60:63], v[236:239]
    buffer_store_dwordx4 v[24:27], v23, s[8:11], s27 offen offset:256 sc0 sc1
    v_mfma_f32_16x16x32_bf16 v[208:211], a[176:179], v[56:59], v[208:211]
    v_exp_f32 v109, v109
    v_mfma_f32_16x16x32_bf16 v[240:243], a[176:179], v[60:63], v[240:243]
    v_cvt_pk_bf16_f32 v54, v108, v109
    v_xor_b32 v18, 196608, v18
    v_mfma_f32_16x16x32_bf16 v[212:215], a[180:183], v[56:59], v[212:215]
    v_exp_f32 v110, v110
    v_mfma_f32_16x16x32_bf16 v[244:247], a[180:183], v[60:63], v[244:247]
    v_bfe_u32 v4, v2, 1, 2
    v_lshlrev_b32 v4, 11, v4
    v_mfma_f32_16x16x32_bf16 v[216:219], a[184:187], v[56:59], v[216:219]
    v_exp_f32 v111, v111
    v_mfma_f32_16x16x32_bf16 v[248:251], a[184:187], v[60:63], v[248:251]
    v_cvt_pk_bf16_f32 v55, v110, v111
    v_lshl_add_u32 v4, v10, 6, v4
    v_mfma_f32_16x16x32_bf16 v[220:223], a[188:191], v[56:59], v[220:223]
    v_add_u32 v9, 7168, v8
    v_add_u32 v10, 14336, v8
    v_mfma_f32_16x16x32_bf16 v[252:255], a[188:191], v[60:63], v[252:255]
    v_add_u32 v11, 21504, v8
    s_waitcnt vmcnt(7) lgkmcnt(0)
    s_barrier
    v_mfma_f32_16x16x32_bf16 v[96:99], a[128:131], a[192:195], v[64:67]
    s_add_u32 m0, s15, 0
    ds_read_b128 a[160:163], v19 offset:0
    v_mfma_f32_16x16x32_bf16 v[96:99], a[132:135], a[196:199], v[96:99]
    ds_read_b128 a[164:167], v19 offset:1024
    v_mfma_f32_16x16x32_bf16 v[96:99], a[136:139], a[200:203], v[96:99]
    v_exp_f32 v112, v112
    v_mfma_f32_16x16x32_bf16 v[96:99], a[140:143], a[204:207], v[96:99]
    buffer_load_dwordx4 v1, s[8:11], s82 offen offset:0 lds
    v_mfma_f32_16x16x32_bf16 v[104:107], a[128:131], a[208:211], v[68:71]
    v_exp_f32 v113, v113
    v_mfma_f32_16x16x32_bf16 v[104:107], a[132:135], a[212:215], v[104:107]
    ds_read_b128 a[168:171], v19 offset:2048
    v_cvt_pk_bf16_f32 v56, v112, v113
    v_mfma_f32_16x16x32_bf16 v[104:107], a[136:139], a[216:219], v[104:107]
    v_exp_f32 v114, v114
    v_mfma_f32_16x16x32_bf16 v[104:107], a[140:143], a[220:223], v[104:107]
    buffer_load_dwordx4 v1, s[8:11], s82 offen offset:1024 lds
    v_mfma_f32_16x16x32_bf16 v[100:103], a[144:147], a[192:195], v[64:67]
    v_exp_f32 v115, v115
    v_mfma_f32_16x16x32_bf16 v[100:103], a[148:151], a[196:199], v[100:103]
    ds_read_b128 a[172:175], v19 offset:3072
    v_cvt_pk_bf16_f32 v57, v114, v115
    v_mfma_f32_16x16x32_bf16 v[100:103], a[152:155], a[200:203], v[100:103]
    v_exp_f32 v116, v116
    v_mfma_f32_16x16x32_bf16 v[100:103], a[156:159], a[204:207], v[100:103]
    buffer_load_dwordx4 v1, s[8:11], s82 offen offset:2048 lds
    v_mfma_f32_16x16x32_bf16 v[108:111], a[144:147], a[208:211], v[68:71]
    v_exp_f32 v117, v117
    v_mfma_f32_16x16x32_bf16 v[108:111], a[148:151], a[212:215], v[108:111]
    ds_read_b128 a[176:179], v20 offset:4096
    v_cvt_pk_bf16_f32 v58, v116, v117
    v_mfma_f32_16x16x32_bf16 v[108:111], a[152:155], a[216:219], v[108:111]
    v_exp_f32 v118, v118
    v_mfma_f32_16x16x32_bf16 v[108:111], a[156:159], a[220:223], v[108:111]
    buffer_load_dwordx4 v1, s[8:11], s82 offen offset:3072 lds
    v_mfma_f32_16x16x32_bf16 v[32:35], v[28:31], v[48:51], v[32:35]
    s_add_u32 m0, s15, 4096
    v_exp_f32 v119, v119
    v_mfma_f32_16x16x32_bf16 v[36:39], v[28:31], v[52:55], v[36:39]
    s_waitcnt lgkmcnt(4)
    ds_read_b128 a[180:183], v20 offset:5120
    v_cvt_pk_bf16_f32 v59, v118, v119
    v_mfma_f32_16x16x32_bf16 v[128:131], a[160:163], v[48:51], v[128:131]
    v_exp_f32 v120, v120
    v_mfma_f32_16x16x32_bf16 v[160:163], a[160:163], v[52:55], v[160:163]
    s_waitcnt lgkmcnt(4)
    v_mfma_f32_16x16x32_bf16 v[132:135], a[164:167], v[48:51], v[132:135]
    v_exp_f32 v121, v121
    v_mfma_f32_16x16x32_bf16 v[164:167], a[164:167], v[52:55], v[164:167]
    s_waitcnt lgkmcnt(3)
    ds_read_b128 a[184:187], v20 offset:6144
    v_cvt_pk_bf16_f32 v60, v120, v121
    v_mfma_f32_16x16x32_bf16 v[136:139], a[168:171], v[48:51], v[136:139]
    s_waitcnt lgkmcnt(3)
    v_exp_f32 v122, v122
    v_mfma_f32_16x16x32_bf16 v[168:171], a[168:171], v[52:55], v[168:171]
    buffer_load_dwordx4 v15, s[8:11], s82 offen offset:0 lds
    v_mfma_f32_16x16x32_bf16 v[140:143], a[172:175], v[48:51], v[140:143]
    v_exp_f32 v123, v123
    v_mfma_f32_16x16x32_bf16 v[172:175], a[172:175], v[52:55], v[172:175]
    s_waitcnt lgkmcnt(2)
    ds_read_b128 a[188:191], v20 offset:7168
    v_cvt_pk_bf16_f32 v61, v122, v123
    v_mfma_f32_16x16x32_bf16 v[144:147], a[176:179], v[48:51], v[144:147]
    s_waitcnt lgkmcnt(2)
    v_exp_f32 v124, v124
    v_mfma_f32_16x16x32_bf16 v[176:179], a[176:179], v[52:55], v[176:179]
    buffer_load_dwordx4 v15, s[8:11], s82 offen offset:1024 lds
    v_mfma_f32_16x16x32_bf16 v[148:151], a[180:183], v[48:51], v[148:151]
    v_exp_f32 v125, v125
    v_mfma_f32_16x16x32_bf16 v[180:183], a[180:183], v[52:55], v[180:183]
    s_waitcnt lgkmcnt(1)
    v_cvt_pk_bf16_f32 v62, v124, v125
    v_mfma_f32_16x16x32_bf16 v[152:155], a[184:187], v[48:51], v[152:155]
    s_waitcnt lgkmcnt(0)
    v_exp_f32 v126, v126
    v_mfma_f32_16x16x32_bf16 v[184:187], a[184:187], v[52:55], v[184:187]
    buffer_load_dwordx4 v15, s[8:11], s82 offen offset:2048 lds
    v_mfma_f32_16x16x32_bf16 v[156:159], a[188:191], v[48:51], v[156:159]
    v_exp_f32 v127, v127
    v_mfma_f32_16x16x32_bf16 v[188:191], a[188:191], v[52:55], v[188:191]
    v_cvt_pk_bf16_f32 v63, v126, v127
    v_mfma_f32_16x16x32_bf16 v[112:115], a[128:131], a[224:227], v[72:75]
    v_mfma_f32_16x16x32_bf16 v[112:115], a[132:135], a[228:231], v[112:115]
    v_mfma_f32_16x16x32_bf16 v[112:115], a[136:139], a[232:235], v[112:115]
    v_exp_f32 v96, v96
    v_mfma_f32_16x16x32_bf16 v[112:115], a[140:143], a[236:239], v[112:115]
    buffer_load_dwordx4 v15, s[8:11], s82 offen offset:3072 lds
    v_mfma_f32_16x16x32_bf16 v[120:123], a[128:131], a[240:243], v[76:79]
    s_xor_b32 s15, s15, 196608
    v_exp_f32 v97, v97
    v_mfma_f32_16x16x32_bf16 v[120:123], a[132:135], a[244:247], v[120:123]
    s_add_u32 m0, s16, 0
    ds_read_b128 a[128:131], v18 offset:0
    v_cvt_pk_bf16_f32 v48, v96, v97
    v_mfma_f32_16x16x32_bf16 v[120:123], a[136:139], a[248:251], v[120:123]
    v_exp_f32 v98, v98
    v_mfma_f32_16x16x32_bf16 v[120:123], a[140:143], a[252:255], v[120:123]
    buffer_load_dwordx4 v1, s[8:11], s19 offen offset:0 lds
    v_mfma_f32_16x16x32_bf16 v[116:119], a[144:147], a[224:227], v[72:75]
    v_exp_f32 v99, v99
    v_mfma_f32_16x16x32_bf16 v[116:119], a[148:151], a[228:231], v[116:119]
    ds_read_b128 a[132:135], v18 offset:1024
    v_cvt_pk_bf16_f32 v49, v98, v99
    v_mfma_f32_16x16x32_bf16 v[116:119], a[152:155], a[232:235], v[116:119]
    v_exp_f32 v100, v100
    v_mfma_f32_16x16x32_bf16 v[116:119], a[156:159], a[236:239], v[116:119]
    buffer_load_dwordx4 v1, s[8:11], s19 offen offset:1024 lds
    v_mfma_f32_16x16x32_bf16 v[124:127], a[144:147], a[240:243], v[76:79]
    v_exp_f32 v101, v101
    v_mfma_f32_16x16x32_bf16 v[124:127], a[148:151], a[244:247], v[124:127]
    ds_read_b128 a[136:139], v18 offset:2048
    v_cvt_pk_bf16_f32 v50, v100, v101
    v_mfma_f32_16x16x32_bf16 v[124:127], a[152:155], a[248:251], v[124:127]
    v_exp_f32 v102, v102
    v_mfma_f32_16x16x32_bf16 v[124:127], a[156:159], a[252:255], v[124:127]
    buffer_load_dwordx4 v1, s[8:11], s19 offen offset:2048 lds
    v_mfma_f32_16x16x32_bf16 v[40:43], v[28:31], v[56:59], v[40:43]
    v_exp_f32 v103, v103
    v_mfma_f32_16x16x32_bf16 v[44:47], v[28:31], v[60:63], v[44:47]
    ds_read_b128 a[140:143], v18 offset:3072
    v_cvt_pk_bf16_f32 v51, v102, v103
    v_mfma_f32_16x16x32_bf16 v[192:195], a[160:163], v[56:59], v[192:195]
    v_exp_f32 v104, v104
    v_mfma_f32_16x16x32_bf16 v[224:227], a[160:163], v[60:63], v[224:227]
    v_mfma_f32_16x16x32_bf16 v[196:199], a[164:167], v[56:59], v[196:199]
    v_exp_f32 v105, v105
    v_mfma_f32_16x16x32_bf16 v[228:231], a[164:167], v[60:63], v[228:231]
    ds_read_b128 a[144:147], v18 offset:4096
    v_cvt_pk_bf16_f32 v52, v104, v105
    v_mfma_f32_16x16x32_bf16 v[200:203], a[168:171], v[56:59], v[200:203]
    v_exp_f32 v106, v106
    v_mfma_f32_16x16x32_bf16 v[232:235], a[168:171], v[60:63], v[232:235]
    buffer_load_dwordx4 v1, s[8:11], s19 offen offset:3072 lds
    v_mfma_f32_16x16x32_bf16 v[204:207], a[172:175], v[56:59], v[204:207]
    s_add_u32 m0, s16, 4096
    v_exp_f32 v107, v107
    v_mfma_f32_16x16x32_bf16 v[236:239], a[172:175], v[60:63], v[236:239]
    ds_read_b128 a[148:151], v18 offset:5120
    v_cvt_pk_bf16_f32 v53, v106, v107
    v_mfma_f32_16x16x32_bf16 v[208:211], a[176:179], v[56:59], v[208:211]
    v_exp_f32 v108, v108
    v_mfma_f32_16x16x32_bf16 v[240:243], a[176:179], v[60:63], v[240:243]
    buffer_load_dwordx4 v15, s[8:11], s19 offen offset:0 lds
    v_mfma_f32_16x16x32_bf16 v[212:215], a[180:183], v[56:59], v[212:215]
    v_exp_f32 v109, v109
    v_mfma_f32_16x16x32_bf16 v[244:247], a[180:183], v[60:63], v[244:247]
    ds_read_b128 a[152:155], v18 offset:6144
    v_cvt_pk_bf16_f32 v54, v108, v109
    v_mfma_f32_16x16x32_bf16 v[216:219], a[184:187], v[56:59], v[216:219]
    v_exp_f32 v110, v110
    v_mfma_f32_16x16x32_bf16 v[248:251], a[184:187], v[60:63], v[248:251]
    buffer_load_dwordx4 v15, s[8:11], s19 offen offset:1024 lds
    v_mfma_f32_16x16x32_bf16 v[220:223], a[188:191], v[56:59], v[220:223]
    v_exp_f32 v111, v111
    v_mfma_f32_16x16x32_bf16 v[252:255], a[188:191], v[60:63], v[252:255]
    ds_read_b128 a[156:159], v18 offset:7168
    v_cvt_pk_bf16_f32 v55, v110, v111
    s_waitcnt lgkmcnt(7)
    v_mfma_f32_16x16x32_bf16 v[96:99], a[128:131], a[192:195], v[64:67]
    s_waitcnt lgkmcnt(6)
    s_mul_i32 s17, s4, 229376
    s_mul_i32 s100, s3, 7168
    ds_read_b128 a[160:163], v19 offset:16384
    v_mfma_f32_16x16x32_bf16 v[96:99], a[132:135], a[196:199], v[96:99]
    s_waitcnt lgkmcnt(6)
    s_add_u32 s17, s17, s100
    s_lshl_b32 s100, s101, 7
    ds_read_b128 a[164:167], v19 offset:17408
    v_mfma_f32_16x16x32_bf16 v[96:99], a[136:139], a[200:203], v[96:99]
    s_waitcnt lgkmcnt(6)
    s_add_u32 s17, s17, s100
    v_exp_f32 v112, v112
    v_mfma_f32_16x16x32_bf16 v[96:99], a[140:143], a[204:207], v[96:99]
    buffer_load_dwordx4 v15, s[8:11], s19 offen offset:2048 lds
    v_mfma_f32_16x16x32_bf16 v[104:107], a[128:131], a[208:211], v[68:71]
    s_add_u32 s17, s17, 8388608
    v_exp_f32 v113, v113
    v_mfma_f32_16x16x32_bf16 v[104:107], a[132:135], a[212:215], v[104:107]
    s_cmp_lt_u32 s101, s26
    s_cselect_b32 s17, s17, 2147479552
    ds_read_b128 a[168:171], v19 offset:18432
    v_cvt_pk_bf16_f32 v56, v112, v113
    v_mfma_f32_16x16x32_bf16 v[104:107], a[136:139], a[216:219], v[104:107]
    s_waitcnt lgkmcnt(6)
    v_exp_f32 v114, v114
    v_mfma_f32_16x16x32_bf16 v[104:107], a[140:143], a[220:223], v[104:107]
    buffer_load_dwordx4 v15, s[8:11], s19 offen offset:3072 lds
    v_mfma_f32_16x16x32_bf16 v[100:103], a[144:147], a[192:195], v[64:67]
    s_waitcnt lgkmcnt(5)
    s_xor_b32 s16, s16, 98304
    v_exp_f32 v115, v115
    v_mfma_f32_16x16x32_bf16 v[100:103], a[148:151], a[196:199], v[100:103]
    s_waitcnt lgkmcnt(4)
    ds_read_b128 a[172:175], v19 offset:19456
    v_cvt_pk_bf16_f32 v57, v114, v115
    v_mfma_f32_16x16x32_bf16 v[100:103], a[152:155], a[200:203], v[100:103]
    s_waitcnt lgkmcnt(4)
    v_exp_f32 v116, v116
    v_mfma_f32_16x16x32_bf16 v[100:103], a[156:159], a[204:207], v[100:103]
    buffer_store_dwordx4 a[16:19], v13, s[8:11], s17 offen sc0 sc1
    v_mfma_f32_16x16x32_bf16 v[108:111], a[144:147], a[208:211], v[68:71]
    s_add_u32 s27, s18, 8519680
    v_exp_f32 v117, v117
    v_mfma_f32_16x16x32_bf16 v[108:111], a[148:151], a[212:215], v[108:111]
    ds_read_b128 a[176:179], v20 offset:20480
    v_cvt_pk_bf16_f32 v58, v116, v117
    v_mfma_f32_16x16x32_bf16 v[108:111], a[152:155], a[216:219], v[108:111]
    v_exp_f32 v118, v118
    v_mfma_f32_16x16x32_bf16 v[108:111], a[156:159], a[220:223], v[108:111]
    buffer_store_dwordx4 v[24:27], v23, s[8:11], s27 offen offset:256 sc0 sc1
    v_mfma_f32_16x16x32_bf16 v[32:35], v[28:31], v[48:51], v[32:35]
    s_add_u32 s27, s18, 8388608
    v_exp_f32 v119, v119
    v_mfma_f32_16x16x32_bf16 v[36:39], v[28:31], v[52:55], v[36:39]
    s_waitcnt lgkmcnt(4)
    ds_read_b128 a[180:183], v20 offset:21504
    v_cvt_pk_bf16_f32 v59, v118, v119
    v_mfma_f32_16x16x32_bf16 v[128:131], a[160:163], v[48:51], v[128:131]
    s_waitcnt lgkmcnt(4)
    v_exp_f32 v120, v120
    v_mfma_f32_16x16x32_bf16 v[160:163], a[160:163], v[52:55], v[160:163]
    buffer_store_dwordx4 v[24:27], v23, s[8:11], s27 offen offset:512 sc0 sc1
    v_mfma_f32_16x16x32_bf16 v[132:135], a[164:167], v[48:51], v[132:135]
    s_add_u32 s27, s18, 8519680
    v_exp_f32 v121, v121
    v_mfma_f32_16x16x32_bf16 v[164:167], a[164:167], v[52:55], v[164:167]
    s_waitcnt lgkmcnt(3)
    ds_read_b128 a[184:187], v20 offset:22528
    v_cvt_pk_bf16_f32 v60, v120, v121
    v_mfma_f32_16x16x32_bf16 v[136:139], a[168:171], v[48:51], v[136:139]
    s_waitcnt lgkmcnt(3)
    v_exp_f32 v122, v122
    v_mfma_f32_16x16x32_bf16 v[168:171], a[168:171], v[52:55], v[168:171]
    buffer_store_dwordx4 v[24:27], v23, s[8:11], s27 offen offset:512 sc0 sc1
    v_mfma_f32_16x16x32_bf16 v[140:143], a[172:175], v[48:51], v[140:143]
    v_exp_f32 v123, v123
    v_mfma_f32_16x16x32_bf16 v[172:175], a[172:175], v[52:55], v[172:175]
    s_waitcnt lgkmcnt(2)
    ds_read_b128 a[188:191], v20 offset:23552
    v_cvt_pk_bf16_f32 v61, v122, v123
    v_mfma_f32_16x16x32_bf16 v[144:147], a[176:179], v[48:51], v[144:147]
    v_exp_f32 v124, v124
    v_mfma_f32_16x16x32_bf16 v[176:179], a[176:179], v[52:55], v[176:179]
    s_waitcnt lgkmcnt(2)
    v_mfma_f32_16x16x32_bf16 v[148:151], a[180:183], v[48:51], v[148:151]
    v_exp_f32 v125, v125
    v_mfma_f32_16x16x32_bf16 v[180:183], a[180:183], v[52:55], v[180:183]
    s_waitcnt lgkmcnt(1)
    v_cvt_pk_bf16_f32 v62, v124, v125
    v_xor_b32 v19, 98304, v19
    v_mfma_f32_16x16x32_bf16 v[152:155], a[184:187], v[48:51], v[152:155]
    v_exp_f32 v126, v126
    v_mfma_f32_16x16x32_bf16 v[184:187], a[184:187], v[52:55], v[184:187]
    s_waitcnt lgkmcnt(0)
    v_xor_b32 v20, 98304, v20
    v_mfma_f32_16x16x32_bf16 v[156:159], a[188:191], v[48:51], v[156:159]
    v_exp_f32 v127, v127
    v_mfma_f32_16x16x32_bf16 v[188:191], a[188:191], v[52:55], v[188:191]
    v_cvt_pk_bf16_f32 v63, v126, v127
    v_mfma_f32_16x16x32_bf16 v[112:115], a[128:131], a[224:227], v[72:75]
    v_exp_f32 v96, v96
    v_mfma_f32_16x16x32_bf16 v[112:115], a[132:135], a[228:231], v[112:115]
    buffer_store_dwordx4 a[20:23], v13, s[8:11], s17 offen offset:3584 sc0 sc1
    v_mfma_f32_16x16x32_bf16 v[112:115], a[136:139], a[232:235], v[112:115]
    s_add_u32 s27, s18, 8388608
    v_exp_f32 v97, v97
    v_mfma_f32_16x16x32_bf16 v[112:115], a[140:143], a[236:239], v[112:115]
    v_cvt_pk_bf16_f32 v48, v96, v97
    v_add_f32 v80, 0, v21
    v_mfma_f32_16x16x32_bf16 v[120:123], a[128:131], a[240:243], v[76:79]
    v_exp_f32 v98, v98
    v_mfma_f32_16x16x32_bf16 v[120:123], a[132:135], a[244:247], v[120:123]
    buffer_store_dwordx4 v[24:27], v23, s[8:11], s27 offen offset:768 sc0 sc1
    v_mfma_f32_16x16x32_bf16 v[120:123], a[136:139], a[248:251], v[120:123]
    s_add_u32 s27, s18, 8519680
    v_exp_f32 v99, v99
    v_mfma_f32_16x16x32_bf16 v[120:123], a[140:143], a[252:255], v[120:123]
    buffer_store_dwordx4 v[24:27], v23, s[8:11], s27 offen offset:768 sc0 sc1
    v_mfma_f32_16x16x32_bf16 v[116:119], a[144:147], a[224:227], v[72:75]
    v_exp_f32 v100, v100
    v_mfma_f32_16x16x32_bf16 v[116:119], a[148:151], a[228:231], v[116:119]
    ds_read_b128 a[128:131], v18 offset:16384
    v_cvt_pk_bf16_f32 v49, v98, v99
    v_mfma_f32_16x16x32_bf16 v[116:119], a[152:155], a[232:235], v[116:119]
    s_add_u32 s19, s82, 32768
    v_exp_f32 v101, v101
    v_mfma_f32_16x16x32_bf16 v[116:119], a[156:159], a[236:239], v[116:119]
    s_sub_u32 s82, s12, s13
    ds_read_b128 a[132:135], v18 offset:17408
    v_cvt_pk_bf16_f32 v50, v100, v101
    v_mfma_f32_16x16x32_bf16 v[124:127], a[144:147], a[240:243], v[76:79]
    s_sub_u32 s82, s82, 1
    v_exp_f32 v102, v102
    v_mfma_f32_16x16x32_bf16 v[124:127], a[148:151], a[244:247], v[124:127]
    s_cmp_gt_u32 s12, s13
    s_cselect_b32 s82, s82, s12
    s_lshl_b32 s82, s82, 16
    ds_read_b128 a[136:139], v18 offset:18432
    v_mfma_f32_16x16x32_bf16 v[124:127], a[152:155], a[248:251], v[124:127]
    s_add_u32 s82, s82, s81
    v_exp_f32 v103, v103
    v_mfma_f32_16x16x32_bf16 v[124:127], a[156:159], a[252:255], v[124:127]
    s_cmp_ge_u32 s12, 17
    s_cselect_b32 s82, 2147471360, s82
    ds_read_b128 a[140:143], v18 offset:19456
    v_cvt_pk_bf16_f32 v51, v102, v103
    v_mfma_f32_16x16x32_bf16 v[40:43], v[28:31], v[56:59], v[40:43]
    s_add_u32 s12, s12, 1
    v_exp_f32 v104, v104
    v_mfma_f32_16x16x32_bf16 v[44:47], v[28:31], v[60:63], v[44:47]
    ds_read_b128 a[144:147], v18 offset:20480
    v_min_f32 v80, v80, v64
    v_mfma_f32_16x16x32_bf16 v[192:195], a[160:163], v[56:59], v[192:195]
    v_exp_f32 v105, v105
    v_mfma_f32_16x16x32_bf16 v[224:227], a[160:163], v[60:63], v[224:227]
    ds_read_b128 a[148:151], v18 offset:21504
    v_cvt_pk_bf16_f32 v52, v104, v105
    v_mfma_f32_16x16x32_bf16 v[196:199], a[164:167], v[56:59], v[196:199]
    v_exp_f32 v106, v106
    v_mfma_f32_16x16x32_bf16 v[228:231], a[164:167], v[60:63], v[228:231]
    ds_read_b128 a[152:155], v18 offset:22528
    v_add_f32 v81, 0xf1800000, v21
    v_mfma_f32_16x16x32_bf16 v[200:203], a[168:171], v[56:59], v[200:203]
    v_exp_f32 v107, v107
    v_mfma_f32_16x16x32_bf16 v[232:235], a[168:171], v[60:63], v[232:235]
    ds_read_b128 a[156:159], v18 offset:23552
    v_cvt_pk_bf16_f32 v53, v106, v107
    v_mfma_f32_16x16x32_bf16 v[204:207], a[172:175], v[56:59], v[204:207]
    v_exp_f32 v108, v108
    v_mfma_f32_16x16x32_bf16 v[236:239], a[172:175], v[60:63], v[236:239]
    buffer_load_dword v3, v4, s[8:11], s23 offen sc0 sc1
    v_mfma_f32_16x16x32_bf16 v[208:211], a[176:179], v[56:59], v[208:211]
    v_exp_f32 v109, v109
    v_mfma_f32_16x16x32_bf16 v[240:243], a[176:179], v[60:63], v[240:243]
    v_cvt_pk_bf16_f32 v54, v108, v109
    v_xor_b32 v18, 196608, v18
    v_mfma_f32_16x16x32_bf16 v[212:215], a[180:183], v[56:59], v[212:215]
    v_exp_f32 v110, v110
    v_mfma_f32_16x16x32_bf16 v[244:247], a[180:183], v[60:63], v[244:247]
    v_min_f32 v81, v81, v65
    v_add_f32 v82, 0xf2000000, v21
    v_mfma_f32_16x16x32_bf16 v[216:219], a[184:187], v[56:59], v[216:219]
    v_exp_f32 v111, v111
    v_mfma_f32_16x16x32_bf16 v[248:251], a[184:187], v[60:63], v[248:251]
    v_cvt_pk_bf16_f32 v55, v110, v111
    v_min_f32 v82, v82, v66
    v_mfma_f32_16x16x32_bf16 v[220:223], a[188:191], v[56:59], v[220:223]
    v_add_f32 v83, 0xf2400000, v21
    v_min_f32 v83, v83, v67
    v_mfma_f32_16x16x32_bf16 v[252:255], a[188:191], v[60:63], v[252:255]
    v_add_f32 v84, 0xf3800000, v21
    v_min_f32 v84, v84, v64
    v_add_f32 v85, 0xf3880000, v21
    v_min_f32 v85, v85, v65
    s_waitcnt vmcnt(8) lgkmcnt(0)
    s_barrier
    v_mfma_f32_16x16x32_bf16 v[96:99], a[128:131], a[192:195], v[64:67]
    s_add_u32 m0, s15, 0
    ds_read_b128 a[160:163], v19 offset:0
    v_mfma_f32_16x16x32_bf16 v[96:99], a[132:135], a[196:199], v[96:99]
    ds_read_b128 a[164:167], v19 offset:1024
    v_mfma_f32_16x16x32_bf16 v[96:99], a[136:139], a[200:203], v[96:99]
    v_exp_f32 v112, v112
    v_mfma_f32_16x16x32_bf16 v[96:99], a[140:143], a[204:207], v[96:99]
    buffer_load_dwordx4 v1, s[8:11], s82 offen offset:0 lds
    v_mfma_f32_16x16x32_bf16 v[104:107], a[128:131], a[208:211], v[68:71]
    v_exp_f32 v113, v113
    v_mfma_f32_16x16x32_bf16 v[104:107], a[132:135], a[212:215], v[104:107]
    ds_read_b128 a[168:171], v19 offset:2048
    v_cvt_pk_bf16_f32 v56, v112, v113
    v_mfma_f32_16x16x32_bf16 v[104:107], a[136:139], a[216:219], v[104:107]
    v_exp_f32 v114, v114
    v_mfma_f32_16x16x32_bf16 v[104:107], a[140:143], a[220:223], v[104:107]
    buffer_load_dwordx4 v1, s[8:11], s82 offen offset:1024 lds
    v_mfma_f32_16x16x32_bf16 v[100:103], a[144:147], a[192:195], v[64:67]
    v_exp_f32 v115, v115
    v_mfma_f32_16x16x32_bf16 v[100:103], a[148:151], a[196:199], v[100:103]
    ds_read_b128 a[172:175], v19 offset:3072
    v_cvt_pk_bf16_f32 v57, v114, v115
    v_mfma_f32_16x16x32_bf16 v[100:103], a[152:155], a[200:203], v[100:103]
    v_exp_f32 v116, v116
    v_mfma_f32_16x16x32_bf16 v[100:103], a[156:159], a[204:207], v[100:103]
    buffer_load_dwordx4 v1, s[8:11], s82 offen offset:2048 lds
    v_mfma_f32_16x16x32_bf16 v[108:111], a[144:147], a[208:211], v[68:71]
    v_exp_f32 v117, v117
    v_mfma_f32_16x16x32_bf16 v[108:111], a[148:151], a[212:215], v[108:111]
    ds_read_b128 a[176:179], v20 offset:4096
    v_cvt_pk_bf16_f32 v58, v116, v117
    v_mfma_f32_16x16x32_bf16 v[108:111], a[152:155], a[216:219], v[108:111]
    v_exp_f32 v118, v118
    v_mfma_f32_16x16x32_bf16 v[108:111], a[156:159], a[220:223], v[108:111]
    buffer_load_dwordx4 v1, s[8:11], s82 offen offset:3072 lds
    v_mfma_f32_16x16x32_bf16 v[32:35], v[28:31], v[48:51], v[32:35]
    s_add_u32 m0, s15, 4096
    v_exp_f32 v119, v119
    v_mfma_f32_16x16x32_bf16 v[36:39], v[28:31], v[52:55], v[36:39]
    s_waitcnt lgkmcnt(4)
    ds_read_b128 a[180:183], v20 offset:5120
    v_cvt_pk_bf16_f32 v59, v118, v119
    v_mfma_f32_16x16x32_bf16 v[128:131], a[160:163], v[48:51], v[128:131]
    v_exp_f32 v120, v120
    v_mfma_f32_16x16x32_bf16 v[160:163], a[160:163], v[52:55], v[160:163]
    s_waitcnt lgkmcnt(4)
    v_mfma_f32_16x16x32_bf16 v[132:135], a[164:167], v[48:51], v[132:135]
    v_exp_f32 v121, v121
    v_mfma_f32_16x16x32_bf16 v[164:167], a[164:167], v[52:55], v[164:167]
    s_waitcnt lgkmcnt(3)
    ds_read_b128 a[184:187], v20 offset:6144
    v_cvt_pk_bf16_f32 v60, v120, v121
    v_mfma_f32_16x16x32_bf16 v[136:139], a[168:171], v[48:51], v[136:139]
    s_waitcnt lgkmcnt(3)
    v_exp_f32 v122, v122
    v_mfma_f32_16x16x32_bf16 v[168:171], a[168:171], v[52:55], v[168:171]
    buffer_load_dwordx4 v15, s[8:11], s82 offen offset:0 lds
    v_mfma_f32_16x16x32_bf16 v[140:143], a[172:175], v[48:51], v[140:143]
    v_exp_f32 v123, v123
    v_mfma_f32_16x16x32_bf16 v[172:175], a[172:175], v[52:55], v[172:175]
    s_waitcnt lgkmcnt(2)
    ds_read_b128 a[188:191], v20 offset:7168
    v_cvt_pk_bf16_f32 v61, v122, v123
    v_mfma_f32_16x16x32_bf16 v[144:147], a[176:179], v[48:51], v[144:147]
    s_waitcnt lgkmcnt(2)
    v_exp_f32 v124, v124
    v_mfma_f32_16x16x32_bf16 v[176:179], a[176:179], v[52:55], v[176:179]
    buffer_load_dwordx4 v15, s[8:11], s82 offen offset:1024 lds
    v_mfma_f32_16x16x32_bf16 v[148:151], a[180:183], v[48:51], v[148:151]
    v_exp_f32 v125, v125
    v_mfma_f32_16x16x32_bf16 v[180:183], a[180:183], v[52:55], v[180:183]
    s_waitcnt lgkmcnt(1)
    v_cvt_pk_bf16_f32 v62, v124, v125
    v_mfma_f32_16x16x32_bf16 v[152:155], a[184:187], v[48:51], v[152:155]
    s_waitcnt lgkmcnt(0)
    v_exp_f32 v126, v126
    v_mfma_f32_16x16x32_bf16 v[184:187], a[184:187], v[52:55], v[184:187]
    buffer_load_dwordx4 v15, s[8:11], s82 offen offset:2048 lds
    v_mfma_f32_16x16x32_bf16 v[156:159], a[188:191], v[48:51], v[156:159]
    v_exp_f32 v127, v127
    v_mfma_f32_16x16x32_bf16 v[188:191], a[188:191], v[52:55], v[188:191]
    v_cvt_pk_bf16_f32 v63, v126, v127
    v_mfma_f32_16x16x32_bf16 v[112:115], a[128:131], a[224:227], v[72:75]
    v_mfma_f32_16x16x32_bf16 v[112:115], a[132:135], a[228:231], v[112:115]
    v_mfma_f32_16x16x32_bf16 v[112:115], a[136:139], a[232:235], v[112:115]
    v_exp_f32 v96, v96
    v_mfma_f32_16x16x32_bf16 v[112:115], a[140:143], a[236:239], v[112:115]
    buffer_load_dwordx4 v15, s[8:11], s82 offen offset:3072 lds
    v_mfma_f32_16x16x32_bf16 v[120:123], a[128:131], a[240:243], v[76:79]
    s_xor_b32 s15, s15, 196608
    v_exp_f32 v97, v97
    v_mfma_f32_16x16x32_bf16 v[120:123], a[132:135], a[244:247], v[120:123]
    s_add_u32 m0, s16, 0
    ds_read_b128 a[128:131], v18 offset:0
    v_cvt_pk_bf16_f32 v48, v96, v97
    v_mfma_f32_16x16x32_bf16 v[120:123], a[136:139], a[248:251], v[120:123]
    v_exp_f32 v98, v98
    v_mfma_f32_16x16x32_bf16 v[120:123], a[140:143], a[252:255], v[120:123]
    buffer_load_dwordx4 v1, s[8:11], s19 offen offset:0 lds
    v_mfma_f32_16x16x32_bf16 v[116:119], a[144:147], a[224:227], v[72:75]
    v_exp_f32 v99, v99
    v_mfma_f32_16x16x32_bf16 v[116:119], a[148:151], a[228:231], v[116:119]
    ds_read_b128 a[132:135], v18 offset:1024
    v_cvt_pk_bf16_f32 v49, v98, v99
    v_mfma_f32_16x16x32_bf16 v[116:119], a[152:155], a[232:235], v[116:119]
    v_exp_f32 v100, v100
    v_mfma_f32_16x16x32_bf16 v[116:119], a[156:159], a[236:239], v[116:119]
    buffer_load_dwordx4 v1, s[8:11], s19 offen offset:1024 lds
    v_mfma_f32_16x16x32_bf16 v[124:127], a[144:147], a[240:243], v[76:79]
    v_exp_f32 v101, v101
    v_mfma_f32_16x16x32_bf16 v[124:127], a[148:151], a[244:247], v[124:127]
    ds_read_b128 a[136:139], v18 offset:2048
    v_cvt_pk_bf16_f32 v50, v100, v101
    v_mfma_f32_16x16x32_bf16 v[124:127], a[152:155], a[248:251], v[124:127]
    v_exp_f32 v102, v102
    v_mfma_f32_16x16x32_bf16 v[124:127], a[156:159], a[252:255], v[124:127]
    buffer_load_dwordx4 v1, s[8:11], s19 offen offset:2048 lds
    v_mfma_f32_16x16x32_bf16 v[40:43], v[28:31], v[56:59], v[40:43]
    v_exp_f32 v103, v103
    v_mfma_f32_16x16x32_bf16 v[44:47], v[28:31], v[60:63], v[44:47]
    ds_read_b128 a[140:143], v18 offset:3072
    v_cvt_pk_bf16_f32 v51, v102, v103
    v_mfma_f32_16x16x32_bf16 v[192:195], a[160:163], v[56:59], v[192:195]
    v_exp_f32 v104, v104
    v_mfma_f32_16x16x32_bf16 v[224:227], a[160:163], v[60:63], v[224:227]
    v_mfma_f32_16x16x32_bf16 v[196:199], a[164:167], v[56:59], v[196:199]
    v_exp_f32 v105, v105
    v_mfma_f32_16x16x32_bf16 v[228:231], a[164:167], v[60:63], v[228:231]
    ds_read_b128 a[144:147], v18 offset:4096
    v_cvt_pk_bf16_f32 v52, v104, v105
    v_mfma_f32_16x16x32_bf16 v[200:203], a[168:171], v[56:59], v[200:203]
    v_exp_f32 v106, v106
    v_mfma_f32_16x16x32_bf16 v[232:235], a[168:171], v[60:63], v[232:235]
    buffer_load_dwordx4 v1, s[8:11], s19 offen offset:3072 lds
    v_mfma_f32_16x16x32_bf16 v[204:207], a[172:175], v[56:59], v[204:207]
    s_add_u32 m0, s16, 4096
    v_exp_f32 v107, v107
    v_mfma_f32_16x16x32_bf16 v[236:239], a[172:175], v[60:63], v[236:239]
    ds_read_b128 a[148:151], v18 offset:5120
    v_cvt_pk_bf16_f32 v53, v106, v107
    v_mfma_f32_16x16x32_bf16 v[208:211], a[176:179], v[56:59], v[208:211]
    v_exp_f32 v108, v108
    v_mfma_f32_16x16x32_bf16 v[240:243], a[176:179], v[60:63], v[240:243]
    buffer_load_dwordx4 v15, s[8:11], s19 offen offset:0 lds
    v_mfma_f32_16x16x32_bf16 v[212:215], a[180:183], v[56:59], v[212:215]
    v_exp_f32 v109, v109
    v_mfma_f32_16x16x32_bf16 v[244:247], a[180:183], v[60:63], v[244:247]
    ds_read_b128 a[152:155], v18 offset:6144
    v_cvt_pk_bf16_f32 v54, v108, v109
    v_mfma_f32_16x16x32_bf16 v[216:219], a[184:187], v[56:59], v[216:219]
    v_exp_f32 v110, v110
    v_mfma_f32_16x16x32_bf16 v[248:251], a[184:187], v[60:63], v[248:251]
    buffer_load_dwordx4 v15, s[8:11], s19 offen offset:1024 lds
    v_mfma_f32_16x16x32_bf16 v[220:223], a[188:191], v[56:59], v[220:223]
    v_exp_f32 v111, v111
    v_mfma_f32_16x16x32_bf16 v[252:255], a[188:191], v[60:63], v[252:255]
    ds_read_b128 a[156:159], v18 offset:7168
    v_cvt_pk_bf16_f32 v55, v110, v111
    s_waitcnt lgkmcnt(7)
    v_mfma_f32_16x16x32_bf16 v[96:99], a[128:131], a[192:195], v[64:67]
    s_waitcnt lgkmcnt(6)
    ds_read_b128 a[160:163], v19 offset:16384
    v_lshlrev_b32 v12, 3, v0
    v_mfma_f32_16x16x32_bf16 v[96:99], a[132:135], a[196:199], v[96:99]
    s_waitcnt lgkmcnt(6)
    s_lshl_b32 s101, s2, 11
    s_add_u32 s101, s101, 524288
    ds_read_b128 a[164:167], v19 offset:17408
    v_mfma_f32_16x16x32_bf16 v[96:99], a[136:139], a[200:203], v[96:99]
    s_waitcnt lgkmcnt(6)
    v_exp_f32 v112, v112
    v_mfma_f32_16x16x32_bf16 v[96:99], a[140:143], a[204:207], v[96:99]
    buffer_load_dwordx4 v15, s[8:11], s19 offen offset:2048 lds
    v_mfma_f32_16x16x32_bf16 v[104:107], a[128:131], a[208:211], v[68:71]
    v_exp_f32 v113, v113
    v_mfma_f32_16x16x32_bf16 v[104:107], a[132:135], a[212:215], v[104:107]
    ds_read_b128 a[168:171], v19 offset:18432
    v_cvt_pk_bf16_f32 v56, v112, v113
    v_mfma_f32_16x16x32_bf16 v[104:107], a[136:139], a[216:219], v[104:107]
    s_waitcnt lgkmcnt(6)
    v_exp_f32 v114, v114
    v_mfma_f32_16x16x32_bf16 v[104:107], a[140:143], a[220:223], v[104:107]
    buffer_load_dwordx4 v15, s[8:11], s19 offen offset:3072 lds
    v_mfma_f32_16x16x32_bf16 v[100:103], a[144:147], a[192:195], v[64:67]
    s_waitcnt lgkmcnt(5)
    s_xor_b32 s16, s16, 98304
    v_exp_f32 v115, v115
    v_mfma_f32_16x16x32_bf16 v[100:103], a[148:151], a[196:199], v[100:103]
    s_waitcnt lgkmcnt(4)
    ds_read_b128 a[172:175], v19 offset:19456
    v_cvt_pk_bf16_f32 v57, v114, v115
    v_mfma_f32_16x16x32_bf16 v[100:103], a[152:155], a[200:203], v[100:103]
    s_waitcnt lgkmcnt(4)
    v_exp_f32 v116, v116
    v_mfma_f32_16x16x32_bf16 v[100:103], a[156:159], a[204:207], v[100:103]
    buffer_store_dwordx2 v[24:25], v12, s[8:11], s101 offen sc0 sc1
    v_mfma_f32_16x16x32_bf16 v[108:111], a[144:147], a[208:211], v[68:71]
    s_lshl_b32 s101, s2, 6
    v_exp_f32 v117, v117
    v_mfma_f32_16x16x32_bf16 v[108:111], a[148:151], a[212:215], v[108:111]
    s_add_u32 s101, s101, 65536
    ds_read_b128 a[176:179], v20 offset:20480
    v_cvt_pk_bf16_f32 v58, v116, v117
    v_mfma_f32_16x16x32_bf16 v[108:111], a[152:155], a[216:219], v[108:111]
    v_exp_f32 v118, v118
    v_mfma_f32_16x16x32_bf16 v[108:111], a[156:159], a[220:223], v[108:111]
    v_mov_b32 v13, 0
    v_mfma_f32_16x16x32_bf16 v[32:35], v[28:31], v[48:51], v[32:35]
    v_exp_f32 v119, v119
    v_mfma_f32_16x16x32_bf16 v[36:39], v[28:31], v[52:55], v[36:39]
    s_waitcnt lgkmcnt(4)
    ds_read_b128 a[180:183], v20 offset:21504
    v_cvt_pk_bf16_f32 v59, v118, v119
    v_mfma_f32_16x16x32_bf16 v[128:131], a[160:163], v[48:51], v[128:131]
    s_waitcnt lgkmcnt(4)
    v_exp_f32 v120, v120
    v_mfma_f32_16x16x32_bf16 v[160:163], a[160:163], v[52:55], v[160:163]
    buffer_store_dword v13, v7, s[8:11], s101 offen sc0 sc1
    v_mfma_f32_16x16x32_bf16 v[132:135], a[164:167], v[48:51], v[132:135]
    s_lshl_b32 s101, s66, 6
    v_exp_f32 v121, v121
    v_mfma_f32_16x16x32_bf16 v[164:167], a[164:167], v[52:55], v[164:167]
    s_waitcnt lgkmcnt(3)
    s_add_u32 s101, s101, 81920
    ds_read_b128 a[184:187], v20 offset:22528
    v_cvt_pk_bf16_f32 v60, v120, v121
    v_mfma_f32_16x16x32_bf16 v[136:139], a[168:171], v[48:51], v[136:139]
    s_waitcnt lgkmcnt(3)
    v_exp_f32 v122, v122
    v_mfma_f32_16x16x32_bf16 v[168:171], a[168:171], v[52:55], v[168:171]
    buffer_store_dwordx4 v[24:27], v7, s[8:11], s101 offen sc0 sc1
    v_mfma_f32_16x16x32_bf16 v[140:143], a[172:175], v[48:51], v[140:143]
    v_exp_f32 v123, v123
    v_mfma_f32_16x16x32_bf16 v[172:175], a[172:175], v[52:55], v[172:175]
    s_waitcnt lgkmcnt(2)
    ds_read_b128 a[188:191], v20 offset:23552
    v_cvt_pk_bf16_f32 v61, v122, v123
    v_mfma_f32_16x16x32_bf16 v[144:147], a[176:179], v[48:51], v[144:147]
    s_waitcnt lgkmcnt(2)
    v_exp_f32 v124, v124
    v_mfma_f32_16x16x32_bf16 v[176:179], a[176:179], v[52:55], v[176:179]
    buffer_store_dwordx4 v[24:27], v7, s[8:11], s101 offen offset:16 sc0 sc1
    v_mfma_f32_16x16x32_bf16 v[148:151], a[180:183], v[48:51], v[148:151]
    v_exp_f32 v125, v125
    v_mfma_f32_16x16x32_bf16 v[180:183], a[180:183], v[52:55], v[180:183]
    s_waitcnt lgkmcnt(1)
    v_cvt_pk_bf16_f32 v62, v124, v125
    v_xor_b32 v19, 98304, v19
    v_mfma_f32_16x16x32_bf16 v[152:155], a[184:187], v[48:51], v[152:155]
    v_exp_f32 v126, v126
    v_mfma_f32_16x16x32_bf16 v[184:187], a[184:187], v[52:55], v[184:187]
    s_waitcnt lgkmcnt(0)
    v_xor_b32 v20, 98304, v20
    v_mfma_f32_16x16x32_bf16 v[156:159], a[188:191], v[48:51], v[156:159]
    v_exp_f32 v127, v127
    v_mfma_f32_16x16x32_bf16 v[188:191], a[188:191], v[52:55], v[188:191]
    v_cvt_pk_bf16_f32 v63, v126, v127
    v_mfma_f32_16x16x32_bf16 v[112:115], a[128:131], a[224:227], v[72:75]
    s_add_u32 m0, s62, 32768
    v_exp_f32 v96, v96
    v_mfma_f32_16x16x32_bf16 v[112:115], a[132:135], a[228:231], v[112:115]
    v_add_f32 v86, 0xf3900000, v21
    v_min_f32 v86, v86, v66
    v_mfma_f32_16x16x32_bf16 v[112:115], a[136:139], a[232:235], v[112:115]
    s_add_u32 s98, s65, 0
    v_exp_f32 v97, v97
    v_mfma_f32_16x16x32_bf16 v[112:115], a[140:143], a[236:239], v[112:115]
    v_cvt_pk_bf16_f32 v48, v96, v97
    v_add_f32 v87, 0xf3980000, v21
    v_mfma_f32_16x16x32_bf16 v[120:123], a[128:131], a[240:243], v[76:79]
    v_exp_f32 v98, v98
    v_mfma_f32_16x16x32_bf16 v[120:123], a[132:135], a[244:247], v[120:123]
    buffer_load_dwordx4 v8, s[28:31], s98 offen offset:0  lds
    v_mfma_f32_16x16x32_bf16 v[120:123], a[136:139], a[248:251], v[120:123]
    v_exp_f32 v99, v99
    v_mfma_f32_16x16x32_bf16 v[120:123], a[140:143], a[252:255], v[120:123]
    buffer_load_dwordx4 v9, s[28:31], s98 offen offset:1024  lds
    v_mfma_f32_16x16x32_bf16 v[116:119], a[144:147], a[224:227], v[72:75]
    v_exp_f32 v100, v100
    v_mfma_f32_16x16x32_bf16 v[116:119], a[148:151], a[228:231], v[116:119]
    ds_read_b128 a[128:131], v18 offset:16384
    v_cvt_pk_bf16_f32 v49, v98, v99
    v_mfma_f32_16x16x32_bf16 v[116:119], a[152:155], a[232:235], v[116:119]
    s_add_u32 s19, s82, 32768
    v_exp_f32 v101, v101
    v_mfma_f32_16x16x32_bf16 v[116:119], a[156:159], a[236:239], v[116:119]
    s_sub_u32 s82, s12, s13
    ds_read_b128 a[132:135], v18 offset:17408
    v_cvt_pk_bf16_f32 v50, v100, v101
    v_mfma_f32_16x16x32_bf16 v[124:127], a[144:147], a[240:243], v[76:79]
    s_sub_u32 s82, s82, 1
    v_exp_f32 v102, v102
    v_mfma_f32_16x16x32_bf16 v[124:127], a[148:151], a[244:247], v[124:127]
    s_cmp_gt_u32 s12, s13
    s_cselect_b32 s82, s82, s12
    s_lshl_b32 s82, s82, 16
    ds_read_b128 a[136:139], v18 offset:18432
    v_mfma_f32_16x16x32_bf16 v[124:127], a[152:155], a[248:251], v[124:127]
    s_add_u32 s82, s82, s81
    v_exp_f32 v103, v103
    v_mfma_f32_16x16x32_bf16 v[124:127], a[156:159], a[252:255], v[124:127]
    s_cmp_ge_u32 s12, 17
    s_cselect_b32 s82, 2147471360, s82
    ds_read_b128 a[140:143], v18 offset:19456
    v_cvt_pk_bf16_f32 v51, v102, v103
    v_mfma_f32_16x16x32_bf16 v[40:43], v[28:31], v[56:59], v[40:43]
    s_add_u32 s12, s12, 1
    v_exp_f32 v104, v104
    v_mfma_f32_16x16x32_bf16 v[44:47], v[28:31], v[60:63], v[44:47]
    ds_read_b128 a[144:147], v18 offset:20480
    v_min_f32 v87, v87, v67
    v_mfma_f32_16x16x32_bf16 v[192:195], a[160:163], v[56:59], v[192:195]
    v_exp_f32 v105, v105
    v_mfma_f32_16x16x32_bf16 v[224:227], a[160:163], v[60:63], v[224:227]
    ds_read_b128 a[148:151], v18 offset:21504
    v_cvt_pk_bf16_f32 v52, v104, v105
    v_mfma_f32_16x16x32_bf16 v[196:199], a[164:167], v[56:59], v[196:199]
    v_exp_f32 v106, v106
    v_mfma_f32_16x16x32_bf16 v[228:231], a[164:167], v[60:63], v[228:231]
    ds_read_b128 a[152:155], v18 offset:22528
    v_add_f32 v88, 0x73800000, v21
    v_mfma_f32_16x16x32_bf16 v[200:203], a[168:171], v[56:59], v[200:203]
    v_exp_f32 v107, v107
    v_mfma_f32_16x16x32_bf16 v[232:235], a[168:171], v[60:63], v[232:235]
    ds_read_b128 a[156:159], v18 offset:23552
    v_cvt_pk_bf16_f32 v53, v106, v107
    v_mfma_f32_16x16x32_bf16 v[204:207], a[172:175], v[56:59], v[204:207]
    v_exp_f32 v108, v108
    v_mfma_f32_16x16x32_bf16 v[236:239], a[172:175], v[60:63], v[236:239]
    buffer_load_dwordx4 v10, s[28:31], s98 offen offset:2048  lds
    v_mfma_f32_16x16x32_bf16 v[208:211], a[176:179], v[56:59], v[208:211]
    v_exp_f32 v109, v109
    v_mfma_f32_16x16x32_bf16 v[240:243], a[176:179], v[60:63], v[240:243]
    v_cvt_pk_bf16_f32 v54, v108, v109
    v_xor_b32 v18, 196608, v18
    v_mfma_f32_16x16x32_bf16 v[212:215], a[180:183], v[56:59], v[212:215]
    v_exp_f32 v110, v110
    v_mfma_f32_16x16x32_bf16 v[244:247], a[180:183], v[60:63], v[244:247]
    buffer_load_dwordx4 v11, s[28:31], s98 offen offset:3072  lds
    v_mfma_f32_16x16x32_bf16 v[216:219], a[184:187], v[56:59], v[216:219]
    v_exp_f32 v111, v111
    v_mfma_f32_16x16x32_bf16 v[248:251], a[184:187], v[60:63], v[248:251]
    v_cvt_pk_bf16_f32 v55, v110, v111
    v_min_f32 v88, v88, v68
    v_mfma_f32_16x16x32_bf16 v[220:223], a[188:191], v[56:59], v[220:223]
    v_add_f32 v89, 0x73700000, v21
    v_min_f32 v89, v89, v69
    v_mfma_f32_16x16x32_bf16 v[252:255], a[188:191], v[60:63], v[252:255]
    v_add_f32 v90, 0x73600000, v21
    v_min_f32 v90, v90, v70
    v_add_f32 v91, 0x73500000, v21
    v_min_f32 v91, v91, v71
    s_waitcnt vmcnt(8) lgkmcnt(0)
    s_barrier
    v_mfma_f32_16x16x32_bf16 v[96:99], a[128:131], a[192:195], v[64:67]
    s_add_u32 m0, s15, 0
    ds_read_b128 a[160:163], v19 offset:0
    v_mfma_f32_16x16x32_bf16 v[96:99], a[132:135], a[196:199], v[96:99]
    ds_read_b128 a[164:167], v19 offset:1024
    v_mfma_f32_16x16x32_bf16 v[96:99], a[136:139], a[200:203], v[96:99]
    v_exp_f32 v112, v112
    v_mfma_f32_16x16x32_bf16 v[96:99], a[140:143], a[204:207], v[96:99]
    buffer_load_dwordx4 v1, s[8:11], s82 offen offset:0 lds
    v_mfma_f32_16x16x32_bf16 v[104:107], a[128:131], a[208:211], v[68:71]
    v_exp_f32 v113, v113
    v_mfma_f32_16x16x32_bf16 v[104:107], a[132:135], a[212:215], v[104:107]
    ds_read_b128 a[168:171], v19 offset:2048
    v_cvt_pk_bf16_f32 v56, v112, v113
    v_mfma_f32_16x16x32_bf16 v[104:107], a[136:139], a[216:219], v[104:107]
    v_exp_f32 v114, v114
    v_mfma_f32_16x16x32_bf16 v[104:107], a[140:143], a[220:223], v[104:107]
    buffer_load_dwordx4 v1, s[8:11], s82 offen offset:1024 lds
    v_mfma_f32_16x16x32_bf16 v[100:103], a[144:147], a[192:195], v[64:67]
    v_exp_f32 v115, v115
    v_mfma_f32_16x16x32_bf16 v[100:103], a[148:151], a[196:199], v[100:103]
    ds_read_b128 a[172:175], v19 offset:3072
    v_cvt_pk_bf16_f32 v57, v114, v115
    v_mfma_f32_16x16x32_bf16 v[100:103], a[152:155], a[200:203], v[100:103]
    v_exp_f32 v116, v116
    v_mfma_f32_16x16x32_bf16 v[100:103], a[156:159], a[204:207], v[100:103]
    buffer_load_dwordx4 v1, s[8:11], s82 offen offset:2048 lds
    v_mfma_f32_16x16x32_bf16 v[108:111], a[144:147], a[208:211], v[68:71]
    v_exp_f32 v117, v117
    v_mfma_f32_16x16x32_bf16 v[108:111], a[148:151], a[212:215], v[108:111]
    ds_read_b128 a[176:179], v20 offset:4096
    v_cvt_pk_bf16_f32 v58, v116, v117
    v_mfma_f32_16x16x32_bf16 v[108:111], a[152:155], a[216:219], v[108:111]
    v_exp_f32 v118, v118
    v_mfma_f32_16x16x32_bf16 v[108:111], a[156:159], a[220:223], v[108:111]
    buffer_load_dwordx4 v1, s[8:11], s82 offen offset:3072 lds
    v_mfma_f32_16x16x32_bf16 v[32:35], v[28:31], v[48:51], v[32:35]
    s_add_u32 m0, s15, 4096
    v_exp_f32 v119, v119
    v_mfma_f32_16x16x32_bf16 v[36:39], v[28:31], v[52:55], v[36:39]
    s_waitcnt lgkmcnt(4)
    ds_read_b128 a[180:183], v20 offset:5120
    v_cvt_pk_bf16_f32 v59, v118, v119
    v_mfma_f32_16x16x32_bf16 v[128:131], a[160:163], v[48:51], v[128:131]
    v_exp_f32 v120, v120
    v_mfma_f32_16x16x32_bf16 v[160:163], a[160:163], v[52:55], v[160:163]
    s_waitcnt lgkmcnt(4)
    v_mfma_f32_16x16x32_bf16 v[132:135], a[164:167], v[48:51], v[132:135]
    v_exp_f32 v121, v121
    v_mfma_f32_16x16x32_bf16 v[164:167], a[164:167], v[52:55], v[164:167]
    s_waitcnt lgkmcnt(3)
    ds_read_b128 a[184:187], v20 offset:6144
    v_cvt_pk_bf16_f32 v60, v120, v121
    v_mfma_f32_16x16x32_bf16 v[136:139], a[168:171], v[48:51], v[136:139]
    s_waitcnt lgkmcnt(3)
    v_exp_f32 v122, v122
    v_mfma_f32_16x16x32_bf16 v[168:171], a[168:171], v[52:55], v[168:171]
    buffer_load_dwordx4 v15, s[8:11], s82 offen offset:0 lds
    v_mfma_f32_16x16x32_bf16 v[140:143], a[172:175], v[48:51], v[140:143]
    v_exp_f32 v123, v123
    v_mfma_f32_16x16x32_bf16 v[172:175], a[172:175], v[52:55], v[172:175]
    s_waitcnt lgkmcnt(2)
    ds_read_b128 a[188:191], v20 offset:7168
    v_cvt_pk_bf16_f32 v61, v122, v123
    v_mfma_f32_16x16x32_bf16 v[144:147], a[176:179], v[48:51], v[144:147]
    s_waitcnt lgkmcnt(2)
    v_exp_f32 v124, v124
    v_mfma_f32_16x16x32_bf16 v[176:179], a[176:179], v[52:55], v[176:179]
    buffer_load_dwordx4 v15, s[8:11], s82 offen offset:1024 lds
    v_mfma_f32_16x16x32_bf16 v[148:151], a[180:183], v[48:51], v[148:151]
    v_exp_f32 v125, v125
    v_mfma_f32_16x16x32_bf16 v[180:183], a[180:183], v[52:55], v[180:183]
    s_waitcnt lgkmcnt(1)
    v_cvt_pk_bf16_f32 v62, v124, v125
    v_mfma_f32_16x16x32_bf16 v[152:155], a[184:187], v[48:51], v[152:155]
    s_waitcnt lgkmcnt(0)
    v_exp_f32 v126, v126
    v_mfma_f32_16x16x32_bf16 v[184:187], a[184:187], v[52:55], v[184:187]
    buffer_load_dwordx4 v15, s[8:11], s82 offen offset:2048 lds
    v_mfma_f32_16x16x32_bf16 v[156:159], a[188:191], v[48:51], v[156:159]
    v_exp_f32 v127, v127
    v_mfma_f32_16x16x32_bf16 v[188:191], a[188:191], v[52:55], v[188:191]
    v_cvt_pk_bf16_f32 v63, v126, v127
    v_mfma_f32_16x16x32_bf16 v[112:115], a[128:131], a[224:227], v[72:75]
    v_mfma_f32_16x16x32_bf16 v[112:115], a[132:135], a[228:231], v[112:115]
    v_mfma_f32_16x16x32_bf16 v[112:115], a[136:139], a[232:235], v[112:115]
    v_exp_f32 v96, v96
    v_mfma_f32_16x16x32_bf16 v[112:115], a[140:143], a[236:239], v[112:115]
    buffer_load_dwordx4 v15, s[8:11], s82 offen offset:3072 lds
    v_mfma_f32_16x16x32_bf16 v[120:123], a[128:131], a[240:243], v[76:79]
    s_xor_b32 s15, s15, 196608
    v_exp_f32 v97, v97
    v_mfma_f32_16x16x32_bf16 v[120:123], a[132:135], a[244:247], v[120:123]
    s_add_u32 m0, s16, 0
    ds_read_b128 a[128:131], v18 offset:0
    v_cvt_pk_bf16_f32 v48, v96, v97
    v_mfma_f32_16x16x32_bf16 v[120:123], a[136:139], a[248:251], v[120:123]
    v_exp_f32 v98, v98
    v_mfma_f32_16x16x32_bf16 v[120:123], a[140:143], a[252:255], v[120:123]
    buffer_load_dwordx4 v1, s[8:11], s19 offen offset:0 lds
    v_mfma_f32_16x16x32_bf16 v[116:119], a[144:147], a[224:227], v[72:75]
    v_exp_f32 v99, v99
    v_mfma_f32_16x16x32_bf16 v[116:119], a[148:151], a[228:231], v[116:119]
    ds_read_b128 a[132:135], v18 offset:1024
    v_cvt_pk_bf16_f32 v49, v98, v99
    v_mfma_f32_16x16x32_bf16 v[116:119], a[152:155], a[232:235], v[116:119]
    v_exp_f32 v100, v100
    v_mfma_f32_16x16x32_bf16 v[116:119], a[156:159], a[236:239], v[116:119]
    buffer_load_dwordx4 v1, s[8:11], s19 offen offset:1024 lds
    v_mfma_f32_16x16x32_bf16 v[124:127], a[144:147], a[240:243], v[76:79]
    v_exp_f32 v101, v101
    v_mfma_f32_16x16x32_bf16 v[124:127], a[148:151], a[244:247], v[124:127]
    ds_read_b128 a[136:139], v18 offset:2048
    v_cvt_pk_bf16_f32 v50, v100, v101
    v_mfma_f32_16x16x32_bf16 v[124:127], a[152:155], a[248:251], v[124:127]
    v_exp_f32 v102, v102
    v_mfma_f32_16x16x32_bf16 v[124:127], a[156:159], a[252:255], v[124:127]
    buffer_load_dwordx4 v1, s[8:11], s19 offen offset:2048 lds
    v_mfma_f32_16x16x32_bf16 v[40:43], v[28:31], v[56:59], v[40:43]
    v_exp_f32 v103, v103
    v_mfma_f32_16x16x32_bf16 v[44:47], v[28:31], v[60:63], v[44:47]
    ds_read_b128 a[140:143], v18 offset:3072
    v_cvt_pk_bf16_f32 v51, v102, v103
    v_mfma_f32_16x16x32_bf16 v[192:195], a[160:163], v[56:59], v[192:195]
    v_exp_f32 v104, v104
    v_mfma_f32_16x16x32_bf16 v[224:227], a[160:163], v[60:63], v[224:227]
    v_mfma_f32_16x16x32_bf16 v[196:199], a[164:167], v[56:59], v[196:199]
    v_exp_f32 v105, v105
    v_mfma_f32_16x16x32_bf16 v[228:231], a[164:167], v[60:63], v[228:231]
    ds_read_b128 a[144:147], v18 offset:4096
    v_cvt_pk_bf16_f32 v52, v104, v105
    v_mfma_f32_16x16x32_bf16 v[200:203], a[168:171], v[56:59], v[200:203]
    v_exp_f32 v106, v106
    v_mfma_f32_16x16x32_bf16 v[232:235], a[168:171], v[60:63], v[232:235]
    buffer_load_dwordx4 v1, s[8:11], s19 offen offset:3072 lds
    v_mfma_f32_16x16x32_bf16 v[204:207], a[172:175], v[56:59], v[204:207]
    s_add_u32 m0, s16, 4096
    v_exp_f32 v107, v107
    v_mfma_f32_16x16x32_bf16 v[236:239], a[172:175], v[60:63], v[236:239]
    ds_read_b128 a[148:151], v18 offset:5120
    v_cvt_pk_bf16_f32 v53, v106, v107
    v_mfma_f32_16x16x32_bf16 v[208:211], a[176:179], v[56:59], v[208:211]
    v_exp_f32 v108, v108
    v_mfma_f32_16x16x32_bf16 v[240:243], a[176:179], v[60:63], v[240:243]
    buffer_load_dwordx4 v15, s[8:11], s19 offen offset:0 lds
    v_mfma_f32_16x16x32_bf16 v[212:215], a[180:183], v[56:59], v[212:215]
    v_exp_f32 v109, v109
    v_mfma_f32_16x16x32_bf16 v[244:247], a[180:183], v[60:63], v[244:247]
    ds_read_b128 a[152:155], v18 offset:6144
    v_cvt_pk_bf16_f32 v54, v108, v109
    v_mfma_f32_16x16x32_bf16 v[216:219], a[184:187], v[56:59], v[216:219]
    v_exp_f32 v110, v110
    v_mfma_f32_16x16x32_bf16 v[248:251], a[184:187], v[60:63], v[248:251]
    buffer_load_dwordx4 v15, s[8:11], s19 offen offset:1024 lds
    v_mfma_f32_16x16x32_bf16 v[220:223], a[188:191], v[56:59], v[220:223]
    v_exp_f32 v111, v111
    v_mfma_f32_16x16x32_bf16 v[252:255], a[188:191], v[60:63], v[252:255]
    ds_read_b128 a[156:159], v18 offset:7168
    v_cvt_pk_bf16_f32 v55, v110, v111
    s_waitcnt lgkmcnt(7)
    v_mfma_f32_16x16x32_bf16 v[96:99], a[128:131], a[192:195], v[64:67]
    s_waitcnt lgkmcnt(6)
    s_lshl_b32 s24, s60, 2
    s_add_u32 s24, s24, s3
    ds_read_b128 a[160:163], v19 offset:16384
    v_mfma_f32_16x16x32_bf16 v[96:99], a[132:135], a[196:199], v[96:99]
    s_waitcnt lgkmcnt(6)
    s_lshl_b32 s24, s24, 3
    s_add_u32 s24, s24, s4
    ds_read_b128 a[164:167], v19 offset:17408
    v_mfma_f32_16x16x32_bf16 v[96:99], a[136:139], a[200:203], v[96:99]
    s_waitcnt lgkmcnt(6)
    s_lshl_b32 s24, s24, 15
    v_exp_f32 v112, v112
    v_mfma_f32_16x16x32_bf16 v[96:99], a[140:143], a[204:207], v[96:99]
    buffer_load_dwordx4 v15, s[8:11], s19 offen offset:2048 lds
    v_mfma_f32_16x16x32_bf16 v[104:107], a[128:131], a[208:211], v[68:71]
    s_add_u32 s24, s24, 50331648
    v_exp_f32 v113, v113
    v_cmp_ne_u32 vcc, 0, v3
    s_cmp_eq_u64 vcc, -1
    s_cbranch_scc0 L_C1_slow_9
L_C1_ok_10:
    v_mfma_f32_16x16x32_bf16 v[104:107], a[132:135], a[212:215], v[104:107]
    s_add_u32 s74, s24, 0
    ds_read_b128 a[168:171], v19 offset:18432
    v_cvt_pk_bf16_f32 v56, v112, v113
    v_mfma_f32_16x16x32_bf16 v[104:107], a[136:139], a[216:219], v[104:107]
    s_waitcnt lgkmcnt(6)
    v_exp_f32 v114, v114
    v_mfma_f32_16x16x32_bf16 v[104:107], a[140:143], a[220:223], v[104:107]
    buffer_load_dwordx4 v15, s[8:11], s19 offen offset:3072 lds
    v_mfma_f32_16x16x32_bf16 v[100:103], a[144:147], a[192:195], v[64:67]
    s_waitcnt lgkmcnt(5)
    s_xor_b32 s16, s16, 98304
    v_exp_f32 v115, v115
    v_mfma_f32_16x16x32_bf16 v[100:103], a[148:151], a[196:199], v[100:103]
    s_waitcnt lgkmcnt(4)
    ds_read_b128 a[172:175], v19 offset:19456
    v_cvt_pk_bf16_f32 v57, v114, v115
    v_mfma_f32_16x16x32_bf16 v[100:103], a[152:155], a[200:203], v[100:103]
    s_waitcnt lgkmcnt(4)
    v_exp_f32 v116, v116
    v_mfma_f32_16x16x32_bf16 v[100:103], a[156:159], a[204:207], v[100:103]
    buffer_load_dwordx4 a[64:67], v1, s[8:11], s74 offen offset:0
    v_mfma_f32_16x16x32_bf16 v[108:111], a[144:147], a[208:211], v[68:71]
    s_add_u32 s74, s24, 0
    v_exp_f32 v117, v117
    v_mfma_f32_16x16x32_bf16 v[108:111], a[148:151], a[212:215], v[108:111]
    ds_read_b128 a[176:179], v20 offset:20480
    v_cvt_pk_bf16_f32 v58, v116, v117
    v_mfma_f32_16x16x32_bf16 v[108:111], a[152:155], a[216:219], v[108:111]
    v_exp_f32 v118, v118
    v_mfma_f32_16x16x32_bf16 v[108:111], a[156:159], a[220:223], v[108:111]
    buffer_load_dwordx4 a[68:71], v1, s[8:11], s74 offen offset:1024
    v_mfma_f32_16x16x32_bf16 v[32:35], v[28:31], v[48:51], v[32:35]
    s_add_u32 s74, s24, 0
    v_exp_f32 v119, v119
    v_mfma_f32_16x16x32_bf16 v[36:39], v[28:31], v[52:55], v[36:39]
    s_waitcnt lgkmcnt(4)
    ds_read_b128 a[180:183], v20 offset:21504
    v_cvt_pk_bf16_f32 v59, v118, v119
    v_mfma_f32_16x16x32_bf16 v[128:131], a[160:163], v[48:51], v[128:131]
    s_waitcnt lgkmcnt(4)
    v_exp_f32 v120, v120
    v_mfma_f32_16x16x32_bf16 v[160:163], a[160:163], v[52:55], v[160:163]
    buffer_load_dwordx4 a[72:75], v1, s[8:11], s74 offen offset:2048
    v_mfma_f32_16x16x32_bf16 v[132:135], a[164:167], v[48:51], v[132:135]
    s_add_u32 s74, s24, 0
    v_exp_f32 v121, v121
    v_mfma_f32_16x16x32_bf16 v[164:167], a[164:167], v[52:55], v[164:167]
    s_waitcnt lgkmcnt(3)
    ds_read_b128 a[184:187], v20 offset:22528
    v_cvt_pk_bf16_f32 v60, v120, v121
    v_mfma_f32_16x16x32_bf16 v[136:139], a[168:171], v[48:51], v[136:139]
    s_waitcnt lgkmcnt(3)
    v_exp_f32 v122, v122
    v_mfma_f32_16x16x32_bf16 v[168:171], a[168:171], v[52:55], v[168:171]
    buffer_load_dwordx4 a[76:79], v1, s[8:11], s74 offen offset:3072
    v_mfma_f32_16x16x32_bf16 v[140:143], a[172:175], v[48:51], v[140:143]
    v_exp_f32 v123, v123
    v_mfma_f32_16x16x32_bf16 v[172:175], a[172:175], v[52:55], v[172:175]
    s_waitcnt lgkmcnt(2)
    ds_read_b128 a[188:191], v20 offset:23552
    v_cvt_pk_bf16_f32 v61, v122, v123
    v_mfma_f32_16x16x32_bf16 v[144:147], a[176:179], v[48:51], v[144:147]
    v_exp_f32 v124, v124
    v_mfma_f32_16x16x32_bf16 v[176:179], a[176:179], v[52:55], v[176:179]
    s_waitcnt lgkmcnt(2)
    v_mfma_f32_16x16x32_bf16 v[148:151], a[180:183], v[48:51], v[148:151]
    v_exp_f32 v125, v125
    v_mfma_f32_16x16x32_bf16 v[180:183], a[180:183], v[52:55], v[180:183]
    s_waitcnt lgkmcnt(1)
    v_cvt_pk_bf16_f32 v62, v124, v125
    v_xor_b32 v19, 98304, v19
    v_mfma_f32_16x16x32_bf16 v[152:155], a[184:187], v[48:51], v[152:155]
    v_exp_f32 v126, v126
    v_mfma_f32_16x16x32_bf16 v[184:187], a[184:187], v[52:55], v[184:187]
    s_waitcnt lgkmcnt(0)
    v_xor_b32 v20, 98304, v20
    v_mfma_f32_16x16x32_bf16 v[156:159], a[188:191], v[48:51], v[156:159]
    v_exp_f32 v127, v127
    v_mfma_f32_16x16x32_bf16 v[188:191], a[188:191], v[52:55], v[188:191]
    v_cvt_pk_bf16_f32 v63, v126, v127
    v_mfma_f32_16x16x32_bf16 v[112:115], a[128:131], a[224:227], v[72:75]
    s_add_u32 m0, s62, 36864
    v_exp_f32 v96, v96
    v_mfma_f32_16x16x32_bf16 v[112:115], a[132:135], a[228:231], v[112:115]
    v_mfma_f32_16x16x32_bf16 v[112:115], a[136:139], a[232:235], v[112:115]
    s_add_u32 s98, s65, 32768
    v_exp_f32 v97, v97
    v_mfma_f32_16x16x32_bf16 v[112:115], a[140:143], a[236:239], v[112:115]
    v_cvt_pk_bf16_f32 v48, v96, v97
    v_mfma_f32_16x16x32_bf16 v[120:123], a[128:131], a[240:243], v[76:79]
    v_exp_f32 v98, v98
    v_mfma_f32_16x16x32_bf16 v[120:123], a[132:135], a[244:247], v[120:123]
    buffer_load_dwordx4 v8, s[28:31], s98 offen offset:0  lds
    v_mfma_f32_16x16x32_bf16 v[120:123], a[136:139], a[248:251], v[120:123]
    v_exp_f32 v99, v99
    v_mfma_f32_16x16x32_bf16 v[120:123], a[140:143], a[252:255], v[120:123]
    buffer_load_dwordx4 v9, s[28:31], s98 offen offset:1024  lds
    v_mfma_f32_16x16x32_bf16 v[116:119], a[144:147], a[224:227], v[72:75]
    v_exp_f32 v100, v100
    v_mfma_f32_16x16x32_bf16 v[116:119], a[148:151], a[228:231], v[116:119]
    ds_read_b128 a[128:131], v18 offset:16384
    v_cvt_pk_bf16_f32 v49, v98, v99
    v_mfma_f32_16x16x32_bf16 v[116:119], a[152:155], a[232:235], v[116:119]
    s_add_u32 s19, s82, 32768
    v_exp_f32 v101, v101
    v_mfma_f32_16x16x32_bf16 v[116:119], a[156:159], a[236:239], v[116:119]
    s_sub_u32 s82, s12, s13
    ds_read_b128 a[132:135], v18 offset:17408
    v_cvt_pk_bf16_f32 v50, v100, v101
    v_mfma_f32_16x16x32_bf16 v[124:127], a[144:147], a[240:243], v[76:79]
    s_sub_u32 s82, s82, 1
    v_exp_f32 v102, v102
    v_mfma_f32_16x16x32_bf16 v[124:127], a[148:151], a[244:247], v[124:127]
    s_cmp_gt_u32 s12, s13
    s_cselect_b32 s82, s82, s12
    s_lshl_b32 s82, s82, 16
    ds_read_b128 a[136:139], v18 offset:18432
    v_mfma_f32_16x16x32_bf16 v[124:127], a[152:155], a[248:251], v[124:127]
    s_add_u32 s82, s82, s81
    v_exp_f32 v103, v103
    v_mfma_f32_16x16x32_bf16 v[124:127], a[156:159], a[252:255], v[124:127]
    s_cmp_ge_u32 s12, 17
    s_cselect_b32 s82, 2147471360, s82
    ds_read_b128 a[140:143], v18 offset:19456
    v_cvt_pk_bf16_f32 v51, v102, v103
    v_mfma_f32_16x16x32_bf16 v[40:43], v[28:31], v[56:59], v[40:43]
    s_add_u32 s12, s12, 1
    v_exp_f32 v104, v104
    v_mfma_f32_16x16x32_bf16 v[44:47], v[28:31], v[60:63], v[44:47]
    ds_read_b128 a[144:147], v18 offset:20480
    v_mfma_f32_16x16x32_bf16 v[192:195], a[160:163], v[56:59], v[192:195]
    v_exp_f32 v105, v105
    v_mfma_f32_16x16x32_bf16 v[224:227], a[160:163], v[60:63], v[224:227]
    ds_read_b128 a[148:151], v18 offset:21504
    v_cvt_pk_bf16_f32 v52, v104, v105
    v_mfma_f32_16x16x32_bf16 v[196:199], a[164:167], v[56:59], v[196:199]
    v_exp_f32 v106, v106
    v_mfma_f32_16x16x32_bf16 v[228:231], a[164:167], v[60:63], v[228:231]
    ds_read_b128 a[152:155], v18 offset:22528
    v_mfma_f32_16x16x32_bf16 v[200:203], a[168:171], v[56:59], v[200:203]
    v_exp_f32 v107, v107
    v_mfma_f32_16x16x32_bf16 v[232:235], a[168:171], v[60:63], v[232:235]
    ds_read_b128 a[156:159], v18 offset:23552
    v_cvt_pk_bf16_f32 v53, v106, v107
    v_mfma_f32_16x16x32_bf16 v[204:207], a[172:175], v[56:59], v[204:207]
    v_exp_f32 v108, v108
    v_mfma_f32_16x16x32_bf16 v[236:239], a[172:175], v[60:63], v[236:239]
    buffer_load_dwordx4 v10, s[28:31], s98 offen offset:2048  lds
    v_mfma_f32_16x16x32_bf16 v[208:211], a[176:179], v[56:59], v[208:211]
    v_exp_f32 v109, v109
    v_mfma_f32_16x16x32_bf16 v[240:243], a[176:179], v[60:63], v[240:243]
    v_cvt_pk_bf16_f32 v54, v108, v109
    v_xor_b32 v18, 196608, v18
    v_mfma_f32_16x16x32_bf16 v[212:215], a[180:183], v[56:59], v[212:215]
    v_exp_f32 v110, v110
    v_mfma_f32_16x16x32_bf16 v[244:247], a[180:183], v[60:63], v[244:247]
    buffer_load_dwordx4 v11, s[28:31], s98 offen offset:3072  lds
    v_mfma_f32_16x16x32_bf16 v[216:219], a[184:187], v[56:59], v[216:219]
    s_add_u32 s74, s24, 4096
    v_exp_f32 v111, v111
    v_mfma_f32_16x16x32_bf16 v[248:251], a[184:187], v[60:63], v[248:251]
    v_cvt_pk_bf16_f32 v55, v110, v111
    v_mfma_f32_16x16x32_bf16 v[220:223], a[188:191], v[56:59], v[220:223]
    buffer_load_dwordx4 a[80:83], v1, s[8:11], s74 offen offset:0
    v_mfma_f32_16x16x32_bf16 v[252:255], a[188:191], v[60:63], v[252:255]
    s_add_u32 s74, s24, 4096
    buffer_load_dwordx4 a[84:87], v1, s[8:11], s74 offen offset:1024
    s_add_u32 s74, s24, 4096
    buffer_load_dwordx4 a[88:91], v1, s[8:11], s74 offen offset:2048
    s_add_u32 s74, s24, 4096
    buffer_load_dwordx4 a[92:95], v1, s[8:11], s74 offen offset:3072
    s_waitcnt vmcnt(12) lgkmcnt(0)
    s_barrier
    v_mfma_f32_16x16x32_bf16 v[96:99], a[128:131], a[192:195], v[64:67]
    s_add_u32 m0, s15, 0
    ds_read_b128 a[160:163], v19 offset:0
    v_mfma_f32_16x16x32_bf16 v[96:99], a[132:135], a[196:199], v[96:99]
    ds_read_b128 a[164:167], v19 offset:1024
    v_mfma_f32_16x16x32_bf16 v[96:99], a[136:139], a[200:203], v[96:99]
    v_exp_f32 v112, v112
    v_mfma_f32_16x16x32_bf16 v[96:99], a[140:143], a[204:207], v[96:99]
    buffer_load_dwordx4 v1, s[8:11], s82 offen offset:0 lds
    v_mfma_f32_16x16x32_bf16 v[104:107], a[128:131], a[208:211], v[68:71]
    v_exp_f32 v113, v113
    v_mfma_f32_16x16x32_bf16 v[104:107], a[132:135], a[212:215], v[104:107]
    ds_read_b128 a[168:171], v19 offset:2048
    v_cvt_pk_bf16_f32 v56, v112, v113
    v_mfma_f32_16x16x32_bf16 v[104:107], a[136:139], a[216:219], v[104:107]
    v_exp_f32 v114, v114
    v_mfma_f32_16x16x32_bf16 v[104:107], a[140:143], a[220:223], v[104:107]
    buffer_load_dwordx4 v1, s[8:11], s82 offen offset:1024 lds
    v_mfma_f32_16x16x32_bf16 v[100:103], a[144:147], a[192:195], v[64:67]
    v_exp_f32 v115, v115
    v_mfma_f32_16x16x32_bf16 v[100:103], a[148:151], a[196:199], v[100:103]
    ds_read_b128 a[172:175], v19 offset:3072
    v_cvt_pk_bf16_f32 v57, v114, v115
    v_mfma_f32_16x16x32_bf16 v[100:103], a[152:155], a[200:203], v[100:103]
    v_exp_f32 v116, v116
    v_mfma_f32_16x16x32_bf16 v[100:103], a[156:159], a[204:207], v[100:103]
    buffer_load_dwordx4 v1, s[8:11], s82 offen offset:2048 lds
    v_mfma_f32_16x16x32_bf16 v[108:111], a[144:147], a[208:211], v[68:71]
    v_exp_f32 v117, v117
    v_mfma_f32_16x16x32_bf16 v[108:111], a[148:151], a[212:215], v[108:111]
    ds_read_b128 a[176:179], v20 offset:4096
    v_cvt_pk_bf16_f32 v58, v116, v117
    v_mfma_f32_16x16x32_bf16 v[108:111], a[152:155], a[216:219], v[108:111]
    v_exp_f32 v118, v118
    v_mfma_f32_16x16x32_bf16 v[108:111], a[156:159], a[220:223], v[108:111]
    buffer_load_dwordx4 v1, s[8:11], s82 offen offset:3072 lds
    v_mfma_f32_16x16x32_bf16 v[32:35], v[28:31], v[48:51], v[32:35]
    s_add_u32 m0, s15, 4096
    v_exp_f32 v119, v119
    v_mfma_f32_16x16x32_bf16 v[36:39], v[28:31], v[52:55], v[36:39]
    s_waitcnt lgkmcnt(4)
    ds_read_b128 a[180:183], v20 offset:5120
    v_cvt_pk_bf16_f32 v59, v118, v119
    v_mfma_f32_16x16x32_bf16 v[128:131], a[160:163], v[48:51], v[128:131]
    v_exp_f32 v120, v120
    v_mfma_f32_16x16x32_bf16 v[160:163], a[160:163], v[52:55], v[160:163]
    s_waitcnt lgkmcnt(4)
    v_mfma_f32_16x16x32_bf16 v[132:135], a[164:167], v[48:51], v[132:135]
    v_exp_f32 v121, v121
    v_mfma_f32_16x16x32_bf16 v[164:167], a[164:167], v[52:55], v[164:167]
    s_waitcnt lgkmcnt(3)
    ds_read_b128 a[184:187], v20 offset:6144
    v_cvt_pk_bf16_f32 v60, v120, v121
    v_mfma_f32_16x16x32_bf16 v[136:139], a[168:171], v[48:51], v[136:139]
    s_waitcnt lgkmcnt(3)
    v_exp_f32 v122, v122
    v_mfma_f32_16x16x32_bf16 v[168:171], a[168:171], v[52:55], v[168:171]
    buffer_load_dwordx4 v15, s[8:11], s82 offen offset:0 lds
    v_mfma_f32_16x16x32_bf16 v[140:143], a[172:175], v[48:51], v[140:143]
    v_exp_f32 v123, v123
    v_mfma_f32_16x16x32_bf16 v[172:175], a[172:175], v[52:55], v[172:175]
    s_waitcnt lgkmcnt(2)
    ds_read_b128 a[188:191], v20 offset:7168
    v_cvt_pk_bf16_f32 v61, v122, v123
    v_mfma_f32_16x16x32_bf16 v[144:147], a[176:179], v[48:51], v[144:147]
    s_waitcnt lgkmcnt(2)
    v_exp_f32 v124, v124
    v_mfma_f32_16x16x32_bf16 v[176:179], a[176:179], v[52:55], v[176:179]
    buffer_load_dwordx4 v15, s[8:11], s82 offen offset:1024 lds
    v_mfma_f32_16x16x32_bf16 v[148:151], a[180:183], v[48:51], v[148:151]
    v_exp_f32 v125, v125
    v_mfma_f32_16x16x32_bf16 v[180:183], a[180:183], v[52:55], v[180:183]
    s_waitcnt lgkmcnt(1)
    v_cvt_pk_bf16_f32 v62, v124, v125
    v_mfma_f32_16x16x32_bf16 v[152:155], a[184:187], v[48:51], v[152:155]
    s_waitcnt lgkmcnt(0)
    v_exp_f32 v126, v126
    v_mfma_f32_16x16x32_bf16 v[184:187], a[184:187], v[52:55], v[184:187]
    buffer_load_dwordx4 v15, s[8:11], s82 offen offset:2048 lds
    v_mfma_f32_16x16x32_bf16 v[156:159], a[188:191], v[48:51], v[156:159]
    v_exp_f32 v127, v127
    v_mfma_f32_16x16x32_bf16 v[188:191], a[188:191], v[52:55], v[188:191]
    v_cvt_pk_bf16_f32 v63, v126, v127
    v_mfma_f32_16x16x32_bf16 v[112:115], a[128:131], a[224:227], v[72:75]
    v_mfma_f32_16x16x32_bf16 v[112:115], a[132:135], a[228:231], v[112:115]
    v_mfma_f32_16x16x32_bf16 v[112:115], a[136:139], a[232:235], v[112:115]
    v_exp_f32 v96, v96
    v_mfma_f32_16x16x32_bf16 v[112:115], a[140:143], a[236:239], v[112:115]
    buffer_load_dwordx4 v15, s[8:11], s82 offen offset:3072 lds
    v_mfma_f32_16x16x32_bf16 v[120:123], a[128:131], a[240:243], v[76:79]
    s_xor_b32 s15, s15, 196608
    v_exp_f32 v97, v97
    v_mfma_f32_16x16x32_bf16 v[120:123], a[132:135], a[244:247], v[120:123]
    s_add_u32 m0, s16, 0
    ds_read_b128 a[128:131], v18 offset:0
    v_cvt_pk_bf16_f32 v48, v96, v97
    v_mfma_f32_16x16x32_bf16 v[120:123], a[136:139], a[248:251], v[120:123]
    v_exp_f32 v98, v98
    v_mfma_f32_16x16x32_bf16 v[120:123], a[140:143], a[252:255], v[120:123]
    buffer_load_dwordx4 v1, s[8:11], s19 offen offset:0 lds
    v_mfma_f32_16x16x32_bf16 v[116:119], a[144:147], a[224:227], v[72:75]
    v_exp_f32 v99, v99
    v_mfma_f32_16x16x32_bf16 v[116:119], a[148:151], a[228:231], v[116:119]
    ds_read_b128 a[132:135], v18 offset:1024
    v_cvt_pk_bf16_f32 v49, v98, v99
    v_mfma_f32_16x16x32_bf16 v[116:119], a[152:155], a[232:235], v[116:119]
    v_exp_f32 v100, v100
    v_mfma_f32_16x16x32_bf16 v[116:119], a[156:159], a[236:239], v[116:119]
    buffer_load_dwordx4 v1, s[8:11], s19 offen offset:1024 lds
    v_mfma_f32_16x16x32_bf16 v[124:127], a[144:147], a[240:243], v[76:79]
    v_exp_f32 v101, v101
    v_mfma_f32_16x16x32_bf16 v[124:127], a[148:151], a[244:247], v[124:127]
    ds_read_b128 a[136:139], v18 offset:2048
    v_cvt_pk_bf16_f32 v50, v100, v101
    v_mfma_f32_16x16x32_bf16 v[124:127], a[152:155], a[248:251], v[124:127]
    v_exp_f32 v102, v102
    v_mfma_f32_16x16x32_bf16 v[124:127], a[156:159], a[252:255], v[124:127]
    buffer_load_dwordx4 v1, s[8:11], s19 offen offset:2048 lds
    v_mfma_f32_16x16x32_bf16 v[40:43], v[28:31], v[56:59], v[40:43]
    v_exp_f32 v103, v103
    v_mfma_f32_16x16x32_bf16 v[44:47], v[28:31], v[60:63], v[44:47]
    ds_read_b128 a[140:143], v18 offset:3072
    v_cvt_pk_bf16_f32 v51, v102, v103
    v_mfma_f32_16x16x32_bf16 v[192:195], a[160:163], v[56:59], v[192:195]
    v_exp_f32 v104, v104
    v_mfma_f32_16x16x32_bf16 v[224:227], a[160:163], v[60:63], v[224:227]
    v_mfma_f32_16x16x32_bf16 v[196:199], a[164:167], v[56:59], v[196:199]
    v_exp_f32 v105, v105
    v_mfma_f32_16x16x32_bf16 v[228:231], a[164:167], v[60:63], v[228:231]
    ds_read_b128 a[144:147], v18 offset:4096
    v_cvt_pk_bf16_f32 v52, v104, v105
    v_mfma_f32_16x16x32_bf16 v[200:203], a[168:171], v[56:59], v[200:203]
    v_exp_f32 v106, v106
    v_mfma_f32_16x16x32_bf16 v[232:235], a[168:171], v[60:63], v[232:235]
    buffer_load_dwordx4 v1, s[8:11], s19 offen offset:3072 lds
    v_mfma_f32_16x16x32_bf16 v[204:207], a[172:175], v[56:59], v[204:207]
    s_add_u32 m0, s16, 4096
    v_exp_f32 v107, v107
    v_mfma_f32_16x16x32_bf16 v[236:239], a[172:175], v[60:63], v[236:239]
    ds_read_b128 a[148:151], v18 offset:5120
    v_cvt_pk_bf16_f32 v53, v106, v107
    v_mfma_f32_16x16x32_bf16 v[208:211], a[176:179], v[56:59], v[208:211]
    v_exp_f32 v108, v108
    v_mfma_f32_16x16x32_bf16 v[240:243], a[176:179], v[60:63], v[240:243]
    buffer_load_dwordx4 v15, s[8:11], s19 offen offset:0 lds
    v_mfma_f32_16x16x32_bf16 v[212:215], a[180:183], v[56:59], v[212:215]
    v_exp_f32 v109, v109
    v_mfma_f32_16x16x32_bf16 v[244:247], a[180:183], v[60:63], v[244:247]
    ds_read_b128 a[152:155], v18 offset:6144
    v_cvt_pk_bf16_f32 v54, v108, v109
    v_mfma_f32_16x16x32_bf16 v[216:219], a[184:187], v[56:59], v[216:219]
    v_exp_f32 v110, v110
    v_mfma_f32_16x16x32_bf16 v[248:251], a[184:187], v[60:63], v[248:251]
    buffer_load_dwordx4 v15, s[8:11], s19 offen offset:1024 lds
    v_mfma_f32_16x16x32_bf16 v[220:223], a[188:191], v[56:59], v[220:223]
    v_exp_f32 v111, v111
    v_mfma_f32_16x16x32_bf16 v[252:255], a[188:191], v[60:63], v[252:255]
    ds_read_b128 a[156:159], v18 offset:7168
    v_cvt_pk_bf16_f32 v55, v110, v111
    s_waitcnt lgkmcnt(7)
    v_mfma_f32_16x16x32_bf16 v[96:99], a[128:131], a[192:195], v[64:67]
    s_waitcnt lgkmcnt(6)
    ds_read_b128 a[160:163], v19 offset:16384
    v_mfma_f32_16x16x32_bf16 v[96:99], a[132:135], a[196:199], v[96:99]
    s_waitcnt lgkmcnt(6)
    ds_read_b128 a[164:167], v19 offset:17408
    v_mfma_f32_16x16x32_bf16 v[96:99], a[136:139], a[200:203], v[96:99]
    s_waitcnt lgkmcnt(6)
    v_exp_f32 v112, v112
    v_mfma_f32_16x16x32_bf16 v[96:99], a[140:143], a[204:207], v[96:99]
    buffer_load_dwordx4 v15, s[8:11], s19 offen offset:2048 lds
    v_mfma_f32_16x16x32_bf16 v[104:107], a[128:131], a[208:211], v[68:71]
    v_exp_f32 v113, v113
    v_mfma_f32_16x16x32_bf16 v[104:107], a[132:135], a[212:215], v[104:107]
    ds_read_b128 a[168:171], v19 offset:18432
    v_cvt_pk_bf16_f32 v56, v112, v113
    v_mfma_f32_16x16x32_bf16 v[104:107], a[136:139], a[216:219], v[104:107]
    s_waitcnt lgkmcnt(6)
    v_exp_f32 v114, v114
    v_mfma_f32_16x16x32_bf16 v[104:107], a[140:143], a[220:223], v[104:107]
    buffer_load_dwordx4 v15, s[8:11], s19 offen offset:3072 lds
    v_mfma_f32_16x16x32_bf16 v[100:103], a[144:147], a[192:195], v[64:67]
    s_waitcnt lgkmcnt(5)
    s_xor_b32 s16, s16, 98304
    v_exp_f32 v115, v115
    v_mfma_f32_16x16x32_bf16 v[100:103], a[148:151], a[196:199], v[100:103]
    s_waitcnt lgkmcnt(4)
    ds_read_b128 a[172:175], v19 offset:19456
    v_cvt_pk_bf16_f32 v57, v114, v115
    v_mfma_f32_16x16x32_bf16 v[100:103], a[152:155], a[200:203], v[100:103]
    s_waitcnt lgkmcnt(4)
    v_exp_f32 v116, v116
    v_mfma_f32_16x16x32_bf16 v[100:103], a[156:159], a[204:207], v[100:103]
    buffer_atomic_add v6, v7, s[36:39], s64 offen sc1
    v_mfma_f32_16x16x32_bf16 v[108:111], a[144:147], a[208:211], v[68:71]
    s_mov_b32 s64, 2147479552
    v_exp_f32 v117, v117
    v_mfma_f32_16x16x32_bf16 v[108:111], a[148:151], a[212:215], v[108:111]
    s_add_u32 s74, s24, 8192
    ds_read_b128 a[176:179], v20 offset:20480
    v_cvt_pk_bf16_f32 v58, v116, v117
    v_mfma_f32_16x16x32_bf16 v[108:111], a[152:155], a[216:219], v[108:111]
    v_exp_f32 v118, v118
    v_mfma_f32_16x16x32_bf16 v[108:111], a[156:159], a[220:223], v[108:111]
    buffer_load_dwordx4 a[96:99], v1, s[8:11], s74 offen offset:0
    v_mfma_f32_16x16x32_bf16 v[32:35], v[28:31], v[48:51], v[32:35]
    s_add_u32 s74, s24, 8192
    v_exp_f32 v119, v119
    v_mfma_f32_16x16x32_bf16 v[36:39], v[28:31], v[52:55], v[36:39]
    s_waitcnt lgkmcnt(4)
    ds_read_b128 a[180:183], v20 offset:21504
    v_cvt_pk_bf16_f32 v59, v118, v119
    v_mfma_f32_16x16x32_bf16 v[128:131], a[160:163], v[48:51], v[128:131]
    s_waitcnt lgkmcnt(4)
    v_exp_f32 v120, v120
    v_mfma_f32_16x16x32_bf16 v[160:163], a[160:163], v[52:55], v[160:163]
    buffer_load_dwordx4 a[100:103], v1, s[8:11], s74 offen offset:1024
    v_mfma_f32_16x16x32_bf16 v[132:135], a[164:167], v[48:51], v[132:135]
    s_add_u32 s74, s24, 8192
    v_exp_f32 v121, v121
    v_mfma_f32_16x16x32_bf16 v[164:167], a[164:167], v[52:55], v[164:167]
    s_waitcnt lgkmcnt(3)
    ds_read_b128 a[184:187], v20 offset:22528
    v_cvt_pk_bf16_f32 v60, v120, v121
    v_mfma_f32_16x16x32_bf16 v[136:139], a[168:171], v[48:51], v[136:139]
    s_waitcnt lgkmcnt(3)
    v_exp_f32 v122, v122
    v_mfma_f32_16x16x32_bf16 v[168:171], a[168:171], v[52:55], v[168:171]
    buffer_load_dwordx4 a[104:107], v1, s[8:11], s74 offen offset:2048
    v_mfma_f32_16x16x32_bf16 v[140:143], a[172:175], v[48:51], v[140:143]
    s_add_u32 s74, s24, 8192
    v_exp_f32 v123, v123
    v_mfma_f32_16x16x32_bf16 v[172:175], a[172:175], v[52:55], v[172:175]
    s_waitcnt lgkmcnt(2)
    ds_read_b128 a[188:191], v20 offset:23552
    v_cvt_pk_bf16_f32 v61, v122, v123
    v_mfma_f32_16x16x32_bf16 v[144:147], a[176:179], v[48:51], v[144:147]
    s_waitcnt lgkmcnt(2)
    v_exp_f32 v124, v124
    v_mfma_f32_16x16x32_bf16 v[176:179], a[176:179], v[52:55], v[176:179]
    buffer_load_dwordx4 a[108:111], v1, s[8:11], s74 offen offset:3072
    v_mfma_f32_16x16x32_bf16 v[148:151], a[180:183], v[48:51], v[148:151]
    v_exp_f32 v125, v125
    v_mfma_f32_16x16x32_bf16 v[180:183], a[180:183], v[52:55], v[180:183]
    s_waitcnt lgkmcnt(1)
    v_cvt_pk_bf16_f32 v62, v124, v125
    v_xor_b32 v19, 98304, v19
    v_mfma_f32_16x16x32_bf16 v[152:155], a[184:187], v[48:51], v[152:155]
    v_exp_f32 v126, v126
    v_mfma_f32_16x16x32_bf16 v[184:187], a[184:187], v[52:55], v[184:187]
    s_waitcnt lgkmcnt(0)
    v_xor_b32 v20, 98304, v20
    v_mfma_f32_16x16x32_bf16 v[156:159], a[188:191], v[48:51], v[156:159]
    v_exp_f32 v127, v127
    v_mfma_f32_16x16x32_bf16 v[188:191], a[188:191], v[52:55], v[188:191]
    v_cvt_pk_bf16_f32 v63, v126, v127
    v_mfma_f32_16x16x32_bf16 v[112:115], a[128:131], a[224:227], v[72:75]
    s_add_u32 s74, s24, 12288
    v_exp_f32 v96, v96
    v_mfma_f32_16x16x32_bf16 v[112:115], a[132:135], a[228:231], v[112:115]
    buffer_load_dwordx4 a[112:115], v1, s[8:11], s74 offen offset:0
    v_mfma_f32_16x16x32_bf16 v[112:115], a[136:139], a[232:235], v[112:115]
    s_add_u32 s74, s24, 12288
    v_exp_f32 v97, v97
    v_mfma_f32_16x16x32_bf16 v[112:115], a[140:143], a[236:239], v[112:115]
    v_cvt_pk_bf16_f32 v48, v96, v97
    v_add_f32 v92, 0, v21
    v_mfma_f32_16x16x32_bf16 v[120:123], a[128:131], a[240:243], v[76:79]
    v_exp_f32 v98, v98
    v_mfma_f32_16x16x32_bf16 v[120:123], a[132:135], a[244:247], v[120:123]
    buffer_load_dwordx4 a[116:119], v1, s[8:11], s74 offen offset:1024
    v_mfma_f32_16x16x32_bf16 v[120:123], a[136:139], a[248:251], v[120:123]
    s_add_u32 s74, s24, 12288
    v_exp_f32 v99, v99
    v_mfma_f32_16x16x32_bf16 v[120:123], a[140:143], a[252:255], v[120:123]
    buffer_load_dwordx4 a[120:123], v1, s[8:11], s74 offen offset:2048
    v_mfma_f32_16x16x32_bf16 v[116:119], a[144:147], a[224:227], v[72:75]
    s_add_u32 s74, s24, 12288
    v_exp_f32 v100, v100
    v_mfma_f32_16x16x32_bf16 v[116:119], a[148:151], a[228:231], v[116:119]
    ds_read_b128 a[128:131], v18 offset:16384
    v_cvt_pk_bf16_f32 v49, v98, v99
    v_mfma_f32_16x16x32_bf16 v[116:119], a[152:155], a[232:235], v[116:119]
    s_add_u32 s19, s82, 32768
    v_exp_f32 v101, v101
    v_mfma_f32_16x16x32_bf16 v[116:119], a[156:159], a[236:239], v[116:119]
    s_sub_u32 s82, s12, s13
    ds_read_b128 a[132:135], v18 offset:17408
    v_cvt_pk_bf16_f32 v50, v100, v101
    v_mfma_f32_16x16x32_bf16 v[124:127], a[144:147], a[240:243], v[76:79]
    s_sub_u32 s82, s82, 1
    v_exp_f32 v102, v102
    v_mfma_f32_16x16x32_bf16 v[124:127], a[148:151], a[244:247], v[124:127]
    s_cmp_gt_u32 s12, s13
    s_cselect_b32 s82, s82, s12
    s_lshl_b32 s82, s82, 16
    ds_read_b128 a[136:139], v18 offset:18432
    v_mfma_f32_16x16x32_bf16 v[124:127], a[152:155], a[248:251], v[124:127]
    s_add_u32 s82, s82, s81
    v_exp_f32 v103, v103
    v_mfma_f32_16x16x32_bf16 v[124:127], a[156:159], a[252:255], v[124:127]
    s_cmp_ge_u32 s12, 17
    s_cselect_b32 s82, 2147471360, s82
    ds_read_b128 a[140:143], v18 offset:19456
    v_cvt_pk_bf16_f32 v51, v102, v103
    v_mfma_f32_16x16x32_bf16 v[40:43], v[28:31], v[56:59], v[40:43]
    s_add_u32 s12, s12, 1
    v_exp_f32 v104, v104
    v_mfma_f32_16x16x32_bf16 v[44:47], v[28:31], v[60:63], v[44:47]
    ds_read_b128 a[144:147], v18 offset:20480
    v_min_f32 v92, v92, v68
    v_mfma_f32_16x16x32_bf16 v[192:195], a[160:163], v[56:59], v[192:195]
    v_exp_f32 v105, v105
    v_mfma_f32_16x16x32_bf16 v[224:227], a[160:163], v[60:63], v[224:227]
    ds_read_b128 a[148:151], v18 offset:21504
    v_cvt_pk_bf16_f32 v52, v104, v105
    v_mfma_f32_16x16x32_bf16 v[196:199], a[164:167], v[56:59], v[196:199]
    v_exp_f32 v106, v106
    v_mfma_f32_16x16x32_bf16 v[228:231], a[164:167], v[60:63], v[228:231]
    ds_read_b128 a[152:155], v18 offset:22528
    v_add_f32 v93, 0xf1800000, v21
    v_mfma_f32_16x16x32_bf16 v[200:203], a[168:171], v[56:59], v[200:203]
    v_exp_f32 v107, v107
    v_mfma_f32_16x16x32_bf16 v[232:235], a[168:171], v[60:63], v[232:235]
    ds_read_b128 a[156:159], v18 offset:23552
    v_cvt_pk_bf16_f32 v53, v106, v107
    v_mfma_f32_16x16x32_bf16 v[204:207], a[172:175], v[56:59], v[204:207]
    v_exp_f32 v108, v108
    v_mfma_f32_16x16x32_bf16 v[236:239], a[172:175], v[60:63], v[236:239]
    buffer_load_dwordx4 a[124:127], v1, s[8:11], s74 offen offset:3072
    v_mfma_f32_16x16x32_bf16 v[208:211], a[176:179], v[56:59], v[208:211]
    v_exp_f32 v109, v109
    v_mfma_f32_16x16x32_bf16 v[240:243], a[176:179], v[60:63], v[240:243]
    v_cvt_pk_bf16_f32 v54, v108, v109
    v_xor_b32 v18, 196608, v18
    v_mfma_f32_16x16x32_bf16 v[212:215], a[180:183], v[56:59], v[212:215]
    v_exp_f32 v110, v110
    v_mfma_f32_16x16x32_bf16 v[244:247], a[180:183], v[60:63], v[244:247]
    v_min_f32 v93, v93, v69
    v_add_f32 v94, 0xf2000000, v21
    v_mfma_f32_16x16x32_bf16 v[216:219], a[184:187], v[56:59], v[216:219]
    v_exp_f32 v111, v111
    v_mfma_f32_16x16x32_bf16 v[248:251], a[184:187], v[60:63], v[248:251]
    v_cvt_pk_bf16_f32 v55, v110, v111
    v_min_f32 v94, v94, v70
    v_mfma_f32_16x16x32_bf16 v[220:223], a[188:191], v[56:59], v[220:223]
    v_add_f32 v95, 0xf2400000, v21
    v_min_f32 v95, v95, v71
    v_mfma_f32_16x16x32_bf16 v[252:255], a[188:191], v[60:63], v[252:255]
    s_waitcnt vmcnt(9) lgkmcnt(0)
    s_barrier
    v_mfma_f32_16x16x32_bf16 v[96:99], a[128:131], a[192:195], v[64:67]
    s_add_u32 m0, s15, 0
    ds_read_b128 a[160:163], v19 offset:0
    v_mfma_f32_16x16x32_bf16 v[96:99], a[132:135], a[196:199], v[96:99]
    ds_read_b128 a[164:167], v19 offset:1024
    v_mfma_f32_16x16x32_bf16 v[96:99], a[136:139], a[200:203], v[96:99]
    v_exp_f32 v112, v112
    v_mfma_f32_16x16x32_bf16 v[96:99], a[140:143], a[204:207], v[96:99]
    buffer_load_dwordx4 v1, s[8:11], s82 offen offset:0 lds
    v_mfma_f32_16x16x32_bf16 v[104:107], a[128:131], a[208:211], v[68:71]
    v_exp_f32 v113, v113
    v_mfma_f32_16x16x32_bf16 v[104:107], a[132:135], a[212:215], v[104:107]
    ds_read_b128 a[168:171], v19 offset:2048
    v_cvt_pk_bf16_f32 v56, v112, v113
    v_mfma_f32_16x16x32_bf16 v[104:107], a[136:139], a[216:219], v[104:107]
    v_exp_f32 v114, v114
    v_mfma_f32_16x16x32_bf16 v[104:107], a[140:143], a[220:223], v[104:107]
    buffer_load_dwordx4 v1, s[8:11], s82 offen offset:1024 lds
    v_mfma_f32_16x16x32_bf16 v[100:103], a[144:147], a[192:195], v[64:67]
    v_exp_f32 v115, v115
    v_mfma_f32_16x16x32_bf16 v[100:103], a[148:151], a[196:199], v[100:103]
    ds_read_b128 a[172:175], v19 offset:3072
    v_cvt_pk_bf16_f32 v57, v114, v115
    v_mfma_f32_16x16x32_bf16 v[100:103], a[152:155], a[200:203], v[100:103]
    v_exp_f32 v116, v116
    v_mfma_f32_16x16x32_bf16 v[100:103], a[156:159], a[204:207], v[100:103]
    buffer_load_dwordx4 v1, s[8:11], s82 offen offset:2048 lds
    v_mfma_f32_16x16x32_bf16 v[108:111], a[144:147], a[208:211], v[68:71]
    v_exp_f32 v117, v117
    v_mfma_f32_16x16x32_bf16 v[108:111], a[148:151], a[212:215], v[108:111]
    ds_read_b128 a[176:179], v20 offset:4096
    v_cvt_pk_bf16_f32 v58, v116, v117
    v_mfma_f32_16x16x32_bf16 v[108:111], a[152:155], a[216:219], v[108:111]
    v_exp_f32 v118, v118
    v_mfma_f32_16x16x32_bf16 v[108:111], a[156:159], a[220:223], v[108:111]
    buffer_load_dwordx4 v1, s[8:11], s82 offen offset:3072 lds
    v_mfma_f32_16x16x32_bf16 v[32:35], v[28:31], v[48:51], v[32:35]
    s_add_u32 m0, s15, 4096
    v_exp_f32 v119, v119
    v_mfma_f32_16x16x32_bf16 v[36:39], v[28:31], v[52:55], v[36:39]
    s_waitcnt lgkmcnt(4)
    ds_read_b128 a[180:183], v20 offset:5120
    v_cvt_pk_bf16_f32 v59, v118, v119
    v_mfma_f32_16x16x32_bf16 v[128:131], a[160:163], v[48:51], v[128:131]
    v_exp_f32 v120, v120
    v_mfma_f32_16x16x32_bf16 v[160:163], a[160:163], v[52:55], v[160:163]
    s_waitcnt lgkmcnt(4)
    v_mfma_f32_16x16x32_bf16 v[132:135], a[164:167], v[48:51], v[132:135]
    v_exp_f32 v121, v121
    v_mfma_f32_16x16x32_bf16 v[164:167], a[164:167], v[52:55], v[164:167]
    s_waitcnt lgkmcnt(3)
    ds_read_b128 a[184:187], v20 offset:6144
    v_cvt_pk_bf16_f32 v60, v120, v121
    v_mfma_f32_16x16x32_bf16 v[136:139], a[168:171], v[48:51], v[136:139]
    s_waitcnt lgkmcnt(3)
    v_exp_f32 v122, v122
    v_mfma_f32_16x16x32_bf16 v[168:171], a[168:171], v[52:55], v[168:171]
    buffer_load_dwordx4 v15, s[8:11], s82 offen offset:0 lds
    v_mfma_f32_16x16x32_bf16 v[140:143], a[172:175], v[48:51], v[140:143]
    v_exp_f32 v123, v123
    v_mfma_f32_16x16x32_bf16 v[172:175], a[172:175], v[52:55], v[172:175]
    s_waitcnt lgkmcnt(2)
    ds_read_b128 a[188:191], v20 offset:7168
    v_cvt_pk_bf16_f32 v61, v122, v123
    v_mfma_f32_16x16x32_bf16 v[144:147], a[176:179], v[48:51], v[144:147]
    s_waitcnt lgkmcnt(2)
    v_exp_f32 v124, v124
    v_mfma_f32_16x16x32_bf16 v[176:179], a[176:179], v[52:55], v[176:179]
    buffer_load_dwordx4 v15, s[8:11], s82 offen offset:1024 lds
    v_mfma_f32_16x16x32_bf16 v[148:151], a[180:183], v[48:51], v[148:151]
    v_exp_f32 v125, v125
    v_mfma_f32_16x16x32_bf16 v[180:183], a[180:183], v[52:55], v[180:183]
    s_waitcnt lgkmcnt(1)
    v_cvt_pk_bf16_f32 v62, v124, v125
    v_mfma_f32_16x16x32_bf16 v[152:155], a[184:187], v[48:51], v[152:155]
    s_waitcnt lgkmcnt(0)
    v_exp_f32 v126, v126
    v_mfma_f32_16x16x32_bf16 v[184:187], a[184:187], v[52:55], v[184:187]
    buffer_load_dwordx4 v15, s[8:11], s82 offen offset:2048 lds
    v_mfma_f32_16x16x32_bf16 v[156:159], a[188:191], v[48:51], v[156:159]
    v_exp_f32 v127, v127
    v_mfma_f32_16x16x32_bf16 v[188:191], a[188:191], v[52:55], v[188:191]
    v_cvt_pk_bf16_f32 v63, v126, v127
    v_mfma_f32_16x16x32_bf16 v[112:115], a[128:131], a[224:227], v[72:75]
    v_mfma_f32_16x16x32_bf16 v[112:115], a[132:135], a[228:231], v[112:115]
    v_mfma_f32_16x16x32_bf16 v[112:115], a[136:139], a[232:235], v[112:115]
    v_exp_f32 v96, v96
    v_mfma_f32_16x16x32_bf16 v[112:115], a[140:143], a[236:239], v[112:115]
    buffer_load_dwordx4 v15, s[8:11], s82 offen offset:3072 lds
    v_mfma_f32_16x16x32_bf16 v[120:123], a[128:131], a[240:243], v[76:79]
    s_xor_b32 s15, s15, 196608
    v_exp_f32 v97, v97
    v_mfma_f32_16x16x32_bf16 v[120:123], a[132:135], a[244:247], v[120:123]
    s_add_u32 m0, s16, 0
    ds_read_b128 a[128:131], v18 offset:0
    v_cvt_pk_bf16_f32 v48, v96, v97
    v_mfma_f32_16x16x32_bf16 v[120:123], a[136:139], a[248:251], v[120:123]
    v_exp_f32 v98, v98
    v_mfma_f32_16x16x32_bf16 v[120:123], a[140:143], a[252:255], v[120:123]
    buffer_load_dwordx4 v1, s[8:11], s19 offen offset:0 lds
    v_mfma_f32_16x16x32_bf16 v[116:119], a[144:147], a[224:227], v[72:75]
    v_exp_f32 v99, v99
    v_mfma_f32_16x16x32_bf16 v[116:119], a[148:151], a[228:231], v[116:119]
    ds_read_b128 a[132:135], v18 offset:1024
    v_cvt_pk_bf16_f32 v49, v98, v99
    v_mfma_f32_16x16x32_bf16 v[116:119], a[152:155], a[232:235], v[116:119]
    v_exp_f32 v100, v100
    v_mfma_f32_16x16x32_bf16 v[116:119], a[156:159], a[236:239], v[116:119]
    buffer_load_dwordx4 v1, s[8:11], s19 offen offset:1024 lds
    v_mfma_f32_16x16x32_bf16 v[124:127], a[144:147], a[240:243], v[76:79]
    v_exp_f32 v101, v101
    v_mfma_f32_16x16x32_bf16 v[124:127], a[148:151], a[244:247], v[124:127]
    ds_read_b128 a[136:139], v18 offset:2048
    v_cvt_pk_bf16_f32 v50, v100, v101
    v_mfma_f32_16x16x32_bf16 v[124:127], a[152:155], a[248:251], v[124:127]
    v_exp_f32 v102, v102
    v_mfma_f32_16x16x32_bf16 v[124:127], a[156:159], a[252:255], v[124:127]
    buffer_load_dwordx4 v1, s[8:11], s19 offen offset:2048 lds
    v_mfma_f32_16x16x32_bf16 v[40:43], v[28:31], v[56:59], v[40:43]
    v_exp_f32 v103, v103
    v_mfma_f32_16x16x32_bf16 v[44:47], v[28:31], v[60:63], v[44:47]
    ds_read_b128 a[140:143], v18 offset:3072
    v_cvt_pk_bf16_f32 v51, v102, v103
    v_mfma_f32_16x16x32_bf16 v[192:195], a[160:163], v[56:59], v[192:195]
    v_exp_f32 v104, v104
    v_mfma_f32_16x16x32_bf16 v[224:227], a[160:163], v[60:63], v[224:227]
    v_mfma_f32_16x16x32_bf16 v[196:199], a[164:167], v[56:59], v[196:199]
    v_exp_f32 v105, v105
    v_mfma_f32_16x16x32_bf16 v[228:231], a[164:167], v[60:63], v[228:231]
    ds_read_b128 a[144:147], v18 offset:4096
    v_cvt_pk_bf16_f32 v52, v104, v105
    v_mfma_f32_16x16x32_bf16 v[200:203], a[168:171], v[56:59], v[200:203]
    v_exp_f32 v106, v106
    v_mfma_f32_16x16x32_bf16 v[232:235], a[168:171], v[60:63], v[232:235]
    buffer_load_dwordx4 v1, s[8:11], s19 offen offset:3072 lds
    v_mfma_f32_16x16x32_bf16 v[204:207], a[172:175], v[56:59], v[204:207]
    s_add_u32 m0, s16, 4096
    v_exp_f32 v107, v107
    v_mfma_f32_16x16x32_bf16 v[236:239], a[172:175], v[60:63], v[236:239]
    ds_read_b128 a[148:151], v18 offset:5120
    v_cvt_pk_bf16_f32 v53, v106, v107
    v_mfma_f32_16x16x32_bf16 v[208:211], a[176:179], v[56:59], v[208:211]
    v_exp_f32 v108, v108
    v_mfma_f32_16x16x32_bf16 v[240:243], a[176:179], v[60:63], v[240:243]
    buffer_load_dwordx4 v15, s[8:11], s19 offen offset:0 lds
    v_mfma_f32_16x16x32_bf16 v[212:215], a[180:183], v[56:59], v[212:215]
    v_exp_f32 v109, v109
    v_mfma_f32_16x16x32_bf16 v[244:247], a[180:183], v[60:63], v[244:247]
    ds_read_b128 a[152:155], v18 offset:6144
    v_cvt_pk_bf16_f32 v54, v108, v109
    v_mfma_f32_16x16x32_bf16 v[216:219], a[184:187], v[56:59], v[216:219]
    v_exp_f32 v110, v110
    v_mfma_f32_16x16x32_bf16 v[248:251], a[184:187], v[60:63], v[248:251]
    buffer_load_dwordx4 v15, s[8:11], s19 offen offset:1024 lds
    v_mfma_f32_16x16x32_bf16 v[220:223], a[188:191], v[56:59], v[220:223]
    v_exp_f32 v111, v111
    v_mfma_f32_16x16x32_bf16 v[252:255], a[188:191], v[60:63], v[252:255]
    ds_read_b128 a[156:159], v18 offset:7168
    v_cvt_pk_bf16_f32 v55, v110, v111
.p2align 3
L_t2_loop:
    s_waitcnt lgkmcnt(7)
    v_mfma_f32_16x16x32_bf16 v[96:99], a[128:131], a[192:195], v[64:67]
    s_waitcnt lgkmcnt(6)
    ds_read_b128 a[160:163], v19 offset:16384
    v_mfma_f32_16x16x32_bf16 v[96:99], a[132:135], a[196:199], v[96:99]
    s_waitcnt lgkmcnt(6)
    ds_read_b128 a[164:167], v19 offset:17408
    v_mfma_f32_16x16x32_bf16 v[96:99], a[136:139], a[200:203], v[96:99]
    s_waitcnt lgkmcnt(6)
    v_exp_f32 v112, v112
    v_mfma_f32_16x16x32_bf16 v[96:99], a[140:143], a[204:207], v[96:99]
    buffer_load_dwordx4 v15, s[8:11], s19 offen offset:2048 lds
    v_mfma_f32_16x16x32_bf16 v[104:107], a[128:131], a[208:211], v[68:71]
    v_exp_f32 v113, v113
    v_mfma_f32_16x16x32_bf16 v[104:107], a[132:135], a[212:215], v[104:107]
    ds_read_b128 a[168:171], v19 offset:18432
    v_cvt_pk_bf16_f32 v56, v112, v113
    v_mfma_f32_16x16x32_bf16 v[104:107], a[136:139], a[216:219], v[104:107]
    s_waitcnt lgkmcnt(6)
    v_exp_f32 v114, v114
    v_mfma_f32_16x16x32_bf16 v[104:107], a[140:143], a[220:223], v[104:107]
    buffer_load_dwordx4 v15, s[8:11], s19 offen offset:3072 lds
    v_mfma_f32_16x16x32_bf16 v[100:103], a[144:147], a[192:195], v[64:67]
    s_waitcnt lgkmcnt(5)
    s_xor_b32 s16, s16, 98304
    v_exp_f32 v115, v115
    v_mfma_f32_16x16x32_bf16 v[100:103], a[148:151], a[196:199], v[100:103]
    s_waitcnt lgkmcnt(4)
    ds_read_b128 a[172:175], v19 offset:19456
    v_cvt_pk_bf16_f32 v57, v114, v115
    v_mfma_f32_16x16x32_bf16 v[100:103], a[152:155], a[200:203], v[100:103]
    s_waitcnt lgkmcnt(4)
    v_exp_f32 v116, v116
    v_mfma_f32_16x16x32_bf16 v[100:103], a[156:159], a[204:207], v[100:103]
    v_mfma_f32_16x16x32_bf16 v[108:111], a[144:147], a[208:211], v[68:71]
    v_exp_f32 v117, v117
    v_mfma_f32_16x16x32_bf16 v[108:111], a[148:151], a[212:215], v[108:111]
    ds_read_b128 a[176:179], v20 offset:20480
    v_cvt_pk_bf16_f32 v58, v116, v117
    v_mfma_f32_16x16x32_bf16 v[108:111], a[152:155], a[216:219], v[108:111]
    v_exp_f32 v118, v118
    v_mfma_f32_16x16x32_bf16 v[108:111], a[156:159], a[220:223], v[108:111]
    v_mfma_f32_16x16x32_bf16 v[32:35], v[28:31], v[48:51], v[32:35]
    v_exp_f32 v119, v119
    v_mfma_f32_16x16x32_bf16 v[36:39], v[28:31], v[52:55], v[36:39]
    s_waitcnt lgkmcnt(4)
    ds_read_b128 a[180:183], v20 offset:21504
    v_cvt_pk_bf16_f32 v59, v118, v119
    v_mfma_f32_16x16x32_bf16 v[128:131], a[160:163], v[48:51], v[128:131]
    v_exp_f32 v120, v120
    v_mfma_f32_16x16x32_bf16 v[160:163], a[160:163], v[52:55], v[160:163]
    s_waitcnt lgkmcnt(4)
    v_mfma_f32_16x16x32_bf16 v[132:135], a[164:167], v[48:51], v[132:135]
    v_exp_f32 v121, v121
    v_mfma_f32_16x16x32_bf16 v[164:167], a[164:167], v[52:55], v[164:167]
    s_waitcnt lgkmcnt(3)
    ds_read_b128 a[184:187], v20 offset:22528
    v_cvt_pk_bf16_f32 v60, v120, v121
    v_mfma_f32_16x16x32_bf16 v[136:139], a[168:171], v[48:51], v[136:139]
    v_exp_f32 v122, v122
    v_mfma_f32_16x16x32_bf16 v[168:171], a[168:171], v[52:55], v[168:171]
    s_waitcnt lgkmcnt(3)
    v_mfma_f32_16x16x32_bf16 v[140:143], a[172:175], v[48:51], v[140:143]
    v_exp_f32 v123, v123
    v_mfma_f32_16x16x32_bf16 v[172:175], a[172:175], v[52:55], v[172:175]
    s_waitcnt lgkmcnt(2)
    ds_read_b128 a[188:191], v20 offset:23552
    v_cvt_pk_bf16_f32 v61, v122, v123
    v_mfma_f32_16x16x32_bf16 v[144:147], a[176:179], v[48:51], v[144:147]
    v_exp_f32 v124, v124
    v_mfma_f32_16x16x32_bf16 v[176:179], a[176:179], v[52:55], v[176:179]
    s_waitcnt lgkmcnt(2)
    v_mfma_f32_16x16x32_bf16 v[148:151], a[180:183], v[48:51], v[148:151]
    v_exp_f32 v125, v125
    v_mfma_f32_16x16x32_bf16 v[180:183], a[180:183], v[52:55], v[180:183]
    s_waitcnt lgkmcnt(1)
    v_cvt_pk_bf16_f32 v62, v124, v125
    v_xor_b32 v19, 98304, v19
    v_mfma_f32_16x16x32_bf16 v[152:155], a[184:187], v[48:51], v[152:155]
    v_exp_f32 v126, v126
    v_mfma_f32_16x16x32_bf16 v[184:187], a[184:187], v[52:55], v[184:187]
    s_waitcnt lgkmcnt(0)
    v_xor_b32 v20, 98304, v20
    v_mfma_f32_16x16x32_bf16 v[156:159], a[188:191], v[48:51], v[156:159]
    v_exp_f32 v127, v127
    v_mfma_f32_16x16x32_bf16 v[188:191], a[188:191], v[52:55], v[188:191]
    v_cvt_pk_bf16_f32 v63, v126, v127
    v_mfma_f32_16x16x32_bf16 v[112:115], a[128:131], a[224:227], v[72:75]
    v_exp_f32 v96, v96
    v_mfma_f32_16x16x32_bf16 v[112:115], a[132:135], a[228:231], v[112:115]
    v_mfma_f32_16x16x32_bf16 v[112:115], a[136:139], a[232:235], v[112:115]
    v_exp_f32 v97, v97
    v_mfma_f32_16x16x32_bf16 v[112:115], a[140:143], a[236:239], v[112:115]
    v_cvt_pk_bf16_f32 v48, v96, v97
    v_mfma_f32_16x16x32_bf16 v[120:123], a[128:131], a[240:243], v[76:79]
    v_exp_f32 v98, v98
    v_mfma_f32_16x16x32_bf16 v[120:123], a[132:135], a[244:247], v[120:123]
    v_mfma_f32_16x16x32_bf16 v[120:123], a[136:139], a[248:251], v[120:123]
    v_exp_f32 v99, v99
    v_mfma_f32_16x16x32_bf16 v[120:123], a[140:143], a[252:255], v[120:123]
    v_mfma_f32_16x16x32_bf16 v[116:119], a[144:147], a[224:227], v[72:75]
    v_exp_f32 v100, v100
    v_mfma_f32_16x16x32_bf16 v[116:119], a[148:151], a[228:231], v[116:119]
    ds_read_b128 a[128:131], v18 offset:16384
    v_cvt_pk_bf16_f32 v49, v98, v99
    v_mfma_f32_16x16x32_bf16 v[116:119], a[152:155], a[232:235], v[116:119]
    s_add_u32 s19, s82, 32768
    v_exp_f32 v101, v101
    v_mfma_f32_16x16x32_bf16 v[116:119], a[156:159], a[236:239], v[116:119]
    s_sub_u32 s82, s12, s13
    ds_read_b128 a[132:135], v18 offset:17408
    v_cvt_pk_bf16_f32 v50, v100, v101
    v_mfma_f32_16x16x32_bf16 v[124:127], a[144:147], a[240:243], v[76:79]
    s_sub_u32 s82, s82, 1
    v_exp_f32 v102, v102
    v_mfma_f32_16x16x32_bf16 v[124:127], a[148:151], a[244:247], v[124:127]
    s_cmp_gt_u32 s12, s13
    s_cselect_b32 s82, s82, s12
    s_lshl_b32 s82, s82, 16
    ds_read_b128 a[136:139], v18 offset:18432
    v_mfma_f32_16x16x32_bf16 v[124:127], a[152:155], a[248:251], v[124:127]
    s_add_u32 s82, s82, s81
    v_exp_f32 v103, v103
    v_mfma_f32_16x16x32_bf16 v[124:127], a[156:159], a[252:255], v[124:127]
    s_cmp_ge_u32 s12, 17
    s_cselect_b32 s82, 2147471360, s82
    ds_read_b128 a[140:143], v18 offset:19456
    v_cvt_pk_bf16_f32 v51, v102, v103
    v_mfma_f32_16x16x32_bf16 v[40:43], v[28:31], v[56:59], v[40:43]
    s_add_u32 s12, s12, 1
    v_exp_f32 v104, v104
    v_mfma_f32_16x16x32_bf16 v[44:47], v[28:31], v[60:63], v[44:47]
    ds_read_b128 a[144:147], v18 offset:20480
    v_mfma_f32_16x16x32_bf16 v[192:195], a[160:163], v[56:59], v[192:195]
    v_exp_f32 v105, v105
    v_mfma_f32_16x16x32_bf16 v[224:227], a[160:163], v[60:63], v[224:227]
    ds_read_b128 a[148:151], v18 offset:21504
    v_cvt_pk_bf16_f32 v52, v104, v105
    v_mfma_f32_16x16x32_bf16 v[196:199], a[164:167], v[56:59], v[196:199]
    v_exp_f32 v106, v106
    v_mfma_f32_16x16x32_bf16 v[228:231], a[164:167], v[60:63], v[228:231]
    ds_read_b128 a[152:155], v18 offset:22528
    v_mfma_f32_16x16x32_bf16 v[200:203], a[168:171], v[56:59], v[200:203]
    v_exp_f32 v107, v107
    v_mfma_f32_16x16x32_bf16 v[232:235], a[168:171], v[60:63], v[232:235]
    ds_read_b128 a[156:159], v18 offset:23552
    v_cvt_pk_bf16_f32 v53, v106, v107
    v_mfma_f32_16x16x32_bf16 v[204:207], a[172:175], v[56:59], v[204:207]
    v_exp_f32 v108, v108
    v_mfma_f32_16x16x32_bf16 v[236:239], a[172:175], v[60:63], v[236:239]
    v_mfma_f32_16x16x32_bf16 v[208:211], a[176:179], v[56:59], v[208:211]
    v_exp_f32 v109, v109
    v_mfma_f32_16x16x32_bf16 v[240:243], a[176:179], v[60:63], v[240:243]
    v_cvt_pk_bf16_f32 v54, v108, v109
    v_xor_b32 v18, 196608, v18
    v_mfma_f32_16x16x32_bf16 v[212:215], a[180:183], v[56:59], v[212:215]
    v_exp_f32 v110, v110
    v_mfma_f32_16x16x32_bf16 v[244:247], a[180:183], v[60:63], v[244:247]
    v_mfma_f32_16x16x32_bf16 v[216:219], a[184:187], v[56:59], v[216:219]
    v_exp_f32 v111, v111
    v_mfma_f32_16x16x32_bf16 v[248:251], a[184:187], v[60:63], v[248:251]
    v_cvt_pk_bf16_f32 v55, v110, v111
    v_mfma_f32_16x16x32_bf16 v[220:223], a[188:191], v[56:59], v[220:223]
    v_mfma_f32_16x16x32_bf16 v[252:255], a[188:191], v[60:63], v[252:255]
    s_waitcnt vmcnt(0) lgkmcnt(0)
    s_barrier
    v_mfma_f32_16x16x32_bf16 v[96:99], a[128:131], a[192:195], v[64:67]
    s_add_u32 m0, s15, 0
    ds_read_b128 a[160:163], v19 offset:0
    v_mfma_f32_16x16x32_bf16 v[96:99], a[132:135], a[196:199], v[96:99]
    ds_read_b128 a[164:167], v19 offset:1024
    v_mfma_f32_16x16x32_bf16 v[96:99], a[136:139], a[200:203], v[96:99]
    v_exp_f32 v112, v112
    v_mfma_f32_16x16x32_bf16 v[96:99], a[140:143], a[204:207], v[96:99]
    buffer_load_dwordx4 v1, s[8:11], s82 offen offset:0 lds
    v_mfma_f32_16x16x32_bf16 v[104:107], a[128:131], a[208:211], v[68:71]
    v_exp_f32 v113, v113
    v_mfma_f32_16x16x32_bf16 v[104:107], a[132:135], a[212:215], v[104:107]
    ds_read_b128 a[168:171], v19 offset:2048
    v_cvt_pk_bf16_f32 v56, v112, v113
    v_mfma_f32_16x16x32_bf16 v[104:107], a[136:139], a[216:219], v[104:107]
    v_exp_f32 v114, v114
    v_mfma_f32_16x16x32_bf16 v[104:107], a[140:143], a[220:223], v[104:107]
    buffer_load_dwordx4 v1, s[8:11], s82 offen offset:1024 lds
    v_mfma_f32_16x16x32_bf16 v[100:103], a[144:147], a[192:195], v[64:67]
    v_exp_f32 v115, v115
    v_mfma_f32_16x16x32_bf16 v[100:103], a[148:151], a[196:199], v[100:103]
    ds_read_b128 a[172:175], v19 offset:3072
    v_cvt_pk_bf16_f32 v57, v114, v115
    v_mfma_f32_16x16x32_bf16 v[100:103], a[152:155], a[200:203], v[100:103]
    v_exp_f32 v116, v116
    v_mfma_f32_16x16x32_bf16 v[100:103], a[156:159], a[204:207], v[100:103]
    buffer_load_dwordx4 v1, s[8:11], s82 offen offset:2048 lds
    v_mfma_f32_16x16x32_bf16 v[108:111], a[144:147], a[208:211], v[68:71]
    v_exp_f32 v117, v117
    v_mfma_f32_16x16x32_bf16 v[108:111], a[148:151], a[212:215], v[108:111]
    ds_read_b128 a[176:179], v20 offset:4096
    v_cvt_pk_bf16_f32 v58, v116, v117
    v_mfma_f32_16x16x32_bf16 v[108:111], a[152:155], a[216:219], v[108:111]
    v_exp_f32 v118, v118
    v_mfma_f32_16x16x32_bf16 v[108:111], a[156:159], a[220:223], v[108:111]
    buffer_load_dwordx4 v1, s[8:11], s82 offen offset:3072 lds
    v_mfma_f32_16x16x32_bf16 v[32:35], v[28:31], v[48:51], v[32:35]
    s_add_u32 m0, s15, 4096
    v_exp_f32 v119, v119
    v_mfma_f32_16x16x32_bf16 v[36:39], v[28:31], v[52:55], v[36:39]
    s_waitcnt lgkmcnt(4)
    ds_read_b128 a[180:183], v20 offset:5120
    v_cvt_pk_bf16_f32 v59, v118, v119
    v_mfma_f32_16x16x32_bf16 v[128:131], a[160:163], v[48:51], v[128:131]
    v_exp_f32 v120, v120
    v_mfma_f32_16x16x32_bf16 v[160:163], a[160:163], v[52:55], v[160:163]
    s_waitcnt lgkmcnt(4)
    v_mfma_f32_16x16x32_bf16 v[132:135], a[164:167], v[48:51], v[132:135]
    v_exp_f32 v121, v121
    v_mfma_f32_16x16x32_bf16 v[164:167], a[164:167], v[52:55], v[164:167]
    s_waitcnt lgkmcnt(3)
    ds_read_b128 a[184:187], v20 offset:6144
    v_cvt_pk_bf16_f32 v60, v120, v121
    v_mfma_f32_16x16x32_bf16 v[136:139], a[168:171], v[48:51], v[136:139]
    s_waitcnt lgkmcnt(3)
    v_exp_f32 v122, v122
    v_mfma_f32_16x16x32_bf16 v[168:171], a[168:171], v[52:55], v[168:171]
    buffer_load_dwordx4 v15, s[8:11], s82 offen offset:0 lds
    v_mfma_f32_16x16x32_bf16 v[140:143], a[172:175], v[48:51], v[140:143]
    v_exp_f32 v123, v123
    v_mfma_f32_16x16x32_bf16 v[172:175], a[172:175], v[52:55], v[172:175]
    s_waitcnt lgkmcnt(2)
    ds_read_b128 a[188:191], v20 offset:7168
    v_cvt_pk_bf16_f32 v61, v122, v123
    v_mfma_f32_16x16x32_bf16 v[144:147], a[176:179], v[48:51], v[144:147]
    s_waitcnt lgkmcnt(2)
    v_exp_f32 v124, v124
    v_mfma_f32_16x16x32_bf16 v[176:179], a[176:179], v[52:55], v[176:179]
    buffer_load_dwordx4 v15, s[8:11], s82 offen offset:1024 lds
    v_mfma_f32_16x16x32_bf16 v[148:151], a[180:183], v[48:51], v[148:151]
    v_exp_f32 v125, v125
    v_mfma_f32_16x16x32_bf16 v[180:183], a[180:183], v[52:55], v[180:183]
    s_waitcnt lgkmcnt(1)
    v_cvt_pk_bf16_f32 v62, v124, v125
    v_mfma_f32_16x16x32_bf16 v[152:155], a[184:187], v[48:51], v[152:155]
    s_waitcnt lgkmcnt(0)
    v_exp_f32 v126, v126
    v_mfma_f32_16x16x32_bf16 v[184:187], a[184:187], v[52:55], v[184:187]
    buffer_load_dwordx4 v15, s[8:11], s82 offen offset:2048 lds
    v_mfma_f32_16x16x32_bf16 v[156:159], a[188:191], v[48:51], v[156:159]
    v_exp_f32 v127, v127
    v_mfma_f32_16x16x32_bf16 v[188:191], a[188:191], v[52:55], v[188:191]
    v_cvt_pk_bf16_f32 v63, v126, v127
    v_mfma_f32_16x16x32_bf16 v[112:115], a[128:131], a[224:227], v[72:75]
    v_mfma_f32_16x16x32_bf16 v[112:115], a[132:135], a[228:231], v[112:115]
    v_mfma_f32_16x16x32_bf16 v[112:115], a[136:139], a[232:235], v[112:115]
    v_exp_f32 v96, v96
    v_mfma_f32_16x16x32_bf16 v[112:115], a[140:143], a[236:239], v[112:115]
    buffer_load_dwordx4 v15, s[8:11], s82 offen offset:3072 lds
    v_mfma_f32_16x16x32_bf16 v[120:123], a[128:131], a[240:243], v[76:79]
    s_xor_b32 s15, s15, 196608
    v_exp_f32 v97, v97
    v_mfma_f32_16x16x32_bf16 v[120:123], a[132:135], a[244:247], v[120:123]
    s_add_u32 m0, s16, 0
    ds_read_b128 a[128:131], v18 offset:0
    v_cvt_pk_bf16_f32 v48, v96, v97
    v_mfma_f32_16x16x32_bf16 v[120:123], a[136:139], a[248:251], v[120:123]
    v_exp_f32 v98, v98
    v_mfma_f32_16x16x32_bf16 v[120:123], a[140:143], a[252:255], v[120:123]
    buffer_load_dwordx4 v1, s[8:11], s19 offen offset:0 lds
    v_mfma_f32_16x16x32_bf16 v[116:119], a[144:147], a[224:227], v[72:75]
    v_exp_f32 v99, v99
    v_mfma_f32_16x16x32_bf16 v[116:119], a[148:151], a[228:231], v[116:119]
    ds_read_b128 a[132:135], v18 offset:1024
    v_cvt_pk_bf16_f32 v49, v98, v99
    v_mfma_f32_16x16x32_bf16 v[116:119], a[152:155], a[232:235], v[116:119]
    v_exp_f32 v100, v100
    v_mfma_f32_16x16x32_bf16 v[116:119], a[156:159], a[236:239], v[116:119]
    buffer_load_dwordx4 v1, s[8:11], s19 offen offset:1024 lds
    v_mfma_f32_16x16x32_bf16 v[124:127], a[144:147], a[240:243], v[76:79]
    v_exp_f32 v101, v101
    v_mfma_f32_16x16x32_bf16 v[124:127], a[148:151], a[244:247], v[124:127]
    ds_read_b128 a[136:139], v18 offset:2048
    v_cvt_pk_bf16_f32 v50, v100, v101
    v_mfma_f32_16x16x32_bf16 v[124:127], a[152:155], a[248:251], v[124:127]
    v_exp_f32 v102, v102
    v_mfma_f32_16x16x32_bf16 v[124:127], a[156:159], a[252:255], v[124:127]
    buffer_load_dwordx4 v1, s[8:11], s19 offen offset:2048 lds
    v_mfma_f32_16x16x32_bf16 v[40:43], v[28:31], v[56:59], v[40:43]
    v_exp_f32 v103, v103
    v_mfma_f32_16x16x32_bf16 v[44:47], v[28:31], v[60:63], v[44:47]
    ds_read_b128 a[140:143], v18 offset:3072
    v_cvt_pk_bf16_f32 v51, v102, v103
    v_mfma_f32_16x16x32_bf16 v[192:195], a[160:163], v[56:59], v[192:195]
    v_exp_f32 v104, v104
    v_mfma_f32_16x16x32_bf16 v[224:227], a[160:163], v[60:63], v[224:227]
    v_mfma_f32_16x16x32_bf16 v[196:199], a[164:167], v[56:59], v[196:199]
    v_exp_f32 v105, v105
    v_mfma_f32_16x16x32_bf16 v[228:231], a[164:167], v[60:63], v[228:231]
    ds_read_b128 a[144:147], v18 offset:4096
    v_cvt_pk_bf16_f32 v52, v104, v105
    v_mfma_f32_16x16x32_bf16 v[200:203], a[168:171], v[56:59], v[200:203]
    v_exp_f32 v106, v106
    v_mfma_f32_16x16x32_bf16 v[232:235], a[168:171], v[60:63], v[232:235]
    buffer_load_dwordx4 v1, s[8:11], s19 offen offset:3072 lds
    v_mfma_f32_16x16x32_bf16 v[204:207], a[172:175], v[56:59], v[204:207]
    s_add_u32 m0, s16, 4096
    v_exp_f32 v107, v107
    v_mfma_f32_16x16x32_bf16 v[236:239], a[172:175], v[60:63], v[236:239]
    ds_read_b128 a[148:151], v18 offset:5120
    v_cvt_pk_bf16_f32 v53, v106, v107
    v_mfma_f32_16x16x32_bf16 v[208:211], a[176:179], v[56:59], v[208:211]
    s_sub_u32 s14, s14, 1
    v_exp_f32 v108, v108
    v_mfma_f32_16x16x32_bf16 v[240:243], a[176:179], v[60:63], v[240:243]
    buffer_load_dwordx4 v15, s[8:11], s19 offen offset:0 lds
    v_mfma_f32_16x16x32_bf16 v[212:215], a[180:183], v[56:59], v[212:215]
    v_exp_f32 v109, v109
    v_mfma_f32_16x16x32_bf16 v[244:247], a[180:183], v[60:63], v[244:247]
    ds_read_b128 a[152:155], v18 offset:6144
    v_cvt_pk_bf16_f32 v54, v108, v109
    v_mfma_f32_16x16x32_bf16 v[216:219], a[184:187], v[56:59], v[216:219]
    v_exp_f32 v110, v110
    v_mfma_f32_16x16x32_bf16 v[248:251], a[184:187], v[60:63], v[248:251]
    buffer_load_dwordx4 v15, s[8:11], s19 offen offset:1024 lds
    v_mfma_f32_16x16x32_bf16 v[220:223], a[188:191], v[56:59], v[220:223]
    v_exp_f32 v111, v111
    v_mfma_f32_16x16x32_bf16 v[252:255], a[188:191], v[60:63], v[252:255]
    ds_read_b128 a[156:159], v18 offset:7168
    v_cvt_pk_bf16_f32 v55, v110, v111
    s_cmp_lg_u32 s14, 0
    s_cbranch_scc1 L_t2_loop
L_t2_diag:
    s_waitcnt lgkmcnt(7)
    v_mfma_f32_16x16x32_bf16 v[96:99], a[128:131], a[192:195], v[80:83]
    s_waitcnt lgkmcnt(6)
    ds_read_b128 a[160:163], v19 offset:16384
    v_mov_b32 v24, v8
    v_mov_b32 v25, v9
    v_mfma_f32_16x16x32_bf16 v[96:99], a[132:135], a[196:199], v[96:99]
    s_waitcnt lgkmcnt(6)
    ds_read_b128 a[164:167], v19 offset:17408
    v_mov_b32 v26, v10
    v_mov_b32 v27, v11
    v_mfma_f32_16x16x32_bf16 v[96:99], a[136:139], a[200:203], v[96:99]
    s_waitcnt lgkmcnt(6)
    v_exp_f32 v112, v112
    v_add_u32 v11, 131072, v16
    v_mfma_f32_16x16x32_bf16 v[96:99], a[140:143], a[204:207], v[96:99]
    buffer_load_dwordx4 v15, s[8:11], s19 offen offset:2048 lds
    v_mov_b32 v12, 0
    v_mfma_f32_16x16x32_bf16 v[104:107], a[128:131], a[208:211], v[88:91]
    s_mov_b32 s71, 128
    v_exp_f32 v113, v113
    v_mfma_f32_16x16x32_bf16 v[104:107], a[132:135], a[212:215], v[104:107]
    ds_read_b128 a[168:171], v19 offset:18432
    v_cvt_pk_bf16_f32 v56, v112, v113
    v_mfma_f32_16x16x32_bf16 v[104:107], a[136:139], a[216:219], v[104:107]
    s_waitcnt lgkmcnt(6)
    v_exp_f32 v114, v114
    v_mfma_f32_16x16x32_bf16 v[104:107], a[140:143], a[220:223], v[104:107]
    buffer_load_dwordx4 v15, s[8:11], s19 offen offset:3072 lds
    v_mfma_f32_16x16x32_bf16 v[100:103], a[144:147], a[192:195], v[84:87]
    s_waitcnt lgkmcnt(5)
    s_xor_b32 s16, s16, 98304
    v_exp_f32 v115, v115
    v_mfma_f32_16x16x32_bf16 v[100:103], a[148:151], a[196:199], v[100:103]
    s_waitcnt lgkmcnt(4)
    ds_read_b128 a[172:175], v19 offset:19456
    v_cvt_pk_bf16_f32 v57, v114, v115
    v_mfma_f32_16x16x32_bf16 v[100:103], a[152:155], a[200:203], v[100:103]
    s_waitcnt lgkmcnt(4)
    v_exp_f32 v116, v116
    v_mfma_f32_16x16x32_bf16 v[100:103], a[156:159], a[204:207], v[100:103]
    buffer_load_dword v3, v12, s[36:39], s71 offen sc0 sc1
    v_mfma_f32_16x16x32_bf16 v[108:111], a[144:147], a[208:211], v[92:95]
    v_exp_f32 v117, v117
    v_mfma_f32_16x16x32_bf16 v[108:111], a[148:151], a[212:215], v[108:111]
    ds_read_b128 a[176:179], v20 offset:20480
    v_cvt_pk_bf16_f32 v58, v116, v117
    v_mfma_f32_16x16x32_bf16 v[108:111], a[152:155], a[216:219], v[108:111]
    v_exp_f32 v118, v118
    v_mfma_f32_16x16x32_bf16 v[108:111], a[156:159], a[220:223], v[108:111]
    v_mfma_f32_16x16x32_bf16 v[32:35], v[28:31], v[48:51], v[32:35]
    v_exp_f32 v119, v119
    v_mfma_f32_16x16x32_bf16 v[36:39], v[28:31], v[52:55], v[36:39]
    s_waitcnt lgkmcnt(4)
    ds_read_b128 a[180:183], v20 offset:21504
    v_cvt_pk_bf16_f32 v59, v118, v119
    v_mfma_f32_16x16x32_bf16 v[128:131], a[160:163], v[48:51], v[128:131]
    v_exp_f32 v120, v120
    v_mfma_f32_16x16x32_bf16 v[160:163], a[160:163], v[52:55], v[160:163]
    s_waitcnt lgkmcnt(4)
    v_add_f32 v80, 0, v22
    v_min_f32 v80, v80, v72
    v_mfma_f32_16x16x32_bf16 v[132:135], a[164:167], v[48:51], v[132:135]
    v_exp_f32 v121, v121
    v_mfma_f32_16x16x32_bf16 v[164:167], a[164:167], v[52:55], v[164:167]
    s_waitcnt lgkmcnt(3)
    ds_read_b128 a[184:187], v20 offset:22528
    v_cvt_pk_bf16_f32 v60, v120, v121
    v_mfma_f32_16x16x32_bf16 v[136:139], a[168:171], v[48:51], v[136:139]
    v_exp_f32 v122, v122
    v_mfma_f32_16x16x32_bf16 v[168:171], a[168:171], v[52:55], v[168:171]
    s_waitcnt lgkmcnt(3)
    v_add_f32 v81, 0xf1800000, v22
    v_min_f32 v81, v81, v73
    v_mfma_f32_16x16x32_bf16 v[140:143], a[172:175], v[48:51], v[140:143]
    v_exp_f32 v123, v123
    v_mfma_f32_16x16x32_bf16 v[172:175], a[172:175], v[52:55], v[172:175]
    s_waitcnt lgkmcnt(2)
    ds_read_b128 a[188:191], v20 offset:23552
    v_cvt_pk_bf16_f32 v61, v122, v123
    v_mfma_f32_16x16x32_bf16 v[144:147], a[176:179], v[48:51], v[144:147]
    v_exp_f32 v124, v124
    v_mfma_f32_16x16x32_bf16 v[176:179], a[176:179], v[52:55], v[176:179]
    s_waitcnt lgkmcnt(2)
    v_add_f32 v82, 0xf2000000, v22
    v_min_f32 v82, v82, v74
    v_mfma_f32_16x16x32_bf16 v[148:151], a[180:183], v[48:51], v[148:151]
    v_exp_f32 v125, v125
    v_mfma_f32_16x16x32_bf16 v[180:183], a[180:183], v[52:55], v[180:183]
    s_waitcnt lgkmcnt(1)
    v_cvt_pk_bf16_f32 v62, v124, v125
    v_xor_b32 v19, 98304, v19
    v_mfma_f32_16x16x32_bf16 v[152:155], a[184:187], v[48:51], v[152:155]
    v_exp_f32 v126, v126
    v_mfma_f32_16x16x32_bf16 v[184:187], a[184:187], v[52:55], v[184:187]
    s_waitcnt lgkmcnt(0)
    v_xor_b32 v20, 98304, v20
    v_add_f32 v83, 0xf2400000, v22
    v_mfma_f32_16x16x32_bf16 v[156:159], a[188:191], v[48:51], v[156:159]
    v_exp_f32 v127, v127
    v_mfma_f32_16x16x32_bf16 v[188:191], a[188:191], v[52:55], v[188:191]
    v_cvt_pk_bf16_f32 v63, v126, v127
    v_min_f32 v83, v83, v75
    v_add_f32 v84, 0xf3800000, v22
    v_min_f32 v84, v84, v72
    v_mfma_f32_16x16x32_bf16 v[112:115], a[128:131], a[224:227], v[72:75]
    v_exp_f32 v96, v96
    v_mfma_f32_16x16x32_bf16 v[112:115], a[132:135], a[228:231], v[112:115]
    v_lshlrev_b32 v13, 4, v0
    v_cmp_gt_u32 vcc, 224, v0
    v_mfma_f32_16x16x32_bf16 v[112:115], a[136:139], a[232:235], v[112:115]
    v_exp_f32 v97, v97
    v_mfma_f32_16x16x32_bf16 v[112:115], a[140:143], a[236:239], v[112:115]
    v_cvt_pk_bf16_f32 v48, v96, v97
    v_mov_b32 v14, 2147479552
    v_mfma_f32_16x16x32_bf16 v[120:123], a[128:131], a[240:243], v[76:79]
    v_exp_f32 v98, v98
    v_mfma_f32_16x16x32_bf16 v[120:123], a[132:135], a[244:247], v[120:123]
    v_cndmask_b32 v14, v14, v13, vcc
    v_add_f32 v85, 0xf3880000, v22
    v_mfma_f32_16x16x32_bf16 v[120:123], a[136:139], a[248:251], v[120:123]
    v_exp_f32 v99, v99
    v_mfma_f32_16x16x32_bf16 v[120:123], a[140:143], a[252:255], v[120:123]
    v_min_f32 v85, v85, v73
    v_add_f32 v86, 0xf3900000, v22
    v_mfma_f32_16x16x32_bf16 v[116:119], a[144:147], a[224:227], v[72:75]
    v_exp_f32 v100, v100
    v_mfma_f32_16x16x32_bf16 v[116:119], a[148:151], a[228:231], v[116:119]
    ds_read_b128 a[128:131], v18 offset:16384
    v_cvt_pk_bf16_f32 v49, v98, v99
    v_mfma_f32_16x16x32_bf16 v[116:119], a[152:155], a[232:235], v[116:119]
    v_exp_f32 v101, v101
    v_mfma_f32_16x16x32_bf16 v[116:119], a[156:159], a[236:239], v[116:119]
    ds_read_b128 a[132:135], v18 offset:17408
    v_cvt_pk_bf16_f32 v50, v100, v101
    v_mfma_f32_16x16x32_bf16 v[124:127], a[144:147], a[240:243], v[76:79]
    v_exp_f32 v102, v102
    v_mfma_f32_16x16x32_bf16 v[124:127], a[148:151], a[244:247], v[124:127]
    ds_read_b128 a[136:139], v18 offset:18432
    v_min_f32 v86, v86, v74
    v_mfma_f32_16x16x32_bf16 v[124:127], a[152:155], a[248:251], v[124:127]
    v_exp_f32 v103, v103
    v_mfma_f32_16x16x32_bf16 v[124:127], a[156:159], a[252:255], v[124:127]
    ds_read_b128 a[140:143], v18 offset:19456
    v_cvt_pk_bf16_f32 v51, v102, v103
    v_mfma_f32_16x16x32_bf16 v[40:43], v[28:31], v[56:59], v[40:43]
    v_exp_f32 v104, v104
    v_mfma_f32_16x16x32_bf16 v[44:47], v[28:31], v[60:63], v[44:47]
    ds_read_b128 a[144:147], v18 offset:20480
    v_add_f32 v87, 0xf3980000, v22
    v_mfma_f32_16x16x32_bf16 v[192:195], a[160:163], v[56:59], v[192:195]
    v_exp_f32 v105, v105
    v_mfma_f32_16x16x32_bf16 v[224:227], a[160:163], v[60:63], v[224:227]
    ds_read_b128 a[148:151], v18 offset:21504
    v_cvt_pk_bf16_f32 v52, v104, v105
    v_mfma_f32_16x16x32_bf16 v[196:199], a[164:167], v[56:59], v[196:199]
    v_exp_f32 v106, v106
    v_mfma_f32_16x16x32_bf16 v[228:231], a[164:167], v[60:63], v[228:231]
    ds_read_b128 a[152:155], v18 offset:22528
    v_min_f32 v87, v87, v75
    v_mfma_f32_16x16x32_bf16 v[200:203], a[168:171], v[56:59], v[200:203]
    v_exp_f32 v107, v107
    s_waitcnt vmcnt(0)
    v_cmp_le_u32 vcc, 256, v3
    s_cmp_eq_u64 vcc, -1
    s_cbranch_scc0 L_F_slow_11
L_F_ok_12:
    v_mfma_f32_16x16x32_bf16 v[232:235], a[168:171], v[60:63], v[232:235]
    s_lshl_b32 s74, s66, 13
    ds_read_b128 a[156:159], v18 offset:23552
    v_cvt_pk_bf16_f32 v53, v106, v107
    v_mfma_f32_16x16x32_bf16 v[204:207], a[172:175], v[56:59], v[204:207]
    s_add_u32 s74, s74, 4194304
    v_exp_f32 v108, v108
    v_mfma_f32_16x16x32_bf16 v[236:239], a[172:175], v[60:63], v[236:239]
    v_add_f32 v88, 0x73800000, v22
    v_min_f32 v88, v88, v76
    v_mfma_f32_16x16x32_bf16 v[208:211], a[176:179], v[56:59], v[208:211]
    s_cmp_lt_u32 s66, 224
    s_cselect_b32 s74, s74, 2143285248
    v_exp_f32 v109, v109
    v_mfma_f32_16x16x32_bf16 v[240:243], a[176:179], v[60:63], v[240:243]
    v_cvt_pk_bf16_f32 v54, v108, v109
    v_xor_b32 v18, 196608, v18
    v_mfma_f32_16x16x32_bf16 v[212:215], a[180:183], v[56:59], v[212:215]
    v_exp_f32 v110, v110
    v_mfma_f32_16x16x32_bf16 v[244:247], a[180:183], v[60:63], v[244:247]
    buffer_load_dwordx4 a[0:3], v13, s[8:11], s74 offen
    v_mfma_f32_16x16x32_bf16 v[216:219], a[184:187], v[56:59], v[216:219]
    s_add_u32 s74, s74, 4096
    v_exp_f32 v111, v111
    v_mfma_f32_16x16x32_bf16 v[248:251], a[184:187], v[60:63], v[248:251]
    v_cvt_pk_bf16_f32 v55, v110, v111
    v_add_f32 v89, 0x73700000, v22
    v_mfma_f32_16x16x32_bf16 v[220:223], a[188:191], v[56:59], v[220:223]
    buffer_load_dwordx4 a[4:7], v13, s[8:11], s74 offen
    v_mfma_f32_16x16x32_bf16 v[252:255], a[188:191], v[60:63], v[252:255]
    s_add_u32 s74, s74, 2093056
    v_min_f32 v89, v89, v77
    v_add_f32 v90, 0x73600000, v22
    v_min_f32 v90, v90, v78
    v_add_f32 v91, 0x73500000, v22
    v_min_f32 v91, v91, v79
    v_add_f32 v92, 0, v22
    v_min_f32 v92, v92, v76
    v_add_f32 v93, 0xf1800000, v22
    v_min_f32 v93, v93, v77
    v_add_f32 v94, 0xf2000000, v22
    v_min_f32 v94, v94, v78
    v_add_f32 v95, 0xf2400000, v22
    v_min_f32 v95, v95, v79
    buffer_load_dwordx4 a[8:11], v13, s[8:11], s74 offen
    s_add_u32 s74, s74, 4096
    buffer_load_dwordx4 a[12:15], v13, s[8:11], s74 offen
    s_waitcnt lgkmcnt(0)
    s_barrier
L_t2_diagC:
    v_mfma_f32_16x16x32_bf16 v[96:99], a[128:131], a[224:227], v[80:83]
    s_xor_b32 s100, s62, 8192
    s_add_u32 s101, s62, 98304
    ds_read_b128 a[176:179], v20 offset:4096
    v_lshrrev_b32 v13, 1, v1
    v_add_u32 v12, s100, v13
    s_add_u32 m0, s62, 65536
    s_add_u32 s98, s65, 128
    buffer_load_dwordx4 v24, s[28:31], s98 offen offset:0  lds
    v_mfma_f32_16x16x32_bf16 v[96:99], a[132:135], a[228:231], v[96:99]
    v_exp_f32 v112, v112
    v_add_u32 v9, s101, v1
    v_mfma_f32_16x16x32_bf16 v[96:99], a[136:139], a[232:235], v[96:99]
    ds_read_b128 a[180:183], v20 offset:5120
    v_xor_b32 v8, 8192, v11
    v_xor_b32 v10, 8192, v9
    v_mfma_f32_16x16x32_bf16 v[96:99], a[140:143], a[236:239], v[96:99]
    v_exp_f32 v113, v113
    v_mfma_f32_16x16x32_bf16 v[100:103], a[144:147], a[224:227], v[84:87]
    ds_read_b128 a[184:187], v20 offset:6144
    v_cvt_pk_bf16_f32 v56, v112, v113
    v_mfma_f32_16x16x32_bf16 v[100:103], a[148:151], a[228:231], v[100:103]
    v_exp_f32 v114, v114
    buffer_load_dwordx4 v25, s[28:31], s98 offen offset:1024  lds
    v_mfma_f32_16x16x32_bf16 v[100:103], a[152:155], a[232:235], v[100:103]
    ds_read_b128 a[188:191], v20 offset:7168
    v_mfma_f32_16x16x32_bf16 v[100:103], a[156:159], a[236:239], v[100:103]
    v_exp_f32 v115, v115
    v_mfma_f32_16x16x32_bf16 v[104:107], a[128:131], a[240:243], v[88:91]
    ds_read_b128 a[160:163], v19 offset:0
    v_cvt_pk_bf16_f32 v57, v114, v115
    v_mfma_f32_16x16x32_bf16 v[104:107], a[132:135], a[244:247], v[104:107]
    v_exp_f32 v116, v116
    v_mfma_f32_16x16x32_bf16 v[104:107], a[136:139], a[248:251], v[104:107]
    ds_read_b128 a[164:167], v19 offset:1024
    buffer_load_dwordx4 v26, s[28:31], s98 offen offset:2048  lds
    v_mfma_f32_16x16x32_bf16 v[104:107], a[140:143], a[252:255], v[104:107]
    v_exp_f32 v117, v117
    v_mfma_f32_16x16x32_bf16 v[108:111], a[144:147], a[240:243], v[92:95]
    ds_read_b128 a[168:171], v19 offset:2048
    v_cvt_pk_bf16_f32 v58, v116, v117
    v_mfma_f32_16x16x32_bf16 v[108:111], a[148:151], a[244:247], v[108:111]
    v_exp_f32 v118, v118
    v_mfma_f32_16x16x32_bf16 v[108:111], a[152:155], a[248:251], v[108:111]
    ds_read_b128 a[172:175], v19 offset:3072
    v_mfma_f32_16x16x32_bf16 v[108:111], a[156:159], a[252:255], v[108:111]
    v_exp_f32 v119, v119
    buffer_load_dwordx4 v27, s[28:31], s98 offen offset:3072  lds
    v_mfma_f32_16x16x32_bf16 v[32:35], v[28:31], v[48:51], v[32:35]
    v_exp_f32 v120, v120
    v_cvt_pk_bf16_f32 v59, v118, v119
    v_mfma_f32_16x16x32_bf16 v[36:39], v[28:31], v[52:55], v[36:39]
    s_waitcnt lgkmcnt(7)
    v_exp_f32 v121, v121
    v_mfma_f32_16x16x32_bf16 v[144:147], a[176:179], v[48:51], v[144:147]
    v_exp_f32 v122, v122
    v_cvt_pk_bf16_f32 v60, v120, v121
    v_mfma_f32_16x16x32_bf16 v[176:179], a[176:179], v[52:55], v[176:179]
    s_waitcnt lgkmcnt(6)
    v_exp_f32 v123, v123
    v_mfma_f32_16x16x32_bf16 v[148:151], a[180:183], v[48:51], v[148:151]
    v_exp_f32 v124, v124
    v_cvt_pk_bf16_f32 v61, v122, v123
    s_add_u32 m0, s62, 69632
    s_add_u32 s98, s65, 32896
    buffer_load_dwordx4 v24, s[28:31], s98 offen offset:0  lds
    v_mfma_f32_16x16x32_bf16 v[180:183], a[180:183], v[52:55], v[180:183]
    s_waitcnt lgkmcnt(5)
    v_exp_f32 v125, v125
    v_mfma_f32_16x16x32_bf16 v[152:155], a[184:187], v[48:51], v[152:155]
    v_exp_f32 v126, v126
    v_mfma_f32_16x16x32_bf16 v[184:187], a[184:187], v[52:55], v[184:187]
    s_waitcnt lgkmcnt(4)
    v_exp_f32 v127, v127
    v_mfma_f32_16x16x32_bf16 v[156:159], a[188:191], v[48:51], v[156:159]
    ds_write_b128 v11, v[144:147] offset:0
    v_cvt_pk_bf16_f32 v62, v124, v125
    v_mfma_f32_16x16x32_bf16 v[188:191], a[188:191], v[52:55], v[188:191]
    s_waitcnt lgkmcnt(4)
    v_exp_f32 v96, v96
    buffer_load_dwordx4 v25, s[28:31], s98 offen offset:1024  lds
    v_mfma_f32_16x16x32_bf16 v[128:131], a[160:163], v[48:51], v[128:131]
    v_exp_f32 v97, v97
    v_mov_b32 v33, v36
    v_mfma_f32_16x16x32_bf16 v[160:163], a[160:163], v[52:55], v[160:163]
    s_waitcnt lgkmcnt(3)
    ds_write_b128 v11, v[176:179] offset:1024
    ds_write_b64 v12, v[32:33]
    v_cvt_pk_bf16_f32 v63, v126, v127
    v_mfma_f32_16x16x32_bf16 v[132:135], a[164:167], v[48:51], v[132:135]
    v_exp_f32 v98, v98
    v_xor_b32 v12, 8192, v12
    v_mfma_f32_16x16x32_bf16 v[164:167], a[164:167], v[52:55], v[164:167]
    s_waitcnt lgkmcnt(4)
    v_exp_f32 v99, v99
    v_mfma_f32_16x16x32_bf16 v[136:139], a[168:171], v[48:51], v[136:139]
    ds_write_b128 v11, v[148:151] offset:2048
    buffer_load_dwordx4 v26, s[28:31], s98 offen offset:2048  lds
    v_mfma_f32_16x16x32_bf16 v[168:171], a[168:171], v[52:55], v[168:171]
    s_waitcnt lgkmcnt(4)
    v_exp_f32 v100, v100
    v_mfma_f32_16x16x32_bf16 v[140:143], a[172:175], v[48:51], v[140:143]
    v_exp_f32 v101, v101
    v_mfma_f32_16x16x32_bf16 v[172:175], a[172:175], v[52:55], v[172:175]
    ds_write_b128 v11, v[180:183] offset:3072
    v_mfma_f32_16x16x32_bf16 v[40:43], v[28:31], v[56:59], v[40:43]
    v_exp_f32 v102, v102
    v_mfma_f32_16x16x32_bf16 v[44:47], v[28:31], v[60:63], v[44:47]
    v_exp_f32 v103, v103
    buffer_load_dwordx4 v27, s[28:31], s98 offen offset:3072  lds
    v_mfma_f32_16x16x32_bf16 v[208:211], a[176:179], v[56:59], v[208:211]
    ds_write_b128 v11, v[152:155] offset:4096
    v_exp_f32 v104, v104
    v_mfma_f32_16x16x32_bf16 v[240:243], a[176:179], v[60:63], v[240:243]
    ds_read_b128 a[176:179], v20 offset:20480
    v_cvt_pk_bf16_f32 v48, v96, v97
    v_mfma_f32_16x16x32_bf16 v[212:215], a[180:183], v[56:59], v[212:215]
    ds_write_b128 v11, v[184:187] offset:5120
    v_cvt_pk_bf16_f32 v49, v98, v99
    v_mfma_f32_16x16x32_bf16 v[244:247], a[180:183], v[60:63], v[244:247]
    ds_read_b128 a[180:183], v20 offset:21504
    v_cvt_pk_bf16_f32 v50, v100, v101
    v_mfma_f32_16x16x32_bf16 v[216:219], a[184:187], v[56:59], v[216:219]
    v_exp_f32 v105, v105
    v_mfma_f32_16x16x32_bf16 v[248:251], a[184:187], v[60:63], v[248:251]
    ds_read_b128 a[184:187], v20 offset:22528
    v_exp_f32 v106, v106
    v_mfma_f32_16x16x32_bf16 v[220:223], a[188:191], v[56:59], v[220:223]
    ds_write_b128 v11, v[156:159] offset:6144
    v_exp_f32 v107, v107
    v_mfma_f32_16x16x32_bf16 v[252:255], a[188:191], v[60:63], v[252:255]
    ds_read_b128 a[188:191], v20 offset:23552
    v_exp_f32 v108, v108
    v_mfma_f32_16x16x32_bf16 v[192:195], a[160:163], v[56:59], v[192:195]
    ds_write_b128 v11, v[188:191] offset:7168
    v_cvt_pk_bf16_f32 v51, v102, v103
    v_mfma_f32_16x16x32_bf16 v[224:227], a[160:163], v[60:63], v[224:227]
    ds_read_b128 a[160:163], v19 offset:16384
    v_cvt_pk_bf16_f32 v52, v104, v105
    v_mfma_f32_16x16x32_bf16 v[196:199], a[164:167], v[56:59], v[196:199]
    v_exp_f32 v109, v109
    v_mfma_f32_16x16x32_bf16 v[228:231], a[164:167], v[60:63], v[228:231]
    ds_read_b128 a[164:167], v19 offset:17408
    v_cvt_pk_bf16_f32 v53, v106, v107
    v_mfma_f32_16x16x32_bf16 v[200:203], a[168:171], v[56:59], v[200:203]
    v_exp_f32 v110, v110
    v_mfma_f32_16x16x32_bf16 v[232:235], a[168:171], v[60:63], v[232:235]
    ds_read_b128 a[168:171], v19 offset:18432
    v_exp_f32 v111, v111
    v_mfma_f32_16x16x32_bf16 v[204:207], a[172:175], v[56:59], v[204:207]
    v_cvt_pk_bf16_f32 v54, v108, v109
    v_cvt_pk_bf16_f32 v55, v110, v111
    v_mfma_f32_16x16x32_bf16 v[236:239], a[172:175], v[60:63], v[236:239]
    ds_read_b128 a[172:175], v19 offset:19456
    v_xor_b32 v19, 98304, v19
    v_xor_b32 v20, 98304, v20
    s_waitcnt lgkmcnt(0)
    s_barrier
    v_mfma_f32_16x16x32_bf16 v[40:43], v[28:31], v[48:51], v[40:43]
    s_lshl_b32 s100, s61, 20
    s_add_u32 s101, s100, s21
    ds_read_b64 v[120:121], v12
    v_mfma_f32_16x16x32_bf16 v[44:47], v[28:31], v[52:55], v[44:47]
    s_add_u32 s100, s100, s20
    ds_read_b128 v[144:147], v8 offset:0
    v_lshrrev_b32 v11, 4, v2
    v_mfma_f32_16x16x32_bf16 v[208:211], a[176:179], v[48:51], v[208:211]
    ds_read_b128 v[176:179], v8 offset:1024
    v_lshrrev_b32 v13, 2, v1
    v_mfma_f32_16x16x32_bf16 v[240:243], a[176:179], v[52:55], v[240:243]
    ds_read_b128 v[148:151], v8 offset:2048
    v_add_u32 v13, 131072, v13
    v_mfma_f32_16x16x32_bf16 v[212:215], a[180:183], v[48:51], v[212:215]
    s_xor_b32 s99, s62, 8192
    ds_read_b128 v[180:183], v8 offset:3072
    v_add_u32 v14, s99, v13
    v_mfma_f32_16x16x32_bf16 v[244:247], a[180:183], v[52:55], v[244:247]
    ds_read_b128 v[152:155], v8 offset:4096
    v_cmp_eq_u32 vcc, 1, v11
    v_mfma_f32_16x16x32_bf16 v[216:219], a[184:187], v[48:51], v[216:219]
    ds_read_b128 v[184:187], v8 offset:5120
    s_waitcnt lgkmcnt(6)
    v_add_f32 v112, v120, v32
    v_mfma_f32_16x16x32_bf16 v[248:251], a[184:187], v[52:55], v[248:251]
    ds_read_b128 v[156:159], v8 offset:6144
    v_add_f32 v114, v121, v36
    v_mfma_f32_16x16x32_bf16 v[220:223], a[188:191], v[48:51], v[220:223]
    ds_read_b128 v[188:191], v8 offset:7168
    v_cndmask_b32 v12, v32, v36, vcc
    v_mfma_f32_16x16x32_bf16 v[252:255], a[188:191], v[52:55], v[252:255]
    v_rcp_f32 v112, v112
    v_mfma_f32_16x16x32_bf16 v[192:195], a[160:163], v[48:51], v[192:195]
    v_rcp_f32 v114, v114
    v_mfma_f32_16x16x32_bf16 v[224:227], a[160:163], v[52:55], v[224:227]
    v_cmp_eq_u32 vcc, 2, v11
    v_cmp_eq_u32 s[96:97], 3, v11
    v_mfma_f32_16x16x32_bf16 v[196:199], a[164:167], v[48:51], v[196:199]
    ds_write_b128 v9, v[208:211] offset:0
    v_mfma_f32_16x16x32_bf16 v[228:231], a[164:167], v[52:55], v[228:231]
    v_mfma_f32_16x16x32_bf16 v[200:203], a[168:171], v[48:51], v[200:203]
    ds_write_b128 v9, v[240:243] offset:1024
    v_mfma_f32_16x16x32_bf16 v[232:235], a[168:171], v[52:55], v[232:235]
    v_mfma_f32_16x16x32_bf16 v[204:207], a[172:175], v[48:51], v[204:207]
    ds_write_b128 v9, v[212:215] offset:2048
    v_mfma_f32_16x16x32_bf16 v[236:239], a[172:175], v[52:55], v[236:239]
    v_cndmask_b32 v12, v12, v40, vcc
    v_cndmask_b32 v12, v12, v44, s[96:97]
    ds_write_b128 v9, v[244:247] offset:3072
    s_waitcnt lgkmcnt(11)
    v_pk_add_f32 v[128:129], v[128:129], v[144:145]
    v_pk_add_f32 v[130:131], v[130:131], v[146:147]
    s_waitcnt lgkmcnt(9)
    v_pk_add_f32 v[132:133], v[132:133], v[148:149]
    v_pk_add_f32 v[134:135], v[134:135], v[150:151]
    v_pk_mul_f32 v[128:129], v[128:129], v[112:113] op_sel_hi:[1,0]
    v_pk_mul_f32 v[130:131], v[130:131], v[112:113] op_sel_hi:[1,0]
    v_pk_mul_f32 v[132:133], v[132:133], v[112:113] op_sel_hi:[1,0]
    v_pk_mul_f32 v[134:135], v[134:135], v[112:113] op_sel_hi:[1,0]
    v_cvt_pk_bf16_f32 v128, v128, v129
    v_cvt_pk_bf16_f32 v129, v130, v131
    v_cvt_pk_bf16_f32 v130, v132, v133
    v_lshrrev_b32 v58, 2, v2
    v_and_b32 v57, 3, v2
    ds_write_b128 v9, v[216:219] offset:4096
    v_cvt_pk_bf16_f32 v131, v134, v135
    buffer_store_dwordx4 v[128:131], v1, s[8:11], s100 offen offset:0 sc0 sc1
    s_waitcnt lgkmcnt(8)
    v_pk_add_f32 v[136:137], v[136:137], v[152:153]
    v_pk_add_f32 v[138:139], v[138:139], v[154:155]
    s_waitcnt lgkmcnt(6)
    v_pk_add_f32 v[140:141], v[140:141], v[156:157]
    v_pk_add_f32 v[142:143], v[142:143], v[158:159]
    v_pk_mul_f32 v[136:137], v[136:137], v[112:113] op_sel_hi:[1,0]
    v_pk_mul_f32 v[138:139], v[138:139], v[112:113] op_sel_hi:[1,0]
    v_pk_mul_f32 v[140:141], v[140:141], v[112:113] op_sel_hi:[1,0]
    v_pk_mul_f32 v[142:143], v[142:143], v[112:113] op_sel_hi:[1,0]
    v_cvt_pk_bf16_f32 v136, v136, v137
    v_lshlrev_b32 v56, 7, v58
    v_lshl_add_u32 v56, v57, 3, v56
    v_bfe_u32 v57, v2, 3, 2
    ds_write_b128 v9, v[248:251] offset:5120
    v_cvt_pk_bf16_f32 v137, v138, v139
    v_cvt_pk_bf16_f32 v138, v140, v141
    v_cvt_pk_bf16_f32 v139, v142, v143
    buffer_store_dwordx4 v[136:139], v1, s[8:11], s100 offen offset:1024 sc0 sc1
    v_pk_add_f32 v[160:161], v[160:161], v[176:177]
    v_pk_add_f32 v[162:163], v[162:163], v[178:179]
    v_pk_add_f32 v[164:165], v[164:165], v[180:181]
    v_pk_add_f32 v[166:167], v[166:167], v[182:183]
    v_pk_mul_f32 v[160:161], v[160:161], v[114:115] op_sel_hi:[1,0]
    v_pk_mul_f32 v[162:163], v[162:163], v[114:115] op_sel_hi:[1,0]
    v_pk_mul_f32 v[164:165], v[164:165], v[114:115] op_sel_hi:[1,0]
    v_lshl_add_u32 v56, v57, 5, v56
    v_xor_b32 v57, 32, v56
    ds_write_b128 v9, v[220:223] offset:6144
    v_pk_mul_f32 v[166:167], v[166:167], v[114:115] op_sel_hi:[1,0]
    v_cvt_pk_bf16_f32 v160, v160, v161
    v_cvt_pk_bf16_f32 v161, v162, v163
    v_cvt_pk_bf16_f32 v162, v164, v165
    v_cvt_pk_bf16_f32 v163, v166, v167
    buffer_store_dwordx4 v[160:163], v15, s[8:11], s100 offen offset:0 sc0 sc1
    v_pk_add_f32 v[168:169], v[168:169], v[184:185]
    v_pk_add_f32 v[170:171], v[170:171], v[186:187]
    s_waitcnt lgkmcnt(7)
    v_pk_add_f32 v[172:173], v[172:173], v[188:189]
    v_pk_add_f32 v[174:175], v[174:175], v[190:191]
    v_pk_mul_f32 v[168:169], v[168:169], v[114:115] op_sel_hi:[1,0]
    v_xor_b32 v58, 64, v56
    v_xor_b32 v59, 96, v56
    v_add_u32 v60, 65536, v56
    ds_write_b128 v9, v[252:255] offset:7168
    v_pk_mul_f32 v[170:171], v[170:171], v[114:115] op_sel_hi:[1,0]
    v_pk_mul_f32 v[172:173], v[172:173], v[114:115] op_sel_hi:[1,0]
    v_pk_mul_f32 v[174:175], v[174:175], v[114:115] op_sel_hi:[1,0]
    v_cvt_pk_bf16_f32 v168, v168, v169
    v_cvt_pk_bf16_f32 v169, v170, v171
    v_cvt_pk_bf16_f32 v170, v172, v173
    v_cvt_pk_bf16_f32 v171, v174, v175
    buffer_store_dwordx4 v[168:171], v15, s[8:11], s100 offen offset:1024 sc0 sc1
    v_add_u32 v61, 65536, v57
    v_add_u32 v62, 65536, v58
    v_add_u32 v63, 65536, v59
    ds_write_b32 v14, v12
    v_and_b32 v14, 4294967103, v13
    v_add_u32 v14, s62, v14
    s_waitcnt vmcnt(4) lgkmcnt(0)
    s_barrier
    ds_read_b32 v116, v14 offset:128
    ds_read_b32 v118, v14 offset:192
    ds_read_b128 v[208:211], v10 offset:0
    ds_read_b128 v[212:215], v10 offset:2048
    ds_read_b128 v[216:219], v10 offset:4096
    ds_read_b128 v[220:223], v10 offset:6144
    ds_read_b128 v[240:243], v10 offset:1024
    ds_read_b128 v[244:247], v10 offset:3072
    ds_read_b128 v[248:251], v10 offset:5120
    ds_read_b128 v[252:255], v10 offset:7168
    ds_read_b32 v120, v13 offset:0
    ds_read_b32 v121, v13 offset:8192
    ds_read_b32 v122, v13 offset:16384
    ds_read_b32 v123, v13 offset:24576
    s_waitcnt lgkmcnt(13)
    v_add_f32 v116, v116, v40
    s_waitcnt lgkmcnt(12)
    v_add_f32 v118, v118, v44
    v_rcp_f32 v116, v116
    v_rcp_f32 v118, v118
    s_waitcnt lgkmcnt(11)
    v_pk_add_f32 v[192:193], v[192:193], v[208:209]
    v_pk_add_f32 v[194:195], v[194:195], v[210:211]
    s_waitcnt lgkmcnt(10)
    v_pk_add_f32 v[196:197], v[196:197], v[212:213]
    v_pk_add_f32 v[198:199], v[198:199], v[214:215]
    v_pk_mul_f32 v[192:193], v[192:193], v[116:117] op_sel_hi:[1,0]
    v_pk_mul_f32 v[194:195], v[194:195], v[116:117] op_sel_hi:[1,0]
    v_pk_mul_f32 v[196:197], v[196:197], v[116:117] op_sel_hi:[1,0]
    v_pk_mul_f32 v[198:199], v[198:199], v[116:117] op_sel_hi:[1,0]
    v_cvt_pk_bf16_f32 v192, v192, v193
    v_cvt_pk_bf16_f32 v193, v194, v195
    v_cvt_pk_bf16_f32 v194, v196, v197
    v_cvt_pk_bf16_f32 v195, v198, v199
    buffer_store_dwordx4 v[192:195], v1, s[8:11], s101 offen offset:0 sc0 sc1
    s_waitcnt lgkmcnt(9)
    v_pk_add_f32 v[200:201], v[200:201], v[216:217]
    v_pk_add_f32 v[202:203], v[202:203], v[218:219]
    s_waitcnt lgkmcnt(8)
    v_pk_add_f32 v[204:205], v[204:205], v[220:221]
    v_pk_add_f32 v[206:207], v[206:207], v[222:223]
    v_pk_mul_f32 v[200:201], v[200:201], v[116:117] op_sel_hi:[1,0]
    v_pk_mul_f32 v[202:203], v[202:203], v[116:117] op_sel_hi:[1,0]
    v_pk_mul_f32 v[204:205], v[204:205], v[116:117] op_sel_hi:[1,0]
    v_pk_mul_f32 v[206:207], v[206:207], v[116:117] op_sel_hi:[1,0]
    v_cvt_pk_bf16_f32 v200, v200, v201
    v_cvt_pk_bf16_f32 v201, v202, v203
    v_cvt_pk_bf16_f32 v202, v204, v205
    v_cvt_pk_bf16_f32 v203, v206, v207
    buffer_store_dwordx4 v[200:203], v1, s[8:11], s101 offen offset:1024 sc0 sc1
    s_waitcnt lgkmcnt(2)
    v_add_f32 v120, v120, v121
    s_waitcnt lgkmcnt(0)
    v_add_f32 v122, v122, v123
    v_min_f32 v124, v120, v122
    v_add_f32 v120, v120, v122
    v_cmp_le_f32 vcc, 0x1f800000, v124
    s_mov_b64 s[96:97], vcc
    v_cmp_ge_f32 vcc, 0x67800000, v120
    s_and_b64 s[96:97], s[96:97], vcc
    s_cmp_eq_u64 s[96:97], -1
    s_cselect_b32 s96, s25, 1
    s_cmp_lg_u32 s96, 0
    s_cbranch_scc1 L_t2_redo
L_t2_safe:
    v_pk_add_f32 v[224:225], v[224:225], v[240:241]
    v_pk_add_f32 v[226:227], v[226:227], v[242:243]
    v_pk_add_f32 v[228:229], v[228:229], v[244:245]
    v_pk_add_f32 v[230:231], v[230:231], v[246:247]
    v_pk_mul_f32 v[224:225], v[224:225], v[118:119] op_sel_hi:[1,0]
    v_pk_mul_f32 v[226:227], v[226:227], v[118:119] op_sel_hi:[1,0]
    v_pk_mul_f32 v[228:229], v[228:229], v[118:119] op_sel_hi:[1,0]
    v_pk_mul_f32 v[230:231], v[230:231], v[118:119] op_sel_hi:[1,0]
    v_cvt_pk_bf16_f32 v224, v224, v225
    v_cvt_pk_bf16_f32 v225, v226, v227
    v_cvt_pk_bf16_f32 v226, v228, v229
    v_cvt_pk_bf16_f32 v227, v230, v231
    buffer_store_dwordx4 v[224:227], v15, s[8:11], s101 offen offset:0 sc0 sc1
    ds_read_b64_tr_b16 a[192:193], v56 offset:32768
    ds_read_b64_tr_b16 a[194:195], v56 offset:34816
    ds_read_b64_tr_b16 a[196:197], v56 offset:36864
    ds_read_b64_tr_b16 a[198:199], v56 offset:38912
    ds_read_b64_tr_b16 a[200:201], v57 offset:32768
    ds_read_b64_tr_b16 a[202:203], v57 offset:34816
    ds_read_b64_tr_b16 a[204:205], v57 offset:36864
    ds_read_b64_tr_b16 a[206:207], v57 offset:38912
    v_pk_add_f32 v[232:233], v[232:233], v[248:249]
    v_pk_add_f32 v[234:235], v[234:235], v[250:251]
    v_pk_add_f32 v[236:237], v[236:237], v[252:253]
    v_pk_add_f32 v[238:239], v[238:239], v[254:255]
    v_pk_mul_f32 v[232:233], v[232:233], v[118:119] op_sel_hi:[1,0]
    v_pk_mul_f32 v[234:235], v[234:235], v[118:119] op_sel_hi:[1,0]
    v_pk_mul_f32 v[236:237], v[236:237], v[118:119] op_sel_hi:[1,0]
    v_pk_mul_f32 v[238:239], v[238:239], v[118:119] op_sel_hi:[1,0]
    v_cvt_pk_bf16_f32 v232, v232, v233
    v_cvt_pk_bf16_f32 v233, v234, v235
    v_cvt_pk_bf16_f32 v234, v236, v237
    v_cvt_pk_bf16_f32 v235, v238, v239
    buffer_store_dwordx4 v[232:235], v15, s[8:11], s101 offen offset:1024 sc0 sc1
    ds_read_b64_tr_b16 a[208:209], v56 offset:40960
    ds_read_b64_tr_b16 a[210:211], v56 offset:43008
    ds_read_b64_tr_b16 a[212:213], v56 offset:45056
    ds_read_b64_tr_b16 a[214:215], v56 offset:47104
    ds_read_b64_tr_b16 a[216:217], v57 offset:40960
    ds_read_b64_tr_b16 a[218:219], v57 offset:43008
    ds_read_b64_tr_b16 a[220:221], v57 offset:45056
    ds_read_b64_tr_b16 a[222:223], v57 offset:47104
    s_waitcnt lgkmcnt(14)
    v_mfma_f32_16x16x32_bf16 v[64:67], a[192:195], a[64:67], 0
    s_waitcnt lgkmcnt(12)
    s_add_u32 m0, s62, 0
    ds_read_b64_tr_b16 a[224:225], v56 offset:49152
    v_mfma_f32_16x16x32_bf16 v[64:67], a[196:199], a[68:71], v[64:67]
    s_add_u32 s98, s65, 262144
    ds_read_b64_tr_b16 a[226:227], v56 offset:51200
    v_mfma_f32_16x16x32_bf16 v[72:75], a[192:195], a[80:83], 0
    buffer_load_dwordx4 v24, s[28:31], s98 offen offset:0  lds
    v_mfma_f32_16x16x32_bf16 v[72:75], a[196:199], a[84:87], v[72:75]
    s_waitcnt lgkmcnt(12)
    ds_read_b64_tr_b16 a[228:229], v56 offset:53248
    v_mfma_f32_16x16x32_bf16 v[68:71], a[200:203], a[64:67], 0
    s_waitcnt lgkmcnt(11)
    ds_read_b64_tr_b16 a[230:231], v56 offset:55296
    v_mfma_f32_16x16x32_bf16 v[68:71], a[204:207], a[68:71], v[68:71]
    ds_read_b64_tr_b16 a[232:233], v57 offset:49152
    v_mfma_f32_16x16x32_bf16 v[76:79], a[200:203], a[80:83], 0
    buffer_load_dwordx4 v25, s[28:31], s98 offen offset:1024  lds
    v_mfma_f32_16x16x32_bf16 v[76:79], a[204:207], a[84:87], v[76:79]
    s_waitcnt lgkmcnt(11)
    ds_read_b64_tr_b16 a[234:235], v57 offset:51200
    v_mfma_f32_16x16x32_bf16 v[64:67], a[208:211], a[72:75], v[64:67]
    s_waitcnt lgkmcnt(10)
    ds_read_b64_tr_b16 a[236:237], v57 offset:53248
    v_mfma_f32_16x16x32_bf16 v[64:67], a[212:215], a[76:79], v[64:67]
    ds_read_b64_tr_b16 a[238:239], v57 offset:55296
    v_mfma_f32_16x16x32_bf16 v[72:75], a[208:211], a[88:91], v[72:75]
    buffer_load_dwordx4 v26, s[28:31], s98 offen offset:2048  lds
    v_mfma_f32_16x16x32_bf16 v[72:75], a[212:215], a[92:95], v[72:75]
    s_waitcnt lgkmcnt(10)
    ds_read_b64_tr_b16 a[240:241], v56 offset:57344
    v_mfma_f32_16x16x32_bf16 v[68:71], a[216:219], a[72:75], v[68:71]
    s_waitcnt lgkmcnt(9)
    ds_read_b64_tr_b16 a[242:243], v56 offset:59392
    v_mfma_f32_16x16x32_bf16 v[68:71], a[220:223], a[76:79], v[68:71]
    ds_read_b64_tr_b16 a[244:245], v56 offset:61440
    v_mfma_f32_16x16x32_bf16 v[76:79], a[216:219], a[88:91], v[76:79]
    buffer_load_dwordx4 v27, s[28:31], s98 offen offset:3072  lds
    v_mfma_f32_16x16x32_bf16 v[76:79], a[220:223], a[92:95], v[76:79]
    s_waitcnt lgkmcnt(9)
    s_add_u32 m0, s62, 4096
    ds_read_b64_tr_b16 a[246:247], v56 offset:63488
    v_mfma_f32_16x16x32_bf16 v[64:67], a[224:227], a[96:99], v[64:67]
    s_waitcnt lgkmcnt(8)
    s_add_u32 s98, s65, 294912
    ds_read_b64_tr_b16 a[248:249], v57 offset:57344
    v_mfma_f32_16x16x32_bf16 v[64:67], a[228:231], a[100:103], v[64:67]
    ds_read_b64_tr_b16 a[250:251], v57 offset:59392
    v_mfma_f32_16x16x32_bf16 v[72:75], a[224:227], a[112:115], v[72:75]
    buffer_load_dwordx4 v24, s[28:31], s98 offen offset:0  lds
    v_mfma_f32_16x16x32_bf16 v[72:75], a[228:231], a[116:119], v[72:75]
    s_waitcnt lgkmcnt(8)
    ds_read_b64_tr_b16 a[252:253], v57 offset:61440
    v_mfma_f32_16x16x32_bf16 v[68:71], a[232:235], a[96:99], v[68:71]
    s_waitcnt lgkmcnt(7)
    ds_read_b64_tr_b16 a[254:255], v57 offset:63488
    v_accvgpr_read_b32 v32, a48
    v_mfma_f32_16x16x32_bf16 v[68:71], a[236:239], a[100:103], v[68:71]
    ds_read_b64_tr_b16 a[192:193], v58 offset:32768
    v_accvgpr_read_b32 v33, a49
    v_mfma_f32_16x16x32_bf16 v[76:79], a[232:235], a[112:115], v[76:79]
    buffer_load_dwordx4 v25, s[28:31], s98 offen offset:1024  lds
    v_mfma_f32_16x16x32_bf16 v[76:79], a[236:239], a[116:119], v[76:79]
    s_waitcnt lgkmcnt(7)
    ds_read_b64_tr_b16 a[194:195], v58 offset:34816
    v_accvgpr_read_b32 v34, a50
    v_mfma_f32_16x16x32_bf16 v[64:67], a[240:243], a[104:107], v[64:67]
    s_waitcnt lgkmcnt(6)
    ds_read_b64_tr_b16 a[196:197], v58 offset:36864
    v_accvgpr_read_b32 v35, a51
    v_mfma_f32_16x16x32_bf16 v[64:67], a[244:247], a[108:111], v[64:67]
    ds_read_b64_tr_b16 a[198:199], v58 offset:38912
    v_accvgpr_read_b32 v36, a52
    v_mfma_f32_16x16x32_bf16 v[72:75], a[240:243], a[120:123], v[72:75]
    buffer_load_dwordx4 v26, s[28:31], s98 offen offset:2048  lds
    v_mfma_f32_16x16x32_bf16 v[72:75], a[244:247], a[124:127], v[72:75]
    s_waitcnt lgkmcnt(6)
    ds_read_b64_tr_b16 a[200:201], v59 offset:32768
    v_accvgpr_read_b32 v37, a53
    v_mfma_f32_16x16x32_bf16 v[68:71], a[248:251], a[104:107], v[68:71]
    s_waitcnt lgkmcnt(5)
    ds_read_b64_tr_b16 a[202:203], v59 offset:34816
    v_accvgpr_read_b32 v38, a54
    v_mfma_f32_16x16x32_bf16 v[68:71], a[252:255], a[108:111], v[68:71]
    ds_read_b64_tr_b16 a[204:205], v59 offset:36864
    v_accvgpr_read_b32 v39, a55
    v_mfma_f32_16x16x32_bf16 v[76:79], a[248:251], a[120:123], v[76:79]
    buffer_load_dwordx4 v27, s[28:31], s98 offen offset:3072  lds
    ds_read_b64_tr_b16 a[206:207], v59 offset:38912
    v_mfma_f32_16x16x32_bf16 v[76:79], a[252:255], a[124:127], v[76:79]
    s_waitcnt lgkmcnt(6)
    s_add_u32 s74, s24, 16384
    ds_read_b64_tr_b16 a[208:209], v58 offset:40960
    v_accvgpr_read_b32 v40, a56
    v_mfma_f32_16x16x32_bf16 v[80:83], a[192:195], a[64:67], 0
    s_waitcnt lgkmcnt(5)
    ds_read_b64_tr_b16 a[210:211], v58 offset:43008
    v_accvgpr_read_b32 v41, a57
    v_mfma_f32_16x16x32_bf16 v[80:83], a[196:199], a[68:71], v[80:83]
    ds_read_b64_tr_b16 a[212:213], v58 offset:45056
    v_accvgpr_read_b32 v42, a58
    v_mfma_f32_16x16x32_bf16 v[88:91], a[192:195], a[80:83], 0
    buffer_load_dwordx4 a[128:131], v1, s[8:11], s74 offen offset:0
    v_mfma_f32_16x16x32_bf16 v[88:91], a[196:199], a[84:87], v[88:91]
    s_waitcnt lgkmcnt(5)
    s_add_u32 s74, s24, 20480
    ds_read_b64_tr_b16 a[214:215], v58 offset:47104
    v_accvgpr_read_b32 v43, a59
    v_mfma_f32_16x16x32_bf16 v[84:87], a[200:203], a[64:67], 0
    s_waitcnt lgkmcnt(4)
    ds_read_b64_tr_b16 a[216:217], v59 offset:40960
    v_mfma_f32_16x16x32_bf16 v[84:87], a[204:207], a[68:71], v[84:87]
    ds_read_b64_tr_b16 a[218:219], v59 offset:43008
    v_mfma_f32_16x16x32_bf16 v[92:95], a[200:203], a[80:83], 0
    buffer_load_dwordx4 a[144:147], v1, s[8:11], s74 offen offset:0
    ds_read_b64_tr_b16 a[220:221], v59 offset:45056
    v_mfma_f32_16x16x32_bf16 v[92:95], a[204:207], a[84:87], v[92:95]
    s_waitcnt lgkmcnt(5)
    s_add_u32 s74, s24, 16384
    ds_read_b64_tr_b16 a[222:223], v59 offset:47104
    v_mfma_f32_16x16x32_bf16 v[80:83], a[208:211], a[72:75], v[80:83]
    s_waitcnt lgkmcnt(4)
    ds_read_b64_tr_b16 a[224:225], v58 offset:49152
    v_mfma_f32_16x16x32_bf16 v[80:83], a[212:215], a[76:79], v[80:83]
    ds_read_b64_tr_b16 a[226:227], v58 offset:51200
    v_mfma_f32_16x16x32_bf16 v[88:91], a[208:211], a[88:91], v[88:91]
    buffer_load_dwordx4 a[132:135], v1, s[8:11], s74 offen offset:1024
    v_mfma_f32_16x16x32_bf16 v[88:91], a[212:215], a[92:95], v[88:91]
    s_waitcnt lgkmcnt(4)
    s_add_u32 s74, s24, 20480
    ds_read_b64_tr_b16 a[228:229], v58 offset:53248
    v_mfma_f32_16x16x32_bf16 v[84:87], a[216:219], a[72:75], v[84:87]
    s_waitcnt lgkmcnt(3)
    ds_read_b64_tr_b16 a[230:231], v58 offset:55296
    v_mfma_f32_16x16x32_bf16 v[84:87], a[220:223], a[76:79], v[84:87]
    ds_read_b64_tr_b16 a[232:233], v59 offset:49152
    v_mfma_f32_16x16x32_bf16 v[92:95], a[216:219], a[88:91], v[92:95]
    buffer_load_dwordx4 a[148:151], v1, s[8:11], s74 offen offset:1024
    ds_read_b64_tr_b16 a[234:235], v59 offset:51200
    v_mfma_f32_16x16x32_bf16 v[92:95], a[220:223], a[92:95], v[92:95]
    s_waitcnt lgkmcnt(4)
    s_add_u32 s74, s24, 16384
    ds_read_b64_tr_b16 a[236:237], v59 offset:53248
    v_mfma_f32_16x16x32_bf16 v[80:83], a[224:227], a[96:99], v[80:83]
    s_waitcnt lgkmcnt(3)
    ds_read_b64_tr_b16 a[238:239], v59 offset:55296
    v_mfma_f32_16x16x32_bf16 v[80:83], a[228:231], a[100:103], v[80:83]
    ds_read_b64_tr_b16 a[240:241], v58 offset:57344
    v_mfma_f32_16x16x32_bf16 v[88:91], a[224:227], a[112:115], v[88:91]
    buffer_load_dwordx4 a[136:139], v1, s[8:11], s74 offen offset:2048
    v_mfma_f32_16x16x32_bf16 v[88:91], a[228:231], a[116:119], v[88:91]
    s_waitcnt lgkmcnt(3)
    s_add_u32 s74, s24, 20480
    ds_read_b64_tr_b16 a[242:243], v58 offset:59392
    v_mfma_f32_16x16x32_bf16 v[84:87], a[232:235], a[96:99], v[84:87]
    s_waitcnt lgkmcnt(2)
    ds_read_b64_tr_b16 a[244:245], v58 offset:61440
    v_mfma_f32_16x16x32_bf16 v[84:87], a[236:239], a[100:103], v[84:87]
    ds_read_b64_tr_b16 a[246:247], v58 offset:63488
    v_mfma_f32_16x16x32_bf16 v[92:95], a[232:235], a[112:115], v[92:95]
    buffer_load_dwordx4 a[152:155], v1, s[8:11], s74 offen offset:2048
    ds_read_b64_tr_b16 a[248:249], v59 offset:57344
    v_mfma_f32_16x16x32_bf16 v[92:95], a[236:239], a[116:119], v[92:95]
    s_waitcnt lgkmcnt(3)
    s_add_u32 s74, s24, 16384
    ds_read_b64_tr_b16 a[250:251], v59 offset:59392
    v_mfma_f32_16x16x32_bf16 v[80:83], a[240:243], a[104:107], v[80:83]
    s_waitcnt lgkmcnt(2)
    ds_read_b64_tr_b16 a[252:253], v59 offset:61440
    v_mfma_f32_16x16x32_bf16 v[80:83], a[244:247], a[108:111], v[80:83]
    ds_read_b64_tr_b16 a[254:255], v59 offset:63488
    v_mfma_f32_16x16x32_bf16 v[88:91], a[240:243], a[120:123], v[88:91]
    buffer_load_dwordx4 a[140:143], v1, s[8:11], s74 offen offset:3072
    v_mfma_f32_16x16x32_bf16 v[88:91], a[244:247], a[124:127], v[88:91]
    s_waitcnt lgkmcnt(2)
    s_add_u32 s74, s24, 20480
    ds_read_b64_tr_b16 a[192:193], v60 offset:0
    v_mfma_f32_16x16x32_bf16 v[84:87], a[248:251], a[104:107], v[84:87]
    s_waitcnt lgkmcnt(1)
    ds_read_b64_tr_b16 a[194:195], v60 offset:2048
    v_mfma_f32_16x16x32_bf16 v[84:87], a[252:255], a[108:111], v[84:87]
    ds_read_b64_tr_b16 a[196:197], v60 offset:4096
    v_mfma_f32_16x16x32_bf16 v[92:95], a[248:251], a[120:123], v[92:95]
    buffer_load_dwordx4 a[156:159], v1, s[8:11], s74 offen offset:3072
    ds_read_b64_tr_b16 a[198:199], v60 offset:6144
    v_mfma_f32_16x16x32_bf16 v[92:95], a[252:255], a[124:127], v[92:95]
    s_waitcnt lgkmcnt(2)
    s_add_u32 s74, s24, 24576
    ds_read_b64_tr_b16 a[200:201], v61 offset:0
    v_mfma_f32_16x16x32_bf16 v[96:99], a[192:195], a[64:67], 0
    s_waitcnt lgkmcnt(1)
    ds_read_b64_tr_b16 a[202:203], v61 offset:2048
    v_mfma_f32_16x16x32_bf16 v[96:99], a[196:199], a[68:71], v[96:99]
    ds_read_b64_tr_b16 a[204:205], v61 offset:4096
    v_mfma_f32_16x16x32_bf16 v[104:107], a[192:195], a[80:83], 0
    buffer_load_dwordx4 a[160:163], v1, s[8:11], s74 offen offset:0
    ds_read_b64_tr_b16 a[206:207], v61 offset:6144
    v_mfma_f32_16x16x32_bf16 v[104:107], a[196:199], a[84:87], v[104:107]
    s_waitcnt lgkmcnt(2)
    s_add_u32 s74, s24, 28672
    ds_read_b64_tr_b16 a[208:209], v60 offset:8192
    v_mfma_f32_16x16x32_bf16 v[100:103], a[200:203], a[64:67], 0
    s_waitcnt lgkmcnt(1)
    ds_read_b64_tr_b16 a[210:211], v60 offset:10240
    v_mfma_f32_16x16x32_bf16 v[100:103], a[204:207], a[68:71], v[100:103]
    ds_read_b64_tr_b16 a[212:213], v60 offset:12288
    v_mfma_f32_16x16x32_bf16 v[108:111], a[200:203], a[80:83], 0
    buffer_load_dwordx4 a[176:179], v1, s[8:11], s74 offen offset:0
    ds_read_b64_tr_b16 a[214:215], v60 offset:14336
    v_mfma_f32_16x16x32_bf16 v[108:111], a[204:207], a[84:87], v[108:111]
    s_waitcnt lgkmcnt(2)
    s_add_u32 s74, s24, 24576
    ds_read_b64_tr_b16 a[216:217], v61 offset:8192
    v_mfma_f32_16x16x32_bf16 v[96:99], a[208:211], a[72:75], v[96:99]
    s_waitcnt lgkmcnt(1)
    ds_read_b64_tr_b16 a[218:219], v61 offset:10240
    v_mfma_f32_16x16x32_bf16 v[96:99], a[212:215], a[76:79], v[96:99]
    ds_read_b64_tr_b16 a[220:221], v61 offset:12288
    v_mfma_f32_16x16x32_bf16 v[104:107], a[208:211], a[88:91], v[104:107]
    buffer_load_dwordx4 a[164:167], v1, s[8:11], s74 offen offset:1024
    ds_read_b64_tr_b16 a[222:223], v61 offset:14336
    v_mfma_f32_16x16x32_bf16 v[104:107], a[212:215], a[92:95], v[104:107]
    s_waitcnt lgkmcnt(2)
    s_add_u32 s74, s24, 28672
    ds_read_b64_tr_b16 a[224:225], v60 offset:16384
    v_mfma_f32_16x16x32_bf16 v[100:103], a[216:219], a[72:75], v[100:103]
    s_waitcnt lgkmcnt(1)
    ds_read_b64_tr_b16 a[226:227], v60 offset:18432
    v_mfma_f32_16x16x32_bf16 v[100:103], a[220:223], a[76:79], v[100:103]
    ds_read_b64_tr_b16 a[228:229], v60 offset:20480
    v_mfma_f32_16x16x32_bf16 v[108:111], a[216:219], a[88:91], v[108:111]
    buffer_load_dwordx4 a[180:183], v1, s[8:11], s74 offen offset:1024
    ds_read_b64_tr_b16 a[230:231], v60 offset:22528
    v_mfma_f32_16x16x32_bf16 v[108:111], a[220:223], a[92:95], v[108:111]
    s_waitcnt lgkmcnt(2)
    s_add_u32 s74, s24, 24576
    ds_read_b64_tr_b16 a[232:233], v61 offset:16384
    v_mfma_f32_16x16x32_bf16 v[96:99], a[224:227], a[96:99], v[96:99]
    s_waitcnt lgkmcnt(1)
    ds_read_b64_tr_b16 a[234:235], v61 offset:18432
    v_mfma_f32_16x16x32_bf16 v[96:99], a[228:231], a[100:103], v[96:99]
    ds_read_b64_tr_b16 a[236:237], v61 offset:20480
    v_mfma_f32_16x16x32_bf16 v[104:107], a[224:227], a[112:115], v[104:107]
    buffer_load_dwordx4 a[168:171], v1, s[8:11], s74 offen offset:2048
    ds_read_b64_tr_b16 a[238:239], v61 offset:22528
    v_mfma_f32_16x16x32_bf16 v[104:107], a[228:231], a[116:119], v[104:107]
    s_waitcnt lgkmcnt(2)
    s_add_u32 s74, s24, 28672
    ds_read_b64_tr_b16 a[240:241], v60 offset:24576
    v_mfma_f32_16x16x32_bf16 v[100:103], a[232:235], a[96:99], v[100:103]
    s_waitcnt lgkmcnt(1)
    ds_read_b64_tr_b16 a[242:243], v60 offset:26624
    v_mfma_f32_16x16x32_bf16 v[100:103], a[236:239], a[100:103], v[100:103]
    ds_read_b64_tr_b16 a[244:245], v60 offset:28672
    v_mfma_f32_16x16x32_bf16 v[108:111], a[232:235], a[112:115], v[108:111]
    buffer_load_dwordx4 a[184:187], v1, s[8:11], s74 offen offset:2048
    ds_read_b64_tr_b16 a[246:247], v60 offset:30720
    v_mfma_f32_16x16x32_bf16 v[108:111], a[236:239], a[116:119], v[108:111]
    s_waitcnt lgkmcnt(2)
    s_add_u32 s74, s24, 24576
    ds_read_b64_tr_b16 a[248:249], v61 offset:24576
    v_mfma_f32_16x16x32_bf16 v[96:99], a[240:243], a[104:107], v[96:99]
    s_waitcnt lgkmcnt(1)
    ds_read_b64_tr_b16 a[250:251], v61 offset:26624
    v_mfma_f32_16x16x32_bf16 v[96:99], a[244:247], a[108:111], v[96:99]
    ds_read_b64_tr_b16 a[252:253], v61 offset:28672
    v_mfma_f32_16x16x32_bf16 v[104:107], a[240:243], a[120:123], v[104:107]
    buffer_load_dwordx4 a[172:175], v1, s[8:11], s74 offen offset:3072
    ds_read_b64_tr_b16 a[254:255], v61 offset:30720
    v_mfma_f32_16x16x32_bf16 v[104:107], a[244:247], a[124:127], v[104:107]
    s_waitcnt lgkmcnt(2)
    s_add_u32 s74, s24, 28672
    ds_read_b64_tr_b16 a[192:193], v62 offset:0
    v_mfma_f32_16x16x32_bf16 v[100:103], a[248:251], a[104:107], v[100:103]
    s_waitcnt lgkmcnt(1)
    ds_read_b64_tr_b16 a[194:195], v62 offset:2048
    v_mfma_f32_16x16x32_bf16 v[100:103], a[252:255], a[108:111], v[100:103]
    ds_read_b64_tr_b16 a[196:197], v62 offset:4096
    v_mfma_f32_16x16x32_bf16 v[108:111], a[248:251], a[120:123], v[108:111]
    buffer_load_dwordx4 a[188:191], v1, s[8:11], s74 offen offset:3072
    ds_read_b64_tr_b16 a[198:199], v62 offset:6144
    v_mfma_f32_16x16x32_bf16 v[108:111], a[252:255], a[124:127], v[108:111]
    s_waitcnt lgkmcnt(2)
    s_add_u32 s22, s22, 65536
    ds_read_b64_tr_b16 a[200:201], v63 offset:0
    v_mfma_f32_16x16x32_bf16 v[112:115], a[192:195], a[64:67], 0
    s_waitcnt lgkmcnt(1)
    s_add_u32 s23, s23, 65536
    ds_read_b64_tr_b16 a[202:203], v63 offset:2048
    v_mfma_f32_16x16x32_bf16 v[112:115], a[196:199], a[68:71], v[112:115]
    s_lshl_b32 s24, s61, 2
    ds_read_b64_tr_b16 a[204:205], v63 offset:4096
    v_mfma_f32_16x16x32_bf16 v[120:123], a[192:195], a[80:83], 0
    s_add_u32 s24, s24, s3
    ds_read_b64_tr_b16 a[206:207], v63 offset:6144
    v_mfma_f32_16x16x32_bf16 v[120:123], a[196:199], a[84:87], v[120:123]
    s_waitcnt lgkmcnt(2)
    s_lshl_b32 s24, s24, 3
    ds_read_b64_tr_b16 a[208:209], v62 offset:8192
    v_mfma_f32_16x16x32_bf16 v[116:119], a[200:203], a[64:67], 0
    s_waitcnt lgkmcnt(1)
    s_add_u32 s24, s24, s4
    ds_read_b64_tr_b16 a[210:211], v62 offset:10240
    v_lshrrev_b32 v46, 2, v2
    v_mfma_f32_16x16x32_bf16 v[116:119], a[204:207], a[68:71], v[116:119]
    ds_read_b64_tr_b16 a[212:213], v62 offset:12288
    v_mfma_f32_16x16x32_bf16 v[124:127], a[200:203], a[80:83], 0
    s_lshl_b32 s24, s24, 15
    ds_read_b64_tr_b16 a[214:215], v62 offset:14336
    v_and_b32 v45, 3, v2
    s_waitcnt vmcnt(16)
    s_barrier
    v_mfma_f32_16x16x32_bf16 v[124:127], a[204:207], a[84:87], v[124:127]
    s_waitcnt lgkmcnt(2)
    s_add_u32 m0, s62, 98304
    ds_read_b64_tr_b16 a[216:217], v63 offset:8192
    v_lshlrev_b32 v44, 8, v46
    v_mfma_f32_16x16x32_bf16 v[112:115], a[208:211], a[72:75], v[112:115]
    s_waitcnt lgkmcnt(1)
    s_add_u32 s98, s65, 262272
    ds_read_b64_tr_b16 a[218:219], v63 offset:10240
    v_lshl_add_u32 v44, v45, 4, v44
    v_mfma_f32_16x16x32_bf16 v[112:115], a[212:215], a[76:79], v[112:115]
    buffer_load_dwordx4 v24, s[28:31], s98 offen offset:0  lds
    ds_read_b64_tr_b16 a[220:221], v63 offset:12288
    v_mfma_f32_16x16x32_bf16 v[120:123], a[208:211], a[88:91], v[120:123]
    s_add_u32 s24, s24, 50331648
    ds_read_b64_tr_b16 a[222:223], v63 offset:14336
    v_lshlrev_b32 v45, 3, v45
    v_mfma_f32_16x16x32_bf16 v[120:123], a[212:215], a[92:95], v[120:123]
    s_waitcnt lgkmcnt(2)
    ds_read_b64_tr_b16 a[224:225], v62 offset:16384
    v_lshl_add_u32 v45, v46, 6, v45
    v_mfma_f32_16x16x32_bf16 v[116:119], a[216:219], a[72:75], v[116:119]
    s_waitcnt lgkmcnt(1)
    ds_read_b64_tr_b16 a[226:227], v62 offset:18432
    v_lshlrev_b32 v46, 1, v45
    v_mfma_f32_16x16x32_bf16 v[116:119], a[220:223], a[76:79], v[116:119]
    buffer_load_dwordx4 v25, s[28:31], s98 offen offset:1024  lds
    ds_read_b64_tr_b16 a[228:229], v62 offset:20480
    v_mfma_f32_16x16x32_bf16 v[124:127], a[216:219], a[88:91], v[124:127]
    s_lshl_b32 s70, s2, 15
    ds_read_b64_tr_b16 a[230:231], v62 offset:22528
    v_mfma_f32_16x16x32_bf16 v[124:127], a[220:223], a[92:95], v[124:127]
    s_waitcnt lgkmcnt(2)
    s_lshl_b32 s100, s3, 6
    ds_read_b64_tr_b16 a[232:233], v63 offset:16384
    v_mfma_f32_16x16x32_bf16 v[112:115], a[224:227], a[96:99], v[112:115]
    s_waitcnt lgkmcnt(1)
    s_add_u32 s70, s70, s100
    ds_read_b64_tr_b16 a[234:235], v63 offset:18432
    v_mfma_f32_16x16x32_bf16 v[112:115], a[228:231], a[100:103], v[112:115]
    buffer_load_dwordx4 v26, s[28:31], s98 offen offset:2048  lds
    ds_read_b64_tr_b16 a[236:237], v63 offset:20480
    v_mfma_f32_16x16x32_bf16 v[120:123], a[224:227], a[112:115], v[120:123]
    s_add_u32 s70, s70, 67108864
    ds_read_b64_tr_b16 a[238:239], v63 offset:22528
    v_mfma_f32_16x16x32_bf16 v[120:123], a[228:231], a[116:119], v[120:123]
    s_waitcnt lgkmcnt(2)
    ds_read_b64_tr_b16 a[240:241], v62 offset:24576
    v_mfma_f32_16x16x32_bf16 v[116:119], a[232:235], a[96:99], v[116:119]
    s_waitcnt lgkmcnt(1)
    ds_read_b64_tr_b16 a[242:243], v62 offset:26624
    v_mfma_f32_16x16x32_bf16 v[116:119], a[236:239], a[100:103], v[116:119]
    buffer_load_dwordx4 v27, s[28:31], s98 offen offset:3072  lds
    ds_read_b64_tr_b16 a[244:245], v62 offset:28672
    v_mfma_f32_16x16x32_bf16 v[124:127], a[232:235], a[112:115], v[124:127]
    s_add_u32 m0, s62, 102400
    ds_read_b64_tr_b16 a[246:247], v62 offset:30720
    v_mfma_f32_16x16x32_bf16 v[124:127], a[236:239], a[116:119], v[124:127]
    s_waitcnt lgkmcnt(2)
    s_add_u32 s98, s65, 295040
    ds_read_b64_tr_b16 a[248:249], v63 offset:24576
    v_mfma_f32_16x16x32_bf16 v[112:115], a[240:243], a[104:107], v[112:115]
    s_waitcnt lgkmcnt(1)
    ds_read_b64_tr_b16 a[250:251], v63 offset:26624
    v_mfma_f32_16x16x32_bf16 v[112:115], a[244:247], a[108:111], v[112:115]
    buffer_load_dwordx4 v24, s[28:31], s98 offen offset:0  lds
    ds_read_b64_tr_b16 a[252:253], v63 offset:28672
    v_mfma_f32_16x16x32_bf16 v[120:123], a[240:243], a[120:123], v[120:123]
    buffer_store_dword v6, v5, s[8:11], s22 offen sc0 sc1
    ds_read_b64_tr_b16 a[254:255], v63 offset:30720
    v_mfma_f32_16x16x32_bf16 v[120:123], a[244:247], a[124:127], v[120:123]
    s_waitcnt lgkmcnt(2)
    ds_read_b64_tr_b16 a[192:193], v56 offset:0
    v_mfma_f32_16x16x32_bf16 v[116:119], a[248:251], a[104:107], v[116:119]
    s_waitcnt lgkmcnt(1)
    ds_read_b64_tr_b16 a[194:195], v56 offset:2048
    v_mfma_f32_16x16x32_bf16 v[116:119], a[252:255], a[108:111], v[116:119]
    buffer_load_dwordx4 v25, s[28:31], s98 offen offset:1024  lds
    ds_read_b64_tr_b16 a[196:197], v56 offset:4096
    v_mfma_f32_16x16x32_bf16 v[124:127], a[248:251], a[120:123], v[124:127]
    ds_read_b64_tr_b16 a[198:199], v56 offset:6144
    v_mfma_f32_16x16x32_bf16 v[124:127], a[252:255], a[124:127], v[124:127]
    s_waitcnt vmcnt(22) lgkmcnt(2)
    ds_read_b64_tr_b16 a[200:201], v57 offset:0
    v_mfma_f32_16x16x32_bf16 v[64:67], a[192:195], a[128:131], v[64:67]
    s_waitcnt vmcnt(20) lgkmcnt(1)
    ds_read_b64_tr_b16 a[202:203], v57 offset:2048
    v_mfma_f32_16x16x32_bf16 v[64:67], a[196:199], a[132:135], v[64:67]
    buffer_load_dwordx4 v26, s[28:31], s98 offen offset:2048  lds
    ds_read_b64_tr_b16 a[204:205], v57 offset:4096
    v_mfma_f32_16x16x32_bf16 v[72:75], a[192:195], a[144:147], v[72:75]
    s_waitcnt vmcnt(20)
    ds_read_b64_tr_b16 a[206:207], v57 offset:6144
    v_mfma_f32_16x16x32_bf16 v[72:75], a[196:199], a[148:151], v[72:75]
    s_waitcnt lgkmcnt(2)
    ds_read_b64_tr_b16 a[208:209], v56 offset:8192
    v_mfma_f32_16x16x32_bf16 v[68:71], a[200:203], a[128:131], v[68:71]
    s_waitcnt lgkmcnt(1)
    ds_read_b64_tr_b16 a[210:211], v56 offset:10240
    v_mfma_f32_16x16x32_bf16 v[68:71], a[204:207], a[132:135], v[68:71]
    buffer_load_dwordx4 v27, s[28:31], s98 offen offset:3072  lds
    ds_read_b64_tr_b16 a[212:213], v56 offset:12288
    v_mfma_f32_16x16x32_bf16 v[76:79], a[200:203], a[144:147], v[76:79]
    ds_read_b64_tr_b16 a[214:215], v56 offset:14336
    v_mfma_f32_16x16x32_bf16 v[76:79], a[204:207], a[148:151], v[76:79]
    s_waitcnt vmcnt(20) lgkmcnt(2)
    ds_read_b64_tr_b16 a[216:217], v57 offset:8192
    v_mfma_f32_16x16x32_bf16 v[64:67], a[208:211], a[136:139], v[64:67]
    s_waitcnt vmcnt(18) lgkmcnt(1)
    ds_read_b64_tr_b16 a[218:219], v57 offset:10240
    v_mfma_f32_16x16x32_bf16 v[64:67], a[212:215], a[140:143], v[64:67]
    ds_read_b64_tr_b16 a[220:221], v57 offset:12288
    v_mfma_f32_16x16x32_bf16 v[72:75], a[208:211], a[152:155], v[72:75]
    s_waitcnt vmcnt(17)
    ds_read_b64_tr_b16 a[222:223], v57 offset:14336
    v_mfma_f32_16x16x32_bf16 v[72:75], a[212:215], a[156:159], v[72:75]
    s_waitcnt lgkmcnt(2)
    ds_read_b64_tr_b16 a[224:225], v56 offset:16384
    v_mfma_f32_16x16x32_bf16 v[68:71], a[216:219], a[136:139], v[68:71]
    s_waitcnt lgkmcnt(1)
    ds_read_b64_tr_b16 a[226:227], v56 offset:18432
    v_mfma_f32_16x16x32_bf16 v[68:71], a[220:223], a[140:143], v[68:71]
    ds_read_b64_tr_b16 a[228:229], v56 offset:20480
    v_mfma_f32_16x16x32_bf16 v[76:79], a[216:219], a[152:155], v[76:79]
    ds_read_b64_tr_b16 a[230:231], v56 offset:22528
    v_mfma_f32_16x16x32_bf16 v[76:79], a[220:223], a[156:159], v[76:79]
    s_waitcnt vmcnt(16) lgkmcnt(2)
    ds_read_b64_tr_b16 a[232:233], v57 offset:16384
    v_mfma_f32_16x16x32_bf16 v[64:67], a[224:227], a[160:163], v[64:67]
    s_waitcnt vmcnt(14) lgkmcnt(1)
    ds_read_b64_tr_b16 a[234:235], v57 offset:18432
    v_mfma_f32_16x16x32_bf16 v[64:67], a[228:231], a[164:167], v[64:67]
    ds_read_b64_tr_b16 a[236:237], v57 offset:20480
    v_mfma_f32_16x16x32_bf16 v[72:75], a[224:227], a[176:179], v[72:75]
    s_waitcnt vmcnt(13)
    ds_read_b64_tr_b16 a[238:239], v57 offset:22528
    v_mfma_f32_16x16x32_bf16 v[72:75], a[228:231], a[180:183], v[72:75]
    s_waitcnt lgkmcnt(2)
    ds_read_b64_tr_b16 a[240:241], v56 offset:24576
    v_mfma_f32_16x16x32_bf16 v[68:71], a[232:235], a[160:163], v[68:71]
    s_waitcnt lgkmcnt(1)
    ds_read_b64_tr_b16 a[242:243], v56 offset:26624
    v_mfma_f32_16x16x32_bf16 v[68:71], a[236:239], a[164:167], v[68:71]
    ds_read_b64_tr_b16 a[244:245], v56 offset:28672
    v_mfma_f32_16x16x32_bf16 v[76:79], a[232:235], a[176:179], v[76:79]
    buffer_load_dword v3, v4, s[8:11], s23 offen sc0 sc1
    ds_read_b64_tr_b16 a[246:247], v56 offset:30720
    v_mfma_f32_16x16x32_bf16 v[76:79], a[236:239], a[180:183], v[76:79]
    s_waitcnt vmcnt(13) lgkmcnt(2)
    ds_read_b64_tr_b16 a[248:249], v57 offset:24576
    v_mfma_f32_16x16x32_bf16 v[64:67], a[240:243], a[168:171], v[64:67]
    s_waitcnt vmcnt(11) lgkmcnt(1)
    ds_read_b64_tr_b16 a[250:251], v57 offset:26624
    v_mfma_f32_16x16x32_bf16 v[64:67], a[244:247], a[172:175], v[64:67]
    ds_read_b64_tr_b16 a[252:253], v57 offset:28672
    v_mfma_f32_16x16x32_bf16 v[72:75], a[240:243], a[184:187], v[72:75]
    s_waitcnt vmcnt(10)
    ds_read_b64_tr_b16 a[254:255], v57 offset:30720
    v_mfma_f32_16x16x32_bf16 v[72:75], a[244:247], a[188:191], v[72:75]
    s_waitcnt lgkmcnt(2)
    ds_read_b64_tr_b16 a[192:193], v58 offset:0
    v_mfma_f32_16x16x32_bf16 v[68:71], a[248:251], a[168:171], v[68:71]
    s_waitcnt lgkmcnt(1)
    ds_read_b64_tr_b16 a[194:195], v58 offset:2048
    v_mfma_f32_16x16x32_bf16 v[68:71], a[252:255], a[172:175], v[68:71]
    ds_read_b64_tr_b16 a[196:197], v58 offset:4096
    v_mfma_f32_16x16x32_bf16 v[76:79], a[248:251], a[184:187], v[76:79]
    ds_read_b64_tr_b16 a[198:199], v58 offset:6144
    v_mfma_f32_16x16x32_bf16 v[76:79], a[252:255], a[188:191], v[76:79]
    s_waitcnt lgkmcnt(2)
    ds_read_b64_tr_b16 a[200:201], v59 offset:0
    v_mfma_f32_16x16x32_bf16 v[80:83], a[192:195], a[128:131], v[80:83]
    s_waitcnt lgkmcnt(1)
    ds_read_b64_tr_b16 a[202:203], v59 offset:2048
    v_mfma_f32_16x16x32_bf16 v[80:83], a[196:199], a[132:135], v[80:83]
    ds_read_b64_tr_b16 a[204:205], v59 offset:4096
    v_mfma_f32_16x16x32_bf16 v[88:91], a[192:195], a[144:147], v[88:91]
    ds_read_b64_tr_b16 a[206:207], v59 offset:6144
    v_mfma_f32_16x16x32_bf16 v[88:91], a[196:199], a[148:151], v[88:91]
    s_waitcnt lgkmcnt(2)
    ds_read_b64_tr_b16 a[208:209], v58 offset:8192
    v_mfma_f32_16x16x32_bf16 v[84:87], a[200:203], a[128:131], v[84:87]
    s_waitcnt lgkmcnt(1)
    ds_read_b64_tr_b16 a[210:211], v58 offset:10240
    v_mfma_f32_16x16x32_bf16 v[84:87], a[204:207], a[132:135], v[84:87]
    ds_read_b64_tr_b16 a[212:213], v58 offset:12288
    v_mfma_f32_16x16x32_bf16 v[92:95], a[200:203], a[144:147], v[92:95]
    ds_read_b64_tr_b16 a[214:215], v58 offset:14336
    v_cvt_pk_bf16_f32 v64, v64, v65
    s_waitcnt vmcnt(1)
    s_barrier
    v_mfma_f32_16x16x32_bf16 v[92:95], a[204:207], a[148:151], v[92:95]
    s_waitcnt lgkmcnt(2)
    ds_read_b64_tr_b16 a[216:217], v59 offset:8192
    v_cvt_pk_bf16_f32 v65, v66, v67
    v_mfma_f32_16x16x32_bf16 v[80:83], a[208:211], a[136:139], v[80:83]
    s_waitcnt lgkmcnt(1)
    ds_read_b64_tr_b16 a[218:219], v59 offset:10240
    v_cvt_pk_bf16_f32 v66, v68, v69
    v_mfma_f32_16x16x32_bf16 v[80:83], a[212:215], a[140:143], v[80:83]
    ds_read_b64_tr_b16 a[220:221], v59 offset:12288
    v_cvt_pk_bf16_f32 v67, v70, v71
    v_mfma_f32_16x16x32_bf16 v[88:91], a[208:211], a[152:155], v[88:91]
    ds_read_b64_tr_b16 a[222:223], v59 offset:14336
    v_min_u32 v64, -2, v64
    v_mfma_f32_16x16x32_bf16 v[88:91], a[212:215], a[156:159], v[88:91]
    s_waitcnt lgkmcnt(2)
    ds_read_b64_tr_b16 a[224:225], v58 offset:16384
    v_min_u32 v65, -2, v65
    v_mfma_f32_16x16x32_bf16 v[84:87], a[216:219], a[136:139], v[84:87]
    s_waitcnt lgkmcnt(1)
    ds_read_b64_tr_b16 a[226:227], v58 offset:18432
    v_min_u32 v66, -2, v66
    v_mfma_f32_16x16x32_bf16 v[84:87], a[220:223], a[140:143], v[84:87]
    ds_read_b64_tr_b16 a[228:229], v58 offset:20480
    v_min_u32 v67, -2, v67
    v_mfma_f32_16x16x32_bf16 v[92:95], a[216:219], a[152:155], v[92:95]
    s_waitcnt lgkmcnt(1)
    s_add_u32 s75, s18, 0
    ds_read_b64_tr_b16 a[230:231], v58 offset:22528
    v_mfma_f32_16x16x32_bf16 v[92:95], a[220:223], a[156:159], v[92:95]
    buffer_store_dwordx4 v[64:67], v23, s[8:11], s75 offen offset:0 sc0 sc1
    ds_read_b64_tr_b16 a[232:233], v59 offset:16384
    v_mfma_f32_16x16x32_bf16 v[80:83], a[224:227], a[160:163], v[80:83]
    s_waitcnt lgkmcnt(1)
    ds_read_b64_tr_b16 a[234:235], v59 offset:18432
    v_cvt_pk_bf16_f32 v72, v72, v73
    v_mfma_f32_16x16x32_bf16 v[80:83], a[228:231], a[164:167], v[80:83]
    ds_read_b64_tr_b16 a[236:237], v59 offset:20480
    v_cvt_pk_bf16_f32 v73, v74, v75
    v_mfma_f32_16x16x32_bf16 v[88:91], a[224:227], a[176:179], v[88:91]
    ds_read_b64_tr_b16 a[238:239], v59 offset:22528
    v_cvt_pk_bf16_f32 v74, v76, v77
    v_mfma_f32_16x16x32_bf16 v[88:91], a[228:231], a[180:183], v[88:91]
    s_waitcnt lgkmcnt(2)
    ds_read_b64_tr_b16 a[240:241], v58 offset:24576
    v_mfma_f32_16x16x32_bf16 v[84:87], a[232:235], a[160:163], v[84:87]
    s_waitcnt lgkmcnt(1)
    ds_read_b64_tr_b16 a[242:243], v58 offset:26624
    v_cvt_pk_bf16_f32 v75, v78, v79
    s_waitcnt vmcnt(1)
    v_cmp_ne_u32 vcc, 0, v3
    s_cmp_eq_u64 vcc, -1
    s_cbranch_scc0 L_C2_slow_13
L_C2_ok_14:
    v_mfma_f32_16x16x32_bf16 v[84:87], a[236:239], a[164:167], v[84:87]
    s_add_u32 s74, s24, 0
    ds_read_b64_tr_b16 a[244:245], v58 offset:28672
    v_min_u32 v72, -2, v72
    v_mfma_f32_16x16x32_bf16 v[92:95], a[232:235], a[176:179], v[92:95]
    buffer_load_dwordx4 v[128:131], v1, s[8:11], s74 offen offset:0
    ds_read_b64_tr_b16 a[246:247], v58 offset:30720
    v_mfma_f32_16x16x32_bf16 v[92:95], a[236:239], a[180:183], v[92:95]
    s_waitcnt lgkmcnt(2)
    s_add_u32 s74, s24, 4096
    ds_read_b64_tr_b16 a[248:249], v59 offset:24576
    v_min_u32 v73, -2, v73
    v_mfma_f32_16x16x32_bf16 v[80:83], a[240:243], a[168:171], v[80:83]
    s_waitcnt lgkmcnt(1)
    ds_read_b64_tr_b16 a[250:251], v59 offset:26624
    v_min_u32 v74, -2, v74
    v_mfma_f32_16x16x32_bf16 v[80:83], a[244:247], a[172:175], v[80:83]
    ds_read_b64_tr_b16 a[252:253], v59 offset:28672
    v_min_u32 v75, -2, v75
    v_mfma_f32_16x16x32_bf16 v[88:91], a[240:243], a[184:187], v[88:91]
    buffer_load_dwordx4 v[144:147], v1, s[8:11], s74 offen offset:0
    ds_read_b64_tr_b16 a[254:255], v59 offset:30720
    v_mfma_f32_16x16x32_bf16 v[88:91], a[244:247], a[188:191], v[88:91]
    s_waitcnt lgkmcnt(2)
    s_add_u32 s74, s24, 0
    ds_read_b64_tr_b16 a[192:193], v60 offset:32768
    v_mfma_f32_16x16x32_bf16 v[84:87], a[248:251], a[168:171], v[84:87]
    s_waitcnt lgkmcnt(1)
    s_add_u32 s75, s18, 131072
    ds_read_b64_tr_b16 a[194:195], v60 offset:34816
    v_mfma_f32_16x16x32_bf16 v[84:87], a[252:255], a[172:175], v[84:87]
    buffer_store_dwordx4 v[72:75], v23, s[8:11], s75 offen offset:0 sc0 sc1
    ds_read_b64_tr_b16 a[196:197], v60 offset:36864
    v_mfma_f32_16x16x32_bf16 v[92:95], a[248:251], a[184:187], v[92:95]
    buffer_load_dwordx4 v[132:135], v1, s[8:11], s74 offen offset:1024
    ds_read_b64_tr_b16 a[198:199], v60 offset:38912
    v_mfma_f32_16x16x32_bf16 v[92:95], a[252:255], a[188:191], v[92:95]
    s_waitcnt lgkmcnt(2)
    s_add_u32 s74, s24, 4096
    ds_read_b64_tr_b16 a[200:201], v61 offset:32768
    v_mfma_f32_16x16x32_bf16 v[96:99], a[192:195], a[128:131], v[96:99]
    s_waitcnt lgkmcnt(1)
    ds_read_b64_tr_b16 a[202:203], v61 offset:34816
    v_mfma_f32_16x16x32_bf16 v[96:99], a[196:199], a[132:135], v[96:99]
    ds_read_b64_tr_b16 a[204:205], v61 offset:36864
    v_mfma_f32_16x16x32_bf16 v[104:107], a[192:195], a[144:147], v[104:107]
    buffer_load_dwordx4 v[148:151], v1, s[8:11], s74 offen offset:1024
    ds_read_b64_tr_b16 a[206:207], v61 offset:38912
    v_mfma_f32_16x16x32_bf16 v[104:107], a[196:199], a[148:151], v[104:107]
    s_waitcnt lgkmcnt(2)
    s_add_u32 s74, s24, 0
    ds_read_b64_tr_b16 a[208:209], v60 offset:40960
    v_mfma_f32_16x16x32_bf16 v[100:103], a[200:203], a[128:131], v[100:103]
    s_waitcnt lgkmcnt(1)
    ds_read_b64_tr_b16 a[210:211], v60 offset:43008
    v_mfma_f32_16x16x32_bf16 v[100:103], a[204:207], a[132:135], v[100:103]
    ds_read_b64_tr_b16 a[212:213], v60 offset:45056
    v_mfma_f32_16x16x32_bf16 v[108:111], a[200:203], a[144:147], v[108:111]
    buffer_load_dwordx4 v[136:139], v1, s[8:11], s74 offen offset:2048
    ds_read_b64_tr_b16 a[214:215], v60 offset:47104
    v_mfma_f32_16x16x32_bf16 v[108:111], a[204:207], a[148:151], v[108:111]
    s_waitcnt lgkmcnt(2)
    s_add_u32 s74, s24, 4096
    ds_read_b64_tr_b16 a[216:217], v61 offset:40960
    v_cvt_pk_bf16_f32 v80, v80, v81
    v_mfma_f32_16x16x32_bf16 v[96:99], a[208:211], a[136:139], v[96:99]
    s_waitcnt lgkmcnt(1)
    ds_read_b64_tr_b16 a[218:219], v61 offset:43008
    v_cvt_pk_bf16_f32 v81, v82, v83
    v_mfma_f32_16x16x32_bf16 v[96:99], a[212:215], a[140:143], v[96:99]
    ds_read_b64_tr_b16 a[220:221], v61 offset:45056
    v_cvt_pk_bf16_f32 v82, v84, v85
    v_mfma_f32_16x16x32_bf16 v[104:107], a[208:211], a[152:155], v[104:107]
    buffer_load_dwordx4 v[152:155], v1, s[8:11], s74 offen offset:2048
    ds_read_b64_tr_b16 a[222:223], v61 offset:47104
    v_mfma_f32_16x16x32_bf16 v[104:107], a[212:215], a[156:159], v[104:107]
    s_waitcnt lgkmcnt(2)
    s_add_u32 s74, s24, 0
    ds_read_b64_tr_b16 a[224:225], v60 offset:49152
    v_cvt_pk_bf16_f32 v83, v86, v87
    v_mfma_f32_16x16x32_bf16 v[100:103], a[216:219], a[136:139], v[100:103]
    s_waitcnt lgkmcnt(1)
    ds_read_b64_tr_b16 a[226:227], v60 offset:51200
    v_min_u32 v80, -2, v80
    v_mfma_f32_16x16x32_bf16 v[100:103], a[220:223], a[140:143], v[100:103]
    ds_read_b64_tr_b16 a[228:229], v60 offset:53248
    v_min_u32 v81, -2, v81
    v_mfma_f32_16x16x32_bf16 v[108:111], a[216:219], a[152:155], v[108:111]
    buffer_load_dwordx4 v[140:143], v1, s[8:11], s74 offen offset:3072
    ds_read_b64_tr_b16 a[230:231], v60 offset:55296
    v_mfma_f32_16x16x32_bf16 v[108:111], a[220:223], a[156:159], v[108:111]
    s_waitcnt lgkmcnt(2)
    s_add_u32 s74, s24, 4096
    ds_read_b64_tr_b16 a[232:233], v61 offset:49152
    v_min_u32 v82, -2, v82
    v_mfma_f32_16x16x32_bf16 v[96:99], a[224:227], a[160:163], v[96:99]
    s_waitcnt lgkmcnt(1)
    ds_read_b64_tr_b16 a[234:235], v61 offset:51200
    v_min_u32 v83, -2, v83
    v_mfma_f32_16x16x32_bf16 v[96:99], a[228:231], a[164:167], v[96:99]
    s_add_u32 s75, s18, 0
    ds_read_b64_tr_b16 a[236:237], v61 offset:53248
    v_mfma_f32_16x16x32_bf16 v[104:107], a[224:227], a[176:179], v[104:107]
    buffer_load_dwordx4 v[156:159], v1, s[8:11], s74 offen offset:3072
    ds_read_b64_tr_b16 a[238:239], v61 offset:55296
    v_mfma_f32_16x16x32_bf16 v[104:107], a[228:231], a[180:183], v[104:107]
    s_waitcnt lgkmcnt(0)
    s_add_u32 s74, s24, 8192
    ds_read_b64_tr_b16 a[240:241], v60 offset:57344
    v_mfma_f32_16x16x32_bf16 v[100:103], a[232:235], a[160:163], v[100:103]
    buffer_store_dwordx4 v[80:83], v23, s[8:11], s75 offen offset:256 sc0 sc1
    ds_read_b64_tr_b16 a[242:243], v60 offset:59392
    v_mfma_f32_16x16x32_bf16 v[100:103], a[236:239], a[164:167], v[100:103]
    ds_read_b64_tr_b16 a[244:245], v60 offset:61440
    v_cvt_pk_bf16_f32 v88, v88, v89
    v_mfma_f32_16x16x32_bf16 v[108:111], a[232:235], a[176:179], v[108:111]
    buffer_load_dwordx4 v[160:163], v1, s[8:11], s74 offen offset:0
    ds_read_b64_tr_b16 a[246:247], v60 offset:63488
    v_mfma_f32_16x16x32_bf16 v[108:111], a[236:239], a[180:183], v[108:111]
    s_waitcnt lgkmcnt(2)
    s_add_u32 s74, s24, 12288
    ds_read_b64_tr_b16 a[248:249], v61 offset:57344
    v_cvt_pk_bf16_f32 v89, v90, v91
    v_mfma_f32_16x16x32_bf16 v[96:99], a[240:243], a[168:171], v[96:99]
    s_waitcnt lgkmcnt(1)
    ds_read_b64_tr_b16 a[250:251], v61 offset:59392
    v_cvt_pk_bf16_f32 v90, v92, v93
    v_mfma_f32_16x16x32_bf16 v[96:99], a[244:247], a[172:175], v[96:99]
    ds_read_b64_tr_b16 a[252:253], v61 offset:61440
    v_cvt_pk_bf16_f32 v91, v94, v95
    v_mfma_f32_16x16x32_bf16 v[104:107], a[240:243], a[184:187], v[104:107]
    buffer_load_dwordx4 v[176:179], v1, s[8:11], s74 offen offset:0
    ds_read_b64_tr_b16 a[254:255], v61 offset:63488
    v_mfma_f32_16x16x32_bf16 v[104:107], a[244:247], a[188:191], v[104:107]
    s_waitcnt lgkmcnt(2)
    s_add_u32 s74, s24, 8192
    ds_read_b64_tr_b16 a[192:193], v62 offset:32768
    v_min_u32 v88, -2, v88
    v_mfma_f32_16x16x32_bf16 v[100:103], a[248:251], a[168:171], v[100:103]
    s_waitcnt lgkmcnt(1)
    ds_read_b64_tr_b16 a[194:195], v62 offset:34816
    v_min_u32 v89, -2, v89
    v_mfma_f32_16x16x32_bf16 v[100:103], a[252:255], a[172:175], v[100:103]
    ds_read_b64_tr_b16 a[196:197], v62 offset:36864
    v_min_u32 v90, -2, v90
    v_mfma_f32_16x16x32_bf16 v[108:111], a[248:251], a[184:187], v[108:111]
    buffer_load_dwordx4 v[164:167], v1, s[8:11], s74 offen offset:1024
    ds_read_b64_tr_b16 a[198:199], v62 offset:38912
    v_mfma_f32_16x16x32_bf16 v[108:111], a[252:255], a[188:191], v[108:111]
    s_waitcnt lgkmcnt(2)
    s_add_u32 s74, s24, 12288
    ds_read_b64_tr_b16 a[200:201], v63 offset:32768
    v_min_u32 v91, -2, v91
    v_mfma_f32_16x16x32_bf16 v[112:115], a[192:195], a[128:131], v[112:115]
    s_waitcnt lgkmcnt(1)
    s_add_u32 s75, s18, 131072
    ds_read_b64_tr_b16 a[202:203], v63 offset:34816
    v_mfma_f32_16x16x32_bf16 v[112:115], a[196:199], a[132:135], v[112:115]
    buffer_store_dwordx4 v[88:91], v23, s[8:11], s75 offen offset:256 sc0 sc1
    ds_read_b64_tr_b16 a[204:205], v63 offset:36864
    v_mfma_f32_16x16x32_bf16 v[120:123], a[192:195], a[144:147], v[120:123]
    buffer_load_dwordx4 v[180:183], v1, s[8:11], s74 offen offset:1024
    ds_read_b64_tr_b16 a[206:207], v63 offset:38912
    v_mfma_f32_16x16x32_bf16 v[120:123], a[196:199], a[148:151], v[120:123]
    s_waitcnt lgkmcnt(2)
    s_add_u32 s74, s24, 8192
    ds_read_b64_tr_b16 a[208:209], v62 offset:40960
    v_mfma_f32_16x16x32_bf16 v[116:119], a[200:203], a[128:131], v[116:119]
    s_waitcnt lgkmcnt(1)
    ds_read_b64_tr_b16 a[210:211], v62 offset:43008
    v_mfma_f32_16x16x32_bf16 v[116:119], a[204:207], a[132:135], v[116:119]
    ds_read_b64_tr_b16 a[212:213], v62 offset:45056
    v_mfma_f32_16x16x32_bf16 v[124:127], a[200:203], a[144:147], v[124:127]
    buffer_load_dwordx4 v[168:171], v1, s[8:11], s74 offen offset:2048
    ds_read_b64_tr_b16 a[214:215], v62 offset:47104
    v_mfma_f32_16x16x32_bf16 v[124:127], a[204:207], a[148:151], v[124:127]
    s_waitcnt lgkmcnt(2)
    s_add_u32 s74, s24, 12288
    ds_read_b64_tr_b16 a[216:217], v63 offset:40960
    v_cvt_pk_bf16_f32 v96, v96, v97
    v_mfma_f32_16x16x32_bf16 v[112:115], a[208:211], a[136:139], v[112:115]
    s_waitcnt lgkmcnt(1)
    ds_read_b64_tr_b16 a[218:219], v63 offset:43008
    v_cvt_pk_bf16_f32 v97, v98, v99
    v_mfma_f32_16x16x32_bf16 v[112:115], a[212:215], a[140:143], v[112:115]
    ds_read_b64_tr_b16 a[220:221], v63 offset:45056
    v_cvt_pk_bf16_f32 v98, v100, v101
    v_mfma_f32_16x16x32_bf16 v[120:123], a[208:211], a[152:155], v[120:123]
    buffer_load_dwordx4 v[184:187], v1, s[8:11], s74 offen offset:2048
    ds_read_b64_tr_b16 a[222:223], v63 offset:47104
    v_mfma_f32_16x16x32_bf16 v[120:123], a[212:215], a[156:159], v[120:123]
    s_waitcnt lgkmcnt(2)
    s_add_u32 s74, s24, 8192
    ds_read_b64_tr_b16 a[224:225], v62 offset:49152
    v_cvt_pk_bf16_f32 v99, v102, v103
    v_mfma_f32_16x16x32_bf16 v[116:119], a[216:219], a[136:139], v[116:119]
    s_waitcnt lgkmcnt(1)
    ds_read_b64_tr_b16 a[226:227], v62 offset:51200
    v_min_u32 v96, -2, v96
    v_mfma_f32_16x16x32_bf16 v[116:119], a[220:223], a[140:143], v[116:119]
    ds_read_b64_tr_b16 a[228:229], v62 offset:53248
    v_min_u32 v97, -2, v97
    v_mfma_f32_16x16x32_bf16 v[124:127], a[216:219], a[152:155], v[124:127]
    buffer_load_dwordx4 v[172:175], v1, s[8:11], s74 offen offset:3072
    ds_read_b64_tr_b16 a[230:231], v62 offset:55296
    v_mfma_f32_16x16x32_bf16 v[124:127], a[220:223], a[156:159], v[124:127]
    s_waitcnt lgkmcnt(2)
    s_add_u32 s74, s24, 12288
    ds_read_b64_tr_b16 a[232:233], v63 offset:49152
    v_min_u32 v98, -2, v98
    v_mfma_f32_16x16x32_bf16 v[112:115], a[224:227], a[160:163], v[112:115]
    s_waitcnt lgkmcnt(1)
    ds_read_b64_tr_b16 a[234:235], v63 offset:51200
    v_min_u32 v99, -2, v99
    v_mfma_f32_16x16x32_bf16 v[112:115], a[228:231], a[164:167], v[112:115]
    s_add_u32 s75, s18, 0
    ds_read_b64_tr_b16 a[236:237], v63 offset:53248
    v_mfma_f32_16x16x32_bf16 v[120:123], a[224:227], a[176:179], v[120:123]
    buffer_load_dwordx4 v[188:191], v1, s[8:11], s74 offen offset:3072
    ds_read_b64_tr_b16 a[238:239], v63 offset:55296
    v_mfma_f32_16x16x32_bf16 v[120:123], a[228:231], a[180:183], v[120:123]
    s_waitcnt lgkmcnt(0)
    s_add_u32 s74, s24, 16384
    ds_read_b64_tr_b16 a[240:241], v62 offset:57344
    v_mfma_f32_16x16x32_bf16 v[116:119], a[232:235], a[160:163], v[116:119]
    buffer_store_dwordx4 v[96:99], v23, s[8:11], s75 offen offset:512 sc0 sc1
    ds_read_b64_tr_b16 a[242:243], v62 offset:59392
    v_mfma_f32_16x16x32_bf16 v[116:119], a[236:239], a[164:167], v[116:119]
    ds_read_b64_tr_b16 a[244:245], v62 offset:61440
    v_cvt_pk_bf16_f32 v104, v104, v105
    v_mfma_f32_16x16x32_bf16 v[124:127], a[232:235], a[176:179], v[124:127]
    buffer_load_dwordx4 v[192:195], v1, s[8:11], s74 offen offset:0
    ds_read_b64_tr_b16 a[246:247], v62 offset:63488
    v_mfma_f32_16x16x32_bf16 v[124:127], a[236:239], a[180:183], v[124:127]
    s_waitcnt lgkmcnt(2)
    s_add_u32 s74, s24, 20480
    ds_read_b64_tr_b16 a[248:249], v63 offset:57344
    v_cvt_pk_bf16_f32 v105, v106, v107
    v_mfma_f32_16x16x32_bf16 v[112:115], a[240:243], a[168:171], v[112:115]
    s_waitcnt lgkmcnt(1)
    ds_read_b64_tr_b16 a[250:251], v63 offset:59392
    v_cvt_pk_bf16_f32 v106, v108, v109
    v_mfma_f32_16x16x32_bf16 v[112:115], a[244:247], a[172:175], v[112:115]
    ds_read_b64_tr_b16 a[252:253], v63 offset:61440
    v_cvt_pk_bf16_f32 v107, v110, v111
    v_mfma_f32_16x16x32_bf16 v[120:123], a[240:243], a[184:187], v[120:123]
    buffer_load_dwordx4 v[208:211], v1, s[8:11], s74 offen offset:0
    ds_read_b64_tr_b16 a[254:255], v63 offset:63488
    v_mfma_f32_16x16x32_bf16 v[120:123], a[244:247], a[188:191], v[120:123]
    s_waitcnt lgkmcnt(2)
    s_add_u32 s74, s24, 16384
    ds_read_b64_tr_b16 a[192:193], v56 offset:32768
    v_min_u32 v104, -2, v104
    v_mfma_f32_16x16x32_bf16 v[116:119], a[248:251], a[168:171], v[116:119]
    s_waitcnt lgkmcnt(1)
    ds_read_b64_tr_b16 a[194:195], v56 offset:34816
    v_min_u32 v105, -2, v105
    v_mfma_f32_16x16x32_bf16 v[116:119], a[252:255], a[172:175], v[116:119]
    ds_read_b64_tr_b16 a[196:197], v56 offset:36864
    v_min_u32 v106, -2, v106
    v_mfma_f32_16x16x32_bf16 v[124:127], a[248:251], a[184:187], v[124:127]
    buffer_load_dwordx4 v[196:199], v1, s[8:11], s74 offen offset:1024
    ds_read_b64_tr_b16 a[198:199], v56 offset:38912
    v_mfma_f32_16x16x32_bf16 v[124:127], a[252:255], a[188:191], v[124:127]
    s_waitcnt vmcnt(22) lgkmcnt(2)
    s_add_u32 s74, s24, 20480
    ds_read_b64_tr_b16 a[200:201], v57 offset:32768
    v_min_u32 v107, -2, v107
    v_mfma_f32_16x16x32_bf16 v[64:67], a[192:195], v[128:131], 0
    s_waitcnt vmcnt(18) lgkmcnt(1)
    s_add_u32 s75, s18, 131072
    ds_read_b64_tr_b16 a[202:203], v57 offset:34816
    v_mfma_f32_16x16x32_bf16 v[64:67], a[196:199], v[132:135], v[64:67]
    buffer_store_dwordx4 v[104:107], v23, s[8:11], s75 offen offset:512 sc0 sc1
    ds_read_b64_tr_b16 a[204:205], v57 offset:36864
    v_mfma_f32_16x16x32_bf16 v[72:75], a[192:195], v[144:147], 0
    buffer_load_dwordx4 v[212:215], v1, s[8:11], s74 offen offset:1024
    ds_read_b64_tr_b16 a[206:207], v57 offset:38912
    v_mfma_f32_16x16x32_bf16 v[72:75], a[196:199], v[148:151], v[72:75]
    s_waitcnt lgkmcnt(2)
    s_add_u32 s74, s24, 16384
    ds_read_b64_tr_b16 a[208:209], v56 offset:40960
    v_mfma_f32_16x16x32_bf16 v[68:71], a[200:203], v[128:131], 0
    s_waitcnt lgkmcnt(1)
    ds_read_b64_tr_b16 a[210:211], v56 offset:43008
    v_mfma_f32_16x16x32_bf16 v[68:71], a[204:207], v[132:135], v[68:71]
    ds_read_b64_tr_b16 a[212:213], v56 offset:45056
    v_mfma_f32_16x16x32_bf16 v[76:79], a[200:203], v[144:147], 0
    buffer_load_dwordx4 v[200:203], v1, s[8:11], s74 offen offset:2048
    ds_read_b64_tr_b16 a[214:215], v56 offset:47104
    v_mfma_f32_16x16x32_bf16 v[76:79], a[204:207], v[148:151], v[76:79]
    s_waitcnt vmcnt(20) lgkmcnt(2)
    s_add_u32 s74, s24, 20480
    ds_read_b64_tr_b16 a[216:217], v57 offset:40960
    v_cvt_pk_bf16_f32 v112, v112, v113
    v_mfma_f32_16x16x32_bf16 v[64:67], a[208:211], v[136:139], v[64:67]
    s_waitcnt vmcnt(18) lgkmcnt(1)
    ds_read_b64_tr_b16 a[218:219], v57 offset:43008
    v_cvt_pk_bf16_f32 v113, v114, v115
    v_mfma_f32_16x16x32_bf16 v[64:67], a[212:215], v[140:143], v[64:67]
    s_waitcnt vmcnt(17)
    ds_read_b64_tr_b16 a[220:221], v57 offset:45056
    v_cvt_pk_bf16_f32 v114, v116, v117
    v_mfma_f32_16x16x32_bf16 v[72:75], a[208:211], v[152:155], v[72:75]
    buffer_load_dwordx4 v[216:219], v1, s[8:11], s74 offen offset:2048
    ds_read_b64_tr_b16 a[222:223], v57 offset:47104
    v_mfma_f32_16x16x32_bf16 v[72:75], a[212:215], v[156:159], v[72:75]
    s_waitcnt lgkmcnt(2)
    s_add_u32 s74, s24, 16384
    ds_read_b64_tr_b16 a[224:225], v56 offset:49152
    v_cvt_pk_bf16_f32 v115, v118, v119
    v_mfma_f32_16x16x32_bf16 v[68:71], a[216:219], v[136:139], v[68:71]
    s_waitcnt lgkmcnt(1)
    ds_read_b64_tr_b16 a[226:227], v56 offset:51200
    v_min_u32 v112, -2, v112
    v_mfma_f32_16x16x32_bf16 v[68:71], a[220:223], v[140:143], v[68:71]
    ds_read_b64_tr_b16 a[228:229], v56 offset:53248
    v_min_u32 v113, -2, v113
    v_mfma_f32_16x16x32_bf16 v[76:79], a[216:219], v[152:155], v[76:79]
    buffer_load_dwordx4 v[204:207], v1, s[8:11], s74 offen offset:3072
    ds_read_b64_tr_b16 a[230:231], v56 offset:55296
    v_mfma_f32_16x16x32_bf16 v[76:79], a[220:223], v[156:159], v[76:79]
    s_waitcnt vmcnt(17) lgkmcnt(2)
    s_add_u32 s74, s24, 20480
    ds_read_b64_tr_b16 a[232:233], v57 offset:49152
    v_min_u32 v114, -2, v114
    v_mfma_f32_16x16x32_bf16 v[64:67], a[224:227], v[160:163], v[64:67]
    s_waitcnt vmcnt(15) lgkmcnt(1)
    ds_read_b64_tr_b16 a[234:235], v57 offset:51200
    v_min_u32 v115, -2, v115
    v_mfma_f32_16x16x32_bf16 v[64:67], a[228:231], v[164:167], v[64:67]
    s_waitcnt vmcnt(13)
    s_add_u32 s75, s18, 0
    ds_read_b64_tr_b16 a[236:237], v57 offset:53248
    v_mfma_f32_16x16x32_bf16 v[72:75], a[224:227], v[176:179], v[72:75]
    buffer_load_dwordx4 v[220:223], v1, s[8:11], s74 offen offset:3072
    ds_read_b64_tr_b16 a[238:239], v57 offset:55296
    v_mfma_f32_16x16x32_bf16 v[72:75], a[228:231], v[180:183], v[72:75]
    s_waitcnt lgkmcnt(0)
    s_add_u32 s74, s24, 24576
    ds_read_b64_tr_b16 a[240:241], v56 offset:57344
    v_mfma_f32_16x16x32_bf16 v[68:71], a[232:235], v[160:163], v[68:71]
    buffer_store_dwordx4 v[112:115], v23, s[8:11], s75 offen offset:768 sc0 sc1
    ds_read_b64_tr_b16 a[242:243], v56 offset:59392
    v_mfma_f32_16x16x32_bf16 v[68:71], a[236:239], v[164:167], v[68:71]
    ds_read_b64_tr_b16 a[244:245], v56 offset:61440
    v_cvt_pk_bf16_f32 v120, v120, v121
    v_mfma_f32_16x16x32_bf16 v[76:79], a[232:235], v[176:179], v[76:79]
    buffer_load_dwordx4 v[224:227], v1, s[8:11], s74 offen offset:0
    ds_read_b64_tr_b16 a[246:247], v56 offset:63488
    v_mfma_f32_16x16x32_bf16 v[76:79], a[236:239], v[180:183], v[76:79]
    s_waitcnt vmcnt(15) lgkmcnt(2)
    s_add_u32 s74, s24, 28672
    ds_read_b64_tr_b16 a[248:249], v57 offset:57344
    v_cvt_pk_bf16_f32 v121, v122, v123
    v_mfma_f32_16x16x32_bf16 v[64:67], a[240:243], v[168:171], v[64:67]
    s_waitcnt vmcnt(13) lgkmcnt(1)
    ds_read_b64_tr_b16 a[250:251], v57 offset:59392
    v_cvt_pk_bf16_f32 v122, v124, v125
    v_mfma_f32_16x16x32_bf16 v[64:67], a[244:247], v[172:175], v[64:67]
    s_waitcnt vmcnt(12)
    ds_read_b64_tr_b16 a[252:253], v57 offset:61440
    v_cvt_pk_bf16_f32 v123, v126, v127
    v_mfma_f32_16x16x32_bf16 v[72:75], a[240:243], v[184:187], v[72:75]
    buffer_load_dwordx4 v[240:243], v1, s[8:11], s74 offen offset:0
    ds_read_b64_tr_b16 a[254:255], v57 offset:63488
    v_mfma_f32_16x16x32_bf16 v[72:75], a[244:247], v[188:191], v[72:75]
    s_waitcnt lgkmcnt(2)
    s_add_u32 s74, s24, 24576
    ds_read_b64_tr_b16 a[192:193], v58 offset:32768
    v_min_u32 v120, -2, v120
    v_mfma_f32_16x16x32_bf16 v[68:71], a[248:251], v[168:171], v[68:71]
    s_waitcnt lgkmcnt(1)
    ds_read_b64_tr_b16 a[194:195], v58 offset:34816
    v_min_u32 v121, -2, v121
    v_mfma_f32_16x16x32_bf16 v[68:71], a[252:255], v[172:175], v[68:71]
    ds_read_b64_tr_b16 a[196:197], v58 offset:36864
    v_min_u32 v122, -2, v122
    v_mfma_f32_16x16x32_bf16 v[76:79], a[248:251], v[184:187], v[76:79]
    buffer_load_dwordx4 v[228:231], v1, s[8:11], s74 offen offset:1024
    ds_read_b64_tr_b16 a[198:199], v58 offset:38912
    v_mfma_f32_16x16x32_bf16 v[76:79], a[252:255], v[188:191], v[76:79]
    s_waitcnt lgkmcnt(2)
    s_add_u32 s74, s24, 28672
    ds_read_b64_tr_b16 a[200:201], v59 offset:32768
    v_min_u32 v123, -2, v123
    v_mfma_f32_16x16x32_bf16 v[80:83], a[192:195], v[128:131], 0
    s_waitcnt lgkmcnt(1)
    s_add_u32 s75, s18, 131072
    ds_read_b64_tr_b16 a[202:203], v59 offset:34816
    v_mfma_f32_16x16x32_bf16 v[80:83], a[196:199], v[132:135], v[80:83]
    buffer_store_dwordx4 v[120:123], v23, s[8:11], s75 offen offset:768 sc0 sc1
    ds_read_b64_tr_b16 a[204:205], v59 offset:36864
    v_mfma_f32_16x16x32_bf16 v[88:91], a[192:195], v[144:147], 0
    buffer_load_dwordx4 v[244:247], v1, s[8:11], s74 offen offset:1024
    ds_read_b64_tr_b16 a[206:207], v59 offset:38912
    v_mfma_f32_16x16x32_bf16 v[88:91], a[196:199], v[148:151], v[88:91]
    s_waitcnt lgkmcnt(2)
    s_add_u32 s74, s24, 24576
    ds_read_b64_tr_b16 a[208:209], v58 offset:40960
    v_mfma_f32_16x16x32_bf16 v[84:87], a[200:203], v[128:131], 0
    s_waitcnt lgkmcnt(1)
    ds_read_b64_tr_b16 a[210:211], v58 offset:43008
    v_mfma_f32_16x16x32_bf16 v[84:87], a[204:207], v[132:135], v[84:87]
    ds_read_b64_tr_b16 a[212:213], v58 offset:45056
    v_mfma_f32_16x16x32_bf16 v[92:95], a[200:203], v[144:147], 0
    buffer_load_dwordx4 v[232:235], v1, s[8:11], s74 offen offset:2048
    ds_read_b64_tr_b16 a[214:215], v58 offset:47104
    v_mfma_f32_16x16x32_bf16 v[92:95], a[204:207], v[148:151], v[92:95]
    s_waitcnt lgkmcnt(2)
    s_add_u32 s74, s24, 28672
    ds_read_b64_tr_b16 a[216:217], v59 offset:40960
    v_mfma_f32_16x16x32_bf16 v[80:83], a[208:211], v[136:139], v[80:83]
    s_waitcnt lgkmcnt(1)
    ds_read_b64_tr_b16 a[218:219], v59 offset:43008
    v_mfma_f32_16x16x32_bf16 v[80:83], a[212:215], v[140:143], v[80:83]
    ds_read_b64_tr_b16 a[220:221], v59 offset:45056
    v_mfma_f32_16x16x32_bf16 v[88:91], a[208:211], v[152:155], v[88:91]
    buffer_load_dwordx4 v[248:251], v1, s[8:11], s74 offen offset:2048
    ds_read_b64_tr_b16 a[222:223], v59 offset:47104
    v_mfma_f32_16x16x32_bf16 v[88:91], a[212:215], v[156:159], v[88:91]
    s_waitcnt lgkmcnt(2)
    s_add_u32 s74, s24, 24576
    ds_read_b64_tr_b16 a[224:225], v58 offset:49152
    v_mfma_f32_16x16x32_bf16 v[84:87], a[216:219], v[136:139], v[84:87]
    s_waitcnt lgkmcnt(1)
    ds_read_b64_tr_b16 a[226:227], v58 offset:51200
    v_mfma_f32_16x16x32_bf16 v[84:87], a[220:223], v[140:143], v[84:87]
    ds_read_b64_tr_b16 a[228:229], v58 offset:53248
    v_mfma_f32_16x16x32_bf16 v[92:95], a[216:219], v[152:155], v[92:95]
    buffer_load_dwordx4 v[236:239], v1, s[8:11], s74 offen offset:3072
    ds_read_b64_tr_b16 a[230:231], v58 offset:55296
    v_mfma_f32_16x16x32_bf16 v[92:95], a[220:223], v[156:159], v[92:95]
    s_waitcnt lgkmcnt(2)
    s_add_u32 s74, s24, 28672
    ds_read_b64_tr_b16 a[232:233], v59 offset:49152
    v_mfma_f32_16x16x32_bf16 v[80:83], a[224:227], v[160:163], v[80:83]
    s_waitcnt lgkmcnt(1)
    ds_read_b64_tr_b16 a[234:235], v59 offset:51200
    v_mfma_f32_16x16x32_bf16 v[80:83], a[228:231], v[164:167], v[80:83]
    ds_read_b64_tr_b16 a[236:237], v59 offset:53248
    v_mfma_f32_16x16x32_bf16 v[88:91], a[224:227], v[176:179], v[88:91]
    buffer_load_dwordx4 v[252:255], v1, s[8:11], s74 offen offset:3072
    ds_read_b64_tr_b16 a[238:239], v59 offset:55296
    v_mfma_f32_16x16x32_bf16 v[88:91], a[228:231], v[180:183], v[88:91]
    s_waitcnt lgkmcnt(2)
    ds_read_b64_tr_b16 a[240:241], v58 offset:57344
    v_lshlrev_b32 v50, 4, v0
    v_mfma_f32_16x16x32_bf16 v[84:87], a[232:235], v[160:163], v[84:87]
    s_waitcnt lgkmcnt(1)
    ds_read_b64_tr_b16 a[242:243], v58 offset:59392
    v_cmp_gt_u32 vcc, 224, v0
    v_mfma_f32_16x16x32_bf16 v[84:87], a[236:239], v[164:167], v[84:87]
    ds_read_b64_tr_b16 a[244:245], v58 offset:61440
    v_mov_b32 v51, 2147479552
    v_mfma_f32_16x16x32_bf16 v[92:95], a[232:235], v[176:179], v[92:95]
    ds_read_b64_tr_b16 a[246:247], v58 offset:63488
    v_cndmask_b32 v51, v51, v50, vcc
    v_mfma_f32_16x16x32_bf16 v[92:95], a[236:239], v[180:183], v[92:95]
    s_waitcnt lgkmcnt(2)
    s_mul_i32 s17, s67, 28672
    ds_read_b64_tr_b16 a[248:249], v59 offset:57344
    v_mfma_f32_16x16x32_bf16 v[80:83], a[240:243], v[168:171], v[80:83]
    s_waitcnt lgkmcnt(1)
    s_add_u32 s17, s17, 8388608
    ds_read_b64_tr_b16 a[250:251], v59 offset:59392
    v_mfma_f32_16x16x32_bf16 v[80:83], a[244:247], v[172:175], v[80:83]
    s_cmp_lt_u32 s67, 64
    s_cselect_b32 s17, s17, 2143285248
    ds_read_b64_tr_b16 a[252:253], v59 offset:61440
    v_mfma_f32_16x16x32_bf16 v[88:91], a[240:243], v[184:187], v[88:91]
    buffer_load_dwordx4 a[16:19], v51, s[8:11], s17 offen offset:0
    ds_read_b64_tr_b16 a[254:255], v59 offset:63488
    v_mfma_f32_16x16x32_bf16 v[88:91], a[244:247], v[188:191], v[88:91]
    s_waitcnt lgkmcnt(2)
    ds_read_b64_tr_b16 a[192:193], v60 offset:0
    v_mfma_f32_16x16x32_bf16 v[84:87], a[248:251], v[168:171], v[84:87]
    s_waitcnt lgkmcnt(1)
    ds_read_b64_tr_b16 a[194:195], v60 offset:2048
    v_mfma_f32_16x16x32_bf16 v[84:87], a[252:255], v[172:175], v[84:87]
    ds_read_b64_tr_b16 a[196:197], v60 offset:4096
    v_mfma_f32_16x16x32_bf16 v[92:95], a[248:251], v[184:187], v[92:95]
    buffer_load_dwordx4 a[20:23], v51, s[8:11], s17 offen offset:3584
    ds_read_b64_tr_b16 a[198:199], v60 offset:6144
    v_mfma_f32_16x16x32_bf16 v[92:95], a[252:255], v[188:191], v[92:95]
    s_waitcnt lgkmcnt(2)
    s_add_u32 s17, s17, 7168
    ds_read_b64_tr_b16 a[200:201], v61 offset:0
    v_mfma_f32_16x16x32_bf16 v[96:99], a[192:195], v[128:131], 0
    s_waitcnt lgkmcnt(1)
    ds_read_b64_tr_b16 a[202:203], v61 offset:2048
    v_mfma_f32_16x16x32_bf16 v[96:99], a[196:199], v[132:135], v[96:99]
    ds_read_b64_tr_b16 a[204:205], v61 offset:4096
    v_mfma_f32_16x16x32_bf16 v[104:107], a[192:195], v[144:147], 0
    buffer_load_dwordx4 a[24:27], v51, s[8:11], s17 offen offset:0
    ds_read_b64_tr_b16 a[206:207], v61 offset:6144
    v_mfma_f32_16x16x32_bf16 v[104:107], a[196:199], v[148:151], v[104:107]
    s_waitcnt lgkmcnt(2)
    ds_read_b64_tr_b16 a[208:209], v60 offset:8192
    v_mfma_f32_16x16x32_bf16 v[100:103], a[200:203], v[128:131], 0
    s_waitcnt lgkmcnt(1)
    ds_read_b64_tr_b16 a[210:211], v60 offset:10240
    v_mfma_f32_16x16x32_bf16 v[100:103], a[204:207], v[132:135], v[100:103]
    ds_read_b64_tr_b16 a[212:213], v60 offset:12288
    v_mfma_f32_16x16x32_bf16 v[108:111], a[200:203], v[144:147], 0
    buffer_load_dwordx4 a[28:31], v51, s[8:11], s17 offen offset:3584
    ds_read_b64_tr_b16 a[214:215], v60 offset:14336
    v_mfma_f32_16x16x32_bf16 v[108:111], a[204:207], v[148:151], v[108:111]
    s_waitcnt lgkmcnt(2)
    s_add_u32 s17, s17, 7168
    ds_read_b64_tr_b16 a[216:217], v61 offset:8192
    v_mfma_f32_16x16x32_bf16 v[96:99], a[208:211], v[136:139], v[96:99]
    s_waitcnt lgkmcnt(1)
    ds_read_b64_tr_b16 a[218:219], v61 offset:10240
    v_mfma_f32_16x16x32_bf16 v[96:99], a[212:215], v[140:143], v[96:99]
    ds_read_b64_tr_b16 a[220:221], v61 offset:12288
    v_mfma_f32_16x16x32_bf16 v[104:107], a[208:211], v[152:155], v[104:107]
    buffer_load_dwordx4 a[32:35], v51, s[8:11], s17 offen offset:0
    ds_read_b64_tr_b16 a[222:223], v61 offset:14336
    v_mfma_f32_16x16x32_bf16 v[104:107], a[212:215], v[156:159], v[104:107]
    s_waitcnt lgkmcnt(2)
    ds_read_b64_tr_b16 a[224:225], v60 offset:16384
    v_mfma_f32_16x16x32_bf16 v[100:103], a[216:219], v[136:139], v[100:103]
    s_waitcnt lgkmcnt(1)
    ds_read_b64_tr_b16 a[226:227], v60 offset:18432
    v_mfma_f32_16x16x32_bf16 v[100:103], a[220:223], v[140:143], v[100:103]
    ds_read_b64_tr_b16 a[228:229], v60 offset:20480
    v_mfma_f32_16x16x32_bf16 v[108:111], a[216:219], v[152:155], v[108:111]
    buffer_load_dwordx4 a[36:39], v51, s[8:11], s17 offen offset:3584
    ds_read_b64_tr_b16 a[230:231], v60 offset:22528
    v_mfma_f32_16x16x32_bf16 v[108:111], a[220:223], v[156:159], v[108:111]
    s_waitcnt lgkmcnt(2)
    s_add_u32 s17, s17, 7168
    ds_read_b64_tr_b16 a[232:233], v61 offset:16384
    v_mfma_f32_16x16x32_bf16 v[96:99], a[224:227], v[160:163], v[96:99]
    s_waitcnt lgkmcnt(1)
    ds_read_b64_tr_b16 a[234:235], v61 offset:18432
    v_mfma_f32_16x16x32_bf16 v[96:99], a[228:231], v[164:167], v[96:99]
    ds_read_b64_tr_b16 a[236:237], v61 offset:20480
    v_mfma_f32_16x16x32_bf16 v[104:107], a[224:227], v[176:179], v[104:107]
    buffer_load_dwordx4 a[40:43], v51, s[8:11], s17 offen offset:0
    ds_read_b64_tr_b16 a[238:239], v61 offset:22528
    v_mfma_f32_16x16x32_bf16 v[104:107], a[228:231], v[180:183], v[104:107]
    s_waitcnt lgkmcnt(2)
    ds_read_b64_tr_b16 a[240:241], v60 offset:24576
    v_mfma_f32_16x16x32_bf16 v[100:103], a[232:235], v[160:163], v[100:103]
    s_waitcnt lgkmcnt(1)
    ds_read_b64_tr_b16 a[242:243], v60 offset:26624
    v_mfma_f32_16x16x32_bf16 v[100:103], a[236:239], v[164:167], v[100:103]
    ds_read_b64_tr_b16 a[244:245], v60 offset:28672
    v_mfma_f32_16x16x32_bf16 v[108:111], a[232:235], v[176:179], v[108:111]
    buffer_load_dwordx4 a[44:47], v51, s[8:11], s17 offen offset:3584
    ds_read_b64_tr_b16 a[246:247], v60 offset:30720
    v_mfma_f32_16x16x32_bf16 v[108:111], a[236:239], v[180:183], v[108:111]
    s_waitcnt lgkmcnt(2)
    ds_read_b64_tr_b16 a[248:249], v61 offset:24576
    v_mfma_f32_16x16x32_bf16 v[96:99], a[240:243], v[168:171], v[96:99]
    s_waitcnt lgkmcnt(1)
    ds_read_b64_tr_b16 a[250:251], v61 offset:26624
    v_mfma_f32_16x16x32_bf16 v[96:99], a[244:247], v[172:175], v[96:99]
    ds_read_b64_tr_b16 a[252:253], v61 offset:28672
    v_mfma_f32_16x16x32_bf16 v[104:107], a[240:243], v[184:187], v[104:107]
    ds_read_b64_tr_b16 a[254:255], v61 offset:30720
    v_mfma_f32_16x16x32_bf16 v[104:107], a[244:247], v[188:191], v[104:107]
    s_waitcnt lgkmcnt(2)
    ds_read_b64_tr_b16 a[192:193], v62 offset:0
    v_mfma_f32_16x16x32_bf16 v[100:103], a[248:251], v[168:171], v[100:103]
    s_waitcnt lgkmcnt(1)
    ds_read_b64_tr_b16 a[194:195], v62 offset:2048
    v_mfma_f32_16x16x32_bf16 v[100:103], a[252:255], v[172:175], v[100:103]
    ds_read_b64_tr_b16 a[196:197], v62 offset:4096
    v_mfma_f32_16x16x32_bf16 v[108:111], a[248:251], v[184:187], v[108:111]
    ds_read_b64_tr_b16 a[198:199], v62 offset:6144
    v_mfma_f32_16x16x32_bf16 v[108:111], a[252:255], v[188:191], v[108:111]
    s_waitcnt lgkmcnt(2)
    ds_read_b64_tr_b16 a[200:201], v63 offset:0
    v_mfma_f32_16x16x32_bf16 v[112:115], a[192:195], v[128:131], 0
    s_waitcnt lgkmcnt(1)
    ds_read_b64_tr_b16 a[202:203], v63 offset:2048
    v_mfma_f32_16x16x32_bf16 v[112:115], a[196:199], v[132:135], v[112:115]
    ds_read_b64_tr_b16 a[204:205], v63 offset:4096
    v_mfma_f32_16x16x32_bf16 v[120:123], a[192:195], v[144:147], 0
    ds_read_b64_tr_b16 a[206:207], v63 offset:6144
    v_mfma_f32_16x16x32_bf16 v[120:123], a[196:199], v[148:151], v[120:123]
    s_waitcnt lgkmcnt(2)
    ds_read_b64_tr_b16 a[208:209], v62 offset:8192
    v_mfma_f32_16x16x32_bf16 v[116:119], a[200:203], v[128:131], 0
    s_waitcnt lgkmcnt(1)
    ds_read_b64_tr_b16 a[210:211], v62 offset:10240
    v_mfma_f32_16x16x32_bf16 v[116:119], a[204:207], v[132:135], v[116:119]
    ds_read_b64_tr_b16 a[212:213], v62 offset:12288
    v_mfma_f32_16x16x32_bf16 v[124:127], a[200:203], v[144:147], 0
    ds_read_b64_tr_b16 a[214:215], v62 offset:14336
    v_mfma_f32_16x16x32_bf16 v[124:127], a[204:207], v[148:151], v[124:127]
    s_waitcnt lgkmcnt(2)
    ds_read_b64_tr_b16 a[216:217], v63 offset:8192
    v_mfma_f32_16x16x32_bf16 v[112:115], a[208:211], v[136:139], v[112:115]
    s_waitcnt lgkmcnt(1)
    ds_read_b64_tr_b16 a[218:219], v63 offset:10240
    v_mfma_f32_16x16x32_bf16 v[112:115], a[212:215], v[140:143], v[112:115]
    ds_read_b64_tr_b16 a[220:221], v63 offset:12288
    v_mfma_f32_16x16x32_bf16 v[120:123], a[208:211], v[152:155], v[120:123]
    ds_read_b64_tr_b16 a[222:223], v63 offset:14336
    v_mfma_f32_16x16x32_bf16 v[120:123], a[212:215], v[156:159], v[120:123]
    s_waitcnt lgkmcnt(2)
    ds_read_b64_tr_b16 a[224:225], v62 offset:16384
    v_mfma_f32_16x16x32_bf16 v[116:119], a[216:219], v[136:139], v[116:119]
    s_waitcnt lgkmcnt(1)
    ds_read_b64_tr_b16 a[226:227], v62 offset:18432
    v_mfma_f32_16x16x32_bf16 v[116:119], a[220:223], v[140:143], v[116:119]
    ds_read_b64_tr_b16 a[228:229], v62 offset:20480
    v_mfma_f32_16x16x32_bf16 v[124:127], a[216:219], v[152:155], v[124:127]
    ds_read_b64_tr_b16 a[230:231], v62 offset:22528
    v_mfma_f32_16x16x32_bf16 v[124:127], a[220:223], v[156:159], v[124:127]
    s_waitcnt lgkmcnt(2)
    ds_read_b64_tr_b16 a[232:233], v63 offset:16384
    v_mfma_f32_16x16x32_bf16 v[112:115], a[224:227], v[160:163], v[112:115]
    s_waitcnt lgkmcnt(1)
    ds_read_b64_tr_b16 a[234:235], v63 offset:18432
    ds_read_b64_tr_b16 a[208:209], v56 offset:8192
    v_mfma_f32_16x16x32_bf16 v[112:115], a[228:231], v[164:167], v[112:115]
    ds_read_b64_tr_b16 a[236:237], v63 offset:20480
    ds_read_b64_tr_b16 a[210:211], v56 offset:10240
    v_mfma_f32_16x16x32_bf16 v[120:123], a[224:227], v[176:179], v[120:123]
    ds_read_b64_tr_b16 a[238:239], v63 offset:22528
    ds_read_b64_tr_b16 a[212:213], v56 offset:12288
    v_mfma_f32_16x16x32_bf16 v[120:123], a[228:231], v[180:183], v[120:123]
    s_waitcnt lgkmcnt(5)
    ds_read_b64_tr_b16 a[240:241], v62 offset:24576
    ds_read_b64_tr_b16 a[214:215], v56 offset:14336
    v_mfma_f32_16x16x32_bf16 v[116:119], a[232:235], v[160:163], v[116:119]
    s_waitcnt lgkmcnt(3)
    ds_read_b64_tr_b16 a[242:243], v62 offset:26624
    ds_read_b64_tr_b16 a[216:217], v57 offset:8192
    v_mfma_f32_16x16x32_bf16 v[116:119], a[236:239], v[164:167], v[116:119]
    ds_read_b64_tr_b16 a[244:245], v62 offset:28672
    ds_read_b64_tr_b16 a[218:219], v57 offset:10240
    v_mfma_f32_16x16x32_bf16 v[124:127], a[232:235], v[176:179], v[124:127]
    ds_read_b64_tr_b16 a[246:247], v62 offset:30720
    ds_read_b64_tr_b16 a[220:221], v57 offset:12288
    v_mfma_f32_16x16x32_bf16 v[124:127], a[236:239], v[180:183], v[124:127]
    s_waitcnt lgkmcnt(5)
    ds_read_b64_tr_b16 a[248:249], v63 offset:24576
    ds_read_b64_tr_b16 a[222:223], v57 offset:14336
    v_mfma_f32_16x16x32_bf16 v[112:115], a[240:243], v[168:171], v[112:115]
    s_waitcnt lgkmcnt(3)
    ds_read_b64_tr_b16 a[250:251], v63 offset:26624
    v_mfma_f32_16x16x32_bf16 v[112:115], a[244:247], v[172:175], v[112:115]
    ds_read_b64_tr_b16 a[252:253], v63 offset:28672
    v_mfma_f32_16x16x32_bf16 v[120:123], a[240:243], v[184:187], v[120:123]
    ds_read_b64_tr_b16 a[254:255], v63 offset:30720
    v_mfma_f32_16x16x32_bf16 v[120:123], a[244:247], v[188:191], v[120:123]
    s_waitcnt lgkmcnt(2)
    ds_read_b64_tr_b16 a[192:193], v56 offset:0
    v_mfma_f32_16x16x32_bf16 v[116:119], a[248:251], v[168:171], v[116:119]
    s_waitcnt lgkmcnt(1)
    ds_read_b64_tr_b16 a[194:195], v56 offset:2048
    v_mfma_f32_16x16x32_bf16 v[116:119], a[252:255], v[172:175], v[116:119]
    ds_read_b64_tr_b16 a[196:197], v56 offset:4096
    v_mfma_f32_16x16x32_bf16 v[124:127], a[248:251], v[184:187], v[124:127]
    ds_read_b64_tr_b16 a[198:199], v56 offset:6144
    v_mfma_f32_16x16x32_bf16 v[124:127], a[252:255], v[188:191], v[124:127]
    s_waitcnt vmcnt(26) lgkmcnt(2)
    ds_read_b64_tr_b16 a[200:201], v57 offset:0
    v_mfma_f32_16x16x32_bf16 v[64:67], a[192:195], v[192:195], v[64:67]
    s_waitcnt vmcnt(24) lgkmcnt(1)
    ds_read_b64_tr_b16 a[202:203], v57 offset:2048
    v_mfma_f32_16x16x32_bf16 v[64:67], a[196:199], v[196:199], v[64:67]
    ds_read_b64_tr_b16 a[204:205], v57 offset:4096
    v_mfma_f32_16x16x32_bf16 v[72:75], a[192:195], v[208:211], v[72:75]
    s_waitcnt vmcnt(22) lgkmcnt(1)
    s_mov_b32 s74, 4096
    ds_read_b64_tr_b16 a[206:207], v57 offset:6144
    v_mfma_f32_16x16x32_bf16 v[72:75], a[196:199], v[212:215], v[72:75]
    buffer_load_dwordx4 v[160:163], v46, s[8:11], s74 offen
    v_mfma_f32_16x16x32_bf16 v[68:71], a[200:203], v[192:195], v[68:71]
    s_waitcnt lgkmcnt(0)
    ds_read_b64_tr_b16 a[224:225], v56 offset:16384
    v_mfma_f32_16x16x32_bf16 v[68:71], a[204:207], v[196:199], v[68:71]
    ds_read_b64_tr_b16 a[226:227], v56 offset:18432
    v_mfma_f32_16x16x32_bf16 v[76:79], a[200:203], v[208:211], v[76:79]
    buffer_load_dwordx4 v[164:167], v46, s[8:11], s74 offen offset:64
    v_mfma_f32_16x16x32_bf16 v[76:79], a[204:207], v[212:215], v[76:79]
    s_waitcnt vmcnt(23)
    s_mov_b32 s74, 8192
    ds_read_b64_tr_b16 a[228:229], v56 offset:20480
    v_mfma_f32_16x16x32_bf16 v[64:67], a[208:211], v[200:203], v[64:67]
    s_waitcnt vmcnt(21)
    ds_read_b64_tr_b16 a[230:231], v56 offset:22528
    v_mfma_f32_16x16x32_bf16 v[64:67], a[212:215], v[204:207], v[64:67]
    buffer_load_dwordx4 v[168:171], v46, s[8:11], s74 offen
    v_mfma_f32_16x16x32_bf16 v[72:75], a[208:211], v[216:219], v[72:75]
    s_waitcnt vmcnt(21)
    ds_read_b64_tr_b16 a[232:233], v57 offset:16384
    v_mfma_f32_16x16x32_bf16 v[72:75], a[212:215], v[220:223], v[72:75]
    ds_read_b64_tr_b16 a[234:235], v57 offset:18432
    v_mfma_f32_16x16x32_bf16 v[68:71], a[216:219], v[200:203], v[68:71]
    buffer_load_dwordx4 v[172:175], v46, s[8:11], s74 offen offset:64
    ds_read_b64_tr_b16 a[236:237], v57 offset:20480
    v_mfma_f32_16x16x32_bf16 v[68:71], a[220:223], v[204:207], v[68:71]
    s_mov_b32 s74, 6144
    ds_read_b64_tr_b16 a[238:239], v57 offset:22528
    v_mfma_f32_16x16x32_bf16 v[76:79], a[216:219], v[216:219], v[76:79]
    s_waitcnt vmcnt(20) lgkmcnt(6)
    ds_read_b64_tr_b16 a[240:241], v56 offset:24576
    v_mfma_f32_16x16x32_bf16 v[76:79], a[220:223], v[220:223], v[76:79]
    buffer_load_dwordx4 v[176:179], v46, s[8:11], s74 offen
    v_mfma_f32_16x16x32_bf16 v[64:67], a[224:227], v[224:227], v[64:67]
    s_waitcnt vmcnt(19) lgkmcnt(5)
    ds_read_b64_tr_b16 a[242:243], v56 offset:26624
    v_mfma_f32_16x16x32_bf16 v[64:67], a[228:231], v[228:231], v[64:67]
    s_waitcnt vmcnt(17)
    ds_read_b64_tr_b16 a[244:245], v56 offset:28672
    v_mfma_f32_16x16x32_bf16 v[72:75], a[224:227], v[240:243], v[72:75]
    buffer_load_dwordx4 v[180:183], v46, s[8:11], s74 offen offset:64
    v_mfma_f32_16x16x32_bf16 v[72:75], a[228:231], v[244:247], v[72:75]
    s_waitcnt lgkmcnt(5)
    s_mov_b32 s74, 10240
    ds_read_b64_tr_b16 a[246:247], v56 offset:30720
    v_mfma_f32_16x16x32_bf16 v[68:71], a[232:235], v[224:227], v[68:71]
    s_waitcnt lgkmcnt(4)
    ds_read_b64_tr_b16 a[248:249], v57 offset:24576
    v_mfma_f32_16x16x32_bf16 v[68:71], a[236:239], v[228:231], v[68:71]
    buffer_load_dwordx4 v[184:187], v46, s[8:11], s74 offen
    ds_read_b64_tr_b16 a[250:251], v57 offset:26624
    v_mfma_f32_16x16x32_bf16 v[76:79], a[232:235], v[240:243], v[76:79]
    ds_read_b64_tr_b16 a[252:253], v57 offset:28672
    v_mfma_f32_16x16x32_bf16 v[76:79], a[236:239], v[244:247], v[76:79]
    s_waitcnt vmcnt(16) lgkmcnt(3)
    ds_read_b64_tr_b16 a[254:255], v57 offset:30720
    v_mfma_f32_16x16x32_bf16 v[64:67], a[240:243], v[232:235], v[64:67]
    buffer_load_dwordx4 v[188:191], v46, s[8:11], s74 offen offset:64
    v_mfma_f32_16x16x32_bf16 v[64:67], a[244:247], v[236:239], v[64:67]
    ds_read_b64_tr_b16 a[192:193], v58 offset:0
    v_mfma_f32_16x16x32_bf16 v[72:75], a[240:243], v[248:251], v[72:75]
    s_waitcnt vmcnt(16)
    ds_read_b64_tr_b16 a[194:195], v58 offset:2048
    v_mfma_f32_16x16x32_bf16 v[72:75], a[244:247], v[252:255], v[72:75]
    s_waitcnt lgkmcnt(4)
    ds_read_b64_tr_b16 a[196:197], v58 offset:4096
    v_mfma_f32_16x16x32_bf16 v[68:71], a[248:251], v[232:235], v[68:71]
    s_waitcnt lgkmcnt(3)
    ds_read_b64_tr_b16 a[198:199], v58 offset:6144
    v_mfma_f32_16x16x32_bf16 v[68:71], a[252:255], v[236:239], v[68:71]
    ds_read_b64_tr_b16 a[200:201], v59 offset:0
    v_mfma_f32_16x16x32_bf16 v[76:79], a[248:251], v[248:251], v[76:79]
    ds_read_b64_tr_b16 a[202:203], v59 offset:2048
    v_mfma_f32_16x16x32_bf16 v[76:79], a[252:255], v[252:255], v[76:79]
    s_waitcnt lgkmcnt(4)
    ds_read_b64_tr_b16 a[204:205], v59 offset:4096
    v_mfma_f32_16x16x32_bf16 v[80:83], a[192:195], v[192:195], v[80:83]
    s_waitcnt lgkmcnt(3)
    ds_read_b64_tr_b16 a[206:207], v59 offset:6144
    v_mfma_f32_16x16x32_bf16 v[80:83], a[196:199], v[196:199], v[80:83]
    ds_read_b64_tr_b16 a[208:209], v58 offset:8192
    v_mfma_f32_16x16x32_bf16 v[88:91], a[192:195], v[208:211], v[88:91]
    ds_read_b64_tr_b16 a[210:211], v58 offset:10240
    v_mfma_f32_16x16x32_bf16 v[88:91], a[196:199], v[212:215], v[88:91]
    s_waitcnt lgkmcnt(4)
    ds_read_b64_tr_b16 a[212:213], v58 offset:12288
    v_mfma_f32_16x16x32_bf16 v[84:87], a[200:203], v[192:195], v[84:87]
    s_waitcnt lgkmcnt(3)
    s_add_u32 s74, s70, 0
    ds_read_b64_tr_b16 a[214:215], v58 offset:14336
    v_mfma_f32_16x16x32_bf16 v[84:87], a[204:207], v[196:199], v[84:87]
    buffer_load_dwordx4 v[128:131], v44, s[8:11], s74 offen sc0 sc1
    ds_read_b64_tr_b16 a[216:217], v59 offset:8192
    v_mfma_f32_16x16x32_bf16 v[92:95], a[200:203], v[208:211], v[92:95]
    s_add_u32 s74, s70, 4096
    ds_read_b64_tr_b16 a[218:219], v59 offset:10240
    v_cvt_pk_bf16_f32 v64, v64, v65
    v_mfma_f32_16x16x32_bf16 v[92:95], a[204:207], v[212:215], v[92:95]
    s_waitcnt lgkmcnt(4)
    ds_read_b64_tr_b16 a[220:221], v59 offset:12288
    v_cvt_pk_bf16_f32 v65, v66, v67
    v_mfma_f32_16x16x32_bf16 v[80:83], a[208:211], v[200:203], v[80:83]
    s_waitcnt lgkmcnt(3)
    ds_read_b64_tr_b16 a[222:223], v59 offset:14336
    v_cvt_pk_bf16_f32 v66, v68, v69
    v_mfma_f32_16x16x32_bf16 v[80:83], a[212:215], v[204:207], v[80:83]
    buffer_load_dwordx4 v[132:135], v44, s[8:11], s74 offen sc0 sc1
    v_mfma_f32_16x16x32_bf16 v[88:91], a[208:211], v[216:219], v[88:91]
    s_add_u32 s74, s70, 8192
    ds_read_b64_tr_b16 a[224:225], v58 offset:16384
    v_cvt_pk_bf16_f32 v67, v70, v71
    v_mfma_f32_16x16x32_bf16 v[88:91], a[212:215], v[220:223], v[88:91]
    s_waitcnt lgkmcnt(3)
    ds_read_b64_tr_b16 a[226:227], v58 offset:18432
    v_min_u32 v64, -2, v64
    v_mfma_f32_16x16x32_bf16 v[84:87], a[216:219], v[200:203], v[84:87]
    s_waitcnt lgkmcnt(2)
    ds_read_b64_tr_b16 a[228:229], v58 offset:20480
    v_min_u32 v65, -2, v65
    v_mfma_f32_16x16x32_bf16 v[84:87], a[220:223], v[204:207], v[84:87]
    buffer_load_dwordx4 v[136:139], v44, s[8:11], s74 offen sc0 sc1
    ds_read_b64_tr_b16 a[230:231], v58 offset:22528
    v_mfma_f32_16x16x32_bf16 v[92:95], a[216:219], v[216:219], v[92:95]
    s_add_u32 s74, s70, 12288
    ds_read_b64_tr_b16 a[232:233], v59 offset:16384
    v_min_u32 v66, -2, v66
    v_mfma_f32_16x16x32_bf16 v[92:95], a[220:223], v[220:223], v[92:95]
    s_waitcnt lgkmcnt(3)
    ds_read_b64_tr_b16 a[234:235], v59 offset:18432
    v_min_u32 v67, -2, v67
    v_mfma_f32_16x16x32_bf16 v[80:83], a[224:227], v[224:227], v[80:83]
    s_waitcnt lgkmcnt(2)
    s_add_u32 s75, s18, 8388608
    ds_read_b64_tr_b16 a[236:237], v59 offset:20480
    v_mfma_f32_16x16x32_bf16 v[80:83], a[228:231], v[228:231], v[80:83]
    buffer_load_dwordx4 v[140:143], v44, s[8:11], s74 offen sc0 sc1
    ds_read_b64_tr_b16 a[238:239], v59 offset:22528
    v_mfma_f32_16x16x32_bf16 v[88:91], a[224:227], v[240:243], v[88:91]
    s_waitcnt lgkmcnt(2)
    s_add_u32 s74, s70, 16384
    ds_read_b64_tr_b16 a[240:241], v58 offset:24576
    v_mfma_f32_16x16x32_bf16 v[88:91], a[228:231], v[244:247], v[88:91]
    buffer_store_dwordx4 v[64:67], v23, s[8:11], s75 offen offset:0 sc0 sc1
    ds_read_b64_tr_b16 a[242:243], v58 offset:26624
    v_mfma_f32_16x16x32_bf16 v[84:87], a[232:235], v[224:227], v[84:87]
    s_waitcnt lgkmcnt(2)
    ds_read_b64_tr_b16 a[244:245], v58 offset:28672
    v_cvt_pk_bf16_f32 v72, v72, v73
    v_mfma_f32_16x16x32_bf16 v[84:87], a[236:239], v[228:231], v[84:87]
    buffer_load_dwordx4 v[144:147], v44, s[8:11], s74 offen sc0 sc1
    ds_read_b64_tr_b16 a[246:247], v58 offset:30720
    v_mfma_f32_16x16x32_bf16 v[92:95], a[232:235], v[240:243], v[92:95]
    s_add_u32 s74, s70, 20480
    ds_read_b64_tr_b16 a[248:249], v59 offset:24576
    v_cvt_pk_bf16_f32 v73, v74, v75
    v_mfma_f32_16x16x32_bf16 v[92:95], a[236:239], v[244:247], v[92:95]
    s_waitcnt lgkmcnt(3)
    ds_read_b64_tr_b16 a[250:251], v59 offset:26624
    v_cvt_pk_bf16_f32 v74, v76, v77
    v_mfma_f32_16x16x32_bf16 v[80:83], a[240:243], v[232:235], v[80:83]
    s_waitcnt lgkmcnt(2)
    ds_read_b64_tr_b16 a[252:253], v59 offset:28672
    v_cvt_pk_bf16_f32 v75, v78, v79
    v_mfma_f32_16x16x32_bf16 v[80:83], a[244:247], v[236:239], v[80:83]
    buffer_load_dwordx4 v[148:151], v44, s[8:11], s74 offen sc0 sc1
    ds_read_b64_tr_b16 a[254:255], v59 offset:30720
    v_mfma_f32_16x16x32_bf16 v[88:91], a[240:243], v[248:251], v[88:91]
    s_add_u32 s74, s70, 24576
    ds_read_b64_tr_b16 a[192:193], v60 offset:32768
    v_min_u32 v72, -2, v72
    v_mfma_f32_16x16x32_bf16 v[88:91], a[244:247], v[252:255], v[88:91]
    s_waitcnt lgkmcnt(3)
    ds_read_b64_tr_b16 a[194:195], v60 offset:34816
    v_min_u32 v73, -2, v73
    v_mfma_f32_16x16x32_bf16 v[84:87], a[248:251], v[232:235], v[84:87]
    s_waitcnt lgkmcnt(2)
    ds_read_b64_tr_b16 a[196:197], v60 offset:36864
    v_min_u32 v74, -2, v74
    v_mfma_f32_16x16x32_bf16 v[84:87], a[252:255], v[236:239], v[84:87]
    buffer_load_dwordx4 v[152:155], v44, s[8:11], s74 offen sc0 sc1
    ds_read_b64_tr_b16 a[198:199], v60 offset:38912
    v_mfma_f32_16x16x32_bf16 v[92:95], a[248:251], v[248:251], v[92:95]
    s_add_u32 s74, s70, 28672
    ds_read_b64_tr_b16 a[200:201], v61 offset:32768
    v_min_u32 v75, -2, v75
    v_mfma_f32_16x16x32_bf16 v[92:95], a[252:255], v[252:255], v[92:95]
    s_waitcnt lgkmcnt(1)
    s_add_u32 s75, s18, 8519680
    ds_read_b64_tr_b16 a[202:203], v61 offset:34816
    v_mfma_f32_16x16x32_bf16 v[96:99], a[192:195], v[192:195], v[96:99]
    buffer_store_dwordx4 v[72:75], v23, s[8:11], s75 offen offset:0 sc0 sc1
    ds_read_b64_tr_b16 a[204:205], v61 offset:36864
    v_mfma_f32_16x16x32_bf16 v[96:99], a[196:199], v[196:199], v[96:99]
    buffer_load_dwordx4 v[156:159], v44, s[8:11], s74 offen sc0 sc1
    ds_read_b64_tr_b16 a[206:207], v61 offset:38912
    v_mfma_f32_16x16x32_bf16 v[104:107], a[192:195], v[208:211], v[104:107]
    ds_read_b64_tr_b16 a[208:209], v60 offset:40960
    v_mfma_f32_16x16x32_bf16 v[104:107], a[196:199], v[212:215], v[104:107]
    s_waitcnt lgkmcnt(3)
    ds_read_b64_tr_b16 a[210:211], v60 offset:43008
    v_mfma_f32_16x16x32_bf16 v[100:103], a[200:203], v[192:195], v[100:103]
    s_waitcnt lgkmcnt(2)
    ds_read_b64_tr_b16 a[212:213], v60 offset:45056
    v_mfma_f32_16x16x32_bf16 v[100:103], a[204:207], v[196:199], v[100:103]
    ds_read_b64_tr_b16 a[214:215], v60 offset:47104
    v_mfma_f32_16x16x32_bf16 v[108:111], a[200:203], v[208:211], v[108:111]
    ds_read_b64_tr_b16 a[216:217], v61 offset:40960
    v_cvt_pk_bf16_f32 v80, v80, v81
    v_mfma_f32_16x16x32_bf16 v[108:111], a[204:207], v[212:215], v[108:111]
    s_waitcnt lgkmcnt(3)
    ds_read_b64_tr_b16 a[218:219], v61 offset:43008
    v_cvt_pk_bf16_f32 v81, v82, v83
    v_mfma_f32_16x16x32_bf16 v[96:99], a[208:211], v[200:203], v[96:99]
    s_waitcnt lgkmcnt(2)
    ds_read_b64_tr_b16 a[220:221], v61 offset:45056
    v_cvt_pk_bf16_f32 v82, v84, v85
    v_mfma_f32_16x16x32_bf16 v[96:99], a[212:215], v[204:207], v[96:99]
    ds_read_b64_tr_b16 a[222:223], v61 offset:47104
    v_cvt_pk_bf16_f32 v83, v86, v87
    v_mfma_f32_16x16x32_bf16 v[104:107], a[208:211], v[216:219], v[104:107]
    ds_read_b64_tr_b16 a[224:225], v60 offset:49152
    v_min_u32 v80, -2, v80
    v_mfma_f32_16x16x32_bf16 v[104:107], a[212:215], v[220:223], v[104:107]
    s_waitcnt lgkmcnt(3)
    ds_read_b64_tr_b16 a[226:227], v60 offset:51200
    v_min_u32 v81, -2, v81
    v_mfma_f32_16x16x32_bf16 v[100:103], a[216:219], v[200:203], v[100:103]
    s_waitcnt lgkmcnt(2)
    ds_read_b64_tr_b16 a[228:229], v60 offset:53248
    v_min_u32 v82, -2, v82
    v_mfma_f32_16x16x32_bf16 v[100:103], a[220:223], v[204:207], v[100:103]
    ds_read_b64_tr_b16 a[230:231], v60 offset:55296
    v_min_u32 v83, -2, v83
    v_mfma_f32_16x16x32_bf16 v[108:111], a[216:219], v[216:219], v[108:111]
    s_waitcnt lgkmcnt(2)
    s_add_u32 s75, s18, 8388608
    ds_read_b64_tr_b16 a[232:233], v61 offset:49152
    v_mfma_f32_16x16x32_bf16 v[108:111], a[220:223], v[220:223], v[108:111]
    buffer_store_dwordx4 v[80:83], v23, s[8:11], s75 offen offset:256 sc0 sc1
    ds_read_b64_tr_b16 a[234:235], v61 offset:51200
    v_mfma_f32_16x16x32_bf16 v[96:99], a[224:227], v[224:227], v[96:99]
    s_waitcnt lgkmcnt(2)
    ds_read_b64_tr_b16 a[236:237], v61 offset:53248
    v_cvt_pk_bf16_f32 v88, v88, v89
    v_mfma_f32_16x16x32_bf16 v[96:99], a[228:231], v[228:231], v[96:99]
    ds_read_b64_tr_b16 a[238:239], v61 offset:55296
    v_cvt_pk_bf16_f32 v89, v90, v91
    v_mfma_f32_16x16x32_bf16 v[104:107], a[224:227], v[240:243], v[104:107]
    ds_read_b64_tr_b16 a[240:241], v60 offset:57344
    v_cvt_pk_bf16_f32 v90, v92, v93
    v_mfma_f32_16x16x32_bf16 v[104:107], a[228:231], v[244:247], v[104:107]
    s_waitcnt lgkmcnt(3)
    ds_read_b64_tr_b16 a[242:243], v60 offset:59392
    v_cvt_pk_bf16_f32 v91, v94, v95
    v_mfma_f32_16x16x32_bf16 v[100:103], a[232:235], v[224:227], v[100:103]
    s_waitcnt lgkmcnt(2)
    ds_read_b64_tr_b16 a[244:245], v60 offset:61440
    v_min_u32 v88, -2, v88
    v_mfma_f32_16x16x32_bf16 v[100:103], a[236:239], v[228:231], v[100:103]
    ds_read_b64_tr_b16 a[246:247], v60 offset:63488
    v_min_u32 v89, -2, v89
    v_mfma_f32_16x16x32_bf16 v[108:111], a[232:235], v[240:243], v[108:111]
    ds_read_b64_tr_b16 a[248:249], v61 offset:57344
    v_min_u32 v90, -2, v90
    v_mfma_f32_16x16x32_bf16 v[108:111], a[236:239], v[244:247], v[108:111]
    s_waitcnt lgkmcnt(3)
    ds_read_b64_tr_b16 a[250:251], v61 offset:59392
    v_min_u32 v91, -2, v91
    v_mfma_f32_16x16x32_bf16 v[96:99], a[240:243], v[232:235], v[96:99]
    s_waitcnt lgkmcnt(2)
    s_add_u32 s75, s18, 8519680
    ds_read_b64_tr_b16 a[252:253], v61 offset:61440
    v_mfma_f32_16x16x32_bf16 v[96:99], a[244:247], v[236:239], v[96:99]
    buffer_store_dwordx4 v[88:91], v23, s[8:11], s75 offen offset:256 sc0 sc1
    ds_read_b64_tr_b16 a[254:255], v61 offset:63488
    v_mfma_f32_16x16x32_bf16 v[104:107], a[240:243], v[248:251], v[104:107]
    ds_read_b64_tr_b16 a[192:193], v62 offset:32768
    v_mfma_f32_16x16x32_bf16 v[104:107], a[244:247], v[252:255], v[104:107]
    s_waitcnt lgkmcnt(3)
    ds_read_b64_tr_b16 a[194:195], v62 offset:34816
    v_mfma_f32_16x16x32_bf16 v[100:103], a[248:251], v[232:235], v[100:103]
    s_waitcnt lgkmcnt(2)
    ds_read_b64_tr_b16 a[196:197], v62 offset:36864
    v_mfma_f32_16x16x32_bf16 v[100:103], a[252:255], v[236:239], v[100:103]
    ds_read_b64_tr_b16 a[198:199], v62 offset:38912
    v_mfma_f32_16x16x32_bf16 v[108:111], a[248:251], v[248:251], v[108:111]
    ds_read_b64_tr_b16 a[200:201], v63 offset:32768
    v_mfma_f32_16x16x32_bf16 v[108:111], a[252:255], v[252:255], v[108:111]
    s_waitcnt lgkmcnt(3)
    ds_read_b64_tr_b16 a[202:203], v63 offset:34816
    v_mfma_f32_16x16x32_bf16 v[112:115], a[192:195], v[192:195], v[112:115]
    s_waitcnt lgkmcnt(2)
    ds_read_b64_tr_b16 a[204:205], v63 offset:36864
    v_mfma_f32_16x16x32_bf16 v[112:115], a[196:199], v[196:199], v[112:115]
    ds_read_b64_tr_b16 a[206:207], v63 offset:38912
    v_mfma_f32_16x16x32_bf16 v[120:123], a[192:195], v[208:211], v[120:123]
    ds_read_b64_tr_b16 a[208:209], v62 offset:40960
    v_mfma_f32_16x16x32_bf16 v[120:123], a[196:199], v[212:215], v[120:123]
    s_waitcnt lgkmcnt(3)
    ds_read_b64_tr_b16 a[210:211], v62 offset:43008
    v_mfma_f32_16x16x32_bf16 v[116:119], a[200:203], v[192:195], v[116:119]
    s_waitcnt lgkmcnt(2)
    ds_read_b64_tr_b16 a[212:213], v62 offset:45056
    v_mfma_f32_16x16x32_bf16 v[116:119], a[204:207], v[196:199], v[116:119]
    ds_read_b64_tr_b16 a[214:215], v62 offset:47104
    v_mfma_f32_16x16x32_bf16 v[124:127], a[200:203], v[208:211], v[124:127]
    ds_read_b64_tr_b16 a[216:217], v63 offset:40960
    v_cvt_pk_bf16_f32 v96, v96, v97
    v_mfma_f32_16x16x32_bf16 v[124:127], a[204:207], v[212:215], v[124:127]
    s_waitcnt lgkmcnt(3)
    ds_read_b64_tr_b16 a[218:219], v63 offset:43008
    v_cvt_pk_bf16_f32 v97, v98, v99
    v_mfma_f32_16x16x32_bf16 v[112:115], a[208:211], v[200:203], v[112:115]
    s_waitcnt lgkmcnt(2)
    ds_read_b64_tr_b16 a[220:221], v63 offset:45056
    v_cvt_pk_bf16_f32 v98, v100, v101
    v_mfma_f32_16x16x32_bf16 v[112:115], a[212:215], v[204:207], v[112:115]
    ds_read_b64_tr_b16 a[222:223], v63 offset:47104
    v_cvt_pk_bf16_f32 v99, v102, v103
    v_mfma_f32_16x16x32_bf16 v[120:123], a[208:211], v[216:219], v[120:123]
    ds_read_b64_tr_b16 a[224:225], v62 offset:49152
    v_min_u32 v96, -2, v96
    v_mfma_f32_16x16x32_bf16 v[120:123], a[212:215], v[220:223], v[120:123]
    s_waitcnt lgkmcnt(3)
    ds_read_b64_tr_b16 a[226:227], v62 offset:51200
    v_min_u32 v97, -2, v97
    v_mfma_f32_16x16x32_bf16 v[116:119], a[216:219], v[200:203], v[116:119]
    s_waitcnt lgkmcnt(2)
    ds_read_b64_tr_b16 a[228:229], v62 offset:53248
    v_min_u32 v98, -2, v98
    v_mfma_f32_16x16x32_bf16 v[116:119], a[220:223], v[204:207], v[116:119]
    ds_read_b64_tr_b16 a[230:231], v62 offset:55296
    v_min_u32 v99, -2, v99
    v_mfma_f32_16x16x32_bf16 v[124:127], a[216:219], v[216:219], v[124:127]
    s_waitcnt lgkmcnt(2)
    s_add_u32 s75, s18, 8388608
    ds_read_b64_tr_b16 a[232:233], v63 offset:49152
    v_mfma_f32_16x16x32_bf16 v[124:127], a[220:223], v[220:223], v[124:127]
    buffer_store_dwordx4 v[96:99], v23, s[8:11], s75 offen offset:512 sc0 sc1
    ds_read_b64_tr_b16 a[234:235], v63 offset:51200
    v_mfma_f32_16x16x32_bf16 v[112:115], a[224:227], v[224:227], v[112:115]
    s_waitcnt lgkmcnt(2)
    ds_read_b64_tr_b16 a[236:237], v63 offset:53248
    v_cvt_pk_bf16_f32 v104, v104, v105
    v_mfma_f32_16x16x32_bf16 v[112:115], a[228:231], v[228:231], v[112:115]
    ds_read_b64_tr_b16 a[238:239], v63 offset:55296
    v_cvt_pk_bf16_f32 v105, v106, v107
    v_mfma_f32_16x16x32_bf16 v[120:123], a[224:227], v[240:243], v[120:123]
    ds_read_b64_tr_b16 a[240:241], v62 offset:57344
    v_cvt_pk_bf16_f32 v106, v108, v109
    v_mfma_f32_16x16x32_bf16 v[120:123], a[228:231], v[244:247], v[120:123]
    s_waitcnt lgkmcnt(3)
    ds_read_b64_tr_b16 a[242:243], v62 offset:59392
    v_cvt_pk_bf16_f32 v107, v110, v111
    v_mfma_f32_16x16x32_bf16 v[116:119], a[232:235], v[224:227], v[116:119]
    s_waitcnt lgkmcnt(2)
    ds_read_b64_tr_b16 a[244:245], v62 offset:61440
    v_min_u32 v104, -2, v104
    v_mfma_f32_16x16x32_bf16 v[116:119], a[236:239], v[228:231], v[116:119]
    ds_read_b64_tr_b16 a[246:247], v62 offset:63488
    v_min_u32 v105, -2, v105
    v_mfma_f32_16x16x32_bf16 v[124:127], a[232:235], v[240:243], v[124:127]
    ds_read_b64_tr_b16 a[248:249], v63 offset:57344
    v_min_u32 v106, -2, v106
    v_mfma_f32_16x16x32_bf16 v[124:127], a[236:239], v[244:247], v[124:127]
    s_waitcnt lgkmcnt(3)
    ds_read_b64_tr_b16 a[250:251], v63 offset:59392
    v_min_u32 v107, -2, v107
    v_mfma_f32_16x16x32_bf16 v[112:115], a[240:243], v[232:235], v[112:115]
    s_waitcnt lgkmcnt(2)
    s_add_u32 s75, s18, 8519680
    ds_read_b64_tr_b16 a[252:253], v63 offset:61440
    v_mfma_f32_16x16x32_bf16 v[112:115], a[244:247], v[236:239], v[112:115]
    buffer_store_dwordx4 v[104:107], v23, s[8:11], s75 offen offset:512 sc0 sc1
    ds_read_b64_tr_b16 a[254:255], v63 offset:63488
    v_mfma_f32_16x16x32_bf16 v[120:123], a[240:243], v[248:251], v[120:123]
    v_mfma_f32_16x16x32_bf16 v[120:123], a[244:247], v[252:255], v[120:123]
    s_waitcnt lgkmcnt(2)
    v_mfma_f32_16x16x32_bf16 v[116:119], a[248:251], v[232:235], v[116:119]
    s_waitcnt lgkmcnt(0)
    v_mfma_f32_16x16x32_bf16 v[116:119], a[252:255], v[236:239], v[116:119]
    v_mfma_f32_16x16x32_bf16 v[124:127], a[248:251], v[248:251], v[124:127]
    v_mfma_f32_16x16x32_bf16 v[124:127], a[252:255], v[252:255], v[124:127]
    v_cvt_pk_bf16_f32 v112, v112, v113
    v_cvt_pk_bf16_f32 v113, v114, v115
    s_nop 3
    v_cvt_pk_bf16_f32 v114, v116, v117
    v_cvt_pk_bf16_f32 v115, v118, v119
    v_min_u32 v112, -2, v112
    v_min_u32 v113, -2, v113
    v_min_u32 v114, -2, v114
    v_min_u32 v115, -2, v115
    s_add_u32 s75, s18, 8388608
    buffer_store_dwordx4 v[112:115], v23, s[8:11], s75 offen offset:768 sc0 sc1
    v_cvt_pk_bf16_f32 v120, v120, v121
    v_cvt_pk_bf16_f32 v121, v122, v123
    v_cvt_pk_bf16_f32 v122, v124, v125
    v_cvt_pk_bf16_f32 v123, v126, v127
    v_min_u32 v120, -2, v120
    v_min_u32 v121, -2, v121
    v_min_u32 v122, -2, v122
    v_min_u32 v123, -2, v123
    s_add_u32 s75, s18, 8519680
    buffer_store_dwordx4 v[120:123], v23, s[8:11], s75 offen offset:768 sc0 sc1
    s_add_u32 s74, s70, 8388608
    buffer_load_dwordx4 v[192:195], v44, s[8:11], s74 offen sc0 sc1
    s_add_u32 s74, s70, 8392704
    buffer_load_dwordx4 v[196:199], v44, s[8:11], s74 offen sc0 sc1
    s_add_u32 s74, s70, 8396800
    buffer_load_dwordx4 v[200:203], v44, s[8:11], s74 offen sc0 sc1
    s_add_u32 s74, s70, 8400896
    buffer_load_dwordx4 v[204:207], v44, s[8:11], s74 offen sc0 sc1
    s_add_u32 s74, s70, 8404992
    buffer_load_dwordx4 v[208:211], v44, s[8:11], s74 offen sc0 sc1
    s_add_u32 s74, s70, 8409088
    buffer_load_dwordx4 v[212:215], v44, s[8:11], s74 offen sc0 sc1
    s_add_u32 s74, s70, 8413184
    buffer_load_dwordx4 v[216:219], v44, s[8:11], s74 offen sc0 sc1
    s_add_u32 s74, s70, 8417280
    buffer_load_dwordx4 v[220:223], v44, s[8:11], s74 offen sc0 sc1
    v_lshlrev_b32 v48, 16, v40
    v_and_b32 v49, 0xffff0000, v40
    v_lshlrev_b32 v50, 16, v41
    v_and_b32 v51, 0xffff0000, v41
    v_lshlrev_b32 v52, 16, v42
    v_and_b32 v53, 0xffff0000, v42
    v_lshlrev_b32 v54, 16, v43
    v_and_b32 v55, 0xffff0000, v43
    s_waitcnt vmcnt(29)
    v_pk_mul_f32 v[8:9], v[48:49], v[168:169]
    v_pk_mul_f32 v[10:11], v[50:51], v[170:171]
    s_waitcnt vmcnt(28)
    v_pk_mul_f32 v[12:13], v[52:53], v[172:173]
    v_pk_mul_f32 v[14:15], v[54:55], v[174:175]
    s_waitcnt vmcnt(27)
    v_mul_f32 v16, v48, v176
    v_fmac_f32 v16, v49, v177
    v_fmac_f32 v16, v50, v178
    v_fmac_f32 v16, v51, v179
    s_waitcnt vmcnt(26)
    v_fmac_f32 v16, v52, v180
    v_fmac_f32 v16, v53, v181
    v_fmac_f32 v16, v54, v182
    v_fmac_f32 v16, v55, v183
    s_nop 1
    v_add_f32_dpp v16, v16, v16 quad_perm:[1,0,3,2] row_mask:0xf bank_mask:0xf
    s_nop 1
    v_add_f32_dpp v16, v16, v16 quad_perm:[2,3,0,1] row_mask:0xf bank_mask:0xf
    s_nop 1
    v_add_f32_dpp v16, v16, v16 row_half_mirror row_mask:0xf bank_mask:0xf
    s_nop 1
    v_add_f32_dpp v16, v16, v16 row_mirror row_mask:0xf bank_mask:0xf
    v_mov_b32 v19, v16
    s_nop 1
    v_permlane16_swap_b32 v16, v19
    v_add_f32 v16, v16, v19
    v_mov_b32 v19, v16
    s_nop 1
    v_permlane32_swap_b32 v16, v19
    v_add_f32 v16, v16, v19
    s_waitcnt vmcnt(23)
    v_max_u32 v3, v128, v129
    v_max3_u32 v3, v3, v130, v131
    s_waitcnt vmcnt(22)
    v_max3_u32 v3, v3, v132, v133
    v_max3_u32 v3, v3, v134, v135
    s_waitcnt vmcnt(21)
    v_max3_u32 v3, v3, v136, v137
    v_max3_u32 v3, v3, v138, v139
    s_waitcnt vmcnt(20)
    v_max3_u32 v3, v3, v140, v141
    v_max3_u32 v3, v3, v142, v143
    s_waitcnt vmcnt(18)
    v_max3_u32 v3, v3, v144, v145
    v_max3_u32 v3, v3, v146, v147
    s_waitcnt vmcnt(17)
    v_max3_u32 v3, v3, v148, v149
    v_max3_u32 v3, v3, v150, v151
    s_waitcnt vmcnt(16)
    v_max3_u32 v3, v3, v152, v153
    v_max3_u32 v3, v3, v154, v155
    s_waitcnt vmcnt(14)
    v_max3_u32 v3, v3, v156, v157
    v_max3_u32 v3, v3, v158, v159
    v_cmp_eq_u32 vcc, -1, v3
    s_cbranch_vccnz L_P1_slow_15
L_P1_ok_16:
    v_lshlrev_b32 v64, 16, v128
    v_and_b32 v65, 0xffff0000, v128
    v_lshlrev_b32 v66, 16, v129
    v_and_b32 v67, 0xffff0000, v129
    v_lshlrev_b32 v68, 16, v130
    v_and_b32 v69, 0xffff0000, v130
    v_lshlrev_b32 v70, 16, v131
    v_and_b32 v71, 0xffff0000, v131
    v_lshlrev_b32 v48, 16, v132
    v_and_b32 v49, 0xffff0000, v132
    v_lshlrev_b32 v50, 16, v133
    v_and_b32 v51, 0xffff0000, v133
    v_lshlrev_b32 v52, 16, v134
    v_and_b32 v53, 0xffff0000, v134
    v_lshlrev_b32 v54, 16, v135
    v_and_b32 v55, 0xffff0000, v135
    v_pk_add_f32 v[64:65], v[64:65], v[48:49]
    v_pk_add_f32 v[66:67], v[66:67], v[50:51]
    v_pk_add_f32 v[68:69], v[68:69], v[52:53]
    v_pk_add_f32 v[70:71], v[70:71], v[54:55]
    v_lshlrev_b32 v48, 16, v136
    v_and_b32 v49, 0xffff0000, v136
    v_lshlrev_b32 v50, 16, v137
    v_and_b32 v51, 0xffff0000, v137
    v_lshlrev_b32 v52, 16, v138
    v_and_b32 v53, 0xffff0000, v138
    v_lshlrev_b32 v54, 16, v139
    v_and_b32 v55, 0xffff0000, v139
    v_pk_add_f32 v[64:65], v[64:65], v[48:49]
    v_pk_add_f32 v[66:67], v[66:67], v[50:51]
    v_pk_add_f32 v[68:69], v[68:69], v[52:53]
    v_pk_add_f32 v[70:71], v[70:71], v[54:55]
    v_lshlrev_b32 v48, 16, v140
    v_and_b32 v49, 0xffff0000, v140
    v_lshlrev_b32 v50, 16, v141
    v_and_b32 v51, 0xffff0000, v141
    v_lshlrev_b32 v52, 16, v142
    v_and_b32 v53, 0xffff0000, v142
    v_lshlrev_b32 v54, 16, v143
    v_and_b32 v55, 0xffff0000, v143
    v_pk_add_f32 v[64:65], v[64:65], v[48:49]
    v_pk_add_f32 v[66:67], v[66:67], v[50:51]
    v_pk_add_f32 v[68:69], v[68:69], v[52:53]
    v_pk_add_f32 v[70:71], v[70:71], v[54:55]
    v_lshlrev_b32 v48, 16, v144
    v_and_b32 v49, 0xffff0000, v144
    v_lshlrev_b32 v50, 16, v145
    v_and_b32 v51, 0xffff0000, v145
    v_lshlrev_b32 v52, 16, v146
    v_and_b32 v53, 0xffff0000, v146
    v_lshlrev_b32 v54, 16, v147
    v_and_b32 v55, 0xffff0000, v147
    v_pk_add_f32 v[64:65], v[64:65], v[48:49]
    v_pk_add_f32 v[66:67], v[66:67], v[50:51]
    v_pk_add_f32 v[68:69], v[68:69], v[52:53]
    v_pk_add_f32 v[70:71], v[70:71], v[54:55]
    v_lshlrev_b32 v48, 16, v148
    v_and_b32 v49, 0xffff0000, v148
    v_lshlrev_b32 v50, 16, v149
    v_and_b32 v51, 0xffff0000, v149
    v_lshlrev_b32 v52, 16, v150
    v_and_b32 v53, 0xffff0000, v150
    v_lshlrev_b32 v54, 16, v151
    v_and_b32 v55, 0xffff0000, v151
    v_pk_add_f32 v[64:65], v[64:65], v[48:49]
    v_pk_add_f32 v[66:67], v[66:67], v[50:51]
    v_pk_add_f32 v[68:69], v[68:69], v[52:53]
    v_pk_add_f32 v[70:71], v[70:71], v[54:55]
    v_lshlrev_b32 v48, 16, v152
    v_and_b32 v49, 0xffff0000, v152
    v_lshlrev_b32 v50, 16, v153
    v_and_b32 v51, 0xffff0000, v153
    v_lshlrev_b32 v52, 16, v154
    v_and_b32 v53, 0xffff0000, v154
    v_lshlrev_b32 v54, 16, v155
    v_and_b32 v55, 0xffff0000, v155
    v_pk_add_f32 v[64:65], v[64:65], v[48:49]
    v_pk_add_f32 v[66:67], v[66:67], v[50:51]
    v_pk_add_f32 v[68:69], v[68:69], v[52:53]
    v_pk_add_f32 v[70:71], v[70:71], v[54:55]
    v_lshlrev_b32 v48, 16, v156
    v_and_b32 v49, 0xffff0000, v156
    v_lshlrev_b32 v50, 16, v157
    v_and_b32 v51, 0xffff0000, v157
    v_lshlrev_b32 v52, 16, v158
    v_and_b32 v53, 0xffff0000, v158
    v_lshlrev_b32 v54, 16, v159
    v_and_b32 v55, 0xffff0000, v159
    v_pk_add_f32 v[64:65], v[64:65], v[48:49]
    v_pk_add_f32 v[66:67], v[66:67], v[50:51]
    v_pk_add_f32 v[68:69], v[68:69], v[52:53]
    v_pk_add_f32 v[70:71], v[70:71], v[54:55]
    v_cvt_pk_bf16_f32 v48, v64, v65
    v_cvt_pk_bf16_f32 v49, v66, v67
    v_cvt_pk_bf16_f32 v50, v68, v69
    v_cvt_pk_bf16_f32 v51, v70, v71
    v_lshlrev_b32 v64, 16, v48
    v_and_b32 v65, 0xffff0000, v48
    v_lshlrev_b32 v66, 16, v49
    v_and_b32 v67, 0xffff0000, v49
    v_lshlrev_b32 v68, 16, v50
    v_and_b32 v69, 0xffff0000, v50
    v_lshlrev_b32 v70, 16, v51
    v_and_b32 v71, 0xffff0000, v51
    v_pk_mul_f32 v[64:65], v[64:65], v[160:161]
    v_pk_mul_f32 v[66:67], v[66:67], v[162:163]
    v_pk_mul_f32 v[68:69], v[68:69], v[164:165]
    v_pk_mul_f32 v[70:71], v[70:71], v[166:167]
    v_cvt_pk_bf16_f32 v48, v64, v65
    v_cvt_pk_bf16_f32 v49, v66, v67
    v_cvt_pk_bf16_f32 v50, v68, v69
    v_cvt_pk_bf16_f32 v51, v70, v71
    v_lshlrev_b32 v64, 16, v48
    v_and_b32 v65, 0xffff0000, v48
    v_lshlrev_b32 v66, 16, v49
    v_and_b32 v67, 0xffff0000, v49
    v_lshlrev_b32 v68, 16, v50
    v_and_b32 v69, 0xffff0000, v50
    v_lshlrev_b32 v70, 16, v51
    v_and_b32 v71, 0xffff0000, v51
    v_lshlrev_b32 v48, 16, v32
    v_and_b32 v49, 0xffff0000, v32
    v_lshlrev_b32 v50, 16, v33
    v_and_b32 v51, 0xffff0000, v33
    v_lshlrev_b32 v52, 16, v34
    v_and_b32 v53, 0xffff0000, v34
    v_lshlrev_b32 v54, 16, v35
    v_and_b32 v55, 0xffff0000, v35
    v_pk_add_f32 v[64:65], v[64:65], v[48:49]
    v_pk_add_f32 v[66:67], v[66:67], v[50:51]
    v_pk_add_f32 v[68:69], v[68:69], v[52:53]
    v_pk_add_f32 v[70:71], v[70:71], v[54:55]
    v_cvt_pk_bf16_f32 v32, v64, v65
    v_cvt_pk_bf16_f32 v33, v66, v67
    v_cvt_pk_bf16_f32 v34, v68, v69
    v_cvt_pk_bf16_f32 v35, v70, v71
    v_lshlrev_b32 v64, 16, v32
    v_and_b32 v65, 0xffff0000, v32
    v_lshlrev_b32 v66, 16, v33
    v_and_b32 v67, 0xffff0000, v33
    v_lshlrev_b32 v68, 16, v34
    v_and_b32 v69, 0xffff0000, v34
    v_lshlrev_b32 v70, 16, v35
    v_and_b32 v71, 0xffff0000, v35
    v_pk_add_f32 v[48:49], v[64:65], v[66:67]
    v_pk_add_f32 v[50:51], v[68:69], v[70:71]
    v_pk_add_f32 v[48:49], v[48:49], v[50:51]
    v_add_f32 v48, v48, v49
    s_nop 1
    v_add_f32_dpp v48, v48, v48 quad_perm:[1,0,3,2] row_mask:0xf bank_mask:0xf
    s_nop 1
    v_add_f32_dpp v48, v48, v48 quad_perm:[2,3,0,1] row_mask:0xf bank_mask:0xf
    s_nop 1
    v_add_f32_dpp v48, v48, v48 row_half_mirror row_mask:0xf bank_mask:0xf
    s_nop 1
    v_add_f32_dpp v48, v48, v48 row_mirror row_mask:0xf bank_mask:0xf
    v_mov_b32 v49, v48
    s_nop 1
    v_permlane16_swap_b32 v48, v49
    v_add_f32 v48, v48, v49
    v_mov_b32 v49, v48
    s_nop 1
    v_permlane32_swap_b32 v48, v49
    v_add_f32 v48, v48, v49
    v_mul_f32 v48, 0xbb000000, v48
    v_pk_add_f32 v[72:73], v[64:65], v[48:49] op_sel_hi:[1,0]
    v_pk_add_f32 v[74:75], v[66:67], v[48:49] op_sel_hi:[1,0]
    v_pk_add_f32 v[76:77], v[68:69], v[48:49] op_sel_hi:[1,0]
    v_pk_add_f32 v[78:79], v[70:71], v[48:49] op_sel_hi:[1,0]
    v_pk_mul_f32 v[50:51], v[72:73], v[72:73]
    v_pk_mul_f32 v[52:53], v[72:73], v[8:9]
    v_pk_fma_f32 v[50:51], v[74:75], v[74:75], v[50:51]
    v_pk_fma_f32 v[52:53], v[74:75], v[10:11], v[52:53]
    v_pk_fma_f32 v[50:51], v[76:77], v[76:77], v[50:51]
    v_pk_fma_f32 v[52:53], v[76:77], v[12:13], v[52:53]
    v_pk_fma_f32 v[50:51], v[78:79], v[78:79], v[50:51]
    v_pk_fma_f32 v[52:53], v[78:79], v[14:15], v[52:53]
    v_add_f32 v50, v50, v51
    v_add_f32 v52, v52, v53
    s_nop 0
    v_add_f32_dpp v50, v50, v50 quad_perm:[1,0,3,2] row_mask:0xf bank_mask:0xf
    v_add_f32_dpp v52, v52, v52 quad_perm:[1,0,3,2] row_mask:0xf bank_mask:0xf
    s_nop 0
    v_add_f32_dpp v50, v50, v50 quad_perm:[2,3,0,1] row_mask:0xf bank_mask:0xf
    v_add_f32_dpp v52, v52, v52 quad_perm:[2,3,0,1] row_mask:0xf bank_mask:0xf
    s_nop 0
    v_add_f32_dpp v50, v50, v50 row_half_mirror row_mask:0xf bank_mask:0xf
    v_add_f32_dpp v52, v52, v52 row_half_mirror row_mask:0xf bank_mask:0xf
    s_nop 0
    v_add_f32_dpp v50, v50, v50 row_mirror row_mask:0xf bank_mask:0xf
    v_add_f32_dpp v52, v52, v52 row_mirror row_mask:0xf bank_mask:0xf
    v_mov_b32 v51, v50
    v_mov_b32 v53, v52
    s_nop 0
    v_permlane16_swap_b32 v50, v51
    v_permlane16_swap_b32 v52, v53
    v_add_f32 v50, v50, v51
    v_add_f32 v52, v52, v53
    v_mov_b32 v51, v50
    v_mov_b32 v53, v52
    s_nop 0
    v_permlane32_swap_b32 v50, v51
    v_permlane32_swap_b32 v52, v53
    v_add_f32 v50, v50, v51
    v_add_f32 v52, v52, v53
    v_mov_b32 v48, 0x3727c5ac
    v_fmac_f32 v48, 0x3b000000, v50
    v_rsq_f32 v48, v48
    s_nop 0
    v_fma_f32 v52, v52, v48, v16
    v_ashrrev_i32 v53, 31, v52
    v_or_b32 v53, 0x80000000, v53
    v_xor_b32 v53, v53, v52
    v_and_b32 v53, 0xfffff800, v53
    v_or_b32 v17, s68, v53
    v_pk_mul_f32 v[72:73], v[72:73], v[48:49] op_sel_hi:[1,0]
    v_pk_mul_f32 v[74:75], v[74:75], v[48:49] op_sel_hi:[1,0]
    v_pk_mul_f32 v[76:77], v[76:77], v[48:49] op_sel_hi:[1,0]
    v_pk_mul_f32 v[78:79], v[78:79], v[48:49] op_sel_hi:[1,0]
    v_pk_fma_f32 v[72:73], v[72:73], v[168:169], v[176:177]
    v_pk_fma_f32 v[74:75], v[74:75], v[170:171], v[178:179]
    v_pk_fma_f32 v[76:77], v[76:77], v[172:173], v[180:181]
    v_pk_fma_f32 v[78:79], v[78:79], v[174:175], v[182:183]
    v_cvt_pk_bf16_f32 v20, v72, v73
    v_cvt_pk_bf16_f32 v21, v74, v75
    v_cvt_pk_bf16_f32 v22, v76, v77
    v_cvt_pk_bf16_f32 v23, v78, v79
    v_lshlrev_b32 v72, 16, v20
    v_and_b32 v73, 0xffff0000, v20
    v_lshlrev_b32 v74, 16, v21
    v_and_b32 v75, 0xffff0000, v21
    v_lshlrev_b32 v76, 16, v22
    v_and_b32 v77, 0xffff0000, v22
    v_lshlrev_b32 v78, 16, v23
    v_and_b32 v79, 0xffff0000, v23
    v_pk_mul_f32 v[72:73], v[72:73], v[184:185]
    v_pk_mul_f32 v[74:75], v[74:75], v[186:187]
    v_pk_mul_f32 v[76:77], v[76:77], v[188:189]
    v_pk_mul_f32 v[78:79], v[78:79], v[190:191]
    v_cvt_pk_bf16_f32 v56, v72, v73
    v_cvt_pk_bf16_f32 v57, v74, v75
    v_cvt_pk_bf16_f32 v58, v76, v77
    v_cvt_pk_bf16_f32 v59, v78, v79
    v_lshlrev_b32 v72, 16, v56
    v_and_b32 v73, 0xffff0000, v56
    v_lshlrev_b32 v74, 16, v57
    v_and_b32 v75, 0xffff0000, v57
    v_lshlrev_b32 v76, 16, v58
    v_and_b32 v77, 0xffff0000, v58
    v_lshlrev_b32 v78, 16, v59
    v_and_b32 v79, 0xffff0000, v59
    v_pk_add_f32 v[72:73], v[72:73], v[64:65]
    v_pk_add_f32 v[74:75], v[74:75], v[66:67]
    v_pk_add_f32 v[76:77], v[76:77], v[68:69]
    v_pk_add_f32 v[78:79], v[78:79], v[70:71]
    v_cvt_pk_bf16_f32 v56, v72, v73
    v_cvt_pk_bf16_f32 v57, v74, v75
    v_cvt_pk_bf16_f32 v58, v76, v77
    v_cvt_pk_bf16_f32 v59, v78, v79
    v_accvgpr_read_b32 v48, a0
    v_lshlrev_b32 v96, 16, v48
    v_and_b32 v97, 0xffff0000, v48
    v_accvgpr_read_b32 v48, a1
    v_lshlrev_b32 v98, 16, v48
    v_and_b32 v99, 0xffff0000, v48
    v_accvgpr_read_b32 v48, a2
    v_lshlrev_b32 v100, 16, v48
    v_and_b32 v101, 0xffff0000, v48
    v_accvgpr_read_b32 v48, a3
    v_lshlrev_b32 v102, 16, v48
    v_and_b32 v103, 0xffff0000, v48
    v_accvgpr_read_b32 v48, a4
    v_lshlrev_b32 v104, 16, v48
    v_and_b32 v105, 0xffff0000, v48
    v_accvgpr_read_b32 v48, a5
    v_lshlrev_b32 v106, 16, v48
    v_and_b32 v107, 0xffff0000, v48
    v_accvgpr_read_b32 v48, a6
    v_lshlrev_b32 v108, 16, v48
    v_and_b32 v109, 0xffff0000, v48
    v_accvgpr_read_b32 v48, a7
    v_lshlrev_b32 v110, 16, v48
    v_and_b32 v111, 0xffff0000, v48
    v_accvgpr_read_b32 v48, a8
    v_lshlrev_b32 v112, 16, v48
    v_and_b32 v113, 0xffff0000, v48
    v_accvgpr_read_b32 v48, a9
    v_lshlrev_b32 v114, 16, v48
    v_and_b32 v115, 0xffff0000, v48
    v_accvgpr_read_b32 v48, a10
    v_lshlrev_b32 v116, 16, v48
    v_and_b32 v117, 0xffff0000, v48
    v_accvgpr_read_b32 v48, a11
    v_lshlrev_b32 v118, 16, v48
    v_and_b32 v119, 0xffff0000, v48
    v_accvgpr_read_b32 v48, a12
    v_lshlrev_b32 v120, 16, v48
    v_and_b32 v121, 0xffff0000, v48
    v_accvgpr_read_b32 v48, a13
    v_lshlrev_b32 v122, 16, v48
    v_and_b32 v123, 0xffff0000, v48
    v_accvgpr_read_b32 v48, a14
    v_lshlrev_b32 v124, 16, v48
    v_and_b32 v125, 0xffff0000, v48
    v_accvgpr_read_b32 v48, a15
    v_lshlrev_b32 v126, 16, v48
    v_and_b32 v127, 0xffff0000, v48
    s_mov_b32 s99, 0
L_P2_l_17:
    s_waitcnt vmcnt(0)
    v_max_u32 v48, v192, v193
    v_max3_u32 v48, v48, v194, v195
    v_max_u32 v49, v196, v197
    v_max3_u32 v49, v49, v198, v199
    v_max_u32 v50, v200, v201
    v_max3_u32 v50, v50, v202, v203
    v_max_u32 v51, v204, v205
    v_max3_u32 v51, v51, v206, v207
    v_max_u32 v52, v208, v209
    v_max3_u32 v52, v52, v210, v211
    v_max_u32 v53, v212, v213
    v_max3_u32 v53, v53, v214, v215
    v_max_u32 v54, v216, v217
    v_max3_u32 v54, v54, v218, v219
    v_max_u32 v55, v220, v221
    v_max3_u32 v55, v55, v222, v223
    v_max3_u32 v3, v48, v49, v50
    v_max3_u32 v3, v3, v51, v52
    v_max3_u32 v3, v3, v53, v54
    v_max_u32 v3, v3, v55
    v_cmp_eq_u32 vcc, -1, v3
    s_add_u32 s99, s99, 1
    s_cbranch_vccz L_P2_ok_18
    s_cmp_ge_u32 s99, 200000
    s_cbranch_scc1 L_P2_ok_18
    s_sleep 2
    v_cmp_eq_u32 vcc, -1, v48
    s_cbranch_vccz L_P2_s_19
    s_mov_b64 exec, vcc
    s_add_u32 s74, s70, 8388608
    buffer_load_dwordx4 v[192:195], v44, s[8:11], s74 offen sc0 sc1
    s_mov_b64 exec, -1
L_P2_s_19:
    v_cmp_eq_u32 vcc, -1, v49
    s_cbranch_vccz L_P2_s_20
    s_mov_b64 exec, vcc
    s_add_u32 s74, s70, 8392704
    buffer_load_dwordx4 v[196:199], v44, s[8:11], s74 offen sc0 sc1
    s_mov_b64 exec, -1
L_P2_s_20:
    v_cmp_eq_u32 vcc, -1, v50
    s_cbranch_vccz L_P2_s_21
    s_mov_b64 exec, vcc
    s_add_u32 s74, s70, 8396800
    buffer_load_dwordx4 v[200:203], v44, s[8:11], s74 offen sc0 sc1
    s_mov_b64 exec, -1
L_P2_s_21:
    v_cmp_eq_u32 vcc, -1, v51
    s_cbranch_vccz L_P2_s_22
    s_mov_b64 exec, vcc
    s_add_u32 s74, s70, 8400896
    buffer_load_dwordx4 v[204:207], v44, s[8:11], s74 offen sc0 sc1
    s_mov_b64 exec, -1
L_P2_s_22:
    v_cmp_eq_u32 vcc, -1, v52
    s_cbranch_vccz L_P2_s_23
    s_mov_b64 exec, vcc
    s_add_u32 s74, s70, 8404992
    buffer_load_dwordx4 v[208:211], v44, s[8:11], s74 offen sc0 sc1
    s_mov_b64 exec, -1
L_P2_s_23:
    v_cmp_eq_u32 vcc, -1, v53
    s_cbranch_vccz L_P2_s_24
    s_mov_b64 exec, vcc
    s_add_u32 s74, s70, 8409088
    buffer_load_dwordx4 v[212:215], v44, s[8:11], s74 offen sc0 sc1
    s_mov_b64 exec, -1
L_P2_s_24:
    v_cmp_eq_u32 vcc, -1, v54
    s_cbranch_vccz L_P2_s_25
    s_mov_b64 exec, vcc
    s_add_u32 s74, s70, 8413184
    buffer_load_dwordx4 v[216:219], v44, s[8:11], s74 offen sc0 sc1
    s_mov_b64 exec, -1
L_P2_s_25:
    v_cmp_eq_u32 vcc, -1, v55
    s_cbranch_vccz L_P2_s_26
    s_mov_b64 exec, vcc
    s_add_u32 s74, s70, 8417280
    buffer_load_dwordx4 v[220:223], v44, s[8:11], s74 offen sc0 sc1
    s_mov_b64 exec, -1
L_P2_s_26:
    s_branch L_P2_l_17
L_P2_ok_18:
    v_lshlrev_b32 v80, 16, v192
    v_and_b32 v81, 0xffff0000, v192
    v_lshlrev_b32 v82, 16, v193
    v_and_b32 v83, 0xffff0000, v193
    v_lshlrev_b32 v84, 16, v194
    v_and_b32 v85, 0xffff0000, v194
    v_lshlrev_b32 v86, 16, v195
    v_and_b32 v87, 0xffff0000, v195
    v_lshlrev_b32 v48, 16, v196
    v_and_b32 v49, 0xffff0000, v196
    v_lshlrev_b32 v50, 16, v197
    v_and_b32 v51, 0xffff0000, v197
    v_lshlrev_b32 v52, 16, v198
    v_and_b32 v53, 0xffff0000, v198
    v_lshlrev_b32 v54, 16, v199
    v_and_b32 v55, 0xffff0000, v199
    v_pk_add_f32 v[80:81], v[80:81], v[48:49]
    v_pk_add_f32 v[82:83], v[82:83], v[50:51]
    v_pk_add_f32 v[84:85], v[84:85], v[52:53]
    v_pk_add_f32 v[86:87], v[86:87], v[54:55]
    v_lshlrev_b32 v48, 16, v200
    v_and_b32 v49, 0xffff0000, v200
    v_lshlrev_b32 v50, 16, v201
    v_and_b32 v51, 0xffff0000, v201
    v_lshlrev_b32 v52, 16, v202
    v_and_b32 v53, 0xffff0000, v202
    v_lshlrev_b32 v54, 16, v203
    v_and_b32 v55, 0xffff0000, v203
    v_pk_add_f32 v[80:81], v[80:81], v[48:49]
    v_pk_add_f32 v[82:83], v[82:83], v[50:51]
    v_pk_add_f32 v[84:85], v[84:85], v[52:53]
    v_pk_add_f32 v[86:87], v[86:87], v[54:55]
    v_lshlrev_b32 v48, 16, v204
    v_and_b32 v49, 0xffff0000, v204
    v_lshlrev_b32 v50, 16, v205
    v_and_b32 v51, 0xffff0000, v205
    v_lshlrev_b32 v52, 16, v206
    v_and_b32 v53, 0xffff0000, v206
    v_lshlrev_b32 v54, 16, v207
    v_and_b32 v55, 0xffff0000, v207
    v_pk_add_f32 v[80:81], v[80:81], v[48:49]
    v_pk_add_f32 v[82:83], v[82:83], v[50:51]
    v_pk_add_f32 v[84:85], v[84:85], v[52:53]
    v_pk_add_f32 v[86:87], v[86:87], v[54:55]
    v_lshlrev_b32 v48, 16, v208
    v_and_b32 v49, 0xffff0000, v208
    v_lshlrev_b32 v50, 16, v209
    v_and_b32 v51, 0xffff0000, v209
    v_lshlrev_b32 v52, 16, v210
    v_and_b32 v53, 0xffff0000, v210
    v_lshlrev_b32 v54, 16, v211
    v_and_b32 v55, 0xffff0000, v211
    v_pk_add_f32 v[80:81], v[80:81], v[48:49]
    v_pk_add_f32 v[82:83], v[82:83], v[50:51]
    v_pk_add_f32 v[84:85], v[84:85], v[52:53]
    v_pk_add_f32 v[86:87], v[86:87], v[54:55]
    v_lshlrev_b32 v48, 16, v212
    v_and_b32 v49, 0xffff0000, v212
    v_lshlrev_b32 v50, 16, v213
    v_and_b32 v51, 0xffff0000, v213
    v_lshlrev_b32 v52, 16, v214
    v_and_b32 v53, 0xffff0000, v214
    v_lshlrev_b32 v54, 16, v215
    v_and_b32 v55, 0xffff0000, v215
    v_pk_add_f32 v[80:81], v[80:81], v[48:49]
    v_pk_add_f32 v[82:83], v[82:83], v[50:51]
    v_pk_add_f32 v[84:85], v[84:85], v[52:53]
    v_pk_add_f32 v[86:87], v[86:87], v[54:55]
    v_lshlrev_b32 v48, 16, v216
    v_and_b32 v49, 0xffff0000, v216
    v_lshlrev_b32 v50, 16, v217
    v_and_b32 v51, 0xffff0000, v217
    v_lshlrev_b32 v52, 16, v218
    v_and_b32 v53, 0xffff0000, v218
    v_lshlrev_b32 v54, 16, v219
    v_and_b32 v55, 0xffff0000, v219
    v_pk_add_f32 v[80:81], v[80:81], v[48:49]
    v_pk_add_f32 v[82:83], v[82:83], v[50:51]
    v_pk_add_f32 v[84:85], v[84:85], v[52:53]
    v_pk_add_f32 v[86:87], v[86:87], v[54:55]
    v_lshlrev_b32 v48, 16, v220
    v_and_b32 v49, 0xffff0000, v220
    v_lshlrev_b32 v50, 16, v221
    v_and_b32 v51, 0xffff0000, v221
    v_lshlrev_b32 v52, 16, v222
    v_and_b32 v53, 0xffff0000, v222
    v_lshlrev_b32 v54, 16, v223
    v_and_b32 v55, 0xffff0000, v223
    v_pk_add_f32 v[80:81], v[80:81], v[48:49]
    v_pk_add_f32 v[82:83], v[82:83], v[50:51]
    v_pk_add_f32 v[84:85], v[84:85], v[52:53]
    v_pk_add_f32 v[86:87], v[86:87], v[54:55]
    v_cvt_pk_bf16_f32 v48, v80, v81
    v_cvt_pk_bf16_f32 v49, v82, v83
    v_cvt_pk_bf16_f32 v50, v84, v85
    v_cvt_pk_bf16_f32 v51, v86, v87
    v_lshlrev_b32 v80, 16, v48
    v_and_b32 v81, 0xffff0000, v48
    v_lshlrev_b32 v82, 16, v49
    v_and_b32 v83, 0xffff0000, v49
    v_lshlrev_b32 v84, 16, v50
    v_and_b32 v85, 0xffff0000, v50
    v_lshlrev_b32 v86, 16, v51
    v_and_b32 v87, 0xffff0000, v51
    v_pk_mul_f32 v[80:81], v[80:81], v[160:161]
    v_pk_mul_f32 v[82:83], v[82:83], v[162:163]
    v_pk_mul_f32 v[84:85], v[84:85], v[164:165]
    v_pk_mul_f32 v[86:87], v[86:87], v[166:167]
    v_cvt_pk_bf16_f32 v48, v80, v81
    v_cvt_pk_bf16_f32 v49, v82, v83
    v_cvt_pk_bf16_f32 v50, v84, v85
    v_cvt_pk_bf16_f32 v51, v86, v87
    v_lshlrev_b32 v80, 16, v48
    v_and_b32 v81, 0xffff0000, v48
    v_lshlrev_b32 v82, 16, v49
    v_and_b32 v83, 0xffff0000, v49
    v_lshlrev_b32 v84, 16, v50
    v_and_b32 v85, 0xffff0000, v50
    v_lshlrev_b32 v86, 16, v51
    v_and_b32 v87, 0xffff0000, v51
    v_lshlrev_b32 v48, 16, v36
    v_and_b32 v49, 0xffff0000, v36
    v_lshlrev_b32 v50, 16, v37
    v_and_b32 v51, 0xffff0000, v37
    v_lshlrev_b32 v52, 16, v38
    v_and_b32 v53, 0xffff0000, v38
    v_lshlrev_b32 v54, 16, v39
    v_and_b32 v55, 0xffff0000, v39
    v_pk_add_f32 v[80:81], v[80:81], v[48:49]
    v_pk_add_f32 v[82:83], v[82:83], v[50:51]
    v_pk_add_f32 v[84:85], v[84:85], v[52:53]
    v_pk_add_f32 v[86:87], v[86:87], v[54:55]
    v_cvt_pk_bf16_f32 v36, v80, v81
    v_cvt_pk_bf16_f32 v37, v82, v83
    v_cvt_pk_bf16_f32 v38, v84, v85
    v_cvt_pk_bf16_f32 v39, v86, v87
    v_lshlrev_b32 v80, 16, v36
    v_and_b32 v81, 0xffff0000, v36
    v_lshlrev_b32 v82, 16, v37
    v_and_b32 v83, 0xffff0000, v37
    v_lshlrev_b32 v84, 16, v38
    v_and_b32 v85, 0xffff0000, v38
    v_lshlrev_b32 v86, 16, v39
    v_and_b32 v87, 0xffff0000, v39
    v_pk_add_f32 v[48:49], v[80:81], v[82:83]
    v_pk_add_f32 v[50:51], v[84:85], v[86:87]
    v_pk_add_f32 v[48:49], v[48:49], v[50:51]
    v_add_f32 v48, v48, v49
    s_nop 1
    v_add_f32_dpp v48, v48, v48 quad_perm:[1,0,3,2] row_mask:0xf bank_mask:0xf
    s_nop 1
    v_add_f32_dpp v48, v48, v48 quad_perm:[2,3,0,1] row_mask:0xf bank_mask:0xf
    s_nop 1
    v_add_f32_dpp v48, v48, v48 row_half_mirror row_mask:0xf bank_mask:0xf
    s_nop 1
    v_add_f32_dpp v48, v48, v48 row_mirror row_mask:0xf bank_mask:0xf
    v_mov_b32 v49, v48
    s_nop 1
    v_permlane16_swap_b32 v48, v49
    v_add_f32 v48, v48, v49
    v_mov_b32 v49, v48
    s_nop 1
    v_permlane32_swap_b32 v48, v49
    v_add_f32 v48, v48, v49
    v_mul_f32 v48, 0xbb000000, v48
    v_pk_add_f32 v[88:89], v[80:81], v[48:49] op_sel_hi:[1,0]
    v_pk_add_f32 v[90:91], v[82:83], v[48:49] op_sel_hi:[1,0]
    v_pk_add_f32 v[92:93], v[84:85], v[48:49] op_sel_hi:[1,0]
    v_pk_add_f32 v[94:95], v[86:87], v[48:49] op_sel_hi:[1,0]
    v_pk_mul_f32 v[50:51], v[88:89], v[88:89]
    v_pk_mul_f32 v[52:53], v[88:89], v[8:9]
    v_pk_fma_f32 v[50:51], v[90:91], v[90:91], v[50:51]
    v_pk_fma_f32 v[52:53], v[90:91], v[10:11], v[52:53]
    v_pk_fma_f32 v[50:51], v[92:93], v[92:93], v[50:51]
    v_pk_fma_f32 v[52:53], v[92:93], v[12:13], v[52:53]
    v_pk_fma_f32 v[50:51], v[94:95], v[94:95], v[50:51]
    v_pk_fma_f32 v[52:53], v[94:95], v[14:15], v[52:53]
    v_add_f32 v50, v50, v51
    v_add_f32 v52, v52, v53
    s_nop 0
    v_add_f32_dpp v50, v50, v50 quad_perm:[1,0,3,2] row_mask:0xf bank_mask:0xf
    v_add_f32_dpp v52, v52, v52 quad_perm:[1,0,3,2] row_mask:0xf bank_mask:0xf
    s_nop 0
    v_add_f32_dpp v50, v50, v50 quad_perm:[2,3,0,1] row_mask:0xf bank_mask:0xf
    v_add_f32_dpp v52, v52, v52 quad_perm:[2,3,0,1] row_mask:0xf bank_mask:0xf
    s_nop 0
    v_add_f32_dpp v50, v50, v50 row_half_mirror row_mask:0xf bank_mask:0xf
    v_add_f32_dpp v52, v52, v52 row_half_mirror row_mask:0xf bank_mask:0xf
    s_nop 0
    v_add_f32_dpp v50, v50, v50 row_mirror row_mask:0xf bank_mask:0xf
    v_add_f32_dpp v52, v52, v52 row_mirror row_mask:0xf bank_mask:0xf
    v_mov_b32 v51, v50
    v_mov_b32 v53, v52
    s_nop 0
    v_permlane16_swap_b32 v50, v51
    v_permlane16_swap_b32 v52, v53
    v_add_f32 v50, v50, v51
    v_add_f32 v52, v52, v53
    v_mov_b32 v51, v50
    v_mov_b32 v53, v52
    s_nop 0
    v_permlane32_swap_b32 v50, v51
    v_permlane32_swap_b32 v52, v53
    v_add_f32 v50, v50, v51
    v_add_f32 v52, v52, v53
    v_mov_b32 v48, 0x3727c5ac
    v_fmac_f32 v48, 0x3b000000, v50
    v_rsq_f32 v48, v48
    s_nop 0
    v_fma_f32 v52, v52, v48, v16
    v_ashrrev_i32 v53, 31, v52
    v_or_b32 v53, 0x80000000, v53
    v_xor_b32 v53, v53, v52
    v_and_b32 v53, 0xfffff800, v53
    v_or_b32 v18, s69, v53
    v_max_u32 v19, v17, v18
    v_max_u32 v19, 1, v19
    s_lshl_b32 s100, s3, 2
    v_mov_b32 v47, s100
    ds_write_b32 v47, v19
    v_mov_b32 v47, 0
    v_pk_mul_f32 v[88:89], v[88:89], v[48:49] op_sel_hi:[1,0]
    v_pk_mul_f32 v[90:91], v[90:91], v[48:49] op_sel_hi:[1,0]
    v_pk_mul_f32 v[92:93], v[92:93], v[48:49] op_sel_hi:[1,0]
    v_pk_mul_f32 v[94:95], v[94:95], v[48:49] op_sel_hi:[1,0]
    v_pk_fma_f32 v[88:89], v[88:89], v[168:169], v[176:177]
    v_pk_fma_f32 v[90:91], v[90:91], v[170:171], v[178:179]
    v_pk_fma_f32 v[92:93], v[92:93], v[172:173], v[180:181]
    v_pk_fma_f32 v[94:95], v[94:95], v[174:175], v[182:183]
    v_cvt_pk_bf16_f32 v24, v88, v89
    v_cvt_pk_bf16_f32 v25, v90, v91
    v_cvt_pk_bf16_f32 v26, v92, v93
    v_cvt_pk_bf16_f32 v27, v94, v95
    s_waitcnt lgkmcnt(0)
    s_barrier
    ds_read_b128 v[52:55], v47
    v_cmp_gt_u32 vcc, v17, v18
    s_nop 1
    v_cndmask_b32 v28, v24, v20, vcc
    v_cndmask_b32 v40, v36, v32, vcc
    v_cndmask_b32 v29, v25, v21, vcc
    v_cndmask_b32 v41, v37, v33, vcc
    v_cndmask_b32 v30, v26, v22, vcc
    v_cndmask_b32 v42, v38, v34, vcc
    v_cndmask_b32 v31, v27, v23, vcc
    v_cndmask_b32 v43, v39, v35, vcc
    v_min_u32 v28, -2, v28
    v_min_u32 v40, -2, v40
    v_min_u32 v29, -2, v29
    v_min_u32 v41, -2, v41
    v_min_u32 v30, -2, v30
    v_min_u32 v42, -2, v42
    v_min_u32 v31, -2, v31
    v_min_u32 v43, -2, v43
    s_lshl_b32 s100, s2, 6
    s_add_u32 s100, s100, 65536
    s_lshl_b32 s101, s2, 11
    s_add_u32 s101, s101, 524288
    s_waitcnt lgkmcnt(0)
    v_max_u32 v52, v52, v53
    v_max3_u32 v52, v52, v54, v55
    v_cmp_eq_u32 vcc, v52, v19
    s_cbranch_vccz L_notbest
    buffer_store_dword v19, v5, s[8:11], s100 offen sc0 sc1
    buffer_store_dwordx4 v[28:31], v1, s[8:11], s101 offen sc0 sc1
    buffer_store_dwordx4 v[40:43], v1, s[8:11], s101 offen offset:1024 sc0 sc1
L_notbest:
    v_lshlrev_b32 v88, 16, v24
    v_and_b32 v89, 0xffff0000, v24
    v_lshlrev_b32 v90, 16, v25
    v_and_b32 v91, 0xffff0000, v25
    v_lshlrev_b32 v92, 16, v26
    v_and_b32 v93, 0xffff0000, v26
    v_lshlrev_b32 v94, 16, v27
    v_and_b32 v95, 0xffff0000, v27
    v_pk_mul_f32 v[88:89], v[88:89], v[184:185]
    v_pk_mul_f32 v[90:91], v[90:91], v[186:187]
    v_pk_mul_f32 v[92:93], v[92:93], v[188:189]
    v_pk_mul_f32 v[94:95], v[94:95], v[190:191]
    v_cvt_pk_bf16_f32 v60, v88, v89
    v_cvt_pk_bf16_f32 v61, v90, v91
    v_cvt_pk_bf16_f32 v62, v92, v93
    v_cvt_pk_bf16_f32 v63, v94, v95
    v_lshlrev_b32 v88, 16, v60
    v_and_b32 v89, 0xffff0000, v60
    v_lshlrev_b32 v90, 16, v61
    v_and_b32 v91, 0xffff0000, v61
    v_lshlrev_b32 v92, 16, v62
    v_and_b32 v93, 0xffff0000, v62
    v_lshlrev_b32 v94, 16, v63
    v_and_b32 v95, 0xffff0000, v63
    v_pk_add_f32 v[88:89], v[88:89], v[80:81]
    v_pk_add_f32 v[90:91], v[90:91], v[82:83]
    v_pk_add_f32 v[92:93], v[92:93], v[84:85]
    v_pk_add_f32 v[94:95], v[94:95], v[86:87]
    v_cvt_pk_bf16_f32 v60, v88, v89
    v_cvt_pk_bf16_f32 v61, v90, v91
    v_cvt_pk_bf16_f32 v62, v92, v93
    v_cvt_pk_bf16_f32 v63, v94, v95
    v_accvgpr_read_b32 v48, a16
    v_lshlrev_b32 v128, 16, v48
    v_and_b32 v129, 0xffff0000, v48
    v_accvgpr_read_b32 v48, a17
    v_lshlrev_b32 v130, 16, v48
    v_and_b32 v131, 0xffff0000, v48
    v_accvgpr_read_b32 v48, a18
    v_lshlrev_b32 v132, 16, v48
    v_and_b32 v133, 0xffff0000, v48
    v_accvgpr_read_b32 v48, a19
    v_lshlrev_b32 v134, 16, v48
    v_and_b32 v135, 0xffff0000, v48
    v_accvgpr_read_b32 v48, a20
    v_lshlrev_b32 v136, 16, v48
    v_and_b32 v137, 0xffff0000, v48
    v_accvgpr_read_b32 v48, a21
    v_lshlrev_b32 v138, 16, v48
    v_and_b32 v139, 0xffff0000, v48
    v_accvgpr_read_b32 v48, a22
    v_lshlrev_b32 v140, 16, v48
    v_and_b32 v141, 0xffff0000, v48
    v_accvgpr_read_b32 v48, a23
    v_lshlrev_b32 v142, 16, v48
    v_and_b32 v143, 0xffff0000, v48
    v_accvgpr_read_b32 v48, a24
    v_lshlrev_b32 v144, 16, v48
    v_and_b32 v145, 0xffff0000, v48
    v_accvgpr_read_b32 v48, a25
    v_lshlrev_b32 v146, 16, v48
    v_and_b32 v147, 0xffff0000, v48
    v_accvgpr_read_b32 v48, a26
    v_lshlrev_b32 v148, 16, v48
    v_and_b32 v149, 0xffff0000, v48
    v_accvgpr_read_b32 v48, a27
    v_lshlrev_b32 v150, 16, v48
    v_and_b32 v151, 0xffff0000, v48
    v_accvgpr_read_b32 v48, a28
    v_lshlrev_b32 v152, 16, v48
    v_and_b32 v153, 0xffff0000, v48
    v_accvgpr_read_b32 v48, a29
    v_lshlrev_b32 v154, 16, v48
    v_and_b32 v155, 0xffff0000, v48
    v_accvgpr_read_b32 v48, a30
    v_lshlrev_b32 v156, 16, v48
    v_and_b32 v157, 0xffff0000, v48
    v_accvgpr_read_b32 v48, a31
    v_lshlrev_b32 v158, 16, v48
    v_and_b32 v159, 0xffff0000, v48
    v_accvgpr_read_b32 v48, a32
    v_lshlrev_b32 v224, 16, v48
    v_and_b32 v225, 0xffff0000, v48
    v_accvgpr_read_b32 v48, a33
    v_lshlrev_b32 v226, 16, v48
    v_and_b32 v227, 0xffff0000, v48
    v_accvgpr_read_b32 v48, a34
    v_lshlrev_b32 v228, 16, v48
    v_and_b32 v229, 0xffff0000, v48
    v_accvgpr_read_b32 v48, a35
    v_lshlrev_b32 v230, 16, v48
    v_and_b32 v231, 0xffff0000, v48
    v_accvgpr_read_b32 v48, a36
    v_lshlrev_b32 v232, 16, v48
    v_and_b32 v233, 0xffff0000, v48
    v_accvgpr_read_b32 v48, a37
    v_lshlrev_b32 v234, 16, v48
    v_and_b32 v235, 0xffff0000, v48
    v_accvgpr_read_b32 v48, a38
    v_lshlrev_b32 v236, 16, v48
    v_and_b32 v237, 0xffff0000, v48
    v_accvgpr_read_b32 v48, a39
    v_lshlrev_b32 v238, 16, v48
    v_and_b32 v239, 0xffff0000, v48
    v_accvgpr_read_b32 v48, a40
    v_lshlrev_b32 v240, 16, v48
    v_and_b32 v241, 0xffff0000, v48
    v_accvgpr_read_b32 v48, a41
    v_lshlrev_b32 v242, 16, v48
    v_and_b32 v243, 0xffff0000, v48
    v_accvgpr_read_b32 v48, a42
    v_lshlrev_b32 v244, 16, v48
    v_and_b32 v245, 0xffff0000, v48
    v_accvgpr_read_b32 v48, a43
    v_lshlrev_b32 v246, 16, v48
    v_and_b32 v247, 0xffff0000, v48
    v_accvgpr_read_b32 v48, a44
    v_lshlrev_b32 v248, 16, v48
    v_and_b32 v249, 0xffff0000, v48
    v_accvgpr_read_b32 v48, a45
    v_lshlrev_b32 v250, 16, v48
    v_and_b32 v251, 0xffff0000, v48
    v_accvgpr_read_b32 v48, a46
    v_lshlrev_b32 v252, 16, v48
    v_and_b32 v253, 0xffff0000, v48
    v_accvgpr_read_b32 v48, a47
    v_lshlrev_b32 v254, 16, v48
    v_and_b32 v255, 0xffff0000, v48
    v_lshlrev_b32 v4, 6, v0
    s_mov_b32 s71, 65536
    s_mov_b32 s99, 0
L_kl:
    buffer_load_dword v3, v4, s[8:11], s71 offen sc0 sc1
    s_add_u32 s99, s99, 1
    s_waitcnt vmcnt(0)
    v_cmp_eq_u32 vcc, 0, v3
    s_cbranch_vccz L_kd
    s_cmp_ge_u32 s99, 200000
    s_cbranch_scc1 L_kd
    s_sleep 3
    s_branch L_kl
L_kd:
    v_max_u32_dpp v3, v3, v3 quad_perm:[1,0,3,2] row_mask:0xf bank_mask:0xf
    s_nop 1
    v_max_u32_dpp v3, v3, v3 quad_perm:[2,3,0,1] row_mask:0xf bank_mask:0xf
    s_nop 1
    v_max_u32_dpp v3, v3, v3 row_half_mirror row_mask:0xf bank_mask:0xf
    s_nop 1
    v_max_u32_dpp v3, v3, v3 row_mirror row_mask:0xf bank_mask:0xf
    v_mov_b32 v19, v3
    s_nop 1
    v_permlane16_swap_b32 v3, v19
    v_max_u32 v3, v3, v19
    v_mov_b32 v19, v3
    s_nop 1
    v_permlane32_swap_b32 v3, v19
    v_max_u32 v3, v3, v19
    s_lshl_b32 s100, s3, 2
    v_mov_b32 v47, s100
    ds_write_b32 v47, v3 offset:64
    v_mov_b32 v47, 0
    s_waitcnt lgkmcnt(0)
    s_barrier
    ds_read_b128 v[52:55], v47 offset:64
    v_lshlrev_b32 v4, 2, v0
    s_waitcnt lgkmcnt(0)
    v_max_u32 v52, v52, v53
    v_max3_u32 v52, v52, v54, v55
    s_nop 0
    v_readfirstlane_b32 s71, v52
    s_and_b32 s72, s71, 2047
    s_lshr_b32 s100, s72, 7
    s_sub_u32 s101, 15, s100
    s_min_u32 s100, s100, s101
    s_lshl_b32 s100, s100, 16
    s_and_b32 s73, s72, 124
    s_lshl_b32 s73, s73, 9
    s_add_u32 s73, s73, s100
    s_add_u32 s73, s73, 524288
    buffer_load_dword v19, v4, s[8:11], s73 offen sc0 sc1
    s_lshl_b32 s100, s68, 10
    s_cmp_eq_u32 s68, s72
    s_cselect_b32 s100, 2147479552, s100
    buffer_store_dwordx2 v[56:57], v45, s[52:55], s100 offen
    buffer_store_dwordx2 v[58:59], v45, s[52:55], s100 offen offset:32
    s_lshl_b32 s100, s69, 10
    s_cmp_eq_u32 s69, s72
    s_cselect_b32 s100, 2147479552, s100
    buffer_store_dwordx2 v[60:61], v45, s[52:55], s100 offen
    buffer_store_dwordx2 v[62:63], v45, s[52:55], s100 offen offset:32
    s_cmp_ge_u32 s66, 224
    s_cbranch_scc1 L_nprod
    s_mov_b32 s99, 0
    s_waitcnt vmcnt(4)
L_hl:
    v_cmp_eq_u32 vcc, -1, v19
    s_add_u32 s99, s99, 1
    s_cbranch_vccz L_hok
    s_cmp_ge_u32 s99, 200000
    s_cbranch_scc1 L_hok
    buffer_load_dword v19, v4, s[8:11], s73 offen sc0 sc1
    s_waitcnt vmcnt(0)
    s_branch L_hl
L_hok:
    v_lshlrev_b32 v48, 16, v19
    v_and_b32 v50, 0xffff0000, v19
    v_pk_mul_f32 v[64:65], v[96:97], v[48:49] op_sel_hi:[1,0]
    v_pk_mul_f32 v[66:67], v[98:99], v[48:49] op_sel_hi:[1,0]
    v_pk_mul_f32 v[68:69], v[100:101], v[48:49] op_sel_hi:[1,0]
    v_pk_mul_f32 v[70:71], v[102:103], v[48:49] op_sel_hi:[1,0]
    v_pk_mul_f32 v[72:73], v[112:113], v[48:49] op_sel_hi:[1,0]
    v_pk_mul_f32 v[74:75], v[114:115], v[48:49] op_sel_hi:[1,0]
    v_pk_mul_f32 v[76:77], v[116:117], v[48:49] op_sel_hi:[1,0]
    v_pk_mul_f32 v[78:79], v[118:119], v[48:49] op_sel_hi:[1,0]
    v_pk_fma_f32 v[64:65], v[104:105], v[50:51], v[64:65] op_sel_hi:[1,0,1]
    v_pk_fma_f32 v[66:67], v[106:107], v[50:51], v[66:67] op_sel_hi:[1,0,1]
    v_pk_fma_f32 v[68:69], v[108:109], v[50:51], v[68:69] op_sel_hi:[1,0,1]
    v_pk_fma_f32 v[70:71], v[110:111], v[50:51], v[70:71] op_sel_hi:[1,0,1]
    v_pk_fma_f32 v[72:73], v[120:121], v[50:51], v[72:73] op_sel_hi:[1,0,1]
    v_pk_fma_f32 v[74:75], v[122:123], v[50:51], v[74:75] op_sel_hi:[1,0,1]
    v_pk_fma_f32 v[76:77], v[124:125], v[50:51], v[76:77] op_sel_hi:[1,0,1]
    v_pk_fma_f32 v[78:79], v[126:127], v[50:51], v[78:79] op_sel_hi:[1,0,1]
    v_permlane32_swap_b32 v64, v72
    v_permlane32_swap_b32 v65, v73
    v_permlane32_swap_b32 v66, v74
    v_permlane32_swap_b32 v67, v75
    v_permlane32_swap_b32 v68, v76
    v_permlane32_swap_b32 v69, v77
    v_permlane32_swap_b32 v70, v78
    v_permlane32_swap_b32 v71, v79
    v_add_f32 v64, v64, v72
    v_add_f32 v65, v65, v73
    v_add_f32 v66, v66, v74
    v_add_f32 v67, v67, v75
    v_add_f32 v68, v68, v76
    v_add_f32 v69, v69, v77
    v_add_f32 v70, v70, v78
    v_add_f32 v71, v71, v79
    v_permlane16_swap_b32 v64, v68
    v_permlane16_swap_b32 v65, v69
    v_permlane16_swap_b32 v66, v70
    v_permlane16_swap_b32 v67, v71
    v_add_f32 v64, v64, v68
    v_add_f32 v65, v65, v69
    v_add_f32 v66, v66, v70
    v_add_f32 v67, v67, v71
    v_add_f32_dpp v64, v64, v64 quad_perm:[1,0,3,2] row_mask:0xf bank_mask:0xf
    v_add_f32_dpp v65, v65, v65 quad_perm:[1,0,3,2] row_mask:0xf bank_mask:0xf
    v_add_f32_dpp v66, v66, v66 quad_perm:[1,0,3,2] row_mask:0xf bank_mask:0xf
    v_add_f32_dpp v67, v67, v67 quad_perm:[1,0,3,2] row_mask:0xf bank_mask:0xf
    v_add_f32_dpp v64, v64, v64 quad_perm:[2,3,0,1] row_mask:0xf bank_mask:0xf
    v_add_f32_dpp v65, v65, v65 quad_perm:[2,3,0,1] row_mask:0xf bank_mask:0xf
    v_add_f32_dpp v66, v66, v66 quad_perm:[2,3,0,1] row_mask:0xf bank_mask:0xf
    v_add_f32_dpp v67, v67, v67 quad_perm:[2,3,0,1] row_mask:0xf bank_mask:0xf
    v_add_f32_dpp v64, v64, v64 row_half_mirror row_mask:0xf bank_mask:0xf
    v_add_f32_dpp v65, v65, v65 row_half_mirror row_mask:0xf bank_mask:0xf
    v_add_f32_dpp v66, v66, v66 row_half_mirror row_mask:0xf bank_mask:0xf
    v_add_f32_dpp v67, v67, v67 row_half_mirror row_mask:0xf bank_mask:0xf
    v_add_f32_dpp v64, v64, v64 row_mirror row_mask:0xf bank_mask:0xf
    v_add_f32_dpp v65, v65, v65 row_mirror row_mask:0xf bank_mask:0xf
    v_add_f32_dpp v66, v66, v66 row_mirror row_mask:0xf bank_mask:0xf
    v_add_f32_dpp v67, v67, v67 row_mirror row_mask:0xf bank_mask:0xf
    v_and_b32 v50, 15, v2
    v_cmp_eq_u32 vcc, 0, v50
    v_mov_b32 v51, 1024
    s_nop 0
    v_cndmask_b32 v51, v51, v0, vcc
    ds_write_b128 v51, v[64:67] offset:256
    v_lshlrev_b32 v50, 2, v50
    s_waitcnt lgkmcnt(0)
    s_barrier
    s_cmp_lg_u32 s3, 0
    s_cbranch_scc1 L_nprod
    ds_read_b32 v64, v50 offset:256
    ds_read_b32 v65, v50 offset:320
    ds_read_b32 v66, v50 offset:384
    ds_read_b32 v67, v50 offset:448
    v_cmp_gt_u32 vcc, 8, v2
    v_mov_b32 v51, 2147479552
    s_nop 0
    v_cndmask_b32 v51, v51, v50, vcc
    s_lshl_b32 s100, s66, 6
    s_add_u32 s100, s100, 81920
    s_waitcnt lgkmcnt(2)
    v_add_f32 v64, v64, v65
    s_waitcnt lgkmcnt(0)
    v_add_f32 v66, v66, v67
    v_add_f32 v64, v64, v66
    v_cvt_pk_bf16_f32 v64, v64, v64
    v_and_b32 v64, 0xffff0000, v64
    s_nop 1
    v_mov_b32_dpp v65, v64 row_ror:8 row_mask:0xf bank_mask:0xf
    v_mul_f32 v66, 0xbfb8aa3b, v64
    v_exp_f32 v66, v66
    s_nop 0
    v_add_f32 v66, 1.0, v66
    v_rcp_f32 v66, v66
    s_nop 0
    v_mul_f32 v64, v64, v66
    v_cvt_pk_bf16_f32 v64, v64, v64
    v_and_b32 v64, 0xffff0000, v64
    v_mul_f32 v64, v64, v65
    v_cvt_pk_bf16_f32 v64, v64, v64
    v_and_b32 v64, 0xffff0000, v64
    buffer_store_dword v64, v51, s[8:11], s100 offen sc0 sc1
L_nprod:
    s_cmp_ge_u32 s67, 64
    s_cbranch_scc1 L_fin
    v_lshlrev_b32 v4, 6, v0
    v_cmp_gt_u32 vcc, 224, v0
    v_mov_b32 v51, 2147479552
    s_nop 0
    v_cndmask_b32 v4, v51, v4, vcc
    s_mov_b32 s100, 81920
    v_and_b32 v52, 7, v2
    s_lshl_b32 s101, s67, 3
    v_add_u32 v52, s101, v52
    v_lshrrev_b32 v53, 5, v52
    v_lshlrev_b32 v53, 6, v53
    v_and_b32 v54, 12, v52
    v_lshl_add_u32 v53, v54, 2, v53
    v_bfe_u32 v54, v52, 4, 1
    v_lshl_add_u32 v53, v54, 3, v53
    v_and_b32 v54, 2, v52
    v_lshl_add_u32 v53, v54, 1, v53
    v_lshlrev_b32 v54, 2, v52
    s_mov_b32 s101, 10240
    buffer_load_dword v55, v54, s[8:11], s101 offen
    s_sleep 8
    buffer_load_dwordx4 v[80:83], v4, s[8:11], s100 offen sc0 sc1
    buffer_load_dwordx4 v[84:87], v4, s[8:11], s100 offen offset:16 sc0 sc1
    buffer_load_dword v88, v53, s[8:11], s73 offen sc0 sc1
    buffer_load_dword v89, v53, s[8:11], s73 offen offset:1024 sc0 sc1
    s_and_b32 s101, s71, 0xfffff800
    s_or_b32 s101, s101, 0x400
    v_mov_b32 v90, s101
    v_not_b32 v91, v90
    v_ashrrev_i32 v91, 31, v91
    v_or_b32 v91, 0x80000000, v91
    v_xor_b32 v90, v90, v91
    v_cvt_pk_bf16_f32 v90, v90, v90
    v_and_b32 v90, 0xffff0000, v90
    v_mul_f32 v90, 0xbfb8aa3b, v90
    v_exp_f32 v90, v90
    s_nop 0
    v_add_f32 v90, 1.0, v90
    v_rcp_f32 v90, v90
    s_nop 0
    v_cvt_pk_bf16_f32 v90, v90, v90
    v_and_b32 v90, 0xffff0000, v90
    s_mov_b32 s99, 0
L_ACT_l_27:
    s_waitcnt vmcnt(0)
    v_max_u32 v3, v80, v81
    v_max3_u32 v3, v3, v82, v83
    v_max3_u32 v3, v3, v84, v85
    v_max3_u32 v3, v3, v86, v87
    v_max3_u32 v3, v3, v88, v89
    v_cmp_eq_u32 vcc, -1, v3
    s_add_u32 s99, s99, 1
    s_cbranch_vccz L_ACT_ok_28
    s_cmp_ge_u32 s99, 200000
    s_cbranch_scc1 L_ACT_ok_28
    s_sleep 3
    buffer_load_dwordx4 v[80:83], v4, s[8:11], s100 offen sc0 sc1
    buffer_load_dwordx4 v[84:87], v4, s[8:11], s100 offen offset:16 sc0 sc1
    buffer_load_dword v88, v53, s[8:11], s73 offen sc0 sc1
    buffer_load_dword v89, v53, s[8:11], s73 offen offset:1024 sc0 sc1
    s_branch L_ACT_l_27
L_ACT_ok_28:
    v_pk_mul_f32 v[64:65], v[128:129], v[80:81] op_sel_hi:[1,0]
    v_pk_mul_f32 v[66:67], v[130:131], v[80:81] op_sel_hi:[1,0]
    v_pk_mul_f32 v[68:69], v[132:133], v[80:81] op_sel_hi:[1,0]
    v_pk_mul_f32 v[70:71], v[134:135], v[80:81] op_sel_hi:[1,0]
    v_pk_fma_f32 v[64:65], v[136:137], v[80:81], v[64:65] op_sel:[0,1,0] op_sel_hi:[1,1,1]
    v_pk_fma_f32 v[66:67], v[138:139], v[80:81], v[66:67] op_sel:[0,1,0] op_sel_hi:[1,1,1]
    v_pk_fma_f32 v[68:69], v[140:141], v[80:81], v[68:69] op_sel:[0,1,0] op_sel_hi:[1,1,1]
    v_pk_fma_f32 v[70:71], v[142:143], v[80:81], v[70:71] op_sel:[0,1,0] op_sel_hi:[1,1,1]
    v_pk_fma_f32 v[64:65], v[144:145], v[82:83], v[64:65] op_sel:[0,0,0] op_sel_hi:[1,0,1]
    v_pk_fma_f32 v[66:67], v[146:147], v[82:83], v[66:67] op_sel:[0,0,0] op_sel_hi:[1,0,1]
    v_pk_fma_f32 v[68:69], v[148:149], v[82:83], v[68:69] op_sel:[0,0,0] op_sel_hi:[1,0,1]
    v_pk_fma_f32 v[70:71], v[150:151], v[82:83], v[70:71] op_sel:[0,0,0] op_sel_hi:[1,0,1]
    v_pk_fma_f32 v[64:65], v[152:153], v[82:83], v[64:65] op_sel:[0,1,0] op_sel_hi:[1,1,1]
    v_pk_fma_f32 v[66:67], v[154:155], v[82:83], v[66:67] op_sel:[0,1,0] op_sel_hi:[1,1,1]
    v_pk_fma_f32 v[68:69], v[156:157], v[82:83], v[68:69] op_sel:[0,1,0] op_sel_hi:[1,1,1]
    v_pk_fma_f32 v[70:71], v[158:159], v[82:83], v[70:71] op_sel:[0,1,0] op_sel_hi:[1,1,1]
    v_pk_fma_f32 v[64:65], v[224:225], v[84:85], v[64:65] op_sel:[0,0,0] op_sel_hi:[1,0,1]
    v_pk_fma_f32 v[66:67], v[226:227], v[84:85], v[66:67] op_sel:[0,0,0] op_sel_hi:[1,0,1]
    v_pk_fma_f32 v[68:69], v[228:229], v[84:85], v[68:69] op_sel:[0,0,0] op_sel_hi:[1,0,1]
    v_pk_fma_f32 v[70:71], v[230:231], v[84:85], v[70:71] op_sel:[0,0,0] op_sel_hi:[1,0,1]
    v_pk_fma_f32 v[64:65], v[232:233], v[84:85], v[64:65] op_sel:[0,1,0] op_sel_hi:[1,1,1]
    v_pk_fma_f32 v[66:67], v[234:235], v[84:85], v[66:67] op_sel:[0,1,0] op_sel_hi:[1,1,1]
    v_pk_fma_f32 v[68:69], v[236:237], v[84:85], v[68:69] op_sel:[0,1,0] op_sel_hi:[1,1,1]
    v_pk_fma_f32 v[70:71], v[238:239], v[84:85], v[70:71] op_sel:[0,1,0] op_sel_hi:[1,1,1]
    v_pk_fma_f32 v[64:65], v[240:241], v[86:87], v[64:65] op_sel:[0,0,0] op_sel_hi:[1,0,1]
    v_pk_fma_f32 v[66:67], v[242:243], v[86:87], v[66:67] op_sel:[0,0,0] op_sel_hi:[1,0,1]
    v_pk_fma_f32 v[68:69], v[244:245], v[86:87], v[68:69] op_sel:[0,0,0] op_sel_hi:[1,0,1]
    v_pk_fma_f32 v[70:71], v[246:247], v[86:87], v[70:71] op_sel:[0,0,0] op_sel_hi:[1,0,1]
    v_pk_fma_f32 v[64:65], v[248:249], v[86:87], v[64:65] op_sel:[0,1,0] op_sel_hi:[1,1,1]
    v_pk_fma_f32 v[66:67], v[250:251], v[86:87], v[66:67] op_sel:[0,1,0] op_sel_hi:[1,1,1]
    v_pk_fma_f32 v[68:69], v[252:253], v[86:87], v[68:69] op_sel:[0,1,0] op_sel_hi:[1,1,1]
    v_pk_fma_f32 v[70:71], v[254:255], v[86:87], v[70:71] op_sel:[0,1,0] op_sel_hi:[1,1,1]
    s_nop 0
    v_permlane32_swap_b32 v64, v68
    v_permlane32_swap_b32 v65, v69
    v_permlane32_swap_b32 v66, v70
    v_permlane32_swap_b32 v67, v71
    v_add_f32 v64, v64, v68
    v_add_f32 v65, v65, v69
    v_add_f32 v66, v66, v70
    v_add_f32 v67, v67, v71
    s_nop 0
    v_permlane16_swap_b32 v64, v66
    v_permlane16_swap_b32 v65, v67
    v_add_f32 v64, v64, v66
    v_add_f32 v65, v65, v67
    s_nop 0
    v_add_f32_dpp v64, v64, v64 quad_perm:[1,0,3,2] row_mask:0xf bank_mask:0xf
    v_add_f32_dpp v65, v65, v65 quad_perm:[1,0,3,2] row_mask:0xf bank_mask:0xf
    s_nop 0
    v_add_f32_dpp v64, v64, v64 quad_perm:[2,3,0,1] row_mask:0xf bank_mask:0xf
    v_add_f32_dpp v65, v65, v65 quad_perm:[2,3,0,1] row_mask:0xf bank_mask:0xf
    s_nop 0
    v_add_f32_dpp v64, v64, v64 row_half_mirror row_mask:0xf bank_mask:0xf
    v_add_f32_dpp v65, v65, v65 row_half_mirror row_mask:0xf bank_mask:0xf
    s_nop 0
    v_add_f32_dpp v64, v64, v64 row_mirror row_mask:0xf bank_mask:0xf
    v_add_f32_dpp v65, v65, v65 row_mirror row_mask:0xf bank_mask:0xf
    v_and_b32 v50, 15, v2
    v_cmp_eq_u32 vcc, 0, v50
    v_lshrrev_b32 v51, 1, v0
    v_mov_b32 v50, 1024
    v_cndmask_b32 v51, v50, v51, vcc
    ds_write_b64 v51, v[64:65] offset:2048
    v_and_b32 v50, 7, v2
    v_lshlrev_b32 v50, 2, v50
    v_and_b32 v51, 1, v52
    v_cmp_eq_u32 vcc, 0, v51
    v_lshlrev_b32 v91, 16, v88
    v_and_b32 v88, 0xffff0000, v88
    v_cndmask_b32 v88, v88, v91, vcc
    v_lshlrev_b32 v91, 16, v89
    v_and_b32 v89, 0xffff0000, v89
    v_cndmask_b32 v89, v89, v91, vcc
    s_waitcnt lgkmcnt(0)
    s_barrier
    s_cmp_lg_u32 s3, 0
    s_cbranch_scc1 L_fin
    ds_read_b32 v64, v50 offset:2048
    ds_read_b32 v65, v50 offset:2080
    ds_read_b32 v66, v50 offset:2112
    ds_read_b32 v67, v50 offset:2144
    v_cmp_gt_u32 vcc, 8, v2
    v_lshlrev_b32 v52, 1, v52
    v_mov_b32 v51, 2147479552
    v_cndmask_b32 v52, v51, v52, vcc
    s_lshl_b32 s100, s72, 10
    s_waitcnt lgkmcnt(2)
    v_add_f32 v64, v64, v65
    s_waitcnt lgkmcnt(0)
    v_add_f32 v66, v66, v67
    v_add_f32 v64, v64, v66
    v_cvt_pk_bf16_f32 v64, v64, v64
    v_and_b32 v64, 0xffff0000, v64
    v_mul_f32 v64, v64, v90
    v_cvt_pk_bf16_f32 v64, v64, v64
    v_and_b32 v64, 0xffff0000, v64
    v_add_f32 v64, v64, v88
    v_cvt_pk_bf16_f32 v64, v64, v64
    v_and_b32 v64, 0xffff0000, v64
    v_mul_f32 v64, v64, v55
    v_cvt_pk_bf16_f32 v64, v64, v64
    v_and_b32 v64, 0xffff0000, v64
    v_add_f32 v64, v64, v89
    v_cvt_pk_bf16_f32 v64, v64, v64
    buffer_store_short v64, v52, s[52:55], s100 offen
L_fin:
L_end:
    s_endpgm
L_E_slow_1:
    s_mov_b32 s99, 0
L_E_slow_1_l:
    s_sleep 4
    buffer_load_dword v3, v4, s[36:39], 0 offen sc0 sc1
    s_add_u32 s99, s99, 1
    s_waitcnt vmcnt(0)
    v_cmp_le_u32 vcc, 64, v3
    s_cmp_eq_u64 vcc, -1
    s_cbranch_scc1 L_E_ok_2
    s_cmp_lt_u32 s99, 200000
    s_cbranch_scc1 L_E_slow_1_l
    s_branch L_E_ok_2
L_H_slow_3:
    s_mov_b32 s99, 0
L_H_slow_3_l:
    s_sleep 4
    buffer_load_dword v3, v16, s[8:11], s78 offen sc0 sc1
    s_add_u32 s99, s99, 1
    s_waitcnt vmcnt(0)
    v_cmp_ne_u32 vcc, 0, v3
    s_cmp_eq_u64 vcc, -1
    s_cbranch_scc1 L_H_ok_4
    s_cmp_lt_u32 s99, 200000
    s_cbranch_scc1 L_H_slow_3_l
    s_branch L_H_ok_4
L_E2_slow_5:
    s_mov_b32 s99, 0
L_E2_slow_5_l:
    s_sleep 4
    buffer_load_dword v118, v4, s[36:39], s69 offen sc0 sc1
    s_add_u32 s99, s99, 1
    s_waitcnt vmcnt(0)
    v_cmp_le_u32 vcc, 128, v118
    s_cmp_eq_u64 vcc, -1
    s_cbranch_scc1 L_E2_ok_6
    s_cmp_lt_u32 s99, 200000
    s_cbranch_scc1 L_E2_slow_5_l
    s_branch L_E2_ok_6
L_KV_slow_7:
    s_mov_b32 s99, 0
L_KV_slow_7_l:
    s_sleep 4
    buffer_load_dword v3, v17, s[8:11], s74 offen sc0 sc1
    s_add_u32 s99, s99, 1
    s_waitcnt vmcnt(0)
    v_cmp_ne_u32 vcc, 0, v3
    s_cmp_eq_u64 vcc, -1
    s_cbranch_scc1 L_KV_ok_8
    s_cmp_lt_u32 s99, 200000
    s_cbranch_scc1 L_KV_slow_7_l
    s_branch L_KV_ok_8
L_t1_zero:
    v_mov_b64 v[128:129], 0
    v_mov_b64 v[130:131], 0
    v_mov_b64 v[132:133], 0
    v_mov_b64 v[134:135], 0
    v_mov_b64 v[136:137], 0
    v_mov_b64 v[138:139], 0
    v_mov_b64 v[140:141], 0
    v_mov_b64 v[142:143], 0
    v_mov_b64 v[144:145], 0
    v_mov_b64 v[146:147], 0
    v_mov_b64 v[148:149], 0
    v_mov_b64 v[150:151], 0
    v_mov_b64 v[152:153], 0
    v_mov_b64 v[154:155], 0
    v_mov_b64 v[156:157], 0
    v_mov_b64 v[158:159], 0
    v_mov_b64 v[160:161], 0
    v_mov_b64 v[162:163], 0
    v_mov_b64 v[164:165], 0
    v_mov_b64 v[166:167], 0
    v_mov_b64 v[168:169], 0
    v_mov_b64 v[170:171], 0
    v_mov_b64 v[172:173], 0
    v_mov_b64 v[174:175], 0
    v_mov_b64 v[176:177], 0
    v_mov_b64 v[178:179], 0
    v_mov_b64 v[180:181], 0
    v_mov_b64 v[182:183], 0
    v_mov_b64 v[184:185], 0
    v_mov_b64 v[186:187], 0
    v_mov_b64 v[188:189], 0
    v_mov_b64 v[190:191], 0
    v_mov_b64 v[192:193], 0
    v_mov_b64 v[194:195], 0
    v_mov_b64 v[196:197], 0
    v_mov_b64 v[198:199], 0
    v_mov_b64 v[200:201], 0
    v_mov_b64 v[202:203], 0
    v_mov_b64 v[204:205], 0
    v_mov_b64 v[206:207], 0
    v_mov_b64 v[208:209], 0
    v_mov_b64 v[210:211], 0
    v_mov_b64 v[212:213], 0
    v_mov_b64 v[214:215], 0
    v_mov_b64 v[216:217], 0
    v_mov_b64 v[218:219], 0
    v_mov_b64 v[220:221], 0
    v_mov_b64 v[222:223], 0
    v_mov_b64 v[224:225], 0
    v_mov_b64 v[226:227], 0
    v_mov_b64 v[228:229], 0
    v_mov_b64 v[230:231], 0
    v_mov_b64 v[232:233], 0
    v_mov_b64 v[234:235], 0
    v_mov_b64 v[236:237], 0
    v_mov_b64 v[238:239], 0
    v_mov_b64 v[240:241], 0
    v_mov_b64 v[242:243], 0
    v_mov_b64 v[244:245], 0
    v_mov_b64 v[246:247], 0
    v_mov_b64 v[248:249], 0
    v_mov_b64 v[250:251], 0
    v_mov_b64 v[252:253], 0
    v_mov_b64 v[254:255], 0
    v_mov_b64 v[32:33], 0
    v_mov_b64 v[34:35], 0
    v_mov_b64 v[36:37], 0
    v_mov_b64 v[38:39], 0
    v_mov_b64 v[40:41], 0
    v_mov_b64 v[42:43], 0
    v_mov_b64 v[44:45], 0
    v_mov_b64 v[46:47], 0
    v_add_f32 v80, 0, v22
    v_min_f32 v80, v80, v72
    v_add_f32 v81, 0xf1800000, v22
    v_min_f32 v81, v81, v73
    v_add_f32 v82, 0xf2000000, v22
    v_min_f32 v82, v82, v74
    v_add_f32 v83, 0xf2400000, v22
    v_min_f32 v83, v83, v75
    v_add_f32 v84, 0xf3800000, v22
    v_min_f32 v84, v84, v72
    v_add_f32 v85, 0xf3880000, v22
    v_min_f32 v85, v85, v73
    v_add_f32 v86, 0xf3900000, v22
    v_min_f32 v86, v86, v74
    v_add_f32 v87, 0xf3980000, v22
    v_min_f32 v87, v87, v75
    v_add_f32 v88, 0x73800000, v22
    v_min_f32 v88, v88, v76
    v_add_f32 v89, 0x73700000, v22
    v_min_f32 v89, v89, v77
    v_add_f32 v90, 0x73600000, v22
    v_min_f32 v90, v90, v78
    v_add_f32 v91, 0x73500000, v22
    v_min_f32 v91, v91, v79
    v_add_f32 v92, 0, v22
    v_min_f32 v92, v92, v76
    v_add_f32 v93, 0xf1800000, v22
    v_min_f32 v93, v93, v77
    v_add_f32 v94, 0xf2000000, v22
    v_min_f32 v94, v94, v78
    v_add_f32 v95, 0xf2400000, v22
    v_min_f32 v95, v95, v79
    s_nop 1
    s_branch L_t1_diagC
L_t1_redo:
    s_cmp_eq_u32 s25, 0
    s_cbranch_scc1 L_t1_max
    s_mov_b32 s25, 0
    v_mov_b32 v64, 0
    v_mov_b32 v65, 0
    v_mov_b32 v66, 0
    v_mov_b32 v67, 0
    v_mov_b32 v68, 0
    v_mov_b32 v69, 0
    v_mov_b32 v70, 0
    v_mov_b32 v71, 0
    v_mov_b32 v72, 0
    v_mov_b32 v73, 0
    v_mov_b32 v74, 0
    v_mov_b32 v75, 0
    v_mov_b32 v76, 0
    v_mov_b32 v77, 0
    v_mov_b32 v78, 0
    v_mov_b32 v79, 0
    s_nop 1
    s_branch L_t1_safe
L_t1_max:
    s_waitcnt vmcnt(0) lgkmcnt(0)
    s_barrier
    s_mov_b32 s25, 1
    s_and_b32 s100, s3, 1
    s_lshl_b32 s100, s100, 13
    s_sub_u32 s101, s81, s62
    s_add_u32 s101, s101, s100
    s_mov_b32 s14, s60
    v_mov_b32 v48, 0xff800000
    v_mov_b32 v49, 0xff800000
    v_mov_b32 v50, 0xff800000
    v_mov_b32 v51, 0xff800000
L_t1_maxl:
    s_cmp_eq_u32 s14, 0
    s_cbranch_scc1 L_t1_maxd
    s_add_u32 s100, s101, 0
    buffer_load_dwordx4 a[128:131], v1, s[8:11], s100 offen offset:0
    buffer_load_dwordx4 a[132:135], v1, s[8:11], s100 offen offset:1024
    buffer_load_dwordx4 a[136:139], v1, s[8:11], s100 offen offset:2048
    buffer_load_dwordx4 a[140:143], v1, s[8:11], s100 offen offset:3072
    buffer_load_dwordx4 a[144:147], v15, s[8:11], s100 offen offset:0
    buffer_load_dwordx4 a[148:151], v15, s[8:11], s100 offen offset:1024
    buffer_load_dwordx4 a[152:155], v15, s[8:11], s100 offen offset:2048
    buffer_load_dwordx4 a[156:159], v15, s[8:11], s100 offen offset:3072
    s_waitcnt vmcnt(7)
    v_mfma_f32_16x16x32_bf16 v[96:99], a[128:131], a[64:67], v[64:67]
    s_waitcnt vmcnt(6)
    v_mfma_f32_16x16x32_bf16 v[96:99], a[132:135], a[68:71], v[96:99]
    s_waitcnt vmcnt(5)
    v_mfma_f32_16x16x32_bf16 v[96:99], a[136:139], a[72:75], v[96:99]
    s_waitcnt vmcnt(4)
    v_mfma_f32_16x16x32_bf16 v[96:99], a[140:143], a[76:79], v[96:99]
    v_mfma_f32_16x16x32_bf16 v[104:107], a[128:131], a[80:83], v[68:71]
    v_mfma_f32_16x16x32_bf16 v[104:107], a[132:135], a[84:87], v[104:107]
    v_mfma_f32_16x16x32_bf16 v[104:107], a[136:139], a[88:91], v[104:107]
    v_mfma_f32_16x16x32_bf16 v[104:107], a[140:143], a[92:95], v[104:107]
    s_waitcnt vmcnt(3)
    v_mfma_f32_16x16x32_bf16 v[100:103], a[144:147], a[64:67], v[64:67]
    s_waitcnt vmcnt(2)
    v_mfma_f32_16x16x32_bf16 v[100:103], a[148:151], a[68:71], v[100:103]
    s_waitcnt vmcnt(1)
    v_mfma_f32_16x16x32_bf16 v[100:103], a[152:155], a[72:75], v[100:103]
    s_waitcnt vmcnt(0)
    v_mfma_f32_16x16x32_bf16 v[100:103], a[156:159], a[76:79], v[100:103]
    v_mfma_f32_16x16x32_bf16 v[108:111], a[144:147], a[80:83], v[68:71]
    v_mfma_f32_16x16x32_bf16 v[108:111], a[148:151], a[84:87], v[108:111]
    v_mfma_f32_16x16x32_bf16 v[108:111], a[152:155], a[88:91], v[108:111]
    v_mfma_f32_16x16x32_bf16 v[108:111], a[156:159], a[92:95], v[108:111]
    v_mfma_f32_16x16x32_bf16 v[112:115], a[128:131], a[96:99], v[72:75]
    v_mfma_f32_16x16x32_bf16 v[112:115], a[132:135], a[100:103], v[112:115]
    v_mfma_f32_16x16x32_bf16 v[112:115], a[136:139], a[104:107], v[112:115]
    v_mfma_f32_16x16x32_bf16 v[112:115], a[140:143], a[108:111], v[112:115]
    v_mfma_f32_16x16x32_bf16 v[120:123], a[128:131], a[112:115], v[76:79]
    v_mfma_f32_16x16x32_bf16 v[120:123], a[132:135], a[116:119], v[120:123]
    v_mfma_f32_16x16x32_bf16 v[120:123], a[136:139], a[120:123], v[120:123]
    v_mfma_f32_16x16x32_bf16 v[120:123], a[140:143], a[124:127], v[120:123]
    v_mfma_f32_16x16x32_bf16 v[116:119], a[144:147], a[96:99], v[72:75]
    v_mfma_f32_16x16x32_bf16 v[116:119], a[148:151], a[100:103], v[116:119]
    v_mfma_f32_16x16x32_bf16 v[116:119], a[152:155], a[104:107], v[116:119]
    v_mfma_f32_16x16x32_bf16 v[116:119], a[156:159], a[108:111], v[116:119]
    v_mfma_f32_16x16x32_bf16 v[124:127], a[144:147], a[112:115], v[76:79]
    v_mfma_f32_16x16x32_bf16 v[124:127], a[148:151], a[116:119], v[124:127]
    v_mfma_f32_16x16x32_bf16 v[124:127], a[152:155], a[120:123], v[124:127]
    v_mfma_f32_16x16x32_bf16 v[124:127], a[156:159], a[124:127], v[124:127]
    v_max3_f32 v48, v48, v96, v97
    v_max3_f32 v48, v48, v98, v99
    v_max3_f32 v48, v48, v100, v101
    v_max3_f32 v48, v48, v102, v103
    v_max3_f32 v49, v49, v104, v105
    v_max3_f32 v49, v49, v106, v107
    v_max3_f32 v49, v49, v108, v109
    v_max3_f32 v49, v49, v110, v111
    v_max3_f32 v50, v50, v112, v113
    v_max3_f32 v50, v50, v114, v115
    v_max3_f32 v50, v50, v116, v117
    v_max3_f32 v50, v50, v118, v119
    v_max3_f32 v51, v51, v120, v121
    v_max3_f32 v51, v51, v122, v123
    v_max3_f32 v51, v51, v124, v125
    v_max3_f32 v51, v51, v126, v127
    s_add_u32 s100, s101, 16384
    buffer_load_dwordx4 a[128:131], v1, s[8:11], s100 offen offset:0
    buffer_load_dwordx4 a[132:135], v1, s[8:11], s100 offen offset:1024
    buffer_load_dwordx4 a[136:139], v1, s[8:11], s100 offen offset:2048
    buffer_load_dwordx4 a[140:143], v1, s[8:11], s100 offen offset:3072
    buffer_load_dwordx4 a[144:147], v15, s[8:11], s100 offen offset:0
    buffer_load_dwordx4 a[148:151], v15, s[8:11], s100 offen offset:1024
    buffer_load_dwordx4 a[152:155], v15, s[8:11], s100 offen offset:2048
    buffer_load_dwordx4 a[156:159], v15, s[8:11], s100 offen offset:3072
    s_waitcnt vmcnt(7)
    v_mfma_f32_16x16x32_bf16 v[96:99], a[128:131], a[64:67], v[64:67]
    s_waitcnt vmcnt(6)
    v_mfma_f32_16x16x32_bf16 v[96:99], a[132:135], a[68:71], v[96:99]
    s_waitcnt vmcnt(5)
    v_mfma_f32_16x16x32_bf16 v[96:99], a[136:139], a[72:75], v[96:99]
    s_waitcnt vmcnt(4)
    v_mfma_f32_16x16x32_bf16 v[96:99], a[140:143], a[76:79], v[96:99]
    v_mfma_f32_16x16x32_bf16 v[104:107], a[128:131], a[80:83], v[68:71]
    v_mfma_f32_16x16x32_bf16 v[104:107], a[132:135], a[84:87], v[104:107]
    v_mfma_f32_16x16x32_bf16 v[104:107], a[136:139], a[88:91], v[104:107]
    v_mfma_f32_16x16x32_bf16 v[104:107], a[140:143], a[92:95], v[104:107]
    s_waitcnt vmcnt(3)
    v_mfma_f32_16x16x32_bf16 v[100:103], a[144:147], a[64:67], v[64:67]
    s_waitcnt vmcnt(2)
    v_mfma_f32_16x16x32_bf16 v[100:103], a[148:151], a[68:71], v[100:103]
    s_waitcnt vmcnt(1)
    v_mfma_f32_16x16x32_bf16 v[100:103], a[152:155], a[72:75], v[100:103]
    s_waitcnt vmcnt(0)
    v_mfma_f32_16x16x32_bf16 v[100:103], a[156:159], a[76:79], v[100:103]
    v_mfma_f32_16x16x32_bf16 v[108:111], a[144:147], a[80:83], v[68:71]
    v_mfma_f32_16x16x32_bf16 v[108:111], a[148:151], a[84:87], v[108:111]
    v_mfma_f32_16x16x32_bf16 v[108:111], a[152:155], a[88:91], v[108:111]
    v_mfma_f32_16x16x32_bf16 v[108:111], a[156:159], a[92:95], v[108:111]
    v_mfma_f32_16x16x32_bf16 v[112:115], a[128:131], a[96:99], v[72:75]
    v_mfma_f32_16x16x32_bf16 v[112:115], a[132:135], a[100:103], v[112:115]
    v_mfma_f32_16x16x32_bf16 v[112:115], a[136:139], a[104:107], v[112:115]
    v_mfma_f32_16x16x32_bf16 v[112:115], a[140:143], a[108:111], v[112:115]
    v_mfma_f32_16x16x32_bf16 v[120:123], a[128:131], a[112:115], v[76:79]
    v_mfma_f32_16x16x32_bf16 v[120:123], a[132:135], a[116:119], v[120:123]
    v_mfma_f32_16x16x32_bf16 v[120:123], a[136:139], a[120:123], v[120:123]
    v_mfma_f32_16x16x32_bf16 v[120:123], a[140:143], a[124:127], v[120:123]
    v_mfma_f32_16x16x32_bf16 v[116:119], a[144:147], a[96:99], v[72:75]
    v_mfma_f32_16x16x32_bf16 v[116:119], a[148:151], a[100:103], v[116:119]
    v_mfma_f32_16x16x32_bf16 v[116:119], a[152:155], a[104:107], v[116:119]
    v_mfma_f32_16x16x32_bf16 v[116:119], a[156:159], a[108:111], v[116:119]
    v_mfma_f32_16x16x32_bf16 v[124:127], a[144:147], a[112:115], v[76:79]
    v_mfma_f32_16x16x32_bf16 v[124:127], a[148:151], a[116:119], v[124:127]
    v_mfma_f32_16x16x32_bf16 v[124:127], a[152:155], a[120:123], v[124:127]
    v_mfma_f32_16x16x32_bf16 v[124:127], a[156:159], a[124:127], v[124:127]
    v_max3_f32 v48, v48, v96, v97
    v_max3_f32 v48, v48, v98, v99
    v_max3_f32 v48, v48, v100, v101
    v_max3_f32 v48, v48, v102, v103
    v_max3_f32 v49, v49, v104, v105
    v_max3_f32 v49, v49, v106, v107
    v_max3_f32 v49, v49, v108, v109
    v_max3_f32 v49, v49, v110, v111
    v_max3_f32 v50, v50, v112, v113
    v_max3_f32 v50, v50, v114, v115
    v_max3_f32 v50, v50, v116, v117
    v_max3_f32 v50, v50, v118, v119
    v_max3_f32 v51, v51, v120, v121
    v_max3_f32 v51, v51, v122, v123
    v_max3_f32 v51, v51, v124, v125
    v_max3_f32 v51, v51, v126, v127
    s_add_u32 s101, s101, 65536
    s_sub_u32 s14, s14, 1
    s_nop 7
    s_branch L_t1_maxl
L_t1_maxd:
    s_add_u32 s100, s101, 0
    buffer_load_dwordx4 a[128:131], v1, s[8:11], s100 offen offset:0
    buffer_load_dwordx4 a[132:135], v1, s[8:11], s100 offen offset:1024
    buffer_load_dwordx4 a[136:139], v1, s[8:11], s100 offen offset:2048
    buffer_load_dwordx4 a[140:143], v1, s[8:11], s100 offen offset:3072
    buffer_load_dwordx4 a[144:147], v15, s[8:11], s100 offen offset:0
    buffer_load_dwordx4 a[148:151], v15, s[8:11], s100 offen offset:1024
    buffer_load_dwordx4 a[152:155], v15, s[8:11], s100 offen offset:2048
    buffer_load_dwordx4 a[156:159], v15, s[8:11], s100 offen offset:3072
    v_add_f32 v80, 0, v21
    v_min_f32 v80, v80, v64
    v_add_f32 v81, 0xf1800000, v21
    v_min_f32 v81, v81, v65
    v_add_f32 v82, 0xf2000000, v21
    v_min_f32 v82, v82, v66
    v_add_f32 v83, 0xf2400000, v21
    v_min_f32 v83, v83, v67
    v_add_f32 v84, 0xf3800000, v21
    v_min_f32 v84, v84, v64
    v_add_f32 v85, 0xf3880000, v21
    v_min_f32 v85, v85, v65
    v_add_f32 v86, 0xf3900000, v21
    v_min_f32 v86, v86, v66
    v_add_f32 v87, 0xf3980000, v21
    v_min_f32 v87, v87, v67
    v_add_f32 v88, 0x73800000, v21
    v_min_f32 v88, v88, v68
    v_add_f32 v89, 0x73700000, v21
    v_min_f32 v89, v89, v69
    v_add_f32 v90, 0x73600000, v21
    v_min_f32 v90, v90, v70
    v_add_f32 v91, 0x73500000, v21
    v_min_f32 v91, v91, v71
    v_add_f32 v92, 0, v21
    v_min_f32 v92, v92, v68
    v_add_f32 v93, 0xf1800000, v21
    v_min_f32 v93, v93, v69
    v_add_f32 v94, 0xf2000000, v21
    v_min_f32 v94, v94, v70
    v_add_f32 v95, 0xf2400000, v21
    v_min_f32 v95, v95, v71
    s_waitcnt vmcnt(7)
    v_mfma_f32_16x16x32_bf16 v[96:99], a[128:131], a[64:67], v[80:83]
    s_waitcnt vmcnt(6)
    v_mfma_f32_16x16x32_bf16 v[96:99], a[132:135], a[68:71], v[96:99]
    s_waitcnt vmcnt(5)
    v_mfma_f32_16x16x32_bf16 v[96:99], a[136:139], a[72:75], v[96:99]
    s_waitcnt vmcnt(4)
    v_mfma_f32_16x16x32_bf16 v[96:99], a[140:143], a[76:79], v[96:99]
    v_mfma_f32_16x16x32_bf16 v[104:107], a[128:131], a[80:83], v[88:91]
    v_mfma_f32_16x16x32_bf16 v[104:107], a[132:135], a[84:87], v[104:107]
    v_mfma_f32_16x16x32_bf16 v[104:107], a[136:139], a[88:91], v[104:107]
    v_mfma_f32_16x16x32_bf16 v[104:107], a[140:143], a[92:95], v[104:107]
    s_waitcnt vmcnt(3)
    v_mfma_f32_16x16x32_bf16 v[100:103], a[144:147], a[64:67], v[84:87]
    s_waitcnt vmcnt(2)
    v_mfma_f32_16x16x32_bf16 v[100:103], a[148:151], a[68:71], v[100:103]
    s_waitcnt vmcnt(1)
    v_mfma_f32_16x16x32_bf16 v[100:103], a[152:155], a[72:75], v[100:103]
    s_waitcnt vmcnt(0)
    v_mfma_f32_16x16x32_bf16 v[100:103], a[156:159], a[76:79], v[100:103]
    v_mfma_f32_16x16x32_bf16 v[108:111], a[144:147], a[80:83], v[92:95]
    v_mfma_f32_16x16x32_bf16 v[108:111], a[148:151], a[84:87], v[108:111]
    v_mfma_f32_16x16x32_bf16 v[108:111], a[152:155], a[88:91], v[108:111]
    v_mfma_f32_16x16x32_bf16 v[108:111], a[156:159], a[92:95], v[108:111]
    v_mfma_f32_16x16x32_bf16 v[112:115], a[128:131], a[96:99], v[72:75]
    v_mfma_f32_16x16x32_bf16 v[112:115], a[132:135], a[100:103], v[112:115]
    v_mfma_f32_16x16x32_bf16 v[112:115], a[136:139], a[104:107], v[112:115]
    v_mfma_f32_16x16x32_bf16 v[112:115], a[140:143], a[108:111], v[112:115]
    v_mfma_f32_16x16x32_bf16 v[120:123], a[128:131], a[112:115], v[76:79]
    v_mfma_f32_16x16x32_bf16 v[120:123], a[132:135], a[116:119], v[120:123]
    v_mfma_f32_16x16x32_bf16 v[120:123], a[136:139], a[120:123], v[120:123]
    v_mfma_f32_16x16x32_bf16 v[120:123], a[140:143], a[124:127], v[120:123]
    v_mfma_f32_16x16x32_bf16 v[116:119], a[144:147], a[96:99], v[72:75]
    v_mfma_f32_16x16x32_bf16 v[116:119], a[148:151], a[100:103], v[116:119]
    v_mfma_f32_16x16x32_bf16 v[116:119], a[152:155], a[104:107], v[116:119]
    v_mfma_f32_16x16x32_bf16 v[116:119], a[156:159], a[108:111], v[116:119]
    v_mfma_f32_16x16x32_bf16 v[124:127], a[144:147], a[112:115], v[76:79]
    v_mfma_f32_16x16x32_bf16 v[124:127], a[148:151], a[116:119], v[124:127]
    v_mfma_f32_16x16x32_bf16 v[124:127], a[152:155], a[120:123], v[124:127]
    v_mfma_f32_16x16x32_bf16 v[124:127], a[156:159], a[124:127], v[124:127]
    v_max3_f32 v48, v48, v96, v97
    v_max3_f32 v48, v48, v98, v99
    v_max3_f32 v48, v48, v100, v101
    v_max3_f32 v48, v48, v102, v103
    v_max3_f32 v49, v49, v104, v105
    v_max3_f32 v49, v49, v106, v107
    v_max3_f32 v49, v49, v108, v109
    v_max3_f32 v49, v49, v110, v111
    v_max3_f32 v50, v50, v112, v113
    v_max3_f32 v50, v50, v114, v115
    v_max3_f32 v50, v50, v116, v117
    v_max3_f32 v50, v50, v118, v119
    v_max3_f32 v51, v51, v120, v121
    v_max3_f32 v51, v51, v122, v123
    v_max3_f32 v51, v51, v124, v125
    v_max3_f32 v51, v51, v126, v127
    s_add_u32 s100, s101, 16384
    buffer_load_dwordx4 a[128:131], v1, s[8:11], s100 offen offset:0
    buffer_load_dwordx4 a[132:135], v1, s[8:11], s100 offen offset:1024
    buffer_load_dwordx4 a[136:139], v1, s[8:11], s100 offen offset:2048
    buffer_load_dwordx4 a[140:143], v1, s[8:11], s100 offen offset:3072
    buffer_load_dwordx4 a[144:147], v15, s[8:11], s100 offen offset:0
    buffer_load_dwordx4 a[148:151], v15, s[8:11], s100 offen offset:1024
    buffer_load_dwordx4 a[152:155], v15, s[8:11], s100 offen offset:2048
    buffer_load_dwordx4 a[156:159], v15, s[8:11], s100 offen offset:3072
    v_add_f32 v80, 0, v22
    v_min_f32 v80, v80, v72
    v_add_f32 v81, 0xf1800000, v22
    v_min_f32 v81, v81, v73
    v_add_f32 v82, 0xf2000000, v22
    v_min_f32 v82, v82, v74
    v_add_f32 v83, 0xf2400000, v22
    v_min_f32 v83, v83, v75
    v_add_f32 v84, 0xf3800000, v22
    v_min_f32 v84, v84, v72
    v_add_f32 v85, 0xf3880000, v22
    v_min_f32 v85, v85, v73
    v_add_f32 v86, 0xf3900000, v22
    v_min_f32 v86, v86, v74
    v_add_f32 v87, 0xf3980000, v22
    v_min_f32 v87, v87, v75
    v_add_f32 v88, 0x73800000, v22
    v_min_f32 v88, v88, v76
    v_add_f32 v89, 0x73700000, v22
    v_min_f32 v89, v89, v77
    v_add_f32 v90, 0x73600000, v22
    v_min_f32 v90, v90, v78
    v_add_f32 v91, 0x73500000, v22
    v_min_f32 v91, v91, v79
    v_add_f32 v92, 0, v22
    v_min_f32 v92, v92, v76
    v_add_f32 v93, 0xf1800000, v22
    v_min_f32 v93, v93, v77
    v_add_f32 v94, 0xf2000000, v22
    v_min_f32 v94, v94, v78
    v_add_f32 v95, 0xf2400000, v22
    v_min_f32 v95, v95, v79
    s_waitcnt vmcnt(7)
    v_mfma_f32_16x16x32_bf16 v[96:99], a[128:131], a[96:99], v[80:83]
    s_waitcnt vmcnt(6)
    v_mfma_f32_16x16x32_bf16 v[96:99], a[132:135], a[100:103], v[96:99]
    s_waitcnt vmcnt(5)
    v_mfma_f32_16x16x32_bf16 v[96:99], a[136:139], a[104:107], v[96:99]
    s_waitcnt vmcnt(4)
    v_mfma_f32_16x16x32_bf16 v[96:99], a[140:143], a[108:111], v[96:99]
    v_mfma_f32_16x16x32_bf16 v[104:107], a[128:131], a[112:115], v[88:91]
    v_mfma_f32_16x16x32_bf16 v[104:107], a[132:135], a[116:119], v[104:107]
    v_mfma_f32_16x16x32_bf16 v[104:107], a[136:139], a[120:123], v[104:107]
    v_mfma_f32_16x16x32_bf16 v[104:107], a[140:143], a[124:127], v[104:107]
    s_waitcnt vmcnt(3)
    v_mfma_f32_16x16x32_bf16 v[100:103], a[144:147], a[96:99], v[84:87]
    s_waitcnt vmcnt(2)
    v_mfma_f32_16x16x32_bf16 v[100:103], a[148:151], a[100:103], v[100:103]
    s_waitcnt vmcnt(1)
    v_mfma_f32_16x16x32_bf16 v[100:103], a[152:155], a[104:107], v[100:103]
    s_waitcnt vmcnt(0)
    v_mfma_f32_16x16x32_bf16 v[100:103], a[156:159], a[108:111], v[100:103]
    v_mfma_f32_16x16x32_bf16 v[108:111], a[144:147], a[112:115], v[92:95]
    v_mfma_f32_16x16x32_bf16 v[108:111], a[148:151], a[116:119], v[108:111]
    v_mfma_f32_16x16x32_bf16 v[108:111], a[152:155], a[120:123], v[108:111]
    v_mfma_f32_16x16x32_bf16 v[108:111], a[156:159], a[124:127], v[108:111]
    v_max3_f32 v50, v50, v96, v97
    v_max3_f32 v50, v50, v98, v99
    s_nop 1
    v_max3_f32 v50, v50, v100, v101
    v_max3_f32 v50, v50, v102, v103
    v_max3_f32 v51, v51, v104, v105
    v_max3_f32 v51, v51, v106, v107
    v_max3_f32 v51, v51, v108, v109
    v_max3_f32 v51, v51, v110, v111
    v_mov_b32 v52, v48
    v_mov_b32 v53, v49
    v_mov_b32 v54, v50
    v_mov_b32 v55, v51
    v_permlane16_swap_b32 v48, v52
    v_permlane16_swap_b32 v49, v53
    v_permlane16_swap_b32 v50, v54
    v_permlane16_swap_b32 v51, v55
    v_max_f32 v48, v48, v52
    v_max_f32 v49, v49, v53
    v_max_f32 v50, v50, v54
    v_max_f32 v51, v51, v55
    v_mov_b32 v52, v48
    v_mov_b32 v53, v49
    v_mov_b32 v54, v50
    v_mov_b32 v55, v51
    v_permlane32_swap_b32 v48, v52
    v_permlane32_swap_b32 v49, v53
    v_permlane32_swap_b32 v50, v54
    v_permlane32_swap_b32 v51, v55
    v_max_f32 v48, v48, v52
    v_max_f32 v49, v49, v53
    v_max_f32 v50, v50, v54
    v_max_f32 v51, v51, v55
    ds_write_b128 v16, v[48:51] offset:32768
    v_xor_b32 v8, 8192, v16
    s_waitcnt lgkmcnt(0)
    s_barrier
    ds_read_b128 v[52:55], v8 offset:32768
    s_waitcnt lgkmcnt(0)
    v_max_f32 v48, v48, v52
    v_max_f32 v49, v49, v53
    v_max_f32 v50, v50, v54
    v_max_f32 v51, v51, v55
    v_sub_f32 v64, 0, v48
    v_sub_f32 v65, 0, v48
    v_sub_f32 v66, 0, v48
    v_sub_f32 v67, 0, v48
    v_sub_f32 v68, 0, v49
    v_sub_f32 v69, 0, v49
    v_sub_f32 v70, 0, v49
    v_sub_f32 v71, 0, v49
    v_sub_f32 v72, 0, v50
    v_sub_f32 v73, 0, v50
    v_sub_f32 v74, 0, v50
    v_sub_f32 v75, 0, v50
    v_sub_f32 v76, 0, v51
    v_sub_f32 v77, 0, v51
    v_sub_f32 v78, 0, v51
    v_sub_f32 v79, 0, v51
    s_mov_b32 s12, 0
    s_and_b32 s100, s12, 1
    s_mul_i32 s15, s100, 196608
    s_xor_b32 s15, s15, 65536
    s_mul_i32 s16, s100, 98304
    s_xor_b32 s16, s16, 98304
    v_and_b32 v18, 0x7fff, v18
    v_or_b32 v18, s15, v18
    v_and_b32 v19, 0x7fff, v19
    v_or_b32 v19, s16, v19
    v_and_b32 v20, 0x7fff, v20
    v_or_b32 v20, s16, v20
    s_add_u32 s15, s15, s62
    s_add_u32 s16, s16, s62
    s_add_u32 s12, s12, 2
    s_mov_b32 s82, s81
    s_add_u32 s19, s81, 32768
    s_add_u32 m0, s15, 0
    s_nop 0
    buffer_load_dwordx4 v1, s[8:11], s82 offen offset:0 lds
    buffer_load_dwordx4 v1, s[8:11], s82 offen offset:1024 lds
    buffer_load_dwordx4 v1, s[8:11], s82 offen offset:2048 lds
    buffer_load_dwordx4 v1, s[8:11], s82 offen offset:3072 lds
    s_add_u32 m0, s15, 4096
    s_nop 0
    buffer_load_dwordx4 v15, s[8:11], s82 offen offset:0 lds
    buffer_load_dwordx4 v15, s[8:11], s82 offen offset:1024 lds
    buffer_load_dwordx4 v15, s[8:11], s82 offen offset:2048 lds
    buffer_load_dwordx4 v15, s[8:11], s82 offen offset:3072 lds
    s_xor_b32 s15, s15, 196608
    s_add_u32 m0, s16, 0
    s_nop 0
    buffer_load_dwordx4 v1, s[8:11], s19 offen offset:0 lds
    buffer_load_dwordx4 v1, s[8:11], s19 offen offset:1024 lds
    buffer_load_dwordx4 v1, s[8:11], s19 offen offset:2048 lds
    buffer_load_dwordx4 v1, s[8:11], s19 offen offset:3072 lds
    s_add_u32 m0, s16, 4096
    s_nop 0
    buffer_load_dwordx4 v15, s[8:11], s19 offen offset:0 lds
    buffer_load_dwordx4 v15, s[8:11], s19 offen offset:1024 lds
    buffer_load_dwordx4 v15, s[8:11], s19 offen offset:2048 lds
    buffer_load_dwordx4 v15, s[8:11], s19 offen offset:3072 lds
    s_xor_b32 s16, s16, 98304
    s_min_u32 s82, s60, 1
    s_lshl_b32 s82, s82, 16
    s_add_u32 s82, s82, s81
    s_add_u32 m0, s15, 0
    s_nop 0
    buffer_load_dwordx4 v1, s[8:11], s82 offen offset:0 lds
    buffer_load_dwordx4 v1, s[8:11], s82 offen offset:1024 lds
    buffer_load_dwordx4 v1, s[8:11], s82 offen offset:2048 lds
    buffer_load_dwordx4 v1, s[8:11], s82 offen offset:3072 lds
    s_add_u32 m0, s15, 4096
    s_nop 0
    buffer_load_dwordx4 v15, s[8:11], s82 offen offset:0 lds
    buffer_load_dwordx4 v15, s[8:11], s82 offen offset:1024 lds
    buffer_load_dwordx4 v15, s[8:11], s82 offen offset:2048 lds
    buffer_load_dwordx4 v15, s[8:11], s82 offen offset:3072 lds
    s_xor_b32 s15, s15, 196608
    v_add_f32 v80, 0, v21
    v_min_f32 v80, v80, v64
    v_add_f32 v81, 0xf1800000, v21
    v_min_f32 v81, v81, v65
    v_add_f32 v82, 0xf2000000, v21
    v_min_f32 v82, v82, v66
    v_add_f32 v83, 0xf2400000, v21
    v_min_f32 v83, v83, v67
    v_add_f32 v84, 0xf3800000, v21
    v_min_f32 v84, v84, v64
    v_add_f32 v85, 0xf3880000, v21
    v_min_f32 v85, v85, v65
    v_add_f32 v86, 0xf3900000, v21
    v_min_f32 v86, v86, v66
    v_add_f32 v87, 0xf3980000, v21
    v_min_f32 v87, v87, v67
    v_add_f32 v88, 0x73800000, v21
    v_min_f32 v88, v88, v68
    v_add_f32 v89, 0x73700000, v21
    v_min_f32 v89, v89, v69
    v_add_f32 v90, 0x73600000, v21
    v_min_f32 v90, v90, v70
    v_add_f32 v91, 0x73500000, v21
    v_min_f32 v91, v91, v71
    v_add_f32 v92, 0, v21
    v_min_f32 v92, v92, v68
    v_add_f32 v93, 0xf1800000, v21
    v_min_f32 v93, v93, v69
    v_add_f32 v94, 0xf2000000, v21
    v_min_f32 v94, v94, v70
    v_add_f32 v95, 0xf2400000, v21
    v_min_f32 v95, v95, v71
    s_cmp_eq_u32 s60, 0
    s_cselect_b32 s19, 0, 0x76800000
    v_add_f32 v3, s19, v21
    v_add_f32 v96, 0, v3
    v_min_f32 v96, v96, v64
    v_add_f32 v97, 0xf1800000, v3
    v_min_f32 v97, v97, v65
    v_add_f32 v98, 0xf2000000, v3
    v_min_f32 v98, v98, v66
    v_add_f32 v99, 0xf2400000, v3
    v_min_f32 v99, v99, v67
    v_add_f32 v100, 0xf3800000, v3
    v_min_f32 v100, v100, v64
    v_add_f32 v101, 0xf3880000, v3
    v_min_f32 v101, v101, v65
    v_add_f32 v102, 0xf3900000, v3
    v_min_f32 v102, v102, v66
    v_add_f32 v103, 0xf3980000, v3
    v_min_f32 v103, v103, v67
    v_add_f32 v104, 0x73800000, v3
    v_min_f32 v104, v104, v68
    v_add_f32 v105, 0x73700000, v3
    v_min_f32 v105, v105, v69
    v_add_f32 v106, 0x73600000, v3
    v_min_f32 v106, v106, v70
    v_add_f32 v107, 0x73500000, v3
    v_min_f32 v107, v107, v71
    v_add_f32 v108, 0, v3
    v_min_f32 v108, v108, v68
    v_add_f32 v109, 0xf1800000, v3
    v_min_f32 v109, v109, v69
    v_add_f32 v110, 0xf2000000, v3
    v_min_f32 v110, v110, v70
    v_add_f32 v111, 0xf2400000, v3
    v_min_f32 v111, v111, v71
    s_waitcnt vmcnt(0) lgkmcnt(0)
    s_barrier
    ds_read_b128 a[128:131], v18 offset:0
    ds_read_b128 a[132:135], v18 offset:1024
    ds_read_b128 a[136:139], v18 offset:2048
    ds_read_b128 a[140:143], v18 offset:3072
    ds_read_b128 a[144:147], v18 offset:4096
    ds_read_b128 a[148:151], v18 offset:5120
    ds_read_b128 a[152:155], v18 offset:6144
    ds_read_b128 a[156:159], v18 offset:7168
    s_waitcnt lgkmcnt(0)
    s_branch L_t1_start
L_C1_slow_9:
    s_mov_b32 s99, 0
L_C1_slow_9_l:
    s_sleep 4
    buffer_load_dword v3, v4, s[8:11], s23 offen sc0 sc1
    s_add_u32 s99, s99, 1
    s_waitcnt vmcnt(0)
    v_cmp_ne_u32 vcc, 0, v3
    s_cmp_eq_u64 vcc, -1
    s_cbranch_scc1 L_C1_ok_10
    s_cmp_lt_u32 s99, 200000
    s_cbranch_scc1 L_C1_slow_9_l
    s_branch L_C1_ok_10
L_F_slow_11:
    s_mov_b32 s99, 0
L_F_slow_11_l:
    s_sleep 4
    buffer_load_dword v3, v12, s[36:39], s71 offen sc0 sc1
    s_add_u32 s99, s99, 1
    s_waitcnt vmcnt(0)
    v_cmp_le_u32 vcc, 256, v3
    s_cmp_eq_u64 vcc, -1
    s_cbranch_scc1 L_F_ok_12
    s_cmp_lt_u32 s99, 200000
    s_cbranch_scc1 L_F_slow_11_l
    s_branch L_F_ok_12
L_t2_redo:
    s_cmp_eq_u32 s25, 0
    s_cbranch_scc1 L_t2_max
    s_mov_b32 s25, 0
    v_mov_b32 v64, 0
    v_mov_b32 v65, 0
    v_mov_b32 v66, 0
    v_mov_b32 v67, 0
    v_mov_b32 v68, 0
    v_mov_b32 v69, 0
    v_mov_b32 v70, 0
    v_mov_b32 v71, 0
    v_mov_b32 v72, 0
    v_mov_b32 v73, 0
    v_mov_b32 v74, 0
    v_mov_b32 v75, 0
    v_mov_b32 v76, 0
    v_mov_b32 v77, 0
    v_mov_b32 v78, 0
    v_mov_b32 v79, 0
    s_nop 1
    s_branch L_t2_safe
L_t2_max:
    s_waitcnt vmcnt(0) lgkmcnt(0)
    s_barrier
    s_mov_b32 s25, 1
    s_and_b32 s100, s3, 1
    s_lshl_b32 s100, s100, 13
    s_sub_u32 s101, s81, s62
    s_add_u32 s101, s101, s100
    s_mov_b32 s14, s61
    s_mov_b32 s26, 0
    v_mov_b32 v24, -1
    v_mov_b32 v25, -1
    v_mov_b32 v26, -1
    v_mov_b32 v27, -1
    v_mov_b32 v48, 0xff800000
    v_mov_b32 v49, 0xff800000
    v_mov_b32 v50, 0xff800000
    v_mov_b32 v51, 0xff800000
L_t2_maxl:
    s_cmp_eq_u32 s14, 0
    s_cbranch_scc1 L_t2_maxd
    s_add_u32 s100, s101, 0
    buffer_load_dwordx4 a[128:131], v1, s[8:11], s100 offen offset:0
    buffer_load_dwordx4 a[132:135], v1, s[8:11], s100 offen offset:1024
    buffer_load_dwordx4 a[136:139], v1, s[8:11], s100 offen offset:2048
    buffer_load_dwordx4 a[140:143], v1, s[8:11], s100 offen offset:3072
    buffer_load_dwordx4 a[144:147], v15, s[8:11], s100 offen offset:0
    buffer_load_dwordx4 a[148:151], v15, s[8:11], s100 offen offset:1024
    buffer_load_dwordx4 a[152:155], v15, s[8:11], s100 offen offset:2048
    buffer_load_dwordx4 a[156:159], v15, s[8:11], s100 offen offset:3072
    s_waitcnt vmcnt(7)
    v_mfma_f32_16x16x32_bf16 v[96:99], a[128:131], a[192:195], v[64:67]
    s_waitcnt vmcnt(6)
    v_mfma_f32_16x16x32_bf16 v[96:99], a[132:135], a[196:199], v[96:99]
    s_waitcnt vmcnt(5)
    v_mfma_f32_16x16x32_bf16 v[96:99], a[136:139], a[200:203], v[96:99]
    s_waitcnt vmcnt(4)
    v_mfma_f32_16x16x32_bf16 v[96:99], a[140:143], a[204:207], v[96:99]
    v_mfma_f32_16x16x32_bf16 v[104:107], a[128:131], a[208:211], v[68:71]
    v_mfma_f32_16x16x32_bf16 v[104:107], a[132:135], a[212:215], v[104:107]
    v_mfma_f32_16x16x32_bf16 v[104:107], a[136:139], a[216:219], v[104:107]
    v_mfma_f32_16x16x32_bf16 v[104:107], a[140:143], a[220:223], v[104:107]
    s_waitcnt vmcnt(3)
    v_mfma_f32_16x16x32_bf16 v[100:103], a[144:147], a[192:195], v[64:67]
    s_waitcnt vmcnt(2)
    v_mfma_f32_16x16x32_bf16 v[100:103], a[148:151], a[196:199], v[100:103]
    s_waitcnt vmcnt(1)
    v_mfma_f32_16x16x32_bf16 v[100:103], a[152:155], a[200:203], v[100:103]
    s_waitcnt vmcnt(0)
    v_mfma_f32_16x16x32_bf16 v[100:103], a[156:159], a[204:207], v[100:103]
    v_mfma_f32_16x16x32_bf16 v[108:111], a[144:147], a[208:211], v[68:71]
    v_mfma_f32_16x16x32_bf16 v[108:111], a[148:151], a[212:215], v[108:111]
    v_mfma_f32_16x16x32_bf16 v[108:111], a[152:155], a[216:219], v[108:111]
    v_mfma_f32_16x16x32_bf16 v[108:111], a[156:159], a[220:223], v[108:111]
    v_mfma_f32_16x16x32_bf16 v[112:115], a[128:131], a[224:227], v[72:75]
    v_mfma_f32_16x16x32_bf16 v[112:115], a[132:135], a[228:231], v[112:115]
    v_mfma_f32_16x16x32_bf16 v[112:115], a[136:139], a[232:235], v[112:115]
    v_mfma_f32_16x16x32_bf16 v[112:115], a[140:143], a[236:239], v[112:115]
    v_mfma_f32_16x16x32_bf16 v[120:123], a[128:131], a[240:243], v[76:79]
    v_mfma_f32_16x16x32_bf16 v[120:123], a[132:135], a[244:247], v[120:123]
    v_mfma_f32_16x16x32_bf16 v[120:123], a[136:139], a[248:251], v[120:123]
    v_mfma_f32_16x16x32_bf16 v[120:123], a[140:143], a[252:255], v[120:123]
    v_mfma_f32_16x16x32_bf16 v[116:119], a[144:147], a[224:227], v[72:75]
    v_mfma_f32_16x16x32_bf16 v[116:119], a[148:151], a[228:231], v[116:119]
    v_mfma_f32_16x16x32_bf16 v[116:119], a[152:155], a[232:235], v[116:119]
    v_mfma_f32_16x16x32_bf16 v[116:119], a[156:159], a[236:239], v[116:119]
    v_mfma_f32_16x16x32_bf16 v[124:127], a[144:147], a[240:243], v[76:79]
    v_mfma_f32_16x16x32_bf16 v[124:127], a[148:151], a[244:247], v[124:127]
    v_mfma_f32_16x16x32_bf16 v[124:127], a[152:155], a[248:251], v[124:127]
    v_mfma_f32_16x16x32_bf16 v[124:127], a[156:159], a[252:255], v[124:127]
    v_max3_f32 v48, v48, v96, v97
    v_max3_f32 v48, v48, v98, v99
    v_max3_f32 v48, v48, v100, v101
    v_max3_f32 v48, v48, v102, v103
    v_max3_f32 v49, v49, v104, v105
    v_max3_f32 v49, v49, v106, v107
    v_max3_f32 v49, v49, v108, v109
    v_max3_f32 v49, v49, v110, v111
    v_max3_f32 v50, v50, v112, v113
    v_max3_f32 v50, v50, v114, v115
    v_max3_f32 v50, v50, v116, v117
    v_max3_f32 v50, v50, v118, v119
    v_max3_f32 v51, v51, v120, v121
    v_max3_f32 v51, v51, v122, v123
    v_max3_f32 v51, v51, v124, v125
    v_max3_f32 v51, v51, v126, v127
    s_add_u32 s100, s101, 16384
    buffer_load_dwordx4 a[128:131], v1, s[8:11], s100 offen offset:0
    buffer_load_dwordx4 a[132:135], v1, s[8:11], s100 offen offset:1024
    buffer_load_dwordx4 a[136:139], v1, s[8:11], s100 offen offset:2048
    buffer_load_dwordx4 a[140:143], v1, s[8:11], s100 offen offset:3072
    buffer_load_dwordx4 a[144:147], v15, s[8:11], s100 offen offset:0
    buffer_load_dwordx4 a[148:151], v15, s[8:11], s100 offen offset:1024
    buffer_load_dwordx4 a[152:155], v15, s[8:11], s100 offen offset:2048
    buffer_load_dwordx4 a[156:159], v15, s[8:11], s100 offen offset:3072
    s_waitcnt vmcnt(7)
    v_mfma_f32_16x16x32_bf16 v[96:99], a[128:131], a[192:195], v[64:67]
    s_waitcnt vmcnt(6)
    v_mfma_f32_16x16x32_bf16 v[96:99], a[132:135], a[196:199], v[96:99]
    s_waitcnt vmcnt(5)
    v_mfma_f32_16x16x32_bf16 v[96:99], a[136:139], a[200:203], v[96:99]
    s_waitcnt vmcnt(4)
    v_mfma_f32_16x16x32_bf16 v[96:99], a[140:143], a[204:207], v[96:99]
    v_mfma_f32_16x16x32_bf16 v[104:107], a[128:131], a[208:211], v[68:71]
    v_mfma_f32_16x16x32_bf16 v[104:107], a[132:135], a[212:215], v[104:107]
    v_mfma_f32_16x16x32_bf16 v[104:107], a[136:139], a[216:219], v[104:107]
    v_mfma_f32_16x16x32_bf16 v[104:107], a[140:143], a[220:223], v[104:107]
    s_waitcnt vmcnt(3)
    v_mfma_f32_16x16x32_bf16 v[100:103], a[144:147], a[192:195], v[64:67]
    s_waitcnt vmcnt(2)
    v_mfma_f32_16x16x32_bf16 v[100:103], a[148:151], a[196:199], v[100:103]
    s_waitcnt vmcnt(1)
    v_mfma_f32_16x16x32_bf16 v[100:103], a[152:155], a[200:203], v[100:103]
    s_waitcnt vmcnt(0)
    v_mfma_f32_16x16x32_bf16 v[100:103], a[156:159], a[204:207], v[100:103]
    v_mfma_f32_16x16x32_bf16 v[108:111], a[144:147], a[208:211], v[68:71]
    v_mfma_f32_16x16x32_bf16 v[108:111], a[148:151], a[212:215], v[108:111]
    v_mfma_f32_16x16x32_bf16 v[108:111], a[152:155], a[216:219], v[108:111]
    v_mfma_f32_16x16x32_bf16 v[108:111], a[156:159], a[220:223], v[108:111]
    v_mfma_f32_16x16x32_bf16 v[112:115], a[128:131], a[224:227], v[72:75]
    v_mfma_f32_16x16x32_bf16 v[112:115], a[132:135], a[228:231], v[112:115]
    v_mfma_f32_16x16x32_bf16 v[112:115], a[136:139], a[232:235], v[112:115]
    v_mfma_f32_16x16x32_bf16 v[112:115], a[140:143], a[236:239], v[112:115]
    v_mfma_f32_16x16x32_bf16 v[120:123], a[128:131], a[240:243], v[76:79]
    v_mfma_f32_16x16x32_bf16 v[120:123], a[132:135], a[244:247], v[120:123]
    v_mfma_f32_16x16x32_bf16 v[120:123], a[136:139], a[248:251], v[120:123]
    v_mfma_f32_16x16x32_bf16 v[120:123], a[140:143], a[252:255], v[120:123]
    v_mfma_f32_16x16x32_bf16 v[116:119], a[144:147], a[224:227], v[72:75]
    v_mfma_f32_16x16x32_bf16 v[116:119], a[148:151], a[228:231], v[116:119]
    v_mfma_f32_16x16x32_bf16 v[116:119], a[152:155], a[232:235], v[116:119]
    v_mfma_f32_16x16x32_bf16 v[116:119], a[156:159], a[236:239], v[116:119]
    v_mfma_f32_16x16x32_bf16 v[124:127], a[144:147], a[240:243], v[76:79]
    v_mfma_f32_16x16x32_bf16 v[124:127], a[148:151], a[244:247], v[124:127]
    v_mfma_f32_16x16x32_bf16 v[124:127], a[152:155], a[248:251], v[124:127]
    v_mfma_f32_16x16x32_bf16 v[124:127], a[156:159], a[252:255], v[124:127]
    v_max3_f32 v48, v48, v96, v97
    v_max3_f32 v48, v48, v98, v99
    v_max3_f32 v48, v48, v100, v101
    v_max3_f32 v48, v48, v102, v103
    v_max3_f32 v49, v49, v104, v105
    v_max3_f32 v49, v49, v106, v107
    v_max3_f32 v49, v49, v108, v109
    v_max3_f32 v49, v49, v110, v111
    v_max3_f32 v50, v50, v112, v113
    v_max3_f32 v50, v50, v114, v115
    v_max3_f32 v50, v50, v116, v117
    v_max3_f32 v50, v50, v118, v119
    v_max3_f32 v51, v51, v120, v121
    v_max3_f32 v51, v51, v122, v123
    v_max3_f32 v51, v51, v124, v125
    v_max3_f32 v51, v51, v126, v127
    s_add_u32 s101, s101, 65536
    s_sub_u32 s14, s14, 1
    s_nop 7
    s_branch L_t2_maxl
L_t2_maxd:
    s_add_u32 s100, s101, 0
    buffer_load_dwordx4 a[128:131], v1, s[8:11], s100 offen offset:0
    buffer_load_dwordx4 a[132:135], v1, s[8:11], s100 offen offset:1024
    buffer_load_dwordx4 a[136:139], v1, s[8:11], s100 offen offset:2048
    buffer_load_dwordx4 a[140:143], v1, s[8:11], s100 offen offset:3072
    buffer_load_dwordx4 a[144:147], v15, s[8:11], s100 offen offset:0
    buffer_load_dwordx4 a[148:151], v15, s[8:11], s100 offen offset:1024
    buffer_load_dwordx4 a[152:155], v15, s[8:11], s100 offen offset:2048
    buffer_load_dwordx4 a[156:159], v15, s[8:11], s100 offen offset:3072
    v_add_f32 v80, 0, v21
    v_min_f32 v80, v80, v64
    v_add_f32 v81, 0xf1800000, v21
    v_min_f32 v81, v81, v65
    v_add_f32 v82, 0xf2000000, v21
    v_min_f32 v82, v82, v66
    v_add_f32 v83, 0xf2400000, v21
    v_min_f32 v83, v83, v67
    v_add_f32 v84, 0xf3800000, v21
    v_min_f32 v84, v84, v64
    v_add_f32 v85, 0xf3880000, v21
    v_min_f32 v85, v85, v65
    v_add_f32 v86, 0xf3900000, v21
    v_min_f32 v86, v86, v66
    v_add_f32 v87, 0xf3980000, v21
    v_min_f32 v87, v87, v67
    v_add_f32 v88, 0x73800000, v21
    v_min_f32 v88, v88, v68
    v_add_f32 v89, 0x73700000, v21
    v_min_f32 v89, v89, v69
    v_add_f32 v90, 0x73600000, v21
    v_min_f32 v90, v90, v70
    v_add_f32 v91, 0x73500000, v21
    v_min_f32 v91, v91, v71
    v_add_f32 v92, 0, v21
    v_min_f32 v92, v92, v68
    v_add_f32 v93, 0xf1800000, v21
    v_min_f32 v93, v93, v69
    v_add_f32 v94, 0xf2000000, v21
    v_min_f32 v94, v94, v70
    v_add_f32 v95, 0xf2400000, v21
    v_min_f32 v95, v95, v71
    s_waitcnt vmcnt(7)
    v_mfma_f32_16x16x32_bf16 v[96:99], a[128:131], a[192:195], v[80:83]
    s_waitcnt vmcnt(6)
    v_mfma_f32_16x16x32_bf16 v[96:99], a[132:135], a[196:199], v[96:99]
    s_waitcnt vmcnt(5)
    v_mfma_f32_16x16x32_bf16 v[96:99], a[136:139], a[200:203], v[96:99]
    s_waitcnt vmcnt(4)
    v_mfma_f32_16x16x32_bf16 v[96:99], a[140:143], a[204:207], v[96:99]
    v_mfma_f32_16x16x32_bf16 v[104:107], a[128:131], a[208:211], v[88:91]
    v_mfma_f32_16x16x32_bf16 v[104:107], a[132:135], a[212:215], v[104:107]
    v_mfma_f32_16x16x32_bf16 v[104:107], a[136:139], a[216:219], v[104:107]
    v_mfma_f32_16x16x32_bf16 v[104:107], a[140:143], a[220:223], v[104:107]
    s_waitcnt vmcnt(3)
    v_mfma_f32_16x16x32_bf16 v[100:103], a[144:147], a[192:195], v[84:87]
    s_waitcnt vmcnt(2)
    v_mfma_f32_16x16x32_bf16 v[100:103], a[148:151], a[196:199], v[100:103]
    s_waitcnt vmcnt(1)
    v_mfma_f32_16x16x32_bf16 v[100:103], a[152:155], a[200:203], v[100:103]
    s_waitcnt vmcnt(0)
    v_mfma_f32_16x16x32_bf16 v[100:103], a[156:159], a[204:207], v[100:103]
    v_mfma_f32_16x16x32_bf16 v[108:111], a[144:147], a[208:211], v[92:95]
    v_mfma_f32_16x16x32_bf16 v[108:111], a[148:151], a[212:215], v[108:111]
    v_mfma_f32_16x16x32_bf16 v[108:111], a[152:155], a[216:219], v[108:111]
    v_mfma_f32_16x16x32_bf16 v[108:111], a[156:159], a[220:223], v[108:111]
    v_mfma_f32_16x16x32_bf16 v[112:115], a[128:131], a[224:227], v[72:75]
    v_mfma_f32_16x16x32_bf16 v[112:115], a[132:135], a[228:231], v[112:115]
    v_mfma_f32_16x16x32_bf16 v[112:115], a[136:139], a[232:235], v[112:115]
    v_mfma_f32_16x16x32_bf16 v[112:115], a[140:143], a[236:239], v[112:115]
    v_mfma_f32_16x16x32_bf16 v[120:123], a[128:131], a[240:243], v[76:79]
    v_mfma_f32_16x16x32_bf16 v[120:123], a[132:135], a[244:247], v[120:123]
    v_mfma_f32_16x16x32_bf16 v[120:123], a[136:139], a[248:251], v[120:123]
    v_mfma_f32_16x16x32_bf16 v[120:123], a[140:143], a[252:255], v[120:123]
    v_mfma_f32_16x16x32_bf16 v[116:119], a[144:147], a[224:227], v[72:75]
    v_mfma_f32_16x16x32_bf16 v[116:119], a[148:151], a[228:231], v[116:119]
    v_mfma_f32_16x16x32_bf16 v[116:119], a[152:155], a[232:235], v[116:119]
    v_mfma_f32_16x16x32_bf16 v[116:119], a[156:159], a[236:239], v[116:119]
    v_mfma_f32_16x16x32_bf16 v[124:127], a[144:147], a[240:243], v[76:79]
    v_mfma_f32_16x16x32_bf16 v[124:127], a[148:151], a[244:247], v[124:127]
    v_mfma_f32_16x16x32_bf16 v[124:127], a[152:155], a[248:251], v[124:127]
    v_mfma_f32_16x16x32_bf16 v[124:127], a[156:159], a[252:255], v[124:127]
    v_max3_f32 v48, v48, v96, v97
    v_max3_f32 v48, v48, v98, v99
    v_max3_f32 v48, v48, v100, v101
    v_max3_f32 v48, v48, v102, v103
    v_max3_f32 v49, v49, v104, v105
    v_max3_f32 v49, v49, v106, v107
    v_max3_f32 v49, v49, v108, v109
    v_max3_f32 v49, v49, v110, v111
    v_max3_f32 v50, v50, v112, v113
    v_max3_f32 v50, v50, v114, v115
    v_max3_f32 v50, v50, v116, v117
    v_max3_f32 v50, v50, v118, v119
    v_max3_f32 v51, v51, v120, v121
    v_max3_f32 v51, v51, v122, v123
    v_max3_f32 v51, v51, v124, v125
    v_max3_f32 v51, v51, v126, v127
    s_add_u32 s100, s101, 16384
    buffer_load_dwordx4 a[128:131], v1, s[8:11], s100 offen offset:0
    buffer_load_dwordx4 a[132:135], v1, s[8:11], s100 offen offset:1024
    buffer_load_dwordx4 a[136:139], v1, s[8:11], s100 offen offset:2048
    buffer_load_dwordx4 a[140:143], v1, s[8:11], s100 offen offset:3072
    buffer_load_dwordx4 a[144:147], v15, s[8:11], s100 offen offset:0
    buffer_load_dwordx4 a[148:151], v15, s[8:11], s100 offen offset:1024
    buffer_load_dwordx4 a[152:155], v15, s[8:11], s100 offen offset:2048
    buffer_load_dwordx4 a[156:159], v15, s[8:11], s100 offen offset:3072
    v_add_f32 v80, 0, v22
    v_min_f32 v80, v80, v72
    v_add_f32 v81, 0xf1800000, v22
    v_min_f32 v81, v81, v73
    v_add_f32 v82, 0xf2000000, v22
    v_min_f32 v82, v82, v74
    v_add_f32 v83, 0xf2400000, v22
    v_min_f32 v83, v83, v75
    v_add_f32 v84, 0xf3800000, v22
    v_min_f32 v84, v84, v72
    v_add_f32 v85, 0xf3880000, v22
    v_min_f32 v85, v85, v73
    v_add_f32 v86, 0xf3900000, v22
    v_min_f32 v86, v86, v74
    v_add_f32 v87, 0xf3980000, v22
    v_min_f32 v87, v87, v75
    v_add_f32 v88, 0x73800000, v22
    v_min_f32 v88, v88, v76
    v_add_f32 v89, 0x73700000, v22
    v_min_f32 v89, v89, v77
    v_add_f32 v90, 0x73600000, v22
    v_min_f32 v90, v90, v78
    v_add_f32 v91, 0x73500000, v22
    v_min_f32 v91, v91, v79
    v_add_f32 v92, 0, v22
    v_min_f32 v92, v92, v76
    v_add_f32 v93, 0xf1800000, v22
    v_min_f32 v93, v93, v77
    v_add_f32 v94, 0xf2000000, v22
    v_min_f32 v94, v94, v78
    v_add_f32 v95, 0xf2400000, v22
    v_min_f32 v95, v95, v79
    s_waitcnt vmcnt(7)
    v_mfma_f32_16x16x32_bf16 v[96:99], a[128:131], a[224:227], v[80:83]
    s_waitcnt vmcnt(6)
    v_mfma_f32_16x16x32_bf16 v[96:99], a[132:135], a[228:231], v[96:99]
    s_waitcnt vmcnt(5)
    v_mfma_f32_16x16x32_bf16 v[96:99], a[136:139], a[232:235], v[96:99]
    s_waitcnt vmcnt(4)
    v_mfma_f32_16x16x32_bf16 v[96:99], a[140:143], a[236:239], v[96:99]
    v_mfma_f32_16x16x32_bf16 v[104:107], a[128:131], a[240:243], v[88:91]
    v_mfma_f32_16x16x32_bf16 v[104:107], a[132:135], a[244:247], v[104:107]
    v_mfma_f32_16x16x32_bf16 v[104:107], a[136:139], a[248:251], v[104:107]
    v_mfma_f32_16x16x32_bf16 v[104:107], a[140:143], a[252:255], v[104:107]
    s_waitcnt vmcnt(3)
    v_mfma_f32_16x16x32_bf16 v[100:103], a[144:147], a[224:227], v[84:87]
    s_waitcnt vmcnt(2)
    v_mfma_f32_16x16x32_bf16 v[100:103], a[148:151], a[228:231], v[100:103]
    s_waitcnt vmcnt(1)
    v_mfma_f32_16x16x32_bf16 v[100:103], a[152:155], a[232:235], v[100:103]
    s_waitcnt vmcnt(0)
    v_mfma_f32_16x16x32_bf16 v[100:103], a[156:159], a[236:239], v[100:103]
    v_mfma_f32_16x16x32_bf16 v[108:111], a[144:147], a[240:243], v[92:95]
    v_mfma_f32_16x16x32_bf16 v[108:111], a[148:151], a[244:247], v[108:111]
    v_mfma_f32_16x16x32_bf16 v[108:111], a[152:155], a[248:251], v[108:111]
    v_mfma_f32_16x16x32_bf16 v[108:111], a[156:159], a[252:255], v[108:111]
    v_max3_f32 v50, v50, v96, v97
    v_max3_f32 v50, v50, v98, v99
    s_nop 1
    v_max3_f32 v50, v50, v100, v101
    v_max3_f32 v50, v50, v102, v103
    v_max3_f32 v51, v51, v104, v105
    v_max3_f32 v51, v51, v106, v107
    v_max3_f32 v51, v51, v108, v109
    v_max3_f32 v51, v51, v110, v111
    v_mov_b32 v52, v48
    v_mov_b32 v53, v49
    v_mov_b32 v54, v50
    v_mov_b32 v55, v51
    v_permlane16_swap_b32 v48, v52
    v_permlane16_swap_b32 v49, v53
    v_permlane16_swap_b32 v50, v54
    v_permlane16_swap_b32 v51, v55
    v_max_f32 v48, v48, v52
    v_max_f32 v49, v49, v53
    v_max_f32 v50, v50, v54
    v_max_f32 v51, v51, v55
    v_mov_b32 v52, v48
    v_mov_b32 v53, v49
    v_mov_b32 v54, v50
    v_mov_b32 v55, v51
    v_permlane32_swap_b32 v48, v52
    v_permlane32_swap_b32 v49, v53
    v_permlane32_swap_b32 v50, v54
    v_permlane32_swap_b32 v51, v55
    v_max_f32 v48, v48, v52
    v_max_f32 v49, v49, v53
    v_max_f32 v50, v50, v54
    v_max_f32 v51, v51, v55
    ds_write_b128 v16, v[48:51] offset:32768
    v_xor_b32 v8, 8192, v16
    s_waitcnt lgkmcnt(0)
    s_barrier
    ds_read_b128 v[52:55], v8 offset:32768
    s_waitcnt lgkmcnt(0)
    v_max_f32 v48, v48, v52
    v_max_f32 v49, v49, v53
    v_max_f32 v50, v50, v54
    v_max_f32 v51, v51, v55
    v_sub_f32 v64, 0, v48
    v_sub_f32 v65, 0, v48
    v_sub_f32 v66, 0, v48
    v_sub_f32 v67, 0, v48
    v_sub_f32 v68, 0, v49
    v_sub_f32 v69, 0, v49
    v_sub_f32 v70, 0, v49
    v_sub_f32 v71, 0, v49
    v_sub_f32 v72, 0, v50
    v_sub_f32 v73, 0, v50
    v_sub_f32 v74, 0, v50
    v_sub_f32 v75, 0, v50
    v_sub_f32 v76, 0, v51
    v_sub_f32 v77, 0, v51
    v_sub_f32 v78, 0, v51
    v_sub_f32 v79, 0, v51
    s_add_u32 s12, s13, 1
    s_and_b32 s100, s12, 1
    s_mul_i32 s15, s100, 196608
    s_xor_b32 s15, s15, 65536
    s_mul_i32 s16, s100, 98304
    s_xor_b32 s16, s16, 98304
    v_and_b32 v18, 0x7fff, v18
    v_or_b32 v18, s15, v18
    v_and_b32 v19, 0x7fff, v19
    v_or_b32 v19, s16, v19
    v_and_b32 v20, 0x7fff, v20
    v_or_b32 v20, s16, v20
    s_add_u32 s15, s15, s62
    s_add_u32 s16, s16, s62
    s_add_u32 s12, s12, 2
    s_mov_b32 s82, s81
    s_add_u32 s19, s81, 32768
    s_add_u32 m0, s15, 0
    s_nop 0
    buffer_load_dwordx4 v1, s[8:11], s82 offen offset:0 lds
    buffer_load_dwordx4 v1, s[8:11], s82 offen offset:1024 lds
    buffer_load_dwordx4 v1, s[8:11], s82 offen offset:2048 lds
    buffer_load_dwordx4 v1, s[8:11], s82 offen offset:3072 lds
    s_add_u32 m0, s15, 4096
    s_nop 0
    buffer_load_dwordx4 v15, s[8:11], s82 offen offset:0 lds
    buffer_load_dwordx4 v15, s[8:11], s82 offen offset:1024 lds
    buffer_load_dwordx4 v15, s[8:11], s82 offen offset:2048 lds
    buffer_load_dwordx4 v15, s[8:11], s82 offen offset:3072 lds
    s_xor_b32 s15, s15, 196608
    s_add_u32 m0, s16, 0
    s_nop 0
    buffer_load_dwordx4 v1, s[8:11], s19 offen offset:0 lds
    buffer_load_dwordx4 v1, s[8:11], s19 offen offset:1024 lds
    buffer_load_dwordx4 v1, s[8:11], s19 offen offset:2048 lds
    buffer_load_dwordx4 v1, s[8:11], s19 offen offset:3072 lds
    s_add_u32 m0, s16, 4096
    s_nop 0
    buffer_load_dwordx4 v15, s[8:11], s19 offen offset:0 lds
    buffer_load_dwordx4 v15, s[8:11], s19 offen offset:1024 lds
    buffer_load_dwordx4 v15, s[8:11], s19 offen offset:2048 lds
    buffer_load_dwordx4 v15, s[8:11], s19 offen offset:3072 lds
    s_xor_b32 s16, s16, 98304
    s_min_u32 s82, s61, 1
    s_lshl_b32 s82, s82, 16
    s_add_u32 s82, s82, s81
    s_add_u32 m0, s15, 0
    s_nop 0
    buffer_load_dwordx4 v1, s[8:11], s82 offen offset:0 lds
    buffer_load_dwordx4 v1, s[8:11], s82 offen offset:1024 lds
    buffer_load_dwordx4 v1, s[8:11], s82 offen offset:2048 lds
    buffer_load_dwordx4 v1, s[8:11], s82 offen offset:3072 lds
    s_add_u32 m0, s15, 4096
    s_nop 0
    buffer_load_dwordx4 v15, s[8:11], s82 offen offset:0 lds
    buffer_load_dwordx4 v15, s[8:11], s82 offen offset:1024 lds
    buffer_load_dwordx4 v15, s[8:11], s82 offen offset:2048 lds
    buffer_load_dwordx4 v15, s[8:11], s82 offen offset:3072 lds
    s_xor_b32 s15, s15, 196608
    s_waitcnt vmcnt(0) lgkmcnt(0)
    s_barrier
    ds_read_b128 a[128:131], v18 offset:0
    ds_read_b128 a[132:135], v18 offset:1024
    ds_read_b128 a[136:139], v18 offset:2048
    ds_read_b128 a[140:143], v18 offset:3072
    ds_read_b128 a[144:147], v18 offset:4096
    ds_read_b128 a[148:151], v18 offset:5120
    ds_read_b128 a[152:155], v18 offset:6144
    ds_read_b128 a[156:159], v18 offset:7168
    s_waitcnt lgkmcnt(0)
    s_branch L_t2_start
L_C2_slow_13:
    s_mov_b32 s99, 0
L_C2_slow_13_l:
    s_sleep 4
    buffer_load_dword v3, v4, s[8:11], s23 offen sc0 sc1
    s_add_u32 s99, s99, 1
    s_waitcnt vmcnt(0)
    v_cmp_ne_u32 vcc, 0, v3
    s_cmp_eq_u64 vcc, -1
    s_cbranch_scc1 L_C2_ok_14
    s_cmp_lt_u32 s99, 200000
    s_cbranch_scc1 L_C2_slow_13_l
    s_branch L_C2_ok_14
L_P1_slow_15:
    s_mov_b32 s99, 0
L_P1_slow_15_l:
    s_sleep 2
    s_add_u32 s74, s70, 0
    buffer_load_dwordx4 v[128:131], v44, s[8:11], s74 offen sc0 sc1
    s_add_u32 s74, s70, 4096
    buffer_load_dwordx4 v[132:135], v44, s[8:11], s74 offen sc0 sc1
    s_add_u32 s74, s70, 8192
    buffer_load_dwordx4 v[136:139], v44, s[8:11], s74 offen sc0 sc1
    s_add_u32 s74, s70, 12288
    buffer_load_dwordx4 v[140:143], v44, s[8:11], s74 offen sc0 sc1
    s_add_u32 s74, s70, 16384
    buffer_load_dwordx4 v[144:147], v44, s[8:11], s74 offen sc0 sc1
    s_add_u32 s74, s70, 20480
    buffer_load_dwordx4 v[148:151], v44, s[8:11], s74 offen sc0 sc1
    s_add_u32 s74, s70, 24576
    buffer_load_dwordx4 v[152:155], v44, s[8:11], s74 offen sc0 sc1
    s_add_u32 s74, s70, 28672
    buffer_load_dwordx4 v[156:159], v44, s[8:11], s74 offen sc0 sc1
    s_add_u32 s99, s99, 1
    s_waitcnt vmcnt(0)
    v_max_u32 v3, v128, v129
    v_max3_u32 v3, v3, v130, v131
    v_max3_u32 v3, v3, v132, v133
    v_max3_u32 v3, v3, v134, v135
    v_max3_u32 v3, v3, v136, v137
    v_max3_u32 v3, v3, v138, v139
    v_max3_u32 v3, v3, v140, v141
    v_max3_u32 v3, v3, v142, v143
    v_max3_u32 v3, v3, v144, v145
    v_max3_u32 v3, v3, v146, v147
    v_max3_u32 v3, v3, v148, v149
    v_max3_u32 v3, v3, v150, v151
    v_max3_u32 v3, v3, v152, v153
    v_max3_u32 v3, v3, v154, v155
    v_max3_u32 v3, v3, v156, v157
    v_max3_u32 v3, v3, v158, v159
    v_cmp_eq_u32 vcc, -1, v3
    s_cbranch_vccz L_P1_ok_16
    s_cmp_lt_u32 s99, 200000
    s_cbranch_scc1 L_P1_slow_15_l
    s_branch L_P1_ok_16
L_code_end:
    s_endpgm
.section .rodata,"a"
.p2align 6
.amdhsa_kernel adaLN_cond__compressed_kv_cla__moe_arch_mod__prompt_kernel
  .amdhsa_next_free_vgpr 512
  .amdhsa_next_free_sgpr 102
  .amdhsa_accum_offset 256
  .amdhsa_group_segment_fixed_size 0
  .amdhsa_kernarg_size 128
  .amdhsa_user_sgpr_count 2
  .amdhsa_user_sgpr_kernarg_segment_ptr 1
  .amdhsa_system_sgpr_workgroup_id_x 1
.end_amdhsa_kernel
```

```asm
; @launch grid=(256,1,1) block=(256,1,1) lds=163840
.amdgcn_target "amdgcn-amd-amdhsa--gfx950"
.text
.globl adaLN_cond__compressed_kv_cla__moe_arch_mod__prompt_kernel
.p2align 8
.type adaLN_cond__compressed_kv_cla__moe_arch_mod__prompt_kernel,@function
adaLN_cond__compressed_kv_cla__moe_arch_mod__prompt_kernel:
    s_cmp_ge_u32 s2, 256
    s_cbranch_scc1 L_end
    s_load_dwordx16 s[64:79], s[0:1], 0
    s_load_dwordx16 s[80:95], s[0:1], 64
    s_getpc_b64 s[100:101]
L_pf1:
    v_lshrrev_b32 v3, 6, v0
    v_and_b32 v2, 63, v0
    s_lshr_b32 s5, s2, 3
    s_mul_i32 s98, s5, 24
    v_min_u32 v5, 5, v2
    v_mad_u32_u24 v5, v3, 6, v5
    v_add_u32 v5, s98, v5
    v_lshlrev_b32 v5, 7, v5
    v_min_u32 v5, L_code_end-L_pf1, v5
    global_load_dword a255, v5, s[100:101]
    v_readfirstlane_b32 s3, v3
    v_lshlrev_b32 v1, 4, v2
    s_and_b32 s4, s2, 7
    s_and_b32 s5, s5, 3
    s_lshr_b32 s6, s2, 5
    s_lshl_b32 s7, s4, 2
    s_add_u32 s7, s7, s5
    s_mov_b32 s60, s6
    s_sub_u32 s61, 15, s6
    v_lshrrev_b32 v3, 3, v2
    v_lshrrev_b32 v4, 4, v2
    v_and_b32 v5, 7, v2
    v_xor_b32 v5, v5, v4
    v_lshlrev_b32 v5, 4, v5
    v_lshl_add_u32 v16, v3, 10, v5
    v_xor_b32 v17, 64, v16
    v_add_u32 v17, 7168, v17
    v_add_u32 v18, 14336, v16
    v_add_u32 v19, 14336, v17
    v_bfe_u32 v5, v2, 1, 3
    v_xor_b32 v5, v5, v4
    v_lshlrev_b32 v5, 5, v5
    v_and_b32 v6, 1, v2
    v_lshl_add_u32 v5, v6, 4, v5
    v_lshl_add_u32 v20, v4, 13, v5
    v_add_u32 v21, 31744, v20
    v_xor_b32 v22, 128, v20
    v_add_u32 v22, 63488, v22
    v_add_u32 v23, 31744, v22
    s_lshl_b32 s62, s3, 13
    s_lshl_b32 s63, s3, 12
    s_lshl_b32 s96, s6, 18
    s_lshl_b32 s98, s3, 16
    s_add_u32 s96, s96, s98
    s_lshl_b32 s97, s3, 17
    s_lshl_b32 s99, s5, 0
    s_xor_b32 s99, s99, s6
    s_lshl_b32 s99, s99, 3
    s_and_b32 s99, s99, 7
    s_lshl_b32 s98, s99, 7
    s_add_u32 s96, s96, s98
    s_lshl_b32 s98, s99, 19
    s_add_u32 s97, s97, s98
    v_and_b32 v84, 7, v2
    v_lshrrev_b32 v65, 3, v0
    v_mul_u32_u24 v64, 24576, v65
    v_lshl_add_u32 v64, v84, 4, v64
    v_lshlrev_b32 v65, 3, v65
    v_lshrrev_b32 v85, 3, v2
    v_lshlrev_b32 v86, 10, v84
    v_lshl_add_u32 v86, v85, 4, v86
    s_lshl_b32 s100, s7, 8
    s_waitcnt lgkmcnt(0)
    s_add_u32 s16, s70, s100
    s_addc_u32 s17, s71, 0
    s_sub_u32 s18, 4194304, s100
    s_mov_b32 s19, 0x00020000
    s_mov_b32 s12, s66
    s_mov_b32 s13, s67
    s_mov_b32 s14, 2097152
    s_mov_b32 s15, 0x00020000
    s_add_u32 m0, s63, 98304
    s_xor_b32 s98, s97, 0
    buffer_load_dwordx4 v20, s[16:19], s98 offen offset:0  lds
    buffer_load_dwordx4 v21, s[16:19], s98 offen offset:1024  lds
    buffer_load_dwordx4 v22, s[16:19], s98 offen offset:2048  lds
    buffer_load_dwordx4 v23, s[16:19], s98 offen offset:3072  lds
    s_add_u32 m0, s62, 0
    s_xor_b32 s98, s96, 0
    buffer_load_dwordx4 v16, s[12:15], s98 offen offset:0  lds
    buffer_load_dwordx4 v17, s[12:15], s98 offen offset:1024  lds
    buffer_load_dwordx4 v18, s[12:15], s98 offen offset:2048  lds
    buffer_load_dwordx4 v19, s[12:15], s98 offen offset:3072  lds
    s_add_u32 m0, s62, 4096
    s_xor_b32 s98, s96, 32768
    buffer_load_dwordx4 v16, s[12:15], s98 offen offset:0  lds
    buffer_load_dwordx4 v17, s[12:15], s98 offen offset:1024  lds
    buffer_load_dwordx4 v18, s[12:15], s98 offen offset:2048  lds
    buffer_load_dwordx4 v19, s[12:15], s98 offen offset:3072  lds
    s_mov_b32 s40, s88
    s_mov_b32 s41, s89
    s_mov_b32 s42, 3145728
    s_mov_b32 s43, 0x00020000
    s_mov_b32 s44, s86
    s_mov_b32 s45, s87
    s_mov_b32 s46, 1024
    s_mov_b32 s47, 0x00020000
    s_mov_b32 s32, s64
    s_mov_b32 s33, s65
    s_mov_b32 s34, 2097152
    s_mov_b32 s35, 0x00020000
    s_mov_b32 s8, s94
    s_mov_b32 s9, s95
    s_mov_b32 s10, 268435456
    s_mov_b32 s11, 0x00020000
    s_add_u32 s20, s72, s100
    s_addc_u32 s21, s73, 0
    s_sub_u32 s22, 4194304, s100
    s_mov_b32 s23, 0x00020000
    s_add_u32 s24, s68, s100
    s_addc_u32 s25, s69, 0
    s_sub_u32 s26, 4194304, s100
    s_mov_b32 s27, 0x00020000
    s_mov_b32 s36, s92
    s_mov_b32 s37, s93
    s_mov_b32 s38, 256
    s_mov_b32 s39, 0x00020000
    s_lshl_b32 s100, s4, 19
    s_lshl_b32 s99, s5, 8
    s_add_u32 s100, s100, s99
    s_add_u32 s28, s74, s100
    s_addc_u32 s29, s75, 0
    s_sub_u32 s30, 4194304, s100
    s_mov_b32 s31, 0x00020000
    s_mov_b32 s48, s84
    s_mov_b32 s49, s85
    s_mov_b32 s50, 1835008
    s_mov_b32 s51, 0x00020000
    s_mov_b32 s52, s90
    s_mov_b32 s53, s91
    s_mov_b32 s54, 2097152
    s_mov_b32 s55, 0x00020000
    s_mov_b64 s[92:93], s[80:81]
    s_mov_b64 s[94:95], s[82:83]
    s_mov_b32 s56, s78
    s_mov_b32 s57, s79
    s_mov_b32 s58, 1024
    s_mov_b32 s59, 0x00020000
    s_load_dword s90, s[36:37], 64
    s_load_dword s91, s[8:9], 0x3f00
    s_lshl_b32 s64, s3, 19
    s_and_b32 s100, s97, 3670016
    s_xor_b32 s64, s64, s100
    s_lshr_b32 s100, s6, 1
    s_and_b32 s100, s100, 0
    s_lshl_b32 s1, s100, 12
    s_lshl_b32 s100, s100, 7
    s_add_u32 s64, s64, s100
    s_lshl_b32 s100, s5, 1
    s_xor_b32 s100, s100, s6
    s_and_b32 s100, s100, 0
    s_lshl_b32 s68, s100, 11
    s_lshl_b32 s100, s100, 19
    s_lshl_b32 s0, s3, 17
    s_add_u32 s0, s0, s100
    s_lshl_b32 s81, s7, 20
    s_add_u32 s81, s81, 16777216
    s_lshl_b32 s100, s6, 17
    s_add_u32 s65, s81, s100
    s_lshr_b32 s100, s3, 1
    s_lshl_b32 s100, s100, 16
    s_add_u32 s65, s65, s100
    s_and_b32 s100, s3, 1
    s_lshl_b32 s100, s100, 14
    s_add_u32 s65, s65, s100
    s_add_u32 s81, s81, s62
    s_min_u32 s82, s60, 1
    s_lshl_b32 s82, s82, 16
    s_add_u32 s82, s82, s81
    s_sub_u32 s100, s6, 2
    s_lshl_b32 s69, s100, 7
    s_lshl_b32 s100, s100, 3
    s_add_u32 s100, s100, s4
    s_lshl_b32 s100, s100, 8
    s_mul_i32 s101, s5, 12288
    s_add_u32 s100, s100, s101
    s_add_u32 s100, s100, 16384
    s_cmp_ge_u32 s6, 2
    s_cselect_b32 s66, s100, 2147479552
    s_cselect_b32 s69, s69, 2147479552
    s_cmp_eq_u32 s3, 0
    s_cselect_b32 s66, s66, 2147479552
    s_lshl_b32 s70, s3, 9
    s_add_u32 s70, s70, 16384
    s_lshr_b32 s71, s2, 1
    s_lshl_b32 s71, s71, 14
    s_and_b32 s100, s2, 1
    s_lshl_b32 s100, s100, 7
    s_add_u32 s71, s71, s100
    s_add_u32 s71, s71, s63
    s_add_u32 s71, s71, 2097152
    s_lshl_b32 s72, s2, 2
    s_add_u32 s72, s72, s3
    s_lshl_b32 s72, s72, 6
    s_add_u32 s72, s72, 1048576
    s_lshl_b32 s74, s7, 11
    s_add_u32 s74, s74, 1114112
    s_lshl_b32 s73, s6, 2
    s_add_u32 s73, s73, s3
    s_lshl_b32 s73, s73, 6
    s_add_u32 s73, s73, s74
    s_lshr_b32 s100, s3, 1
    s_sub_u32 s101, 3, s100
    s_and_b32 s98, s3, 1
    s_cselect_b32 s100, s101, s100
    s_lshl_b32 s75, s60, 2
    s_add_u32 s75, s75, s100
    s_lshl_b32 s76, s61, 2
    s_add_u32 s76, s76, s100
    s_sub_u32 s77, s76, s75
    s_lshl_b32 s77, s77, 10
    s_lshl_b32 s78, s75, 10
    s_add_u32 s78, s78, 983040
    s_lshl_b32 s75, s75, 15
    s_add_u32 s75, s75, 2097152
    s_add_u32 s75, s75, s68
    s_lshl_b32 s76, s76, 15
    s_add_u32 s76, s76, 2097152
    s_add_u32 s76, s76, s68
    s_add_u32 s1, s1, s65
    s_cmp_eq_u32 s3, 0
    s_cselect_b32 s68, 32, 0
    s_cselect_b32 s67, 0, 2147479552
    v_and_b32 v48, 15, v2
    v_lshrrev_b32 v49, 4, v2
    v_lshrrev_b32 v50, 1, v48
    v_xor_b32 v50, v50, v49
    v_lshlrev_b32 v50, 4, v50
    v_lshl_add_u32 v28, v48, 7, v50
    v_add_u32 v28, s62, v28
    v_xor_b32 v29, 64, v28
    v_add_u32 v30, 65536, v28
    v_add_u32 v31, 65536, v29
    v_lshrrev_b32 v50, 2, v48
    v_and_b32 v51, 3, v48
    v_lshl_add_u32 v52, v49, 3, v50
    v_lshlrev_b32 v53, 8, v52
    v_lshl_add_u32 v53, v51, 3, v53
    v_add_u32 v53, 98304, v53
    v_and_b32 v54, 1, v49
    v_lshl_add_u32 v54, v54, 2, v50
    v_xor_b32 v55, 0, v54
    v_lshl_add_u32 v8, v55, 5, v53
    v_xor_b32 v55, 1, v54
    v_lshl_add_u32 v9, v55, 5, v53
    v_xor_b32 v55, 2, v54
    v_lshl_add_u32 v10, v55, 5, v53
    v_xor_b32 v55, 3, v54
    v_lshl_add_u32 v11, v55, 5, v53
    v_xor_b32 v55, 4, v54
    v_lshl_add_u32 v12, v55, 5, v53
    v_xor_b32 v55, 5, v54
    v_lshl_add_u32 v13, v55, 5, v53
    v_xor_b32 v55, 6, v54
    v_lshl_add_u32 v14, v55, 5, v53
    v_xor_b32 v55, 7, v54
    v_lshl_add_u32 v15, v55, 5, v53
    v_bfe_u32 v49, v2, 1, 2
    v_bfe_u32 v50, v2, 4, 1
    v_xor_b32 v49, v49, v50
    v_lshlrev_b32 v49, 5, v49
    v_and_b32 v50, 1, v2
    v_lshl_add_u32 v49, v50, 4, v49
    v_lshl_add_u32 v24, v85, 13, v49
    v_xor_b32 v25, 64, v24
    v_add_u32 v25, 64512, v25
    v_add_u32 v26, 129024, v24
    v_add_u32 v27, 129024, v25
    v_cmp_eq_u32 vcc, 0, v2
    v_mov_b32 v6, 2147479552
    s_nop 0
    v_cndmask_b32 v5, v6, v2, vcc
    v_cmp_eq_u32 vcc, 0, v0
    s_nop 1
    v_cndmask_b32 v7, v6, v0, vcc
    v_and_b32 v48, 8, v2
    v_cmp_eq_u32 vcc, 0, v48
    v_lshlrev_b32 v48, 5, v84
    v_lshrrev_b32 v49, 1, v2
    v_and_b32 v49, 24, v49
    v_add_u32 v48, v48, v49
    s_lshl_b32 s100, s3, 8
    s_add_u32 s100, s100, 147456
    v_add_u32 v48, s100, v48
    v_mov_b32 v49, 148480
    v_cndmask_b32 v98, v49, v48, vcc
    v_lshlrev_b32 v99, 5, v84
    v_add_u32 v99, 149504, v99
    s_lshl_b32 s100, s3, 3
    v_add_u32 v100, s100, v99
    v_lshlrev_b32 v106, 5, v85
    v_lshlrev_b32 v107, 8, v85
    v_lshl_add_u32 v107, v84, 4, v107
    s_sub_u32 s100, s2, 64
    s_lshl_b32 s80, s100, 12
    s_add_u32 s80, s80, 1048576
    s_cmp_lt_u32 s100, 64
    s_cselect_b32 s80, s80, 2147479552
    s_mul_i32 s99, s5, 786432
    s_sub_u32 s79, s6, 2
    s_lshl_b32 s79, s79, 3
    s_add_u32 s79, s79, s4
    s_lshl_b32 s79, s79, 7
    s_add_u32 s79, s79, s99
    s_cmp_ge_u32 s6, 2
    s_cselect_b32 s79, s79, 2147414016
    s_lshl_b32 s100, s5, 8
    v_add_u32 v65, s100, v65
    v_mov_b32 v6, 1
    v_and_b32 v4, 1, v2
    v_lshlrev_b32 v4, 7, v4
    buffer_load_dwordx2 v[66:67], v65, s[44:47], 0 offen
    buffer_load_dwordx4 v[68:71], v64, s[40:43], s79 offen
    s_add_u32 s79, s79, 6144
    buffer_load_dwordx4 v[72:75], v64, s[40:43], s79 offen
    s_add_u32 s79, s79, 6144
    buffer_load_dwordx4 v[76:79], v64, s[40:43], s79 offen
    s_add_u32 s79, s79, 6144
    buffer_load_dwordx4 v[80:83], v64, s[40:43], s79 offen
    s_lshl_b32 s79, s2, 5
    s_add_u32 s79, s79, s3
    s_lshl_b32 s79, s79, 8
    buffer_load_dwordx4 v[88:91], v86, s[32:35], s79 offen
    buffer_load_dwordx4 v[92:95], v86, s[32:35], s79 offen offset:128
    s_add_u32 m0, s63, 114688
    s_xor_b32 s98, s97, 524288
    buffer_load_dwordx4 v20, s[16:19], s98 offen offset:0  lds
    buffer_load_dwordx4 v21, s[16:19], s98 offen offset:1024  lds
    buffer_load_dwordx4 v22, s[16:19], s98 offen offset:2048  lds
    buffer_load_dwordx4 v23, s[16:19], s98 offen offset:3072  lds
    s_add_u32 m0, s62, 32768
    s_xor_b32 s98, s96, 128
    buffer_load_dwordx4 v16, s[12:15], s98 offen offset:0  lds
    buffer_load_dwordx4 v17, s[12:15], s98 offen offset:1024  lds
    buffer_load_dwordx4 v18, s[12:15], s98 offen offset:2048  lds
    buffer_load_dwordx4 v19, s[12:15], s98 offen offset:3072  lds
    s_add_u32 m0, s62, 36864
    s_xor_b32 s98, s96, 32896
    buffer_load_dwordx4 v16, s[12:15], s98 offen offset:0  lds
    buffer_load_dwordx4 v17, s[12:15], s98 offen offset:1024  lds
    buffer_load_dwordx4 v18, s[12:15], s98 offen offset:2048  lds
    buffer_load_dwordx4 v19, s[12:15], s98 offen offset:3072  lds
    s_waitcnt vmcnt(19) lgkmcnt(0)
    s_barrier
    ds_read_b64_tr_b16 v[32:33], v8 offset:0
    ds_read_b64_tr_b16 v[34:35], v8 offset:1024
    ds_read_b128 a[0:3], v28 offset:0
    ds_read_b128 a[4:7], v28 offset:2048
    ds_read_b128 a[8:11], v28 offset:4096
    ds_read_b128 a[12:15], v28 offset:6144
    ds_read_b64_tr_b16 v[36:37], v9 offset:0
    ds_read_b64_tr_b16 v[38:39], v9 offset:1024
    ds_read_b64_tr_b16 v[40:41], v10 offset:0
    ds_read_b64_tr_b16 v[42:43], v10 offset:1024
    ds_read_b64_tr_b16 v[44:45], v11 offset:0
    ds_read_b64_tr_b16 v[46:47], v11 offset:1024
    ds_read_b64_tr_b16 v[48:49], v12 offset:0
    ds_read_b64_tr_b16 v[50:51], v12 offset:1024
    ds_read_b64_tr_b16 v[52:53], v13 offset:0
    ds_read_b64_tr_b16 v[54:55], v13 offset:1024
    ds_read_b64_tr_b16 v[56:57], v14 offset:0
    ds_read_b64_tr_b16 v[58:59], v14 offset:1024
    ds_read_b64_tr_b16 v[60:61], v15 offset:0
    ds_read_b64_tr_b16 v[62:63], v15 offset:1024
    s_waitcnt lgkmcnt(15)
    v_mfma_f32_16x16x32_bf16 v[128:131], v[32:35], a[0:3], 0
    v_mfma_f32_16x16x32_bf16 v[160:163], v[32:35], a[4:7], 0
    v_mfma_f32_16x16x32_bf16 v[192:195], v[32:35], a[8:11], 0
    s_waitcnt lgkmcnt(14)
    s_add_u32 m0, s63, 131072
    s_xor_b32 s98, s97, 1048576
    ds_read_b128 a[16:19], v29 offset:0
    v_mfma_f32_16x16x32_bf16 v[224:227], v[32:35], a[12:15], 0
    s_waitcnt lgkmcnt(13)
    ds_read_b128 a[20:23], v29 offset:2048
    v_mfma_f32_16x16x32_bf16 v[132:135], v[36:39], a[0:3], 0
    ds_read_b64_tr_b16 v[32:33], v8 offset:8192
    v_mfma_f32_16x16x32_bf16 v[164:167], v[36:39], a[4:7], 0
    ds_read_b64_tr_b16 v[34:35], v8 offset:9216
    v_mfma_f32_16x16x32_bf16 v[196:199], v[36:39], a[8:11], 0
    ds_read_b128 a[24:27], v29 offset:4096
    v_mfma_f32_16x16x32_bf16 v[228:231], v[36:39], a[12:15], 0
    s_waitcnt lgkmcnt(15)
    ds_read_b128 a[28:31], v29 offset:6144
    v_mfma_f32_16x16x32_bf16 v[136:139], v[40:43], a[0:3], 0
    ds_read_b64_tr_b16 v[36:37], v9 offset:8192
    v_mfma_f32_16x16x32_bf16 v[168:171], v[40:43], a[4:7], 0
    s_waitcnt lgkmcnt(15)
    ds_read_b64_tr_b16 v[38:39], v9 offset:9216
    v_mfma_f32_16x16x32_bf16 v[200:203], v[40:43], a[8:11], 0
    buffer_load_dwordx4 v20, s[16:19], s98 offen offset:0  lds
    v_mfma_f32_16x16x32_bf16 v[232:235], v[40:43], a[12:15], 0
    buffer_load_dwordx4 v21, s[16:19], s98 offen offset:1024  lds
    v_mfma_f32_16x16x32_bf16 v[140:143], v[44:47], a[0:3], 0
    ds_read_b64_tr_b16 v[40:41], v10 offset:8192
    v_mfma_f32_16x16x32_bf16 v[172:175], v[44:47], a[4:7], 0
    s_waitcnt lgkmcnt(15)
    ds_read_b64_tr_b16 v[42:43], v10 offset:9216
    v_mfma_f32_16x16x32_bf16 v[204:207], v[44:47], a[8:11], 0
    buffer_load_dwordx4 v22, s[16:19], s98 offen offset:2048  lds
    v_mfma_f32_16x16x32_bf16 v[236:239], v[44:47], a[12:15], 0
    buffer_load_dwordx4 v23, s[16:19], s98 offen offset:3072  lds
    v_mfma_f32_16x16x32_bf16 v[144:147], v[48:51], a[0:3], 0
    s_add_u32 m0, s62, 65536
    s_xor_b32 s98, s96, 256
    ds_read_b64_tr_b16 v[44:45], v11 offset:8192
    v_mfma_f32_16x16x32_bf16 v[176:179], v[48:51], a[4:7], 0
    s_waitcnt lgkmcnt(15)
    ds_read_b64_tr_b16 v[46:47], v11 offset:9216
    v_mfma_f32_16x16x32_bf16 v[208:211], v[48:51], a[8:11], 0
    buffer_load_dwordx4 v16, s[12:15], s98 offen offset:0  lds
    v_mfma_f32_16x16x32_bf16 v[240:243], v[48:51], a[12:15], 0
    buffer_load_dwordx4 v17, s[12:15], s98 offen offset:1024  lds
    v_mfma_f32_16x16x32_bf16 v[148:151], v[52:55], a[0:3], 0
    ds_read_b64_tr_b16 v[48:49], v12 offset:8192
    v_mfma_f32_16x16x32_bf16 v[180:183], v[52:55], a[4:7], 0
    s_waitcnt lgkmcnt(15)
    ds_read_b64_tr_b16 v[50:51], v12 offset:9216
    v_mfma_f32_16x16x32_bf16 v[212:215], v[52:55], a[8:11], 0
    buffer_load_dwordx4 v18, s[12:15], s98 offen offset:2048  lds
    v_mfma_f32_16x16x32_bf16 v[244:247], v[52:55], a[12:15], 0
    buffer_load_dwordx4 v19, s[12:15], s98 offen offset:3072  lds
    v_mfma_f32_16x16x32_bf16 v[152:155], v[56:59], a[0:3], 0
    s_add_u32 m0, s62, 69632
    s_xor_b32 s98, s96, 33024
    ds_read_b64_tr_b16 v[52:53], v13 offset:8192
    v_mfma_f32_16x16x32_bf16 v[184:187], v[56:59], a[4:7], 0
    s_waitcnt lgkmcnt(15)
    ds_read_b64_tr_b16 v[54:55], v13 offset:9216
    v_mfma_f32_16x16x32_bf16 v[216:219], v[56:59], a[8:11], 0
    buffer_load_dwordx4 v16, s[12:15], s98 offen offset:0  lds
    v_mfma_f32_16x16x32_bf16 v[248:251], v[56:59], a[12:15], 0
    buffer_load_dwordx4 v17, s[12:15], s98 offen offset:1024  lds
    v_mfma_f32_16x16x32_bf16 v[156:159], v[60:63], a[0:3], 0
    ds_read_b64_tr_b16 v[56:57], v14 offset:8192
    v_mfma_f32_16x16x32_bf16 v[188:191], v[60:63], a[4:7], 0
    s_waitcnt lgkmcnt(13)
    ds_read_b64_tr_b16 v[58:59], v14 offset:9216
    v_mfma_f32_16x16x32_bf16 v[220:223], v[60:63], a[8:11], 0
    buffer_load_dwordx4 v18, s[12:15], s98 offen offset:2048  lds
    v_mfma_f32_16x16x32_bf16 v[252:255], v[60:63], a[12:15], 0
    buffer_load_dwordx4 v19, s[12:15], s98 offen offset:3072  lds
    v_mfma_f32_16x16x32_bf16 v[128:131], v[32:35], a[16:19], v[128:131]
    ds_read_b64_tr_b16 v[60:61], v15 offset:8192
    v_mfma_f32_16x16x32_bf16 v[160:163], v[32:35], a[20:23], v[160:163]
    s_waitcnt lgkmcnt(14)
    ds_read_b64_tr_b16 v[62:63], v15 offset:9216
    v_mfma_f32_16x16x32_bf16 v[192:195], v[32:35], a[24:27], v[192:195]
    s_waitcnt lgkmcnt(14)
    v_mfma_f32_16x16x32_bf16 v[224:227], v[32:35], a[28:31], v[224:227]
    s_waitcnt lgkmcnt(12)
    v_mfma_f32_16x16x32_bf16 v[132:135], v[36:39], a[16:19], v[132:135]
    v_mfma_f32_16x16x32_bf16 v[164:167], v[36:39], a[20:23], v[164:167]
    v_mfma_f32_16x16x32_bf16 v[196:199], v[36:39], a[24:27], v[196:199]
    v_mfma_f32_16x16x32_bf16 v[228:231], v[36:39], a[28:31], v[228:231]
    s_waitcnt lgkmcnt(10)
    v_mfma_f32_16x16x32_bf16 v[136:139], v[40:43], a[16:19], v[136:139]
    s_waitcnt vmcnt(12) lgkmcnt(0)
    s_barrier
    v_mfma_f32_16x16x32_bf16 v[168:171], v[40:43], a[20:23], v[168:171]
    s_add_u32 m0, s63, 98304
    s_xor_b32 s98, s97, 1572864
    ds_read_b64_tr_b16 v[32:33], v8 offset:16384
    v_lshlrev_b32 v102, 16, v66
    v_and_b32 v103, 0xffff0000, v66
    v_lshlrev_b32 v104, 16, v67
    v_mfma_f32_16x16x32_bf16 v[200:203], v[40:43], a[24:27], v[200:203]
    ds_read_b64_tr_b16 v[34:35], v8 offset:17408
    v_and_b32 v105, 0xffff0000, v67
    v_mul_f32 v108, 0xbfb8aa3b, v102
    v_mul_f32 v109, 0xbfb8aa3b, v103
    v_mfma_f32_16x16x32_bf16 v[232:235], v[40:43], a[28:31], v[232:235]
    ds_read_b64_tr_b16 v[36:37], v9 offset:16384
    v_mul_f32 v110, 0xbfb8aa3b, v104
    v_mul_f32 v111, 0xbfb8aa3b, v105
    v_mfma_f32_16x16x32_bf16 v[140:143], v[44:47], a[16:19], v[140:143]
    ds_read_b64_tr_b16 v[38:39], v9 offset:17408
    v_exp_f32 v108, v108
    v_mfma_f32_16x16x32_bf16 v[172:175], v[44:47], a[20:23], v[172:175]
    ds_read_b64_tr_b16 v[40:41], v10 offset:16384
    v_exp_f32 v109, v109
    v_mfma_f32_16x16x32_bf16 v[204:207], v[44:47], a[24:27], v[204:207]
    ds_read_b64_tr_b16 v[42:43], v10 offset:17408
    v_exp_f32 v110, v110
    v_mfma_f32_16x16x32_bf16 v[236:239], v[44:47], a[28:31], v[236:239]
    ds_read_b128 a[32:35], v28 offset:32768
    v_exp_f32 v111, v111
    v_add_f32 v108, 1.0, v108
    v_mfma_f32_16x16x32_bf16 v[144:147], v[48:51], a[16:19], v[144:147]
    ds_read_b64_tr_b16 v[44:45], v11 offset:16384
    v_add_f32 v109, 1.0, v109
    v_add_f32 v110, 1.0, v110
    v_add_f32 v111, 1.0, v111
    v_mfma_f32_16x16x32_bf16 v[176:179], v[48:51], a[20:23], v[176:179]
    ds_read_b64_tr_b16 v[46:47], v11 offset:17408
    v_rcp_f32 v108, v108
    v_mfma_f32_16x16x32_bf16 v[208:211], v[48:51], a[24:27], v[208:211]
    ds_read_b128 a[36:39], v28 offset:34816
    v_mov_b32 v112, 0
    v_rcp_f32 v109, v109
    v_mfma_f32_16x16x32_bf16 v[240:243], v[48:51], a[28:31], v[240:243]
    ds_read_b128 a[40:43], v28 offset:36864
    v_mov_b32 v113, 0
    v_rcp_f32 v110, v110
    v_mfma_f32_16x16x32_bf16 v[148:151], v[52:55], a[16:19], v[148:151]
    ds_read_b64_tr_b16 v[48:49], v12 offset:16384
    v_mov_b32 v114, 0
    v_rcp_f32 v111, v111
    v_mfma_f32_16x16x32_bf16 v[180:183], v[52:55], a[20:23], v[180:183]
    ds_read_b64_tr_b16 v[50:51], v12 offset:17408
    v_mov_b32 v115, 0
    v_mul_f32 v102, v102, v108
    v_mul_f32 v103, v103, v109
    v_mfma_f32_16x16x32_bf16 v[212:215], v[52:55], a[24:27], v[212:215]
    ds_read_b128 a[44:47], v28 offset:38912
    v_lshlrev_b32 v116, 4, v0
    v_mul_f32 v104, v104, v110
    v_mul_f32 v105, v105, v111
    v_mfma_f32_16x16x32_bf16 v[244:247], v[52:55], a[28:31], v[244:247]
    buffer_load_dwordx4 v20, s[16:19], s98 offen offset:0  lds
    v_cvt_pk_bf16_f32 v108, v102, v103
    v_cvt_pk_bf16_f32 v109, v104, v105
    v_mfma_f32_16x16x32_bf16 v[152:155], v[56:59], a[16:19], v[152:155]
    ds_read_b64_tr_b16 v[52:53], v13 offset:16384
    v_lshlrev_b32 v102, 16, v108
    v_and_b32 v103, 0xffff0000, v108
    v_lshlrev_b32 v104, 16, v109
    v_mfma_f32_16x16x32_bf16 v[184:187], v[56:59], a[20:23], v[184:187]
    ds_read_b64_tr_b16 v[54:55], v13 offset:17408
    v_and_b32 v105, 0xffff0000, v109
    v_lshlrev_b32 v108, 16, v68
    v_and_b32 v109, 0xffff0000, v68
    v_mfma_f32_16x16x32_bf16 v[216:219], v[56:59], a[24:27], v[216:219]
    buffer_load_dwordx4 v21, s[16:19], s98 offen offset:1024  lds
    v_mul_f32 v120, v108, v102
    v_mul_f32 v121, v109, v102
    v_mfma_f32_16x16x32_bf16 v[248:251], v[56:59], a[28:31], v[248:251]
    buffer_store_dwordx4 v[112:115], v116, s[8:11], s80 offen sc0 sc1
    v_lshlrev_b32 v110, 16, v69
    v_and_b32 v111, 0xffff0000, v69
    v_mfma_f32_16x16x32_bf16 v[156:159], v[60:63], a[16:19], v[156:159]
    ds_read_b64_tr_b16 v[56:57], v14 offset:16384
    v_lshlrev_b32 v117, 13, v2
    v_mul_f32 v122, v110, v102
    v_mul_f32 v123, v111, v102
    v_mfma_f32_16x16x32_bf16 v[188:191], v[60:63], a[20:23], v[188:191]
    s_lshl_b32 s100, s6, 19
    s_and_b32 s101, s3, 1
    ds_read_b64_tr_b16 v[58:59], v14 offset:17408
    v_lshlrev_b32 v108, 16, v70
    v_and_b32 v109, 0xffff0000, v70
    v_mul_f32 v124, v108, v102
    v_mfma_f32_16x16x32_bf16 v[220:223], v[60:63], a[24:27], v[220:223]
    buffer_load_dwordx4 v22, s[16:19], s98 offen offset:2048  lds
    v_mul_f32 v125, v109, v102
    v_lshlrev_b32 v110, 16, v71
    v_mfma_f32_16x16x32_bf16 v[252:255], v[60:63], a[28:31], v[252:255]
    s_waitcnt lgkmcnt(11)
    s_lshl_b32 s101, s101, 7
    s_add_u32 s100, s100, s101
    v_min_u32 v116, 496, v116
    v_and_b32 v111, 0xffff0000, v71
    v_mul_f32 v126, v110, v102
    v_mul_f32 v127, v111, v102
    v_mfma_f32_16x16x32_bf16 v[128:131], v[32:35], a[32:35], v[128:131]
    s_waitcnt lgkmcnt(8)
    s_sub_u32 s80, s80, 1048576
    s_lshr_b32 s80, s80, 3
    ds_read_b64_tr_b16 v[60:61], v15 offset:16384
    v_lshlrev_b32 v108, 16, v72
    v_and_b32 v109, 0xffff0000, v72
    v_fmac_f32 v120, v108, v103
    v_mfma_f32_16x16x32_bf16 v[160:163], v[32:35], a[36:39], v[160:163]
    s_waitcnt lgkmcnt(8)
    s_add_u32 s80, s80, 1310720
    s_cmp_lt_u32 s80, 1343488
    s_cselect_b32 s80, s80, 2147479552
    ds_read_b64_tr_b16 v[62:63], v15 offset:17408
    v_fmac_f32 v121, v109, v103
    v_lshlrev_b32 v110, 16, v73
    v_and_b32 v111, 0xffff0000, v73
    v_mfma_f32_16x16x32_bf16 v[192:195], v[32:35], a[40:43], v[192:195]
    s_waitcnt lgkmcnt(6)
    ds_read_b128 a[48:51], v29 offset:32768
    v_fmac_f32 v122, v110, v103
    v_fmac_f32 v123, v111, v103
    v_lshlrev_b32 v108, 16, v74
    v_mfma_f32_16x16x32_bf16 v[224:227], v[32:35], a[44:47], v[224:227]
    ds_read_b128 a[52:55], v29 offset:34816
    v_and_b32 v109, 0xffff0000, v74
    v_fmac_f32 v124, v108, v103
    v_fmac_f32 v125, v109, v103
    v_mfma_f32_16x16x32_bf16 v[132:135], v[36:39], a[32:35], v[132:135]
    ds_read_b64_tr_b16 v[32:33], v8 offset:24576
    v_lshlrev_b32 v110, 16, v75
    v_and_b32 v111, 0xffff0000, v75
    v_fmac_f32 v126, v110, v103
    v_mfma_f32_16x16x32_bf16 v[164:167], v[36:39], a[36:39], v[164:167]
    ds_read_b64_tr_b16 v[34:35], v8 offset:25600
    v_fmac_f32 v127, v111, v103
    v_lshlrev_b32 v108, 16, v76
    v_and_b32 v109, 0xffff0000, v76
    v_mfma_f32_16x16x32_bf16 v[196:199], v[36:39], a[40:43], v[196:199]
    ds_read_b128 a[56:59], v29 offset:36864
    v_fmac_f32 v120, v108, v104
    v_fmac_f32 v121, v109, v104
    v_lshlrev_b32 v110, 16, v77
    v_mfma_f32_16x16x32_bf16 v[228:231], v[36:39], a[44:47], v[228:231]
    ds_read_b128 a[60:63], v29 offset:38912
    v_and_b32 v111, 0xffff0000, v77
    v_fmac_f32 v122, v110, v104
    v_fmac_f32 v123, v111, v104
    v_mfma_f32_16x16x32_bf16 v[136:139], v[40:43], a[32:35], v[136:139]
    ds_read_b64_tr_b16 v[36:37], v9 offset:24576
    v_lshlrev_b32 v108, 16, v78
    v_and_b32 v109, 0xffff0000, v78
    v_fmac_f32 v124, v108, v104
    v_mfma_f32_16x16x32_bf16 v[168:171], v[40:43], a[36:39], v[168:171]
    ds_read_b64_tr_b16 v[38:39], v9 offset:25600
    v_fmac_f32 v125, v109, v104
    v_lshlrev_b32 v110, 16, v79
    v_and_b32 v111, 0xffff0000, v79
    v_mfma_f32_16x16x32_bf16 v[200:203], v[40:43], a[40:43], v[200:203]
    buffer_load_dwordx4 v23, s[16:19], s98 offen offset:3072  lds
    v_fmac_f32 v126, v110, v104
    v_fmac_f32 v127, v111, v104
    v_mfma_f32_16x16x32_bf16 v[232:235], v[40:43], a[44:47], v[232:235]
    buffer_store_dwordx4 v[112:115], v116, s[8:11], s80 offen sc0 sc1
    v_lshlrev_b32 v108, 16, v80
    v_and_b32 v109, 0xffff0000, v80
    v_mfma_f32_16x16x32_bf16 v[140:143], v[44:47], a[32:35], v[140:143]
    s_add_u32 m0, s62, 0
    s_xor_b32 s98, s96, 384
    ds_read_b64_tr_b16 v[40:41], v10 offset:24576
    v_fmac_f32 v120, v108, v105
    v_fmac_f32 v121, v109, v105
    v_lshlrev_b32 v110, 16, v81
    v_mfma_f32_16x16x32_bf16 v[172:175], v[44:47], a[36:39], v[172:175]
    ds_read_b64_tr_b16 v[42:43], v10 offset:25600
    v_and_b32 v111, 0xffff0000, v81
    v_fmac_f32 v122, v110, v105
    v_fmac_f32 v123, v111, v105
    v_mfma_f32_16x16x32_bf16 v[204:207], v[44:47], a[40:43], v[204:207]
    buffer_load_dwordx4 v16, s[12:15], s98 offen offset:0  lds
    v_lshlrev_b32 v108, 16, v82
    v_and_b32 v109, 0xffff0000, v82
    v_mfma_f32_16x16x32_bf16 v[236:239], v[44:47], a[44:47], v[236:239]
    v_fmac_f32 v124, v108, v105
    v_fmac_f32 v125, v109, v105
    v_lshlrev_b32 v110, 16, v83
    v_and_b32 v111, 0xffff0000, v83
    v_mfma_f32_16x16x32_bf16 v[144:147], v[48:51], a[32:35], v[144:147]
    ds_read_b64_tr_b16 v[44:45], v11 offset:24576
    v_fmac_f32 v126, v110, v105
    v_fmac_f32 v127, v111, v105
    v_permlane32_swap_b32 v120, v124
    v_mfma_f32_16x16x32_bf16 v[176:179], v[48:51], a[36:39], v[176:179]
    ds_read_b64_tr_b16 v[46:47], v11 offset:25600
    v_permlane32_swap_b32 v121, v125
    v_permlane32_swap_b32 v122, v126
    v_permlane32_swap_b32 v123, v127
    v_mfma_f32_16x16x32_bf16 v[208:211], v[48:51], a[40:43], v[208:211]
    buffer_load_dwordx4 v17, s[12:15], s98 offen offset:1024  lds
    v_add_f32 v120, v120, v124
    v_add_f32 v121, v121, v125
    v_mfma_f32_16x16x32_bf16 v[240:243], v[48:51], a[44:47], v[240:243]
    s_waitcnt lgkmcnt(15)
    v_add_f32 v122, v122, v126
    v_add_f32 v123, v123, v127
    s_nop 0
    v_permlane16_swap_b32 v120, v122
    v_permlane16_swap_b32 v121, v123
    v_mfma_f32_16x16x32_bf16 v[148:151], v[52:55], a[32:35], v[148:151]
    ds_read_b64_tr_b16 v[48:49], v12 offset:24576
    v_add_f32 v120, v120, v122
    v_add_f32 v121, v121, v123
    s_nop 0
    v_add_f32_dpp v120, v120, v120 row_ror:8 row_mask:0xf bank_mask:0xf
    v_mfma_f32_16x16x32_bf16 v[180:183], v[52:55], a[36:39], v[180:183]
    ds_read_b64_tr_b16 v[50:51], v12 offset:25600
    v_add_f32_dpp v121, v121, v121 row_ror:8 row_mask:0xf bank_mask:0xf
    v_mfma_f32_16x16x32_bf16 v[212:215], v[52:55], a[40:43], v[212:215]
    buffer_load_dwordx4 v18, s[12:15], s98 offen offset:2048  lds
    ds_write_b64 v98, v[120:121]
    v_mfma_f32_16x16x32_bf16 v[244:247], v[52:55], a[44:47], v[244:247]
    s_waitcnt lgkmcnt(15)
    v_mfma_f32_16x16x32_bf16 v[152:155], v[56:59], a[32:35], v[152:155]
    ds_read_b64_tr_b16 v[52:53], v13 offset:24576
    v_lshlrev_b32 v64, 16, v88
    v_mfma_f32_16x16x32_bf16 v[184:187], v[56:59], a[36:39], v[184:187]
    ds_read_b64_tr_b16 v[54:55], v13 offset:25600
    v_and_b32 v65, 0xffff0000, v88
    v_mfma_f32_16x16x32_bf16 v[216:219], v[56:59], a[40:43], v[216:219]
    buffer_load_dwordx4 v19, s[12:15], s98 offen offset:3072  lds
    v_mfma_f32_16x16x32_bf16 v[248:251], v[56:59], a[44:47], v[248:251]
    v_lshlrev_b32 v66, 16, v89
    v_and_b32 v67, 0xffff0000, v89
    v_mfma_f32_16x16x32_bf16 v[156:159], v[60:63], a[32:35], v[156:159]
    s_add_u32 m0, s62, 4096
    s_xor_b32 s98, s96, 33152
    ds_read_b64_tr_b16 v[56:57], v14 offset:24576
    v_mfma_f32_16x16x32_bf16 v[188:191], v[60:63], a[36:39], v[188:191]
    ds_read_b64_tr_b16 v[58:59], v14 offset:25600
    v_lshlrev_b32 v68, 16, v90
    v_mfma_f32_16x16x32_bf16 v[220:223], v[60:63], a[40:43], v[220:223]
    buffer_load_dwordx4 v16, s[12:15], s98 offen offset:0  lds
    v_mfma_f32_16x16x32_bf16 v[252:255], v[60:63], a[44:47], v[252:255]
    s_waitcnt lgkmcnt(15)
    v_and_b32 v69, 0xffff0000, v90
    v_lshlrev_b32 v70, 16, v91
    v_mfma_f32_16x16x32_bf16 v[128:131], v[32:35], a[48:51], v[128:131]
    ds_read_b64_tr_b16 v[60:61], v15 offset:24576
    v_and_b32 v71, 0xffff0000, v91
    v_mfma_f32_16x16x32_bf16 v[160:163], v[32:35], a[52:55], v[160:163]
    s_waitcnt lgkmcnt(14)
    ds_read_b64_tr_b16 v[62:63], v15 offset:25600
    v_lshlrev_b32 v72, 16, v92
    v_mfma_f32_16x16x32_bf16 v[192:195], v[32:35], a[56:59], v[192:195]
    buffer_load_dwordx4 v17, s[12:15], s98 offen offset:1024  lds
    v_mfma_f32_16x16x32_bf16 v[224:227], v[32:35], a[60:63], v[224:227]
    s_waitcnt lgkmcnt(13)
    v_and_b32 v73, 0xffff0000, v92
    v_lshlrev_b32 v74, 16, v93
    v_mfma_f32_16x16x32_bf16 v[132:135], v[36:39], a[48:51], v[132:135]
    buffer_load_dwordx4 v18, s[12:15], s98 offen offset:2048  lds
    v_mfma_f32_16x16x32_bf16 v[164:167], v[36:39], a[52:55], v[164:167]
    v_and_b32 v75, 0xffff0000, v93
    v_lshlrev_b32 v76, 16, v94
    v_mfma_f32_16x16x32_bf16 v[196:199], v[36:39], a[56:59], v[196:199]
    buffer_load_dwordx4 v19, s[12:15], s98 offen offset:3072  lds
    s_cmp_eq_u32 s3, 0
    s_cselect_b32 s101, s100, 2147479552
    buffer_load_dword a241, v117, s[20:23], s101 offen offset:4
    v_mfma_f32_16x16x32_bf16 v[228:231], v[36:39], a[60:63], v[228:231]
    s_waitcnt lgkmcnt(11)
    v_and_b32 v77, 0xffff0000, v94
    v_lshlrev_b32 v78, 16, v95
    s_waitcnt vmcnt(9)
    v_mfma_f32_16x16x32_bf16 v[136:139], v[40:43], a[48:51], v[136:139]
    v_and_b32 v79, 0xffff0000, v95
    v_add_f32 v108, v64, v65
    s_waitcnt lgkmcnt(0)
    s_barrier
    v_mfma_f32_16x16x32_bf16 v[168:171], v[40:43], a[52:55], v[168:171]
    s_add_u32 m0, s63, 114688
    s_xor_b32 s98, s97, 2097152
    ds_read_b64_tr_b16 v[32:33], v8 offset:32768
    v_lshrrev_b32 v87, 2, v1
    v_add_u32 v101, 147456, v87
    v_mfma_f32_16x16x32_bf16 v[200:203], v[40:43], a[56:59], v[200:203]
    ds_read_b64_tr_b16 v[34:35], v8 offset:33792
    ds_read_b32 v102, v101
    v_mfma_f32_16x16x32_bf16 v[232:235], v[40:43], a[60:63], v[232:235]
    ds_read_b64_tr_b16 v[36:37], v9 offset:32768
    ds_read_b32 v103, v101 offset:256
    v_mfma_f32_16x16x32_bf16 v[140:143], v[44:47], a[48:51], v[140:143]
    ds_read_b64_tr_b16 v[38:39], v9 offset:33792
    ds_read_b32 v104, v101 offset:512
    v_mfma_f32_16x16x32_bf16 v[172:175], v[44:47], a[52:55], v[172:175]
    ds_read_b64_tr_b16 v[40:41], v10 offset:32768
    ds_read_b32 v105, v101 offset:768
    v_mfma_f32_16x16x32_bf16 v[204:207], v[44:47], a[56:59], v[204:207]
    ds_read_b64_tr_b16 v[42:43], v10 offset:33792
    v_add_f32 v109, v66, v67
    v_mfma_f32_16x16x32_bf16 v[236:239], v[44:47], a[60:63], v[236:239]
    ds_read_b128 a[64:67], v30 offset:0
    v_add_f32 v108, v108, v68
    v_mfma_f32_16x16x32_bf16 v[144:147], v[48:51], a[48:51], v[144:147]
    ds_read_b64_tr_b16 v[44:45], v11 offset:32768
    v_add_f32 v109, v109, v69
    v_mfma_f32_16x16x32_bf16 v[176:179], v[48:51], a[52:55], v[176:179]
    ds_read_b64_tr_b16 v[46:47], v11 offset:33792
    v_add_f32 v108, v108, v70
    v_mfma_f32_16x16x32_bf16 v[208:211], v[48:51], a[56:59], v[208:211]
    ds_read_b128 a[68:71], v30 offset:2048
    v_add_f32 v109, v109, v71
    v_mfma_f32_16x16x32_bf16 v[240:243], v[48:51], a[60:63], v[240:243]
    ds_read_b128 a[72:75], v30 offset:4096
    s_waitcnt lgkmcnt(10)
    v_add_f32 v102, v102, v103
    v_mfma_f32_16x16x32_bf16 v[148:151], v[52:55], a[48:51], v[148:151]
    ds_read_b64_tr_b16 v[48:49], v12 offset:32768
    s_waitcnt lgkmcnt(7)
    v_add_f32 v104, v104, v105
    v_mfma_f32_16x16x32_bf16 v[180:183], v[52:55], a[52:55], v[180:183]
    ds_read_b64_tr_b16 v[50:51], v12 offset:33792
    v_add_f32 v102, v102, v104
    buffer_store_dword v102, v87, s[8:11], s66 offen sc0 sc1
    v_mfma_f32_16x16x32_bf16 v[212:215], v[52:55], a[56:59], v[212:215]
    ds_read_b128 a[76:79], v30 offset:6144
    v_add_f32 v108, v108, v72
    v_mfma_f32_16x16x32_bf16 v[244:247], v[52:55], a[60:63], v[244:247]
    buffer_load_dwordx4 v20, s[16:19], s98 offen offset:0  lds
    v_mfma_f32_16x16x32_bf16 v[152:155], v[56:59], a[48:51], v[152:155]
    s_mov_b32 s40, s92
    s_mov_b32 s41, s93
    ds_read_b64_tr_b16 v[52:53], v13 offset:32768
    v_mfma_f32_16x16x32_bf16 v[184:187], v[56:59], a[52:55], v[184:187]
    s_mov_b32 s42, 1835008
    s_mov_b32 s44, s94
    ds_read_b64_tr_b16 v[54:55], v13 offset:33792
    v_mfma_f32_16x16x32_bf16 v[216:219], v[56:59], a[56:59], v[216:219]
    s_mov_b32 s45, s95
    s_mov_b32 s46, 1835008
    v_add_f32 v109, v109, v73
    v_mfma_f32_16x16x32_bf16 v[248:251], v[56:59], a[60:63], v[248:251]
    buffer_load_dwordx4 v21, s[16:19], s98 offen offset:1024  lds
    v_mfma_f32_16x16x32_bf16 v[156:159], v[60:63], a[48:51], v[156:159]
    ds_read_b64_tr_b16 v[56:57], v14 offset:32768
    v_add_f32 v108, v108, v74
    v_mfma_f32_16x16x32_bf16 v[188:191], v[60:63], a[52:55], v[188:191]
    ds_read_b64_tr_b16 v[58:59], v14 offset:33792
    v_add_f32 v109, v109, v75
    v_mfma_f32_16x16x32_bf16 v[220:223], v[60:63], a[56:59], v[220:223]
    buffer_load_dwordx4 v22, s[16:19], s98 offen offset:2048  lds
    v_mfma_f32_16x16x32_bf16 v[252:255], v[60:63], a[60:63], v[252:255]
    s_waitcnt lgkmcnt(11)
    v_add_f32 v108, v108, v76
    v_add_f32 v109, v109, v77
    v_mfma_f32_16x16x32_bf16 v[128:131], v[32:35], a[64:67], v[128:131]
    s_waitcnt lgkmcnt(8)
    ds_read_b64_tr_b16 v[60:61], v15 offset:32768
    v_add_f32 v108, v108, v78
    v_mfma_f32_16x16x32_bf16 v[160:163], v[32:35], a[68:71], v[160:163]
    s_waitcnt lgkmcnt(8)
    ds_read_b64_tr_b16 v[62:63], v15 offset:33792
    v_add_f32 v109, v109, v79
    v_mfma_f32_16x16x32_bf16 v[192:195], v[32:35], a[72:75], v[192:195]
    s_waitcnt lgkmcnt(6)
    ds_read_b128 a[80:83], v31 offset:0
    v_add_f32 v108, v108, v109
    v_mfma_f32_16x16x32_bf16 v[224:227], v[32:35], a[76:79], v[224:227]
    ds_read_b128 a[84:87], v31 offset:2048
    v_add_f32_dpp v108, v108, v108 row_ror:8 row_mask:0xf bank_mask:0xf
    v_mfma_f32_16x16x32_bf16 v[132:135], v[36:39], a[64:67], v[132:135]
    ds_read_b64_tr_b16 v[32:33], v8 offset:40960
    v_mov_b32 v110, v108
    v_mfma_f32_16x16x32_bf16 v[164:167], v[36:39], a[68:71], v[164:167]
    ds_read_b64_tr_b16 v[34:35], v8 offset:41984
    v_permlane16_swap_b32 v108, v110
    v_mfma_f32_16x16x32_bf16 v[196:199], v[36:39], a[72:75], v[196:199]
    ds_read_b128 a[88:91], v31 offset:4096
    v_add_f32 v108, v108, v110
    v_mfma_f32_16x16x32_bf16 v[228:231], v[36:39], a[76:79], v[228:231]
    ds_read_b128 a[92:95], v31 offset:6144
    v_mov_b32 v110, v108
    v_mfma_f32_16x16x32_bf16 v[136:139], v[40:43], a[64:67], v[136:139]
    ds_read_b64_tr_b16 v[36:37], v9 offset:40960
    v_permlane32_swap_b32 v108, v110
    v_mfma_f32_16x16x32_bf16 v[168:171], v[40:43], a[68:71], v[168:171]
    ds_read_b64_tr_b16 v[38:39], v9 offset:41984
    v_add_f32 v108, v108, v110
    v_mfma_f32_16x16x32_bf16 v[200:203], v[40:43], a[72:75], v[200:203]
    buffer_load_dwordx4 v23, s[16:19], s98 offen offset:3072  lds
    v_mfma_f32_16x16x32_bf16 v[232:235], v[40:43], a[76:79], v[232:235]
    v_mul_f32 v108, 0x3c000000, v108
    v_sub_f32 v110, v64, v108
    v_mfma_f32_16x16x32_bf16 v[140:143], v[44:47], a[64:67], v[140:143]
    s_add_u32 m0, s62, 32768
    s_xor_b32 s98, s96, 512
    ds_read_b64_tr_b16 v[40:41], v10 offset:40960
    v_mfma_f32_16x16x32_bf16 v[172:175], v[44:47], a[68:71], v[172:175]
    ds_read_b64_tr_b16 v[42:43], v10 offset:41984
    v_mul_f32 v109, v110, v110
    v_mfma_f32_16x16x32_bf16 v[204:207], v[44:47], a[72:75], v[204:207]
    buffer_load_dwordx4 v16, s[12:15], s98 offen offset:0  lds
    v_mfma_f32_16x16x32_bf16 v[236:239], v[44:47], a[76:79], v[236:239]
    v_sub_f32 v111, v65, v108
    v_fmac_f32 v109, v111, v111
    v_mfma_f32_16x16x32_bf16 v[144:147], v[48:51], a[64:67], v[144:147]
    ds_read_b64_tr_b16 v[44:45], v11 offset:40960
    v_sub_f32 v110, v66, v108
    v_mfma_f32_16x16x32_bf16 v[176:179], v[48:51], a[68:71], v[176:179]
    ds_read_b64_tr_b16 v[46:47], v11 offset:41984
    v_fmac_f32 v109, v110, v110
    v_mfma_f32_16x16x32_bf16 v[208:211], v[48:51], a[72:75], v[208:211]
    buffer_load_dwordx4 v17, s[12:15], s98 offen offset:1024  lds
    v_mfma_f32_16x16x32_bf16 v[240:243], v[48:51], a[76:79], v[240:243]
    s_waitcnt lgkmcnt(15)
    v_sub_f32 v111, v67, v108
    v_fmac_f32 v109, v111, v111
    v_mfma_f32_16x16x32_bf16 v[148:151], v[52:55], a[64:67], v[148:151]
    ds_read_b64_tr_b16 v[48:49], v12 offset:40960
    v_sub_f32 v110, v68, v108
    v_mfma_f32_16x16x32_bf16 v[180:183], v[52:55], a[68:71], v[180:183]
    ds_read_b64_tr_b16 v[50:51], v12 offset:41984
    v_fmac_f32 v109, v110, v110
    v_mfma_f32_16x16x32_bf16 v[212:215], v[52:55], a[72:75], v[212:215]
    buffer_load_dwordx4 v18, s[12:15], s98 offen offset:2048  lds
    v_mfma_f32_16x16x32_bf16 v[244:247], v[52:55], a[76:79], v[244:247]
    s_waitcnt lgkmcnt(15)
    v_sub_f32 v111, v69, v108
    v_fmac_f32 v109, v111, v111
    v_mfma_f32_16x16x32_bf16 v[152:155], v[56:59], a[64:67], v[152:155]
    ds_read_b64_tr_b16 v[52:53], v13 offset:40960
    v_sub_f32 v110, v70, v108
    v_mfma_f32_16x16x32_bf16 v[184:187], v[56:59], a[68:71], v[184:187]
    ds_read_b64_tr_b16 v[54:55], v13 offset:41984
    v_fmac_f32 v109, v110, v110
    v_mfma_f32_16x16x32_bf16 v[216:219], v[56:59], a[72:75], v[216:219]
    buffer_load_dwordx4 v19, s[12:15], s98 offen offset:3072  lds
    v_mfma_f32_16x16x32_bf16 v[248:251], v[56:59], a[76:79], v[248:251]
    s_waitcnt lgkmcnt(15)
    v_sub_f32 v111, v71, v108
    v_fmac_f32 v109, v111, v111
    v_mfma_f32_16x16x32_bf16 v[156:159], v[60:63], a[64:67], v[156:159]
    s_add_u32 m0, s62, 36864
    s_xor_b32 s98, s96, 33280
    ds_read_b64_tr_b16 v[56:57], v14 offset:40960
    v_mfma_f32_16x16x32_bf16 v[188:191], v[60:63], a[68:71], v[188:191]
    ds_read_b64_tr_b16 v[58:59], v14 offset:41984
    v_sub_f32 v110, v72, v108
    v_mfma_f32_16x16x32_bf16 v[220:223], v[60:63], a[72:75], v[220:223]
    buffer_load_dwordx4 v16, s[12:15], s98 offen offset:0  lds
    v_mfma_f32_16x16x32_bf16 v[252:255], v[60:63], a[76:79], v[252:255]
    s_waitcnt lgkmcnt(14)
    v_fmac_f32 v109, v110, v110
    v_sub_f32 v111, v73, v108
    v_mfma_f32_16x16x32_bf16 v[128:131], v[32:35], a[80:83], v[128:131]
    ds_read_b64_tr_b16 v[60:61], v15 offset:40960
    v_fmac_f32 v109, v111, v111
    v_mfma_f32_16x16x32_bf16 v[160:163], v[32:35], a[84:87], v[160:163]
    s_waitcnt lgkmcnt(13)
    ds_read_b64_tr_b16 v[62:63], v15 offset:41984
    v_sub_f32 v110, v74, v108
    v_mfma_f32_16x16x32_bf16 v[192:195], v[32:35], a[88:91], v[192:195]
    buffer_load_dwordx4 v17, s[12:15], s98 offen offset:1024  lds
    v_mfma_f32_16x16x32_bf16 v[224:227], v[32:35], a[92:95], v[224:227]
    s_waitcnt lgkmcnt(12)
    v_fmac_f32 v109, v110, v110
    v_sub_f32 v111, v75, v108
    v_mfma_f32_16x16x32_bf16 v[132:135], v[36:39], a[80:83], v[132:135]
    buffer_load_dwordx4 v18, s[12:15], s98 offen offset:2048  lds
    v_mfma_f32_16x16x32_bf16 v[164:167], v[36:39], a[84:87], v[164:167]
    v_fmac_f32 v109, v111, v111
    v_sub_f32 v110, v76, v108
    v_mfma_f32_16x16x32_bf16 v[196:199], v[36:39], a[88:91], v[196:199]
    buffer_load_dwordx4 v19, s[12:15], s98 offen offset:3072  lds
    s_cmp_eq_u32 s3, 1
    s_cselect_b32 s101, s100, 2147479552
    buffer_load_dword a243, v117, s[20:23], s101 offen offset:4
    v_mfma_f32_16x16x32_bf16 v[228:231], v[36:39], a[92:95], v[228:231]
    s_waitcnt lgkmcnt(10)
    v_fmac_f32 v109, v110, v110
    v_sub_f32 v111, v77, v108
    v_mfma_f32_16x16x32_bf16 v[136:139], v[40:43], a[80:83], v[136:139]
    v_fmac_f32 v109, v111, v111
    v_sub_f32 v110, v78, v108
    s_waitcnt vmcnt(15) lgkmcnt(0)
    s_barrier
    v_mfma_f32_16x16x32_bf16 v[168:171], v[40:43], a[84:87], v[168:171]
    s_add_u32 m0, s63, 131072
    s_xor_b32 s98, s97, 2621440
    ds_read_b64_tr_b16 v[32:33], v8 offset:0
    v_mfma_f32_16x16x32_bf16 v[200:203], v[40:43], a[88:91], v[200:203]
    ds_read_b64_tr_b16 v[34:35], v8 offset:1024
    v_fmac_f32 v109, v110, v110
    v_mfma_f32_16x16x32_bf16 v[232:235], v[40:43], a[92:95], v[232:235]
    ds_read_b64_tr_b16 v[36:37], v9 offset:0
    v_sub_f32 v111, v79, v108
    v_mfma_f32_16x16x32_bf16 v[140:143], v[44:47], a[80:83], v[140:143]
    ds_read_b64_tr_b16 v[38:39], v9 offset:1024
    v_fmac_f32 v109, v111, v111
    v_mfma_f32_16x16x32_bf16 v[172:175], v[44:47], a[84:87], v[172:175]
    ds_read_b64_tr_b16 v[40:41], v10 offset:0
    v_add_f32_dpp v109, v109, v109 row_ror:8 row_mask:0xf bank_mask:0xf
    v_mfma_f32_16x16x32_bf16 v[204:207], v[44:47], a[88:91], v[204:207]
    ds_read_b64_tr_b16 v[42:43], v10 offset:1024
    v_mov_b32 v110, v109
    v_mfma_f32_16x16x32_bf16 v[236:239], v[44:47], a[92:95], v[236:239]
    ds_read_b128 a[96:99], v28 offset:0
    v_permlane16_swap_b32 v109, v110
    v_mfma_f32_16x16x32_bf16 v[144:147], v[48:51], a[80:83], v[144:147]
    ds_read_b64_tr_b16 v[44:45], v11 offset:0
    v_add_f32 v109, v109, v110
    v_mfma_f32_16x16x32_bf16 v[176:179], v[48:51], a[84:87], v[176:179]
    ds_read_b64_tr_b16 v[46:47], v11 offset:1024
    v_mov_b32 v110, v109
    s_waitcnt vmcnt(13)
    buffer_atomic_add v6, v7, s[36:39], s69 offen sc1
    v_mfma_f32_16x16x32_bf16 v[208:211], v[48:51], a[88:91], v[208:211]
    ds_read_b128 a[100:103], v28 offset:2048
    v_permlane32_swap_b32 v109, v110
    v_mfma_f32_16x16x32_bf16 v[240:243], v[48:51], a[92:95], v[240:243]
    ds_read_b128 a[104:107], v28 offset:4096
    v_add_f32 v109, v109, v110
    v_mfma_f32_16x16x32_bf16 v[148:151], v[52:55], a[80:83], v[148:151]
    ds_read_b64_tr_b16 v[48:49], v12 offset:0
    v_mfma_f32_16x16x32_bf16 v[180:183], v[52:55], a[84:87], v[180:183]
    ds_read_b64_tr_b16 v[50:51], v12 offset:1024
    v_mfma_f32_16x16x32_bf16 v[212:215], v[52:55], a[88:91], v[212:215]
    ds_read_b128 a[108:111], v28 offset:6144
    v_mfma_f32_16x16x32_bf16 v[244:247], v[52:55], a[92:95], v[244:247]
    buffer_load_dwordx4 v20, s[16:19], s98 offen offset:0  lds
    v_mfma_f32_16x16x32_bf16 v[152:155], v[56:59], a[80:83], v[152:155]
    ds_read_b64_tr_b16 v[52:53], v13 offset:0
    v_mfma_f32_16x16x32_bf16 v[184:187], v[56:59], a[84:87], v[184:187]
    ds_read_b64_tr_b16 v[54:55], v13 offset:1024
    v_mfma_f32_16x16x32_bf16 v[216:219], v[56:59], a[88:91], v[216:219]
    buffer_load_dwordx4 v21, s[16:19], s98 offen offset:1024  lds
    v_mfma_f32_16x16x32_bf16 v[248:251], v[56:59], a[92:95], v[248:251]
    ds_write_b64 v100, v[108:109]
    v_mfma_f32_16x16x32_bf16 v[156:159], v[60:63], a[80:83], v[156:159]
    ds_read_b64_tr_b16 v[56:57], v14 offset:0
    v_mfma_f32_16x16x32_bf16 v[188:191], v[60:63], a[84:87], v[188:191]
    ds_read_b64_tr_b16 v[58:59], v14 offset:1024
    v_mfma_f32_16x16x32_bf16 v[220:223], v[60:63], a[88:91], v[220:223]
    buffer_load_dwordx4 v22, s[16:19], s98 offen offset:2048  lds
    v_mfma_f32_16x16x32_bf16 v[252:255], v[60:63], a[92:95], v[252:255]
    s_waitcnt lgkmcnt(12)
    v_mfma_f32_16x16x32_bf16 v[128:131], v[32:35], a[96:99], v[128:131]
    s_waitcnt lgkmcnt(9)
    ds_read_b64_tr_b16 v[60:61], v15 offset:0
    v_mfma_f32_16x16x32_bf16 v[160:163], v[32:35], a[100:103], v[160:163]
    s_waitcnt lgkmcnt(9)
    ds_read_b64_tr_b16 v[62:63], v15 offset:1024
    v_mfma_f32_16x16x32_bf16 v[192:195], v[32:35], a[104:107], v[192:195]
    s_waitcnt lgkmcnt(7)
    ds_read_b128 a[112:115], v29 offset:0
    v_mfma_f32_16x16x32_bf16 v[224:227], v[32:35], a[108:111], v[224:227]
    ds_read_b128 a[116:119], v29 offset:2048
    v_mfma_f32_16x16x32_bf16 v[132:135], v[36:39], a[96:99], v[132:135]
    ds_read_b64_tr_b16 v[32:33], v8 offset:8192
    v_mfma_f32_16x16x32_bf16 v[164:167], v[36:39], a[100:103], v[164:167]
    ds_read_b64_tr_b16 v[34:35], v8 offset:9216
    v_mfma_f32_16x16x32_bf16 v[196:199], v[36:39], a[104:107], v[196:199]
    ds_read_b128 a[120:123], v29 offset:4096
    v_mfma_f32_16x16x32_bf16 v[228:231], v[36:39], a[108:111], v[228:231]
    ds_read_b128 a[124:127], v29 offset:6144
    v_mfma_f32_16x16x32_bf16 v[136:139], v[40:43], a[96:99], v[136:139]
    ds_read_b64_tr_b16 v[36:37], v9 offset:8192
    v_mfma_f32_16x16x32_bf16 v[168:171], v[40:43], a[100:103], v[168:171]
    ds_read_b64_tr_b16 v[38:39], v9 offset:9216
    v_mfma_f32_16x16x32_bf16 v[200:203], v[40:43], a[104:107], v[200:203]
    buffer_load_dwordx4 v23, s[16:19], s98 offen offset:3072  lds
    v_mfma_f32_16x16x32_bf16 v[232:235], v[40:43], a[108:111], v[232:235]
    v_mfma_f32_16x16x32_bf16 v[140:143], v[44:47], a[96:99], v[140:143]
    s_add_u32 m0, s62, 65536
    s_xor_b32 s98, s96, 640
    ds_read_b64_tr_b16 v[40:41], v10 offset:8192
    v_mfma_f32_16x16x32_bf16 v[172:175], v[44:47], a[100:103], v[172:175]
    ds_read_b64_tr_b16 v[42:43], v10 offset:9216
    v_mfma_f32_16x16x32_bf16 v[204:207], v[44:47], a[104:107], v[204:207]
    buffer_load_dwordx4 v16, s[12:15], s98 offen offset:0  lds
    v_mfma_f32_16x16x32_bf16 v[236:239], v[44:47], a[108:111], v[236:239]
    v_mfma_f32_16x16x32_bf16 v[144:147], v[48:51], a[96:99], v[144:147]
    ds_read_b64_tr_b16 v[44:45], v11 offset:8192
    v_mfma_f32_16x16x32_bf16 v[176:179], v[48:51], a[100:103], v[176:179]
    ds_read_b64_tr_b16 v[46:47], v11 offset:9216
    v_mfma_f32_16x16x32_bf16 v[208:211], v[48:51], a[104:107], v[208:211]
    buffer_load_dwordx4 v17, s[12:15], s98 offen offset:1024  lds
    v_mfma_f32_16x16x32_bf16 v[240:243], v[48:51], a[108:111], v[240:243]
    s_waitcnt lgkmcnt(15)
    v_mfma_f32_16x16x32_bf16 v[148:151], v[52:55], a[96:99], v[148:151]
    ds_read_b64_tr_b16 v[48:49], v12 offset:8192
    v_mfma_f32_16x16x32_bf16 v[180:183], v[52:55], a[100:103], v[180:183]
    ds_read_b64_tr_b16 v[50:51], v12 offset:9216
    v_mfma_f32_16x16x32_bf16 v[212:215], v[52:55], a[104:107], v[212:215]
    buffer_load_dwordx4 v18, s[12:15], s98 offen offset:2048  lds
    v_mfma_f32_16x16x32_bf16 v[244:247], v[52:55], a[108:111], v[244:247]
    s_waitcnt lgkmcnt(15)
    v_mfma_f32_16x16x32_bf16 v[152:155], v[56:59], a[96:99], v[152:155]
    ds_read_b64_tr_b16 v[52:53], v13 offset:8192
    v_mfma_f32_16x16x32_bf16 v[184:187], v[56:59], a[100:103], v[184:187]
    ds_read_b64_tr_b16 v[54:55], v13 offset:9216
    v_mfma_f32_16x16x32_bf16 v[216:219], v[56:59], a[104:107], v[216:219]
    buffer_load_dwordx4 v19, s[12:15], s98 offen offset:3072  lds
    v_mfma_f32_16x16x32_bf16 v[248:251], v[56:59], a[108:111], v[248:251]
    s_waitcnt lgkmcnt(15)
    v_mfma_f32_16x16x32_bf16 v[156:159], v[60:63], a[96:99], v[156:159]
    s_add_u32 m0, s62, 69632
    s_xor_b32 s98, s96, 33408
    ds_read_b64_tr_b16 v[56:57], v14 offset:8192
    v_mfma_f32_16x16x32_bf16 v[188:191], v[60:63], a[100:103], v[188:191]
    ds_read_b64_tr_b16 v[58:59], v14 offset:9216
    v_mfma_f32_16x16x32_bf16 v[220:223], v[60:63], a[104:107], v[220:223]
    buffer_load_dwordx4 v16, s[12:15], s98 offen offset:0  lds
    v_mfma_f32_16x16x32_bf16 v[252:255], v[60:63], a[108:111], v[252:255]
    s_waitcnt lgkmcnt(14)
    v_mfma_f32_16x16x32_bf16 v[128:131], v[32:35], a[112:115], v[128:131]
    ds_read_b64_tr_b16 v[60:61], v15 offset:8192
    v_mfma_f32_16x16x32_bf16 v[160:163], v[32:35], a[116:119], v[160:163]
    s_waitcnt lgkmcnt(13)
    ds_read_b64_tr_b16 v[62:63], v15 offset:9216
    v_mfma_f32_16x16x32_bf16 v[192:195], v[32:35], a[120:123], v[192:195]
    buffer_load_dwordx4 v17, s[12:15], s98 offen offset:1024  lds
    v_mfma_f32_16x16x32_bf16 v[224:227], v[32:35], a[124:127], v[224:227]
    s_waitcnt lgkmcnt(12)
    v_mfma_f32_16x16x32_bf16 v[132:135], v[36:39], a[112:115], v[132:135]
    buffer_load_dwordx4 v18, s[12:15], s98 offen offset:2048  lds
    v_mfma_f32_16x16x32_bf16 v[164:167], v[36:39], a[116:119], v[164:167]
    v_mfma_f32_16x16x32_bf16 v[196:199], v[36:39], a[120:123], v[196:199]
    buffer_load_dwordx4 v19, s[12:15], s98 offen offset:3072  lds
    s_cmp_eq_u32 s3, 2
    s_cselect_b32 s101, s100, 2147479552
    buffer_load_dword a245, v117, s[24:27], s101 offen offset:4
    v_mfma_f32_16x16x32_bf16 v[228:231], v[36:39], a[124:127], v[228:231]
    s_waitcnt lgkmcnt(10)
    v_mfma_f32_16x16x32_bf16 v[136:139], v[40:43], a[112:115], v[136:139]
    s_waitcnt vmcnt(15) lgkmcnt(0)
    s_barrier
    v_mfma_f32_16x16x32_bf16 v[168:171], v[40:43], a[116:119], v[168:171]
    s_add_u32 m0, s63, 98304
    s_xor_b32 s98, s97, 3145728
    ds_read_b64_tr_b16 v[32:33], v8 offset:16384
    v_mfma_f32_16x16x32_bf16 v[200:203], v[40:43], a[120:123], v[200:203]
    ds_read_b64_tr_b16 v[34:35], v8 offset:17408
    v_mfma_f32_16x16x32_bf16 v[232:235], v[40:43], a[124:127], v[232:235]
    ds_read_b64_tr_b16 v[36:37], v9 offset:16384
    v_mfma_f32_16x16x32_bf16 v[140:143], v[44:47], a[112:115], v[140:143]
    ds_read_b64_tr_b16 v[38:39], v9 offset:17408
    v_mfma_f32_16x16x32_bf16 v[172:175], v[44:47], a[116:119], v[172:175]
    ds_read_b64_tr_b16 v[40:41], v10 offset:16384
    v_mfma_f32_16x16x32_bf16 v[204:207], v[44:47], a[120:123], v[204:207]
    ds_read_b64_tr_b16 v[42:43], v10 offset:17408
    v_mfma_f32_16x16x32_bf16 v[236:239], v[44:47], a[124:127], v[236:239]
    ds_read_b128 a[128:131], v28 offset:32768
    v_mfma_f32_16x16x32_bf16 v[144:147], v[48:51], a[112:115], v[144:147]
    ds_read_b64_tr_b16 v[44:45], v11 offset:16384
    v_mfma_f32_16x16x32_bf16 v[176:179], v[48:51], a[116:119], v[176:179]
    ds_read_b64_tr_b16 v[46:47], v11 offset:17408
    v_mfma_f32_16x16x32_bf16 v[208:211], v[48:51], a[120:123], v[208:211]
    ds_read_b128 a[132:135], v28 offset:34816
    v_mfma_f32_16x16x32_bf16 v[240:243], v[48:51], a[124:127], v[240:243]
    ds_read_b128 a[136:139], v28 offset:36864
    v_mfma_f32_16x16x32_bf16 v[148:151], v[52:55], a[112:115], v[148:151]
    ds_read_b64_tr_b16 v[48:49], v12 offset:16384
    v_mfma_f32_16x16x32_bf16 v[180:183], v[52:55], a[116:119], v[180:183]
    ds_read_b64_tr_b16 v[50:51], v12 offset:17408
    v_mfma_f32_16x16x32_bf16 v[212:215], v[52:55], a[120:123], v[212:215]
    ds_read_b128 a[140:143], v28 offset:38912
    v_mfma_f32_16x16x32_bf16 v[244:247], v[52:55], a[124:127], v[244:247]
    buffer_load_dwordx4 v20, s[16:19], s98 offen offset:0  lds
    v_mfma_f32_16x16x32_bf16 v[152:155], v[56:59], a[112:115], v[152:155]
    ds_read_b64_tr_b16 v[52:53], v13 offset:16384
    v_mfma_f32_16x16x32_bf16 v[184:187], v[56:59], a[116:119], v[184:187]
    ds_read_b64_tr_b16 v[54:55], v13 offset:17408
    v_mfma_f32_16x16x32_bf16 v[216:219], v[56:59], a[120:123], v[216:219]
    buffer_load_dwordx4 v21, s[16:19], s98 offen offset:1024  lds
    v_mfma_f32_16x16x32_bf16 v[248:251], v[56:59], a[124:127], v[248:251]
    ds_read_b128 v[88:91], v99
    v_mfma_f32_16x16x32_bf16 v[156:159], v[60:63], a[112:115], v[156:159]
    ds_read_b64_tr_b16 v[56:57], v14 offset:16384
    v_mfma_f32_16x16x32_bf16 v[188:191], v[60:63], a[116:119], v[188:191]
    ds_read_b64_tr_b16 v[58:59], v14 offset:17408
    v_mfma_f32_16x16x32_bf16 v[220:223], v[60:63], a[120:123], v[220:223]
    buffer_load_dwordx4 v22, s[16:19], s98 offen offset:2048  lds
    v_mfma_f32_16x16x32_bf16 v[252:255], v[60:63], a[124:127], v[252:255]
    s_waitcnt lgkmcnt(12)
    ds_read_b128 v[92:95], v99 offset:16
    v_mfma_f32_16x16x32_bf16 v[128:131], v[32:35], a[128:131], v[128:131]
    s_waitcnt lgkmcnt(10)
    ds_read_b64_tr_b16 v[60:61], v15 offset:16384
    v_mfma_f32_16x16x32_bf16 v[160:163], v[32:35], a[132:135], v[160:163]
    s_waitcnt lgkmcnt(10)
    ds_read_b64_tr_b16 v[62:63], v15 offset:17408
    v_mfma_f32_16x16x32_bf16 v[192:195], v[32:35], a[136:139], v[192:195]
    s_waitcnt lgkmcnt(8)
    ds_read_b128 a[144:147], v29 offset:32768
    v_mfma_f32_16x16x32_bf16 v[224:227], v[32:35], a[140:143], v[224:227]
    ds_read_b128 a[148:151], v29 offset:34816
    v_mfma_f32_16x16x32_bf16 v[132:135], v[36:39], a[128:131], v[132:135]
    ds_read_b64_tr_b16 v[32:33], v8 offset:24576
    v_mfma_f32_16x16x32_bf16 v[164:167], v[36:39], a[132:135], v[164:167]
    ds_read_b64_tr_b16 v[34:35], v8 offset:25600
    v_mfma_f32_16x16x32_bf16 v[196:199], v[36:39], a[136:139], v[196:199]
    ds_read_b128 a[152:155], v29 offset:36864
    v_mfma_f32_16x16x32_bf16 v[228:231], v[36:39], a[140:143], v[228:231]
    ds_read_b128 a[156:159], v29 offset:38912
    s_waitcnt lgkmcnt(11)
    v_add_f32 v108, v88, v90
    v_mfma_f32_16x16x32_bf16 v[136:139], v[40:43], a[128:131], v[136:139]
    ds_read_b64_tr_b16 v[36:37], v9 offset:24576
    s_waitcnt lgkmcnt(9)
    v_add_f32 v109, v92, v94
    v_mfma_f32_16x16x32_bf16 v[168:171], v[40:43], a[132:135], v[168:171]
    ds_read_b64_tr_b16 v[38:39], v9 offset:25600
    v_add_f32 v108, v108, v109
    v_mfma_f32_16x16x32_bf16 v[200:203], v[40:43], a[136:139], v[200:203]
    buffer_load_dwordx4 v23, s[16:19], s98 offen offset:3072  lds
    v_mfma_f32_16x16x32_bf16 v[232:235], v[40:43], a[140:143], v[232:235]
    v_mul_f32 v108, 0x3e800000, v108
    v_add_f32 v109, v89, v91
    v_mfma_f32_16x16x32_bf16 v[140:143], v[44:47], a[128:131], v[140:143]
    s_add_u32 m0, s62, 0
    s_xor_b32 s98, s96, 768
    ds_read_b64_tr_b16 v[40:41], v10 offset:24576
    v_mfma_f32_16x16x32_bf16 v[172:175], v[44:47], a[132:135], v[172:175]
    ds_read_b64_tr_b16 v[42:43], v10 offset:25600
    v_add_f32 v110, v93, v95
    v_mfma_f32_16x16x32_bf16 v[204:207], v[44:47], a[136:139], v[204:207]
    buffer_load_dwordx4 v16, s[12:15], s98 offen offset:0  lds
    v_mfma_f32_16x16x32_bf16 v[236:239], v[44:47], a[140:143], v[236:239]
    v_add_f32 v109, v109, v110
    v_sub_f32 v88, v88, v108
    v_mfma_f32_16x16x32_bf16 v[144:147], v[48:51], a[128:131], v[144:147]
    ds_read_b64_tr_b16 v[44:45], v11 offset:24576
    v_sub_f32 v90, v90, v108
    v_mfma_f32_16x16x32_bf16 v[176:179], v[48:51], a[132:135], v[176:179]
    ds_read_b64_tr_b16 v[46:47], v11 offset:25600
    v_sub_f32 v92, v92, v108
    v_mfma_f32_16x16x32_bf16 v[208:211], v[48:51], a[136:139], v[208:211]
    buffer_load_dwordx4 v17, s[12:15], s98 offen offset:1024  lds
    v_mfma_f32_16x16x32_bf16 v[240:243], v[48:51], a[140:143], v[240:243]
    v_sub_f32 v94, v94, v108
    v_mul_f32 v110, v88, v88
    v_mfma_f32_16x16x32_bf16 v[148:151], v[52:55], a[128:131], v[148:151]
    ds_read_b64_tr_b16 v[48:49], v12 offset:24576
    v_fmac_f32 v110, v90, v90
    v_mfma_f32_16x16x32_bf16 v[180:183], v[52:55], a[132:135], v[180:183]
    ds_read_b64_tr_b16 v[50:51], v12 offset:25600
    v_fmac_f32 v110, v92, v92
    v_mfma_f32_16x16x32_bf16 v[212:215], v[52:55], a[136:139], v[212:215]
    buffer_load_dwordx4 v18, s[12:15], s98 offen offset:2048  lds
    v_mfma_f32_16x16x32_bf16 v[244:247], v[52:55], a[140:143], v[244:247]
    v_fmac_f32 v110, v94, v94
    v_fmac_f32 v109, 0x43000000, v110
    v_mfma_f32_16x16x32_bf16 v[152:155], v[56:59], a[128:131], v[152:155]
    ds_read_b64_tr_b16 v[52:53], v13 offset:24576
    v_mov_b32 v110, 0x3727c5ac
    v_mfma_f32_16x16x32_bf16 v[184:187], v[56:59], a[132:135], v[184:187]
    ds_read_b64_tr_b16 v[54:55], v13 offset:25600
    v_fmac_f32 v110, 0x3b000000, v109
    v_mfma_f32_16x16x32_bf16 v[216:219], v[56:59], a[136:139], v[216:219]
    buffer_load_dwordx4 v19, s[12:15], s98 offen offset:3072  lds
    v_mfma_f32_16x16x32_bf16 v[248:251], v[56:59], a[140:143], v[248:251]
    s_waitcnt lgkmcnt(15)
    v_rsq_f32 v110, v110
    v_mfma_f32_16x16x32_bf16 v[156:159], v[60:63], a[128:131], v[156:159]
    s_add_u32 m0, s62, 4096
    s_xor_b32 s98, s96, 33536
    ds_read_b64_tr_b16 v[56:57], v14 offset:24576
    v_mfma_f32_16x16x32_bf16 v[188:191], v[60:63], a[132:135], v[188:191]
    ds_read_b64_tr_b16 v[58:59], v14 offset:25600
    v_sub_f32 v64, v64, v108
    v_mfma_f32_16x16x32_bf16 v[220:223], v[60:63], a[136:139], v[220:223]
    buffer_load_dwordx4 v16, s[12:15], s98 offen offset:0  lds
    v_mfma_f32_16x16x32_bf16 v[252:255], v[60:63], a[140:143], v[252:255]
    s_waitcnt lgkmcnt(14)
    v_sub_f32 v65, v65, v108
    v_sub_f32 v66, v66, v108
    v_mfma_f32_16x16x32_bf16 v[128:131], v[32:35], a[144:147], v[128:131]
    ds_read_b64_tr_b16 v[60:61], v15 offset:24576
    v_sub_f32 v67, v67, v108
    v_mfma_f32_16x16x32_bf16 v[160:163], v[32:35], a[148:151], v[160:163]
    s_waitcnt lgkmcnt(13)
    ds_read_b64_tr_b16 v[62:63], v15 offset:25600
    v_sub_f32 v68, v68, v108
    v_mfma_f32_16x16x32_bf16 v[192:195], v[32:35], a[152:155], v[192:195]
    buffer_load_dwordx4 v17, s[12:15], s98 offen offset:1024  lds
    v_mfma_f32_16x16x32_bf16 v[224:227], v[32:35], a[156:159], v[224:227]
    s_waitcnt lgkmcnt(12)
    v_sub_f32 v69, v69, v108
    v_sub_f32 v70, v70, v108
    v_mfma_f32_16x16x32_bf16 v[132:135], v[36:39], a[144:147], v[132:135]
    buffer_load_dwordx4 v18, s[12:15], s98 offen offset:2048  lds
    v_mfma_f32_16x16x32_bf16 v[164:167], v[36:39], a[148:151], v[164:167]
    v_sub_f32 v71, v71, v108
    v_sub_f32 v72, v72, v108
    v_mfma_f32_16x16x32_bf16 v[196:199], v[36:39], a[152:155], v[196:199]
    buffer_load_dwordx4 v19, s[12:15], s98 offen offset:3072  lds
    s_cmp_eq_u32 s3, 3
    s_cselect_b32 s101, s100, 2147479552
    buffer_load_dword a247, v117, s[24:27], s101 offen offset:4
    v_mfma_f32_16x16x32_bf16 v[228:231], v[36:39], a[156:159], v[228:231]
    s_waitcnt lgkmcnt(10)
    v_sub_f32 v73, v73, v108
    v_sub_f32 v74, v74, v108
    v_mfma_f32_16x16x32_bf16 v[136:139], v[40:43], a[144:147], v[136:139]
    v_sub_f32 v75, v75, v108
    v_sub_f32 v76, v76, v108
    s_waitcnt vmcnt(14) lgkmcnt(0)
    s_barrier
    v_mfma_f32_16x16x32_bf16 v[168:171], v[40:43], a[148:151], v[168:171]
    s_add_u32 m0, s63, 114688
    s_xor_b32 s98, s97, 3670016
    ds_read_b64_tr_b16 v[32:33], v8 offset:32768
    v_mfma_f32_16x16x32_bf16 v[200:203], v[40:43], a[152:155], v[200:203]
    ds_read_b64_tr_b16 v[34:35], v8 offset:33792
    v_sub_f32 v77, v77, v108
    v_mfma_f32_16x16x32_bf16 v[232:235], v[40:43], a[156:159], v[232:235]
    ds_read_b64_tr_b16 v[36:37], v9 offset:32768
    v_sub_f32 v78, v78, v108
    v_mfma_f32_16x16x32_bf16 v[140:143], v[44:47], a[144:147], v[140:143]
    ds_read_b64_tr_b16 v[38:39], v9 offset:33792
    v_sub_f32 v79, v79, v108
    v_mfma_f32_16x16x32_bf16 v[172:175], v[44:47], a[148:151], v[172:175]
    ds_read_b64_tr_b16 v[40:41], v10 offset:32768
    v_mul_f32 v64, v64, v110
    v_mfma_f32_16x16x32_bf16 v[204:207], v[44:47], a[152:155], v[204:207]
    ds_read_b64_tr_b16 v[42:43], v10 offset:33792
    v_mul_f32 v65, v65, v110
    v_mfma_f32_16x16x32_bf16 v[236:239], v[44:47], a[156:159], v[236:239]
    ds_read_b128 a[160:163], v30 offset:0
    v_mul_f32 v66, v66, v110
    v_mfma_f32_16x16x32_bf16 v[144:147], v[48:51], a[144:147], v[144:147]
    ds_read_b64_tr_b16 v[44:45], v11 offset:32768
    v_mul_f32 v67, v67, v110
    v_mfma_f32_16x16x32_bf16 v[176:179], v[48:51], a[148:151], v[176:179]
    ds_read_b64_tr_b16 v[46:47], v11 offset:33792
    v_mul_f32 v68, v68, v110
    v_mfma_f32_16x16x32_bf16 v[208:211], v[48:51], a[152:155], v[208:211]
    ds_read_b128 a[164:167], v30 offset:2048
    v_mul_f32 v69, v69, v110
    v_mfma_f32_16x16x32_bf16 v[240:243], v[48:51], a[156:159], v[240:243]
    ds_read_b128 a[168:171], v30 offset:4096
    v_mul_f32 v70, v70, v110
    v_mfma_f32_16x16x32_bf16 v[148:151], v[52:55], a[144:147], v[148:151]
    ds_read_b64_tr_b16 v[48:49], v12 offset:32768
    v_mul_f32 v71, v71, v110
    v_mfma_f32_16x16x32_bf16 v[180:183], v[52:55], a[148:151], v[180:183]
    ds_read_b64_tr_b16 v[50:51], v12 offset:33792
    v_mul_f32 v72, v72, v110
    v_mfma_f32_16x16x32_bf16 v[212:215], v[52:55], a[152:155], v[212:215]
    ds_read_b128 a[172:175], v30 offset:6144
    v_mul_f32 v73, v73, v110
    buffer_load_dword v3, v4, s[36:39], s67 offen sc0 sc1
    v_mfma_f32_16x16x32_bf16 v[244:247], v[52:55], a[156:159], v[244:247]
    buffer_load_dwordx4 v20, s[16:19], s98 offen offset:0  lds
    v_mfma_f32_16x16x32_bf16 v[152:155], v[56:59], a[144:147], v[152:155]
    ds_read_b64_tr_b16 v[52:53], v13 offset:32768
    v_mul_f32 v74, v74, v110
    v_mfma_f32_16x16x32_bf16 v[184:187], v[56:59], a[148:151], v[184:187]
    ds_read_b64_tr_b16 v[54:55], v13 offset:33792
    v_mul_f32 v75, v75, v110
    v_mfma_f32_16x16x32_bf16 v[216:219], v[56:59], a[152:155], v[216:219]
    buffer_load_dwordx4 v21, s[16:19], s98 offen offset:1024  lds
    v_mfma_f32_16x16x32_bf16 v[248:251], v[56:59], a[156:159], v[248:251]
    v_mul_f32 v76, v76, v110
    v_mul_f32 v77, v77, v110
    v_mfma_f32_16x16x32_bf16 v[156:159], v[60:63], a[144:147], v[156:159]
    ds_read_b64_tr_b16 v[56:57], v14 offset:32768
    v_mul_f32 v78, v78, v110
    v_mfma_f32_16x16x32_bf16 v[188:191], v[60:63], a[148:151], v[188:191]
    ds_read_b64_tr_b16 v[58:59], v14 offset:33792
    v_mul_f32 v79, v79, v110
    v_mfma_f32_16x16x32_bf16 v[220:223], v[60:63], a[152:155], v[220:223]
    buffer_load_dwordx4 v22, s[16:19], s98 offen offset:2048  lds
    v_mfma_f32_16x16x32_bf16 v[252:255], v[60:63], a[156:159], v[252:255]
    s_waitcnt lgkmcnt(11)
    v_mfma_f32_16x16x32_bf16 v[128:131], v[32:35], a[160:163], v[128:131]
    s_waitcnt lgkmcnt(8)
    ds_read_b64_tr_b16 v[60:61], v15 offset:32768
    v_and_b32 v96, 31, v2
    v_mfma_f32_16x16x32_bf16 v[160:163], v[32:35], a[164:167], v[160:163]
    s_waitcnt lgkmcnt(8)
    ds_read_b64_tr_b16 v[62:63], v15 offset:33792
    v_lshlrev_b32 v96, 4, v96
    v_mfma_f32_16x16x32_bf16 v[192:195], v[32:35], a[168:171], v[192:195]
    s_waitcnt lgkmcnt(6)
    ds_read_b128 a[176:179], v31 offset:0
    v_lshrrev_b32 v97, 5, v2
    v_mfma_f32_16x16x32_bf16 v[224:227], v[32:35], a[172:175], v[224:227]
    ds_read_b128 a[180:183], v31 offset:2048
    v_lshl_add_u32 v96, v97, 11, v96
    v_mfma_f32_16x16x32_bf16 v[132:135], v[36:39], a[160:163], v[132:135]
    ds_read_b64_tr_b16 v[32:33], v8 offset:40960
    v_mfma_f32_16x16x32_bf16 v[164:167], v[36:39], a[164:167], v[164:167]
    ds_read_b64_tr_b16 v[34:35], v8 offset:41984
    v_mfma_f32_16x16x32_bf16 v[196:199], v[36:39], a[168:171], v[196:199]
    ds_read_b128 a[184:187], v31 offset:4096
    v_mfma_f32_16x16x32_bf16 v[228:231], v[36:39], a[172:175], v[228:231]
    ds_read_b128 a[188:191], v31 offset:6144
    v_mfma_f32_16x16x32_bf16 v[136:139], v[40:43], a[160:163], v[136:139]
    ds_read_b64_tr_b16 v[36:37], v9 offset:40960
    v_mfma_f32_16x16x32_bf16 v[168:171], v[40:43], a[164:167], v[168:171]
    ds_read_b64_tr_b16 v[38:39], v9 offset:41984
    v_mfma_f32_16x16x32_bf16 v[200:203], v[40:43], a[168:171], v[200:203]
    buffer_load_dwordx4 v23, s[16:19], s98 offen offset:3072  lds
    v_mfma_f32_16x16x32_bf16 v[232:235], v[40:43], a[172:175], v[232:235]
    v_mfma_f32_16x16x32_bf16 v[140:143], v[44:47], a[160:163], v[140:143]
    s_add_u32 m0, s62, 32768
    s_xor_b32 s98, s96, 896
    ds_read_b64_tr_b16 v[40:41], v10 offset:40960
    v_mfma_f32_16x16x32_bf16 v[172:175], v[44:47], a[164:167], v[172:175]
    ds_read_b64_tr_b16 v[42:43], v10 offset:41984
    v_mfma_f32_16x16x32_bf16 v[204:207], v[44:47], a[168:171], v[204:207]
    buffer_load_dwordx4 v16, s[12:15], s98 offen offset:0  lds
    v_mfma_f32_16x16x32_bf16 v[236:239], v[44:47], a[172:175], v[236:239]
    v_mfma_f32_16x16x32_bf16 v[144:147], v[48:51], a[160:163], v[144:147]
    ds_read_b64_tr_b16 v[44:45], v11 offset:40960
    v_mfma_f32_16x16x32_bf16 v[176:179], v[48:51], a[164:167], v[176:179]
    ds_read_b64_tr_b16 v[46:47], v11 offset:41984
    v_mfma_f32_16x16x32_bf16 v[208:211], v[48:51], a[168:171], v[208:211]
    buffer_load_dwordx4 v17, s[12:15], s98 offen offset:1024  lds
    v_mfma_f32_16x16x32_bf16 v[240:243], v[48:51], a[172:175], v[240:243]
    s_waitcnt lgkmcnt(15)
    v_mfma_f32_16x16x32_bf16 v[148:151], v[52:55], a[160:163], v[148:151]
    ds_read_b64_tr_b16 v[48:49], v12 offset:40960
    v_mfma_f32_16x16x32_bf16 v[180:183], v[52:55], a[164:167], v[180:183]
    ds_read_b64_tr_b16 v[50:51], v12 offset:41984
    v_mfma_f32_16x16x32_bf16 v[212:215], v[52:55], a[168:171], v[212:215]
    buffer_load_dwordx4 v18, s[12:15], s98 offen offset:2048  lds
    v_mfma_f32_16x16x32_bf16 v[244:247], v[52:55], a[172:175], v[244:247]
    s_waitcnt lgkmcnt(15)
    v_mfma_f32_16x16x32_bf16 v[152:155], v[56:59], a[160:163], v[152:155]
    ds_read_b64_tr_b16 v[52:53], v13 offset:40960
    v_mfma_f32_16x16x32_bf16 v[184:187], v[56:59], a[164:167], v[184:187]
    ds_read_b64_tr_b16 v[54:55], v13 offset:41984
    v_mfma_f32_16x16x32_bf16 v[216:219], v[56:59], a[168:171], v[216:219]
    buffer_load_dwordx4 v19, s[12:15], s98 offen offset:3072  lds
    v_mfma_f32_16x16x32_bf16 v[248:251], v[56:59], a[172:175], v[248:251]
    s_waitcnt lgkmcnt(15)
    v_mfma_f32_16x16x32_bf16 v[156:159], v[60:63], a[160:163], v[156:159]
    s_add_u32 m0, s62, 36864
    s_xor_b32 s98, s96, 33664
    ds_read_b64_tr_b16 v[56:57], v14 offset:40960
    v_mfma_f32_16x16x32_bf16 v[188:191], v[60:63], a[164:167], v[188:191]
    ds_read_b64_tr_b16 v[58:59], v14 offset:41984
    v_mfma_f32_16x16x32_bf16 v[220:223], v[60:63], a[168:171], v[220:223]
    buffer_load_dwordx4 v16, s[12:15], s98 offen offset:0  lds
    v_mfma_f32_16x16x32_bf16 v[252:255], v[60:63], a[172:175], v[252:255]
    s_waitcnt lgkmcnt(14)
    v_mfma_f32_16x16x32_bf16 v[128:131], v[32:35], a[176:179], v[128:131]
    ds_read_b64_tr_b16 v[60:61], v15 offset:40960
    v_mfma_f32_16x16x32_bf16 v[160:163], v[32:35], a[180:183], v[160:163]
    s_waitcnt lgkmcnt(13)
    ds_read_b64_tr_b16 v[62:63], v15 offset:41984
    v_mfma_f32_16x16x32_bf16 v[192:195], v[32:35], a[184:187], v[192:195]
    buffer_load_dwordx4 v17, s[12:15], s98 offen offset:1024  lds
    v_mfma_f32_16x16x32_bf16 v[224:227], v[32:35], a[188:191], v[224:227]
    s_waitcnt lgkmcnt(12)
    v_mfma_f32_16x16x32_bf16 v[132:135], v[36:39], a[176:179], v[132:135]
    buffer_load_dwordx4 v18, s[12:15], s98 offen offset:2048  lds
    v_mfma_f32_16x16x32_bf16 v[164:167], v[36:39], a[180:183], v[164:167]
    v_mfma_f32_16x16x32_bf16 v[196:199], v[36:39], a[184:187], v[196:199]
    buffer_load_dwordx4 v19, s[12:15], s98 offen offset:3072  lds
    v_mfma_f32_16x16x32_bf16 v[228:231], v[36:39], a[188:191], v[228:231]
    s_waitcnt lgkmcnt(10)
    s_waitcnt vmcnt(12)
    v_cmp_le_u32 vcc, s68, v3
    s_cmp_eq_u64 vcc, -1
    s_cbranch_scc0 L_E_slow_1
L_E_ok_2:
    v_mfma_f32_16x16x32_bf16 v[136:139], v[40:43], a[176:179], v[136:139]
    s_waitcnt lgkmcnt(0)
    s_barrier
    v_mfma_f32_16x16x32_bf16 v[168:171], v[40:43], a[180:183], v[168:171]
    s_add_u32 m0, s62, 65536
    s_xor_b32 s98, s64, 0
    ds_read_b64_tr_b16 v[32:33], v8 offset:0
    v_mfma_f32_16x16x32_bf16 v[200:203], v[40:43], a[184:187], v[200:203]
    ds_read_b64_tr_b16 v[34:35], v8 offset:1024
    v_mov_b32 v18, v106
    v_mfma_f32_16x16x32_bf16 v[232:235], v[40:43], a[188:191], v[232:235]
    ds_read_b64_tr_b16 v[36:37], v9 offset:0
    v_mov_b32 v19, v107
    v_mfma_f32_16x16x32_bf16 v[140:143], v[44:47], a[176:179], v[140:143]
    ds_read_b64_tr_b16 v[38:39], v9 offset:1024
    v_mfma_f32_16x16x32_bf16 v[172:175], v[44:47], a[180:183], v[172:175]
    ds_read_b64_tr_b16 v[40:41], v10 offset:0
    v_mfma_f32_16x16x32_bf16 v[204:207], v[44:47], a[184:187], v[204:207]
    ds_read_b64_tr_b16 v[42:43], v10 offset:1024
    v_mfma_f32_16x16x32_bf16 v[236:239], v[44:47], a[188:191], v[236:239]
    ds_read_b128 a[192:195], v28 offset:0
    v_mfma_f32_16x16x32_bf16 v[144:147], v[48:51], a[176:179], v[144:147]
    ds_read_b64_tr_b16 v[44:45], v11 offset:0
    v_mfma_f32_16x16x32_bf16 v[176:179], v[48:51], a[180:183], v[176:179]
    ds_read_b64_tr_b16 v[46:47], v11 offset:1024
    v_mfma_f32_16x16x32_bf16 v[208:211], v[48:51], a[184:187], v[208:211]
    ds_read_b128 a[196:199], v28 offset:2048
    v_mfma_f32_16x16x32_bf16 v[240:243], v[48:51], a[188:191], v[240:243]
    ds_read_b128 a[200:203], v28 offset:4096
    v_mfma_f32_16x16x32_bf16 v[148:151], v[52:55], a[176:179], v[148:151]
    ds_read_b64_tr_b16 v[48:49], v12 offset:0
    v_mfma_f32_16x16x32_bf16 v[180:183], v[52:55], a[180:183], v[180:183]
    ds_read_b64_tr_b16 v[50:51], v12 offset:1024
    v_mfma_f32_16x16x32_bf16 v[212:215], v[52:55], a[184:187], v[212:215]
    ds_read_b128 a[204:207], v28 offset:6144
    v_mfma_f32_16x16x32_bf16 v[244:247], v[52:55], a[188:191], v[244:247]
    buffer_load_dwordx4 v24, s[20:23], s98 offen offset:0  lds
    v_mfma_f32_16x16x32_bf16 v[152:155], v[56:59], a[176:179], v[152:155]
    ds_read_b64_tr_b16 v[52:53], v13 offset:0
    v_mfma_f32_16x16x32_bf16 v[184:187], v[56:59], a[180:183], v[184:187]
    ds_read_b64_tr_b16 v[54:55], v13 offset:1024
    v_mfma_f32_16x16x32_bf16 v[216:219], v[56:59], a[184:187], v[216:219]
    buffer_load_dwordx4 v[80:83], v96, s[8:11], s70 offen
    v_mfma_f32_16x16x32_bf16 v[248:251], v[56:59], a[188:191], v[248:251]
    buffer_load_dwordx4 v25, s[20:23], s98 offen offset:1024  lds
    v_mfma_f32_16x16x32_bf16 v[156:159], v[60:63], a[176:179], v[156:159]
    s_lshl_b32 s80, s2, 6
    s_add_u32 s80, s80, 1310720
    ds_read_b64_tr_b16 v[56:57], v14 offset:0
    v_mfma_f32_16x16x32_bf16 v[188:191], v[60:63], a[180:183], v[188:191]
    s_waitcnt lgkmcnt(10)
    s_add_u32 s70, s70, 12288
    ds_read_b64_tr_b16 v[58:59], v14 offset:1024
    v_mfma_f32_16x16x32_bf16 v[220:223], v[60:63], a[184:187], v[220:223]
    buffer_store_dword v6, v7, s[8:11], s80 offen sc0 sc1
    v_mfma_f32_16x16x32_bf16 v[252:255], v[60:63], a[188:191], v[252:255]
    buffer_load_dwordx4 v26, s[20:23], s98 offen offset:2048  lds
    v_mfma_f32_16x16x32_bf16 v[128:131], v[32:35], a[192:195], v[128:131]
    s_waitcnt lgkmcnt(8)
    ds_read_b64_tr_b16 v[60:61], v15 offset:0
    v_mfma_f32_16x16x32_bf16 v[160:163], v[32:35], a[196:199], v[160:163]
    s_waitcnt lgkmcnt(8)
    ds_read_b64_tr_b16 v[62:63], v15 offset:1024
    v_mfma_f32_16x16x32_bf16 v[192:195], v[32:35], a[200:203], v[192:195]
    s_waitcnt lgkmcnt(6)
    ds_read_b128 a[208:211], v29 offset:0
    v_mfma_f32_16x16x32_bf16 v[224:227], v[32:35], a[204:207], v[224:227]
    ds_read_b128 a[212:215], v29 offset:2048
    v_mfma_f32_16x16x32_bf16 v[132:135], v[36:39], a[192:195], v[132:135]
    ds_read_b64_tr_b16 v[32:33], v8 offset:8192
    v_mfma_f32_16x16x32_bf16 v[164:167], v[36:39], a[196:199], v[164:167]
    ds_read_b64_tr_b16 v[34:35], v8 offset:9216
    v_mfma_f32_16x16x32_bf16 v[196:199], v[36:39], a[200:203], v[196:199]
    ds_read_b128 a[216:219], v29 offset:4096
    v_mfma_f32_16x16x32_bf16 v[228:231], v[36:39], a[204:207], v[228:231]
    ds_read_b128 a[220:223], v29 offset:6144
    v_mfma_f32_16x16x32_bf16 v[136:139], v[40:43], a[192:195], v[136:139]
    ds_read_b64_tr_b16 v[36:37], v9 offset:8192
    v_mfma_f32_16x16x32_bf16 v[168:171], v[40:43], a[196:199], v[168:171]
    ds_read_b64_tr_b16 v[38:39], v9 offset:9216
    v_mfma_f32_16x16x32_bf16 v[200:203], v[40:43], a[200:203], v[200:203]
    buffer_load_dwordx4 v27, s[20:23], s98 offen offset:3072  lds
    v_mfma_f32_16x16x32_bf16 v[232:235], v[40:43], a[204:207], v[232:235]
    buffer_load_dwordx4 v[84:87], v96, s[8:11], s70 offen
    v_mfma_f32_16x16x32_bf16 v[140:143], v[44:47], a[192:195], v[140:143]
    s_add_u32 m0, s62, 69632
    s_xor_b32 s98, s64, 262144
    ds_read_b64_tr_b16 v[40:41], v10 offset:8192
    v_mfma_f32_16x16x32_bf16 v[172:175], v[44:47], a[196:199], v[172:175]
    s_add_u32 s70, s70, 12288
    ds_read_b64_tr_b16 v[42:43], v10 offset:9216
    v_mfma_f32_16x16x32_bf16 v[204:207], v[44:47], a[200:203], v[204:207]
    buffer_load_dwordx4 v24, s[20:23], s98 offen offset:0  lds
    v_mfma_f32_16x16x32_bf16 v[236:239], v[44:47], a[204:207], v[236:239]
    buffer_load_dwordx4 v[88:91], v96, s[8:11], s70 offen
    v_mfma_f32_16x16x32_bf16 v[144:147], v[48:51], a[192:195], v[144:147]
    s_add_u32 s70, s70, 12288
    ds_read_b64_tr_b16 v[44:45], v11 offset:8192
    v_mfma_f32_16x16x32_bf16 v[176:179], v[48:51], a[196:199], v[176:179]
    s_waitcnt lgkmcnt(15)
    ds_read_b64_tr_b16 v[46:47], v11 offset:9216
    v_mfma_f32_16x16x32_bf16 v[208:211], v[48:51], a[200:203], v[208:211]
    buffer_load_dwordx4 v25, s[20:23], s98 offen offset:1024  lds
    v_mfma_f32_16x16x32_bf16 v[240:243], v[48:51], a[204:207], v[240:243]
    buffer_load_dwordx4 v[92:95], v96, s[8:11], s70 offen
    v_mfma_f32_16x16x32_bf16 v[148:151], v[52:55], a[192:195], v[148:151]
    ds_read_b64_tr_b16 v[48:49], v12 offset:8192
    v_mfma_f32_16x16x32_bf16 v[180:183], v[52:55], a[196:199], v[180:183]
    ds_read_b64_tr_b16 v[50:51], v12 offset:9216
    v_mfma_f32_16x16x32_bf16 v[212:215], v[52:55], a[200:203], v[212:215]
    buffer_load_dwordx4 v26, s[20:23], s98 offen offset:2048  lds
    v_mfma_f32_16x16x32_bf16 v[244:247], v[52:55], a[204:207], v[244:247]
    s_waitcnt lgkmcnt(15)
    v_mfma_f32_16x16x32_bf16 v[152:155], v[56:59], a[192:195], v[152:155]
    ds_read_b64_tr_b16 v[52:53], v13 offset:8192
    v_mfma_f32_16x16x32_bf16 v[184:187], v[56:59], a[196:199], v[184:187]
    ds_read_b64_tr_b16 v[54:55], v13 offset:9216
    v_mfma_f32_16x16x32_bf16 v[216:219], v[56:59], a[200:203], v[216:219]
    buffer_load_dwordx4 v27, s[20:23], s98 offen offset:3072  lds
    v_mfma_f32_16x16x32_bf16 v[248:251], v[56:59], a[204:207], v[248:251]
    s_waitcnt lgkmcnt(15)
    v_mfma_f32_16x16x32_bf16 v[156:159], v[60:63], a[192:195], v[156:159]
    ds_read_b64_tr_b16 v[56:57], v14 offset:8192
    v_mfma_f32_16x16x32_bf16 v[188:191], v[60:63], a[196:199], v[188:191]
    ds_read_b64_tr_b16 v[58:59], v14 offset:9216
    v_mfma_f32_16x16x32_bf16 v[220:223], v[60:63], a[200:203], v[220:223]
    v_mfma_f32_16x16x32_bf16 v[252:255], v[60:63], a[204:207], v[252:255]
    s_waitcnt lgkmcnt(14)
    v_mfma_f32_16x16x32_bf16 v[128:131], v[32:35], a[208:211], v[128:131]
    ds_read_b64_tr_b16 v[60:61], v15 offset:8192
    v_mfma_f32_16x16x32_bf16 v[160:163], v[32:35], a[212:215], v[160:163]
    s_waitcnt lgkmcnt(14)
    ds_read_b64_tr_b16 v[62:63], v15 offset:9216
    v_mfma_f32_16x16x32_bf16 v[192:195], v[32:35], a[216:219], v[192:195]
    s_waitcnt lgkmcnt(14)
    v_mfma_f32_16x16x32_bf16 v[224:227], v[32:35], a[220:223], v[224:227]
    s_waitcnt lgkmcnt(12)
    v_mfma_f32_16x16x32_bf16 v[132:135], v[36:39], a[208:211], v[132:135]
    v_mfma_f32_16x16x32_bf16 v[164:167], v[36:39], a[212:215], v[164:167]
    v_mfma_f32_16x16x32_bf16 v[196:199], v[36:39], a[216:219], v[196:199]
    v_mfma_f32_16x16x32_bf16 v[228:231], v[36:39], a[220:223], v[228:231]
    s_waitcnt lgkmcnt(10)
    v_mfma_f32_16x16x32_bf16 v[136:139], v[40:43], a[208:211], v[136:139]
    s_waitcnt vmcnt(13) lgkmcnt(0)
    s_barrier
    v_mfma_f32_16x16x32_bf16 v[168:171], v[40:43], a[212:215], v[168:171]
    s_add_u32 m0, s62, 0
    s_xor_b32 s98, s64, 2097152
    ds_read_b64_tr_b16 v[32:33], v8 offset:16384
    v_mfma_f32_16x16x32_bf16 v[200:203], v[40:43], a[216:219], v[200:203]
    ds_read_b64_tr_b16 v[34:35], v8 offset:17408
    v_mfma_f32_16x16x32_bf16 v[232:235], v[40:43], a[220:223], v[232:235]
    ds_read_b64_tr_b16 v[36:37], v9 offset:16384
    v_mfma_f32_16x16x32_bf16 v[140:143], v[44:47], a[208:211], v[140:143]
    ds_read_b64_tr_b16 v[38:39], v9 offset:17408
    v_mfma_f32_16x16x32_bf16 v[172:175], v[44:47], a[212:215], v[172:175]
    ds_read_b64_tr_b16 v[40:41], v10 offset:16384
    v_mfma_f32_16x16x32_bf16 v[204:207], v[44:47], a[216:219], v[204:207]
    ds_read_b64_tr_b16 v[42:43], v10 offset:17408
    v_mfma_f32_16x16x32_bf16 v[236:239], v[44:47], a[220:223], v[236:239]
    ds_read_b128 a[224:227], v28 offset:32768
    v_mfma_f32_16x16x32_bf16 v[144:147], v[48:51], a[208:211], v[144:147]
    ds_read_b64_tr_b16 v[44:45], v11 offset:16384
    v_mfma_f32_16x16x32_bf16 v[176:179], v[48:51], a[212:215], v[176:179]
    ds_read_b64_tr_b16 v[46:47], v11 offset:17408
    v_mfma_f32_16x16x32_bf16 v[208:211], v[48:51], a[216:219], v[208:211]
    ds_read_b128 a[228:231], v28 offset:34816
    v_mfma_f32_16x16x32_bf16 v[240:243], v[48:51], a[220:223], v[240:243]
    ds_read_b128 a[232:235], v28 offset:36864
    v_mfma_f32_16x16x32_bf16 v[148:151], v[52:55], a[208:211], v[148:151]
    ds_read_b64_tr_b16 v[48:49], v12 offset:16384
    v_mfma_f32_16x16x32_bf16 v[180:183], v[52:55], a[212:215], v[180:183]
    ds_read_b64_tr_b16 v[50:51], v12 offset:17408
    v_mfma_f32_16x16x32_bf16 v[212:215], v[52:55], a[216:219], v[212:215]
    ds_read_b128 a[236:239], v28 offset:38912
    v_mfma_f32_16x16x32_bf16 v[244:247], v[52:55], a[220:223], v[244:247]
    buffer_load_dwordx4 v24, s[20:23], s98 offen offset:0  lds
    v_mfma_f32_16x16x32_bf16 v[152:155], v[56:59], a[208:211], v[152:155]
    ds_read_b64_tr_b16 v[52:53], v13 offset:16384
    v_mfma_f32_16x16x32_bf16 v[184:187], v[56:59], a[212:215], v[184:187]
    ds_read_b64_tr_b16 v[54:55], v13 offset:17408
    v_mfma_f32_16x16x32_bf16 v[216:219], v[56:59], a[216:219], v[216:219]
    v_mfma_f32_16x16x32_bf16 v[248:251], v[56:59], a[220:223], v[248:251]
    buffer_load_dwordx4 v25, s[20:23], s98 offen offset:1024  lds
    v_mfma_f32_16x16x32_bf16 v[156:159], v[60:63], a[208:211], v[156:159]
    ds_read_b64_tr_b16 v[56:57], v14 offset:16384
    v_mfma_f32_16x16x32_bf16 v[188:191], v[60:63], a[212:215], v[188:191]
    ds_read_b64_tr_b16 v[58:59], v14 offset:17408
    v_mfma_f32_16x16x32_bf16 v[220:223], v[60:63], a[216:219], v[220:223]
    s_waitcnt lgkmcnt(11)
    v_mfma_f32_16x16x32_bf16 v[252:255], v[60:63], a[220:223], v[252:255]
    buffer_load_dwordx4 v26, s[20:23], s98 offen offset:2048  lds
    v_mfma_f32_16x16x32_bf16 v[128:131], v[32:35], a[224:227], v[128:131]
    s_waitcnt lgkmcnt(8)
    ds_read_b64_tr_b16 v[60:61], v15 offset:16384
    v_mfma_f32_16x16x32_bf16 v[160:163], v[32:35], a[228:231], v[160:163]
    s_waitcnt lgkmcnt(8)
    ds_read_b64_tr_b16 v[62:63], v15 offset:17408
    v_mfma_f32_16x16x32_bf16 v[192:195], v[32:35], a[232:235], v[192:195]
    s_waitcnt lgkmcnt(6)
    ds_read_b128 a[240:243], v29 offset:32768
    v_mfma_f32_16x16x32_bf16 v[224:227], v[32:35], a[236:239], v[224:227]
    ds_read_b128 a[244:247], v29 offset:34816
    v_mfma_f32_16x16x32_bf16 v[132:135], v[36:39], a[224:227], v[132:135]
    ds_read_b64_tr_b16 v[32:33], v8 offset:24576
    v_mfma_f32_16x16x32_bf16 v[164:167], v[36:39], a[228:231], v[164:167]
    ds_read_b64_tr_b16 v[34:35], v8 offset:25600
    s_waitcnt vmcnt(9)
    v_add_f32 v80, v80, v84
    s_waitcnt vmcnt(5)
    v_add_f32 v88, v88, v92
    v_mfma_f32_16x16x32_bf16 v[196:199], v[36:39], a[232:235], v[196:199]
    ds_read_b128 a[248:251], v29 offset:36864
    v_add_f32 v81, v81, v85
    v_add_f32 v89, v89, v93
    v_mfma_f32_16x16x32_bf16 v[228:231], v[36:39], a[236:239], v[228:231]
    ds_read_b128 a[252:255], v29 offset:38912
    v_add_f32 v82, v82, v86
    v_add_f32 v90, v90, v94
    v_mfma_f32_16x16x32_bf16 v[136:139], v[40:43], a[224:227], v[136:139]
    ds_read_b64_tr_b16 v[36:37], v9 offset:24576
    v_and_b32 v16, 15, v2
    v_add_f32 v83, v83, v87
    v_mfma_f32_16x16x32_bf16 v[168:171], v[40:43], a[228:231], v[168:171]
    ds_read_b64_tr_b16 v[38:39], v9 offset:25600
    v_lshrrev_b32 v17, 4, v2
    v_add_f32 v91, v91, v95
    v_mfma_f32_16x16x32_bf16 v[200:203], v[40:43], a[232:235], v[200:203]
    v_lshrrev_b32 v29, 2, v16
    v_and_b32 v16, 3, v16
    v_add_f32 v80, v80, v88
    v_mfma_f32_16x16x32_bf16 v[232:235], v[40:43], a[236:239], v[232:235]
    buffer_load_dwordx4 v27, s[20:23], s98 offen offset:3072  lds
    v_add_f32 v81, v81, v89
    v_mfma_f32_16x16x32_bf16 v[140:143], v[44:47], a[224:227], v[140:143]
    s_add_u32 m0, s62, 4096
    ds_read_b64_tr_b16 v[40:41], v10 offset:24576
    v_lshl_add_u32 v28, v17, 3, v29
    v_add_f32 v82, v82, v90
    v_mfma_f32_16x16x32_bf16 v[172:175], v[44:47], a[228:231], v[172:175]
    s_xor_b32 s98, s64, 2359296
    ds_read_b64_tr_b16 v[42:43], v10 offset:25600
    v_lshlrev_b32 v28, 7, v28
    v_add_f32 v83, v83, v91
    v_mfma_f32_16x16x32_bf16 v[204:207], v[44:47], a[232:235], v[204:207]
    v_lshl_add_u32 v28, v16, 3, v28
    v_and_b32 v17, 1, v17
    v_lshrrev_b32 v88, 5, v2
    v_mfma_f32_16x16x32_bf16 v[236:239], v[44:47], a[236:239], v[236:239]
    buffer_load_dwordx4 v24, s[20:23], s98 offen offset:0  lds
    v_cvt_f32_u32 v88, v88
    v_mfma_f32_16x16x32_bf16 v[144:147], v[48:51], a[224:227], v[144:147]
    ds_read_b64_tr_b16 v[44:45], v11 offset:24576
    v_lshrrev_b32 v29, 1, v29
    v_cvt_pk_bf16_f32 v84, v80, v81
    v_mfma_f32_16x16x32_bf16 v[176:179], v[48:51], a[228:231], v[176:179]
    ds_read_b64_tr_b16 v[46:47], v11 offset:25600
    v_lshl_add_u32 v29, v17, 1, v29
    v_cvt_pk_bf16_f32 v85, v82, v83
    v_mfma_f32_16x16x32_bf16 v[208:211], v[48:51], a[232:235], v[208:211]
    s_waitcnt lgkmcnt(15)
    v_lshl_add_u32 v28, v29, 5, v28
    v_add_u32 v28, 65536, v28
    v_lshlrev_b32 v80, 16, v84
    v_mfma_f32_16x16x32_bf16 v[240:243], v[48:51], a[236:239], v[240:243]
    buffer_load_dwordx4 v25, s[20:23], s98 offen offset:1024  lds
    v_and_b32 v81, 0xffff0000, v84
    v_mfma_f32_16x16x32_bf16 v[148:151], v[52:55], a[224:227], v[148:151]
    ds_read_b64_tr_b16 v[48:49], v12 offset:24576
    v_xor_b32 v29, 32, v28
    v_lshlrev_b32 v82, 16, v85
    v_mfma_f32_16x16x32_bf16 v[180:183], v[52:55], a[228:231], v[180:183]
    ds_read_b64_tr_b16 v[50:51], v12 offset:25600
    v_xor_b32 v30, 64, v28
    v_and_b32 v83, 0xffff0000, v85
    v_mfma_f32_16x16x32_bf16 v[212:215], v[52:55], a[232:235], v[212:215]
    s_waitcnt lgkmcnt(15)
    v_xor_b32 v31, 96, v28
    v_and_b32 v16, 15, v2
    v_add_f32 v80, v80, v88
    v_mfma_f32_16x16x32_bf16 v[244:247], v[52:55], a[236:239], v[244:247]
    buffer_load_dwordx4 v26, s[20:23], s98 offen offset:2048  lds
    v_add_f32 v81, v81, v88
    v_mfma_f32_16x16x32_bf16 v[152:155], v[56:59], a[224:227], v[152:155]
    ds_read_b64_tr_b16 v[52:53], v13 offset:24576
    v_lshlrev_b32 v16, 6, v16
    v_add_f32 v82, v82, v88
    v_mfma_f32_16x16x32_bf16 v[184:187], v[56:59], a[228:231], v[184:187]
    ds_read_b64_tr_b16 v[54:55], v13 offset:25600
    v_add_u32 v16, 65536, v16
    v_add_f32 v83, v83, v88
    v_mfma_f32_16x16x32_bf16 v[216:219], v[56:59], a[232:235], v[216:219]
    s_waitcnt lgkmcnt(15)
    v_mad_i32_i24 v16, v17, s77, v16
    v_and_b32 v17, 31, v2
    v_cvt_pk_bf16_f32 v84, v80, v81
    v_mfma_f32_16x16x32_bf16 v[248:251], v[56:59], a[236:239], v[248:251]
    buffer_load_dwordx4 v27, s[20:23], s98 offen offset:3072  lds
    v_cvt_pk_bf16_f32 v85, v82, v83
    v_mfma_f32_16x16x32_bf16 v[156:159], v[60:63], a[224:227], v[156:159]
    ds_read_b64_tr_b16 v[56:57], v14 offset:24576
    v_lshlrev_b32 v17, 6, v17
    v_lshlrev_b32 v80, 16, v84
    v_mfma_f32_16x16x32_bf16 v[188:191], v[60:63], a[228:231], v[188:191]
    ds_read_b64_tr_b16 v[58:59], v14 offset:25600
    v_and_b32 v81, 0xffff0000, v84
    v_lshlrev_b32 v82, 16, v85
    v_mfma_f32_16x16x32_bf16 v[220:223], v[60:63], a[232:235], v[220:223]
    v_and_b32 v83, 0xffff0000, v85
    v_mul_f32 v80, 0x3e0293ee, v80
    v_mul_f32 v81, 0x3e0293ee, v81
    v_mfma_f32_16x16x32_bf16 v[252:255], v[60:63], a[236:239], v[252:255]
    s_waitcnt lgkmcnt(14)
    v_mul_f32 v82, 0x3e0293ee, v82
    v_mul_f32 v83, 0x3e0293ee, v83
    v_mfma_f32_16x16x32_bf16 v[128:131], v[32:35], a[240:243], v[128:131]
    s_lshl_b32 s70, s3, 10
    s_add_u32 s70, s70, 151552
    ds_read_b64_tr_b16 v[60:61], v15 offset:24576
    v_add_u32 v88, s70, v1
    v_add_u32 v18, s70, v18
    v_mfma_f32_16x16x32_bf16 v[160:163], v[32:35], a[244:247], v[160:163]
    s_waitcnt lgkmcnt(14)
    ds_read_b64_tr_b16 v[62:63], v15 offset:25600
    ds_write_b128 v88, v[80:83]
    v_mfma_f32_16x16x32_bf16 v[192:195], v[32:35], a[248:251], v[192:195]
    s_waitcnt lgkmcnt(15)
    v_mfma_f32_16x16x32_bf16 v[224:227], v[32:35], a[252:255], v[224:227]
    s_waitcnt lgkmcnt(13)
    v_mfma_f32_16x16x32_bf16 v[132:135], v[36:39], a[240:243], v[132:135]
    v_mfma_f32_16x16x32_bf16 v[164:167], v[36:39], a[244:247], v[164:167]
    v_mfma_f32_16x16x32_bf16 v[196:199], v[36:39], a[248:251], v[196:199]
    v_mfma_f32_16x16x32_bf16 v[228:231], v[36:39], a[252:255], v[228:231]
    s_waitcnt lgkmcnt(11)
    ds_read_b128 v[80:83], v18 offset:0
    v_mfma_f32_16x16x32_bf16 v[136:139], v[40:43], a[240:243], v[136:139]
    ds_read_b128 v[84:87], v18 offset:16
    s_waitcnt vmcnt(8) lgkmcnt(0)
    s_barrier
    v_mfma_f32_16x16x32_bf16 v[168:171], v[40:43], a[244:247], v[168:171]
    s_add_u32 m0, s62, 32768
    s_xor_b32 s98, s64, 128
    ds_read_b64_tr_b16 v[32:33], v28 offset:0
    v_mfma_f32_16x16x32_bf16 v[200:203], v[40:43], a[248:251], v[200:203]
    ds_read_b64_tr_b16 v[34:35], v28 offset:512
    v_mfma_f32_16x16x32_bf16 v[232:235], v[40:43], a[252:255], v[232:235]
    ds_read_b64_tr_b16 v[36:37], v28 offset:4096
    v_mfma_f32_16x16x32_bf16 v[140:143], v[44:47], a[240:243], v[140:143]
    ds_read_b64_tr_b16 v[38:39], v28 offset:4608
    v_mfma_f32_16x16x32_bf16 v[172:175], v[44:47], a[244:247], v[172:175]
    ds_read_b64_tr_b16 v[40:41], v29 offset:0
    v_mfma_f32_16x16x32_bf16 v[204:207], v[44:47], a[248:251], v[204:207]
    ds_read_b64_tr_b16 v[42:43], v29 offset:512
    v_mfma_f32_16x16x32_bf16 v[236:239], v[44:47], a[252:255], v[236:239]
    buffer_load_dwordx4 v24, s[20:23], s98 offen offset:0  lds
    v_mfma_f32_16x16x32_bf16 v[144:147], v[48:51], a[240:243], v[144:147]
    ds_read_b64_tr_b16 v[44:45], v29 offset:4096
    v_mfma_f32_16x16x32_bf16 v[176:179], v[48:51], a[244:247], v[176:179]
    ds_read_b64_tr_b16 v[46:47], v29 offset:4608
    v_mfma_f32_16x16x32_bf16 v[208:211], v[48:51], a[248:251], v[208:211]
    ds_read_b128 v[88:91], v18 offset:512
    v_mfma_f32_16x16x32_bf16 v[240:243], v[48:51], a[252:255], v[240:243]
    buffer_load_dwordx4 v25, s[20:23], s98 offen offset:1024  lds
    v_mfma_f32_16x16x32_bf16 v[148:151], v[52:55], a[240:243], v[148:151]
    ds_read_b64_tr_b16 v[48:49], v28 offset:8192
    v_mfma_f32_16x16x32_bf16 v[180:183], v[52:55], a[244:247], v[180:183]
    ds_read_b64_tr_b16 v[50:51], v28 offset:8704
    v_mfma_f32_16x16x32_bf16 v[212:215], v[52:55], a[248:251], v[212:215]
    ds_read_b128 v[92:95], v18 offset:528
    v_mfma_f32_16x16x32_bf16 v[244:247], v[52:55], a[252:255], v[244:247]
    buffer_load_dwordx4 v26, s[20:23], s98 offen offset:2048  lds
    v_mfma_f32_16x16x32_bf16 v[152:155], v[56:59], a[240:243], v[152:155]
    ds_read_b64_tr_b16 v[52:53], v28 offset:12288
    v_mfma_f32_16x16x32_bf16 v[184:187], v[56:59], a[244:247], v[184:187]
    ds_read_b64_tr_b16 v[54:55], v28 offset:12800
    v_mfma_f32_16x16x32_bf16 v[216:219], v[56:59], a[248:251], v[216:219]
    v_mfma_f32_16x16x32_bf16 v[248:251], v[56:59], a[252:255], v[248:251]
    buffer_load_dwordx4 v27, s[20:23], s98 offen offset:3072  lds
    v_mfma_f32_16x16x32_bf16 v[156:159], v[60:63], a[240:243], v[156:159]
    s_add_u32 m0, s62, 36864
    s_xor_b32 s98, s64, 262272
    ds_read_b64_tr_b16 v[56:57], v29 offset:8192
    v_mfma_f32_16x16x32_bf16 v[188:191], v[60:63], a[244:247], v[188:191]
    ds_read_b64_tr_b16 v[58:59], v29 offset:8704
    s_waitcnt lgkmcnt(7)
    v_fma_f32 v64, v64, v88, v80
    v_mfma_f32_16x16x32_bf16 v[220:223], v[60:63], a[248:251], v[220:223]
    v_fma_f32 v65, v65, v89, v81
    v_fma_f32 v66, v66, v90, v82
    v_mfma_f32_16x16x32_bf16 v[252:255], v[60:63], a[252:255], v[252:255]
    buffer_load_dwordx4 v24, s[20:23], s98 offen offset:0  lds
    v_mfma_f32_16x16x32_bf16 v[96:99], a[0:3], v[32:35], 0
    ds_read_b64_tr_b16 v[60:61], v29 offset:12288
    v_fma_f32 v67, v67, v91, v83
    v_mfma_f32_16x16x32_bf16 v[96:99], a[16:19], v[36:39], v[96:99]
    ds_read_b64_tr_b16 v[62:63], v29 offset:12800
    s_waitcnt lgkmcnt(6)
    v_fma_f32 v68, v68, v92, v84
    v_mfma_f32_16x16x32_bf16 v[100:103], a[4:7], v[32:35], 0
    v_fma_f32 v69, v69, v93, v85
    v_fma_f32 v70, v70, v94, v86
    v_mfma_f32_16x16x32_bf16 v[100:103], a[20:23], v[36:39], v[100:103]
    buffer_load_dwordx4 v25, s[20:23], s98 offen offset:1024  lds
    v_mfma_f32_16x16x32_bf16 v[104:107], a[8:11], v[32:35], 0
    v_fma_f32 v71, v71, v95, v87
    v_mfma_f32_16x16x32_bf16 v[104:107], a[24:27], v[36:39], v[104:107]
    v_cvt_pk_bf16_f32 v64, v64, v65
    v_cvt_pk_bf16_f32 v65, v66, v67
    v_mfma_f32_16x16x32_bf16 v[108:111], a[12:15], v[32:35], 0
    v_cvt_pk_bf16_f32 v66, v68, v69
    v_cvt_pk_bf16_f32 v67, v70, v71
    v_mfma_f32_16x16x32_bf16 v[108:111], a[28:31], v[36:39], v[108:111]
    buffer_load_dwordx4 v26, s[20:23], s98 offen offset:2048  lds
    v_mfma_f32_16x16x32_bf16 v[112:115], a[0:3], v[40:43], 0
    ds_read_b64_tr_b16 v[32:33], v28 offset:16384
    v_cvt_pk_bf16_f32 v128, v128, v129
    v_mfma_f32_16x16x32_bf16 v[112:115], a[16:19], v[44:47], v[112:115]
    ds_read_b64_tr_b16 v[34:35], v28 offset:16896
    v_cvt_pk_bf16_f32 v129, v130, v131
    v_mfma_f32_16x16x32_bf16 v[116:119], a[4:7], v[40:43], 0
    ds_read_b64_tr_b16 v[36:37], v28 offset:20480
    v_cvt_pk_bf16_f32 v130, v132, v133
    v_mfma_f32_16x16x32_bf16 v[116:119], a[20:23], v[44:47], v[116:119]
    ds_read_b64_tr_b16 v[38:39], v28 offset:20992
    v_cvt_pk_bf16_f32 v131, v134, v135
    v_mfma_f32_16x16x32_bf16 v[120:123], a[8:11], v[40:43], 0
    buffer_load_dwordx4 v27, s[20:23], s98 offen offset:3072  lds
    v_mfma_f32_16x16x32_bf16 v[120:123], a[24:27], v[44:47], v[120:123]
    s_add_u32 m0, s63, 131072
    s_xor_b32 s98, s0, 0
    ds_read_b128 v[80:83], v18 offset:256
    v_mfma_f32_16x16x32_bf16 v[124:127], a[12:15], v[40:43], 0
    buffer_store_dwordx4 v[64:67], v19, s[8:11], s71 offen offset:0 sc0 sc1
    v_mfma_f32_16x16x32_bf16 v[124:127], a[28:31], v[44:47], v[124:127]
    s_xor_b32 s79, s65, 0
    ds_read_b128 v[84:87], v18 offset:272
    v_mfma_f32_16x16x32_bf16 v[96:99], a[32:35], v[48:51], v[96:99]
    s_waitcnt lgkmcnt(10)
    ds_read_b64_tr_b16 v[40:41], v29 offset:16384
    v_mfma_f32_16x16x32_bf16 v[96:99], a[48:51], v[52:55], v[96:99]
    ds_read_b64_tr_b16 v[42:43], v29 offset:16896
    v_mfma_f32_16x16x32_bf16 v[100:103], a[36:39], v[48:51], v[100:103]
    ds_read_b64_tr_b16 v[44:45], v29 offset:20480
    v_mfma_f32_16x16x32_bf16 v[100:103], a[52:55], v[52:55], v[100:103]
    ds_read_b64_tr_b16 v[46:47], v29 offset:20992
    v_mfma_f32_16x16x32_bf16 v[104:107], a[40:43], v[48:51], v[104:107]
    buffer_load_dwordx4 v20, s[24:27], s98 offen offset:0  lds
    v_mfma_f32_16x16x32_bf16 v[104:107], a[56:59], v[52:55], v[104:107]
    s_lshr_b32 s100, s2, 3
    s_mul_i32 s66, s4, 28
    ds_read_b128 v[88:91], v18 offset:768
    v_mfma_f32_16x16x32_bf16 v[108:111], a[44:47], v[48:51], v[108:111]
    s_waitcnt lgkmcnt(13)
    s_add_u32 s66, s66, s100
    s_cmp_lt_u32 s100, 28
    s_cselect_b32 s66, s66, 255
    ds_read_b128 v[92:95], v18 offset:784
    v_mfma_f32_16x16x32_bf16 v[108:111], a[60:63], v[52:55], v[108:111]
    buffer_store_dwordx4 v[128:131], v1, s[8:11], s79 offen offset:0 sc0 sc1
    v_mfma_f32_16x16x32_bf16 v[112:115], a[32:35], v[56:59], v[112:115]
    s_waitcnt lgkmcnt(12)
    s_lshl_b32 s67, s4, 3
    s_add_u32 s67, s67, s100
    ds_read_b64_tr_b16 v[48:49], v28 offset:24576
    v_mfma_f32_16x16x32_bf16 v[112:115], a[48:51], v[60:63], v[112:115]
    s_sub_u32 s67, s67, 24
    ds_read_b64_tr_b16 v[50:51], v28 offset:25088
    v_cvt_pk_bf16_f32 v136, v136, v137
    v_mfma_f32_16x16x32_bf16 v[116:119], a[36:39], v[56:59], v[116:119]
    s_cmp_ge_u32 s100, 24
    s_cselect_b32 s67, s67, 255
    ds_read_b64_tr_b16 v[52:53], v28 offset:28672
    v_cvt_pk_bf16_f32 v137, v138, v139
    v_mfma_f32_16x16x32_bf16 v[116:119], a[52:55], v[60:63], v[116:119]
    ds_read_b64_tr_b16 v[54:55], v28 offset:29184
    v_cvt_pk_bf16_f32 v138, v140, v141
    v_mfma_f32_16x16x32_bf16 v[120:123], a[40:43], v[56:59], v[120:123]
    buffer_load_dwordx4 v21, s[24:27], s98 offen offset:1024  lds
    v_mfma_f32_16x16x32_bf16 v[120:123], a[56:59], v[60:63], v[120:123]
    s_waitcnt lgkmcnt(5)
    v_fma_f32 v72, v72, v88, v80
    v_fma_f32 v73, v73, v89, v81
    v_mfma_f32_16x16x32_bf16 v[124:127], a[44:47], v[56:59], v[124:127]
    v_fma_f32 v74, v74, v90, v82
    v_fma_f32 v75, v75, v91, v83
    v_mfma_f32_16x16x32_bf16 v[124:127], a[60:63], v[60:63], v[124:127]
    v_cvt_pk_bf16_f32 v139, v142, v143
    v_mfma_f32_16x16x32_bf16 v[96:99], a[64:67], v[32:35], v[96:99]
    s_xor_b32 s79, s65, 0
    ds_read_b64_tr_b16 v[56:57], v29 offset:24576
    s_waitcnt lgkmcnt(5)
    v_fma_f32 v76, v76, v92, v84
    v_mfma_f32_16x16x32_bf16 v[96:99], a[80:83], v[36:39], v[96:99]
    ds_read_b64_tr_b16 v[58:59], v29 offset:25088
    v_fma_f32 v77, v77, v93, v85
    v_mfma_f32_16x16x32_bf16 v[100:103], a[68:71], v[32:35], v[100:103]
    ds_read_b64_tr_b16 v[60:61], v29 offset:28672
    v_fma_f32 v78, v78, v94, v86
    v_mfma_f32_16x16x32_bf16 v[100:103], a[84:87], v[36:39], v[100:103]
    ds_read_b64_tr_b16 v[62:63], v29 offset:29184
    v_fma_f32 v79, v79, v95, v87
    v_mfma_f32_16x16x32_bf16 v[104:107], a[72:75], v[32:35], v[104:107]
    buffer_load_dwordx4 v22, s[24:27], s98 offen offset:2048  lds
    v_mfma_f32_16x16x32_bf16 v[104:107], a[88:91], v[36:39], v[104:107]
    v_cvt_pk_bf16_f32 v72, v72, v73
    v_cvt_pk_bf16_f32 v73, v74, v75
    v_mfma_f32_16x16x32_bf16 v[108:111], a[76:79], v[32:35], v[108:111]
    v_cvt_pk_bf16_f32 v74, v76, v77
    v_cvt_pk_bf16_f32 v75, v78, v79
    v_mfma_f32_16x16x32_bf16 v[108:111], a[92:95], v[36:39], v[108:111]
    buffer_store_dwordx4 v[72:75], v19, s[8:11], s71 offen offset:2048 sc0 sc1
    v_mfma_f32_16x16x32_bf16 v[112:115], a[64:67], v[40:43], v[112:115]
    ds_read_b64_tr_b16 v[32:33], v30 offset:0
    v_mfma_f32_16x16x32_bf16 v[112:115], a[80:83], v[44:47], v[112:115]
    ds_read_b64_tr_b16 v[34:35], v30 offset:512
    v_mfma_f32_16x16x32_bf16 v[116:119], a[68:71], v[40:43], v[116:119]
    ds_read_b64_tr_b16 v[36:37], v30 offset:4096
    v_mfma_f32_16x16x32_bf16 v[116:119], a[84:87], v[44:47], v[116:119]
    ds_read_b64_tr_b16 v[38:39], v30 offset:4608
    v_mfma_f32_16x16x32_bf16 v[120:123], a[72:75], v[40:43], v[120:123]
    buffer_load_dwordx4 v23, s[24:27], s98 offen offset:3072  lds
    v_mfma_f32_16x16x32_bf16 v[120:123], a[88:91], v[44:47], v[120:123]
    s_add_u32 m0, s63, 98304
    s_xor_b32 s98, s0, 524288
    v_mfma_f32_16x16x32_bf16 v[124:127], a[76:79], v[40:43], v[124:127]
    buffer_store_dwordx4 v[136:139], v1, s[8:11], s79 offen offset:1024 sc0 sc1
    v_mfma_f32_16x16x32_bf16 v[124:127], a[92:95], v[44:47], v[124:127]
    s_waitcnt lgkmcnt(10)
    v_mfma_f32_16x16x32_bf16 v[96:99], a[96:99], v[48:51], v[96:99]
    s_waitcnt lgkmcnt(8)
    ds_read_b64_tr_b16 v[40:41], v31 offset:0
    v_cvt_pk_bf16_f32 v144, v144, v145
    v_mfma_f32_16x16x32_bf16 v[96:99], a[112:115], v[52:55], v[96:99]
    ds_read_b64_tr_b16 v[42:43], v31 offset:512
    v_cvt_pk_bf16_f32 v145, v146, v147
    v_mfma_f32_16x16x32_bf16 v[100:103], a[100:103], v[48:51], v[100:103]
    ds_read_b64_tr_b16 v[44:45], v31 offset:4096
    v_cvt_pk_bf16_f32 v146, v148, v149
    v_mfma_f32_16x16x32_bf16 v[100:103], a[116:119], v[52:55], v[100:103]
    ds_read_b64_tr_b16 v[46:47], v31 offset:4608
    v_cvt_pk_bf16_f32 v147, v150, v151
    v_mfma_f32_16x16x32_bf16 v[104:107], a[104:107], v[48:51], v[104:107]
    buffer_load_dwordx4 v20, s[24:27], s98 offen offset:0  lds
    v_mfma_f32_16x16x32_bf16 v[104:107], a[120:123], v[52:55], v[104:107]
    s_xor_b32 s79, s65, 0
    v_mfma_f32_16x16x32_bf16 v[108:111], a[108:111], v[48:51], v[108:111]
    buffer_store_dwordx4 v[144:147], v1, s[8:11], s79 offen offset:2048 sc0 sc1
    v_mfma_f32_16x16x32_bf16 v[108:111], a[124:127], v[52:55], v[108:111]
    s_waitcnt lgkmcnt(10)
    v_mfma_f32_16x16x32_bf16 v[112:115], a[96:99], v[56:59], v[112:115]
    s_waitcnt lgkmcnt(8)
    ds_read_b64_tr_b16 v[48:49], v30 offset:8192
    v_mfma_f32_16x16x32_bf16 v[112:115], a[112:115], v[60:63], v[112:115]
    ds_read_b64_tr_b16 v[50:51], v30 offset:8704
    v_mfma_f32_16x16x32_bf16 v[116:119], a[100:103], v[56:59], v[116:119]
    ds_read_b64_tr_b16 v[52:53], v30 offset:12288
    v_mfma_f32_16x16x32_bf16 v[116:119], a[116:119], v[60:63], v[116:119]
    ds_read_b64_tr_b16 v[54:55], v30 offset:12800
    v_cvt_pk_bf16_f32 v152, v152, v153
    v_mfma_f32_16x16x32_bf16 v[120:123], a[104:107], v[56:59], v[120:123]
    buffer_load_dwordx4 v21, s[24:27], s98 offen offset:1024  lds
    v_mfma_f32_16x16x32_bf16 v[120:123], a[120:123], v[60:63], v[120:123]
    v_cvt_pk_bf16_f32 v153, v154, v155
    v_cvt_pk_bf16_f32 v154, v156, v157
    v_mfma_f32_16x16x32_bf16 v[124:127], a[108:111], v[56:59], v[124:127]
    v_cvt_pk_bf16_f32 v155, v158, v159
    v_mfma_f32_16x16x32_bf16 v[124:127], a[124:127], v[60:63], v[124:127]
    s_waitcnt lgkmcnt(10)
    v_mfma_f32_16x16x32_bf16 v[64:67], a[0:3], v[32:35], 0
    s_waitcnt lgkmcnt(8)
    s_xor_b32 s79, s65, 0
    ds_read_b64_tr_b16 v[56:57], v31 offset:8192
    v_mfma_f32_16x16x32_bf16 v[64:67], a[16:19], v[36:39], v[64:67]
    ds_read_b64_tr_b16 v[58:59], v31 offset:8704
    v_mfma_f32_16x16x32_bf16 v[68:71], a[4:7], v[32:35], 0
    ds_read_b64_tr_b16 v[60:61], v31 offset:12288
    v_mfma_f32_16x16x32_bf16 v[68:71], a[20:23], v[36:39], v[68:71]
    ds_read_b64_tr_b16 v[62:63], v31 offset:12800
    v_mfma_f32_16x16x32_bf16 v[72:75], a[8:11], v[32:35], 0
    buffer_load_dwordx4 v22, s[24:27], s98 offen offset:2048  lds
    v_mfma_f32_16x16x32_bf16 v[72:75], a[24:27], v[36:39], v[72:75]
    buffer_store_dwordx4 v[152:155], v1, s[8:11], s79 offen offset:3072 sc0 sc1
    v_mfma_f32_16x16x32_bf16 v[76:79], a[12:15], v[32:35], 0
    v_mfma_f32_16x16x32_bf16 v[76:79], a[28:31], v[36:39], v[76:79]
    s_waitcnt lgkmcnt(10)
    v_mfma_f32_16x16x32_bf16 v[80:83], a[0:3], v[40:43], 0
    s_waitcnt lgkmcnt(8)
    ds_read_b64_tr_b16 v[32:33], v30 offset:16384
    v_mfma_f32_16x16x32_bf16 v[80:83], a[16:19], v[44:47], v[80:83]
    ds_read_b64_tr_b16 v[34:35], v30 offset:16896
    v_mfma_f32_16x16x32_bf16 v[84:87], a[4:7], v[40:43], 0
    ds_read_b64_tr_b16 v[36:37], v30 offset:20480
    v_mfma_f32_16x16x32_bf16 v[84:87], a[20:23], v[44:47], v[84:87]
    ds_read_b64_tr_b16 v[38:39], v30 offset:20992
    v_mfma_f32_16x16x32_bf16 v[88:91], a[8:11], v[40:43], 0
    buffer_load_dwordx4 v23, s[24:27], s98 offen offset:3072  lds
    v_mfma_f32_16x16x32_bf16 v[88:91], a[24:27], v[44:47], v[88:91]
    v_cvt_pk_bf16_f32 v160, v160, v161
    v_cvt_pk_bf16_f32 v161, v162, v163
    v_mfma_f32_16x16x32_bf16 v[92:95], a[12:15], v[40:43], 0
    v_cvt_pk_bf16_f32 v162, v164, v165
    v_cvt_pk_bf16_f32 v163, v166, v167
    v_mfma_f32_16x16x32_bf16 v[92:95], a[28:31], v[44:47], v[92:95]
    s_waitcnt lgkmcnt(10)
    v_mfma_f32_16x16x32_bf16 v[64:67], a[32:35], v[48:51], v[64:67]
    s_waitcnt lgkmcnt(8)
    s_xor_b32 s79, s65, 4096
    ds_read_b64_tr_b16 v[40:41], v31 offset:16384
    v_mfma_f32_16x16x32_bf16 v[64:67], a[48:51], v[52:55], v[64:67]
    ds_read_b64_tr_b16 v[42:43], v31 offset:16896
    v_mfma_f32_16x16x32_bf16 v[68:71], a[36:39], v[48:51], v[68:71]
    ds_read_b64_tr_b16 v[44:45], v31 offset:20480
    v_mfma_f32_16x16x32_bf16 v[68:71], a[52:55], v[52:55], v[68:71]
    ds_read_b64_tr_b16 v[46:47], v31 offset:20992
    v_mfma_f32_16x16x32_bf16 v[72:75], a[40:43], v[48:51], v[72:75]
    buffer_store_dwordx4 v[160:163], v1, s[8:11], s79 offen offset:0 sc0 sc1
    v_mfma_f32_16x16x32_bf16 v[72:75], a[56:59], v[52:55], v[72:75]
    v_mfma_f32_16x16x32_bf16 v[76:79], a[44:47], v[48:51], v[76:79]
    v_mfma_f32_16x16x32_bf16 v[76:79], a[60:63], v[52:55], v[76:79]
    s_waitcnt lgkmcnt(10)
    v_mfma_f32_16x16x32_bf16 v[80:83], a[32:35], v[56:59], v[80:83]
    s_waitcnt lgkmcnt(8)
    ds_read_b64_tr_b16 v[48:49], v30 offset:24576
    v_mfma_f32_16x16x32_bf16 v[80:83], a[48:51], v[60:63], v[80:83]
    ds_read_b64_tr_b16 v[50:51], v30 offset:25088
    v_mfma_f32_16x16x32_bf16 v[84:87], a[36:39], v[56:59], v[84:87]
    ds_read_b64_tr_b16 v[52:53], v30 offset:28672
    v_mfma_f32_16x16x32_bf16 v[84:87], a[52:55], v[60:63], v[84:87]
    ds_read_b64_tr_b16 v[54:55], v30 offset:29184
    v_mfma_f32_16x16x32_bf16 v[88:91], a[40:43], v[56:59], v[88:91]
    v_mfma_f32_16x16x32_bf16 v[88:91], a[56:59], v[60:63], v[88:91]
    v_cvt_pk_bf16_f32 v168, v168, v169
    v_cvt_pk_bf16_f32 v169, v170, v171
    v_mfma_f32_16x16x32_bf16 v[92:95], a[44:47], v[56:59], v[92:95]
    v_cvt_pk_bf16_f32 v170, v172, v173
    v_cvt_pk_bf16_f32 v171, v174, v175
    v_mfma_f32_16x16x32_bf16 v[92:95], a[60:63], v[60:63], v[92:95]
    s_waitcnt lgkmcnt(10)
    v_mfma_f32_16x16x32_bf16 v[64:67], a[64:67], v[32:35], v[64:67]
    s_waitcnt lgkmcnt(8)
    s_xor_b32 s79, s65, 4096
    ds_read_b64_tr_b16 v[56:57], v31 offset:24576
    v_mfma_f32_16x16x32_bf16 v[64:67], a[80:83], v[36:39], v[64:67]
    ds_read_b64_tr_b16 v[58:59], v31 offset:25088
    v_mfma_f32_16x16x32_bf16 v[68:71], a[68:71], v[32:35], v[68:71]
    ds_read_b64_tr_b16 v[60:61], v31 offset:28672
    v_mfma_f32_16x16x32_bf16 v[68:71], a[84:87], v[36:39], v[68:71]
    ds_read_b64_tr_b16 v[62:63], v31 offset:29184
    v_mfma_f32_16x16x32_bf16 v[72:75], a[72:75], v[32:35], v[72:75]
    buffer_store_dwordx4 v[168:171], v1, s[8:11], s79 offen offset:1024 sc0 sc1
    v_mfma_f32_16x16x32_bf16 v[72:75], a[88:91], v[36:39], v[72:75]
    v_mfma_f32_16x16x32_bf16 v[76:79], a[76:79], v[32:35], v[76:79]
    v_mfma_f32_16x16x32_bf16 v[76:79], a[92:95], v[36:39], v[76:79]
    s_waitcnt lgkmcnt(10)
    v_mfma_f32_16x16x32_bf16 v[80:83], a[64:67], v[40:43], v[80:83]
    s_waitcnt lgkmcnt(8)
    v_mfma_f32_16x16x32_bf16 v[80:83], a[80:83], v[44:47], v[80:83]
    v_mfma_f32_16x16x32_bf16 v[84:87], a[68:71], v[40:43], v[84:87]
    v_mfma_f32_16x16x32_bf16 v[84:87], a[84:87], v[44:47], v[84:87]
    v_mfma_f32_16x16x32_bf16 v[88:91], a[72:75], v[40:43], v[88:91]
    v_mfma_f32_16x16x32_bf16 v[88:91], a[88:91], v[44:47], v[88:91]
    s_waitcnt vmcnt(10)
    v_mfma_f32_16x16x32_bf16 v[92:95], a[76:79], v[40:43], v[92:95]
    v_xor_b32 v28, 65536, v28
    v_cvt_pk_bf16_f32 v176, v176, v177
    s_waitcnt lgkmcnt(0)
    s_barrier
    v_mfma_f32_16x16x32_bf16 v[92:95], a[92:95], v[44:47], v[92:95]
    s_add_u32 m0, s62, 65536
    ds_read_b64_tr_b16 v[32:33], v28 offset:0
    v_xor_b32 v29, 65536, v29
    v_mfma_f32_16x16x32_bf16 v[64:67], a[96:99], v[48:51], v[64:67]
    s_xor_b32 s98, s64, 2097280
    ds_read_b64_tr_b16 v[34:35], v28 offset:512
    v_cvt_pk_bf16_f32 v177, v178, v179
    v_mfma_f32_16x16x32_bf16 v[64:67], a[112:115], v[52:55], v[64:67]
    ds_read_b64_tr_b16 v[36:37], v28 offset:4096
    v_cvt_pk_bf16_f32 v178, v180, v181
    v_mfma_f32_16x16x32_bf16 v[68:71], a[100:103], v[48:51], v[68:71]
    ds_read_b64_tr_b16 v[38:39], v28 offset:4608
    v_cvt_pk_bf16_f32 v179, v182, v183
    v_mfma_f32_16x16x32_bf16 v[68:71], a[116:119], v[52:55], v[68:71]
    s_xor_b32 s79, s65, 4096
    ds_read_b64_tr_b16 v[40:41], v29 offset:0
    v_mfma_f32_16x16x32_bf16 v[72:75], a[104:107], v[48:51], v[72:75]
    ds_read_b64_tr_b16 v[42:43], v29 offset:512
    v_mfma_f32_16x16x32_bf16 v[72:75], a[120:123], v[52:55], v[72:75]
    ds_read_b64_tr_b16 v[44:45], v29 offset:4096
    v_mfma_f32_16x16x32_bf16 v[76:79], a[108:111], v[48:51], v[76:79]
    ds_read_b64_tr_b16 v[46:47], v29 offset:4608
    v_mfma_f32_16x16x32_bf16 v[76:79], a[124:127], v[52:55], v[76:79]
    buffer_load_dwordx4 v24, s[20:23], s98 offen offset:0  lds
    v_mfma_f32_16x16x32_bf16 v[80:83], a[96:99], v[56:59], v[80:83]
    ds_read_b64_tr_b16 v[48:49], v28 offset:8192
    v_mfma_f32_16x16x32_bf16 v[80:83], a[112:115], v[60:63], v[80:83]
    ds_read_b64_tr_b16 v[50:51], v28 offset:8704
    v_mfma_f32_16x16x32_bf16 v[84:87], a[100:103], v[56:59], v[84:87]
    ds_read_b64_tr_b16 v[52:53], v28 offset:12288
    v_mfma_f32_16x16x32_bf16 v[84:87], a[116:119], v[60:63], v[84:87]
    ds_read_b64_tr_b16 v[54:55], v28 offset:12800
    v_mfma_f32_16x16x32_bf16 v[88:91], a[104:107], v[56:59], v[88:91]
    buffer_load_dwordx4 v25, s[20:23], s98 offen offset:1024  lds
    v_mfma_f32_16x16x32_bf16 v[88:91], a[120:123], v[60:63], v[88:91]
    buffer_store_dword v6, v5, s[8:11], s72 offen sc0 sc1
    v_mfma_f32_16x16x32_bf16 v[92:95], a[108:111], v[56:59], v[92:95]
    buffer_store_dwordx4 v[176:179], v1, s[8:11], s79 offen offset:2048 sc0 sc1
    v_mfma_f32_16x16x32_bf16 v[92:95], a[124:127], v[60:63], v[92:95]
    s_waitcnt lgkmcnt(10)
    v_mfma_f32_16x16x32_bf16 v[96:99], a[128:131], v[32:35], v[96:99]
    s_waitcnt lgkmcnt(8)
    ds_read_b64_tr_b16 v[56:57], v29 offset:8192
    v_cvt_pk_bf16_f32 v184, v184, v185
    v_mfma_f32_16x16x32_bf16 v[96:99], a[144:147], v[36:39], v[96:99]
    ds_read_b64_tr_b16 v[58:59], v29 offset:8704
    v_cvt_pk_bf16_f32 v185, v186, v187
    v_mfma_f32_16x16x32_bf16 v[100:103], a[132:135], v[32:35], v[100:103]
    ds_read_b64_tr_b16 v[60:61], v29 offset:12288
    v_cvt_pk_bf16_f32 v186, v188, v189
    v_mfma_f32_16x16x32_bf16 v[100:103], a[148:151], v[36:39], v[100:103]
    ds_read_b64_tr_b16 v[62:63], v29 offset:12800
    v_cvt_pk_bf16_f32 v187, v190, v191
    v_mfma_f32_16x16x32_bf16 v[104:107], a[136:139], v[32:35], v[104:107]
    buffer_load_dwordx4 v26, s[20:23], s98 offen offset:2048  lds
    v_mfma_f32_16x16x32_bf16 v[104:107], a[152:155], v[36:39], v[104:107]
    s_xor_b32 s79, s65, 4096
    v_mfma_f32_16x16x32_bf16 v[108:111], a[140:143], v[32:35], v[108:111]
    buffer_store_dwordx4 v[184:187], v1, s[8:11], s79 offen offset:3072 sc0 sc1
    v_mfma_f32_16x16x32_bf16 v[108:111], a[156:159], v[36:39], v[108:111]
    s_waitcnt lgkmcnt(10)
    v_mfma_f32_16x16x32_bf16 v[112:115], a[128:131], v[40:43], v[112:115]
    s_waitcnt lgkmcnt(8)
    ds_read_b64_tr_b16 v[32:33], v28 offset:16384
    v_mfma_f32_16x16x32_bf16 v[112:115], a[144:147], v[44:47], v[112:115]
    ds_read_b64_tr_b16 v[34:35], v28 offset:16896
    v_mfma_f32_16x16x32_bf16 v[116:119], a[132:135], v[40:43], v[116:119]
    ds_read_b64_tr_b16 v[36:37], v28 offset:20480
    v_mfma_f32_16x16x32_bf16 v[116:119], a[148:151], v[44:47], v[116:119]
    ds_read_b64_tr_b16 v[38:39], v28 offset:20992
    v_mfma_f32_16x16x32_bf16 v[120:123], a[136:139], v[40:43], v[120:123]
    buffer_load_dwordx4 v27, s[20:23], s98 offen offset:3072  lds
    v_mfma_f32_16x16x32_bf16 v[120:123], a[152:155], v[44:47], v[120:123]
    s_add_u32 m0, s62, 69632
    s_xor_b32 s98, s64, 2359424
    v_mfma_f32_16x16x32_bf16 v[124:127], a[140:143], v[40:43], v[124:127]
    v_mfma_f32_16x16x32_bf16 v[124:127], a[156:159], v[44:47], v[124:127]
    s_waitcnt lgkmcnt(10)
    v_mfma_f32_16x16x32_bf16 v[96:99], a[160:163], v[48:51], v[96:99]
    s_waitcnt lgkmcnt(8)
    ds_read_b64_tr_b16 v[40:41], v29 offset:16384
    v_cvt_pk_bf16_f32 v192, v192, v193
    v_mfma_f32_16x16x32_bf16 v[96:99], a[176:179], v[52:55], v[96:99]
    ds_read_b64_tr_b16 v[42:43], v29 offset:16896
    v_cvt_pk_bf16_f32 v193, v194, v195
    v_mfma_f32_16x16x32_bf16 v[100:103], a[164:167], v[48:51], v[100:103]
    ds_read_b64_tr_b16 v[44:45], v29 offset:20480
    v_cvt_pk_bf16_f32 v194, v196, v197
    v_mfma_f32_16x16x32_bf16 v[100:103], a[180:183], v[52:55], v[100:103]
    ds_read_b64_tr_b16 v[46:47], v29 offset:20992
    v_cvt_pk_bf16_f32 v195, v198, v199
    v_mfma_f32_16x16x32_bf16 v[104:107], a[168:171], v[48:51], v[104:107]
    buffer_load_dwordx4 v24, s[20:23], s98 offen offset:0  lds
    v_mfma_f32_16x16x32_bf16 v[104:107], a[184:187], v[52:55], v[104:107]
    s_xor_b32 s79, s65, 8192
    v_mfma_f32_16x16x32_bf16 v[108:111], a[172:175], v[48:51], v[108:111]
    buffer_store_dwordx4 v[192:195], v1, s[8:11], s79 offen offset:0 sc0 sc1
    v_mfma_f32_16x16x32_bf16 v[108:111], a[188:191], v[52:55], v[108:111]
    s_waitcnt lgkmcnt(10)
    v_mfma_f32_16x16x32_bf16 v[112:115], a[160:163], v[56:59], v[112:115]
    s_waitcnt lgkmcnt(8)
    ds_read_b64_tr_b16 v[48:49], v28 offset:24576
    v_mfma_f32_16x16x32_bf16 v[112:115], a[176:179], v[60:63], v[112:115]
    ds_read_b64_tr_b16 v[50:51], v28 offset:25088
    v_mfma_f32_16x16x32_bf16 v[116:119], a[164:167], v[56:59], v[116:119]
    ds_read_b64_tr_b16 v[52:53], v28 offset:28672
    v_mfma_f32_16x16x32_bf16 v[116:119], a[180:183], v[60:63], v[116:119]
    ds_read_b64_tr_b16 v[54:55], v28 offset:29184
    v_mfma_f32_16x16x32_bf16 v[120:123], a[168:171], v[56:59], v[120:123]
    buffer_load_dwordx4 v25, s[20:23], s98 offen offset:1024  lds
    v_mfma_f32_16x16x32_bf16 v[120:123], a[184:187], v[60:63], v[120:123]
    v_mfma_f32_16x16x32_bf16 v[124:127], a[172:175], v[56:59], v[124:127]
    v_mfma_f32_16x16x32_bf16 v[124:127], a[188:191], v[60:63], v[124:127]
    s_waitcnt lgkmcnt(10)
    v_mfma_f32_16x16x32_bf16 v[96:99], a[192:195], v[32:35], v[96:99]
    s_waitcnt lgkmcnt(8)
    ds_read_b64_tr_b16 v[56:57], v29 offset:24576
    v_mfma_f32_16x16x32_bf16 v[96:99], a[208:211], v[36:39], v[96:99]
    ds_read_b64_tr_b16 v[58:59], v29 offset:25088
    v_cvt_pk_bf16_f32 v200, v200, v201
    v_mfma_f32_16x16x32_bf16 v[100:103], a[196:199], v[32:35], v[100:103]
    ds_read_b64_tr_b16 v[60:61], v29 offset:28672
    v_cvt_pk_bf16_f32 v201, v202, v203
    v_mfma_f32_16x16x32_bf16 v[100:103], a[212:215], v[36:39], v[100:103]
    ds_read_b64_tr_b16 v[62:63], v29 offset:29184
    v_cvt_pk_bf16_f32 v202, v204, v205
    v_mfma_f32_16x16x32_bf16 v[104:107], a[200:203], v[32:35], v[104:107]
    buffer_load_dwordx4 v26, s[20:23], s98 offen offset:2048  lds
    v_mfma_f32_16x16x32_bf16 v[104:107], a[216:219], v[36:39], v[104:107]
    v_cvt_pk_bf16_f32 v203, v206, v207
    v_mfma_f32_16x16x32_bf16 v[108:111], a[204:207], v[32:35], v[108:111]
    v_mfma_f32_16x16x32_bf16 v[108:111], a[220:223], v[36:39], v[108:111]
    s_waitcnt lgkmcnt(10)
    s_xor_b32 s79, s65, 8192
    v_xor_b32 v30, 65536, v30
    v_mfma_f32_16x16x32_bf16 v[112:115], a[192:195], v[40:43], v[112:115]
    s_waitcnt lgkmcnt(8)
    ds_read_b64_tr_b16 v[32:33], v30 offset:0
    v_mfma_f32_16x16x32_bf16 v[112:115], a[208:211], v[44:47], v[112:115]
    ds_read_b64_tr_b16 v[34:35], v30 offset:512
    v_mfma_f32_16x16x32_bf16 v[116:119], a[196:199], v[40:43], v[116:119]
    ds_read_b64_tr_b16 v[36:37], v30 offset:4096
    v_mfma_f32_16x16x32_bf16 v[116:119], a[212:215], v[44:47], v[116:119]
    ds_read_b64_tr_b16 v[38:39], v30 offset:4608
    v_mfma_f32_16x16x32_bf16 v[120:123], a[200:203], v[40:43], v[120:123]
    buffer_load_dwordx4 v27, s[20:23], s98 offen offset:3072  lds
    v_mfma_f32_16x16x32_bf16 v[120:123], a[216:219], v[44:47], v[120:123]
    buffer_store_dwordx4 v[200:203], v1, s[8:11], s79 offen offset:1024 sc0 sc1
    v_mfma_f32_16x16x32_bf16 v[124:127], a[204:207], v[40:43], v[124:127]
    v_mfma_f32_16x16x32_bf16 v[124:127], a[220:223], v[44:47], v[124:127]
    s_waitcnt lgkmcnt(10)
    s_add_u32 m0, s63, 114688
    s_xor_b32 s98, s0, 1048576
    v_xor_b32 v31, 65536, v31
    v_mfma_f32_16x16x32_bf16 v[96:99], a[224:227], v[48:51], v[96:99]
    s_waitcnt lgkmcnt(8)
    ds_read_b64_tr_b16 v[40:41], v31 offset:0
    v_mfma_f32_16x16x32_bf16 v[96:99], a[240:243], v[52:55], v[96:99]
    ds_read_b64_tr_b16 v[42:43], v31 offset:512
    v_mfma_f32_16x16x32_bf16 v[100:103], a[228:231], v[48:51], v[100:103]
    ds_read_b64_tr_b16 v[44:45], v31 offset:4096
    v_cvt_pk_bf16_f32 v208, v208, v209
    v_mfma_f32_16x16x32_bf16 v[100:103], a[244:247], v[52:55], v[100:103]
    ds_read_b64_tr_b16 v[46:47], v31 offset:4608
    v_cvt_pk_bf16_f32 v209, v210, v211
    v_mfma_f32_16x16x32_bf16 v[104:107], a[232:235], v[48:51], v[104:107]
    buffer_load_dwordx4 v20, s[24:27], s98 offen offset:0  lds
    v_mfma_f32_16x16x32_bf16 v[104:107], a[248:251], v[52:55], v[104:107]
    v_cvt_pk_bf16_f32 v210, v212, v213
    v_cvt_pk_bf16_f32 v211, v214, v215
    v_mfma_f32_16x16x32_bf16 v[108:111], a[236:239], v[48:51], v[108:111]
    v_mfma_f32_16x16x32_bf16 v[108:111], a[252:255], v[52:55], v[108:111]
    s_waitcnt lgkmcnt(10)
    v_mfma_f32_16x16x32_bf16 v[112:115], a[224:227], v[56:59], v[112:115]
    s_waitcnt lgkmcnt(8)
    s_xor_b32 s79, s65, 8192
    ds_read_b64_tr_b16 v[48:49], v30 offset:8192
    v_mfma_f32_16x16x32_bf16 v[112:115], a[240:243], v[60:63], v[112:115]
    ds_read_b64_tr_b16 v[50:51], v30 offset:8704
    v_mfma_f32_16x16x32_bf16 v[116:119], a[228:231], v[56:59], v[116:119]
    ds_read_b64_tr_b16 v[52:53], v30 offset:12288
    v_mfma_f32_16x16x32_bf16 v[116:119], a[244:247], v[60:63], v[116:119]
    ds_read_b64_tr_b16 v[54:55], v30 offset:12800
    v_mfma_f32_16x16x32_bf16 v[120:123], a[232:235], v[56:59], v[120:123]
    buffer_load_dwordx4 v21, s[24:27], s98 offen offset:1024  lds
    v_mfma_f32_16x16x32_bf16 v[120:123], a[248:251], v[60:63], v[120:123]
    buffer_store_dwordx4 v[208:211], v1, s[8:11], s79 offen offset:2048 sc0 sc1
    v_mfma_f32_16x16x32_bf16 v[124:127], a[236:239], v[56:59], v[124:127]
    v_mfma_f32_16x16x32_bf16 v[124:127], a[252:255], v[60:63], v[124:127]
    s_waitcnt lgkmcnt(10)
    v_mfma_f32_16x16x32_bf16 v[64:67], a[128:131], v[32:35], v[64:67]
    s_waitcnt lgkmcnt(8)
    ds_read_b64_tr_b16 v[56:57], v31 offset:8192
    v_mfma_f32_16x16x32_bf16 v[64:67], a[144:147], v[36:39], v[64:67]
    ds_read_b64_tr_b16 v[58:59], v31 offset:8704
    v_mfma_f32_16x16x32_bf16 v[68:71], a[132:135], v[32:35], v[68:71]
    ds_read_b64_tr_b16 v[60:61], v31 offset:12288
    v_mfma_f32_16x16x32_bf16 v[68:71], a[148:151], v[36:39], v[68:71]
    ds_read_b64_tr_b16 v[62:63], v31 offset:12800
    v_mfma_f32_16x16x32_bf16 v[72:75], a[136:139], v[32:35], v[72:75]
    buffer_load_dwordx4 v22, s[24:27], s98 offen offset:2048  lds
    v_mfma_f32_16x16x32_bf16 v[72:75], a[152:155], v[36:39], v[72:75]
    v_mfma_f32_16x16x32_bf16 v[76:79], a[140:143], v[32:35], v[76:79]
    v_mfma_f32_16x16x32_bf16 v[76:79], a[156:159], v[36:39], v[76:79]
    s_waitcnt lgkmcnt(10)
    v_mfma_f32_16x16x32_bf16 v[80:83], a[128:131], v[40:43], v[80:83]
    s_waitcnt lgkmcnt(8)
    ds_read_b64_tr_b16 v[32:33], v30 offset:16384
    v_cvt_pk_bf16_f32 v96, v96, v97
    v_mfma_f32_16x16x32_bf16 v[80:83], a[144:147], v[44:47], v[80:83]
    ds_read_b64_tr_b16 v[34:35], v30 offset:16896
    v_cvt_pk_bf16_f32 v97, v98, v99
    v_mfma_f32_16x16x32_bf16 v[84:87], a[132:135], v[40:43], v[84:87]
    ds_read_b64_tr_b16 v[36:37], v30 offset:20480
    v_cvt_pk_bf16_f32 v98, v100, v101
    v_mfma_f32_16x16x32_bf16 v[84:87], a[148:151], v[44:47], v[84:87]
    ds_read_b64_tr_b16 v[38:39], v30 offset:20992
    v_cvt_pk_bf16_f32 v99, v102, v103
    v_mfma_f32_16x16x32_bf16 v[88:91], a[136:139], v[40:43], v[88:91]
    buffer_load_dwordx4 v23, s[24:27], s98 offen offset:3072  lds
    v_mfma_f32_16x16x32_bf16 v[88:91], a[152:155], v[44:47], v[88:91]
    s_add_u32 m0, s63, 147456
    s_xor_b32 s98, s0, 1572864
    s_xor_b32 s79, s1, 32768
    v_mfma_f32_16x16x32_bf16 v[92:95], a[140:143], v[40:43], v[92:95]
    buffer_store_dwordx4 v[96:99], v1, s[8:11], s79 offen offset:0 sc0 sc1
    v_mfma_f32_16x16x32_bf16 v[92:95], a[156:159], v[44:47], v[92:95]
    s_waitcnt lgkmcnt(10)
    v_mfma_f32_16x16x32_bf16 v[64:67], a[160:163], v[48:51], v[64:67]
    s_waitcnt lgkmcnt(8)
    ds_read_b64_tr_b16 v[40:41], v31 offset:16384
    v_mfma_f32_16x16x32_bf16 v[64:67], a[176:179], v[52:55], v[64:67]
    ds_read_b64_tr_b16 v[42:43], v31 offset:16896
    v_mfma_f32_16x16x32_bf16 v[68:71], a[164:167], v[48:51], v[68:71]
    ds_read_b64_tr_b16 v[44:45], v31 offset:20480
    v_mfma_f32_16x16x32_bf16 v[68:71], a[180:183], v[52:55], v[68:71]
    ds_read_b64_tr_b16 v[46:47], v31 offset:20992
    v_mfma_f32_16x16x32_bf16 v[72:75], a[168:171], v[48:51], v[72:75]
    buffer_load_dwordx4 v20, s[24:27], s98 offen offset:0  lds
    v_mfma_f32_16x16x32_bf16 v[72:75], a[184:187], v[52:55], v[72:75]
    v_cvt_pk_bf16_f32 v104, v104, v105
    v_cvt_pk_bf16_f32 v105, v106, v107
    v_mfma_f32_16x16x32_bf16 v[76:79], a[172:175], v[48:51], v[76:79]
    v_cvt_pk_bf16_f32 v106, v108, v109
    v_cvt_pk_bf16_f32 v107, v110, v111
    v_mfma_f32_16x16x32_bf16 v[76:79], a[188:191], v[52:55], v[76:79]
    s_waitcnt lgkmcnt(10)
    v_mfma_f32_16x16x32_bf16 v[80:83], a[160:163], v[56:59], v[80:83]
    s_waitcnt lgkmcnt(8)
    s_xor_b32 s79, s1, 40960
    ds_read_b64_tr_b16 v[48:49], v30 offset:24576
    v_mfma_f32_16x16x32_bf16 v[80:83], a[176:179], v[60:63], v[80:83]
    ds_read_b64_tr_b16 v[50:51], v30 offset:25088
    v_mfma_f32_16x16x32_bf16 v[84:87], a[164:167], v[56:59], v[84:87]
    ds_read_b64_tr_b16 v[52:53], v30 offset:28672
    v_mfma_f32_16x16x32_bf16 v[84:87], a[180:183], v[60:63], v[84:87]
    ds_read_b64_tr_b16 v[54:55], v30 offset:29184
    v_mfma_f32_16x16x32_bf16 v[88:91], a[168:171], v[56:59], v[88:91]
    buffer_load_dwordx4 v21, s[24:27], s98 offen offset:1024  lds
    v_mfma_f32_16x16x32_bf16 v[88:91], a[184:187], v[60:63], v[88:91]
    buffer_store_dwordx4 v[104:107], v1, s[8:11], s79 offen offset:0 sc0 sc1
    v_mfma_f32_16x16x32_bf16 v[92:95], a[172:175], v[56:59], v[92:95]
    v_mfma_f32_16x16x32_bf16 v[92:95], a[188:191], v[60:63], v[92:95]
    s_waitcnt lgkmcnt(10)
    v_mfma_f32_16x16x32_bf16 v[64:67], a[192:195], v[32:35], v[64:67]
    s_waitcnt lgkmcnt(8)
    ds_read_b64_tr_b16 v[56:57], v31 offset:24576
    v_mfma_f32_16x16x32_bf16 v[64:67], a[208:211], v[36:39], v[64:67]
    ds_read_b64_tr_b16 v[58:59], v31 offset:25088
    v_mfma_f32_16x16x32_bf16 v[68:71], a[196:199], v[32:35], v[68:71]
    ds_read_b64_tr_b16 v[60:61], v31 offset:28672
    v_cvt_pk_bf16_f32 v112, v112, v113
    v_mfma_f32_16x16x32_bf16 v[68:71], a[212:215], v[36:39], v[68:71]
    ds_read_b64_tr_b16 v[62:63], v31 offset:29184
    v_cvt_pk_bf16_f32 v113, v114, v115
    v_mfma_f32_16x16x32_bf16 v[72:75], a[200:203], v[32:35], v[72:75]
    buffer_load_dwordx4 v22, s[24:27], s98 offen offset:2048  lds
    v_mfma_f32_16x16x32_bf16 v[72:75], a[216:219], v[36:39], v[72:75]
    v_cvt_pk_bf16_f32 v114, v116, v117
    v_cvt_pk_bf16_f32 v115, v118, v119
    v_mfma_f32_16x16x32_bf16 v[76:79], a[204:207], v[32:35], v[76:79]
    s_waitcnt lgkmcnt(10)
    s_xor_b32 s79, s1, 32768
    v_mfma_f32_16x16x32_bf16 v[76:79], a[220:223], v[36:39], v[76:79]
    buffer_store_dwordx4 v[112:115], v1, s[8:11], s79 offen offset:1024 sc0 sc1
    v_mfma_f32_16x16x32_bf16 v[80:83], a[192:195], v[40:43], v[80:83]
    s_waitcnt lgkmcnt(8)
    v_mfma_f32_16x16x32_bf16 v[80:83], a[208:211], v[44:47], v[80:83]
    buffer_load_dwordx4 v23, s[24:27], s98 offen offset:3072  lds
    v_mfma_f32_16x16x32_bf16 v[84:87], a[196:199], v[40:43], v[84:87]
    v_mfma_f32_16x16x32_bf16 v[84:87], a[212:215], v[44:47], v[84:87]
    v_mfma_f32_16x16x32_bf16 v[88:91], a[200:203], v[40:43], v[88:91]
    v_mfma_f32_16x16x32_bf16 v[88:91], a[216:219], v[44:47], v[88:91]
    v_mfma_f32_16x16x32_bf16 v[92:95], a[204:207], v[40:43], v[92:95]
    s_waitcnt lgkmcnt(0)
    s_barrier
    v_mfma_f32_16x16x32_bf16 v[92:95], a[220:223], v[44:47], v[92:95]
    s_add_u32 m0, s63, 0
    s_xor_b32 s98, s0, 2097152
    ds_read_b64_tr_b16 v[32:33], v28 offset:32768
    v_mfma_f32_16x16x32_bf16 v[64:67], a[224:227], v[48:51], v[64:67]
    ds_read_b64_tr_b16 v[34:35], v28 offset:33280
    v_cvt_pk_bf16_f32 v120, v120, v121
    v_mfma_f32_16x16x32_bf16 v[64:67], a[240:243], v[52:55], v[64:67]
    ds_read_b64_tr_b16 v[36:37], v28 offset:36864
    v_cvt_pk_bf16_f32 v121, v122, v123
    v_mfma_f32_16x16x32_bf16 v[68:71], a[228:231], v[48:51], v[68:71]
    ds_read_b64_tr_b16 v[38:39], v28 offset:37376
    v_cvt_pk_bf16_f32 v122, v124, v125
    v_mfma_f32_16x16x32_bf16 v[68:71], a[244:247], v[52:55], v[68:71]
    ds_read_b64_tr_b16 v[40:41], v29 offset:32768
    v_cvt_pk_bf16_f32 v123, v126, v127
    v_mfma_f32_16x16x32_bf16 v[72:75], a[232:235], v[48:51], v[72:75]
    s_xor_b32 s79, s1, 40960
    ds_read_b64_tr_b16 v[42:43], v29 offset:33280
    v_mfma_f32_16x16x32_bf16 v[72:75], a[248:251], v[52:55], v[72:75]
    ds_read_b64_tr_b16 v[44:45], v29 offset:36864
    v_mfma_f32_16x16x32_bf16 v[76:79], a[236:239], v[48:51], v[76:79]
    ds_read_b64_tr_b16 v[46:47], v29 offset:37376
    v_mfma_f32_16x16x32_bf16 v[76:79], a[252:255], v[52:55], v[76:79]
    buffer_load_dwordx4 v20, s[24:27], s98 offen offset:0  lds
    v_mfma_f32_16x16x32_bf16 v[80:83], a[224:227], v[56:59], v[80:83]
    ds_read_b64_tr_b16 v[48:49], v28 offset:40960
    v_mfma_f32_16x16x32_bf16 v[80:83], a[240:243], v[60:63], v[80:83]
    ds_read_b64_tr_b16 v[50:51], v28 offset:41472
    v_mfma_f32_16x16x32_bf16 v[84:87], a[228:231], v[56:59], v[84:87]
    ds_read_b64_tr_b16 v[52:53], v28 offset:45056
    v_mfma_f32_16x16x32_bf16 v[84:87], a[244:247], v[60:63], v[84:87]
    ds_read_b64_tr_b16 v[54:55], v28 offset:45568
    v_mfma_f32_16x16x32_bf16 v[88:91], a[232:235], v[56:59], v[88:91]
    buffer_store_dwordx4 v[120:123], v1, s[8:11], s79 offen offset:1024 sc0 sc1
    v_mfma_f32_16x16x32_bf16 v[88:91], a[248:251], v[60:63], v[88:91]
    buffer_load_dwordx4 v21, s[24:27], s98 offen offset:1024  lds
    v_mfma_f32_16x16x32_bf16 v[92:95], a[236:239], v[56:59], v[92:95]
    v_mfma_f32_16x16x32_bf16 v[92:95], a[252:255], v[60:63], v[92:95]
    s_waitcnt lgkmcnt(10)
    v_mfma_f32_16x16x32_bf16 v[96:99], a[0:3], v[32:35], 0
    s_waitcnt lgkmcnt(8)
    ds_read_b64_tr_b16 v[56:57], v29 offset:40960
    v_mfma_f32_16x16x32_bf16 v[96:99], a[16:19], v[36:39], v[96:99]
    ds_read_b64_tr_b16 v[58:59], v29 offset:41472
    v_mfma_f32_16x16x32_bf16 v[100:103], a[4:7], v[32:35], 0
    ds_read_b64_tr_b16 v[60:61], v29 offset:45056
    v_mfma_f32_16x16x32_bf16 v[100:103], a[20:23], v[36:39], v[100:103]
    ds_read_b64_tr_b16 v[62:63], v29 offset:45568
    v_mfma_f32_16x16x32_bf16 v[104:107], a[8:11], v[32:35], 0
    buffer_load_dwordx4 v22, s[24:27], s98 offen offset:2048  lds
    v_mfma_f32_16x16x32_bf16 v[104:107], a[24:27], v[36:39], v[104:107]
    v_mfma_f32_16x16x32_bf16 v[108:111], a[12:15], v[32:35], 0
    v_mfma_f32_16x16x32_bf16 v[108:111], a[28:31], v[36:39], v[108:111]
    s_waitcnt lgkmcnt(10)
    v_mfma_f32_16x16x32_bf16 v[112:115], a[0:3], v[40:43], 0
    s_waitcnt lgkmcnt(8)
    ds_read_b64_tr_b16 v[32:33], v28 offset:49152
    v_cvt_pk_bf16_f32 v64, v64, v65
    v_mfma_f32_16x16x32_bf16 v[112:115], a[16:19], v[44:47], v[112:115]
    ds_read_b64_tr_b16 v[34:35], v28 offset:49664
    v_cvt_pk_bf16_f32 v65, v66, v67
    v_mfma_f32_16x16x32_bf16 v[116:119], a[4:7], v[40:43], 0
    ds_read_b64_tr_b16 v[36:37], v28 offset:53248
    v_cvt_pk_bf16_f32 v66, v68, v69
    v_mfma_f32_16x16x32_bf16 v[116:119], a[20:23], v[44:47], v[116:119]
    ds_read_b64_tr_b16 v[38:39], v28 offset:53760
    v_cvt_pk_bf16_f32 v67, v70, v71
    v_mfma_f32_16x16x32_bf16 v[120:123], a[8:11], v[40:43], 0
    buffer_load_dwordx4 v23, s[24:27], s98 offen offset:3072  lds
    v_mfma_f32_16x16x32_bf16 v[120:123], a[24:27], v[44:47], v[120:123]
    s_add_u32 m0, s63, 16384
    s_xor_b32 s98, s0, 2621440
    s_xor_b32 s79, s1, 32768
    v_mfma_f32_16x16x32_bf16 v[124:127], a[12:15], v[40:43], 0
    buffer_store_dwordx4 v[64:67], v1, s[8:11], s79 offen offset:2048 sc0 sc1
    v_mfma_f32_16x16x32_bf16 v[124:127], a[28:31], v[44:47], v[124:127]
    s_waitcnt lgkmcnt(10)
    v_mfma_f32_16x16x32_bf16 v[96:99], a[32:35], v[48:51], v[96:99]
    s_waitcnt lgkmcnt(8)
    ds_read_b64_tr_b16 v[40:41], v29 offset:49152
    v_mfma_f32_16x16x32_bf16 v[96:99], a[48:51], v[52:55], v[96:99]
    ds_read_b64_tr_b16 v[42:43], v29 offset:49664
    v_mfma_f32_16x16x32_bf16 v[100:103], a[36:39], v[48:51], v[100:103]
    ds_read_b64_tr_b16 v[44:45], v29 offset:53248
    v_mfma_f32_16x16x32_bf16 v[100:103], a[52:55], v[52:55], v[100:103]
    ds_read_b64_tr_b16 v[46:47], v29 offset:53760
    v_mfma_f32_16x16x32_bf16 v[104:107], a[40:43], v[48:51], v[104:107]
    buffer_load_dwordx4 v20, s[24:27], s98 offen offset:0  lds
    v_mfma_f32_16x16x32_bf16 v[104:107], a[56:59], v[52:55], v[104:107]
    v_cvt_pk_bf16_f32 v72, v72, v73
    v_cvt_pk_bf16_f32 v73, v74, v75
    v_mfma_f32_16x16x32_bf16 v[108:111], a[44:47], v[48:51], v[108:111]
    v_cvt_pk_bf16_f32 v74, v76, v77
    v_cvt_pk_bf16_f32 v75, v78, v79
    v_mfma_f32_16x16x32_bf16 v[108:111], a[60:63], v[52:55], v[108:111]
    s_waitcnt lgkmcnt(10)
    v_mfma_f32_16x16x32_bf16 v[112:115], a[32:35], v[56:59], v[112:115]
    s_waitcnt lgkmcnt(8)
    s_xor_b32 s79, s1, 40960
    ds_read_b64_tr_b16 v[48:49], v28 offset:57344
    v_mfma_f32_16x16x32_bf16 v[112:115], a[48:51], v[60:63], v[112:115]
    ds_read_b64_tr_b16 v[50:51], v28 offset:57856
    v_mfma_f32_16x16x32_bf16 v[116:119], a[36:39], v[56:59], v[116:119]
    ds_read_b64_tr_b16 v[52:53], v28 offset:61440
    v_mfma_f32_16x16x32_bf16 v[116:119], a[52:55], v[60:63], v[116:119]
    ds_read_b64_tr_b16 v[54:55], v28 offset:61952
    v_mfma_f32_16x16x32_bf16 v[120:123], a[40:43], v[56:59], v[120:123]
    buffer_load_dwordx4 v21, s[24:27], s98 offen offset:1024  lds
    v_mfma_f32_16x16x32_bf16 v[120:123], a[56:59], v[60:63], v[120:123]
    buffer_store_dwordx4 v[72:75], v1, s[8:11], s79 offen offset:2048 sc0 sc1
    v_mfma_f32_16x16x32_bf16 v[124:127], a[44:47], v[56:59], v[124:127]
    v_mfma_f32_16x16x32_bf16 v[124:127], a[60:63], v[60:63], v[124:127]
    s_waitcnt lgkmcnt(10)
    v_mfma_f32_16x16x32_bf16 v[96:99], a[64:67], v[32:35], v[96:99]
    s_waitcnt lgkmcnt(8)
    ds_read_b64_tr_b16 v[56:57], v29 offset:57344
    v_mfma_f32_16x16x32_bf16 v[96:99], a[80:83], v[36:39], v[96:99]
    ds_read_b64_tr_b16 v[58:59], v29 offset:57856
    v_mfma_f32_16x16x32_bf16 v[100:103], a[68:71], v[32:35], v[100:103]
    ds_read_b64_tr_b16 v[60:61], v29 offset:61440
    v_cvt_pk_bf16_f32 v80, v80, v81
    v_mfma_f32_16x16x32_bf16 v[100:103], a[84:87], v[36:39], v[100:103]
    ds_read_b64_tr_b16 v[62:63], v29 offset:61952
    v_cvt_pk_bf16_f32 v81, v82, v83
    v_mfma_f32_16x16x32_bf16 v[104:107], a[72:75], v[32:35], v[104:107]
    buffer_load_dwordx4 v22, s[24:27], s98 offen offset:2048  lds
    v_mfma_f32_16x16x32_bf16 v[104:107], a[88:91], v[36:39], v[104:107]
    v_cvt_pk_bf16_f32 v82, v84, v85
    v_cvt_pk_bf16_f32 v83, v86, v87
    v_mfma_f32_16x16x32_bf16 v[108:111], a[76:79], v[32:35], v[108:111]
    v_mfma_f32_16x16x32_bf16 v[108:111], a[92:95], v[36:39], v[108:111]
    s_waitcnt lgkmcnt(10)
    v_mfma_f32_16x16x32_bf16 v[112:115], a[64:67], v[40:43], v[112:115]
    s_waitcnt lgkmcnt(8)
    s_xor_b32 s79, s1, 32768
    ds_read_b64_tr_b16 v[32:33], v30 offset:32768
    v_mfma_f32_16x16x32_bf16 v[112:115], a[80:83], v[44:47], v[112:115]
    ds_read_b64_tr_b16 v[34:35], v30 offset:33280
    v_mfma_f32_16x16x32_bf16 v[116:119], a[68:71], v[40:43], v[116:119]
    ds_read_b64_tr_b16 v[36:37], v30 offset:36864
    v_mfma_f32_16x16x32_bf16 v[116:119], a[84:87], v[44:47], v[116:119]
    ds_read_b64_tr_b16 v[38:39], v30 offset:37376
    v_mfma_f32_16x16x32_bf16 v[120:123], a[72:75], v[40:43], v[120:123]
    buffer_load_dwordx4 v23, s[24:27], s98 offen offset:3072  lds
    v_mfma_f32_16x16x32_bf16 v[120:123], a[88:91], v[44:47], v[120:123]
    buffer_store_dwordx4 v[80:83], v1, s[8:11], s79 offen offset:3072 sc0 sc1
    v_mfma_f32_16x16x32_bf16 v[124:127], a[76:79], v[40:43], v[124:127]
    v_mfma_f32_16x16x32_bf16 v[124:127], a[92:95], v[44:47], v[124:127]
    s_waitcnt lgkmcnt(10)
    v_mfma_f32_16x16x32_bf16 v[96:99], a[96:99], v[48:51], v[96:99]
    s_waitcnt lgkmcnt(8)
    ds_read_b64_tr_b16 v[40:41], v31 offset:32768
    v_cvt_pk_bf16_f32 v88, v88, v89
    v_mfma_f32_16x16x32_bf16 v[96:99], a[112:115], v[52:55], v[96:99]
    ds_read_b64_tr_b16 v[42:43], v31 offset:33280
    v_cvt_pk_bf16_f32 v89, v90, v91
    v_mfma_f32_16x16x32_bf16 v[100:103], a[100:103], v[48:51], v[100:103]
    ds_read_b64_tr_b16 v[44:45], v31 offset:36864
    v_cvt_pk_bf16_f32 v90, v92, v93
    v_mfma_f32_16x16x32_bf16 v[100:103], a[116:119], v[52:55], v[100:103]
    ds_read_b64_tr_b16 v[46:47], v31 offset:37376
    v_cvt_pk_bf16_f32 v91, v94, v95
    v_mfma_f32_16x16x32_bf16 v[104:107], a[104:107], v[48:51], v[104:107]
    s_xor_b32 s79, s1, 40960
    v_mfma_f32_16x16x32_bf16 v[104:107], a[120:123], v[52:55], v[104:107]
    buffer_store_dwordx4 v[88:91], v1, s[8:11], s79 offen offset:3072 sc0 sc1
    v_mfma_f32_16x16x32_bf16 v[108:111], a[108:111], v[48:51], v[108:111]
    v_mfma_f32_16x16x32_bf16 v[108:111], a[124:127], v[52:55], v[108:111]
    s_waitcnt lgkmcnt(10)
    v_mfma_f32_16x16x32_bf16 v[112:115], a[96:99], v[56:59], v[112:115]
    s_waitcnt lgkmcnt(8)
    ds_read_b64_tr_b16 v[48:49], v30 offset:40960
    v_mfma_f32_16x16x32_bf16 v[112:115], a[112:115], v[60:63], v[112:115]
    ds_read_b64_tr_b16 v[50:51], v30 offset:41472
    v_mfma_f32_16x16x32_bf16 v[116:119], a[100:103], v[56:59], v[116:119]
    ds_read_b64_tr_b16 v[52:53], v30 offset:45056
    v_mfma_f32_16x16x32_bf16 v[116:119], a[116:119], v[60:63], v[116:119]
    ds_read_b64_tr_b16 v[54:55], v30 offset:45568
    v_mfma_f32_16x16x32_bf16 v[120:123], a[104:107], v[56:59], v[120:123]
    v_mfma_f32_16x16x32_bf16 v[120:123], a[120:123], v[60:63], v[120:123]
    v_mfma_f32_16x16x32_bf16 v[124:127], a[108:111], v[56:59], v[124:127]
    v_mfma_f32_16x16x32_bf16 v[124:127], a[124:127], v[60:63], v[124:127]
    s_waitcnt lgkmcnt(10)
    v_mfma_f32_16x16x32_bf16 v[64:67], a[0:3], v[32:35], 0
    s_waitcnt lgkmcnt(8)
    ds_read_b64_tr_b16 v[56:57], v31 offset:40960
    v_mfma_f32_16x16x32_bf16 v[64:67], a[16:19], v[36:39], v[64:67]
    ds_read_b64_tr_b16 v[58:59], v31 offset:41472
    v_mfma_f32_16x16x32_bf16 v[68:71], a[4:7], v[32:35], 0
    ds_read_b64_tr_b16 v[60:61], v31 offset:45056
    v_cvt_pk_bf16_f32 v216, v216, v217
    v_mfma_f32_16x16x32_bf16 v[68:71], a[20:23], v[36:39], v[68:71]
    ds_read_b64_tr_b16 v[62:63], v31 offset:45568
    v_cvt_pk_bf16_f32 v217, v218, v219
    v_mfma_f32_16x16x32_bf16 v[72:75], a[8:11], v[32:35], 0
    v_cvt_pk_bf16_f32 v218, v220, v221
    v_cvt_pk_bf16_f32 v219, v222, v223
    v_mfma_f32_16x16x32_bf16 v[72:75], a[24:27], v[36:39], v[72:75]
    s_xor_b32 s79, s65, 8192
    v_mfma_f32_16x16x32_bf16 v[76:79], a[12:15], v[32:35], 0
    buffer_store_dwordx4 v[216:219], v1, s[8:11], s79 offen offset:3072 sc0 sc1
    v_mfma_f32_16x16x32_bf16 v[76:79], a[28:31], v[36:39], v[76:79]
    s_waitcnt lgkmcnt(10)
    v_mfma_f32_16x16x32_bf16 v[80:83], a[0:3], v[40:43], 0
    s_waitcnt lgkmcnt(8)
    ds_read_b64_tr_b16 v[32:33], v30 offset:49152
    v_mfma_f32_16x16x32_bf16 v[80:83], a[16:19], v[44:47], v[80:83]
    ds_read_b64_tr_b16 v[34:35], v30 offset:49664
    v_mfma_f32_16x16x32_bf16 v[84:87], a[4:7], v[40:43], 0
    ds_read_b64_tr_b16 v[36:37], v30 offset:53248
    v_mfma_f32_16x16x32_bf16 v[84:87], a[20:23], v[44:47], v[84:87]
    ds_read_b64_tr_b16 v[38:39], v30 offset:53760
    v_mfma_f32_16x16x32_bf16 v[88:91], a[8:11], v[40:43], 0
    v_mfma_f32_16x16x32_bf16 v[88:91], a[24:27], v[44:47], v[88:91]
    v_mfma_f32_16x16x32_bf16 v[92:95], a[12:15], v[40:43], 0
    v_mfma_f32_16x16x32_bf16 v[92:95], a[28:31], v[44:47], v[92:95]
    s_waitcnt lgkmcnt(10)
    v_mfma_f32_16x16x32_bf16 v[64:67], a[32:35], v[48:51], v[64:67]
    s_waitcnt lgkmcnt(8)
    ds_read_b64_tr_b16 v[40:41], v31 offset:49152
    v_mfma_f32_16x16x32_bf16 v[64:67], a[48:51], v[52:55], v[64:67]
    ds_read_b64_tr_b16 v[42:43], v31 offset:49664
    v_mfma_f32_16x16x32_bf16 v[68:71], a[36:39], v[48:51], v[68:71]
    ds_read_b64_tr_b16 v[44:45], v31 offset:53248
    v_mfma_f32_16x16x32_bf16 v[68:71], a[52:55], v[52:55], v[68:71]
    ds_read_b64_tr_b16 v[46:47], v31 offset:53760
    v_mfma_f32_16x16x32_bf16 v[72:75], a[40:43], v[48:51], v[72:75]
    buffer_load_dword v3, v16, s[8:11], s78 offen sc0 sc1
    v_mfma_f32_16x16x32_bf16 v[72:75], a[56:59], v[52:55], v[72:75]
    v_mfma_f32_16x16x32_bf16 v[76:79], a[44:47], v[48:51], v[76:79]
    v_mfma_f32_16x16x32_bf16 v[76:79], a[60:63], v[52:55], v[76:79]
    s_waitcnt lgkmcnt(10)
    v_mfma_f32_16x16x32_bf16 v[80:83], a[32:35], v[56:59], v[80:83]
    s_waitcnt lgkmcnt(8)
    ds_read_b64_tr_b16 v[48:49], v30 offset:57344
    v_cvt_pk_bf16_f32 v224, v224, v225
    v_mfma_f32_16x16x32_bf16 v[80:83], a[48:51], v[60:63], v[80:83]
    ds_read_b64_tr_b16 v[50:51], v30 offset:57856
    v_cvt_pk_bf16_f32 v225, v226, v227
    v_mfma_f32_16x16x32_bf16 v[84:87], a[36:39], v[56:59], v[84:87]
    ds_read_b64_tr_b16 v[52:53], v30 offset:61440
    v_cvt_pk_bf16_f32 v226, v228, v229
    v_mfma_f32_16x16x32_bf16 v[84:87], a[52:55], v[60:63], v[84:87]
    ds_read_b64_tr_b16 v[54:55], v30 offset:61952
    v_cvt_pk_bf16_f32 v227, v230, v231
    v_mfma_f32_16x16x32_bf16 v[88:91], a[40:43], v[56:59], v[88:91]
    s_xor_b32 s79, s65, 12288
    v_mfma_f32_16x16x32_bf16 v[88:91], a[56:59], v[60:63], v[88:91]
    buffer_store_dwordx4 v[224:227], v1, s[8:11], s79 offen offset:0 sc0 sc1
    v_mfma_f32_16x16x32_bf16 v[92:95], a[44:47], v[56:59], v[92:95]
    v_mfma_f32_16x16x32_bf16 v[92:95], a[60:63], v[60:63], v[92:95]
    s_waitcnt lgkmcnt(10)
    v_mfma_f32_16x16x32_bf16 v[64:67], a[64:67], v[32:35], v[64:67]
    s_waitcnt lgkmcnt(8)
    ds_read_b64_tr_b16 v[56:57], v31 offset:57344
    v_mfma_f32_16x16x32_bf16 v[64:67], a[80:83], v[36:39], v[64:67]
    ds_read_b64_tr_b16 v[58:59], v31 offset:57856
    v_mfma_f32_16x16x32_bf16 v[68:71], a[68:71], v[32:35], v[68:71]
    ds_read_b64_tr_b16 v[60:61], v31 offset:61440
    v_mfma_f32_16x16x32_bf16 v[68:71], a[84:87], v[36:39], v[68:71]
    ds_read_b64_tr_b16 v[62:63], v31 offset:61952
    v_mfma_f32_16x16x32_bf16 v[72:75], a[72:75], v[32:35], v[72:75]
    v_mfma_f32_16x16x32_bf16 v[72:75], a[88:91], v[36:39], v[72:75]
    v_mfma_f32_16x16x32_bf16 v[76:79], a[76:79], v[32:35], v[76:79]
    v_mfma_f32_16x16x32_bf16 v[76:79], a[92:95], v[36:39], v[76:79]
    s_waitcnt lgkmcnt(10)
    v_mfma_f32_16x16x32_bf16 v[80:83], a[64:67], v[40:43], v[80:83]
    s_waitcnt lgkmcnt(8)
    v_mfma_f32_16x16x32_bf16 v[80:83], a[80:83], v[44:47], v[80:83]
    v_mfma_f32_16x16x32_bf16 v[84:87], a[68:71], v[40:43], v[84:87]
    v_mfma_f32_16x16x32_bf16 v[84:87], a[84:87], v[44:47], v[84:87]
    v_mfma_f32_16x16x32_bf16 v[88:91], a[72:75], v[40:43], v[88:91]
    v_mfma_f32_16x16x32_bf16 v[88:91], a[88:91], v[44:47], v[88:91]
    v_mfma_f32_16x16x32_bf16 v[92:95], a[76:79], v[40:43], v[92:95]
    v_xor_b32 v28, 65536, v28
    v_cvt_pk_bf16_f32 v232, v232, v233
    s_waitcnt vmcnt(29) lgkmcnt(0)
    s_barrier
    v_mfma_f32_16x16x32_bf16 v[92:95], a[92:95], v[44:47], v[92:95]
    s_add_u32 m0, s63, 32768
    ds_read_b64_tr_b16 v[32:33], v28 offset:0
    v_xor_b32 v29, 65536, v29
    v_mfma_f32_16x16x32_bf16 v[64:67], a[96:99], v[48:51], v[64:67]
    s_xor_b32 s98, s0, 3145728
    ds_read_b64_tr_b16 v[34:35], v28 offset:512
    v_cvt_pk_bf16_f32 v233, v234, v235
    v_mfma_f32_16x16x32_bf16 v[64:67], a[112:115], v[52:55], v[64:67]
    ds_read_b64_tr_b16 v[36:37], v28 offset:4096
    v_cvt_pk_bf16_f32 v234, v236, v237
    v_mfma_f32_16x16x32_bf16 v[68:71], a[100:103], v[48:51], v[68:71]
    ds_read_b64_tr_b16 v[38:39], v28 offset:4608
    v_cvt_pk_bf16_f32 v235, v238, v239
    v_mfma_f32_16x16x32_bf16 v[68:71], a[116:119], v[52:55], v[68:71]
    s_xor_b32 s79, s65, 12288
    ds_read_b64_tr_b16 v[40:41], v29 offset:0
    v_mfma_f32_16x16x32_bf16 v[72:75], a[104:107], v[48:51], v[72:75]
    ds_read_b64_tr_b16 v[42:43], v29 offset:512
    v_mfma_f32_16x16x32_bf16 v[72:75], a[120:123], v[52:55], v[72:75]
    ds_read_b64_tr_b16 v[44:45], v29 offset:4096
    v_mfma_f32_16x16x32_bf16 v[76:79], a[108:111], v[48:51], v[76:79]
    ds_read_b64_tr_b16 v[46:47], v29 offset:4608
    v_mfma_f32_16x16x32_bf16 v[76:79], a[124:127], v[52:55], v[76:79]
    buffer_load_dwordx4 v20, s[24:27], s98 offen offset:0  lds
    v_mfma_f32_16x16x32_bf16 v[80:83], a[96:99], v[56:59], v[80:83]
    ds_read_b64_tr_b16 v[48:49], v28 offset:8192
    v_mfma_f32_16x16x32_bf16 v[80:83], a[112:115], v[60:63], v[80:83]
    ds_read_b64_tr_b16 v[50:51], v28 offset:8704
    v_mfma_f32_16x16x32_bf16 v[84:87], a[100:103], v[56:59], v[84:87]
    ds_read_b64_tr_b16 v[52:53], v28 offset:12288
    v_mfma_f32_16x16x32_bf16 v[84:87], a[116:119], v[60:63], v[84:87]
    ds_read_b64_tr_b16 v[54:55], v28 offset:12800
    v_mfma_f32_16x16x32_bf16 v[88:91], a[104:107], v[56:59], v[88:91]
    buffer_store_dwordx4 v[232:235], v1, s[8:11], s79 offen offset:1024 sc0 sc1
    v_mfma_f32_16x16x32_bf16 v[88:91], a[120:123], v[60:63], v[88:91]
    buffer_load_dwordx4 v21, s[24:27], s98 offen offset:1024  lds
    v_mfma_f32_16x16x32_bf16 v[92:95], a[108:111], v[56:59], v[92:95]
    v_mfma_f32_16x16x32_bf16 v[92:95], a[124:127], v[60:63], v[92:95]
    s_waitcnt lgkmcnt(10)
    v_mfma_f32_16x16x32_bf16 v[96:99], a[128:131], v[32:35], v[96:99]
    s_waitcnt lgkmcnt(8)
    ds_read_b64_tr_b16 v[56:57], v29 offset:8192
    s_waitcnt vmcnt(4)
    v_cmp_ne_u32 vcc, 0, v3
    s_cmp_eq_u64 vcc, -1
    s_cbranch_scc0 L_H_slow_3
L_H_ok_4:
    v_mfma_f32_16x16x32_bf16 v[96:99], a[144:147], v[36:39], v[96:99]
    ds_read_b64_tr_b16 v[58:59], v29 offset:8704
    v_mfma_f32_16x16x32_bf16 v[100:103], a[132:135], v[32:35], v[100:103]
    s_xor_b32 s80, s75, 0
    ds_read_b64_tr_b16 v[60:61], v29 offset:12288
    v_mfma_f32_16x16x32_bf16 v[100:103], a[148:151], v[36:39], v[100:103]
    ds_read_b64_tr_b16 v[62:63], v29 offset:12800
    v_mfma_f32_16x16x32_bf16 v[104:107], a[136:139], v[32:35], v[104:107]
    buffer_load_dwordx4 v22, s[24:27], s98 offen offset:2048  lds
    v_mfma_f32_16x16x32_bf16 v[104:107], a[152:155], v[36:39], v[104:107]
    v_cvt_pk_bf16_f32 v240, v240, v241
    v_cvt_pk_bf16_f32 v241, v242, v243
    v_mfma_f32_16x16x32_bf16 v[108:111], a[140:143], v[32:35], v[108:111]
    s_waitcnt lgkmcnt(10)
    v_cvt_pk_bf16_f32 v242, v244, v245
    v_cvt_pk_bf16_f32 v243, v246, v247
    v_mfma_f32_16x16x32_bf16 v[108:111], a[156:159], v[36:39], v[108:111]
    buffer_load_dwordx4 a[0:3], v1, s[8:11], s80 offen offset:0
    v_mfma_f32_16x16x32_bf16 v[112:115], a[128:131], v[40:43], v[112:115]
    s_waitcnt lgkmcnt(8)
    s_xor_b32 s79, s65, 12288
    s_xor_b32 s80, s75, 16384
    ds_read_b64_tr_b16 v[32:33], v28 offset:16384
    v_mfma_f32_16x16x32_bf16 v[112:115], a[144:147], v[44:47], v[112:115]
    ds_read_b64_tr_b16 v[34:35], v28 offset:16896
    v_mfma_f32_16x16x32_bf16 v[116:119], a[132:135], v[40:43], v[116:119]
    ds_read_b64_tr_b16 v[36:37], v28 offset:20480
    v_mfma_f32_16x16x32_bf16 v[116:119], a[148:151], v[44:47], v[116:119]
    ds_read_b64_tr_b16 v[38:39], v28 offset:20992
    v_mfma_f32_16x16x32_bf16 v[120:123], a[136:139], v[40:43], v[120:123]
    buffer_load_dwordx4 v23, s[24:27], s98 offen offset:3072  lds
    v_mfma_f32_16x16x32_bf16 v[120:123], a[152:155], v[44:47], v[120:123]
    s_waitcnt lgkmcnt(10)
    s_add_u32 m0, s63, 49152
    s_xor_b32 s98, s0, 3670016
    v_mfma_f32_16x16x32_bf16 v[124:127], a[140:143], v[40:43], v[124:127]
    buffer_store_dwordx4 v[240:243], v1, s[8:11], s79 offen offset:2048 sc0 sc1
    v_mfma_f32_16x16x32_bf16 v[124:127], a[156:159], v[44:47], v[124:127]
    buffer_load_dwordx4 a[4:7], v1, s[8:11], s80 offen offset:0
    v_mfma_f32_16x16x32_bf16 v[96:99], a[160:163], v[48:51], v[96:99]
    s_waitcnt lgkmcnt(8)
    s_xor_b32 s80, s76, 0
    ds_read_b64_tr_b16 v[40:41], v29 offset:16384
    v_mfma_f32_16x16x32_bf16 v[96:99], a[176:179], v[52:55], v[96:99]
    ds_read_b64_tr_b16 v[42:43], v29 offset:16896
    v_mfma_f32_16x16x32_bf16 v[100:103], a[164:167], v[48:51], v[100:103]
    ds_read_b64_tr_b16 v[44:45], v29 offset:20480
    v_mfma_f32_16x16x32_bf16 v[100:103], a[180:183], v[52:55], v[100:103]
    ds_read_b64_tr_b16 v[46:47], v29 offset:20992
    v_mfma_f32_16x16x32_bf16 v[104:107], a[168:171], v[48:51], v[104:107]
    buffer_load_dwordx4 v20, s[24:27], s98 offen offset:0  lds
    v_mfma_f32_16x16x32_bf16 v[104:107], a[184:187], v[52:55], v[104:107]
    buffer_load_dwordx4 a[8:11], v1, s[8:11], s80 offen offset:0
    v_mfma_f32_16x16x32_bf16 v[108:111], a[172:175], v[48:51], v[108:111]
    v_mfma_f32_16x16x32_bf16 v[108:111], a[188:191], v[52:55], v[108:111]
    s_waitcnt lgkmcnt(10)
    v_mfma_f32_16x16x32_bf16 v[112:115], a[160:163], v[56:59], v[112:115]
    s_waitcnt lgkmcnt(8)
    s_xor_b32 s80, s76, 16384
    ds_read_b64_tr_b16 v[48:49], v28 offset:24576
    v_mfma_f32_16x16x32_bf16 v[112:115], a[176:179], v[60:63], v[112:115]
    ds_read_b64_tr_b16 v[50:51], v28 offset:25088
    v_mfma_f32_16x16x32_bf16 v[116:119], a[164:167], v[56:59], v[116:119]
    ds_read_b64_tr_b16 v[52:53], v28 offset:28672
    v_cvt_pk_bf16_f32 v248, v248, v249
    v_mfma_f32_16x16x32_bf16 v[116:119], a[180:183], v[60:63], v[116:119]
    ds_read_b64_tr_b16 v[54:55], v28 offset:29184
    v_cvt_pk_bf16_f32 v249, v250, v251
    v_mfma_f32_16x16x32_bf16 v[120:123], a[168:171], v[56:59], v[120:123]
    buffer_load_dwordx4 v21, s[24:27], s98 offen offset:1024  lds
    v_mfma_f32_16x16x32_bf16 v[120:123], a[184:187], v[60:63], v[120:123]
    v_cvt_pk_bf16_f32 v250, v252, v253
    v_cvt_pk_bf16_f32 v251, v254, v255
    v_mfma_f32_16x16x32_bf16 v[124:127], a[172:175], v[56:59], v[124:127]
    buffer_load_dwordx4 a[12:15], v1, s[8:11], s80 offen offset:0
    v_mfma_f32_16x16x32_bf16 v[124:127], a[188:191], v[60:63], v[124:127]
    s_waitcnt lgkmcnt(10)
    v_mfma_f32_16x16x32_bf16 v[96:99], a[192:195], v[32:35], v[96:99]
    s_waitcnt lgkmcnt(8)
    s_xor_b32 s79, s65, 12288
    s_xor_b32 s80, s75, 0
    ds_read_b64_tr_b16 v[56:57], v29 offset:24576
    v_mfma_f32_16x16x32_bf16 v[96:99], a[208:211], v[36:39], v[96:99]
    ds_read_b64_tr_b16 v[58:59], v29 offset:25088
    v_mfma_f32_16x16x32_bf16 v[100:103], a[196:199], v[32:35], v[100:103]
    ds_read_b64_tr_b16 v[60:61], v29 offset:28672
    v_mfma_f32_16x16x32_bf16 v[100:103], a[212:215], v[36:39], v[100:103]
    ds_read_b64_tr_b16 v[62:63], v29 offset:29184
    v_mfma_f32_16x16x32_bf16 v[104:107], a[200:203], v[32:35], v[104:107]
    buffer_load_dwordx4 v22, s[24:27], s98 offen offset:2048  lds
    v_mfma_f32_16x16x32_bf16 v[104:107], a[216:219], v[36:39], v[104:107]
    buffer_store_dwordx4 v[248:251], v1, s[8:11], s79 offen offset:3072 sc0 sc1
    v_mfma_f32_16x16x32_bf16 v[108:111], a[204:207], v[32:35], v[108:111]
    buffer_load_dwordx4 a[16:19], v1, s[8:11], s80 offen offset:1024
    v_mfma_f32_16x16x32_bf16 v[108:111], a[220:223], v[36:39], v[108:111]
    s_waitcnt lgkmcnt(10)
    s_xor_b32 s80, s75, 16384
    v_xor_b32 v30, 65536, v30
    v_mfma_f32_16x16x32_bf16 v[112:115], a[192:195], v[40:43], v[112:115]
    s_waitcnt lgkmcnt(8)
    ds_read_b64_tr_b16 v[32:33], v30 offset:0
    v_mfma_f32_16x16x32_bf16 v[112:115], a[208:211], v[44:47], v[112:115]
    ds_read_b64_tr_b16 v[34:35], v30 offset:512
    v_mfma_f32_16x16x32_bf16 v[116:119], a[196:199], v[40:43], v[116:119]
    ds_read_b64_tr_b16 v[36:37], v30 offset:4096
    v_mfma_f32_16x16x32_bf16 v[116:119], a[212:215], v[44:47], v[116:119]
    ds_read_b64_tr_b16 v[38:39], v30 offset:4608
    v_mfma_f32_16x16x32_bf16 v[120:123], a[200:203], v[40:43], v[120:123]
    buffer_load_dwordx4 v23, s[24:27], s98 offen offset:3072  lds
    v_mfma_f32_16x16x32_bf16 v[120:123], a[216:219], v[44:47], v[120:123]
    buffer_load_dwordx4 a[20:23], v1, s[8:11], s80 offen offset:1024
    v_mfma_f32_16x16x32_bf16 v[124:127], a[204:207], v[40:43], v[124:127]
    v_mfma_f32_16x16x32_bf16 v[124:127], a[220:223], v[44:47], v[124:127]
    s_waitcnt lgkmcnt(10)
    s_xor_b32 s80, s76, 0
    v_xor_b32 v31, 65536, v31
    v_mfma_f32_16x16x32_bf16 v[96:99], a[224:227], v[48:51], v[96:99]
    s_waitcnt lgkmcnt(8)
    ds_read_b64_tr_b16 v[40:41], v31 offset:0
    v_mfma_f32_16x16x32_bf16 v[96:99], a[240:243], v[52:55], v[96:99]
    ds_read_b64_tr_b16 v[42:43], v31 offset:512
    v_mfma_f32_16x16x32_bf16 v[100:103], a[228:231], v[48:51], v[100:103]
    ds_read_b64_tr_b16 v[44:45], v31 offset:4096
    v_mfma_f32_16x16x32_bf16 v[100:103], a[244:247], v[52:55], v[100:103]
    ds_read_b64_tr_b16 v[46:47], v31 offset:4608
    v_mfma_f32_16x16x32_bf16 v[104:107], a[232:235], v[48:51], v[104:107]
    buffer_load_dwordx4 a[24:27], v1, s[8:11], s80 offen offset:1024
    v_mfma_f32_16x16x32_bf16 v[104:107], a[248:251], v[52:55], v[104:107]
    s_xor_b32 s80, s76, 16384
    v_mfma_f32_16x16x32_bf16 v[108:111], a[236:239], v[48:51], v[108:111]
    buffer_load_dwordx4 a[28:31], v1, s[8:11], s80 offen offset:1024
    v_mfma_f32_16x16x32_bf16 v[108:111], a[252:255], v[52:55], v[108:111]
    s_waitcnt lgkmcnt(10)
    v_mfma_f32_16x16x32_bf16 v[112:115], a[224:227], v[56:59], v[112:115]
    s_waitcnt lgkmcnt(8)
    ds_read_b64_tr_b16 v[48:49], v30 offset:8192
    v_mfma_f32_16x16x32_bf16 v[112:115], a[240:243], v[60:63], v[112:115]
    s_xor_b32 s80, s75, 2048
    ds_read_b64_tr_b16 v[50:51], v30 offset:8704
    v_mfma_f32_16x16x32_bf16 v[116:119], a[228:231], v[56:59], v[116:119]
    ds_read_b64_tr_b16 v[52:53], v30 offset:12288
    v_mfma_f32_16x16x32_bf16 v[116:119], a[244:247], v[60:63], v[116:119]
    ds_read_b64_tr_b16 v[54:55], v30 offset:12800
    v_mfma_f32_16x16x32_bf16 v[120:123], a[232:235], v[56:59], v[120:123]
    buffer_load_dwordx4 a[32:35], v1, s[8:11], s80 offen offset:0
    v_mfma_f32_16x16x32_bf16 v[120:123], a[248:251], v[60:63], v[120:123]
    v_mfma_f32_16x16x32_bf16 v[124:127], a[236:239], v[56:59], v[124:127]
    v_mfma_f32_16x16x32_bf16 v[124:127], a[252:255], v[60:63], v[124:127]
    s_waitcnt lgkmcnt(10)
    v_mfma_f32_16x16x32_bf16 v[64:67], a[128:131], v[32:35], v[64:67]
    s_waitcnt lgkmcnt(8)
    s_xor_b32 s80, s75, 18432
    ds_read_b64_tr_b16 v[56:57], v31 offset:8192
    v_mfma_f32_16x16x32_bf16 v[64:67], a[144:147], v[36:39], v[64:67]
    ds_read_b64_tr_b16 v[58:59], v31 offset:8704
    v_mfma_f32_16x16x32_bf16 v[68:71], a[132:135], v[32:35], v[68:71]
    ds_read_b64_tr_b16 v[60:61], v31 offset:12288
    v_mfma_f32_16x16x32_bf16 v[68:71], a[148:151], v[36:39], v[68:71]
    ds_read_b64_tr_b16 v[62:63], v31 offset:12800
    v_mfma_f32_16x16x32_bf16 v[72:75], a[136:139], v[32:35], v[72:75]
    buffer_load_dwordx4 a[36:39], v1, s[8:11], s80 offen offset:0
    v_mfma_f32_16x16x32_bf16 v[72:75], a[152:155], v[36:39], v[72:75]
    v_mfma_f32_16x16x32_bf16 v[76:79], a[140:143], v[32:35], v[76:79]
    v_mfma_f32_16x16x32_bf16 v[76:79], a[156:159], v[36:39], v[76:79]
    s_waitcnt lgkmcnt(10)
    v_mfma_f32_16x16x32_bf16 v[80:83], a[128:131], v[40:43], v[80:83]
    s_waitcnt lgkmcnt(8)
    s_xor_b32 s80, s76, 2048
    ds_read_b64_tr_b16 v[32:33], v30 offset:16384
    v_cvt_pk_bf16_f32 v96, v96, v97
    v_mfma_f32_16x16x32_bf16 v[80:83], a[144:147], v[44:47], v[80:83]
    ds_read_b64_tr_b16 v[34:35], v30 offset:16896
    v_cvt_pk_bf16_f32 v97, v98, v99
    v_mfma_f32_16x16x32_bf16 v[84:87], a[132:135], v[40:43], v[84:87]
    ds_read_b64_tr_b16 v[36:37], v30 offset:20480
    v_cvt_pk_bf16_f32 v98, v100, v101
    v_mfma_f32_16x16x32_bf16 v[84:87], a[148:151], v[44:47], v[84:87]
    ds_read_b64_tr_b16 v[38:39], v30 offset:20992
    v_cvt_pk_bf16_f32 v99, v102, v103
    v_mfma_f32_16x16x32_bf16 v[88:91], a[136:139], v[40:43], v[88:91]
    s_xor_b32 s79, s1, 36864
    v_mfma_f32_16x16x32_bf16 v[88:91], a[152:155], v[44:47], v[88:91]
    buffer_store_dwordx4 v[96:99], v1, s[8:11], s79 offen offset:0 sc0 sc1
    v_mfma_f32_16x16x32_bf16 v[92:95], a[140:143], v[40:43], v[92:95]
    buffer_load_dwordx4 a[40:43], v1, s[8:11], s80 offen offset:0
    v_mfma_f32_16x16x32_bf16 v[92:95], a[156:159], v[44:47], v[92:95]
    s_waitcnt lgkmcnt(10)
    v_mfma_f32_16x16x32_bf16 v[64:67], a[160:163], v[48:51], v[64:67]
    s_waitcnt lgkmcnt(8)
    s_xor_b32 s80, s76, 18432
    ds_read_b64_tr_b16 v[40:41], v31 offset:16384
    v_mfma_f32_16x16x32_bf16 v[64:67], a[176:179], v[52:55], v[64:67]
    ds_read_b64_tr_b16 v[42:43], v31 offset:16896
    v_mfma_f32_16x16x32_bf16 v[68:71], a[164:167], v[48:51], v[68:71]
    ds_read_b64_tr_b16 v[44:45], v31 offset:20480
    v_mfma_f32_16x16x32_bf16 v[68:71], a[180:183], v[52:55], v[68:71]
    ds_read_b64_tr_b16 v[46:47], v31 offset:20992
    v_mfma_f32_16x16x32_bf16 v[72:75], a[168:171], v[48:51], v[72:75]
    buffer_load_dwordx4 a[44:47], v1, s[8:11], s80 offen offset:0
    v_mfma_f32_16x16x32_bf16 v[72:75], a[184:187], v[52:55], v[72:75]
    s_xor_b32 s80, s75, 2048
    v_mfma_f32_16x16x32_bf16 v[76:79], a[172:175], v[48:51], v[76:79]
    buffer_load_dwordx4 a[48:51], v1, s[8:11], s80 offen offset:1024
    v_mfma_f32_16x16x32_bf16 v[76:79], a[188:191], v[52:55], v[76:79]
    s_waitcnt lgkmcnt(10)
    v_mfma_f32_16x16x32_bf16 v[80:83], a[160:163], v[56:59], v[80:83]
    s_waitcnt lgkmcnt(8)
    ds_read_b64_tr_b16 v[48:49], v30 offset:24576
    v_mfma_f32_16x16x32_bf16 v[80:83], a[176:179], v[60:63], v[80:83]
    ds_read_b64_tr_b16 v[50:51], v30 offset:25088
    v_mfma_f32_16x16x32_bf16 v[84:87], a[164:167], v[56:59], v[84:87]
    ds_read_b64_tr_b16 v[52:53], v30 offset:28672
    v_mfma_f32_16x16x32_bf16 v[84:87], a[180:183], v[60:63], v[84:87]
    ds_read_b64_tr_b16 v[54:55], v30 offset:29184
    v_mfma_f32_16x16x32_bf16 v[88:91], a[168:171], v[56:59], v[88:91]
    s_xor_b32 s80, s75, 18432
    v_mfma_f32_16x16x32_bf16 v[88:91], a[184:187], v[60:63], v[88:91]
    buffer_load_dwordx4 a[52:55], v1, s[8:11], s80 offen offset:1024
    v_mfma_f32_16x16x32_bf16 v[92:95], a[172:175], v[56:59], v[92:95]
    v_mfma_f32_16x16x32_bf16 v[92:95], a[188:191], v[60:63], v[92:95]
    s_waitcnt lgkmcnt(10)
    v_mfma_f32_16x16x32_bf16 v[64:67], a[192:195], v[32:35], v[64:67]
    s_waitcnt lgkmcnt(8)
    ds_read_b64_tr_b16 v[56:57], v31 offset:24576
    v_cvt_pk_bf16_f32 v104, v104, v105
    v_mfma_f32_16x16x32_bf16 v[64:67], a[208:211], v[36:39], v[64:67]
    ds_read_b64_tr_b16 v[58:59], v31 offset:25088
    v_cvt_pk_bf16_f32 v105, v106, v107
    v_mfma_f32_16x16x32_bf16 v[68:71], a[196:199], v[32:35], v[68:71]
    ds_read_b64_tr_b16 v[60:61], v31 offset:28672
    v_cvt_pk_bf16_f32 v106, v108, v109
    v_mfma_f32_16x16x32_bf16 v[68:71], a[212:215], v[36:39], v[68:71]
    s_xor_b32 s80, s76, 2048
    ds_read_b64_tr_b16 v[62:63], v31 offset:29184
    v_cvt_pk_bf16_f32 v107, v110, v111
    v_mfma_f32_16x16x32_bf16 v[72:75], a[200:203], v[32:35], v[72:75]
    s_xor_b32 s79, s1, 45056
    v_mfma_f32_16x16x32_bf16 v[72:75], a[216:219], v[36:39], v[72:75]
    buffer_store_dwordx4 v[104:107], v1, s[8:11], s79 offen offset:0 sc0 sc1
    v_mfma_f32_16x16x32_bf16 v[76:79], a[204:207], v[32:35], v[76:79]
    buffer_load_dwordx4 a[56:59], v1, s[8:11], s80 offen offset:1024
    v_mfma_f32_16x16x32_bf16 v[76:79], a[220:223], v[36:39], v[76:79]
    s_waitcnt lgkmcnt(10)
    v_mfma_f32_16x16x32_bf16 v[80:83], a[192:195], v[40:43], v[80:83]
    s_waitcnt lgkmcnt(8)
    v_mfma_f32_16x16x32_bf16 v[80:83], a[208:211], v[44:47], v[80:83]
    v_mfma_f32_16x16x32_bf16 v[84:87], a[196:199], v[40:43], v[84:87]
    s_xor_b32 s80, s76, 18432
    v_mfma_f32_16x16x32_bf16 v[84:87], a[212:215], v[44:47], v[84:87]
    buffer_load_dwordx4 a[60:63], v1, s[8:11], s80 offen offset:1024
    v_mfma_f32_16x16x32_bf16 v[88:91], a[200:203], v[40:43], v[88:91]
    v_mfma_f32_16x16x32_bf16 v[88:91], a[216:219], v[44:47], v[88:91]
    v_mfma_f32_16x16x32_bf16 v[92:95], a[204:207], v[40:43], v[92:95]
    s_waitcnt lgkmcnt(0)
    s_barrier
    v_mfma_f32_16x16x32_bf16 v[92:95], a[220:223], v[44:47], v[92:95]
    ds_read_b64_tr_b16 v[32:33], v8 offset:32768
    v_mfma_f32_16x16x32_bf16 v[64:67], a[224:227], v[48:51], v[64:67]
    ds_read_b64_tr_b16 v[34:35], v8 offset:33792
    v_mfma_f32_16x16x32_bf16 v[64:67], a[240:243], v[52:55], v[64:67]
    s_xor_b32 s80, s75, 4096
    ds_read_b64_tr_b16 v[36:37], v9 offset:32768
    v_mfma_f32_16x16x32_bf16 v[68:71], a[228:231], v[48:51], v[68:71]
    ds_read_b64_tr_b16 v[38:39], v9 offset:33792
    v_mfma_f32_16x16x32_bf16 v[68:71], a[244:247], v[52:55], v[68:71]
    ds_read_b64_tr_b16 v[40:41], v10 offset:32768
    v_mfma_f32_16x16x32_bf16 v[72:75], a[232:235], v[48:51], v[72:75]
    ds_read_b64_tr_b16 v[42:43], v10 offset:33792
    v_mfma_f32_16x16x32_bf16 v[72:75], a[248:251], v[52:55], v[72:75]
    ds_read_b64_tr_b16 v[44:45], v11 offset:32768
    v_mfma_f32_16x16x32_bf16 v[76:79], a[236:239], v[48:51], v[76:79]
    ds_read_b64_tr_b16 v[46:47], v11 offset:33792
    v_cvt_pk_bf16_f32 v112, v112, v113
    v_mfma_f32_16x16x32_bf16 v[76:79], a[252:255], v[52:55], v[76:79]
    buffer_load_dwordx4 a[64:67], v1, s[8:11], s80 offen offset:0
    v_mfma_f32_16x16x32_bf16 v[80:83], a[224:227], v[56:59], v[80:83]
    s_xor_b32 s80, s75, 20480
    ds_read_b64_tr_b16 v[48:49], v12 offset:32768
    v_cvt_pk_bf16_f32 v113, v114, v115
    v_mfma_f32_16x16x32_bf16 v[80:83], a[240:243], v[60:63], v[80:83]
    ds_read_b64_tr_b16 v[50:51], v12 offset:33792
    v_cvt_pk_bf16_f32 v114, v116, v117
    v_mfma_f32_16x16x32_bf16 v[84:87], a[228:231], v[56:59], v[84:87]
    ds_read_b64_tr_b16 v[52:53], v13 offset:32768
    v_cvt_pk_bf16_f32 v115, v118, v119
    v_mfma_f32_16x16x32_bf16 v[84:87], a[244:247], v[60:63], v[84:87]
    s_xor_b32 s79, s1, 36864
    ds_read_b64_tr_b16 v[54:55], v13 offset:33792
    v_mfma_f32_16x16x32_bf16 v[88:91], a[232:235], v[56:59], v[88:91]
    buffer_store_dwordx4 v[112:115], v1, s[8:11], s79 offen offset:1024 sc0 sc1
    v_mfma_f32_16x16x32_bf16 v[88:91], a[248:251], v[60:63], v[88:91]
    buffer_load_dwordx4 a[68:71], v1, s[8:11], s80 offen offset:0
    v_mfma_f32_16x16x32_bf16 v[92:95], a[236:239], v[56:59], v[92:95]
    v_mfma_f32_16x16x32_bf16 v[92:95], a[252:255], v[60:63], v[92:95]
    s_waitcnt vmcnt(27) lgkmcnt(10)
    v_mfma_f32_16x16x32_bf16 v[128:131], v[32:35], a[0:3], 0
    s_waitcnt vmcnt(24)
    s_xor_b32 s80, s76, 4096
    ds_read_b64_tr_b16 v[56:57], v14 offset:32768
    v_mfma_f32_16x16x32_bf16 v[160:163], v[32:35], a[4:7], 0
    s_waitcnt vmcnt(22)
    ds_read_b64_tr_b16 v[58:59], v14 offset:33792
    v_mfma_f32_16x16x32_bf16 v[192:195], v[32:35], a[8:11], 0
    s_waitcnt vmcnt(20)
    ds_read_b64_tr_b16 v[60:61], v15 offset:32768
    v_mfma_f32_16x16x32_bf16 v[224:227], v[32:35], a[12:15], 0
    s_waitcnt lgkmcnt(11)
    ds_read_b64_tr_b16 v[62:63], v15 offset:33792
    v_mfma_f32_16x16x32_bf16 v[132:135], v[36:39], a[0:3], 0
    ds_read_b64_tr_b16 v[32:33], v8 offset:40960
    v_mfma_f32_16x16x32_bf16 v[164:167], v[36:39], a[4:7], 0
    ds_read_b64_tr_b16 v[34:35], v8 offset:41984
    v_mfma_f32_16x16x32_bf16 v[196:199], v[36:39], a[8:11], 0
    buffer_load_dwordx4 a[72:75], v1, s[8:11], s80 offen offset:0
    v_mfma_f32_16x16x32_bf16 v[228:231], v[36:39], a[12:15], 0
    s_waitcnt lgkmcnt(12)
    v_mfma_f32_16x16x32_bf16 v[136:139], v[40:43], a[0:3], 0
    s_xor_b32 s80, s76, 20480
    ds_read_b64_tr_b16 v[36:37], v9 offset:40960
    v_mfma_f32_16x16x32_bf16 v[168:171], v[40:43], a[4:7], 0
    ds_read_b64_tr_b16 v[38:39], v9 offset:41984
    v_mfma_f32_16x16x32_bf16 v[200:203], v[40:43], a[8:11], 0
    buffer_load_dwordx4 a[76:79], v1, s[8:11], s80 offen offset:0
    v_mfma_f32_16x16x32_bf16 v[232:235], v[40:43], a[12:15], 0
    s_waitcnt lgkmcnt(12)
    v_mfma_f32_16x16x32_bf16 v[140:143], v[44:47], a[0:3], 0
    ds_read_b64_tr_b16 v[40:41], v10 offset:40960
    v_mfma_f32_16x16x32_bf16 v[172:175], v[44:47], a[4:7], 0
    s_xor_b32 s80, s75, 4096
    ds_read_b64_tr_b16 v[42:43], v10 offset:41984
    v_mfma_f32_16x16x32_bf16 v[204:207], v[44:47], a[8:11], 0
    buffer_load_dwordx4 a[80:83], v1, s[8:11], s80 offen offset:1024
    v_mfma_f32_16x16x32_bf16 v[236:239], v[44:47], a[12:15], 0
    s_waitcnt lgkmcnt(12)
    v_mfma_f32_16x16x32_bf16 v[144:147], v[48:51], a[0:3], 0
    ds_read_b64_tr_b16 v[44:45], v11 offset:40960
    v_cvt_pk_bf16_f32 v120, v120, v121
    v_mfma_f32_16x16x32_bf16 v[176:179], v[48:51], a[4:7], 0
    ds_read_b64_tr_b16 v[46:47], v11 offset:41984
    v_cvt_pk_bf16_f32 v121, v122, v123
    v_mfma_f32_16x16x32_bf16 v[208:211], v[48:51], a[8:11], 0
    v_cvt_pk_bf16_f32 v122, v124, v125
    v_cvt_pk_bf16_f32 v123, v126, v127
    v_mfma_f32_16x16x32_bf16 v[240:243], v[48:51], a[12:15], 0
    s_waitcnt lgkmcnt(12)
    v_mfma_f32_16x16x32_bf16 v[148:151], v[52:55], a[0:3], 0
    s_xor_b32 s79, s1, 45056
    s_xor_b32 s80, s75, 20480
    ds_read_b64_tr_b16 v[48:49], v12 offset:40960
    v_mfma_f32_16x16x32_bf16 v[180:183], v[52:55], a[4:7], 0
    s_waitcnt lgkmcnt(11)
    ds_read_b64_tr_b16 v[50:51], v12 offset:41984
    v_mfma_f32_16x16x32_bf16 v[212:215], v[52:55], a[8:11], 0
    buffer_store_dwordx4 v[120:123], v1, s[8:11], s79 offen offset:1024 sc0 sc1
    v_mfma_f32_16x16x32_bf16 v[244:247], v[52:55], a[12:15], 0
    buffer_load_dwordx4 a[84:87], v1, s[8:11], s80 offen offset:1024
    v_mfma_f32_16x16x32_bf16 v[152:155], v[56:59], a[0:3], 0
    ds_read_b64_tr_b16 v[52:53], v13 offset:40960
    v_mfma_f32_16x16x32_bf16 v[184:187], v[56:59], a[4:7], 0
    ds_read_b64_tr_b16 v[54:55], v13 offset:41984
    v_mfma_f32_16x16x32_bf16 v[216:219], v[56:59], a[8:11], 0
    v_mfma_f32_16x16x32_bf16 v[248:251], v[56:59], a[12:15], 0
    s_waitcnt lgkmcnt(12)
    v_mfma_f32_16x16x32_bf16 v[156:159], v[60:63], a[0:3], 0
    s_xor_b32 s80, s76, 4096
    ds_read_b64_tr_b16 v[56:57], v14 offset:40960
    v_mfma_f32_16x16x32_bf16 v[188:191], v[60:63], a[4:7], 0
    ds_read_b64_tr_b16 v[58:59], v14 offset:41984
    v_mfma_f32_16x16x32_bf16 v[220:223], v[60:63], a[8:11], 0
    buffer_load_dwordx4 a[88:91], v1, s[8:11], s80 offen offset:1024
    v_mfma_f32_16x16x32_bf16 v[252:255], v[60:63], a[12:15], 0
    s_waitcnt vmcnt(23) lgkmcnt(12)
    v_mfma_f32_16x16x32_bf16 v[128:131], v[32:35], a[16:19], v[128:131]
    s_waitcnt vmcnt(21)
    ds_read_b64_tr_b16 v[60:61], v15 offset:40960
    v_mfma_f32_16x16x32_bf16 v[160:163], v[32:35], a[20:23], v[160:163]
    s_waitcnt vmcnt(20)
    ds_read_b64_tr_b16 v[62:63], v15 offset:41984
    v_mfma_f32_16x16x32_bf16 v[192:195], v[32:35], a[24:27], v[192:195]
    s_waitcnt vmcnt(19)
    v_mfma_f32_16x16x32_bf16 v[224:227], v[32:35], a[28:31], v[224:227]
    s_waitcnt lgkmcnt(12)
    v_mfma_f32_16x16x32_bf16 v[132:135], v[36:39], a[16:19], v[132:135]
    s_xor_b32 s80, s76, 20480
    ds_read_b64_tr_b16 v[32:33], v8 offset:0
    v_mfma_f32_16x16x32_bf16 v[164:167], v[36:39], a[20:23], v[164:167]
    ds_read_b64_tr_b16 v[34:35], v8 offset:1024
    v_mfma_f32_16x16x32_bf16 v[196:199], v[36:39], a[24:27], v[196:199]
    buffer_load_dwordx4 a[92:95], v1, s[8:11], s80 offen offset:1024
    v_mfma_f32_16x16x32_bf16 v[228:231], v[36:39], a[28:31], v[228:231]
    s_waitcnt lgkmcnt(12)
    v_mfma_f32_16x16x32_bf16 v[136:139], v[40:43], a[16:19], v[136:139]
    ds_read_b64_tr_b16 v[36:37], v9 offset:0
    v_cvt_pk_bf16_f32 v64, v64, v65
    v_mfma_f32_16x16x32_bf16 v[168:171], v[40:43], a[20:23], v[168:171]
    s_xor_b32 s80, s75, 6144
    ds_read_b64_tr_b16 v[38:39], v9 offset:1024
    v_cvt_pk_bf16_f32 v65, v66, v67
    v_mfma_f32_16x16x32_bf16 v[200:203], v[40:43], a[24:27], v[200:203]
    s_waitcnt lgkmcnt(12)
    v_cvt_pk_bf16_f32 v66, v68, v69
    v_cvt_pk_bf16_f32 v67, v70, v71
    v_mfma_f32_16x16x32_bf16 v[232:235], v[40:43], a[28:31], v[232:235]
    buffer_load_dwordx4 a[96:99], v1, s[8:11], s80 offen offset:0
    v_mfma_f32_16x16x32_bf16 v[140:143], v[44:47], a[16:19], v[140:143]
    s_xor_b32 s79, s1, 36864
    ds_read_b64_tr_b16 v[40:41], v10 offset:0
    v_mfma_f32_16x16x32_bf16 v[172:175], v[44:47], a[20:23], v[172:175]
    ds_read_b64_tr_b16 v[42:43], v10 offset:1024
    v_mfma_f32_16x16x32_bf16 v[204:207], v[44:47], a[24:27], v[204:207]
    buffer_store_dwordx4 v[64:67], v1, s[8:11], s79 offen offset:2048 sc0 sc1
    v_mfma_f32_16x16x32_bf16 v[236:239], v[44:47], a[28:31], v[236:239]
    s_waitcnt lgkmcnt(12)
    v_mfma_f32_16x16x32_bf16 v[144:147], v[48:51], a[16:19], v[144:147]
    s_xor_b32 s80, s75, 22528
    ds_read_b64_tr_b16 v[44:45], v11 offset:0
    v_mfma_f32_16x16x32_bf16 v[176:179], v[48:51], a[20:23], v[176:179]
    ds_read_b64_tr_b16 v[46:47], v11 offset:1024
    v_mfma_f32_16x16x32_bf16 v[208:211], v[48:51], a[24:27], v[208:211]
    buffer_load_dwordx4 a[100:103], v1, s[8:11], s80 offen offset:0
    v_mfma_f32_16x16x32_bf16 v[240:243], v[48:51], a[28:31], v[240:243]
    s_waitcnt lgkmcnt(12)
    v_mfma_f32_16x16x32_bf16 v[148:151], v[52:55], a[16:19], v[148:151]
    ds_read_b64_tr_b16 v[48:49], v12 offset:0
    v_mfma_f32_16x16x32_bf16 v[180:183], v[52:55], a[20:23], v[180:183]
    ds_read_b64_tr_b16 v[50:51], v12 offset:1024
    v_mfma_f32_16x16x32_bf16 v[212:215], v[52:55], a[24:27], v[212:215]
    v_mfma_f32_16x16x32_bf16 v[244:247], v[52:55], a[28:31], v[244:247]
    s_waitcnt lgkmcnt(12)
    v_mfma_f32_16x16x32_bf16 v[152:155], v[56:59], a[16:19], v[152:155]
    s_xor_b32 s80, s76, 6144
    ds_read_b64_tr_b16 v[52:53], v13 offset:0
    v_mfma_f32_16x16x32_bf16 v[184:187], v[56:59], a[20:23], v[184:187]
    ds_read_b64_tr_b16 v[54:55], v13 offset:1024
    v_mfma_f32_16x16x32_bf16 v[216:219], v[56:59], a[24:27], v[216:219]
    buffer_load_dwordx4 a[104:107], v1, s[8:11], s80 offen offset:0
    v_mfma_f32_16x16x32_bf16 v[248:251], v[56:59], a[28:31], v[248:251]
    s_waitcnt lgkmcnt(12)
    v_mfma_f32_16x16x32_bf16 v[156:159], v[60:63], a[16:19], v[156:159]
    ds_read_b64_tr_b16 v[56:57], v14 offset:0
    v_mfma_f32_16x16x32_bf16 v[188:191], v[60:63], a[20:23], v[188:191]
    ds_read_b64_tr_b16 v[58:59], v14 offset:1024
    v_mfma_f32_16x16x32_bf16 v[220:223], v[60:63], a[24:27], v[220:223]
    v_mfma_f32_16x16x32_bf16 v[252:255], v[60:63], a[28:31], v[252:255]
    s_waitcnt vmcnt(23) lgkmcnt(12)
    v_mfma_f32_16x16x32_bf16 v[128:131], v[32:35], a[32:35], v[128:131]
    s_waitcnt vmcnt(22)
    s_xor_b32 s80, s76, 22528
    ds_read_b64_tr_b16 v[60:61], v15 offset:0
    v_cvt_pk_bf16_f32 v72, v72, v73
    v_mfma_f32_16x16x32_bf16 v[160:163], v[32:35], a[36:39], v[160:163]
    s_waitcnt vmcnt(20)
    ds_read_b64_tr_b16 v[62:63], v15 offset:1024
    v_cvt_pk_bf16_f32 v73, v74, v75
    v_mfma_f32_16x16x32_bf16 v[192:195], v[32:35], a[40:43], v[192:195]
    s_waitcnt vmcnt(19) lgkmcnt(12)
    v_cvt_pk_bf16_f32 v74, v76, v77
    v_cvt_pk_bf16_f32 v75, v78, v79
    v_mfma_f32_16x16x32_bf16 v[224:227], v[32:35], a[44:47], v[224:227]
    buffer_load_dwordx4 a[108:111], v1, s[8:11], s80 offen offset:0
    v_mfma_f32_16x16x32_bf16 v[132:135], v[36:39], a[32:35], v[132:135]
    s_xor_b32 s79, s1, 45056
    ds_read_b64_tr_b16 v[32:33], v8 offset:8192
    v_mfma_f32_16x16x32_bf16 v[164:167], v[36:39], a[36:39], v[164:167]
    s_waitcnt lgkmcnt(11)
    s_xor_b32 s80, s75, 6144
    ds_read_b64_tr_b16 v[34:35], v8 offset:9216
    v_mfma_f32_16x16x32_bf16 v[196:199], v[36:39], a[40:43], v[196:199]
    buffer_store_dwordx4 v[72:75], v1, s[8:11], s79 offen offset:2048 sc0 sc1
    v_mfma_f32_16x16x32_bf16 v[228:231], v[36:39], a[44:47], v[228:231]
    buffer_load_dwordx4 a[112:115], v1, s[8:11], s80 offen offset:1024
    v_mfma_f32_16x16x32_bf16 v[136:139], v[40:43], a[32:35], v[136:139]
    ds_read_b64_tr_b16 v[36:37], v9 offset:8192
    v_mfma_f32_16x16x32_bf16 v[168:171], v[40:43], a[36:39], v[168:171]
    ds_read_b64_tr_b16 v[38:39], v9 offset:9216
    v_mfma_f32_16x16x32_bf16 v[200:203], v[40:43], a[40:43], v[200:203]
    v_mfma_f32_16x16x32_bf16 v[232:235], v[40:43], a[44:47], v[232:235]
    s_waitcnt lgkmcnt(12)
    v_mfma_f32_16x16x32_bf16 v[140:143], v[44:47], a[32:35], v[140:143]
    s_xor_b32 s80, s75, 22528
    ds_read_b64_tr_b16 v[40:41], v10 offset:8192
    v_mfma_f32_16x16x32_bf16 v[172:175], v[44:47], a[36:39], v[172:175]
    ds_read_b64_tr_b16 v[42:43], v10 offset:9216
    v_mfma_f32_16x16x32_bf16 v[204:207], v[44:47], a[40:43], v[204:207]
    buffer_load_dwordx4 a[116:119], v1, s[8:11], s80 offen offset:1024
    v_mfma_f32_16x16x32_bf16 v[236:239], v[44:47], a[44:47], v[236:239]
    s_waitcnt lgkmcnt(12)
    v_mfma_f32_16x16x32_bf16 v[144:147], v[48:51], a[32:35], v[144:147]
    ds_read_b64_tr_b16 v[44:45], v11 offset:8192
    v_mfma_f32_16x16x32_bf16 v[176:179], v[48:51], a[36:39], v[176:179]
    ds_read_b64_tr_b16 v[46:47], v11 offset:9216
    v_mfma_f32_16x16x32_bf16 v[208:211], v[48:51], a[40:43], v[208:211]
    v_mfma_f32_16x16x32_bf16 v[240:243], v[48:51], a[44:47], v[240:243]
    s_waitcnt lgkmcnt(12)
    v_mfma_f32_16x16x32_bf16 v[148:151], v[52:55], a[32:35], v[148:151]
    s_xor_b32 s80, s76, 6144
    ds_read_b64_tr_b16 v[48:49], v12 offset:8192
    v_mfma_f32_16x16x32_bf16 v[180:183], v[52:55], a[36:39], v[180:183]
    ds_read_b64_tr_b16 v[50:51], v12 offset:9216
    v_mfma_f32_16x16x32_bf16 v[212:215], v[52:55], a[40:43], v[212:215]
    buffer_load_dwordx4 a[120:123], v1, s[8:11], s80 offen offset:1024
    v_mfma_f32_16x16x32_bf16 v[244:247], v[52:55], a[44:47], v[244:247]
    s_waitcnt lgkmcnt(12)
    v_mfma_f32_16x16x32_bf16 v[152:155], v[56:59], a[32:35], v[152:155]
    ds_read_b64_tr_b16 v[52:53], v13 offset:8192
    v_cvt_pk_bf16_f32 v80, v80, v81
    v_mfma_f32_16x16x32_bf16 v[184:187], v[56:59], a[36:39], v[184:187]
    ds_read_b64_tr_b16 v[54:55], v13 offset:9216
    v_cvt_pk_bf16_f32 v81, v82, v83
    v_mfma_f32_16x16x32_bf16 v[216:219], v[56:59], a[40:43], v[216:219]
    s_waitcnt lgkmcnt(12)
    s_xor_b32 s80, s76, 22528
    v_cvt_pk_bf16_f32 v82, v84, v85
    v_cvt_pk_bf16_f32 v83, v86, v87
    v_mfma_f32_16x16x32_bf16 v[248:251], v[56:59], a[44:47], v[248:251]
    buffer_load_dwordx4 a[124:127], v1, s[8:11], s80 offen offset:1024
    v_mfma_f32_16x16x32_bf16 v[156:159], v[60:63], a[32:35], v[156:159]
    s_xor_b32 s79, s1, 36864
    ds_read_b64_tr_b16 v[56:57], v14 offset:8192
    v_mfma_f32_16x16x32_bf16 v[188:191], v[60:63], a[36:39], v[188:191]
    ds_read_b64_tr_b16 v[58:59], v14 offset:9216
    v_mfma_f32_16x16x32_bf16 v[220:223], v[60:63], a[40:43], v[220:223]
    buffer_store_dwordx4 v[80:83], v1, s[8:11], s79 offen offset:3072 sc0 sc1
    v_mfma_f32_16x16x32_bf16 v[252:255], v[60:63], a[44:47], v[252:255]
    s_waitcnt vmcnt(25) lgkmcnt(12)
    v_mfma_f32_16x16x32_bf16 v[128:131], v[32:35], a[48:51], v[128:131]
    s_waitcnt vmcnt(24)
    ds_read_b64_tr_b16 v[60:61], v15 offset:8192
    v_mfma_f32_16x16x32_bf16 v[160:163], v[32:35], a[52:55], v[160:163]
    s_waitcnt vmcnt(21)
    s_xor_b32 s80, s75, 8192
    ds_read_b64_tr_b16 v[62:63], v15 offset:9216
    v_mfma_f32_16x16x32_bf16 v[192:195], v[32:35], a[56:59], v[192:195]
    buffer_load_dwordx4 a[128:131], v1, s[8:11], s80 offen offset:0
    v_mfma_f32_16x16x32_bf16 v[224:227], v[32:35], a[60:63], v[224:227]
    s_waitcnt lgkmcnt(12)
    v_mfma_f32_16x16x32_bf16 v[132:135], v[36:39], a[48:51], v[132:135]
    ds_read_b64_tr_b16 v[32:33], v8 offset:16384
    v_mfma_f32_16x16x32_bf16 v[164:167], v[36:39], a[52:55], v[164:167]
    ds_read_b64_tr_b16 v[34:35], v8 offset:17408
    v_mfma_f32_16x16x32_bf16 v[196:199], v[36:39], a[56:59], v[196:199]
    v_mfma_f32_16x16x32_bf16 v[228:231], v[36:39], a[60:63], v[228:231]
    s_waitcnt lgkmcnt(12)
    v_mfma_f32_16x16x32_bf16 v[136:139], v[40:43], a[48:51], v[136:139]
    s_xor_b32 s80, s75, 24576
    ds_read_b64_tr_b16 v[36:37], v9 offset:16384
    v_mfma_f32_16x16x32_bf16 v[168:171], v[40:43], a[52:55], v[168:171]
    ds_read_b64_tr_b16 v[38:39], v9 offset:17408
    v_mfma_f32_16x16x32_bf16 v[200:203], v[40:43], a[56:59], v[200:203]
    buffer_load_dwordx4 a[132:135], v1, s[8:11], s80 offen offset:0
    v_mfma_f32_16x16x32_bf16 v[232:235], v[40:43], a[60:63], v[232:235]
    s_waitcnt lgkmcnt(12)
    v_mfma_f32_16x16x32_bf16 v[140:143], v[44:47], a[48:51], v[140:143]
    ds_read_b64_tr_b16 v[40:41], v10 offset:16384
    v_mfma_f32_16x16x32_bf16 v[172:175], v[44:47], a[52:55], v[172:175]
    ds_read_b64_tr_b16 v[42:43], v10 offset:17408
    v_mfma_f32_16x16x32_bf16 v[204:207], v[44:47], a[56:59], v[204:207]
    v_mfma_f32_16x16x32_bf16 v[236:239], v[44:47], a[60:63], v[236:239]
    s_waitcnt lgkmcnt(12)
    v_mfma_f32_16x16x32_bf16 v[144:147], v[48:51], a[48:51], v[144:147]
    s_xor_b32 s80, s76, 8192
    ds_read_b64_tr_b16 v[44:45], v11 offset:16384
    v_cvt_pk_bf16_f32 v88, v88, v89
    v_mfma_f32_16x16x32_bf16 v[176:179], v[48:51], a[52:55], v[176:179]
    ds_read_b64_tr_b16 v[46:47], v11 offset:17408
    v_cvt_pk_bf16_f32 v89, v90, v91
    v_mfma_f32_16x16x32_bf16 v[208:211], v[48:51], a[56:59], v[208:211]
    s_waitcnt lgkmcnt(12)
    v_cvt_pk_bf16_f32 v90, v92, v93
    v_cvt_pk_bf16_f32 v91, v94, v95
    v_mfma_f32_16x16x32_bf16 v[240:243], v[48:51], a[60:63], v[240:243]
    buffer_load_dwordx4 a[136:139], v1, s[8:11], s80 offen offset:0
    v_mfma_f32_16x16x32_bf16 v[148:151], v[52:55], a[48:51], v[148:151]
    s_xor_b32 s79, s1, 45056
    ds_read_b64_tr_b16 v[48:49], v12 offset:16384
    v_mfma_f32_16x16x32_bf16 v[180:183], v[52:55], a[52:55], v[180:183]
    ds_read_b64_tr_b16 v[50:51], v12 offset:17408
    v_mfma_f32_16x16x32_bf16 v[212:215], v[52:55], a[56:59], v[212:215]
    buffer_store_dwordx4 v[88:91], v1, s[8:11], s79 offen offset:3072 sc0 sc1
    v_mfma_f32_16x16x32_bf16 v[244:247], v[52:55], a[60:63], v[244:247]
    s_waitcnt lgkmcnt(12)
    v_mfma_f32_16x16x32_bf16 v[152:155], v[56:59], a[48:51], v[152:155]
    s_xor_b32 s80, s76, 24576
    ds_read_b64_tr_b16 v[52:53], v13 offset:16384
    v_mfma_f32_16x16x32_bf16 v[184:187], v[56:59], a[52:55], v[184:187]
    ds_read_b64_tr_b16 v[54:55], v13 offset:17408
    v_mfma_f32_16x16x32_bf16 v[216:219], v[56:59], a[56:59], v[216:219]
    buffer_load_dwordx4 a[140:143], v1, s[8:11], s80 offen offset:0
    v_mfma_f32_16x16x32_bf16 v[248:251], v[56:59], a[60:63], v[248:251]
    s_waitcnt lgkmcnt(12)
    v_mfma_f32_16x16x32_bf16 v[156:159], v[60:63], a[48:51], v[156:159]
    ds_read_b64_tr_b16 v[56:57], v14 offset:16384
    v_mfma_f32_16x16x32_bf16 v[188:191], v[60:63], a[52:55], v[188:191]
    s_xor_b32 s80, s75, 8192
    ds_read_b64_tr_b16 v[58:59], v14 offset:17408
    v_mfma_f32_16x16x32_bf16 v[220:223], v[60:63], a[56:59], v[220:223]
    buffer_load_dwordx4 a[144:147], v1, s[8:11], s80 offen offset:1024
    v_mfma_f32_16x16x32_bf16 v[252:255], v[60:63], a[60:63], v[252:255]
    s_waitcnt vmcnt(26) lgkmcnt(12)
    v_mfma_f32_16x16x32_bf16 v[128:131], v[32:35], a[64:67], v[128:131]
    s_waitcnt vmcnt(24)
    ds_read_b64_tr_b16 v[60:61], v15 offset:16384
    v_mfma_f32_16x16x32_bf16 v[160:163], v[32:35], a[68:71], v[160:163]
    s_waitcnt vmcnt(23)
    ds_read_b64_tr_b16 v[62:63], v15 offset:17408
    v_mfma_f32_16x16x32_bf16 v[192:195], v[32:35], a[72:75], v[192:195]
    s_waitcnt vmcnt(22)
    v_mfma_f32_16x16x32_bf16 v[224:227], v[32:35], a[76:79], v[224:227]
    s_waitcnt lgkmcnt(12)
    v_mfma_f32_16x16x32_bf16 v[132:135], v[36:39], a[64:67], v[132:135]
    s_xor_b32 s80, s75, 24576
    ds_read_b64_tr_b16 v[32:33], v8 offset:24576
    v_mfma_f32_16x16x32_bf16 v[164:167], v[36:39], a[68:71], v[164:167]
    ds_read_b64_tr_b16 v[34:35], v8 offset:25600
    v_mfma_f32_16x16x32_bf16 v[196:199], v[36:39], a[72:75], v[196:199]
    buffer_load_dwordx4 a[148:151], v1, s[8:11], s80 offen offset:1024
    v_mfma_f32_16x16x32_bf16 v[228:231], v[36:39], a[76:79], v[228:231]
    s_waitcnt lgkmcnt(12)
    v_mfma_f32_16x16x32_bf16 v[136:139], v[40:43], a[64:67], v[136:139]
    ds_read_b64_tr_b16 v[36:37], v9 offset:24576
    v_mfma_f32_16x16x32_bf16 v[168:171], v[40:43], a[68:71], v[168:171]
    ds_read_b64_tr_b16 v[38:39], v9 offset:25600
    v_mfma_f32_16x16x32_bf16 v[200:203], v[40:43], a[72:75], v[200:203]
    v_mfma_f32_16x16x32_bf16 v[232:235], v[40:43], a[76:79], v[232:235]
    s_waitcnt lgkmcnt(12)
    v_mfma_f32_16x16x32_bf16 v[140:143], v[44:47], a[64:67], v[140:143]
    s_xor_b32 s80, s76, 8192
    ds_read_b64_tr_b16 v[40:41], v10 offset:24576
    v_mfma_f32_16x16x32_bf16 v[172:175], v[44:47], a[68:71], v[172:175]
    ds_read_b64_tr_b16 v[42:43], v10 offset:25600
    v_mfma_f32_16x16x32_bf16 v[204:207], v[44:47], a[72:75], v[204:207]
    buffer_load_dwordx4 a[152:155], v1, s[8:11], s80 offen offset:1024
    v_mfma_f32_16x16x32_bf16 v[236:239], v[44:47], a[76:79], v[236:239]
    s_waitcnt lgkmcnt(12)
    v_mfma_f32_16x16x32_bf16 v[144:147], v[48:51], a[64:67], v[144:147]
    ds_read_b64_tr_b16 v[44:45], v11 offset:24576
    v_mfma_f32_16x16x32_bf16 v[176:179], v[48:51], a[68:71], v[176:179]
    ds_read_b64_tr_b16 v[46:47], v11 offset:25600
    v_mfma_f32_16x16x32_bf16 v[208:211], v[48:51], a[72:75], v[208:211]
    v_mfma_f32_16x16x32_bf16 v[240:243], v[48:51], a[76:79], v[240:243]
    s_waitcnt lgkmcnt(12)
    v_mfma_f32_16x16x32_bf16 v[148:151], v[52:55], a[64:67], v[148:151]
    s_xor_b32 s80, s76, 24576
    ds_read_b64_tr_b16 v[48:49], v12 offset:24576
    v_mfma_f32_16x16x32_bf16 v[180:183], v[52:55], a[68:71], v[180:183]
    ds_read_b64_tr_b16 v[50:51], v12 offset:25600
    v_mfma_f32_16x16x32_bf16 v[212:215], v[52:55], a[72:75], v[212:215]
    buffer_load_dwordx4 a[156:159], v1, s[8:11], s80 offen offset:1024
    v_mfma_f32_16x16x32_bf16 v[244:247], v[52:55], a[76:79], v[244:247]
    s_waitcnt lgkmcnt(12)
    v_mfma_f32_16x16x32_bf16 v[152:155], v[56:59], a[64:67], v[152:155]
    ds_read_b64_tr_b16 v[52:53], v13 offset:24576
    v_lshlrev_b32 v116, 2, v0
    v_mfma_f32_16x16x32_bf16 v[184:187], v[56:59], a[68:71], v[184:187]
    s_xor_b32 s80, s75, 10240
    ds_read_b64_tr_b16 v[54:55], v13 offset:25600
    v_cmp_gt_u32 vcc, 8, v0
    v_mfma_f32_16x16x32_bf16 v[216:219], v[56:59], a[72:75], v[216:219]
    buffer_load_dwordx4 a[160:163], v1, s[8:11], s80 offen offset:0
    v_mfma_f32_16x16x32_bf16 v[248:251], v[56:59], a[76:79], v[248:251]
    s_waitcnt lgkmcnt(12)
    v_mov_b32 v117, 2147479552
    v_cndmask_b32 v116, v117, v116, vcc
    v_mfma_f32_16x16x32_bf16 v[156:159], v[60:63], a[64:67], v[156:159]
    s_lshl_b32 s70, s2, 5
    s_add_u32 s70, s70, 20480
    ds_read_b64_tr_b16 v[56:57], v14 offset:24576
    v_mfma_f32_16x16x32_bf16 v[188:191], v[60:63], a[68:71], v[188:191]
    ds_read_b64_tr_b16 v[58:59], v14 offset:25600
    v_and_b32 v119, 3, v2
    v_mfma_f32_16x16x32_bf16 v[220:223], v[60:63], a[72:75], v[220:223]
    v_lshlrev_b32 v119, 9, v119
    v_mfma_f32_16x16x32_bf16 v[252:255], v[60:63], a[76:79], v[252:255]
    s_waitcnt vmcnt(25) lgkmcnt(12)
    v_mfma_f32_16x16x32_bf16 v[128:131], v[32:35], a[80:83], v[128:131]
    s_waitcnt vmcnt(23)
    s_xor_b32 s80, s75, 26624
    s_lshr_b32 s69, s2, 6
    ds_read_b64_tr_b16 v[60:61], v15 offset:24576
    v_mfma_f32_16x16x32_bf16 v[160:163], v[32:35], a[84:87], v[160:163]
    s_waitcnt vmcnt(21)
    s_add_u32 s69, s69, 4
    s_lshl_b32 s69, s69, 5
    ds_read_b64_tr_b16 v[62:63], v15 offset:25600
    v_mfma_f32_16x16x32_bf16 v[192:195], v[32:35], a[88:91], v[192:195]
    buffer_load_dwordx4 a[164:167], v1, s[8:11], s80 offen offset:0
    v_mfma_f32_16x16x32_bf16 v[224:227], v[32:35], a[92:95], v[224:227]
    s_waitcnt lgkmcnt(12)
    s_bfe_u32 s68, s2, 196611
    s_add_u32 s69, s69, s68
    s_lshl_b32 s69, s69, 6
    v_mfma_f32_16x16x32_bf16 v[132:135], v[36:39], a[80:83], v[132:135]
    s_add_u32 s69, s69, 1310720
    ds_read_b64_tr_b16 v[32:33], v8 offset:49152
    v_mfma_f32_16x16x32_bf16 v[164:167], v[36:39], a[84:87], v[164:167]
    ds_read_b64_tr_b16 v[34:35], v8 offset:50176
    v_mfma_f32_16x16x32_bf16 v[196:199], v[36:39], a[88:91], v[196:199]
    buffer_load_dword v118, v119, s[8:11], s69 offen sc0 sc1
    v_mfma_f32_16x16x32_bf16 v[228:231], v[36:39], a[92:95], v[228:231]
    s_waitcnt lgkmcnt(12)
    v_mfma_f32_16x16x32_bf16 v[136:139], v[40:43], a[80:83], v[136:139]
    s_xor_b32 s80, s76, 10240
    ds_read_b64_tr_b16 v[36:37], v9 offset:49152
    v_mfma_f32_16x16x32_bf16 v[168:171], v[40:43], a[84:87], v[168:171]
    ds_read_b64_tr_b16 v[38:39], v9 offset:50176
    v_mfma_f32_16x16x32_bf16 v[200:203], v[40:43], a[88:91], v[200:203]
    buffer_load_dwordx4 a[168:171], v1, s[8:11], s80 offen offset:0
    v_mfma_f32_16x16x32_bf16 v[232:235], v[40:43], a[92:95], v[232:235]
    s_waitcnt lgkmcnt(12)
    v_mfma_f32_16x16x32_bf16 v[140:143], v[44:47], a[80:83], v[140:143]
    ds_read_b64_tr_b16 v[40:41], v10 offset:49152
    v_mfma_f32_16x16x32_bf16 v[172:175], v[44:47], a[84:87], v[172:175]
    ds_read_b64_tr_b16 v[42:43], v10 offset:50176
    v_mfma_f32_16x16x32_bf16 v[204:207], v[44:47], a[88:91], v[204:207]
    v_mfma_f32_16x16x32_bf16 v[236:239], v[44:47], a[92:95], v[236:239]
    s_waitcnt lgkmcnt(12)
    v_mfma_f32_16x16x32_bf16 v[144:147], v[48:51], a[80:83], v[144:147]
    s_xor_b32 s80, s76, 26624
    ds_read_b64_tr_b16 v[44:45], v11 offset:49152
    v_mfma_f32_16x16x32_bf16 v[176:179], v[48:51], a[84:87], v[176:179]
    s_waitcnt lgkmcnt(11)
    ds_read_b64_tr_b16 v[46:47], v11 offset:50176
    v_mfma_f32_16x16x32_bf16 v[208:211], v[48:51], a[88:91], v[208:211]
    buffer_load_dwordx4 a[172:175], v1, s[8:11], s80 offen offset:0
    s_waitcnt vmcnt(10)
    v_mfma_f32_16x16x32_bf16 v[240:243], v[48:51], a[92:95], v[240:243]
    buffer_store_dword v6, v5, s[8:11], s73 offen sc0 sc1
    v_mfma_f32_16x16x32_bf16 v[148:151], v[52:55], a[80:83], v[148:151]
    ds_read_b64_tr_b16 v[48:49], v12 offset:49152
    v_mfma_f32_16x16x32_bf16 v[180:183], v[52:55], a[84:87], v[180:183]
    s_xor_b32 s80, s75, 10240
    ds_read_b64_tr_b16 v[50:51], v12 offset:50176
    v_mfma_f32_16x16x32_bf16 v[212:215], v[52:55], a[88:91], v[212:215]
    buffer_load_dwordx4 a[176:179], v1, s[8:11], s80 offen offset:1024
    v_mfma_f32_16x16x32_bf16 v[244:247], v[52:55], a[92:95], v[244:247]
    s_waitcnt lgkmcnt(12)
    v_mfma_f32_16x16x32_bf16 v[152:155], v[56:59], a[80:83], v[152:155]
    ds_read_b64_tr_b16 v[52:53], v13 offset:49152
    v_mfma_f32_16x16x32_bf16 v[184:187], v[56:59], a[84:87], v[184:187]
    ds_read_b64_tr_b16 v[54:55], v13 offset:50176
    v_mfma_f32_16x16x32_bf16 v[216:219], v[56:59], a[88:91], v[216:219]
    v_mfma_f32_16x16x32_bf16 v[248:251], v[56:59], a[92:95], v[248:251]
    s_waitcnt lgkmcnt(12)
    v_mfma_f32_16x16x32_bf16 v[156:159], v[60:63], a[80:83], v[156:159]
    s_xor_b32 s80, s75, 26624
    ds_read_b64_tr_b16 v[56:57], v14 offset:49152
    v_mfma_f32_16x16x32_bf16 v[188:191], v[60:63], a[84:87], v[188:191]
    ds_read_b64_tr_b16 v[58:59], v14 offset:50176
    v_mfma_f32_16x16x32_bf16 v[220:223], v[60:63], a[88:91], v[220:223]
    buffer_load_dwordx4 a[180:183], v1, s[8:11], s80 offen offset:1024
    v_mfma_f32_16x16x32_bf16 v[252:255], v[60:63], a[92:95], v[252:255]
    s_waitcnt lgkmcnt(12)
    v_mfma_f32_16x16x32_bf16 v[128:131], v[32:35], a[96:99], v[128:131]
    ds_read_b64_tr_b16 v[60:61], v15 offset:49152
    v_mfma_f32_16x16x32_bf16 v[160:163], v[32:35], a[100:103], v[160:163]
    ds_read_b64_tr_b16 v[62:63], v15 offset:50176
    v_mfma_f32_16x16x32_bf16 v[192:195], v[32:35], a[104:107], v[192:195]
    v_mfma_f32_16x16x32_bf16 v[224:227], v[32:35], a[108:111], v[224:227]
    s_waitcnt lgkmcnt(12)
    v_mfma_f32_16x16x32_bf16 v[132:135], v[36:39], a[96:99], v[132:135]
    s_xor_b32 s80, s76, 10240
    ds_read_b64_tr_b16 v[32:33], v8 offset:57344
    v_mfma_f32_16x16x32_bf16 v[164:167], v[36:39], a[100:103], v[164:167]
    ds_read_b64_tr_b16 v[34:35], v8 offset:58368
    v_mfma_f32_16x16x32_bf16 v[196:199], v[36:39], a[104:107], v[196:199]
    buffer_load_dwordx4 a[184:187], v1, s[8:11], s80 offen offset:1024
    v_mfma_f32_16x16x32_bf16 v[228:231], v[36:39], a[108:111], v[228:231]
    s_waitcnt lgkmcnt(12)
    v_mfma_f32_16x16x32_bf16 v[136:139], v[40:43], a[96:99], v[136:139]
    ds_read_b64_tr_b16 v[36:37], v9 offset:57344
    v_mfma_f32_16x16x32_bf16 v[168:171], v[40:43], a[100:103], v[168:171]
    ds_read_b64_tr_b16 v[38:39], v9 offset:58368
    v_mfma_f32_16x16x32_bf16 v[200:203], v[40:43], a[104:107], v[200:203]
    v_mfma_f32_16x16x32_bf16 v[232:235], v[40:43], a[108:111], v[232:235]
    s_waitcnt lgkmcnt(12)
    v_mfma_f32_16x16x32_bf16 v[140:143], v[44:47], a[96:99], v[140:143]
    s_xor_b32 s80, s76, 26624
    ds_read_b64_tr_b16 v[40:41], v10 offset:57344
    v_mfma_f32_16x16x32_bf16 v[172:175], v[44:47], a[100:103], v[172:175]
    ds_read_b64_tr_b16 v[42:43], v10 offset:58368
    v_mfma_f32_16x16x32_bf16 v[204:207], v[44:47], a[104:107], v[204:207]
    buffer_load_dwordx4 a[188:191], v1, s[8:11], s80 offen offset:1024
    v_mfma_f32_16x16x32_bf16 v[236:239], v[44:47], a[108:111], v[236:239]
    s_waitcnt lgkmcnt(12)
    v_mfma_f32_16x16x32_bf16 v[144:147], v[48:51], a[96:99], v[144:147]
    ds_read_b64_tr_b16 v[44:45], v11 offset:57344
    v_mfma_f32_16x16x32_bf16 v[176:179], v[48:51], a[100:103], v[176:179]
    s_xor_b32 s80, s75, 12288
    ds_read_b64_tr_b16 v[46:47], v11 offset:58368
    v_mfma_f32_16x16x32_bf16 v[208:211], v[48:51], a[104:107], v[208:211]
    buffer_load_dwordx4 a[192:195], v1, s[8:11], s80 offen offset:0
    v_mfma_f32_16x16x32_bf16 v[240:243], v[48:51], a[108:111], v[240:243]
    s_waitcnt lgkmcnt(12)
    v_mfma_f32_16x16x32_bf16 v[148:151], v[52:55], a[96:99], v[148:151]
    ds_read_b64_tr_b16 v[48:49], v12 offset:57344
    v_mfma_f32_16x16x32_bf16 v[180:183], v[52:55], a[100:103], v[180:183]
    ds_read_b64_tr_b16 v[50:51], v12 offset:58368
    v_mfma_f32_16x16x32_bf16 v[212:215], v[52:55], a[104:107], v[212:215]
    v_mfma_f32_16x16x32_bf16 v[244:247], v[52:55], a[108:111], v[244:247]
    s_waitcnt lgkmcnt(12)
    v_mfma_f32_16x16x32_bf16 v[152:155], v[56:59], a[96:99], v[152:155]
    s_xor_b32 s80, s75, 28672
    ds_read_b64_tr_b16 v[52:53], v13 offset:57344
    s_waitcnt vmcnt(8)
    v_cmp_ne_u32 vcc, 0, v118
    s_cmp_eq_u64 vcc, -1
    s_cbranch_scc0 L_E2_slow_5
L_E2_ok_6:
    v_mfma_f32_16x16x32_bf16 v[184:187], v[56:59], a[100:103], v[184:187]
    s_waitcnt lgkmcnt(11)
    ds_read_b64_tr_b16 v[54:55], v13 offset:58368
    v_mfma_f32_16x16x32_bf16 v[216:219], v[56:59], a[104:107], v[216:219]
    buffer_load_dwordx4 a[196:199], v1, s[8:11], s80 offen offset:0
    v_mfma_f32_16x16x32_bf16 v[248:251], v[56:59], a[108:111], v[248:251]
    buffer_load_dword v112, v116, s[8:11], s70 offen
    v_mfma_f32_16x16x32_bf16 v[156:159], v[60:63], a[96:99], v[156:159]
    s_add_u32 s70, s70, 12288
    ds_read_b64_tr_b16 v[56:57], v14 offset:57344
    v_mfma_f32_16x16x32_bf16 v[188:191], v[60:63], a[100:103], v[188:191]
    s_waitcnt lgkmcnt(11)
    ds_read_b64_tr_b16 v[58:59], v14 offset:58368
    v_mfma_f32_16x16x32_bf16 v[220:223], v[60:63], a[104:107], v[220:223]
    buffer_load_dword v113, v116, s[8:11], s70 offen
    v_mfma_f32_16x16x32_bf16 v[252:255], v[60:63], a[108:111], v[252:255]
    buffer_load_dword v3, v17, s[8:11], s74 offen sc0 sc1
    v_mfma_f32_16x16x32_bf16 v[128:131], v[32:35], a[112:115], v[128:131]
    s_xor_b32 s80, s76, 12288
    s_add_u32 s70, s70, 12288
    ds_read_b64_tr_b16 v[60:61], v15 offset:57344
    v_mfma_f32_16x16x32_bf16 v[160:163], v[32:35], a[116:119], v[160:163]
    s_waitcnt lgkmcnt(11)
    ds_read_b64_tr_b16 v[62:63], v15 offset:58368
    v_mfma_f32_16x16x32_bf16 v[192:195], v[32:35], a[120:123], v[192:195]
    buffer_load_dwordx4 a[200:203], v1, s[8:11], s80 offen offset:0
    v_mfma_f32_16x16x32_bf16 v[224:227], v[32:35], a[124:127], v[224:227]
    buffer_load_dword v114, v116, s[8:11], s70 offen
    v_mfma_f32_16x16x32_bf16 v[132:135], v[36:39], a[112:115], v[132:135]
    s_add_u32 s70, s70, 12288
    v_mfma_f32_16x16x32_bf16 v[164:167], v[36:39], a[116:119], v[164:167]
    buffer_load_dword v115, v116, s[8:11], s70 offen
    v_mfma_f32_16x16x32_bf16 v[196:199], v[36:39], a[120:123], v[196:199]
    s_add_u32 s70, s70, 12288
    v_mfma_f32_16x16x32_bf16 v[228:231], v[36:39], a[124:127], v[228:231]
    s_waitcnt lgkmcnt(10)
    v_mfma_f32_16x16x32_bf16 v[136:139], v[40:43], a[112:115], v[136:139]
    s_xor_b32 s80, s76, 28672
    v_subrev_u32 v8, 98304, v8
    v_subrev_u32 v9, 98304, v9
    s_waitcnt lgkmcnt(0)
    s_barrier
    v_mfma_f32_16x16x32_bf16 v[168:171], v[40:43], a[116:119], v[168:171]
    ds_read_b64_tr_b16 v[32:33], v8 offset:0
    v_mfma_f32_16x16x32_bf16 v[200:203], v[40:43], a[120:123], v[200:203]
    ds_read_b64_tr_b16 v[34:35], v8 offset:1024
    v_mfma_f32_16x16x32_bf16 v[232:235], v[40:43], a[124:127], v[232:235]
    ds_read_b64_tr_b16 v[36:37], v9 offset:0
    v_subrev_u32 v10, 98304, v10
    v_mfma_f32_16x16x32_bf16 v[140:143], v[44:47], a[112:115], v[140:143]
    ds_read_b64_tr_b16 v[38:39], v9 offset:1024
    v_mfma_f32_16x16x32_bf16 v[172:175], v[44:47], a[116:119], v[172:175]
    ds_read_b64_tr_b16 v[40:41], v10 offset:0
    v_mfma_f32_16x16x32_bf16 v[204:207], v[44:47], a[120:123], v[204:207]
    ds_read_b64_tr_b16 v[42:43], v10 offset:1024
    v_mfma_f32_16x16x32_bf16 v[236:239], v[44:47], a[124:127], v[236:239]
    v_subrev_u32 v11, 98304, v11
    v_mfma_f32_16x16x32_bf16 v[144:147], v[48:51], a[112:115], v[144:147]
    ds_read_b64_tr_b16 v[44:45], v11 offset:0
    v_mfma_f32_16x16x32_bf16 v[176:179], v[48:51], a[116:119], v[176:179]
    ds_read_b64_tr_b16 v[46:47], v11 offset:1024
    v_mfma_f32_16x16x32_bf16 v[208:211], v[48:51], a[120:123], v[208:211]
    buffer_load_dwordx4 a[204:207], v1, s[8:11], s80 offen offset:0
    v_mfma_f32_16x16x32_bf16 v[240:243], v[48:51], a[124:127], v[240:243]
    s_xor_b32 s80, s75, 12288
    v_subrev_u32 v12, 98304, v12
    v_mfma_f32_16x16x32_bf16 v[148:151], v[52:55], a[112:115], v[148:151]
    ds_read_b64_tr_b16 v[48:49], v12 offset:0
    v_mfma_f32_16x16x32_bf16 v[180:183], v[52:55], a[116:119], v[180:183]
    ds_read_b64_tr_b16 v[50:51], v12 offset:1024
    v_mfma_f32_16x16x32_bf16 v[212:215], v[52:55], a[120:123], v[212:215]
    buffer_load_dwordx4 a[208:211], v1, s[8:11], s80 offen offset:1024
    v_mfma_f32_16x16x32_bf16 v[244:247], v[52:55], a[124:127], v[244:247]
    s_xor_b32 s80, s75, 28672
    v_subrev_u32 v13, 98304, v13
    v_mfma_f32_16x16x32_bf16 v[152:155], v[56:59], a[112:115], v[152:155]
    ds_read_b64_tr_b16 v[52:53], v13 offset:0
    v_mfma_f32_16x16x32_bf16 v[184:187], v[56:59], a[116:119], v[184:187]
    ds_read_b64_tr_b16 v[54:55], v13 offset:1024
    v_mfma_f32_16x16x32_bf16 v[216:219], v[56:59], a[120:123], v[216:219]
    buffer_load_dwordx4 a[212:215], v1, s[8:11], s80 offen offset:1024
    v_mfma_f32_16x16x32_bf16 v[248:251], v[56:59], a[124:127], v[248:251]
    s_xor_b32 s80, s76, 12288
    v_subrev_u32 v14, 98304, v14
    v_mfma_f32_16x16x32_bf16 v[156:159], v[60:63], a[112:115], v[156:159]
    ds_read_b64_tr_b16 v[56:57], v14 offset:0
    v_mfma_f32_16x16x32_bf16 v[188:191], v[60:63], a[116:119], v[188:191]
    ds_read_b64_tr_b16 v[58:59], v14 offset:1024
    v_mfma_f32_16x16x32_bf16 v[220:223], v[60:63], a[120:123], v[220:223]
    buffer_load_dwordx4 a[216:219], v1, s[8:11], s80 offen offset:1024
    v_mfma_f32_16x16x32_bf16 v[252:255], v[60:63], a[124:127], v[252:255]
    s_waitcnt lgkmcnt(12)
    v_subrev_u32 v15, 98304, v15
    v_mfma_f32_16x16x32_bf16 v[128:131], v[32:35], a[128:131], v[128:131]
    ds_read_b64_tr_b16 v[60:61], v15 offset:0
    v_mfma_f32_16x16x32_bf16 v[160:163], v[32:35], a[132:135], v[160:163]
    ds_read_b64_tr_b16 v[62:63], v15 offset:1024
    v_mfma_f32_16x16x32_bf16 v[192:195], v[32:35], a[136:139], v[192:195]
    v_mfma_f32_16x16x32_bf16 v[224:227], v[32:35], a[140:143], v[224:227]
    s_waitcnt lgkmcnt(12)
    v_mfma_f32_16x16x32_bf16 v[132:135], v[36:39], a[128:131], v[132:135]
    s_xor_b32 s80, s76, 28672
    ds_read_b64_tr_b16 v[32:33], v8 offset:8192
    v_mfma_f32_16x16x32_bf16 v[164:167], v[36:39], a[132:135], v[164:167]
    ds_read_b64_tr_b16 v[34:35], v8 offset:9216
    v_mfma_f32_16x16x32_bf16 v[196:199], v[36:39], a[136:139], v[196:199]
    buffer_load_dwordx4 a[220:223], v1, s[8:11], s80 offen offset:1024
    s_waitcnt vmcnt(8)
    v_cmp_ne_u32 vcc, 0, v3
    s_cmp_eq_u64 vcc, -1
    s_cbranch_scc0 L_KV_slow_7
L_KV_ok_8:
    v_mfma_f32_16x16x32_bf16 v[228:231], v[36:39], a[140:143], v[228:231]
    s_waitcnt lgkmcnt(12)
    v_mfma_f32_16x16x32_bf16 v[136:139], v[40:43], a[128:131], v[136:139]
    s_add_u32 m0, s62, 65536
    s_add_u32 s98, s81, 0
    ds_read_b64_tr_b16 v[36:37], v9 offset:8192
    v_mfma_f32_16x16x32_bf16 v[168:171], v[40:43], a[132:135], v[168:171]
    s_waitcnt lgkmcnt(11)
    s_xor_b32 s80, s75, 14336
    s_and_b32 s100, s3, 1
    ds_read_b64_tr_b16 v[38:39], v9 offset:9216
    v_mfma_f32_16x16x32_bf16 v[200:203], v[40:43], a[136:139], v[200:203]
    buffer_load_dwordx4 a[224:227], v1, s[8:11], s80 offen offset:0
    v_mfma_f32_16x16x32_bf16 v[232:235], v[40:43], a[140:143], v[232:235]
    buffer_load_dwordx4 v1, s[8:11], s98 offen offset:0  lds
    v_mfma_f32_16x16x32_bf16 v[140:143], v[44:47], a[128:131], v[140:143]
    s_lshr_b32 s101, s3, 1
    ds_read_b64_tr_b16 v[40:41], v10 offset:8192
    v_add_u32 v16, s62, v1
    v_mfma_f32_16x16x32_bf16 v[172:175], v[44:47], a[132:135], v[172:175]
    s_lshl_b32 s19, s101, 14
    ds_read_b64_tr_b16 v[42:43], v10 offset:9216
    v_add_u32 v17, s19, v1
    v_mfma_f32_16x16x32_bf16 v[204:207], v[44:47], a[136:139], v[204:207]
    v_mfma_f32_16x16x32_bf16 v[236:239], v[44:47], a[140:143], v[236:239]
    s_waitcnt lgkmcnt(12)
    v_mfma_f32_16x16x32_bf16 v[144:147], v[48:51], a[128:131], v[144:147]
    s_xor_b32 s80, s75, 30720
    s_lshl_b32 s19, s100, 13
    ds_read_b64_tr_b16 v[44:45], v11 offset:8192
    v_mfma_f32_16x16x32_bf16 v[176:179], v[48:51], a[132:135], v[176:179]
    s_waitcnt lgkmcnt(11)
    s_add_u32 s19, s19, 65536
    ds_read_b64_tr_b16 v[46:47], v11 offset:9216
    v_add_u32 v18, s19, v1
    v_mfma_f32_16x16x32_bf16 v[208:211], v[48:51], a[136:139], v[208:211]
    buffer_load_dwordx4 a[228:231], v1, s[8:11], s80 offen offset:0
    v_mfma_f32_16x16x32_bf16 v[240:243], v[48:51], a[140:143], v[240:243]
    buffer_load_dwordx4 v1, s[8:11], s98 offen offset:1024  lds
    v_mfma_f32_16x16x32_bf16 v[148:151], v[52:55], a[128:131], v[148:151]
    s_mul_i32 s19, s100, 12288
    s_add_u32 s19, s19, 98304
    ds_read_b64_tr_b16 v[48:49], v12 offset:8192
    v_mfma_f32_16x16x32_bf16 v[180:183], v[52:55], a[132:135], v[180:183]
    ds_read_b64_tr_b16 v[50:51], v12 offset:9216
    v_add_u32 v19, s19, v1
    v_mfma_f32_16x16x32_bf16 v[212:215], v[52:55], a[136:139], v[212:215]
    v_mfma_f32_16x16x32_bf16 v[244:247], v[52:55], a[140:143], v[244:247]
    s_waitcnt lgkmcnt(12)
    v_mfma_f32_16x16x32_bf16 v[152:155], v[56:59], a[128:131], v[152:155]
    s_xor_b32 s80, s76, 14336
    s_lshl_b32 s19, s100, 12
    ds_read_b64_tr_b16 v[52:53], v13 offset:8192
    v_mfma_f32_16x16x32_bf16 v[184:187], v[56:59], a[132:135], v[184:187]
    s_waitcnt lgkmcnt(11)
    s_add_u32 s19, s19, 98304
    ds_read_b64_tr_b16 v[54:55], v13 offset:9216
    v_add_u32 v20, s19, v1
    v_mfma_f32_16x16x32_bf16 v[216:219], v[56:59], a[136:139], v[216:219]
    buffer_load_dwordx4 a[232:235], v1, s[8:11], s80 offen offset:0
    v_mfma_f32_16x16x32_bf16 v[248:251], v[56:59], a[140:143], v[248:251]
    buffer_load_dwordx4 v1, s[8:11], s98 offen offset:2048  lds
    v_mfma_f32_16x16x32_bf16 v[156:159], v[60:63], a[128:131], v[156:159]
    ds_read_b64_tr_b16 v[56:57], v14 offset:8192
    v_and_b32 v23, 15, v2
    v_mfma_f32_16x16x32_bf16 v[188:191], v[60:63], a[132:135], v[188:191]
    ds_read_b64_tr_b16 v[58:59], v14 offset:9216
    v_lshrrev_b32 v24, 4, v2
    v_mfma_f32_16x16x32_bf16 v[220:223], v[60:63], a[136:139], v[220:223]
    v_lshlrev_b32 v25, 2, v24
    v_sub_u32 v25, v23, v25
    v_mfma_f32_16x16x32_bf16 v[252:255], v[60:63], a[140:143], v[252:255]
    s_waitcnt lgkmcnt(12)
    v_mfma_f32_16x16x32_bf16 v[128:131], v[32:35], a[144:147], v[128:131]
    s_xor_b32 s80, s76, 30720
    s_sub_i32 s19, s101, s100
    ds_read_b64_tr_b16 v[60:61], v15 offset:8192
    v_mfma_f32_16x16x32_bf16 v[160:163], v[32:35], a[148:151], v[160:163]
    s_waitcnt lgkmcnt(11)
    s_lshl_b32 s19, s19, 5
    ds_read_b64_tr_b16 v[62:63], v15 offset:9216
    v_add_u32 v21, s19, v25
    v_mfma_f32_16x16x32_bf16 v[192:195], v[32:35], a[152:155], v[192:195]
    buffer_load_dwordx4 a[236:239], v1, s[8:11], s80 offen offset:0
    v_mfma_f32_16x16x32_bf16 v[224:227], v[32:35], a[156:159], v[224:227]
    buffer_load_dwordx4 v1, s[8:11], s98 offen offset:3072  lds
    v_mfma_f32_16x16x32_bf16 v[132:135], v[36:39], a[144:147], v[132:135]
    s_add_u32 m0, s62, 69632
    ds_read_b64_tr_b16 v[32:33], v8 offset:16384
    v_add_f32 v112, v112, v113
    v_mfma_f32_16x16x32_bf16 v[164:167], v[36:39], a[148:151], v[164:167]
    s_xor_b32 s80, s75, 14336
    ds_read_b64_tr_b16 v[34:35], v8 offset:17408
    s_waitcnt vmcnt(13)
    v_add_f32 v114, v114, v115
    v_mfma_f32_16x16x32_bf16 v[196:199], v[36:39], a[152:155], v[196:199]
    buffer_load_dwordx4 a[240:243], v1, s[8:11], s80 offen offset:1024
    v_mfma_f32_16x16x32_bf16 v[228:231], v[36:39], a[156:159], v[228:231]
    s_waitcnt lgkmcnt(12)
    s_add_u32 s98, s81, 4096
    v_add_f32 v112, v112, v114
    v_cvt_pk_bf16_f32 v112, v112, v112
    v_mfma_f32_16x16x32_bf16 v[136:139], v[40:43], a[144:147], v[136:139]
    s_add_u32 s19, s101, s100
    ds_read_b64_tr_b16 v[36:37], v9 offset:16384
    v_and_b32 v112, 0xffff0000, v112
    v_mfma_f32_16x16x32_bf16 v[168:171], v[40:43], a[148:151], v[168:171]
    s_lshr_b32 s70, s2, 6
    s_cmp_eq_u32 s70, 2
    s_cselect_b32 s70, 1.0, 0
    ds_read_b64_tr_b16 v[38:39], v9 offset:17408
    v_mfma_f32_16x16x32_bf16 v[200:203], v[40:43], a[152:155], v[200:203]
    s_waitcnt lgkmcnt(12)
    s_sub_i32 s19, 1, s19
    v_add_f32 v112, s70, v112
    v_cvt_pk_bf16_f32 v112, v112, v112
    v_mfma_f32_16x16x32_bf16 v[232:235], v[40:43], a[156:159], v[232:235]
    buffer_load_dwordx4 v1, s[8:11], s98 offen offset:0  lds
    v_mfma_f32_16x16x32_bf16 v[140:143], v[44:47], a[144:147], v[140:143]
    s_xor_b32 s80, s75, 30720
    ds_read_b64_tr_b16 v[40:41], v10 offset:16384
    v_and_b32 v112, 0xffff0000, v112
    v_mfma_f32_16x16x32_bf16 v[172:175], v[44:47], a[148:151], v[172:175]
    s_waitcnt lgkmcnt(11)
    s_lshl_b32 s70, s2, 5
    s_add_u32 s70, s70, 4096
    ds_read_b64_tr_b16 v[42:43], v10 offset:17408
    v_mfma_f32_16x16x32_bf16 v[204:207], v[44:47], a[152:155], v[204:207]
    buffer_load_dwordx4 a[244:247], v1, s[8:11], s80 offen offset:1024
    v_mfma_f32_16x16x32_bf16 v[236:239], v[44:47], a[156:159], v[236:239]
    buffer_store_dword v112, v116, s[8:11], s70 offen sc0 sc1
    v_mfma_f32_16x16x32_bf16 v[144:147], v[48:51], a[144:147], v[144:147]
    s_lshl_b32 s19, s19, 5
    ds_read_b64_tr_b16 v[44:45], v11 offset:16384
    v_add_u32 v22, s19, v25
    v_mfma_f32_16x16x32_bf16 v[176:179], v[48:51], a[148:151], v[176:179]
    ds_read_b64_tr_b16 v[46:47], v11 offset:17408
    v_cvt_f32_i32 v21, v21
    v_mfma_f32_16x16x32_bf16 v[208:211], v[48:51], a[152:155], v[208:211]
    buffer_load_dwordx4 v1, s[8:11], s98 offen offset:1024  lds
    v_mfma_f32_16x16x32_bf16 v[240:243], v[48:51], a[156:159], v[240:243]
    s_waitcnt lgkmcnt(12)
    v_cvt_f32_i32 v22, v22
    v_add_f32 v21, 0.5, v21
    v_mfma_f32_16x16x32_bf16 v[148:151], v[52:55], a[144:147], v[148:151]
    s_xor_b32 s80, s76, 14336
    ds_read_b64_tr_b16 v[48:49], v12 offset:16384
    v_add_f32 v22, 0.5, v22
    v_mfma_f32_16x16x32_bf16 v[180:183], v[52:55], a[148:151], v[180:183]
    s_waitcnt lgkmcnt(11)
    ds_read_b64_tr_b16 v[50:51], v12 offset:17408
    v_mul_f32 v21, 0x71800000, v21
    v_mfma_f32_16x16x32_bf16 v[212:215], v[52:55], a[152:155], v[212:215]
    buffer_load_dwordx4 a[248:251], v1, s[8:11], s80 offen offset:1024
    v_mfma_f32_16x16x32_bf16 v[244:247], v[52:55], a[156:159], v[244:247]
    buffer_load_dwordx4 v1, s[8:11], s98 offen offset:2048  lds
    v_mfma_f32_16x16x32_bf16 v[152:155], v[56:59], a[144:147], v[152:155]
    ds_read_b64_tr_b16 v[52:53], v13 offset:16384
    v_mul_f32 v22, 0x71800000, v22
    v_mfma_f32_16x16x32_bf16 v[184:187], v[56:59], a[148:151], v[184:187]
    ds_read_b64_tr_b16 v[54:55], v13 offset:17408
    v_lshrrev_b32 v25, 2, v23
    v_mfma_f32_16x16x32_bf16 v[216:219], v[56:59], a[152:155], v[216:219]
    v_and_b32 v23, 3, v23
    v_lshlrev_b32 v23, 6, v23
    v_mfma_f32_16x16x32_bf16 v[248:251], v[56:59], a[156:159], v[248:251]
    s_waitcnt lgkmcnt(12)
    v_mfma_f32_16x16x32_bf16 v[156:159], v[60:63], a[144:147], v[156:159]
    s_xor_b32 s80, s76, 30720
    ds_read_b64_tr_b16 v[56:57], v14 offset:16384
    v_lshl_add_u32 v23, v25, 15, v23
    v_mfma_f32_16x16x32_bf16 v[188:191], v[60:63], a[148:151], v[188:191]
    s_waitcnt lgkmcnt(11)
    ds_read_b64_tr_b16 v[58:59], v14 offset:17408
    v_lshl_add_u32 v23, v24, 4, v23
    v_mfma_f32_16x16x32_bf16 v[220:223], v[60:63], a[152:155], v[220:223]
    buffer_load_dwordx4 a[252:255], v1, s[8:11], s80 offen offset:1024
    v_mfma_f32_16x16x32_bf16 v[252:255], v[60:63], a[156:159], v[252:255]
    buffer_load_dwordx4 v1, s[8:11], s98 offen offset:3072  lds
    v_mfma_f32_16x16x32_bf16 v[128:131], v[32:35], a[160:163], v[128:131]
    s_add_u32 m0, s62, 98304
    s_add_u32 s98, s81, 32768
    ds_read_b64_tr_b16 v[60:61], v15 offset:16384
    v_mfma_f32_16x16x32_bf16 v[160:163], v[32:35], a[164:167], v[160:163]
    s_lshl_b32 s18, s6, 20
    s_lshl_b32 s19, s3, 18
    ds_read_b64_tr_b16 v[62:63], v15 offset:17408
    v_mfma_f32_16x16x32_bf16 v[192:195], v[32:35], a[168:171], v[192:195]
    s_add_u32 s18, s18, s19
    s_lshl_b32 s19, s7, 10
    s_add_u32 s18, s18, s19
    v_mfma_f32_16x16x32_bf16 v[224:227], v[32:35], a[172:175], v[224:227]
    s_waitcnt lgkmcnt(12)
    v_mfma_f32_16x16x32_bf16 v[132:135], v[36:39], a[160:163], v[132:135]
    s_add_u32 s18, s18, 67108864
    s_mov_b32 s13, s60
    ds_read_b64_tr_b16 v[32:33], v8 offset:24576
    v_mfma_f32_16x16x32_bf16 v[164:167], v[36:39], a[164:167], v[164:167]
    s_mov_b32 s12, 2
    s_mov_b32 s25, 0
    ds_read_b64_tr_b16 v[34:35], v8 offset:25600
    v_mfma_f32_16x16x32_bf16 v[196:199], v[36:39], a[168:171], v[196:199]
    buffer_load_dwordx4 v1, s[8:11], s98 offen offset:0  lds
    v_mfma_f32_16x16x32_bf16 v[228:231], v[36:39], a[172:175], v[228:231]
    s_waitcnt lgkmcnt(12)
    s_mov_b32 s26, 28
    s_mov_b32 s64, 128
    s_lshl_b32 s65, s3, 16
    v_mfma_f32_16x16x32_bf16 v[136:139], v[40:43], a[160:163], v[136:139]
    s_add_u32 s15, s62, 65536
    s_add_u32 s16, s62, 0
    ds_read_b64_tr_b16 v[36:37], v9 offset:24576
    v_mfma_f32_16x16x32_bf16 v[168:171], v[40:43], a[164:167], v[168:171]
    s_lshl_b32 s20, s7, 13
    s_lshl_b32 s19, s100, 11
    ds_read_b64_tr_b16 v[38:39], v9 offset:25600
    v_mfma_f32_16x16x32_bf16 v[200:203], v[40:43], a[168:171], v[200:203]
    s_waitcnt lgkmcnt(12)
    s_add_u32 s20, s20, s19
    s_add_u32 s20, s20, 50331648
    s_sub_u32 s19, 3, s101
    v_mfma_f32_16x16x32_bf16 v[232:235], v[40:43], a[172:175], v[232:235]
    buffer_load_dwordx4 v1, s[8:11], s98 offen offset:1024  lds
    v_mfma_f32_16x16x32_bf16 v[140:143], v[44:47], a[160:163], v[140:143]
    s_lshl_b32 s19, s19, 18
    s_add_u32 s21, s20, s19
    ds_read_b64_tr_b16 v[40:41], v10 offset:24576
    v_mfma_f32_16x16x32_bf16 v[172:175], v[44:47], a[164:167], v[172:175]
    s_lshl_b32 s19, s101, 18
    s_add_u32 s20, s20, s19
    ds_read_b64_tr_b16 v[42:43], v10 offset:25600
    v_mfma_f32_16x16x32_bf16 v[204:207], v[44:47], a[168:171], v[204:207]
    s_add_u32 s22, s72, 131072
    s_and_b32 s23, s2, 231
    s_lshl_b32 s23, s23, 8
    v_mfma_f32_16x16x32_bf16 v[236:239], v[44:47], a[172:175], v[236:239]
    s_waitcnt lgkmcnt(12)
    v_mfma_f32_16x16x32_bf16 v[144:147], v[48:51], a[160:163], v[144:147]
    s_sub_u32 s19, 3, s3
    s_min_u32 s19, s19, s3
    ds_read_b64_tr_b16 v[44:45], v11 offset:24576
    v_mfma_f32_16x16x32_bf16 v[176:179], v[48:51], a[164:167], v[176:179]
    s_lshl_b32 s19, s19, 7
    s_add_u32 s23, s23, s19
    ds_read_b64_tr_b16 v[46:47], v11 offset:25600
    v_mfma_f32_16x16x32_bf16 v[208:211], v[48:51], a[168:171], v[208:211]
    buffer_load_dwordx4 v1, s[8:11], s98 offen offset:2048  lds
    v_mfma_f32_16x16x32_bf16 v[240:243], v[48:51], a[172:175], v[240:243]
    s_waitcnt lgkmcnt(12)
    s_add_u32 s23, s23, 1179648
    v_mov_b32 v24, -1
    v_mov_b32 v28, 0x3f803f80
    v_mfma_f32_16x16x32_bf16 v[148:151], v[52:55], a[160:163], v[148:151]
    ds_read_b64_tr_b16 v[48:49], v12 offset:24576
    v_mov_b32 v25, -1
    v_mfma_f32_16x16x32_bf16 v[180:183], v[52:55], a[164:167], v[180:183]
    ds_read_b64_tr_b16 v[50:51], v12 offset:25600
    v_mov_b32 v29, 0x3f803f80
    v_mfma_f32_16x16x32_bf16 v[212:215], v[52:55], a[168:171], v[212:215]
    s_waitcnt lgkmcnt(12)
    v_mov_b32 v26, -1
    v_mov_b32 v30, 0x3f803f80
    v_mfma_f32_16x16x32_bf16 v[244:247], v[52:55], a[172:175], v[244:247]
    buffer_load_dwordx4 v1, s[8:11], s98 offen offset:3072  lds
    v_mfma_f32_16x16x32_bf16 v[152:155], v[56:59], a[160:163], v[152:155]
    s_add_u32 m0, s62, 102400
    s_add_u32 s98, s81, 36864
    ds_read_b64_tr_b16 v[52:53], v13 offset:24576
    v_mfma_f32_16x16x32_bf16 v[184:187], v[56:59], a[164:167], v[184:187]
    ds_read_b64_tr_b16 v[54:55], v13 offset:25600
    v_mov_b32 v27, -1
    v_mfma_f32_16x16x32_bf16 v[216:219], v[56:59], a[168:171], v[216:219]
    v_mov_b32 v31, 0x3f803f80
    v_mov_b32 v64, 0
    v_mfma_f32_16x16x32_bf16 v[248:251], v[56:59], a[172:175], v[248:251]
    s_waitcnt lgkmcnt(12)
    v_mfma_f32_16x16x32_bf16 v[156:159], v[60:63], a[160:163], v[156:159]
    ds_read_b64_tr_b16 v[56:57], v14 offset:24576
    v_mov_b32 v65, 0
    v_mfma_f32_16x16x32_bf16 v[188:191], v[60:63], a[164:167], v[188:191]
    ds_read_b64_tr_b16 v[58:59], v14 offset:25600
    v_mov_b32 v66, 0
    v_mfma_f32_16x16x32_bf16 v[220:223], v[60:63], a[168:171], v[220:223]
    buffer_load_dwordx4 v1, s[8:11], s98 offen offset:0  lds
    v_mfma_f32_16x16x32_bf16 v[252:255], v[60:63], a[172:175], v[252:255]
    s_waitcnt lgkmcnt(12)
    v_mov_b32 v67, 0
    v_mov_b32 v68, 0
    v_mfma_f32_16x16x32_bf16 v[128:131], v[32:35], a[176:179], v[128:131]
    ds_read_b64_tr_b16 v[60:61], v15 offset:24576
    v_mov_b32 v69, 0
    v_mfma_f32_16x16x32_bf16 v[160:163], v[32:35], a[180:183], v[160:163]
    ds_read_b64_tr_b16 v[62:63], v15 offset:25600
    v_mov_b32 v70, 0
    v_mfma_f32_16x16x32_bf16 v[192:195], v[32:35], a[184:187], v[192:195]
    s_waitcnt lgkmcnt(12)
    v_mov_b32 v71, 0
    v_mov_b32 v72, 0
    v_mfma_f32_16x16x32_bf16 v[224:227], v[32:35], a[188:191], v[224:227]
    buffer_load_dwordx4 v1, s[8:11], s98 offen offset:1024  lds
    v_mfma_f32_16x16x32_bf16 v[132:135], v[36:39], a[176:179], v[132:135]
    ds_read_b64_tr_b16 v[32:33], v8 offset:32768
    v_mov_b32 v73, 0
    v_mfma_f32_16x16x32_bf16 v[164:167], v[36:39], a[180:183], v[164:167]
    ds_read_b64_tr_b16 v[34:35], v8 offset:33792
    v_mov_b32 v74, 0
    v_mfma_f32_16x16x32_bf16 v[196:199], v[36:39], a[184:187], v[196:199]
    v_mov_b32 v75, 0
    v_mov_b32 v76, 0
    v_mfma_f32_16x16x32_bf16 v[228:231], v[36:39], a[188:191], v[228:231]
    s_waitcnt lgkmcnt(12)
    v_mfma_f32_16x16x32_bf16 v[136:139], v[40:43], a[176:179], v[136:139]
    ds_read_b64_tr_b16 v[36:37], v9 offset:32768
    v_mov_b32 v77, 0
    v_mfma_f32_16x16x32_bf16 v[168:171], v[40:43], a[180:183], v[168:171]
    ds_read_b64_tr_b16 v[38:39], v9 offset:33792
    v_mov_b32 v78, 0
    v_mfma_f32_16x16x32_bf16 v[200:203], v[40:43], a[184:187], v[200:203]
    buffer_load_dwordx4 v1, s[8:11], s98 offen offset:2048  lds
    v_mfma_f32_16x16x32_bf16 v[232:235], v[40:43], a[188:191], v[232:235]
    s_waitcnt lgkmcnt(12)
    v_mov_b32 v79, 0
    v_mfma_f32_16x16x32_bf16 v[140:143], v[44:47], a[176:179], v[140:143]
    s_cmp_eq_u32 s60, 0
    s_cselect_b32 s19, 0, 0x76800000
    ds_read_b64_tr_b16 v[40:41], v10 offset:32768
    v_add_f32 v3, s19, v21
    v_mfma_f32_16x16x32_bf16 v[172:175], v[44:47], a[180:183], v[172:175]
    ds_read_b64_tr_b16 v[42:43], v10 offset:33792
    v_add_f32 v96, 0, v3
    v_mfma_f32_16x16x32_bf16 v[204:207], v[44:47], a[184:187], v[204:207]
    s_waitcnt lgkmcnt(12)
    v_min_f32 v96, v96, v64
    v_add_f32 v97, 0xf1800000, v3
    v_mfma_f32_16x16x32_bf16 v[236:239], v[44:47], a[188:191], v[236:239]
    buffer_load_dwordx4 v1, s[8:11], s98 offen offset:3072  lds
    v_mfma_f32_16x16x32_bf16 v[144:147], v[48:51], a[176:179], v[144:147]
    s_add_u32 m0, s62, 131072
    s_add_u32 s98, s82, 0
    ds_read_b64_tr_b16 v[44:45], v11 offset:32768
    v_mfma_f32_16x16x32_bf16 v[176:179], v[48:51], a[180:183], v[176:179]
    ds_read_b64_tr_b16 v[46:47], v11 offset:33792
    v_min_f32 v97, v97, v65
    v_mfma_f32_16x16x32_bf16 v[208:211], v[48:51], a[184:187], v[208:211]
    v_add_f32 v98, 0xf2000000, v3
    v_min_f32 v98, v98, v66
    v_mfma_f32_16x16x32_bf16 v[240:243], v[48:51], a[188:191], v[240:243]
    s_waitcnt lgkmcnt(12)
    v_mfma_f32_16x16x32_bf16 v[148:151], v[52:55], a[176:179], v[148:151]
    ds_read_b64_tr_b16 v[48:49], v12 offset:32768
    v_add_f32 v99, 0xf2400000, v3
    v_mfma_f32_16x16x32_bf16 v[180:183], v[52:55], a[180:183], v[180:183]
    ds_read_b64_tr_b16 v[50:51], v12 offset:33792
    v_min_f32 v99, v99, v67
    v_mfma_f32_16x16x32_bf16 v[212:215], v[52:55], a[184:187], v[212:215]
    buffer_load_dwordx4 v1, s[8:11], s98 offen offset:0  lds
    v_mfma_f32_16x16x32_bf16 v[244:247], v[52:55], a[188:191], v[244:247]
    s_waitcnt lgkmcnt(12)
    v_add_f32 v100, 0xf3800000, v3
    v_min_f32 v100, v100, v64
    v_mfma_f32_16x16x32_bf16 v[152:155], v[56:59], a[176:179], v[152:155]
    ds_read_b64_tr_b16 v[52:53], v13 offset:32768
    v_add_f32 v101, 0xf3880000, v3
    v_mfma_f32_16x16x32_bf16 v[184:187], v[56:59], a[180:183], v[184:187]
    ds_read_b64_tr_b16 v[54:55], v13 offset:33792
    v_min_f32 v101, v101, v65
    v_mfma_f32_16x16x32_bf16 v[216:219], v[56:59], a[184:187], v[216:219]
    s_waitcnt lgkmcnt(12)
    v_add_f32 v102, 0xf3900000, v3
    v_min_f32 v102, v102, v66
    v_mfma_f32_16x16x32_bf16 v[248:251], v[56:59], a[188:191], v[248:251]
    buffer_load_dwordx4 v1, s[8:11], s98 offen offset:1024  lds
    v_mfma_f32_16x16x32_bf16 v[156:159], v[60:63], a[176:179], v[156:159]
    ds_read_b64_tr_b16 v[56:57], v14 offset:32768
    v_add_f32 v103, 0xf3980000, v3
    v_mfma_f32_16x16x32_bf16 v[188:191], v[60:63], a[180:183], v[188:191]
    ds_read_b64_tr_b16 v[58:59], v14 offset:33792
    v_min_f32 v103, v103, v67
    v_mfma_f32_16x16x32_bf16 v[220:223], v[60:63], a[184:187], v[220:223]
    v_add_f32 v104, 0x73800000, v3
    v_min_f32 v104, v104, v68
    v_mfma_f32_16x16x32_bf16 v[252:255], v[60:63], a[188:191], v[252:255]
    s_waitcnt lgkmcnt(12)
    v_mfma_f32_16x16x32_bf16 v[128:131], v[32:35], a[192:195], v[128:131]
    ds_read_b64_tr_b16 v[60:61], v15 offset:32768
    v_add_f32 v105, 0x73700000, v3
    v_mfma_f32_16x16x32_bf16 v[160:163], v[32:35], a[196:199], v[160:163]
    s_waitcnt vmcnt(31)
    ds_read_b64_tr_b16 v[62:63], v15 offset:33792
    v_min_f32 v105, v105, v69
    v_mfma_f32_16x16x32_bf16 v[192:195], v[32:35], a[200:203], v[192:195]
    buffer_load_dwordx4 v1, s[8:11], s98 offen offset:2048  lds
    v_mfma_f32_16x16x32_bf16 v[224:227], v[32:35], a[204:207], v[224:227]
    s_waitcnt lgkmcnt(12)
    v_add_f32 v106, 0x73600000, v3
    v_min_f32 v106, v106, v70
    v_mfma_f32_16x16x32_bf16 v[132:135], v[36:39], a[192:195], v[132:135]
    ds_read_b64_tr_b16 v[32:33], v8 offset:40960
    v_add_f32 v107, 0x73500000, v3
    v_mfma_f32_16x16x32_bf16 v[164:167], v[36:39], a[196:199], v[164:167]
    ds_read_b64_tr_b16 v[34:35], v8 offset:41984
    v_min_f32 v107, v107, v71
    v_mfma_f32_16x16x32_bf16 v[196:199], v[36:39], a[200:203], v[196:199]
    s_waitcnt lgkmcnt(12)
    v_add_f32 v108, 0, v3
    v_min_f32 v108, v108, v68
    v_mfma_f32_16x16x32_bf16 v[228:231], v[36:39], a[204:207], v[228:231]
    buffer_load_dwordx4 v1, s[8:11], s98 offen offset:3072  lds
    v_mfma_f32_16x16x32_bf16 v[136:139], v[40:43], a[192:195], v[136:139]
    s_add_u32 m0, s62, 135168
    s_add_u32 s98, s82, 4096
    ds_read_b64_tr_b16 v[36:37], v9 offset:40960
    v_mfma_f32_16x16x32_bf16 v[168:171], v[40:43], a[196:199], v[168:171]
    ds_read_b64_tr_b16 v[38:39], v9 offset:41984
    v_add_f32 v109, 0xf1800000, v3
    v_mfma_f32_16x16x32_bf16 v[200:203], v[40:43], a[200:203], v[200:203]
    v_min_f32 v109, v109, v69
    v_add_f32 v110, 0xf2000000, v3
    v_mfma_f32_16x16x32_bf16 v[232:235], v[40:43], a[204:207], v[232:235]
    s_waitcnt lgkmcnt(12)
    v_mfma_f32_16x16x32_bf16 v[140:143], v[44:47], a[192:195], v[140:143]
    ds_read_b64_tr_b16 v[40:41], v10 offset:40960
    v_min_f32 v110, v110, v70
    v_mfma_f32_16x16x32_bf16 v[172:175], v[44:47], a[196:199], v[172:175]
    ds_read_b64_tr_b16 v[42:43], v10 offset:41984
    v_add_f32 v111, 0xf2400000, v3
    v_mfma_f32_16x16x32_bf16 v[204:207], v[44:47], a[200:203], v[204:207]
    buffer_load_dwordx4 v1, s[8:11], s98 offen offset:0  lds
    v_mfma_f32_16x16x32_bf16 v[236:239], v[44:47], a[204:207], v[236:239]
    s_waitcnt lgkmcnt(12)
    v_min_f32 v111, v111, v71
    v_mfma_f32_16x16x32_bf16 v[144:147], v[48:51], a[192:195], v[144:147]
    s_cmp_eq_u32 s60, 0
    s_cselect_b32 s19, 1.0, 0
    ds_read_b64_tr_b16 v[44:45], v11 offset:40960
    v_sub_f32 v3, v22, v21
    v_mfma_f32_16x16x32_bf16 v[176:179], v[48:51], a[196:199], v[176:179]
    ds_read_b64_tr_b16 v[46:47], v11 offset:41984
    v_fma_f32 v3, s19, v3, v21
    v_mfma_f32_16x16x32_bf16 v[208:211], v[48:51], a[200:203], v[208:211]
    s_waitcnt lgkmcnt(12)
    v_add_f32 v80, 0, v3
    v_min_f32 v80, v80, v64
    v_mfma_f32_16x16x32_bf16 v[240:243], v[48:51], a[204:207], v[240:243]
    buffer_load_dwordx4 v1, s[8:11], s98 offen offset:1024  lds
    v_mfma_f32_16x16x32_bf16 v[148:151], v[52:55], a[192:195], v[148:151]
    ds_read_b64_tr_b16 v[48:49], v12 offset:40960
    v_add_f32 v81, 0xf1800000, v3
    v_mfma_f32_16x16x32_bf16 v[180:183], v[52:55], a[196:199], v[180:183]
    ds_read_b64_tr_b16 v[50:51], v12 offset:41984
    v_min_f32 v81, v81, v65
    v_mfma_f32_16x16x32_bf16 v[212:215], v[52:55], a[200:203], v[212:215]
    v_add_f32 v82, 0xf2000000, v3
    v_min_f32 v82, v82, v66
    v_mfma_f32_16x16x32_bf16 v[244:247], v[52:55], a[204:207], v[244:247]
    s_waitcnt lgkmcnt(12)
    v_mfma_f32_16x16x32_bf16 v[152:155], v[56:59], a[192:195], v[152:155]
    ds_read_b64_tr_b16 v[52:53], v13 offset:40960
    v_add_f32 v83, 0xf2400000, v3
    v_mfma_f32_16x16x32_bf16 v[184:187], v[56:59], a[196:199], v[184:187]
    ds_read_b64_tr_b16 v[54:55], v13 offset:41984
    v_min_f32 v83, v83, v67
    v_mfma_f32_16x16x32_bf16 v[216:219], v[56:59], a[200:203], v[216:219]
    buffer_load_dwordx4 v1, s[8:11], s98 offen offset:2048  lds
    v_mfma_f32_16x16x32_bf16 v[248:251], v[56:59], a[204:207], v[248:251]
    s_waitcnt lgkmcnt(12)
    v_add_f32 v84, 0xf3800000, v3
    v_min_f32 v84, v84, v64
    v_mfma_f32_16x16x32_bf16 v[156:159], v[60:63], a[192:195], v[156:159]
    ds_read_b64_tr_b16 v[56:57], v14 offset:40960
    v_add_f32 v85, 0xf3880000, v3
    v_mfma_f32_16x16x32_bf16 v[188:191], v[60:63], a[196:199], v[188:191]
    ds_read_b64_tr_b16 v[58:59], v14 offset:41984
    v_min_f32 v85, v85, v65
    v_mfma_f32_16x16x32_bf16 v[220:223], v[60:63], a[200:203], v[220:223]
    s_waitcnt vmcnt(35) lgkmcnt(12)
    v_add_f32 v86, 0xf3900000, v3
    v_min_f32 v86, v86, v66
    v_mfma_f32_16x16x32_bf16 v[252:255], v[60:63], a[204:207], v[252:255]
    buffer_load_dwordx4 v1, s[8:11], s98 offen offset:3072  lds
    v_mfma_f32_16x16x32_bf16 v[128:131], v[32:35], a[208:211], v[128:131]
    s_waitcnt vmcnt(35)
    ds_read_b64_tr_b16 v[60:61], v15 offset:40960
    v_add_f32 v87, 0xf3980000, v3
    v_mfma_f32_16x16x32_bf16 v[160:163], v[32:35], a[212:215], v[160:163]
    s_waitcnt vmcnt(34)
    ds_read_b64_tr_b16 v[62:63], v15 offset:41984
    v_min_f32 v87, v87, v67
    v_mfma_f32_16x16x32_bf16 v[192:195], v[32:35], a[216:219], v[192:195]
    s_waitcnt vmcnt(33)
    v_add_f32 v88, 0x73800000, v3
    v_min_f32 v88, v88, v68
    v_mfma_f32_16x16x32_bf16 v[224:227], v[32:35], a[220:223], v[224:227]
    s_waitcnt lgkmcnt(12)
    v_mfma_f32_16x16x32_bf16 v[132:135], v[36:39], a[208:211], v[132:135]
    ds_read_b64_tr_b16 v[32:33], v8 offset:49152
    v_add_f32 v89, 0x73700000, v3
    v_mfma_f32_16x16x32_bf16 v[164:167], v[36:39], a[212:215], v[164:167]
    ds_read_b64_tr_b16 v[34:35], v8 offset:50176
    v_min_f32 v89, v89, v69
    v_mfma_f32_16x16x32_bf16 v[196:199], v[36:39], a[216:219], v[196:199]
    v_add_f32 v90, 0x73600000, v3
    v_min_f32 v90, v90, v70
    v_mfma_f32_16x16x32_bf16 v[228:231], v[36:39], a[220:223], v[228:231]
    s_waitcnt lgkmcnt(12)
    v_mfma_f32_16x16x32_bf16 v[136:139], v[40:43], a[208:211], v[136:139]
    ds_read_b64_tr_b16 v[36:37], v9 offset:49152
    v_add_f32 v91, 0x73500000, v3
    v_mfma_f32_16x16x32_bf16 v[168:171], v[40:43], a[212:215], v[168:171]
    ds_read_b64_tr_b16 v[38:39], v9 offset:50176
    v_min_f32 v91, v91, v71
    v_mfma_f32_16x16x32_bf16 v[200:203], v[40:43], a[216:219], v[200:203]
    v_add_f32 v92, 0, v3
    v_min_f32 v92, v92, v68
    v_mfma_f32_16x16x32_bf16 v[232:235], v[40:43], a[220:223], v[232:235]
    s_waitcnt lgkmcnt(12)
    v_mfma_f32_16x16x32_bf16 v[140:143], v[44:47], a[208:211], v[140:143]
    ds_read_b64_tr_b16 v[40:41], v10 offset:49152
    v_add_f32 v93, 0xf1800000, v3
    v_mfma_f32_16x16x32_bf16 v[172:175], v[44:47], a[212:215], v[172:175]
    ds_read_b64_tr_b16 v[42:43], v10 offset:50176
    v_min_f32 v93, v93, v69
    v_mfma_f32_16x16x32_bf16 v[204:207], v[44:47], a[216:219], v[204:207]
    v_add_f32 v94, 0xf2000000, v3
    v_min_f32 v94, v94, v70
    v_mfma_f32_16x16x32_bf16 v[236:239], v[44:47], a[220:223], v[236:239]
    s_waitcnt lgkmcnt(12)
    v_mfma_f32_16x16x32_bf16 v[144:147], v[48:51], a[208:211], v[144:147]
    ds_read_b64_tr_b16 v[44:45], v11 offset:49152
    v_add_f32 v95, 0xf2400000, v3
    v_mfma_f32_16x16x32_bf16 v[176:179], v[48:51], a[212:215], v[176:179]
    ds_read_b64_tr_b16 v[46:47], v11 offset:50176
    v_min_f32 v95, v95, v71
    v_mfma_f32_16x16x32_bf16 v[208:211], v[48:51], a[216:219], v[208:211]
    v_mfma_f32_16x16x32_bf16 v[240:243], v[48:51], a[220:223], v[240:243]
    s_waitcnt lgkmcnt(12)
    v_mfma_f32_16x16x32_bf16 v[148:151], v[52:55], a[208:211], v[148:151]
    s_lshl_b32 s79, s2, 2
    s_add_u32 s79, s79, s3
    ds_read_b64_tr_b16 v[48:49], v12 offset:49152
    v_mfma_f32_16x16x32_bf16 v[180:183], v[52:55], a[212:215], v[180:183]
    s_and_b32 s100, s79, 31
    s_lshr_b32 s101, s79, 5
    ds_read_b64_tr_b16 v[50:51], v12 offset:50176
    v_mfma_f32_16x16x32_bf16 v[212:215], v[52:55], a[216:219], v[212:215]
    s_sub_u32 s101, s101, 4
    s_and_b32 s101, s101, 31
    v_lshrrev_b32 v121, 3, v2
    v_mfma_f32_16x16x32_bf16 v[244:247], v[52:55], a[220:223], v[244:247]
    s_waitcnt lgkmcnt(12)
    v_mfma_f32_16x16x32_bf16 v[152:155], v[56:59], a[208:211], v[152:155]
    ds_read_b64_tr_b16 v[52:53], v13 offset:49152
    v_and_b32 v120, 4, v121
    v_mfma_f32_16x16x32_bf16 v[184:187], v[56:59], a[212:215], v[184:187]
    ds_read_b64_tr_b16 v[54:55], v13 offset:50176
    v_and_b32 v122, 2, v121
    v_mfma_f32_16x16x32_bf16 v[216:219], v[56:59], a[216:219], v[216:219]
    v_lshl_add_u32 v120, v122, 3, v120
    v_and_b32 v122, 1, v121
    v_mfma_f32_16x16x32_bf16 v[248:251], v[56:59], a[220:223], v[248:251]
    s_waitcnt lgkmcnt(12)
    v_mfma_f32_16x16x32_bf16 v[156:159], v[60:63], a[208:211], v[156:159]
    ds_read_b64_tr_b16 v[56:57], v14 offset:49152
    v_lshl_add_u32 v120, v122, 1, v120
    v_mfma_f32_16x16x32_bf16 v[188:191], v[60:63], a[212:215], v[188:191]
    ds_read_b64_tr_b16 v[58:59], v14 offset:50176
    v_mul_u32_u24 v120, 3584, v120
    v_mfma_f32_16x16x32_bf16 v[220:223], v[60:63], a[216:219], v[220:223]
    v_and_b32 v122, 7, v2
    v_lshl_add_u32 v120, v122, 4, v120
    v_mfma_f32_16x16x32_bf16 v[252:255], v[60:63], a[220:223], v[252:255]
    s_waitcnt vmcnt(32) lgkmcnt(12)
    v_mfma_f32_16x16x32_bf16 v[128:131], v[32:35], a[224:227], v[128:131]
    s_waitcnt vmcnt(30)
    ds_read_b64_tr_b16 v[60:61], v15 offset:49152
    v_lshlrev_b32 v121, 13, v121
    v_mfma_f32_16x16x32_bf16 v[160:163], v[32:35], a[228:231], v[160:163]
    s_waitcnt vmcnt(28)
    ds_read_b64_tr_b16 v[62:63], v15 offset:50176
    v_lshl_add_u32 v121, v122, 4, v121
    v_mfma_f32_16x16x32_bf16 v[192:195], v[32:35], a[232:235], v[192:195]
    s_waitcnt vmcnt(26)
    v_mfma_f32_16x16x32_bf16 v[224:227], v[32:35], a[236:239], v[224:227]
    s_waitcnt lgkmcnt(12)
    v_mfma_f32_16x16x32_bf16 v[132:135], v[36:39], a[224:227], v[132:135]
    s_lshr_b32 s79, s100, 1
    s_lshl_b32 s79, s79, 2
    ds_read_b64_tr_b16 v[32:33], v8 offset:57344
    v_mfma_f32_16x16x32_bf16 v[164:167], v[36:39], a[228:231], v[164:167]
    s_and_b32 s100, s100, 1
    s_add_u32 s79, s79, s100
    ds_read_b64_tr_b16 v[34:35], v8 offset:58368
    v_mfma_f32_16x16x32_bf16 v[196:199], v[36:39], a[232:235], v[196:199]
    s_mul_i32 s79, s79, 28672
    s_lshl_b32 s100, s101, 7
    s_add_u32 s79, s79, s100
    v_mfma_f32_16x16x32_bf16 v[228:231], v[36:39], a[236:239], v[228:231]
    s_waitcnt lgkmcnt(12)
    v_mfma_f32_16x16x32_bf16 v[136:139], v[40:43], a[224:227], v[136:139]
    s_cmp_lt_u32 s101, 28
    s_cselect_b32 s79, s79, 2147479552
    ds_read_b64_tr_b16 v[36:37], v9 offset:57344
    v_mfma_f32_16x16x32_bf16 v[168:171], v[40:43], a[228:231], v[168:171]
    s_waitcnt lgkmcnt(11)
    ds_read_b64_tr_b16 v[38:39], v9 offset:58368
    v_mfma_f32_16x16x32_bf16 v[200:203], v[40:43], a[232:235], v[200:203]
    buffer_load_dwordx4 a[0:3], v120, s[40:43], s79 offen
    v_mfma_f32_16x16x32_bf16 v[232:235], v[40:43], a[236:239], v[232:235]
    buffer_load_dwordx4 a[4:7], v120, s[40:43], s79 offen offset:3584
    v_mfma_f32_16x16x32_bf16 v[140:143], v[44:47], a[224:227], v[140:143]
    ds_read_b64_tr_b16 v[40:41], v10 offset:57344
    v_mfma_f32_16x16x32_bf16 v[172:175], v[44:47], a[228:231], v[172:175]
    s_waitcnt lgkmcnt(11)
    ds_read_b64_tr_b16 v[42:43], v10 offset:58368
    v_mfma_f32_16x16x32_bf16 v[204:207], v[44:47], a[232:235], v[204:207]
    buffer_load_dwordx4 a[8:11], v120, s[44:47], s79 offen
    v_mfma_f32_16x16x32_bf16 v[236:239], v[44:47], a[236:239], v[236:239]
    buffer_load_dwordx4 a[12:15], v120, s[44:47], s79 offen offset:3584
    v_mfma_f32_16x16x32_bf16 v[144:147], v[48:51], a[224:227], v[144:147]
    s_lshl_b32 s79, s101, 16
    s_lshl_b32 s100, s3, 11
    ds_read_b64_tr_b16 v[44:45], v11 offset:57344
    v_mfma_f32_16x16x32_bf16 v[176:179], v[48:51], a[228:231], v[176:179]
    s_add_u32 s79, s79, s100
    s_lshl_b32 s100, s4, 7
    ds_read_b64_tr_b16 v[46:47], v11 offset:58368
    v_mfma_f32_16x16x32_bf16 v[208:211], v[48:51], a[232:235], v[208:211]
    s_waitcnt lgkmcnt(12)
    s_add_u32 s79, s79, s100
    v_mfma_f32_16x16x32_bf16 v[240:243], v[48:51], a[236:239], v[240:243]
    buffer_load_dwordx4 a[16:19], v121, s[48:51], s79 offen
    v_mfma_f32_16x16x32_bf16 v[148:151], v[52:55], a[224:227], v[148:151]
    ds_read_b64_tr_b16 v[48:49], v12 offset:57344
    v_mfma_f32_16x16x32_bf16 v[180:183], v[52:55], a[228:231], v[180:183]
    ds_read_b64_tr_b16 v[50:51], v12 offset:58368
    v_mfma_f32_16x16x32_bf16 v[212:215], v[52:55], a[232:235], v[212:215]
    buffer_load_dwordx4 a[20:23], v121, s[48:51], s79 offen offset:1024
    v_mfma_f32_16x16x32_bf16 v[244:247], v[52:55], a[236:239], v[244:247]
    s_waitcnt lgkmcnt(12)
    v_mfma_f32_16x16x32_bf16 v[152:155], v[56:59], a[224:227], v[152:155]
    ds_read_b64_tr_b16 v[52:53], v13 offset:57344
    v_lshrrev_b32 v121, 1, v2
    v_mfma_f32_16x16x32_bf16 v[184:187], v[56:59], a[228:231], v[184:187]
    ds_read_b64_tr_b16 v[54:55], v13 offset:58368
    v_and_b32 v121, 15, v121
    v_mfma_f32_16x16x32_bf16 v[216:219], v[56:59], a[232:235], v[216:219]
    v_lshlrev_b32 v121, 10, v121
    v_and_b32 v122, 1, v2
    v_mfma_f32_16x16x32_bf16 v[248:251], v[56:59], a[236:239], v[248:251]
    s_waitcnt lgkmcnt(12)
    v_mfma_f32_16x16x32_bf16 v[156:159], v[60:63], a[224:227], v[156:159]
    ds_read_b64_tr_b16 v[56:57], v14 offset:57344
    v_lshl_add_u32 v121, v122, 7, v121
    v_mfma_f32_16x16x32_bf16 v[188:191], v[60:63], a[228:231], v[188:191]
    s_lshl_b32 s79, s6, 2
    s_add_u32 s79, s79, s3
    ds_read_b64_tr_b16 v[58:59], v14 offset:58368
    v_mfma_f32_16x16x32_bf16 v[220:223], v[60:63], a[232:235], v[220:223]
    s_waitcnt vmcnt(30) lgkmcnt(12)
    s_lshl_b32 s79, s79, 14
    v_mfma_f32_16x16x32_bf16 v[252:255], v[60:63], a[236:239], v[252:255]
    buffer_load_dword a60, v121, s[28:31], s79 offen
    v_mfma_f32_16x16x32_bf16 v[128:131], v[32:35], a[240:243], v[128:131]
    s_waitcnt vmcnt(29)
    ds_read_b64_tr_b16 v[60:61], v15 offset:57344
    v_mfma_f32_16x16x32_bf16 v[160:163], v[32:35], a[244:247], v[160:163]
    s_waitcnt vmcnt(26)
    ds_read_b64_tr_b16 v[62:63], v15 offset:58368
    v_mfma_f32_16x16x32_bf16 v[192:195], v[32:35], a[248:251], v[192:195]
    s_waitcnt vmcnt(24)
    v_mfma_f32_16x16x32_bf16 v[224:227], v[32:35], a[252:255], v[224:227]
    s_waitcnt lgkmcnt(12)
    v_mfma_f32_16x16x32_bf16 v[132:135], v[36:39], a[240:243], v[132:135]
    v_mfma_f32_16x16x32_bf16 v[164:167], v[36:39], a[244:247], v[164:167]
    v_mfma_f32_16x16x32_bf16 v[196:199], v[36:39], a[248:251], v[196:199]
    v_mfma_f32_16x16x32_bf16 v[228:231], v[36:39], a[252:255], v[228:231]
    s_waitcnt lgkmcnt(10)
    v_mfma_f32_16x16x32_bf16 v[136:139], v[40:43], a[240:243], v[136:139]
    v_mfma_f32_16x16x32_bf16 v[168:171], v[40:43], a[244:247], v[168:171]
    v_mfma_f32_16x16x32_bf16 v[200:203], v[40:43], a[248:251], v[200:203]
    s_waitcnt lgkmcnt(0)
    s_barrier
    v_mfma_f32_16x16x32_bf16 v[232:235], v[40:43], a[252:255], v[232:235]
    v_mfma_f32_16x16x32_bf16 v[140:143], v[44:47], a[240:243], v[140:143]
    v_mfma_f32_16x16x32_bf16 v[172:175], v[44:47], a[244:247], v[172:175]
    v_mfma_f32_16x16x32_bf16 v[204:207], v[44:47], a[248:251], v[204:207]
    v_mfma_f32_16x16x32_bf16 v[236:239], v[44:47], a[252:255], v[236:239]
    v_mfma_f32_16x16x32_bf16 v[144:147], v[48:51], a[240:243], v[144:147]
    v_mfma_f32_16x16x32_bf16 v[176:179], v[48:51], a[244:247], v[176:179]
    v_mfma_f32_16x16x32_bf16 v[208:211], v[48:51], a[248:251], v[208:211]
    v_mfma_f32_16x16x32_bf16 v[240:243], v[48:51], a[252:255], v[240:243]
    v_mfma_f32_16x16x32_bf16 v[148:151], v[52:55], a[240:243], v[148:151]
    v_mfma_f32_16x16x32_bf16 v[180:183], v[52:55], a[244:247], v[180:183]
    v_mfma_f32_16x16x32_bf16 v[212:215], v[52:55], a[248:251], v[212:215]
    v_mfma_f32_16x16x32_bf16 v[244:247], v[52:55], a[252:255], v[244:247]
    v_mfma_f32_16x16x32_bf16 v[152:155], v[56:59], a[240:243], v[152:155]
    v_mfma_f32_16x16x32_bf16 v[184:187], v[56:59], a[244:247], v[184:187]
    v_mfma_f32_16x16x32_bf16 v[216:219], v[56:59], a[248:251], v[216:219]
    v_mfma_f32_16x16x32_bf16 v[248:251], v[56:59], a[252:255], v[248:251]
    v_mfma_f32_16x16x32_bf16 v[156:159], v[60:63], a[240:243], v[156:159]
    v_mfma_f32_16x16x32_bf16 v[188:191], v[60:63], a[244:247], v[188:191]
    v_mfma_f32_16x16x32_bf16 v[220:223], v[60:63], a[248:251], v[220:223]
    v_mfma_f32_16x16x32_bf16 v[252:255], v[60:63], a[252:255], v[252:255]
    v_cvt_pk_bf16_f32 v128, v128, v129
    v_cvt_pk_bf16_f32 v129, v130, v131
    v_cvt_pk_bf16_f32 v130, v132, v133
    v_cvt_pk_bf16_f32 v131, v134, v135
    ds_write_b128 v16, v[128:131] offset:0
    v_cvt_pk_bf16_f32 v136, v136, v137
    v_cvt_pk_bf16_f32 v137, v138, v139
    v_cvt_pk_bf16_f32 v138, v140, v141
    v_cvt_pk_bf16_f32 v139, v142, v143
    ds_write_b128 v16, v[136:139] offset:1024
    v_cvt_pk_bf16_f32 v144, v144, v145
    v_cvt_pk_bf16_f32 v145, v146, v147
    v_cvt_pk_bf16_f32 v146, v148, v149
    v_cvt_pk_bf16_f32 v147, v150, v151
    ds_write_b128 v16, v[144:147] offset:2048
    v_cvt_pk_bf16_f32 v152, v152, v153
    v_cvt_pk_bf16_f32 v153, v154, v155
    v_cvt_pk_bf16_f32 v154, v156, v157
    v_cvt_pk_bf16_f32 v155, v158, v159
    ds_write_b128 v16, v[152:155] offset:3072
    v_cvt_pk_bf16_f32 v160, v160, v161
    v_cvt_pk_bf16_f32 v161, v162, v163
    v_cvt_pk_bf16_f32 v162, v164, v165
    v_cvt_pk_bf16_f32 v163, v166, v167
    ds_write_b128 v16, v[160:163] offset:4096
    v_cvt_pk_bf16_f32 v168, v168, v169
    v_cvt_pk_bf16_f32 v169, v170, v171
    v_cvt_pk_bf16_f32 v170, v172, v173
    v_cvt_pk_bf16_f32 v171, v174, v175
    ds_write_b128 v16, v[168:171] offset:5120
    v_cvt_pk_bf16_f32 v176, v176, v177
    v_cvt_pk_bf16_f32 v177, v178, v179
    v_cvt_pk_bf16_f32 v178, v180, v181
    v_cvt_pk_bf16_f32 v179, v182, v183
    ds_write_b128 v16, v[176:179] offset:6144
    v_cvt_pk_bf16_f32 v184, v184, v185
    v_cvt_pk_bf16_f32 v185, v186, v187
    v_cvt_pk_bf16_f32 v186, v188, v189
    v_cvt_pk_bf16_f32 v187, v190, v191
    ds_write_b128 v16, v[184:187] offset:7168
    v_cvt_pk_bf16_f32 v192, v192, v193
    v_cvt_pk_bf16_f32 v193, v194, v195
    v_cvt_pk_bf16_f32 v194, v196, v197
    v_cvt_pk_bf16_f32 v195, v198, v199
    ds_write_b128 v16, v[192:195] offset:32768
    v_cvt_pk_bf16_f32 v200, v200, v201
    v_cvt_pk_bf16_f32 v201, v202, v203
    v_cvt_pk_bf16_f32 v202, v204, v205
    v_cvt_pk_bf16_f32 v203, v206, v207
    ds_write_b128 v16, v[200:203] offset:33792
    v_cvt_pk_bf16_f32 v208, v208, v209
    v_cvt_pk_bf16_f32 v209, v210, v211
    v_cvt_pk_bf16_f32 v210, v212, v213
    v_cvt_pk_bf16_f32 v211, v214, v215
    ds_write_b128 v16, v[208:211] offset:34816
    v_cvt_pk_bf16_f32 v216, v216, v217
    v_cvt_pk_bf16_f32 v217, v218, v219
    v_cvt_pk_bf16_f32 v218, v220, v221
    v_cvt_pk_bf16_f32 v219, v222, v223
    ds_write_b128 v16, v[216:219] offset:35840
    v_cvt_pk_bf16_f32 v224, v224, v225
    v_cvt_pk_bf16_f32 v225, v226, v227
    v_cvt_pk_bf16_f32 v226, v228, v229
    v_cvt_pk_bf16_f32 v227, v230, v231
    ds_write_b128 v16, v[224:227] offset:36864
    v_cvt_pk_bf16_f32 v232, v232, v233
    v_cvt_pk_bf16_f32 v233, v234, v235
    v_cvt_pk_bf16_f32 v234, v236, v237
    v_cvt_pk_bf16_f32 v235, v238, v239
    ds_write_b128 v16, v[232:235] offset:37888
    v_cvt_pk_bf16_f32 v240, v240, v241
    v_cvt_pk_bf16_f32 v241, v242, v243
    v_cvt_pk_bf16_f32 v242, v244, v245
    v_cvt_pk_bf16_f32 v243, v246, v247
    ds_write_b128 v16, v[240:243] offset:38912
    v_cvt_pk_bf16_f32 v248, v248, v249
    v_cvt_pk_bf16_f32 v249, v250, v251
    v_cvt_pk_bf16_f32 v250, v252, v253
    v_cvt_pk_bf16_f32 v251, v254, v255
    ds_write_b128 v16, v[248:251] offset:39936
    v_add_u32 v15, 4096, v1
    s_waitcnt vmcnt(23) lgkmcnt(0)
    s_barrier
    ds_read_b128 a[64:67], v17 offset:0
    ds_read_b128 a[128:131], v18 offset:0
    ds_read_b128 a[68:71], v17 offset:1024
    ds_read_b128 a[132:135], v18 offset:1024
    ds_read_b128 a[72:75], v17 offset:2048
    ds_read_b128 a[136:139], v18 offset:2048
    ds_read_b128 a[76:79], v17 offset:3072
    ds_read_b128 a[140:143], v18 offset:3072
    ds_read_b128 a[144:147], v18 offset:4096
    ds_read_b128 a[148:151], v18 offset:5120
    ds_read_b128 a[152:155], v18 offset:6144
    ds_read_b128 a[156:159], v18 offset:7168
    ds_read_b128 a[80:83], v17 offset:4096
    ds_read_b128 a[84:87], v17 offset:5120
    ds_read_b128 a[88:91], v17 offset:6144
    ds_read_b128 a[92:95], v17 offset:7168
    ds_read_b128 a[96:99], v17 offset:8192
    ds_read_b128 a[100:103], v17 offset:9216
    ds_read_b128 a[104:107], v17 offset:10240
    ds_read_b128 a[108:111], v17 offset:11264
    ds_read_b128 a[112:115], v17 offset:12288
    ds_read_b128 a[116:119], v17 offset:13312
    ds_read_b128 a[120:123], v17 offset:14336
    ds_read_b128 a[124:127], v17 offset:15360
    ds_read_b128 a[192:195], v17 offset:32768
    ds_read_b128 a[196:199], v17 offset:33792
    ds_read_b128 a[200:203], v17 offset:34816
    ds_read_b128 a[204:207], v17 offset:35840
    ds_read_b128 a[208:211], v17 offset:36864
    ds_read_b128 a[212:215], v17 offset:37888
    ds_read_b128 a[216:219], v17 offset:38912
    ds_read_b128 a[220:223], v17 offset:39936
    ds_read_b128 a[224:227], v17 offset:40960
    ds_read_b128 a[228:231], v17 offset:41984
    ds_read_b128 a[232:235], v17 offset:43008
    ds_read_b128 a[236:239], v17 offset:44032
    ds_read_b128 a[240:243], v17 offset:45056
    ds_read_b128 a[244:247], v17 offset:46080
    ds_read_b128 a[248:251], v17 offset:47104
    ds_read_b128 a[252:255], v17 offset:48128
    v_lshrrev_b32 v17, 4, v2
    v_lshlrev_b32 v17, 15, v17
    v_and_b32 v14, 255, v1
    v_add_u32 v17, v17, v14
L_t1_start:
    s_waitcnt lgkmcnt(15)
    v_mfma_f32_16x16x32_bf16 v[96:99], a[128:131], a[64:67], v[96:99]
    s_add_u32 s19, s82, 32768
    s_sub_u32 s82, s12, s13
    s_sub_u32 s82, s82, 1
    v_mfma_f32_16x16x32_bf16 v[96:99], a[132:135], a[68:71], v[96:99]
    s_cmp_gt_u32 s12, s13
    s_cselect_b32 s82, s82, s12
    s_lshl_b32 s82, s82, 16
    s_add_u32 s82, s82, s81
    v_mfma_f32_16x16x32_bf16 v[96:99], a[136:139], a[72:75], v[96:99]
    s_cmp_ge_u32 s12, 17
    s_cselect_b32 s82, 2147471360, s82
    s_add_u32 s12, s12, 1
    s_sub_u32 s14, s60, 1
    v_mfma_f32_16x16x32_bf16 v[96:99], a[140:143], a[76:79], v[96:99]
    v_mfma_f32_16x16x32_bf16 v[100:103], a[144:147], a[64:67], v[100:103]
    v_mfma_f32_16x16x32_bf16 v[100:103], a[148:151], a[68:71], v[100:103]
    v_mfma_f32_16x16x32_bf16 v[100:103], a[152:155], a[72:75], v[100:103]
    v_mfma_f32_16x16x32_bf16 v[100:103], a[156:159], a[76:79], v[100:103]
    v_mfma_f32_16x16x32_bf16 v[104:107], a[128:131], a[80:83], v[104:107]
    s_nop 2
    v_exp_f32 v96, v96
    v_mfma_f32_16x16x32_bf16 v[104:107], a[132:135], a[84:87], v[104:107]
    v_exp_f32 v97, v97
    v_mfma_f32_16x16x32_bf16 v[104:107], a[136:139], a[88:91], v[104:107]
    v_exp_f32 v98, v98
    v_mfma_f32_16x16x32_bf16 v[104:107], a[140:143], a[92:95], v[104:107]
    v_exp_f32 v99, v99
    v_mfma_f32_16x16x32_bf16 v[108:111], a[144:147], a[80:83], v[108:111]
    v_exp_f32 v100, v100
    v_mfma_f32_16x16x32_bf16 v[108:111], a[148:151], a[84:87], v[108:111]
    v_exp_f32 v101, v101
    v_mfma_f32_16x16x32_bf16 v[108:111], a[152:155], a[88:91], v[108:111]
    v_exp_f32 v102, v102
    v_mfma_f32_16x16x32_bf16 v[108:111], a[156:159], a[92:95], v[108:111]
    v_exp_f32 v103, v103
    v_mfma_f32_16x16x32_bf16 v[112:115], a[128:131], a[96:99], v[72:75]
    v_exp_f32 v104, v104
    v_mfma_f32_16x16x32_bf16 v[112:115], a[132:135], a[100:103], v[112:115]
    v_exp_f32 v105, v105
    v_mfma_f32_16x16x32_bf16 v[112:115], a[136:139], a[104:107], v[112:115]
    v_exp_f32 v106, v106
    v_mfma_f32_16x16x32_bf16 v[112:115], a[140:143], a[108:111], v[112:115]
    v_exp_f32 v107, v107
    v_mfma_f32_16x16x32_bf16 v[120:123], a[128:131], a[112:115], v[76:79]
    v_exp_f32 v108, v108
    v_mfma_f32_16x16x32_bf16 v[120:123], a[132:135], a[116:119], v[120:123]
    v_exp_f32 v109, v109
    v_mfma_f32_16x16x32_bf16 v[120:123], a[136:139], a[120:123], v[120:123]
    v_exp_f32 v110, v110
    v_mfma_f32_16x16x32_bf16 v[120:123], a[140:143], a[124:127], v[120:123]
    v_exp_f32 v111, v111
    v_mfma_f32_16x16x32_bf16 v[116:119], a[144:147], a[96:99], v[72:75]
    ds_read_b128 a[128:131], v18 offset:16384
    v_cvt_pk_bf16_f32 v48, v96, v97
    v_mfma_f32_16x16x32_bf16 v[116:119], a[148:151], a[100:103], v[116:119]
    ds_read_b128 a[132:135], v18 offset:17408
    v_cvt_pk_bf16_f32 v49, v98, v99
    v_mfma_f32_16x16x32_bf16 v[116:119], a[152:155], a[104:107], v[116:119]
    ds_read_b128 a[136:139], v18 offset:18432
    v_cvt_pk_bf16_f32 v50, v100, v101
    v_mfma_f32_16x16x32_bf16 v[116:119], a[156:159], a[108:111], v[116:119]
    ds_read_b128 a[140:143], v18 offset:19456
    v_cvt_pk_bf16_f32 v51, v102, v103
    v_mfma_f32_16x16x32_bf16 v[124:127], a[144:147], a[112:115], v[76:79]
    ds_read_b128 a[144:147], v18 offset:20480
    v_cvt_pk_bf16_f32 v52, v104, v105
    v_mfma_f32_16x16x32_bf16 v[124:127], a[148:151], a[116:119], v[124:127]
    ds_read_b128 a[148:151], v18 offset:21504
    v_cvt_pk_bf16_f32 v53, v106, v107
    v_mfma_f32_16x16x32_bf16 v[124:127], a[152:155], a[120:123], v[124:127]
    ds_read_b128 a[152:155], v18 offset:22528
    v_cvt_pk_bf16_f32 v54, v108, v109
    v_mfma_f32_16x16x32_bf16 v[124:127], a[156:159], a[124:127], v[124:127]
    ds_read_b128 a[156:159], v18 offset:23552
    v_cvt_pk_bf16_f32 v55, v110, v111
    v_xor_b32 v18, 196608, v18
    s_waitcnt vmcnt(7) lgkmcnt(0)
    s_barrier
    s_cmp_eq_u32 s60, 0
    s_cbranch_scc1 L_t1_zero
    v_mfma_f32_16x16x32_bf16 v[96:99], a[128:131], a[64:67], v[64:67]
    s_add_u32 m0, s15, 0
    ds_read_b128 a[160:163], v19 offset:0
    v_mfma_f32_16x16x32_bf16 v[96:99], a[132:135], a[68:71], v[96:99]
    ds_read_b128 a[164:167], v19 offset:1024
    v_mfma_f32_16x16x32_bf16 v[96:99], a[136:139], a[72:75], v[96:99]
    v_exp_f32 v112, v112
    v_mfma_f32_16x16x32_bf16 v[96:99], a[140:143], a[76:79], v[96:99]
    buffer_load_dwordx4 v1, s[8:11], s82 offen offset:0 lds
    v_mfma_f32_16x16x32_bf16 v[104:107], a[128:131], a[80:83], v[68:71]
    v_exp_f32 v113, v113
    v_mfma_f32_16x16x32_bf16 v[104:107], a[132:135], a[84:87], v[104:107]
    ds_read_b128 a[168:171], v19 offset:2048
    v_cvt_pk_bf16_f32 v56, v112, v113
    v_mfma_f32_16x16x32_bf16 v[104:107], a[136:139], a[88:91], v[104:107]
    v_exp_f32 v114, v114
    v_mfma_f32_16x16x32_bf16 v[104:107], a[140:143], a[92:95], v[104:107]
    buffer_load_dwordx4 v1, s[8:11], s82 offen offset:1024 lds
    v_mfma_f32_16x16x32_bf16 v[100:103], a[144:147], a[64:67], v[64:67]
    v_exp_f32 v115, v115
    v_mfma_f32_16x16x32_bf16 v[100:103], a[148:151], a[68:71], v[100:103]
    ds_read_b128 a[172:175], v19 offset:3072
    v_cvt_pk_bf16_f32 v57, v114, v115
    v_mfma_f32_16x16x32_bf16 v[100:103], a[152:155], a[72:75], v[100:103]
    v_exp_f32 v116, v116
    v_mfma_f32_16x16x32_bf16 v[100:103], a[156:159], a[76:79], v[100:103]
    buffer_load_dwordx4 v1, s[8:11], s82 offen offset:2048 lds
    v_mfma_f32_16x16x32_bf16 v[108:111], a[144:147], a[80:83], v[68:71]
    v_exp_f32 v117, v117
    v_mfma_f32_16x16x32_bf16 v[108:111], a[148:151], a[84:87], v[108:111]
    ds_read_b128 a[176:179], v20 offset:4096
    v_cvt_pk_bf16_f32 v58, v116, v117
    v_mfma_f32_16x16x32_bf16 v[108:111], a[152:155], a[88:91], v[108:111]
    v_exp_f32 v118, v118
    v_mfma_f32_16x16x32_bf16 v[108:111], a[156:159], a[92:95], v[108:111]
    buffer_load_dwordx4 v1, s[8:11], s82 offen offset:3072 lds
    v_mfma_f32_16x16x32_bf16 v[32:35], v[28:31], v[48:51], 0
    s_add_u32 m0, s15, 4096
    v_exp_f32 v119, v119
    v_mfma_f32_16x16x32_bf16 v[36:39], v[28:31], v[52:55], 0
    s_waitcnt lgkmcnt(4)
    ds_read_b128 a[180:183], v20 offset:5120
    v_cvt_pk_bf16_f32 v59, v118, v119
    v_mfma_f32_16x16x32_bf16 v[128:131], a[160:163], v[48:51], 0
    v_exp_f32 v120, v120
    v_mfma_f32_16x16x32_bf16 v[160:163], a[160:163], v[52:55], 0
    s_waitcnt lgkmcnt(4)
    v_mfma_f32_16x16x32_bf16 v[132:135], a[164:167], v[48:51], 0
    v_exp_f32 v121, v121
    v_mfma_f32_16x16x32_bf16 v[164:167], a[164:167], v[52:55], 0
    s_waitcnt lgkmcnt(3)
    ds_read_b128 a[184:187], v20 offset:6144
    v_cvt_pk_bf16_f32 v60, v120, v121
    v_mfma_f32_16x16x32_bf16 v[136:139], a[168:171], v[48:51], 0
    s_waitcnt lgkmcnt(3)
    v_exp_f32 v122, v122
    v_mfma_f32_16x16x32_bf16 v[168:171], a[168:171], v[52:55], 0
    buffer_load_dwordx4 v15, s[8:11], s82 offen offset:0 lds
    v_mfma_f32_16x16x32_bf16 v[140:143], a[172:175], v[48:51], 0
    v_exp_f32 v123, v123
    v_mfma_f32_16x16x32_bf16 v[172:175], a[172:175], v[52:55], 0
    s_waitcnt lgkmcnt(2)
    ds_read_b128 a[188:191], v20 offset:7168
    v_cvt_pk_bf16_f32 v61, v122, v123
    v_mfma_f32_16x16x32_bf16 v[144:147], a[176:179], v[48:51], 0
    s_waitcnt lgkmcnt(2)
    v_exp_f32 v124, v124
    v_mfma_f32_16x16x32_bf16 v[176:179], a[176:179], v[52:55], 0
    buffer_load_dwordx4 v15, s[8:11], s82 offen offset:1024 lds
    v_mfma_f32_16x16x32_bf16 v[148:151], a[180:183], v[48:51], 0
    v_exp_f32 v125, v125
    v_mfma_f32_16x16x32_bf16 v[180:183], a[180:183], v[52:55], 0
    s_waitcnt lgkmcnt(1)
    v_cvt_pk_bf16_f32 v62, v124, v125
    v_mfma_f32_16x16x32_bf16 v[152:155], a[184:187], v[48:51], 0
    s_waitcnt lgkmcnt(0)
    v_exp_f32 v126, v126
    v_mfma_f32_16x16x32_bf16 v[184:187], a[184:187], v[52:55], 0
    buffer_load_dwordx4 v15, s[8:11], s82 offen offset:2048 lds
    v_mfma_f32_16x16x32_bf16 v[156:159], a[188:191], v[48:51], 0
    v_exp_f32 v127, v127
    v_mfma_f32_16x16x32_bf16 v[188:191], a[188:191], v[52:55], 0
    v_cvt_pk_bf16_f32 v63, v126, v127
    v_mfma_f32_16x16x32_bf16 v[112:115], a[128:131], a[96:99], v[72:75]
    v_mfma_f32_16x16x32_bf16 v[112:115], a[132:135], a[100:103], v[112:115]
    v_mfma_f32_16x16x32_bf16 v[112:115], a[136:139], a[104:107], v[112:115]
    v_exp_f32 v96, v96
    v_mfma_f32_16x16x32_bf16 v[112:115], a[140:143], a[108:111], v[112:115]
    buffer_load_dwordx4 v15, s[8:11], s82 offen offset:3072 lds
    v_mfma_f32_16x16x32_bf16 v[120:123], a[128:131], a[112:115], v[76:79]
    s_xor_b32 s15, s15, 196608
    v_exp_f32 v97, v97
    v_mfma_f32_16x16x32_bf16 v[120:123], a[132:135], a[116:119], v[120:123]
    s_add_u32 m0, s16, 0
    ds_read_b128 a[128:131], v18 offset:0
    v_cvt_pk_bf16_f32 v48, v96, v97
    v_mfma_f32_16x16x32_bf16 v[120:123], a[136:139], a[120:123], v[120:123]
    v_exp_f32 v98, v98
    v_mfma_f32_16x16x32_bf16 v[120:123], a[140:143], a[124:127], v[120:123]
    buffer_load_dwordx4 v1, s[8:11], s19 offen offset:0 lds
    v_mfma_f32_16x16x32_bf16 v[116:119], a[144:147], a[96:99], v[72:75]
    v_exp_f32 v99, v99
    v_mfma_f32_16x16x32_bf16 v[116:119], a[148:151], a[100:103], v[116:119]
    ds_read_b128 a[132:135], v18 offset:1024
    v_cvt_pk_bf16_f32 v49, v98, v99
    v_mfma_f32_16x16x32_bf16 v[116:119], a[152:155], a[104:107], v[116:119]
    v_exp_f32 v100, v100
    v_mfma_f32_16x16x32_bf16 v[116:119], a[156:159], a[108:111], v[116:119]
    buffer_load_dwordx4 v1, s[8:11], s19 offen offset:1024 lds
    v_mfma_f32_16x16x32_bf16 v[124:127], a[144:147], a[112:115], v[76:79]
    v_exp_f32 v101, v101
    v_mfma_f32_16x16x32_bf16 v[124:127], a[148:151], a[116:119], v[124:127]
    ds_read_b128 a[136:139], v18 offset:2048
    v_cvt_pk_bf16_f32 v50, v100, v101
    v_mfma_f32_16x16x32_bf16 v[124:127], a[152:155], a[120:123], v[124:127]
    v_exp_f32 v102, v102
    v_mfma_f32_16x16x32_bf16 v[124:127], a[156:159], a[124:127], v[124:127]
    buffer_load_dwordx4 v1, s[8:11], s19 offen offset:2048 lds
    v_mfma_f32_16x16x32_bf16 v[40:43], v[28:31], v[56:59], 0
    v_exp_f32 v103, v103
    v_mfma_f32_16x16x32_bf16 v[44:47], v[28:31], v[60:63], 0
    ds_read_b128 a[140:143], v18 offset:3072
    v_cvt_pk_bf16_f32 v51, v102, v103
    v_mfma_f32_16x16x32_bf16 v[192:195], a[160:163], v[56:59], 0
    v_exp_f32 v104, v104
    v_mfma_f32_16x16x32_bf16 v[224:227], a[160:163], v[60:63], 0
    v_mfma_f32_16x16x32_bf16 v[196:199], a[164:167], v[56:59], 0
    v_exp_f32 v105, v105
    v_mfma_f32_16x16x32_bf16 v[228:231], a[164:167], v[60:63], 0
    ds_read_b128 a[144:147], v18 offset:4096
    v_cvt_pk_bf16_f32 v52, v104, v105
    v_mfma_f32_16x16x32_bf16 v[200:203], a[168:171], v[56:59], 0
    v_exp_f32 v106, v106
    v_mfma_f32_16x16x32_bf16 v[232:235], a[168:171], v[60:63], 0
    buffer_load_dwordx4 v1, s[8:11], s19 offen offset:3072 lds
    v_mfma_f32_16x16x32_bf16 v[204:207], a[172:175], v[56:59], 0
    s_add_u32 m0, s16, 4096
    v_exp_f32 v107, v107
    v_mfma_f32_16x16x32_bf16 v[236:239], a[172:175], v[60:63], 0
    ds_read_b128 a[148:151], v18 offset:5120
    v_cvt_pk_bf16_f32 v53, v106, v107
    v_mfma_f32_16x16x32_bf16 v[208:211], a[176:179], v[56:59], 0
    v_exp_f32 v108, v108
    v_mfma_f32_16x16x32_bf16 v[240:243], a[176:179], v[60:63], 0
    buffer_load_dwordx4 v15, s[8:11], s19 offen offset:0 lds
    v_mfma_f32_16x16x32_bf16 v[212:215], a[180:183], v[56:59], 0
    v_exp_f32 v109, v109
    v_mfma_f32_16x16x32_bf16 v[244:247], a[180:183], v[60:63], 0
    ds_read_b128 a[152:155], v18 offset:6144
    v_cvt_pk_bf16_f32 v54, v108, v109
    v_mfma_f32_16x16x32_bf16 v[216:219], a[184:187], v[56:59], 0
    v_exp_f32 v110, v110
    v_mfma_f32_16x16x32_bf16 v[248:251], a[184:187], v[60:63], 0
    buffer_load_dwordx4 v15, s[8:11], s19 offen offset:1024 lds
    v_mfma_f32_16x16x32_bf16 v[220:223], a[188:191], v[56:59], 0
    v_exp_f32 v111, v111
    v_mfma_f32_16x16x32_bf16 v[252:255], a[188:191], v[60:63], 0
    ds_read_b128 a[156:159], v18 offset:7168
    v_cvt_pk_bf16_f32 v55, v110, v111
    s_cmp_eq_u32 s14, 0
    s_cbranch_scc1 L_t1_diag
.p2align 3
L_t1_loop:
    s_waitcnt lgkmcnt(7)
    v_mfma_f32_16x16x32_bf16 v[96:99], a[128:131], a[64:67], v[64:67]
    s_waitcnt lgkmcnt(6)
    ds_read_b128 a[160:163], v19 offset:16384
    v_mfma_f32_16x16x32_bf16 v[96:99], a[132:135], a[68:71], v[96:99]
    s_waitcnt lgkmcnt(6)
    ds_read_b128 a[164:167], v19 offset:17408
    v_mfma_f32_16x16x32_bf16 v[96:99], a[136:139], a[72:75], v[96:99]
    s_waitcnt lgkmcnt(6)
    v_exp_f32 v112, v112
    v_mfma_f32_16x16x32_bf16 v[96:99], a[140:143], a[76:79], v[96:99]
    buffer_load_dwordx4 v15, s[8:11], s19 offen offset:2048 lds
    v_mfma_f32_16x16x32_bf16 v[104:107], a[128:131], a[80:83], v[68:71]
    v_exp_f32 v113, v113
    v_mfma_f32_16x16x32_bf16 v[104:107], a[132:135], a[84:87], v[104:107]
    ds_read_b128 a[168:171], v19 offset:18432
    v_cvt_pk_bf16_f32 v56, v112, v113
    v_mfma_f32_16x16x32_bf16 v[104:107], a[136:139], a[88:91], v[104:107]
    s_waitcnt lgkmcnt(6)
    v_exp_f32 v114, v114
    v_mfma_f32_16x16x32_bf16 v[104:107], a[140:143], a[92:95], v[104:107]
    buffer_load_dwordx4 v15, s[8:11], s19 offen offset:3072 lds
    v_mfma_f32_16x16x32_bf16 v[100:103], a[144:147], a[64:67], v[64:67]
    s_waitcnt lgkmcnt(5)
    s_xor_b32 s16, s16, 98304
    v_exp_f32 v115, v115
    v_mfma_f32_16x16x32_bf16 v[100:103], a[148:151], a[68:71], v[100:103]
    s_waitcnt lgkmcnt(4)
    ds_read_b128 a[172:175], v19 offset:19456
    v_cvt_pk_bf16_f32 v57, v114, v115
    v_mfma_f32_16x16x32_bf16 v[100:103], a[152:155], a[72:75], v[100:103]
    s_waitcnt lgkmcnt(4)
    v_exp_f32 v116, v116
    v_mfma_f32_16x16x32_bf16 v[100:103], a[156:159], a[76:79], v[100:103]
    v_mfma_f32_16x16x32_bf16 v[108:111], a[144:147], a[80:83], v[68:71]
    v_exp_f32 v117, v117
    v_mfma_f32_16x16x32_bf16 v[108:111], a[148:151], a[84:87], v[108:111]
    ds_read_b128 a[176:179], v20 offset:20480
    v_cvt_pk_bf16_f32 v58, v116, v117
    v_mfma_f32_16x16x32_bf16 v[108:111], a[152:155], a[88:91], v[108:111]
    v_exp_f32 v118, v118
    v_mfma_f32_16x16x32_bf16 v[108:111], a[156:159], a[92:95], v[108:111]
    v_mfma_f32_16x16x32_bf16 v[32:35], v[28:31], v[48:51], v[32:35]
    v_exp_f32 v119, v119
    v_mfma_f32_16x16x32_bf16 v[36:39], v[28:31], v[52:55], v[36:39]
    s_waitcnt lgkmcnt(4)
    ds_read_b128 a[180:183], v20 offset:21504
    v_cvt_pk_bf16_f32 v59, v118, v119
    v_mfma_f32_16x16x32_bf16 v[128:131], a[160:163], v[48:51], v[128:131]
    v_exp_f32 v120, v120
    v_mfma_f32_16x16x32_bf16 v[160:163], a[160:163], v[52:55], v[160:163]
    s_waitcnt lgkmcnt(4)
    v_mfma_f32_16x16x32_bf16 v[132:135], a[164:167], v[48:51], v[132:135]
    v_exp_f32 v121, v121
    v_mfma_f32_16x16x32_bf16 v[164:167], a[164:167], v[52:55], v[164:167]
    s_waitcnt lgkmcnt(3)
    ds_read_b128 a[184:187], v20 offset:22528
    v_cvt_pk_bf16_f32 v60, v120, v121
    v_mfma_f32_16x16x32_bf16 v[136:139], a[168:171], v[48:51], v[136:139]
    v_exp_f32 v122, v122
    v_mfma_f32_16x16x32_bf16 v[168:171], a[168:171], v[52:55], v[168:171]
    s_waitcnt lgkmcnt(3)
    v_mfma_f32_16x16x32_bf16 v[140:143], a[172:175], v[48:51], v[140:143]
    v_exp_f32 v123, v123
    v_mfma_f32_16x16x32_bf16 v[172:175], a[172:175], v[52:55], v[172:175]
    s_waitcnt lgkmcnt(2)
    ds_read_b128 a[188:191], v20 offset:23552
    v_cvt_pk_bf16_f32 v61, v122, v123
    v_mfma_f32_16x16x32_bf16 v[144:147], a[176:179], v[48:51], v[144:147]
    v_exp_f32 v124, v124
    v_mfma_f32_16x16x32_bf16 v[176:179], a[176:179], v[52:55], v[176:179]
    s_waitcnt lgkmcnt(2)
    v_mfma_f32_16x16x32_bf16 v[148:151], a[180:183], v[48:51], v[148:151]
    v_exp_f32 v125, v125
    v_mfma_f32_16x16x32_bf16 v[180:183], a[180:183], v[52:55], v[180:183]
    s_waitcnt lgkmcnt(1)
    v_cvt_pk_bf16_f32 v62, v124, v125
    v_xor_b32 v19, 98304, v19
    v_mfma_f32_16x16x32_bf16 v[152:155], a[184:187], v[48:51], v[152:155]
    v_exp_f32 v126, v126
    v_mfma_f32_16x16x32_bf16 v[184:187], a[184:187], v[52:55], v[184:187]
    s_waitcnt lgkmcnt(0)
    v_xor_b32 v20, 98304, v20
    v_mfma_f32_16x16x32_bf16 v[156:159], a[188:191], v[48:51], v[156:159]
    v_exp_f32 v127, v127
    v_mfma_f32_16x16x32_bf16 v[188:191], a[188:191], v[52:55], v[188:191]
    v_cvt_pk_bf16_f32 v63, v126, v127
    v_mfma_f32_16x16x32_bf16 v[112:115], a[128:131], a[96:99], v[72:75]
    v_exp_f32 v96, v96
    v_mfma_f32_16x16x32_bf16 v[112:115], a[132:135], a[100:103], v[112:115]
    v_mfma_f32_16x16x32_bf16 v[112:115], a[136:139], a[104:107], v[112:115]
    v_exp_f32 v97, v97
    v_mfma_f32_16x16x32_bf16 v[112:115], a[140:143], a[108:111], v[112:115]
    v_cvt_pk_bf16_f32 v48, v96, v97
    v_mfma_f32_16x16x32_bf16 v[120:123], a[128:131], a[112:115], v[76:79]
    v_exp_f32 v98, v98
    v_mfma_f32_16x16x32_bf16 v[120:123], a[132:135], a[116:119], v[120:123]
    v_mfma_f32_16x16x32_bf16 v[120:123], a[136:139], a[120:123], v[120:123]
    v_exp_f32 v99, v99
    v_mfma_f32_16x16x32_bf16 v[120:123], a[140:143], a[124:127], v[120:123]
    v_mfma_f32_16x16x32_bf16 v[116:119], a[144:147], a[96:99], v[72:75]
    v_exp_f32 v100, v100
    v_mfma_f32_16x16x32_bf16 v[116:119], a[148:151], a[100:103], v[116:119]
    ds_read_b128 a[128:131], v18 offset:16384
    v_cvt_pk_bf16_f32 v49, v98, v99
    v_mfma_f32_16x16x32_bf16 v[116:119], a[152:155], a[104:107], v[116:119]
    s_add_u32 s19, s82, 32768
    v_exp_f32 v101, v101
    v_mfma_f32_16x16x32_bf16 v[116:119], a[156:159], a[108:111], v[116:119]
    s_sub_u32 s82, s12, s13
    ds_read_b128 a[132:135], v18 offset:17408
    v_cvt_pk_bf16_f32 v50, v100, v101
    v_mfma_f32_16x16x32_bf16 v[124:127], a[144:147], a[112:115], v[76:79]
    s_sub_u32 s82, s82, 1
    v_exp_f32 v102, v102
    v_mfma_f32_16x16x32_bf16 v[124:127], a[148:151], a[116:119], v[124:127]
    s_cmp_gt_u32 s12, s13
    s_cselect_b32 s82, s82, s12
    s_lshl_b32 s82, s82, 16
    ds_read_b128 a[136:139], v18 offset:18432
    v_mfma_f32_16x16x32_bf16 v[124:127], a[152:155], a[120:123], v[124:127]
    s_add_u32 s82, s82, s81
    v_exp_f32 v103, v103
    v_mfma_f32_16x16x32_bf16 v[124:127], a[156:159], a[124:127], v[124:127]
    s_cmp_ge_u32 s12, 17
    s_cselect_b32 s82, 2147471360, s82
    ds_read_b128 a[140:143], v18 offset:19456
    v_cvt_pk_bf16_f32 v51, v102, v103
    v_mfma_f32_16x16x32_bf16 v[40:43], v[28:31], v[56:59], v[40:43]
    s_add_u32 s12, s12, 1
    v_exp_f32 v104, v104
    v_mfma_f32_16x16x32_bf16 v[44:47], v[28:31], v[60:63], v[44:47]
    ds_read_b128 a[144:147], v18 offset:20480
    v_mfma_f32_16x16x32_bf16 v[192:195], a[160:163], v[56:59], v[192:195]
    v_exp_f32 v105, v105
    v_mfma_f32_16x16x32_bf16 v[224:227], a[160:163], v[60:63], v[224:227]
    ds_read_b128 a[148:151], v18 offset:21504
    v_cvt_pk_bf16_f32 v52, v104, v105
    v_mfma_f32_16x16x32_bf16 v[196:199], a[164:167], v[56:59], v[196:199]
    v_exp_f32 v106, v106
    v_mfma_f32_16x16x32_bf16 v[228:231], a[164:167], v[60:63], v[228:231]
    ds_read_b128 a[152:155], v18 offset:22528
    v_mfma_f32_16x16x32_bf16 v[200:203], a[168:171], v[56:59], v[200:203]
    v_exp_f32 v107, v107
    v_mfma_f32_16x16x32_bf16 v[232:235], a[168:171], v[60:63], v[232:235]
    ds_read_b128 a[156:159], v18 offset:23552
    v_cvt_pk_bf16_f32 v53, v106, v107
    v_mfma_f32_16x16x32_bf16 v[204:207], a[172:175], v[56:59], v[204:207]
    v_exp_f32 v108, v108
    v_mfma_f32_16x16x32_bf16 v[236:239], a[172:175], v[60:63], v[236:239]
    v_mfma_f32_16x16x32_bf16 v[208:211], a[176:179], v[56:59], v[208:211]
    v_exp_f32 v109, v109
    v_mfma_f32_16x16x32_bf16 v[240:243], a[176:179], v[60:63], v[240:243]
    v_cvt_pk_bf16_f32 v54, v108, v109
    v_xor_b32 v18, 196608, v18
    v_mfma_f32_16x16x32_bf16 v[212:215], a[180:183], v[56:59], v[212:215]
    v_exp_f32 v110, v110
    v_mfma_f32_16x16x32_bf16 v[244:247], a[180:183], v[60:63], v[244:247]
    v_mfma_f32_16x16x32_bf16 v[216:219], a[184:187], v[56:59], v[216:219]
    v_exp_f32 v111, v111
    v_mfma_f32_16x16x32_bf16 v[248:251], a[184:187], v[60:63], v[248:251]
    v_cvt_pk_bf16_f32 v55, v110, v111
    v_mfma_f32_16x16x32_bf16 v[220:223], a[188:191], v[56:59], v[220:223]
    v_mfma_f32_16x16x32_bf16 v[252:255], a[188:191], v[60:63], v[252:255]
    s_waitcnt vmcnt(0) lgkmcnt(0)
    s_barrier
    v_mfma_f32_16x16x32_bf16 v[96:99], a[128:131], a[64:67], v[64:67]
    s_add_u32 m0, s15, 0
    ds_read_b128 a[160:163], v19 offset:0
    v_mfma_f32_16x16x32_bf16 v[96:99], a[132:135], a[68:71], v[96:99]
    ds_read_b128 a[164:167], v19 offset:1024
    v_mfma_f32_16x16x32_bf16 v[96:99], a[136:139], a[72:75], v[96:99]
    v_exp_f32 v112, v112
    v_mfma_f32_16x16x32_bf16 v[96:99], a[140:143], a[76:79], v[96:99]
    buffer_load_dwordx4 v1, s[8:11], s82 offen offset:0 lds
    v_mfma_f32_16x16x32_bf16 v[104:107], a[128:131], a[80:83], v[68:71]
    v_exp_f32 v113, v113
    v_mfma_f32_16x16x32_bf16 v[104:107], a[132:135], a[84:87], v[104:107]
    ds_read_b128 a[168:171], v19 offset:2048
    v_cvt_pk_bf16_f32 v56, v112, v113
    v_mfma_f32_16x16x32_bf16 v[104:107], a[136:139], a[88:91], v[104:107]
    v_exp_f32 v114, v114
    v_mfma_f32_16x16x32_bf16 v[104:107], a[140:143], a[92:95], v[104:107]
    buffer_load_dwordx4 v1, s[8:11], s82 offen offset:1024 lds
    v_mfma_f32_16x16x32_bf16 v[100:103], a[144:147], a[64:67], v[64:67]
    v_exp_f32 v115, v115
    v_mfma_f32_16x16x32_bf16 v[100:103], a[148:151], a[68:71], v[100:103]
    ds_read_b128 a[172:175], v19 offset:3072
    v_cvt_pk_bf16_f32 v57, v114, v115
    v_mfma_f32_16x16x32_bf16 v[100:103], a[152:155], a[72:75], v[100:103]
    v_exp_f32 v116, v116
    v_mfma_f32_16x16x32_bf16 v[100:103], a[156:159], a[76:79], v[100:103]
    buffer_load_dwordx4 v1, s[8:11], s82 offen offset:2048 lds
    v_mfma_f32_16x16x32_bf16 v[108:111], a[144:147], a[80:83], v[68:71]
    v_exp_f32 v117, v117
    v_mfma_f32_16x16x32_bf16 v[108:111], a[148:151], a[84:87], v[108:111]
    ds_read_b128 a[176:179], v20 offset:4096
    v_cvt_pk_bf16_f32 v58, v116, v117
    v_mfma_f32_16x16x32_bf16 v[108:111], a[152:155], a[88:91], v[108:111]
    v_exp_f32 v118, v118
    v_mfma_f32_16x16x32_bf16 v[108:111], a[156:159], a[92:95], v[108:111]
    buffer_load_dwordx4 v1, s[8:11], s82 offen offset:3072 lds
    v_mfma_f32_16x16x32_bf16 v[32:35], v[28:31], v[48:51], v[32:35]
    s_add_u32 m0, s15, 4096
    v_exp_f32 v119, v119
    v_mfma_f32_16x16x32_bf16 v[36:39], v[28:31], v[52:55], v[36:39]
    s_waitcnt lgkmcnt(4)
    ds_read_b128 a[180:183], v20 offset:5120
    v_cvt_pk_bf16_f32 v59, v118, v119
    v_mfma_f32_16x16x32_bf16 v[128:131], a[160:163], v[48:51], v[128:131]
    v_exp_f32 v120, v120
    v_mfma_f32_16x16x32_bf16 v[160:163], a[160:163], v[52:55], v[160:163]
    s_waitcnt lgkmcnt(4)
    v_mfma_f32_16x16x32_bf16 v[132:135], a[164:167], v[48:51], v[132:135]
    v_exp_f32 v121, v121
    v_mfma_f32_16x16x32_bf16 v[164:167], a[164:167], v[52:55], v[164:167]
    s_waitcnt lgkmcnt(3)
    ds_read_b128 a[184:187], v20 offset:6144
    v_cvt_pk_bf16_f32 v60, v120, v121
    v_mfma_f32_16x16x32_bf16 v[136:139], a[168:171], v[48:51], v[136:139]
    s_waitcnt lgkmcnt(3)
    v_exp_f32 v122, v122
    v_mfma_f32_16x16x32_bf16 v[168:171], a[168:171], v[52:55], v[168:171]
    buffer_load_dwordx4 v15, s[8:11], s82 offen offset:0 lds
    v_mfma_f32_16x16x32_bf16 v[140:143], a[172:175], v[48:51], v[140:143]
    v_exp_f32 v123, v123
    v_mfma_f32_16x16x32_bf16 v[172:175], a[172:175], v[52:55], v[172:175]
    s_waitcnt lgkmcnt(2)
    ds_read_b128 a[188:191], v20 offset:7168
    v_cvt_pk_bf16_f32 v61, v122, v123
    v_mfma_f32_16x16x32_bf16 v[144:147], a[176:179], v[48:51], v[144:147]
    s_waitcnt lgkmcnt(2)
    v_exp_f32 v124, v124
    v_mfma_f32_16x16x32_bf16 v[176:179], a[176:179], v[52:55], v[176:179]
    buffer_load_dwordx4 v15, s[8:11], s82 offen offset:1024 lds
    v_mfma_f32_16x16x32_bf16 v[148:151], a[180:183], v[48:51], v[148:151]
    v_exp_f32 v125, v125
    v_mfma_f32_16x16x32_bf16 v[180:183], a[180:183], v[52:55], v[180:183]
    s_waitcnt lgkmcnt(1)
    v_cvt_pk_bf16_f32 v62, v124, v125
    v_mfma_f32_16x16x32_bf16 v[152:155], a[184:187], v[48:51], v[152:155]
    s_waitcnt lgkmcnt(0)
    v_exp_f32 v126, v126
    v_mfma_f32_16x16x32_bf16 v[184:187], a[184:187], v[52:55], v[184:187]
    buffer_load_dwordx4 v15, s[8:11], s82 offen offset:2048 lds
    v_mfma_f32_16x16x32_bf16 v[156:159], a[188:191], v[48:51], v[156:159]
    v_exp_f32 v127, v127
    v_mfma_f32_16x16x32_bf16 v[188:191], a[188:191], v[52:55], v[188:191]
    v_cvt_pk_bf16_f32 v63, v126, v127
    v_mfma_f32_16x16x32_bf16 v[112:115], a[128:131], a[96:99], v[72:75]
    v_mfma_f32_16x16x32_bf16 v[112:115], a[132:135], a[100:103], v[112:115]
    v_mfma_f32_16x16x32_bf16 v[112:115], a[136:139], a[104:107], v[112:115]
    v_exp_f32 v96, v96
    v_mfma_f32_16x16x32_bf16 v[112:115], a[140:143], a[108:111], v[112:115]
    buffer_load_dwordx4 v15, s[8:11], s82 offen offset:3072 lds
    v_mfma_f32_16x16x32_bf16 v[120:123], a[128:131], a[112:115], v[76:79]
    s_xor_b32 s15, s15, 196608
    v_exp_f32 v97, v97
    v_mfma_f32_16x16x32_bf16 v[120:123], a[132:135], a[116:119], v[120:123]
    s_add_u32 m0, s16, 0
    ds_read_b128 a[128:131], v18 offset:0
    v_cvt_pk_bf16_f32 v48, v96, v97
    v_mfma_f32_16x16x32_bf16 v[120:123], a[136:139], a[120:123], v[120:123]
    v_exp_f32 v98, v98
    v_mfma_f32_16x16x32_bf16 v[120:123], a[140:143], a[124:127], v[120:123]
    buffer_load_dwordx4 v1, s[8:11], s19 offen offset:0 lds
    v_mfma_f32_16x16x32_bf16 v[116:119], a[144:147], a[96:99], v[72:75]
    v_exp_f32 v99, v99
    v_mfma_f32_16x16x32_bf16 v[116:119], a[148:151], a[100:103], v[116:119]
    ds_read_b128 a[132:135], v18 offset:1024
    v_cvt_pk_bf16_f32 v49, v98, v99
    v_mfma_f32_16x16x32_bf16 v[116:119], a[152:155], a[104:107], v[116:119]
    v_exp_f32 v100, v100
    v_mfma_f32_16x16x32_bf16 v[116:119], a[156:159], a[108:111], v[116:119]
    buffer_load_dwordx4 v1, s[8:11], s19 offen offset:1024 lds
    v_mfma_f32_16x16x32_bf16 v[124:127], a[144:147], a[112:115], v[76:79]
    v_exp_f32 v101, v101
    v_mfma_f32_16x16x32_bf16 v[124:127], a[148:151], a[116:119], v[124:127]
    ds_read_b128 a[136:139], v18 offset:2048
    v_cvt_pk_bf16_f32 v50, v100, v101
    v_mfma_f32_16x16x32_bf16 v[124:127], a[152:155], a[120:123], v[124:127]
    v_exp_f32 v102, v102
    v_mfma_f32_16x16x32_bf16 v[124:127], a[156:159], a[124:127], v[124:127]
    buffer_load_dwordx4 v1, s[8:11], s19 offen offset:2048 lds
    v_mfma_f32_16x16x32_bf16 v[40:43], v[28:31], v[56:59], v[40:43]
    v_exp_f32 v103, v103
    v_mfma_f32_16x16x32_bf16 v[44:47], v[28:31], v[60:63], v[44:47]
    ds_read_b128 a[140:143], v18 offset:3072
    v_cvt_pk_bf16_f32 v51, v102, v103
    v_mfma_f32_16x16x32_bf16 v[192:195], a[160:163], v[56:59], v[192:195]
    v_exp_f32 v104, v104
    v_mfma_f32_16x16x32_bf16 v[224:227], a[160:163], v[60:63], v[224:227]
    v_mfma_f32_16x16x32_bf16 v[196:199], a[164:167], v[56:59], v[196:199]
    v_exp_f32 v105, v105
    v_mfma_f32_16x16x32_bf16 v[228:231], a[164:167], v[60:63], v[228:231]
    ds_read_b128 a[144:147], v18 offset:4096
    v_cvt_pk_bf16_f32 v52, v104, v105
    v_mfma_f32_16x16x32_bf16 v[200:203], a[168:171], v[56:59], v[200:203]
    v_exp_f32 v106, v106
    v_mfma_f32_16x16x32_bf16 v[232:235], a[168:171], v[60:63], v[232:235]
    buffer_load_dwordx4 v1, s[8:11], s19 offen offset:3072 lds
    v_mfma_f32_16x16x32_bf16 v[204:207], a[172:175], v[56:59], v[204:207]
    s_add_u32 m0, s16, 4096
    v_exp_f32 v107, v107
    v_mfma_f32_16x16x32_bf16 v[236:239], a[172:175], v[60:63], v[236:239]
    ds_read_b128 a[148:151], v18 offset:5120
    v_cvt_pk_bf16_f32 v53, v106, v107
    v_mfma_f32_16x16x32_bf16 v[208:211], a[176:179], v[56:59], v[208:211]
    s_sub_u32 s14, s14, 1
    v_exp_f32 v108, v108
    v_mfma_f32_16x16x32_bf16 v[240:243], a[176:179], v[60:63], v[240:243]
    buffer_load_dwordx4 v15, s[8:11], s19 offen offset:0 lds
    v_mfma_f32_16x16x32_bf16 v[212:215], a[180:183], v[56:59], v[212:215]
    v_exp_f32 v109, v109
    v_mfma_f32_16x16x32_bf16 v[244:247], a[180:183], v[60:63], v[244:247]
    ds_read_b128 a[152:155], v18 offset:6144
    v_cvt_pk_bf16_f32 v54, v108, v109
    v_mfma_f32_16x16x32_bf16 v[216:219], a[184:187], v[56:59], v[216:219]
    v_exp_f32 v110, v110
    v_mfma_f32_16x16x32_bf16 v[248:251], a[184:187], v[60:63], v[248:251]
    buffer_load_dwordx4 v15, s[8:11], s19 offen offset:1024 lds
    v_mfma_f32_16x16x32_bf16 v[220:223], a[188:191], v[56:59], v[220:223]
    v_exp_f32 v111, v111
    v_mfma_f32_16x16x32_bf16 v[252:255], a[188:191], v[60:63], v[252:255]
    ds_read_b128 a[156:159], v18 offset:7168
    v_cvt_pk_bf16_f32 v55, v110, v111
    s_cmp_lg_u32 s14, 0
    s_cbranch_scc1 L_t1_loop
L_t1_diag:
    s_waitcnt lgkmcnt(7)
    v_mfma_f32_16x16x32_bf16 v[96:99], a[128:131], a[64:67], v[80:83]
    s_waitcnt lgkmcnt(6)
    ds_read_b128 a[160:163], v19 offset:16384
    v_mfma_f32_16x16x32_bf16 v[96:99], a[132:135], a[68:71], v[96:99]
    s_waitcnt lgkmcnt(6)
    ds_read_b128 a[164:167], v19 offset:17408
    v_mfma_f32_16x16x32_bf16 v[96:99], a[136:139], a[72:75], v[96:99]
    s_waitcnt lgkmcnt(6)
    v_exp_f32 v112, v112
    v_mfma_f32_16x16x32_bf16 v[96:99], a[140:143], a[76:79], v[96:99]
    buffer_load_dwordx4 v15, s[8:11], s19 offen offset:2048 lds
    v_mfma_f32_16x16x32_bf16 v[104:107], a[128:131], a[80:83], v[88:91]
    v_exp_f32 v113, v113
    v_mfma_f32_16x16x32_bf16 v[104:107], a[132:135], a[84:87], v[104:107]
    ds_read_b128 a[168:171], v19 offset:18432
    v_cvt_pk_bf16_f32 v56, v112, v113
    v_mfma_f32_16x16x32_bf16 v[104:107], a[136:139], a[88:91], v[104:107]
    s_waitcnt lgkmcnt(6)
    v_exp_f32 v114, v114
    v_mfma_f32_16x16x32_bf16 v[104:107], a[140:143], a[92:95], v[104:107]
    buffer_load_dwordx4 v15, s[8:11], s19 offen offset:3072 lds
    v_mfma_f32_16x16x32_bf16 v[100:103], a[144:147], a[64:67], v[84:87]
    s_waitcnt lgkmcnt(5)
    s_xor_b32 s16, s16, 98304
    v_exp_f32 v115, v115
    v_mfma_f32_16x16x32_bf16 v[100:103], a[148:151], a[68:71], v[100:103]
    s_waitcnt lgkmcnt(4)
    ds_read_b128 a[172:175], v19 offset:19456
    v_cvt_pk_bf16_f32 v57, v114, v115
    v_mfma_f32_16x16x32_bf16 v[100:103], a[152:155], a[72:75], v[100:103]
    s_waitcnt lgkmcnt(4)
    v_exp_f32 v116, v116
    v_mfma_f32_16x16x32_bf16 v[100:103], a[156:159], a[76:79], v[100:103]
    v_mfma_f32_16x16x32_bf16 v[108:111], a[144:147], a[80:83], v[92:95]
    v_exp_f32 v117, v117
    v_mfma_f32_16x16x32_bf16 v[108:111], a[148:151], a[84:87], v[108:111]
    ds_read_b128 a[176:179], v20 offset:20480
    v_cvt_pk_bf16_f32 v58, v116, v117
    v_mfma_f32_16x16x32_bf16 v[108:111], a[152:155], a[88:91], v[108:111]
    v_exp_f32 v118, v118
    v_mfma_f32_16x16x32_bf16 v[108:111], a[156:159], a[92:95], v[108:111]
    v_mfma_f32_16x16x32_bf16 v[32:35], v[28:31], v[48:51], v[32:35]
    v_exp_f32 v119, v119
    v_mfma_f32_16x16x32_bf16 v[36:39], v[28:31], v[52:55], v[36:39]
    s_waitcnt lgkmcnt(4)
    ds_read_b128 a[180:183], v20 offset:21504
    v_cvt_pk_bf16_f32 v59, v118, v119
    v_mfma_f32_16x16x32_bf16 v[128:131], a[160:163], v[48:51], v[128:131]
    v_exp_f32 v120, v120
    v_mfma_f32_16x16x32_bf16 v[160:163], a[160:163], v[52:55], v[160:163]
    s_waitcnt lgkmcnt(4)
    v_add_f32 v80, 0, v22
    v_min_f32 v80, v80, v72
    v_mfma_f32_16x16x32_bf16 v[132:135], a[164:167], v[48:51], v[132:135]
    v_exp_f32 v121, v121
    v_mfma_f32_16x16x32_bf16 v[164:167], a[164:167], v[52:55], v[164:167]
    s_waitcnt lgkmcnt(3)
    ds_read_b128 a[184:187], v20 offset:22528
    v_cvt_pk_bf16_f32 v60, v120, v121
    v_mfma_f32_16x16x32_bf16 v[136:139], a[168:171], v[48:51], v[136:139]
    v_exp_f32 v122, v122
    v_mfma_f32_16x16x32_bf16 v[168:171], a[168:171], v[52:55], v[168:171]
    s_waitcnt lgkmcnt(3)
    v_add_f32 v81, 0xf1800000, v22
    v_min_f32 v81, v81, v73
    v_mfma_f32_16x16x32_bf16 v[140:143], a[172:175], v[48:51], v[140:143]
    v_exp_f32 v123, v123
    v_mfma_f32_16x16x32_bf16 v[172:175], a[172:175], v[52:55], v[172:175]
    s_waitcnt lgkmcnt(2)
    ds_read_b128 a[188:191], v20 offset:23552
    v_cvt_pk_bf16_f32 v61, v122, v123
    v_mfma_f32_16x16x32_bf16 v[144:147], a[176:179], v[48:51], v[144:147]
    v_exp_f32 v124, v124
    v_mfma_f32_16x16x32_bf16 v[176:179], a[176:179], v[52:55], v[176:179]
    s_waitcnt lgkmcnt(2)
    v_add_f32 v82, 0xf2000000, v22
    v_min_f32 v82, v82, v74
    v_mfma_f32_16x16x32_bf16 v[148:151], a[180:183], v[48:51], v[148:151]
    v_exp_f32 v125, v125
    v_mfma_f32_16x16x32_bf16 v[180:183], a[180:183], v[52:55], v[180:183]
    s_waitcnt lgkmcnt(1)
    v_cvt_pk_bf16_f32 v62, v124, v125
    v_xor_b32 v19, 98304, v19
    v_mfma_f32_16x16x32_bf16 v[152:155], a[184:187], v[48:51], v[152:155]
    v_exp_f32 v126, v126
    v_mfma_f32_16x16x32_bf16 v[184:187], a[184:187], v[52:55], v[184:187]
    s_waitcnt lgkmcnt(0)
    v_xor_b32 v20, 98304, v20
    v_add_f32 v83, 0xf2400000, v22
    v_mfma_f32_16x16x32_bf16 v[156:159], a[188:191], v[48:51], v[156:159]
    v_exp_f32 v127, v127
    v_mfma_f32_16x16x32_bf16 v[188:191], a[188:191], v[52:55], v[188:191]
    v_cvt_pk_bf16_f32 v63, v126, v127
    v_min_f32 v83, v83, v75
    v_add_f32 v84, 0xf3800000, v22
    v_min_f32 v84, v84, v72
    v_mfma_f32_16x16x32_bf16 v[112:115], a[128:131], a[96:99], v[72:75]
    v_exp_f32 v96, v96
    v_mfma_f32_16x16x32_bf16 v[112:115], a[132:135], a[100:103], v[112:115]
    v_mfma_f32_16x16x32_bf16 v[112:115], a[136:139], a[104:107], v[112:115]
    v_exp_f32 v97, v97
    v_mfma_f32_16x16x32_bf16 v[112:115], a[140:143], a[108:111], v[112:115]
    v_cvt_pk_bf16_f32 v48, v96, v97
    v_add_f32 v85, 0xf3880000, v22
    v_mfma_f32_16x16x32_bf16 v[120:123], a[128:131], a[112:115], v[76:79]
    v_exp_f32 v98, v98
    v_mfma_f32_16x16x32_bf16 v[120:123], a[132:135], a[116:119], v[120:123]
    v_min_f32 v85, v85, v73
    v_add_f32 v86, 0xf3900000, v22
    v_mfma_f32_16x16x32_bf16 v[120:123], a[136:139], a[120:123], v[120:123]
    v_exp_f32 v99, v99
    v_mfma_f32_16x16x32_bf16 v[120:123], a[140:143], a[124:127], v[120:123]
    v_min_f32 v86, v86, v74
    v_add_f32 v87, 0xf3980000, v22
    v_mfma_f32_16x16x32_bf16 v[116:119], a[144:147], a[96:99], v[72:75]
    v_exp_f32 v100, v100
    v_mfma_f32_16x16x32_bf16 v[116:119], a[148:151], a[100:103], v[116:119]
    ds_read_b128 a[128:131], v18 offset:16384
    v_cvt_pk_bf16_f32 v49, v98, v99
    v_mfma_f32_16x16x32_bf16 v[116:119], a[152:155], a[104:107], v[116:119]
    s_add_u32 s19, s82, 32768
    v_exp_f32 v101, v101
    v_mfma_f32_16x16x32_bf16 v[116:119], a[156:159], a[108:111], v[116:119]
    s_sub_u32 s82, s12, s13
    ds_read_b128 a[132:135], v18 offset:17408
    v_cvt_pk_bf16_f32 v50, v100, v101
    v_mfma_f32_16x16x32_bf16 v[124:127], a[144:147], a[112:115], v[76:79]
    s_sub_u32 s82, s82, 1
    v_exp_f32 v102, v102
    v_mfma_f32_16x16x32_bf16 v[124:127], a[148:151], a[116:119], v[124:127]
    s_cmp_gt_u32 s12, s13
    s_cselect_b32 s82, s82, s12
    s_lshl_b32 s82, s82, 16
    ds_read_b128 a[136:139], v18 offset:18432
    v_mfma_f32_16x16x32_bf16 v[124:127], a[152:155], a[120:123], v[124:127]
    s_add_u32 s82, s82, s81
    v_exp_f32 v103, v103
    v_mfma_f32_16x16x32_bf16 v[124:127], a[156:159], a[124:127], v[124:127]
    s_cmp_ge_u32 s12, 17
    s_cselect_b32 s82, 2147471360, s82
    ds_read_b128 a[140:143], v18 offset:19456
    v_cvt_pk_bf16_f32 v51, v102, v103
    v_mfma_f32_16x16x32_bf16 v[40:43], v[28:31], v[56:59], v[40:43]
    s_add_u32 s12, s12, 1
    v_exp_f32 v104, v104
    v_mfma_f32_16x16x32_bf16 v[44:47], v[28:31], v[60:63], v[44:47]
    ds_read_b128 a[144:147], v18 offset:20480
    v_min_f32 v87, v87, v75
    v_mfma_f32_16x16x32_bf16 v[192:195], a[160:163], v[56:59], v[192:195]
    v_exp_f32 v105, v105
    v_mfma_f32_16x16x32_bf16 v[224:227], a[160:163], v[60:63], v[224:227]
    ds_read_b128 a[148:151], v18 offset:21504
    v_cvt_pk_bf16_f32 v52, v104, v105
    v_mfma_f32_16x16x32_bf16 v[196:199], a[164:167], v[56:59], v[196:199]
    v_exp_f32 v106, v106
    v_mfma_f32_16x16x32_bf16 v[228:231], a[164:167], v[60:63], v[228:231]
    ds_read_b128 a[152:155], v18 offset:22528
    v_add_f32 v88, 0x73800000, v22
    v_mfma_f32_16x16x32_bf16 v[200:203], a[168:171], v[56:59], v[200:203]
    v_exp_f32 v107, v107
    v_mfma_f32_16x16x32_bf16 v[232:235], a[168:171], v[60:63], v[232:235]
    ds_read_b128 a[156:159], v18 offset:23552
    v_cvt_pk_bf16_f32 v53, v106, v107
    v_mfma_f32_16x16x32_bf16 v[204:207], a[172:175], v[56:59], v[204:207]
    v_exp_f32 v108, v108
    v_mfma_f32_16x16x32_bf16 v[236:239], a[172:175], v[60:63], v[236:239]
    v_min_f32 v88, v88, v76
    v_add_f32 v89, 0x73700000, v22
    v_mfma_f32_16x16x32_bf16 v[208:211], a[176:179], v[56:59], v[208:211]
    v_exp_f32 v109, v109
    v_mfma_f32_16x16x32_bf16 v[240:243], a[176:179], v[60:63], v[240:243]
    v_cvt_pk_bf16_f32 v54, v108, v109
    v_xor_b32 v18, 196608, v18
    v_mfma_f32_16x16x32_bf16 v[212:215], a[180:183], v[56:59], v[212:215]
    v_exp_f32 v110, v110
    v_mfma_f32_16x16x32_bf16 v[244:247], a[180:183], v[60:63], v[244:247]
    v_min_f32 v89, v89, v77
    v_add_f32 v90, 0x73600000, v22
    v_mfma_f32_16x16x32_bf16 v[216:219], a[184:187], v[56:59], v[216:219]
    v_exp_f32 v111, v111
    v_mfma_f32_16x16x32_bf16 v[248:251], a[184:187], v[60:63], v[248:251]
    v_cvt_pk_bf16_f32 v55, v110, v111
    v_min_f32 v90, v90, v78
    v_mfma_f32_16x16x32_bf16 v[220:223], a[188:191], v[56:59], v[220:223]
    v_add_f32 v91, 0x73500000, v22
    v_min_f32 v91, v91, v79
    v_mfma_f32_16x16x32_bf16 v[252:255], a[188:191], v[60:63], v[252:255]
    v_add_f32 v92, 0, v22
    v_min_f32 v92, v92, v76
    v_add_f32 v93, 0xf1800000, v22
    v_min_f32 v93, v93, v77
    v_add_f32 v94, 0xf2000000, v22
    v_min_f32 v94, v94, v78
    v_add_f32 v95, 0xf2400000, v22
    v_min_f32 v95, v95, v79
    s_waitcnt vmcnt(0) lgkmcnt(0)
    s_barrier
    v_mfma_f32_16x16x32_bf16 v[96:99], a[128:131], a[96:99], v[80:83]
    s_xor_b32 s100, s16, 8192
    ds_read_b128 a[176:179], v20 offset:4096
    v_lshrrev_b32 v13, 1, v1
    v_mfma_f32_16x16x32_bf16 v[96:99], a[132:135], a[100:103], v[96:99]
    s_add_u32 m0, s15, 0
    ds_read_b128 a[180:183], v20 offset:5120
    v_add_u32 v12, s100, v13
    v_mfma_f32_16x16x32_bf16 v[96:99], a[136:139], a[104:107], v[96:99]
    buffer_load_dwordx4 v1, s[8:11], s82 offen offset:0 lds
    v_exp_f32 v112, v112
    v_mfma_f32_16x16x32_bf16 v[96:99], a[140:143], a[108:111], v[96:99]
    v_exp_f32 v113, v113
    v_mfma_f32_16x16x32_bf16 v[100:103], a[144:147], a[96:99], v[84:87]
    ds_read_b128 a[184:187], v20 offset:6144
    v_cvt_pk_bf16_f32 v56, v112, v113
    v_mfma_f32_16x16x32_bf16 v[100:103], a[148:151], a[100:103], v[100:103]
    v_exp_f32 v114, v114
    v_mfma_f32_16x16x32_bf16 v[100:103], a[152:155], a[104:107], v[100:103]
    buffer_load_dwordx4 v1, s[8:11], s82 offen offset:1024 lds
    v_exp_f32 v115, v115
    v_mfma_f32_16x16x32_bf16 v[100:103], a[156:159], a[108:111], v[100:103]
    ds_read_b128 a[188:191], v20 offset:7168
    v_cvt_pk_bf16_f32 v57, v114, v115
    v_mfma_f32_16x16x32_bf16 v[104:107], a[128:131], a[112:115], v[88:91]
    v_exp_f32 v116, v116
    v_mfma_f32_16x16x32_bf16 v[104:107], a[132:135], a[116:119], v[104:107]
    v_exp_f32 v117, v117
    v_mfma_f32_16x16x32_bf16 v[104:107], a[136:139], a[120:123], v[104:107]
    ds_read_b128 a[160:163], v19 offset:0
    v_cvt_pk_bf16_f32 v58, v116, v117
    v_mfma_f32_16x16x32_bf16 v[104:107], a[140:143], a[124:127], v[104:107]
    buffer_load_dwordx4 v1, s[8:11], s82 offen offset:2048 lds
    v_exp_f32 v118, v118
    v_mfma_f32_16x16x32_bf16 v[108:111], a[144:147], a[112:115], v[92:95]
    v_exp_f32 v119, v119
    v_mfma_f32_16x16x32_bf16 v[108:111], a[148:151], a[116:119], v[108:111]
    ds_read_b128 a[164:167], v19 offset:1024
    v_cvt_pk_bf16_f32 v59, v118, v119
    v_mfma_f32_16x16x32_bf16 v[108:111], a[152:155], a[120:123], v[108:111]
    v_exp_f32 v120, v120
    v_mfma_f32_16x16x32_bf16 v[108:111], a[156:159], a[124:127], v[108:111]
    buffer_load_dwordx4 v1, s[8:11], s82 offen offset:3072 lds
    v_exp_f32 v121, v121
    v_mfma_f32_16x16x32_bf16 v[32:35], v[28:31], v[48:51], v[32:35]
    s_add_u32 m0, s15, 4096
    ds_read_b128 a[168:171], v19 offset:2048
    v_cvt_pk_bf16_f32 v60, v120, v121
    v_mfma_f32_16x16x32_bf16 v[36:39], v[28:31], v[52:55], v[36:39]
    s_waitcnt lgkmcnt(6)
    v_exp_f32 v122, v122
    v_mfma_f32_16x16x32_bf16 v[144:147], a[176:179], v[48:51], v[144:147]
    v_exp_f32 v123, v123
    v_mfma_f32_16x16x32_bf16 v[176:179], a[176:179], v[52:55], v[176:179]
    s_waitcnt lgkmcnt(5)
    ds_read_b128 a[172:175], v19 offset:3072
    v_cvt_pk_bf16_f32 v61, v122, v123
    v_mfma_f32_16x16x32_bf16 v[148:151], a[180:183], v[48:51], v[148:151]
    buffer_load_dwordx4 v15, s[8:11], s82 offen offset:0 lds
    v_exp_f32 v124, v124
    v_mfma_f32_16x16x32_bf16 v[180:183], a[180:183], v[52:55], v[180:183]
    s_waitcnt lgkmcnt(5)
    v_exp_f32 v125, v125
    v_mfma_f32_16x16x32_bf16 v[152:155], a[184:187], v[48:51], v[152:155]
    s_waitcnt lgkmcnt(4)
    v_exp_f32 v126, v126
    v_mfma_f32_16x16x32_bf16 v[184:187], a[184:187], v[52:55], v[184:187]
    buffer_load_dwordx4 v15, s[8:11], s82 offen offset:1024 lds
    v_exp_f32 v127, v127
    v_mfma_f32_16x16x32_bf16 v[156:159], a[188:191], v[48:51], v[156:159]
    ds_write_b128 v16, v[144:147] offset:32768
    v_cvt_pk_bf16_f32 v62, v124, v125
    v_mfma_f32_16x16x32_bf16 v[188:191], a[188:191], v[52:55], v[188:191]
    s_waitcnt lgkmcnt(4)
    v_exp_f32 v96, v96
    v_mfma_f32_16x16x32_bf16 v[128:131], a[160:163], v[48:51], v[128:131]
    v_exp_f32 v97, v97
    v_mfma_f32_16x16x32_bf16 v[160:163], a[160:163], v[52:55], v[160:163]
    s_waitcnt lgkmcnt(3)
    ds_write_b128 v16, v[176:179] offset:33792
    v_cvt_pk_bf16_f32 v63, v126, v127
    v_mfma_f32_16x16x32_bf16 v[132:135], a[164:167], v[48:51], v[132:135]
    s_waitcnt lgkmcnt(3)
    v_exp_f32 v98, v98
    v_mfma_f32_16x16x32_bf16 v[164:167], a[164:167], v[52:55], v[164:167]
    buffer_load_dwordx4 v15, s[8:11], s82 offen offset:2048 lds
    v_exp_f32 v99, v99
    v_mfma_f32_16x16x32_bf16 v[136:139], a[168:171], v[48:51], v[136:139]
    ds_write_b128 v16, v[148:151] offset:34816
    v_mfma_f32_16x16x32_bf16 v[168:171], a[168:171], v[52:55], v[168:171]
    s_waitcnt lgkmcnt(3)
    v_exp_f32 v100, v100
    v_mfma_f32_16x16x32_bf16 v[140:143], a[172:175], v[48:51], v[140:143]
    v_exp_f32 v101, v101
    v_mfma_f32_16x16x32_bf16 v[172:175], a[172:175], v[52:55], v[172:175]
    ds_write_b128 v16, v[180:183] offset:35840
    v_mov_b32 v33, v36
    v_mfma_f32_16x16x32_bf16 v[40:43], v[28:31], v[56:59], v[40:43]
    buffer_load_dwordx4 v15, s[8:11], s82 offen offset:3072 lds
    v_exp_f32 v102, v102
    v_mfma_f32_16x16x32_bf16 v[44:47], v[28:31], v[60:63], v[44:47]
    s_xor_b32 s15, s15, 196608
    v_exp_f32 v103, v103
    v_mfma_f32_16x16x32_bf16 v[208:211], a[176:179], v[56:59], v[208:211]
    ds_write_b128 v16, v[152:155] offset:36864
    v_cvt_pk_bf16_f32 v48, v96, v97
    v_mfma_f32_16x16x32_bf16 v[240:243], a[176:179], v[60:63], v[240:243]
    ds_read_b128 a[176:179], v20 offset:20480
    v_exp_f32 v104, v104
    v_mfma_f32_16x16x32_bf16 v[212:215], a[180:183], v[56:59], v[212:215]
    v_exp_f32 v105, v105
    v_mfma_f32_16x16x32_bf16 v[244:247], a[180:183], v[60:63], v[244:247]
    ds_read_b128 a[180:183], v20 offset:21504
    v_exp_f32 v106, v106
    v_mfma_f32_16x16x32_bf16 v[216:219], a[184:187], v[56:59], v[216:219]
    ds_write_b128 v16, v[184:187] offset:37888
    v_cvt_pk_bf16_f32 v49, v98, v99
    v_mfma_f32_16x16x32_bf16 v[248:251], a[184:187], v[60:63], v[248:251]
    ds_read_b128 a[184:187], v20 offset:22528
    v_exp_f32 v107, v107
    v_mfma_f32_16x16x32_bf16 v[220:223], a[188:191], v[56:59], v[220:223]
    v_exp_f32 v108, v108
    v_mfma_f32_16x16x32_bf16 v[252:255], a[188:191], v[60:63], v[252:255]
    ds_read_b128 a[188:191], v20 offset:23552
    v_exp_f32 v109, v109
    v_mfma_f32_16x16x32_bf16 v[192:195], a[160:163], v[56:59], v[192:195]
    ds_write_b128 v16, v[156:159] offset:38912
    v_cvt_pk_bf16_f32 v50, v100, v101
    v_mfma_f32_16x16x32_bf16 v[224:227], a[160:163], v[60:63], v[224:227]
    ds_read_b128 a[160:163], v19 offset:16384
    v_exp_f32 v110, v110
    v_mfma_f32_16x16x32_bf16 v[196:199], a[164:167], v[56:59], v[196:199]
    v_exp_f32 v111, v111
    v_mfma_f32_16x16x32_bf16 v[228:231], a[164:167], v[60:63], v[228:231]
    ds_read_b128 a[164:167], v19 offset:17408
    v_cvt_pk_bf16_f32 v51, v102, v103
    v_mfma_f32_16x16x32_bf16 v[200:203], a[168:171], v[56:59], v[200:203]
    ds_write_b128 v16, v[188:191] offset:39936
    v_cvt_pk_bf16_f32 v52, v104, v105
    v_mfma_f32_16x16x32_bf16 v[232:235], a[168:171], v[60:63], v[232:235]
    ds_read_b128 a[168:171], v19 offset:18432
    v_cvt_pk_bf16_f32 v53, v106, v107
    v_mfma_f32_16x16x32_bf16 v[204:207], a[172:175], v[56:59], v[204:207]
    v_cvt_pk_bf16_f32 v54, v108, v109
    v_cvt_pk_bf16_f32 v55, v110, v111
    v_mfma_f32_16x16x32_bf16 v[236:239], a[172:175], v[60:63], v[236:239]
    ds_read_b128 a[172:175], v19 offset:19456
    ds_write_b64 v12, v[32:33]
    s_xor_b32 s101, s16, 98304
    v_xor_b32 v12, 8192, v12
    v_add_u32 v9, s101, v1
    v_xor_b32 v8, 8192, v16
    v_xor_b32 v10, 8192, v9
L_t1_join:
    v_xor_b32 v19, 98304, v19
    v_xor_b32 v20, 98304, v20
    s_waitcnt lgkmcnt(0)
    s_barrier
    v_mfma_f32_16x16x32_bf16 v[40:43], v[28:31], v[48:51], v[40:43]
    s_lshl_b32 s100, s60, 20
    s_add_u32 s101, s100, s21
    ds_read_b64 v[120:121], v12
    v_mfma_f32_16x16x32_bf16 v[44:47], v[28:31], v[52:55], v[44:47]
    s_add_u32 s100, s100, s20
    ds_read_b128 v[144:147], v8 offset:32768
    v_lshrrev_b32 v11, 4, v2
    v_mfma_f32_16x16x32_bf16 v[208:211], a[176:179], v[48:51], v[208:211]
    ds_read_b128 v[176:179], v8 offset:33792
    v_lshrrev_b32 v13, 2, v1
    v_mfma_f32_16x16x32_bf16 v[240:243], a[176:179], v[52:55], v[240:243]
    ds_read_b128 v[148:151], v8 offset:34816
    v_add_u32 v13, 32768, v13
    v_mfma_f32_16x16x32_bf16 v[212:215], a[180:183], v[48:51], v[212:215]
    s_xor_b32 s99, s62, 8192
    ds_read_b128 v[180:183], v8 offset:35840
    v_add_u32 v14, s99, v13
    v_mfma_f32_16x16x32_bf16 v[244:247], a[180:183], v[52:55], v[244:247]
    ds_read_b128 v[152:155], v8 offset:36864
    v_cmp_eq_u32 vcc, 1, v11
    v_mfma_f32_16x16x32_bf16 v[216:219], a[184:187], v[48:51], v[216:219]
    ds_read_b128 v[184:187], v8 offset:37888
    s_waitcnt lgkmcnt(6)
    v_add_f32 v112, v120, v32
    v_mfma_f32_16x16x32_bf16 v[248:251], a[184:187], v[52:55], v[248:251]
    ds_read_b128 v[156:159], v8 offset:38912
    v_add_f32 v114, v121, v36
    v_mfma_f32_16x16x32_bf16 v[220:223], a[188:191], v[48:51], v[220:223]
    ds_read_b128 v[188:191], v8 offset:39936
    v_cndmask_b32 v12, v32, v36, vcc
    v_mfma_f32_16x16x32_bf16 v[252:255], a[188:191], v[52:55], v[252:255]
    v_rcp_f32 v112, v112
    v_mfma_f32_16x16x32_bf16 v[192:195], a[160:163], v[48:51], v[192:195]
    v_rcp_f32 v114, v114
    v_mfma_f32_16x16x32_bf16 v[224:227], a[160:163], v[52:55], v[224:227]
    v_cmp_eq_u32 vcc, 2, v11
    v_cmp_eq_u32 s[96:97], 3, v11
    v_mfma_f32_16x16x32_bf16 v[196:199], a[164:167], v[48:51], v[196:199]
    ds_write_b128 v9, v[208:211] offset:0
    v_mfma_f32_16x16x32_bf16 v[228:231], a[164:167], v[52:55], v[228:231]
    v_mfma_f32_16x16x32_bf16 v[200:203], a[168:171], v[48:51], v[200:203]
    ds_write_b128 v9, v[240:243] offset:1024
    v_mfma_f32_16x16x32_bf16 v[232:235], a[168:171], v[52:55], v[232:235]
    v_mfma_f32_16x16x32_bf16 v[204:207], a[172:175], v[48:51], v[204:207]
    ds_write_b128 v9, v[212:215] offset:2048
    v_mfma_f32_16x16x32_bf16 v[236:239], a[172:175], v[52:55], v[236:239]
    v_cndmask_b32 v12, v12, v40, vcc
    v_cndmask_b32 v12, v12, v44, s[96:97]
    ds_write_b128 v9, v[244:247] offset:3072
    s_waitcnt lgkmcnt(11)
    v_pk_add_f32 v[128:129], v[128:129], v[144:145]
    v_pk_add_f32 v[130:131], v[130:131], v[146:147]
    s_waitcnt lgkmcnt(9)
    v_pk_add_f32 v[132:133], v[132:133], v[148:149]
    v_pk_add_f32 v[134:135], v[134:135], v[150:151]
    v_pk_mul_f32 v[128:129], v[128:129], v[112:113] op_sel_hi:[1,0]
    v_pk_mul_f32 v[130:131], v[130:131], v[112:113] op_sel_hi:[1,0]
    v_pk_mul_f32 v[132:133], v[132:133], v[112:113] op_sel_hi:[1,0]
    v_pk_mul_f32 v[134:135], v[134:135], v[112:113] op_sel_hi:[1,0]
    v_cvt_pk_bf16_f32 v128, v128, v129
    v_cvt_pk_bf16_f32 v129, v130, v131
    v_cvt_pk_bf16_f32 v130, v132, v133
    s_add_u32 m0, s16, 0
    ds_write_b128 v9, v[216:219] offset:4096
    v_cvt_pk_bf16_f32 v131, v134, v135
    buffer_store_dwordx4 v[128:131], v1, s[8:11], s100 offen offset:0 sc0 sc1
    s_waitcnt lgkmcnt(8)
    v_pk_add_f32 v[136:137], v[136:137], v[152:153]
    v_pk_add_f32 v[138:139], v[138:139], v[154:155]
    s_waitcnt lgkmcnt(6)
    v_pk_add_f32 v[140:141], v[140:141], v[156:157]
    v_pk_add_f32 v[142:143], v[142:143], v[158:159]
    v_pk_mul_f32 v[136:137], v[136:137], v[112:113] op_sel_hi:[1,0]
    v_pk_mul_f32 v[138:139], v[138:139], v[112:113] op_sel_hi:[1,0]
    v_pk_mul_f32 v[140:141], v[140:141], v[112:113] op_sel_hi:[1,0]
    v_pk_mul_f32 v[142:143], v[142:143], v[112:113] op_sel_hi:[1,0]
    v_cvt_pk_bf16_f32 v136, v136, v137
    buffer_load_dwordx4 v1, s[8:11], s19 offen offset:0 lds
    ds_write_b128 v9, v[248:251] offset:5120
    v_cvt_pk_bf16_f32 v137, v138, v139
    v_cvt_pk_bf16_f32 v138, v140, v141
    v_cvt_pk_bf16_f32 v139, v142, v143
    buffer_store_dwordx4 v[136:139], v1, s[8:11], s100 offen offset:1024 sc0 sc1
    v_pk_add_f32 v[160:161], v[160:161], v[176:177]
    v_pk_add_f32 v[162:163], v[162:163], v[178:179]
    v_pk_add_f32 v[164:165], v[164:165], v[180:181]
    v_pk_add_f32 v[166:167], v[166:167], v[182:183]
    v_pk_mul_f32 v[160:161], v[160:161], v[114:115] op_sel_hi:[1,0]
    v_pk_mul_f32 v[162:163], v[162:163], v[114:115] op_sel_hi:[1,0]
    v_pk_mul_f32 v[164:165], v[164:165], v[114:115] op_sel_hi:[1,0]
    buffer_load_dwordx4 v1, s[8:11], s19 offen offset:1024 lds
    ds_write_b128 v9, v[220:223] offset:6144
    v_pk_mul_f32 v[166:167], v[166:167], v[114:115] op_sel_hi:[1,0]
    v_cvt_pk_bf16_f32 v160, v160, v161
    v_cvt_pk_bf16_f32 v161, v162, v163
    v_cvt_pk_bf16_f32 v162, v164, v165
    v_cvt_pk_bf16_f32 v163, v166, v167
    buffer_store_dwordx4 v[160:163], v15, s[8:11], s100 offen offset:0 sc0 sc1
    v_pk_add_f32 v[168:169], v[168:169], v[184:185]
    v_pk_add_f32 v[170:171], v[170:171], v[186:187]
    s_waitcnt lgkmcnt(7)
    v_pk_add_f32 v[172:173], v[172:173], v[188:189]
    v_pk_add_f32 v[174:175], v[174:175], v[190:191]
    v_pk_mul_f32 v[168:169], v[168:169], v[114:115] op_sel_hi:[1,0]
    buffer_load_dwordx4 v1, s[8:11], s19 offen offset:2048 lds
    ds_write_b128 v9, v[252:255] offset:7168
    v_pk_mul_f32 v[170:171], v[170:171], v[114:115] op_sel_hi:[1,0]
    v_pk_mul_f32 v[172:173], v[172:173], v[114:115] op_sel_hi:[1,0]
    v_pk_mul_f32 v[174:175], v[174:175], v[114:115] op_sel_hi:[1,0]
    v_cvt_pk_bf16_f32 v168, v168, v169
    v_cvt_pk_bf16_f32 v169, v170, v171
    v_cvt_pk_bf16_f32 v170, v172, v173
    v_cvt_pk_bf16_f32 v171, v174, v175
    buffer_store_dwordx4 v[168:171], v15, s[8:11], s100 offen offset:1024 sc0 sc1
    buffer_load_dwordx4 v1, s[8:11], s19 offen offset:3072 lds
    ds_write_b32 v14, v12
    v_and_b32 v14, 4294967103, v13
    v_add_u32 v14, s62, v14
    s_waitcnt lgkmcnt(0)
    s_barrier
    ds_read_b32 v116, v14 offset:128
    ds_read_b32 v118, v14 offset:192
    ds_read_b128 v[208:211], v10 offset:0
    ds_read_b128 v[212:215], v10 offset:2048
    ds_read_b128 v[216:219], v10 offset:4096
    ds_read_b128 v[220:223], v10 offset:6144
    ds_read_b128 v[240:243], v10 offset:1024
    ds_read_b128 v[244:247], v10 offset:3072
    ds_read_b128 v[248:251], v10 offset:5120
    ds_read_b128 v[252:255], v10 offset:7168
    ds_read_b32 v120, v13 offset:0
    ds_read_b32 v121, v13 offset:8192
    ds_read_b32 v122, v13 offset:16384
    ds_read_b32 v123, v13 offset:24576
    s_waitcnt lgkmcnt(13)
    v_add_f32 v116, v116, v40
    s_waitcnt lgkmcnt(12)
    v_add_f32 v118, v118, v44
    v_rcp_f32 v116, v116
    v_rcp_f32 v118, v118
    s_waitcnt lgkmcnt(11)
    v_pk_add_f32 v[192:193], v[192:193], v[208:209]
    v_pk_add_f32 v[194:195], v[194:195], v[210:211]
    s_waitcnt lgkmcnt(10)
    v_pk_add_f32 v[196:197], v[196:197], v[212:213]
    v_pk_add_f32 v[198:199], v[198:199], v[214:215]
    v_pk_mul_f32 v[192:193], v[192:193], v[116:117] op_sel_hi:[1,0]
    v_pk_mul_f32 v[194:195], v[194:195], v[116:117] op_sel_hi:[1,0]
    v_pk_mul_f32 v[196:197], v[196:197], v[116:117] op_sel_hi:[1,0]
    v_pk_mul_f32 v[198:199], v[198:199], v[116:117] op_sel_hi:[1,0]
    v_cvt_pk_bf16_f32 v192, v192, v193
    v_cvt_pk_bf16_f32 v193, v194, v195
    v_cvt_pk_bf16_f32 v194, v196, v197
    v_cvt_pk_bf16_f32 v195, v198, v199
    buffer_store_dwordx4 v[192:195], v1, s[8:11], s101 offen offset:0 sc0 sc1
    s_add_u32 m0, s16, 4096
    s_waitcnt lgkmcnt(9)
    v_pk_add_f32 v[200:201], v[200:201], v[216:217]
    v_pk_add_f32 v[202:203], v[202:203], v[218:219]
    s_waitcnt lgkmcnt(8)
    v_pk_add_f32 v[204:205], v[204:205], v[220:221]
    v_pk_add_f32 v[206:207], v[206:207], v[222:223]
    v_pk_mul_f32 v[200:201], v[200:201], v[116:117] op_sel_hi:[1,0]
    v_pk_mul_f32 v[202:203], v[202:203], v[116:117] op_sel_hi:[1,0]
    v_pk_mul_f32 v[204:205], v[204:205], v[116:117] op_sel_hi:[1,0]
    v_pk_mul_f32 v[206:207], v[206:207], v[116:117] op_sel_hi:[1,0]
    v_cvt_pk_bf16_f32 v200, v200, v201
    v_cvt_pk_bf16_f32 v201, v202, v203
    v_cvt_pk_bf16_f32 v202, v204, v205
    v_cvt_pk_bf16_f32 v203, v206, v207
    buffer_store_dwordx4 v[200:203], v1, s[8:11], s101 offen offset:1024 sc0 sc1
    buffer_load_dwordx4 v15, s[8:11], s19 offen offset:0 lds
    buffer_load_dwordx4 v15, s[8:11], s19 offen offset:1024 lds
    s_waitcnt lgkmcnt(2)
    v_add_f32 v120, v120, v121
    s_waitcnt lgkmcnt(0)
    v_add_f32 v122, v122, v123
    v_min_f32 v124, v120, v122
    v_add_f32 v120, v120, v122
    v_cmp_le_f32 vcc, 0x1f800000, v124
    s_mov_b64 s[96:97], vcc
    v_cmp_ge_f32 vcc, 0x67800000, v120
    s_and_b64 s[96:97], s[96:97], vcc
    s_cmp_eq_u64 s[96:97], -1
    s_cselect_b32 s96, s25, 1
    s_cmp_lg_u32 s96, 0
    s_cbranch_scc1 L_t1_redo
L_t1_safe:
    v_pk_add_f32 v[224:225], v[224:225], v[240:241]
    v_pk_add_f32 v[226:227], v[226:227], v[242:243]
    v_pk_add_f32 v[228:229], v[228:229], v[244:245]
    v_pk_add_f32 v[230:231], v[230:231], v[246:247]
    v_pk_mul_f32 v[224:225], v[224:225], v[118:119] op_sel_hi:[1,0]
    v_pk_mul_f32 v[226:227], v[226:227], v[118:119] op_sel_hi:[1,0]
    v_pk_mul_f32 v[228:229], v[228:229], v[118:119] op_sel_hi:[1,0]
    v_pk_mul_f32 v[230:231], v[230:231], v[118:119] op_sel_hi:[1,0]
    v_cvt_pk_bf16_f32 v224, v224, v225
    v_cvt_pk_bf16_f32 v225, v226, v227
    v_cvt_pk_bf16_f32 v226, v228, v229
    v_cvt_pk_bf16_f32 v227, v230, v231
    buffer_store_dwordx4 v[224:227], v15, s[8:11], s101 offen offset:0 sc0 sc1
    buffer_load_dwordx4 v15, s[8:11], s19 offen offset:2048 lds
    ds_read_b128 a[128:131], v18 offset:0
    ds_read_b128 a[132:135], v18 offset:1024
    ds_read_b128 a[136:139], v18 offset:2048
    ds_read_b128 a[140:143], v18 offset:3072
    v_pk_add_f32 v[232:233], v[232:233], v[248:249]
    v_pk_add_f32 v[234:235], v[234:235], v[250:251]
    v_pk_add_f32 v[236:237], v[236:237], v[252:253]
    v_pk_add_f32 v[238:239], v[238:239], v[254:255]
    v_pk_mul_f32 v[232:233], v[232:233], v[118:119] op_sel_hi:[1,0]
    v_pk_mul_f32 v[234:235], v[234:235], v[118:119] op_sel_hi:[1,0]
    v_pk_mul_f32 v[236:237], v[236:237], v[118:119] op_sel_hi:[1,0]
    v_pk_mul_f32 v[238:239], v[238:239], v[118:119] op_sel_hi:[1,0]
    v_cvt_pk_bf16_f32 v232, v232, v233
    v_cvt_pk_bf16_f32 v233, v234, v235
    v_cvt_pk_bf16_f32 v234, v236, v237
    v_cvt_pk_bf16_f32 v235, v238, v239
    buffer_store_dwordx4 v[232:235], v15, s[8:11], s101 offen offset:1024 sc0 sc1
    buffer_load_dwordx4 v15, s[8:11], s19 offen offset:3072 lds
    s_xor_b32 s16, s16, 98304
    ds_read_b128 a[144:147], v18 offset:4096
    ds_read_b128 a[148:151], v18 offset:5120
    ds_read_b128 a[152:155], v18 offset:6144
    ds_read_b128 a[156:159], v18 offset:7168
L_t2_start:
    s_waitcnt lgkmcnt(7)
    v_mfma_f32_16x16x32_bf16 v[96:99], a[128:131], a[192:195], v[64:67]
    s_waitcnt lgkmcnt(6)
    s_add_u32 s19, s82, 32768
    s_sub_u32 s82, s12, s13
    s_sub_u32 s82, s82, 1
    v_mfma_f32_16x16x32_bf16 v[96:99], a[132:135], a[196:199], v[96:99]
    s_waitcnt lgkmcnt(5)
    s_cmp_gt_u32 s12, s13
    s_cselect_b32 s82, s82, s12
    s_lshl_b32 s82, s82, 16
    s_add_u32 s82, s82, s81
    v_mfma_f32_16x16x32_bf16 v[96:99], a[136:139], a[200:203], v[96:99]
    s_waitcnt lgkmcnt(4)
    s_cmp_ge_u32 s12, 17
    s_cselect_b32 s82, 2147471360, s82
    s_add_u32 s12, s12, 1
    s_sub_u32 s14, s61, 8
    v_mfma_f32_16x16x32_bf16 v[96:99], a[140:143], a[204:207], v[96:99]
    s_waitcnt lgkmcnt(3)
    v_mfma_f32_16x16x32_bf16 v[100:103], a[144:147], a[192:195], v[64:67]
    s_waitcnt lgkmcnt(2)
    v_mfma_f32_16x16x32_bf16 v[100:103], a[148:151], a[196:199], v[100:103]
    s_waitcnt lgkmcnt(1)
    v_mfma_f32_16x16x32_bf16 v[100:103], a[152:155], a[200:203], v[100:103]
    s_waitcnt lgkmcnt(0)
    v_mfma_f32_16x16x32_bf16 v[100:103], a[156:159], a[204:207], v[100:103]
    v_mfma_f32_16x16x32_bf16 v[104:107], a[128:131], a[208:211], v[68:71]
    v_exp_f32 v96, v96
    v_mfma_f32_16x16x32_bf16 v[104:107], a[132:135], a[212:215], v[104:107]
    v_exp_f32 v97, v97
    v_mfma_f32_16x16x32_bf16 v[104:107], a[136:139], a[216:219], v[104:107]
    v_exp_f32 v98, v98
    v_mfma_f32_16x16x32_bf16 v[104:107], a[140:143], a[220:223], v[104:107]
    v_exp_f32 v99, v99
    v_mfma_f32_16x16x32_bf16 v[108:111], a[144:147], a[208:211], v[68:71]
    v_exp_f32 v100, v100
    v_mfma_f32_16x16x32_bf16 v[108:111], a[148:151], a[212:215], v[108:111]
    v_exp_f32 v101, v101
    v_mfma_f32_16x16x32_bf16 v[108:111], a[152:155], a[216:219], v[108:111]
    v_exp_f32 v102, v102
    v_mfma_f32_16x16x32_bf16 v[108:111], a[156:159], a[220:223], v[108:111]
    v_exp_f32 v103, v103
    v_mfma_f32_16x16x32_bf16 v[112:115], a[128:131], a[224:227], v[72:75]
    v_exp_f32 v104, v104
    v_mfma_f32_16x16x32_bf16 v[112:115], a[132:135], a[228:231], v[112:115]
    v_exp_f32 v105, v105
    v_mfma_f32_16x16x32_bf16 v[112:115], a[136:139], a[232:235], v[112:115]
    v_exp_f32 v106, v106
    v_mfma_f32_16x16x32_bf16 v[112:115], a[140:143], a[236:239], v[112:115]
    v_exp_f32 v107, v107
    v_mfma_f32_16x16x32_bf16 v[120:123], a[128:131], a[240:243], v[76:79]
    v_exp_f32 v108, v108
    v_mfma_f32_16x16x32_bf16 v[120:123], a[132:135], a[244:247], v[120:123]
    v_exp_f32 v109, v109
    v_mfma_f32_16x16x32_bf16 v[120:123], a[136:139], a[248:251], v[120:123]
    v_exp_f32 v110, v110
    v_mfma_f32_16x16x32_bf16 v[120:123], a[140:143], a[252:255], v[120:123]
    v_exp_f32 v111, v111
    v_mfma_f32_16x16x32_bf16 v[116:119], a[144:147], a[224:227], v[72:75]
    ds_read_b128 a[128:131], v18 offset:16384
    v_cvt_pk_bf16_f32 v48, v96, v97
    v_mfma_f32_16x16x32_bf16 v[116:119], a[148:151], a[228:231], v[116:119]
    ds_read_b128 a[132:135], v18 offset:17408
    v_cvt_pk_bf16_f32 v49, v98, v99
    v_mfma_f32_16x16x32_bf16 v[116:119], a[152:155], a[232:235], v[116:119]
    ds_read_b128 a[136:139], v18 offset:18432
    v_cvt_pk_bf16_f32 v50, v100, v101
    v_mfma_f32_16x16x32_bf16 v[116:119], a[156:159], a[236:239], v[116:119]
    ds_read_b128 a[140:143], v18 offset:19456
    v_cvt_pk_bf16_f32 v51, v102, v103
    v_mfma_f32_16x16x32_bf16 v[124:127], a[144:147], a[240:243], v[76:79]
    ds_read_b128 a[144:147], v18 offset:20480
    v_cvt_pk_bf16_f32 v52, v104, v105
    v_mfma_f32_16x16x32_bf16 v[124:127], a[148:151], a[244:247], v[124:127]
    ds_read_b128 a[148:151], v18 offset:21504
    v_cvt_pk_bf16_f32 v53, v106, v107
    v_mfma_f32_16x16x32_bf16 v[124:127], a[152:155], a[248:251], v[124:127]
    ds_read_b128 a[152:155], v18 offset:22528
    v_cvt_pk_bf16_f32 v54, v108, v109
    v_mfma_f32_16x16x32_bf16 v[124:127], a[156:159], a[252:255], v[124:127]
    ds_read_b128 a[156:159], v18 offset:23552
    v_cvt_pk_bf16_f32 v55, v110, v111
    v_xor_b32 v18, 196608, v18
    s_waitcnt vmcnt(0) lgkmcnt(0)
    s_barrier
    v_mfma_f32_16x16x32_bf16 v[96:99], a[128:131], a[192:195], v[64:67]
    s_add_u32 m0, s15, 0
    ds_read_b128 a[160:163], v19 offset:0
    v_mfma_f32_16x16x32_bf16 v[96:99], a[132:135], a[196:199], v[96:99]
    ds_read_b128 a[164:167], v19 offset:1024
    v_mfma_f32_16x16x32_bf16 v[96:99], a[136:139], a[200:203], v[96:99]
    v_exp_f32 v112, v112
    v_mfma_f32_16x16x32_bf16 v[96:99], a[140:143], a[204:207], v[96:99]
    buffer_load_dwordx4 v1, s[8:11], s82 offen offset:0 lds
    v_mfma_f32_16x16x32_bf16 v[104:107], a[128:131], a[208:211], v[68:71]
    v_exp_f32 v113, v113
    v_mfma_f32_16x16x32_bf16 v[104:107], a[132:135], a[212:215], v[104:107]
    ds_read_b128 a[168:171], v19 offset:2048
    v_cvt_pk_bf16_f32 v56, v112, v113
    v_mfma_f32_16x16x32_bf16 v[104:107], a[136:139], a[216:219], v[104:107]
    v_exp_f32 v114, v114
    v_mfma_f32_16x16x32_bf16 v[104:107], a[140:143], a[220:223], v[104:107]
    buffer_load_dwordx4 v1, s[8:11], s82 offen offset:1024 lds
    v_mfma_f32_16x16x32_bf16 v[100:103], a[144:147], a[192:195], v[64:67]
    v_exp_f32 v115, v115
    v_mfma_f32_16x16x32_bf16 v[100:103], a[148:151], a[196:199], v[100:103]
    ds_read_b128 a[172:175], v19 offset:3072
    v_cvt_pk_bf16_f32 v57, v114, v115
    v_mfma_f32_16x16x32_bf16 v[100:103], a[152:155], a[200:203], v[100:103]
    v_exp_f32 v116, v116
    v_mfma_f32_16x16x32_bf16 v[100:103], a[156:159], a[204:207], v[100:103]
    buffer_load_dwordx4 v1, s[8:11], s82 offen offset:2048 lds
    v_mfma_f32_16x16x32_bf16 v[108:111], a[144:147], a[208:211], v[68:71]
    v_exp_f32 v117, v117
    v_mfma_f32_16x16x32_bf16 v[108:111], a[148:151], a[212:215], v[108:111]
    ds_read_b128 a[176:179], v20 offset:4096
    v_cvt_pk_bf16_f32 v58, v116, v117
    v_mfma_f32_16x16x32_bf16 v[108:111], a[152:155], a[216:219], v[108:111]
    v_exp_f32 v118, v118
    v_mfma_f32_16x16x32_bf16 v[108:111], a[156:159], a[220:223], v[108:111]
    buffer_load_dwordx4 v1, s[8:11], s82 offen offset:3072 lds
    v_mfma_f32_16x16x32_bf16 v[32:35], v[28:31], v[48:51], 0
    s_add_u32 m0, s15, 4096
    v_exp_f32 v119, v119
    v_mfma_f32_16x16x32_bf16 v[36:39], v[28:31], v[52:55], 0
    s_waitcnt lgkmcnt(4)
    ds_read_b128 a[180:183], v20 offset:5120
    v_cvt_pk_bf16_f32 v59, v118, v119
    v_mfma_f32_16x16x32_bf16 v[128:131], a[160:163], v[48:51], 0
    v_exp_f32 v120, v120
    v_mfma_f32_16x16x32_bf16 v[160:163], a[160:163], v[52:55], 0
    s_waitcnt lgkmcnt(4)
    v_mfma_f32_16x16x32_bf16 v[132:135], a[164:167], v[48:51], 0
    v_exp_f32 v121, v121
    v_mfma_f32_16x16x32_bf16 v[164:167], a[164:167], v[52:55], 0
    s_waitcnt lgkmcnt(3)
    ds_read_b128 a[184:187], v20 offset:6144
    v_cvt_pk_bf16_f32 v60, v120, v121
    v_mfma_f32_16x16x32_bf16 v[136:139], a[168:171], v[48:51], 0
    s_waitcnt lgkmcnt(3)
    v_exp_f32 v122, v122
    v_mfma_f32_16x16x32_bf16 v[168:171], a[168:171], v[52:55], 0
    buffer_load_dwordx4 v15, s[8:11], s82 offen offset:0 lds
    v_mfma_f32_16x16x32_bf16 v[140:143], a[172:175], v[48:51], 0
    v_exp_f32 v123, v123
    v_mfma_f32_16x16x32_bf16 v[172:175], a[172:175], v[52:55], 0
    s_waitcnt lgkmcnt(2)
    ds_read_b128 a[188:191], v20 offset:7168
    v_cvt_pk_bf16_f32 v61, v122, v123
    v_mfma_f32_16x16x32_bf16 v[144:147], a[176:179], v[48:51], 0
    s_waitcnt lgkmcnt(2)
    v_exp_f32 v124, v124
    v_mfma_f32_16x16x32_bf16 v[176:179], a[176:179], v[52:55], 0
    buffer_load_dwordx4 v15, s[8:11], s82 offen offset:1024 lds
    v_mfma_f32_16x16x32_bf16 v[148:151], a[180:183], v[48:51], 0
    v_exp_f32 v125, v125
    v_mfma_f32_16x16x32_bf16 v[180:183], a[180:183], v[52:55], 0
    s_waitcnt lgkmcnt(1)
    v_cvt_pk_bf16_f32 v62, v124, v125
    v_mfma_f32_16x16x32_bf16 v[152:155], a[184:187], v[48:51], 0
    s_waitcnt lgkmcnt(0)
    v_exp_f32 v126, v126
    v_mfma_f32_16x16x32_bf16 v[184:187], a[184:187], v[52:55], 0
    buffer_load_dwordx4 v15, s[8:11], s82 offen offset:2048 lds
    v_mfma_f32_16x16x32_bf16 v[156:159], a[188:191], v[48:51], 0
    v_exp_f32 v127, v127
    v_mfma_f32_16x16x32_bf16 v[188:191], a[188:191], v[52:55], 0
    v_cvt_pk_bf16_f32 v63, v126, v127
    v_mfma_f32_16x16x32_bf16 v[112:115], a[128:131], a[224:227], v[72:75]
    v_mfma_f32_16x16x32_bf16 v[112:115], a[132:135], a[228:231], v[112:115]
    v_mfma_f32_16x16x32_bf16 v[112:115], a[136:139], a[232:235], v[112:115]
    v_exp_f32 v96, v96
    v_mfma_f32_16x16x32_bf16 v[112:115], a[140:143], a[236:239], v[112:115]
    buffer_load_dwordx4 v15, s[8:11], s82 offen offset:3072 lds
    v_mfma_f32_16x16x32_bf16 v[120:123], a[128:131], a[240:243], v[76:79]
    s_xor_b32 s15, s15, 196608
    v_exp_f32 v97, v97
    v_mfma_f32_16x16x32_bf16 v[120:123], a[132:135], a[244:247], v[120:123]
    s_add_u32 m0, s16, 0
    ds_read_b128 a[128:131], v18 offset:0
    v_cvt_pk_bf16_f32 v48, v96, v97
    v_mfma_f32_16x16x32_bf16 v[120:123], a[136:139], a[248:251], v[120:123]
    v_exp_f32 v98, v98
    v_mfma_f32_16x16x32_bf16 v[120:123], a[140:143], a[252:255], v[120:123]
    buffer_load_dwordx4 v1, s[8:11], s19 offen offset:0 lds
    v_mfma_f32_16x16x32_bf16 v[116:119], a[144:147], a[224:227], v[72:75]
    v_exp_f32 v99, v99
    v_mfma_f32_16x16x32_bf16 v[116:119], a[148:151], a[228:231], v[116:119]
    ds_read_b128 a[132:135], v18 offset:1024
    v_cvt_pk_bf16_f32 v49, v98, v99
    v_mfma_f32_16x16x32_bf16 v[116:119], a[152:155], a[232:235], v[116:119]
    v_exp_f32 v100, v100
    v_mfma_f32_16x16x32_bf16 v[116:119], a[156:159], a[236:239], v[116:119]
    buffer_load_dwordx4 v1, s[8:11], s19 offen offset:1024 lds
    v_mfma_f32_16x16x32_bf16 v[124:127], a[144:147], a[240:243], v[76:79]
    v_exp_f32 v101, v101
    v_mfma_f32_16x16x32_bf16 v[124:127], a[148:151], a[244:247], v[124:127]
    ds_read_b128 a[136:139], v18 offset:2048
    v_cvt_pk_bf16_f32 v50, v100, v101
    v_mfma_f32_16x16x32_bf16 v[124:127], a[152:155], a[248:251], v[124:127]
    v_exp_f32 v102, v102
    v_mfma_f32_16x16x32_bf16 v[124:127], a[156:159], a[252:255], v[124:127]
    buffer_load_dwordx4 v1, s[8:11], s19 offen offset:2048 lds
    v_mfma_f32_16x16x32_bf16 v[40:43], v[28:31], v[56:59], 0
    v_exp_f32 v103, v103
    v_mfma_f32_16x16x32_bf16 v[44:47], v[28:31], v[60:63], 0
    ds_read_b128 a[140:143], v18 offset:3072
    v_cvt_pk_bf16_f32 v51, v102, v103
    v_mfma_f32_16x16x32_bf16 v[192:195], a[160:163], v[56:59], 0
    v_exp_f32 v104, v104
    v_mfma_f32_16x16x32_bf16 v[224:227], a[160:163], v[60:63], 0
    v_mfma_f32_16x16x32_bf16 v[196:199], a[164:167], v[56:59], 0
    v_exp_f32 v105, v105
    v_mfma_f32_16x16x32_bf16 v[228:231], a[164:167], v[60:63], 0
    ds_read_b128 a[144:147], v18 offset:4096
    v_cvt_pk_bf16_f32 v52, v104, v105
    v_mfma_f32_16x16x32_bf16 v[200:203], a[168:171], v[56:59], 0
    v_exp_f32 v106, v106
    v_mfma_f32_16x16x32_bf16 v[232:235], a[168:171], v[60:63], 0
    buffer_load_dwordx4 v1, s[8:11], s19 offen offset:3072 lds
    v_mfma_f32_16x16x32_bf16 v[204:207], a[172:175], v[56:59], 0
    s_add_u32 m0, s16, 4096
    v_exp_f32 v107, v107
    v_mfma_f32_16x16x32_bf16 v[236:239], a[172:175], v[60:63], 0
    ds_read_b128 a[148:151], v18 offset:5120
    v_cvt_pk_bf16_f32 v53, v106, v107
    v_mfma_f32_16x16x32_bf16 v[208:211], a[176:179], v[56:59], 0
    v_exp_f32 v108, v108
    v_mfma_f32_16x16x32_bf16 v[240:243], a[176:179], v[60:63], 0
    buffer_load_dwordx4 v15, s[8:11], s19 offen offset:0 lds
    v_mfma_f32_16x16x32_bf16 v[212:215], a[180:183], v[56:59], 0
    v_exp_f32 v109, v109
    v_mfma_f32_16x16x32_bf16 v[244:247], a[180:183], v[60:63], 0
    ds_read_b128 a[152:155], v18 offset:6144
    v_cvt_pk_bf16_f32 v54, v108, v109
    v_mfma_f32_16x16x32_bf16 v[216:219], a[184:187], v[56:59], 0
    v_exp_f32 v110, v110
    v_mfma_f32_16x16x32_bf16 v[248:251], a[184:187], v[60:63], 0
    buffer_load_dwordx4 v15, s[8:11], s19 offen offset:1024 lds
    v_mfma_f32_16x16x32_bf16 v[220:223], a[188:191], v[56:59], 0
    v_exp_f32 v111, v111
    v_mfma_f32_16x16x32_bf16 v[252:255], a[188:191], v[60:63], 0
    ds_read_b128 a[156:159], v18 offset:7168
    v_cvt_pk_bf16_f32 v55, v110, v111
    s_waitcnt lgkmcnt(7)
    v_mfma_f32_16x16x32_bf16 v[96:99], a[128:131], a[192:195], v[64:67]
    s_waitcnt lgkmcnt(6)
    s_lshr_b32 s101, s2, 3
    s_sub_u32 s101, s101, 4
    ds_read_b128 a[160:163], v19 offset:16384
    v_mfma_f32_16x16x32_bf16 v[96:99], a[132:135], a[196:199], v[96:99]
    s_waitcnt lgkmcnt(6)
    s_and_b32 s101, s101, 31
    ds_read_b128 a[164:167], v19 offset:17408
    v_lshrrev_b32 v14, 3, v2
    v_mfma_f32_16x16x32_bf16 v[96:99], a[136:139], a[200:203], v[96:99]
    s_waitcnt lgkmcnt(6)
    v_exp_f32 v112, v112
    v_mfma_f32_16x16x32_bf16 v[96:99], a[140:143], a[204:207], v[96:99]
    buffer_load_dwordx4 v15, s[8:11], s19 offen offset:2048 lds
    v_mfma_f32_16x16x32_bf16 v[104:107], a[128:131], a[208:211], v[68:71]
    v_exp_f32 v113, v113
    v_mfma_f32_16x16x32_bf16 v[104:107], a[132:135], a[212:215], v[104:107]
    ds_read_b128 a[168:171], v19 offset:18432
    v_cvt_pk_bf16_f32 v56, v112, v113
    v_mfma_f32_16x16x32_bf16 v[104:107], a[136:139], a[216:219], v[104:107]
    s_waitcnt lgkmcnt(6)
    v_exp_f32 v114, v114
    v_mfma_f32_16x16x32_bf16 v[104:107], a[140:143], a[220:223], v[104:107]
    buffer_load_dwordx4 v15, s[8:11], s19 offen offset:3072 lds
    v_mfma_f32_16x16x32_bf16 v[100:103], a[144:147], a[192:195], v[64:67]
    s_waitcnt lgkmcnt(5)
    s_xor_b32 s16, s16, 98304
    v_exp_f32 v115, v115
    v_mfma_f32_16x16x32_bf16 v[100:103], a[148:151], a[196:199], v[100:103]
    s_waitcnt lgkmcnt(4)
    s_add_u32 s27, s18, 0
    ds_read_b128 a[172:175], v19 offset:19456
    v_cvt_pk_bf16_f32 v57, v114, v115
    v_mfma_f32_16x16x32_bf16 v[100:103], a[152:155], a[200:203], v[100:103]
    s_waitcnt lgkmcnt(4)
    v_exp_f32 v116, v116
    v_mfma_f32_16x16x32_bf16 v[100:103], a[156:159], a[204:207], v[100:103]
    buffer_store_dwordx4 v[24:27], v17, s[8:11], s27 offen offset:0 sc0 sc1
    v_mfma_f32_16x16x32_bf16 v[108:111], a[144:147], a[208:211], v[68:71]
    s_add_u32 s27, s18, 131072
    v_exp_f32 v117, v117
    v_mfma_f32_16x16x32_bf16 v[108:111], a[148:151], a[212:215], v[108:111]
    ds_read_b128 a[176:179], v20 offset:20480
    v_cvt_pk_bf16_f32 v58, v116, v117
    v_mfma_f32_16x16x32_bf16 v[108:111], a[152:155], a[216:219], v[108:111]
    v_exp_f32 v118, v118
    v_mfma_f32_16x16x32_bf16 v[108:111], a[156:159], a[220:223], v[108:111]
    buffer_store_dwordx4 v[24:27], v17, s[8:11], s27 offen offset:0 sc0 sc1
    v_mfma_f32_16x16x32_bf16 v[32:35], v[28:31], v[48:51], v[32:35]
    v_exp_f32 v119, v119
    v_mfma_f32_16x16x32_bf16 v[36:39], v[28:31], v[52:55], v[36:39]
    s_waitcnt lgkmcnt(4)
    ds_read_b128 a[180:183], v20 offset:21504
    v_cvt_pk_bf16_f32 v59, v118, v119
    v_mfma_f32_16x16x32_bf16 v[128:131], a[160:163], v[48:51], v[128:131]
    v_exp_f32 v120, v120
    v_mfma_f32_16x16x32_bf16 v[160:163], a[160:163], v[52:55], v[160:163]
    s_waitcnt lgkmcnt(4)
    v_lshlrev_b32 v14, 4, v14
    v_and_b32 v13, 7, v2
    v_mfma_f32_16x16x32_bf16 v[132:135], a[164:167], v[48:51], v[132:135]
    v_exp_f32 v121, v121
    v_mfma_f32_16x16x32_bf16 v[164:167], a[164:167], v[52:55], v[164:167]
    s_waitcnt lgkmcnt(3)
    ds_read_b128 a[184:187], v20 offset:22528
    v_cvt_pk_bf16_f32 v60, v120, v121
    v_mfma_f32_16x16x32_bf16 v[136:139], a[168:171], v[48:51], v[136:139]
    v_exp_f32 v122, v122
    v_mfma_f32_16x16x32_bf16 v[168:171], a[168:171], v[52:55], v[168:171]
    s_waitcnt lgkmcnt(3)
    v_lshl_add_u32 v12, v13, 13, v14
    v_mul_u32_u24 v13, 28672, v13
    v_mfma_f32_16x16x32_bf16 v[140:143], a[172:175], v[48:51], v[140:143]
    v_exp_f32 v123, v123
    v_mfma_f32_16x16x32_bf16 v[172:175], a[172:175], v[52:55], v[172:175]
    s_waitcnt lgkmcnt(2)
    ds_read_b128 a[188:191], v20 offset:23552
    v_cvt_pk_bf16_f32 v61, v122, v123
    v_mfma_f32_16x16x32_bf16 v[144:147], a[176:179], v[48:51], v[144:147]
    v_exp_f32 v124, v124
    v_mfma_f32_16x16x32_bf16 v[176:179], a[176:179], v[52:55], v[176:179]
    s_waitcnt lgkmcnt(2)
    v_add_u32 v13, v13, v14
    v_mfma_f32_16x16x32_bf16 v[148:151], a[180:183], v[48:51], v[148:151]
    s_lshl_b32 s17, s4, 2
    v_exp_f32 v125, v125
    v_mfma_f32_16x16x32_bf16 v[180:183], a[180:183], v[52:55], v[180:183]
    s_waitcnt lgkmcnt(1)
    s_add_u32 s17, s17, s3
    v_cvt_pk_bf16_f32 v62, v124, v125
    v_xor_b32 v19, 98304, v19
    v_mfma_f32_16x16x32_bf16 v[152:155], a[184:187], v[48:51], v[152:155]
    s_lshl_b32 s17, s17, 7
    v_exp_f32 v126, v126
    v_mfma_f32_16x16x32_bf16 v[184:187], a[184:187], v[52:55], v[184:187]
    s_waitcnt lgkmcnt(0)
    s_lshl_b32 s100, s101, 16
    s_add_u32 s17, s17, s100
    v_xor_b32 v20, 98304, v20
    v_mfma_f32_16x16x32_bf16 v[156:159], a[188:191], v[48:51], v[156:159]
    s_add_u32 s17, s17, 4194304
    v_exp_f32 v127, v127
    v_mfma_f32_16x16x32_bf16 v[188:191], a[188:191], v[52:55], v[188:191]
    s_cmp_lt_u32 s101, s26
    s_cselect_b32 s17, s17, 2143285248
    v_cvt_pk_bf16_f32 v63, v126, v127
    buffer_store_dwordx4 a[0:3], v12, s[8:11], s17 offen sc0 sc1
    v_mfma_f32_16x16x32_bf16 v[112:115], a[128:131], a[224:227], v[72:75]
    s_add_u32 s17, s17, 4096
    v_exp_f32 v96, v96
    v_mfma_f32_16x16x32_bf16 v[112:115], a[132:135], a[228:231], v[112:115]
    buffer_store_dwordx4 a[4:7], v12, s[8:11], s17 offen sc0 sc1
    v_mfma_f32_16x16x32_bf16 v[112:115], a[136:139], a[232:235], v[112:115]
    s_add_u32 s27, s18, 0
    v_exp_f32 v97, v97
    v_mfma_f32_16x16x32_bf16 v[112:115], a[140:143], a[236:239], v[112:115]
    v_cvt_pk_bf16_f32 v48, v96, v97
    v_lshrrev_b32 v9, 1, v2
    v_mfma_f32_16x16x32_bf16 v[120:123], a[128:131], a[240:243], v[76:79]
    v_exp_f32 v98, v98
    v_mfma_f32_16x16x32_bf16 v[120:123], a[132:135], a[244:247], v[120:123]
    buffer_store_dwordx4 v[24:27], v17, s[8:11], s27 offen offset:256 sc0 sc1
    v_mfma_f32_16x16x32_bf16 v[120:123], a[136:139], a[248:251], v[120:123]
    s_add_u32 s27, s18, 131072
    v_exp_f32 v99, v99
    v_mfma_f32_16x16x32_bf16 v[120:123], a[140:143], a[252:255], v[120:123]
    buffer_store_dwordx4 v[24:27], v17, s[8:11], s27 offen offset:256 sc0 sc1
    v_mfma_f32_16x16x32_bf16 v[116:119], a[144:147], a[224:227], v[72:75]
    s_add_u32 s27, s18, 0
    v_exp_f32 v100, v100
    v_mfma_f32_16x16x32_bf16 v[116:119], a[148:151], a[228:231], v[116:119]
    ds_read_b128 a[128:131], v18 offset:16384
    v_cvt_pk_bf16_f32 v49, v98, v99
    v_mfma_f32_16x16x32_bf16 v[116:119], a[152:155], a[232:235], v[116:119]
    s_add_u32 s19, s82, 32768
    v_exp_f32 v101, v101
    v_mfma_f32_16x16x32_bf16 v[116:119], a[156:159], a[236:239], v[116:119]
    s_sub_u32 s82, s12, s13
    ds_read_b128 a[132:135], v18 offset:17408
    v_cvt_pk_bf16_f32 v50, v100, v101
    v_mfma_f32_16x16x32_bf16 v[124:127], a[144:147], a[240:243], v[76:79]
    s_sub_u32 s82, s82, 1
    v_exp_f32 v102, v102
    v_mfma_f32_16x16x32_bf16 v[124:127], a[148:151], a[244:247], v[124:127]
    s_cmp_gt_u32 s12, s13
    s_cselect_b32 s82, s82, s12
    s_lshl_b32 s82, s82, 16
    ds_read_b128 a[136:139], v18 offset:18432
    v_mfma_f32_16x16x32_bf16 v[124:127], a[152:155], a[248:251], v[124:127]
    s_add_u32 s82, s82, s81
    v_exp_f32 v103, v103
    v_mfma_f32_16x16x32_bf16 v[124:127], a[156:159], a[252:255], v[124:127]
    s_cmp_ge_u32 s12, 17
    s_cselect_b32 s82, 2147471360, s82
    ds_read_b128 a[140:143], v18 offset:19456
    v_cvt_pk_bf16_f32 v51, v102, v103
    v_mfma_f32_16x16x32_bf16 v[40:43], v[28:31], v[56:59], v[40:43]
    s_add_u32 s12, s12, 1
    v_exp_f32 v104, v104
    v_mfma_f32_16x16x32_bf16 v[44:47], v[28:31], v[60:63], v[44:47]
    ds_read_b128 a[144:147], v18 offset:20480
    v_lshrrev_b32 v10, 4, v2
    v_mfma_f32_16x16x32_bf16 v[192:195], a[160:163], v[56:59], v[192:195]
    v_exp_f32 v105, v105
    v_mfma_f32_16x16x32_bf16 v[224:227], a[160:163], v[60:63], v[224:227]
    ds_read_b128 a[148:151], v18 offset:21504
    v_cvt_pk_bf16_f32 v52, v104, v105
    v_mfma_f32_16x16x32_bf16 v[196:199], a[164:167], v[56:59], v[196:199]
    v_exp_f32 v106, v106
    v_mfma_f32_16x16x32_bf16 v[228:231], a[164:167], v[60:63], v[228:231]
    ds_read_b128 a[152:155], v18 offset:22528
    v_xor_b32 v9, v9, v10
    v_mfma_f32_16x16x32_bf16 v[200:203], a[168:171], v[56:59], v[200:203]
    v_exp_f32 v107, v107
    v_mfma_f32_16x16x32_bf16 v[232:235], a[168:171], v[60:63], v[232:235]
    ds_read_b128 a[156:159], v18 offset:23552
    v_cvt_pk_bf16_f32 v53, v106, v107
    v_mfma_f32_16x16x32_bf16 v[204:207], a[172:175], v[56:59], v[204:207]
    v_exp_f32 v108, v108
    v_mfma_f32_16x16x32_bf16 v[236:239], a[172:175], v[60:63], v[236:239]
    buffer_store_dwordx4 v[24:27], v17, s[8:11], s27 offen offset:512 sc0 sc1
    v_mfma_f32_16x16x32_bf16 v[208:211], a[176:179], v[56:59], v[208:211]
    s_add_u32 s27, s18, 131072
    v_exp_f32 v109, v109
    v_mfma_f32_16x16x32_bf16 v[240:243], a[176:179], v[60:63], v[240:243]
    v_cvt_pk_bf16_f32 v54, v108, v109
    v_xor_b32 v18, 196608, v18
    v_mfma_f32_16x16x32_bf16 v[212:215], a[180:183], v[56:59], v[212:215]
    v_exp_f32 v110, v110
    v_mfma_f32_16x16x32_bf16 v[244:247], a[180:183], v[60:63], v[244:247]
    buffer_store_dwordx4 v[24:27], v17, s[8:11], s27 offen offset:512 sc0 sc1
    v_mfma_f32_16x16x32_bf16 v[216:219], a[184:187], v[56:59], v[216:219]
    s_add_u32 s27, s18, 0
    v_exp_f32 v111, v111
    v_mfma_f32_16x16x32_bf16 v[248:251], a[184:187], v[60:63], v[248:251]
    v_cvt_pk_bf16_f32 v55, v110, v111
    v_and_b32 v9, 3, v9
    v_mfma_f32_16x16x32_bf16 v[220:223], a[188:191], v[56:59], v[220:223]
    buffer_store_dwordx4 v[24:27], v17, s[8:11], s27 offen offset:768 sc0 sc1
    v_mfma_f32_16x16x32_bf16 v[252:255], a[188:191], v[60:63], v[252:255]
    v_lshlrev_b32 v9, 5, v9
    v_and_b32 v10, 1, v2
    v_lshl_add_u32 v9, v10, 4, v9
    v_lshrrev_b32 v8, 3, v2
    s_waitcnt vmcnt(9) lgkmcnt(0)
    s_barrier
    buffer_store_dword v6, v5, s[8:11], s22 offen sc0 sc1
    v_mfma_f32_16x16x32_bf16 v[96:99], a[128:131], a[192:195], v[64:67]
    s_add_u32 m0, s15, 0
    ds_read_b128 a[160:163], v19 offset:0
    v_mfma_f32_16x16x32_bf16 v[96:99], a[132:135], a[196:199], v[96:99]
    ds_read_b128 a[164:167], v19 offset:1024
    v_mfma_f32_16x16x32_bf16 v[96:99], a[136:139], a[200:203], v[96:99]
    v_exp_f32 v112, v112
    v_mfma_f32_16x16x32_bf16 v[96:99], a[140:143], a[204:207], v[96:99]
    buffer_load_dwordx4 v1, s[8:11], s82 offen offset:0 lds
    v_mfma_f32_16x16x32_bf16 v[104:107], a[128:131], a[208:211], v[68:71]
    v_exp_f32 v113, v113
    v_mfma_f32_16x16x32_bf16 v[104:107], a[132:135], a[212:215], v[104:107]
    ds_read_b128 a[168:171], v19 offset:2048
    v_cvt_pk_bf16_f32 v56, v112, v113
    v_mfma_f32_16x16x32_bf16 v[104:107], a[136:139], a[216:219], v[104:107]
    v_exp_f32 v114, v114
    v_mfma_f32_16x16x32_bf16 v[104:107], a[140:143], a[220:223], v[104:107]
    buffer_load_dwordx4 v1, s[8:11], s82 offen offset:1024 lds
    v_mfma_f32_16x16x32_bf16 v[100:103], a[144:147], a[192:195], v[64:67]
    v_exp_f32 v115, v115
    v_mfma_f32_16x16x32_bf16 v[100:103], a[148:151], a[196:199], v[100:103]
    ds_read_b128 a[172:175], v19 offset:3072
    v_cvt_pk_bf16_f32 v57, v114, v115
    v_mfma_f32_16x16x32_bf16 v[100:103], a[152:155], a[200:203], v[100:103]
    v_exp_f32 v116, v116
    v_mfma_f32_16x16x32_bf16 v[100:103], a[156:159], a[204:207], v[100:103]
    buffer_load_dwordx4 v1, s[8:11], s82 offen offset:2048 lds
    v_mfma_f32_16x16x32_bf16 v[108:111], a[144:147], a[208:211], v[68:71]
    v_exp_f32 v117, v117
    v_mfma_f32_16x16x32_bf16 v[108:111], a[148:151], a[212:215], v[108:111]
    ds_read_b128 a[176:179], v20 offset:4096
    v_cvt_pk_bf16_f32 v58, v116, v117
    v_mfma_f32_16x16x32_bf16 v[108:111], a[152:155], a[216:219], v[108:111]
    v_exp_f32 v118, v118
    v_mfma_f32_16x16x32_bf16 v[108:111], a[156:159], a[220:223], v[108:111]
    buffer_load_dwordx4 v1, s[8:11], s82 offen offset:3072 lds
    v_mfma_f32_16x16x32_bf16 v[32:35], v[28:31], v[48:51], v[32:35]
    s_add_u32 m0, s15, 4096
    v_exp_f32 v119, v119
    v_mfma_f32_16x16x32_bf16 v[36:39], v[28:31], v[52:55], v[36:39]
    s_waitcnt lgkmcnt(4)
    ds_read_b128 a[180:183], v20 offset:5120
    v_cvt_pk_bf16_f32 v59, v118, v119
    v_mfma_f32_16x16x32_bf16 v[128:131], a[160:163], v[48:51], v[128:131]
    v_exp_f32 v120, v120
    v_mfma_f32_16x16x32_bf16 v[160:163], a[160:163], v[52:55], v[160:163]
    s_waitcnt lgkmcnt(4)
    v_mfma_f32_16x16x32_bf16 v[132:135], a[164:167], v[48:51], v[132:135]
    v_exp_f32 v121, v121
    v_mfma_f32_16x16x32_bf16 v[164:167], a[164:167], v[52:55], v[164:167]
    s_waitcnt lgkmcnt(3)
    ds_read_b128 a[184:187], v20 offset:6144
    v_cvt_pk_bf16_f32 v60, v120, v121
    v_mfma_f32_16x16x32_bf16 v[136:139], a[168:171], v[48:51], v[136:139]
    s_waitcnt lgkmcnt(3)
    v_exp_f32 v122, v122
    v_mfma_f32_16x16x32_bf16 v[168:171], a[168:171], v[52:55], v[168:171]
    buffer_load_dwordx4 v15, s[8:11], s82 offen offset:0 lds
    v_mfma_f32_16x16x32_bf16 v[140:143], a[172:175], v[48:51], v[140:143]
    v_exp_f32 v123, v123
    v_mfma_f32_16x16x32_bf16 v[172:175], a[172:175], v[52:55], v[172:175]
    s_waitcnt lgkmcnt(2)
    ds_read_b128 a[188:191], v20 offset:7168
    v_cvt_pk_bf16_f32 v61, v122, v123
    v_mfma_f32_16x16x32_bf16 v[144:147], a[176:179], v[48:51], v[144:147]
    s_waitcnt lgkmcnt(2)
    v_exp_f32 v124, v124
    v_mfma_f32_16x16x32_bf16 v[176:179], a[176:179], v[52:55], v[176:179]
    buffer_load_dwordx4 v15, s[8:11], s82 offen offset:1024 lds
    v_mfma_f32_16x16x32_bf16 v[148:151], a[180:183], v[48:51], v[148:151]
    v_exp_f32 v125, v125
    v_mfma_f32_16x16x32_bf16 v[180:183], a[180:183], v[52:55], v[180:183]
    s_waitcnt lgkmcnt(1)
    v_cvt_pk_bf16_f32 v62, v124, v125
    v_mfma_f32_16x16x32_bf16 v[152:155], a[184:187], v[48:51], v[152:155]
    s_waitcnt lgkmcnt(0)
    v_exp_f32 v126, v126
    v_mfma_f32_16x16x32_bf16 v[184:187], a[184:187], v[52:55], v[184:187]
    buffer_load_dwordx4 v15, s[8:11], s82 offen offset:2048 lds
    v_mfma_f32_16x16x32_bf16 v[156:159], a[188:191], v[48:51], v[156:159]
    v_exp_f32 v127, v127
    v_mfma_f32_16x16x32_bf16 v[188:191], a[188:191], v[52:55], v[188:191]
    v_cvt_pk_bf16_f32 v63, v126, v127
    v_mfma_f32_16x16x32_bf16 v[112:115], a[128:131], a[224:227], v[72:75]
    v_mfma_f32_16x16x32_bf16 v[112:115], a[132:135], a[228:231], v[112:115]
    v_mfma_f32_16x16x32_bf16 v[112:115], a[136:139], a[232:235], v[112:115]
    v_exp_f32 v96, v96
    v_mfma_f32_16x16x32_bf16 v[112:115], a[140:143], a[236:239], v[112:115]
    buffer_load_dwordx4 v15, s[8:11], s82 offen offset:3072 lds
    v_mfma_f32_16x16x32_bf16 v[120:123], a[128:131], a[240:243], v[76:79]
    s_xor_b32 s15, s15, 196608
    v_exp_f32 v97, v97
    v_mfma_f32_16x16x32_bf16 v[120:123], a[132:135], a[244:247], v[120:123]
    s_add_u32 m0, s16, 0
    ds_read_b128 a[128:131], v18 offset:0
    v_cvt_pk_bf16_f32 v48, v96, v97
    v_mfma_f32_16x16x32_bf16 v[120:123], a[136:139], a[248:251], v[120:123]
    v_exp_f32 v98, v98
    v_mfma_f32_16x16x32_bf16 v[120:123], a[140:143], a[252:255], v[120:123]
    buffer_load_dwordx4 v1, s[8:11], s19 offen offset:0 lds
    v_mfma_f32_16x16x32_bf16 v[116:119], a[144:147], a[224:227], v[72:75]
    v_exp_f32 v99, v99
    v_mfma_f32_16x16x32_bf16 v[116:119], a[148:151], a[228:231], v[116:119]
    ds_read_b128 a[132:135], v18 offset:1024
    v_cvt_pk_bf16_f32 v49, v98, v99
    v_mfma_f32_16x16x32_bf16 v[116:119], a[152:155], a[232:235], v[116:119]
    v_exp_f32 v100, v100
    v_mfma_f32_16x16x32_bf16 v[116:119], a[156:159], a[236:239], v[116:119]
    buffer_load_dwordx4 v1, s[8:11], s19 offen offset:1024 lds
    v_mfma_f32_16x16x32_bf16 v[124:127], a[144:147], a[240:243], v[76:79]
    v_exp_f32 v101, v101
    v_mfma_f32_16x16x32_bf16 v[124:127], a[148:151], a[244:247], v[124:127]
    ds_read_b128 a[136:139], v18 offset:2048
    v_cvt_pk_bf16_f32 v50, v100, v101
    v_mfma_f32_16x16x32_bf16 v[124:127], a[152:155], a[248:251], v[124:127]
    v_exp_f32 v102, v102
    v_mfma_f32_16x16x32_bf16 v[124:127], a[156:159], a[252:255], v[124:127]
    buffer_load_dwordx4 v1, s[8:11], s19 offen offset:2048 lds
    v_mfma_f32_16x16x32_bf16 v[40:43], v[28:31], v[56:59], v[40:43]
    v_exp_f32 v103, v103
    v_mfma_f32_16x16x32_bf16 v[44:47], v[28:31], v[60:63], v[44:47]
    ds_read_b128 a[140:143], v18 offset:3072
    v_cvt_pk_bf16_f32 v51, v102, v103
    v_mfma_f32_16x16x32_bf16 v[192:195], a[160:163], v[56:59], v[192:195]
    v_exp_f32 v104, v104
    v_mfma_f32_16x16x32_bf16 v[224:227], a[160:163], v[60:63], v[224:227]
    v_mfma_f32_16x16x32_bf16 v[196:199], a[164:167], v[56:59], v[196:199]
    v_exp_f32 v105, v105
    v_mfma_f32_16x16x32_bf16 v[228:231], a[164:167], v[60:63], v[228:231]
    ds_read_b128 a[144:147], v18 offset:4096
    v_cvt_pk_bf16_f32 v52, v104, v105
    v_mfma_f32_16x16x32_bf16 v[200:203], a[168:171], v[56:59], v[200:203]
    v_exp_f32 v106, v106
    v_mfma_f32_16x16x32_bf16 v[232:235], a[168:171], v[60:63], v[232:235]
    buffer_load_dwordx4 v1, s[8:11], s19 offen offset:3072 lds
    v_mfma_f32_16x16x32_bf16 v[204:207], a[172:175], v[56:59], v[204:207]
    s_add_u32 m0, s16, 4096
    v_exp_f32 v107, v107
    v_mfma_f32_16x16x32_bf16 v[236:239], a[172:175], v[60:63], v[236:239]
    ds_read_b128 a[148:151], v18 offset:5120
    v_cvt_pk_bf16_f32 v53, v106, v107
    v_mfma_f32_16x16x32_bf16 v[208:211], a[176:179], v[56:59], v[208:211]
    v_exp_f32 v108, v108
    v_mfma_f32_16x16x32_bf16 v[240:243], a[176:179], v[60:63], v[240:243]
    buffer_load_dwordx4 v15, s[8:11], s19 offen offset:0 lds
    v_mfma_f32_16x16x32_bf16 v[212:215], a[180:183], v[56:59], v[212:215]
    v_exp_f32 v109, v109
    v_mfma_f32_16x16x32_bf16 v[244:247], a[180:183], v[60:63], v[244:247]
    ds_read_b128 a[152:155], v18 offset:6144
    v_cvt_pk_bf16_f32 v54, v108, v109
    v_mfma_f32_16x16x32_bf16 v[216:219], a[184:187], v[56:59], v[216:219]
    v_exp_f32 v110, v110
    v_mfma_f32_16x16x32_bf16 v[248:251], a[184:187], v[60:63], v[248:251]
    buffer_load_dwordx4 v15, s[8:11], s19 offen offset:1024 lds
    v_mfma_f32_16x16x32_bf16 v[220:223], a[188:191], v[56:59], v[220:223]
    v_exp_f32 v111, v111
    v_mfma_f32_16x16x32_bf16 v[252:255], a[188:191], v[60:63], v[252:255]
    ds_read_b128 a[156:159], v18 offset:7168
    v_cvt_pk_bf16_f32 v55, v110, v111
    s_waitcnt lgkmcnt(7)
    v_mfma_f32_16x16x32_bf16 v[96:99], a[128:131], a[192:195], v[64:67]
    s_waitcnt lgkmcnt(6)
    ds_read_b128 a[160:163], v19 offset:16384
    v_mfma_f32_16x16x32_bf16 v[96:99], a[132:135], a[196:199], v[96:99]
    s_waitcnt lgkmcnt(6)
    ds_read_b128 a[164:167], v19 offset:17408
    v_mfma_f32_16x16x32_bf16 v[96:99], a[136:139], a[200:203], v[96:99]
    s_waitcnt lgkmcnt(6)
    v_exp_f32 v112, v112
    v_mfma_f32_16x16x32_bf16 v[96:99], a[140:143], a[204:207], v[96:99]
    buffer_load_dwordx4 v15, s[8:11], s19 offen offset:2048 lds
    v_mfma_f32_16x16x32_bf16 v[104:107], a[128:131], a[208:211], v[68:71]
    v_exp_f32 v113, v113
    v_mfma_f32_16x16x32_bf16 v[104:107], a[132:135], a[212:215], v[104:107]
    ds_read_b128 a[168:171], v19 offset:18432
    v_cvt_pk_bf16_f32 v56, v112, v113
    v_mfma_f32_16x16x32_bf16 v[104:107], a[136:139], a[216:219], v[104:107]
    s_waitcnt lgkmcnt(6)
    v_exp_f32 v114, v114
    v_mfma_f32_16x16x32_bf16 v[104:107], a[140:143], a[220:223], v[104:107]
    buffer_load_dwordx4 v15, s[8:11], s19 offen offset:3072 lds
    v_mfma_f32_16x16x32_bf16 v[100:103], a[144:147], a[192:195], v[64:67]
    s_waitcnt lgkmcnt(5)
    s_xor_b32 s16, s16, 98304
    v_exp_f32 v115, v115
    v_mfma_f32_16x16x32_bf16 v[100:103], a[148:151], a[196:199], v[100:103]
    s_waitcnt lgkmcnt(4)
    s_add_u32 s17, s17, 2093056
    ds_read_b128 a[172:175], v19 offset:19456
    v_cvt_pk_bf16_f32 v57, v114, v115
    v_mfma_f32_16x16x32_bf16 v[100:103], a[152:155], a[200:203], v[100:103]
    s_waitcnt lgkmcnt(4)
    v_exp_f32 v116, v116
    v_mfma_f32_16x16x32_bf16 v[100:103], a[156:159], a[204:207], v[100:103]
    buffer_store_dwordx4 a[8:11], v12, s[8:11], s17 offen sc0 sc1
    v_mfma_f32_16x16x32_bf16 v[108:111], a[144:147], a[208:211], v[68:71]
    s_add_u32 s27, s18, 131072
    v_exp_f32 v117, v117
    v_mfma_f32_16x16x32_bf16 v[108:111], a[148:151], a[212:215], v[108:111]
    ds_read_b128 a[176:179], v20 offset:20480
    v_cvt_pk_bf16_f32 v58, v116, v117
    v_mfma_f32_16x16x32_bf16 v[108:111], a[152:155], a[216:219], v[108:111]
    v_exp_f32 v118, v118
    v_mfma_f32_16x16x32_bf16 v[108:111], a[156:159], a[220:223], v[108:111]
    buffer_store_dwordx4 v[24:27], v17, s[8:11], s27 offen offset:768 sc0 sc1
    v_mfma_f32_16x16x32_bf16 v[32:35], v[28:31], v[48:51], v[32:35]
    s_add_u32 s27, s18, 8388608
    v_exp_f32 v119, v119
    v_mfma_f32_16x16x32_bf16 v[36:39], v[28:31], v[52:55], v[36:39]
    s_waitcnt lgkmcnt(4)
    ds_read_b128 a[180:183], v20 offset:21504
    v_cvt_pk_bf16_f32 v59, v118, v119
    v_mfma_f32_16x16x32_bf16 v[128:131], a[160:163], v[48:51], v[128:131]
    s_waitcnt lgkmcnt(4)
    v_exp_f32 v120, v120
    v_mfma_f32_16x16x32_bf16 v[160:163], a[160:163], v[52:55], v[160:163]
    buffer_store_dwordx4 v[24:27], v17, s[8:11], s27 offen offset:0 sc0 sc1
    v_mfma_f32_16x16x32_bf16 v[132:135], a[164:167], v[48:51], v[132:135]
    s_add_u32 s27, s18, 8519680
    v_exp_f32 v121, v121
    v_mfma_f32_16x16x32_bf16 v[164:167], a[164:167], v[52:55], v[164:167]
    s_waitcnt lgkmcnt(3)
    ds_read_b128 a[184:187], v20 offset:22528
    v_cvt_pk_bf16_f32 v60, v120, v121
    v_mfma_f32_16x16x32_bf16 v[136:139], a[168:171], v[48:51], v[136:139]
    s_waitcnt lgkmcnt(3)
    v_exp_f32 v122, v122
    v_mfma_f32_16x16x32_bf16 v[168:171], a[168:171], v[52:55], v[168:171]
    buffer_store_dwordx4 v[24:27], v17, s[8:11], s27 offen offset:0 sc0 sc1
    v_mfma_f32_16x16x32_bf16 v[140:143], a[172:175], v[48:51], v[140:143]
    v_exp_f32 v123, v123
    v_mfma_f32_16x16x32_bf16 v[172:175], a[172:175], v[52:55], v[172:175]
    s_waitcnt lgkmcnt(2)
    ds_read_b128 a[188:191], v20 offset:23552
    v_cvt_pk_bf16_f32 v61, v122, v123
    v_mfma_f32_16x16x32_bf16 v[144:147], a[176:179], v[48:51], v[144:147]
    v_exp_f32 v124, v124
    v_mfma_f32_16x16x32_bf16 v[176:179], a[176:179], v[52:55], v[176:179]
    s_waitcnt lgkmcnt(2)
    v_mfma_f32_16x16x32_bf16 v[148:151], a[180:183], v[48:51], v[148:151]
    v_exp_f32 v125, v125
    v_mfma_f32_16x16x32_bf16 v[180:183], a[180:183], v[52:55], v[180:183]
    s_waitcnt lgkmcnt(1)
    v_cvt_pk_bf16_f32 v62, v124, v125
    v_xor_b32 v19, 98304, v19
    v_mfma_f32_16x16x32_bf16 v[152:155], a[184:187], v[48:51], v[152:155]
    v_exp_f32 v126, v126
    v_mfma_f32_16x16x32_bf16 v[184:187], a[184:187], v[52:55], v[184:187]
    s_waitcnt lgkmcnt(0)
    v_xor_b32 v20, 98304, v20
    v_mfma_f32_16x16x32_bf16 v[156:159], a[188:191], v[48:51], v[156:159]
    v_exp_f32 v127, v127
    v_mfma_f32_16x16x32_bf16 v[188:191], a[188:191], v[52:55], v[188:191]
    v_cvt_pk_bf16_f32 v63, v126, v127
    v_mfma_f32_16x16x32_bf16 v[112:115], a[128:131], a[224:227], v[72:75]
    s_add_u32 s17, s17, 4096
    v_exp_f32 v96, v96
    v_mfma_f32_16x16x32_bf16 v[112:115], a[132:135], a[228:231], v[112:115]
    buffer_store_dwordx4 a[12:15], v12, s[8:11], s17 offen sc0 sc1
    v_mfma_f32_16x16x32_bf16 v[112:115], a[136:139], a[232:235], v[112:115]
    s_add_u32 s27, s18, 8388608
    v_exp_f32 v97, v97
    v_mfma_f32_16x16x32_bf16 v[112:115], a[140:143], a[236:239], v[112:115]
    v_cvt_pk_bf16_f32 v48, v96, v97
    v_lshl_add_u32 v8, v8, 10, v9
    v_mfma_f32_16x16x32_bf16 v[120:123], a[128:131], a[240:243], v[76:79]
    v_exp_f32 v98, v98
    v_mfma_f32_16x16x32_bf16 v[120:123], a[132:135], a[244:247], v[120:123]
    buffer_store_dwordx4 v[24:27], v17, s[8:11], s27 offen offset:256 sc0 sc1
    v_mfma_f32_16x16x32_bf16 v[120:123], a[136:139], a[248:251], v[120:123]
    s_add_u32 s27, s18, 8519680
    v_exp_f32 v99, v99
    v_mfma_f32_16x16x32_bf16 v[120:123], a[140:143], a[252:255], v[120:123]
    buffer_store_dwordx4 v[24:27], v17, s[8:11], s27 offen offset:256 sc0 sc1
    v_mfma_f32_16x16x32_bf16 v[116:119], a[144:147], a[224:227], v[72:75]
    s_add_u32 s27, s18, 8388608
    v_exp_f32 v100, v100
    v_mfma_f32_16x16x32_bf16 v[116:119], a[148:151], a[228:231], v[116:119]
    ds_read_b128 a[128:131], v18 offset:16384
    v_cvt_pk_bf16_f32 v49, v98, v99
    v_mfma_f32_16x16x32_bf16 v[116:119], a[152:155], a[232:235], v[116:119]
    s_add_u32 s19, s82, 32768
    v_exp_f32 v101, v101
    v_mfma_f32_16x16x32_bf16 v[116:119], a[156:159], a[236:239], v[116:119]
    s_sub_u32 s82, s12, s13
    ds_read_b128 a[132:135], v18 offset:17408
    v_cvt_pk_bf16_f32 v50, v100, v101
    v_mfma_f32_16x16x32_bf16 v[124:127], a[144:147], a[240:243], v[76:79]
    s_sub_u32 s82, s82, 1
    v_exp_f32 v102, v102
    v_mfma_f32_16x16x32_bf16 v[124:127], a[148:151], a[244:247], v[124:127]
    s_cmp_gt_u32 s12, s13
    s_cselect_b32 s82, s82, s12
    s_lshl_b32 s82, s82, 16
    ds_read_b128 a[136:139], v18 offset:18432
    v_mfma_f32_16x16x32_bf16 v[124:127], a[152:155], a[248:251], v[124:127]
    s_add_u32 s82, s82, s81
    v_exp_f32 v103, v103
    v_mfma_f32_16x16x32_bf16 v[124:127], a[156:159], a[252:255], v[124:127]
    s_cmp_ge_u32 s12, 17
    s_cselect_b32 s82, 2147471360, s82
    ds_read_b128 a[140:143], v18 offset:19456
    v_cvt_pk_bf16_f32 v51, v102, v103
    v_mfma_f32_16x16x32_bf16 v[40:43], v[28:31], v[56:59], v[40:43]
    s_add_u32 s12, s12, 1
    v_exp_f32 v104, v104
    v_mfma_f32_16x16x32_bf16 v[44:47], v[28:31], v[60:63], v[44:47]
    ds_read_b128 a[144:147], v18 offset:20480
    v_bfe_u32 v4, v2, 1, 2
    v_mfma_f32_16x16x32_bf16 v[192:195], a[160:163], v[56:59], v[192:195]
    v_exp_f32 v105, v105
    v_mfma_f32_16x16x32_bf16 v[224:227], a[160:163], v[60:63], v[224:227]
    ds_read_b128 a[148:151], v18 offset:21504
    v_cvt_pk_bf16_f32 v52, v104, v105
    v_mfma_f32_16x16x32_bf16 v[196:199], a[164:167], v[56:59], v[196:199]
    v_exp_f32 v106, v106
    v_mfma_f32_16x16x32_bf16 v[228:231], a[164:167], v[60:63], v[228:231]
    ds_read_b128 a[152:155], v18 offset:22528
    v_lshlrev_b32 v4, 11, v4
    v_mfma_f32_16x16x32_bf16 v[200:203], a[168:171], v[56:59], v[200:203]
    v_exp_f32 v107, v107
    v_mfma_f32_16x16x32_bf16 v[232:235], a[168:171], v[60:63], v[232:235]
    ds_read_b128 a[156:159], v18 offset:23552
    v_cvt_pk_bf16_f32 v53, v106, v107
    v_mfma_f32_16x16x32_bf16 v[204:207], a[172:175], v[56:59], v[204:207]
    v_exp_f32 v108, v108
    v_mfma_f32_16x16x32_bf16 v[236:239], a[172:175], v[60:63], v[236:239]
    buffer_store_dwordx4 v[24:27], v17, s[8:11], s27 offen offset:512 sc0 sc1
    v_mfma_f32_16x16x32_bf16 v[208:211], a[176:179], v[56:59], v[208:211]
    s_add_u32 s27, s18, 8519680
    v_exp_f32 v109, v109
    v_mfma_f32_16x16x32_bf16 v[240:243], a[176:179], v[60:63], v[240:243]
    v_cvt_pk_bf16_f32 v54, v108, v109
    v_xor_b32 v18, 196608, v18
    v_mfma_f32_16x16x32_bf16 v[212:215], a[180:183], v[56:59], v[212:215]
    v_exp_f32 v110, v110
    v_mfma_f32_16x16x32_bf16 v[244:247], a[180:183], v[60:63], v[244:247]
    buffer_store_dwordx4 v[24:27], v17, s[8:11], s27 offen offset:512 sc0 sc1
    v_mfma_f32_16x16x32_bf16 v[216:219], a[184:187], v[56:59], v[216:219]
    v_exp_f32 v111, v111
    v_mfma_f32_16x16x32_bf16 v[248:251], a[184:187], v[60:63], v[248:251]
    v_cvt_pk_bf16_f32 v55, v110, v111
    v_lshl_add_u32 v4, v10, 6, v4
    v_mfma_f32_16x16x32_bf16 v[220:223], a[188:191], v[56:59], v[220:223]
    v_add_u32 v9, 7168, v8
    v_add_u32 v10, 14336, v8
    v_mfma_f32_16x16x32_bf16 v[252:255], a[188:191], v[60:63], v[252:255]
    v_add_u32 v11, 21504, v8
    s_waitcnt vmcnt(9) lgkmcnt(0)
    s_barrier
    v_mfma_f32_16x16x32_bf16 v[96:99], a[128:131], a[192:195], v[64:67]
    s_add_u32 m0, s15, 0
    ds_read_b128 a[160:163], v19 offset:0
    v_mfma_f32_16x16x32_bf16 v[96:99], a[132:135], a[196:199], v[96:99]
    ds_read_b128 a[164:167], v19 offset:1024
    v_mfma_f32_16x16x32_bf16 v[96:99], a[136:139], a[200:203], v[96:99]
    v_exp_f32 v112, v112
    v_mfma_f32_16x16x32_bf16 v[96:99], a[140:143], a[204:207], v[96:99]
    buffer_load_dwordx4 v1, s[8:11], s82 offen offset:0 lds
    v_mfma_f32_16x16x32_bf16 v[104:107], a[128:131], a[208:211], v[68:71]
    v_exp_f32 v113, v113
    v_mfma_f32_16x16x32_bf16 v[104:107], a[132:135], a[212:215], v[104:107]
    ds_read_b128 a[168:171], v19 offset:2048
    v_cvt_pk_bf16_f32 v56, v112, v113
    v_mfma_f32_16x16x32_bf16 v[104:107], a[136:139], a[216:219], v[104:107]
    v_exp_f32 v114, v114
    v_mfma_f32_16x16x32_bf16 v[104:107], a[140:143], a[220:223], v[104:107]
    buffer_load_dwordx4 v1, s[8:11], s82 offen offset:1024 lds
    v_mfma_f32_16x16x32_bf16 v[100:103], a[144:147], a[192:195], v[64:67]
    v_exp_f32 v115, v115
    v_mfma_f32_16x16x32_bf16 v[100:103], a[148:151], a[196:199], v[100:103]
    ds_read_b128 a[172:175], v19 offset:3072
    v_cvt_pk_bf16_f32 v57, v114, v115
    v_mfma_f32_16x16x32_bf16 v[100:103], a[152:155], a[200:203], v[100:103]
    v_exp_f32 v116, v116
    v_mfma_f32_16x16x32_bf16 v[100:103], a[156:159], a[204:207], v[100:103]
    buffer_load_dwordx4 v1, s[8:11], s82 offen offset:2048 lds
    v_mfma_f32_16x16x32_bf16 v[108:111], a[144:147], a[208:211], v[68:71]
    v_exp_f32 v117, v117
    v_mfma_f32_16x16x32_bf16 v[108:111], a[148:151], a[212:215], v[108:111]
    ds_read_b128 a[176:179], v20 offset:4096
    v_cvt_pk_bf16_f32 v58, v116, v117
    v_mfma_f32_16x16x32_bf16 v[108:111], a[152:155], a[216:219], v[108:111]
    v_exp_f32 v118, v118
    v_mfma_f32_16x16x32_bf16 v[108:111], a[156:159], a[220:223], v[108:111]
    buffer_load_dwordx4 v1, s[8:11], s82 offen offset:3072 lds
    v_mfma_f32_16x16x32_bf16 v[32:35], v[28:31], v[48:51], v[32:35]
    s_add_u32 m0, s15, 4096
    v_exp_f32 v119, v119
    v_mfma_f32_16x16x32_bf16 v[36:39], v[28:31], v[52:55], v[36:39]
    s_waitcnt lgkmcnt(4)
    ds_read_b128 a[180:183], v20 offset:5120
    v_cvt_pk_bf16_f32 v59, v118, v119
    v_mfma_f32_16x16x32_bf16 v[128:131], a[160:163], v[48:51], v[128:131]
    v_exp_f32 v120, v120
    v_mfma_f32_16x16x32_bf16 v[160:163], a[160:163], v[52:55], v[160:163]
    s_waitcnt lgkmcnt(4)
    v_mfma_f32_16x16x32_bf16 v[132:135], a[164:167], v[48:51], v[132:135]
    v_exp_f32 v121, v121
    v_mfma_f32_16x16x32_bf16 v[164:167], a[164:167], v[52:55], v[164:167]
    s_waitcnt lgkmcnt(3)
    ds_read_b128 a[184:187], v20 offset:6144
    v_cvt_pk_bf16_f32 v60, v120, v121
    v_mfma_f32_16x16x32_bf16 v[136:139], a[168:171], v[48:51], v[136:139]
    s_waitcnt lgkmcnt(3)
    v_exp_f32 v122, v122
    v_mfma_f32_16x16x32_bf16 v[168:171], a[168:171], v[52:55], v[168:171]
    buffer_load_dwordx4 v15, s[8:11], s82 offen offset:0 lds
    v_mfma_f32_16x16x32_bf16 v[140:143], a[172:175], v[48:51], v[140:143]
    v_exp_f32 v123, v123
    v_mfma_f32_16x16x32_bf16 v[172:175], a[172:175], v[52:55], v[172:175]
    s_waitcnt lgkmcnt(2)
    ds_read_b128 a[188:191], v20 offset:7168
    v_cvt_pk_bf16_f32 v61, v122, v123
    v_mfma_f32_16x16x32_bf16 v[144:147], a[176:179], v[48:51], v[144:147]
    s_waitcnt lgkmcnt(2)
    v_exp_f32 v124, v124
    v_mfma_f32_16x16x32_bf16 v[176:179], a[176:179], v[52:55], v[176:179]
    buffer_load_dwordx4 v15, s[8:11], s82 offen offset:1024 lds
    v_mfma_f32_16x16x32_bf16 v[148:151], a[180:183], v[48:51], v[148:151]
    v_exp_f32 v125, v125
    v_mfma_f32_16x16x32_bf16 v[180:183], a[180:183], v[52:55], v[180:183]
    s_waitcnt lgkmcnt(1)
    v_cvt_pk_bf16_f32 v62, v124, v125
    v_mfma_f32_16x16x32_bf16 v[152:155], a[184:187], v[48:51], v[152:155]
    s_waitcnt lgkmcnt(0)
    v_exp_f32 v126, v126
    v_mfma_f32_16x16x32_bf16 v[184:187], a[184:187], v[52:55], v[184:187]
    buffer_load_dwordx4 v15, s[8:11], s82 offen offset:2048 lds
    v_mfma_f32_16x16x32_bf16 v[156:159], a[188:191], v[48:51], v[156:159]
    v_exp_f32 v127, v127
    v_mfma_f32_16x16x32_bf16 v[188:191], a[188:191], v[52:55], v[188:191]
    v_cvt_pk_bf16_f32 v63, v126, v127
    v_mfma_f32_16x16x32_bf16 v[112:115], a[128:131], a[224:227], v[72:75]
    v_mfma_f32_16x16x32_bf16 v[112:115], a[132:135], a[228:231], v[112:115]
    v_mfma_f32_16x16x32_bf16 v[112:115], a[136:139], a[232:235], v[112:115]
    v_exp_f32 v96, v96
    v_mfma_f32_16x16x32_bf16 v[112:115], a[140:143], a[236:239], v[112:115]
    buffer_load_dwordx4 v15, s[8:11], s82 offen offset:3072 lds
    v_mfma_f32_16x16x32_bf16 v[120:123], a[128:131], a[240:243], v[76:79]
    s_xor_b32 s15, s15, 196608
    v_exp_f32 v97, v97
    v_mfma_f32_16x16x32_bf16 v[120:123], a[132:135], a[244:247], v[120:123]
    s_add_u32 m0, s16, 0
    ds_read_b128 a[128:131], v18 offset:0
    v_cvt_pk_bf16_f32 v48, v96, v97
    v_mfma_f32_16x16x32_bf16 v[120:123], a[136:139], a[248:251], v[120:123]
    v_exp_f32 v98, v98
    v_mfma_f32_16x16x32_bf16 v[120:123], a[140:143], a[252:255], v[120:123]
    buffer_load_dwordx4 v1, s[8:11], s19 offen offset:0 lds
    v_mfma_f32_16x16x32_bf16 v[116:119], a[144:147], a[224:227], v[72:75]
    v_exp_f32 v99, v99
    v_mfma_f32_16x16x32_bf16 v[116:119], a[148:151], a[228:231], v[116:119]
    ds_read_b128 a[132:135], v18 offset:1024
    v_cvt_pk_bf16_f32 v49, v98, v99
    v_mfma_f32_16x16x32_bf16 v[116:119], a[152:155], a[232:235], v[116:119]
    v_exp_f32 v100, v100
    v_mfma_f32_16x16x32_bf16 v[116:119], a[156:159], a[236:239], v[116:119]
    buffer_load_dwordx4 v1, s[8:11], s19 offen offset:1024 lds
    v_mfma_f32_16x16x32_bf16 v[124:127], a[144:147], a[240:243], v[76:79]
    v_exp_f32 v101, v101
    v_mfma_f32_16x16x32_bf16 v[124:127], a[148:151], a[244:247], v[124:127]
    ds_read_b128 a[136:139], v18 offset:2048
    v_cvt_pk_bf16_f32 v50, v100, v101
    v_mfma_f32_16x16x32_bf16 v[124:127], a[152:155], a[248:251], v[124:127]
    v_exp_f32 v102, v102
    v_mfma_f32_16x16x32_bf16 v[124:127], a[156:159], a[252:255], v[124:127]
    buffer_load_dwordx4 v1, s[8:11], s19 offen offset:2048 lds
    v_mfma_f32_16x16x32_bf16 v[40:43], v[28:31], v[56:59], v[40:43]
    v_exp_f32 v103, v103
    v_mfma_f32_16x16x32_bf16 v[44:47], v[28:31], v[60:63], v[44:47]
    ds_read_b128 a[140:143], v18 offset:3072
    v_cvt_pk_bf16_f32 v51, v102, v103
    v_mfma_f32_16x16x32_bf16 v[192:195], a[160:163], v[56:59], v[192:195]
    v_exp_f32 v104, v104
    v_mfma_f32_16x16x32_bf16 v[224:227], a[160:163], v[60:63], v[224:227]
    v_mfma_f32_16x16x32_bf16 v[196:199], a[164:167], v[56:59], v[196:199]
    v_exp_f32 v105, v105
    v_mfma_f32_16x16x32_bf16 v[228:231], a[164:167], v[60:63], v[228:231]
    ds_read_b128 a[144:147], v18 offset:4096
    v_cvt_pk_bf16_f32 v52, v104, v105
    v_mfma_f32_16x16x32_bf16 v[200:203], a[168:171], v[56:59], v[200:203]
    v_exp_f32 v106, v106
    v_mfma_f32_16x16x32_bf16 v[232:235], a[168:171], v[60:63], v[232:235]
    buffer_load_dwordx4 v1, s[8:11], s19 offen offset:3072 lds
    v_mfma_f32_16x16x32_bf16 v[204:207], a[172:175], v[56:59], v[204:207]
    s_add_u32 m0, s16, 4096
    v_exp_f32 v107, v107
    v_mfma_f32_16x16x32_bf16 v[236:239], a[172:175], v[60:63], v[236:239]
    ds_read_b128 a[148:151], v18 offset:5120
    v_cvt_pk_bf16_f32 v53, v106, v107
    v_mfma_f32_16x16x32_bf16 v[208:211], a[176:179], v[56:59], v[208:211]
    v_exp_f32 v108, v108
    v_mfma_f32_16x16x32_bf16 v[240:243], a[176:179], v[60:63], v[240:243]
    buffer_load_dwordx4 v15, s[8:11], s19 offen offset:0 lds
    v_mfma_f32_16x16x32_bf16 v[212:215], a[180:183], v[56:59], v[212:215]
    v_exp_f32 v109, v109
    v_mfma_f32_16x16x32_bf16 v[244:247], a[180:183], v[60:63], v[244:247]
    ds_read_b128 a[152:155], v18 offset:6144
    v_cvt_pk_bf16_f32 v54, v108, v109
    v_mfma_f32_16x16x32_bf16 v[216:219], a[184:187], v[56:59], v[216:219]
    v_exp_f32 v110, v110
    v_mfma_f32_16x16x32_bf16 v[248:251], a[184:187], v[60:63], v[248:251]
    buffer_load_dwordx4 v15, s[8:11], s19 offen offset:1024 lds
    v_mfma_f32_16x16x32_bf16 v[220:223], a[188:191], v[56:59], v[220:223]
    v_exp_f32 v111, v111
    v_mfma_f32_16x16x32_bf16 v[252:255], a[188:191], v[60:63], v[252:255]
    ds_read_b128 a[156:159], v18 offset:7168
    v_cvt_pk_bf16_f32 v55, v110, v111
    s_waitcnt lgkmcnt(7)
    v_mfma_f32_16x16x32_bf16 v[96:99], a[128:131], a[192:195], v[64:67]
    s_waitcnt lgkmcnt(6)
    s_mul_i32 s17, s4, 229376
    s_mul_i32 s100, s3, 7168
    ds_read_b128 a[160:163], v19 offset:16384
    v_mfma_f32_16x16x32_bf16 v[96:99], a[132:135], a[196:199], v[96:99]
    s_waitcnt lgkmcnt(6)
    s_add_u32 s17, s17, s100
    s_lshl_b32 s100, s101, 7
    ds_read_b128 a[164:167], v19 offset:17408
    v_mfma_f32_16x16x32_bf16 v[96:99], a[136:139], a[200:203], v[96:99]
    s_waitcnt lgkmcnt(6)
    s_add_u32 s17, s17, s100
    v_exp_f32 v112, v112
    v_mfma_f32_16x16x32_bf16 v[96:99], a[140:143], a[204:207], v[96:99]
    buffer_load_dwordx4 v15, s[8:11], s19 offen offset:2048 lds
    v_mfma_f32_16x16x32_bf16 v[104:107], a[128:131], a[208:211], v[68:71]
    s_add_u32 s17, s17, 8388608
    v_exp_f32 v113, v113
    v_mfma_f32_16x16x32_bf16 v[104:107], a[132:135], a[212:215], v[104:107]
    s_cmp_lt_u32 s101, s26
    s_cselect_b32 s17, s17, 2147479552
    ds_read_b128 a[168:171], v19 offset:18432
    v_cvt_pk_bf16_f32 v56, v112, v113
    v_mfma_f32_16x16x32_bf16 v[104:107], a[136:139], a[216:219], v[104:107]
    s_waitcnt lgkmcnt(6)
    v_exp_f32 v114, v114
    v_mfma_f32_16x16x32_bf16 v[104:107], a[140:143], a[220:223], v[104:107]
    buffer_load_dwordx4 v15, s[8:11], s19 offen offset:3072 lds
    v_mfma_f32_16x16x32_bf16 v[100:103], a[144:147], a[192:195], v[64:67]
    s_waitcnt lgkmcnt(5)
    s_xor_b32 s16, s16, 98304
    v_exp_f32 v115, v115
    v_mfma_f32_16x16x32_bf16 v[100:103], a[148:151], a[196:199], v[100:103]
    s_waitcnt lgkmcnt(4)
    ds_read_b128 a[172:175], v19 offset:19456
    v_cvt_pk_bf16_f32 v57, v114, v115
    v_mfma_f32_16x16x32_bf16 v[100:103], a[152:155], a[200:203], v[100:103]
    s_waitcnt lgkmcnt(4)
    v_exp_f32 v116, v116
    v_mfma_f32_16x16x32_bf16 v[100:103], a[156:159], a[204:207], v[100:103]
    buffer_store_dwordx4 a[16:19], v13, s[8:11], s17 offen sc0 sc1
    v_mfma_f32_16x16x32_bf16 v[108:111], a[144:147], a[208:211], v[68:71]
    s_add_u32 s27, s18, 8388608
    v_exp_f32 v117, v117
    v_mfma_f32_16x16x32_bf16 v[108:111], a[148:151], a[212:215], v[108:111]
    ds_read_b128 a[176:179], v20 offset:20480
    v_cvt_pk_bf16_f32 v58, v116, v117
    v_mfma_f32_16x16x32_bf16 v[108:111], a[152:155], a[216:219], v[108:111]
    v_exp_f32 v118, v118
    v_mfma_f32_16x16x32_bf16 v[108:111], a[156:159], a[220:223], v[108:111]
    buffer_store_dwordx4 v[24:27], v17, s[8:11], s27 offen offset:768 sc0 sc1
    v_mfma_f32_16x16x32_bf16 v[32:35], v[28:31], v[48:51], v[32:35]
    s_add_u32 s27, s18, 8519680
    v_exp_f32 v119, v119
    v_mfma_f32_16x16x32_bf16 v[36:39], v[28:31], v[52:55], v[36:39]
    s_waitcnt lgkmcnt(4)
    ds_read_b128 a[180:183], v20 offset:21504
    v_cvt_pk_bf16_f32 v59, v118, v119
    v_mfma_f32_16x16x32_bf16 v[128:131], a[160:163], v[48:51], v[128:131]
    s_waitcnt lgkmcnt(4)
    v_exp_f32 v120, v120
    v_mfma_f32_16x16x32_bf16 v[160:163], a[160:163], v[52:55], v[160:163]
    buffer_store_dwordx4 v[24:27], v17, s[8:11], s27 offen offset:768 sc0 sc1
    v_mfma_f32_16x16x32_bf16 v[132:135], a[164:167], v[48:51], v[132:135]
    v_exp_f32 v121, v121
    v_mfma_f32_16x16x32_bf16 v[164:167], a[164:167], v[52:55], v[164:167]
    s_waitcnt lgkmcnt(3)
    ds_read_b128 a[184:187], v20 offset:22528
    v_cvt_pk_bf16_f32 v60, v120, v121
    v_mfma_f32_16x16x32_bf16 v[136:139], a[168:171], v[48:51], v[136:139]
    s_waitcnt lgkmcnt(3)
    v_exp_f32 v122, v122
    v_mfma_f32_16x16x32_bf16 v[168:171], a[168:171], v[52:55], v[168:171]
    buffer_load_dword v3, v4, s[8:11], s23 offen sc0 sc1
    v_mfma_f32_16x16x32_bf16 v[140:143], a[172:175], v[48:51], v[140:143]
    v_exp_f32 v123, v123
    v_mfma_f32_16x16x32_bf16 v[172:175], a[172:175], v[52:55], v[172:175]
    s_waitcnt lgkmcnt(2)
    ds_read_b128 a[188:191], v20 offset:23552
    v_cvt_pk_bf16_f32 v61, v122, v123
    v_mfma_f32_16x16x32_bf16 v[144:147], a[176:179], v[48:51], v[144:147]
    v_exp_f32 v124, v124
    v_mfma_f32_16x16x32_bf16 v[176:179], a[176:179], v[52:55], v[176:179]
    s_waitcnt lgkmcnt(2)
    v_mfma_f32_16x16x32_bf16 v[148:151], a[180:183], v[48:51], v[148:151]
    v_exp_f32 v125, v125
    v_mfma_f32_16x16x32_bf16 v[180:183], a[180:183], v[52:55], v[180:183]
    s_waitcnt lgkmcnt(1)
    v_cvt_pk_bf16_f32 v62, v124, v125
    v_xor_b32 v19, 98304, v19
    v_mfma_f32_16x16x32_bf16 v[152:155], a[184:187], v[48:51], v[152:155]
    v_exp_f32 v126, v126
    v_mfma_f32_16x16x32_bf16 v[184:187], a[184:187], v[52:55], v[184:187]
    s_waitcnt lgkmcnt(0)
    v_xor_b32 v20, 98304, v20
    v_mfma_f32_16x16x32_bf16 v[156:159], a[188:191], v[48:51], v[156:159]
    v_exp_f32 v127, v127
    v_mfma_f32_16x16x32_bf16 v[188:191], a[188:191], v[52:55], v[188:191]
    v_cvt_pk_bf16_f32 v63, v126, v127
    v_mfma_f32_16x16x32_bf16 v[112:115], a[128:131], a[224:227], v[72:75]
    v_exp_f32 v96, v96
    v_mfma_f32_16x16x32_bf16 v[112:115], a[132:135], a[228:231], v[112:115]
    buffer_store_dwordx4 a[20:23], v13, s[8:11], s17 offen offset:3584 sc0 sc1
    v_mfma_f32_16x16x32_bf16 v[112:115], a[136:139], a[232:235], v[112:115]
    v_exp_f32 v97, v97
    v_mfma_f32_16x16x32_bf16 v[112:115], a[140:143], a[236:239], v[112:115]
    v_cvt_pk_bf16_f32 v48, v96, v97
    v_lshlrev_b32 v12, 3, v0
    v_mfma_f32_16x16x32_bf16 v[120:123], a[128:131], a[240:243], v[76:79]
    s_lshl_b32 s101, s2, 11
    v_exp_f32 v98, v98
    v_mfma_f32_16x16x32_bf16 v[120:123], a[132:135], a[244:247], v[120:123]
    v_add_f32 v80, 0, v21
    v_min_f32 v80, v80, v64
    v_mfma_f32_16x16x32_bf16 v[120:123], a[136:139], a[248:251], v[120:123]
    s_add_u32 s101, s101, 524288
    v_exp_f32 v99, v99
    v_mfma_f32_16x16x32_bf16 v[120:123], a[140:143], a[252:255], v[120:123]
    buffer_store_dwordx2 v[24:25], v12, s[8:11], s101 offen sc0 sc1
    v_mfma_f32_16x16x32_bf16 v[116:119], a[144:147], a[224:227], v[72:75]
    s_lshl_b32 s101, s2, 6
    v_exp_f32 v100, v100
    v_mfma_f32_16x16x32_bf16 v[116:119], a[148:151], a[228:231], v[116:119]
    s_add_u32 s101, s101, 65536
    ds_read_b128 a[128:131], v18 offset:16384
    v_cvt_pk_bf16_f32 v49, v98, v99
    v_mfma_f32_16x16x32_bf16 v[116:119], a[152:155], a[232:235], v[116:119]
    s_add_u32 s19, s82, 32768
    v_exp_f32 v101, v101
    v_mfma_f32_16x16x32_bf16 v[116:119], a[156:159], a[236:239], v[116:119]
    s_sub_u32 s82, s12, s13
    ds_read_b128 a[132:135], v18 offset:17408
    v_cvt_pk_bf16_f32 v50, v100, v101
    v_mfma_f32_16x16x32_bf16 v[124:127], a[144:147], a[240:243], v[76:79]
    s_sub_u32 s82, s82, 1
    v_exp_f32 v102, v102
    v_mfma_f32_16x16x32_bf16 v[124:127], a[148:151], a[244:247], v[124:127]
    s_cmp_gt_u32 s12, s13
    s_cselect_b32 s82, s82, s12
    s_lshl_b32 s82, s82, 16
    ds_read_b128 a[136:139], v18 offset:18432
    v_mfma_f32_16x16x32_bf16 v[124:127], a[152:155], a[248:251], v[124:127]
    s_add_u32 s82, s82, s81
    v_exp_f32 v103, v103
    v_mfma_f32_16x16x32_bf16 v[124:127], a[156:159], a[252:255], v[124:127]
    s_cmp_ge_u32 s12, 17
    s_cselect_b32 s82, 2147471360, s82
    ds_read_b128 a[140:143], v18 offset:19456
    v_cvt_pk_bf16_f32 v51, v102, v103
    v_mfma_f32_16x16x32_bf16 v[40:43], v[28:31], v[56:59], v[40:43]
    s_add_u32 s12, s12, 1
    v_exp_f32 v104, v104
    v_mfma_f32_16x16x32_bf16 v[44:47], v[28:31], v[60:63], v[44:47]
    ds_read_b128 a[144:147], v18 offset:20480
    v_mov_b32 v13, 0
    v_mfma_f32_16x16x32_bf16 v[192:195], a[160:163], v[56:59], v[192:195]
    v_exp_f32 v105, v105
    v_mfma_f32_16x16x32_bf16 v[224:227], a[160:163], v[60:63], v[224:227]
    ds_read_b128 a[148:151], v18 offset:21504
    v_cvt_pk_bf16_f32 v52, v104, v105
    v_mfma_f32_16x16x32_bf16 v[196:199], a[164:167], v[56:59], v[196:199]
    v_exp_f32 v106, v106
    v_mfma_f32_16x16x32_bf16 v[228:231], a[164:167], v[60:63], v[228:231]
    ds_read_b128 a[152:155], v18 offset:22528
    v_add_f32 v81, 0xf1800000, v21
    v_mfma_f32_16x16x32_bf16 v[200:203], a[168:171], v[56:59], v[200:203]
    v_exp_f32 v107, v107
    v_mfma_f32_16x16x32_bf16 v[232:235], a[168:171], v[60:63], v[232:235]
    ds_read_b128 a[156:159], v18 offset:23552
    v_cvt_pk_bf16_f32 v53, v106, v107
    v_mfma_f32_16x16x32_bf16 v[204:207], a[172:175], v[56:59], v[204:207]
    v_exp_f32 v108, v108
    v_mfma_f32_16x16x32_bf16 v[236:239], a[172:175], v[60:63], v[236:239]
    buffer_store_dword v13, v7, s[8:11], s101 offen sc0 sc1
    v_mfma_f32_16x16x32_bf16 v[208:211], a[176:179], v[56:59], v[208:211]
    s_lshl_b32 s101, s66, 6
    v_exp_f32 v109, v109
    v_mfma_f32_16x16x32_bf16 v[240:243], a[176:179], v[60:63], v[240:243]
    s_add_u32 s101, s101, 81920
    v_cvt_pk_bf16_f32 v54, v108, v109
    v_xor_b32 v18, 196608, v18
    v_mfma_f32_16x16x32_bf16 v[212:215], a[180:183], v[56:59], v[212:215]
    v_exp_f32 v110, v110
    v_mfma_f32_16x16x32_bf16 v[244:247], a[180:183], v[60:63], v[244:247]
    buffer_store_dwordx4 v[24:27], v7, s[8:11], s101 offen sc0 sc1
    v_mfma_f32_16x16x32_bf16 v[216:219], a[184:187], v[56:59], v[216:219]
    v_exp_f32 v111, v111
    v_mfma_f32_16x16x32_bf16 v[248:251], a[184:187], v[60:63], v[248:251]
    v_cvt_pk_bf16_f32 v55, v110, v111
    v_min_f32 v81, v81, v65
    v_mfma_f32_16x16x32_bf16 v[220:223], a[188:191], v[56:59], v[220:223]
    buffer_store_dwordx4 v[24:27], v7, s[8:11], s101 offen offset:16 sc0 sc1
    v_mfma_f32_16x16x32_bf16 v[252:255], a[188:191], v[60:63], v[252:255]
    v_add_f32 v82, 0xf2000000, v21
    v_min_f32 v82, v82, v66
    s_waitcnt vmcnt(9) lgkmcnt(0)
    s_barrier
    v_mfma_f32_16x16x32_bf16 v[96:99], a[128:131], a[192:195], v[64:67]
    s_add_u32 m0, s15, 0
    ds_read_b128 a[160:163], v19 offset:0
    v_mfma_f32_16x16x32_bf16 v[96:99], a[132:135], a[196:199], v[96:99]
    ds_read_b128 a[164:167], v19 offset:1024
    v_mfma_f32_16x16x32_bf16 v[96:99], a[136:139], a[200:203], v[96:99]
    v_exp_f32 v112, v112
    v_mfma_f32_16x16x32_bf16 v[96:99], a[140:143], a[204:207], v[96:99]
    buffer_load_dwordx4 v1, s[8:11], s82 offen offset:0 lds
    v_mfma_f32_16x16x32_bf16 v[104:107], a[128:131], a[208:211], v[68:71]
    v_exp_f32 v113, v113
    v_mfma_f32_16x16x32_bf16 v[104:107], a[132:135], a[212:215], v[104:107]
    ds_read_b128 a[168:171], v19 offset:2048
    v_cvt_pk_bf16_f32 v56, v112, v113
    v_mfma_f32_16x16x32_bf16 v[104:107], a[136:139], a[216:219], v[104:107]
    v_exp_f32 v114, v114
    v_mfma_f32_16x16x32_bf16 v[104:107], a[140:143], a[220:223], v[104:107]
    buffer_load_dwordx4 v1, s[8:11], s82 offen offset:1024 lds
    v_mfma_f32_16x16x32_bf16 v[100:103], a[144:147], a[192:195], v[64:67]
    v_exp_f32 v115, v115
    v_mfma_f32_16x16x32_bf16 v[100:103], a[148:151], a[196:199], v[100:103]
    ds_read_b128 a[172:175], v19 offset:3072
    v_cvt_pk_bf16_f32 v57, v114, v115
    v_mfma_f32_16x16x32_bf16 v[100:103], a[152:155], a[200:203], v[100:103]
    v_exp_f32 v116, v116
    v_mfma_f32_16x16x32_bf16 v[100:103], a[156:159], a[204:207], v[100:103]
    buffer_load_dwordx4 v1, s[8:11], s82 offen offset:2048 lds
    v_mfma_f32_16x16x32_bf16 v[108:111], a[144:147], a[208:211], v[68:71]
    v_exp_f32 v117, v117
    v_mfma_f32_16x16x32_bf16 v[108:111], a[148:151], a[212:215], v[108:111]
    ds_read_b128 a[176:179], v20 offset:4096
    v_cvt_pk_bf16_f32 v58, v116, v117
    v_mfma_f32_16x16x32_bf16 v[108:111], a[152:155], a[216:219], v[108:111]
    v_exp_f32 v118, v118
    v_mfma_f32_16x16x32_bf16 v[108:111], a[156:159], a[220:223], v[108:111]
    buffer_load_dwordx4 v1, s[8:11], s82 offen offset:3072 lds
    v_mfma_f32_16x16x32_bf16 v[32:35], v[28:31], v[48:51], v[32:35]
    s_add_u32 m0, s15, 4096
    v_exp_f32 v119, v119
    v_mfma_f32_16x16x32_bf16 v[36:39], v[28:31], v[52:55], v[36:39]
    s_waitcnt lgkmcnt(4)
    ds_read_b128 a[180:183], v20 offset:5120
    v_cvt_pk_bf16_f32 v59, v118, v119
    v_mfma_f32_16x16x32_bf16 v[128:131], a[160:163], v[48:51], v[128:131]
    v_exp_f32 v120, v120
    v_mfma_f32_16x16x32_bf16 v[160:163], a[160:163], v[52:55], v[160:163]
    s_waitcnt lgkmcnt(4)
    v_mfma_f32_16x16x32_bf16 v[132:135], a[164:167], v[48:51], v[132:135]
    v_exp_f32 v121, v121
    v_mfma_f32_16x16x32_bf16 v[164:167], a[164:167], v[52:55], v[164:167]
    s_waitcnt lgkmcnt(3)
    ds_read_b128 a[184:187], v20 offset:6144
    v_cvt_pk_bf16_f32 v60, v120, v121
    v_mfma_f32_16x16x32_bf16 v[136:139], a[168:171], v[48:51], v[136:139]
    s_waitcnt lgkmcnt(3)
    v_exp_f32 v122, v122
    v_mfma_f32_16x16x32_bf16 v[168:171], a[168:171], v[52:55], v[168:171]
    buffer_load_dwordx4 v15, s[8:11], s82 offen offset:0 lds
    v_mfma_f32_16x16x32_bf16 v[140:143], a[172:175], v[48:51], v[140:143]
    v_exp_f32 v123, v123
    v_mfma_f32_16x16x32_bf16 v[172:175], a[172:175], v[52:55], v[172:175]
    s_waitcnt lgkmcnt(2)
    ds_read_b128 a[188:191], v20 offset:7168
    v_cvt_pk_bf16_f32 v61, v122, v123
    v_mfma_f32_16x16x32_bf16 v[144:147], a[176:179], v[48:51], v[144:147]
    s_waitcnt lgkmcnt(2)
    v_exp_f32 v124, v124
    v_mfma_f32_16x16x32_bf16 v[176:179], a[176:179], v[52:55], v[176:179]
    buffer_load_dwordx4 v15, s[8:11], s82 offen offset:1024 lds
    v_mfma_f32_16x16x32_bf16 v[148:151], a[180:183], v[48:51], v[148:151]
    v_exp_f32 v125, v125
    v_mfma_f32_16x16x32_bf16 v[180:183], a[180:183], v[52:55], v[180:183]
    s_waitcnt lgkmcnt(1)
    v_cvt_pk_bf16_f32 v62, v124, v125
    v_mfma_f32_16x16x32_bf16 v[152:155], a[184:187], v[48:51], v[152:155]
    s_waitcnt lgkmcnt(0)
    v_exp_f32 v126, v126
    v_mfma_f32_16x16x32_bf16 v[184:187], a[184:187], v[52:55], v[184:187]
    buffer_load_dwordx4 v15, s[8:11], s82 offen offset:2048 lds
    v_mfma_f32_16x16x32_bf16 v[156:159], a[188:191], v[48:51], v[156:159]
    v_exp_f32 v127, v127
    v_mfma_f32_16x16x32_bf16 v[188:191], a[188:191], v[52:55], v[188:191]
    v_cvt_pk_bf16_f32 v63, v126, v127
    v_mfma_f32_16x16x32_bf16 v[112:115], a[128:131], a[224:227], v[72:75]
    v_mfma_f32_16x16x32_bf16 v[112:115], a[132:135], a[228:231], v[112:115]
    v_mfma_f32_16x16x32_bf16 v[112:115], a[136:139], a[232:235], v[112:115]
    v_exp_f32 v96, v96
    v_mfma_f32_16x16x32_bf16 v[112:115], a[140:143], a[236:239], v[112:115]
    buffer_load_dwordx4 v15, s[8:11], s82 offen offset:3072 lds
    v_mfma_f32_16x16x32_bf16 v[120:123], a[128:131], a[240:243], v[76:79]
    s_xor_b32 s15, s15, 196608
    v_exp_f32 v97, v97
    v_mfma_f32_16x16x32_bf16 v[120:123], a[132:135], a[244:247], v[120:123]
    s_add_u32 m0, s16, 0
    ds_read_b128 a[128:131], v18 offset:0
    v_cvt_pk_bf16_f32 v48, v96, v97
    v_mfma_f32_16x16x32_bf16 v[120:123], a[136:139], a[248:251], v[120:123]
    v_exp_f32 v98, v98
    v_mfma_f32_16x16x32_bf16 v[120:123], a[140:143], a[252:255], v[120:123]
    buffer_load_dwordx4 v1, s[8:11], s19 offen offset:0 lds
    v_mfma_f32_16x16x32_bf16 v[116:119], a[144:147], a[224:227], v[72:75]
    v_exp_f32 v99, v99
    v_mfma_f32_16x16x32_bf16 v[116:119], a[148:151], a[228:231], v[116:119]
    ds_read_b128 a[132:135], v18 offset:1024
    v_cvt_pk_bf16_f32 v49, v98, v99
    v_mfma_f32_16x16x32_bf16 v[116:119], a[152:155], a[232:235], v[116:119]
    v_exp_f32 v100, v100
    v_mfma_f32_16x16x32_bf16 v[116:119], a[156:159], a[236:239], v[116:119]
    buffer_load_dwordx4 v1, s[8:11], s19 offen offset:1024 lds
    v_mfma_f32_16x16x32_bf16 v[124:127], a[144:147], a[240:243], v[76:79]
    v_exp_f32 v101, v101
    v_mfma_f32_16x16x32_bf16 v[124:127], a[148:151], a[244:247], v[124:127]
    ds_read_b128 a[136:139], v18 offset:2048
    v_cvt_pk_bf16_f32 v50, v100, v101
    v_mfma_f32_16x16x32_bf16 v[124:127], a[152:155], a[248:251], v[124:127]
    v_exp_f32 v102, v102
    v_mfma_f32_16x16x32_bf16 v[124:127], a[156:159], a[252:255], v[124:127]
    buffer_load_dwordx4 v1, s[8:11], s19 offen offset:2048 lds
    v_mfma_f32_16x16x32_bf16 v[40:43], v[28:31], v[56:59], v[40:43]
    v_exp_f32 v103, v103
    v_mfma_f32_16x16x32_bf16 v[44:47], v[28:31], v[60:63], v[44:47]
    ds_read_b128 a[140:143], v18 offset:3072
    v_cvt_pk_bf16_f32 v51, v102, v103
    v_mfma_f32_16x16x32_bf16 v[192:195], a[160:163], v[56:59], v[192:195]
    v_exp_f32 v104, v104
    v_mfma_f32_16x16x32_bf16 v[224:227], a[160:163], v[60:63], v[224:227]
    v_mfma_f32_16x16x32_bf16 v[196:199], a[164:167], v[56:59], v[196:199]
    v_exp_f32 v105, v105
    v_mfma_f32_16x16x32_bf16 v[228:231], a[164:167], v[60:63], v[228:231]
    ds_read_b128 a[144:147], v18 offset:4096
    v_cvt_pk_bf16_f32 v52, v104, v105
    v_mfma_f32_16x16x32_bf16 v[200:203], a[168:171], v[56:59], v[200:203]
    v_exp_f32 v106, v106
    v_mfma_f32_16x16x32_bf16 v[232:235], a[168:171], v[60:63], v[232:235]
    buffer_load_dwordx4 v1, s[8:11], s19 offen offset:3072 lds
    v_mfma_f32_16x16x32_bf16 v[204:207], a[172:175], v[56:59], v[204:207]
    s_add_u32 m0, s16, 4096
    v_exp_f32 v107, v107
    v_mfma_f32_16x16x32_bf16 v[236:239], a[172:175], v[60:63], v[236:239]
    ds_read_b128 a[148:151], v18 offset:5120
    v_cvt_pk_bf16_f32 v53, v106, v107
    v_mfma_f32_16x16x32_bf16 v[208:211], a[176:179], v[56:59], v[208:211]
    v_exp_f32 v108, v108
    v_mfma_f32_16x16x32_bf16 v[240:243], a[176:179], v[60:63], v[240:243]
    buffer_load_dwordx4 v15, s[8:11], s19 offen offset:0 lds
    v_mfma_f32_16x16x32_bf16 v[212:215], a[180:183], v[56:59], v[212:215]
    v_exp_f32 v109, v109
    v_mfma_f32_16x16x32_bf16 v[244:247], a[180:183], v[60:63], v[244:247]
    ds_read_b128 a[152:155], v18 offset:6144
    v_cvt_pk_bf16_f32 v54, v108, v109
    v_mfma_f32_16x16x32_bf16 v[216:219], a[184:187], v[56:59], v[216:219]
    v_exp_f32 v110, v110
    v_mfma_f32_16x16x32_bf16 v[248:251], a[184:187], v[60:63], v[248:251]
    buffer_load_dwordx4 v15, s[8:11], s19 offen offset:1024 lds
    v_mfma_f32_16x16x32_bf16 v[220:223], a[188:191], v[56:59], v[220:223]
    v_exp_f32 v111, v111
    v_mfma_f32_16x16x32_bf16 v[252:255], a[188:191], v[60:63], v[252:255]
    ds_read_b128 a[156:159], v18 offset:7168
    v_cvt_pk_bf16_f32 v55, v110, v111
    s_waitcnt lgkmcnt(7)
    v_mfma_f32_16x16x32_bf16 v[96:99], a[128:131], a[192:195], v[64:67]
    s_waitcnt lgkmcnt(6)
    s_lshl_b32 s24, s60, 2
    s_add_u32 s24, s24, s3
    ds_read_b128 a[160:163], v19 offset:16384
    v_mfma_f32_16x16x32_bf16 v[96:99], a[132:135], a[196:199], v[96:99]
    s_waitcnt lgkmcnt(6)
    s_lshl_b32 s24, s24, 3
    s_add_u32 s24, s24, s4
    ds_read_b128 a[164:167], v19 offset:17408
    v_mfma_f32_16x16x32_bf16 v[96:99], a[136:139], a[200:203], v[96:99]
    s_waitcnt lgkmcnt(6)
    s_lshl_b32 s24, s24, 15
    v_exp_f32 v112, v112
    v_mfma_f32_16x16x32_bf16 v[96:99], a[140:143], a[204:207], v[96:99]
    buffer_load_dwordx4 v15, s[8:11], s19 offen offset:2048 lds
    v_mfma_f32_16x16x32_bf16 v[104:107], a[128:131], a[208:211], v[68:71]
    s_add_u32 s24, s24, 50331648
    v_exp_f32 v113, v113
    s_waitcnt vmcnt(20)
    v_cmp_ne_u32 vcc, 0, v3
    s_cmp_eq_u64 vcc, -1
    s_cbranch_scc0 L_C1_slow_9
L_C1_ok_10:
    v_mfma_f32_16x16x32_bf16 v[104:107], a[132:135], a[212:215], v[104:107]
    s_add_u32 s74, s24, 0
    ds_read_b128 a[168:171], v19 offset:18432
    v_cvt_pk_bf16_f32 v56, v112, v113
    v_mfma_f32_16x16x32_bf16 v[104:107], a[136:139], a[216:219], v[104:107]
    s_waitcnt lgkmcnt(6)
    v_exp_f32 v114, v114
    v_mfma_f32_16x16x32_bf16 v[104:107], a[140:143], a[220:223], v[104:107]
    buffer_load_dwordx4 v15, s[8:11], s19 offen offset:3072 lds
    v_mfma_f32_16x16x32_bf16 v[100:103], a[144:147], a[192:195], v[64:67]
    s_waitcnt lgkmcnt(5)
    s_xor_b32 s16, s16, 98304
    v_exp_f32 v115, v115
    v_mfma_f32_16x16x32_bf16 v[100:103], a[148:151], a[196:199], v[100:103]
    s_waitcnt lgkmcnt(4)
    ds_read_b128 a[172:175], v19 offset:19456
    v_cvt_pk_bf16_f32 v57, v114, v115
    v_mfma_f32_16x16x32_bf16 v[100:103], a[152:155], a[200:203], v[100:103]
    s_waitcnt lgkmcnt(4)
    v_exp_f32 v116, v116
    v_mfma_f32_16x16x32_bf16 v[100:103], a[156:159], a[204:207], v[100:103]
    buffer_load_dwordx4 a[64:67], v1, s[8:11], s74 offen offset:0
    v_mfma_f32_16x16x32_bf16 v[108:111], a[144:147], a[208:211], v[68:71]
    s_add_u32 s74, s24, 0
    v_exp_f32 v117, v117
    v_mfma_f32_16x16x32_bf16 v[108:111], a[148:151], a[212:215], v[108:111]
    ds_read_b128 a[176:179], v20 offset:20480
    v_cvt_pk_bf16_f32 v58, v116, v117
    v_mfma_f32_16x16x32_bf16 v[108:111], a[152:155], a[216:219], v[108:111]
    v_exp_f32 v118, v118
    v_mfma_f32_16x16x32_bf16 v[108:111], a[156:159], a[220:223], v[108:111]
    buffer_load_dwordx4 a[68:71], v1, s[8:11], s74 offen offset:1024
    v_mfma_f32_16x16x32_bf16 v[32:35], v[28:31], v[48:51], v[32:35]
    s_add_u32 s74, s24, 0
    v_exp_f32 v119, v119
    v_mfma_f32_16x16x32_bf16 v[36:39], v[28:31], v[52:55], v[36:39]
    s_waitcnt lgkmcnt(4)
    ds_read_b128 a[180:183], v20 offset:21504
    v_cvt_pk_bf16_f32 v59, v118, v119
    v_mfma_f32_16x16x32_bf16 v[128:131], a[160:163], v[48:51], v[128:131]
    s_waitcnt lgkmcnt(4)
    v_exp_f32 v120, v120
    v_mfma_f32_16x16x32_bf16 v[160:163], a[160:163], v[52:55], v[160:163]
    buffer_load_dwordx4 a[72:75], v1, s[8:11], s74 offen offset:2048
    v_mfma_f32_16x16x32_bf16 v[132:135], a[164:167], v[48:51], v[132:135]
    s_add_u32 s74, s24, 0
    v_exp_f32 v121, v121
    v_mfma_f32_16x16x32_bf16 v[164:167], a[164:167], v[52:55], v[164:167]
    s_waitcnt lgkmcnt(3)
    ds_read_b128 a[184:187], v20 offset:22528
    v_cvt_pk_bf16_f32 v60, v120, v121
    v_mfma_f32_16x16x32_bf16 v[136:139], a[168:171], v[48:51], v[136:139]
    s_waitcnt lgkmcnt(3)
    v_exp_f32 v122, v122
    v_mfma_f32_16x16x32_bf16 v[168:171], a[168:171], v[52:55], v[168:171]
    buffer_load_dwordx4 a[76:79], v1, s[8:11], s74 offen offset:3072
    v_mfma_f32_16x16x32_bf16 v[140:143], a[172:175], v[48:51], v[140:143]
    s_add_u32 s74, s24, 4096
    v_exp_f32 v123, v123
    v_mfma_f32_16x16x32_bf16 v[172:175], a[172:175], v[52:55], v[172:175]
    s_waitcnt lgkmcnt(2)
    ds_read_b128 a[188:191], v20 offset:23552
    v_cvt_pk_bf16_f32 v61, v122, v123
    v_mfma_f32_16x16x32_bf16 v[144:147], a[176:179], v[48:51], v[144:147]
    s_waitcnt lgkmcnt(2)
    v_exp_f32 v124, v124
    v_mfma_f32_16x16x32_bf16 v[176:179], a[176:179], v[52:55], v[176:179]
    buffer_load_dwordx4 a[80:83], v1, s[8:11], s74 offen offset:0
    v_mfma_f32_16x16x32_bf16 v[148:151], a[180:183], v[48:51], v[148:151]
    v_exp_f32 v125, v125
    v_mfma_f32_16x16x32_bf16 v[180:183], a[180:183], v[52:55], v[180:183]
    s_waitcnt lgkmcnt(1)
    v_cvt_pk_bf16_f32 v62, v124, v125
    v_xor_b32 v19, 98304, v19
    v_mfma_f32_16x16x32_bf16 v[152:155], a[184:187], v[48:51], v[152:155]
    v_exp_f32 v126, v126
    v_mfma_f32_16x16x32_bf16 v[184:187], a[184:187], v[52:55], v[184:187]
    s_waitcnt lgkmcnt(0)
    v_xor_b32 v20, 98304, v20
    v_mfma_f32_16x16x32_bf16 v[156:159], a[188:191], v[48:51], v[156:159]
    v_exp_f32 v127, v127
    v_mfma_f32_16x16x32_bf16 v[188:191], a[188:191], v[52:55], v[188:191]
    v_cvt_pk_bf16_f32 v63, v126, v127
    v_mfma_f32_16x16x32_bf16 v[112:115], a[128:131], a[224:227], v[72:75]
    s_add_u32 m0, s62, 32768
    v_exp_f32 v96, v96
    v_mfma_f32_16x16x32_bf16 v[112:115], a[132:135], a[228:231], v[112:115]
    v_add_f32 v83, 0xf2400000, v21
    v_min_f32 v83, v83, v67
    v_mfma_f32_16x16x32_bf16 v[112:115], a[136:139], a[232:235], v[112:115]
    s_add_u32 s98, s65, 0
    v_exp_f32 v97, v97
    v_mfma_f32_16x16x32_bf16 v[112:115], a[140:143], a[236:239], v[112:115]
    v_cvt_pk_bf16_f32 v48, v96, v97
    v_add_f32 v84, 0xf3800000, v21
    v_mfma_f32_16x16x32_bf16 v[120:123], a[128:131], a[240:243], v[76:79]
    v_exp_f32 v98, v98
    v_mfma_f32_16x16x32_bf16 v[120:123], a[132:135], a[244:247], v[120:123]
    buffer_load_dwordx4 v8, s[28:31], s98 offen offset:0  lds
    v_mfma_f32_16x16x32_bf16 v[120:123], a[136:139], a[248:251], v[120:123]
    v_exp_f32 v99, v99
    v_mfma_f32_16x16x32_bf16 v[120:123], a[140:143], a[252:255], v[120:123]
    buffer_load_dwordx4 v9, s[28:31], s98 offen offset:1024  lds
    v_mfma_f32_16x16x32_bf16 v[116:119], a[144:147], a[224:227], v[72:75]
    v_exp_f32 v100, v100
    v_mfma_f32_16x16x32_bf16 v[116:119], a[148:151], a[228:231], v[116:119]
    ds_read_b128 a[128:131], v18 offset:16384
    v_cvt_pk_bf16_f32 v49, v98, v99
    v_mfma_f32_16x16x32_bf16 v[116:119], a[152:155], a[232:235], v[116:119]
    s_add_u32 s19, s82, 32768
    v_exp_f32 v101, v101
    v_mfma_f32_16x16x32_bf16 v[116:119], a[156:159], a[236:239], v[116:119]
    s_sub_u32 s82, s12, s13
    ds_read_b128 a[132:135], v18 offset:17408
    v_cvt_pk_bf16_f32 v50, v100, v101
    v_mfma_f32_16x16x32_bf16 v[124:127], a[144:147], a[240:243], v[76:79]
    s_sub_u32 s82, s82, 1
    v_exp_f32 v102, v102
    v_mfma_f32_16x16x32_bf16 v[124:127], a[148:151], a[244:247], v[124:127]
    s_cmp_gt_u32 s12, s13
    s_cselect_b32 s82, s82, s12
    s_lshl_b32 s82, s82, 16
    ds_read_b128 a[136:139], v18 offset:18432
    v_mfma_f32_16x16x32_bf16 v[124:127], a[152:155], a[248:251], v[124:127]
    s_add_u32 s82, s82, s81
    v_exp_f32 v103, v103
    v_mfma_f32_16x16x32_bf16 v[124:127], a[156:159], a[252:255], v[124:127]
    s_cmp_ge_u32 s12, 17
    s_cselect_b32 s82, 2147471360, s82
    ds_read_b128 a[140:143], v18 offset:19456
    v_cvt_pk_bf16_f32 v51, v102, v103
    v_mfma_f32_16x16x32_bf16 v[40:43], v[28:31], v[56:59], v[40:43]
    s_add_u32 s12, s12, 1
    v_exp_f32 v104, v104
    v_mfma_f32_16x16x32_bf16 v[44:47], v[28:31], v[60:63], v[44:47]
    ds_read_b128 a[144:147], v18 offset:20480
    v_min_f32 v84, v84, v64
    v_mfma_f32_16x16x32_bf16 v[192:195], a[160:163], v[56:59], v[192:195]
    v_exp_f32 v105, v105
    v_mfma_f32_16x16x32_bf16 v[224:227], a[160:163], v[60:63], v[224:227]
    ds_read_b128 a[148:151], v18 offset:21504
    v_cvt_pk_bf16_f32 v52, v104, v105
    v_mfma_f32_16x16x32_bf16 v[196:199], a[164:167], v[56:59], v[196:199]
    v_exp_f32 v106, v106
    v_mfma_f32_16x16x32_bf16 v[228:231], a[164:167], v[60:63], v[228:231]
    ds_read_b128 a[152:155], v18 offset:22528
    v_add_f32 v85, 0xf3880000, v21
    v_mfma_f32_16x16x32_bf16 v[200:203], a[168:171], v[56:59], v[200:203]
    v_exp_f32 v107, v107
    v_mfma_f32_16x16x32_bf16 v[232:235], a[168:171], v[60:63], v[232:235]
    ds_read_b128 a[156:159], v18 offset:23552
    v_cvt_pk_bf16_f32 v53, v106, v107
    v_mfma_f32_16x16x32_bf16 v[204:207], a[172:175], v[56:59], v[204:207]
    v_exp_f32 v108, v108
    v_mfma_f32_16x16x32_bf16 v[236:239], a[172:175], v[60:63], v[236:239]
    buffer_load_dwordx4 v10, s[28:31], s98 offen offset:2048  lds
    v_mfma_f32_16x16x32_bf16 v[208:211], a[176:179], v[56:59], v[208:211]
    v_exp_f32 v109, v109
    v_mfma_f32_16x16x32_bf16 v[240:243], a[176:179], v[60:63], v[240:243]
    v_cvt_pk_bf16_f32 v54, v108, v109
    v_xor_b32 v18, 196608, v18
    v_mfma_f32_16x16x32_bf16 v[212:215], a[180:183], v[56:59], v[212:215]
    v_exp_f32 v110, v110
    v_mfma_f32_16x16x32_bf16 v[244:247], a[180:183], v[60:63], v[244:247]
    buffer_load_dwordx4 v11, s[28:31], s98 offen offset:3072  lds
    v_mfma_f32_16x16x32_bf16 v[216:219], a[184:187], v[56:59], v[216:219]
    s_add_u32 s74, s24, 4096
    v_exp_f32 v111, v111
    v_mfma_f32_16x16x32_bf16 v[248:251], a[184:187], v[60:63], v[248:251]
    v_cvt_pk_bf16_f32 v55, v110, v111
    v_min_f32 v85, v85, v65
    v_mfma_f32_16x16x32_bf16 v[220:223], a[188:191], v[56:59], v[220:223]
    buffer_load_dwordx4 a[84:87], v1, s[8:11], s74 offen offset:1024
    v_mfma_f32_16x16x32_bf16 v[252:255], a[188:191], v[60:63], v[252:255]
    s_add_u32 s74, s24, 4096
    buffer_load_dwordx4 a[88:91], v1, s[8:11], s74 offen offset:2048
    s_add_u32 s74, s24, 4096
    buffer_load_dwordx4 a[92:95], v1, s[8:11], s74 offen offset:3072
    s_waitcnt vmcnt(12) lgkmcnt(0)
    s_barrier
    v_mfma_f32_16x16x32_bf16 v[96:99], a[128:131], a[192:195], v[64:67]
    s_add_u32 m0, s15, 0
    ds_read_b128 a[160:163], v19 offset:0
    v_mfma_f32_16x16x32_bf16 v[96:99], a[132:135], a[196:199], v[96:99]
    ds_read_b128 a[164:167], v19 offset:1024
    v_mfma_f32_16x16x32_bf16 v[96:99], a[136:139], a[200:203], v[96:99]
    v_exp_f32 v112, v112
    v_mfma_f32_16x16x32_bf16 v[96:99], a[140:143], a[204:207], v[96:99]
    buffer_load_dwordx4 v1, s[8:11], s82 offen offset:0 lds
    v_mfma_f32_16x16x32_bf16 v[104:107], a[128:131], a[208:211], v[68:71]
    v_exp_f32 v113, v113
    v_mfma_f32_16x16x32_bf16 v[104:107], a[132:135], a[212:215], v[104:107]
    ds_read_b128 a[168:171], v19 offset:2048
    v_cvt_pk_bf16_f32 v56, v112, v113
    v_mfma_f32_16x16x32_bf16 v[104:107], a[136:139], a[216:219], v[104:107]
    v_exp_f32 v114, v114
    v_mfma_f32_16x16x32_bf16 v[104:107], a[140:143], a[220:223], v[104:107]
    buffer_load_dwordx4 v1, s[8:11], s82 offen offset:1024 lds
    v_mfma_f32_16x16x32_bf16 v[100:103], a[144:147], a[192:195], v[64:67]
    v_exp_f32 v115, v115
    v_mfma_f32_16x16x32_bf16 v[100:103], a[148:151], a[196:199], v[100:103]
    ds_read_b128 a[172:175], v19 offset:3072
    v_cvt_pk_bf16_f32 v57, v114, v115
    v_mfma_f32_16x16x32_bf16 v[100:103], a[152:155], a[200:203], v[100:103]
    v_exp_f32 v116, v116
    v_mfma_f32_16x16x32_bf16 v[100:103], a[156:159], a[204:207], v[100:103]
    buffer_load_dwordx4 v1, s[8:11], s82 offen offset:2048 lds
    v_mfma_f32_16x16x32_bf16 v[108:111], a[144:147], a[208:211], v[68:71]
    v_exp_f32 v117, v117
    v_mfma_f32_16x16x32_bf16 v[108:111], a[148:151], a[212:215], v[108:111]
    ds_read_b128 a[176:179], v20 offset:4096
    v_cvt_pk_bf16_f32 v58, v116, v117
    v_mfma_f32_16x16x32_bf16 v[108:111], a[152:155], a[216:219], v[108:111]
    v_exp_f32 v118, v118
    v_mfma_f32_16x16x32_bf16 v[108:111], a[156:159], a[220:223], v[108:111]
    buffer_load_dwordx4 v1, s[8:11], s82 offen offset:3072 lds
    v_mfma_f32_16x16x32_bf16 v[32:35], v[28:31], v[48:51], v[32:35]
    s_add_u32 m0, s15, 4096
    v_exp_f32 v119, v119
    v_mfma_f32_16x16x32_bf16 v[36:39], v[28:31], v[52:55], v[36:39]
    s_waitcnt lgkmcnt(4)
    ds_read_b128 a[180:183], v20 offset:5120
    v_cvt_pk_bf16_f32 v59, v118, v119
    v_mfma_f32_16x16x32_bf16 v[128:131], a[160:163], v[48:51], v[128:131]
    v_exp_f32 v120, v120
    v_mfma_f32_16x16x32_bf16 v[160:163], a[160:163], v[52:55], v[160:163]
    s_waitcnt lgkmcnt(4)
    v_mfma_f32_16x16x32_bf16 v[132:135], a[164:167], v[48:51], v[132:135]
    v_exp_f32 v121, v121
    v_mfma_f32_16x16x32_bf16 v[164:167], a[164:167], v[52:55], v[164:167]
    s_waitcnt lgkmcnt(3)
    ds_read_b128 a[184:187], v20 offset:6144
    v_cvt_pk_bf16_f32 v60, v120, v121
    v_mfma_f32_16x16x32_bf16 v[136:139], a[168:171], v[48:51], v[136:139]
    s_waitcnt lgkmcnt(3)
    v_exp_f32 v122, v122
    v_mfma_f32_16x16x32_bf16 v[168:171], a[168:171], v[52:55], v[168:171]
    buffer_load_dwordx4 v15, s[8:11], s82 offen offset:0 lds
    v_mfma_f32_16x16x32_bf16 v[140:143], a[172:175], v[48:51], v[140:143]
    v_exp_f32 v123, v123
    v_mfma_f32_16x16x32_bf16 v[172:175], a[172:175], v[52:55], v[172:175]
    s_waitcnt lgkmcnt(2)
    ds_read_b128 a[188:191], v20 offset:7168
    v_cvt_pk_bf16_f32 v61, v122, v123
    v_mfma_f32_16x16x32_bf16 v[144:147], a[176:179], v[48:51], v[144:147]
    s_waitcnt lgkmcnt(2)
    v_exp_f32 v124, v124
    v_mfma_f32_16x16x32_bf16 v[176:179], a[176:179], v[52:55], v[176:179]
    buffer_load_dwordx4 v15, s[8:11], s82 offen offset:1024 lds
    v_mfma_f32_16x16x32_bf16 v[148:151], a[180:183], v[48:51], v[148:151]
    v_exp_f32 v125, v125
    v_mfma_f32_16x16x32_bf16 v[180:183], a[180:183], v[52:55], v[180:183]
    s_waitcnt lgkmcnt(1)
    v_cvt_pk_bf16_f32 v62, v124, v125
    v_mfma_f32_16x16x32_bf16 v[152:155], a[184:187], v[48:51], v[152:155]
    s_waitcnt lgkmcnt(0)
    v_exp_f32 v126, v126
    v_mfma_f32_16x16x32_bf16 v[184:187], a[184:187], v[52:55], v[184:187]
    buffer_load_dwordx4 v15, s[8:11], s82 offen offset:2048 lds
    v_mfma_f32_16x16x32_bf16 v[156:159], a[188:191], v[48:51], v[156:159]
    v_exp_f32 v127, v127
    v_mfma_f32_16x16x32_bf16 v[188:191], a[188:191], v[52:55], v[188:191]
    v_cvt_pk_bf16_f32 v63, v126, v127
    v_mfma_f32_16x16x32_bf16 v[112:115], a[128:131], a[224:227], v[72:75]
    v_mfma_f32_16x16x32_bf16 v[112:115], a[132:135], a[228:231], v[112:115]
    v_mfma_f32_16x16x32_bf16 v[112:115], a[136:139], a[232:235], v[112:115]
    v_exp_f32 v96, v96
    v_mfma_f32_16x16x32_bf16 v[112:115], a[140:143], a[236:239], v[112:115]
    buffer_load_dwordx4 v15, s[8:11], s82 offen offset:3072 lds
    v_mfma_f32_16x16x32_bf16 v[120:123], a[128:131], a[240:243], v[76:79]
    s_xor_b32 s15, s15, 196608
    v_exp_f32 v97, v97
    v_mfma_f32_16x16x32_bf16 v[120:123], a[132:135], a[244:247], v[120:123]
    s_add_u32 m0, s16, 0
    ds_read_b128 a[128:131], v18 offset:0
    v_cvt_pk_bf16_f32 v48, v96, v97
    v_mfma_f32_16x16x32_bf16 v[120:123], a[136:139], a[248:251], v[120:123]
    v_exp_f32 v98, v98
    v_mfma_f32_16x16x32_bf16 v[120:123], a[140:143], a[252:255], v[120:123]
    buffer_load_dwordx4 v1, s[8:11], s19 offen offset:0 lds
    v_mfma_f32_16x16x32_bf16 v[116:119], a[144:147], a[224:227], v[72:75]
    v_exp_f32 v99, v99
    v_mfma_f32_16x16x32_bf16 v[116:119], a[148:151], a[228:231], v[116:119]
    ds_read_b128 a[132:135], v18 offset:1024
    v_cvt_pk_bf16_f32 v49, v98, v99
    v_mfma_f32_16x16x32_bf16 v[116:119], a[152:155], a[232:235], v[116:119]
    v_exp_f32 v100, v100
    v_mfma_f32_16x16x32_bf16 v[116:119], a[156:159], a[236:239], v[116:119]
    buffer_load_dwordx4 v1, s[8:11], s19 offen offset:1024 lds
    v_mfma_f32_16x16x32_bf16 v[124:127], a[144:147], a[240:243], v[76:79]
    v_exp_f32 v101, v101
    v_mfma_f32_16x16x32_bf16 v[124:127], a[148:151], a[244:247], v[124:127]
    ds_read_b128 a[136:139], v18 offset:2048
    v_cvt_pk_bf16_f32 v50, v100, v101
    v_mfma_f32_16x16x32_bf16 v[124:127], a[152:155], a[248:251], v[124:127]
    v_exp_f32 v102, v102
    v_mfma_f32_16x16x32_bf16 v[124:127], a[156:159], a[252:255], v[124:127]
    buffer_load_dwordx4 v1, s[8:11], s19 offen offset:2048 lds
    v_mfma_f32_16x16x32_bf16 v[40:43], v[28:31], v[56:59], v[40:43]
    v_exp_f32 v103, v103
    v_mfma_f32_16x16x32_bf16 v[44:47], v[28:31], v[60:63], v[44:47]
    ds_read_b128 a[140:143], v18 offset:3072
    v_cvt_pk_bf16_f32 v51, v102, v103
    v_mfma_f32_16x16x32_bf16 v[192:195], a[160:163], v[56:59], v[192:195]
    v_exp_f32 v104, v104
    v_mfma_f32_16x16x32_bf16 v[224:227], a[160:163], v[60:63], v[224:227]
    v_mfma_f32_16x16x32_bf16 v[196:199], a[164:167], v[56:59], v[196:199]
    v_exp_f32 v105, v105
    v_mfma_f32_16x16x32_bf16 v[228:231], a[164:167], v[60:63], v[228:231]
    ds_read_b128 a[144:147], v18 offset:4096
    v_cvt_pk_bf16_f32 v52, v104, v105
    v_mfma_f32_16x16x32_bf16 v[200:203], a[168:171], v[56:59], v[200:203]
    v_exp_f32 v106, v106
    v_mfma_f32_16x16x32_bf16 v[232:235], a[168:171], v[60:63], v[232:235]
    buffer_load_dwordx4 v1, s[8:11], s19 offen offset:3072 lds
    v_mfma_f32_16x16x32_bf16 v[204:207], a[172:175], v[56:59], v[204:207]
    s_add_u32 m0, s16, 4096
    v_exp_f32 v107, v107
    v_mfma_f32_16x16x32_bf16 v[236:239], a[172:175], v[60:63], v[236:239]
    ds_read_b128 a[148:151], v18 offset:5120
    v_cvt_pk_bf16_f32 v53, v106, v107
    v_mfma_f32_16x16x32_bf16 v[208:211], a[176:179], v[56:59], v[208:211]
    v_exp_f32 v108, v108
    v_mfma_f32_16x16x32_bf16 v[240:243], a[176:179], v[60:63], v[240:243]
    buffer_load_dwordx4 v15, s[8:11], s19 offen offset:0 lds
    v_mfma_f32_16x16x32_bf16 v[212:215], a[180:183], v[56:59], v[212:215]
    v_exp_f32 v109, v109
    v_mfma_f32_16x16x32_bf16 v[244:247], a[180:183], v[60:63], v[244:247]
    ds_read_b128 a[152:155], v18 offset:6144
    v_cvt_pk_bf16_f32 v54, v108, v109
    v_mfma_f32_16x16x32_bf16 v[216:219], a[184:187], v[56:59], v[216:219]
    v_exp_f32 v110, v110
    v_mfma_f32_16x16x32_bf16 v[248:251], a[184:187], v[60:63], v[248:251]
    buffer_load_dwordx4 v15, s[8:11], s19 offen offset:1024 lds
    v_mfma_f32_16x16x32_bf16 v[220:223], a[188:191], v[56:59], v[220:223]
    v_exp_f32 v111, v111
    v_mfma_f32_16x16x32_bf16 v[252:255], a[188:191], v[60:63], v[252:255]
    ds_read_b128 a[156:159], v18 offset:7168
    v_cvt_pk_bf16_f32 v55, v110, v111
    s_waitcnt lgkmcnt(7)
    v_mfma_f32_16x16x32_bf16 v[96:99], a[128:131], a[192:195], v[64:67]
    s_waitcnt lgkmcnt(6)
    ds_read_b128 a[160:163], v19 offset:16384
    v_mfma_f32_16x16x32_bf16 v[96:99], a[132:135], a[196:199], v[96:99]
    s_waitcnt lgkmcnt(6)
    ds_read_b128 a[164:167], v19 offset:17408
    v_mfma_f32_16x16x32_bf16 v[96:99], a[136:139], a[200:203], v[96:99]
    s_waitcnt lgkmcnt(6)
    v_exp_f32 v112, v112
    v_mfma_f32_16x16x32_bf16 v[96:99], a[140:143], a[204:207], v[96:99]
    buffer_load_dwordx4 v15, s[8:11], s19 offen offset:2048 lds
    v_mfma_f32_16x16x32_bf16 v[104:107], a[128:131], a[208:211], v[68:71]
    v_exp_f32 v113, v113
    v_mfma_f32_16x16x32_bf16 v[104:107], a[132:135], a[212:215], v[104:107]
    ds_read_b128 a[168:171], v19 offset:18432
    v_cvt_pk_bf16_f32 v56, v112, v113
    v_mfma_f32_16x16x32_bf16 v[104:107], a[136:139], a[216:219], v[104:107]
    s_waitcnt lgkmcnt(6)
    v_exp_f32 v114, v114
    v_mfma_f32_16x16x32_bf16 v[104:107], a[140:143], a[220:223], v[104:107]
    buffer_load_dwordx4 v15, s[8:11], s19 offen offset:3072 lds
    v_mfma_f32_16x16x32_bf16 v[100:103], a[144:147], a[192:195], v[64:67]
    s_waitcnt lgkmcnt(5)
    s_xor_b32 s16, s16, 98304
    v_exp_f32 v115, v115
    v_mfma_f32_16x16x32_bf16 v[100:103], a[148:151], a[196:199], v[100:103]
    s_waitcnt lgkmcnt(4)
    s_lshl_b32 s64, s2, 6
    ds_read_b128 a[172:175], v19 offset:19456
    v_cvt_pk_bf16_f32 v57, v114, v115
    v_mfma_f32_16x16x32_bf16 v[100:103], a[152:155], a[200:203], v[100:103]
    s_waitcnt lgkmcnt(4)
    s_add_u32 s64, s64, 1327104
    v_exp_f32 v116, v116
    v_mfma_f32_16x16x32_bf16 v[100:103], a[156:159], a[204:207], v[100:103]
    buffer_store_dword v6, v7, s[8:11], s64 offen sc0 sc1
    v_mfma_f32_16x16x32_bf16 v[108:111], a[144:147], a[208:211], v[68:71]
    s_add_u32 s74, s24, 8192
    v_exp_f32 v117, v117
    v_mfma_f32_16x16x32_bf16 v[108:111], a[148:151], a[212:215], v[108:111]
    ds_read_b128 a[176:179], v20 offset:20480
    v_cvt_pk_bf16_f32 v58, v116, v117
    v_mfma_f32_16x16x32_bf16 v[108:111], a[152:155], a[216:219], v[108:111]
    v_exp_f32 v118, v118
    v_mfma_f32_16x16x32_bf16 v[108:111], a[156:159], a[220:223], v[108:111]
    buffer_load_dwordx4 a[96:99], v1, s[8:11], s74 offen offset:0
    v_mfma_f32_16x16x32_bf16 v[32:35], v[28:31], v[48:51], v[32:35]
    s_add_u32 s74, s24, 8192
    v_exp_f32 v119, v119
    v_mfma_f32_16x16x32_bf16 v[36:39], v[28:31], v[52:55], v[36:39]
    s_waitcnt lgkmcnt(4)
    ds_read_b128 a[180:183], v20 offset:21504
    v_cvt_pk_bf16_f32 v59, v118, v119
    v_mfma_f32_16x16x32_bf16 v[128:131], a[160:163], v[48:51], v[128:131]
    s_waitcnt lgkmcnt(4)
    v_exp_f32 v120, v120
    v_mfma_f32_16x16x32_bf16 v[160:163], a[160:163], v[52:55], v[160:163]
    buffer_load_dwordx4 a[100:103], v1, s[8:11], s74 offen offset:1024
    v_mfma_f32_16x16x32_bf16 v[132:135], a[164:167], v[48:51], v[132:135]
    s_add_u32 s74, s24, 8192
    v_exp_f32 v121, v121
    v_mfma_f32_16x16x32_bf16 v[164:167], a[164:167], v[52:55], v[164:167]
    s_waitcnt lgkmcnt(3)
    ds_read_b128 a[184:187], v20 offset:22528
    v_cvt_pk_bf16_f32 v60, v120, v121
    v_mfma_f32_16x16x32_bf16 v[136:139], a[168:171], v[48:51], v[136:139]
    s_waitcnt lgkmcnt(3)
    v_exp_f32 v122, v122
    v_mfma_f32_16x16x32_bf16 v[168:171], a[168:171], v[52:55], v[168:171]
    buffer_load_dwordx4 a[104:107], v1, s[8:11], s74 offen offset:2048
    v_mfma_f32_16x16x32_bf16 v[140:143], a[172:175], v[48:51], v[140:143]
    s_add_u32 s74, s24, 8192
    v_exp_f32 v123, v123
    v_mfma_f32_16x16x32_bf16 v[172:175], a[172:175], v[52:55], v[172:175]
    s_waitcnt lgkmcnt(2)
    ds_read_b128 a[188:191], v20 offset:23552
    v_cvt_pk_bf16_f32 v61, v122, v123
    v_mfma_f32_16x16x32_bf16 v[144:147], a[176:179], v[48:51], v[144:147]
    s_waitcnt lgkmcnt(2)
    v_exp_f32 v124, v124
    v_mfma_f32_16x16x32_bf16 v[176:179], a[176:179], v[52:55], v[176:179]
    buffer_load_dwordx4 a[108:111], v1, s[8:11], s74 offen offset:3072
    v_mfma_f32_16x16x32_bf16 v[148:151], a[180:183], v[48:51], v[148:151]
    s_add_u32 s74, s24, 12288
    v_exp_f32 v125, v125
    v_mfma_f32_16x16x32_bf16 v[180:183], a[180:183], v[52:55], v[180:183]
    s_waitcnt lgkmcnt(1)
    v_cvt_pk_bf16_f32 v62, v124, v125
    v_xor_b32 v19, 98304, v19
    v_mfma_f32_16x16x32_bf16 v[152:155], a[184:187], v[48:51], v[152:155]
    buffer_load_dwordx4 a[112:115], v1, s[8:11], s74 offen offset:0
    v_exp_f32 v126, v126
    v_mfma_f32_16x16x32_bf16 v[184:187], a[184:187], v[52:55], v[184:187]
    s_waitcnt lgkmcnt(0)
    v_xor_b32 v20, 98304, v20
    v_mfma_f32_16x16x32_bf16 v[156:159], a[188:191], v[48:51], v[156:159]
    v_exp_f32 v127, v127
    v_mfma_f32_16x16x32_bf16 v[188:191], a[188:191], v[52:55], v[188:191]
    v_cvt_pk_bf16_f32 v63, v126, v127
    v_mfma_f32_16x16x32_bf16 v[112:115], a[128:131], a[224:227], v[72:75]
    s_add_u32 m0, s62, 36864
    v_exp_f32 v96, v96
    v_mfma_f32_16x16x32_bf16 v[112:115], a[132:135], a[228:231], v[112:115]
    v_add_f32 v86, 0xf3900000, v21
    v_min_f32 v86, v86, v66
    v_mfma_f32_16x16x32_bf16 v[112:115], a[136:139], a[232:235], v[112:115]
    s_add_u32 s98, s65, 32768
    v_exp_f32 v97, v97
    v_mfma_f32_16x16x32_bf16 v[112:115], a[140:143], a[236:239], v[112:115]
    v_cvt_pk_bf16_f32 v48, v96, v97
    v_add_f32 v87, 0xf3980000, v21
    v_mfma_f32_16x16x32_bf16 v[120:123], a[128:131], a[240:243], v[76:79]
    v_exp_f32 v98, v98
    v_mfma_f32_16x16x32_bf16 v[120:123], a[132:135], a[244:247], v[120:123]
    buffer_load_dwordx4 v8, s[28:31], s98 offen offset:0  lds
    v_mfma_f32_16x16x32_bf16 v[120:123], a[136:139], a[248:251], v[120:123]
    v_exp_f32 v99, v99
    v_mfma_f32_16x16x32_bf16 v[120:123], a[140:143], a[252:255], v[120:123]
    buffer_load_dwordx4 v9, s[28:31], s98 offen offset:1024  lds
    v_mfma_f32_16x16x32_bf16 v[116:119], a[144:147], a[224:227], v[72:75]
    v_exp_f32 v100, v100
    v_mfma_f32_16x16x32_bf16 v[116:119], a[148:151], a[228:231], v[116:119]
    ds_read_b128 a[128:131], v18 offset:16384
    v_cvt_pk_bf16_f32 v49, v98, v99
    v_mfma_f32_16x16x32_bf16 v[116:119], a[152:155], a[232:235], v[116:119]
    s_add_u32 s19, s82, 32768
    v_exp_f32 v101, v101
    v_mfma_f32_16x16x32_bf16 v[116:119], a[156:159], a[236:239], v[116:119]
    s_sub_u32 s82, s12, s13
    ds_read_b128 a[132:135], v18 offset:17408
    v_cvt_pk_bf16_f32 v50, v100, v101
    v_mfma_f32_16x16x32_bf16 v[124:127], a[144:147], a[240:243], v[76:79]
    s_sub_u32 s82, s82, 1
    v_exp_f32 v102, v102
    v_mfma_f32_16x16x32_bf16 v[124:127], a[148:151], a[244:247], v[124:127]
    s_cmp_gt_u32 s12, s13
    s_cselect_b32 s82, s82, s12
    s_lshl_b32 s82, s82, 16
    ds_read_b128 a[136:139], v18 offset:18432
    v_mfma_f32_16x16x32_bf16 v[124:127], a[152:155], a[248:251], v[124:127]
    s_add_u32 s82, s82, s81
    v_exp_f32 v103, v103
    v_mfma_f32_16x16x32_bf16 v[124:127], a[156:159], a[252:255], v[124:127]
    s_cmp_ge_u32 s12, 17
    s_cselect_b32 s82, 2147471360, s82
    ds_read_b128 a[140:143], v18 offset:19456
    v_cvt_pk_bf16_f32 v51, v102, v103
    v_mfma_f32_16x16x32_bf16 v[40:43], v[28:31], v[56:59], v[40:43]
    s_add_u32 s12, s12, 1
    v_exp_f32 v104, v104
    v_mfma_f32_16x16x32_bf16 v[44:47], v[28:31], v[60:63], v[44:47]
    ds_read_b128 a[144:147], v18 offset:20480
    v_min_f32 v87, v87, v67
    v_mfma_f32_16x16x32_bf16 v[192:195], a[160:163], v[56:59], v[192:195]
    v_exp_f32 v105, v105
    v_mfma_f32_16x16x32_bf16 v[224:227], a[160:163], v[60:63], v[224:227]
    ds_read_b128 a[148:151], v18 offset:21504
    v_cvt_pk_bf16_f32 v52, v104, v105
    v_mfma_f32_16x16x32_bf16 v[196:199], a[164:167], v[56:59], v[196:199]
    v_exp_f32 v106, v106
    v_mfma_f32_16x16x32_bf16 v[228:231], a[164:167], v[60:63], v[228:231]
    ds_read_b128 a[152:155], v18 offset:22528
    v_add_f32 v88, 0x73800000, v21
    v_mfma_f32_16x16x32_bf16 v[200:203], a[168:171], v[56:59], v[200:203]
    v_exp_f32 v107, v107
    v_mfma_f32_16x16x32_bf16 v[232:235], a[168:171], v[60:63], v[232:235]
    ds_read_b128 a[156:159], v18 offset:23552
    v_cvt_pk_bf16_f32 v53, v106, v107
    v_mfma_f32_16x16x32_bf16 v[204:207], a[172:175], v[56:59], v[204:207]
    v_exp_f32 v108, v108
    v_mfma_f32_16x16x32_bf16 v[236:239], a[172:175], v[60:63], v[236:239]
    buffer_load_dwordx4 v10, s[28:31], s98 offen offset:2048  lds
    v_mfma_f32_16x16x32_bf16 v[208:211], a[176:179], v[56:59], v[208:211]
    v_exp_f32 v109, v109
    v_mfma_f32_16x16x32_bf16 v[240:243], a[176:179], v[60:63], v[240:243]
    v_cvt_pk_bf16_f32 v54, v108, v109
    v_xor_b32 v18, 196608, v18
    v_mfma_f32_16x16x32_bf16 v[212:215], a[180:183], v[56:59], v[212:215]
    v_exp_f32 v110, v110
    v_mfma_f32_16x16x32_bf16 v[244:247], a[180:183], v[60:63], v[244:247]
    buffer_load_dwordx4 v11, s[28:31], s98 offen offset:3072  lds
    v_mfma_f32_16x16x32_bf16 v[216:219], a[184:187], v[56:59], v[216:219]
    s_add_u32 s74, s24, 12288
    v_exp_f32 v111, v111
    v_mfma_f32_16x16x32_bf16 v[248:251], a[184:187], v[60:63], v[248:251]
    v_cvt_pk_bf16_f32 v55, v110, v111
    v_min_f32 v88, v88, v68
    v_mfma_f32_16x16x32_bf16 v[220:223], a[188:191], v[56:59], v[220:223]
    buffer_load_dwordx4 a[116:119], v1, s[8:11], s74 offen offset:1024
    v_mfma_f32_16x16x32_bf16 v[252:255], a[188:191], v[60:63], v[252:255]
    s_add_u32 s74, s24, 12288
    buffer_load_dwordx4 a[120:123], v1, s[8:11], s74 offen offset:2048
    s_add_u32 s74, s24, 12288
    buffer_load_dwordx4 a[124:127], v1, s[8:11], s74 offen offset:3072
    s_waitcnt vmcnt(13) lgkmcnt(0)
    s_barrier
    v_mfma_f32_16x16x32_bf16 v[96:99], a[128:131], a[192:195], v[64:67]
    s_add_u32 m0, s15, 0
    ds_read_b128 a[160:163], v19 offset:0
    v_mfma_f32_16x16x32_bf16 v[96:99], a[132:135], a[196:199], v[96:99]
    ds_read_b128 a[164:167], v19 offset:1024
    v_mfma_f32_16x16x32_bf16 v[96:99], a[136:139], a[200:203], v[96:99]
    v_exp_f32 v112, v112
    v_mfma_f32_16x16x32_bf16 v[96:99], a[140:143], a[204:207], v[96:99]
    buffer_load_dwordx4 v1, s[8:11], s82 offen offset:0 lds
    v_mfma_f32_16x16x32_bf16 v[104:107], a[128:131], a[208:211], v[68:71]
    v_exp_f32 v113, v113
    v_mfma_f32_16x16x32_bf16 v[104:107], a[132:135], a[212:215], v[104:107]
    ds_read_b128 a[168:171], v19 offset:2048
    v_cvt_pk_bf16_f32 v56, v112, v113
    v_mfma_f32_16x16x32_bf16 v[104:107], a[136:139], a[216:219], v[104:107]
    v_exp_f32 v114, v114
    v_mfma_f32_16x16x32_bf16 v[104:107], a[140:143], a[220:223], v[104:107]
    buffer_load_dwordx4 v1, s[8:11], s82 offen offset:1024 lds
    v_mfma_f32_16x16x32_bf16 v[100:103], a[144:147], a[192:195], v[64:67]
    v_exp_f32 v115, v115
    v_mfma_f32_16x16x32_bf16 v[100:103], a[148:151], a[196:199], v[100:103]
    ds_read_b128 a[172:175], v19 offset:3072
    v_cvt_pk_bf16_f32 v57, v114, v115
    v_mfma_f32_16x16x32_bf16 v[100:103], a[152:155], a[200:203], v[100:103]
    v_exp_f32 v116, v116
    v_mfma_f32_16x16x32_bf16 v[100:103], a[156:159], a[204:207], v[100:103]
    buffer_load_dwordx4 v1, s[8:11], s82 offen offset:2048 lds
    v_mfma_f32_16x16x32_bf16 v[108:111], a[144:147], a[208:211], v[68:71]
    v_exp_f32 v117, v117
    v_mfma_f32_16x16x32_bf16 v[108:111], a[148:151], a[212:215], v[108:111]
    ds_read_b128 a[176:179], v20 offset:4096
    v_cvt_pk_bf16_f32 v58, v116, v117
    v_mfma_f32_16x16x32_bf16 v[108:111], a[152:155], a[216:219], v[108:111]
    v_exp_f32 v118, v118
    v_mfma_f32_16x16x32_bf16 v[108:111], a[156:159], a[220:223], v[108:111]
    buffer_load_dwordx4 v1, s[8:11], s82 offen offset:3072 lds
    v_mfma_f32_16x16x32_bf16 v[32:35], v[28:31], v[48:51], v[32:35]
    s_add_u32 m0, s15, 4096
    v_exp_f32 v119, v119
    v_mfma_f32_16x16x32_bf16 v[36:39], v[28:31], v[52:55], v[36:39]
    s_waitcnt lgkmcnt(4)
    ds_read_b128 a[180:183], v20 offset:5120
    v_cvt_pk_bf16_f32 v59, v118, v119
    v_mfma_f32_16x16x32_bf16 v[128:131], a[160:163], v[48:51], v[128:131]
    v_exp_f32 v120, v120
    v_mfma_f32_16x16x32_bf16 v[160:163], a[160:163], v[52:55], v[160:163]
    s_waitcnt lgkmcnt(4)
    v_mfma_f32_16x16x32_bf16 v[132:135], a[164:167], v[48:51], v[132:135]
    v_exp_f32 v121, v121
    v_mfma_f32_16x16x32_bf16 v[164:167], a[164:167], v[52:55], v[164:167]
    s_waitcnt lgkmcnt(3)
    ds_read_b128 a[184:187], v20 offset:6144
    v_cvt_pk_bf16_f32 v60, v120, v121
    v_mfma_f32_16x16x32_bf16 v[136:139], a[168:171], v[48:51], v[136:139]
    s_waitcnt lgkmcnt(3)
    v_exp_f32 v122, v122
    v_mfma_f32_16x16x32_bf16 v[168:171], a[168:171], v[52:55], v[168:171]
    buffer_load_dwordx4 v15, s[8:11], s82 offen offset:0 lds
    v_mfma_f32_16x16x32_bf16 v[140:143], a[172:175], v[48:51], v[140:143]
    v_exp_f32 v123, v123
    v_mfma_f32_16x16x32_bf16 v[172:175], a[172:175], v[52:55], v[172:175]
    s_waitcnt lgkmcnt(2)
    ds_read_b128 a[188:191], v20 offset:7168
    v_cvt_pk_bf16_f32 v61, v122, v123
    v_mfma_f32_16x16x32_bf16 v[144:147], a[176:179], v[48:51], v[144:147]
    s_waitcnt lgkmcnt(2)
    v_exp_f32 v124, v124
    v_mfma_f32_16x16x32_bf16 v[176:179], a[176:179], v[52:55], v[176:179]
    buffer_load_dwordx4 v15, s[8:11], s82 offen offset:1024 lds
    v_mfma_f32_16x16x32_bf16 v[148:151], a[180:183], v[48:51], v[148:151]
    v_exp_f32 v125, v125
    v_mfma_f32_16x16x32_bf16 v[180:183], a[180:183], v[52:55], v[180:183]
    s_waitcnt lgkmcnt(1)
    v_cvt_pk_bf16_f32 v62, v124, v125
    v_mfma_f32_16x16x32_bf16 v[152:155], a[184:187], v[48:51], v[152:155]
    s_waitcnt lgkmcnt(0)
    v_exp_f32 v126, v126
    v_mfma_f32_16x16x32_bf16 v[184:187], a[184:187], v[52:55], v[184:187]
    buffer_load_dwordx4 v15, s[8:11], s82 offen offset:2048 lds
    v_mfma_f32_16x16x32_bf16 v[156:159], a[188:191], v[48:51], v[156:159]
    v_exp_f32 v127, v127
    v_mfma_f32_16x16x32_bf16 v[188:191], a[188:191], v[52:55], v[188:191]
    v_cvt_pk_bf16_f32 v63, v126, v127
    v_mfma_f32_16x16x32_bf16 v[112:115], a[128:131], a[224:227], v[72:75]
    v_mfma_f32_16x16x32_bf16 v[112:115], a[132:135], a[228:231], v[112:115]
    v_mfma_f32_16x16x32_bf16 v[112:115], a[136:139], a[232:235], v[112:115]
    v_exp_f32 v96, v96
    v_mfma_f32_16x16x32_bf16 v[112:115], a[140:143], a[236:239], v[112:115]
    buffer_load_dwordx4 v15, s[8:11], s82 offen offset:3072 lds
    v_mfma_f32_16x16x32_bf16 v[120:123], a[128:131], a[240:243], v[76:79]
    s_xor_b32 s15, s15, 196608
    v_exp_f32 v97, v97
    v_mfma_f32_16x16x32_bf16 v[120:123], a[132:135], a[244:247], v[120:123]
    s_add_u32 m0, s16, 0
    ds_read_b128 a[128:131], v18 offset:0
    v_cvt_pk_bf16_f32 v48, v96, v97
    v_mfma_f32_16x16x32_bf16 v[120:123], a[136:139], a[248:251], v[120:123]
    v_exp_f32 v98, v98
    v_mfma_f32_16x16x32_bf16 v[120:123], a[140:143], a[252:255], v[120:123]
    buffer_load_dwordx4 v1, s[8:11], s19 offen offset:0 lds
    v_mfma_f32_16x16x32_bf16 v[116:119], a[144:147], a[224:227], v[72:75]
    v_exp_f32 v99, v99
    v_mfma_f32_16x16x32_bf16 v[116:119], a[148:151], a[228:231], v[116:119]
    ds_read_b128 a[132:135], v18 offset:1024
    v_cvt_pk_bf16_f32 v49, v98, v99
    v_mfma_f32_16x16x32_bf16 v[116:119], a[152:155], a[232:235], v[116:119]
    v_exp_f32 v100, v100
    v_mfma_f32_16x16x32_bf16 v[116:119], a[156:159], a[236:239], v[116:119]
    buffer_load_dwordx4 v1, s[8:11], s19 offen offset:1024 lds
    v_mfma_f32_16x16x32_bf16 v[124:127], a[144:147], a[240:243], v[76:79]
    v_exp_f32 v101, v101
    v_mfma_f32_16x16x32_bf16 v[124:127], a[148:151], a[244:247], v[124:127]
    ds_read_b128 a[136:139], v18 offset:2048
    v_cvt_pk_bf16_f32 v50, v100, v101
    v_mfma_f32_16x16x32_bf16 v[124:127], a[152:155], a[248:251], v[124:127]
    v_exp_f32 v102, v102
    v_mfma_f32_16x16x32_bf16 v[124:127], a[156:159], a[252:255], v[124:127]
    buffer_load_dwordx4 v1, s[8:11], s19 offen offset:2048 lds
    v_mfma_f32_16x16x32_bf16 v[40:43], v[28:31], v[56:59], v[40:43]
    v_exp_f32 v103, v103
    v_mfma_f32_16x16x32_bf16 v[44:47], v[28:31], v[60:63], v[44:47]
    ds_read_b128 a[140:143], v18 offset:3072
    v_cvt_pk_bf16_f32 v51, v102, v103
    v_mfma_f32_16x16x32_bf16 v[192:195], a[160:163], v[56:59], v[192:195]
    v_exp_f32 v104, v104
    v_mfma_f32_16x16x32_bf16 v[224:227], a[160:163], v[60:63], v[224:227]
    v_mfma_f32_16x16x32_bf16 v[196:199], a[164:167], v[56:59], v[196:199]
    v_exp_f32 v105, v105
    v_mfma_f32_16x16x32_bf16 v[228:231], a[164:167], v[60:63], v[228:231]
    ds_read_b128 a[144:147], v18 offset:4096
    v_cvt_pk_bf16_f32 v52, v104, v105
    v_mfma_f32_16x16x32_bf16 v[200:203], a[168:171], v[56:59], v[200:203]
    v_exp_f32 v106, v106
    v_mfma_f32_16x16x32_bf16 v[232:235], a[168:171], v[60:63], v[232:235]
    buffer_load_dwordx4 v1, s[8:11], s19 offen offset:3072 lds
    v_mfma_f32_16x16x32_bf16 v[204:207], a[172:175], v[56:59], v[204:207]
    s_add_u32 m0, s16, 4096
    v_exp_f32 v107, v107
    v_mfma_f32_16x16x32_bf16 v[236:239], a[172:175], v[60:63], v[236:239]
    ds_read_b128 a[148:151], v18 offset:5120
    v_cvt_pk_bf16_f32 v53, v106, v107
    v_mfma_f32_16x16x32_bf16 v[208:211], a[176:179], v[56:59], v[208:211]
    v_exp_f32 v108, v108
    v_mfma_f32_16x16x32_bf16 v[240:243], a[176:179], v[60:63], v[240:243]
    buffer_load_dwordx4 v15, s[8:11], s19 offen offset:0 lds
    v_mfma_f32_16x16x32_bf16 v[212:215], a[180:183], v[56:59], v[212:215]
    v_exp_f32 v109, v109
    v_mfma_f32_16x16x32_bf16 v[244:247], a[180:183], v[60:63], v[244:247]
    ds_read_b128 a[152:155], v18 offset:6144
    v_cvt_pk_bf16_f32 v54, v108, v109
    v_mfma_f32_16x16x32_bf16 v[216:219], a[184:187], v[56:59], v[216:219]
    v_exp_f32 v110, v110
    v_mfma_f32_16x16x32_bf16 v[248:251], a[184:187], v[60:63], v[248:251]
    buffer_load_dwordx4 v15, s[8:11], s19 offen offset:1024 lds
    v_mfma_f32_16x16x32_bf16 v[220:223], a[188:191], v[56:59], v[220:223]
    v_exp_f32 v111, v111
    v_mfma_f32_16x16x32_bf16 v[252:255], a[188:191], v[60:63], v[252:255]
    ds_read_b128 a[156:159], v18 offset:7168
    v_cvt_pk_bf16_f32 v55, v110, v111
    s_waitcnt lgkmcnt(7)
    v_mfma_f32_16x16x32_bf16 v[96:99], a[128:131], a[192:195], v[64:67]
    s_waitcnt lgkmcnt(6)
    ds_read_b128 a[160:163], v19 offset:16384
    v_mfma_f32_16x16x32_bf16 v[96:99], a[132:135], a[196:199], v[96:99]
    s_waitcnt lgkmcnt(6)
    ds_read_b128 a[164:167], v19 offset:17408
    v_mfma_f32_16x16x32_bf16 v[96:99], a[136:139], a[200:203], v[96:99]
    s_waitcnt lgkmcnt(6)
    v_exp_f32 v112, v112
    v_mfma_f32_16x16x32_bf16 v[96:99], a[140:143], a[204:207], v[96:99]
    buffer_load_dwordx4 v15, s[8:11], s19 offen offset:2048 lds
    v_mfma_f32_16x16x32_bf16 v[104:107], a[128:131], a[208:211], v[68:71]
    v_exp_f32 v113, v113
    v_mfma_f32_16x16x32_bf16 v[104:107], a[132:135], a[212:215], v[104:107]
    ds_read_b128 a[168:171], v19 offset:18432
    v_cvt_pk_bf16_f32 v56, v112, v113
    v_mfma_f32_16x16x32_bf16 v[104:107], a[136:139], a[216:219], v[104:107]
    s_waitcnt lgkmcnt(6)
    v_exp_f32 v114, v114
    v_mfma_f32_16x16x32_bf16 v[104:107], a[140:143], a[220:223], v[104:107]
    buffer_load_dwordx4 v15, s[8:11], s19 offen offset:3072 lds
    v_mfma_f32_16x16x32_bf16 v[100:103], a[144:147], a[192:195], v[64:67]
    s_waitcnt lgkmcnt(5)
    s_xor_b32 s16, s16, 98304
    v_exp_f32 v115, v115
    v_mfma_f32_16x16x32_bf16 v[100:103], a[148:151], a[196:199], v[100:103]
    s_waitcnt lgkmcnt(4)
    s_add_u32 s74, s24, 16384
    ds_read_b128 a[172:175], v19 offset:19456
    v_cvt_pk_bf16_f32 v57, v114, v115
    v_mfma_f32_16x16x32_bf16 v[100:103], a[152:155], a[200:203], v[100:103]
    s_waitcnt lgkmcnt(4)
    v_exp_f32 v116, v116
    v_mfma_f32_16x16x32_bf16 v[100:103], a[156:159], a[204:207], v[100:103]
    buffer_load_dwordx4 a[0:3], v1, s[8:11], s74 offen offset:0
    v_mfma_f32_16x16x32_bf16 v[108:111], a[144:147], a[208:211], v[68:71]
    s_add_u32 s74, s24, 16384
    v_exp_f32 v117, v117
    v_mfma_f32_16x16x32_bf16 v[108:111], a[148:151], a[212:215], v[108:111]
    ds_read_b128 a[176:179], v20 offset:20480
    v_cvt_pk_bf16_f32 v58, v116, v117
    v_mfma_f32_16x16x32_bf16 v[108:111], a[152:155], a[216:219], v[108:111]
    v_exp_f32 v118, v118
    v_mfma_f32_16x16x32_bf16 v[108:111], a[156:159], a[220:223], v[108:111]
    buffer_load_dwordx4 a[4:7], v1, s[8:11], s74 offen offset:1024
    v_mfma_f32_16x16x32_bf16 v[32:35], v[28:31], v[48:51], v[32:35]
    s_add_u32 s74, s24, 16384
    v_exp_f32 v119, v119
    v_mfma_f32_16x16x32_bf16 v[36:39], v[28:31], v[52:55], v[36:39]
    s_waitcnt lgkmcnt(4)
    ds_read_b128 a[180:183], v20 offset:21504
    v_cvt_pk_bf16_f32 v59, v118, v119
    v_mfma_f32_16x16x32_bf16 v[128:131], a[160:163], v[48:51], v[128:131]
    s_waitcnt lgkmcnt(4)
    v_exp_f32 v120, v120
    v_mfma_f32_16x16x32_bf16 v[160:163], a[160:163], v[52:55], v[160:163]
    buffer_load_dwordx4 a[8:11], v1, s[8:11], s74 offen offset:2048
    v_mfma_f32_16x16x32_bf16 v[132:135], a[164:167], v[48:51], v[132:135]
    s_add_u32 s74, s24, 16384
    v_exp_f32 v121, v121
    v_mfma_f32_16x16x32_bf16 v[164:167], a[164:167], v[52:55], v[164:167]
    s_waitcnt lgkmcnt(3)
    ds_read_b128 a[184:187], v20 offset:22528
    v_cvt_pk_bf16_f32 v60, v120, v121
    v_mfma_f32_16x16x32_bf16 v[136:139], a[168:171], v[48:51], v[136:139]
    s_waitcnt lgkmcnt(3)
    v_exp_f32 v122, v122
    v_mfma_f32_16x16x32_bf16 v[168:171], a[168:171], v[52:55], v[168:171]
    buffer_load_dwordx4 a[12:15], v1, s[8:11], s74 offen offset:3072
    v_mfma_f32_16x16x32_bf16 v[140:143], a[172:175], v[48:51], v[140:143]
    s_add_u32 s74, s24, 20480
    v_exp_f32 v123, v123
    v_mfma_f32_16x16x32_bf16 v[172:175], a[172:175], v[52:55], v[172:175]
    s_waitcnt lgkmcnt(2)
    ds_read_b128 a[188:191], v20 offset:23552
    v_cvt_pk_bf16_f32 v61, v122, v123
    v_mfma_f32_16x16x32_bf16 v[144:147], a[176:179], v[48:51], v[144:147]
    s_waitcnt lgkmcnt(2)
    v_exp_f32 v124, v124
    v_mfma_f32_16x16x32_bf16 v[176:179], a[176:179], v[52:55], v[176:179]
    buffer_load_dwordx4 a[16:19], v1, s[8:11], s74 offen offset:0
    v_mfma_f32_16x16x32_bf16 v[148:151], a[180:183], v[48:51], v[148:151]
    s_add_u32 s74, s24, 20480
    v_exp_f32 v125, v125
    v_mfma_f32_16x16x32_bf16 v[180:183], a[180:183], v[52:55], v[180:183]
    s_waitcnt lgkmcnt(1)
    v_cvt_pk_bf16_f32 v62, v124, v125
    v_xor_b32 v19, 98304, v19
    v_mfma_f32_16x16x32_bf16 v[152:155], a[184:187], v[48:51], v[152:155]
    buffer_load_dwordx4 a[20:23], v1, s[8:11], s74 offen offset:1024
    v_exp_f32 v126, v126
    v_mfma_f32_16x16x32_bf16 v[184:187], a[184:187], v[52:55], v[184:187]
    s_waitcnt lgkmcnt(0)
    v_xor_b32 v20, 98304, v20
    v_mfma_f32_16x16x32_bf16 v[156:159], a[188:191], v[48:51], v[156:159]
    v_exp_f32 v127, v127
    v_mfma_f32_16x16x32_bf16 v[188:191], a[188:191], v[52:55], v[188:191]
    v_cvt_pk_bf16_f32 v63, v126, v127
    v_mfma_f32_16x16x32_bf16 v[112:115], a[128:131], a[224:227], v[72:75]
    s_add_u32 s74, s24, 20480
    v_exp_f32 v96, v96
    v_mfma_f32_16x16x32_bf16 v[112:115], a[132:135], a[228:231], v[112:115]
    buffer_load_dwordx4 a[24:27], v1, s[8:11], s74 offen offset:2048
    v_mfma_f32_16x16x32_bf16 v[112:115], a[136:139], a[232:235], v[112:115]
    s_add_u32 s74, s24, 20480
    v_exp_f32 v97, v97
    v_mfma_f32_16x16x32_bf16 v[112:115], a[140:143], a[236:239], v[112:115]
    v_cvt_pk_bf16_f32 v48, v96, v97
    v_add_f32 v89, 0x73700000, v21
    v_mfma_f32_16x16x32_bf16 v[120:123], a[128:131], a[240:243], v[76:79]
    v_exp_f32 v98, v98
    v_mfma_f32_16x16x32_bf16 v[120:123], a[132:135], a[244:247], v[120:123]
    buffer_load_dwordx4 a[28:31], v1, s[8:11], s74 offen offset:3072
    v_mfma_f32_16x16x32_bf16 v[120:123], a[136:139], a[248:251], v[120:123]
    s_add_u32 s74, s24, 24576
    v_exp_f32 v99, v99
    v_mfma_f32_16x16x32_bf16 v[120:123], a[140:143], a[252:255], v[120:123]
    buffer_load_dwordx4 a[32:35], v1, s[8:11], s74 offen offset:0
    v_mfma_f32_16x16x32_bf16 v[116:119], a[144:147], a[224:227], v[72:75]
    s_add_u32 s74, s24, 24576
    v_exp_f32 v100, v100
    v_mfma_f32_16x16x32_bf16 v[116:119], a[148:151], a[228:231], v[116:119]
    ds_read_b128 a[128:131], v18 offset:16384
    v_cvt_pk_bf16_f32 v49, v98, v99
    v_mfma_f32_16x16x32_bf16 v[116:119], a[152:155], a[232:235], v[116:119]
    s_add_u32 s19, s82, 32768
    v_exp_f32 v101, v101
    v_mfma_f32_16x16x32_bf16 v[116:119], a[156:159], a[236:239], v[116:119]
    s_sub_u32 s82, s12, s13
    ds_read_b128 a[132:135], v18 offset:17408
    v_cvt_pk_bf16_f32 v50, v100, v101
    v_mfma_f32_16x16x32_bf16 v[124:127], a[144:147], a[240:243], v[76:79]
    s_sub_u32 s82, s82, 1
    v_exp_f32 v102, v102
    v_mfma_f32_16x16x32_bf16 v[124:127], a[148:151], a[244:247], v[124:127]
    s_cmp_gt_u32 s12, s13
    s_cselect_b32 s82, s82, s12
    s_lshl_b32 s82, s82, 16
    ds_read_b128 a[136:139], v18 offset:18432
    v_mfma_f32_16x16x32_bf16 v[124:127], a[152:155], a[248:251], v[124:127]
    s_add_u32 s82, s82, s81
    v_exp_f32 v103, v103
    v_mfma_f32_16x16x32_bf16 v[124:127], a[156:159], a[252:255], v[124:127]
    s_cmp_ge_u32 s12, 17
    s_cselect_b32 s82, 2147471360, s82
    ds_read_b128 a[140:143], v18 offset:19456
    v_cvt_pk_bf16_f32 v51, v102, v103
    v_mfma_f32_16x16x32_bf16 v[40:43], v[28:31], v[56:59], v[40:43]
    s_add_u32 s12, s12, 1
    v_exp_f32 v104, v104
    v_mfma_f32_16x16x32_bf16 v[44:47], v[28:31], v[60:63], v[44:47]
    ds_read_b128 a[144:147], v18 offset:20480
    v_min_f32 v89, v89, v69
    v_mfma_f32_16x16x32_bf16 v[192:195], a[160:163], v[56:59], v[192:195]
    v_exp_f32 v105, v105
    v_mfma_f32_16x16x32_bf16 v[224:227], a[160:163], v[60:63], v[224:227]
    ds_read_b128 a[148:151], v18 offset:21504
    v_cvt_pk_bf16_f32 v52, v104, v105
    v_mfma_f32_16x16x32_bf16 v[196:199], a[164:167], v[56:59], v[196:199]
    v_exp_f32 v106, v106
    v_mfma_f32_16x16x32_bf16 v[228:231], a[164:167], v[60:63], v[228:231]
    ds_read_b128 a[152:155], v18 offset:22528
    v_add_f32 v90, 0x73600000, v21
    v_mfma_f32_16x16x32_bf16 v[200:203], a[168:171], v[56:59], v[200:203]
    v_exp_f32 v107, v107
    v_mfma_f32_16x16x32_bf16 v[232:235], a[168:171], v[60:63], v[232:235]
    ds_read_b128 a[156:159], v18 offset:23552
    v_cvt_pk_bf16_f32 v53, v106, v107
    v_mfma_f32_16x16x32_bf16 v[204:207], a[172:175], v[56:59], v[204:207]
    v_exp_f32 v108, v108
    v_mfma_f32_16x16x32_bf16 v[236:239], a[172:175], v[60:63], v[236:239]
    buffer_load_dwordx4 a[36:39], v1, s[8:11], s74 offen offset:1024
    v_mfma_f32_16x16x32_bf16 v[208:211], a[176:179], v[56:59], v[208:211]
    s_add_u32 s74, s24, 24576
    v_exp_f32 v109, v109
    v_mfma_f32_16x16x32_bf16 v[240:243], a[176:179], v[60:63], v[240:243]
    v_cvt_pk_bf16_f32 v54, v108, v109
    v_xor_b32 v18, 196608, v18
    v_mfma_f32_16x16x32_bf16 v[212:215], a[180:183], v[56:59], v[212:215]
    v_exp_f32 v110, v110
    v_mfma_f32_16x16x32_bf16 v[244:247], a[180:183], v[60:63], v[244:247]
    buffer_load_dwordx4 a[40:43], v1, s[8:11], s74 offen offset:2048
    v_mfma_f32_16x16x32_bf16 v[216:219], a[184:187], v[56:59], v[216:219]
    s_add_u32 s74, s24, 24576
    v_exp_f32 v111, v111
    v_mfma_f32_16x16x32_bf16 v[248:251], a[184:187], v[60:63], v[248:251]
    v_cvt_pk_bf16_f32 v55, v110, v111
    v_min_f32 v90, v90, v70
    v_mfma_f32_16x16x32_bf16 v[220:223], a[188:191], v[56:59], v[220:223]
    buffer_load_dwordx4 a[44:47], v1, s[8:11], s74 offen offset:3072
    v_mfma_f32_16x16x32_bf16 v[252:255], a[188:191], v[60:63], v[252:255]
    v_add_f32 v91, 0x73500000, v21
    v_min_f32 v91, v91, v71
    v_add_f32 v92, 0, v21
    v_min_f32 v92, v92, v68
    s_waitcnt vmcnt(12) lgkmcnt(0)
    s_barrier
    v_mfma_f32_16x16x32_bf16 v[96:99], a[128:131], a[192:195], v[64:67]
    s_add_u32 m0, s15, 0
    ds_read_b128 a[160:163], v19 offset:0
    v_mfma_f32_16x16x32_bf16 v[96:99], a[132:135], a[196:199], v[96:99]
    ds_read_b128 a[164:167], v19 offset:1024
    v_mfma_f32_16x16x32_bf16 v[96:99], a[136:139], a[200:203], v[96:99]
    v_exp_f32 v112, v112
    v_mfma_f32_16x16x32_bf16 v[96:99], a[140:143], a[204:207], v[96:99]
    buffer_load_dwordx4 v1, s[8:11], s82 offen offset:0 lds
    v_mfma_f32_16x16x32_bf16 v[104:107], a[128:131], a[208:211], v[68:71]
    v_exp_f32 v113, v113
    v_mfma_f32_16x16x32_bf16 v[104:107], a[132:135], a[212:215], v[104:107]
    ds_read_b128 a[168:171], v19 offset:2048
    v_cvt_pk_bf16_f32 v56, v112, v113
    v_mfma_f32_16x16x32_bf16 v[104:107], a[136:139], a[216:219], v[104:107]
    v_exp_f32 v114, v114
    v_mfma_f32_16x16x32_bf16 v[104:107], a[140:143], a[220:223], v[104:107]
    buffer_load_dwordx4 v1, s[8:11], s82 offen offset:1024 lds
    v_mfma_f32_16x16x32_bf16 v[100:103], a[144:147], a[192:195], v[64:67]
    v_exp_f32 v115, v115
    v_mfma_f32_16x16x32_bf16 v[100:103], a[148:151], a[196:199], v[100:103]
    ds_read_b128 a[172:175], v19 offset:3072
    v_cvt_pk_bf16_f32 v57, v114, v115
    v_mfma_f32_16x16x32_bf16 v[100:103], a[152:155], a[200:203], v[100:103]
    v_exp_f32 v116, v116
    v_mfma_f32_16x16x32_bf16 v[100:103], a[156:159], a[204:207], v[100:103]
    buffer_load_dwordx4 v1, s[8:11], s82 offen offset:2048 lds
    v_mfma_f32_16x16x32_bf16 v[108:111], a[144:147], a[208:211], v[68:71]
    v_exp_f32 v117, v117
    v_mfma_f32_16x16x32_bf16 v[108:111], a[148:151], a[212:215], v[108:111]
    ds_read_b128 a[176:179], v20 offset:4096
    v_cvt_pk_bf16_f32 v58, v116, v117
    v_mfma_f32_16x16x32_bf16 v[108:111], a[152:155], a[216:219], v[108:111]
    v_exp_f32 v118, v118
    v_mfma_f32_16x16x32_bf16 v[108:111], a[156:159], a[220:223], v[108:111]
    buffer_load_dwordx4 v1, s[8:11], s82 offen offset:3072 lds
    v_mfma_f32_16x16x32_bf16 v[32:35], v[28:31], v[48:51], v[32:35]
    s_add_u32 m0, s15, 4096
    v_exp_f32 v119, v119
    v_mfma_f32_16x16x32_bf16 v[36:39], v[28:31], v[52:55], v[36:39]
    s_waitcnt lgkmcnt(4)
    ds_read_b128 a[180:183], v20 offset:5120
    v_cvt_pk_bf16_f32 v59, v118, v119
    v_mfma_f32_16x16x32_bf16 v[128:131], a[160:163], v[48:51], v[128:131]
    v_exp_f32 v120, v120
    v_mfma_f32_16x16x32_bf16 v[160:163], a[160:163], v[52:55], v[160:163]
    s_waitcnt lgkmcnt(4)
    v_mfma_f32_16x16x32_bf16 v[132:135], a[164:167], v[48:51], v[132:135]
    v_exp_f32 v121, v121
    v_mfma_f32_16x16x32_bf16 v[164:167], a[164:167], v[52:55], v[164:167]
    s_waitcnt lgkmcnt(3)
    ds_read_b128 a[184:187], v20 offset:6144
    v_cvt_pk_bf16_f32 v60, v120, v121
    v_mfma_f32_16x16x32_bf16 v[136:139], a[168:171], v[48:51], v[136:139]
    s_waitcnt lgkmcnt(3)
    v_exp_f32 v122, v122
    v_mfma_f32_16x16x32_bf16 v[168:171], a[168:171], v[52:55], v[168:171]
    buffer_load_dwordx4 v15, s[8:11], s82 offen offset:0 lds
    v_mfma_f32_16x16x32_bf16 v[140:143], a[172:175], v[48:51], v[140:143]
    v_exp_f32 v123, v123
    v_mfma_f32_16x16x32_bf16 v[172:175], a[172:175], v[52:55], v[172:175]
    s_waitcnt lgkmcnt(2)
    ds_read_b128 a[188:191], v20 offset:7168
    v_cvt_pk_bf16_f32 v61, v122, v123
    v_mfma_f32_16x16x32_bf16 v[144:147], a[176:179], v[48:51], v[144:147]
    s_waitcnt lgkmcnt(2)
    v_exp_f32 v124, v124
    v_mfma_f32_16x16x32_bf16 v[176:179], a[176:179], v[52:55], v[176:179]
    buffer_load_dwordx4 v15, s[8:11], s82 offen offset:1024 lds
    v_mfma_f32_16x16x32_bf16 v[148:151], a[180:183], v[48:51], v[148:151]
    v_exp_f32 v125, v125
    v_mfma_f32_16x16x32_bf16 v[180:183], a[180:183], v[52:55], v[180:183]
    s_waitcnt lgkmcnt(1)
    v_cvt_pk_bf16_f32 v62, v124, v125
    v_mfma_f32_16x16x32_bf16 v[152:155], a[184:187], v[48:51], v[152:155]
    s_waitcnt lgkmcnt(0)
    v_exp_f32 v126, v126
    v_mfma_f32_16x16x32_bf16 v[184:187], a[184:187], v[52:55], v[184:187]
    buffer_load_dwordx4 v15, s[8:11], s82 offen offset:2048 lds
    v_mfma_f32_16x16x32_bf16 v[156:159], a[188:191], v[48:51], v[156:159]
    v_exp_f32 v127, v127
    v_mfma_f32_16x16x32_bf16 v[188:191], a[188:191], v[52:55], v[188:191]
    v_cvt_pk_bf16_f32 v63, v126, v127
    v_mfma_f32_16x16x32_bf16 v[112:115], a[128:131], a[224:227], v[72:75]
    v_mfma_f32_16x16x32_bf16 v[112:115], a[132:135], a[228:231], v[112:115]
    v_mfma_f32_16x16x32_bf16 v[112:115], a[136:139], a[232:235], v[112:115]
    v_exp_f32 v96, v96
    v_mfma_f32_16x16x32_bf16 v[112:115], a[140:143], a[236:239], v[112:115]
    buffer_load_dwordx4 v15, s[8:11], s82 offen offset:3072 lds
    v_mfma_f32_16x16x32_bf16 v[120:123], a[128:131], a[240:243], v[76:79]
    s_xor_b32 s15, s15, 196608
    v_exp_f32 v97, v97
    v_mfma_f32_16x16x32_bf16 v[120:123], a[132:135], a[244:247], v[120:123]
    s_add_u32 m0, s16, 0
    ds_read_b128 a[128:131], v18 offset:0
    v_cvt_pk_bf16_f32 v48, v96, v97
    v_mfma_f32_16x16x32_bf16 v[120:123], a[136:139], a[248:251], v[120:123]
    v_exp_f32 v98, v98
    v_mfma_f32_16x16x32_bf16 v[120:123], a[140:143], a[252:255], v[120:123]
    buffer_load_dwordx4 v1, s[8:11], s19 offen offset:0 lds
    v_mfma_f32_16x16x32_bf16 v[116:119], a[144:147], a[224:227], v[72:75]
    v_exp_f32 v99, v99
    v_mfma_f32_16x16x32_bf16 v[116:119], a[148:151], a[228:231], v[116:119]
    ds_read_b128 a[132:135], v18 offset:1024
    v_cvt_pk_bf16_f32 v49, v98, v99
    v_mfma_f32_16x16x32_bf16 v[116:119], a[152:155], a[232:235], v[116:119]
    v_exp_f32 v100, v100
    v_mfma_f32_16x16x32_bf16 v[116:119], a[156:159], a[236:239], v[116:119]
    buffer_load_dwordx4 v1, s[8:11], s19 offen offset:1024 lds
    v_mfma_f32_16x16x32_bf16 v[124:127], a[144:147], a[240:243], v[76:79]
    v_exp_f32 v101, v101
    v_mfma_f32_16x16x32_bf16 v[124:127], a[148:151], a[244:247], v[124:127]
    ds_read_b128 a[136:139], v18 offset:2048
    v_cvt_pk_bf16_f32 v50, v100, v101
    v_mfma_f32_16x16x32_bf16 v[124:127], a[152:155], a[248:251], v[124:127]
    v_exp_f32 v102, v102
    v_mfma_f32_16x16x32_bf16 v[124:127], a[156:159], a[252:255], v[124:127]
    buffer_load_dwordx4 v1, s[8:11], s19 offen offset:2048 lds
    v_mfma_f32_16x16x32_bf16 v[40:43], v[28:31], v[56:59], v[40:43]
    v_exp_f32 v103, v103
    v_mfma_f32_16x16x32_bf16 v[44:47], v[28:31], v[60:63], v[44:47]
    ds_read_b128 a[140:143], v18 offset:3072
    v_cvt_pk_bf16_f32 v51, v102, v103
    v_mfma_f32_16x16x32_bf16 v[192:195], a[160:163], v[56:59], v[192:195]
    v_exp_f32 v104, v104
    v_mfma_f32_16x16x32_bf16 v[224:227], a[160:163], v[60:63], v[224:227]
    v_mfma_f32_16x16x32_bf16 v[196:199], a[164:167], v[56:59], v[196:199]
    v_exp_f32 v105, v105
    v_mfma_f32_16x16x32_bf16 v[228:231], a[164:167], v[60:63], v[228:231]
    ds_read_b128 a[144:147], v18 offset:4096
    v_cvt_pk_bf16_f32 v52, v104, v105
    v_mfma_f32_16x16x32_bf16 v[200:203], a[168:171], v[56:59], v[200:203]
    v_exp_f32 v106, v106
    v_mfma_f32_16x16x32_bf16 v[232:235], a[168:171], v[60:63], v[232:235]
    buffer_load_dwordx4 v1, s[8:11], s19 offen offset:3072 lds
    v_mfma_f32_16x16x32_bf16 v[204:207], a[172:175], v[56:59], v[204:207]
    s_add_u32 m0, s16, 4096
    v_exp_f32 v107, v107
    v_mfma_f32_16x16x32_bf16 v[236:239], a[172:175], v[60:63], v[236:239]
    ds_read_b128 a[148:151], v18 offset:5120
    v_cvt_pk_bf16_f32 v53, v106, v107
    v_mfma_f32_16x16x32_bf16 v[208:211], a[176:179], v[56:59], v[208:211]
    v_exp_f32 v108, v108
    v_mfma_f32_16x16x32_bf16 v[240:243], a[176:179], v[60:63], v[240:243]
    buffer_load_dwordx4 v15, s[8:11], s19 offen offset:0 lds
    v_mfma_f32_16x16x32_bf16 v[212:215], a[180:183], v[56:59], v[212:215]
    v_exp_f32 v109, v109
    v_mfma_f32_16x16x32_bf16 v[244:247], a[180:183], v[60:63], v[244:247]
    ds_read_b128 a[152:155], v18 offset:6144
    v_cvt_pk_bf16_f32 v54, v108, v109
    v_mfma_f32_16x16x32_bf16 v[216:219], a[184:187], v[56:59], v[216:219]
    v_exp_f32 v110, v110
    v_mfma_f32_16x16x32_bf16 v[248:251], a[184:187], v[60:63], v[248:251]
    buffer_load_dwordx4 v15, s[8:11], s19 offen offset:1024 lds
    v_mfma_f32_16x16x32_bf16 v[220:223], a[188:191], v[56:59], v[220:223]
    v_exp_f32 v111, v111
    v_mfma_f32_16x16x32_bf16 v[252:255], a[188:191], v[60:63], v[252:255]
    ds_read_b128 a[156:159], v18 offset:7168
    v_cvt_pk_bf16_f32 v55, v110, v111
    s_waitcnt lgkmcnt(7)
    v_mfma_f32_16x16x32_bf16 v[96:99], a[128:131], a[192:195], v[64:67]
    s_waitcnt lgkmcnt(6)
    ds_read_b128 a[160:163], v19 offset:16384
    v_add_f32 v93, 0xf1800000, v21
    v_mfma_f32_16x16x32_bf16 v[96:99], a[132:135], a[196:199], v[96:99]
    s_waitcnt lgkmcnt(6)
    ds_read_b128 a[164:167], v19 offset:17408
    v_min_f32 v93, v93, v69
    v_mfma_f32_16x16x32_bf16 v[96:99], a[136:139], a[200:203], v[96:99]
    s_waitcnt lgkmcnt(6)
    v_exp_f32 v112, v112
    v_mfma_f32_16x16x32_bf16 v[96:99], a[140:143], a[204:207], v[96:99]
    buffer_load_dwordx4 v15, s[8:11], s19 offen offset:2048 lds
    v_mfma_f32_16x16x32_bf16 v[104:107], a[128:131], a[208:211], v[68:71]
    v_exp_f32 v113, v113
    v_mfma_f32_16x16x32_bf16 v[104:107], a[132:135], a[212:215], v[104:107]
    ds_read_b128 a[168:171], v19 offset:18432
    v_cvt_pk_bf16_f32 v56, v112, v113
    v_mfma_f32_16x16x32_bf16 v[104:107], a[136:139], a[216:219], v[104:107]
    s_waitcnt lgkmcnt(6)
    v_exp_f32 v114, v114
    v_mfma_f32_16x16x32_bf16 v[104:107], a[140:143], a[220:223], v[104:107]
    buffer_load_dwordx4 v15, s[8:11], s19 offen offset:3072 lds
    v_mfma_f32_16x16x32_bf16 v[100:103], a[144:147], a[192:195], v[64:67]
    s_waitcnt lgkmcnt(5)
    s_xor_b32 s16, s16, 98304
    v_exp_f32 v115, v115
    v_mfma_f32_16x16x32_bf16 v[100:103], a[148:151], a[196:199], v[100:103]
    s_waitcnt lgkmcnt(4)
    s_add_u32 s74, s24, 28672
    ds_read_b128 a[172:175], v19 offset:19456
    v_cvt_pk_bf16_f32 v57, v114, v115
    v_mfma_f32_16x16x32_bf16 v[100:103], a[152:155], a[200:203], v[100:103]
    s_waitcnt lgkmcnt(4)
    v_exp_f32 v116, v116
    v_mfma_f32_16x16x32_bf16 v[100:103], a[156:159], a[204:207], v[100:103]
    buffer_load_dwordx4 a[48:51], v1, s[8:11], s74 offen offset:0
    v_mfma_f32_16x16x32_bf16 v[108:111], a[144:147], a[208:211], v[68:71]
    s_add_u32 s74, s24, 28672
    v_exp_f32 v117, v117
    v_mfma_f32_16x16x32_bf16 v[108:111], a[148:151], a[212:215], v[108:111]
    ds_read_b128 a[176:179], v20 offset:20480
    v_cvt_pk_bf16_f32 v58, v116, v117
    v_mfma_f32_16x16x32_bf16 v[108:111], a[152:155], a[216:219], v[108:111]
    v_exp_f32 v118, v118
    v_mfma_f32_16x16x32_bf16 v[108:111], a[156:159], a[220:223], v[108:111]
    buffer_load_dwordx4 a[52:55], v1, s[8:11], s74 offen offset:1024
    v_mfma_f32_16x16x32_bf16 v[32:35], v[28:31], v[48:51], v[32:35]
    s_add_u32 s74, s24, 28672
    v_exp_f32 v119, v119
    v_mfma_f32_16x16x32_bf16 v[36:39], v[28:31], v[52:55], v[36:39]
    s_waitcnt lgkmcnt(4)
    ds_read_b128 a[180:183], v20 offset:21504
    v_cvt_pk_bf16_f32 v59, v118, v119
    v_mfma_f32_16x16x32_bf16 v[128:131], a[160:163], v[48:51], v[128:131]
    s_waitcnt lgkmcnt(4)
    v_exp_f32 v120, v120
    v_mfma_f32_16x16x32_bf16 v[160:163], a[160:163], v[52:55], v[160:163]
    buffer_load_dwordx4 a[56:59], v1, s[8:11], s74 offen offset:2048
    v_mfma_f32_16x16x32_bf16 v[132:135], a[164:167], v[48:51], v[132:135]
    s_add_u32 s74, s24, 28672
    v_exp_f32 v121, v121
    v_mfma_f32_16x16x32_bf16 v[164:167], a[164:167], v[52:55], v[164:167]
    s_waitcnt lgkmcnt(3)
    ds_read_b128 a[184:187], v20 offset:22528
    v_cvt_pk_bf16_f32 v60, v120, v121
    v_mfma_f32_16x16x32_bf16 v[136:139], a[168:171], v[48:51], v[136:139]
    s_waitcnt lgkmcnt(3)
    v_exp_f32 v122, v122
    v_mfma_f32_16x16x32_bf16 v[168:171], a[168:171], v[52:55], v[168:171]
    buffer_load_dwordx4 a[60:63], v1, s[8:11], s74 offen offset:3072
    v_mfma_f32_16x16x32_bf16 v[140:143], a[172:175], v[48:51], v[140:143]
    v_exp_f32 v123, v123
    v_mfma_f32_16x16x32_bf16 v[172:175], a[172:175], v[52:55], v[172:175]
    s_waitcnt lgkmcnt(2)
    ds_read_b128 a[188:191], v20 offset:23552
    v_cvt_pk_bf16_f32 v61, v122, v123
    v_mfma_f32_16x16x32_bf16 v[144:147], a[176:179], v[48:51], v[144:147]
    v_exp_f32 v124, v124
    v_mfma_f32_16x16x32_bf16 v[176:179], a[176:179], v[52:55], v[176:179]
    s_waitcnt lgkmcnt(2)
    v_add_f32 v94, 0xf2000000, v21
    v_min_f32 v94, v94, v70
    v_mfma_f32_16x16x32_bf16 v[148:151], a[180:183], v[48:51], v[148:151]
    v_exp_f32 v125, v125
    v_mfma_f32_16x16x32_bf16 v[180:183], a[180:183], v[52:55], v[180:183]
    s_waitcnt lgkmcnt(1)
    v_cvt_pk_bf16_f32 v62, v124, v125
    v_xor_b32 v19, 98304, v19
    v_mfma_f32_16x16x32_bf16 v[152:155], a[184:187], v[48:51], v[152:155]
    v_exp_f32 v126, v126
    v_mfma_f32_16x16x32_bf16 v[184:187], a[184:187], v[52:55], v[184:187]
    s_waitcnt lgkmcnt(0)
    v_xor_b32 v20, 98304, v20
    v_add_f32 v95, 0xf2400000, v21
    v_mfma_f32_16x16x32_bf16 v[156:159], a[188:191], v[48:51], v[156:159]
    v_exp_f32 v127, v127
    v_mfma_f32_16x16x32_bf16 v[188:191], a[188:191], v[52:55], v[188:191]
    v_cvt_pk_bf16_f32 v63, v126, v127
    v_min_f32 v95, v95, v71
    v_mfma_f32_16x16x32_bf16 v[112:115], a[128:131], a[224:227], v[72:75]
    v_exp_f32 v96, v96
    v_mfma_f32_16x16x32_bf16 v[112:115], a[132:135], a[228:231], v[112:115]
    v_mfma_f32_16x16x32_bf16 v[112:115], a[136:139], a[232:235], v[112:115]
    v_exp_f32 v97, v97
    v_mfma_f32_16x16x32_bf16 v[112:115], a[140:143], a[236:239], v[112:115]
    v_cvt_pk_bf16_f32 v48, v96, v97
    v_mfma_f32_16x16x32_bf16 v[120:123], a[128:131], a[240:243], v[76:79]
    v_exp_f32 v98, v98
    v_mfma_f32_16x16x32_bf16 v[120:123], a[132:135], a[244:247], v[120:123]
    v_mfma_f32_16x16x32_bf16 v[120:123], a[136:139], a[248:251], v[120:123]
    v_exp_f32 v99, v99
    v_mfma_f32_16x16x32_bf16 v[120:123], a[140:143], a[252:255], v[120:123]
    v_mfma_f32_16x16x32_bf16 v[116:119], a[144:147], a[224:227], v[72:75]
    v_exp_f32 v100, v100
    v_mfma_f32_16x16x32_bf16 v[116:119], a[148:151], a[228:231], v[116:119]
    ds_read_b128 a[128:131], v18 offset:16384
    v_cvt_pk_bf16_f32 v49, v98, v99
    v_mfma_f32_16x16x32_bf16 v[116:119], a[152:155], a[232:235], v[116:119]
    s_add_u32 s19, s82, 32768
    v_exp_f32 v101, v101
    v_mfma_f32_16x16x32_bf16 v[116:119], a[156:159], a[236:239], v[116:119]
    s_sub_u32 s82, s12, s13
    ds_read_b128 a[132:135], v18 offset:17408
    v_cvt_pk_bf16_f32 v50, v100, v101
    v_mfma_f32_16x16x32_bf16 v[124:127], a[144:147], a[240:243], v[76:79]
    s_sub_u32 s82, s82, 1
    v_exp_f32 v102, v102
    v_mfma_f32_16x16x32_bf16 v[124:127], a[148:151], a[244:247], v[124:127]
    s_cmp_gt_u32 s12, s13
    s_cselect_b32 s82, s82, s12
    s_lshl_b32 s82, s82, 16
    ds_read_b128 a[136:139], v18 offset:18432
    v_mfma_f32_16x16x32_bf16 v[124:127], a[152:155], a[248:251], v[124:127]
    s_add_u32 s82, s82, s81
    v_exp_f32 v103, v103
    v_mfma_f32_16x16x32_bf16 v[124:127], a[156:159], a[252:255], v[124:127]
    s_cmp_ge_u32 s12, 17
    s_cselect_b32 s82, 2147471360, s82
    ds_read_b128 a[140:143], v18 offset:19456
    v_cvt_pk_bf16_f32 v51, v102, v103
    v_mfma_f32_16x16x32_bf16 v[40:43], v[28:31], v[56:59], v[40:43]
    s_add_u32 s12, s12, 1
    v_exp_f32 v104, v104
    v_mfma_f32_16x16x32_bf16 v[44:47], v[28:31], v[60:63], v[44:47]
    ds_read_b128 a[144:147], v18 offset:20480
    v_mfma_f32_16x16x32_bf16 v[192:195], a[160:163], v[56:59], v[192:195]
    v_exp_f32 v105, v105
    v_mfma_f32_16x16x32_bf16 v[224:227], a[160:163], v[60:63], v[224:227]
    ds_read_b128 a[148:151], v18 offset:21504
    v_cvt_pk_bf16_f32 v52, v104, v105
    v_mfma_f32_16x16x32_bf16 v[196:199], a[164:167], v[56:59], v[196:199]
    v_exp_f32 v106, v106
    v_mfma_f32_16x16x32_bf16 v[228:231], a[164:167], v[60:63], v[228:231]
    ds_read_b128 a[152:155], v18 offset:22528
    v_mfma_f32_16x16x32_bf16 v[200:203], a[168:171], v[56:59], v[200:203]
    v_exp_f32 v107, v107
    v_mfma_f32_16x16x32_bf16 v[232:235], a[168:171], v[60:63], v[232:235]
    ds_read_b128 a[156:159], v18 offset:23552
    v_cvt_pk_bf16_f32 v53, v106, v107
    v_mfma_f32_16x16x32_bf16 v[204:207], a[172:175], v[56:59], v[204:207]
    v_exp_f32 v108, v108
    v_mfma_f32_16x16x32_bf16 v[236:239], a[172:175], v[60:63], v[236:239]
    v_mfma_f32_16x16x32_bf16 v[208:211], a[176:179], v[56:59], v[208:211]
    v_exp_f32 v109, v109
    v_mfma_f32_16x16x32_bf16 v[240:243], a[176:179], v[60:63], v[240:243]
    v_cvt_pk_bf16_f32 v54, v108, v109
    v_xor_b32 v18, 196608, v18
    v_mfma_f32_16x16x32_bf16 v[212:215], a[180:183], v[56:59], v[212:215]
    v_exp_f32 v110, v110
    v_mfma_f32_16x16x32_bf16 v[244:247], a[180:183], v[60:63], v[244:247]
    v_mfma_f32_16x16x32_bf16 v[216:219], a[184:187], v[56:59], v[216:219]
    v_exp_f32 v111, v111
    v_mfma_f32_16x16x32_bf16 v[248:251], a[184:187], v[60:63], v[248:251]
    v_cvt_pk_bf16_f32 v55, v110, v111
    v_mfma_f32_16x16x32_bf16 v[220:223], a[188:191], v[56:59], v[220:223]
    v_mfma_f32_16x16x32_bf16 v[252:255], a[188:191], v[60:63], v[252:255]
    s_waitcnt vmcnt(4) lgkmcnt(0)
    s_barrier
    v_mfma_f32_16x16x32_bf16 v[96:99], a[128:131], a[192:195], v[64:67]
    s_add_u32 m0, s15, 0
    ds_read_b128 a[160:163], v19 offset:0
    v_mfma_f32_16x16x32_bf16 v[96:99], a[132:135], a[196:199], v[96:99]
    ds_read_b128 a[164:167], v19 offset:1024
    v_mfma_f32_16x16x32_bf16 v[96:99], a[136:139], a[200:203], v[96:99]
    v_exp_f32 v112, v112
    v_mfma_f32_16x16x32_bf16 v[96:99], a[140:143], a[204:207], v[96:99]
    buffer_load_dwordx4 v1, s[8:11], s82 offen offset:0 lds
    v_mfma_f32_16x16x32_bf16 v[104:107], a[128:131], a[208:211], v[68:71]
    v_exp_f32 v113, v113
    v_mfma_f32_16x16x32_bf16 v[104:107], a[132:135], a[212:215], v[104:107]
    ds_read_b128 a[168:171], v19 offset:2048
    v_cvt_pk_bf16_f32 v56, v112, v113
    v_mfma_f32_16x16x32_bf16 v[104:107], a[136:139], a[216:219], v[104:107]
    v_exp_f32 v114, v114
    v_mfma_f32_16x16x32_bf16 v[104:107], a[140:143], a[220:223], v[104:107]
    buffer_load_dwordx4 v1, s[8:11], s82 offen offset:1024 lds
    v_mfma_f32_16x16x32_bf16 v[100:103], a[144:147], a[192:195], v[64:67]
    v_exp_f32 v115, v115
    v_mfma_f32_16x16x32_bf16 v[100:103], a[148:151], a[196:199], v[100:103]
    ds_read_b128 a[172:175], v19 offset:3072
    v_cvt_pk_bf16_f32 v57, v114, v115
    v_mfma_f32_16x16x32_bf16 v[100:103], a[152:155], a[200:203], v[100:103]
    v_exp_f32 v116, v116
    v_mfma_f32_16x16x32_bf16 v[100:103], a[156:159], a[204:207], v[100:103]
    buffer_load_dwordx4 v1, s[8:11], s82 offen offset:2048 lds
    v_mfma_f32_16x16x32_bf16 v[108:111], a[144:147], a[208:211], v[68:71]
    v_exp_f32 v117, v117
    v_mfma_f32_16x16x32_bf16 v[108:111], a[148:151], a[212:215], v[108:111]
    ds_read_b128 a[176:179], v20 offset:4096
    v_cvt_pk_bf16_f32 v58, v116, v117
    v_mfma_f32_16x16x32_bf16 v[108:111], a[152:155], a[216:219], v[108:111]
    v_exp_f32 v118, v118
    v_mfma_f32_16x16x32_bf16 v[108:111], a[156:159], a[220:223], v[108:111]
    buffer_load_dwordx4 v1, s[8:11], s82 offen offset:3072 lds
    v_mfma_f32_16x16x32_bf16 v[32:35], v[28:31], v[48:51], v[32:35]
    s_add_u32 m0, s15, 4096
    v_exp_f32 v119, v119
    v_mfma_f32_16x16x32_bf16 v[36:39], v[28:31], v[52:55], v[36:39]
    s_waitcnt lgkmcnt(4)
    ds_read_b128 a[180:183], v20 offset:5120
    v_cvt_pk_bf16_f32 v59, v118, v119
    v_mfma_f32_16x16x32_bf16 v[128:131], a[160:163], v[48:51], v[128:131]
    v_exp_f32 v120, v120
    v_mfma_f32_16x16x32_bf16 v[160:163], a[160:163], v[52:55], v[160:163]
    s_waitcnt lgkmcnt(4)
    v_mfma_f32_16x16x32_bf16 v[132:135], a[164:167], v[48:51], v[132:135]
    v_exp_f32 v121, v121
    v_mfma_f32_16x16x32_bf16 v[164:167], a[164:167], v[52:55], v[164:167]
    s_waitcnt lgkmcnt(3)
    ds_read_b128 a[184:187], v20 offset:6144
    v_cvt_pk_bf16_f32 v60, v120, v121
    v_mfma_f32_16x16x32_bf16 v[136:139], a[168:171], v[48:51], v[136:139]
    s_waitcnt lgkmcnt(3)
    v_exp_f32 v122, v122
    v_mfma_f32_16x16x32_bf16 v[168:171], a[168:171], v[52:55], v[168:171]
    buffer_load_dwordx4 v15, s[8:11], s82 offen offset:0 lds
    v_mfma_f32_16x16x32_bf16 v[140:143], a[172:175], v[48:51], v[140:143]
    v_exp_f32 v123, v123
    v_mfma_f32_16x16x32_bf16 v[172:175], a[172:175], v[52:55], v[172:175]
    s_waitcnt lgkmcnt(2)
    ds_read_b128 a[188:191], v20 offset:7168
    v_cvt_pk_bf16_f32 v61, v122, v123
    v_mfma_f32_16x16x32_bf16 v[144:147], a[176:179], v[48:51], v[144:147]
    s_waitcnt lgkmcnt(2)
    v_exp_f32 v124, v124
    v_mfma_f32_16x16x32_bf16 v[176:179], a[176:179], v[52:55], v[176:179]
    buffer_load_dwordx4 v15, s[8:11], s82 offen offset:1024 lds
    v_mfma_f32_16x16x32_bf16 v[148:151], a[180:183], v[48:51], v[148:151]
    v_exp_f32 v125, v125
    v_mfma_f32_16x16x32_bf16 v[180:183], a[180:183], v[52:55], v[180:183]
    s_waitcnt lgkmcnt(1)
    v_cvt_pk_bf16_f32 v62, v124, v125
    v_mfma_f32_16x16x32_bf16 v[152:155], a[184:187], v[48:51], v[152:155]
    s_waitcnt lgkmcnt(0)
    v_exp_f32 v126, v126
    v_mfma_f32_16x16x32_bf16 v[184:187], a[184:187], v[52:55], v[184:187]
    buffer_load_dwordx4 v15, s[8:11], s82 offen offset:2048 lds
    v_mfma_f32_16x16x32_bf16 v[156:159], a[188:191], v[48:51], v[156:159]
    v_exp_f32 v127, v127
    v_mfma_f32_16x16x32_bf16 v[188:191], a[188:191], v[52:55], v[188:191]
    v_cvt_pk_bf16_f32 v63, v126, v127
    v_mfma_f32_16x16x32_bf16 v[112:115], a[128:131], a[224:227], v[72:75]
    v_mfma_f32_16x16x32_bf16 v[112:115], a[132:135], a[228:231], v[112:115]
    v_mfma_f32_16x16x32_bf16 v[112:115], a[136:139], a[232:235], v[112:115]
    v_exp_f32 v96, v96
    v_mfma_f32_16x16x32_bf16 v[112:115], a[140:143], a[236:239], v[112:115]
    buffer_load_dwordx4 v15, s[8:11], s82 offen offset:3072 lds
    v_mfma_f32_16x16x32_bf16 v[120:123], a[128:131], a[240:243], v[76:79]
    s_xor_b32 s15, s15, 196608
    v_exp_f32 v97, v97
    v_mfma_f32_16x16x32_bf16 v[120:123], a[132:135], a[244:247], v[120:123]
    s_add_u32 m0, s16, 0
    ds_read_b128 a[128:131], v18 offset:0
    v_cvt_pk_bf16_f32 v48, v96, v97
    v_mfma_f32_16x16x32_bf16 v[120:123], a[136:139], a[248:251], v[120:123]
    v_exp_f32 v98, v98
    v_mfma_f32_16x16x32_bf16 v[120:123], a[140:143], a[252:255], v[120:123]
    buffer_load_dwordx4 v1, s[8:11], s19 offen offset:0 lds
    v_mfma_f32_16x16x32_bf16 v[116:119], a[144:147], a[224:227], v[72:75]
    v_exp_f32 v99, v99
    v_mfma_f32_16x16x32_bf16 v[116:119], a[148:151], a[228:231], v[116:119]
    ds_read_b128 a[132:135], v18 offset:1024
    v_cvt_pk_bf16_f32 v49, v98, v99
    v_mfma_f32_16x16x32_bf16 v[116:119], a[152:155], a[232:235], v[116:119]
    v_exp_f32 v100, v100
    v_mfma_f32_16x16x32_bf16 v[116:119], a[156:159], a[236:239], v[116:119]
    buffer_load_dwordx4 v1, s[8:11], s19 offen offset:1024 lds
    v_mfma_f32_16x16x32_bf16 v[124:127], a[144:147], a[240:243], v[76:79]
    v_exp_f32 v101, v101
    v_mfma_f32_16x16x32_bf16 v[124:127], a[148:151], a[244:247], v[124:127]
    ds_read_b128 a[136:139], v18 offset:2048
    v_cvt_pk_bf16_f32 v50, v100, v101
    v_mfma_f32_16x16x32_bf16 v[124:127], a[152:155], a[248:251], v[124:127]
    v_exp_f32 v102, v102
    v_mfma_f32_16x16x32_bf16 v[124:127], a[156:159], a[252:255], v[124:127]
    buffer_load_dwordx4 v1, s[8:11], s19 offen offset:2048 lds
    v_mfma_f32_16x16x32_bf16 v[40:43], v[28:31], v[56:59], v[40:43]
    v_exp_f32 v103, v103
    v_mfma_f32_16x16x32_bf16 v[44:47], v[28:31], v[60:63], v[44:47]
    ds_read_b128 a[140:143], v18 offset:3072
    v_cvt_pk_bf16_f32 v51, v102, v103
    v_mfma_f32_16x16x32_bf16 v[192:195], a[160:163], v[56:59], v[192:195]
    v_exp_f32 v104, v104
    v_mfma_f32_16x16x32_bf16 v[224:227], a[160:163], v[60:63], v[224:227]
    v_mfma_f32_16x16x32_bf16 v[196:199], a[164:167], v[56:59], v[196:199]
    v_exp_f32 v105, v105
    v_mfma_f32_16x16x32_bf16 v[228:231], a[164:167], v[60:63], v[228:231]
    ds_read_b128 a[144:147], v18 offset:4096
    v_cvt_pk_bf16_f32 v52, v104, v105
    v_mfma_f32_16x16x32_bf16 v[200:203], a[168:171], v[56:59], v[200:203]
    v_exp_f32 v106, v106
    v_mfma_f32_16x16x32_bf16 v[232:235], a[168:171], v[60:63], v[232:235]
    buffer_load_dwordx4 v1, s[8:11], s19 offen offset:3072 lds
    v_mfma_f32_16x16x32_bf16 v[204:207], a[172:175], v[56:59], v[204:207]
    s_add_u32 m0, s16, 4096
    v_exp_f32 v107, v107
    v_mfma_f32_16x16x32_bf16 v[236:239], a[172:175], v[60:63], v[236:239]
    ds_read_b128 a[148:151], v18 offset:5120
    v_cvt_pk_bf16_f32 v53, v106, v107
    v_mfma_f32_16x16x32_bf16 v[208:211], a[176:179], v[56:59], v[208:211]
    v_exp_f32 v108, v108
    v_mfma_f32_16x16x32_bf16 v[240:243], a[176:179], v[60:63], v[240:243]
    buffer_load_dwordx4 v15, s[8:11], s19 offen offset:0 lds
    v_mfma_f32_16x16x32_bf16 v[212:215], a[180:183], v[56:59], v[212:215]
    v_exp_f32 v109, v109
    v_mfma_f32_16x16x32_bf16 v[244:247], a[180:183], v[60:63], v[244:247]
    ds_read_b128 a[152:155], v18 offset:6144
    v_cvt_pk_bf16_f32 v54, v108, v109
    v_mfma_f32_16x16x32_bf16 v[216:219], a[184:187], v[56:59], v[216:219]
    v_exp_f32 v110, v110
    v_mfma_f32_16x16x32_bf16 v[248:251], a[184:187], v[60:63], v[248:251]
    buffer_load_dwordx4 v15, s[8:11], s19 offen offset:1024 lds
    v_mfma_f32_16x16x32_bf16 v[220:223], a[188:191], v[56:59], v[220:223]
    v_exp_f32 v111, v111
    v_mfma_f32_16x16x32_bf16 v[252:255], a[188:191], v[60:63], v[252:255]
    ds_read_b128 a[156:159], v18 offset:7168
    v_cvt_pk_bf16_f32 v55, v110, v111
    s_cmp_eq_u32 s14, 0
    s_cbranch_scc1 L_t2_diag
.p2align 3
L_t2_loop:
    s_waitcnt lgkmcnt(7)
    v_mfma_f32_16x16x32_bf16 v[96:99], a[128:131], a[192:195], v[64:67]
    s_waitcnt lgkmcnt(6)
    ds_read_b128 a[160:163], v19 offset:16384
    v_mfma_f32_16x16x32_bf16 v[96:99], a[132:135], a[196:199], v[96:99]
    s_waitcnt lgkmcnt(6)
    ds_read_b128 a[164:167], v19 offset:17408
    v_mfma_f32_16x16x32_bf16 v[96:99], a[136:139], a[200:203], v[96:99]
    s_waitcnt lgkmcnt(6)
    v_exp_f32 v112, v112
    v_mfma_f32_16x16x32_bf16 v[96:99], a[140:143], a[204:207], v[96:99]
    buffer_load_dwordx4 v15, s[8:11], s19 offen offset:2048 lds
    v_mfma_f32_16x16x32_bf16 v[104:107], a[128:131], a[208:211], v[68:71]
    v_exp_f32 v113, v113
    v_mfma_f32_16x16x32_bf16 v[104:107], a[132:135], a[212:215], v[104:107]
    ds_read_b128 a[168:171], v19 offset:18432
    v_cvt_pk_bf16_f32 v56, v112, v113
    v_mfma_f32_16x16x32_bf16 v[104:107], a[136:139], a[216:219], v[104:107]
    s_waitcnt lgkmcnt(6)
    v_exp_f32 v114, v114
    v_mfma_f32_16x16x32_bf16 v[104:107], a[140:143], a[220:223], v[104:107]
    buffer_load_dwordx4 v15, s[8:11], s19 offen offset:3072 lds
    v_mfma_f32_16x16x32_bf16 v[100:103], a[144:147], a[192:195], v[64:67]
    s_waitcnt lgkmcnt(5)
    s_xor_b32 s16, s16, 98304
    v_exp_f32 v115, v115
    v_mfma_f32_16x16x32_bf16 v[100:103], a[148:151], a[196:199], v[100:103]
    s_waitcnt lgkmcnt(4)
    ds_read_b128 a[172:175], v19 offset:19456
    v_cvt_pk_bf16_f32 v57, v114, v115
    v_mfma_f32_16x16x32_bf16 v[100:103], a[152:155], a[200:203], v[100:103]
    s_waitcnt lgkmcnt(4)
    v_exp_f32 v116, v116
    v_mfma_f32_16x16x32_bf16 v[100:103], a[156:159], a[204:207], v[100:103]
    v_mfma_f32_16x16x32_bf16 v[108:111], a[144:147], a[208:211], v[68:71]
    v_exp_f32 v117, v117
    v_mfma_f32_16x16x32_bf16 v[108:111], a[148:151], a[212:215], v[108:111]
    ds_read_b128 a[176:179], v20 offset:20480
    v_cvt_pk_bf16_f32 v58, v116, v117
    v_mfma_f32_16x16x32_bf16 v[108:111], a[152:155], a[216:219], v[108:111]
    v_exp_f32 v118, v118
    v_mfma_f32_16x16x32_bf16 v[108:111], a[156:159], a[220:223], v[108:111]
    v_mfma_f32_16x16x32_bf16 v[32:35], v[28:31], v[48:51], v[32:35]
    v_exp_f32 v119, v119
    v_mfma_f32_16x16x32_bf16 v[36:39], v[28:31], v[52:55], v[36:39]
    s_waitcnt lgkmcnt(4)
    ds_read_b128 a[180:183], v20 offset:21504
    v_cvt_pk_bf16_f32 v59, v118, v119
    v_mfma_f32_16x16x32_bf16 v[128:131], a[160:163], v[48:51], v[128:131]
    v_exp_f32 v120, v120
    v_mfma_f32_16x16x32_bf16 v[160:163], a[160:163], v[52:55], v[160:163]
    s_waitcnt lgkmcnt(4)
    v_mfma_f32_16x16x32_bf16 v[132:135], a[164:167], v[48:51], v[132:135]
    v_exp_f32 v121, v121
    v_mfma_f32_16x16x32_bf16 v[164:167], a[164:167], v[52:55], v[164:167]
    s_waitcnt lgkmcnt(3)
    ds_read_b128 a[184:187], v20 offset:22528
    v_cvt_pk_bf16_f32 v60, v120, v121
    v_mfma_f32_16x16x32_bf16 v[136:139], a[168:171], v[48:51], v[136:139]
    v_exp_f32 v122, v122
    v_mfma_f32_16x16x32_bf16 v[168:171], a[168:171], v[52:55], v[168:171]
    s_waitcnt lgkmcnt(3)
    v_mfma_f32_16x16x32_bf16 v[140:143], a[172:175], v[48:51], v[140:143]
    v_exp_f32 v123, v123
    v_mfma_f32_16x16x32_bf16 v[172:175], a[172:175], v[52:55], v[172:175]
    s_waitcnt lgkmcnt(2)
    ds_read_b128 a[188:191], v20 offset:23552
    v_cvt_pk_bf16_f32 v61, v122, v123
    v_mfma_f32_16x16x32_bf16 v[144:147], a[176:179], v[48:51], v[144:147]
    v_exp_f32 v124, v124
    v_mfma_f32_16x16x32_bf16 v[176:179], a[176:179], v[52:55], v[176:179]
    s_waitcnt lgkmcnt(2)
    v_mfma_f32_16x16x32_bf16 v[148:151], a[180:183], v[48:51], v[148:151]
    v_exp_f32 v125, v125
    v_mfma_f32_16x16x32_bf16 v[180:183], a[180:183], v[52:55], v[180:183]
    s_waitcnt lgkmcnt(1)
    v_cvt_pk_bf16_f32 v62, v124, v125
    v_xor_b32 v19, 98304, v19
    v_mfma_f32_16x16x32_bf16 v[152:155], a[184:187], v[48:51], v[152:155]
    v_exp_f32 v126, v126
    v_mfma_f32_16x16x32_bf16 v[184:187], a[184:187], v[52:55], v[184:187]
    s_waitcnt lgkmcnt(0)
    v_xor_b32 v20, 98304, v20
    v_mfma_f32_16x16x32_bf16 v[156:159], a[188:191], v[48:51], v[156:159]
    v_exp_f32 v127, v127
    v_mfma_f32_16x16x32_bf16 v[188:191], a[188:191], v[52:55], v[188:191]
    v_cvt_pk_bf16_f32 v63, v126, v127
    v_mfma_f32_16x16x32_bf16 v[112:115], a[128:131], a[224:227], v[72:75]
    v_exp_f32 v96, v96
    v_mfma_f32_16x16x32_bf16 v[112:115], a[132:135], a[228:231], v[112:115]
    v_mfma_f32_16x16x32_bf16 v[112:115], a[136:139], a[232:235], v[112:115]
    v_exp_f32 v97, v97
    v_mfma_f32_16x16x32_bf16 v[112:115], a[140:143], a[236:239], v[112:115]
    v_cvt_pk_bf16_f32 v48, v96, v97
    v_mfma_f32_16x16x32_bf16 v[120:123], a[128:131], a[240:243], v[76:79]
    v_exp_f32 v98, v98
    v_mfma_f32_16x16x32_bf16 v[120:123], a[132:135], a[244:247], v[120:123]
    v_mfma_f32_16x16x32_bf16 v[120:123], a[136:139], a[248:251], v[120:123]
    v_exp_f32 v99, v99
    v_mfma_f32_16x16x32_bf16 v[120:123], a[140:143], a[252:255], v[120:123]
    v_mfma_f32_16x16x32_bf16 v[116:119], a[144:147], a[224:227], v[72:75]
    v_exp_f32 v100, v100
    v_mfma_f32_16x16x32_bf16 v[116:119], a[148:151], a[228:231], v[116:119]
    ds_read_b128 a[128:131], v18 offset:16384
    v_cvt_pk_bf16_f32 v49, v98, v99
    v_mfma_f32_16x16x32_bf16 v[116:119], a[152:155], a[232:235], v[116:119]
    s_add_u32 s19, s82, 32768
    v_exp_f32 v101, v101
    v_mfma_f32_16x16x32_bf16 v[116:119], a[156:159], a[236:239], v[116:119]
    s_sub_u32 s82, s12, s13
    ds_read_b128 a[132:135], v18 offset:17408
    v_cvt_pk_bf16_f32 v50, v100, v101
    v_mfma_f32_16x16x32_bf16 v[124:127], a[144:147], a[240:243], v[76:79]
    s_sub_u32 s82, s82, 1
    v_exp_f32 v102, v102
    v_mfma_f32_16x16x32_bf16 v[124:127], a[148:151], a[244:247], v[124:127]
    s_cmp_gt_u32 s12, s13
    s_cselect_b32 s82, s82, s12
    s_lshl_b32 s82, s82, 16
    ds_read_b128 a[136:139], v18 offset:18432
    v_mfma_f32_16x16x32_bf16 v[124:127], a[152:155], a[248:251], v[124:127]
    s_add_u32 s82, s82, s81
    v_exp_f32 v103, v103
    v_mfma_f32_16x16x32_bf16 v[124:127], a[156:159], a[252:255], v[124:127]
    s_cmp_ge_u32 s12, 17
    s_cselect_b32 s82, 2147471360, s82
    ds_read_b128 a[140:143], v18 offset:19456
    v_cvt_pk_bf16_f32 v51, v102, v103
    v_mfma_f32_16x16x32_bf16 v[40:43], v[28:31], v[56:59], v[40:43]
    s_add_u32 s12, s12, 1
    v_exp_f32 v104, v104
    v_mfma_f32_16x16x32_bf16 v[44:47], v[28:31], v[60:63], v[44:47]
    ds_read_b128 a[144:147], v18 offset:20480
    v_mfma_f32_16x16x32_bf16 v[192:195], a[160:163], v[56:59], v[192:195]
    v_exp_f32 v105, v105
    v_mfma_f32_16x16x32_bf16 v[224:227], a[160:163], v[60:63], v[224:227]
    ds_read_b128 a[148:151], v18 offset:21504
    v_cvt_pk_bf16_f32 v52, v104, v105
    v_mfma_f32_16x16x32_bf16 v[196:199], a[164:167], v[56:59], v[196:199]
    v_exp_f32 v106, v106
    v_mfma_f32_16x16x32_bf16 v[228:231], a[164:167], v[60:63], v[228:231]
    ds_read_b128 a[152:155], v18 offset:22528
    v_mfma_f32_16x16x32_bf16 v[200:203], a[168:171], v[56:59], v[200:203]
    v_exp_f32 v107, v107
    v_mfma_f32_16x16x32_bf16 v[232:235], a[168:171], v[60:63], v[232:235]
    ds_read_b128 a[156:159], v18 offset:23552
    v_cvt_pk_bf16_f32 v53, v106, v107
    v_mfma_f32_16x16x32_bf16 v[204:207], a[172:175], v[56:59], v[204:207]
    v_exp_f32 v108, v108
    v_mfma_f32_16x16x32_bf16 v[236:239], a[172:175], v[60:63], v[236:239]
    v_mfma_f32_16x16x32_bf16 v[208:211], a[176:179], v[56:59], v[208:211]
    v_exp_f32 v109, v109
    v_mfma_f32_16x16x32_bf16 v[240:243], a[176:179], v[60:63], v[240:243]
    v_cvt_pk_bf16_f32 v54, v108, v109
    v_xor_b32 v18, 196608, v18
    v_mfma_f32_16x16x32_bf16 v[212:215], a[180:183], v[56:59], v[212:215]
    v_exp_f32 v110, v110
    v_mfma_f32_16x16x32_bf16 v[244:247], a[180:183], v[60:63], v[244:247]
    v_mfma_f32_16x16x32_bf16 v[216:219], a[184:187], v[56:59], v[216:219]
    v_exp_f32 v111, v111
    v_mfma_f32_16x16x32_bf16 v[248:251], a[184:187], v[60:63], v[248:251]
    v_cvt_pk_bf16_f32 v55, v110, v111
    v_mfma_f32_16x16x32_bf16 v[220:223], a[188:191], v[56:59], v[220:223]
    v_mfma_f32_16x16x32_bf16 v[252:255], a[188:191], v[60:63], v[252:255]
    s_waitcnt vmcnt(0) lgkmcnt(0)
    s_barrier
    v_mfma_f32_16x16x32_bf16 v[96:99], a[128:131], a[192:195], v[64:67]
    s_add_u32 m0, s15, 0
    ds_read_b128 a[160:163], v19 offset:0
    v_mfma_f32_16x16x32_bf16 v[96:99], a[132:135], a[196:199], v[96:99]
    ds_read_b128 a[164:167], v19 offset:1024
    v_mfma_f32_16x16x32_bf16 v[96:99], a[136:139], a[200:203], v[96:99]
    v_exp_f32 v112, v112
    v_mfma_f32_16x16x32_bf16 v[96:99], a[140:143], a[204:207], v[96:99]
    buffer_load_dwordx4 v1, s[8:11], s82 offen offset:0 lds
    v_mfma_f32_16x16x32_bf16 v[104:107], a[128:131], a[208:211], v[68:71]
    v_exp_f32 v113, v113
    v_mfma_f32_16x16x32_bf16 v[104:107], a[132:135], a[212:215], v[104:107]
    ds_read_b128 a[168:171], v19 offset:2048
    v_cvt_pk_bf16_f32 v56, v112, v113
    v_mfma_f32_16x16x32_bf16 v[104:107], a[136:139], a[216:219], v[104:107]
    v_exp_f32 v114, v114
    v_mfma_f32_16x16x32_bf16 v[104:107], a[140:143], a[220:223], v[104:107]
    buffer_load_dwordx4 v1, s[8:11], s82 offen offset:1024 lds
    v_mfma_f32_16x16x32_bf16 v[100:103], a[144:147], a[192:195], v[64:67]
    v_exp_f32 v115, v115
    v_mfma_f32_16x16x32_bf16 v[100:103], a[148:151], a[196:199], v[100:103]
    ds_read_b128 a[172:175], v19 offset:3072
    v_cvt_pk_bf16_f32 v57, v114, v115
    v_mfma_f32_16x16x32_bf16 v[100:103], a[152:155], a[200:203], v[100:103]
    v_exp_f32 v116, v116
    v_mfma_f32_16x16x32_bf16 v[100:103], a[156:159], a[204:207], v[100:103]
    buffer_load_dwordx4 v1, s[8:11], s82 offen offset:2048 lds
    v_mfma_f32_16x16x32_bf16 v[108:111], a[144:147], a[208:211], v[68:71]
    v_exp_f32 v117, v117
    v_mfma_f32_16x16x32_bf16 v[108:111], a[148:151], a[212:215], v[108:111]
    ds_read_b128 a[176:179], v20 offset:4096
    v_cvt_pk_bf16_f32 v58, v116, v117
    v_mfma_f32_16x16x32_bf16 v[108:111], a[152:155], a[216:219], v[108:111]
    v_exp_f32 v118, v118
    v_mfma_f32_16x16x32_bf16 v[108:111], a[156:159], a[220:223], v[108:111]
    buffer_load_dwordx4 v1, s[8:11], s82 offen offset:3072 lds
    v_mfma_f32_16x16x32_bf16 v[32:35], v[28:31], v[48:51], v[32:35]
    s_add_u32 m0, s15, 4096
    v_exp_f32 v119, v119
    v_mfma_f32_16x16x32_bf16 v[36:39], v[28:31], v[52:55], v[36:39]
    s_waitcnt lgkmcnt(4)
    ds_read_b128 a[180:183], v20 offset:5120
    v_cvt_pk_bf16_f32 v59, v118, v119
    v_mfma_f32_16x16x32_bf16 v[128:131], a[160:163], v[48:51], v[128:131]
    v_exp_f32 v120, v120
    v_mfma_f32_16x16x32_bf16 v[160:163], a[160:163], v[52:55], v[160:163]
    s_waitcnt lgkmcnt(4)
    v_mfma_f32_16x16x32_bf16 v[132:135], a[164:167], v[48:51], v[132:135]
    v_exp_f32 v121, v121
    v_mfma_f32_16x16x32_bf16 v[164:167], a[164:167], v[52:55], v[164:167]
    s_waitcnt lgkmcnt(3)
    ds_read_b128 a[184:187], v20 offset:6144
    v_cvt_pk_bf16_f32 v60, v120, v121
    v_mfma_f32_16x16x32_bf16 v[136:139], a[168:171], v[48:51], v[136:139]
    s_waitcnt lgkmcnt(3)
    v_exp_f32 v122, v122
    v_mfma_f32_16x16x32_bf16 v[168:171], a[168:171], v[52:55], v[168:171]
    buffer_load_dwordx4 v15, s[8:11], s82 offen offset:0 lds
    v_mfma_f32_16x16x32_bf16 v[140:143], a[172:175], v[48:51], v[140:143]
    v_exp_f32 v123, v123
    v_mfma_f32_16x16x32_bf16 v[172:175], a[172:175], v[52:55], v[172:175]
    s_waitcnt lgkmcnt(2)
    ds_read_b128 a[188:191], v20 offset:7168
    v_cvt_pk_bf16_f32 v61, v122, v123
    v_mfma_f32_16x16x32_bf16 v[144:147], a[176:179], v[48:51], v[144:147]
    s_waitcnt lgkmcnt(2)
    v_exp_f32 v124, v124
    v_mfma_f32_16x16x32_bf16 v[176:179], a[176:179], v[52:55], v[176:179]
    buffer_load_dwordx4 v15, s[8:11], s82 offen offset:1024 lds
    v_mfma_f32_16x16x32_bf16 v[148:151], a[180:183], v[48:51], v[148:151]
    v_exp_f32 v125, v125
    v_mfma_f32_16x16x32_bf16 v[180:183], a[180:183], v[52:55], v[180:183]
    s_waitcnt lgkmcnt(1)
    v_cvt_pk_bf16_f32 v62, v124, v125
    v_mfma_f32_16x16x32_bf16 v[152:155], a[184:187], v[48:51], v[152:155]
    s_waitcnt lgkmcnt(0)
    v_exp_f32 v126, v126
    v_mfma_f32_16x16x32_bf16 v[184:187], a[184:187], v[52:55], v[184:187]
    buffer_load_dwordx4 v15, s[8:11], s82 offen offset:2048 lds
    v_mfma_f32_16x16x32_bf16 v[156:159], a[188:191], v[48:51], v[156:159]
    v_exp_f32 v127, v127
    v_mfma_f32_16x16x32_bf16 v[188:191], a[188:191], v[52:55], v[188:191]
    v_cvt_pk_bf16_f32 v63, v126, v127
    v_mfma_f32_16x16x32_bf16 v[112:115], a[128:131], a[224:227], v[72:75]
    v_mfma_f32_16x16x32_bf16 v[112:115], a[132:135], a[228:231], v[112:115]
    v_mfma_f32_16x16x32_bf16 v[112:115], a[136:139], a[232:235], v[112:115]
    v_exp_f32 v96, v96
    v_mfma_f32_16x16x32_bf16 v[112:115], a[140:143], a[236:239], v[112:115]
    buffer_load_dwordx4 v15, s[8:11], s82 offen offset:3072 lds
    v_mfma_f32_16x16x32_bf16 v[120:123], a[128:131], a[240:243], v[76:79]
    s_xor_b32 s15, s15, 196608
    v_exp_f32 v97, v97
    v_mfma_f32_16x16x32_bf16 v[120:123], a[132:135], a[244:247], v[120:123]
    s_add_u32 m0, s16, 0
    ds_read_b128 a[128:131], v18 offset:0
    v_cvt_pk_bf16_f32 v48, v96, v97
    v_mfma_f32_16x16x32_bf16 v[120:123], a[136:139], a[248:251], v[120:123]
    v_exp_f32 v98, v98
    v_mfma_f32_16x16x32_bf16 v[120:123], a[140:143], a[252:255], v[120:123]
    buffer_load_dwordx4 v1, s[8:11], s19 offen offset:0 lds
    v_mfma_f32_16x16x32_bf16 v[116:119], a[144:147], a[224:227], v[72:75]
    v_exp_f32 v99, v99
    v_mfma_f32_16x16x32_bf16 v[116:119], a[148:151], a[228:231], v[116:119]
    ds_read_b128 a[132:135], v18 offset:1024
    v_cvt_pk_bf16_f32 v49, v98, v99
    v_mfma_f32_16x16x32_bf16 v[116:119], a[152:155], a[232:235], v[116:119]
    v_exp_f32 v100, v100
    v_mfma_f32_16x16x32_bf16 v[116:119], a[156:159], a[236:239], v[116:119]
    buffer_load_dwordx4 v1, s[8:11], s19 offen offset:1024 lds
    v_mfma_f32_16x16x32_bf16 v[124:127], a[144:147], a[240:243], v[76:79]
    v_exp_f32 v101, v101
    v_mfma_f32_16x16x32_bf16 v[124:127], a[148:151], a[244:247], v[124:127]
    ds_read_b128 a[136:139], v18 offset:2048
    v_cvt_pk_bf16_f32 v50, v100, v101
    v_mfma_f32_16x16x32_bf16 v[124:127], a[152:155], a[248:251], v[124:127]
    v_exp_f32 v102, v102
    v_mfma_f32_16x16x32_bf16 v[124:127], a[156:159], a[252:255], v[124:127]
    buffer_load_dwordx4 v1, s[8:11], s19 offen offset:2048 lds
    v_mfma_f32_16x16x32_bf16 v[40:43], v[28:31], v[56:59], v[40:43]
    v_exp_f32 v103, v103
    v_mfma_f32_16x16x32_bf16 v[44:47], v[28:31], v[60:63], v[44:47]
    ds_read_b128 a[140:143], v18 offset:3072
    v_cvt_pk_bf16_f32 v51, v102, v103
    v_mfma_f32_16x16x32_bf16 v[192:195], a[160:163], v[56:59], v[192:195]
    v_exp_f32 v104, v104
    v_mfma_f32_16x16x32_bf16 v[224:227], a[160:163], v[60:63], v[224:227]
    v_mfma_f32_16x16x32_bf16 v[196:199], a[164:167], v[56:59], v[196:199]
    v_exp_f32 v105, v105
    v_mfma_f32_16x16x32_bf16 v[228:231], a[164:167], v[60:63], v[228:231]
    ds_read_b128 a[144:147], v18 offset:4096
    v_cvt_pk_bf16_f32 v52, v104, v105
    v_mfma_f32_16x16x32_bf16 v[200:203], a[168:171], v[56:59], v[200:203]
    v_exp_f32 v106, v106
    v_mfma_f32_16x16x32_bf16 v[232:235], a[168:171], v[60:63], v[232:235]
    buffer_load_dwordx4 v1, s[8:11], s19 offen offset:3072 lds
    v_mfma_f32_16x16x32_bf16 v[204:207], a[172:175], v[56:59], v[204:207]
    s_add_u32 m0, s16, 4096
    v_exp_f32 v107, v107
    v_mfma_f32_16x16x32_bf16 v[236:239], a[172:175], v[60:63], v[236:239]
    ds_read_b128 a[148:151], v18 offset:5120
    v_cvt_pk_bf16_f32 v53, v106, v107
    v_mfma_f32_16x16x32_bf16 v[208:211], a[176:179], v[56:59], v[208:211]
    s_sub_u32 s14, s14, 1
    v_exp_f32 v108, v108
    v_mfma_f32_16x16x32_bf16 v[240:243], a[176:179], v[60:63], v[240:243]
    buffer_load_dwordx4 v15, s[8:11], s19 offen offset:0 lds
    v_mfma_f32_16x16x32_bf16 v[212:215], a[180:183], v[56:59], v[212:215]
    v_exp_f32 v109, v109
    v_mfma_f32_16x16x32_bf16 v[244:247], a[180:183], v[60:63], v[244:247]
    ds_read_b128 a[152:155], v18 offset:6144
    v_cvt_pk_bf16_f32 v54, v108, v109
    v_mfma_f32_16x16x32_bf16 v[216:219], a[184:187], v[56:59], v[216:219]
    v_exp_f32 v110, v110
    v_mfma_f32_16x16x32_bf16 v[248:251], a[184:187], v[60:63], v[248:251]
    buffer_load_dwordx4 v15, s[8:11], s19 offen offset:1024 lds
    v_mfma_f32_16x16x32_bf16 v[220:223], a[188:191], v[56:59], v[220:223]
    v_exp_f32 v111, v111
    v_mfma_f32_16x16x32_bf16 v[252:255], a[188:191], v[60:63], v[252:255]
    ds_read_b128 a[156:159], v18 offset:7168
    v_cvt_pk_bf16_f32 v55, v110, v111
    s_cmp_lg_u32 s14, 0
    s_cbranch_scc1 L_t2_loop
L_t2_diag:
    s_waitcnt lgkmcnt(7)
    v_mfma_f32_16x16x32_bf16 v[96:99], a[128:131], a[192:195], v[80:83]
    s_waitcnt lgkmcnt(6)
    ds_read_b128 a[160:163], v19 offset:16384
    v_mov_b32 v24, v8
    v_mov_b32 v25, v9
    v_mfma_f32_16x16x32_bf16 v[96:99], a[132:135], a[196:199], v[96:99]
    s_waitcnt lgkmcnt(6)
    ds_read_b128 a[164:167], v19 offset:17408
    v_mov_b32 v26, v10
    v_mov_b32 v27, v11
    v_mfma_f32_16x16x32_bf16 v[96:99], a[136:139], a[200:203], v[96:99]
    s_waitcnt lgkmcnt(6)
    v_exp_f32 v112, v112
    v_add_u32 v11, 131072, v16
    v_mfma_f32_16x16x32_bf16 v[96:99], a[140:143], a[204:207], v[96:99]
    buffer_load_dwordx4 v15, s[8:11], s19 offen offset:2048 lds
    v_lshlrev_b32 v12, 6, v0
    v_mfma_f32_16x16x32_bf16 v[104:107], a[128:131], a[208:211], v[88:91]
    s_mov_b32 s71, 1327104
    v_exp_f32 v113, v113
    v_mfma_f32_16x16x32_bf16 v[104:107], a[132:135], a[212:215], v[104:107]
    ds_read_b128 a[168:171], v19 offset:18432
    v_cvt_pk_bf16_f32 v56, v112, v113
    v_mfma_f32_16x16x32_bf16 v[104:107], a[136:139], a[216:219], v[104:107]
    s_waitcnt lgkmcnt(6)
    v_exp_f32 v114, v114
    v_mfma_f32_16x16x32_bf16 v[104:107], a[140:143], a[220:223], v[104:107]
    buffer_load_dwordx4 v15, s[8:11], s19 offen offset:3072 lds
    v_mfma_f32_16x16x32_bf16 v[100:103], a[144:147], a[192:195], v[84:87]
    s_waitcnt lgkmcnt(5)
    s_xor_b32 s16, s16, 98304
    v_exp_f32 v115, v115
    v_mfma_f32_16x16x32_bf16 v[100:103], a[148:151], a[196:199], v[100:103]
    s_waitcnt lgkmcnt(4)
    ds_read_b128 a[172:175], v19 offset:19456
    v_cvt_pk_bf16_f32 v57, v114, v115
    v_mfma_f32_16x16x32_bf16 v[100:103], a[152:155], a[200:203], v[100:103]
    s_waitcnt lgkmcnt(4)
    v_exp_f32 v116, v116
    v_mfma_f32_16x16x32_bf16 v[100:103], a[156:159], a[204:207], v[100:103]
    buffer_load_dword v3, v12, s[8:11], s71 offen sc0 sc1
    v_bfe_u32 v13, v2, 1, 4
    v_mfma_f32_16x16x32_bf16 v[108:111], a[144:147], a[208:211], v[92:95]
    v_exp_f32 v117, v117
    v_lshlrev_b32 v13, 10, v13
    v_mfma_f32_16x16x32_bf16 v[108:111], a[148:151], a[212:215], v[108:111]
    ds_read_b128 a[176:179], v20 offset:20480
    v_cvt_pk_bf16_f32 v58, v116, v117
    v_and_b32 v14, 1, v2
    v_mfma_f32_16x16x32_bf16 v[108:111], a[152:155], a[216:219], v[108:111]
    v_exp_f32 v118, v118
    v_lshl_add_u32 v13, v14, 7, v13
    v_mfma_f32_16x16x32_bf16 v[108:111], a[156:159], a[220:223], v[108:111]
    s_lshl_b32 s74, s6, 2
    s_add_u32 s74, s74, s3
    s_lshl_b32 s74, s74, 14
    v_mfma_f32_16x16x32_bf16 v[32:35], v[28:31], v[48:51], v[32:35]
    v_exp_f32 v119, v119
    v_mfma_f32_16x16x32_bf16 v[36:39], v[28:31], v[52:55], v[36:39]
    s_waitcnt lgkmcnt(4)
    ds_read_b128 a[180:183], v20 offset:21504
    v_cvt_pk_bf16_f32 v59, v118, v119
    v_mfma_f32_16x16x32_bf16 v[128:131], a[160:163], v[48:51], v[128:131]
    s_waitcnt lgkmcnt(4)
    v_exp_f32 v120, v120
    v_mfma_f32_16x16x32_bf16 v[160:163], a[160:163], v[52:55], v[160:163]
    buffer_load_dword v14, v13, s[28:31], s74 offen
    v_mfma_f32_16x16x32_bf16 v[132:135], a[164:167], v[48:51], v[132:135]
    v_exp_f32 v121, v121
    v_mfma_f32_16x16x32_bf16 v[164:167], a[164:167], v[52:55], v[164:167]
    s_waitcnt lgkmcnt(3)
    ds_read_b128 a[184:187], v20 offset:22528
    v_cvt_pk_bf16_f32 v60, v120, v121
    v_mfma_f32_16x16x32_bf16 v[136:139], a[168:171], v[48:51], v[136:139]
    v_exp_f32 v122, v122
    v_mfma_f32_16x16x32_bf16 v[168:171], a[168:171], v[52:55], v[168:171]
    s_waitcnt lgkmcnt(3)
    v_add_f32 v80, 0, v22
    v_min_f32 v80, v80, v72
    v_mfma_f32_16x16x32_bf16 v[140:143], a[172:175], v[48:51], v[140:143]
    v_exp_f32 v123, v123
    v_mfma_f32_16x16x32_bf16 v[172:175], a[172:175], v[52:55], v[172:175]
    s_waitcnt lgkmcnt(2)
    ds_read_b128 a[188:191], v20 offset:23552
    v_cvt_pk_bf16_f32 v61, v122, v123
    v_mfma_f32_16x16x32_bf16 v[144:147], a[176:179], v[48:51], v[144:147]
    v_exp_f32 v124, v124
    v_mfma_f32_16x16x32_bf16 v[176:179], a[176:179], v[52:55], v[176:179]
    s_waitcnt lgkmcnt(2)
    v_add_f32 v81, 0xf1800000, v22
    v_min_f32 v81, v81, v73
    v_mfma_f32_16x16x32_bf16 v[148:151], a[180:183], v[48:51], v[148:151]
    v_exp_f32 v125, v125
    v_mfma_f32_16x16x32_bf16 v[180:183], a[180:183], v[52:55], v[180:183]
    s_waitcnt lgkmcnt(1)
    v_cvt_pk_bf16_f32 v62, v124, v125
    v_xor_b32 v19, 98304, v19
    v_mfma_f32_16x16x32_bf16 v[152:155], a[184:187], v[48:51], v[152:155]
    v_exp_f32 v126, v126
    v_mfma_f32_16x16x32_bf16 v[184:187], a[184:187], v[52:55], v[184:187]
    s_waitcnt lgkmcnt(0)
    v_xor_b32 v20, 98304, v20
    v_add_f32 v82, 0xf2000000, v22
    v_mfma_f32_16x16x32_bf16 v[156:159], a[188:191], v[48:51], v[156:159]
    v_exp_f32 v127, v127
    v_mfma_f32_16x16x32_bf16 v[188:191], a[188:191], v[52:55], v[188:191]
    v_cvt_pk_bf16_f32 v63, v126, v127
    v_min_f32 v82, v82, v74
    v_add_f32 v83, 0xf2400000, v22
    v_min_f32 v83, v83, v75
    v_add_f32 v84, 0xf3800000, v22
    v_min_f32 v84, v84, v72
    v_mfma_f32_16x16x32_bf16 v[112:115], a[128:131], a[224:227], v[72:75]
    v_exp_f32 v96, v96
    v_mfma_f32_16x16x32_bf16 v[112:115], a[132:135], a[228:231], v[112:115]
    v_mfma_f32_16x16x32_bf16 v[112:115], a[136:139], a[232:235], v[112:115]
    v_exp_f32 v97, v97
    v_mfma_f32_16x16x32_bf16 v[112:115], a[140:143], a[236:239], v[112:115]
    v_cvt_pk_bf16_f32 v48, v96, v97
    v_add_f32 v85, 0xf3880000, v22
    v_mfma_f32_16x16x32_bf16 v[120:123], a[128:131], a[240:243], v[76:79]
    v_exp_f32 v98, v98
    v_mfma_f32_16x16x32_bf16 v[120:123], a[132:135], a[244:247], v[120:123]
    v_min_f32 v85, v85, v73
    v_add_f32 v86, 0xf3900000, v22
    v_mfma_f32_16x16x32_bf16 v[120:123], a[136:139], a[248:251], v[120:123]
    v_exp_f32 v99, v99
    v_mfma_f32_16x16x32_bf16 v[120:123], a[140:143], a[252:255], v[120:123]
    v_min_f32 v86, v86, v74
    v_add_f32 v87, 0xf3980000, v22
    v_mfma_f32_16x16x32_bf16 v[116:119], a[144:147], a[224:227], v[72:75]
    v_exp_f32 v100, v100
    v_mfma_f32_16x16x32_bf16 v[116:119], a[148:151], a[228:231], v[116:119]
    ds_read_b128 a[128:131], v18 offset:16384
    v_cvt_pk_bf16_f32 v49, v98, v99
    v_mfma_f32_16x16x32_bf16 v[116:119], a[152:155], a[232:235], v[116:119]
    v_exp_f32 v101, v101
    v_mfma_f32_16x16x32_bf16 v[116:119], a[156:159], a[236:239], v[116:119]
    ds_read_b128 a[132:135], v18 offset:17408
    v_cvt_pk_bf16_f32 v50, v100, v101
    v_mfma_f32_16x16x32_bf16 v[124:127], a[144:147], a[240:243], v[76:79]
    v_exp_f32 v102, v102
    v_mfma_f32_16x16x32_bf16 v[124:127], a[148:151], a[244:247], v[124:127]
    ds_read_b128 a[136:139], v18 offset:18432
    v_min_f32 v87, v87, v75
    v_mfma_f32_16x16x32_bf16 v[124:127], a[152:155], a[248:251], v[124:127]
    v_exp_f32 v103, v103
    v_mfma_f32_16x16x32_bf16 v[124:127], a[156:159], a[252:255], v[124:127]
    ds_read_b128 a[140:143], v18 offset:19456
    v_cvt_pk_bf16_f32 v51, v102, v103
    v_mfma_f32_16x16x32_bf16 v[40:43], v[28:31], v[56:59], v[40:43]
    v_exp_f32 v104, v104
    v_mfma_f32_16x16x32_bf16 v[44:47], v[28:31], v[60:63], v[44:47]
    ds_read_b128 a[144:147], v18 offset:20480
    v_add_f32 v88, 0x73800000, v22
    v_mfma_f32_16x16x32_bf16 v[192:195], a[160:163], v[56:59], v[192:195]
    v_exp_f32 v105, v105
    v_mfma_f32_16x16x32_bf16 v[224:227], a[160:163], v[60:63], v[224:227]
    ds_read_b128 a[148:151], v18 offset:21504
    v_cvt_pk_bf16_f32 v52, v104, v105
    v_mfma_f32_16x16x32_bf16 v[196:199], a[164:167], v[56:59], v[196:199]
    v_exp_f32 v106, v106
    v_mfma_f32_16x16x32_bf16 v[228:231], a[164:167], v[60:63], v[228:231]
    ds_read_b128 a[152:155], v18 offset:22528
    v_min_f32 v88, v88, v76
    v_mfma_f32_16x16x32_bf16 v[200:203], a[168:171], v[56:59], v[200:203]
    v_exp_f32 v107, v107
    v_mfma_f32_16x16x32_bf16 v[232:235], a[168:171], v[60:63], v[232:235]
    ds_read_b128 a[156:159], v18 offset:23552
    v_cvt_pk_bf16_f32 v53, v106, v107
    v_mfma_f32_16x16x32_bf16 v[204:207], a[172:175], v[56:59], v[204:207]
    v_exp_f32 v108, v108
    v_mfma_f32_16x16x32_bf16 v[236:239], a[172:175], v[60:63], v[236:239]
    v_add_f32 v89, 0x73700000, v22
    v_min_f32 v89, v89, v77
    v_mfma_f32_16x16x32_bf16 v[208:211], a[176:179], v[56:59], v[208:211]
    v_exp_f32 v109, v109
    v_mfma_f32_16x16x32_bf16 v[240:243], a[176:179], v[60:63], v[240:243]
    v_cvt_pk_bf16_f32 v54, v108, v109
    v_xor_b32 v18, 196608, v18
    v_mfma_f32_16x16x32_bf16 v[212:215], a[180:183], v[56:59], v[212:215]
    v_exp_f32 v110, v110
    v_mfma_f32_16x16x32_bf16 v[244:247], a[180:183], v[60:63], v[244:247]
    v_add_f32 v90, 0x73600000, v22
    v_min_f32 v90, v90, v78
    v_mfma_f32_16x16x32_bf16 v[216:219], a[184:187], v[56:59], v[216:219]
    v_exp_f32 v111, v111
    v_mfma_f32_16x16x32_bf16 v[248:251], a[184:187], v[60:63], v[248:251]
    v_cvt_pk_bf16_f32 v55, v110, v111
    v_add_f32 v91, 0x73500000, v22
    s_waitcnt vmcnt(1)
    v_cmp_ne_u32 vcc, 0, v3
    s_cmp_eq_u64 vcc, -1
    s_cbranch_scc0 L_F_slow_11
L_F_ok_12:
    v_mfma_f32_16x16x32_bf16 v[220:223], a[188:191], v[56:59], v[220:223]
    v_min_f32 v91, v91, v79
    v_add_f32 v92, 0, v22
    v_mfma_f32_16x16x32_bf16 v[252:255], a[188:191], v[60:63], v[252:255]
    v_min_f32 v92, v92, v76
    v_add_f32 v93, 0xf1800000, v22
    v_min_f32 v93, v93, v77
    v_add_f32 v94, 0xf2000000, v22
    v_min_f32 v94, v94, v78
    v_add_f32 v95, 0xf2400000, v22
    v_min_f32 v95, v95, v79
    s_waitcnt lgkmcnt(0)
    s_barrier
    v_mfma_f32_16x16x32_bf16 v[96:99], a[128:131], a[224:227], v[80:83]
    s_xor_b32 s100, s62, 8192
    s_add_u32 s98, s65, 128
    ds_read_b128 a[176:179], v20 offset:4096
    v_lshrrev_b32 v13, 1, v1
    v_mfma_f32_16x16x32_bf16 v[96:99], a[132:135], a[228:231], v[96:99]
    s_add_u32 m0, s62, 65536
    ds_read_b128 a[180:183], v20 offset:5120
    v_add_u32 v12, s100, v13
    v_mfma_f32_16x16x32_bf16 v[96:99], a[136:139], a[232:235], v[96:99]
    buffer_load_dwordx4 v24, s[28:31], s98 offen offset:0  lds
    v_exp_f32 v112, v112
    v_mfma_f32_16x16x32_bf16 v[96:99], a[140:143], a[236:239], v[96:99]
    v_exp_f32 v113, v113
    v_mfma_f32_16x16x32_bf16 v[100:103], a[144:147], a[224:227], v[84:87]
    ds_read_b128 a[184:187], v20 offset:6144
    v_cvt_pk_bf16_f32 v56, v112, v113
    v_mfma_f32_16x16x32_bf16 v[100:103], a[148:151], a[228:231], v[100:103]
    v_exp_f32 v114, v114
    v_mfma_f32_16x16x32_bf16 v[100:103], a[152:155], a[232:235], v[100:103]
    buffer_load_dwordx4 v25, s[28:31], s98 offen offset:1024  lds
    v_exp_f32 v115, v115
    v_mfma_f32_16x16x32_bf16 v[100:103], a[156:159], a[236:239], v[100:103]
    ds_read_b128 a[188:191], v20 offset:7168
    v_cvt_pk_bf16_f32 v57, v114, v115
    v_mfma_f32_16x16x32_bf16 v[104:107], a[128:131], a[240:243], v[88:91]
    v_exp_f32 v116, v116
    v_mfma_f32_16x16x32_bf16 v[104:107], a[132:135], a[244:247], v[104:107]
    v_exp_f32 v117, v117
    v_mfma_f32_16x16x32_bf16 v[104:107], a[136:139], a[248:251], v[104:107]
    ds_read_b128 a[160:163], v19 offset:0
    v_cvt_pk_bf16_f32 v58, v116, v117
    v_mfma_f32_16x16x32_bf16 v[104:107], a[140:143], a[252:255], v[104:107]
    buffer_load_dwordx4 v26, s[28:31], s98 offen offset:2048  lds
    v_exp_f32 v118, v118
    v_mfma_f32_16x16x32_bf16 v[108:111], a[144:147], a[240:243], v[92:95]
    v_exp_f32 v119, v119
    v_mfma_f32_16x16x32_bf16 v[108:111], a[148:151], a[244:247], v[108:111]
    ds_read_b128 a[164:167], v19 offset:1024
    v_cvt_pk_bf16_f32 v59, v118, v119
    v_mfma_f32_16x16x32_bf16 v[108:111], a[152:155], a[248:251], v[108:111]
    v_exp_f32 v120, v120
    v_mfma_f32_16x16x32_bf16 v[108:111], a[156:159], a[252:255], v[108:111]
    buffer_load_dwordx4 v27, s[28:31], s98 offen offset:3072  lds
    v_exp_f32 v121, v121
    v_mfma_f32_16x16x32_bf16 v[32:35], v[28:31], v[48:51], v[32:35]
    s_add_u32 m0, s62, 69632
    ds_read_b128 a[168:171], v19 offset:2048
    v_cvt_pk_bf16_f32 v60, v120, v121
    v_mfma_f32_16x16x32_bf16 v[36:39], v[28:31], v[52:55], v[36:39]
    s_waitcnt lgkmcnt(6)
    s_add_u32 s98, s65, 32896
    v_exp_f32 v122, v122
    v_mfma_f32_16x16x32_bf16 v[144:147], a[176:179], v[48:51], v[144:147]
    v_exp_f32 v123, v123
    v_mfma_f32_16x16x32_bf16 v[176:179], a[176:179], v[52:55], v[176:179]
    s_waitcnt lgkmcnt(5)
    ds_read_b128 a[172:175], v19 offset:3072
    v_cvt_pk_bf16_f32 v61, v122, v123
    v_mfma_f32_16x16x32_bf16 v[148:151], a[180:183], v[48:51], v[148:151]
    buffer_load_dwordx4 v24, s[28:31], s98 offen offset:0  lds
    v_exp_f32 v124, v124
    v_mfma_f32_16x16x32_bf16 v[180:183], a[180:183], v[52:55], v[180:183]
    s_waitcnt lgkmcnt(5)
    v_exp_f32 v125, v125
    v_mfma_f32_16x16x32_bf16 v[152:155], a[184:187], v[48:51], v[152:155]
    s_waitcnt lgkmcnt(4)
    v_exp_f32 v126, v126
    v_mfma_f32_16x16x32_bf16 v[184:187], a[184:187], v[52:55], v[184:187]
    buffer_load_dwordx4 v25, s[28:31], s98 offen offset:1024  lds
    v_exp_f32 v127, v127
    v_mfma_f32_16x16x32_bf16 v[156:159], a[188:191], v[48:51], v[156:159]
    ds_write_b128 v11, v[144:147] offset:0
    v_cvt_pk_bf16_f32 v62, v124, v125
    v_mfma_f32_16x16x32_bf16 v[188:191], a[188:191], v[52:55], v[188:191]
    s_waitcnt lgkmcnt(4)
    v_exp_f32 v96, v96
    v_mfma_f32_16x16x32_bf16 v[128:131], a[160:163], v[48:51], v[128:131]
    v_exp_f32 v97, v97
    v_mfma_f32_16x16x32_bf16 v[160:163], a[160:163], v[52:55], v[160:163]
    s_waitcnt lgkmcnt(3)
    ds_write_b128 v11, v[176:179] offset:1024
    v_cvt_pk_bf16_f32 v63, v126, v127
    v_mfma_f32_16x16x32_bf16 v[132:135], a[164:167], v[48:51], v[132:135]
    s_waitcnt lgkmcnt(3)
    v_exp_f32 v98, v98
    v_mfma_f32_16x16x32_bf16 v[164:167], a[164:167], v[52:55], v[164:167]
    buffer_load_dwordx4 v26, s[28:31], s98 offen offset:2048  lds
    v_exp_f32 v99, v99
    v_mfma_f32_16x16x32_bf16 v[136:139], a[168:171], v[48:51], v[136:139]
    ds_write_b128 v11, v[148:151] offset:2048
    v_mfma_f32_16x16x32_bf16 v[168:171], a[168:171], v[52:55], v[168:171]
    s_waitcnt lgkmcnt(3)
    v_exp_f32 v100, v100
    v_mfma_f32_16x16x32_bf16 v[140:143], a[172:175], v[48:51], v[140:143]
    v_exp_f32 v101, v101
    v_mfma_f32_16x16x32_bf16 v[172:175], a[172:175], v[52:55], v[172:175]
    ds_write_b128 v11, v[180:183] offset:3072
    v_mov_b32 v33, v36
    v_mfma_f32_16x16x32_bf16 v[40:43], v[28:31], v[56:59], v[40:43]
    buffer_load_dwordx4 v27, s[28:31], s98 offen offset:3072  lds
    v_exp_f32 v102, v102
    v_mfma_f32_16x16x32_bf16 v[44:47], v[28:31], v[60:63], v[44:47]
    v_exp_f32 v103, v103
    v_mfma_f32_16x16x32_bf16 v[208:211], a[176:179], v[56:59], v[208:211]
    ds_write_b128 v11, v[152:155] offset:4096
    v_cvt_pk_bf16_f32 v48, v96, v97
    v_mfma_f32_16x16x32_bf16 v[240:243], a[176:179], v[60:63], v[240:243]
    ds_read_b128 a[176:179], v20 offset:20480
    v_exp_f32 v104, v104
    v_mfma_f32_16x16x32_bf16 v[212:215], a[180:183], v[56:59], v[212:215]
    v_exp_f32 v105, v105
    v_mfma_f32_16x16x32_bf16 v[244:247], a[180:183], v[60:63], v[244:247]
    ds_read_b128 a[180:183], v20 offset:21504
    v_exp_f32 v106, v106
    v_mfma_f32_16x16x32_bf16 v[216:219], a[184:187], v[56:59], v[216:219]
    ds_write_b128 v11, v[184:187] offset:5120
    v_cvt_pk_bf16_f32 v49, v98, v99
    v_mfma_f32_16x16x32_bf16 v[248:251], a[184:187], v[60:63], v[248:251]
    ds_read_b128 a[184:187], v20 offset:22528
    v_exp_f32 v107, v107
    v_mfma_f32_16x16x32_bf16 v[220:223], a[188:191], v[56:59], v[220:223]
    v_exp_f32 v108, v108
    v_mfma_f32_16x16x32_bf16 v[252:255], a[188:191], v[60:63], v[252:255]
    ds_read_b128 a[188:191], v20 offset:23552
    v_exp_f32 v109, v109
    v_mfma_f32_16x16x32_bf16 v[192:195], a[160:163], v[56:59], v[192:195]
    ds_write_b128 v11, v[156:159] offset:6144
    v_cvt_pk_bf16_f32 v50, v100, v101
    v_mfma_f32_16x16x32_bf16 v[224:227], a[160:163], v[60:63], v[224:227]
    ds_read_b128 a[160:163], v19 offset:16384
    v_exp_f32 v110, v110
    v_mfma_f32_16x16x32_bf16 v[196:199], a[164:167], v[56:59], v[196:199]
    v_exp_f32 v111, v111
    v_mfma_f32_16x16x32_bf16 v[228:231], a[164:167], v[60:63], v[228:231]
    ds_read_b128 a[164:167], v19 offset:17408
    v_cvt_pk_bf16_f32 v51, v102, v103
    v_mfma_f32_16x16x32_bf16 v[200:203], a[168:171], v[56:59], v[200:203]
    ds_write_b128 v11, v[188:191] offset:7168
    v_cvt_pk_bf16_f32 v52, v104, v105
    v_mfma_f32_16x16x32_bf16 v[232:235], a[168:171], v[60:63], v[232:235]
    ds_read_b128 a[168:171], v19 offset:18432
    v_cvt_pk_bf16_f32 v53, v106, v107
    v_mfma_f32_16x16x32_bf16 v[204:207], a[172:175], v[56:59], v[204:207]
    v_cvt_pk_bf16_f32 v54, v108, v109
    v_cvt_pk_bf16_f32 v55, v110, v111
    v_mfma_f32_16x16x32_bf16 v[236:239], a[172:175], v[60:63], v[236:239]
    ds_read_b128 a[172:175], v19 offset:19456
    ds_write_b64 v12, v[32:33]
    s_add_u32 s101, s62, 98304
    v_xor_b32 v12, 8192, v12
    v_add_u32 v9, s101, v1
    v_xor_b32 v8, 8192, v11
    v_xor_b32 v10, 8192, v9
L_t2_join:
    v_xor_b32 v19, 98304, v19
    v_xor_b32 v20, 98304, v20
    s_waitcnt lgkmcnt(0)
    s_barrier
    v_mfma_f32_16x16x32_bf16 v[40:43], v[28:31], v[48:51], v[40:43]
    s_lshl_b32 s100, s61, 20
    s_add_u32 s101, s100, s21
    ds_read_b64 v[120:121], v12
    v_mfma_f32_16x16x32_bf16 v[44:47], v[28:31], v[52:55], v[44:47]
    s_add_u32 s100, s100, s20
    ds_read_b128 v[144:147], v8 offset:0
    v_lshrrev_b32 v11, 4, v2
    v_mfma_f32_16x16x32_bf16 v[208:211], a[176:179], v[48:51], v[208:211]
    ds_read_b128 v[176:179], v8 offset:1024
    v_lshrrev_b32 v13, 2, v1
    v_mfma_f32_16x16x32_bf16 v[240:243], a[176:179], v[52:55], v[240:243]
    ds_read_b128 v[148:151], v8 offset:2048
    v_add_u32 v13, 131072, v13
    v_mfma_f32_16x16x32_bf16 v[212:215], a[180:183], v[48:51], v[212:215]
    s_xor_b32 s99, s62, 8192
    ds_read_b128 v[180:183], v8 offset:3072
    s_waitcnt vmcnt(8)
    v_add_u32 v14, s99, v13
    v_mfma_f32_16x16x32_bf16 v[244:247], a[180:183], v[52:55], v[244:247]
    ds_read_b128 v[152:155], v8 offset:4096
    v_cmp_eq_u32 vcc, 1, v11
    v_mfma_f32_16x16x32_bf16 v[216:219], a[184:187], v[48:51], v[216:219]
    ds_read_b128 v[184:187], v8 offset:5120
    s_waitcnt lgkmcnt(6)
    v_add_f32 v112, v120, v32
    v_mfma_f32_16x16x32_bf16 v[248:251], a[184:187], v[52:55], v[248:251]
    ds_read_b128 v[156:159], v8 offset:6144
    v_add_f32 v114, v121, v36
    v_mfma_f32_16x16x32_bf16 v[220:223], a[188:191], v[48:51], v[220:223]
    ds_read_b128 v[188:191], v8 offset:7168
    v_cndmask_b32 v12, v32, v36, vcc
    v_mfma_f32_16x16x32_bf16 v[252:255], a[188:191], v[52:55], v[252:255]
    v_rcp_f32 v112, v112
    v_mfma_f32_16x16x32_bf16 v[192:195], a[160:163], v[48:51], v[192:195]
    v_rcp_f32 v114, v114
    v_mfma_f32_16x16x32_bf16 v[224:227], a[160:163], v[52:55], v[224:227]
    v_cmp_eq_u32 vcc, 2, v11
    v_cmp_eq_u32 s[96:97], 3, v11
    v_mfma_f32_16x16x32_bf16 v[196:199], a[164:167], v[48:51], v[196:199]
    ds_write_b128 v9, v[208:211] offset:0
    v_mfma_f32_16x16x32_bf16 v[228:231], a[164:167], v[52:55], v[228:231]
    v_mfma_f32_16x16x32_bf16 v[200:203], a[168:171], v[48:51], v[200:203]
    ds_write_b128 v9, v[240:243] offset:1024
    v_mfma_f32_16x16x32_bf16 v[232:235], a[168:171], v[52:55], v[232:235]
    v_mfma_f32_16x16x32_bf16 v[204:207], a[172:175], v[48:51], v[204:207]
    ds_write_b128 v9, v[212:215] offset:2048
    v_mfma_f32_16x16x32_bf16 v[236:239], a[172:175], v[52:55], v[236:239]
    v_cndmask_b32 v12, v12, v40, vcc
    v_cndmask_b32 v12, v12, v44, s[96:97]
    ds_write_b128 v9, v[244:247] offset:3072
    s_waitcnt lgkmcnt(11)
    v_pk_add_f32 v[128:129], v[128:129], v[144:145]
    v_pk_add_f32 v[130:131], v[130:131], v[146:147]
    s_waitcnt lgkmcnt(9)
    v_pk_add_f32 v[132:133], v[132:133], v[148:149]
    v_pk_add_f32 v[134:135], v[134:135], v[150:151]
    v_pk_mul_f32 v[128:129], v[128:129], v[112:113] op_sel_hi:[1,0]
    v_pk_mul_f32 v[130:131], v[130:131], v[112:113] op_sel_hi:[1,0]
    v_pk_mul_f32 v[132:133], v[132:133], v[112:113] op_sel_hi:[1,0]
    v_pk_mul_f32 v[134:135], v[134:135], v[112:113] op_sel_hi:[1,0]
    v_cvt_pk_bf16_f32 v128, v128, v129
    v_cvt_pk_bf16_f32 v129, v130, v131
    v_cvt_pk_bf16_f32 v130, v132, v133
    v_lshrrev_b32 v58, 2, v2
    v_and_b32 v57, 3, v2
    ds_write_b128 v9, v[216:219] offset:4096
    v_cvt_pk_bf16_f32 v131, v134, v135
    buffer_store_dwordx4 v[128:131], v1, s[8:11], s100 offen offset:0 sc0 sc1
    s_waitcnt lgkmcnt(8)
    v_pk_add_f32 v[136:137], v[136:137], v[152:153]
    v_pk_add_f32 v[138:139], v[138:139], v[154:155]
    s_waitcnt lgkmcnt(6)
    v_pk_add_f32 v[140:141], v[140:141], v[156:157]
    v_pk_add_f32 v[142:143], v[142:143], v[158:159]
    v_pk_mul_f32 v[136:137], v[136:137], v[112:113] op_sel_hi:[1,0]
    v_pk_mul_f32 v[138:139], v[138:139], v[112:113] op_sel_hi:[1,0]
    v_pk_mul_f32 v[140:141], v[140:141], v[112:113] op_sel_hi:[1,0]
    v_pk_mul_f32 v[142:143], v[142:143], v[112:113] op_sel_hi:[1,0]
    v_cvt_pk_bf16_f32 v136, v136, v137
    v_lshlrev_b32 v56, 7, v58
    v_lshl_add_u32 v56, v57, 3, v56
    v_bfe_u32 v57, v2, 3, 2
    ds_write_b128 v9, v[248:251] offset:5120
    v_cvt_pk_bf16_f32 v137, v138, v139
    v_cvt_pk_bf16_f32 v138, v140, v141
    v_cvt_pk_bf16_f32 v139, v142, v143
    buffer_store_dwordx4 v[136:139], v1, s[8:11], s100 offen offset:1024 sc0 sc1
    v_pk_add_f32 v[160:161], v[160:161], v[176:177]
    v_pk_add_f32 v[162:163], v[162:163], v[178:179]
    v_pk_add_f32 v[164:165], v[164:165], v[180:181]
    v_pk_add_f32 v[166:167], v[166:167], v[182:183]
    v_pk_mul_f32 v[160:161], v[160:161], v[114:115] op_sel_hi:[1,0]
    v_pk_mul_f32 v[162:163], v[162:163], v[114:115] op_sel_hi:[1,0]
    v_pk_mul_f32 v[164:165], v[164:165], v[114:115] op_sel_hi:[1,0]
    v_lshl_add_u32 v56, v57, 5, v56
    v_xor_b32 v57, 32, v56
    ds_write_b128 v9, v[220:223] offset:6144
    v_pk_mul_f32 v[166:167], v[166:167], v[114:115] op_sel_hi:[1,0]
    v_cvt_pk_bf16_f32 v160, v160, v161
    v_cvt_pk_bf16_f32 v161, v162, v163
    v_cvt_pk_bf16_f32 v162, v164, v165
    v_cvt_pk_bf16_f32 v163, v166, v167
    buffer_store_dwordx4 v[160:163], v15, s[8:11], s100 offen offset:0 sc0 sc1
    v_pk_add_f32 v[168:169], v[168:169], v[184:185]
    v_pk_add_f32 v[170:171], v[170:171], v[186:187]
    s_waitcnt lgkmcnt(7)
    v_pk_add_f32 v[172:173], v[172:173], v[188:189]
    v_pk_add_f32 v[174:175], v[174:175], v[190:191]
    v_pk_mul_f32 v[168:169], v[168:169], v[114:115] op_sel_hi:[1,0]
    v_xor_b32 v58, 64, v56
    v_xor_b32 v59, 96, v56
    v_add_u32 v60, 65536, v56
    ds_write_b128 v9, v[252:255] offset:7168
    v_pk_mul_f32 v[170:171], v[170:171], v[114:115] op_sel_hi:[1,0]
    v_pk_mul_f32 v[172:173], v[172:173], v[114:115] op_sel_hi:[1,0]
    v_pk_mul_f32 v[174:175], v[174:175], v[114:115] op_sel_hi:[1,0]
    v_cvt_pk_bf16_f32 v168, v168, v169
    v_cvt_pk_bf16_f32 v169, v170, v171
    v_cvt_pk_bf16_f32 v170, v172, v173
    v_cvt_pk_bf16_f32 v171, v174, v175
    buffer_store_dwordx4 v[168:171], v15, s[8:11], s100 offen offset:1024 sc0 sc1
    v_add_u32 v61, 65536, v57
    v_add_u32 v62, 65536, v58
    v_add_u32 v63, 65536, v59
    ds_write_b32 v14, v12
    v_and_b32 v14, 4294967103, v13
    v_add_u32 v14, s62, v14
    s_waitcnt lgkmcnt(0)
    s_barrier
    ds_read_b32 v116, v14 offset:128
    ds_read_b32 v118, v14 offset:192
    ds_read_b128 v[208:211], v10 offset:0
    ds_read_b128 v[212:215], v10 offset:2048
    ds_read_b128 v[216:219], v10 offset:4096
    ds_read_b128 v[220:223], v10 offset:6144
    ds_read_b128 v[240:243], v10 offset:1024
    ds_read_b128 v[244:247], v10 offset:3072
    ds_read_b128 v[248:251], v10 offset:5120
    ds_read_b128 v[252:255], v10 offset:7168
    ds_read_b32 v120, v13 offset:0
    ds_read_b32 v121, v13 offset:8192
    ds_read_b32 v122, v13 offset:16384
    ds_read_b32 v123, v13 offset:24576
    s_waitcnt lgkmcnt(13)
    v_add_f32 v116, v116, v40
    s_waitcnt lgkmcnt(12)
    v_add_f32 v118, v118, v44
    v_rcp_f32 v116, v116
    v_rcp_f32 v118, v118
    s_waitcnt lgkmcnt(11)
    v_pk_add_f32 v[192:193], v[192:193], v[208:209]
    v_pk_add_f32 v[194:195], v[194:195], v[210:211]
    s_waitcnt lgkmcnt(10)
    v_pk_add_f32 v[196:197], v[196:197], v[212:213]
    v_pk_add_f32 v[198:199], v[198:199], v[214:215]
    v_pk_mul_f32 v[192:193], v[192:193], v[116:117] op_sel_hi:[1,0]
    v_pk_mul_f32 v[194:195], v[194:195], v[116:117] op_sel_hi:[1,0]
    v_pk_mul_f32 v[196:197], v[196:197], v[116:117] op_sel_hi:[1,0]
    v_pk_mul_f32 v[198:199], v[198:199], v[116:117] op_sel_hi:[1,0]
    v_cvt_pk_bf16_f32 v192, v192, v193
    v_cvt_pk_bf16_f32 v193, v194, v195
    v_cvt_pk_bf16_f32 v194, v196, v197
    v_cvt_pk_bf16_f32 v195, v198, v199
    buffer_store_dwordx4 v[192:195], v1, s[8:11], s101 offen offset:0 sc0 sc1
    s_waitcnt lgkmcnt(9)
    v_pk_add_f32 v[200:201], v[200:201], v[216:217]
    v_pk_add_f32 v[202:203], v[202:203], v[218:219]
    s_waitcnt lgkmcnt(8)
    v_pk_add_f32 v[204:205], v[204:205], v[220:221]
    v_pk_add_f32 v[206:207], v[206:207], v[222:223]
    v_pk_mul_f32 v[200:201], v[200:201], v[116:117] op_sel_hi:[1,0]
    v_pk_mul_f32 v[202:203], v[202:203], v[116:117] op_sel_hi:[1,0]
    v_pk_mul_f32 v[204:205], v[204:205], v[116:117] op_sel_hi:[1,0]
    v_pk_mul_f32 v[206:207], v[206:207], v[116:117] op_sel_hi:[1,0]
    v_cvt_pk_bf16_f32 v200, v200, v201
    v_cvt_pk_bf16_f32 v201, v202, v203
    v_cvt_pk_bf16_f32 v202, v204, v205
    v_cvt_pk_bf16_f32 v203, v206, v207
    buffer_store_dwordx4 v[200:203], v1, s[8:11], s101 offen offset:1024 sc0 sc1
    s_waitcnt lgkmcnt(2)
    v_add_f32 v120, v120, v121
    s_waitcnt lgkmcnt(0)
    v_add_f32 v122, v122, v123
    v_min_f32 v124, v120, v122
    v_add_f32 v120, v120, v122
    v_cmp_le_f32 vcc, 0x1f800000, v124
    s_mov_b64 s[96:97], vcc
    v_cmp_ge_f32 vcc, 0x67800000, v120
    s_and_b64 s[96:97], s[96:97], vcc
    s_cmp_eq_u64 s[96:97], -1
    s_cselect_b32 s96, s25, 1
    s_cmp_lg_u32 s96, 0
    s_cbranch_scc1 L_t2_redo
L_t2_safe:
    v_pk_add_f32 v[224:225], v[224:225], v[240:241]
    v_pk_add_f32 v[226:227], v[226:227], v[242:243]
    v_pk_add_f32 v[228:229], v[228:229], v[244:245]
    v_pk_add_f32 v[230:231], v[230:231], v[246:247]
    v_pk_mul_f32 v[224:225], v[224:225], v[118:119] op_sel_hi:[1,0]
    v_pk_mul_f32 v[226:227], v[226:227], v[118:119] op_sel_hi:[1,0]
    v_pk_mul_f32 v[228:229], v[228:229], v[118:119] op_sel_hi:[1,0]
    v_pk_mul_f32 v[230:231], v[230:231], v[118:119] op_sel_hi:[1,0]
    v_cvt_pk_bf16_f32 v224, v224, v225
    v_cvt_pk_bf16_f32 v225, v226, v227
    v_cvt_pk_bf16_f32 v226, v228, v229
    v_cvt_pk_bf16_f32 v227, v230, v231
    buffer_store_dwordx4 v[224:227], v15, s[8:11], s101 offen offset:0 sc0 sc1
    ds_read_b64_tr_b16 a[192:193], v56 offset:32768
    ds_read_b64_tr_b16 a[194:195], v56 offset:34816
    ds_read_b64_tr_b16 a[196:197], v56 offset:36864
    ds_read_b64_tr_b16 a[198:199], v56 offset:38912
    ds_read_b64_tr_b16 a[200:201], v57 offset:32768
    ds_read_b64_tr_b16 a[202:203], v57 offset:34816
    ds_read_b64_tr_b16 a[204:205], v57 offset:36864
    ds_read_b64_tr_b16 a[206:207], v57 offset:38912
    v_pk_add_f32 v[232:233], v[232:233], v[248:249]
    v_pk_add_f32 v[234:235], v[234:235], v[250:251]
    v_pk_add_f32 v[236:237], v[236:237], v[252:253]
    v_pk_add_f32 v[238:239], v[238:239], v[254:255]
    v_pk_mul_f32 v[232:233], v[232:233], v[118:119] op_sel_hi:[1,0]
    v_pk_mul_f32 v[234:235], v[234:235], v[118:119] op_sel_hi:[1,0]
    v_pk_mul_f32 v[236:237], v[236:237], v[118:119] op_sel_hi:[1,0]
    v_pk_mul_f32 v[238:239], v[238:239], v[118:119] op_sel_hi:[1,0]
    v_cvt_pk_bf16_f32 v232, v232, v233
    v_cvt_pk_bf16_f32 v233, v234, v235
    v_cvt_pk_bf16_f32 v234, v236, v237
    v_cvt_pk_bf16_f32 v235, v238, v239
    buffer_store_dwordx4 v[232:235], v15, s[8:11], s101 offen offset:1024 sc0 sc1
    ds_read_b64_tr_b16 a[208:209], v56 offset:40960
    ds_read_b64_tr_b16 a[210:211], v56 offset:43008
    ds_read_b64_tr_b16 a[212:213], v56 offset:45056
    ds_read_b64_tr_b16 a[214:215], v56 offset:47104
    ds_read_b64_tr_b16 a[216:217], v57 offset:40960
    ds_read_b64_tr_b16 a[218:219], v57 offset:43008
    ds_read_b64_tr_b16 a[220:221], v57 offset:45056
    ds_read_b64_tr_b16 a[222:223], v57 offset:47104
    s_waitcnt lgkmcnt(14)
    v_mfma_f32_16x16x32_bf16 v[64:67], a[192:195], a[64:67], 0
    s_waitcnt lgkmcnt(12)
    s_add_u32 m0, s62, 0
    ds_read_b64_tr_b16 a[224:225], v56 offset:49152
    v_mfma_f32_16x16x32_bf16 v[64:67], a[196:199], a[68:71], v[64:67]
    s_add_u32 s98, s65, 262144
    ds_read_b64_tr_b16 a[226:227], v56 offset:51200
    v_mfma_f32_16x16x32_bf16 v[72:75], a[192:195], a[80:83], 0
    buffer_load_dwordx4 v24, s[28:31], s98 offen offset:0  lds
    v_mfma_f32_16x16x32_bf16 v[72:75], a[196:199], a[84:87], v[72:75]
    s_waitcnt lgkmcnt(12)
    ds_read_b64_tr_b16 a[228:229], v56 offset:53248
    v_mfma_f32_16x16x32_bf16 v[68:71], a[200:203], a[64:67], 0
    s_waitcnt lgkmcnt(11)
    s_add_u32 s22, s22, 65536
    ds_read_b64_tr_b16 a[230:231], v56 offset:55296
    v_mfma_f32_16x16x32_bf16 v[68:71], a[204:207], a[68:71], v[68:71]
    s_add_u32 s23, s23, 65536
    ds_read_b64_tr_b16 a[232:233], v57 offset:49152
    v_mfma_f32_16x16x32_bf16 v[76:79], a[200:203], a[80:83], 0
    buffer_load_dwordx4 v25, s[28:31], s98 offen offset:1024  lds
    v_mfma_f32_16x16x32_bf16 v[76:79], a[204:207], a[84:87], v[76:79]
    s_waitcnt lgkmcnt(11)
    s_lshl_b32 s24, s61, 2
    ds_read_b64_tr_b16 a[234:235], v57 offset:51200
    v_mfma_f32_16x16x32_bf16 v[64:67], a[208:211], a[72:75], v[64:67]
    s_waitcnt lgkmcnt(10)
    s_add_u32 s24, s24, s3
    ds_read_b64_tr_b16 a[236:237], v57 offset:53248
    v_mfma_f32_16x16x32_bf16 v[64:67], a[212:215], a[76:79], v[64:67]
    s_lshl_b32 s24, s24, 3
    ds_read_b64_tr_b16 a[238:239], v57 offset:55296
    v_mfma_f32_16x16x32_bf16 v[72:75], a[208:211], a[88:91], v[72:75]
    buffer_load_dwordx4 v26, s[28:31], s98 offen offset:2048  lds
    v_mfma_f32_16x16x32_bf16 v[72:75], a[212:215], a[92:95], v[72:75]
    s_waitcnt lgkmcnt(10)
    s_add_u32 s24, s24, s4
    ds_read_b64_tr_b16 a[240:241], v56 offset:57344
    v_mfma_f32_16x16x32_bf16 v[68:71], a[216:219], a[72:75], v[68:71]
    s_waitcnt lgkmcnt(9)
    s_lshl_b32 s24, s24, 15
    ds_read_b64_tr_b16 a[242:243], v56 offset:59392
    v_mfma_f32_16x16x32_bf16 v[68:71], a[220:223], a[76:79], v[68:71]
    s_add_u32 s24, s24, 50331648
    ds_read_b64_tr_b16 a[244:245], v56 offset:61440
    v_mfma_f32_16x16x32_bf16 v[76:79], a[216:219], a[88:91], v[76:79]
    buffer_load_dwordx4 v27, s[28:31], s98 offen offset:3072  lds
    v_mfma_f32_16x16x32_bf16 v[76:79], a[220:223], a[92:95], v[76:79]
    s_waitcnt lgkmcnt(9)
    s_add_u32 m0, s62, 4096
    ds_read_b64_tr_b16 a[246:247], v56 offset:63488
    v_mfma_f32_16x16x32_bf16 v[64:67], a[224:227], a[96:99], v[64:67]
    s_waitcnt lgkmcnt(8)
    s_add_u32 s98, s65, 294912
    ds_read_b64_tr_b16 a[248:249], v57 offset:57344
    v_mfma_f32_16x16x32_bf16 v[64:67], a[228:231], a[100:103], v[64:67]
    ds_read_b64_tr_b16 a[250:251], v57 offset:59392
    v_mfma_f32_16x16x32_bf16 v[72:75], a[224:227], a[112:115], v[72:75]
    buffer_load_dwordx4 v24, s[28:31], s98 offen offset:0  lds
    v_mfma_f32_16x16x32_bf16 v[72:75], a[228:231], a[116:119], v[72:75]
    s_waitcnt lgkmcnt(8)
    ds_read_b64_tr_b16 a[252:253], v57 offset:61440
    v_mfma_f32_16x16x32_bf16 v[68:71], a[232:235], a[96:99], v[68:71]
    s_waitcnt lgkmcnt(7)
    ds_read_b64_tr_b16 a[254:255], v57 offset:63488
    v_mfma_f32_16x16x32_bf16 v[68:71], a[236:239], a[100:103], v[68:71]
    ds_read_b64_tr_b16 a[192:193], v58 offset:32768
    v_mfma_f32_16x16x32_bf16 v[76:79], a[232:235], a[112:115], v[76:79]
    buffer_load_dwordx4 v25, s[28:31], s98 offen offset:1024  lds
    v_mfma_f32_16x16x32_bf16 v[76:79], a[236:239], a[116:119], v[76:79]
    s_waitcnt lgkmcnt(7)
    ds_read_b64_tr_b16 a[194:195], v58 offset:34816
    v_mfma_f32_16x16x32_bf16 v[64:67], a[240:243], a[104:107], v[64:67]
    s_waitcnt lgkmcnt(6)
    ds_read_b64_tr_b16 a[196:197], v58 offset:36864
    v_mfma_f32_16x16x32_bf16 v[64:67], a[244:247], a[108:111], v[64:67]
    ds_read_b64_tr_b16 a[198:199], v58 offset:38912
    v_mfma_f32_16x16x32_bf16 v[72:75], a[240:243], a[120:123], v[72:75]
    buffer_load_dwordx4 v26, s[28:31], s98 offen offset:2048  lds
    v_mfma_f32_16x16x32_bf16 v[72:75], a[244:247], a[124:127], v[72:75]
    s_waitcnt lgkmcnt(6)
    ds_read_b64_tr_b16 a[200:201], v59 offset:32768
    v_mfma_f32_16x16x32_bf16 v[68:71], a[248:251], a[104:107], v[68:71]
    s_waitcnt lgkmcnt(5)
    ds_read_b64_tr_b16 a[202:203], v59 offset:34816
    v_mfma_f32_16x16x32_bf16 v[68:71], a[252:255], a[108:111], v[68:71]
    ds_read_b64_tr_b16 a[204:205], v59 offset:36864
    v_mfma_f32_16x16x32_bf16 v[76:79], a[248:251], a[120:123], v[76:79]
    buffer_load_dwordx4 v27, s[28:31], s98 offen offset:3072  lds
    ds_read_b64_tr_b16 a[206:207], v59 offset:38912
    v_mfma_f32_16x16x32_bf16 v[76:79], a[252:255], a[124:127], v[76:79]
    s_waitcnt lgkmcnt(6)
    ds_read_b64_tr_b16 a[208:209], v58 offset:40960
    v_mfma_f32_16x16x32_bf16 v[80:83], a[192:195], a[64:67], 0
    s_waitcnt lgkmcnt(5)
    ds_read_b64_tr_b16 a[210:211], v58 offset:43008
    v_mfma_f32_16x16x32_bf16 v[80:83], a[196:199], a[68:71], v[80:83]
    ds_read_b64_tr_b16 a[212:213], v58 offset:45056
    v_mfma_f32_16x16x32_bf16 v[88:91], a[192:195], a[80:83], 0
    ds_read_b64_tr_b16 a[214:215], v58 offset:47104
    s_waitcnt vmcnt(16)
    s_barrier
    v_mfma_f32_16x16x32_bf16 v[88:91], a[196:199], a[84:87], v[88:91]
    s_waitcnt lgkmcnt(6)
    s_add_u32 m0, s62, 98304
    ds_read_b64_tr_b16 a[216:217], v59 offset:40960
    v_mfma_f32_16x16x32_bf16 v[84:87], a[200:203], a[64:67], 0
    s_waitcnt lgkmcnt(5)
    s_add_u32 s98, s65, 262272
    ds_read_b64_tr_b16 a[218:219], v59 offset:43008
    v_mfma_f32_16x16x32_bf16 v[84:87], a[204:207], a[68:71], v[84:87]
    buffer_load_dwordx4 v24, s[28:31], s98 offen offset:0  lds
    ds_read_b64_tr_b16 a[220:221], v59 offset:45056
    v_mfma_f32_16x16x32_bf16 v[92:95], a[200:203], a[80:83], 0
    ds_read_b64_tr_b16 a[222:223], v59 offset:47104
    v_mfma_f32_16x16x32_bf16 v[92:95], a[204:207], a[84:87], v[92:95]
    s_waitcnt lgkmcnt(6)
    ds_read_b64_tr_b16 a[224:225], v58 offset:49152
    v_mfma_f32_16x16x32_bf16 v[80:83], a[208:211], a[72:75], v[80:83]
    s_waitcnt lgkmcnt(5)
    ds_read_b64_tr_b16 a[226:227], v58 offset:51200
    v_mfma_f32_16x16x32_bf16 v[80:83], a[212:215], a[76:79], v[80:83]
    buffer_load_dwordx4 v25, s[28:31], s98 offen offset:1024  lds
    v_mfma_f32_16x16x32_bf16 v[88:91], a[208:211], a[88:91], v[88:91]
    ds_read_b64_tr_b16 a[228:229], v58 offset:53248
    v_mfma_f32_16x16x32_bf16 v[88:91], a[212:215], a[92:95], v[88:91]
    s_waitcnt lgkmcnt(5)
    ds_read_b64_tr_b16 a[230:231], v58 offset:55296
    v_mfma_f32_16x16x32_bf16 v[84:87], a[216:219], a[72:75], v[84:87]
    s_waitcnt lgkmcnt(4)
    ds_read_b64_tr_b16 a[232:233], v59 offset:49152
    v_mfma_f32_16x16x32_bf16 v[84:87], a[220:223], a[76:79], v[84:87]
    buffer_load_dwordx4 v26, s[28:31], s98 offen offset:2048  lds
    ds_read_b64_tr_b16 a[234:235], v59 offset:51200
    v_mfma_f32_16x16x32_bf16 v[92:95], a[216:219], a[88:91], v[92:95]
    ds_read_b64_tr_b16 a[236:237], v59 offset:53248
    v_mfma_f32_16x16x32_bf16 v[92:95], a[220:223], a[92:95], v[92:95]
    s_waitcnt lgkmcnt(5)
    ds_read_b64_tr_b16 a[238:239], v59 offset:55296
    v_mfma_f32_16x16x32_bf16 v[80:83], a[224:227], a[96:99], v[80:83]
    s_waitcnt lgkmcnt(4)
    ds_read_b64_tr_b16 a[240:241], v58 offset:57344
    v_mfma_f32_16x16x32_bf16 v[80:83], a[228:231], a[100:103], v[80:83]
    buffer_load_dwordx4 v27, s[28:31], s98 offen offset:3072  lds
    v_mfma_f32_16x16x32_bf16 v[88:91], a[224:227], a[112:115], v[88:91]
    s_add_u32 m0, s62, 102400
    ds_read_b64_tr_b16 a[242:243], v58 offset:59392
    v_mfma_f32_16x16x32_bf16 v[88:91], a[228:231], a[116:119], v[88:91]
    s_waitcnt lgkmcnt(4)
    s_add_u32 s98, s65, 295040
    ds_read_b64_tr_b16 a[244:245], v58 offset:61440
    v_mfma_f32_16x16x32_bf16 v[84:87], a[232:235], a[96:99], v[84:87]
    s_waitcnt lgkmcnt(3)
    ds_read_b64_tr_b16 a[246:247], v58 offset:63488
    v_mfma_f32_16x16x32_bf16 v[84:87], a[236:239], a[100:103], v[84:87]
    buffer_load_dwordx4 v24, s[28:31], s98 offen offset:0  lds
    ds_read_b64_tr_b16 a[248:249], v59 offset:57344
    v_mfma_f32_16x16x32_bf16 v[92:95], a[232:235], a[112:115], v[92:95]
    ds_read_b64_tr_b16 a[250:251], v59 offset:59392
    v_mfma_f32_16x16x32_bf16 v[92:95], a[236:239], a[116:119], v[92:95]
    s_waitcnt lgkmcnt(4)
    ds_read_b64_tr_b16 a[252:253], v59 offset:61440
    v_mfma_f32_16x16x32_bf16 v[80:83], a[240:243], a[104:107], v[80:83]
    s_waitcnt lgkmcnt(3)
    ds_read_b64_tr_b16 a[254:255], v59 offset:63488
    v_mfma_f32_16x16x32_bf16 v[80:83], a[244:247], a[108:111], v[80:83]
    buffer_load_dwordx4 v25, s[28:31], s98 offen offset:1024  lds
    v_mfma_f32_16x16x32_bf16 v[88:91], a[240:243], a[120:123], v[88:91]
    ds_read_b64_tr_b16 a[192:193], v60 offset:0
    v_mfma_f32_16x16x32_bf16 v[88:91], a[244:247], a[124:127], v[88:91]
    s_waitcnt lgkmcnt(3)
    ds_read_b64_tr_b16 a[194:195], v60 offset:2048
    v_mfma_f32_16x16x32_bf16 v[84:87], a[248:251], a[104:107], v[84:87]
    s_waitcnt lgkmcnt(2)
    ds_read_b64_tr_b16 a[196:197], v60 offset:4096
    v_mfma_f32_16x16x32_bf16 v[84:87], a[252:255], a[108:111], v[84:87]
    buffer_load_dwordx4 v26, s[28:31], s98 offen offset:2048  lds
    ds_read_b64_tr_b16 a[198:199], v60 offset:6144
    v_mfma_f32_16x16x32_bf16 v[92:95], a[248:251], a[120:123], v[92:95]
    ds_read_b64_tr_b16 a[200:201], v61 offset:0
    v_mfma_f32_16x16x32_bf16 v[92:95], a[252:255], a[124:127], v[92:95]
    s_waitcnt lgkmcnt(3)
    ds_read_b64_tr_b16 a[202:203], v61 offset:2048
    v_mfma_f32_16x16x32_bf16 v[96:99], a[192:195], a[64:67], 0
    s_waitcnt lgkmcnt(2)
    ds_read_b64_tr_b16 a[204:205], v61 offset:4096
    v_mfma_f32_16x16x32_bf16 v[96:99], a[196:199], a[68:71], v[96:99]
    buffer_load_dwordx4 v27, s[28:31], s98 offen offset:3072  lds
    ds_read_b64_tr_b16 a[206:207], v61 offset:6144
    v_mfma_f32_16x16x32_bf16 v[104:107], a[192:195], a[80:83], 0
    ds_read_b64_tr_b16 a[208:209], v60 offset:8192
    v_mfma_f32_16x16x32_bf16 v[104:107], a[196:199], a[84:87], v[104:107]
    s_waitcnt lgkmcnt(3)
    ds_read_b64_tr_b16 a[210:211], v60 offset:10240
    v_mfma_f32_16x16x32_bf16 v[100:103], a[200:203], a[64:67], 0
    s_waitcnt lgkmcnt(2)
    ds_read_b64_tr_b16 a[212:213], v60 offset:12288
    v_mfma_f32_16x16x32_bf16 v[100:103], a[204:207], a[68:71], v[100:103]
    ds_read_b64_tr_b16 a[214:215], v60 offset:14336
    v_mfma_f32_16x16x32_bf16 v[108:111], a[200:203], a[80:83], 0
    ds_read_b64_tr_b16 a[216:217], v61 offset:8192
    v_mfma_f32_16x16x32_bf16 v[108:111], a[204:207], a[84:87], v[108:111]
    s_waitcnt lgkmcnt(3)
    ds_read_b64_tr_b16 a[218:219], v61 offset:10240
    v_mfma_f32_16x16x32_bf16 v[96:99], a[208:211], a[72:75], v[96:99]
    s_waitcnt lgkmcnt(2)
    ds_read_b64_tr_b16 a[220:221], v61 offset:12288
    v_mfma_f32_16x16x32_bf16 v[96:99], a[212:215], a[76:79], v[96:99]
    ds_read_b64_tr_b16 a[222:223], v61 offset:14336
    v_mfma_f32_16x16x32_bf16 v[104:107], a[208:211], a[88:91], v[104:107]
    ds_read_b64_tr_b16 a[224:225], v60 offset:16384
    v_mfma_f32_16x16x32_bf16 v[104:107], a[212:215], a[92:95], v[104:107]
    s_waitcnt lgkmcnt(3)
    ds_read_b64_tr_b16 a[226:227], v60 offset:18432
    v_mfma_f32_16x16x32_bf16 v[100:103], a[216:219], a[72:75], v[100:103]
    s_waitcnt lgkmcnt(2)
    ds_read_b64_tr_b16 a[228:229], v60 offset:20480
    v_mfma_f32_16x16x32_bf16 v[100:103], a[220:223], a[76:79], v[100:103]
    ds_read_b64_tr_b16 a[230:231], v60 offset:22528
    v_mfma_f32_16x16x32_bf16 v[108:111], a[216:219], a[88:91], v[108:111]
    ds_read_b64_tr_b16 a[232:233], v61 offset:16384
    v_mfma_f32_16x16x32_bf16 v[108:111], a[220:223], a[92:95], v[108:111]
    s_waitcnt lgkmcnt(3)
    ds_read_b64_tr_b16 a[234:235], v61 offset:18432
    v_mfma_f32_16x16x32_bf16 v[96:99], a[224:227], a[96:99], v[96:99]
    s_waitcnt lgkmcnt(2)
    ds_read_b64_tr_b16 a[236:237], v61 offset:20480
    s_waitcnt vmcnt(16)
    v_mfma_f32_16x16x32_bf16 v[96:99], a[228:231], a[100:103], v[96:99]
    buffer_store_dword v6, v5, s[8:11], s22 offen sc0 sc1
    ds_read_b64_tr_b16 a[238:239], v61 offset:22528
    v_mfma_f32_16x16x32_bf16 v[104:107], a[224:227], a[112:115], v[104:107]
    ds_read_b64_tr_b16 a[240:241], v60 offset:24576
    v_mfma_f32_16x16x32_bf16 v[104:107], a[228:231], a[116:119], v[104:107]
    s_waitcnt lgkmcnt(3)
    ds_read_b64_tr_b16 a[242:243], v60 offset:26624
    v_mfma_f32_16x16x32_bf16 v[100:103], a[232:235], a[96:99], v[100:103]
    s_waitcnt lgkmcnt(2)
    ds_read_b64_tr_b16 a[244:245], v60 offset:28672
    v_mfma_f32_16x16x32_bf16 v[100:103], a[236:239], a[100:103], v[100:103]
    ds_read_b64_tr_b16 a[246:247], v60 offset:30720
    v_mfma_f32_16x16x32_bf16 v[108:111], a[232:235], a[112:115], v[108:111]
    ds_read_b64_tr_b16 a[248:249], v61 offset:24576
    v_mfma_f32_16x16x32_bf16 v[108:111], a[236:239], a[116:119], v[108:111]
    s_waitcnt lgkmcnt(3)
    ds_read_b64_tr_b16 a[250:251], v61 offset:26624
    v_mfma_f32_16x16x32_bf16 v[96:99], a[240:243], a[104:107], v[96:99]
    s_waitcnt lgkmcnt(2)
    ds_read_b64_tr_b16 a[252:253], v61 offset:28672
    v_mfma_f32_16x16x32_bf16 v[96:99], a[244:247], a[108:111], v[96:99]
    ds_read_b64_tr_b16 a[254:255], v61 offset:30720
    v_mfma_f32_16x16x32_bf16 v[104:107], a[240:243], a[120:123], v[104:107]
    ds_read_b64_tr_b16 a[192:193], v62 offset:0
    v_mfma_f32_16x16x32_bf16 v[104:107], a[244:247], a[124:127], v[104:107]
    s_waitcnt lgkmcnt(3)
    ds_read_b64_tr_b16 a[194:195], v62 offset:2048
    v_mfma_f32_16x16x32_bf16 v[100:103], a[248:251], a[104:107], v[100:103]
    s_waitcnt lgkmcnt(2)
    ds_read_b64_tr_b16 a[196:197], v62 offset:4096
    v_mfma_f32_16x16x32_bf16 v[100:103], a[252:255], a[108:111], v[100:103]
    ds_read_b64_tr_b16 a[198:199], v62 offset:6144
    v_mfma_f32_16x16x32_bf16 v[108:111], a[248:251], a[120:123], v[108:111]
    ds_read_b64_tr_b16 a[200:201], v63 offset:0
    v_mfma_f32_16x16x32_bf16 v[108:111], a[252:255], a[124:127], v[108:111]
    s_waitcnt lgkmcnt(3)
    ds_read_b64_tr_b16 a[202:203], v63 offset:2048
    v_mfma_f32_16x16x32_bf16 v[112:115], a[192:195], a[64:67], 0
    s_waitcnt lgkmcnt(2)
    ds_read_b64_tr_b16 a[204:205], v63 offset:4096
    v_mfma_f32_16x16x32_bf16 v[112:115], a[196:199], a[68:71], v[112:115]
    ds_read_b64_tr_b16 a[206:207], v63 offset:6144
    v_mfma_f32_16x16x32_bf16 v[120:123], a[192:195], a[80:83], 0
    ds_read_b64_tr_b16 a[208:209], v62 offset:8192
    v_mfma_f32_16x16x32_bf16 v[120:123], a[196:199], a[84:87], v[120:123]
    s_waitcnt lgkmcnt(3)
    ds_read_b64_tr_b16 a[210:211], v62 offset:10240
    v_mfma_f32_16x16x32_bf16 v[116:119], a[200:203], a[64:67], 0
    s_waitcnt lgkmcnt(2)
    ds_read_b64_tr_b16 a[212:213], v62 offset:12288
    v_mfma_f32_16x16x32_bf16 v[116:119], a[204:207], a[68:71], v[116:119]
    ds_read_b64_tr_b16 a[214:215], v62 offset:14336
    v_mfma_f32_16x16x32_bf16 v[124:127], a[200:203], a[80:83], 0
    ds_read_b64_tr_b16 a[216:217], v63 offset:8192
    s_waitcnt vmcnt(1)
    s_barrier
    v_mfma_f32_16x16x32_bf16 v[124:127], a[204:207], a[84:87], v[124:127]
    s_waitcnt lgkmcnt(3)
    ds_read_b64_tr_b16 a[218:219], v63 offset:10240
    v_mfma_f32_16x16x32_bf16 v[112:115], a[208:211], a[72:75], v[112:115]
    s_waitcnt lgkmcnt(2)
    ds_read_b64_tr_b16 a[220:221], v63 offset:12288
    v_lshrrev_b32 v46, 2, v2
    v_mfma_f32_16x16x32_bf16 v[112:115], a[212:215], a[76:79], v[112:115]
    ds_read_b64_tr_b16 a[222:223], v63 offset:14336
    v_and_b32 v45, 3, v2
    v_mfma_f32_16x16x32_bf16 v[120:123], a[208:211], a[88:91], v[120:123]
    ds_read_b64_tr_b16 a[224:225], v62 offset:16384
    v_lshlrev_b32 v44, 8, v46
    v_mfma_f32_16x16x32_bf16 v[120:123], a[212:215], a[92:95], v[120:123]
    s_waitcnt lgkmcnt(3)
    ds_read_b64_tr_b16 a[226:227], v62 offset:18432
    v_lshl_add_u32 v44, v45, 4, v44
    v_mfma_f32_16x16x32_bf16 v[116:119], a[216:219], a[72:75], v[116:119]
    s_waitcnt lgkmcnt(2)
    ds_read_b64_tr_b16 a[228:229], v62 offset:20480
    v_lshlrev_b32 v45, 3, v45
    v_mfma_f32_16x16x32_bf16 v[116:119], a[220:223], a[76:79], v[116:119]
    ds_read_b64_tr_b16 a[230:231], v62 offset:22528
    v_lshl_add_u32 v45, v46, 6, v45
    v_mfma_f32_16x16x32_bf16 v[124:127], a[216:219], a[88:91], v[124:127]
    buffer_load_dword v3, v4, s[8:11], s23 offen sc0 sc1
    ds_read_b64_tr_b16 a[232:233], v63 offset:16384
    v_mfma_f32_16x16x32_bf16 v[124:127], a[220:223], a[92:95], v[124:127]
    s_waitcnt lgkmcnt(3)
    ds_read_b64_tr_b16 a[234:235], v63 offset:18432
    v_lshlrev_b32 v46, 1, v45
    v_mfma_f32_16x16x32_bf16 v[112:115], a[224:227], a[96:99], v[112:115]
    s_waitcnt lgkmcnt(2)
    s_lshl_b32 s70, s2, 15
    ds_read_b64_tr_b16 a[236:237], v63 offset:20480
    v_mfma_f32_16x16x32_bf16 v[112:115], a[228:231], a[100:103], v[112:115]
    s_lshl_b32 s100, s3, 6
    ds_read_b64_tr_b16 a[238:239], v63 offset:22528
    v_mfma_f32_16x16x32_bf16 v[120:123], a[224:227], a[112:115], v[120:123]
    s_add_u32 s70, s70, s100
    ds_read_b64_tr_b16 a[240:241], v62 offset:24576
    v_mfma_f32_16x16x32_bf16 v[120:123], a[228:231], a[116:119], v[120:123]
    s_waitcnt lgkmcnt(3)
    s_add_u32 s70, s70, 67108864
    ds_read_b64_tr_b16 a[242:243], v62 offset:26624
    v_mfma_f32_16x16x32_bf16 v[116:119], a[232:235], a[96:99], v[116:119]
    s_waitcnt lgkmcnt(2)
    s_and_b32 s68, s2, 31
    ds_read_b64_tr_b16 a[244:245], v62 offset:28672
    v_mfma_f32_16x16x32_bf16 v[116:119], a[236:239], a[100:103], v[116:119]
    s_lshl_b32 s68, s68, 2
    ds_read_b64_tr_b16 a[246:247], v62 offset:30720
    v_mfma_f32_16x16x32_bf16 v[124:127], a[232:235], a[112:115], v[124:127]
    s_add_u32 s68, s68, s3
    ds_read_b64_tr_b16 a[248:249], v63 offset:24576
    v_mfma_f32_16x16x32_bf16 v[124:127], a[236:239], a[116:119], v[124:127]
    s_waitcnt lgkmcnt(3)
    s_lshl_b32 s69, s61, 7
    ds_read_b64_tr_b16 a[250:251], v63 offset:26624
    v_mfma_f32_16x16x32_bf16 v[112:115], a[240:243], a[104:107], v[112:115]
    s_waitcnt lgkmcnt(2)
    s_add_u32 s69, s69, s68
    ds_read_b64_tr_b16 a[252:253], v63 offset:28672
    v_mfma_f32_16x16x32_bf16 v[112:115], a[244:247], a[108:111], v[112:115]
    s_lshl_b32 s100, s60, 7
    ds_read_b64_tr_b16 a[254:255], v63 offset:30720
    v_mfma_f32_16x16x32_bf16 v[120:123], a[240:243], a[120:123], v[120:123]
    s_add_u32 s68, s68, s100
    ds_read_b64_tr_b16 a[192:193], v56 offset:0
    v_mfma_f32_16x16x32_bf16 v[120:123], a[244:247], a[124:127], v[120:123]
    s_waitcnt lgkmcnt(3)
    s_lshl_b32 s100, s68, 10
    ds_read_b64_tr_b16 a[194:195], v56 offset:2048
    v_mfma_f32_16x16x32_bf16 v[116:119], a[248:251], a[104:107], v[116:119]
    s_waitcnt lgkmcnt(2)
    s_lshl_b32 s101, s69, 10
    ds_read_b64_tr_b16 a[196:197], v56 offset:4096
    v_mfma_f32_16x16x32_bf16 v[116:119], a[252:255], a[108:111], v[116:119]
    ds_read_b64_tr_b16 a[198:199], v56 offset:6144
    v_mfma_f32_16x16x32_bf16 v[124:127], a[248:251], a[120:123], v[124:127]
    ds_read_b64_tr_b16 a[200:201], v57 offset:0
    v_mfma_f32_16x16x32_bf16 v[124:127], a[252:255], a[124:127], v[124:127]
    s_waitcnt lgkmcnt(3)
    ds_read_b64_tr_b16 a[202:203], v57 offset:2048
    v_mfma_f32_16x16x32_bf16 v[64:67], a[192:195], a[0:3], v[64:67]
    s_waitcnt lgkmcnt(2)
    ds_read_b64_tr_b16 a[204:205], v57 offset:4096
    v_mfma_f32_16x16x32_bf16 v[64:67], a[196:199], a[4:7], v[64:67]
    ds_read_b64_tr_b16 a[206:207], v57 offset:6144
    v_mfma_f32_16x16x32_bf16 v[72:75], a[192:195], a[16:19], v[72:75]
    ds_read_b64_tr_b16 a[208:209], v56 offset:8192
    v_mfma_f32_16x16x32_bf16 v[72:75], a[196:199], a[20:23], v[72:75]
    s_waitcnt lgkmcnt(3)
    ds_read_b64_tr_b16 a[210:211], v56 offset:10240
    v_mfma_f32_16x16x32_bf16 v[68:71], a[200:203], a[0:3], v[68:71]
    s_waitcnt lgkmcnt(2)
    ds_read_b64_tr_b16 a[212:213], v56 offset:12288
    v_mfma_f32_16x16x32_bf16 v[68:71], a[204:207], a[4:7], v[68:71]
    ds_read_b64_tr_b16 a[214:215], v56 offset:14336
    v_mfma_f32_16x16x32_bf16 v[76:79], a[200:203], a[16:19], v[76:79]
    ds_read_b64_tr_b16 a[216:217], v57 offset:8192
    v_mfma_f32_16x16x32_bf16 v[76:79], a[204:207], a[20:23], v[76:79]
    s_waitcnt lgkmcnt(3)
    ds_read_b64_tr_b16 a[218:219], v57 offset:10240
    v_mfma_f32_16x16x32_bf16 v[64:67], a[208:211], a[8:11], v[64:67]
    s_waitcnt lgkmcnt(2)
    ds_read_b64_tr_b16 a[220:221], v57 offset:12288
    v_mfma_f32_16x16x32_bf16 v[64:67], a[212:215], a[12:15], v[64:67]
    ds_read_b64_tr_b16 a[222:223], v57 offset:14336
    v_mfma_f32_16x16x32_bf16 v[72:75], a[208:211], a[24:27], v[72:75]
    ds_read_b64_tr_b16 a[224:225], v56 offset:16384
    v_mfma_f32_16x16x32_bf16 v[72:75], a[212:215], a[28:31], v[72:75]
    s_waitcnt lgkmcnt(3)
    ds_read_b64_tr_b16 a[226:227], v56 offset:18432
    v_mfma_f32_16x16x32_bf16 v[68:71], a[216:219], a[8:11], v[68:71]
    s_waitcnt lgkmcnt(2)
    ds_read_b64_tr_b16 a[228:229], v56 offset:20480
    s_waitcnt vmcnt(0)
    v_cmp_ne_u32 vcc, 0, v3
    s_cmp_eq_u64 vcc, -1
    s_cbranch_scc0 L_C2_slow_13
L_C2_ok_14:
    v_mfma_f32_16x16x32_bf16 v[68:71], a[220:223], a[12:15], v[68:71]
    s_add_u32 s74, s24, 0
    ds_read_b64_tr_b16 a[230:231], v56 offset:22528
    v_mfma_f32_16x16x32_bf16 v[76:79], a[216:219], a[24:27], v[76:79]
    buffer_load_dwordx4 v[128:131], v1, s[8:11], s74 offen offset:0
    ds_read_b64_tr_b16 a[232:233], v57 offset:16384
    v_mfma_f32_16x16x32_bf16 v[76:79], a[220:223], a[28:31], v[76:79]
    s_waitcnt lgkmcnt(3)
    s_add_u32 s74, s24, 4096
    ds_read_b64_tr_b16 a[234:235], v57 offset:18432
    v_mfma_f32_16x16x32_bf16 v[64:67], a[224:227], a[32:35], v[64:67]
    s_waitcnt lgkmcnt(2)
    ds_read_b64_tr_b16 a[236:237], v57 offset:20480
    v_mfma_f32_16x16x32_bf16 v[64:67], a[228:231], a[36:39], v[64:67]
    ds_read_b64_tr_b16 a[238:239], v57 offset:22528
    v_mfma_f32_16x16x32_bf16 v[72:75], a[224:227], a[48:51], v[72:75]
    buffer_load_dwordx4 v[144:147], v1, s[8:11], s74 offen offset:0
    v_mfma_f32_16x16x32_bf16 v[72:75], a[228:231], a[52:55], v[72:75]
    s_waitcnt lgkmcnt(2)
    s_add_u32 s74, s24, 0
    ds_read_b64_tr_b16 a[240:241], v56 offset:24576
    v_mfma_f32_16x16x32_bf16 v[68:71], a[232:235], a[32:35], v[68:71]
    s_waitcnt lgkmcnt(1)
    ds_read_b64_tr_b16 a[242:243], v56 offset:26624
    v_mfma_f32_16x16x32_bf16 v[68:71], a[236:239], a[36:39], v[68:71]
    ds_read_b64_tr_b16 a[244:245], v56 offset:28672
    v_mfma_f32_16x16x32_bf16 v[76:79], a[232:235], a[48:51], v[76:79]
    buffer_load_dwordx4 v[132:135], v1, s[8:11], s74 offen offset:1024
    ds_read_b64_tr_b16 a[246:247], v56 offset:30720
    v_mfma_f32_16x16x32_bf16 v[76:79], a[236:239], a[52:55], v[76:79]
    s_waitcnt lgkmcnt(2)
    s_add_u32 s74, s24, 4096
    ds_read_b64_tr_b16 a[248:249], v57 offset:24576
    v_mfma_f32_16x16x32_bf16 v[64:67], a[240:243], a[40:43], v[64:67]
    s_waitcnt lgkmcnt(1)
    ds_read_b64_tr_b16 a[250:251], v57 offset:26624
    v_mfma_f32_16x16x32_bf16 v[64:67], a[244:247], a[44:47], v[64:67]
    ds_read_b64_tr_b16 a[252:253], v57 offset:28672
    v_mfma_f32_16x16x32_bf16 v[72:75], a[240:243], a[56:59], v[72:75]
    buffer_load_dwordx4 v[148:151], v1, s[8:11], s74 offen offset:1024
    ds_read_b64_tr_b16 a[254:255], v57 offset:30720
    v_mfma_f32_16x16x32_bf16 v[72:75], a[244:247], a[60:63], v[72:75]
    s_waitcnt lgkmcnt(2)
    s_add_u32 s74, s24, 0
    ds_read_b64_tr_b16 a[192:193], v58 offset:0
    v_mfma_f32_16x16x32_bf16 v[68:71], a[248:251], a[40:43], v[68:71]
    s_waitcnt lgkmcnt(1)
    ds_read_b64_tr_b16 a[194:195], v58 offset:2048
    v_mfma_f32_16x16x32_bf16 v[68:71], a[252:255], a[44:47], v[68:71]
    ds_read_b64_tr_b16 a[196:197], v58 offset:4096
    v_mfma_f32_16x16x32_bf16 v[76:79], a[248:251], a[56:59], v[76:79]
    buffer_load_dwordx4 v[136:139], v1, s[8:11], s74 offen offset:2048
    ds_read_b64_tr_b16 a[198:199], v58 offset:6144
    v_mfma_f32_16x16x32_bf16 v[76:79], a[252:255], a[60:63], v[76:79]
    s_waitcnt lgkmcnt(2)
    s_add_u32 s74, s24, 4096
    ds_read_b64_tr_b16 a[200:201], v59 offset:0
    v_mfma_f32_16x16x32_bf16 v[80:83], a[192:195], a[0:3], v[80:83]
    s_waitcnt lgkmcnt(1)
    ds_read_b64_tr_b16 a[202:203], v59 offset:2048
    v_mfma_f32_16x16x32_bf16 v[80:83], a[196:199], a[4:7], v[80:83]
    ds_read_b64_tr_b16 a[204:205], v59 offset:4096
    v_mfma_f32_16x16x32_bf16 v[88:91], a[192:195], a[16:19], v[88:91]
    buffer_load_dwordx4 v[152:155], v1, s[8:11], s74 offen offset:2048
    ds_read_b64_tr_b16 a[206:207], v59 offset:6144
    v_mfma_f32_16x16x32_bf16 v[88:91], a[196:199], a[20:23], v[88:91]
    s_waitcnt lgkmcnt(2)
    s_add_u32 s74, s24, 0
    ds_read_b64_tr_b16 a[208:209], v58 offset:8192
    v_mfma_f32_16x16x32_bf16 v[84:87], a[200:203], a[0:3], v[84:87]
    s_waitcnt lgkmcnt(1)
    ds_read_b64_tr_b16 a[210:211], v58 offset:10240
    v_mfma_f32_16x16x32_bf16 v[84:87], a[204:207], a[4:7], v[84:87]
    ds_read_b64_tr_b16 a[212:213], v58 offset:12288
    v_mfma_f32_16x16x32_bf16 v[92:95], a[200:203], a[16:19], v[92:95]
    buffer_load_dwordx4 v[140:143], v1, s[8:11], s74 offen offset:3072
    ds_read_b64_tr_b16 a[214:215], v58 offset:14336
    v_mfma_f32_16x16x32_bf16 v[92:95], a[204:207], a[20:23], v[92:95]
    s_waitcnt lgkmcnt(2)
    s_add_u32 s74, s24, 4096
    ds_read_b64_tr_b16 a[216:217], v59 offset:8192
    v_cvt_pk_bf16_f32 v64, v64, v65
    v_mfma_f32_16x16x32_bf16 v[80:83], a[208:211], a[8:11], v[80:83]
    s_waitcnt lgkmcnt(1)
    ds_read_b64_tr_b16 a[218:219], v59 offset:10240
    v_cvt_pk_bf16_f32 v65, v66, v67
    v_mfma_f32_16x16x32_bf16 v[80:83], a[212:215], a[12:15], v[80:83]
    ds_read_b64_tr_b16 a[220:221], v59 offset:12288
    v_cvt_pk_bf16_f32 v66, v68, v69
    v_mfma_f32_16x16x32_bf16 v[88:91], a[208:211], a[24:27], v[88:91]
    buffer_load_dwordx4 v[156:159], v1, s[8:11], s74 offen offset:3072
    ds_read_b64_tr_b16 a[222:223], v59 offset:14336
    v_mfma_f32_16x16x32_bf16 v[88:91], a[212:215], a[28:31], v[88:91]
    s_waitcnt lgkmcnt(2)
    s_add_u32 s74, s24, 8192
    ds_read_b64_tr_b16 a[224:225], v58 offset:16384
    v_cvt_pk_bf16_f32 v67, v70, v71
    v_mfma_f32_16x16x32_bf16 v[84:87], a[216:219], a[8:11], v[84:87]
    s_waitcnt lgkmcnt(1)
    ds_read_b64_tr_b16 a[226:227], v58 offset:18432
    v_min_u32 v64, -2, v64
    v_mfma_f32_16x16x32_bf16 v[84:87], a[220:223], a[12:15], v[84:87]
    ds_read_b64_tr_b16 a[228:229], v58 offset:20480
    v_min_u32 v65, -2, v65
    v_mfma_f32_16x16x32_bf16 v[92:95], a[216:219], a[24:27], v[92:95]
    buffer_load_dwordx4 v[160:163], v1, s[8:11], s74 offen offset:0
    ds_read_b64_tr_b16 a[230:231], v58 offset:22528
    v_mfma_f32_16x16x32_bf16 v[92:95], a[220:223], a[28:31], v[92:95]
    s_waitcnt lgkmcnt(2)
    s_add_u32 s74, s24, 12288
    ds_read_b64_tr_b16 a[232:233], v59 offset:16384
    v_min_u32 v66, -2, v66
    v_mfma_f32_16x16x32_bf16 v[80:83], a[224:227], a[32:35], v[80:83]
    s_waitcnt lgkmcnt(1)
    ds_read_b64_tr_b16 a[234:235], v59 offset:18432
    v_min_u32 v67, -2, v67
    v_mfma_f32_16x16x32_bf16 v[80:83], a[228:231], a[36:39], v[80:83]
    s_add_u32 s75, s18, 0
    ds_read_b64_tr_b16 a[236:237], v59 offset:20480
    v_mfma_f32_16x16x32_bf16 v[88:91], a[224:227], a[48:51], v[88:91]
    buffer_load_dwordx4 v[176:179], v1, s[8:11], s74 offen offset:0
    ds_read_b64_tr_b16 a[238:239], v59 offset:22528
    v_mfma_f32_16x16x32_bf16 v[88:91], a[228:231], a[52:55], v[88:91]
    s_waitcnt lgkmcnt(0)
    s_add_u32 s74, s24, 8192
    ds_read_b64_tr_b16 a[240:241], v58 offset:24576
    v_mfma_f32_16x16x32_bf16 v[84:87], a[232:235], a[32:35], v[84:87]
    buffer_store_dwordx4 v[64:67], v23, s[8:11], s75 offen offset:0 sc0 sc1
    ds_read_b64_tr_b16 a[242:243], v58 offset:26624
    v_mfma_f32_16x16x32_bf16 v[84:87], a[236:239], a[36:39], v[84:87]
    ds_read_b64_tr_b16 a[244:245], v58 offset:28672
    v_cvt_pk_bf16_f32 v72, v72, v73
    v_mfma_f32_16x16x32_bf16 v[92:95], a[232:235], a[48:51], v[92:95]
    buffer_load_dwordx4 v[164:167], v1, s[8:11], s74 offen offset:1024
    ds_read_b64_tr_b16 a[246:247], v58 offset:30720
    v_mfma_f32_16x16x32_bf16 v[92:95], a[236:239], a[52:55], v[92:95]
    s_waitcnt lgkmcnt(2)
    s_add_u32 s74, s24, 12288
    ds_read_b64_tr_b16 a[248:249], v59 offset:24576
    v_cvt_pk_bf16_f32 v73, v74, v75
    v_mfma_f32_16x16x32_bf16 v[80:83], a[240:243], a[40:43], v[80:83]
    s_waitcnt lgkmcnt(1)
    ds_read_b64_tr_b16 a[250:251], v59 offset:26624
    v_cvt_pk_bf16_f32 v74, v76, v77
    v_mfma_f32_16x16x32_bf16 v[80:83], a[244:247], a[44:47], v[80:83]
    ds_read_b64_tr_b16 a[252:253], v59 offset:28672
    v_cvt_pk_bf16_f32 v75, v78, v79
    v_mfma_f32_16x16x32_bf16 v[88:91], a[240:243], a[56:59], v[88:91]
    buffer_load_dwordx4 v[180:183], v1, s[8:11], s74 offen offset:1024
    ds_read_b64_tr_b16 a[254:255], v59 offset:30720
    v_mfma_f32_16x16x32_bf16 v[88:91], a[244:247], a[60:63], v[88:91]
    s_waitcnt lgkmcnt(2)
    s_add_u32 s74, s24, 8192
    ds_read_b64_tr_b16 a[192:193], v60 offset:32768
    v_min_u32 v72, -2, v72
    v_mfma_f32_16x16x32_bf16 v[84:87], a[248:251], a[40:43], v[84:87]
    s_waitcnt lgkmcnt(1)
    ds_read_b64_tr_b16 a[194:195], v60 offset:34816
    v_min_u32 v73, -2, v73
    v_mfma_f32_16x16x32_bf16 v[84:87], a[252:255], a[44:47], v[84:87]
    ds_read_b64_tr_b16 a[196:197], v60 offset:36864
    v_min_u32 v74, -2, v74
    v_mfma_f32_16x16x32_bf16 v[92:95], a[248:251], a[56:59], v[92:95]
    buffer_load_dwordx4 v[168:171], v1, s[8:11], s74 offen offset:2048
    ds_read_b64_tr_b16 a[198:199], v60 offset:38912
    v_mfma_f32_16x16x32_bf16 v[92:95], a[252:255], a[60:63], v[92:95]
    s_waitcnt lgkmcnt(2)
    s_add_u32 s74, s24, 12288
    ds_read_b64_tr_b16 a[200:201], v61 offset:32768
    v_min_u32 v75, -2, v75
    v_mfma_f32_16x16x32_bf16 v[96:99], a[192:195], a[0:3], v[96:99]
    s_waitcnt lgkmcnt(1)
    s_add_u32 s75, s18, 131072
    ds_read_b64_tr_b16 a[202:203], v61 offset:34816
    v_mfma_f32_16x16x32_bf16 v[96:99], a[196:199], a[4:7], v[96:99]
    buffer_store_dwordx4 v[72:75], v23, s[8:11], s75 offen offset:0 sc0 sc1
    ds_read_b64_tr_b16 a[204:205], v61 offset:36864
    v_mfma_f32_16x16x32_bf16 v[104:107], a[192:195], a[16:19], v[104:107]
    buffer_load_dwordx4 v[184:187], v1, s[8:11], s74 offen offset:2048
    ds_read_b64_tr_b16 a[206:207], v61 offset:38912
    v_mfma_f32_16x16x32_bf16 v[104:107], a[196:199], a[20:23], v[104:107]
    s_waitcnt lgkmcnt(2)
    s_add_u32 s74, s24, 8192
    ds_read_b64_tr_b16 a[208:209], v60 offset:40960
    v_mfma_f32_16x16x32_bf16 v[100:103], a[200:203], a[0:3], v[100:103]
    s_waitcnt lgkmcnt(1)
    ds_read_b64_tr_b16 a[210:211], v60 offset:43008
    v_mfma_f32_16x16x32_bf16 v[100:103], a[204:207], a[4:7], v[100:103]
    ds_read_b64_tr_b16 a[212:213], v60 offset:45056
    v_mfma_f32_16x16x32_bf16 v[108:111], a[200:203], a[16:19], v[108:111]
    buffer_load_dwordx4 v[172:175], v1, s[8:11], s74 offen offset:3072
    ds_read_b64_tr_b16 a[214:215], v60 offset:47104
    v_mfma_f32_16x16x32_bf16 v[108:111], a[204:207], a[20:23], v[108:111]
    s_waitcnt lgkmcnt(2)
    s_add_u32 s74, s24, 12288
    ds_read_b64_tr_b16 a[216:217], v61 offset:40960
    v_cvt_pk_bf16_f32 v80, v80, v81
    v_mfma_f32_16x16x32_bf16 v[96:99], a[208:211], a[8:11], v[96:99]
    s_waitcnt lgkmcnt(1)
    ds_read_b64_tr_b16 a[218:219], v61 offset:43008
    v_cvt_pk_bf16_f32 v81, v82, v83
    v_mfma_f32_16x16x32_bf16 v[96:99], a[212:215], a[12:15], v[96:99]
    ds_read_b64_tr_b16 a[220:221], v61 offset:45056
    v_cvt_pk_bf16_f32 v82, v84, v85
    v_mfma_f32_16x16x32_bf16 v[104:107], a[208:211], a[24:27], v[104:107]
    buffer_load_dwordx4 v[188:191], v1, s[8:11], s74 offen offset:3072
    ds_read_b64_tr_b16 a[222:223], v61 offset:47104
    v_mfma_f32_16x16x32_bf16 v[104:107], a[212:215], a[28:31], v[104:107]
    s_waitcnt lgkmcnt(2)
    s_add_u32 s74, s24, 16384
    ds_read_b64_tr_b16 a[224:225], v60 offset:49152
    v_cvt_pk_bf16_f32 v83, v86, v87
    v_mfma_f32_16x16x32_bf16 v[100:103], a[216:219], a[8:11], v[100:103]
    s_waitcnt lgkmcnt(1)
    ds_read_b64_tr_b16 a[226:227], v60 offset:51200
    v_min_u32 v80, -2, v80
    v_mfma_f32_16x16x32_bf16 v[100:103], a[220:223], a[12:15], v[100:103]
    ds_read_b64_tr_b16 a[228:229], v60 offset:53248
    v_min_u32 v81, -2, v81
    v_mfma_f32_16x16x32_bf16 v[108:111], a[216:219], a[24:27], v[108:111]
    buffer_load_dwordx4 v[192:195], v1, s[8:11], s74 offen offset:0
    ds_read_b64_tr_b16 a[230:231], v60 offset:55296
    v_mfma_f32_16x16x32_bf16 v[108:111], a[220:223], a[28:31], v[108:111]
    s_waitcnt lgkmcnt(2)
    s_add_u32 s74, s24, 20480
    ds_read_b64_tr_b16 a[232:233], v61 offset:49152
    v_min_u32 v82, -2, v82
    v_mfma_f32_16x16x32_bf16 v[96:99], a[224:227], a[32:35], v[96:99]
    s_waitcnt lgkmcnt(1)
    ds_read_b64_tr_b16 a[234:235], v61 offset:51200
    v_min_u32 v83, -2, v83
    v_mfma_f32_16x16x32_bf16 v[96:99], a[228:231], a[36:39], v[96:99]
    s_add_u32 s75, s18, 0
    ds_read_b64_tr_b16 a[236:237], v61 offset:53248
    v_mfma_f32_16x16x32_bf16 v[104:107], a[224:227], a[48:51], v[104:107]
    buffer_load_dwordx4 v[208:211], v1, s[8:11], s74 offen offset:0
    ds_read_b64_tr_b16 a[238:239], v61 offset:55296
    v_mfma_f32_16x16x32_bf16 v[104:107], a[228:231], a[52:55], v[104:107]
    s_waitcnt lgkmcnt(0)
    s_add_u32 s74, s24, 16384
    ds_read_b64_tr_b16 a[240:241], v60 offset:57344
    v_mfma_f32_16x16x32_bf16 v[100:103], a[232:235], a[32:35], v[100:103]
    buffer_store_dwordx4 v[80:83], v23, s[8:11], s75 offen offset:256 sc0 sc1
    ds_read_b64_tr_b16 a[242:243], v60 offset:59392
    v_mfma_f32_16x16x32_bf16 v[100:103], a[236:239], a[36:39], v[100:103]
    ds_read_b64_tr_b16 a[244:245], v60 offset:61440
    v_cvt_pk_bf16_f32 v88, v88, v89
    v_mfma_f32_16x16x32_bf16 v[108:111], a[232:235], a[48:51], v[108:111]
    buffer_load_dwordx4 v[196:199], v1, s[8:11], s74 offen offset:1024
    ds_read_b64_tr_b16 a[246:247], v60 offset:63488
    v_mfma_f32_16x16x32_bf16 v[108:111], a[236:239], a[52:55], v[108:111]
    s_waitcnt lgkmcnt(2)
    s_add_u32 s74, s24, 20480
    ds_read_b64_tr_b16 a[248:249], v61 offset:57344
    v_cvt_pk_bf16_f32 v89, v90, v91
    v_mfma_f32_16x16x32_bf16 v[96:99], a[240:243], a[40:43], v[96:99]
    s_waitcnt lgkmcnt(1)
    ds_read_b64_tr_b16 a[250:251], v61 offset:59392
    v_cvt_pk_bf16_f32 v90, v92, v93
    v_mfma_f32_16x16x32_bf16 v[96:99], a[244:247], a[44:47], v[96:99]
    ds_read_b64_tr_b16 a[252:253], v61 offset:61440
    v_cvt_pk_bf16_f32 v91, v94, v95
    v_mfma_f32_16x16x32_bf16 v[104:107], a[240:243], a[56:59], v[104:107]
    buffer_load_dwordx4 v[212:215], v1, s[8:11], s74 offen offset:1024
    ds_read_b64_tr_b16 a[254:255], v61 offset:63488
    v_mfma_f32_16x16x32_bf16 v[104:107], a[244:247], a[60:63], v[104:107]
    s_waitcnt lgkmcnt(2)
    s_add_u32 s74, s24, 16384
    ds_read_b64_tr_b16 a[192:193], v62 offset:32768
    v_min_u32 v88, -2, v88
    v_mfma_f32_16x16x32_bf16 v[100:103], a[248:251], a[40:43], v[100:103]
    s_waitcnt lgkmcnt(1)
    ds_read_b64_tr_b16 a[194:195], v62 offset:34816
    v_min_u32 v89, -2, v89
    v_mfma_f32_16x16x32_bf16 v[100:103], a[252:255], a[44:47], v[100:103]
    ds_read_b64_tr_b16 a[196:197], v62 offset:36864
    v_min_u32 v90, -2, v90
    v_mfma_f32_16x16x32_bf16 v[108:111], a[248:251], a[56:59], v[108:111]
    buffer_load_dwordx4 v[200:203], v1, s[8:11], s74 offen offset:2048
    ds_read_b64_tr_b16 a[198:199], v62 offset:38912
    v_mfma_f32_16x16x32_bf16 v[108:111], a[252:255], a[60:63], v[108:111]
    s_waitcnt lgkmcnt(2)
    s_add_u32 s74, s24, 20480
    ds_read_b64_tr_b16 a[200:201], v63 offset:32768
    v_min_u32 v91, -2, v91
    v_mfma_f32_16x16x32_bf16 v[112:115], a[192:195], a[0:3], v[112:115]
    s_waitcnt lgkmcnt(1)
    s_add_u32 s75, s18, 131072
    ds_read_b64_tr_b16 a[202:203], v63 offset:34816
    v_mfma_f32_16x16x32_bf16 v[112:115], a[196:199], a[4:7], v[112:115]
    buffer_store_dwordx4 v[88:91], v23, s[8:11], s75 offen offset:256 sc0 sc1
    ds_read_b64_tr_b16 a[204:205], v63 offset:36864
    v_mfma_f32_16x16x32_bf16 v[120:123], a[192:195], a[16:19], v[120:123]
    buffer_load_dwordx4 v[216:219], v1, s[8:11], s74 offen offset:2048
    ds_read_b64_tr_b16 a[206:207], v63 offset:38912
    v_mfma_f32_16x16x32_bf16 v[120:123], a[196:199], a[20:23], v[120:123]
    s_waitcnt lgkmcnt(2)
    s_add_u32 s74, s24, 16384
    ds_read_b64_tr_b16 a[208:209], v62 offset:40960
    v_mfma_f32_16x16x32_bf16 v[116:119], a[200:203], a[0:3], v[116:119]
    s_waitcnt lgkmcnt(1)
    ds_read_b64_tr_b16 a[210:211], v62 offset:43008
    v_mfma_f32_16x16x32_bf16 v[116:119], a[204:207], a[4:7], v[116:119]
    ds_read_b64_tr_b16 a[212:213], v62 offset:45056
    v_mfma_f32_16x16x32_bf16 v[124:127], a[200:203], a[16:19], v[124:127]
    buffer_load_dwordx4 v[204:207], v1, s[8:11], s74 offen offset:3072
    ds_read_b64_tr_b16 a[214:215], v62 offset:47104
    v_mfma_f32_16x16x32_bf16 v[124:127], a[204:207], a[20:23], v[124:127]
    s_waitcnt lgkmcnt(2)
    s_add_u32 s74, s24, 20480
    ds_read_b64_tr_b16 a[216:217], v63 offset:40960
    v_cvt_pk_bf16_f32 v96, v96, v97
    v_mfma_f32_16x16x32_bf16 v[112:115], a[208:211], a[8:11], v[112:115]
    s_waitcnt lgkmcnt(1)
    ds_read_b64_tr_b16 a[218:219], v63 offset:43008
    v_cvt_pk_bf16_f32 v97, v98, v99
    v_mfma_f32_16x16x32_bf16 v[112:115], a[212:215], a[12:15], v[112:115]
    ds_read_b64_tr_b16 a[220:221], v63 offset:45056
    v_cvt_pk_bf16_f32 v98, v100, v101
    v_mfma_f32_16x16x32_bf16 v[120:123], a[208:211], a[24:27], v[120:123]
    buffer_load_dwordx4 v[220:223], v1, s[8:11], s74 offen offset:3072
    ds_read_b64_tr_b16 a[222:223], v63 offset:47104
    v_mfma_f32_16x16x32_bf16 v[120:123], a[212:215], a[28:31], v[120:123]
    s_waitcnt lgkmcnt(2)
    s_add_u32 s74, s24, 24576
    ds_read_b64_tr_b16 a[224:225], v62 offset:49152
    v_cvt_pk_bf16_f32 v99, v102, v103
    v_mfma_f32_16x16x32_bf16 v[116:119], a[216:219], a[8:11], v[116:119]
    s_waitcnt lgkmcnt(1)
    ds_read_b64_tr_b16 a[226:227], v62 offset:51200
    v_min_u32 v96, -2, v96
    v_mfma_f32_16x16x32_bf16 v[116:119], a[220:223], a[12:15], v[116:119]
    ds_read_b64_tr_b16 a[228:229], v62 offset:53248
    v_min_u32 v97, -2, v97
    v_mfma_f32_16x16x32_bf16 v[124:127], a[216:219], a[24:27], v[124:127]
    buffer_load_dwordx4 v[224:227], v1, s[8:11], s74 offen offset:0
    ds_read_b64_tr_b16 a[230:231], v62 offset:55296
    v_mfma_f32_16x16x32_bf16 v[124:127], a[220:223], a[28:31], v[124:127]
    s_waitcnt lgkmcnt(2)
    s_add_u32 s74, s24, 28672
    ds_read_b64_tr_b16 a[232:233], v63 offset:49152
    v_min_u32 v98, -2, v98
    v_mfma_f32_16x16x32_bf16 v[112:115], a[224:227], a[32:35], v[112:115]
    s_waitcnt lgkmcnt(1)
    ds_read_b64_tr_b16 a[234:235], v63 offset:51200
    v_min_u32 v99, -2, v99
    v_mfma_f32_16x16x32_bf16 v[112:115], a[228:231], a[36:39], v[112:115]
    s_add_u32 s75, s18, 0
    ds_read_b64_tr_b16 a[236:237], v63 offset:53248
    v_mfma_f32_16x16x32_bf16 v[120:123], a[224:227], a[48:51], v[120:123]
    buffer_load_dwordx4 v[240:243], v1, s[8:11], s74 offen offset:0
    ds_read_b64_tr_b16 a[238:239], v63 offset:55296
    v_mfma_f32_16x16x32_bf16 v[120:123], a[228:231], a[52:55], v[120:123]
    s_waitcnt lgkmcnt(0)
    s_add_u32 s74, s24, 24576
    ds_read_b64_tr_b16 a[240:241], v62 offset:57344
    v_mfma_f32_16x16x32_bf16 v[116:119], a[232:235], a[32:35], v[116:119]
    buffer_store_dwordx4 v[96:99], v23, s[8:11], s75 offen offset:512 sc0 sc1
    ds_read_b64_tr_b16 a[242:243], v62 offset:59392
    v_mfma_f32_16x16x32_bf16 v[116:119], a[236:239], a[36:39], v[116:119]
    ds_read_b64_tr_b16 a[244:245], v62 offset:61440
    v_cvt_pk_bf16_f32 v104, v104, v105
    v_mfma_f32_16x16x32_bf16 v[124:127], a[232:235], a[48:51], v[124:127]
    buffer_load_dwordx4 v[228:231], v1, s[8:11], s74 offen offset:1024
    ds_read_b64_tr_b16 a[246:247], v62 offset:63488
    v_mfma_f32_16x16x32_bf16 v[124:127], a[236:239], a[52:55], v[124:127]
    s_waitcnt lgkmcnt(2)
    s_add_u32 s74, s24, 28672
    ds_read_b64_tr_b16 a[248:249], v63 offset:57344
    v_cvt_pk_bf16_f32 v105, v106, v107
    v_mfma_f32_16x16x32_bf16 v[112:115], a[240:243], a[40:43], v[112:115]
    s_waitcnt lgkmcnt(1)
    ds_read_b64_tr_b16 a[250:251], v63 offset:59392
    v_cvt_pk_bf16_f32 v106, v108, v109
    v_mfma_f32_16x16x32_bf16 v[112:115], a[244:247], a[44:47], v[112:115]
    ds_read_b64_tr_b16 a[252:253], v63 offset:61440
    v_cvt_pk_bf16_f32 v107, v110, v111
    v_mfma_f32_16x16x32_bf16 v[120:123], a[240:243], a[56:59], v[120:123]
    buffer_load_dwordx4 v[244:247], v1, s[8:11], s74 offen offset:1024
    ds_read_b64_tr_b16 a[254:255], v63 offset:63488
    v_mfma_f32_16x16x32_bf16 v[120:123], a[244:247], a[60:63], v[120:123]
    s_waitcnt lgkmcnt(2)
    s_add_u32 s74, s24, 24576
    ds_read_b64_tr_b16 a[192:193], v56 offset:32768
    v_min_u32 v104, -2, v104
    v_mfma_f32_16x16x32_bf16 v[116:119], a[248:251], a[40:43], v[116:119]
    s_waitcnt lgkmcnt(1)
    ds_read_b64_tr_b16 a[194:195], v56 offset:34816
    v_min_u32 v105, -2, v105
    v_mfma_f32_16x16x32_bf16 v[116:119], a[252:255], a[44:47], v[116:119]
    ds_read_b64_tr_b16 a[196:197], v56 offset:36864
    v_min_u32 v106, -2, v106
    v_mfma_f32_16x16x32_bf16 v[124:127], a[248:251], a[56:59], v[124:127]
    buffer_load_dwordx4 v[232:235], v1, s[8:11], s74 offen offset:2048
    ds_read_b64_tr_b16 a[198:199], v56 offset:38912
    v_mfma_f32_16x16x32_bf16 v[124:127], a[252:255], a[60:63], v[124:127]
    s_waitcnt vmcnt(33) lgkmcnt(2)
    s_add_u32 s74, s24, 28672
    ds_read_b64_tr_b16 a[200:201], v57 offset:32768
    v_min_u32 v107, -2, v107
    v_mfma_f32_16x16x32_bf16 v[64:67], a[192:195], v[128:131], 0
    s_waitcnt vmcnt(30) lgkmcnt(1)
    s_add_u32 s75, s18, 131072
    ds_read_b64_tr_b16 a[202:203], v57 offset:34816
    v_mfma_f32_16x16x32_bf16 v[64:67], a[196:199], v[132:135], v[64:67]
    buffer_store_dwordx4 v[104:107], v23, s[8:11], s75 offen offset:512 sc0 sc1
    ds_read_b64_tr_b16 a[204:205], v57 offset:36864
    v_mfma_f32_16x16x32_bf16 v[72:75], a[192:195], v[144:147], 0
    buffer_load_dwordx4 v[248:251], v1, s[8:11], s74 offen offset:2048
    ds_read_b64_tr_b16 a[206:207], v57 offset:38912
    v_mfma_f32_16x16x32_bf16 v[72:75], a[196:199], v[148:151], v[72:75]
    s_waitcnt lgkmcnt(2)
    s_add_u32 s74, s24, 24576
    ds_read_b64_tr_b16 a[208:209], v56 offset:40960
    v_mfma_f32_16x16x32_bf16 v[68:71], a[200:203], v[128:131], 0
    s_waitcnt lgkmcnt(1)
    ds_read_b64_tr_b16 a[210:211], v56 offset:43008
    ds_read_b64_tr_b16 a[224:225], v56 offset:49152
    v_mfma_f32_16x16x32_bf16 v[68:71], a[204:207], v[132:135], v[68:71]
    ds_read_b64_tr_b16 a[212:213], v56 offset:45056
    ds_read_b64_tr_b16 a[226:227], v56 offset:51200
    v_mfma_f32_16x16x32_bf16 v[76:79], a[200:203], v[144:147], 0
    buffer_load_dwordx4 v[236:239], v1, s[8:11], s74 offen offset:3072
    ds_read_b64_tr_b16 a[214:215], v56 offset:47104
    v_mfma_f32_16x16x32_bf16 v[76:79], a[204:207], v[148:151], v[76:79]
    s_waitcnt vmcnt(32) lgkmcnt(4)
    s_add_u32 s74, s24, 28672
    ds_read_b64_tr_b16 a[216:217], v57 offset:40960
    v_cvt_pk_bf16_f32 v112, v112, v113
    v_mfma_f32_16x16x32_bf16 v[64:67], a[208:211], v[136:139], v[64:67]
    s_waitcnt vmcnt(30) lgkmcnt(1)
    ds_read_b64_tr_b16 a[218:219], v57 offset:43008
    v_cvt_pk_bf16_f32 v113, v114, v115
    v_mfma_f32_16x16x32_bf16 v[64:67], a[212:215], v[140:143], v[64:67]
    s_waitcnt vmcnt(29) lgkmcnt(0)
    ds_read_b64_tr_b16 a[220:221], v57 offset:45056
    v_cvt_pk_bf16_f32 v114, v116, v117
    v_mfma_f32_16x16x32_bf16 v[72:75], a[208:211], v[152:155], v[72:75]
    buffer_load_dwordx4 v[252:255], v1, s[8:11], s74 offen offset:3072
    ds_read_b64_tr_b16 a[222:223], v57 offset:47104
    v_mfma_f32_16x16x32_bf16 v[72:75], a[212:215], v[156:159], v[72:75]
    buffer_load_dwordx2 v[32:33], v45, s[32:35], s100 offen
    ds_read_b64_tr_b16 a[228:229], v56 offset:53248
    v_mfma_f32_16x16x32_bf16 v[68:71], a[216:219], v[136:139], v[68:71]
    s_waitcnt lgkmcnt(1)
    ds_read_b64_tr_b16 a[230:231], v56 offset:55296
    v_cvt_pk_bf16_f32 v115, v118, v119
    v_mfma_f32_16x16x32_bf16 v[68:71], a[220:223], v[140:143], v[68:71]
    ds_read_b64_tr_b16 a[232:233], v57 offset:49152
    v_min_u32 v112, -2, v112
    v_mfma_f32_16x16x32_bf16 v[76:79], a[216:219], v[152:155], v[76:79]
    s_waitcnt vmcnt(30)
    ds_read_b64_tr_b16 a[234:235], v57 offset:51200
    v_min_u32 v113, -2, v113
    v_mfma_f32_16x16x32_bf16 v[76:79], a[220:223], v[156:159], v[76:79]
    buffer_load_dwordx2 v[34:35], v45, s[32:35], s100 offen offset:32
    ds_read_b64_tr_b16 a[236:237], v57 offset:53248
    v_mfma_f32_16x16x32_bf16 v[64:67], a[224:227], v[160:163], v[64:67]
    s_waitcnt vmcnt(28) lgkmcnt(3)
    ds_read_b64_tr_b16 a[238:239], v57 offset:55296
    v_min_u32 v114, -2, v114
    v_mfma_f32_16x16x32_bf16 v[64:67], a[228:231], v[164:167], v[64:67]
    ds_read_b64_tr_b16 a[240:241], v56 offset:57344
    v_min_u32 v115, -2, v115
    v_mfma_f32_16x16x32_bf16 v[72:75], a[224:227], v[176:179], v[72:75]
    s_waitcnt vmcnt(27) lgkmcnt(1)
    s_add_u32 s75, s18, 0
    ds_read_b64_tr_b16 a[242:243], v56 offset:59392
    v_mfma_f32_16x16x32_bf16 v[72:75], a[228:231], v[180:183], v[72:75]
    buffer_load_dwordx2 v[36:37], v45, s[32:35], s101 offen
    ds_read_b64_tr_b16 a[244:245], v56 offset:61440
    v_mfma_f32_16x16x32_bf16 v[68:71], a[232:235], v[160:163], v[68:71]
    buffer_store_dwordx4 v[112:115], v23, s[8:11], s75 offen offset:768 sc0 sc1
    ds_read_b64_tr_b16 a[246:247], v56 offset:63488
    v_mfma_f32_16x16x32_bf16 v[68:71], a[236:239], v[164:167], v[68:71]
    ds_read_b64_tr_b16 a[248:249], v57 offset:57344
    v_cvt_pk_bf16_f32 v120, v120, v121
    v_mfma_f32_16x16x32_bf16 v[76:79], a[232:235], v[176:179], v[76:79]
    s_waitcnt vmcnt(28) lgkmcnt(3)
    ds_read_b64_tr_b16 a[250:251], v57 offset:59392
    v_cvt_pk_bf16_f32 v121, v122, v123
    v_mfma_f32_16x16x32_bf16 v[76:79], a[236:239], v[180:183], v[76:79]
    buffer_load_dwordx2 v[38:39], v45, s[32:35], s101 offen offset:32
    ds_read_b64_tr_b16 a[252:253], v57 offset:61440
    v_mfma_f32_16x16x32_bf16 v[64:67], a[240:243], v[168:171], v[64:67]
    s_waitcnt vmcnt(26) lgkmcnt(3)
    ds_read_b64_tr_b16 a[254:255], v57 offset:63488
    v_cvt_pk_bf16_f32 v122, v124, v125
    v_mfma_f32_16x16x32_bf16 v[64:67], a[244:247], v[172:175], v[64:67]
    ds_read_b64_tr_b16 a[192:193], v58 offset:32768
    v_cvt_pk_bf16_f32 v123, v126, v127
    v_mfma_f32_16x16x32_bf16 v[72:75], a[240:243], v[184:187], v[72:75]
    s_waitcnt vmcnt(25) lgkmcnt(3)
    ds_read_b64_tr_b16 a[194:195], v58 offset:34816
    v_min_u32 v120, -2, v120
    v_mfma_f32_16x16x32_bf16 v[72:75], a[244:247], v[188:191], v[72:75]
    buffer_load_dwordx2 v[40:41], v45, s[56:59], 0 offen
    ds_read_b64_tr_b16 a[196:197], v58 offset:36864
    v_mfma_f32_16x16x32_bf16 v[68:71], a[248:251], v[168:171], v[68:71]
    s_waitcnt lgkmcnt(3)
    ds_read_b64_tr_b16 a[198:199], v58 offset:38912
    v_min_u32 v121, -2, v121
    v_mfma_f32_16x16x32_bf16 v[68:71], a[252:255], v[172:175], v[68:71]
    ds_read_b64_tr_b16 a[200:201], v59 offset:32768
    v_min_u32 v122, -2, v122
    v_mfma_f32_16x16x32_bf16 v[76:79], a[248:251], v[184:187], v[76:79]
    s_waitcnt lgkmcnt(3)
    ds_read_b64_tr_b16 a[202:203], v59 offset:34816
    v_min_u32 v123, -2, v123
    v_mfma_f32_16x16x32_bf16 v[76:79], a[252:255], v[188:191], v[76:79]
    buffer_load_dwordx2 v[42:43], v45, s[56:59], 0 offen offset:32
    ds_read_b64_tr_b16 a[204:205], v59 offset:36864
    v_mfma_f32_16x16x32_bf16 v[80:83], a[192:195], v[128:131], 0
    s_waitcnt lgkmcnt(3)
    s_add_u32 s75, s18, 131072
    ds_read_b64_tr_b16 a[206:207], v59 offset:38912
    v_mfma_f32_16x16x32_bf16 v[80:83], a[196:199], v[132:135], v[80:83]
    buffer_store_dwordx4 v[120:123], v23, s[8:11], s75 offen offset:768 sc0 sc1
    v_mfma_f32_16x16x32_bf16 v[88:91], a[192:195], v[144:147], 0
    ds_read_b64_tr_b16 a[208:209], v58 offset:40960
    v_mfma_f32_16x16x32_bf16 v[88:91], a[196:199], v[148:151], v[88:91]
    s_waitcnt lgkmcnt(3)
    ds_read_b64_tr_b16 a[210:211], v58 offset:43008
    v_mfma_f32_16x16x32_bf16 v[84:87], a[200:203], v[128:131], 0
    s_waitcnt lgkmcnt(2)
    ds_read_b64_tr_b16 a[212:213], v58 offset:45056
    v_mfma_f32_16x16x32_bf16 v[84:87], a[204:207], v[132:135], v[84:87]
    ds_read_b64_tr_b16 a[214:215], v58 offset:47104
    v_mfma_f32_16x16x32_bf16 v[92:95], a[200:203], v[144:147], 0
    ds_read_b64_tr_b16 a[216:217], v59 offset:40960
    v_mfma_f32_16x16x32_bf16 v[92:95], a[204:207], v[148:151], v[92:95]
    s_waitcnt lgkmcnt(3)
    ds_read_b64_tr_b16 a[218:219], v59 offset:43008
    v_mfma_f32_16x16x32_bf16 v[80:83], a[208:211], v[136:139], v[80:83]
    s_waitcnt lgkmcnt(2)
    ds_read_b64_tr_b16 a[220:221], v59 offset:45056
    v_mfma_f32_16x16x32_bf16 v[80:83], a[212:215], v[140:143], v[80:83]
    ds_read_b64_tr_b16 a[222:223], v59 offset:47104
    v_mfma_f32_16x16x32_bf16 v[88:91], a[208:211], v[152:155], v[88:91]
    ds_read_b64_tr_b16 a[224:225], v58 offset:49152
    v_mfma_f32_16x16x32_bf16 v[88:91], a[212:215], v[156:159], v[88:91]
    s_waitcnt lgkmcnt(3)
    ds_read_b64_tr_b16 a[226:227], v58 offset:51200
    v_mfma_f32_16x16x32_bf16 v[84:87], a[216:219], v[136:139], v[84:87]
    s_waitcnt lgkmcnt(2)
    ds_read_b64_tr_b16 a[228:229], v58 offset:53248
    v_mfma_f32_16x16x32_bf16 v[84:87], a[220:223], v[140:143], v[84:87]
    ds_read_b64_tr_b16 a[230:231], v58 offset:55296
    v_mfma_f32_16x16x32_bf16 v[92:95], a[216:219], v[152:155], v[92:95]
    ds_read_b64_tr_b16 a[232:233], v59 offset:49152
    v_mfma_f32_16x16x32_bf16 v[92:95], a[220:223], v[156:159], v[92:95]
    s_waitcnt lgkmcnt(3)
    ds_read_b64_tr_b16 a[234:235], v59 offset:51200
    v_mfma_f32_16x16x32_bf16 v[80:83], a[224:227], v[160:163], v[80:83]
    s_waitcnt lgkmcnt(2)
    ds_read_b64_tr_b16 a[236:237], v59 offset:53248
    v_mfma_f32_16x16x32_bf16 v[80:83], a[228:231], v[164:167], v[80:83]
    ds_read_b64_tr_b16 a[238:239], v59 offset:55296
    v_mfma_f32_16x16x32_bf16 v[88:91], a[224:227], v[176:179], v[88:91]
    ds_read_b64_tr_b16 a[240:241], v58 offset:57344
    v_mfma_f32_16x16x32_bf16 v[88:91], a[228:231], v[180:183], v[88:91]
    s_waitcnt lgkmcnt(3)
    ds_read_b64_tr_b16 a[242:243], v58 offset:59392
    v_mfma_f32_16x16x32_bf16 v[84:87], a[232:235], v[160:163], v[84:87]
    s_waitcnt lgkmcnt(2)
    ds_read_b64_tr_b16 a[244:245], v58 offset:61440
    v_mfma_f32_16x16x32_bf16 v[84:87], a[236:239], v[164:167], v[84:87]
    ds_read_b64_tr_b16 a[246:247], v58 offset:63488
    v_mfma_f32_16x16x32_bf16 v[92:95], a[232:235], v[176:179], v[92:95]
    ds_read_b64_tr_b16 a[248:249], v59 offset:57344
    v_mfma_f32_16x16x32_bf16 v[92:95], a[236:239], v[180:183], v[92:95]
    s_waitcnt lgkmcnt(3)
    ds_read_b64_tr_b16 a[250:251], v59 offset:59392
    v_mfma_f32_16x16x32_bf16 v[80:83], a[240:243], v[168:171], v[80:83]
    s_waitcnt lgkmcnt(2)
    ds_read_b64_tr_b16 a[252:253], v59 offset:61440
    v_mfma_f32_16x16x32_bf16 v[80:83], a[244:247], v[172:175], v[80:83]
    ds_read_b64_tr_b16 a[254:255], v59 offset:63488
    v_mfma_f32_16x16x32_bf16 v[88:91], a[240:243], v[184:187], v[88:91]
    ds_read_b64_tr_b16 a[192:193], v60 offset:0
    v_mfma_f32_16x16x32_bf16 v[88:91], a[244:247], v[188:191], v[88:91]
    s_waitcnt lgkmcnt(3)
    ds_read_b64_tr_b16 a[194:195], v60 offset:2048
    v_mfma_f32_16x16x32_bf16 v[84:87], a[248:251], v[168:171], v[84:87]
    s_waitcnt lgkmcnt(2)
    ds_read_b64_tr_b16 a[196:197], v60 offset:4096
    v_mfma_f32_16x16x32_bf16 v[84:87], a[252:255], v[172:175], v[84:87]
    ds_read_b64_tr_b16 a[198:199], v60 offset:6144
    v_mfma_f32_16x16x32_bf16 v[92:95], a[248:251], v[184:187], v[92:95]
    ds_read_b64_tr_b16 a[200:201], v61 offset:0
    v_mfma_f32_16x16x32_bf16 v[92:95], a[252:255], v[188:191], v[92:95]
    s_waitcnt lgkmcnt(3)
    ds_read_b64_tr_b16 a[202:203], v61 offset:2048
    v_mfma_f32_16x16x32_bf16 v[96:99], a[192:195], v[128:131], 0
    s_waitcnt lgkmcnt(2)
    ds_read_b64_tr_b16 a[204:205], v61 offset:4096
    v_mfma_f32_16x16x32_bf16 v[96:99], a[196:199], v[132:135], v[96:99]
    ds_read_b64_tr_b16 a[206:207], v61 offset:6144
    v_mfma_f32_16x16x32_bf16 v[104:107], a[192:195], v[144:147], 0
    ds_read_b64_tr_b16 a[208:209], v60 offset:8192
    v_mfma_f32_16x16x32_bf16 v[104:107], a[196:199], v[148:151], v[104:107]
    s_waitcnt lgkmcnt(3)
    ds_read_b64_tr_b16 a[210:211], v60 offset:10240
    v_mfma_f32_16x16x32_bf16 v[100:103], a[200:203], v[128:131], 0
    s_waitcnt lgkmcnt(2)
    ds_read_b64_tr_b16 a[212:213], v60 offset:12288
    v_mfma_f32_16x16x32_bf16 v[100:103], a[204:207], v[132:135], v[100:103]
    ds_read_b64_tr_b16 a[214:215], v60 offset:14336
    v_mfma_f32_16x16x32_bf16 v[108:111], a[200:203], v[144:147], 0
    ds_read_b64_tr_b16 a[216:217], v61 offset:8192
    v_mfma_f32_16x16x32_bf16 v[108:111], a[204:207], v[148:151], v[108:111]
    s_waitcnt lgkmcnt(3)
    ds_read_b64_tr_b16 a[218:219], v61 offset:10240
    v_mfma_f32_16x16x32_bf16 v[96:99], a[208:211], v[136:139], v[96:99]
    s_waitcnt lgkmcnt(2)
    ds_read_b64_tr_b16 a[220:221], v61 offset:12288
    v_mfma_f32_16x16x32_bf16 v[96:99], a[212:215], v[140:143], v[96:99]
    ds_read_b64_tr_b16 a[222:223], v61 offset:14336
    v_mfma_f32_16x16x32_bf16 v[104:107], a[208:211], v[152:155], v[104:107]
    ds_read_b64_tr_b16 a[224:225], v60 offset:16384
    v_mfma_f32_16x16x32_bf16 v[104:107], a[212:215], v[156:159], v[104:107]
    s_waitcnt lgkmcnt(3)
    ds_read_b64_tr_b16 a[226:227], v60 offset:18432
    v_mfma_f32_16x16x32_bf16 v[100:103], a[216:219], v[136:139], v[100:103]
    s_waitcnt lgkmcnt(2)
    ds_read_b64_tr_b16 a[228:229], v60 offset:20480
    v_mfma_f32_16x16x32_bf16 v[100:103], a[220:223], v[140:143], v[100:103]
    ds_read_b64_tr_b16 a[230:231], v60 offset:22528
    v_mfma_f32_16x16x32_bf16 v[108:111], a[216:219], v[152:155], v[108:111]
    ds_read_b64_tr_b16 a[232:233], v61 offset:16384
    v_mfma_f32_16x16x32_bf16 v[108:111], a[220:223], v[156:159], v[108:111]
    s_waitcnt lgkmcnt(3)
    ds_read_b64_tr_b16 a[234:235], v61 offset:18432
    v_mfma_f32_16x16x32_bf16 v[96:99], a[224:227], v[160:163], v[96:99]
    s_waitcnt lgkmcnt(2)
    ds_read_b64_tr_b16 a[236:237], v61 offset:20480
    v_mfma_f32_16x16x32_bf16 v[96:99], a[228:231], v[164:167], v[96:99]
    ds_read_b64_tr_b16 a[238:239], v61 offset:22528
    v_mfma_f32_16x16x32_bf16 v[104:107], a[224:227], v[176:179], v[104:107]
    ds_read_b64_tr_b16 a[240:241], v60 offset:24576
    v_mfma_f32_16x16x32_bf16 v[104:107], a[228:231], v[180:183], v[104:107]
    s_waitcnt lgkmcnt(3)
    ds_read_b64_tr_b16 a[242:243], v60 offset:26624
    v_mfma_f32_16x16x32_bf16 v[100:103], a[232:235], v[160:163], v[100:103]
    s_waitcnt lgkmcnt(2)
    ds_read_b64_tr_b16 a[244:245], v60 offset:28672
    v_mfma_f32_16x16x32_bf16 v[100:103], a[236:239], v[164:167], v[100:103]
    ds_read_b64_tr_b16 a[246:247], v60 offset:30720
    v_mfma_f32_16x16x32_bf16 v[108:111], a[232:235], v[176:179], v[108:111]
    ds_read_b64_tr_b16 a[248:249], v61 offset:24576
    v_mfma_f32_16x16x32_bf16 v[108:111], a[236:239], v[180:183], v[108:111]
    s_waitcnt lgkmcnt(3)
    ds_read_b64_tr_b16 a[250:251], v61 offset:26624
    v_mfma_f32_16x16x32_bf16 v[96:99], a[240:243], v[168:171], v[96:99]
    s_waitcnt lgkmcnt(2)
    ds_read_b64_tr_b16 a[252:253], v61 offset:28672
    v_mfma_f32_16x16x32_bf16 v[96:99], a[244:247], v[172:175], v[96:99]
    ds_read_b64_tr_b16 a[254:255], v61 offset:30720
    v_mfma_f32_16x16x32_bf16 v[104:107], a[240:243], v[184:187], v[104:107]
    ds_read_b64_tr_b16 a[192:193], v62 offset:0
    v_mfma_f32_16x16x32_bf16 v[104:107], a[244:247], v[188:191], v[104:107]
    s_waitcnt lgkmcnt(3)
    ds_read_b64_tr_b16 a[194:195], v62 offset:2048
    v_mfma_f32_16x16x32_bf16 v[100:103], a[248:251], v[168:171], v[100:103]
    s_waitcnt lgkmcnt(2)
    ds_read_b64_tr_b16 a[196:197], v62 offset:4096
    v_mfma_f32_16x16x32_bf16 v[100:103], a[252:255], v[172:175], v[100:103]
    ds_read_b64_tr_b16 a[198:199], v62 offset:6144
    v_mfma_f32_16x16x32_bf16 v[108:111], a[248:251], v[184:187], v[108:111]
    ds_read_b64_tr_b16 a[200:201], v63 offset:0
    v_mfma_f32_16x16x32_bf16 v[108:111], a[252:255], v[188:191], v[108:111]
    s_waitcnt lgkmcnt(3)
    ds_read_b64_tr_b16 a[202:203], v63 offset:2048
    v_mfma_f32_16x16x32_bf16 v[112:115], a[192:195], v[128:131], 0
    s_waitcnt lgkmcnt(2)
    ds_read_b64_tr_b16 a[204:205], v63 offset:4096
    v_mfma_f32_16x16x32_bf16 v[112:115], a[196:199], v[132:135], v[112:115]
    ds_read_b64_tr_b16 a[206:207], v63 offset:6144
    v_mfma_f32_16x16x32_bf16 v[120:123], a[192:195], v[144:147], 0
    ds_read_b64_tr_b16 a[208:209], v62 offset:8192
    v_mfma_f32_16x16x32_bf16 v[120:123], a[196:199], v[148:151], v[120:123]
    s_waitcnt lgkmcnt(3)
    ds_read_b64_tr_b16 a[210:211], v62 offset:10240
    v_mfma_f32_16x16x32_bf16 v[116:119], a[200:203], v[128:131], 0
    s_waitcnt lgkmcnt(2)
    ds_read_b64_tr_b16 a[212:213], v62 offset:12288
    v_mfma_f32_16x16x32_bf16 v[116:119], a[204:207], v[132:135], v[116:119]
    ds_read_b64_tr_b16 a[214:215], v62 offset:14336
    v_mfma_f32_16x16x32_bf16 v[124:127], a[200:203], v[144:147], 0
    ds_read_b64_tr_b16 a[216:217], v63 offset:8192
    v_mfma_f32_16x16x32_bf16 v[124:127], a[204:207], v[148:151], v[124:127]
    s_waitcnt lgkmcnt(3)
    ds_read_b64_tr_b16 a[218:219], v63 offset:10240
    v_mfma_f32_16x16x32_bf16 v[112:115], a[208:211], v[136:139], v[112:115]
    s_waitcnt lgkmcnt(2)
    ds_read_b64_tr_b16 a[220:221], v63 offset:12288
    v_mfma_f32_16x16x32_bf16 v[112:115], a[212:215], v[140:143], v[112:115]
    ds_read_b64_tr_b16 a[222:223], v63 offset:14336
    v_mfma_f32_16x16x32_bf16 v[120:123], a[208:211], v[152:155], v[120:123]
    ds_read_b64_tr_b16 a[224:225], v62 offset:16384
    v_mfma_f32_16x16x32_bf16 v[120:123], a[212:215], v[156:159], v[120:123]
    s_waitcnt lgkmcnt(3)
    ds_read_b64_tr_b16 a[226:227], v62 offset:18432
    v_mfma_f32_16x16x32_bf16 v[116:119], a[216:219], v[136:139], v[116:119]
    s_waitcnt lgkmcnt(2)
    ds_read_b64_tr_b16 a[228:229], v62 offset:20480
    v_mfma_f32_16x16x32_bf16 v[116:119], a[220:223], v[140:143], v[116:119]
    ds_read_b64_tr_b16 a[230:231], v62 offset:22528
    v_mfma_f32_16x16x32_bf16 v[124:127], a[216:219], v[152:155], v[124:127]
    ds_read_b64_tr_b16 a[232:233], v63 offset:16384
    v_mfma_f32_16x16x32_bf16 v[124:127], a[220:223], v[156:159], v[124:127]
    s_waitcnt lgkmcnt(3)
    ds_read_b64_tr_b16 a[234:235], v63 offset:18432
    v_mfma_f32_16x16x32_bf16 v[112:115], a[224:227], v[160:163], v[112:115]
    s_waitcnt lgkmcnt(2)
    ds_read_b64_tr_b16 a[236:237], v63 offset:20480
    v_mfma_f32_16x16x32_bf16 v[112:115], a[228:231], v[164:167], v[112:115]
    ds_read_b64_tr_b16 a[238:239], v63 offset:22528
    v_mfma_f32_16x16x32_bf16 v[120:123], a[224:227], v[176:179], v[120:123]
    ds_read_b64_tr_b16 a[240:241], v62 offset:24576
    v_mfma_f32_16x16x32_bf16 v[120:123], a[228:231], v[180:183], v[120:123]
    s_waitcnt lgkmcnt(3)
    ds_read_b64_tr_b16 a[242:243], v62 offset:26624
    v_mfma_f32_16x16x32_bf16 v[116:119], a[232:235], v[160:163], v[116:119]
    s_waitcnt lgkmcnt(2)
    ds_read_b64_tr_b16 a[244:245], v62 offset:28672
    v_mfma_f32_16x16x32_bf16 v[116:119], a[236:239], v[164:167], v[116:119]
    ds_read_b64_tr_b16 a[246:247], v62 offset:30720
    v_mfma_f32_16x16x32_bf16 v[124:127], a[232:235], v[176:179], v[124:127]
    ds_read_b64_tr_b16 a[248:249], v63 offset:24576
    v_mfma_f32_16x16x32_bf16 v[124:127], a[236:239], v[180:183], v[124:127]
    s_waitcnt lgkmcnt(3)
    ds_read_b64_tr_b16 a[250:251], v63 offset:26624
    v_mfma_f32_16x16x32_bf16 v[112:115], a[240:243], v[168:171], v[112:115]
    s_waitcnt lgkmcnt(2)
    ds_read_b64_tr_b16 a[252:253], v63 offset:28672
    v_mfma_f32_16x16x32_bf16 v[112:115], a[244:247], v[172:175], v[112:115]
    ds_read_b64_tr_b16 a[254:255], v63 offset:30720
    v_mfma_f32_16x16x32_bf16 v[120:123], a[240:243], v[184:187], v[120:123]
    ds_read_b64_tr_b16 a[192:193], v56 offset:0
    v_mfma_f32_16x16x32_bf16 v[120:123], a[244:247], v[188:191], v[120:123]
    s_waitcnt lgkmcnt(3)
    ds_read_b64_tr_b16 a[194:195], v56 offset:2048
    v_mfma_f32_16x16x32_bf16 v[116:119], a[248:251], v[168:171], v[116:119]
    s_waitcnt lgkmcnt(2)
    ds_read_b64_tr_b16 a[196:197], v56 offset:4096
    v_mfma_f32_16x16x32_bf16 v[116:119], a[252:255], v[172:175], v[116:119]
    ds_read_b64_tr_b16 a[198:199], v56 offset:6144
    v_mfma_f32_16x16x32_bf16 v[124:127], a[248:251], v[184:187], v[124:127]
    ds_read_b64_tr_b16 a[200:201], v57 offset:0
    v_mfma_f32_16x16x32_bf16 v[124:127], a[252:255], v[188:191], v[124:127]
    s_waitcnt vmcnt(27) lgkmcnt(3)
    ds_read_b64_tr_b16 a[202:203], v57 offset:2048
    v_mfma_f32_16x16x32_bf16 v[64:67], a[192:195], v[192:195], v[64:67]
    s_waitcnt vmcnt(24) lgkmcnt(2)
    ds_read_b64_tr_b16 a[204:205], v57 offset:4096
    v_mfma_f32_16x16x32_bf16 v[64:67], a[196:199], v[196:199], v[64:67]
    ds_read_b64_tr_b16 a[206:207], v57 offset:6144
    v_mfma_f32_16x16x32_bf16 v[72:75], a[192:195], v[208:211], v[72:75]
    s_waitcnt vmcnt(23) lgkmcnt(2)
    s_mov_b32 s74, 4096
    ds_read_b64_tr_b16 a[208:209], v56 offset:8192
    v_mfma_f32_16x16x32_bf16 v[72:75], a[196:199], v[212:215], v[72:75]
    buffer_load_dwordx4 v[160:163], v46, s[8:11], s74 offen
    ds_read_b64_tr_b16 a[210:211], v56 offset:10240
    v_mfma_f32_16x16x32_bf16 v[68:71], a[200:203], v[192:195], v[68:71]
    s_waitcnt lgkmcnt(2)
    ds_read_b64_tr_b16 a[212:213], v56 offset:12288
    v_mfma_f32_16x16x32_bf16 v[68:71], a[204:207], v[196:199], v[68:71]
    ds_read_b64_tr_b16 a[214:215], v56 offset:14336
    v_mfma_f32_16x16x32_bf16 v[76:79], a[200:203], v[208:211], v[76:79]
    buffer_load_dwordx4 v[164:167], v46, s[8:11], s74 offen offset:64
    ds_read_b64_tr_b16 a[216:217], v57 offset:8192
    v_mfma_f32_16x16x32_bf16 v[76:79], a[204:207], v[212:215], v[76:79]
    s_waitcnt vmcnt(24) lgkmcnt(3)
    s_mov_b32 s74, 8192
    ds_read_b64_tr_b16 a[218:219], v57 offset:10240
    v_mfma_f32_16x16x32_bf16 v[64:67], a[208:211], v[200:203], v[64:67]
    s_waitcnt vmcnt(21) lgkmcnt(2)
    ds_read_b64_tr_b16 a[220:221], v57 offset:12288
    v_mfma_f32_16x16x32_bf16 v[64:67], a[212:215], v[204:207], v[64:67]
    buffer_load_dwordx4 v[168:171], v46, s[8:11], s74 offen
    ds_read_b64_tr_b16 a[222:223], v57 offset:14336
    v_mfma_f32_16x16x32_bf16 v[72:75], a[208:211], v[216:219], v[72:75]
    s_waitcnt vmcnt(21)
    ds_read_b64_tr_b16 a[224:225], v56 offset:16384
    v_mfma_f32_16x16x32_bf16 v[72:75], a[212:215], v[220:223], v[72:75]
    s_waitcnt lgkmcnt(1)
    ds_read_b64_tr_b16 a[226:227], v56 offset:18432
    v_mfma_f32_16x16x32_bf16 v[68:71], a[216:219], v[200:203], v[68:71]
    buffer_load_dwordx4 v[172:175], v46, s[8:11], s74 offen offset:64
    ds_read_b64_tr_b16 a[228:229], v56 offset:20480
    v_mfma_f32_16x16x32_bf16 v[68:71], a[220:223], v[204:207], v[68:71]
    s_mov_b32 s74, 6144
    ds_read_b64_tr_b16 a[230:231], v56 offset:22528
    v_mfma_f32_16x16x32_bf16 v[76:79], a[216:219], v[216:219], v[76:79]
    s_waitcnt vmcnt(21) lgkmcnt(2)
    ds_read_b64_tr_b16 a[232:233], v57 offset:16384
    v_mfma_f32_16x16x32_bf16 v[76:79], a[220:223], v[220:223], v[76:79]
    buffer_load_dwordx4 v[176:179], v46, s[8:11], s74 offen
    ds_read_b64_tr_b16 a[234:235], v57 offset:18432
    v_mfma_f32_16x16x32_bf16 v[64:67], a[224:227], v[224:227], v[64:67]
    s_waitcnt vmcnt(19) lgkmcnt(2)
    ds_read_b64_tr_b16 a[236:237], v57 offset:20480
    v_mfma_f32_16x16x32_bf16 v[64:67], a[228:231], v[228:231], v[64:67]
    s_waitcnt vmcnt(18)
    ds_read_b64_tr_b16 a[238:239], v57 offset:22528
    v_mfma_f32_16x16x32_bf16 v[72:75], a[224:227], v[240:243], v[72:75]
    buffer_load_dwordx4 v[180:183], v46, s[8:11], s74 offen offset:64
    v_mfma_f32_16x16x32_bf16 v[72:75], a[228:231], v[244:247], v[72:75]
    s_waitcnt lgkmcnt(2)
    s_mov_b32 s74, 10240
    ds_read_b64_tr_b16 a[240:241], v56 offset:24576
    v_mfma_f32_16x16x32_bf16 v[68:71], a[232:235], v[224:227], v[68:71]
    s_waitcnt lgkmcnt(1)
    ds_read_b64_tr_b16 a[242:243], v56 offset:26624
    v_mfma_f32_16x16x32_bf16 v[68:71], a[236:239], v[228:231], v[68:71]
    buffer_load_dwordx4 v[184:187], v46, s[8:11], s74 offen
    ds_read_b64_tr_b16 a[244:245], v56 offset:28672
    v_mfma_f32_16x16x32_bf16 v[76:79], a[232:235], v[240:243], v[76:79]
    ds_read_b64_tr_b16 a[246:247], v56 offset:30720
    v_mfma_f32_16x16x32_bf16 v[76:79], a[236:239], v[244:247], v[76:79]
    s_waitcnt vmcnt(16) lgkmcnt(0)
    ds_read_b64_tr_b16 a[248:249], v57 offset:24576
    v_mfma_f32_16x16x32_bf16 v[64:67], a[240:243], v[232:235], v[64:67]
    buffer_load_dwordx4 v[188:191], v46, s[8:11], s74 offen offset:64
    ds_read_b64_tr_b16 a[250:251], v57 offset:26624
    v_mfma_f32_16x16x32_bf16 v[64:67], a[244:247], v[236:239], v[64:67]
    ds_read_b64_tr_b16 a[252:253], v57 offset:28672
    v_mfma_f32_16x16x32_bf16 v[72:75], a[240:243], v[248:251], v[72:75]
    s_waitcnt vmcnt(16)
    ds_read_b64_tr_b16 a[254:255], v57 offset:30720
    v_mfma_f32_16x16x32_bf16 v[72:75], a[244:247], v[252:255], v[72:75]
    s_waitcnt lgkmcnt(2)
    ds_read_b64_tr_b16 a[192:193], v58 offset:0
    v_mfma_f32_16x16x32_bf16 v[68:71], a[248:251], v[232:235], v[68:71]
    s_waitcnt lgkmcnt(1)
    ds_read_b64_tr_b16 a[194:195], v58 offset:2048
    v_mfma_f32_16x16x32_bf16 v[68:71], a[252:255], v[236:239], v[68:71]
    ds_read_b64_tr_b16 a[196:197], v58 offset:4096
    v_mfma_f32_16x16x32_bf16 v[76:79], a[248:251], v[248:251], v[76:79]
    ds_read_b64_tr_b16 a[198:199], v58 offset:6144
    v_mfma_f32_16x16x32_bf16 v[76:79], a[252:255], v[252:255], v[76:79]
    s_waitcnt lgkmcnt(2)
    ds_read_b64_tr_b16 a[200:201], v59 offset:0
    v_mfma_f32_16x16x32_bf16 v[80:83], a[192:195], v[192:195], v[80:83]
    s_waitcnt lgkmcnt(1)
    ds_read_b64_tr_b16 a[202:203], v59 offset:2048
    ds_read_b64_tr_b16 a[240:241], v58 offset:24576
    v_mfma_f32_16x16x32_bf16 v[80:83], a[196:199], v[196:199], v[80:83]
    ds_read_b64_tr_b16 a[204:205], v59 offset:4096
    ds_read_b64_tr_b16 a[242:243], v58 offset:26624
    v_mfma_f32_16x16x32_bf16 v[88:91], a[192:195], v[208:211], v[88:91]
    ds_read_b64_tr_b16 a[206:207], v59 offset:6144
    ds_read_b64_tr_b16 a[244:245], v58 offset:28672
    v_mfma_f32_16x16x32_bf16 v[88:91], a[196:199], v[212:215], v[88:91]
    s_waitcnt lgkmcnt(5)
    ds_read_b64_tr_b16 a[208:209], v58 offset:8192
    ds_read_b64_tr_b16 a[246:247], v58 offset:30720
    v_mfma_f32_16x16x32_bf16 v[84:87], a[200:203], v[192:195], v[84:87]
    s_waitcnt lgkmcnt(3)
    s_add_u32 s74, s70, 0
    ds_read_b64_tr_b16 a[210:211], v58 offset:10240
    v_mfma_f32_16x16x32_bf16 v[84:87], a[204:207], v[196:199], v[84:87]
    buffer_load_dwordx4 v[128:131], v44, s[8:11], s74 offen sc0 sc1
    ds_read_b64_tr_b16 a[212:213], v58 offset:12288
    v_mfma_f32_16x16x32_bf16 v[92:95], a[200:203], v[208:211], v[92:95]
    s_add_u32 s74, s70, 4096
    ds_read_b64_tr_b16 a[214:215], v58 offset:14336
    v_cvt_pk_bf16_f32 v64, v64, v65
    v_mfma_f32_16x16x32_bf16 v[92:95], a[204:207], v[212:215], v[92:95]
    s_waitcnt lgkmcnt(2)
    ds_read_b64_tr_b16 a[216:217], v59 offset:8192
    v_cvt_pk_bf16_f32 v65, v66, v67
    v_mfma_f32_16x16x32_bf16 v[80:83], a[208:211], v[200:203], v[80:83]
    s_waitcnt lgkmcnt(1)
    ds_read_b64_tr_b16 a[218:219], v59 offset:10240
    v_cvt_pk_bf16_f32 v66, v68, v69
    v_mfma_f32_16x16x32_bf16 v[80:83], a[212:215], v[204:207], v[80:83]
    buffer_load_dwordx4 v[132:135], v44, s[8:11], s74 offen sc0 sc1
    ds_read_b64_tr_b16 a[220:221], v59 offset:12288
    v_mfma_f32_16x16x32_bf16 v[88:91], a[208:211], v[216:219], v[88:91]
    s_add_u32 s74, s70, 8192
    ds_read_b64_tr_b16 a[222:223], v59 offset:14336
    v_cvt_pk_bf16_f32 v67, v70, v71
    v_mfma_f32_16x16x32_bf16 v[88:91], a[212:215], v[220:223], v[88:91]
    s_waitcnt lgkmcnt(2)
    ds_read_b64_tr_b16 a[224:225], v58 offset:16384
    v_min_u32 v64, -2, v64
    v_mfma_f32_16x16x32_bf16 v[84:87], a[216:219], v[200:203], v[84:87]
    s_waitcnt lgkmcnt(1)
    ds_read_b64_tr_b16 a[226:227], v58 offset:18432
    v_min_u32 v65, -2, v65
    v_mfma_f32_16x16x32_bf16 v[84:87], a[220:223], v[204:207], v[84:87]
    buffer_load_dwordx4 v[136:139], v44, s[8:11], s74 offen sc0 sc1
    ds_read_b64_tr_b16 a[228:229], v58 offset:20480
    v_mfma_f32_16x16x32_bf16 v[92:95], a[216:219], v[216:219], v[92:95]
    s_add_u32 s74, s70, 12288
    ds_read_b64_tr_b16 a[230:231], v58 offset:22528
    v_min_u32 v66, -2, v66
    v_mfma_f32_16x16x32_bf16 v[92:95], a[220:223], v[220:223], v[92:95]
    s_waitcnt lgkmcnt(2)
    ds_read_b64_tr_b16 a[232:233], v59 offset:16384
    v_min_u32 v67, -2, v67
    v_mfma_f32_16x16x32_bf16 v[80:83], a[224:227], v[224:227], v[80:83]
    s_waitcnt lgkmcnt(1)
    s_add_u32 s75, s18, 8388608
    ds_read_b64_tr_b16 a[234:235], v59 offset:18432
    v_mfma_f32_16x16x32_bf16 v[80:83], a[228:231], v[228:231], v[80:83]
    buffer_load_dwordx4 v[140:143], v44, s[8:11], s74 offen sc0 sc1
    ds_read_b64_tr_b16 a[236:237], v59 offset:20480
    v_mfma_f32_16x16x32_bf16 v[88:91], a[224:227], v[240:243], v[88:91]
    s_waitcnt lgkmcnt(1)
    s_add_u32 s74, s70, 16384
    ds_read_b64_tr_b16 a[238:239], v59 offset:22528
    v_mfma_f32_16x16x32_bf16 v[88:91], a[228:231], v[244:247], v[88:91]
    buffer_store_dwordx4 v[64:67], v23, s[8:11], s75 offen offset:0 sc0 sc1
    ds_read_b64_tr_b16 a[248:249], v59 offset:24576
    v_mfma_f32_16x16x32_bf16 v[84:87], a[232:235], v[224:227], v[84:87]
    s_waitcnt lgkmcnt(1)
    ds_read_b64_tr_b16 a[250:251], v59 offset:26624
    v_cvt_pk_bf16_f32 v72, v72, v73
    v_mfma_f32_16x16x32_bf16 v[84:87], a[236:239], v[228:231], v[84:87]
    buffer_load_dwordx4 v[144:147], v44, s[8:11], s74 offen sc0 sc1
    ds_read_b64_tr_b16 a[252:253], v59 offset:28672
    v_mfma_f32_16x16x32_bf16 v[92:95], a[232:235], v[240:243], v[92:95]
    s_add_u32 s74, s70, 20480
    ds_read_b64_tr_b16 a[254:255], v59 offset:30720
    v_cvt_pk_bf16_f32 v73, v74, v75
    v_mfma_f32_16x16x32_bf16 v[92:95], a[236:239], v[244:247], v[92:95]
    ds_read_b64_tr_b16 a[192:193], v60 offset:32768
    v_cvt_pk_bf16_f32 v74, v76, v77
    v_mfma_f32_16x16x32_bf16 v[80:83], a[240:243], v[232:235], v[80:83]
    ds_read_b64_tr_b16 a[194:195], v60 offset:34816
    v_cvt_pk_bf16_f32 v75, v78, v79
    v_mfma_f32_16x16x32_bf16 v[80:83], a[244:247], v[236:239], v[80:83]
    buffer_load_dwordx4 v[148:151], v44, s[8:11], s74 offen sc0 sc1
    v_mfma_f32_16x16x32_bf16 v[88:91], a[240:243], v[248:251], v[88:91]
    s_add_u32 s74, s70, 24576
    ds_read_b64_tr_b16 a[196:197], v60 offset:36864
    v_min_u32 v72, -2, v72
    v_mfma_f32_16x16x32_bf16 v[88:91], a[244:247], v[252:255], v[88:91]
    s_waitcnt lgkmcnt(5)
    ds_read_b64_tr_b16 a[198:199], v60 offset:38912
    v_min_u32 v73, -2, v73
    v_mfma_f32_16x16x32_bf16 v[84:87], a[248:251], v[232:235], v[84:87]
    s_waitcnt lgkmcnt(4)
    ds_read_b64_tr_b16 a[200:201], v61 offset:32768
    v_min_u32 v74, -2, v74
    v_mfma_f32_16x16x32_bf16 v[84:87], a[252:255], v[236:239], v[84:87]
    buffer_load_dwordx4 v[152:155], v44, s[8:11], s74 offen sc0 sc1
    ds_read_b64_tr_b16 a[202:203], v61 offset:34816
    v_mfma_f32_16x16x32_bf16 v[92:95], a[248:251], v[248:251], v[92:95]
    s_add_u32 s74, s70, 28672
    ds_read_b64_tr_b16 a[204:205], v61 offset:36864
    v_min_u32 v75, -2, v75
    v_mfma_f32_16x16x32_bf16 v[92:95], a[252:255], v[252:255], v[92:95]
    s_waitcnt lgkmcnt(3)
    s_add_u32 s75, s18, 8519680
    ds_read_b64_tr_b16 a[206:207], v61 offset:38912
    s_waitcnt vmcnt(18)
    v_lshlrev_b32 v48, 16, v40
    v_mfma_f32_16x16x32_bf16 v[96:99], a[192:195], v[192:195], v[96:99]
    buffer_store_dwordx4 v[72:75], v23, s[8:11], s75 offen offset:0 sc0 sc1
    v_mfma_f32_16x16x32_bf16 v[96:99], a[196:199], v[196:199], v[96:99]
    buffer_load_dwordx4 v[156:159], v44, s[8:11], s74 offen sc0 sc1
    v_mfma_f32_16x16x32_bf16 v[104:107], a[192:195], v[208:211], v[104:107]
    ds_read_b64_tr_b16 a[208:209], v60 offset:40960
    v_and_b32 v49, 0xffff0000, v40
    v_mfma_f32_16x16x32_bf16 v[104:107], a[196:199], v[212:215], v[104:107]
    s_waitcnt lgkmcnt(3)
    ds_read_b64_tr_b16 a[210:211], v60 offset:43008
    v_lshlrev_b32 v50, 16, v41
    v_mfma_f32_16x16x32_bf16 v[100:103], a[200:203], v[192:195], v[100:103]
    s_waitcnt lgkmcnt(2)
    ds_read_b64_tr_b16 a[212:213], v60 offset:45056
    v_and_b32 v51, 0xffff0000, v41
    v_mfma_f32_16x16x32_bf16 v[100:103], a[204:207], v[196:199], v[100:103]
    ds_read_b64_tr_b16 a[214:215], v60 offset:47104
    s_waitcnt vmcnt(19)
    v_lshlrev_b32 v52, 16, v42
    v_mfma_f32_16x16x32_bf16 v[108:111], a[200:203], v[208:211], v[108:111]
    ds_read_b64_tr_b16 a[216:217], v61 offset:40960
    v_cvt_pk_bf16_f32 v80, v80, v81
    v_mfma_f32_16x16x32_bf16 v[108:111], a[204:207], v[212:215], v[108:111]
    s_waitcnt lgkmcnt(3)
    ds_read_b64_tr_b16 a[218:219], v61 offset:43008
    v_cvt_pk_bf16_f32 v81, v82, v83
    v_mfma_f32_16x16x32_bf16 v[96:99], a[208:211], v[200:203], v[96:99]
    s_waitcnt lgkmcnt(2)
    ds_read_b64_tr_b16 a[220:221], v61 offset:45056
    v_cvt_pk_bf16_f32 v82, v84, v85
    v_mfma_f32_16x16x32_bf16 v[96:99], a[212:215], v[204:207], v[96:99]
    ds_read_b64_tr_b16 a[222:223], v61 offset:47104
    v_cvt_pk_bf16_f32 v83, v86, v87
    v_mfma_f32_16x16x32_bf16 v[104:107], a[208:211], v[216:219], v[104:107]
    ds_read_b64_tr_b16 a[224:225], v60 offset:49152
    v_min_u32 v80, -2, v80
    v_mfma_f32_16x16x32_bf16 v[104:107], a[212:215], v[220:223], v[104:107]
    s_waitcnt lgkmcnt(3)
    ds_read_b64_tr_b16 a[226:227], v60 offset:51200
    v_min_u32 v81, -2, v81
    v_mfma_f32_16x16x32_bf16 v[100:103], a[216:219], v[200:203], v[100:103]
    s_waitcnt lgkmcnt(2)
    ds_read_b64_tr_b16 a[228:229], v60 offset:53248
    v_min_u32 v82, -2, v82
    v_mfma_f32_16x16x32_bf16 v[100:103], a[220:223], v[204:207], v[100:103]
    ds_read_b64_tr_b16 a[230:231], v60 offset:55296
    v_min_u32 v83, -2, v83
    v_mfma_f32_16x16x32_bf16 v[108:111], a[216:219], v[216:219], v[108:111]
    s_waitcnt lgkmcnt(2)
    s_add_u32 s75, s18, 8388608
    ds_read_b64_tr_b16 a[232:233], v61 offset:49152
    v_and_b32 v53, 0xffff0000, v42
    v_mfma_f32_16x16x32_bf16 v[108:111], a[220:223], v[220:223], v[108:111]
    buffer_store_dwordx4 v[80:83], v23, s[8:11], s75 offen offset:256 sc0 sc1
    ds_read_b64_tr_b16 a[234:235], v61 offset:51200
    v_mfma_f32_16x16x32_bf16 v[96:99], a[224:227], v[224:227], v[96:99]
    s_waitcnt lgkmcnt(2)
    ds_read_b64_tr_b16 a[236:237], v61 offset:53248
    v_cvt_pk_bf16_f32 v88, v88, v89
    v_mfma_f32_16x16x32_bf16 v[96:99], a[228:231], v[228:231], v[96:99]
    ds_read_b64_tr_b16 a[238:239], v61 offset:55296
    v_cvt_pk_bf16_f32 v89, v90, v91
    v_mfma_f32_16x16x32_bf16 v[104:107], a[224:227], v[240:243], v[104:107]
    ds_read_b64_tr_b16 a[240:241], v60 offset:57344
    v_cvt_pk_bf16_f32 v90, v92, v93
    v_mfma_f32_16x16x32_bf16 v[104:107], a[228:231], v[244:247], v[104:107]
    s_waitcnt lgkmcnt(3)
    ds_read_b64_tr_b16 a[242:243], v60 offset:59392
    v_cvt_pk_bf16_f32 v91, v94, v95
    v_mfma_f32_16x16x32_bf16 v[100:103], a[232:235], v[224:227], v[100:103]
    s_waitcnt lgkmcnt(2)
    ds_read_b64_tr_b16 a[244:245], v60 offset:61440
    v_min_u32 v88, -2, v88
    v_mfma_f32_16x16x32_bf16 v[100:103], a[236:239], v[228:231], v[100:103]
    ds_read_b64_tr_b16 a[246:247], v60 offset:63488
    v_min_u32 v89, -2, v89
    v_mfma_f32_16x16x32_bf16 v[108:111], a[232:235], v[240:243], v[108:111]
    ds_read_b64_tr_b16 a[248:249], v61 offset:57344
    v_min_u32 v90, -2, v90
    v_mfma_f32_16x16x32_bf16 v[108:111], a[236:239], v[244:247], v[108:111]
    s_waitcnt lgkmcnt(3)
    ds_read_b64_tr_b16 a[250:251], v61 offset:59392
    v_min_u32 v91, -2, v91
    v_mfma_f32_16x16x32_bf16 v[96:99], a[240:243], v[232:235], v[96:99]
    s_waitcnt lgkmcnt(2)
    s_add_u32 s75, s18, 8519680
    ds_read_b64_tr_b16 a[252:253], v61 offset:61440
    v_lshlrev_b32 v54, 16, v43
    v_mfma_f32_16x16x32_bf16 v[96:99], a[244:247], v[236:239], v[96:99]
    buffer_store_dwordx4 v[88:91], v23, s[8:11], s75 offen offset:256 sc0 sc1
    ds_read_b64_tr_b16 a[254:255], v61 offset:63488
    v_mfma_f32_16x16x32_bf16 v[104:107], a[240:243], v[248:251], v[104:107]
    ds_read_b64_tr_b16 a[192:193], v62 offset:32768
    v_and_b32 v55, 0xffff0000, v43
    v_mfma_f32_16x16x32_bf16 v[104:107], a[244:247], v[252:255], v[104:107]
    s_waitcnt lgkmcnt(3)
    ds_read_b64_tr_b16 a[194:195], v62 offset:34816
    s_waitcnt vmcnt(17)
    v_mul_f32 v8, v48, v168
    v_mfma_f32_16x16x32_bf16 v[100:103], a[248:251], v[232:235], v[100:103]
    s_waitcnt lgkmcnt(2)
    ds_read_b64_tr_b16 a[196:197], v62 offset:36864
    v_mul_f32 v9, v49, v169
    v_mfma_f32_16x16x32_bf16 v[100:103], a[252:255], v[236:239], v[100:103]
    ds_read_b64_tr_b16 a[198:199], v62 offset:38912
    v_mul_f32 v10, v50, v170
    v_mfma_f32_16x16x32_bf16 v[108:111], a[248:251], v[248:251], v[108:111]
    ds_read_b64_tr_b16 a[200:201], v63 offset:32768
    v_mul_f32 v11, v51, v171
    v_mfma_f32_16x16x32_bf16 v[108:111], a[252:255], v[252:255], v[108:111]
    s_waitcnt lgkmcnt(3)
    ds_read_b64_tr_b16 a[202:203], v63 offset:34816
    s_waitcnt vmcnt(16)
    v_mul_f32 v12, v52, v172
    v_mfma_f32_16x16x32_bf16 v[112:115], a[192:195], v[192:195], v[112:115]
    s_waitcnt lgkmcnt(2)
    ds_read_b64_tr_b16 a[204:205], v63 offset:36864
    v_mul_f32 v13, v53, v173
    v_mfma_f32_16x16x32_bf16 v[112:115], a[196:199], v[196:199], v[112:115]
    ds_read_b64_tr_b16 a[206:207], v63 offset:38912
    v_mul_f32 v14, v54, v174
    v_mfma_f32_16x16x32_bf16 v[120:123], a[192:195], v[208:211], v[120:123]
    ds_read_b64_tr_b16 a[208:209], v62 offset:40960
    v_mul_f32 v15, v55, v175
    v_mfma_f32_16x16x32_bf16 v[120:123], a[196:199], v[212:215], v[120:123]
    s_waitcnt lgkmcnt(3)
    ds_read_b64_tr_b16 a[210:211], v62 offset:43008
    s_waitcnt vmcnt(15)
    v_mul_f32 v16, v48, v176
    v_mfma_f32_16x16x32_bf16 v[116:119], a[200:203], v[192:195], v[116:119]
    s_waitcnt lgkmcnt(2)
    ds_read_b64_tr_b16 a[212:213], v62 offset:45056
    v_fmac_f32 v16, v49, v177
    v_mfma_f32_16x16x32_bf16 v[116:119], a[204:207], v[196:199], v[116:119]
    ds_read_b64_tr_b16 a[214:215], v62 offset:47104
    v_fmac_f32 v16, v50, v178
    v_mfma_f32_16x16x32_bf16 v[124:127], a[200:203], v[208:211], v[124:127]
    ds_read_b64_tr_b16 a[216:217], v63 offset:40960
    v_cvt_pk_bf16_f32 v96, v96, v97
    v_mfma_f32_16x16x32_bf16 v[124:127], a[204:207], v[212:215], v[124:127]
    s_waitcnt lgkmcnt(3)
    ds_read_b64_tr_b16 a[218:219], v63 offset:43008
    v_cvt_pk_bf16_f32 v97, v98, v99
    v_mfma_f32_16x16x32_bf16 v[112:115], a[208:211], v[200:203], v[112:115]
    s_waitcnt lgkmcnt(2)
    ds_read_b64_tr_b16 a[220:221], v63 offset:45056
    v_cvt_pk_bf16_f32 v98, v100, v101
    v_mfma_f32_16x16x32_bf16 v[112:115], a[212:215], v[204:207], v[112:115]
    ds_read_b64_tr_b16 a[222:223], v63 offset:47104
    v_cvt_pk_bf16_f32 v99, v102, v103
    v_mfma_f32_16x16x32_bf16 v[120:123], a[208:211], v[216:219], v[120:123]
    ds_read_b64_tr_b16 a[224:225], v62 offset:49152
    v_min_u32 v96, -2, v96
    v_mfma_f32_16x16x32_bf16 v[120:123], a[212:215], v[220:223], v[120:123]
    s_waitcnt lgkmcnt(3)
    ds_read_b64_tr_b16 a[226:227], v62 offset:51200
    v_min_u32 v97, -2, v97
    v_mfma_f32_16x16x32_bf16 v[116:119], a[216:219], v[200:203], v[116:119]
    s_waitcnt lgkmcnt(2)
    ds_read_b64_tr_b16 a[228:229], v62 offset:53248
    v_min_u32 v98, -2, v98
    v_mfma_f32_16x16x32_bf16 v[116:119], a[220:223], v[204:207], v[116:119]
    ds_read_b64_tr_b16 a[230:231], v62 offset:55296
    v_min_u32 v99, -2, v99
    v_mfma_f32_16x16x32_bf16 v[124:127], a[216:219], v[216:219], v[124:127]
    s_waitcnt lgkmcnt(2)
    s_add_u32 s75, s18, 8388608
    ds_read_b64_tr_b16 a[232:233], v63 offset:49152
    v_fmac_f32 v16, v51, v179
    v_mfma_f32_16x16x32_bf16 v[124:127], a[220:223], v[220:223], v[124:127]
    buffer_store_dwordx4 v[96:99], v23, s[8:11], s75 offen offset:512 sc0 sc1
    ds_read_b64_tr_b16 a[234:235], v63 offset:51200
    v_mfma_f32_16x16x32_bf16 v[112:115], a[224:227], v[224:227], v[112:115]
    s_waitcnt lgkmcnt(2)
    ds_read_b64_tr_b16 a[236:237], v63 offset:53248
    v_cvt_pk_bf16_f32 v104, v104, v105
    v_mfma_f32_16x16x32_bf16 v[112:115], a[228:231], v[228:231], v[112:115]
    ds_read_b64_tr_b16 a[238:239], v63 offset:55296
    v_cvt_pk_bf16_f32 v105, v106, v107
    v_mfma_f32_16x16x32_bf16 v[120:123], a[224:227], v[240:243], v[120:123]
    ds_read_b64_tr_b16 a[240:241], v62 offset:57344
    v_cvt_pk_bf16_f32 v106, v108, v109
    v_mfma_f32_16x16x32_bf16 v[120:123], a[228:231], v[244:247], v[120:123]
    s_waitcnt lgkmcnt(3)
    ds_read_b64_tr_b16 a[242:243], v62 offset:59392
    v_cvt_pk_bf16_f32 v107, v110, v111
    v_mfma_f32_16x16x32_bf16 v[116:119], a[232:235], v[224:227], v[116:119]
    s_waitcnt lgkmcnt(2)
    ds_read_b64_tr_b16 a[244:245], v62 offset:61440
    v_min_u32 v104, -2, v104
    v_mfma_f32_16x16x32_bf16 v[116:119], a[236:239], v[228:231], v[116:119]
    ds_read_b64_tr_b16 a[246:247], v62 offset:63488
    v_min_u32 v105, -2, v105
    v_mfma_f32_16x16x32_bf16 v[124:127], a[232:235], v[240:243], v[124:127]
    ds_read_b64_tr_b16 a[248:249], v63 offset:57344
    v_min_u32 v106, -2, v106
    v_mfma_f32_16x16x32_bf16 v[124:127], a[236:239], v[244:247], v[124:127]
    s_waitcnt lgkmcnt(3)
    ds_read_b64_tr_b16 a[250:251], v63 offset:59392
    v_min_u32 v107, -2, v107
    v_mfma_f32_16x16x32_bf16 v[112:115], a[240:243], v[232:235], v[112:115]
    s_waitcnt lgkmcnt(2)
    s_add_u32 s75, s18, 8519680
    ds_read_b64_tr_b16 a[252:253], v63 offset:61440
    s_waitcnt vmcnt(15)
    v_fmac_f32 v16, v52, v180
    v_mfma_f32_16x16x32_bf16 v[112:115], a[244:247], v[236:239], v[112:115]
    buffer_store_dwordx4 v[104:107], v23, s[8:11], s75 offen offset:512 sc0 sc1
    ds_read_b64_tr_b16 a[254:255], v63 offset:63488
    v_mfma_f32_16x16x32_bf16 v[120:123], a[240:243], v[248:251], v[120:123]
    v_fmac_f32 v16, v53, v181
    v_mfma_f32_16x16x32_bf16 v[120:123], a[244:247], v[252:255], v[120:123]
    s_waitcnt lgkmcnt(2)
    v_fmac_f32 v16, v54, v182
    v_mfma_f32_16x16x32_bf16 v[116:119], a[248:251], v[232:235], v[116:119]
    s_waitcnt lgkmcnt(0)
    v_fmac_f32 v16, v55, v183
    v_mfma_f32_16x16x32_bf16 v[116:119], a[252:255], v[236:239], v[116:119]
    s_nop 0
    v_add_f32_dpp v16, v16, v16 quad_perm:[1,0,3,2] row_mask:0xf bank_mask:0xf
    v_mfma_f32_16x16x32_bf16 v[124:127], a[248:251], v[248:251], v[124:127]
    s_nop 0
    v_add_f32_dpp v16, v16, v16 quad_perm:[2,3,0,1] row_mask:0xf bank_mask:0xf
    v_mfma_f32_16x16x32_bf16 v[124:127], a[252:255], v[252:255], v[124:127]
    s_nop 0
    v_add_f32_dpp v16, v16, v16 row_half_mirror row_mask:0xf bank_mask:0xf
    s_nop 1
    v_add_f32_dpp v16, v16, v16 row_mirror row_mask:0xf bank_mask:0xf
    v_mov_b32 v19, v16
    s_nop 1
    v_permlane16_swap_b32 v16, v19
    v_add_f32 v16, v16, v19
    v_mov_b32 v19, v16
    s_nop 1
    v_permlane32_swap_b32 v16, v19
    v_add_f32 v16, v16, v19
    v_cvt_pk_bf16_f32 v112, v112, v113
    v_cvt_pk_bf16_f32 v113, v114, v115
    v_cvt_pk_bf16_f32 v114, v116, v117
    v_cvt_pk_bf16_f32 v115, v118, v119
    v_min_u32 v112, -2, v112
    v_min_u32 v113, -2, v113
    v_min_u32 v114, -2, v114
    v_min_u32 v115, -2, v115
    s_add_u32 s75, s18, 8388608
    buffer_store_dwordx4 v[112:115], v23, s[8:11], s75 offen offset:768 sc0 sc1
    v_cvt_pk_bf16_f32 v120, v120, v121
    v_cvt_pk_bf16_f32 v121, v122, v123
    v_cvt_pk_bf16_f32 v122, v124, v125
    v_cvt_pk_bf16_f32 v123, v126, v127
    v_min_u32 v120, -2, v120
    v_min_u32 v121, -2, v121
    v_min_u32 v122, -2, v122
    v_min_u32 v123, -2, v123
    s_add_u32 s75, s18, 8519680
    buffer_store_dwordx4 v[120:123], v23, s[8:11], s75 offen offset:768 sc0 sc1
    s_add_u32 s74, s70, 8388608
    buffer_load_dwordx4 v[192:195], v44, s[8:11], s74 offen sc0 sc1
    s_add_u32 s74, s70, 8392704
    buffer_load_dwordx4 v[196:199], v44, s[8:11], s74 offen sc0 sc1
    s_add_u32 s74, s70, 8396800
    buffer_load_dwordx4 v[200:203], v44, s[8:11], s74 offen sc0 sc1
    s_add_u32 s74, s70, 8400896
    buffer_load_dwordx4 v[204:207], v44, s[8:11], s74 offen sc0 sc1
    s_add_u32 s74, s70, 8404992
    buffer_load_dwordx4 v[208:211], v44, s[8:11], s74 offen sc0 sc1
    s_add_u32 s74, s70, 8409088
    buffer_load_dwordx4 v[212:215], v44, s[8:11], s74 offen sc0 sc1
    s_add_u32 s74, s70, 8413184
    buffer_load_dwordx4 v[216:219], v44, s[8:11], s74 offen sc0 sc1
    s_add_u32 s74, s70, 8417280
    buffer_load_dwordx4 v[220:223], v44, s[8:11], s74 offen sc0 sc1
    v_mov_b32 v100, 0x3f80
    v_mov_b32 v101, 0x3f800000
    v_lshlrev_b32 v72, 16, v32
    v_and_b32 v73, 0xffff0000, v32
    v_lshlrev_b32 v74, 16, v33
    v_and_b32 v75, 0xffff0000, v33
    v_lshlrev_b32 v76, 16, v34
    v_and_b32 v77, 0xffff0000, v34
    v_lshlrev_b32 v78, 16, v35
    v_and_b32 v79, 0xffff0000, v35
    v_lshlrev_b32 v88, 16, v36
    v_and_b32 v89, 0xffff0000, v36
    v_lshlrev_b32 v90, 16, v37
    v_and_b32 v91, 0xffff0000, v37
    v_lshlrev_b32 v92, 16, v38
    v_and_b32 v93, 0xffff0000, v38
    v_lshlrev_b32 v94, 16, v39
    v_and_b32 v95, 0xffff0000, v39
    s_waitcnt vmcnt(23)
    v_max_u32 v3, v128, v129
    v_max3_u32 v3, v3, v130, v131
    s_waitcnt vmcnt(22)
    v_max3_u32 v3, v3, v132, v133
    v_max3_u32 v3, v3, v134, v135
    s_waitcnt vmcnt(21)
    v_max3_u32 v3, v3, v136, v137
    v_max3_u32 v3, v3, v138, v139
    s_waitcnt vmcnt(20)
    v_max3_u32 v3, v3, v140, v141
    v_max3_u32 v3, v3, v142, v143
    s_waitcnt vmcnt(18)
    v_max3_u32 v3, v3, v144, v145
    v_max3_u32 v3, v3, v146, v147
    s_waitcnt vmcnt(17)
    v_max3_u32 v3, v3, v148, v149
    v_max3_u32 v3, v3, v150, v151
    s_waitcnt vmcnt(16)
    v_max3_u32 v3, v3, v152, v153
    v_max3_u32 v3, v3, v154, v155
    s_waitcnt vmcnt(14)
    v_max3_u32 v3, v3, v156, v157
    v_max3_u32 v3, v3, v158, v159
    v_cmp_eq_u32 vcc, -1, v3
    s_cbranch_vccnz L_P1_slow_15
L_P1_ok_16:
    v_lshlrev_b32 v64, 16, v128
    v_and_b32 v65, 0xffff0000, v128
    v_lshlrev_b32 v66, 16, v129
    v_and_b32 v67, 0xffff0000, v129
    v_lshlrev_b32 v68, 16, v130
    v_and_b32 v69, 0xffff0000, v130
    v_lshlrev_b32 v70, 16, v131
    v_and_b32 v71, 0xffff0000, v131
    v_dot2c_f32_bf16 v64, v132, v100
    v_dot2c_f32_bf16 v65, v132, v101
    v_dot2c_f32_bf16 v66, v133, v100
    v_dot2c_f32_bf16 v67, v133, v101
    v_dot2c_f32_bf16 v68, v134, v100
    v_dot2c_f32_bf16 v69, v134, v101
    v_dot2c_f32_bf16 v70, v135, v100
    v_dot2c_f32_bf16 v71, v135, v101
    v_dot2c_f32_bf16 v64, v136, v100
    v_dot2c_f32_bf16 v65, v136, v101
    v_dot2c_f32_bf16 v66, v137, v100
    v_dot2c_f32_bf16 v67, v137, v101
    v_dot2c_f32_bf16 v68, v138, v100
    v_dot2c_f32_bf16 v69, v138, v101
    v_dot2c_f32_bf16 v70, v139, v100
    v_dot2c_f32_bf16 v71, v139, v101
    v_dot2c_f32_bf16 v64, v140, v100
    v_dot2c_f32_bf16 v65, v140, v101
    v_dot2c_f32_bf16 v66, v141, v100
    v_dot2c_f32_bf16 v67, v141, v101
    v_dot2c_f32_bf16 v68, v142, v100
    v_dot2c_f32_bf16 v69, v142, v101
    v_dot2c_f32_bf16 v70, v143, v100
    v_dot2c_f32_bf16 v71, v143, v101
    v_dot2c_f32_bf16 v64, v144, v100
    v_dot2c_f32_bf16 v65, v144, v101
    v_dot2c_f32_bf16 v66, v145, v100
    v_dot2c_f32_bf16 v67, v145, v101
    v_dot2c_f32_bf16 v68, v146, v100
    v_dot2c_f32_bf16 v69, v146, v101
    v_dot2c_f32_bf16 v70, v147, v100
    v_dot2c_f32_bf16 v71, v147, v101
    v_dot2c_f32_bf16 v64, v148, v100
    v_dot2c_f32_bf16 v65, v148, v101
    v_dot2c_f32_bf16 v66, v149, v100
    v_dot2c_f32_bf16 v67, v149, v101
    v_dot2c_f32_bf16 v68, v150, v100
    v_dot2c_f32_bf16 v69, v150, v101
    v_dot2c_f32_bf16 v70, v151, v100
    v_dot2c_f32_bf16 v71, v151, v101
    v_dot2c_f32_bf16 v64, v152, v100
    v_dot2c_f32_bf16 v65, v152, v101
    v_dot2c_f32_bf16 v66, v153, v100
    v_dot2c_f32_bf16 v67, v153, v101
    v_dot2c_f32_bf16 v68, v154, v100
    v_dot2c_f32_bf16 v69, v154, v101
    v_dot2c_f32_bf16 v70, v155, v100
    v_dot2c_f32_bf16 v71, v155, v101
    v_dot2c_f32_bf16 v64, v156, v100
    v_dot2c_f32_bf16 v65, v156, v101
    v_dot2c_f32_bf16 v66, v157, v100
    v_dot2c_f32_bf16 v67, v157, v101
    v_dot2c_f32_bf16 v68, v158, v100
    v_dot2c_f32_bf16 v69, v158, v101
    v_dot2c_f32_bf16 v70, v159, v100
    v_dot2c_f32_bf16 v71, v159, v101
    v_pk_fma_f32 v[64:65], v[64:65], v[160:161], v[72:73]
    v_pk_fma_f32 v[66:67], v[66:67], v[162:163], v[74:75]
    v_pk_fma_f32 v[68:69], v[68:69], v[164:165], v[76:77]
    v_pk_fma_f32 v[70:71], v[70:71], v[166:167], v[78:79]
    v_cvt_pk_bf16_f32 v32, v64, v65
    v_cvt_pk_bf16_f32 v33, v66, v67
    v_cvt_pk_bf16_f32 v34, v68, v69
    v_cvt_pk_bf16_f32 v35, v70, v71
    v_lshlrev_b32 v64, 16, v32
    v_and_b32 v65, 0xffff0000, v32
    v_lshlrev_b32 v66, 16, v33
    v_and_b32 v67, 0xffff0000, v33
    v_lshlrev_b32 v68, 16, v34
    v_and_b32 v69, 0xffff0000, v34
    v_lshlrev_b32 v70, 16, v35
    v_and_b32 v71, 0xffff0000, v35
    v_pk_add_f32 v[48:49], v[64:65], v[66:67]
    v_pk_add_f32 v[50:51], v[68:69], v[70:71]
    v_pk_add_f32 v[48:49], v[48:49], v[50:51]
    v_add_f32 v48, v48, v49
    s_nop 1
    v_add_f32_dpp v48, v48, v48 quad_perm:[1,0,3,2] row_mask:0xf bank_mask:0xf
    s_nop 1
    v_add_f32_dpp v48, v48, v48 quad_perm:[2,3,0,1] row_mask:0xf bank_mask:0xf
    s_nop 1
    v_add_f32_dpp v48, v48, v48 row_half_mirror row_mask:0xf bank_mask:0xf
    s_nop 1
    v_add_f32_dpp v48, v48, v48 row_mirror row_mask:0xf bank_mask:0xf
    v_mov_b32 v49, v48
    s_nop 1
    v_permlane16_swap_b32 v48, v49
    v_add_f32 v48, v48, v49
    v_mov_b32 v49, v48
    s_nop 1
    v_permlane32_swap_b32 v48, v49
    v_add_f32 v48, v48, v49
    v_mul_f32 v48, 0xbb000000, v48
    v_pk_add_f32 v[72:73], v[64:65], v[48:49] op_sel_hi:[1,0]
    v_pk_add_f32 v[74:75], v[66:67], v[48:49] op_sel_hi:[1,0]
    v_pk_add_f32 v[76:77], v[68:69], v[48:49] op_sel_hi:[1,0]
    v_pk_add_f32 v[78:79], v[70:71], v[48:49] op_sel_hi:[1,0]
    v_pk_mul_f32 v[50:51], v[72:73], v[72:73]
    v_pk_mul_f32 v[52:53], v[72:73], v[8:9]
    v_pk_fma_f32 v[50:51], v[74:75], v[74:75], v[50:51]
    v_pk_fma_f32 v[52:53], v[74:75], v[10:11], v[52:53]
    v_pk_fma_f32 v[50:51], v[76:77], v[76:77], v[50:51]
    v_pk_fma_f32 v[52:53], v[76:77], v[12:13], v[52:53]
    v_pk_fma_f32 v[50:51], v[78:79], v[78:79], v[50:51]
    v_pk_fma_f32 v[52:53], v[78:79], v[14:15], v[52:53]
    v_add_f32 v50, v50, v51
    v_add_f32 v52, v52, v53
    s_nop 0
    v_add_f32_dpp v50, v50, v50 quad_perm:[1,0,3,2] row_mask:0xf bank_mask:0xf
    v_add_f32_dpp v52, v52, v52 quad_perm:[1,0,3,2] row_mask:0xf bank_mask:0xf
    s_nop 0
    v_add_f32_dpp v50, v50, v50 quad_perm:[2,3,0,1] row_mask:0xf bank_mask:0xf
    v_add_f32_dpp v52, v52, v52 quad_perm:[2,3,0,1] row_mask:0xf bank_mask:0xf
    s_nop 0
    v_add_f32_dpp v50, v50, v50 row_half_mirror row_mask:0xf bank_mask:0xf
    v_add_f32_dpp v52, v52, v52 row_half_mirror row_mask:0xf bank_mask:0xf
    s_nop 0
    v_add_f32_dpp v50, v50, v50 row_mirror row_mask:0xf bank_mask:0xf
    v_add_f32_dpp v52, v52, v52 row_mirror row_mask:0xf bank_mask:0xf
    v_mov_b32 v51, v50
    v_mov_b32 v53, v52
    s_nop 0
    v_permlane16_swap_b32 v50, v51
    v_permlane16_swap_b32 v52, v53
    v_add_f32 v50, v50, v51
    v_add_f32 v52, v52, v53
    v_mov_b32 v51, v50
    v_mov_b32 v53, v52
    s_nop 0
    v_permlane32_swap_b32 v50, v51
    v_permlane32_swap_b32 v52, v53
    v_add_f32 v50, v50, v51
    v_add_f32 v52, v52, v53
    v_mov_b32 v48, 0x3727c5ac
    v_fmac_f32 v48, 0x3b000000, v50
    v_rsq_f32 v48, v48
    s_nop 0
    v_fma_f32 v52, v52, v48, v16
    v_ashrrev_i32 v53, 31, v52
    v_or_b32 v53, 0x80000000, v53
    v_xor_b32 v53, v53, v52
    v_and_b32 v53, 0xfffff800, v53
    v_or_b32 v17, s68, v53
    v_pk_mul_f32 v[72:73], v[72:73], v[48:49] op_sel_hi:[1,0]
    v_pk_mul_f32 v[74:75], v[74:75], v[48:49] op_sel_hi:[1,0]
    v_pk_mul_f32 v[76:77], v[76:77], v[48:49] op_sel_hi:[1,0]
    v_pk_mul_f32 v[78:79], v[78:79], v[48:49] op_sel_hi:[1,0]
    v_pk_fma_f32 v[72:73], v[72:73], v[168:169], v[176:177]
    v_pk_fma_f32 v[74:75], v[74:75], v[170:171], v[178:179]
    v_pk_fma_f32 v[76:77], v[76:77], v[172:173], v[180:181]
    v_pk_fma_f32 v[78:79], v[78:79], v[174:175], v[182:183]
    v_cvt_pk_bf16_f32 v20, v72, v73
    v_cvt_pk_bf16_f32 v21, v74, v75
    v_cvt_pk_bf16_f32 v22, v76, v77
    v_cvt_pk_bf16_f32 v23, v78, v79
    v_lshlrev_b32 v98, 4, v0
    v_cmp_gt_u32 vcc, 224, v0
    v_mov_b32 v99, 2147479552
    s_nop 0
    v_cndmask_b32 v99, v99, v98, vcc
    s_lshl_b32 s17, s66, 13
    s_add_u32 s17, s17, 4194304
    s_cmp_lt_u32 s66, 224
    s_cselect_b32 s17, s17, 2143285248
    s_lshl_b32 s100, s3, 2
    v_mov_b32 v47, s100
    v_mov_b32 v102, 0
    s_lshl_b32 s100, s2, 6
    s_add_u32 s100, s100, 65536
    s_lshl_b32 s101, s2, 11
    s_add_u32 s101, s101, 524288
    s_mov_b32 s99, 0
L_P2_l_17:
    s_waitcnt vmcnt(0)
    v_max_u32 v48, v192, v193
    v_max3_u32 v48, v48, v194, v195
    v_max_u32 v49, v196, v197
    v_max3_u32 v49, v49, v198, v199
    v_max_u32 v50, v200, v201
    v_max3_u32 v50, v50, v202, v203
    v_max_u32 v51, v204, v205
    v_max3_u32 v51, v51, v206, v207
    v_max_u32 v52, v208, v209
    v_max3_u32 v52, v52, v210, v211
    v_max_u32 v53, v212, v213
    v_max3_u32 v53, v53, v214, v215
    v_max_u32 v54, v216, v217
    v_max3_u32 v54, v54, v218, v219
    v_max_u32 v55, v220, v221
    v_max3_u32 v55, v55, v222, v223
    v_max3_u32 v3, v48, v49, v50
    v_max3_u32 v3, v3, v51, v52
    v_max3_u32 v3, v3, v53, v54
    v_max_u32 v3, v3, v55
    v_cmp_eq_u32 vcc, -1, v3
    s_add_u32 s99, s99, 1
    s_cbranch_vccz L_P2_ok_18
    s_cmp_ge_u32 s99, 200000
    s_cbranch_scc1 L_P2_ok_18
    s_sleep 1
    v_cmp_eq_u32 vcc, -1, v48
    s_cbranch_vccz L_P2_s_19
    s_mov_b64 exec, vcc
    s_add_u32 s74, s70, 8388608
    buffer_load_dwordx4 v[192:195], v44, s[8:11], s74 offen sc0 sc1
    s_mov_b64 exec, -1
L_P2_s_19:
    v_cmp_eq_u32 vcc, -1, v49
    s_cbranch_vccz L_P2_s_20
    s_mov_b64 exec, vcc
    s_add_u32 s74, s70, 8392704
    buffer_load_dwordx4 v[196:199], v44, s[8:11], s74 offen sc0 sc1
    s_mov_b64 exec, -1
L_P2_s_20:
    v_cmp_eq_u32 vcc, -1, v50
    s_cbranch_vccz L_P2_s_21
    s_mov_b64 exec, vcc
    s_add_u32 s74, s70, 8396800
    buffer_load_dwordx4 v[200:203], v44, s[8:11], s74 offen sc0 sc1
    s_mov_b64 exec, -1
L_P2_s_21:
    v_cmp_eq_u32 vcc, -1, v51
    s_cbranch_vccz L_P2_s_22
    s_mov_b64 exec, vcc
    s_add_u32 s74, s70, 8400896
    buffer_load_dwordx4 v[204:207], v44, s[8:11], s74 offen sc0 sc1
    s_mov_b64 exec, -1
L_P2_s_22:
    v_cmp_eq_u32 vcc, -1, v52
    s_cbranch_vccz L_P2_s_23
    s_mov_b64 exec, vcc
    s_add_u32 s74, s70, 8404992
    buffer_load_dwordx4 v[208:211], v44, s[8:11], s74 offen sc0 sc1
    s_mov_b64 exec, -1
L_P2_s_23:
    v_cmp_eq_u32 vcc, -1, v53
    s_cbranch_vccz L_P2_s_24
    s_mov_b64 exec, vcc
    s_add_u32 s74, s70, 8409088
    buffer_load_dwordx4 v[212:215], v44, s[8:11], s74 offen sc0 sc1
    s_mov_b64 exec, -1
L_P2_s_24:
    v_cmp_eq_u32 vcc, -1, v54
    s_cbranch_vccz L_P2_s_25
    s_mov_b64 exec, vcc
    s_add_u32 s74, s70, 8413184
    buffer_load_dwordx4 v[216:219], v44, s[8:11], s74 offen sc0 sc1
    s_mov_b64 exec, -1
L_P2_s_25:
    v_cmp_eq_u32 vcc, -1, v55
    s_cbranch_vccz L_P2_s_26
    s_mov_b64 exec, vcc
    s_add_u32 s74, s70, 8417280
    buffer_load_dwordx4 v[220:223], v44, s[8:11], s74 offen sc0 sc1
    s_mov_b64 exec, -1
L_P2_s_26:
    s_branch L_P2_l_17
L_P2_ok_18:
    v_lshlrev_b32 v80, 16, v192
    v_and_b32 v81, 0xffff0000, v192
    v_lshlrev_b32 v82, 16, v193
    v_and_b32 v83, 0xffff0000, v193
    v_lshlrev_b32 v84, 16, v194
    v_and_b32 v85, 0xffff0000, v194
    v_lshlrev_b32 v86, 16, v195
    v_and_b32 v87, 0xffff0000, v195
    v_dot2c_f32_bf16 v80, v196, v100
    v_dot2c_f32_bf16 v81, v196, v101
    v_dot2c_f32_bf16 v82, v197, v100
    v_dot2c_f32_bf16 v83, v197, v101
    v_dot2c_f32_bf16 v84, v198, v100
    v_dot2c_f32_bf16 v85, v198, v101
    v_dot2c_f32_bf16 v86, v199, v100
    v_dot2c_f32_bf16 v87, v199, v101
    v_dot2c_f32_bf16 v80, v200, v100
    v_dot2c_f32_bf16 v81, v200, v101
    v_dot2c_f32_bf16 v82, v201, v100
    v_dot2c_f32_bf16 v83, v201, v101
    v_dot2c_f32_bf16 v84, v202, v100
    v_dot2c_f32_bf16 v85, v202, v101
    v_dot2c_f32_bf16 v86, v203, v100
    v_dot2c_f32_bf16 v87, v203, v101
    v_dot2c_f32_bf16 v80, v204, v100
    v_dot2c_f32_bf16 v81, v204, v101
    v_dot2c_f32_bf16 v82, v205, v100
    v_dot2c_f32_bf16 v83, v205, v101
    v_dot2c_f32_bf16 v84, v206, v100
    v_dot2c_f32_bf16 v85, v206, v101
    v_dot2c_f32_bf16 v86, v207, v100
    v_dot2c_f32_bf16 v87, v207, v101
    v_dot2c_f32_bf16 v80, v208, v100
    v_dot2c_f32_bf16 v81, v208, v101
    v_dot2c_f32_bf16 v82, v209, v100
    v_dot2c_f32_bf16 v83, v209, v101
    v_dot2c_f32_bf16 v84, v210, v100
    v_dot2c_f32_bf16 v85, v210, v101
    v_dot2c_f32_bf16 v86, v211, v100
    v_dot2c_f32_bf16 v87, v211, v101
    v_dot2c_f32_bf16 v80, v212, v100
    v_dot2c_f32_bf16 v81, v212, v101
    v_dot2c_f32_bf16 v82, v213, v100
    v_dot2c_f32_bf16 v83, v213, v101
    v_dot2c_f32_bf16 v84, v214, v100
    v_dot2c_f32_bf16 v85, v214, v101
    v_dot2c_f32_bf16 v86, v215, v100
    v_dot2c_f32_bf16 v87, v215, v101
    v_dot2c_f32_bf16 v80, v216, v100
    v_dot2c_f32_bf16 v81, v216, v101
    v_dot2c_f32_bf16 v82, v217, v100
    v_dot2c_f32_bf16 v83, v217, v101
    v_dot2c_f32_bf16 v84, v218, v100
    v_dot2c_f32_bf16 v85, v218, v101
    v_dot2c_f32_bf16 v86, v219, v100
    v_dot2c_f32_bf16 v87, v219, v101
    v_dot2c_f32_bf16 v80, v220, v100
    v_dot2c_f32_bf16 v81, v220, v101
    v_dot2c_f32_bf16 v82, v221, v100
    v_dot2c_f32_bf16 v83, v221, v101
    v_dot2c_f32_bf16 v84, v222, v100
    v_dot2c_f32_bf16 v85, v222, v101
    v_dot2c_f32_bf16 v86, v223, v100
    v_dot2c_f32_bf16 v87, v223, v101
    v_pk_fma_f32 v[80:81], v[80:81], v[160:161], v[88:89]
    v_pk_fma_f32 v[82:83], v[82:83], v[162:163], v[90:91]
    v_pk_fma_f32 v[84:85], v[84:85], v[164:165], v[92:93]
    v_pk_fma_f32 v[86:87], v[86:87], v[166:167], v[94:95]
    v_cvt_pk_bf16_f32 v36, v80, v81
    v_cvt_pk_bf16_f32 v37, v82, v83
    v_cvt_pk_bf16_f32 v38, v84, v85
    v_cvt_pk_bf16_f32 v39, v86, v87
    v_lshlrev_b32 v80, 16, v36
    v_and_b32 v81, 0xffff0000, v36
    v_lshlrev_b32 v82, 16, v37
    v_and_b32 v83, 0xffff0000, v37
    v_lshlrev_b32 v84, 16, v38
    v_and_b32 v85, 0xffff0000, v38
    v_lshlrev_b32 v86, 16, v39
    v_and_b32 v87, 0xffff0000, v39
    v_pk_add_f32 v[48:49], v[80:81], v[82:83]
    v_pk_add_f32 v[50:51], v[84:85], v[86:87]
    v_pk_add_f32 v[48:49], v[48:49], v[50:51]
    v_add_f32 v48, v48, v49
    s_nop 1
    v_add_f32_dpp v48, v48, v48 quad_perm:[1,0,3,2] row_mask:0xf bank_mask:0xf
    s_nop 1
    v_add_f32_dpp v48, v48, v48 quad_perm:[2,3,0,1] row_mask:0xf bank_mask:0xf
    s_nop 1
    v_add_f32_dpp v48, v48, v48 row_half_mirror row_mask:0xf bank_mask:0xf
    s_nop 1
    v_add_f32_dpp v48, v48, v48 row_mirror row_mask:0xf bank_mask:0xf
    v_mov_b32 v49, v48
    s_nop 1
    v_permlane16_swap_b32 v48, v49
    v_add_f32 v48, v48, v49
    v_mov_b32 v49, v48
    s_nop 1
    v_permlane32_swap_b32 v48, v49
    v_add_f32 v48, v48, v49
    v_mul_f32 v48, 0xbb000000, v48
    v_pk_add_f32 v[88:89], v[80:81], v[48:49] op_sel_hi:[1,0]
    v_pk_add_f32 v[90:91], v[82:83], v[48:49] op_sel_hi:[1,0]
    v_pk_add_f32 v[92:93], v[84:85], v[48:49] op_sel_hi:[1,0]
    v_pk_add_f32 v[94:95], v[86:87], v[48:49] op_sel_hi:[1,0]
    v_pk_mul_f32 v[50:51], v[88:89], v[88:89]
    v_pk_mul_f32 v[52:53], v[88:89], v[8:9]
    v_pk_fma_f32 v[50:51], v[90:91], v[90:91], v[50:51]
    v_pk_fma_f32 v[52:53], v[90:91], v[10:11], v[52:53]
    v_pk_fma_f32 v[50:51], v[92:93], v[92:93], v[50:51]
    v_pk_fma_f32 v[52:53], v[92:93], v[12:13], v[52:53]
    v_pk_fma_f32 v[50:51], v[94:95], v[94:95], v[50:51]
    v_pk_fma_f32 v[52:53], v[94:95], v[14:15], v[52:53]
    v_add_f32 v50, v50, v51
    v_add_f32 v52, v52, v53
    s_nop 0
    v_add_f32_dpp v50, v50, v50 quad_perm:[1,0,3,2] row_mask:0xf bank_mask:0xf
    v_add_f32_dpp v52, v52, v52 quad_perm:[1,0,3,2] row_mask:0xf bank_mask:0xf
    s_nop 0
    v_add_f32_dpp v50, v50, v50 quad_perm:[2,3,0,1] row_mask:0xf bank_mask:0xf
    v_add_f32_dpp v52, v52, v52 quad_perm:[2,3,0,1] row_mask:0xf bank_mask:0xf
    s_nop 0
    v_add_f32_dpp v50, v50, v50 row_half_mirror row_mask:0xf bank_mask:0xf
    v_add_f32_dpp v52, v52, v52 row_half_mirror row_mask:0xf bank_mask:0xf
    s_nop 0
    v_add_f32_dpp v50, v50, v50 row_mirror row_mask:0xf bank_mask:0xf
    v_add_f32_dpp v52, v52, v52 row_mirror row_mask:0xf bank_mask:0xf
    v_mov_b32 v51, v50
    v_mov_b32 v53, v52
    s_nop 0
    v_permlane16_swap_b32 v50, v51
    v_permlane16_swap_b32 v52, v53
    v_add_f32 v50, v50, v51
    v_add_f32 v52, v52, v53
    v_mov_b32 v51, v50
    v_mov_b32 v53, v52
    s_nop 0
    v_permlane32_swap_b32 v50, v51
    v_permlane32_swap_b32 v52, v53
    v_add_f32 v50, v50, v51
    v_add_f32 v52, v52, v53
    v_mov_b32 v48, 0x3727c5ac
    v_fmac_f32 v48, 0x3b000000, v50
    v_rsq_f32 v48, v48
    s_nop 0
    v_fma_f32 v52, v52, v48, v16
    v_ashrrev_i32 v53, 31, v52
    v_or_b32 v53, 0x80000000, v53
    v_xor_b32 v53, v53, v52
    v_and_b32 v53, 0xfffff800, v53
    v_or_b32 v18, s69, v53
    v_max3_u32 v19, v17, v18, 1
    ds_write_b32 v47, v19
    s_waitcnt lgkmcnt(0)
    s_barrier
    ds_read_b128 v[52:55], v102
    v_pk_mul_f32 v[88:89], v[88:89], v[48:49] op_sel_hi:[1,0]
    v_pk_mul_f32 v[90:91], v[90:91], v[48:49] op_sel_hi:[1,0]
    v_pk_mul_f32 v[92:93], v[92:93], v[48:49] op_sel_hi:[1,0]
    v_pk_mul_f32 v[94:95], v[94:95], v[48:49] op_sel_hi:[1,0]
    v_pk_fma_f32 v[88:89], v[88:89], v[168:169], v[176:177]
    v_pk_fma_f32 v[90:91], v[90:91], v[170:171], v[178:179]
    v_pk_fma_f32 v[92:93], v[92:93], v[172:173], v[180:181]
    v_pk_fma_f32 v[94:95], v[94:95], v[174:175], v[182:183]
    v_cvt_pk_bf16_f32 v24, v88, v89
    v_cvt_pk_bf16_f32 v25, v90, v91
    v_cvt_pk_bf16_f32 v26, v92, v93
    v_cvt_pk_bf16_f32 v27, v94, v95
    s_waitcnt lgkmcnt(0)
    v_max_u32 v52, v52, v53
    v_max3_u32 v52, v52, v54, v55
    v_cmp_eq_u32 vcc, v52, v19
    s_cbranch_vccz L_notbest
    buffer_store_dword v19, v5, s[8:11], s100 offen sc0 sc1
    v_cmp_gt_u32 vcc, v17, v18
    s_nop 1
    v_cndmask_b32 v28, v24, v20, vcc
    v_cndmask_b32 v40, v36, v32, vcc
    v_cndmask_b32 v29, v25, v21, vcc
    v_cndmask_b32 v41, v37, v33, vcc
    v_cndmask_b32 v30, v26, v22, vcc
    v_cndmask_b32 v42, v38, v34, vcc
    v_cndmask_b32 v31, v27, v23, vcc
    v_cndmask_b32 v43, v39, v35, vcc
    v_min_u32 v28, -2, v28
    v_min_u32 v40, -2, v40
    v_min_u32 v29, -2, v29
    v_min_u32 v41, -2, v41
    v_min_u32 v30, -2, v30
    v_min_u32 v42, -2, v42
    v_min_u32 v31, -2, v31
    v_min_u32 v43, -2, v43
    buffer_store_dwordx4 v[28:31], v1, s[8:11], s101 offen sc0 sc1
    buffer_store_dwordx4 v[40:43], v1, s[8:11], s101 offen offset:1024 sc0 sc1
L_notbest:
    buffer_load_dwordx4 v[112:115], v98, s[8:11], s17 offen
    s_add_u32 s17, s17, 4096
    buffer_load_dwordx4 v[116:119], v98, s[8:11], s17 offen
    s_add_u32 s17, s17, 2093056
    buffer_load_dwordx4 v[120:123], v98, s[8:11], s17 offen
    s_add_u32 s17, s17, 4096
    buffer_load_dwordx4 v[124:127], v98, s[8:11], s17 offen
    s_mul_i32 s17, s67, 28672
    s_add_u32 s17, s17, 8388608
    s_cmp_lt_u32 s67, 64
    s_cselect_b32 s17, s17, 2143285248
    buffer_load_dwordx4 v[128:131], v99, s[8:11], s17 offen offset:0
    buffer_load_dwordx4 v[132:135], v99, s[8:11], s17 offen offset:3584
    s_add_u32 s17, s17, 7168
    buffer_load_dwordx4 v[136:139], v99, s[8:11], s17 offen offset:0
    buffer_load_dwordx4 v[140:143], v99, s[8:11], s17 offen offset:3584
    s_add_u32 s17, s17, 7168
    buffer_load_dwordx4 v[144:147], v99, s[8:11], s17 offen offset:0
    buffer_load_dwordx4 v[148:151], v99, s[8:11], s17 offen offset:3584
    s_add_u32 s17, s17, 7168
    buffer_load_dwordx4 v[152:155], v99, s[8:11], s17 offen offset:0
    buffer_load_dwordx4 v[156:159], v99, s[8:11], s17 offen offset:3584
    v_lshlrev_b32 v72, 16, v20
    v_and_b32 v73, 0xffff0000, v20
    v_lshlrev_b32 v74, 16, v21
    v_and_b32 v75, 0xffff0000, v21
    v_lshlrev_b32 v76, 16, v22
    v_and_b32 v77, 0xffff0000, v22
    v_lshlrev_b32 v78, 16, v23
    v_and_b32 v79, 0xffff0000, v23
    v_pk_mul_f32 v[72:73], v[72:73], v[184:185]
    v_pk_mul_f32 v[74:75], v[74:75], v[186:187]
    v_pk_mul_f32 v[76:77], v[76:77], v[188:189]
    v_pk_mul_f32 v[78:79], v[78:79], v[190:191]
    v_cvt_pk_bf16_f32 v56, v72, v73
    v_cvt_pk_bf16_f32 v57, v74, v75
    v_cvt_pk_bf16_f32 v58, v76, v77
    v_cvt_pk_bf16_f32 v59, v78, v79
    v_lshlrev_b32 v72, 16, v56
    v_and_b32 v73, 0xffff0000, v56
    v_lshlrev_b32 v74, 16, v57
    v_and_b32 v75, 0xffff0000, v57
    v_lshlrev_b32 v76, 16, v58
    v_and_b32 v77, 0xffff0000, v58
    v_lshlrev_b32 v78, 16, v59
    v_and_b32 v79, 0xffff0000, v59
    v_pk_add_f32 v[72:73], v[72:73], v[64:65]
    v_pk_add_f32 v[74:75], v[74:75], v[66:67]
    v_pk_add_f32 v[76:77], v[76:77], v[68:69]
    v_pk_add_f32 v[78:79], v[78:79], v[70:71]
    v_cvt_pk_bf16_f32 v56, v72, v73
    v_cvt_pk_bf16_f32 v57, v74, v75
    v_cvt_pk_bf16_f32 v58, v76, v77
    v_cvt_pk_bf16_f32 v59, v78, v79
    v_lshlrev_b32 v88, 16, v24
    v_and_b32 v89, 0xffff0000, v24
    v_lshlrev_b32 v90, 16, v25
    v_and_b32 v91, 0xffff0000, v25
    v_lshlrev_b32 v92, 16, v26
    v_and_b32 v93, 0xffff0000, v26
    v_lshlrev_b32 v94, 16, v27
    v_and_b32 v95, 0xffff0000, v27
    v_pk_mul_f32 v[88:89], v[88:89], v[184:185]
    v_pk_mul_f32 v[90:91], v[90:91], v[186:187]
    v_pk_mul_f32 v[92:93], v[92:93], v[188:189]
    v_pk_mul_f32 v[94:95], v[94:95], v[190:191]
    v_cvt_pk_bf16_f32 v60, v88, v89
    v_cvt_pk_bf16_f32 v61, v90, v91
    v_cvt_pk_bf16_f32 v62, v92, v93
    v_cvt_pk_bf16_f32 v63, v94, v95
    v_lshlrev_b32 v88, 16, v60
    v_and_b32 v89, 0xffff0000, v60
    v_lshlrev_b32 v90, 16, v61
    v_and_b32 v91, 0xffff0000, v61
    v_lshlrev_b32 v92, 16, v62
    v_and_b32 v93, 0xffff0000, v62
    v_lshlrev_b32 v94, 16, v63
    v_and_b32 v95, 0xffff0000, v63
    v_pk_add_f32 v[88:89], v[88:89], v[80:81]
    v_pk_add_f32 v[90:91], v[90:91], v[82:83]
    v_pk_add_f32 v[92:93], v[92:93], v[84:85]
    v_pk_add_f32 v[94:95], v[94:95], v[86:87]
    v_cvt_pk_bf16_f32 v60, v88, v89
    v_cvt_pk_bf16_f32 v61, v90, v91
    v_cvt_pk_bf16_f32 v62, v92, v93
    v_cvt_pk_bf16_f32 v63, v94, v95
    v_lshlrev_b32 v4, 6, v0
    s_mov_b32 s71, 65536
    s_mov_b32 s99, 0
L_kl:
    buffer_load_dword v3, v4, s[8:11], s71 offen sc0 sc1
    s_add_u32 s99, s99, 1
    s_waitcnt vmcnt(0)
    v_cmp_eq_u32 vcc, 0, v3
    s_cbranch_vccz L_kd
    s_cmp_ge_u32 s99, 200000
    s_cbranch_scc1 L_kd
    s_mov_b64 exec, vcc
    s_sleep 2
    s_branch L_kl
L_kd:
    s_mov_b64 exec, -1
    v_max_u32_dpp v3, v3, v3 quad_perm:[1,0,3,2] row_mask:0xf bank_mask:0xf
    s_nop 1
    v_max_u32_dpp v3, v3, v3 quad_perm:[2,3,0,1] row_mask:0xf bank_mask:0xf
    s_nop 1
    v_max_u32_dpp v3, v3, v3 row_half_mirror row_mask:0xf bank_mask:0xf
    s_nop 1
    v_max_u32_dpp v3, v3, v3 row_mirror row_mask:0xf bank_mask:0xf
    v_mov_b32 v19, v3
    s_nop 1
    v_permlane16_swap_b32 v3, v19
    v_max_u32 v3, v3, v19
    v_mov_b32 v19, v3
    s_nop 1
    v_permlane32_swap_b32 v3, v19
    v_max_u32 v3, v3, v19
    ds_write_b32 v47, v3 offset:64
    s_waitcnt lgkmcnt(0)
    s_barrier
    ds_read_b128 v[52:55], v102 offset:64
    v_lshlrev_b32 v4, 2, v0
    s_waitcnt lgkmcnt(0)
    v_max_u32 v52, v52, v53
    v_max3_u32 v52, v52, v54, v55
    s_nop 0
    v_readfirstlane_b32 s71, v52
    s_and_b32 s72, s71, 2047
    s_lshr_b32 s100, s72, 7
    s_sub_u32 s101, 15, s100
    s_min_u32 s100, s100, s101
    s_lshl_b32 s100, s100, 16
    s_and_b32 s73, s72, 124
    s_lshl_b32 s73, s73, 9
    s_add_u32 s73, s73, s100
    s_add_u32 s73, s73, 524288
    buffer_load_dword v19, v4, s[8:11], s73 offen sc0 sc1
    s_lshl_b32 s100, s68, 10
    s_cmp_eq_u32 s68, s72
    s_cselect_b32 s100, 2147479552, s100
    buffer_store_dwordx2 v[56:57], v45, s[52:55], s100 offen
    buffer_store_dwordx2 v[58:59], v45, s[52:55], s100 offen offset:32
    s_lshl_b32 s100, s69, 10
    s_cmp_eq_u32 s69, s72
    s_cselect_b32 s100, 2147479552, s100
    buffer_store_dwordx2 v[60:61], v45, s[52:55], s100 offen
    buffer_store_dwordx2 v[62:63], v45, s[52:55], s100 offen offset:32
    s_cmp_ge_u32 s66, 224
    s_cbranch_scc1 L_nprod
    v_lshlrev_b32 v160, 16, v112
    v_and_b32 v161, 0xffff0000, v112
    v_lshlrev_b32 v162, 16, v113
    v_and_b32 v163, 0xffff0000, v113
    v_lshlrev_b32 v164, 16, v114
    v_and_b32 v165, 0xffff0000, v114
    v_lshlrev_b32 v166, 16, v115
    v_and_b32 v167, 0xffff0000, v115
    v_lshlrev_b32 v168, 16, v116
    v_and_b32 v169, 0xffff0000, v116
    v_lshlrev_b32 v170, 16, v117
    v_and_b32 v171, 0xffff0000, v117
    v_lshlrev_b32 v172, 16, v118
    v_and_b32 v173, 0xffff0000, v118
    v_lshlrev_b32 v174, 16, v119
    v_and_b32 v175, 0xffff0000, v119
    v_lshlrev_b32 v176, 16, v120
    v_and_b32 v177, 0xffff0000, v120
    v_lshlrev_b32 v178, 16, v121
    v_and_b32 v179, 0xffff0000, v121
    v_lshlrev_b32 v180, 16, v122
    v_and_b32 v181, 0xffff0000, v122
    v_lshlrev_b32 v182, 16, v123
    v_and_b32 v183, 0xffff0000, v123
    v_lshlrev_b32 v184, 16, v124
    v_and_b32 v185, 0xffff0000, v124
    v_lshlrev_b32 v186, 16, v125
    v_and_b32 v187, 0xffff0000, v125
    v_lshlrev_b32 v188, 16, v126
    v_and_b32 v189, 0xffff0000, v126
    v_lshlrev_b32 v190, 16, v127
    v_and_b32 v191, 0xffff0000, v127
    s_mov_b32 s99, 0
    s_waitcnt vmcnt(4)
L_hl:
    v_cmp_eq_u32 vcc, -1, v19
    s_add_u32 s99, s99, 1
    s_cbranch_vccz L_hok
    s_cmp_ge_u32 s99, 200000
    s_cbranch_scc1 L_hok
    buffer_load_dword v19, v4, s[8:11], s73 offen sc0 sc1
    s_waitcnt vmcnt(0)
    s_branch L_hl
L_hok:
    v_lshlrev_b32 v48, 16, v19
    v_and_b32 v50, 0xffff0000, v19
    v_pk_mul_f32 v[64:65], v[160:161], v[48:49] op_sel_hi:[1,0]
    v_pk_mul_f32 v[66:67], v[162:163], v[48:49] op_sel_hi:[1,0]
    v_pk_mul_f32 v[68:69], v[164:165], v[48:49] op_sel_hi:[1,0]
    v_pk_mul_f32 v[70:71], v[166:167], v[48:49] op_sel_hi:[1,0]
    v_pk_mul_f32 v[72:73], v[176:177], v[48:49] op_sel_hi:[1,0]
    v_pk_mul_f32 v[74:75], v[178:179], v[48:49] op_sel_hi:[1,0]
    v_pk_mul_f32 v[76:77], v[180:181], v[48:49] op_sel_hi:[1,0]
    v_pk_mul_f32 v[78:79], v[182:183], v[48:49] op_sel_hi:[1,0]
    v_pk_fma_f32 v[64:65], v[168:169], v[50:51], v[64:65] op_sel_hi:[1,0,1]
    v_pk_fma_f32 v[66:67], v[170:171], v[50:51], v[66:67] op_sel_hi:[1,0,1]
    v_pk_fma_f32 v[68:69], v[172:173], v[50:51], v[68:69] op_sel_hi:[1,0,1]
    v_pk_fma_f32 v[70:71], v[174:175], v[50:51], v[70:71] op_sel_hi:[1,0,1]
    v_pk_fma_f32 v[72:73], v[184:185], v[50:51], v[72:73] op_sel_hi:[1,0,1]
    v_pk_fma_f32 v[74:75], v[186:187], v[50:51], v[74:75] op_sel_hi:[1,0,1]
    v_pk_fma_f32 v[76:77], v[188:189], v[50:51], v[76:77] op_sel_hi:[1,0,1]
    v_pk_fma_f32 v[78:79], v[190:191], v[50:51], v[78:79] op_sel_hi:[1,0,1]
    v_permlane32_swap_b32 v64, v72
    v_permlane32_swap_b32 v65, v73
    v_permlane32_swap_b32 v66, v74
    v_permlane32_swap_b32 v67, v75
    v_permlane32_swap_b32 v68, v76
    v_permlane32_swap_b32 v69, v77
    v_permlane32_swap_b32 v70, v78
    v_permlane32_swap_b32 v71, v79
    v_add_f32 v64, v64, v72
    v_add_f32 v65, v65, v73
    v_add_f32 v66, v66, v74
    v_add_f32 v67, v67, v75
    v_add_f32 v68, v68, v76
    v_add_f32 v69, v69, v77
    v_add_f32 v70, v70, v78
    v_add_f32 v71, v71, v79
    v_permlane16_swap_b32 v64, v68
    v_permlane16_swap_b32 v65, v69
    v_permlane16_swap_b32 v66, v70
    v_permlane16_swap_b32 v67, v71
    v_add_f32 v64, v64, v68
    v_add_f32 v65, v65, v69
    v_add_f32 v66, v66, v70
    v_add_f32 v67, v67, v71
    v_add_f32_dpp v64, v64, v64 quad_perm:[1,0,3,2] row_mask:0xf bank_mask:0xf
    v_add_f32_dpp v65, v65, v65 quad_perm:[1,0,3,2] row_mask:0xf bank_mask:0xf
    v_add_f32_dpp v66, v66, v66 quad_perm:[1,0,3,2] row_mask:0xf bank_mask:0xf
    v_add_f32_dpp v67, v67, v67 quad_perm:[1,0,3,2] row_mask:0xf bank_mask:0xf
    v_add_f32_dpp v64, v64, v64 quad_perm:[2,3,0,1] row_mask:0xf bank_mask:0xf
    v_add_f32_dpp v65, v65, v65 quad_perm:[2,3,0,1] row_mask:0xf bank_mask:0xf
    v_add_f32_dpp v66, v66, v66 quad_perm:[2,3,0,1] row_mask:0xf bank_mask:0xf
    v_add_f32_dpp v67, v67, v67 quad_perm:[2,3,0,1] row_mask:0xf bank_mask:0xf
    v_add_f32_dpp v64, v64, v64 row_half_mirror row_mask:0xf bank_mask:0xf
    v_add_f32_dpp v65, v65, v65 row_half_mirror row_mask:0xf bank_mask:0xf
    v_add_f32_dpp v66, v66, v66 row_half_mirror row_mask:0xf bank_mask:0xf
    v_add_f32_dpp v67, v67, v67 row_half_mirror row_mask:0xf bank_mask:0xf
    v_add_f32_dpp v64, v64, v64 row_mirror row_mask:0xf bank_mask:0xf
    v_add_f32_dpp v65, v65, v65 row_mirror row_mask:0xf bank_mask:0xf
    v_add_f32_dpp v66, v66, v66 row_mirror row_mask:0xf bank_mask:0xf
    v_add_f32_dpp v67, v67, v67 row_mirror row_mask:0xf bank_mask:0xf
    v_and_b32 v50, 15, v2
    v_cmp_eq_u32 vcc, 0, v50
    v_mov_b32 v51, 1024
    s_nop 0
    v_cndmask_b32 v51, v51, v0, vcc
    ds_write_b128 v51, v[64:67] offset:256
    v_lshlrev_b32 v50, 2, v50
    s_waitcnt lgkmcnt(0)
    s_barrier
    s_cmp_lg_u32 s3, 0
    s_cbranch_scc1 L_nprod
    ds_read_b32 v64, v50 offset:256
    ds_read_b32 v65, v50 offset:320
    ds_read_b32 v66, v50 offset:384
    ds_read_b32 v67, v50 offset:448
    v_cmp_gt_u32 vcc, 8, v2
    v_mov_b32 v51, 2147479552
    s_nop 0
    v_cndmask_b32 v51, v51, v50, vcc
    s_lshl_b32 s100, s66, 6
    s_add_u32 s100, s100, 81920
    s_waitcnt lgkmcnt(2)
    v_add_f32 v64, v64, v65
    s_waitcnt lgkmcnt(0)
    v_add_f32 v66, v66, v67
    v_add_f32 v64, v64, v66
    v_cvt_pk_bf16_f32 v64, v64, v64
    v_and_b32 v64, 0xffff0000, v64
    s_nop 1
    v_mov_b32_dpp v65, v64 row_ror:8 row_mask:0xf bank_mask:0xf
    v_mul_f32 v66, 0xbfb8aa3b, v64
    v_exp_f32 v66, v66
    s_nop 0
    v_add_f32 v66, 1.0, v66
    v_rcp_f32 v66, v66
    s_nop 0
    v_mul_f32 v64, v64, v66
    v_cvt_pk_bf16_f32 v64, v64, v64
    v_and_b32 v64, 0xffff0000, v64
    v_mul_f32 v64, v64, v65
    v_cvt_pk_bf16_f32 v64, v64, v64
    v_and_b32 v64, 0xffff0000, v64
    buffer_store_dword v64, v51, s[8:11], s100 offen sc0 sc1
L_nprod:
    s_cmp_ge_u32 s67, 64
    s_cbranch_scc1 L_fin
    v_lshlrev_b32 v4, 6, v0
    v_cmp_gt_u32 vcc, 224, v0
    v_mov_b32 v51, 2147479552
    s_nop 0
    v_cndmask_b32 v4, v51, v4, vcc
    s_mov_b32 s100, 81920
    v_and_b32 v52, 7, v2
    s_lshl_b32 s101, s67, 3
    v_add_u32 v52, s101, v52
    v_lshrrev_b32 v53, 5, v52
    v_lshlrev_b32 v53, 6, v53
    v_and_b32 v54, 12, v52
    v_lshl_add_u32 v53, v54, 2, v53
    v_bfe_u32 v54, v52, 4, 1
    v_lshl_add_u32 v53, v54, 3, v53
    v_and_b32 v54, 2, v52
    v_lshl_add_u32 v53, v54, 1, v53
    v_lshlrev_b32 v54, 2, v52
    s_mov_b32 s101, 10240
    buffer_load_dword v55, v54, s[8:11], s101 offen
    buffer_load_dword v88, v53, s[8:11], s73 offen sc0 sc1
    buffer_load_dword v89, v53, s[8:11], s73 offen offset:1024 sc0 sc1
    v_lshlrev_b32 v192, 16, v128
    v_and_b32 v193, 0xffff0000, v128
    v_lshlrev_b32 v194, 16, v129
    v_and_b32 v195, 0xffff0000, v129
    v_lshlrev_b32 v196, 16, v130
    v_and_b32 v197, 0xffff0000, v130
    v_lshlrev_b32 v198, 16, v131
    v_and_b32 v199, 0xffff0000, v131
    v_lshlrev_b32 v200, 16, v132
    v_and_b32 v201, 0xffff0000, v132
    v_lshlrev_b32 v202, 16, v133
    v_and_b32 v203, 0xffff0000, v133
    v_lshlrev_b32 v204, 16, v134
    v_and_b32 v205, 0xffff0000, v134
    v_lshlrev_b32 v206, 16, v135
    v_and_b32 v207, 0xffff0000, v135
    v_lshlrev_b32 v208, 16, v136
    v_and_b32 v209, 0xffff0000, v136
    v_lshlrev_b32 v210, 16, v137
    v_and_b32 v211, 0xffff0000, v137
    v_lshlrev_b32 v212, 16, v138
    v_and_b32 v213, 0xffff0000, v138
    v_lshlrev_b32 v214, 16, v139
    v_and_b32 v215, 0xffff0000, v139
    v_lshlrev_b32 v216, 16, v140
    v_and_b32 v217, 0xffff0000, v140
    v_lshlrev_b32 v218, 16, v141
    v_and_b32 v219, 0xffff0000, v141
    v_lshlrev_b32 v220, 16, v142
    v_and_b32 v221, 0xffff0000, v142
    v_lshlrev_b32 v222, 16, v143
    v_and_b32 v223, 0xffff0000, v143
    v_lshlrev_b32 v224, 16, v144
    v_and_b32 v225, 0xffff0000, v144
    v_lshlrev_b32 v226, 16, v145
    v_and_b32 v227, 0xffff0000, v145
    v_lshlrev_b32 v228, 16, v146
    v_and_b32 v229, 0xffff0000, v146
    v_lshlrev_b32 v230, 16, v147
    v_and_b32 v231, 0xffff0000, v147
    v_lshlrev_b32 v232, 16, v148
    v_and_b32 v233, 0xffff0000, v148
    v_lshlrev_b32 v234, 16, v149
    v_and_b32 v235, 0xffff0000, v149
    v_lshlrev_b32 v236, 16, v150
    v_and_b32 v237, 0xffff0000, v150
    v_lshlrev_b32 v238, 16, v151
    v_and_b32 v239, 0xffff0000, v151
    v_lshlrev_b32 v240, 16, v152
    v_and_b32 v241, 0xffff0000, v152
    v_lshlrev_b32 v242, 16, v153
    v_and_b32 v243, 0xffff0000, v153
    v_lshlrev_b32 v244, 16, v154
    v_and_b32 v245, 0xffff0000, v154
    v_lshlrev_b32 v246, 16, v155
    v_and_b32 v247, 0xffff0000, v155
    v_lshlrev_b32 v248, 16, v156
    v_and_b32 v249, 0xffff0000, v156
    v_lshlrev_b32 v250, 16, v157
    v_and_b32 v251, 0xffff0000, v157
    v_lshlrev_b32 v252, 16, v158
    v_and_b32 v253, 0xffff0000, v158
    v_lshlrev_b32 v254, 16, v159
    v_and_b32 v255, 0xffff0000, v159
    s_and_b32 s101, s71, 0xfffff800
    s_or_b32 s101, s101, 0x400
    v_mov_b32 v90, s101
    v_not_b32 v91, v90
    v_ashrrev_i32 v91, 31, v91
    v_or_b32 v91, 0x80000000, v91
    v_xor_b32 v90, v90, v91
    v_cvt_pk_bf16_f32 v90, v90, v90
    v_and_b32 v90, 0xffff0000, v90
    v_mul_f32 v90, 0xbfb8aa3b, v90
    v_exp_f32 v90, v90
    s_nop 0
    v_add_f32 v90, 1.0, v90
    v_rcp_f32 v90, v90
    s_nop 0
    v_cvt_pk_bf16_f32 v90, v90, v90
    v_and_b32 v90, 0xffff0000, v90
    s_mov_b32 s99, 0
L_CND_l_27:
    s_waitcnt vmcnt(0)
    v_max_u32 v3, v88, v89
    v_cmp_eq_u32 vcc, -1, v3
    s_add_u32 s99, s99, 1
    s_cbranch_vccz L_CND_ok_28
    s_cmp_ge_u32 s99, 200000
    s_cbranch_scc1 L_CND_ok_28
    s_mov_b64 exec, vcc
    s_sleep 1
    buffer_load_dword v88, v53, s[8:11], s73 offen sc0 sc1
    buffer_load_dword v89, v53, s[8:11], s73 offen offset:1024 sc0 sc1
    s_branch L_CND_l_27
L_CND_ok_28:
    s_mov_b64 exec, -1
    v_and_b32 v51, 1, v52
    v_cmp_eq_u32 vcc, 0, v51
    v_lshlrev_b32 v91, 16, v88
    v_and_b32 v88, 0xffff0000, v88
    v_cndmask_b32 v88, v88, v91, vcc
    v_lshlrev_b32 v91, 16, v89
    v_and_b32 v89, 0xffff0000, v89
    v_cndmask_b32 v89, v89, v91, vcc
    v_and_b32 v50, 15, v2
    v_cmp_eq_u32 vcc, 0, v50
    v_lshrrev_b32 v51, 1, v0
    v_mov_b32 v50, 1024
    v_cndmask_b32 v51, v50, v51, vcc
    v_and_b32 v50, 7, v2
    v_lshlrev_b32 v50, 2, v50
    v_cmp_gt_u32 vcc, 8, v2
    v_lshlrev_b32 v52, 1, v52
    v_mov_b32 v53, 2147479552
    v_cndmask_b32 v52, v53, v52, vcc
    s_cmp_lt_u32 s66, 224
    s_cbranch_scc1 L_asl
    s_sleep 16
L_asl:
    s_sleep 7
    buffer_load_dwordx4 v[80:83], v4, s[8:11], s100 offen sc0 sc1
    buffer_load_dwordx4 v[84:87], v4, s[8:11], s100 offen offset:16 sc0 sc1
    s_mov_b32 s99, 0
L_ACT_l_29:
    s_waitcnt vmcnt(0)
    v_max_u32 v3, v80, v81
    v_max3_u32 v3, v3, v82, v83
    v_max3_u32 v3, v3, v84, v85
    v_max3_u32 v3, v3, v86, v87
    v_cmp_eq_u32 vcc, -1, v3
    s_add_u32 s99, s99, 1
    s_cbranch_vccz L_ACT_ok_30
    s_cmp_ge_u32 s99, 200000
    s_cbranch_scc1 L_ACT_ok_30
    s_mov_b64 exec, vcc
    s_sleep 2
    buffer_load_dwordx4 v[80:83], v4, s[8:11], s100 offen sc0 sc1
    buffer_load_dwordx4 v[84:87], v4, s[8:11], s100 offen offset:16 sc0 sc1
    s_branch L_ACT_l_29
L_ACT_ok_30:
    s_mov_b64 exec, -1
    v_pk_mul_f32 v[64:65], v[192:193], v[80:81] op_sel_hi:[1,0]
    v_pk_mul_f32 v[66:67], v[194:195], v[80:81] op_sel_hi:[1,0]
    v_pk_mul_f32 v[68:69], v[196:197], v[80:81] op_sel_hi:[1,0]
    v_pk_mul_f32 v[70:71], v[198:199], v[80:81] op_sel_hi:[1,0]
    v_pk_fma_f32 v[64:65], v[200:201], v[80:81], v[64:65] op_sel:[0,1,0] op_sel_hi:[1,1,1]
    v_pk_fma_f32 v[66:67], v[202:203], v[80:81], v[66:67] op_sel:[0,1,0] op_sel_hi:[1,1,1]
    v_pk_fma_f32 v[68:69], v[204:205], v[80:81], v[68:69] op_sel:[0,1,0] op_sel_hi:[1,1,1]
    v_pk_fma_f32 v[70:71], v[206:207], v[80:81], v[70:71] op_sel:[0,1,0] op_sel_hi:[1,1,1]
    v_pk_fma_f32 v[64:65], v[208:209], v[82:83], v[64:65] op_sel:[0,0,0] op_sel_hi:[1,0,1]
    v_pk_fma_f32 v[66:67], v[210:211], v[82:83], v[66:67] op_sel:[0,0,0] op_sel_hi:[1,0,1]
    v_pk_fma_f32 v[68:69], v[212:213], v[82:83], v[68:69] op_sel:[0,0,0] op_sel_hi:[1,0,1]
    v_pk_fma_f32 v[70:71], v[214:215], v[82:83], v[70:71] op_sel:[0,0,0] op_sel_hi:[1,0,1]
    v_pk_fma_f32 v[64:65], v[216:217], v[82:83], v[64:65] op_sel:[0,1,0] op_sel_hi:[1,1,1]
    v_pk_fma_f32 v[66:67], v[218:219], v[82:83], v[66:67] op_sel:[0,1,0] op_sel_hi:[1,1,1]
    v_pk_fma_f32 v[68:69], v[220:221], v[82:83], v[68:69] op_sel:[0,1,0] op_sel_hi:[1,1,1]
    v_pk_fma_f32 v[70:71], v[222:223], v[82:83], v[70:71] op_sel:[0,1,0] op_sel_hi:[1,1,1]
    v_pk_fma_f32 v[64:65], v[224:225], v[84:85], v[64:65] op_sel:[0,0,0] op_sel_hi:[1,0,1]
    v_pk_fma_f32 v[66:67], v[226:227], v[84:85], v[66:67] op_sel:[0,0,0] op_sel_hi:[1,0,1]
    v_pk_fma_f32 v[68:69], v[228:229], v[84:85], v[68:69] op_sel:[0,0,0] op_sel_hi:[1,0,1]
    v_pk_fma_f32 v[70:71], v[230:231], v[84:85], v[70:71] op_sel:[0,0,0] op_sel_hi:[1,0,1]
    v_pk_fma_f32 v[64:65], v[232:233], v[84:85], v[64:65] op_sel:[0,1,0] op_sel_hi:[1,1,1]
    v_pk_fma_f32 v[66:67], v[234:235], v[84:85], v[66:67] op_sel:[0,1,0] op_sel_hi:[1,1,1]
    v_pk_fma_f32 v[68:69], v[236:237], v[84:85], v[68:69] op_sel:[0,1,0] op_sel_hi:[1,1,1]
    v_pk_fma_f32 v[70:71], v[238:239], v[84:85], v[70:71] op_sel:[0,1,0] op_sel_hi:[1,1,1]
    v_pk_fma_f32 v[64:65], v[240:241], v[86:87], v[64:65] op_sel:[0,0,0] op_sel_hi:[1,0,1]
    v_pk_fma_f32 v[66:67], v[242:243], v[86:87], v[66:67] op_sel:[0,0,0] op_sel_hi:[1,0,1]
    v_pk_fma_f32 v[68:69], v[244:245], v[86:87], v[68:69] op_sel:[0,0,0] op_sel_hi:[1,0,1]
    v_pk_fma_f32 v[70:71], v[246:247], v[86:87], v[70:71] op_sel:[0,0,0] op_sel_hi:[1,0,1]
    v_pk_fma_f32 v[64:65], v[248:249], v[86:87], v[64:65] op_sel:[0,1,0] op_sel_hi:[1,1,1]
    v_pk_fma_f32 v[66:67], v[250:251], v[86:87], v[66:67] op_sel:[0,1,0] op_sel_hi:[1,1,1]
    v_pk_fma_f32 v[68:69], v[252:253], v[86:87], v[68:69] op_sel:[0,1,0] op_sel_hi:[1,1,1]
    v_pk_fma_f32 v[70:71], v[254:255], v[86:87], v[70:71] op_sel:[0,1,0] op_sel_hi:[1,1,1]
    s_nop 0
    v_permlane32_swap_b32 v64, v68
    v_permlane32_swap_b32 v65, v69
    v_permlane32_swap_b32 v66, v70
    v_permlane32_swap_b32 v67, v71
    v_add_f32 v64, v64, v68
    v_add_f32 v65, v65, v69
    v_add_f32 v66, v66, v70
    v_add_f32 v67, v67, v71
    s_nop 0
    v_permlane16_swap_b32 v64, v66
    v_permlane16_swap_b32 v65, v67
    v_add_f32 v64, v64, v66
    v_add_f32 v65, v65, v67
    s_nop 0
    v_add_f32_dpp v64, v64, v64 quad_perm:[1,0,3,2] row_mask:0xf bank_mask:0xf
    v_add_f32_dpp v65, v65, v65 quad_perm:[1,0,3,2] row_mask:0xf bank_mask:0xf
    s_nop 0
    v_add_f32_dpp v64, v64, v64 quad_perm:[2,3,0,1] row_mask:0xf bank_mask:0xf
    v_add_f32_dpp v65, v65, v65 quad_perm:[2,3,0,1] row_mask:0xf bank_mask:0xf
    s_nop 0
    v_add_f32_dpp v64, v64, v64 row_half_mirror row_mask:0xf bank_mask:0xf
    v_add_f32_dpp v65, v65, v65 row_half_mirror row_mask:0xf bank_mask:0xf
    s_nop 0
    v_add_f32_dpp v64, v64, v64 row_mirror row_mask:0xf bank_mask:0xf
    v_add_f32_dpp v65, v65, v65 row_mirror row_mask:0xf bank_mask:0xf
    ds_write_b64 v51, v[64:65] offset:2048
    s_waitcnt lgkmcnt(0)
    s_barrier
    s_cmp_lg_u32 s3, 0
    s_cbranch_scc1 L_fin
    ds_read_b32 v64, v50 offset:2048
    ds_read_b32 v65, v50 offset:2080
    ds_read_b32 v66, v50 offset:2112
    ds_read_b32 v67, v50 offset:2144
    s_lshl_b32 s100, s72, 10
    s_waitcnt lgkmcnt(2)
    v_add_f32 v64, v64, v65
    s_waitcnt lgkmcnt(0)
    v_add_f32 v66, v66, v67
    v_add_f32 v64, v64, v66
    v_cvt_pk_bf16_f32 v64, v64, v64
    v_and_b32 v64, 0xffff0000, v64
    v_mul_f32 v64, v64, v90
    v_cvt_pk_bf16_f32 v64, v64, v64
    v_and_b32 v64, 0xffff0000, v64
    v_add_f32 v64, v64, v88
    v_cvt_pk_bf16_f32 v64, v64, v64
    v_and_b32 v64, 0xffff0000, v64
    v_mul_f32 v64, v64, v55
    v_cvt_pk_bf16_f32 v64, v64, v64
    v_and_b32 v64, 0xffff0000, v64
    v_add_f32 v64, v64, v89
    v_cvt_pk_bf16_f32 v64, v64, v64
    buffer_store_short v64, v52, s[52:55], s100 offen
L_fin:
L_end:
    s_endpgm
L_E_slow_1:
    s_mov_b32 s99, 0
L_E_slow_1_l:
    s_sleep 4
    buffer_load_dword v3, v4, s[36:39], s67 offen sc0 sc1
    s_add_u32 s99, s99, 1
    s_waitcnt vmcnt(0)
    v_cmp_le_u32 vcc, s68, v3
    s_cmp_eq_u64 vcc, -1
    s_cbranch_scc1 L_E_ok_2
    s_cmp_lt_u32 s99, 200000
    s_cbranch_scc1 L_E_slow_1_l
    s_branch L_E_ok_2
L_H_slow_3:
    s_mov_b32 s99, 0
L_H_slow_3_l:
    s_sleep 4
    buffer_load_dword v3, v16, s[8:11], s78 offen sc0 sc1
    s_add_u32 s99, s99, 1
    s_waitcnt vmcnt(0)
    v_cmp_ne_u32 vcc, 0, v3
    s_cmp_eq_u64 vcc, -1
    s_cbranch_scc1 L_H_ok_4
    s_cmp_lt_u32 s99, 200000
    s_cbranch_scc1 L_H_slow_3_l
    s_branch L_H_ok_4
L_E2_slow_5:
    s_mov_b32 s99, 0
L_E2_slow_5_l:
    s_sleep 4
    buffer_load_dword v118, v119, s[8:11], s69 offen sc0 sc1
    s_add_u32 s99, s99, 1
    s_waitcnt vmcnt(0)
    v_cmp_ne_u32 vcc, 0, v118
    s_cmp_eq_u64 vcc, -1
    s_cbranch_scc1 L_E2_ok_6
    s_cmp_lt_u32 s99, 200000
    s_cbranch_scc1 L_E2_slow_5_l
    s_branch L_E2_ok_6
L_KV_slow_7:
    s_mov_b32 s99, 0
L_KV_slow_7_l:
    s_sleep 4
    buffer_load_dword v3, v17, s[8:11], s74 offen sc0 sc1
    s_add_u32 s99, s99, 1
    s_waitcnt vmcnt(0)
    v_cmp_ne_u32 vcc, 0, v3
    s_cmp_eq_u64 vcc, -1
    s_cbranch_scc1 L_KV_ok_8
    s_cmp_lt_u32 s99, 200000
    s_cbranch_scc1 L_KV_slow_7_l
    s_branch L_KV_ok_8
L_t1_zero:
    v_mfma_f32_16x16x32_bf16 v[96:99], a[128:131], a[96:99], v[80:83]
    s_xor_b32 s100, s16, 8192
    ds_read_b128 a[176:179], v20 offset:4096
    v_lshrrev_b32 v13, 1, v1
    v_mfma_f32_16x16x32_bf16 v[96:99], a[132:135], a[100:103], v[96:99]
    s_add_u32 m0, s15, 0
    ds_read_b128 a[180:183], v20 offset:5120
    v_add_u32 v12, s100, v13
    v_mfma_f32_16x16x32_bf16 v[96:99], a[136:139], a[104:107], v[96:99]
    buffer_load_dwordx4 v1, s[8:11], s82 offen offset:0 lds
    v_exp_f32 v112, v112
    v_mfma_f32_16x16x32_bf16 v[96:99], a[140:143], a[108:111], v[96:99]
    v_exp_f32 v113, v113
    v_mfma_f32_16x16x32_bf16 v[100:103], a[144:147], a[96:99], v[84:87]
    ds_read_b128 a[184:187], v20 offset:6144
    v_cvt_pk_bf16_f32 v56, v112, v113
    v_mfma_f32_16x16x32_bf16 v[100:103], a[148:151], a[100:103], v[100:103]
    v_exp_f32 v114, v114
    v_mfma_f32_16x16x32_bf16 v[100:103], a[152:155], a[104:107], v[100:103]
    buffer_load_dwordx4 v1, s[8:11], s82 offen offset:1024 lds
    v_exp_f32 v115, v115
    v_mfma_f32_16x16x32_bf16 v[100:103], a[156:159], a[108:111], v[100:103]
    ds_read_b128 a[188:191], v20 offset:7168
    v_cvt_pk_bf16_f32 v57, v114, v115
    v_mfma_f32_16x16x32_bf16 v[104:107], a[128:131], a[112:115], v[88:91]
    v_exp_f32 v116, v116
    v_mfma_f32_16x16x32_bf16 v[104:107], a[132:135], a[116:119], v[104:107]
    v_exp_f32 v117, v117
    v_mfma_f32_16x16x32_bf16 v[104:107], a[136:139], a[120:123], v[104:107]
    ds_read_b128 a[160:163], v19 offset:0
    v_cvt_pk_bf16_f32 v58, v116, v117
    v_mfma_f32_16x16x32_bf16 v[104:107], a[140:143], a[124:127], v[104:107]
    buffer_load_dwordx4 v1, s[8:11], s82 offen offset:2048 lds
    v_exp_f32 v118, v118
    v_mfma_f32_16x16x32_bf16 v[108:111], a[144:147], a[112:115], v[92:95]
    v_exp_f32 v119, v119
    v_mfma_f32_16x16x32_bf16 v[108:111], a[148:151], a[116:119], v[108:111]
    ds_read_b128 a[164:167], v19 offset:1024
    v_cvt_pk_bf16_f32 v59, v118, v119
    v_mfma_f32_16x16x32_bf16 v[108:111], a[152:155], a[120:123], v[108:111]
    v_exp_f32 v120, v120
    v_mfma_f32_16x16x32_bf16 v[108:111], a[156:159], a[124:127], v[108:111]
    buffer_load_dwordx4 v1, s[8:11], s82 offen offset:3072 lds
    v_exp_f32 v121, v121
    v_mfma_f32_16x16x32_bf16 v[32:35], v[28:31], v[48:51], 0
    s_add_u32 m0, s15, 4096
    ds_read_b128 a[168:171], v19 offset:2048
    v_cvt_pk_bf16_f32 v60, v120, v121
    v_mfma_f32_16x16x32_bf16 v[36:39], v[28:31], v[52:55], 0
    s_waitcnt lgkmcnt(6)
    v_exp_f32 v122, v122
    v_mfma_f32_16x16x32_bf16 v[144:147], a[176:179], v[48:51], 0
    v_exp_f32 v123, v123
    v_mfma_f32_16x16x32_bf16 v[176:179], a[176:179], v[52:55], 0
    s_waitcnt lgkmcnt(5)
    ds_read_b128 a[172:175], v19 offset:3072
    v_cvt_pk_bf16_f32 v61, v122, v123
    v_mfma_f32_16x16x32_bf16 v[148:151], a[180:183], v[48:51], 0
    buffer_load_dwordx4 v15, s[8:11], s82 offen offset:0 lds
    v_exp_f32 v124, v124
    v_mfma_f32_16x16x32_bf16 v[180:183], a[180:183], v[52:55], 0
    s_waitcnt lgkmcnt(5)
    v_exp_f32 v125, v125
    v_mfma_f32_16x16x32_bf16 v[152:155], a[184:187], v[48:51], 0
    s_waitcnt lgkmcnt(4)
    v_exp_f32 v126, v126
    v_mfma_f32_16x16x32_bf16 v[184:187], a[184:187], v[52:55], 0
    buffer_load_dwordx4 v15, s[8:11], s82 offen offset:1024 lds
    v_exp_f32 v127, v127
    v_mfma_f32_16x16x32_bf16 v[156:159], a[188:191], v[48:51], 0
    ds_write_b128 v16, v[144:147] offset:32768
    v_cvt_pk_bf16_f32 v62, v124, v125
    v_mfma_f32_16x16x32_bf16 v[188:191], a[188:191], v[52:55], 0
    s_waitcnt lgkmcnt(4)
    v_exp_f32 v96, v96
    v_mfma_f32_16x16x32_bf16 v[128:131], a[160:163], v[48:51], 0
    v_exp_f32 v97, v97
    v_mfma_f32_16x16x32_bf16 v[160:163], a[160:163], v[52:55], 0
    s_waitcnt lgkmcnt(3)
    ds_write_b128 v16, v[176:179] offset:33792
    v_cvt_pk_bf16_f32 v63, v126, v127
    v_mfma_f32_16x16x32_bf16 v[132:135], a[164:167], v[48:51], 0
    s_waitcnt lgkmcnt(3)
    v_exp_f32 v98, v98
    v_mfma_f32_16x16x32_bf16 v[164:167], a[164:167], v[52:55], 0
    buffer_load_dwordx4 v15, s[8:11], s82 offen offset:2048 lds
    v_exp_f32 v99, v99
    v_mfma_f32_16x16x32_bf16 v[136:139], a[168:171], v[48:51], 0
    ds_write_b128 v16, v[148:151] offset:34816
    v_mfma_f32_16x16x32_bf16 v[168:171], a[168:171], v[52:55], 0
    s_waitcnt lgkmcnt(3)
    v_exp_f32 v100, v100
    v_mfma_f32_16x16x32_bf16 v[140:143], a[172:175], v[48:51], 0
    v_exp_f32 v101, v101
    v_mfma_f32_16x16x32_bf16 v[172:175], a[172:175], v[52:55], 0
    ds_write_b128 v16, v[180:183] offset:35840
    v_mov_b32 v33, v36
    v_mfma_f32_16x16x32_bf16 v[40:43], v[28:31], v[56:59], 0
    buffer_load_dwordx4 v15, s[8:11], s82 offen offset:3072 lds
    v_exp_f32 v102, v102
    v_mfma_f32_16x16x32_bf16 v[44:47], v[28:31], v[60:63], 0
    s_xor_b32 s15, s15, 196608
    v_exp_f32 v103, v103
    v_mfma_f32_16x16x32_bf16 v[208:211], a[176:179], v[56:59], 0
    ds_write_b128 v16, v[152:155] offset:36864
    v_cvt_pk_bf16_f32 v48, v96, v97
    v_mfma_f32_16x16x32_bf16 v[240:243], a[176:179], v[60:63], 0
    ds_read_b128 a[176:179], v20 offset:20480
    v_exp_f32 v104, v104
    v_mfma_f32_16x16x32_bf16 v[212:215], a[180:183], v[56:59], 0
    v_exp_f32 v105, v105
    v_mfma_f32_16x16x32_bf16 v[244:247], a[180:183], v[60:63], 0
    ds_read_b128 a[180:183], v20 offset:21504
    v_exp_f32 v106, v106
    v_mfma_f32_16x16x32_bf16 v[216:219], a[184:187], v[56:59], 0
    ds_write_b128 v16, v[184:187] offset:37888
    v_cvt_pk_bf16_f32 v49, v98, v99
    v_mfma_f32_16x16x32_bf16 v[248:251], a[184:187], v[60:63], 0
    ds_read_b128 a[184:187], v20 offset:22528
    v_exp_f32 v107, v107
    v_mfma_f32_16x16x32_bf16 v[220:223], a[188:191], v[56:59], 0
    v_exp_f32 v108, v108
    v_mfma_f32_16x16x32_bf16 v[252:255], a[188:191], v[60:63], 0
    ds_read_b128 a[188:191], v20 offset:23552
    v_exp_f32 v109, v109
    v_mfma_f32_16x16x32_bf16 v[192:195], a[160:163], v[56:59], 0
    ds_write_b128 v16, v[156:159] offset:38912
    v_cvt_pk_bf16_f32 v50, v100, v101
    v_mfma_f32_16x16x32_bf16 v[224:227], a[160:163], v[60:63], 0
    ds_read_b128 a[160:163], v19 offset:16384
    v_exp_f32 v110, v110
    v_mfma_f32_16x16x32_bf16 v[196:199], a[164:167], v[56:59], 0
    v_exp_f32 v111, v111
    v_mfma_f32_16x16x32_bf16 v[228:231], a[164:167], v[60:63], 0
    ds_read_b128 a[164:167], v19 offset:17408
    v_cvt_pk_bf16_f32 v51, v102, v103
    v_mfma_f32_16x16x32_bf16 v[200:203], a[168:171], v[56:59], 0
    ds_write_b128 v16, v[188:191] offset:39936
    v_cvt_pk_bf16_f32 v52, v104, v105
    v_mfma_f32_16x16x32_bf16 v[232:235], a[168:171], v[60:63], 0
    ds_read_b128 a[168:171], v19 offset:18432
    v_cvt_pk_bf16_f32 v53, v106, v107
    v_mfma_f32_16x16x32_bf16 v[204:207], a[172:175], v[56:59], 0
    v_cvt_pk_bf16_f32 v54, v108, v109
    v_cvt_pk_bf16_f32 v55, v110, v111
    v_mfma_f32_16x16x32_bf16 v[236:239], a[172:175], v[60:63], 0
    ds_read_b128 a[172:175], v19 offset:19456
    ds_write_b64 v12, v[32:33]
    s_xor_b32 s101, s16, 98304
    v_xor_b32 v12, 8192, v12
    v_add_u32 v9, s101, v1
    v_xor_b32 v8, 8192, v16
    v_xor_b32 v10, 8192, v9
    s_branch L_t1_join
L_t1_redo:
    s_cmp_eq_u32 s25, 0
    s_cbranch_scc1 L_t1_max
    s_mov_b32 s25, 0
    v_mov_b32 v64, 0
    v_mov_b32 v65, 0
    v_mov_b32 v66, 0
    v_mov_b32 v67, 0
    v_mov_b32 v68, 0
    v_mov_b32 v69, 0
    v_mov_b32 v70, 0
    v_mov_b32 v71, 0
    v_mov_b32 v72, 0
    v_mov_b32 v73, 0
    v_mov_b32 v74, 0
    v_mov_b32 v75, 0
    v_mov_b32 v76, 0
    v_mov_b32 v77, 0
    v_mov_b32 v78, 0
    v_mov_b32 v79, 0
    s_nop 1
    s_branch L_t1_safe
L_t1_max:
    s_waitcnt vmcnt(0) lgkmcnt(0)
    s_barrier
    s_mov_b32 s25, 1
    s_and_b32 s100, s3, 1
    s_lshl_b32 s100, s100, 13
    s_sub_u32 s101, s81, s62
    s_add_u32 s101, s101, s100
    s_mov_b32 s14, s60
    v_mov_b32 v48, 0xff800000
    v_mov_b32 v49, 0xff800000
    v_mov_b32 v50, 0xff800000
    v_mov_b32 v51, 0xff800000
L_t1_maxl:
    s_cmp_eq_u32 s14, 0
    s_cbranch_scc1 L_t1_maxd
    s_add_u32 s100, s101, 0
    buffer_load_dwordx4 a[128:131], v1, s[8:11], s100 offen offset:0
    buffer_load_dwordx4 a[132:135], v1, s[8:11], s100 offen offset:1024
    buffer_load_dwordx4 a[136:139], v1, s[8:11], s100 offen offset:2048
    buffer_load_dwordx4 a[140:143], v1, s[8:11], s100 offen offset:3072
    buffer_load_dwordx4 a[144:147], v15, s[8:11], s100 offen offset:0
    buffer_load_dwordx4 a[148:151], v15, s[8:11], s100 offen offset:1024
    buffer_load_dwordx4 a[152:155], v15, s[8:11], s100 offen offset:2048
    buffer_load_dwordx4 a[156:159], v15, s[8:11], s100 offen offset:3072
    s_waitcnt vmcnt(7)
    v_mfma_f32_16x16x32_bf16 v[96:99], a[128:131], a[64:67], v[64:67]
    s_waitcnt vmcnt(6)
    v_mfma_f32_16x16x32_bf16 v[96:99], a[132:135], a[68:71], v[96:99]
    s_waitcnt vmcnt(5)
    v_mfma_f32_16x16x32_bf16 v[96:99], a[136:139], a[72:75], v[96:99]
    s_waitcnt vmcnt(4)
    v_mfma_f32_16x16x32_bf16 v[96:99], a[140:143], a[76:79], v[96:99]
    v_mfma_f32_16x16x32_bf16 v[104:107], a[128:131], a[80:83], v[68:71]
    v_mfma_f32_16x16x32_bf16 v[104:107], a[132:135], a[84:87], v[104:107]
    v_mfma_f32_16x16x32_bf16 v[104:107], a[136:139], a[88:91], v[104:107]
    v_mfma_f32_16x16x32_bf16 v[104:107], a[140:143], a[92:95], v[104:107]
    s_waitcnt vmcnt(3)
    v_mfma_f32_16x16x32_bf16 v[100:103], a[144:147], a[64:67], v[64:67]
    s_waitcnt vmcnt(2)
    v_mfma_f32_16x16x32_bf16 v[100:103], a[148:151], a[68:71], v[100:103]
    s_waitcnt vmcnt(1)
    v_mfma_f32_16x16x32_bf16 v[100:103], a[152:155], a[72:75], v[100:103]
    s_waitcnt vmcnt(0)
    v_mfma_f32_16x16x32_bf16 v[100:103], a[156:159], a[76:79], v[100:103]
    v_mfma_f32_16x16x32_bf16 v[108:111], a[144:147], a[80:83], v[68:71]
    v_mfma_f32_16x16x32_bf16 v[108:111], a[148:151], a[84:87], v[108:111]
    v_mfma_f32_16x16x32_bf16 v[108:111], a[152:155], a[88:91], v[108:111]
    v_mfma_f32_16x16x32_bf16 v[108:111], a[156:159], a[92:95], v[108:111]
    v_mfma_f32_16x16x32_bf16 v[112:115], a[128:131], a[96:99], v[72:75]
    v_mfma_f32_16x16x32_bf16 v[112:115], a[132:135], a[100:103], v[112:115]
    v_mfma_f32_16x16x32_bf16 v[112:115], a[136:139], a[104:107], v[112:115]
    v_mfma_f32_16x16x32_bf16 v[112:115], a[140:143], a[108:111], v[112:115]
    v_mfma_f32_16x16x32_bf16 v[120:123], a[128:131], a[112:115], v[76:79]
    v_mfma_f32_16x16x32_bf16 v[120:123], a[132:135], a[116:119], v[120:123]
    v_mfma_f32_16x16x32_bf16 v[120:123], a[136:139], a[120:123], v[120:123]
    v_mfma_f32_16x16x32_bf16 v[120:123], a[140:143], a[124:127], v[120:123]
    v_mfma_f32_16x16x32_bf16 v[116:119], a[144:147], a[96:99], v[72:75]
    v_mfma_f32_16x16x32_bf16 v[116:119], a[148:151], a[100:103], v[116:119]
    v_mfma_f32_16x16x32_bf16 v[116:119], a[152:155], a[104:107], v[116:119]
    v_mfma_f32_16x16x32_bf16 v[116:119], a[156:159], a[108:111], v[116:119]
    v_mfma_f32_16x16x32_bf16 v[124:127], a[144:147], a[112:115], v[76:79]
    v_mfma_f32_16x16x32_bf16 v[124:127], a[148:151], a[116:119], v[124:127]
    v_mfma_f32_16x16x32_bf16 v[124:127], a[152:155], a[120:123], v[124:127]
    v_mfma_f32_16x16x32_bf16 v[124:127], a[156:159], a[124:127], v[124:127]
    v_max3_f32 v48, v48, v96, v97
    v_max3_f32 v48, v48, v98, v99
    v_max3_f32 v48, v48, v100, v101
    v_max3_f32 v48, v48, v102, v103
    v_max3_f32 v49, v49, v104, v105
    v_max3_f32 v49, v49, v106, v107
    v_max3_f32 v49, v49, v108, v109
    v_max3_f32 v49, v49, v110, v111
    v_max3_f32 v50, v50, v112, v113
    v_max3_f32 v50, v50, v114, v115
    v_max3_f32 v50, v50, v116, v117
    v_max3_f32 v50, v50, v118, v119
    v_max3_f32 v51, v51, v120, v121
    v_max3_f32 v51, v51, v122, v123
    v_max3_f32 v51, v51, v124, v125
    v_max3_f32 v51, v51, v126, v127
    s_add_u32 s100, s101, 16384
    buffer_load_dwordx4 a[128:131], v1, s[8:11], s100 offen offset:0
    buffer_load_dwordx4 a[132:135], v1, s[8:11], s100 offen offset:1024
    buffer_load_dwordx4 a[136:139], v1, s[8:11], s100 offen offset:2048
    buffer_load_dwordx4 a[140:143], v1, s[8:11], s100 offen offset:3072
    buffer_load_dwordx4 a[144:147], v15, s[8:11], s100 offen offset:0
    buffer_load_dwordx4 a[148:151], v15, s[8:11], s100 offen offset:1024
    buffer_load_dwordx4 a[152:155], v15, s[8:11], s100 offen offset:2048
    buffer_load_dwordx4 a[156:159], v15, s[8:11], s100 offen offset:3072
    s_waitcnt vmcnt(7)
    v_mfma_f32_16x16x32_bf16 v[96:99], a[128:131], a[64:67], v[64:67]
    s_waitcnt vmcnt(6)
    v_mfma_f32_16x16x32_bf16 v[96:99], a[132:135], a[68:71], v[96:99]
    s_waitcnt vmcnt(5)
    v_mfma_f32_16x16x32_bf16 v[96:99], a[136:139], a[72:75], v[96:99]
    s_waitcnt vmcnt(4)
    v_mfma_f32_16x16x32_bf16 v[96:99], a[140:143], a[76:79], v[96:99]
    v_mfma_f32_16x16x32_bf16 v[104:107], a[128:131], a[80:83], v[68:71]
    v_mfma_f32_16x16x32_bf16 v[104:107], a[132:135], a[84:87], v[104:107]
    v_mfma_f32_16x16x32_bf16 v[104:107], a[136:139], a[88:91], v[104:107]
    v_mfma_f32_16x16x32_bf16 v[104:107], a[140:143], a[92:95], v[104:107]
    s_waitcnt vmcnt(3)
    v_mfma_f32_16x16x32_bf16 v[100:103], a[144:147], a[64:67], v[64:67]
    s_waitcnt vmcnt(2)
    v_mfma_f32_16x16x32_bf16 v[100:103], a[148:151], a[68:71], v[100:103]
    s_waitcnt vmcnt(1)
    v_mfma_f32_16x16x32_bf16 v[100:103], a[152:155], a[72:75], v[100:103]
    s_waitcnt vmcnt(0)
    v_mfma_f32_16x16x32_bf16 v[100:103], a[156:159], a[76:79], v[100:103]
    v_mfma_f32_16x16x32_bf16 v[108:111], a[144:147], a[80:83], v[68:71]
    v_mfma_f32_16x16x32_bf16 v[108:111], a[148:151], a[84:87], v[108:111]
    v_mfma_f32_16x16x32_bf16 v[108:111], a[152:155], a[88:91], v[108:111]
    v_mfma_f32_16x16x32_bf16 v[108:111], a[156:159], a[92:95], v[108:111]
    v_mfma_f32_16x16x32_bf16 v[112:115], a[128:131], a[96:99], v[72:75]
    v_mfma_f32_16x16x32_bf16 v[112:115], a[132:135], a[100:103], v[112:115]
    v_mfma_f32_16x16x32_bf16 v[112:115], a[136:139], a[104:107], v[112:115]
    v_mfma_f32_16x16x32_bf16 v[112:115], a[140:143], a[108:111], v[112:115]
    v_mfma_f32_16x16x32_bf16 v[120:123], a[128:131], a[112:115], v[76:79]
    v_mfma_f32_16x16x32_bf16 v[120:123], a[132:135], a[116:119], v[120:123]
    v_mfma_f32_16x16x32_bf16 v[120:123], a[136:139], a[120:123], v[120:123]
    v_mfma_f32_16x16x32_bf16 v[120:123], a[140:143], a[124:127], v[120:123]
    v_mfma_f32_16x16x32_bf16 v[116:119], a[144:147], a[96:99], v[72:75]
    v_mfma_f32_16x16x32_bf16 v[116:119], a[148:151], a[100:103], v[116:119]
    v_mfma_f32_16x16x32_bf16 v[116:119], a[152:155], a[104:107], v[116:119]
    v_mfma_f32_16x16x32_bf16 v[116:119], a[156:159], a[108:111], v[116:119]
    v_mfma_f32_16x16x32_bf16 v[124:127], a[144:147], a[112:115], v[76:79]
    v_mfma_f32_16x16x32_bf16 v[124:127], a[148:151], a[116:119], v[124:127]
    v_mfma_f32_16x16x32_bf16 v[124:127], a[152:155], a[120:123], v[124:127]
    v_mfma_f32_16x16x32_bf16 v[124:127], a[156:159], a[124:127], v[124:127]
    v_max3_f32 v48, v48, v96, v97
    v_max3_f32 v48, v48, v98, v99
    v_max3_f32 v48, v48, v100, v101
    v_max3_f32 v48, v48, v102, v103
    v_max3_f32 v49, v49, v104, v105
    v_max3_f32 v49, v49, v106, v107
    v_max3_f32 v49, v49, v108, v109
    v_max3_f32 v49, v49, v110, v111
    v_max3_f32 v50, v50, v112, v113
    v_max3_f32 v50, v50, v114, v115
    v_max3_f32 v50, v50, v116, v117
    v_max3_f32 v50, v50, v118, v119
    v_max3_f32 v51, v51, v120, v121
    v_max3_f32 v51, v51, v122, v123
    v_max3_f32 v51, v51, v124, v125
    v_max3_f32 v51, v51, v126, v127
    s_add_u32 s101, s101, 65536
    s_sub_u32 s14, s14, 1
    s_nop 7
    s_branch L_t1_maxl
L_t1_maxd:
    s_add_u32 s100, s101, 0
    buffer_load_dwordx4 a[128:131], v1, s[8:11], s100 offen offset:0
    buffer_load_dwordx4 a[132:135], v1, s[8:11], s100 offen offset:1024
    buffer_load_dwordx4 a[136:139], v1, s[8:11], s100 offen offset:2048
    buffer_load_dwordx4 a[140:143], v1, s[8:11], s100 offen offset:3072
    buffer_load_dwordx4 a[144:147], v15, s[8:11], s100 offen offset:0
    buffer_load_dwordx4 a[148:151], v15, s[8:11], s100 offen offset:1024
    buffer_load_dwordx4 a[152:155], v15, s[8:11], s100 offen offset:2048
    buffer_load_dwordx4 a[156:159], v15, s[8:11], s100 offen offset:3072
    v_add_f32 v80, 0, v21
    v_min_f32 v80, v80, v64
    v_add_f32 v81, 0xf1800000, v21
    v_min_f32 v81, v81, v65
    v_add_f32 v82, 0xf2000000, v21
    v_min_f32 v82, v82, v66
    v_add_f32 v83, 0xf2400000, v21
    v_min_f32 v83, v83, v67
    v_add_f32 v84, 0xf3800000, v21
    v_min_f32 v84, v84, v64
    v_add_f32 v85, 0xf3880000, v21
    v_min_f32 v85, v85, v65
    v_add_f32 v86, 0xf3900000, v21
    v_min_f32 v86, v86, v66
    v_add_f32 v87, 0xf3980000, v21
    v_min_f32 v87, v87, v67
    v_add_f32 v88, 0x73800000, v21
    v_min_f32 v88, v88, v68
    v_add_f32 v89, 0x73700000, v21
    v_min_f32 v89, v89, v69
    v_add_f32 v90, 0x73600000, v21
    v_min_f32 v90, v90, v70
    v_add_f32 v91, 0x73500000, v21
    v_min_f32 v91, v91, v71
    v_add_f32 v92, 0, v21
    v_min_f32 v92, v92, v68
    v_add_f32 v93, 0xf1800000, v21
    v_min_f32 v93, v93, v69
    v_add_f32 v94, 0xf2000000, v21
    v_min_f32 v94, v94, v70
    v_add_f32 v95, 0xf2400000, v21
    v_min_f32 v95, v95, v71
    s_waitcnt vmcnt(7)
    v_mfma_f32_16x16x32_bf16 v[96:99], a[128:131], a[64:67], v[80:83]
    s_waitcnt vmcnt(6)
    v_mfma_f32_16x16x32_bf16 v[96:99], a[132:135], a[68:71], v[96:99]
    s_waitcnt vmcnt(5)
    v_mfma_f32_16x16x32_bf16 v[96:99], a[136:139], a[72:75], v[96:99]
    s_waitcnt vmcnt(4)
    v_mfma_f32_16x16x32_bf16 v[96:99], a[140:143], a[76:79], v[96:99]
    v_mfma_f32_16x16x32_bf16 v[104:107], a[128:131], a[80:83], v[88:91]
    v_mfma_f32_16x16x32_bf16 v[104:107], a[132:135], a[84:87], v[104:107]
    v_mfma_f32_16x16x32_bf16 v[104:107], a[136:139], a[88:91], v[104:107]
    v_mfma_f32_16x16x32_bf16 v[104:107], a[140:143], a[92:95], v[104:107]
    s_waitcnt vmcnt(3)
    v_mfma_f32_16x16x32_bf16 v[100:103], a[144:147], a[64:67], v[84:87]
    s_waitcnt vmcnt(2)
    v_mfma_f32_16x16x32_bf16 v[100:103], a[148:151], a[68:71], v[100:103]
    s_waitcnt vmcnt(1)
    v_mfma_f32_16x16x32_bf16 v[100:103], a[152:155], a[72:75], v[100:103]
    s_waitcnt vmcnt(0)
    v_mfma_f32_16x16x32_bf16 v[100:103], a[156:159], a[76:79], v[100:103]
    v_mfma_f32_16x16x32_bf16 v[108:111], a[144:147], a[80:83], v[92:95]
    v_mfma_f32_16x16x32_bf16 v[108:111], a[148:151], a[84:87], v[108:111]
    v_mfma_f32_16x16x32_bf16 v[108:111], a[152:155], a[88:91], v[108:111]
    v_mfma_f32_16x16x32_bf16 v[108:111], a[156:159], a[92:95], v[108:111]
    v_mfma_f32_16x16x32_bf16 v[112:115], a[128:131], a[96:99], v[72:75]
    v_mfma_f32_16x16x32_bf16 v[112:115], a[132:135], a[100:103], v[112:115]
    v_mfma_f32_16x16x32_bf16 v[112:115], a[136:139], a[104:107], v[112:115]
    v_mfma_f32_16x16x32_bf16 v[112:115], a[140:143], a[108:111], v[112:115]
    v_mfma_f32_16x16x32_bf16 v[120:123], a[128:131], a[112:115], v[76:79]
    v_mfma_f32_16x16x32_bf16 v[120:123], a[132:135], a[116:119], v[120:123]
    v_mfma_f32_16x16x32_bf16 v[120:123], a[136:139], a[120:123], v[120:123]
    v_mfma_f32_16x16x32_bf16 v[120:123], a[140:143], a[124:127], v[120:123]
    v_mfma_f32_16x16x32_bf16 v[116:119], a[144:147], a[96:99], v[72:75]
    v_mfma_f32_16x16x32_bf16 v[116:119], a[148:151], a[100:103], v[116:119]
    v_mfma_f32_16x16x32_bf16 v[116:119], a[152:155], a[104:107], v[116:119]
    v_mfma_f32_16x16x32_bf16 v[116:119], a[156:159], a[108:111], v[116:119]
    v_mfma_f32_16x16x32_bf16 v[124:127], a[144:147], a[112:115], v[76:79]
    v_mfma_f32_16x16x32_bf16 v[124:127], a[148:151], a[116:119], v[124:127]
    v_mfma_f32_16x16x32_bf16 v[124:127], a[152:155], a[120:123], v[124:127]
    v_mfma_f32_16x16x32_bf16 v[124:127], a[156:159], a[124:127], v[124:127]
    v_max3_f32 v48, v48, v96, v97
    v_max3_f32 v48, v48, v98, v99
    v_max3_f32 v48, v48, v100, v101
    v_max3_f32 v48, v48, v102, v103
    v_max3_f32 v49, v49, v104, v105
    v_max3_f32 v49, v49, v106, v107
    v_max3_f32 v49, v49, v108, v109
    v_max3_f32 v49, v49, v110, v111
    v_max3_f32 v50, v50, v112, v113
    v_max3_f32 v50, v50, v114, v115
    v_max3_f32 v50, v50, v116, v117
    v_max3_f32 v50, v50, v118, v119
    v_max3_f32 v51, v51, v120, v121
    v_max3_f32 v51, v51, v122, v123
    v_max3_f32 v51, v51, v124, v125
    v_max3_f32 v51, v51, v126, v127
    s_add_u32 s100, s101, 16384
    buffer_load_dwordx4 a[128:131], v1, s[8:11], s100 offen offset:0
    buffer_load_dwordx4 a[132:135], v1, s[8:11], s100 offen offset:1024
    buffer_load_dwordx4 a[136:139], v1, s[8:11], s100 offen offset:2048
    buffer_load_dwordx4 a[140:143], v1, s[8:11], s100 offen offset:3072
    buffer_load_dwordx4 a[144:147], v15, s[8:11], s100 offen offset:0
    buffer_load_dwordx4 a[148:151], v15, s[8:11], s100 offen offset:1024
    buffer_load_dwordx4 a[152:155], v15, s[8:11], s100 offen offset:2048
    buffer_load_dwordx4 a[156:159], v15, s[8:11], s100 offen offset:3072
    v_add_f32 v80, 0, v22
    v_min_f32 v80, v80, v72
    v_add_f32 v81, 0xf1800000, v22
    v_min_f32 v81, v81, v73
    v_add_f32 v82, 0xf2000000, v22
    v_min_f32 v82, v82, v74
    v_add_f32 v83, 0xf2400000, v22
    v_min_f32 v83, v83, v75
    v_add_f32 v84, 0xf3800000, v22
    v_min_f32 v84, v84, v72
    v_add_f32 v85, 0xf3880000, v22
    v_min_f32 v85, v85, v73
    v_add_f32 v86, 0xf3900000, v22
    v_min_f32 v86, v86, v74
    v_add_f32 v87, 0xf3980000, v22
    v_min_f32 v87, v87, v75
    v_add_f32 v88, 0x73800000, v22
    v_min_f32 v88, v88, v76
    v_add_f32 v89, 0x73700000, v22
    v_min_f32 v89, v89, v77
    v_add_f32 v90, 0x73600000, v22
    v_min_f32 v90, v90, v78
    v_add_f32 v91, 0x73500000, v22
    v_min_f32 v91, v91, v79
    v_add_f32 v92, 0, v22
    v_min_f32 v92, v92, v76
    v_add_f32 v93, 0xf1800000, v22
    v_min_f32 v93, v93, v77
    v_add_f32 v94, 0xf2000000, v22
    v_min_f32 v94, v94, v78
    v_add_f32 v95, 0xf2400000, v22
    v_min_f32 v95, v95, v79
    s_waitcnt vmcnt(7)
    v_mfma_f32_16x16x32_bf16 v[96:99], a[128:131], a[96:99], v[80:83]
    s_waitcnt vmcnt(6)
    v_mfma_f32_16x16x32_bf16 v[96:99], a[132:135], a[100:103], v[96:99]
    s_waitcnt vmcnt(5)
    v_mfma_f32_16x16x32_bf16 v[96:99], a[136:139], a[104:107], v[96:99]
    s_waitcnt vmcnt(4)
    v_mfma_f32_16x16x32_bf16 v[96:99], a[140:143], a[108:111], v[96:99]
    v_mfma_f32_16x16x32_bf16 v[104:107], a[128:131], a[112:115], v[88:91]
    v_mfma_f32_16x16x32_bf16 v[104:107], a[132:135], a[116:119], v[104:107]
    v_mfma_f32_16x16x32_bf16 v[104:107], a[136:139], a[120:123], v[104:107]
    v_mfma_f32_16x16x32_bf16 v[104:107], a[140:143], a[124:127], v[104:107]
    s_waitcnt vmcnt(3)
    v_mfma_f32_16x16x32_bf16 v[100:103], a[144:147], a[96:99], v[84:87]
    s_waitcnt vmcnt(2)
    v_mfma_f32_16x16x32_bf16 v[100:103], a[148:151], a[100:103], v[100:103]
    s_waitcnt vmcnt(1)
    v_mfma_f32_16x16x32_bf16 v[100:103], a[152:155], a[104:107], v[100:103]
    s_waitcnt vmcnt(0)
    v_mfma_f32_16x16x32_bf16 v[100:103], a[156:159], a[108:111], v[100:103]
    v_mfma_f32_16x16x32_bf16 v[108:111], a[144:147], a[112:115], v[92:95]
    v_mfma_f32_16x16x32_bf16 v[108:111], a[148:151], a[116:119], v[108:111]
    v_mfma_f32_16x16x32_bf16 v[108:111], a[152:155], a[120:123], v[108:111]
    v_mfma_f32_16x16x32_bf16 v[108:111], a[156:159], a[124:127], v[108:111]
    v_max3_f32 v50, v50, v96, v97
    v_max3_f32 v50, v50, v98, v99
    s_nop 1
    v_max3_f32 v50, v50, v100, v101
    v_max3_f32 v50, v50, v102, v103
    v_max3_f32 v51, v51, v104, v105
    v_max3_f32 v51, v51, v106, v107
    v_max3_f32 v51, v51, v108, v109
    v_max3_f32 v51, v51, v110, v111
    v_mov_b32 v52, v48
    v_mov_b32 v53, v49
    v_mov_b32 v54, v50
    v_mov_b32 v55, v51
    v_permlane16_swap_b32 v48, v52
    v_permlane16_swap_b32 v49, v53
    v_permlane16_swap_b32 v50, v54
    v_permlane16_swap_b32 v51, v55
    v_max_f32 v48, v48, v52
    v_max_f32 v49, v49, v53
    v_max_f32 v50, v50, v54
    v_max_f32 v51, v51, v55
    v_mov_b32 v52, v48
    v_mov_b32 v53, v49
    v_mov_b32 v54, v50
    v_mov_b32 v55, v51
    v_permlane32_swap_b32 v48, v52
    v_permlane32_swap_b32 v49, v53
    v_permlane32_swap_b32 v50, v54
    v_permlane32_swap_b32 v51, v55
    v_max_f32 v48, v48, v52
    v_max_f32 v49, v49, v53
    v_max_f32 v50, v50, v54
    v_max_f32 v51, v51, v55
    ds_write_b128 v16, v[48:51] offset:32768
    v_xor_b32 v8, 8192, v16
    s_waitcnt lgkmcnt(0)
    s_barrier
    ds_read_b128 v[52:55], v8 offset:32768
    s_waitcnt lgkmcnt(0)
    v_max_f32 v48, v48, v52
    v_max_f32 v49, v49, v53
    v_max_f32 v50, v50, v54
    v_max_f32 v51, v51, v55
    v_sub_f32 v64, 0, v48
    v_sub_f32 v65, 0, v48
    v_sub_f32 v66, 0, v48
    v_sub_f32 v67, 0, v48
    v_sub_f32 v68, 0, v49
    v_sub_f32 v69, 0, v49
    v_sub_f32 v70, 0, v49
    v_sub_f32 v71, 0, v49
    v_sub_f32 v72, 0, v50
    v_sub_f32 v73, 0, v50
    v_sub_f32 v74, 0, v50
    v_sub_f32 v75, 0, v50
    v_sub_f32 v76, 0, v51
    v_sub_f32 v77, 0, v51
    v_sub_f32 v78, 0, v51
    v_sub_f32 v79, 0, v51
    s_mov_b32 s12, 0
    s_and_b32 s100, s12, 1
    s_mul_i32 s15, s100, 196608
    s_xor_b32 s15, s15, 65536
    s_mul_i32 s16, s100, 98304
    s_xor_b32 s16, s16, 98304
    v_and_b32 v18, 0x7fff, v18
    v_or_b32 v18, s15, v18
    v_and_b32 v19, 0x7fff, v19
    v_or_b32 v19, s16, v19
    v_and_b32 v20, 0x7fff, v20
    v_or_b32 v20, s16, v20
    s_add_u32 s15, s15, s62
    s_add_u32 s16, s16, s62
    s_add_u32 s12, s12, 2
    s_mov_b32 s82, s81
    s_add_u32 s19, s81, 32768
    s_add_u32 m0, s15, 0
    s_nop 0
    buffer_load_dwordx4 v1, s[8:11], s82 offen offset:0 lds
    buffer_load_dwordx4 v1, s[8:11], s82 offen offset:1024 lds
    buffer_load_dwordx4 v1, s[8:11], s82 offen offset:2048 lds
    buffer_load_dwordx4 v1, s[8:11], s82 offen offset:3072 lds
    s_add_u32 m0, s15, 4096
    s_nop 0
    buffer_load_dwordx4 v15, s[8:11], s82 offen offset:0 lds
    buffer_load_dwordx4 v15, s[8:11], s82 offen offset:1024 lds
    buffer_load_dwordx4 v15, s[8:11], s82 offen offset:2048 lds
    buffer_load_dwordx4 v15, s[8:11], s82 offen offset:3072 lds
    s_xor_b32 s15, s15, 196608
    s_add_u32 m0, s16, 0
    s_nop 0
    buffer_load_dwordx4 v1, s[8:11], s19 offen offset:0 lds
    buffer_load_dwordx4 v1, s[8:11], s19 offen offset:1024 lds
    buffer_load_dwordx4 v1, s[8:11], s19 offen offset:2048 lds
    buffer_load_dwordx4 v1, s[8:11], s19 offen offset:3072 lds
    s_add_u32 m0, s16, 4096
    s_nop 0
    buffer_load_dwordx4 v15, s[8:11], s19 offen offset:0 lds
    buffer_load_dwordx4 v15, s[8:11], s19 offen offset:1024 lds
    buffer_load_dwordx4 v15, s[8:11], s19 offen offset:2048 lds
    buffer_load_dwordx4 v15, s[8:11], s19 offen offset:3072 lds
    s_xor_b32 s16, s16, 98304
    s_min_u32 s82, s60, 1
    s_lshl_b32 s82, s82, 16
    s_add_u32 s82, s82, s81
    s_add_u32 m0, s15, 0
    s_nop 0
    buffer_load_dwordx4 v1, s[8:11], s82 offen offset:0 lds
    buffer_load_dwordx4 v1, s[8:11], s82 offen offset:1024 lds
    buffer_load_dwordx4 v1, s[8:11], s82 offen offset:2048 lds
    buffer_load_dwordx4 v1, s[8:11], s82 offen offset:3072 lds
    s_add_u32 m0, s15, 4096
    s_nop 0
    buffer_load_dwordx4 v15, s[8:11], s82 offen offset:0 lds
    buffer_load_dwordx4 v15, s[8:11], s82 offen offset:1024 lds
    buffer_load_dwordx4 v15, s[8:11], s82 offen offset:2048 lds
    buffer_load_dwordx4 v15, s[8:11], s82 offen offset:3072 lds
    s_xor_b32 s15, s15, 196608
    s_cmp_eq_u32 s60, 0
    s_cselect_b32 s19, 0, 0x76800000
    v_add_f32 v3, s19, v21
    v_add_f32 v96, 0, v3
    v_min_f32 v96, v96, v64
    v_add_f32 v97, 0xf1800000, v3
    v_min_f32 v97, v97, v65
    v_add_f32 v98, 0xf2000000, v3
    v_min_f32 v98, v98, v66
    v_add_f32 v99, 0xf2400000, v3
    v_min_f32 v99, v99, v67
    v_add_f32 v100, 0xf3800000, v3
    v_min_f32 v100, v100, v64
    v_add_f32 v101, 0xf3880000, v3
    v_min_f32 v101, v101, v65
    v_add_f32 v102, 0xf3900000, v3
    v_min_f32 v102, v102, v66
    v_add_f32 v103, 0xf3980000, v3
    v_min_f32 v103, v103, v67
    v_add_f32 v104, 0x73800000, v3
    v_min_f32 v104, v104, v68
    v_add_f32 v105, 0x73700000, v3
    v_min_f32 v105, v105, v69
    v_add_f32 v106, 0x73600000, v3
    v_min_f32 v106, v106, v70
    v_add_f32 v107, 0x73500000, v3
    v_min_f32 v107, v107, v71
    v_add_f32 v108, 0, v3
    v_min_f32 v108, v108, v68
    v_add_f32 v109, 0xf1800000, v3
    v_min_f32 v109, v109, v69
    v_add_f32 v110, 0xf2000000, v3
    v_min_f32 v110, v110, v70
    v_add_f32 v111, 0xf2400000, v3
    v_min_f32 v111, v111, v71
    v_add_f32 v80, 0, v22
    v_min_f32 v80, v80, v72
    v_add_f32 v81, 0xf1800000, v22
    v_min_f32 v81, v81, v73
    v_add_f32 v82, 0xf2000000, v22
    v_min_f32 v82, v82, v74
    v_add_f32 v83, 0xf2400000, v22
    v_min_f32 v83, v83, v75
    v_add_f32 v84, 0xf3800000, v22
    v_min_f32 v84, v84, v72
    v_add_f32 v85, 0xf3880000, v22
    v_min_f32 v85, v85, v73
    v_add_f32 v86, 0xf3900000, v22
    v_min_f32 v86, v86, v74
    v_add_f32 v87, 0xf3980000, v22
    v_min_f32 v87, v87, v75
    v_add_f32 v88, 0x73800000, v22
    v_min_f32 v88, v88, v76
    v_add_f32 v89, 0x73700000, v22
    v_min_f32 v89, v89, v77
    v_add_f32 v90, 0x73600000, v22
    v_min_f32 v90, v90, v78
    v_add_f32 v91, 0x73500000, v22
    v_min_f32 v91, v91, v79
    v_add_f32 v92, 0, v22
    v_min_f32 v92, v92, v76
    v_add_f32 v93, 0xf1800000, v22
    v_min_f32 v93, v93, v77
    v_add_f32 v94, 0xf2000000, v22
    v_min_f32 v94, v94, v78
    v_add_f32 v95, 0xf2400000, v22
    v_min_f32 v95, v95, v79
    s_cmp_eq_u32 s60, 0
    s_cbranch_scc1 L_t1_mk
    v_add_f32 v80, 0, v21
    v_min_f32 v80, v80, v64
    v_add_f32 v81, 0xf1800000, v21
    v_min_f32 v81, v81, v65
    v_add_f32 v82, 0xf2000000, v21
    v_min_f32 v82, v82, v66
    v_add_f32 v83, 0xf2400000, v21
    v_min_f32 v83, v83, v67
    v_add_f32 v84, 0xf3800000, v21
    v_min_f32 v84, v84, v64
    v_add_f32 v85, 0xf3880000, v21
    v_min_f32 v85, v85, v65
    v_add_f32 v86, 0xf3900000, v21
    v_min_f32 v86, v86, v66
    v_add_f32 v87, 0xf3980000, v21
    v_min_f32 v87, v87, v67
    v_add_f32 v88, 0x73800000, v21
    v_min_f32 v88, v88, v68
    v_add_f32 v89, 0x73700000, v21
    v_min_f32 v89, v89, v69
    v_add_f32 v90, 0x73600000, v21
    v_min_f32 v90, v90, v70
    v_add_f32 v91, 0x73500000, v21
    v_min_f32 v91, v91, v71
    v_add_f32 v92, 0, v21
    v_min_f32 v92, v92, v68
    v_add_f32 v93, 0xf1800000, v21
    v_min_f32 v93, v93, v69
    v_add_f32 v94, 0xf2000000, v21
    v_min_f32 v94, v94, v70
    v_add_f32 v95, 0xf2400000, v21
    v_min_f32 v95, v95, v71
L_t1_mk:
    s_waitcnt vmcnt(0) lgkmcnt(0)
    s_barrier
    ds_read_b128 a[128:131], v18 offset:0
    ds_read_b128 a[132:135], v18 offset:1024
    ds_read_b128 a[136:139], v18 offset:2048
    ds_read_b128 a[140:143], v18 offset:3072
    ds_read_b128 a[144:147], v18 offset:4096
    ds_read_b128 a[148:151], v18 offset:5120
    ds_read_b128 a[152:155], v18 offset:6144
    ds_read_b128 a[156:159], v18 offset:7168
    s_waitcnt lgkmcnt(0)
    s_branch L_t1_start
L_C1_slow_9:
    s_mov_b32 s99, 0
L_C1_slow_9_l:
    s_sleep 4
    buffer_load_dword v3, v4, s[8:11], s23 offen sc0 sc1
    s_add_u32 s99, s99, 1
    s_waitcnt vmcnt(0)
    v_cmp_ne_u32 vcc, 0, v3
    s_cmp_eq_u64 vcc, -1
    s_cbranch_scc1 L_C1_ok_10
    s_cmp_lt_u32 s99, 200000
    s_cbranch_scc1 L_C1_slow_9_l
    s_branch L_C1_ok_10
L_F_slow_11:
    s_mov_b32 s99, 0
L_F_slow_11_l:
    s_sleep 4
    buffer_load_dword v3, v12, s[8:11], s71 offen sc0 sc1
    s_add_u32 s99, s99, 1
    s_waitcnt vmcnt(0)
    v_cmp_ne_u32 vcc, 0, v3
    s_cmp_eq_u64 vcc, -1
    s_cbranch_scc1 L_F_ok_12
    s_cmp_lt_u32 s99, 200000
    s_cbranch_scc1 L_F_slow_11_l
    s_branch L_F_ok_12
L_t2_redo:
    s_cmp_eq_u32 s25, 0
    s_cbranch_scc1 L_t2_max
    s_mov_b32 s25, 0
    v_mov_b32 v64, 0
    v_mov_b32 v65, 0
    v_mov_b32 v66, 0
    v_mov_b32 v67, 0
    v_mov_b32 v68, 0
    v_mov_b32 v69, 0
    v_mov_b32 v70, 0
    v_mov_b32 v71, 0
    v_mov_b32 v72, 0
    v_mov_b32 v73, 0
    v_mov_b32 v74, 0
    v_mov_b32 v75, 0
    v_mov_b32 v76, 0
    v_mov_b32 v77, 0
    v_mov_b32 v78, 0
    v_mov_b32 v79, 0
    s_nop 1
    s_branch L_t2_safe
L_t2_max:
    s_waitcnt vmcnt(0) lgkmcnt(0)
    s_barrier
    s_mov_b32 s25, 1
    s_and_b32 s100, s3, 1
    s_lshl_b32 s100, s100, 13
    s_sub_u32 s101, s81, s62
    s_add_u32 s101, s101, s100
    s_mov_b32 s14, s61
    s_mov_b32 s26, 0
    v_mov_b32 v24, -1
    v_mov_b32 v25, -1
    v_mov_b32 v26, -1
    v_mov_b32 v27, -1
    v_mov_b32 v48, 0xff800000
    v_mov_b32 v49, 0xff800000
    v_mov_b32 v50, 0xff800000
    v_mov_b32 v51, 0xff800000
L_t2_maxl:
    s_cmp_eq_u32 s14, 0
    s_cbranch_scc1 L_t2_maxd
    s_add_u32 s100, s101, 0
    buffer_load_dwordx4 a[128:131], v1, s[8:11], s100 offen offset:0
    buffer_load_dwordx4 a[132:135], v1, s[8:11], s100 offen offset:1024
    buffer_load_dwordx4 a[136:139], v1, s[8:11], s100 offen offset:2048
    buffer_load_dwordx4 a[140:143], v1, s[8:11], s100 offen offset:3072
    buffer_load_dwordx4 a[144:147], v15, s[8:11], s100 offen offset:0
    buffer_load_dwordx4 a[148:151], v15, s[8:11], s100 offen offset:1024
    buffer_load_dwordx4 a[152:155], v15, s[8:11], s100 offen offset:2048
    buffer_load_dwordx4 a[156:159], v15, s[8:11], s100 offen offset:3072
    s_waitcnt vmcnt(7)
    v_mfma_f32_16x16x32_bf16 v[96:99], a[128:131], a[192:195], v[64:67]
    s_waitcnt vmcnt(6)
    v_mfma_f32_16x16x32_bf16 v[96:99], a[132:135], a[196:199], v[96:99]
    s_waitcnt vmcnt(5)
    v_mfma_f32_16x16x32_bf16 v[96:99], a[136:139], a[200:203], v[96:99]
    s_waitcnt vmcnt(4)
    v_mfma_f32_16x16x32_bf16 v[96:99], a[140:143], a[204:207], v[96:99]
    v_mfma_f32_16x16x32_bf16 v[104:107], a[128:131], a[208:211], v[68:71]
    v_mfma_f32_16x16x32_bf16 v[104:107], a[132:135], a[212:215], v[104:107]
    v_mfma_f32_16x16x32_bf16 v[104:107], a[136:139], a[216:219], v[104:107]
    v_mfma_f32_16x16x32_bf16 v[104:107], a[140:143], a[220:223], v[104:107]
    s_waitcnt vmcnt(3)
    v_mfma_f32_16x16x32_bf16 v[100:103], a[144:147], a[192:195], v[64:67]
    s_waitcnt vmcnt(2)
    v_mfma_f32_16x16x32_bf16 v[100:103], a[148:151], a[196:199], v[100:103]
    s_waitcnt vmcnt(1)
    v_mfma_f32_16x16x32_bf16 v[100:103], a[152:155], a[200:203], v[100:103]
    s_waitcnt vmcnt(0)
    v_mfma_f32_16x16x32_bf16 v[100:103], a[156:159], a[204:207], v[100:103]
    v_mfma_f32_16x16x32_bf16 v[108:111], a[144:147], a[208:211], v[68:71]
    v_mfma_f32_16x16x32_bf16 v[108:111], a[148:151], a[212:215], v[108:111]
    v_mfma_f32_16x16x32_bf16 v[108:111], a[152:155], a[216:219], v[108:111]
    v_mfma_f32_16x16x32_bf16 v[108:111], a[156:159], a[220:223], v[108:111]
    v_mfma_f32_16x16x32_bf16 v[112:115], a[128:131], a[224:227], v[72:75]
    v_mfma_f32_16x16x32_bf16 v[112:115], a[132:135], a[228:231], v[112:115]
    v_mfma_f32_16x16x32_bf16 v[112:115], a[136:139], a[232:235], v[112:115]
    v_mfma_f32_16x16x32_bf16 v[112:115], a[140:143], a[236:239], v[112:115]
    v_mfma_f32_16x16x32_bf16 v[120:123], a[128:131], a[240:243], v[76:79]
    v_mfma_f32_16x16x32_bf16 v[120:123], a[132:135], a[244:247], v[120:123]
    v_mfma_f32_16x16x32_bf16 v[120:123], a[136:139], a[248:251], v[120:123]
    v_mfma_f32_16x16x32_bf16 v[120:123], a[140:143], a[252:255], v[120:123]
    v_mfma_f32_16x16x32_bf16 v[116:119], a[144:147], a[224:227], v[72:75]
    v_mfma_f32_16x16x32_bf16 v[116:119], a[148:151], a[228:231], v[116:119]
    v_mfma_f32_16x16x32_bf16 v[116:119], a[152:155], a[232:235], v[116:119]
    v_mfma_f32_16x16x32_bf16 v[116:119], a[156:159], a[236:239], v[116:119]
    v_mfma_f32_16x16x32_bf16 v[124:127], a[144:147], a[240:243], v[76:79]
    v_mfma_f32_16x16x32_bf16 v[124:127], a[148:151], a[244:247], v[124:127]
    v_mfma_f32_16x16x32_bf16 v[124:127], a[152:155], a[248:251], v[124:127]
    v_mfma_f32_16x16x32_bf16 v[124:127], a[156:159], a[252:255], v[124:127]
    v_max3_f32 v48, v48, v96, v97
    v_max3_f32 v48, v48, v98, v99
    v_max3_f32 v48, v48, v100, v101
    v_max3_f32 v48, v48, v102, v103
    v_max3_f32 v49, v49, v104, v105
    v_max3_f32 v49, v49, v106, v107
    v_max3_f32 v49, v49, v108, v109
    v_max3_f32 v49, v49, v110, v111
    v_max3_f32 v50, v50, v112, v113
    v_max3_f32 v50, v50, v114, v115
    v_max3_f32 v50, v50, v116, v117
    v_max3_f32 v50, v50, v118, v119
    v_max3_f32 v51, v51, v120, v121
    v_max3_f32 v51, v51, v122, v123
    v_max3_f32 v51, v51, v124, v125
    v_max3_f32 v51, v51, v126, v127
    s_add_u32 s100, s101, 16384
    buffer_load_dwordx4 a[128:131], v1, s[8:11], s100 offen offset:0
    buffer_load_dwordx4 a[132:135], v1, s[8:11], s100 offen offset:1024
    buffer_load_dwordx4 a[136:139], v1, s[8:11], s100 offen offset:2048
    buffer_load_dwordx4 a[140:143], v1, s[8:11], s100 offen offset:3072
    buffer_load_dwordx4 a[144:147], v15, s[8:11], s100 offen offset:0
    buffer_load_dwordx4 a[148:151], v15, s[8:11], s100 offen offset:1024
    buffer_load_dwordx4 a[152:155], v15, s[8:11], s100 offen offset:2048
    buffer_load_dwordx4 a[156:159], v15, s[8:11], s100 offen offset:3072
    s_waitcnt vmcnt(7)
    v_mfma_f32_16x16x32_bf16 v[96:99], a[128:131], a[192:195], v[64:67]
    s_waitcnt vmcnt(6)
    v_mfma_f32_16x16x32_bf16 v[96:99], a[132:135], a[196:199], v[96:99]
    s_waitcnt vmcnt(5)
    v_mfma_f32_16x16x32_bf16 v[96:99], a[136:139], a[200:203], v[96:99]
    s_waitcnt vmcnt(4)
    v_mfma_f32_16x16x32_bf16 v[96:99], a[140:143], a[204:207], v[96:99]
    v_mfma_f32_16x16x32_bf16 v[104:107], a[128:131], a[208:211], v[68:71]
    v_mfma_f32_16x16x32_bf16 v[104:107], a[132:135], a[212:215], v[104:107]
    v_mfma_f32_16x16x32_bf16 v[104:107], a[136:139], a[216:219], v[104:107]
    v_mfma_f32_16x16x32_bf16 v[104:107], a[140:143], a[220:223], v[104:107]
    s_waitcnt vmcnt(3)
    v_mfma_f32_16x16x32_bf16 v[100:103], a[144:147], a[192:195], v[64:67]
    s_waitcnt vmcnt(2)
    v_mfma_f32_16x16x32_bf16 v[100:103], a[148:151], a[196:199], v[100:103]
    s_waitcnt vmcnt(1)
    v_mfma_f32_16x16x32_bf16 v[100:103], a[152:155], a[200:203], v[100:103]
    s_waitcnt vmcnt(0)
    v_mfma_f32_16x16x32_bf16 v[100:103], a[156:159], a[204:207], v[100:103]
    v_mfma_f32_16x16x32_bf16 v[108:111], a[144:147], a[208:211], v[68:71]
    v_mfma_f32_16x16x32_bf16 v[108:111], a[148:151], a[212:215], v[108:111]
    v_mfma_f32_16x16x32_bf16 v[108:111], a[152:155], a[216:219], v[108:111]
    v_mfma_f32_16x16x32_bf16 v[108:111], a[156:159], a[220:223], v[108:111]
    v_mfma_f32_16x16x32_bf16 v[112:115], a[128:131], a[224:227], v[72:75]
    v_mfma_f32_16x16x32_bf16 v[112:115], a[132:135], a[228:231], v[112:115]
    v_mfma_f32_16x16x32_bf16 v[112:115], a[136:139], a[232:235], v[112:115]
    v_mfma_f32_16x16x32_bf16 v[112:115], a[140:143], a[236:239], v[112:115]
    v_mfma_f32_16x16x32_bf16 v[120:123], a[128:131], a[240:243], v[76:79]
    v_mfma_f32_16x16x32_bf16 v[120:123], a[132:135], a[244:247], v[120:123]
    v_mfma_f32_16x16x32_bf16 v[120:123], a[136:139], a[248:251], v[120:123]
    v_mfma_f32_16x16x32_bf16 v[120:123], a[140:143], a[252:255], v[120:123]
    v_mfma_f32_16x16x32_bf16 v[116:119], a[144:147], a[224:227], v[72:75]
    v_mfma_f32_16x16x32_bf16 v[116:119], a[148:151], a[228:231], v[116:119]
    v_mfma_f32_16x16x32_bf16 v[116:119], a[152:155], a[232:235], v[116:119]
    v_mfma_f32_16x16x32_bf16 v[116:119], a[156:159], a[236:239], v[116:119]
    v_mfma_f32_16x16x32_bf16 v[124:127], a[144:147], a[240:243], v[76:79]
    v_mfma_f32_16x16x32_bf16 v[124:127], a[148:151], a[244:247], v[124:127]
    v_mfma_f32_16x16x32_bf16 v[124:127], a[152:155], a[248:251], v[124:127]
    v_mfma_f32_16x16x32_bf16 v[124:127], a[156:159], a[252:255], v[124:127]
    v_max3_f32 v48, v48, v96, v97
    v_max3_f32 v48, v48, v98, v99
    v_max3_f32 v48, v48, v100, v101
    v_max3_f32 v48, v48, v102, v103
    v_max3_f32 v49, v49, v104, v105
    v_max3_f32 v49, v49, v106, v107
    v_max3_f32 v49, v49, v108, v109
    v_max3_f32 v49, v49, v110, v111
    v_max3_f32 v50, v50, v112, v113
    v_max3_f32 v50, v50, v114, v115
    v_max3_f32 v50, v50, v116, v117
    v_max3_f32 v50, v50, v118, v119
    v_max3_f32 v51, v51, v120, v121
    v_max3_f32 v51, v51, v122, v123
    v_max3_f32 v51, v51, v124, v125
    v_max3_f32 v51, v51, v126, v127
    s_add_u32 s101, s101, 65536
    s_sub_u32 s14, s14, 1
    s_nop 7
    s_branch L_t2_maxl
L_t2_maxd:
    s_add_u32 s100, s101, 0
    buffer_load_dwordx4 a[128:131], v1, s[8:11], s100 offen offset:0
    buffer_load_dwordx4 a[132:135], v1, s[8:11], s100 offen offset:1024
    buffer_load_dwordx4 a[136:139], v1, s[8:11], s100 offen offset:2048
    buffer_load_dwordx4 a[140:143], v1, s[8:11], s100 offen offset:3072
    buffer_load_dwordx4 a[144:147], v15, s[8:11], s100 offen offset:0
    buffer_load_dwordx4 a[148:151], v15, s[8:11], s100 offen offset:1024
    buffer_load_dwordx4 a[152:155], v15, s[8:11], s100 offen offset:2048
    buffer_load_dwordx4 a[156:159], v15, s[8:11], s100 offen offset:3072
    v_add_f32 v80, 0, v21
    v_min_f32 v80, v80, v64
    v_add_f32 v81, 0xf1800000, v21
    v_min_f32 v81, v81, v65
    v_add_f32 v82, 0xf2000000, v21
    v_min_f32 v82, v82, v66
    v_add_f32 v83, 0xf2400000, v21
    v_min_f32 v83, v83, v67
    v_add_f32 v84, 0xf3800000, v21
    v_min_f32 v84, v84, v64
    v_add_f32 v85, 0xf3880000, v21
    v_min_f32 v85, v85, v65
    v_add_f32 v86, 0xf3900000, v21
    v_min_f32 v86, v86, v66
    v_add_f32 v87, 0xf3980000, v21
    v_min_f32 v87, v87, v67
    v_add_f32 v88, 0x73800000, v21
    v_min_f32 v88, v88, v68
    v_add_f32 v89, 0x73700000, v21
    v_min_f32 v89, v89, v69
    v_add_f32 v90, 0x73600000, v21
    v_min_f32 v90, v90, v70
    v_add_f32 v91, 0x73500000, v21
    v_min_f32 v91, v91, v71
    v_add_f32 v92, 0, v21
    v_min_f32 v92, v92, v68
    v_add_f32 v93, 0xf1800000, v21
    v_min_f32 v93, v93, v69
    v_add_f32 v94, 0xf2000000, v21
    v_min_f32 v94, v94, v70
    v_add_f32 v95, 0xf2400000, v21
    v_min_f32 v95, v95, v71
    s_waitcnt vmcnt(7)
    v_mfma_f32_16x16x32_bf16 v[96:99], a[128:131], a[192:195], v[80:83]
    s_waitcnt vmcnt(6)
    v_mfma_f32_16x16x32_bf16 v[96:99], a[132:135], a[196:199], v[96:99]
    s_waitcnt vmcnt(5)
    v_mfma_f32_16x16x32_bf16 v[96:99], a[136:139], a[200:203], v[96:99]
    s_waitcnt vmcnt(4)
    v_mfma_f32_16x16x32_bf16 v[96:99], a[140:143], a[204:207], v[96:99]
    v_mfma_f32_16x16x32_bf16 v[104:107], a[128:131], a[208:211], v[88:91]
    v_mfma_f32_16x16x32_bf16 v[104:107], a[132:135], a[212:215], v[104:107]
    v_mfma_f32_16x16x32_bf16 v[104:107], a[136:139], a[216:219], v[104:107]
    v_mfma_f32_16x16x32_bf16 v[104:107], a[140:143], a[220:223], v[104:107]
    s_waitcnt vmcnt(3)
    v_mfma_f32_16x16x32_bf16 v[100:103], a[144:147], a[192:195], v[84:87]
    s_waitcnt vmcnt(2)
    v_mfma_f32_16x16x32_bf16 v[100:103], a[148:151], a[196:199], v[100:103]
    s_waitcnt vmcnt(1)
    v_mfma_f32_16x16x32_bf16 v[100:103], a[152:155], a[200:203], v[100:103]
    s_waitcnt vmcnt(0)
    v_mfma_f32_16x16x32_bf16 v[100:103], a[156:159], a[204:207], v[100:103]
    v_mfma_f32_16x16x32_bf16 v[108:111], a[144:147], a[208:211], v[92:95]
    v_mfma_f32_16x16x32_bf16 v[108:111], a[148:151], a[212:215], v[108:111]
    v_mfma_f32_16x16x32_bf16 v[108:111], a[152:155], a[216:219], v[108:111]
    v_mfma_f32_16x16x32_bf16 v[108:111], a[156:159], a[220:223], v[108:111]
    v_mfma_f32_16x16x32_bf16 v[112:115], a[128:131], a[224:227], v[72:75]
    v_mfma_f32_16x16x32_bf16 v[112:115], a[132:135], a[228:231], v[112:115]
    v_mfma_f32_16x16x32_bf16 v[112:115], a[136:139], a[232:235], v[112:115]
    v_mfma_f32_16x16x32_bf16 v[112:115], a[140:143], a[236:239], v[112:115]
    v_mfma_f32_16x16x32_bf16 v[120:123], a[128:131], a[240:243], v[76:79]
    v_mfma_f32_16x16x32_bf16 v[120:123], a[132:135], a[244:247], v[120:123]
    v_mfma_f32_16x16x32_bf16 v[120:123], a[136:139], a[248:251], v[120:123]
    v_mfma_f32_16x16x32_bf16 v[120:123], a[140:143], a[252:255], v[120:123]
    v_mfma_f32_16x16x32_bf16 v[116:119], a[144:147], a[224:227], v[72:75]
    v_mfma_f32_16x16x32_bf16 v[116:119], a[148:151], a[228:231], v[116:119]
    v_mfma_f32_16x16x32_bf16 v[116:119], a[152:155], a[232:235], v[116:119]
    v_mfma_f32_16x16x32_bf16 v[116:119], a[156:159], a[236:239], v[116:119]
    v_mfma_f32_16x16x32_bf16 v[124:127], a[144:147], a[240:243], v[76:79]
    v_mfma_f32_16x16x32_bf16 v[124:127], a[148:151], a[244:247], v[124:127]
    v_mfma_f32_16x16x32_bf16 v[124:127], a[152:155], a[248:251], v[124:127]
    v_mfma_f32_16x16x32_bf16 v[124:127], a[156:159], a[252:255], v[124:127]
    v_max3_f32 v48, v48, v96, v97
    v_max3_f32 v48, v48, v98, v99
    v_max3_f32 v48, v48, v100, v101
    v_max3_f32 v48, v48, v102, v103
    v_max3_f32 v49, v49, v104, v105
    v_max3_f32 v49, v49, v106, v107
    v_max3_f32 v49, v49, v108, v109
    v_max3_f32 v49, v49, v110, v111
    v_max3_f32 v50, v50, v112, v113
    v_max3_f32 v50, v50, v114, v115
    v_max3_f32 v50, v50, v116, v117
    v_max3_f32 v50, v50, v118, v119
    v_max3_f32 v51, v51, v120, v121
    v_max3_f32 v51, v51, v122, v123
    v_max3_f32 v51, v51, v124, v125
    v_max3_f32 v51, v51, v126, v127
    s_add_u32 s100, s101, 16384
    buffer_load_dwordx4 a[128:131], v1, s[8:11], s100 offen offset:0
    buffer_load_dwordx4 a[132:135], v1, s[8:11], s100 offen offset:1024
    buffer_load_dwordx4 a[136:139], v1, s[8:11], s100 offen offset:2048
    buffer_load_dwordx4 a[140:143], v1, s[8:11], s100 offen offset:3072
    buffer_load_dwordx4 a[144:147], v15, s[8:11], s100 offen offset:0
    buffer_load_dwordx4 a[148:151], v15, s[8:11], s100 offen offset:1024
    buffer_load_dwordx4 a[152:155], v15, s[8:11], s100 offen offset:2048
    buffer_load_dwordx4 a[156:159], v15, s[8:11], s100 offen offset:3072
    v_add_f32 v80, 0, v22
    v_min_f32 v80, v80, v72
    v_add_f32 v81, 0xf1800000, v22
    v_min_f32 v81, v81, v73
    v_add_f32 v82, 0xf2000000, v22
    v_min_f32 v82, v82, v74
    v_add_f32 v83, 0xf2400000, v22
    v_min_f32 v83, v83, v75
    v_add_f32 v84, 0xf3800000, v22
    v_min_f32 v84, v84, v72
    v_add_f32 v85, 0xf3880000, v22
    v_min_f32 v85, v85, v73
    v_add_f32 v86, 0xf3900000, v22
    v_min_f32 v86, v86, v74
    v_add_f32 v87, 0xf3980000, v22
    v_min_f32 v87, v87, v75
    v_add_f32 v88, 0x73800000, v22
    v_min_f32 v88, v88, v76
    v_add_f32 v89, 0x73700000, v22
    v_min_f32 v89, v89, v77
    v_add_f32 v90, 0x73600000, v22
    v_min_f32 v90, v90, v78
    v_add_f32 v91, 0x73500000, v22
    v_min_f32 v91, v91, v79
    v_add_f32 v92, 0, v22
    v_min_f32 v92, v92, v76
    v_add_f32 v93, 0xf1800000, v22
    v_min_f32 v93, v93, v77
    v_add_f32 v94, 0xf2000000, v22
    v_min_f32 v94, v94, v78
    v_add_f32 v95, 0xf2400000, v22
    v_min_f32 v95, v95, v79
    s_waitcnt vmcnt(7)
    v_mfma_f32_16x16x32_bf16 v[96:99], a[128:131], a[224:227], v[80:83]
    s_waitcnt vmcnt(6)
    v_mfma_f32_16x16x32_bf16 v[96:99], a[132:135], a[228:231], v[96:99]
    s_waitcnt vmcnt(5)
    v_mfma_f32_16x16x32_bf16 v[96:99], a[136:139], a[232:235], v[96:99]
    s_waitcnt vmcnt(4)
    v_mfma_f32_16x16x32_bf16 v[96:99], a[140:143], a[236:239], v[96:99]
    v_mfma_f32_16x16x32_bf16 v[104:107], a[128:131], a[240:243], v[88:91]
    v_mfma_f32_16x16x32_bf16 v[104:107], a[132:135], a[244:247], v[104:107]
    v_mfma_f32_16x16x32_bf16 v[104:107], a[136:139], a[248:251], v[104:107]
    v_mfma_f32_16x16x32_bf16 v[104:107], a[140:143], a[252:255], v[104:107]
    s_waitcnt vmcnt(3)
    v_mfma_f32_16x16x32_bf16 v[100:103], a[144:147], a[224:227], v[84:87]
    s_waitcnt vmcnt(2)
    v_mfma_f32_16x16x32_bf16 v[100:103], a[148:151], a[228:231], v[100:103]
    s_waitcnt vmcnt(1)
    v_mfma_f32_16x16x32_bf16 v[100:103], a[152:155], a[232:235], v[100:103]
    s_waitcnt vmcnt(0)
    v_mfma_f32_16x16x32_bf16 v[100:103], a[156:159], a[236:239], v[100:103]
    v_mfma_f32_16x16x32_bf16 v[108:111], a[144:147], a[240:243], v[92:95]
    v_mfma_f32_16x16x32_bf16 v[108:111], a[148:151], a[244:247], v[108:111]
    v_mfma_f32_16x16x32_bf16 v[108:111], a[152:155], a[248:251], v[108:111]
    v_mfma_f32_16x16x32_bf16 v[108:111], a[156:159], a[252:255], v[108:111]
    v_max3_f32 v50, v50, v96, v97
    v_max3_f32 v50, v50, v98, v99
    s_nop 1
    v_max3_f32 v50, v50, v100, v101
    v_max3_f32 v50, v50, v102, v103
    v_max3_f32 v51, v51, v104, v105
    v_max3_f32 v51, v51, v106, v107
    v_max3_f32 v51, v51, v108, v109
    v_max3_f32 v51, v51, v110, v111
    v_mov_b32 v52, v48
    v_mov_b32 v53, v49
    v_mov_b32 v54, v50
    v_mov_b32 v55, v51
    v_permlane16_swap_b32 v48, v52
    v_permlane16_swap_b32 v49, v53
    v_permlane16_swap_b32 v50, v54
    v_permlane16_swap_b32 v51, v55
    v_max_f32 v48, v48, v52
    v_max_f32 v49, v49, v53
    v_max_f32 v50, v50, v54
    v_max_f32 v51, v51, v55
    v_mov_b32 v52, v48
    v_mov_b32 v53, v49
    v_mov_b32 v54, v50
    v_mov_b32 v55, v51
    v_permlane32_swap_b32 v48, v52
    v_permlane32_swap_b32 v49, v53
    v_permlane32_swap_b32 v50, v54
    v_permlane32_swap_b32 v51, v55
    v_max_f32 v48, v48, v52
    v_max_f32 v49, v49, v53
    v_max_f32 v50, v50, v54
    v_max_f32 v51, v51, v55
    ds_write_b128 v16, v[48:51] offset:32768
    v_xor_b32 v8, 8192, v16
    s_waitcnt lgkmcnt(0)
    s_barrier
    ds_read_b128 v[52:55], v8 offset:32768
    s_waitcnt lgkmcnt(0)
    v_max_f32 v48, v48, v52
    v_max_f32 v49, v49, v53
    v_max_f32 v50, v50, v54
    v_max_f32 v51, v51, v55
    v_sub_f32 v64, 0, v48
    v_sub_f32 v65, 0, v48
    v_sub_f32 v66, 0, v48
    v_sub_f32 v67, 0, v48
    v_sub_f32 v68, 0, v49
    v_sub_f32 v69, 0, v49
    v_sub_f32 v70, 0, v49
    v_sub_f32 v71, 0, v49
    v_sub_f32 v72, 0, v50
    v_sub_f32 v73, 0, v50
    v_sub_f32 v74, 0, v50
    v_sub_f32 v75, 0, v50
    v_sub_f32 v76, 0, v51
    v_sub_f32 v77, 0, v51
    v_sub_f32 v78, 0, v51
    v_sub_f32 v79, 0, v51
    s_add_u32 s12, s13, 1
    s_and_b32 s100, s12, 1
    s_mul_i32 s15, s100, 196608
    s_xor_b32 s15, s15, 65536
    s_mul_i32 s16, s100, 98304
    s_xor_b32 s16, s16, 98304
    v_and_b32 v18, 0x7fff, v18
    v_or_b32 v18, s15, v18
    v_and_b32 v19, 0x7fff, v19
    v_or_b32 v19, s16, v19
    v_and_b32 v20, 0x7fff, v20
    v_or_b32 v20, s16, v20
    s_add_u32 s15, s15, s62
    s_add_u32 s16, s16, s62
    s_add_u32 s12, s12, 2
    s_mov_b32 s82, s81
    s_add_u32 s19, s81, 32768
    s_add_u32 m0, s15, 0
    s_nop 0
    buffer_load_dwordx4 v1, s[8:11], s82 offen offset:0 lds
    buffer_load_dwordx4 v1, s[8:11], s82 offen offset:1024 lds
    buffer_load_dwordx4 v1, s[8:11], s82 offen offset:2048 lds
    buffer_load_dwordx4 v1, s[8:11], s82 offen offset:3072 lds
    s_add_u32 m0, s15, 4096
    s_nop 0
    buffer_load_dwordx4 v15, s[8:11], s82 offen offset:0 lds
    buffer_load_dwordx4 v15, s[8:11], s82 offen offset:1024 lds
    buffer_load_dwordx4 v15, s[8:11], s82 offen offset:2048 lds
    buffer_load_dwordx4 v15, s[8:11], s82 offen offset:3072 lds
    s_xor_b32 s15, s15, 196608
    s_add_u32 m0, s16, 0
    s_nop 0
    buffer_load_dwordx4 v1, s[8:11], s19 offen offset:0 lds
    buffer_load_dwordx4 v1, s[8:11], s19 offen offset:1024 lds
    buffer_load_dwordx4 v1, s[8:11], s19 offen offset:2048 lds
    buffer_load_dwordx4 v1, s[8:11], s19 offen offset:3072 lds
    s_add_u32 m0, s16, 4096
    s_nop 0
    buffer_load_dwordx4 v15, s[8:11], s19 offen offset:0 lds
    buffer_load_dwordx4 v15, s[8:11], s19 offen offset:1024 lds
    buffer_load_dwordx4 v15, s[8:11], s19 offen offset:2048 lds
    buffer_load_dwordx4 v15, s[8:11], s19 offen offset:3072 lds
    s_xor_b32 s16, s16, 98304
    s_min_u32 s82, s61, 1
    s_lshl_b32 s82, s82, 16
    s_add_u32 s82, s82, s81
    s_add_u32 m0, s15, 0
    s_nop 0
    buffer_load_dwordx4 v1, s[8:11], s82 offen offset:0 lds
    buffer_load_dwordx4 v1, s[8:11], s82 offen offset:1024 lds
    buffer_load_dwordx4 v1, s[8:11], s82 offen offset:2048 lds
    buffer_load_dwordx4 v1, s[8:11], s82 offen offset:3072 lds
    s_add_u32 m0, s15, 4096
    s_nop 0
    buffer_load_dwordx4 v15, s[8:11], s82 offen offset:0 lds
    buffer_load_dwordx4 v15, s[8:11], s82 offen offset:1024 lds
    buffer_load_dwordx4 v15, s[8:11], s82 offen offset:2048 lds
    buffer_load_dwordx4 v15, s[8:11], s82 offen offset:3072 lds
    s_xor_b32 s15, s15, 196608
    s_waitcnt vmcnt(0) lgkmcnt(0)
    s_barrier
    ds_read_b128 a[128:131], v18 offset:0
    ds_read_b128 a[132:135], v18 offset:1024
    ds_read_b128 a[136:139], v18 offset:2048
    ds_read_b128 a[140:143], v18 offset:3072
    ds_read_b128 a[144:147], v18 offset:4096
    ds_read_b128 a[148:151], v18 offset:5120
    ds_read_b128 a[152:155], v18 offset:6144
    ds_read_b128 a[156:159], v18 offset:7168
    s_waitcnt lgkmcnt(0)
    s_branch L_t2_start
L_C2_slow_13:
    s_mov_b32 s99, 0
L_C2_slow_13_l:
    s_sleep 4
    buffer_load_dword v3, v4, s[8:11], s23 offen sc0 sc1
    s_add_u32 s99, s99, 1
    s_waitcnt vmcnt(0)
    v_cmp_ne_u32 vcc, 0, v3
    s_cmp_eq_u64 vcc, -1
    s_cbranch_scc1 L_C2_ok_14
    s_cmp_lt_u32 s99, 200000
    s_cbranch_scc1 L_C2_slow_13_l
    s_branch L_C2_ok_14
L_P1_slow_15:
    s_mov_b32 s99, 0
L_P2_l_5001:
    s_waitcnt vmcnt(0)
    v_max_u32 v48, v128, v129
    v_max3_u32 v48, v48, v130, v131
    v_max_u32 v49, v132, v133
    v_max3_u32 v49, v49, v134, v135
    v_max_u32 v50, v136, v137
    v_max3_u32 v50, v50, v138, v139
    v_max_u32 v51, v140, v141
    v_max3_u32 v51, v51, v142, v143
    v_max_u32 v52, v144, v145
    v_max3_u32 v52, v52, v146, v147
    v_max_u32 v53, v148, v149
    v_max3_u32 v53, v53, v150, v151
    v_max_u32 v54, v152, v153
    v_max3_u32 v54, v54, v154, v155
    v_max_u32 v55, v156, v157
    v_max3_u32 v55, v55, v158, v159
    v_max3_u32 v3, v48, v49, v50
    v_max3_u32 v3, v3, v51, v52
    v_max3_u32 v3, v3, v53, v54
    v_max_u32 v3, v3, v55
    v_cmp_eq_u32 vcc, -1, v3
    s_add_u32 s99, s99, 1
    s_cbranch_vccz L_P2_ok_5002
    s_cmp_ge_u32 s99, 200000
    s_cbranch_scc1 L_P2_ok_5002
    s_sleep 1
    v_cmp_eq_u32 vcc, -1, v48
    s_cbranch_vccz L_P2_s_5003
    s_mov_b64 exec, vcc
    s_add_u32 s74, s70, 0
    buffer_load_dwordx4 v[128:131], v44, s[8:11], s74 offen sc0 sc1
    s_mov_b64 exec, -1
L_P2_s_5003:
    v_cmp_eq_u32 vcc, -1, v49
    s_cbranch_vccz L_P2_s_5004
    s_mov_b64 exec, vcc
    s_add_u32 s74, s70, 4096
    buffer_load_dwordx4 v[132:135], v44, s[8:11], s74 offen sc0 sc1
    s_mov_b64 exec, -1
L_P2_s_5004:
    v_cmp_eq_u32 vcc, -1, v50
    s_cbranch_vccz L_P2_s_5005
    s_mov_b64 exec, vcc
    s_add_u32 s74, s70, 8192
    buffer_load_dwordx4 v[136:139], v44, s[8:11], s74 offen sc0 sc1
    s_mov_b64 exec, -1
L_P2_s_5005:
    v_cmp_eq_u32 vcc, -1, v51
    s_cbranch_vccz L_P2_s_5006
    s_mov_b64 exec, vcc
    s_add_u32 s74, s70, 12288
    buffer_load_dwordx4 v[140:143], v44, s[8:11], s74 offen sc0 sc1
    s_mov_b64 exec, -1
L_P2_s_5006:
    v_cmp_eq_u32 vcc, -1, v52
    s_cbranch_vccz L_P2_s_5007
    s_mov_b64 exec, vcc
    s_add_u32 s74, s70, 16384
    buffer_load_dwordx4 v[144:147], v44, s[8:11], s74 offen sc0 sc1
    s_mov_b64 exec, -1
L_P2_s_5007:
    v_cmp_eq_u32 vcc, -1, v53
    s_cbranch_vccz L_P2_s_5008
    s_mov_b64 exec, vcc
    s_add_u32 s74, s70, 20480
    buffer_load_dwordx4 v[148:151], v44, s[8:11], s74 offen sc0 sc1
    s_mov_b64 exec, -1
L_P2_s_5008:
    v_cmp_eq_u32 vcc, -1, v54
    s_cbranch_vccz L_P2_s_5009
    s_mov_b64 exec, vcc
    s_add_u32 s74, s70, 24576
    buffer_load_dwordx4 v[152:155], v44, s[8:11], s74 offen sc0 sc1
    s_mov_b64 exec, -1
L_P2_s_5009:
    v_cmp_eq_u32 vcc, -1, v55
    s_cbranch_vccz L_P2_s_5010
    s_mov_b64 exec, vcc
    s_add_u32 s74, s70, 28672
    buffer_load_dwordx4 v[156:159], v44, s[8:11], s74 offen sc0 sc1
    s_mov_b64 exec, -1
L_P2_s_5010:
    s_branch L_P2_l_5001
L_P2_ok_5002:
    s_branch L_P1_ok_16
L_code_end:
    s_endpgm
.section .rodata,"a"
.p2align 6
.amdhsa_kernel adaLN_cond__compressed_kv_cla__moe_arch_mod__prompt_kernel
  .amdhsa_next_free_vgpr 512
  .amdhsa_next_free_sgpr 102
  .amdhsa_accum_offset 256
  .amdhsa_group_segment_fixed_size 0
  .amdhsa_kernarg_size 128
  .amdhsa_user_sgpr_count 2
  .amdhsa_user_sgpr_kernarg_segment_ptr 1
  .amdhsa_system_sgpr_workgroup_id_x 1
.end_amdhsa_kernel
```

```asm
; @launch grid=(256,1,1) block=(256,1,1) lds=163840
.amdgcn_target "amdgcn-amd-amdhsa--gfx950"
.text
.globl adaLN_cond__compressed_kv_cla__moe_arch_mod__prompt_kernel
.p2align 8
.type adaLN_cond__compressed_kv_cla__moe_arch_mod__prompt_kernel,@function
adaLN_cond__compressed_kv_cla__moe_arch_mod__prompt_kernel:
    s_cmp_ge_u32 s2, 256
    s_cbranch_scc1 L_end
    s_load_dwordx16 s[64:79], s[0:1], 0
    s_load_dwordx16 s[80:95], s[0:1], 64
    s_getpc_b64 s[100:101]
L_pf1:
    v_lshrrev_b32 v3, 6, v0
    v_and_b32 v2, 63, v0
    s_lshr_b32 s5, s2, 3
    s_mul_i32 s98, s5, 24
    v_min_u32 v5, 5, v2
    v_mad_u32_u24 v5, v3, 6, v5
    v_add_u32 v5, s98, v5
    v_lshlrev_b32 v5, 7, v5
    v_min_u32 v5, L_code_end-L_pf1, v5
    global_load_dword a255, v5, s[100:101]
    v_readfirstlane_b32 s3, v3
    v_lshlrev_b32 v1, 4, v2
    s_and_b32 s4, s2, 7
    s_and_b32 s5, s5, 3
    s_lshr_b32 s6, s2, 5
    s_lshl_b32 s7, s4, 2
    s_add_u32 s7, s7, s5
    s_mov_b32 s60, s6
    s_sub_u32 s61, 15, s6
    v_lshrrev_b32 v3, 3, v2
    v_lshrrev_b32 v4, 4, v2
    v_and_b32 v5, 7, v2
    v_xor_b32 v5, v5, v4
    v_lshlrev_b32 v5, 4, v5
    v_lshl_add_u32 v16, v3, 10, v5
    v_xor_b32 v17, 64, v16
    v_add_u32 v17, 7168, v17
    v_add_u32 v18, 14336, v16
    v_add_u32 v19, 14336, v17
    v_bfe_u32 v5, v2, 1, 3
    v_xor_b32 v5, v5, v4
    v_lshlrev_b32 v5, 5, v5
    v_and_b32 v6, 1, v2
    v_lshl_add_u32 v5, v6, 4, v5
    v_lshl_add_u32 v20, v4, 13, v5
    v_add_u32 v21, 31744, v20
    v_xor_b32 v22, 128, v20
    v_add_u32 v22, 63488, v22
    v_add_u32 v23, 31744, v22
    s_lshl_b32 s62, s3, 13
    s_lshl_b32 s63, s3, 12
    s_lshl_b32 s96, s6, 18
    s_lshl_b32 s98, s3, 16
    s_add_u32 s96, s96, s98
    s_lshl_b32 s97, s3, 17
    s_lshl_b32 s99, s5, 0
    s_xor_b32 s99, s99, s6
    s_lshl_b32 s99, s99, 3
    s_and_b32 s99, s99, 7
    s_lshl_b32 s98, s99, 7
    s_add_u32 s96, s96, s98
    s_lshl_b32 s98, s99, 19
    s_add_u32 s97, s97, s98
    v_and_b32 v84, 7, v2
    v_lshrrev_b32 v65, 3, v0
    v_mul_u32_u24 v64, 24576, v65
    v_lshl_add_u32 v64, v84, 4, v64
    v_lshlrev_b32 v65, 3, v65
    v_lshrrev_b32 v85, 3, v2
    v_lshlrev_b32 v86, 10, v84
    v_lshl_add_u32 v86, v85, 4, v86
    s_lshl_b32 s100, s7, 8
    s_waitcnt lgkmcnt(0)
    s_add_u32 s16, s70, s100
    s_addc_u32 s17, s71, 0
    s_sub_u32 s18, 4194304, s100
    s_mov_b32 s19, 0x00020000
    s_mov_b32 s12, s66
    s_mov_b32 s13, s67
    s_mov_b32 s14, 2097152
    s_mov_b32 s15, 0x00020000
    s_add_u32 m0, s63, 98304
    s_xor_b32 s98, s97, 0
    buffer_load_dwordx4 v20, s[16:19], s98 offen offset:0  lds
    buffer_load_dwordx4 v21, s[16:19], s98 offen offset:1024  lds
    buffer_load_dwordx4 v22, s[16:19], s98 offen offset:2048  lds
    buffer_load_dwordx4 v23, s[16:19], s98 offen offset:3072  lds
    s_add_u32 m0, s62, 0
    s_xor_b32 s98, s96, 0
    buffer_load_dwordx4 v16, s[12:15], s98 offen offset:0  lds
    buffer_load_dwordx4 v17, s[12:15], s98 offen offset:1024  lds
    buffer_load_dwordx4 v18, s[12:15], s98 offen offset:2048  lds
    buffer_load_dwordx4 v19, s[12:15], s98 offen offset:3072  lds
    s_add_u32 m0, s62, 4096
    s_xor_b32 s98, s96, 32768
    buffer_load_dwordx4 v16, s[12:15], s98 offen offset:0  lds
    buffer_load_dwordx4 v17, s[12:15], s98 offen offset:1024  lds
    buffer_load_dwordx4 v18, s[12:15], s98 offen offset:2048  lds
    buffer_load_dwordx4 v19, s[12:15], s98 offen offset:3072  lds
    s_mov_b32 s40, s88
    s_mov_b32 s41, s89
    s_mov_b32 s42, 3145728
    s_mov_b32 s43, 0x00020000
    s_mov_b32 s44, s86
    s_mov_b32 s45, s87
    s_mov_b32 s46, 1024
    s_mov_b32 s47, 0x00020000
    s_mov_b32 s32, s64
    s_mov_b32 s33, s65
    s_mov_b32 s34, 2097152
    s_mov_b32 s35, 0x00020000
    s_mov_b32 s8, s94
    s_mov_b32 s9, s95
    s_mov_b32 s10, 268435456
    s_mov_b32 s11, 0x00020000
    s_add_u32 s20, s72, s100
    s_addc_u32 s21, s73, 0
    s_sub_u32 s22, 4194304, s100
    s_mov_b32 s23, 0x00020000
    s_add_u32 s24, s68, s100
    s_addc_u32 s25, s69, 0
    s_sub_u32 s26, 4194304, s100
    s_mov_b32 s27, 0x00020000
    s_mov_b32 s36, s92
    s_mov_b32 s37, s93
    s_mov_b32 s38, 256
    s_mov_b32 s39, 0x00020000
    s_lshl_b32 s100, s4, 19
    s_lshl_b32 s99, s5, 8
    s_add_u32 s100, s100, s99
    s_add_u32 s28, s74, s100
    s_addc_u32 s29, s75, 0
    s_sub_u32 s30, 4194304, s100
    s_mov_b32 s31, 0x00020000
    s_mov_b32 s48, s84
    s_mov_b32 s49, s85
    s_mov_b32 s50, 1835008
    s_mov_b32 s51, 0x00020000
    s_mov_b32 s52, s90
    s_mov_b32 s53, s91
    s_mov_b32 s54, 2097152
    s_mov_b32 s55, 0x00020000
    s_mov_b64 s[92:93], s[80:81]
    s_mov_b64 s[94:95], s[82:83]
    s_mov_b32 s56, s78
    s_mov_b32 s57, s79
    s_mov_b32 s58, 1024
    s_mov_b32 s59, 0x00020000
    s_load_dword s90, s[36:37], 64
    s_load_dword s91, s[8:9], 0x3f00
    s_lshl_b32 s64, s3, 19
    s_and_b32 s100, s97, 3670016
    s_xor_b32 s64, s64, s100
    s_lshr_b32 s100, s6, 1
    s_and_b32 s100, s100, 0
    s_lshl_b32 s1, s100, 12
    s_lshl_b32 s100, s100, 7
    s_add_u32 s64, s64, s100
    s_lshl_b32 s100, s5, 1
    s_xor_b32 s100, s100, s6
    s_and_b32 s100, s100, 0
    s_lshl_b32 s68, s100, 11
    s_lshl_b32 s100, s100, 19
    s_lshl_b32 s0, s3, 17
    s_add_u32 s0, s0, s100
    s_lshl_b32 s81, s7, 20
    s_add_u32 s81, s81, 16777216
    s_lshl_b32 s100, s6, 17
    s_add_u32 s65, s81, s100
    s_lshr_b32 s100, s3, 1
    s_lshl_b32 s100, s100, 16
    s_add_u32 s65, s65, s100
    s_and_b32 s100, s3, 1
    s_lshl_b32 s100, s100, 14
    s_add_u32 s65, s65, s100
    s_add_u32 s81, s81, s62
    s_min_u32 s82, s60, 1
    s_lshl_b32 s82, s82, 16
    s_add_u32 s82, s82, s81
    s_sub_u32 s100, s6, 2
    s_lshl_b32 s69, s100, 7
    s_lshl_b32 s100, s100, 3
    s_add_u32 s100, s100, s4
    s_lshl_b32 s100, s100, 8
    s_mul_i32 s101, s5, 12288
    s_add_u32 s100, s100, s101
    s_add_u32 s100, s100, 16384
    s_cmp_ge_u32 s6, 2
    s_cselect_b32 s66, s100, 2147479552
    s_cselect_b32 s69, s69, 2147479552
    s_cmp_eq_u32 s3, 0
    s_cselect_b32 s66, s66, 2147479552
    s_lshl_b32 s70, s3, 9
    s_add_u32 s70, s70, 16384
    s_lshr_b32 s71, s2, 1
    s_lshl_b32 s71, s71, 14
    s_and_b32 s100, s2, 1
    s_lshl_b32 s100, s100, 7
    s_add_u32 s71, s71, s100
    s_add_u32 s71, s71, s63
    s_add_u32 s71, s71, 2097152
    s_lshl_b32 s72, s2, 2
    s_add_u32 s72, s72, s3
    s_lshl_b32 s72, s72, 6
    s_add_u32 s72, s72, 1048576
    s_lshl_b32 s74, s7, 11
    s_add_u32 s74, s74, 1114112
    s_lshl_b32 s73, s6, 2
    s_add_u32 s73, s73, s3
    s_lshl_b32 s73, s73, 6
    s_add_u32 s73, s73, s74
    s_lshr_b32 s100, s3, 1
    s_sub_u32 s101, 3, s100
    s_and_b32 s98, s3, 1
    s_cselect_b32 s100, s101, s100
    s_lshl_b32 s75, s60, 2
    s_add_u32 s75, s75, s100
    s_lshl_b32 s76, s61, 2
    s_add_u32 s76, s76, s100
    s_sub_u32 s77, s76, s75
    s_lshl_b32 s77, s77, 10
    s_lshl_b32 s78, s75, 10
    s_add_u32 s78, s78, 983040
    s_lshl_b32 s75, s75, 15
    s_add_u32 s75, s75, 2097152
    s_add_u32 s75, s75, s68
    s_lshl_b32 s76, s76, 15
    s_add_u32 s76, s76, 2097152
    s_add_u32 s76, s76, s68
    s_add_u32 s1, s1, s65
    s_cmp_eq_u32 s3, 0
    s_cselect_b32 s68, 32, 0
    s_cselect_b32 s67, 0, 2147479552
    v_and_b32 v48, 15, v2
    v_lshrrev_b32 v49, 4, v2
    v_lshrrev_b32 v50, 1, v48
    v_xor_b32 v50, v50, v49
    v_lshlrev_b32 v50, 4, v50
    v_lshl_add_u32 v28, v48, 7, v50
    v_add_u32 v28, s62, v28
    v_xor_b32 v29, 64, v28
    v_add_u32 v30, 65536, v28
    v_add_u32 v31, 65536, v29
    v_lshrrev_b32 v50, 2, v48
    v_and_b32 v51, 3, v48
    v_lshl_add_u32 v52, v49, 3, v50
    v_lshlrev_b32 v53, 8, v52
    v_lshl_add_u32 v53, v51, 3, v53
    v_add_u32 v53, 98304, v53
    v_and_b32 v54, 1, v49
    v_lshl_add_u32 v54, v54, 2, v50
    v_xor_b32 v55, 0, v54
    v_lshl_add_u32 v8, v55, 5, v53
    v_xor_b32 v55, 1, v54
    v_lshl_add_u32 v9, v55, 5, v53
    v_xor_b32 v55, 2, v54
    v_lshl_add_u32 v10, v55, 5, v53
    v_xor_b32 v55, 3, v54
    v_lshl_add_u32 v11, v55, 5, v53
    v_xor_b32 v55, 4, v54
    v_lshl_add_u32 v12, v55, 5, v53
    v_xor_b32 v55, 5, v54
    v_lshl_add_u32 v13, v55, 5, v53
    v_xor_b32 v55, 6, v54
    v_lshl_add_u32 v14, v55, 5, v53
    v_xor_b32 v55, 7, v54
    v_lshl_add_u32 v15, v55, 5, v53
    v_bfe_u32 v49, v2, 1, 2
    v_bfe_u32 v50, v2, 4, 1
    v_xor_b32 v49, v49, v50
    v_lshlrev_b32 v49, 5, v49
    v_and_b32 v50, 1, v2
    v_lshl_add_u32 v49, v50, 4, v49
    v_lshl_add_u32 v24, v85, 13, v49
    v_xor_b32 v25, 64, v24
    v_add_u32 v25, 64512, v25
    v_add_u32 v26, 129024, v24
    v_add_u32 v27, 129024, v25
    v_cmp_eq_u32 vcc, 0, v2
    v_mov_b32 v6, 2147479552
    s_nop 0
    v_cndmask_b32 v5, v6, v2, vcc
    v_cmp_eq_u32 vcc, 0, v0
    s_nop 1
    v_cndmask_b32 v7, v6, v0, vcc
    v_and_b32 v48, 8, v2
    v_cmp_eq_u32 vcc, 0, v48
    v_lshlrev_b32 v48, 5, v84
    v_lshrrev_b32 v49, 1, v2
    v_and_b32 v49, 24, v49
    v_add_u32 v48, v48, v49
    s_lshl_b32 s100, s3, 8
    s_add_u32 s100, s100, 147456
    v_add_u32 v48, s100, v48
    v_mov_b32 v49, 148480
    v_cndmask_b32 v98, v49, v48, vcc
    v_lshlrev_b32 v99, 5, v84
    v_add_u32 v99, 149504, v99
    s_lshl_b32 s100, s3, 3
    v_add_u32 v100, s100, v99
    v_lshlrev_b32 v106, 5, v85
    v_lshlrev_b32 v107, 8, v85
    v_lshl_add_u32 v107, v84, 4, v107
    s_sub_u32 s100, s2, 64
    s_lshl_b32 s80, s100, 12
    s_add_u32 s80, s80, 1048576
    s_cmp_lt_u32 s100, 64
    s_cselect_b32 s80, s80, 2147479552
    s_mul_i32 s99, s5, 786432
    s_sub_u32 s79, s6, 2
    s_lshl_b32 s79, s79, 3
    s_add_u32 s79, s79, s4
    s_lshl_b32 s79, s79, 7
    s_add_u32 s79, s79, s99
    s_cmp_ge_u32 s6, 2
    s_cselect_b32 s79, s79, 2147414016
    s_lshl_b32 s100, s5, 8
    v_add_u32 v65, s100, v65
    v_mov_b32 v6, 1
    v_and_b32 v4, 1, v2
    v_lshlrev_b32 v4, 7, v4
    buffer_load_dwordx2 v[66:67], v65, s[44:47], 0 offen
    buffer_load_dwordx4 v[68:71], v64, s[40:43], s79 offen
    s_add_u32 s79, s79, 6144
    buffer_load_dwordx4 v[72:75], v64, s[40:43], s79 offen
    s_add_u32 s79, s79, 6144
    buffer_load_dwordx4 v[76:79], v64, s[40:43], s79 offen
    s_add_u32 s79, s79, 6144
    buffer_load_dwordx4 v[80:83], v64, s[40:43], s79 offen
    s_lshl_b32 s79, s2, 5
    s_add_u32 s79, s79, s3
    s_lshl_b32 s79, s79, 8
    buffer_load_dwordx4 v[88:91], v86, s[32:35], s79 offen
    buffer_load_dwordx4 v[92:95], v86, s[32:35], s79 offen offset:128
    s_add_u32 m0, s63, 114688
    s_xor_b32 s98, s97, 524288
    buffer_load_dwordx4 v20, s[16:19], s98 offen offset:0  lds
    buffer_load_dwordx4 v21, s[16:19], s98 offen offset:1024  lds
    buffer_load_dwordx4 v22, s[16:19], s98 offen offset:2048  lds
    buffer_load_dwordx4 v23, s[16:19], s98 offen offset:3072  lds
    s_add_u32 m0, s62, 32768
    s_xor_b32 s98, s96, 128
    buffer_load_dwordx4 v16, s[12:15], s98 offen offset:0  lds
    buffer_load_dwordx4 v17, s[12:15], s98 offen offset:1024  lds
    buffer_load_dwordx4 v18, s[12:15], s98 offen offset:2048  lds
    buffer_load_dwordx4 v19, s[12:15], s98 offen offset:3072  lds
    s_add_u32 m0, s62, 36864
    s_xor_b32 s98, s96, 32896
    buffer_load_dwordx4 v16, s[12:15], s98 offen offset:0  lds
    buffer_load_dwordx4 v17, s[12:15], s98 offen offset:1024  lds
    buffer_load_dwordx4 v18, s[12:15], s98 offen offset:2048  lds
    buffer_load_dwordx4 v19, s[12:15], s98 offen offset:3072  lds
    s_waitcnt vmcnt(19) lgkmcnt(0)
    s_barrier
    ds_read_b64_tr_b16 v[32:33], v8 offset:0
    ds_read_b64_tr_b16 v[34:35], v8 offset:1024
    ds_read_b128 a[0:3], v28 offset:0
    ds_read_b128 a[4:7], v28 offset:2048
    ds_read_b128 a[8:11], v28 offset:4096
    ds_read_b128 a[12:15], v28 offset:6144
    ds_read_b64_tr_b16 v[36:37], v9 offset:0
    ds_read_b64_tr_b16 v[38:39], v9 offset:1024
    ds_read_b64_tr_b16 v[40:41], v10 offset:0
    ds_read_b64_tr_b16 v[42:43], v10 offset:1024
    ds_read_b64_tr_b16 v[44:45], v11 offset:0
    ds_read_b64_tr_b16 v[46:47], v11 offset:1024
    ds_read_b64_tr_b16 v[48:49], v12 offset:0
    ds_read_b64_tr_b16 v[50:51], v12 offset:1024
    ds_read_b64_tr_b16 v[52:53], v13 offset:0
    ds_read_b64_tr_b16 v[54:55], v13 offset:1024
    ds_read_b64_tr_b16 v[56:57], v14 offset:0
    ds_read_b64_tr_b16 v[58:59], v14 offset:1024
    ds_read_b64_tr_b16 v[60:61], v15 offset:0
    ds_read_b64_tr_b16 v[62:63], v15 offset:1024
    s_waitcnt lgkmcnt(15)
    v_mfma_f32_16x16x32_bf16 v[128:131], v[32:35], a[0:3], 0
    v_mfma_f32_16x16x32_bf16 v[160:163], v[32:35], a[4:7], 0
    v_mfma_f32_16x16x32_bf16 v[192:195], v[32:35], a[8:11], 0
    s_waitcnt lgkmcnt(14)
    s_add_u32 m0, s63, 131072
    s_xor_b32 s98, s97, 1048576
    ds_read_b128 a[16:19], v29 offset:0
    v_mfma_f32_16x16x32_bf16 v[224:227], v[32:35], a[12:15], 0
    s_waitcnt lgkmcnt(13)
    ds_read_b128 a[20:23], v29 offset:2048
    v_mfma_f32_16x16x32_bf16 v[132:135], v[36:39], a[0:3], 0
    ds_read_b64_tr_b16 v[32:33], v8 offset:8192
    v_mfma_f32_16x16x32_bf16 v[164:167], v[36:39], a[4:7], 0
    ds_read_b64_tr_b16 v[34:35], v8 offset:9216
    v_mfma_f32_16x16x32_bf16 v[196:199], v[36:39], a[8:11], 0
    ds_read_b128 a[24:27], v29 offset:4096
    v_mfma_f32_16x16x32_bf16 v[228:231], v[36:39], a[12:15], 0
    s_waitcnt lgkmcnt(15)
    ds_read_b128 a[28:31], v29 offset:6144
    v_mfma_f32_16x16x32_bf16 v[136:139], v[40:43], a[0:3], 0
    ds_read_b64_tr_b16 v[36:37], v9 offset:8192
    v_mfma_f32_16x16x32_bf16 v[168:171], v[40:43], a[4:7], 0
    s_waitcnt lgkmcnt(7)
    ds_read_b64_tr_b16 v[38:39], v9 offset:9216
    v_mfma_f32_16x16x32_bf16 v[200:203], v[40:43], a[8:11], 0
    buffer_load_dwordx4 v20, s[16:19], s98 offen offset:0  lds
    v_mfma_f32_16x16x32_bf16 v[232:235], v[40:43], a[12:15], 0
    buffer_load_dwordx4 v21, s[16:19], s98 offen offset:1024  lds
    v_mfma_f32_16x16x32_bf16 v[140:143], v[44:47], a[0:3], 0
    ds_read_b64_tr_b16 v[40:41], v10 offset:8192
    v_mfma_f32_16x16x32_bf16 v[172:175], v[44:47], a[4:7], 0
    ds_read_b64_tr_b16 v[42:43], v10 offset:9216
    v_mfma_f32_16x16x32_bf16 v[204:207], v[44:47], a[8:11], 0
    buffer_load_dwordx4 v22, s[16:19], s98 offen offset:2048  lds
    v_mfma_f32_16x16x32_bf16 v[236:239], v[44:47], a[12:15], 0
    buffer_load_dwordx4 v23, s[16:19], s98 offen offset:3072  lds
    v_mfma_f32_16x16x32_bf16 v[144:147], v[48:51], a[0:3], 0
    s_add_u32 m0, s62, 65536
    s_xor_b32 s98, s96, 256
    ds_read_b64_tr_b16 v[44:45], v11 offset:8192
    v_mfma_f32_16x16x32_bf16 v[176:179], v[48:51], a[4:7], 0
    ds_read_b64_tr_b16 v[46:47], v11 offset:9216
    v_mfma_f32_16x16x32_bf16 v[208:211], v[48:51], a[8:11], 0
    buffer_load_dwordx4 v16, s[12:15], s98 offen offset:0  lds
    v_mfma_f32_16x16x32_bf16 v[240:243], v[48:51], a[12:15], 0
    buffer_load_dwordx4 v17, s[12:15], s98 offen offset:1024  lds
    v_mfma_f32_16x16x32_bf16 v[148:151], v[52:55], a[0:3], 0
    ds_read_b64_tr_b16 v[48:49], v12 offset:8192
    v_mfma_f32_16x16x32_bf16 v[180:183], v[52:55], a[4:7], 0
    ds_read_b64_tr_b16 v[50:51], v12 offset:9216
    v_mfma_f32_16x16x32_bf16 v[212:215], v[52:55], a[8:11], 0
    buffer_load_dwordx4 v18, s[12:15], s98 offen offset:2048  lds
    v_mfma_f32_16x16x32_bf16 v[244:247], v[52:55], a[12:15], 0
    buffer_load_dwordx4 v19, s[12:15], s98 offen offset:3072  lds
    v_mfma_f32_16x16x32_bf16 v[152:155], v[56:59], a[0:3], 0
    s_add_u32 m0, s62, 69632
    s_xor_b32 s98, s96, 33024
    ds_read_b64_tr_b16 v[52:53], v13 offset:8192
    v_mfma_f32_16x16x32_bf16 v[184:187], v[56:59], a[4:7], 0
    ds_read_b64_tr_b16 v[54:55], v13 offset:9216
    v_mfma_f32_16x16x32_bf16 v[216:219], v[56:59], a[8:11], 0
    buffer_load_dwordx4 v16, s[12:15], s98 offen offset:0  lds
    v_mfma_f32_16x16x32_bf16 v[248:251], v[56:59], a[12:15], 0
    buffer_load_dwordx4 v17, s[12:15], s98 offen offset:1024  lds
    v_mfma_f32_16x16x32_bf16 v[156:159], v[60:63], a[0:3], 0
    ds_read_b64_tr_b16 v[56:57], v14 offset:8192
    v_mfma_f32_16x16x32_bf16 v[188:191], v[60:63], a[4:7], 0
    s_waitcnt lgkmcnt(5)
    ds_read_b64_tr_b16 v[58:59], v14 offset:9216
    v_mfma_f32_16x16x32_bf16 v[220:223], v[60:63], a[8:11], 0
    buffer_load_dwordx4 v18, s[12:15], s98 offen offset:2048  lds
    v_mfma_f32_16x16x32_bf16 v[252:255], v[60:63], a[12:15], 0
    buffer_load_dwordx4 v19, s[12:15], s98 offen offset:3072  lds
    v_mfma_f32_16x16x32_bf16 v[128:131], v[32:35], a[16:19], v[128:131]
    ds_read_b64_tr_b16 v[60:61], v15 offset:8192
    v_mfma_f32_16x16x32_bf16 v[160:163], v[32:35], a[20:23], v[160:163]
    ds_read_b64_tr_b16 v[62:63], v15 offset:9216
    v_mfma_f32_16x16x32_bf16 v[192:195], v[32:35], a[24:27], v[192:195]
    v_mfma_f32_16x16x32_bf16 v[224:227], v[32:35], a[28:31], v[224:227]
    v_mfma_f32_16x16x32_bf16 v[132:135], v[36:39], a[16:19], v[132:135]
    v_mfma_f32_16x16x32_bf16 v[164:167], v[36:39], a[20:23], v[164:167]
    v_mfma_f32_16x16x32_bf16 v[196:199], v[36:39], a[24:27], v[196:199]
    v_mfma_f32_16x16x32_bf16 v[228:231], v[36:39], a[28:31], v[228:231]
    v_mfma_f32_16x16x32_bf16 v[136:139], v[40:43], a[16:19], v[136:139]
    s_waitcnt vmcnt(12) lgkmcnt(0)
    s_barrier
    v_mfma_f32_16x16x32_bf16 v[168:171], v[40:43], a[20:23], v[168:171]
    s_add_u32 m0, s63, 98304
    s_xor_b32 s98, s97, 1572864
    ds_read_b64_tr_b16 v[32:33], v8 offset:16384
    v_lshlrev_b32 v102, 16, v66
    v_and_b32 v103, 0xffff0000, v66
    v_lshlrev_b32 v104, 16, v67
    v_mfma_f32_16x16x32_bf16 v[200:203], v[40:43], a[24:27], v[200:203]
    ds_read_b64_tr_b16 v[34:35], v8 offset:17408
    v_and_b32 v105, 0xffff0000, v67
    v_mul_f32 v108, 0xbfb8aa3b, v102
    v_mul_f32 v109, 0xbfb8aa3b, v103
    v_mfma_f32_16x16x32_bf16 v[232:235], v[40:43], a[28:31], v[232:235]
    ds_read_b64_tr_b16 v[36:37], v9 offset:16384
    v_mul_f32 v110, 0xbfb8aa3b, v104
    v_mul_f32 v111, 0xbfb8aa3b, v105
    v_mfma_f32_16x16x32_bf16 v[140:143], v[44:47], a[16:19], v[140:143]
    ds_read_b64_tr_b16 v[38:39], v9 offset:17408
    v_exp_f32 v108, v108
    v_mfma_f32_16x16x32_bf16 v[172:175], v[44:47], a[20:23], v[172:175]
    ds_read_b64_tr_b16 v[40:41], v10 offset:16384
    v_exp_f32 v109, v109
    v_mfma_f32_16x16x32_bf16 v[204:207], v[44:47], a[24:27], v[204:207]
    ds_read_b64_tr_b16 v[42:43], v10 offset:17408
    v_exp_f32 v110, v110
    v_mfma_f32_16x16x32_bf16 v[236:239], v[44:47], a[28:31], v[236:239]
    ds_read_b128 a[32:35], v28 offset:32768
    v_exp_f32 v111, v111
    v_add_f32 v108, 1.0, v108
    v_mfma_f32_16x16x32_bf16 v[144:147], v[48:51], a[16:19], v[144:147]
    ds_read_b64_tr_b16 v[44:45], v11 offset:16384
    v_add_f32 v109, 1.0, v109
    v_add_f32 v110, 1.0, v110
    v_add_f32 v111, 1.0, v111
    v_mfma_f32_16x16x32_bf16 v[176:179], v[48:51], a[20:23], v[176:179]
    ds_read_b64_tr_b16 v[46:47], v11 offset:17408
    v_rcp_f32 v108, v108
    v_mfma_f32_16x16x32_bf16 v[208:211], v[48:51], a[24:27], v[208:211]
    ds_read_b128 a[36:39], v28 offset:34816
    v_mov_b32 v112, 0
    v_rcp_f32 v109, v109
    v_mfma_f32_16x16x32_bf16 v[240:243], v[48:51], a[28:31], v[240:243]
    ds_read_b128 a[40:43], v28 offset:36864
    v_mov_b32 v113, 0
    v_rcp_f32 v110, v110
    v_mfma_f32_16x16x32_bf16 v[148:151], v[52:55], a[16:19], v[148:151]
    ds_read_b64_tr_b16 v[48:49], v12 offset:16384
    v_mov_b32 v114, 0
    v_rcp_f32 v111, v111
    v_mfma_f32_16x16x32_bf16 v[180:183], v[52:55], a[20:23], v[180:183]
    ds_read_b64_tr_b16 v[50:51], v12 offset:17408
    v_mov_b32 v115, 0
    v_mul_f32 v102, v102, v108
    v_mul_f32 v103, v103, v109
    v_mfma_f32_16x16x32_bf16 v[212:215], v[52:55], a[24:27], v[212:215]
    ds_read_b128 a[44:47], v28 offset:38912
    v_lshlrev_b32 v116, 4, v0
    v_mul_f32 v104, v104, v110
    v_mul_f32 v105, v105, v111
    v_mfma_f32_16x16x32_bf16 v[244:247], v[52:55], a[28:31], v[244:247]
    buffer_load_dwordx4 v20, s[16:19], s98 offen offset:0  lds
    v_cvt_pk_bf16_f32 v108, v102, v103
    v_cvt_pk_bf16_f32 v109, v104, v105
    v_mfma_f32_16x16x32_bf16 v[152:155], v[56:59], a[16:19], v[152:155]
    ds_read_b64_tr_b16 v[52:53], v13 offset:16384
    v_lshlrev_b32 v102, 16, v108
    v_and_b32 v103, 0xffff0000, v108
    v_lshlrev_b32 v104, 16, v109
    v_mfma_f32_16x16x32_bf16 v[184:187], v[56:59], a[20:23], v[184:187]
    ds_read_b64_tr_b16 v[54:55], v13 offset:17408
    v_and_b32 v105, 0xffff0000, v109
    v_lshlrev_b32 v108, 16, v68
    v_and_b32 v109, 0xffff0000, v68
    v_mfma_f32_16x16x32_bf16 v[216:219], v[56:59], a[24:27], v[216:219]
    buffer_load_dwordx4 v21, s[16:19], s98 offen offset:1024  lds
    v_mul_f32 v120, v108, v102
    v_mul_f32 v121, v109, v102
    v_mfma_f32_16x16x32_bf16 v[248:251], v[56:59], a[28:31], v[248:251]
    buffer_store_dwordx4 v[112:115], v116, s[8:11], s80 offen sc0 sc1
    v_lshlrev_b32 v110, 16, v69
    v_and_b32 v111, 0xffff0000, v69
    v_mfma_f32_16x16x32_bf16 v[156:159], v[60:63], a[16:19], v[156:159]
    ds_read_b64_tr_b16 v[56:57], v14 offset:16384
    v_lshlrev_b32 v117, 13, v2
    v_mul_f32 v122, v110, v102
    v_mul_f32 v123, v111, v102
    v_mfma_f32_16x16x32_bf16 v[188:191], v[60:63], a[20:23], v[188:191]
    s_lshl_b32 s100, s6, 19
    s_and_b32 s101, s3, 1
    ds_read_b64_tr_b16 v[58:59], v14 offset:17408
    v_lshlrev_b32 v108, 16, v70
    v_and_b32 v109, 0xffff0000, v70
    v_mul_f32 v124, v108, v102
    v_mfma_f32_16x16x32_bf16 v[220:223], v[60:63], a[24:27], v[220:223]
    buffer_load_dwordx4 v22, s[16:19], s98 offen offset:2048  lds
    v_mul_f32 v125, v109, v102
    v_lshlrev_b32 v110, 16, v71
    v_mfma_f32_16x16x32_bf16 v[252:255], v[60:63], a[28:31], v[252:255]
    s_waitcnt lgkmcnt(5)
    s_lshl_b32 s101, s101, 7
    s_add_u32 s100, s100, s101
    v_min_u32 v116, 496, v116
    v_and_b32 v111, 0xffff0000, v71
    v_mul_f32 v126, v110, v102
    v_mul_f32 v127, v111, v102
    v_mfma_f32_16x16x32_bf16 v[128:131], v[32:35], a[32:35], v[128:131]
    s_sub_u32 s80, s80, 1048576
    s_lshr_b32 s80, s80, 3
    ds_read_b64_tr_b16 v[60:61], v15 offset:16384
    v_lshlrev_b32 v108, 16, v72
    v_and_b32 v109, 0xffff0000, v72
    v_fmac_f32 v120, v108, v103
    v_mfma_f32_16x16x32_bf16 v[160:163], v[32:35], a[36:39], v[160:163]
    s_add_u32 s80, s80, 1310720
    s_cmp_lt_u32 s80, 1343488
    s_cselect_b32 s80, s80, 2147479552
    ds_read_b64_tr_b16 v[62:63], v15 offset:17408
    v_fmac_f32 v121, v109, v103
    v_lshlrev_b32 v110, 16, v73
    v_and_b32 v111, 0xffff0000, v73
    v_mfma_f32_16x16x32_bf16 v[192:195], v[32:35], a[40:43], v[192:195]
    s_waitcnt lgkmcnt(5)
    ds_read_b128 a[48:51], v29 offset:32768
    v_fmac_f32 v122, v110, v103
    v_fmac_f32 v123, v111, v103
    v_lshlrev_b32 v108, 16, v74
    v_mfma_f32_16x16x32_bf16 v[224:227], v[32:35], a[44:47], v[224:227]
    ds_read_b128 a[52:55], v29 offset:34816
    v_and_b32 v109, 0xffff0000, v74
    v_fmac_f32 v124, v108, v103
    v_fmac_f32 v125, v109, v103
    v_mfma_f32_16x16x32_bf16 v[132:135], v[36:39], a[32:35], v[132:135]
    ds_read_b64_tr_b16 v[32:33], v8 offset:24576
    v_lshlrev_b32 v110, 16, v75
    v_and_b32 v111, 0xffff0000, v75
    v_fmac_f32 v126, v110, v103
    v_mfma_f32_16x16x32_bf16 v[164:167], v[36:39], a[36:39], v[164:167]
    ds_read_b64_tr_b16 v[34:35], v8 offset:25600
    v_fmac_f32 v127, v111, v103
    v_lshlrev_b32 v108, 16, v76
    v_and_b32 v109, 0xffff0000, v76
    v_mfma_f32_16x16x32_bf16 v[196:199], v[36:39], a[40:43], v[196:199]
    ds_read_b128 a[56:59], v29 offset:36864
    v_fmac_f32 v120, v108, v104
    v_fmac_f32 v121, v109, v104
    v_lshlrev_b32 v110, 16, v77
    v_mfma_f32_16x16x32_bf16 v[228:231], v[36:39], a[44:47], v[228:231]
    ds_read_b128 a[60:63], v29 offset:38912
    v_and_b32 v111, 0xffff0000, v77
    v_fmac_f32 v122, v110, v104
    v_fmac_f32 v123, v111, v104
    v_mfma_f32_16x16x32_bf16 v[136:139], v[40:43], a[32:35], v[136:139]
    ds_read_b64_tr_b16 v[36:37], v9 offset:24576
    v_lshlrev_b32 v108, 16, v78
    v_and_b32 v109, 0xffff0000, v78
    v_fmac_f32 v124, v108, v104
    v_mfma_f32_16x16x32_bf16 v[168:171], v[40:43], a[36:39], v[168:171]
    ds_read_b64_tr_b16 v[38:39], v9 offset:25600
    v_fmac_f32 v125, v109, v104
    v_lshlrev_b32 v110, 16, v79
    v_and_b32 v111, 0xffff0000, v79
    v_mfma_f32_16x16x32_bf16 v[200:203], v[40:43], a[40:43], v[200:203]
    buffer_load_dwordx4 v23, s[16:19], s98 offen offset:3072  lds
    v_fmac_f32 v126, v110, v104
    v_fmac_f32 v127, v111, v104
    v_mfma_f32_16x16x32_bf16 v[232:235], v[40:43], a[44:47], v[232:235]
    buffer_store_dwordx4 v[112:115], v116, s[8:11], s80 offen sc0 sc1
    v_lshlrev_b32 v108, 16, v80
    v_and_b32 v109, 0xffff0000, v80
    v_mfma_f32_16x16x32_bf16 v[140:143], v[44:47], a[32:35], v[140:143]
    s_add_u32 m0, s62, 0
    s_xor_b32 s98, s96, 384
    ds_read_b64_tr_b16 v[40:41], v10 offset:24576
    v_fmac_f32 v120, v108, v105
    v_fmac_f32 v121, v109, v105
    v_lshlrev_b32 v110, 16, v81
    v_mfma_f32_16x16x32_bf16 v[172:175], v[44:47], a[36:39], v[172:175]
    ds_read_b64_tr_b16 v[42:43], v10 offset:25600
    v_and_b32 v111, 0xffff0000, v81
    v_fmac_f32 v122, v110, v105
    v_fmac_f32 v123, v111, v105
    v_mfma_f32_16x16x32_bf16 v[204:207], v[44:47], a[40:43], v[204:207]
    buffer_load_dwordx4 v16, s[12:15], s98 offen offset:0  lds
    v_lshlrev_b32 v108, 16, v82
    v_and_b32 v109, 0xffff0000, v82
    v_mfma_f32_16x16x32_bf16 v[236:239], v[44:47], a[44:47], v[236:239]
    v_fmac_f32 v124, v108, v105
    v_fmac_f32 v125, v109, v105
    v_lshlrev_b32 v110, 16, v83
    v_and_b32 v111, 0xffff0000, v83
    v_mfma_f32_16x16x32_bf16 v[144:147], v[48:51], a[32:35], v[144:147]
    ds_read_b64_tr_b16 v[44:45], v11 offset:24576
    v_fmac_f32 v126, v110, v105
    v_fmac_f32 v127, v111, v105
    v_permlane32_swap_b32 v120, v124
    v_mfma_f32_16x16x32_bf16 v[176:179], v[48:51], a[36:39], v[176:179]
    ds_read_b64_tr_b16 v[46:47], v11 offset:25600
    v_permlane32_swap_b32 v121, v125
    v_permlane32_swap_b32 v122, v126
    v_permlane32_swap_b32 v123, v127
    v_mfma_f32_16x16x32_bf16 v[208:211], v[48:51], a[40:43], v[208:211]
    buffer_load_dwordx4 v17, s[12:15], s98 offen offset:1024  lds
    v_add_f32 v120, v120, v124
    v_add_f32 v121, v121, v125
    v_mfma_f32_16x16x32_bf16 v[240:243], v[48:51], a[44:47], v[240:243]
    s_waitcnt lgkmcnt(4)
    v_add_f32 v122, v122, v126
    v_add_f32 v123, v123, v127
    s_nop 0
    v_permlane16_swap_b32 v120, v122
    v_permlane16_swap_b32 v121, v123
    v_mfma_f32_16x16x32_bf16 v[148:151], v[52:55], a[32:35], v[148:151]
    ds_read_b64_tr_b16 v[48:49], v12 offset:24576
    v_add_f32 v120, v120, v122
    v_add_f32 v121, v121, v123
    s_nop 0
    v_add_f32_dpp v120, v120, v120 row_ror:8 row_mask:0xf bank_mask:0xf
    v_mfma_f32_16x16x32_bf16 v[180:183], v[52:55], a[36:39], v[180:183]
    ds_read_b64_tr_b16 v[50:51], v12 offset:25600
    v_add_f32_dpp v121, v121, v121 row_ror:8 row_mask:0xf bank_mask:0xf
    v_mfma_f32_16x16x32_bf16 v[212:215], v[52:55], a[40:43], v[212:215]
    buffer_load_dwordx4 v18, s[12:15], s98 offen offset:2048  lds
    ds_write_b64 v98, v[120:121]
    v_mfma_f32_16x16x32_bf16 v[244:247], v[52:55], a[44:47], v[244:247]
    v_mfma_f32_16x16x32_bf16 v[152:155], v[56:59], a[32:35], v[152:155]
    ds_read_b64_tr_b16 v[52:53], v13 offset:24576
    v_lshlrev_b32 v64, 16, v88
    v_mfma_f32_16x16x32_bf16 v[184:187], v[56:59], a[36:39], v[184:187]
    ds_read_b64_tr_b16 v[54:55], v13 offset:25600
    v_and_b32 v65, 0xffff0000, v88
    v_mfma_f32_16x16x32_bf16 v[216:219], v[56:59], a[40:43], v[216:219]
    buffer_load_dwordx4 v19, s[12:15], s98 offen offset:3072  lds
    v_mfma_f32_16x16x32_bf16 v[248:251], v[56:59], a[44:47], v[248:251]
    v_lshlrev_b32 v66, 16, v89
    v_and_b32 v67, 0xffff0000, v89
    v_mfma_f32_16x16x32_bf16 v[156:159], v[60:63], a[32:35], v[156:159]
    s_add_u32 m0, s62, 4096
    s_xor_b32 s98, s96, 33152
    ds_read_b64_tr_b16 v[56:57], v14 offset:24576
    v_mfma_f32_16x16x32_bf16 v[188:191], v[60:63], a[36:39], v[188:191]
    ds_read_b64_tr_b16 v[58:59], v14 offset:25600
    v_lshlrev_b32 v68, 16, v90
    v_mfma_f32_16x16x32_bf16 v[220:223], v[60:63], a[40:43], v[220:223]
    buffer_load_dwordx4 v16, s[12:15], s98 offen offset:0  lds
    v_mfma_f32_16x16x32_bf16 v[252:255], v[60:63], a[44:47], v[252:255]
    v_and_b32 v69, 0xffff0000, v90
    v_lshlrev_b32 v70, 16, v91
    v_mfma_f32_16x16x32_bf16 v[128:131], v[32:35], a[48:51], v[128:131]
    ds_read_b64_tr_b16 v[60:61], v15 offset:24576
    v_and_b32 v71, 0xffff0000, v91
    v_mfma_f32_16x16x32_bf16 v[160:163], v[32:35], a[52:55], v[160:163]
    ds_read_b64_tr_b16 v[62:63], v15 offset:25600
    v_lshlrev_b32 v72, 16, v92
    v_mfma_f32_16x16x32_bf16 v[192:195], v[32:35], a[56:59], v[192:195]
    buffer_load_dwordx4 v17, s[12:15], s98 offen offset:1024  lds
    v_mfma_f32_16x16x32_bf16 v[224:227], v[32:35], a[60:63], v[224:227]
    v_and_b32 v73, 0xffff0000, v92
    v_lshlrev_b32 v74, 16, v93
    v_mfma_f32_16x16x32_bf16 v[132:135], v[36:39], a[48:51], v[132:135]
    buffer_load_dwordx4 v18, s[12:15], s98 offen offset:2048  lds
    v_mfma_f32_16x16x32_bf16 v[164:167], v[36:39], a[52:55], v[164:167]
    v_and_b32 v75, 0xffff0000, v93
    v_lshlrev_b32 v76, 16, v94
    v_mfma_f32_16x16x32_bf16 v[196:199], v[36:39], a[56:59], v[196:199]
    buffer_load_dwordx4 v19, s[12:15], s98 offen offset:3072  lds
    s_cmp_eq_u32 s3, 0
    s_cselect_b32 s101, s100, 2147479552
    buffer_load_dword a241, v117, s[20:23], s101 offen offset:4
    v_mfma_f32_16x16x32_bf16 v[228:231], v[36:39], a[60:63], v[228:231]
    s_waitcnt lgkmcnt(2)
    v_and_b32 v77, 0xffff0000, v94
    v_lshlrev_b32 v78, 16, v95
    s_waitcnt vmcnt(9)
    v_mfma_f32_16x16x32_bf16 v[136:139], v[40:43], a[48:51], v[136:139]
    v_and_b32 v79, 0xffff0000, v95
    v_add_f32 v108, v64, v65
    s_waitcnt lgkmcnt(0)
    s_barrier
    v_mfma_f32_16x16x32_bf16 v[168:171], v[40:43], a[52:55], v[168:171]
    s_add_u32 m0, s63, 114688
    s_xor_b32 s98, s97, 2097152
    ds_read_b64_tr_b16 v[32:33], v8 offset:32768
    v_lshrrev_b32 v87, 2, v1
    v_add_u32 v101, 147456, v87
    v_mfma_f32_16x16x32_bf16 v[200:203], v[40:43], a[56:59], v[200:203]
    ds_read_b64_tr_b16 v[34:35], v8 offset:33792
    ds_read_b32 v102, v101
    v_mfma_f32_16x16x32_bf16 v[232:235], v[40:43], a[60:63], v[232:235]
    ds_read_b64_tr_b16 v[36:37], v9 offset:32768
    ds_read_b32 v103, v101 offset:256
    v_mfma_f32_16x16x32_bf16 v[140:143], v[44:47], a[48:51], v[140:143]
    ds_read_b64_tr_b16 v[38:39], v9 offset:33792
    ds_read_b32 v104, v101 offset:512
    v_mfma_f32_16x16x32_bf16 v[172:175], v[44:47], a[52:55], v[172:175]
    ds_read_b64_tr_b16 v[40:41], v10 offset:32768
    ds_read_b32 v105, v101 offset:768
    v_mfma_f32_16x16x32_bf16 v[204:207], v[44:47], a[56:59], v[204:207]
    ds_read_b64_tr_b16 v[42:43], v10 offset:33792
    v_add_f32 v109, v66, v67
    v_mfma_f32_16x16x32_bf16 v[236:239], v[44:47], a[60:63], v[236:239]
    ds_read_b128 a[64:67], v30 offset:0
    v_add_f32 v108, v108, v68
    v_mfma_f32_16x16x32_bf16 v[144:147], v[48:51], a[48:51], v[144:147]
    ds_read_b64_tr_b16 v[44:45], v11 offset:32768
    v_add_f32 v109, v109, v69
    v_mfma_f32_16x16x32_bf16 v[176:179], v[48:51], a[52:55], v[176:179]
    ds_read_b64_tr_b16 v[46:47], v11 offset:33792
    v_add_f32 v108, v108, v70
    v_mfma_f32_16x16x32_bf16 v[208:211], v[48:51], a[56:59], v[208:211]
    ds_read_b128 a[68:71], v30 offset:2048
    v_add_f32 v109, v109, v71
    v_mfma_f32_16x16x32_bf16 v[240:243], v[48:51], a[60:63], v[240:243]
    ds_read_b128 a[72:75], v30 offset:4096
    s_waitcnt lgkmcnt(10)
    v_add_f32 v102, v102, v103
    v_mfma_f32_16x16x32_bf16 v[148:151], v[52:55], a[48:51], v[148:151]
    ds_read_b64_tr_b16 v[48:49], v12 offset:32768
    s_waitcnt lgkmcnt(7)
    v_add_f32 v104, v104, v105
    v_mfma_f32_16x16x32_bf16 v[180:183], v[52:55], a[52:55], v[180:183]
    ds_read_b64_tr_b16 v[50:51], v12 offset:33792
    v_add_f32 v102, v102, v104
    buffer_store_dword v102, v87, s[8:11], s66 offen sc0 sc1
    v_mfma_f32_16x16x32_bf16 v[212:215], v[52:55], a[56:59], v[212:215]
    ds_read_b128 a[76:79], v30 offset:6144
    v_add_f32 v108, v108, v72
    v_mfma_f32_16x16x32_bf16 v[244:247], v[52:55], a[60:63], v[244:247]
    buffer_load_dwordx4 v20, s[16:19], s98 offen offset:0  lds
    v_mfma_f32_16x16x32_bf16 v[152:155], v[56:59], a[48:51], v[152:155]
    s_mov_b32 s40, s92
    s_mov_b32 s41, s93
    ds_read_b64_tr_b16 v[52:53], v13 offset:32768
    v_mfma_f32_16x16x32_bf16 v[184:187], v[56:59], a[52:55], v[184:187]
    s_mov_b32 s42, 1835008
    s_mov_b32 s44, s94
    ds_read_b64_tr_b16 v[54:55], v13 offset:33792
    v_mfma_f32_16x16x32_bf16 v[216:219], v[56:59], a[56:59], v[216:219]
    s_mov_b32 s45, s95
    s_mov_b32 s46, 1835008
    v_add_f32 v109, v109, v73
    v_mfma_f32_16x16x32_bf16 v[248:251], v[56:59], a[60:63], v[248:251]
    buffer_load_dwordx4 v21, s[16:19], s98 offen offset:1024  lds
    v_mfma_f32_16x16x32_bf16 v[156:159], v[60:63], a[48:51], v[156:159]
    ds_read_b64_tr_b16 v[56:57], v14 offset:32768
    v_add_f32 v108, v108, v74
    v_mfma_f32_16x16x32_bf16 v[188:191], v[60:63], a[52:55], v[188:191]
    ds_read_b64_tr_b16 v[58:59], v14 offset:33792
    v_add_f32 v109, v109, v75
    v_mfma_f32_16x16x32_bf16 v[220:223], v[60:63], a[56:59], v[220:223]
    buffer_load_dwordx4 v22, s[16:19], s98 offen offset:2048  lds
    v_mfma_f32_16x16x32_bf16 v[252:255], v[60:63], a[60:63], v[252:255]
    s_waitcnt lgkmcnt(5)
    v_add_f32 v108, v108, v76
    v_add_f32 v109, v109, v77
    v_mfma_f32_16x16x32_bf16 v[128:131], v[32:35], a[64:67], v[128:131]
    ds_read_b64_tr_b16 v[60:61], v15 offset:32768
    v_add_f32 v108, v108, v78
    v_mfma_f32_16x16x32_bf16 v[160:163], v[32:35], a[68:71], v[160:163]
    ds_read_b64_tr_b16 v[62:63], v15 offset:33792
    v_add_f32 v109, v109, v79
    v_mfma_f32_16x16x32_bf16 v[192:195], v[32:35], a[72:75], v[192:195]
    s_waitcnt lgkmcnt(5)
    ds_read_b128 a[80:83], v31 offset:0
    v_add_f32 v108, v108, v109
    v_mfma_f32_16x16x32_bf16 v[224:227], v[32:35], a[76:79], v[224:227]
    ds_read_b128 a[84:87], v31 offset:2048
    v_add_f32_dpp v108, v108, v108 row_ror:8 row_mask:0xf bank_mask:0xf
    v_mfma_f32_16x16x32_bf16 v[132:135], v[36:39], a[64:67], v[132:135]
    ds_read_b64_tr_b16 v[32:33], v8 offset:40960
    v_mov_b32 v110, v108
    v_mfma_f32_16x16x32_bf16 v[164:167], v[36:39], a[68:71], v[164:167]
    ds_read_b64_tr_b16 v[34:35], v8 offset:41984
    v_permlane16_swap_b32 v108, v110
    v_mfma_f32_16x16x32_bf16 v[196:199], v[36:39], a[72:75], v[196:199]
    ds_read_b128 a[88:91], v31 offset:4096
    v_add_f32 v108, v108, v110
    v_mfma_f32_16x16x32_bf16 v[228:231], v[36:39], a[76:79], v[228:231]
    ds_read_b128 a[92:95], v31 offset:6144
    v_mov_b32 v110, v108
    v_mfma_f32_16x16x32_bf16 v[136:139], v[40:43], a[64:67], v[136:139]
    ds_read_b64_tr_b16 v[36:37], v9 offset:40960
    v_permlane32_swap_b32 v108, v110
    v_mfma_f32_16x16x32_bf16 v[168:171], v[40:43], a[68:71], v[168:171]
    ds_read_b64_tr_b16 v[38:39], v9 offset:41984
    v_add_f32 v108, v108, v110
    v_mfma_f32_16x16x32_bf16 v[200:203], v[40:43], a[72:75], v[200:203]
    buffer_load_dwordx4 v23, s[16:19], s98 offen offset:3072  lds
    v_mfma_f32_16x16x32_bf16 v[232:235], v[40:43], a[76:79], v[232:235]
    v_mul_f32 v108, 0x3c000000, v108
    v_sub_f32 v110, v64, v108
    v_mfma_f32_16x16x32_bf16 v[140:143], v[44:47], a[64:67], v[140:143]
    s_add_u32 m0, s62, 32768
    s_xor_b32 s98, s96, 512
    ds_read_b64_tr_b16 v[40:41], v10 offset:40960
    v_mfma_f32_16x16x32_bf16 v[172:175], v[44:47], a[68:71], v[172:175]
    ds_read_b64_tr_b16 v[42:43], v10 offset:41984
    v_mul_f32 v109, v110, v110
    v_mfma_f32_16x16x32_bf16 v[204:207], v[44:47], a[72:75], v[204:207]
    buffer_load_dwordx4 v16, s[12:15], s98 offen offset:0  lds
    v_mfma_f32_16x16x32_bf16 v[236:239], v[44:47], a[76:79], v[236:239]
    v_sub_f32 v111, v65, v108
    v_fmac_f32 v109, v111, v111
    v_mfma_f32_16x16x32_bf16 v[144:147], v[48:51], a[64:67], v[144:147]
    ds_read_b64_tr_b16 v[44:45], v11 offset:40960
    v_sub_f32 v110, v66, v108
    v_mfma_f32_16x16x32_bf16 v[176:179], v[48:51], a[68:71], v[176:179]
    ds_read_b64_tr_b16 v[46:47], v11 offset:41984
    v_fmac_f32 v109, v110, v110
    v_mfma_f32_16x16x32_bf16 v[208:211], v[48:51], a[72:75], v[208:211]
    buffer_load_dwordx4 v17, s[12:15], s98 offen offset:1024  lds
    v_mfma_f32_16x16x32_bf16 v[240:243], v[48:51], a[76:79], v[240:243]
    s_waitcnt lgkmcnt(4)
    v_sub_f32 v111, v67, v108
    v_fmac_f32 v109, v111, v111
    v_mfma_f32_16x16x32_bf16 v[148:151], v[52:55], a[64:67], v[148:151]
    ds_read_b64_tr_b16 v[48:49], v12 offset:40960
    v_sub_f32 v110, v68, v108
    v_mfma_f32_16x16x32_bf16 v[180:183], v[52:55], a[68:71], v[180:183]
    ds_read_b64_tr_b16 v[50:51], v12 offset:41984
    v_fmac_f32 v109, v110, v110
    v_mfma_f32_16x16x32_bf16 v[212:215], v[52:55], a[72:75], v[212:215]
    buffer_load_dwordx4 v18, s[12:15], s98 offen offset:2048  lds
    v_mfma_f32_16x16x32_bf16 v[244:247], v[52:55], a[76:79], v[244:247]
    v_sub_f32 v111, v69, v108
    v_fmac_f32 v109, v111, v111
    v_mfma_f32_16x16x32_bf16 v[152:155], v[56:59], a[64:67], v[152:155]
    ds_read_b64_tr_b16 v[52:53], v13 offset:40960
    v_sub_f32 v110, v70, v108
    v_mfma_f32_16x16x32_bf16 v[184:187], v[56:59], a[68:71], v[184:187]
    ds_read_b64_tr_b16 v[54:55], v13 offset:41984
    v_fmac_f32 v109, v110, v110
    v_mfma_f32_16x16x32_bf16 v[216:219], v[56:59], a[72:75], v[216:219]
    buffer_load_dwordx4 v19, s[12:15], s98 offen offset:3072  lds
    v_mfma_f32_16x16x32_bf16 v[248:251], v[56:59], a[76:79], v[248:251]
    v_sub_f32 v111, v71, v108
    v_fmac_f32 v109, v111, v111
    v_mfma_f32_16x16x32_bf16 v[156:159], v[60:63], a[64:67], v[156:159]
    s_add_u32 m0, s62, 36864
    s_xor_b32 s98, s96, 33280
    ds_read_b64_tr_b16 v[56:57], v14 offset:40960
    v_mfma_f32_16x16x32_bf16 v[188:191], v[60:63], a[68:71], v[188:191]
    ds_read_b64_tr_b16 v[58:59], v14 offset:41984
    v_sub_f32 v110, v72, v108
    v_mfma_f32_16x16x32_bf16 v[220:223], v[60:63], a[72:75], v[220:223]
    buffer_load_dwordx4 v16, s[12:15], s98 offen offset:0  lds
    v_mfma_f32_16x16x32_bf16 v[252:255], v[60:63], a[76:79], v[252:255]
    v_fmac_f32 v109, v110, v110
    v_sub_f32 v111, v73, v108
    v_mfma_f32_16x16x32_bf16 v[128:131], v[32:35], a[80:83], v[128:131]
    ds_read_b64_tr_b16 v[60:61], v15 offset:40960
    v_fmac_f32 v109, v111, v111
    v_mfma_f32_16x16x32_bf16 v[160:163], v[32:35], a[84:87], v[160:163]
    ds_read_b64_tr_b16 v[62:63], v15 offset:41984
    v_sub_f32 v110, v74, v108
    v_mfma_f32_16x16x32_bf16 v[192:195], v[32:35], a[88:91], v[192:195]
    buffer_load_dwordx4 v17, s[12:15], s98 offen offset:1024  lds
    v_mfma_f32_16x16x32_bf16 v[224:227], v[32:35], a[92:95], v[224:227]
    v_fmac_f32 v109, v110, v110
    v_sub_f32 v111, v75, v108
    v_mfma_f32_16x16x32_bf16 v[132:135], v[36:39], a[80:83], v[132:135]
    buffer_load_dwordx4 v18, s[12:15], s98 offen offset:2048  lds
    v_mfma_f32_16x16x32_bf16 v[164:167], v[36:39], a[84:87], v[164:167]
    v_fmac_f32 v109, v111, v111
    v_sub_f32 v110, v76, v108
    v_mfma_f32_16x16x32_bf16 v[196:199], v[36:39], a[88:91], v[196:199]
    buffer_load_dwordx4 v19, s[12:15], s98 offen offset:3072  lds
    s_cmp_eq_u32 s3, 1
    s_cselect_b32 s101, s100, 2147479552
    buffer_load_dword a243, v117, s[20:23], s101 offen offset:4
    v_mfma_f32_16x16x32_bf16 v[228:231], v[36:39], a[92:95], v[228:231]
    s_waitcnt lgkmcnt(2)
    v_fmac_f32 v109, v110, v110
    v_sub_f32 v111, v77, v108
    v_mfma_f32_16x16x32_bf16 v[136:139], v[40:43], a[80:83], v[136:139]
    v_fmac_f32 v109, v111, v111
    v_sub_f32 v110, v78, v108
    s_waitcnt vmcnt(15) lgkmcnt(0)
    s_barrier
    v_mfma_f32_16x16x32_bf16 v[168:171], v[40:43], a[84:87], v[168:171]
    s_add_u32 m0, s63, 131072
    s_xor_b32 s98, s97, 2621440
    ds_read_b64_tr_b16 v[32:33], v8 offset:0
    v_mfma_f32_16x16x32_bf16 v[200:203], v[40:43], a[88:91], v[200:203]
    ds_read_b64_tr_b16 v[34:35], v8 offset:1024
    v_fmac_f32 v109, v110, v110
    v_mfma_f32_16x16x32_bf16 v[232:235], v[40:43], a[92:95], v[232:235]
    ds_read_b64_tr_b16 v[36:37], v9 offset:0
    v_sub_f32 v111, v79, v108
    v_mfma_f32_16x16x32_bf16 v[140:143], v[44:47], a[80:83], v[140:143]
    ds_read_b64_tr_b16 v[38:39], v9 offset:1024
    v_fmac_f32 v109, v111, v111
    v_mfma_f32_16x16x32_bf16 v[172:175], v[44:47], a[84:87], v[172:175]
    ds_read_b64_tr_b16 v[40:41], v10 offset:0
    v_add_f32_dpp v109, v109, v109 row_ror:8 row_mask:0xf bank_mask:0xf
    v_mfma_f32_16x16x32_bf16 v[204:207], v[44:47], a[88:91], v[204:207]
    ds_read_b64_tr_b16 v[42:43], v10 offset:1024
    v_mov_b32 v110, v109
    v_mfma_f32_16x16x32_bf16 v[236:239], v[44:47], a[92:95], v[236:239]
    ds_read_b128 a[96:99], v28 offset:0
    v_permlane16_swap_b32 v109, v110
    v_mfma_f32_16x16x32_bf16 v[144:147], v[48:51], a[80:83], v[144:147]
    ds_read_b64_tr_b16 v[44:45], v11 offset:0
    v_add_f32 v109, v109, v110
    v_mfma_f32_16x16x32_bf16 v[176:179], v[48:51], a[84:87], v[176:179]
    ds_read_b64_tr_b16 v[46:47], v11 offset:1024
    v_mov_b32 v110, v109
    s_waitcnt vmcnt(13)
    buffer_atomic_add v6, v7, s[36:39], s69 offen sc1
    v_mfma_f32_16x16x32_bf16 v[208:211], v[48:51], a[88:91], v[208:211]
    ds_read_b128 a[100:103], v28 offset:2048
    v_permlane32_swap_b32 v109, v110
    v_mfma_f32_16x16x32_bf16 v[240:243], v[48:51], a[92:95], v[240:243]
    ds_read_b128 a[104:107], v28 offset:4096
    v_add_f32 v109, v109, v110
    v_mfma_f32_16x16x32_bf16 v[148:151], v[52:55], a[80:83], v[148:151]
    ds_read_b64_tr_b16 v[48:49], v12 offset:0
    v_mfma_f32_16x16x32_bf16 v[180:183], v[52:55], a[84:87], v[180:183]
    ds_read_b64_tr_b16 v[50:51], v12 offset:1024
    v_mfma_f32_16x16x32_bf16 v[212:215], v[52:55], a[88:91], v[212:215]
    ds_read_b128 a[108:111], v28 offset:6144
    v_mfma_f32_16x16x32_bf16 v[244:247], v[52:55], a[92:95], v[244:247]
    buffer_load_dwordx4 v20, s[16:19], s98 offen offset:0  lds
    v_mfma_f32_16x16x32_bf16 v[152:155], v[56:59], a[80:83], v[152:155]
    ds_read_b64_tr_b16 v[52:53], v13 offset:0
    v_mfma_f32_16x16x32_bf16 v[184:187], v[56:59], a[84:87], v[184:187]
    ds_read_b64_tr_b16 v[54:55], v13 offset:1024
    v_mfma_f32_16x16x32_bf16 v[216:219], v[56:59], a[88:91], v[216:219]
    buffer_load_dwordx4 v21, s[16:19], s98 offen offset:1024  lds
    v_mfma_f32_16x16x32_bf16 v[248:251], v[56:59], a[92:95], v[248:251]
    ds_write_b64 v100, v[108:109]
    v_mfma_f32_16x16x32_bf16 v[156:159], v[60:63], a[80:83], v[156:159]
    ds_read_b64_tr_b16 v[56:57], v14 offset:0
    v_mfma_f32_16x16x32_bf16 v[188:191], v[60:63], a[84:87], v[188:191]
    ds_read_b64_tr_b16 v[58:59], v14 offset:1024
    v_mfma_f32_16x16x32_bf16 v[220:223], v[60:63], a[88:91], v[220:223]
    buffer_load_dwordx4 v22, s[16:19], s98 offen offset:2048  lds
    v_mfma_f32_16x16x32_bf16 v[252:255], v[60:63], a[92:95], v[252:255]
    s_waitcnt lgkmcnt(6)
    v_mfma_f32_16x16x32_bf16 v[128:131], v[32:35], a[96:99], v[128:131]
    ds_read_b64_tr_b16 v[60:61], v15 offset:0
    v_mfma_f32_16x16x32_bf16 v[160:163], v[32:35], a[100:103], v[160:163]
    ds_read_b64_tr_b16 v[62:63], v15 offset:1024
    v_mfma_f32_16x16x32_bf16 v[192:195], v[32:35], a[104:107], v[192:195]
    s_waitcnt lgkmcnt(6)
    ds_read_b128 a[112:115], v29 offset:0
    v_mfma_f32_16x16x32_bf16 v[224:227], v[32:35], a[108:111], v[224:227]
    ds_read_b128 a[116:119], v29 offset:2048
    v_mfma_f32_16x16x32_bf16 v[132:135], v[36:39], a[96:99], v[132:135]
    ds_read_b64_tr_b16 v[32:33], v8 offset:8192
    v_mfma_f32_16x16x32_bf16 v[164:167], v[36:39], a[100:103], v[164:167]
    ds_read_b64_tr_b16 v[34:35], v8 offset:9216
    v_mfma_f32_16x16x32_bf16 v[196:199], v[36:39], a[104:107], v[196:199]
    ds_read_b128 a[120:123], v29 offset:4096
    v_mfma_f32_16x16x32_bf16 v[228:231], v[36:39], a[108:111], v[228:231]
    ds_read_b128 a[124:127], v29 offset:6144
    v_mfma_f32_16x16x32_bf16 v[136:139], v[40:43], a[96:99], v[136:139]
    ds_read_b64_tr_b16 v[36:37], v9 offset:8192
    v_mfma_f32_16x16x32_bf16 v[168:171], v[40:43], a[100:103], v[168:171]
    ds_read_b64_tr_b16 v[38:39], v9 offset:9216
    v_mfma_f32_16x16x32_bf16 v[200:203], v[40:43], a[104:107], v[200:203]
    buffer_load_dwordx4 v23, s[16:19], s98 offen offset:3072  lds
    v_mfma_f32_16x16x32_bf16 v[232:235], v[40:43], a[108:111], v[232:235]
    v_mfma_f32_16x16x32_bf16 v[140:143], v[44:47], a[96:99], v[140:143]
    s_add_u32 m0, s62, 65536
    s_xor_b32 s98, s96, 640
    ds_read_b64_tr_b16 v[40:41], v10 offset:8192
    v_mfma_f32_16x16x32_bf16 v[172:175], v[44:47], a[100:103], v[172:175]
    ds_read_b64_tr_b16 v[42:43], v10 offset:9216
    v_mfma_f32_16x16x32_bf16 v[204:207], v[44:47], a[104:107], v[204:207]
    buffer_load_dwordx4 v16, s[12:15], s98 offen offset:0  lds
    v_mfma_f32_16x16x32_bf16 v[236:239], v[44:47], a[108:111], v[236:239]
    v_mfma_f32_16x16x32_bf16 v[144:147], v[48:51], a[96:99], v[144:147]
    ds_read_b64_tr_b16 v[44:45], v11 offset:8192
    v_mfma_f32_16x16x32_bf16 v[176:179], v[48:51], a[100:103], v[176:179]
    ds_read_b64_tr_b16 v[46:47], v11 offset:9216
    v_mfma_f32_16x16x32_bf16 v[208:211], v[48:51], a[104:107], v[208:211]
    buffer_load_dwordx4 v17, s[12:15], s98 offen offset:1024  lds
    v_mfma_f32_16x16x32_bf16 v[240:243], v[48:51], a[108:111], v[240:243]
    s_waitcnt lgkmcnt(4)
    v_mfma_f32_16x16x32_bf16 v[148:151], v[52:55], a[96:99], v[148:151]
    ds_read_b64_tr_b16 v[48:49], v12 offset:8192
    v_mfma_f32_16x16x32_bf16 v[180:183], v[52:55], a[100:103], v[180:183]
    ds_read_b64_tr_b16 v[50:51], v12 offset:9216
    v_mfma_f32_16x16x32_bf16 v[212:215], v[52:55], a[104:107], v[212:215]
    buffer_load_dwordx4 v18, s[12:15], s98 offen offset:2048  lds
    v_mfma_f32_16x16x32_bf16 v[244:247], v[52:55], a[108:111], v[244:247]
    v_mfma_f32_16x16x32_bf16 v[152:155], v[56:59], a[96:99], v[152:155]
    ds_read_b64_tr_b16 v[52:53], v13 offset:8192
    v_mfma_f32_16x16x32_bf16 v[184:187], v[56:59], a[100:103], v[184:187]
    ds_read_b64_tr_b16 v[54:55], v13 offset:9216
    v_mfma_f32_16x16x32_bf16 v[216:219], v[56:59], a[104:107], v[216:219]
    buffer_load_dwordx4 v19, s[12:15], s98 offen offset:3072  lds
    v_mfma_f32_16x16x32_bf16 v[248:251], v[56:59], a[108:111], v[248:251]
    v_mfma_f32_16x16x32_bf16 v[156:159], v[60:63], a[96:99], v[156:159]
    s_add_u32 m0, s62, 69632
    s_xor_b32 s98, s96, 33408
    ds_read_b64_tr_b16 v[56:57], v14 offset:8192
    v_mfma_f32_16x16x32_bf16 v[188:191], v[60:63], a[100:103], v[188:191]
    ds_read_b64_tr_b16 v[58:59], v14 offset:9216
    v_mfma_f32_16x16x32_bf16 v[220:223], v[60:63], a[104:107], v[220:223]
    buffer_load_dwordx4 v16, s[12:15], s98 offen offset:0  lds
    v_mfma_f32_16x16x32_bf16 v[252:255], v[60:63], a[108:111], v[252:255]
    v_mfma_f32_16x16x32_bf16 v[128:131], v[32:35], a[112:115], v[128:131]
    ds_read_b64_tr_b16 v[60:61], v15 offset:8192
    v_mfma_f32_16x16x32_bf16 v[160:163], v[32:35], a[116:119], v[160:163]
    ds_read_b64_tr_b16 v[62:63], v15 offset:9216
    v_mfma_f32_16x16x32_bf16 v[192:195], v[32:35], a[120:123], v[192:195]
    buffer_load_dwordx4 v17, s[12:15], s98 offen offset:1024  lds
    v_mfma_f32_16x16x32_bf16 v[224:227], v[32:35], a[124:127], v[224:227]
    v_mfma_f32_16x16x32_bf16 v[132:135], v[36:39], a[112:115], v[132:135]
    buffer_load_dwordx4 v18, s[12:15], s98 offen offset:2048  lds
    v_mfma_f32_16x16x32_bf16 v[164:167], v[36:39], a[116:119], v[164:167]
    v_mfma_f32_16x16x32_bf16 v[196:199], v[36:39], a[120:123], v[196:199]
    buffer_load_dwordx4 v19, s[12:15], s98 offen offset:3072  lds
    s_cmp_eq_u32 s3, 2
    s_cselect_b32 s101, s100, 2147479552
    buffer_load_dword a245, v117, s[24:27], s101 offen offset:4
    v_mfma_f32_16x16x32_bf16 v[228:231], v[36:39], a[124:127], v[228:231]
    s_waitcnt lgkmcnt(2)
    v_mfma_f32_16x16x32_bf16 v[136:139], v[40:43], a[112:115], v[136:139]
    s_waitcnt vmcnt(15) lgkmcnt(0)
    s_barrier
    v_mfma_f32_16x16x32_bf16 v[168:171], v[40:43], a[116:119], v[168:171]
    s_add_u32 m0, s63, 98304
    s_xor_b32 s98, s97, 3145728
    ds_read_b64_tr_b16 v[32:33], v8 offset:16384
    v_mfma_f32_16x16x32_bf16 v[200:203], v[40:43], a[120:123], v[200:203]
    ds_read_b64_tr_b16 v[34:35], v8 offset:17408
    v_mfma_f32_16x16x32_bf16 v[232:235], v[40:43], a[124:127], v[232:235]
    ds_read_b64_tr_b16 v[36:37], v9 offset:16384
    v_mfma_f32_16x16x32_bf16 v[140:143], v[44:47], a[112:115], v[140:143]
    ds_read_b64_tr_b16 v[38:39], v9 offset:17408
    v_mfma_f32_16x16x32_bf16 v[172:175], v[44:47], a[116:119], v[172:175]
    ds_read_b64_tr_b16 v[40:41], v10 offset:16384
    v_mfma_f32_16x16x32_bf16 v[204:207], v[44:47], a[120:123], v[204:207]
    ds_read_b64_tr_b16 v[42:43], v10 offset:17408
    v_mfma_f32_16x16x32_bf16 v[236:239], v[44:47], a[124:127], v[236:239]
    ds_read_b128 a[128:131], v28 offset:32768
    v_mfma_f32_16x16x32_bf16 v[144:147], v[48:51], a[112:115], v[144:147]
    ds_read_b64_tr_b16 v[44:45], v11 offset:16384
    v_mfma_f32_16x16x32_bf16 v[176:179], v[48:51], a[116:119], v[176:179]
    ds_read_b64_tr_b16 v[46:47], v11 offset:17408
    v_mfma_f32_16x16x32_bf16 v[208:211], v[48:51], a[120:123], v[208:211]
    ds_read_b128 a[132:135], v28 offset:34816
    v_mfma_f32_16x16x32_bf16 v[240:243], v[48:51], a[124:127], v[240:243]
    ds_read_b128 a[136:139], v28 offset:36864
    v_mfma_f32_16x16x32_bf16 v[148:151], v[52:55], a[112:115], v[148:151]
    ds_read_b64_tr_b16 v[48:49], v12 offset:16384
    v_mfma_f32_16x16x32_bf16 v[180:183], v[52:55], a[116:119], v[180:183]
    ds_read_b64_tr_b16 v[50:51], v12 offset:17408
    v_mfma_f32_16x16x32_bf16 v[212:215], v[52:55], a[120:123], v[212:215]
    ds_read_b128 a[140:143], v28 offset:38912
    v_mfma_f32_16x16x32_bf16 v[244:247], v[52:55], a[124:127], v[244:247]
    buffer_load_dwordx4 v20, s[16:19], s98 offen offset:0  lds
    v_mfma_f32_16x16x32_bf16 v[152:155], v[56:59], a[112:115], v[152:155]
    ds_read_b64_tr_b16 v[52:53], v13 offset:16384
    v_mfma_f32_16x16x32_bf16 v[184:187], v[56:59], a[116:119], v[184:187]
    ds_read_b64_tr_b16 v[54:55], v13 offset:17408
    v_mfma_f32_16x16x32_bf16 v[216:219], v[56:59], a[120:123], v[216:219]
    buffer_load_dwordx4 v21, s[16:19], s98 offen offset:1024  lds
    v_mfma_f32_16x16x32_bf16 v[248:251], v[56:59], a[124:127], v[248:251]
    ds_read_b128 v[88:91], v99
    v_mfma_f32_16x16x32_bf16 v[156:159], v[60:63], a[112:115], v[156:159]
    ds_read_b64_tr_b16 v[56:57], v14 offset:16384
    v_mfma_f32_16x16x32_bf16 v[188:191], v[60:63], a[116:119], v[188:191]
    ds_read_b64_tr_b16 v[58:59], v14 offset:17408
    v_mfma_f32_16x16x32_bf16 v[220:223], v[60:63], a[120:123], v[220:223]
    buffer_load_dwordx4 v22, s[16:19], s98 offen offset:2048  lds
    v_mfma_f32_16x16x32_bf16 v[252:255], v[60:63], a[124:127], v[252:255]
    s_waitcnt lgkmcnt(6)
    ds_read_b128 v[92:95], v99 offset:16
    v_mfma_f32_16x16x32_bf16 v[128:131], v[32:35], a[128:131], v[128:131]
    ds_read_b64_tr_b16 v[60:61], v15 offset:16384
    v_mfma_f32_16x16x32_bf16 v[160:163], v[32:35], a[132:135], v[160:163]
    ds_read_b64_tr_b16 v[62:63], v15 offset:17408
    v_mfma_f32_16x16x32_bf16 v[192:195], v[32:35], a[136:139], v[192:195]
    s_waitcnt lgkmcnt(7)
    ds_read_b128 a[144:147], v29 offset:32768
    v_mfma_f32_16x16x32_bf16 v[224:227], v[32:35], a[140:143], v[224:227]
    ds_read_b128 a[148:151], v29 offset:34816
    v_mfma_f32_16x16x32_bf16 v[132:135], v[36:39], a[128:131], v[132:135]
    ds_read_b64_tr_b16 v[32:33], v8 offset:24576
    v_mfma_f32_16x16x32_bf16 v[164:167], v[36:39], a[132:135], v[164:167]
    ds_read_b64_tr_b16 v[34:35], v8 offset:25600
    v_mfma_f32_16x16x32_bf16 v[196:199], v[36:39], a[136:139], v[196:199]
    ds_read_b128 a[152:155], v29 offset:36864
    v_mfma_f32_16x16x32_bf16 v[228:231], v[36:39], a[140:143], v[228:231]
    ds_read_b128 a[156:159], v29 offset:38912
    s_waitcnt lgkmcnt(11)
    v_add_f32 v108, v88, v90
    v_mfma_f32_16x16x32_bf16 v[136:139], v[40:43], a[128:131], v[136:139]
    ds_read_b64_tr_b16 v[36:37], v9 offset:24576
    s_waitcnt lgkmcnt(9)
    v_add_f32 v109, v92, v94
    v_mfma_f32_16x16x32_bf16 v[168:171], v[40:43], a[132:135], v[168:171]
    ds_read_b64_tr_b16 v[38:39], v9 offset:25600
    v_add_f32 v108, v108, v109
    v_mfma_f32_16x16x32_bf16 v[200:203], v[40:43], a[136:139], v[200:203]
    buffer_load_dwordx4 v23, s[16:19], s98 offen offset:3072  lds
    v_mfma_f32_16x16x32_bf16 v[232:235], v[40:43], a[140:143], v[232:235]
    v_mul_f32 v108, 0x3e800000, v108
    v_add_f32 v109, v89, v91
    v_mfma_f32_16x16x32_bf16 v[140:143], v[44:47], a[128:131], v[140:143]
    s_add_u32 m0, s62, 0
    s_xor_b32 s98, s96, 768
    ds_read_b64_tr_b16 v[40:41], v10 offset:24576
    v_mfma_f32_16x16x32_bf16 v[172:175], v[44:47], a[132:135], v[172:175]
    ds_read_b64_tr_b16 v[42:43], v10 offset:25600
    v_add_f32 v110, v93, v95
    v_mfma_f32_16x16x32_bf16 v[204:207], v[44:47], a[136:139], v[204:207]
    buffer_load_dwordx4 v16, s[12:15], s98 offen offset:0  lds
    v_mfma_f32_16x16x32_bf16 v[236:239], v[44:47], a[140:143], v[236:239]
    v_add_f32 v109, v109, v110
    v_sub_f32 v88, v88, v108
    v_mfma_f32_16x16x32_bf16 v[144:147], v[48:51], a[128:131], v[144:147]
    ds_read_b64_tr_b16 v[44:45], v11 offset:24576
    v_sub_f32 v90, v90, v108
    v_mfma_f32_16x16x32_bf16 v[176:179], v[48:51], a[132:135], v[176:179]
    ds_read_b64_tr_b16 v[46:47], v11 offset:25600
    v_sub_f32 v92, v92, v108
    v_mfma_f32_16x16x32_bf16 v[208:211], v[48:51], a[136:139], v[208:211]
    buffer_load_dwordx4 v17, s[12:15], s98 offen offset:1024  lds
    v_mfma_f32_16x16x32_bf16 v[240:243], v[48:51], a[140:143], v[240:243]
    v_sub_f32 v94, v94, v108
    v_mul_f32 v110, v88, v88
    v_mfma_f32_16x16x32_bf16 v[148:151], v[52:55], a[128:131], v[148:151]
    ds_read_b64_tr_b16 v[48:49], v12 offset:24576
    v_fmac_f32 v110, v90, v90
    v_mfma_f32_16x16x32_bf16 v[180:183], v[52:55], a[132:135], v[180:183]
    ds_read_b64_tr_b16 v[50:51], v12 offset:25600
    v_fmac_f32 v110, v92, v92
    v_mfma_f32_16x16x32_bf16 v[212:215], v[52:55], a[136:139], v[212:215]
    buffer_load_dwordx4 v18, s[12:15], s98 offen offset:2048  lds
    v_mfma_f32_16x16x32_bf16 v[244:247], v[52:55], a[140:143], v[244:247]
    v_fmac_f32 v110, v94, v94
    v_fmac_f32 v109, 0x43000000, v110
    v_mfma_f32_16x16x32_bf16 v[152:155], v[56:59], a[128:131], v[152:155]
    ds_read_b64_tr_b16 v[52:53], v13 offset:24576
    v_mov_b32 v110, 0x3727c5ac
    v_mfma_f32_16x16x32_bf16 v[184:187], v[56:59], a[132:135], v[184:187]
    ds_read_b64_tr_b16 v[54:55], v13 offset:25600
    v_fmac_f32 v110, 0x3b000000, v109
    v_mfma_f32_16x16x32_bf16 v[216:219], v[56:59], a[136:139], v[216:219]
    buffer_load_dwordx4 v19, s[12:15], s98 offen offset:3072  lds
    v_mfma_f32_16x16x32_bf16 v[248:251], v[56:59], a[140:143], v[248:251]
    s_waitcnt lgkmcnt(4)
    v_rsq_f32 v110, v110
    v_mfma_f32_16x16x32_bf16 v[156:159], v[60:63], a[128:131], v[156:159]
    s_add_u32 m0, s62, 4096
    s_xor_b32 s98, s96, 33536
    ds_read_b64_tr_b16 v[56:57], v14 offset:24576
    v_mfma_f32_16x16x32_bf16 v[188:191], v[60:63], a[132:135], v[188:191]
    ds_read_b64_tr_b16 v[58:59], v14 offset:25600
    v_sub_f32 v64, v64, v108
    v_mfma_f32_16x16x32_bf16 v[220:223], v[60:63], a[136:139], v[220:223]
    buffer_load_dwordx4 v16, s[12:15], s98 offen offset:0  lds
    v_mfma_f32_16x16x32_bf16 v[252:255], v[60:63], a[140:143], v[252:255]
    v_sub_f32 v65, v65, v108
    v_sub_f32 v66, v66, v108
    v_mfma_f32_16x16x32_bf16 v[128:131], v[32:35], a[144:147], v[128:131]
    ds_read_b64_tr_b16 v[60:61], v15 offset:24576
    v_sub_f32 v67, v67, v108
    v_mfma_f32_16x16x32_bf16 v[160:163], v[32:35], a[148:151], v[160:163]
    ds_read_b64_tr_b16 v[62:63], v15 offset:25600
    v_sub_f32 v68, v68, v108
    v_mfma_f32_16x16x32_bf16 v[192:195], v[32:35], a[152:155], v[192:195]
    buffer_load_dwordx4 v17, s[12:15], s98 offen offset:1024  lds
    v_mfma_f32_16x16x32_bf16 v[224:227], v[32:35], a[156:159], v[224:227]
    v_sub_f32 v69, v69, v108
    v_sub_f32 v70, v70, v108
    v_mfma_f32_16x16x32_bf16 v[132:135], v[36:39], a[144:147], v[132:135]
    buffer_load_dwordx4 v18, s[12:15], s98 offen offset:2048  lds
    v_mfma_f32_16x16x32_bf16 v[164:167], v[36:39], a[148:151], v[164:167]
    v_sub_f32 v71, v71, v108
    v_sub_f32 v72, v72, v108
    v_mfma_f32_16x16x32_bf16 v[196:199], v[36:39], a[152:155], v[196:199]
    buffer_load_dwordx4 v19, s[12:15], s98 offen offset:3072  lds
    s_cmp_eq_u32 s3, 3
    s_cselect_b32 s101, s100, 2147479552
    buffer_load_dword a247, v117, s[24:27], s101 offen offset:4
    v_mfma_f32_16x16x32_bf16 v[228:231], v[36:39], a[156:159], v[228:231]
    v_sub_f32 v73, v73, v108
    v_sub_f32 v74, v74, v108
    v_mfma_f32_16x16x32_bf16 v[136:139], v[40:43], a[144:147], v[136:139]
    v_sub_f32 v75, v75, v108
    v_sub_f32 v76, v76, v108
    s_waitcnt vmcnt(14) lgkmcnt(0)
    s_barrier
    v_mfma_f32_16x16x32_bf16 v[168:171], v[40:43], a[148:151], v[168:171]
    s_add_u32 m0, s63, 114688
    s_xor_b32 s98, s97, 3670016
    ds_read_b64_tr_b16 v[32:33], v8 offset:32768
    v_mfma_f32_16x16x32_bf16 v[200:203], v[40:43], a[152:155], v[200:203]
    ds_read_b64_tr_b16 v[34:35], v8 offset:33792
    v_sub_f32 v77, v77, v108
    v_mfma_f32_16x16x32_bf16 v[232:235], v[40:43], a[156:159], v[232:235]
    ds_read_b64_tr_b16 v[36:37], v9 offset:32768
    v_sub_f32 v78, v78, v108
    v_mfma_f32_16x16x32_bf16 v[140:143], v[44:47], a[144:147], v[140:143]
    ds_read_b64_tr_b16 v[38:39], v9 offset:33792
    v_sub_f32 v79, v79, v108
    v_mfma_f32_16x16x32_bf16 v[172:175], v[44:47], a[148:151], v[172:175]
    ds_read_b64_tr_b16 v[40:41], v10 offset:32768
    v_mul_f32 v64, v64, v110
    v_mfma_f32_16x16x32_bf16 v[204:207], v[44:47], a[152:155], v[204:207]
    ds_read_b64_tr_b16 v[42:43], v10 offset:33792
    v_mul_f32 v65, v65, v110
    v_mfma_f32_16x16x32_bf16 v[236:239], v[44:47], a[156:159], v[236:239]
    ds_read_b128 a[160:163], v30 offset:0
    v_mul_f32 v66, v66, v110
    v_mfma_f32_16x16x32_bf16 v[144:147], v[48:51], a[144:147], v[144:147]
    ds_read_b64_tr_b16 v[44:45], v11 offset:32768
    v_mul_f32 v67, v67, v110
    v_mfma_f32_16x16x32_bf16 v[176:179], v[48:51], a[148:151], v[176:179]
    ds_read_b64_tr_b16 v[46:47], v11 offset:33792
    v_mul_f32 v68, v68, v110
    v_mfma_f32_16x16x32_bf16 v[208:211], v[48:51], a[152:155], v[208:211]
    ds_read_b128 a[164:167], v30 offset:2048
    v_mul_f32 v69, v69, v110
    v_mfma_f32_16x16x32_bf16 v[240:243], v[48:51], a[156:159], v[240:243]
    ds_read_b128 a[168:171], v30 offset:4096
    v_mul_f32 v70, v70, v110
    v_mfma_f32_16x16x32_bf16 v[148:151], v[52:55], a[144:147], v[148:151]
    ds_read_b64_tr_b16 v[48:49], v12 offset:32768
    v_mul_f32 v71, v71, v110
    v_mfma_f32_16x16x32_bf16 v[180:183], v[52:55], a[148:151], v[180:183]
    ds_read_b64_tr_b16 v[50:51], v12 offset:33792
    v_mul_f32 v72, v72, v110
    v_mfma_f32_16x16x32_bf16 v[212:215], v[52:55], a[152:155], v[212:215]
    ds_read_b128 a[172:175], v30 offset:6144
    v_mul_f32 v73, v73, v110
    buffer_load_dword v3, v4, s[36:39], s67 offen sc0 sc1
    v_mfma_f32_16x16x32_bf16 v[244:247], v[52:55], a[156:159], v[244:247]
    buffer_load_dwordx4 v20, s[16:19], s98 offen offset:0  lds
    v_mfma_f32_16x16x32_bf16 v[152:155], v[56:59], a[144:147], v[152:155]
    ds_read_b64_tr_b16 v[52:53], v13 offset:32768
    v_mul_f32 v74, v74, v110
    v_mfma_f32_16x16x32_bf16 v[184:187], v[56:59], a[148:151], v[184:187]
    ds_read_b64_tr_b16 v[54:55], v13 offset:33792
    v_mul_f32 v75, v75, v110
    v_mfma_f32_16x16x32_bf16 v[216:219], v[56:59], a[152:155], v[216:219]
    buffer_load_dwordx4 v21, s[16:19], s98 offen offset:1024  lds
    v_mfma_f32_16x16x32_bf16 v[248:251], v[56:59], a[156:159], v[248:251]
    v_mul_f32 v76, v76, v110
    v_mul_f32 v77, v77, v110
    v_mfma_f32_16x16x32_bf16 v[156:159], v[60:63], a[144:147], v[156:159]
    ds_read_b64_tr_b16 v[56:57], v14 offset:32768
    v_mul_f32 v78, v78, v110
    v_mfma_f32_16x16x32_bf16 v[188:191], v[60:63], a[148:151], v[188:191]
    ds_read_b64_tr_b16 v[58:59], v14 offset:33792
    v_mul_f32 v79, v79, v110
    v_mfma_f32_16x16x32_bf16 v[220:223], v[60:63], a[152:155], v[220:223]
    buffer_load_dwordx4 v22, s[16:19], s98 offen offset:2048  lds
    v_mfma_f32_16x16x32_bf16 v[252:255], v[60:63], a[156:159], v[252:255]
    s_waitcnt lgkmcnt(5)
    v_mfma_f32_16x16x32_bf16 v[128:131], v[32:35], a[160:163], v[128:131]
    ds_read_b64_tr_b16 v[60:61], v15 offset:32768
    v_and_b32 v96, 31, v2
    v_mfma_f32_16x16x32_bf16 v[160:163], v[32:35], a[164:167], v[160:163]
    ds_read_b64_tr_b16 v[62:63], v15 offset:33792
    v_lshlrev_b32 v96, 4, v96
    v_mfma_f32_16x16x32_bf16 v[192:195], v[32:35], a[168:171], v[192:195]
    s_waitcnt lgkmcnt(5)
    ds_read_b128 a[176:179], v31 offset:0
    v_lshrrev_b32 v97, 5, v2
    v_mfma_f32_16x16x32_bf16 v[224:227], v[32:35], a[172:175], v[224:227]
    ds_read_b128 a[180:183], v31 offset:2048
    v_lshl_add_u32 v96, v97, 11, v96
    v_mfma_f32_16x16x32_bf16 v[132:135], v[36:39], a[160:163], v[132:135]
    ds_read_b64_tr_b16 v[32:33], v8 offset:40960
    v_mfma_f32_16x16x32_bf16 v[164:167], v[36:39], a[164:167], v[164:167]
    ds_read_b64_tr_b16 v[34:35], v8 offset:41984
    v_mfma_f32_16x16x32_bf16 v[196:199], v[36:39], a[168:171], v[196:199]
    ds_read_b128 a[184:187], v31 offset:4096
    v_mfma_f32_16x16x32_bf16 v[228:231], v[36:39], a[172:175], v[228:231]
    ds_read_b128 a[188:191], v31 offset:6144
    v_mfma_f32_16x16x32_bf16 v[136:139], v[40:43], a[160:163], v[136:139]
    ds_read_b64_tr_b16 v[36:37], v9 offset:40960
    v_mfma_f32_16x16x32_bf16 v[168:171], v[40:43], a[164:167], v[168:171]
    ds_read_b64_tr_b16 v[38:39], v9 offset:41984
    v_mfma_f32_16x16x32_bf16 v[200:203], v[40:43], a[168:171], v[200:203]
    buffer_load_dwordx4 v23, s[16:19], s98 offen offset:3072  lds
    v_mfma_f32_16x16x32_bf16 v[232:235], v[40:43], a[172:175], v[232:235]
    v_mfma_f32_16x16x32_bf16 v[140:143], v[44:47], a[160:163], v[140:143]
    s_add_u32 m0, s62, 32768
    s_xor_b32 s98, s96, 896
    ds_read_b64_tr_b16 v[40:41], v10 offset:40960
    v_mfma_f32_16x16x32_bf16 v[172:175], v[44:47], a[164:167], v[172:175]
    ds_read_b64_tr_b16 v[42:43], v10 offset:41984
    v_mfma_f32_16x16x32_bf16 v[204:207], v[44:47], a[168:171], v[204:207]
    buffer_load_dwordx4 v16, s[12:15], s98 offen offset:0  lds
    v_mfma_f32_16x16x32_bf16 v[236:239], v[44:47], a[172:175], v[236:239]
    v_mfma_f32_16x16x32_bf16 v[144:147], v[48:51], a[160:163], v[144:147]
    ds_read_b64_tr_b16 v[44:45], v11 offset:40960
    v_mfma_f32_16x16x32_bf16 v[176:179], v[48:51], a[164:167], v[176:179]
    ds_read_b64_tr_b16 v[46:47], v11 offset:41984
    v_mfma_f32_16x16x32_bf16 v[208:211], v[48:51], a[168:171], v[208:211]
    buffer_load_dwordx4 v17, s[12:15], s98 offen offset:1024  lds
    v_mfma_f32_16x16x32_bf16 v[240:243], v[48:51], a[172:175], v[240:243]
    s_waitcnt lgkmcnt(4)
    v_mfma_f32_16x16x32_bf16 v[148:151], v[52:55], a[160:163], v[148:151]
    ds_read_b64_tr_b16 v[48:49], v12 offset:40960
    v_mfma_f32_16x16x32_bf16 v[180:183], v[52:55], a[164:167], v[180:183]
    ds_read_b64_tr_b16 v[50:51], v12 offset:41984
    v_mfma_f32_16x16x32_bf16 v[212:215], v[52:55], a[168:171], v[212:215]
    buffer_load_dwordx4 v18, s[12:15], s98 offen offset:2048  lds
    v_mfma_f32_16x16x32_bf16 v[244:247], v[52:55], a[172:175], v[244:247]
    v_mfma_f32_16x16x32_bf16 v[152:155], v[56:59], a[160:163], v[152:155]
    ds_read_b64_tr_b16 v[52:53], v13 offset:40960
    v_mfma_f32_16x16x32_bf16 v[184:187], v[56:59], a[164:167], v[184:187]
    ds_read_b64_tr_b16 v[54:55], v13 offset:41984
    v_mfma_f32_16x16x32_bf16 v[216:219], v[56:59], a[168:171], v[216:219]
    buffer_load_dwordx4 v19, s[12:15], s98 offen offset:3072  lds
    v_mfma_f32_16x16x32_bf16 v[248:251], v[56:59], a[172:175], v[248:251]
    v_mfma_f32_16x16x32_bf16 v[156:159], v[60:63], a[160:163], v[156:159]
    s_add_u32 m0, s62, 36864
    s_xor_b32 s98, s96, 33664
    ds_read_b64_tr_b16 v[56:57], v14 offset:40960
    v_mfma_f32_16x16x32_bf16 v[188:191], v[60:63], a[164:167], v[188:191]
    ds_read_b64_tr_b16 v[58:59], v14 offset:41984
    v_mfma_f32_16x16x32_bf16 v[220:223], v[60:63], a[168:171], v[220:223]
    buffer_load_dwordx4 v16, s[12:15], s98 offen offset:0  lds
    v_mfma_f32_16x16x32_bf16 v[252:255], v[60:63], a[172:175], v[252:255]
    v_mfma_f32_16x16x32_bf16 v[128:131], v[32:35], a[176:179], v[128:131]
    ds_read_b64_tr_b16 v[60:61], v15 offset:40960
    v_mfma_f32_16x16x32_bf16 v[160:163], v[32:35], a[180:183], v[160:163]
    ds_read_b64_tr_b16 v[62:63], v15 offset:41984
    v_mfma_f32_16x16x32_bf16 v[192:195], v[32:35], a[184:187], v[192:195]
    buffer_load_dwordx4 v17, s[12:15], s98 offen offset:1024  lds
    v_mfma_f32_16x16x32_bf16 v[224:227], v[32:35], a[188:191], v[224:227]
    v_mfma_f32_16x16x32_bf16 v[132:135], v[36:39], a[176:179], v[132:135]
    buffer_load_dwordx4 v18, s[12:15], s98 offen offset:2048  lds
    v_mfma_f32_16x16x32_bf16 v[164:167], v[36:39], a[180:183], v[164:167]
    v_mfma_f32_16x16x32_bf16 v[196:199], v[36:39], a[184:187], v[196:199]
    buffer_load_dwordx4 v19, s[12:15], s98 offen offset:3072  lds
    v_mfma_f32_16x16x32_bf16 v[228:231], v[36:39], a[188:191], v[228:231]
    s_waitcnt lgkmcnt(2)
    s_waitcnt vmcnt(12)
    v_cmp_le_u32 vcc, s68, v3
    s_cmp_eq_u64 vcc, -1
    s_cbranch_scc0 L_E_slow_1
L_E_ok_2:
    v_mfma_f32_16x16x32_bf16 v[136:139], v[40:43], a[176:179], v[136:139]
    s_waitcnt lgkmcnt(0)
    s_barrier
    v_mfma_f32_16x16x32_bf16 v[168:171], v[40:43], a[180:183], v[168:171]
    s_add_u32 m0, s62, 65536
    s_xor_b32 s98, s64, 0
    ds_read_b64_tr_b16 v[32:33], v8 offset:0
    v_mfma_f32_16x16x32_bf16 v[200:203], v[40:43], a[184:187], v[200:203]
    ds_read_b64_tr_b16 v[34:35], v8 offset:1024
    v_mov_b32 v18, v106
    v_mfma_f32_16x16x32_bf16 v[232:235], v[40:43], a[188:191], v[232:235]
    ds_read_b64_tr_b16 v[36:37], v9 offset:0
    v_mov_b32 v19, v107
    v_mfma_f32_16x16x32_bf16 v[140:143], v[44:47], a[176:179], v[140:143]
    ds_read_b64_tr_b16 v[38:39], v9 offset:1024
    v_mfma_f32_16x16x32_bf16 v[172:175], v[44:47], a[180:183], v[172:175]
    ds_read_b64_tr_b16 v[40:41], v10 offset:0
    v_mfma_f32_16x16x32_bf16 v[204:207], v[44:47], a[184:187], v[204:207]
    ds_read_b64_tr_b16 v[42:43], v10 offset:1024
    v_mfma_f32_16x16x32_bf16 v[236:239], v[44:47], a[188:191], v[236:239]
    ds_read_b128 a[192:195], v28 offset:0
    v_mfma_f32_16x16x32_bf16 v[144:147], v[48:51], a[176:179], v[144:147]
    ds_read_b64_tr_b16 v[44:45], v11 offset:0
    v_mfma_f32_16x16x32_bf16 v[176:179], v[48:51], a[180:183], v[176:179]
    ds_read_b64_tr_b16 v[46:47], v11 offset:1024
    v_mfma_f32_16x16x32_bf16 v[208:211], v[48:51], a[184:187], v[208:211]
    ds_read_b128 a[196:199], v28 offset:2048
    v_mfma_f32_16x16x32_bf16 v[240:243], v[48:51], a[188:191], v[240:243]
    ds_read_b128 a[200:203], v28 offset:4096
    v_mfma_f32_16x16x32_bf16 v[148:151], v[52:55], a[176:179], v[148:151]
    ds_read_b64_tr_b16 v[48:49], v12 offset:0
    v_mfma_f32_16x16x32_bf16 v[180:183], v[52:55], a[180:183], v[180:183]
    ds_read_b64_tr_b16 v[50:51], v12 offset:1024
    v_mfma_f32_16x16x32_bf16 v[212:215], v[52:55], a[184:187], v[212:215]
    ds_read_b128 a[204:207], v28 offset:6144
    v_mfma_f32_16x16x32_bf16 v[244:247], v[52:55], a[188:191], v[244:247]
    buffer_load_dwordx4 v24, s[20:23], s98 offen offset:0  lds
    v_mfma_f32_16x16x32_bf16 v[152:155], v[56:59], a[176:179], v[152:155]
    ds_read_b64_tr_b16 v[52:53], v13 offset:0
    v_mfma_f32_16x16x32_bf16 v[184:187], v[56:59], a[180:183], v[184:187]
    ds_read_b64_tr_b16 v[54:55], v13 offset:1024
    v_mfma_f32_16x16x32_bf16 v[216:219], v[56:59], a[184:187], v[216:219]
    buffer_load_dwordx4 v[80:83], v96, s[8:11], s70 offen
    v_mfma_f32_16x16x32_bf16 v[248:251], v[56:59], a[188:191], v[248:251]
    buffer_load_dwordx4 v25, s[20:23], s98 offen offset:1024  lds
    v_mfma_f32_16x16x32_bf16 v[156:159], v[60:63], a[176:179], v[156:159]
    s_lshl_b32 s80, s2, 6
    s_add_u32 s80, s80, 1310720
    ds_read_b64_tr_b16 v[56:57], v14 offset:0
    v_mfma_f32_16x16x32_bf16 v[188:191], v[60:63], a[180:183], v[188:191]
    s_waitcnt lgkmcnt(6)
    s_add_u32 s70, s70, 12288
    ds_read_b64_tr_b16 v[58:59], v14 offset:1024
    v_mfma_f32_16x16x32_bf16 v[220:223], v[60:63], a[184:187], v[220:223]
    buffer_store_dword v6, v7, s[8:11], s80 offen sc0 sc1
    v_mfma_f32_16x16x32_bf16 v[252:255], v[60:63], a[188:191], v[252:255]
    buffer_load_dwordx4 v26, s[20:23], s98 offen offset:2048  lds
    v_mfma_f32_16x16x32_bf16 v[128:131], v[32:35], a[192:195], v[128:131]
    ds_read_b64_tr_b16 v[60:61], v15 offset:0
    v_mfma_f32_16x16x32_bf16 v[160:163], v[32:35], a[196:199], v[160:163]
    ds_read_b64_tr_b16 v[62:63], v15 offset:1024
    v_mfma_f32_16x16x32_bf16 v[192:195], v[32:35], a[200:203], v[192:195]
    s_waitcnt lgkmcnt(5)
    ds_read_b128 a[208:211], v29 offset:0
    v_mfma_f32_16x16x32_bf16 v[224:227], v[32:35], a[204:207], v[224:227]
    ds_read_b128 a[212:215], v29 offset:2048
    v_mfma_f32_16x16x32_bf16 v[132:135], v[36:39], a[192:195], v[132:135]
    ds_read_b64_tr_b16 v[32:33], v8 offset:8192
    v_mfma_f32_16x16x32_bf16 v[164:167], v[36:39], a[196:199], v[164:167]
    ds_read_b64_tr_b16 v[34:35], v8 offset:9216
    v_mfma_f32_16x16x32_bf16 v[196:199], v[36:39], a[200:203], v[196:199]
    ds_read_b128 a[216:219], v29 offset:4096
    v_mfma_f32_16x16x32_bf16 v[228:231], v[36:39], a[204:207], v[228:231]
    ds_read_b128 a[220:223], v29 offset:6144
    v_mfma_f32_16x16x32_bf16 v[136:139], v[40:43], a[192:195], v[136:139]
    ds_read_b64_tr_b16 v[36:37], v9 offset:8192
    v_mfma_f32_16x16x32_bf16 v[168:171], v[40:43], a[196:199], v[168:171]
    ds_read_b64_tr_b16 v[38:39], v9 offset:9216
    v_mfma_f32_16x16x32_bf16 v[200:203], v[40:43], a[200:203], v[200:203]
    buffer_load_dwordx4 v27, s[20:23], s98 offen offset:3072  lds
    v_mfma_f32_16x16x32_bf16 v[232:235], v[40:43], a[204:207], v[232:235]
    buffer_load_dwordx4 v[84:87], v96, s[8:11], s70 offen
    v_mfma_f32_16x16x32_bf16 v[140:143], v[44:47], a[192:195], v[140:143]
    s_add_u32 m0, s62, 69632
    s_xor_b32 s98, s64, 262144
    ds_read_b64_tr_b16 v[40:41], v10 offset:8192
    v_mfma_f32_16x16x32_bf16 v[172:175], v[44:47], a[196:199], v[172:175]
    s_add_u32 s70, s70, 12288
    ds_read_b64_tr_b16 v[42:43], v10 offset:9216
    v_mfma_f32_16x16x32_bf16 v[204:207], v[44:47], a[200:203], v[204:207]
    buffer_load_dwordx4 v24, s[20:23], s98 offen offset:0  lds
    v_mfma_f32_16x16x32_bf16 v[236:239], v[44:47], a[204:207], v[236:239]
    buffer_load_dwordx4 v[88:91], v96, s[8:11], s70 offen
    v_mfma_f32_16x16x32_bf16 v[144:147], v[48:51], a[192:195], v[144:147]
    s_add_u32 s70, s70, 12288
    ds_read_b64_tr_b16 v[44:45], v11 offset:8192
    v_mfma_f32_16x16x32_bf16 v[176:179], v[48:51], a[196:199], v[176:179]
    s_waitcnt lgkmcnt(5)
    ds_read_b64_tr_b16 v[46:47], v11 offset:9216
    v_mfma_f32_16x16x32_bf16 v[208:211], v[48:51], a[200:203], v[208:211]
    buffer_load_dwordx4 v25, s[20:23], s98 offen offset:1024  lds
    v_mfma_f32_16x16x32_bf16 v[240:243], v[48:51], a[204:207], v[240:243]
    buffer_load_dwordx4 v[92:95], v96, s[8:11], s70 offen
    v_mfma_f32_16x16x32_bf16 v[148:151], v[52:55], a[192:195], v[148:151]
    ds_read_b64_tr_b16 v[48:49], v12 offset:8192
    v_mfma_f32_16x16x32_bf16 v[180:183], v[52:55], a[196:199], v[180:183]
    ds_read_b64_tr_b16 v[50:51], v12 offset:9216
    v_mfma_f32_16x16x32_bf16 v[212:215], v[52:55], a[200:203], v[212:215]
    buffer_load_dwordx4 v26, s[20:23], s98 offen offset:2048  lds
    v_mfma_f32_16x16x32_bf16 v[244:247], v[52:55], a[204:207], v[244:247]
    v_mfma_f32_16x16x32_bf16 v[152:155], v[56:59], a[192:195], v[152:155]
    ds_read_b64_tr_b16 v[52:53], v13 offset:8192
    v_mfma_f32_16x16x32_bf16 v[184:187], v[56:59], a[196:199], v[184:187]
    ds_read_b64_tr_b16 v[54:55], v13 offset:9216
    v_mfma_f32_16x16x32_bf16 v[216:219], v[56:59], a[200:203], v[216:219]
    buffer_load_dwordx4 v27, s[20:23], s98 offen offset:3072  lds
    v_mfma_f32_16x16x32_bf16 v[248:251], v[56:59], a[204:207], v[248:251]
    v_mfma_f32_16x16x32_bf16 v[156:159], v[60:63], a[192:195], v[156:159]
    ds_read_b64_tr_b16 v[56:57], v14 offset:8192
    v_mfma_f32_16x16x32_bf16 v[188:191], v[60:63], a[196:199], v[188:191]
    ds_read_b64_tr_b16 v[58:59], v14 offset:9216
    v_mfma_f32_16x16x32_bf16 v[220:223], v[60:63], a[200:203], v[220:223]
    v_mfma_f32_16x16x32_bf16 v[252:255], v[60:63], a[204:207], v[252:255]
    v_mfma_f32_16x16x32_bf16 v[128:131], v[32:35], a[208:211], v[128:131]
    ds_read_b64_tr_b16 v[60:61], v15 offset:8192
    v_mfma_f32_16x16x32_bf16 v[160:163], v[32:35], a[212:215], v[160:163]
    ds_read_b64_tr_b16 v[62:63], v15 offset:9216
    v_mfma_f32_16x16x32_bf16 v[192:195], v[32:35], a[216:219], v[192:195]
    s_getpc_b64 s[100:101]
L_ct1:
    s_lshr_b32 s99, s2, 3
    s_lshl_b32 s99, s99, 2
    s_add_u32 s99, s99, s3
    s_mul_i32 s99, s99, 2
    v_min_u32 v119, 1, v2
    v_add_u32 v119, s99, v119
    v_lshlrev_b32 v119, 7, v119
    v_add_u32 v119, L_ct1-L_ct1, v119
    v_min_u32 v119, L_attn-L_ct1, v119
    global_load_dword v119, v119, s[100:101]
    v_mfma_f32_16x16x32_bf16 v[224:227], v[32:35], a[220:223], v[224:227]
    s_waitcnt lgkmcnt(4)
    v_mfma_f32_16x16x32_bf16 v[132:135], v[36:39], a[208:211], v[132:135]
    v_mfma_f32_16x16x32_bf16 v[164:167], v[36:39], a[212:215], v[164:167]
    v_mfma_f32_16x16x32_bf16 v[196:199], v[36:39], a[216:219], v[196:199]
    v_mfma_f32_16x16x32_bf16 v[228:231], v[36:39], a[220:223], v[228:231]
    v_mfma_f32_16x16x32_bf16 v[136:139], v[40:43], a[208:211], v[136:139]
    s_waitcnt vmcnt(14) lgkmcnt(0)
    s_barrier
    v_mfma_f32_16x16x32_bf16 v[168:171], v[40:43], a[212:215], v[168:171]
    s_add_u32 m0, s62, 0
    s_xor_b32 s98, s64, 2097152
    ds_read_b64_tr_b16 v[32:33], v8 offset:16384
    v_mfma_f32_16x16x32_bf16 v[200:203], v[40:43], a[216:219], v[200:203]
    ds_read_b64_tr_b16 v[34:35], v8 offset:17408
    v_mfma_f32_16x16x32_bf16 v[232:235], v[40:43], a[220:223], v[232:235]
    ds_read_b64_tr_b16 v[36:37], v9 offset:16384
    v_mfma_f32_16x16x32_bf16 v[140:143], v[44:47], a[208:211], v[140:143]
    ds_read_b64_tr_b16 v[38:39], v9 offset:17408
    v_mfma_f32_16x16x32_bf16 v[172:175], v[44:47], a[212:215], v[172:175]
    ds_read_b64_tr_b16 v[40:41], v10 offset:16384
    v_mfma_f32_16x16x32_bf16 v[204:207], v[44:47], a[216:219], v[204:207]
    ds_read_b64_tr_b16 v[42:43], v10 offset:17408
    v_mfma_f32_16x16x32_bf16 v[236:239], v[44:47], a[220:223], v[236:239]
    ds_read_b128 a[224:227], v28 offset:32768
    v_mfma_f32_16x16x32_bf16 v[144:147], v[48:51], a[208:211], v[144:147]
    ds_read_b64_tr_b16 v[44:45], v11 offset:16384
    v_mfma_f32_16x16x32_bf16 v[176:179], v[48:51], a[212:215], v[176:179]
    ds_read_b64_tr_b16 v[46:47], v11 offset:17408
    v_mfma_f32_16x16x32_bf16 v[208:211], v[48:51], a[216:219], v[208:211]
    ds_read_b128 a[228:231], v28 offset:34816
    v_mfma_f32_16x16x32_bf16 v[240:243], v[48:51], a[220:223], v[240:243]
    ds_read_b128 a[232:235], v28 offset:36864
    v_mfma_f32_16x16x32_bf16 v[148:151], v[52:55], a[208:211], v[148:151]
    ds_read_b64_tr_b16 v[48:49], v12 offset:16384
    v_mfma_f32_16x16x32_bf16 v[180:183], v[52:55], a[212:215], v[180:183]
    ds_read_b64_tr_b16 v[50:51], v12 offset:17408
    v_mfma_f32_16x16x32_bf16 v[212:215], v[52:55], a[216:219], v[212:215]
    ds_read_b128 a[236:239], v28 offset:38912
    v_mfma_f32_16x16x32_bf16 v[244:247], v[52:55], a[220:223], v[244:247]
    buffer_load_dwordx4 v24, s[20:23], s98 offen offset:0  lds
    v_mfma_f32_16x16x32_bf16 v[152:155], v[56:59], a[208:211], v[152:155]
    ds_read_b64_tr_b16 v[52:53], v13 offset:16384
    v_mfma_f32_16x16x32_bf16 v[184:187], v[56:59], a[212:215], v[184:187]
    ds_read_b64_tr_b16 v[54:55], v13 offset:17408
    v_mfma_f32_16x16x32_bf16 v[216:219], v[56:59], a[216:219], v[216:219]
    v_mfma_f32_16x16x32_bf16 v[248:251], v[56:59], a[220:223], v[248:251]
    buffer_load_dwordx4 v25, s[20:23], s98 offen offset:1024  lds
    v_mfma_f32_16x16x32_bf16 v[156:159], v[60:63], a[208:211], v[156:159]
    ds_read_b64_tr_b16 v[56:57], v14 offset:16384
    v_mfma_f32_16x16x32_bf16 v[188:191], v[60:63], a[212:215], v[188:191]
    ds_read_b64_tr_b16 v[58:59], v14 offset:17408
    v_mfma_f32_16x16x32_bf16 v[220:223], v[60:63], a[216:219], v[220:223]
    s_waitcnt lgkmcnt(6)
    v_mfma_f32_16x16x32_bf16 v[252:255], v[60:63], a[220:223], v[252:255]
    buffer_load_dwordx4 v26, s[20:23], s98 offen offset:2048  lds
    v_mfma_f32_16x16x32_bf16 v[128:131], v[32:35], a[224:227], v[128:131]
    ds_read_b64_tr_b16 v[60:61], v15 offset:16384
    v_mfma_f32_16x16x32_bf16 v[160:163], v[32:35], a[228:231], v[160:163]
    ds_read_b64_tr_b16 v[62:63], v15 offset:17408
    v_mfma_f32_16x16x32_bf16 v[192:195], v[32:35], a[232:235], v[192:195]
    s_waitcnt lgkmcnt(5)
    ds_read_b128 a[240:243], v29 offset:32768
    v_mfma_f32_16x16x32_bf16 v[224:227], v[32:35], a[236:239], v[224:227]
    ds_read_b128 a[244:247], v29 offset:34816
    v_mfma_f32_16x16x32_bf16 v[132:135], v[36:39], a[224:227], v[132:135]
    ds_read_b64_tr_b16 v[32:33], v8 offset:24576
    v_mfma_f32_16x16x32_bf16 v[164:167], v[36:39], a[228:231], v[164:167]
    ds_read_b64_tr_b16 v[34:35], v8 offset:25600
    s_waitcnt vmcnt(10)
    v_add_f32 v80, v80, v84
    s_waitcnt vmcnt(6)
    v_add_f32 v88, v88, v92
    v_mfma_f32_16x16x32_bf16 v[196:199], v[36:39], a[232:235], v[196:199]
    ds_read_b128 a[248:251], v29 offset:36864
    v_add_f32 v81, v81, v85
    v_add_f32 v89, v89, v93
    v_mfma_f32_16x16x32_bf16 v[228:231], v[36:39], a[236:239], v[228:231]
    ds_read_b128 a[252:255], v29 offset:38912
    v_add_f32 v82, v82, v86
    v_add_f32 v90, v90, v94
    v_mfma_f32_16x16x32_bf16 v[136:139], v[40:43], a[224:227], v[136:139]
    ds_read_b64_tr_b16 v[36:37], v9 offset:24576
    v_and_b32 v16, 15, v2
    v_add_f32 v83, v83, v87
    v_mfma_f32_16x16x32_bf16 v[168:171], v[40:43], a[228:231], v[168:171]
    ds_read_b64_tr_b16 v[38:39], v9 offset:25600
    v_lshrrev_b32 v17, 4, v2
    v_add_f32 v91, v91, v95
    v_mfma_f32_16x16x32_bf16 v[200:203], v[40:43], a[232:235], v[200:203]
    v_lshrrev_b32 v29, 2, v16
    v_and_b32 v16, 3, v16
    v_add_f32 v80, v80, v88
    v_mfma_f32_16x16x32_bf16 v[232:235], v[40:43], a[236:239], v[232:235]
    buffer_load_dwordx4 v27, s[20:23], s98 offen offset:3072  lds
    v_add_f32 v81, v81, v89
    v_mfma_f32_16x16x32_bf16 v[140:143], v[44:47], a[224:227], v[140:143]
    s_add_u32 m0, s62, 4096
    ds_read_b64_tr_b16 v[40:41], v10 offset:24576
    v_lshl_add_u32 v28, v17, 3, v29
    v_add_f32 v82, v82, v90
    v_mfma_f32_16x16x32_bf16 v[172:175], v[44:47], a[228:231], v[172:175]
    s_xor_b32 s98, s64, 2359296
    ds_read_b64_tr_b16 v[42:43], v10 offset:25600
    v_lshlrev_b32 v28, 7, v28
    v_add_f32 v83, v83, v91
    v_mfma_f32_16x16x32_bf16 v[204:207], v[44:47], a[232:235], v[204:207]
    v_lshl_add_u32 v28, v16, 3, v28
    v_and_b32 v17, 1, v17
    v_lshrrev_b32 v88, 5, v2
    v_mfma_f32_16x16x32_bf16 v[236:239], v[44:47], a[236:239], v[236:239]
    buffer_load_dwordx4 v24, s[20:23], s98 offen offset:0  lds
    v_cvt_f32_u32 v88, v88
    v_mfma_f32_16x16x32_bf16 v[144:147], v[48:51], a[224:227], v[144:147]
    ds_read_b64_tr_b16 v[44:45], v11 offset:24576
    v_lshrrev_b32 v29, 1, v29
    v_cvt_pk_bf16_f32 v84, v80, v81
    v_mfma_f32_16x16x32_bf16 v[176:179], v[48:51], a[228:231], v[176:179]
    ds_read_b64_tr_b16 v[46:47], v11 offset:25600
    v_lshl_add_u32 v29, v17, 1, v29
    v_cvt_pk_bf16_f32 v85, v82, v83
    v_mfma_f32_16x16x32_bf16 v[208:211], v[48:51], a[232:235], v[208:211]
    s_waitcnt lgkmcnt(5)
    v_lshl_add_u32 v28, v29, 5, v28
    v_add_u32 v28, 65536, v28
    v_lshlrev_b32 v80, 16, v84
    v_mfma_f32_16x16x32_bf16 v[240:243], v[48:51], a[236:239], v[240:243]
    buffer_load_dwordx4 v25, s[20:23], s98 offen offset:1024  lds
    v_and_b32 v81, 0xffff0000, v84
    v_mfma_f32_16x16x32_bf16 v[148:151], v[52:55], a[224:227], v[148:151]
    ds_read_b64_tr_b16 v[48:49], v12 offset:24576
    v_xor_b32 v29, 32, v28
    v_lshlrev_b32 v82, 16, v85
    v_mfma_f32_16x16x32_bf16 v[180:183], v[52:55], a[228:231], v[180:183]
    ds_read_b64_tr_b16 v[50:51], v12 offset:25600
    v_xor_b32 v30, 64, v28
    v_and_b32 v83, 0xffff0000, v85
    v_mfma_f32_16x16x32_bf16 v[212:215], v[52:55], a[232:235], v[212:215]
    v_xor_b32 v31, 96, v28
    v_and_b32 v16, 15, v2
    v_add_f32 v80, v80, v88
    v_mfma_f32_16x16x32_bf16 v[244:247], v[52:55], a[236:239], v[244:247]
    buffer_load_dwordx4 v26, s[20:23], s98 offen offset:2048  lds
    v_add_f32 v81, v81, v88
    v_mfma_f32_16x16x32_bf16 v[152:155], v[56:59], a[224:227], v[152:155]
    ds_read_b64_tr_b16 v[52:53], v13 offset:24576
    v_lshlrev_b32 v16, 6, v16
    v_add_f32 v82, v82, v88
    v_mfma_f32_16x16x32_bf16 v[184:187], v[56:59], a[228:231], v[184:187]
    ds_read_b64_tr_b16 v[54:55], v13 offset:25600
    v_add_u32 v16, 65536, v16
    v_add_f32 v83, v83, v88
    v_mfma_f32_16x16x32_bf16 v[216:219], v[56:59], a[232:235], v[216:219]
    v_mad_i32_i24 v16, v17, s77, v16
    v_and_b32 v17, 31, v2
    v_cvt_pk_bf16_f32 v84, v80, v81
    v_mfma_f32_16x16x32_bf16 v[248:251], v[56:59], a[236:239], v[248:251]
    buffer_load_dwordx4 v27, s[20:23], s98 offen offset:3072  lds
    v_cvt_pk_bf16_f32 v85, v82, v83
    v_mfma_f32_16x16x32_bf16 v[156:159], v[60:63], a[224:227], v[156:159]
    ds_read_b64_tr_b16 v[56:57], v14 offset:24576
    v_lshlrev_b32 v17, 6, v17
    v_lshlrev_b32 v80, 16, v84
    v_mfma_f32_16x16x32_bf16 v[188:191], v[60:63], a[228:231], v[188:191]
    ds_read_b64_tr_b16 v[58:59], v14 offset:25600
    v_and_b32 v81, 0xffff0000, v84
    v_lshlrev_b32 v82, 16, v85
    v_mfma_f32_16x16x32_bf16 v[220:223], v[60:63], a[232:235], v[220:223]
    v_and_b32 v83, 0xffff0000, v85
    v_mul_f32 v80, 0x3e0293ee, v80
    v_mul_f32 v81, 0x3e0293ee, v81
    v_mfma_f32_16x16x32_bf16 v[252:255], v[60:63], a[236:239], v[252:255]
    v_mul_f32 v82, 0x3e0293ee, v82
    v_mul_f32 v83, 0x3e0293ee, v83
    v_mfma_f32_16x16x32_bf16 v[128:131], v[32:35], a[240:243], v[128:131]
    s_lshl_b32 s70, s3, 10
    s_add_u32 s70, s70, 151552
    ds_read_b64_tr_b16 v[60:61], v15 offset:24576
    v_add_u32 v88, s70, v1
    v_add_u32 v18, s70, v18
    v_mfma_f32_16x16x32_bf16 v[160:163], v[32:35], a[244:247], v[160:163]
    ds_read_b64_tr_b16 v[62:63], v15 offset:25600
    ds_write_b128 v88, v[80:83]
    v_mfma_f32_16x16x32_bf16 v[192:195], v[32:35], a[248:251], v[192:195]
    v_mfma_f32_16x16x32_bf16 v[224:227], v[32:35], a[252:255], v[224:227]
    s_waitcnt lgkmcnt(5)
    v_mfma_f32_16x16x32_bf16 v[132:135], v[36:39], a[240:243], v[132:135]
    v_mfma_f32_16x16x32_bf16 v[164:167], v[36:39], a[244:247], v[164:167]
    v_mfma_f32_16x16x32_bf16 v[196:199], v[36:39], a[248:251], v[196:199]
    v_mfma_f32_16x16x32_bf16 v[228:231], v[36:39], a[252:255], v[228:231]
    ds_read_b128 v[80:83], v18 offset:0
    v_mfma_f32_16x16x32_bf16 v[136:139], v[40:43], a[240:243], v[136:139]
    ds_read_b128 v[84:87], v18 offset:16
    s_waitcnt vmcnt(9) lgkmcnt(0)
    s_barrier
    v_mfma_f32_16x16x32_bf16 v[168:171], v[40:43], a[244:247], v[168:171]
    s_add_u32 m0, s62, 32768
    s_xor_b32 s98, s64, 128
    ds_read_b64_tr_b16 v[32:33], v28 offset:0
    v_mfma_f32_16x16x32_bf16 v[200:203], v[40:43], a[248:251], v[200:203]
    ds_read_b64_tr_b16 v[34:35], v28 offset:512
    v_mfma_f32_16x16x32_bf16 v[232:235], v[40:43], a[252:255], v[232:235]
    ds_read_b64_tr_b16 v[36:37], v28 offset:4096
    v_mfma_f32_16x16x32_bf16 v[140:143], v[44:47], a[240:243], v[140:143]
    ds_read_b64_tr_b16 v[38:39], v28 offset:4608
    v_mfma_f32_16x16x32_bf16 v[172:175], v[44:47], a[244:247], v[172:175]
    ds_read_b64_tr_b16 v[40:41], v29 offset:0
    v_mfma_f32_16x16x32_bf16 v[204:207], v[44:47], a[248:251], v[204:207]
    ds_read_b64_tr_b16 v[42:43], v29 offset:512
    v_mfma_f32_16x16x32_bf16 v[236:239], v[44:47], a[252:255], v[236:239]
    buffer_load_dwordx4 v24, s[20:23], s98 offen offset:0  lds
    v_mfma_f32_16x16x32_bf16 v[144:147], v[48:51], a[240:243], v[144:147]
    ds_read_b64_tr_b16 v[44:45], v29 offset:4096
    v_mfma_f32_16x16x32_bf16 v[176:179], v[48:51], a[244:247], v[176:179]
    ds_read_b64_tr_b16 v[46:47], v29 offset:4608
    v_mfma_f32_16x16x32_bf16 v[208:211], v[48:51], a[248:251], v[208:211]
    ds_read_b128 v[88:91], v18 offset:512
    v_mfma_f32_16x16x32_bf16 v[240:243], v[48:51], a[252:255], v[240:243]
    buffer_load_dwordx4 v25, s[20:23], s98 offen offset:1024  lds
    v_mfma_f32_16x16x32_bf16 v[148:151], v[52:55], a[240:243], v[148:151]
    ds_read_b64_tr_b16 v[48:49], v28 offset:8192
    v_mfma_f32_16x16x32_bf16 v[180:183], v[52:55], a[244:247], v[180:183]
    ds_read_b64_tr_b16 v[50:51], v28 offset:8704
    v_mfma_f32_16x16x32_bf16 v[212:215], v[52:55], a[248:251], v[212:215]
    ds_read_b128 v[92:95], v18 offset:528
    v_mfma_f32_16x16x32_bf16 v[244:247], v[52:55], a[252:255], v[244:247]
    buffer_load_dwordx4 v26, s[20:23], s98 offen offset:2048  lds
    v_mfma_f32_16x16x32_bf16 v[152:155], v[56:59], a[240:243], v[152:155]
    ds_read_b64_tr_b16 v[52:53], v28 offset:12288
    v_mfma_f32_16x16x32_bf16 v[184:187], v[56:59], a[244:247], v[184:187]
    ds_read_b64_tr_b16 v[54:55], v28 offset:12800
    v_mfma_f32_16x16x32_bf16 v[216:219], v[56:59], a[248:251], v[216:219]
    v_mfma_f32_16x16x32_bf16 v[248:251], v[56:59], a[252:255], v[248:251]
    buffer_load_dwordx4 v27, s[20:23], s98 offen offset:3072  lds
    v_mfma_f32_16x16x32_bf16 v[156:159], v[60:63], a[240:243], v[156:159]
    s_add_u32 m0, s62, 36864
    s_xor_b32 s98, s64, 262272
    ds_read_b64_tr_b16 v[56:57], v29 offset:8192
    v_mfma_f32_16x16x32_bf16 v[188:191], v[60:63], a[244:247], v[188:191]
    ds_read_b64_tr_b16 v[58:59], v29 offset:8704
    s_waitcnt lgkmcnt(7)
    v_fma_f32 v64, v64, v88, v80
    v_mfma_f32_16x16x32_bf16 v[220:223], v[60:63], a[248:251], v[220:223]
    v_fma_f32 v65, v65, v89, v81
    v_fma_f32 v66, v66, v90, v82
    v_mfma_f32_16x16x32_bf16 v[252:255], v[60:63], a[252:255], v[252:255]
    buffer_load_dwordx4 v24, s[20:23], s98 offen offset:0  lds
    v_mfma_f32_16x16x32_bf16 v[96:99], a[0:3], v[32:35], 0
    ds_read_b64_tr_b16 v[60:61], v29 offset:12288
    v_fma_f32 v67, v67, v91, v83
    v_mfma_f32_16x16x32_bf16 v[96:99], a[16:19], v[36:39], v[96:99]
    ds_read_b64_tr_b16 v[62:63], v29 offset:12800
    s_waitcnt lgkmcnt(6)
    v_fma_f32 v68, v68, v92, v84
    v_mfma_f32_16x16x32_bf16 v[100:103], a[4:7], v[32:35], 0
    v_fma_f32 v69, v69, v93, v85
    v_fma_f32 v70, v70, v94, v86
    v_mfma_f32_16x16x32_bf16 v[100:103], a[20:23], v[36:39], v[100:103]
    buffer_load_dwordx4 v25, s[20:23], s98 offen offset:1024  lds
    v_mfma_f32_16x16x32_bf16 v[104:107], a[8:11], v[32:35], 0
    v_fma_f32 v71, v71, v95, v87
    v_mfma_f32_16x16x32_bf16 v[104:107], a[24:27], v[36:39], v[104:107]
    v_cvt_pk_bf16_f32 v64, v64, v65
    v_cvt_pk_bf16_f32 v65, v66, v67
    v_mfma_f32_16x16x32_bf16 v[108:111], a[12:15], v[32:35], 0
    v_cvt_pk_bf16_f32 v66, v68, v69
    v_cvt_pk_bf16_f32 v67, v70, v71
    v_mfma_f32_16x16x32_bf16 v[108:111], a[28:31], v[36:39], v[108:111]
    buffer_load_dwordx4 v26, s[20:23], s98 offen offset:2048  lds
    v_mfma_f32_16x16x32_bf16 v[112:115], a[0:3], v[40:43], 0
    ds_read_b64_tr_b16 v[32:33], v28 offset:16384
    v_cvt_pk_bf16_f32 v128, v128, v129
    v_mfma_f32_16x16x32_bf16 v[112:115], a[16:19], v[44:47], v[112:115]
    s_waitcnt vmcnt(15)
    ds_read_b64_tr_b16 v[34:35], v28 offset:16896
    v_cvt_pk_bf16_f32 v129, v130, v131
    v_mfma_f32_16x16x32_bf16 v[116:119], a[4:7], v[40:43], 0
    ds_read_b64_tr_b16 v[36:37], v28 offset:20480
    v_cvt_pk_bf16_f32 v130, v132, v133
    v_mfma_f32_16x16x32_bf16 v[116:119], a[20:23], v[44:47], v[116:119]
    ds_read_b64_tr_b16 v[38:39], v28 offset:20992
    v_cvt_pk_bf16_f32 v131, v134, v135
    v_mfma_f32_16x16x32_bf16 v[120:123], a[8:11], v[40:43], 0
    buffer_load_dwordx4 v27, s[20:23], s98 offen offset:3072  lds
    v_mfma_f32_16x16x32_bf16 v[120:123], a[24:27], v[44:47], v[120:123]
    s_add_u32 m0, s63, 131072
    s_xor_b32 s98, s0, 0
    ds_read_b128 v[80:83], v18 offset:256
    v_mfma_f32_16x16x32_bf16 v[124:127], a[12:15], v[40:43], 0
    buffer_store_dwordx4 v[64:67], v19, s[8:11], s71 offen offset:0 sc0 sc1
    v_mfma_f32_16x16x32_bf16 v[124:127], a[28:31], v[44:47], v[124:127]
    s_xor_b32 s79, s65, 0
    ds_read_b128 v[84:87], v18 offset:272
    v_mfma_f32_16x16x32_bf16 v[96:99], a[32:35], v[48:51], v[96:99]
    s_waitcnt lgkmcnt(6)
    ds_read_b64_tr_b16 v[40:41], v29 offset:16384
    v_mfma_f32_16x16x32_bf16 v[96:99], a[48:51], v[52:55], v[96:99]
    ds_read_b64_tr_b16 v[42:43], v29 offset:16896
    v_mfma_f32_16x16x32_bf16 v[100:103], a[36:39], v[48:51], v[100:103]
    ds_read_b64_tr_b16 v[44:45], v29 offset:20480
    v_mfma_f32_16x16x32_bf16 v[100:103], a[52:55], v[52:55], v[100:103]
    ds_read_b64_tr_b16 v[46:47], v29 offset:20992
    v_mfma_f32_16x16x32_bf16 v[104:107], a[40:43], v[48:51], v[104:107]
    buffer_load_dwordx4 v20, s[24:27], s98 offen offset:0  lds
    v_mfma_f32_16x16x32_bf16 v[104:107], a[56:59], v[52:55], v[104:107]
    s_lshr_b32 s100, s2, 3
    s_mul_i32 s66, s4, 28
    ds_read_b128 v[88:91], v18 offset:768
    v_mfma_f32_16x16x32_bf16 v[108:111], a[44:47], v[48:51], v[108:111]
    s_add_u32 s66, s66, s100
    s_cmp_lt_u32 s100, 28
    s_cselect_b32 s66, s66, 255
    ds_read_b128 v[92:95], v18 offset:784
    v_mfma_f32_16x16x32_bf16 v[108:111], a[60:63], v[52:55], v[108:111]
    buffer_store_dwordx4 v[128:131], v1, s[8:11], s79 offen offset:0 sc0 sc1
    v_mfma_f32_16x16x32_bf16 v[112:115], a[32:35], v[56:59], v[112:115]
    s_lshl_b32 s67, s4, 3
    s_add_u32 s67, s67, s100
    ds_read_b64_tr_b16 v[48:49], v28 offset:24576
    v_mfma_f32_16x16x32_bf16 v[112:115], a[48:51], v[60:63], v[112:115]
    s_sub_u32 s67, s67, 24
    ds_read_b64_tr_b16 v[50:51], v28 offset:25088
    v_cvt_pk_bf16_f32 v136, v136, v137
    v_mfma_f32_16x16x32_bf16 v[116:119], a[36:39], v[56:59], v[116:119]
    s_cmp_ge_u32 s100, 24
    s_cselect_b32 s67, s67, 255
    ds_read_b64_tr_b16 v[52:53], v28 offset:28672
    v_cvt_pk_bf16_f32 v137, v138, v139
    v_mfma_f32_16x16x32_bf16 v[116:119], a[52:55], v[60:63], v[116:119]
    ds_read_b64_tr_b16 v[54:55], v28 offset:29184
    v_cvt_pk_bf16_f32 v138, v140, v141
    v_mfma_f32_16x16x32_bf16 v[120:123], a[40:43], v[56:59], v[120:123]
    buffer_load_dwordx4 v21, s[24:27], s98 offen offset:1024  lds
    v_mfma_f32_16x16x32_bf16 v[120:123], a[56:59], v[60:63], v[120:123]
    s_waitcnt lgkmcnt(5)
    v_fma_f32 v72, v72, v88, v80
    v_fma_f32 v73, v73, v89, v81
    v_mfma_f32_16x16x32_bf16 v[124:127], a[44:47], v[56:59], v[124:127]
    v_fma_f32 v74, v74, v90, v82
    v_fma_f32 v75, v75, v91, v83
    v_mfma_f32_16x16x32_bf16 v[124:127], a[60:63], v[60:63], v[124:127]
    v_cvt_pk_bf16_f32 v139, v142, v143
    v_mfma_f32_16x16x32_bf16 v[96:99], a[64:67], v[32:35], v[96:99]
    s_xor_b32 s79, s65, 0
    ds_read_b64_tr_b16 v[56:57], v29 offset:24576
    s_waitcnt lgkmcnt(5)
    v_fma_f32 v76, v76, v92, v84
    v_mfma_f32_16x16x32_bf16 v[96:99], a[80:83], v[36:39], v[96:99]
    ds_read_b64_tr_b16 v[58:59], v29 offset:25088
    v_fma_f32 v77, v77, v93, v85
    v_mfma_f32_16x16x32_bf16 v[100:103], a[68:71], v[32:35], v[100:103]
    ds_read_b64_tr_b16 v[60:61], v29 offset:28672
    v_fma_f32 v78, v78, v94, v86
    v_mfma_f32_16x16x32_bf16 v[100:103], a[84:87], v[36:39], v[100:103]
    ds_read_b64_tr_b16 v[62:63], v29 offset:29184
    v_fma_f32 v79, v79, v95, v87
    v_mfma_f32_16x16x32_bf16 v[104:107], a[72:75], v[32:35], v[104:107]
    buffer_load_dwordx4 v22, s[24:27], s98 offen offset:2048  lds
    v_mfma_f32_16x16x32_bf16 v[104:107], a[88:91], v[36:39], v[104:107]
    v_cvt_pk_bf16_f32 v72, v72, v73
    v_cvt_pk_bf16_f32 v73, v74, v75
    v_mfma_f32_16x16x32_bf16 v[108:111], a[76:79], v[32:35], v[108:111]
    v_cvt_pk_bf16_f32 v74, v76, v77
    v_cvt_pk_bf16_f32 v75, v78, v79
    v_mfma_f32_16x16x32_bf16 v[108:111], a[92:95], v[36:39], v[108:111]
    buffer_store_dwordx4 v[72:75], v19, s[8:11], s71 offen offset:2048 sc0 sc1
    v_mfma_f32_16x16x32_bf16 v[112:115], a[64:67], v[40:43], v[112:115]
    ds_read_b64_tr_b16 v[32:33], v30 offset:0
    v_mfma_f32_16x16x32_bf16 v[112:115], a[80:83], v[44:47], v[112:115]
    ds_read_b64_tr_b16 v[34:35], v30 offset:512
    v_mfma_f32_16x16x32_bf16 v[116:119], a[68:71], v[40:43], v[116:119]
    ds_read_b64_tr_b16 v[36:37], v30 offset:4096
    v_mfma_f32_16x16x32_bf16 v[116:119], a[84:87], v[44:47], v[116:119]
    ds_read_b64_tr_b16 v[38:39], v30 offset:4608
    v_mfma_f32_16x16x32_bf16 v[120:123], a[72:75], v[40:43], v[120:123]
    buffer_load_dwordx4 v23, s[24:27], s98 offen offset:3072  lds
    v_mfma_f32_16x16x32_bf16 v[120:123], a[88:91], v[44:47], v[120:123]
    s_add_u32 m0, s63, 98304
    s_xor_b32 s98, s0, 524288
    v_mfma_f32_16x16x32_bf16 v[124:127], a[76:79], v[40:43], v[124:127]
    buffer_store_dwordx4 v[136:139], v1, s[8:11], s79 offen offset:1024 sc0 sc1
    v_mfma_f32_16x16x32_bf16 v[124:127], a[92:95], v[44:47], v[124:127]
    s_waitcnt lgkmcnt(4)
    v_mfma_f32_16x16x32_bf16 v[96:99], a[96:99], v[48:51], v[96:99]
    ds_read_b64_tr_b16 v[40:41], v31 offset:0
    v_cvt_pk_bf16_f32 v144, v144, v145
    v_mfma_f32_16x16x32_bf16 v[96:99], a[112:115], v[52:55], v[96:99]
    ds_read_b64_tr_b16 v[42:43], v31 offset:512
    v_cvt_pk_bf16_f32 v145, v146, v147
    v_mfma_f32_16x16x32_bf16 v[100:103], a[100:103], v[48:51], v[100:103]
    ds_read_b64_tr_b16 v[44:45], v31 offset:4096
    v_cvt_pk_bf16_f32 v146, v148, v149
    v_mfma_f32_16x16x32_bf16 v[100:103], a[116:119], v[52:55], v[100:103]
    ds_read_b64_tr_b16 v[46:47], v31 offset:4608
    v_cvt_pk_bf16_f32 v147, v150, v151
    v_mfma_f32_16x16x32_bf16 v[104:107], a[104:107], v[48:51], v[104:107]
    buffer_load_dwordx4 v20, s[24:27], s98 offen offset:0  lds
    v_mfma_f32_16x16x32_bf16 v[104:107], a[120:123], v[52:55], v[104:107]
    s_xor_b32 s79, s65, 0
    v_mfma_f32_16x16x32_bf16 v[108:111], a[108:111], v[48:51], v[108:111]
    buffer_store_dwordx4 v[144:147], v1, s[8:11], s79 offen offset:2048 sc0 sc1
    v_mfma_f32_16x16x32_bf16 v[108:111], a[124:127], v[52:55], v[108:111]
    v_mfma_f32_16x16x32_bf16 v[112:115], a[96:99], v[56:59], v[112:115]
    ds_read_b64_tr_b16 v[48:49], v30 offset:8192
    v_mfma_f32_16x16x32_bf16 v[112:115], a[112:115], v[60:63], v[112:115]
    ds_read_b64_tr_b16 v[50:51], v30 offset:8704
    v_mfma_f32_16x16x32_bf16 v[116:119], a[100:103], v[56:59], v[116:119]
    ds_read_b64_tr_b16 v[52:53], v30 offset:12288
    v_mfma_f32_16x16x32_bf16 v[116:119], a[116:119], v[60:63], v[116:119]
    ds_read_b64_tr_b16 v[54:55], v30 offset:12800
    v_cvt_pk_bf16_f32 v152, v152, v153
    v_mfma_f32_16x16x32_bf16 v[120:123], a[104:107], v[56:59], v[120:123]
    buffer_load_dwordx4 v21, s[24:27], s98 offen offset:1024  lds
    v_mfma_f32_16x16x32_bf16 v[120:123], a[120:123], v[60:63], v[120:123]
    v_cvt_pk_bf16_f32 v153, v154, v155
    v_cvt_pk_bf16_f32 v154, v156, v157
    v_mfma_f32_16x16x32_bf16 v[124:127], a[108:111], v[56:59], v[124:127]
    v_cvt_pk_bf16_f32 v155, v158, v159
    v_mfma_f32_16x16x32_bf16 v[124:127], a[124:127], v[60:63], v[124:127]
    s_waitcnt lgkmcnt(4)
    v_mfma_f32_16x16x32_bf16 v[64:67], a[0:3], v[32:35], 0
    s_xor_b32 s79, s65, 0
    ds_read_b64_tr_b16 v[56:57], v31 offset:8192
    v_mfma_f32_16x16x32_bf16 v[64:67], a[16:19], v[36:39], v[64:67]
    ds_read_b64_tr_b16 v[58:59], v31 offset:8704
    v_mfma_f32_16x16x32_bf16 v[68:71], a[4:7], v[32:35], 0
    ds_read_b64_tr_b16 v[60:61], v31 offset:12288
    v_mfma_f32_16x16x32_bf16 v[68:71], a[20:23], v[36:39], v[68:71]
    ds_read_b64_tr_b16 v[62:63], v31 offset:12800
    v_mfma_f32_16x16x32_bf16 v[72:75], a[8:11], v[32:35], 0
    buffer_load_dwordx4 v22, s[24:27], s98 offen offset:2048  lds
    v_mfma_f32_16x16x32_bf16 v[72:75], a[24:27], v[36:39], v[72:75]
    buffer_store_dwordx4 v[152:155], v1, s[8:11], s79 offen offset:3072 sc0 sc1
    v_mfma_f32_16x16x32_bf16 v[76:79], a[12:15], v[32:35], 0
    v_mfma_f32_16x16x32_bf16 v[76:79], a[28:31], v[36:39], v[76:79]
    v_mfma_f32_16x16x32_bf16 v[80:83], a[0:3], v[40:43], 0
    ds_read_b64_tr_b16 v[32:33], v30 offset:16384
    v_mfma_f32_16x16x32_bf16 v[80:83], a[16:19], v[44:47], v[80:83]
    ds_read_b64_tr_b16 v[34:35], v30 offset:16896
    v_mfma_f32_16x16x32_bf16 v[84:87], a[4:7], v[40:43], 0
    ds_read_b64_tr_b16 v[36:37], v30 offset:20480
    v_mfma_f32_16x16x32_bf16 v[84:87], a[20:23], v[44:47], v[84:87]
    ds_read_b64_tr_b16 v[38:39], v30 offset:20992
    v_mfma_f32_16x16x32_bf16 v[88:91], a[8:11], v[40:43], 0
    buffer_load_dwordx4 v23, s[24:27], s98 offen offset:3072  lds
    v_mfma_f32_16x16x32_bf16 v[88:91], a[24:27], v[44:47], v[88:91]
    v_cvt_pk_bf16_f32 v160, v160, v161
    v_cvt_pk_bf16_f32 v161, v162, v163
    v_mfma_f32_16x16x32_bf16 v[92:95], a[12:15], v[40:43], 0
    v_cvt_pk_bf16_f32 v162, v164, v165
    v_cvt_pk_bf16_f32 v163, v166, v167
    v_mfma_f32_16x16x32_bf16 v[92:95], a[28:31], v[44:47], v[92:95]
    s_waitcnt lgkmcnt(4)
    v_mfma_f32_16x16x32_bf16 v[64:67], a[32:35], v[48:51], v[64:67]
    s_xor_b32 s79, s65, 4096
    ds_read_b64_tr_b16 v[40:41], v31 offset:16384
    v_mfma_f32_16x16x32_bf16 v[64:67], a[48:51], v[52:55], v[64:67]
    ds_read_b64_tr_b16 v[42:43], v31 offset:16896
    v_mfma_f32_16x16x32_bf16 v[68:71], a[36:39], v[48:51], v[68:71]
    ds_read_b64_tr_b16 v[44:45], v31 offset:20480
    v_mfma_f32_16x16x32_bf16 v[68:71], a[52:55], v[52:55], v[68:71]
    ds_read_b64_tr_b16 v[46:47], v31 offset:20992
    v_mfma_f32_16x16x32_bf16 v[72:75], a[40:43], v[48:51], v[72:75]
    buffer_store_dwordx4 v[160:163], v1, s[8:11], s79 offen offset:0 sc0 sc1
    v_mfma_f32_16x16x32_bf16 v[72:75], a[56:59], v[52:55], v[72:75]
    v_mfma_f32_16x16x32_bf16 v[76:79], a[44:47], v[48:51], v[76:79]
    v_mfma_f32_16x16x32_bf16 v[76:79], a[60:63], v[52:55], v[76:79]
    v_mfma_f32_16x16x32_bf16 v[80:83], a[32:35], v[56:59], v[80:83]
    ds_read_b64_tr_b16 v[48:49], v30 offset:24576
    v_mfma_f32_16x16x32_bf16 v[80:83], a[48:51], v[60:63], v[80:83]
    ds_read_b64_tr_b16 v[50:51], v30 offset:25088
    v_mfma_f32_16x16x32_bf16 v[84:87], a[36:39], v[56:59], v[84:87]
    ds_read_b64_tr_b16 v[52:53], v30 offset:28672
    v_mfma_f32_16x16x32_bf16 v[84:87], a[52:55], v[60:63], v[84:87]
    ds_read_b64_tr_b16 v[54:55], v30 offset:29184
    v_mfma_f32_16x16x32_bf16 v[88:91], a[40:43], v[56:59], v[88:91]
    v_mfma_f32_16x16x32_bf16 v[88:91], a[56:59], v[60:63], v[88:91]
    v_cvt_pk_bf16_f32 v168, v168, v169
    v_cvt_pk_bf16_f32 v169, v170, v171
    v_mfma_f32_16x16x32_bf16 v[92:95], a[44:47], v[56:59], v[92:95]
    v_cvt_pk_bf16_f32 v170, v172, v173
    v_cvt_pk_bf16_f32 v171, v174, v175
    v_mfma_f32_16x16x32_bf16 v[92:95], a[60:63], v[60:63], v[92:95]
    s_waitcnt lgkmcnt(4)
    v_mfma_f32_16x16x32_bf16 v[64:67], a[64:67], v[32:35], v[64:67]
    s_xor_b32 s79, s65, 4096
    ds_read_b64_tr_b16 v[56:57], v31 offset:24576
    v_mfma_f32_16x16x32_bf16 v[64:67], a[80:83], v[36:39], v[64:67]
    ds_read_b64_tr_b16 v[58:59], v31 offset:25088
    v_mfma_f32_16x16x32_bf16 v[68:71], a[68:71], v[32:35], v[68:71]
    ds_read_b64_tr_b16 v[60:61], v31 offset:28672
    v_mfma_f32_16x16x32_bf16 v[68:71], a[84:87], v[36:39], v[68:71]
    ds_read_b64_tr_b16 v[62:63], v31 offset:29184
    v_mfma_f32_16x16x32_bf16 v[72:75], a[72:75], v[32:35], v[72:75]
    buffer_store_dwordx4 v[168:171], v1, s[8:11], s79 offen offset:1024 sc0 sc1
    v_mfma_f32_16x16x32_bf16 v[72:75], a[88:91], v[36:39], v[72:75]
    v_mfma_f32_16x16x32_bf16 v[76:79], a[76:79], v[32:35], v[76:79]
    v_mfma_f32_16x16x32_bf16 v[76:79], a[92:95], v[36:39], v[76:79]
    v_mfma_f32_16x16x32_bf16 v[80:83], a[64:67], v[40:43], v[80:83]
    v_mfma_f32_16x16x32_bf16 v[80:83], a[80:83], v[44:47], v[80:83]
    v_mfma_f32_16x16x32_bf16 v[84:87], a[68:71], v[40:43], v[84:87]
    v_mfma_f32_16x16x32_bf16 v[84:87], a[84:87], v[44:47], v[84:87]
    v_mfma_f32_16x16x32_bf16 v[88:91], a[72:75], v[40:43], v[88:91]
    v_mfma_f32_16x16x32_bf16 v[88:91], a[88:91], v[44:47], v[88:91]
    s_waitcnt vmcnt(10)
    v_mfma_f32_16x16x32_bf16 v[92:95], a[76:79], v[40:43], v[92:95]
    v_xor_b32 v28, 65536, v28
    v_cvt_pk_bf16_f32 v176, v176, v177
    s_waitcnt lgkmcnt(0)
    s_barrier
    v_mfma_f32_16x16x32_bf16 v[92:95], a[92:95], v[44:47], v[92:95]
    s_add_u32 m0, s62, 65536
    ds_read_b64_tr_b16 v[32:33], v28 offset:0
    v_xor_b32 v29, 65536, v29
    v_mfma_f32_16x16x32_bf16 v[64:67], a[96:99], v[48:51], v[64:67]
    s_xor_b32 s98, s64, 2097280
    ds_read_b64_tr_b16 v[34:35], v28 offset:512
    v_cvt_pk_bf16_f32 v177, v178, v179
    v_mfma_f32_16x16x32_bf16 v[64:67], a[112:115], v[52:55], v[64:67]
    ds_read_b64_tr_b16 v[36:37], v28 offset:4096
    v_cvt_pk_bf16_f32 v178, v180, v181
    v_mfma_f32_16x16x32_bf16 v[68:71], a[100:103], v[48:51], v[68:71]
    ds_read_b64_tr_b16 v[38:39], v28 offset:4608
    v_cvt_pk_bf16_f32 v179, v182, v183
    v_mfma_f32_16x16x32_bf16 v[68:71], a[116:119], v[52:55], v[68:71]
    s_xor_b32 s79, s65, 4096
    ds_read_b64_tr_b16 v[40:41], v29 offset:0
    v_mfma_f32_16x16x32_bf16 v[72:75], a[104:107], v[48:51], v[72:75]
    ds_read_b64_tr_b16 v[42:43], v29 offset:512
    v_mfma_f32_16x16x32_bf16 v[72:75], a[120:123], v[52:55], v[72:75]
    ds_read_b64_tr_b16 v[44:45], v29 offset:4096
    v_mfma_f32_16x16x32_bf16 v[76:79], a[108:111], v[48:51], v[76:79]
    ds_read_b64_tr_b16 v[46:47], v29 offset:4608
    v_mfma_f32_16x16x32_bf16 v[76:79], a[124:127], v[52:55], v[76:79]
    buffer_load_dwordx4 v24, s[20:23], s98 offen offset:0  lds
    v_mfma_f32_16x16x32_bf16 v[80:83], a[96:99], v[56:59], v[80:83]
    ds_read_b64_tr_b16 v[48:49], v28 offset:8192
    v_mfma_f32_16x16x32_bf16 v[80:83], a[112:115], v[60:63], v[80:83]
    ds_read_b64_tr_b16 v[50:51], v28 offset:8704
    v_mfma_f32_16x16x32_bf16 v[84:87], a[100:103], v[56:59], v[84:87]
    ds_read_b64_tr_b16 v[52:53], v28 offset:12288
    v_mfma_f32_16x16x32_bf16 v[84:87], a[116:119], v[60:63], v[84:87]
    ds_read_b64_tr_b16 v[54:55], v28 offset:12800
    v_mfma_f32_16x16x32_bf16 v[88:91], a[104:107], v[56:59], v[88:91]
    buffer_load_dwordx4 v25, s[20:23], s98 offen offset:1024  lds
    v_mfma_f32_16x16x32_bf16 v[88:91], a[120:123], v[60:63], v[88:91]
    buffer_store_dword v6, v5, s[8:11], s72 offen sc0 sc1
    v_mfma_f32_16x16x32_bf16 v[92:95], a[108:111], v[56:59], v[92:95]
    buffer_store_dwordx4 v[176:179], v1, s[8:11], s79 offen offset:2048 sc0 sc1
    v_mfma_f32_16x16x32_bf16 v[92:95], a[124:127], v[60:63], v[92:95]
    s_waitcnt lgkmcnt(5)
    v_mfma_f32_16x16x32_bf16 v[96:99], a[128:131], v[32:35], v[96:99]
    ds_read_b64_tr_b16 v[56:57], v29 offset:8192
    v_cvt_pk_bf16_f32 v184, v184, v185
    v_mfma_f32_16x16x32_bf16 v[96:99], a[144:147], v[36:39], v[96:99]
    ds_read_b64_tr_b16 v[58:59], v29 offset:8704
    v_cvt_pk_bf16_f32 v185, v186, v187
    v_mfma_f32_16x16x32_bf16 v[100:103], a[132:135], v[32:35], v[100:103]
    ds_read_b64_tr_b16 v[60:61], v29 offset:12288
    v_cvt_pk_bf16_f32 v186, v188, v189
    v_mfma_f32_16x16x32_bf16 v[100:103], a[148:151], v[36:39], v[100:103]
    ds_read_b64_tr_b16 v[62:63], v29 offset:12800
    v_cvt_pk_bf16_f32 v187, v190, v191
    v_mfma_f32_16x16x32_bf16 v[104:107], a[136:139], v[32:35], v[104:107]
    buffer_load_dwordx4 v26, s[20:23], s98 offen offset:2048  lds
    v_mfma_f32_16x16x32_bf16 v[104:107], a[152:155], v[36:39], v[104:107]
    s_xor_b32 s79, s65, 4096
    v_mfma_f32_16x16x32_bf16 v[108:111], a[140:143], v[32:35], v[108:111]
    buffer_store_dwordx4 v[184:187], v1, s[8:11], s79 offen offset:3072 sc0 sc1
    v_mfma_f32_16x16x32_bf16 v[108:111], a[156:159], v[36:39], v[108:111]
    v_mfma_f32_16x16x32_bf16 v[112:115], a[128:131], v[40:43], v[112:115]
    s_waitcnt lgkmcnt(4)
    ds_read_b64_tr_b16 v[32:33], v28 offset:16384
    v_mfma_f32_16x16x32_bf16 v[112:115], a[144:147], v[44:47], v[112:115]
    ds_read_b64_tr_b16 v[34:35], v28 offset:16896
    v_mfma_f32_16x16x32_bf16 v[116:119], a[132:135], v[40:43], v[116:119]
    ds_read_b64_tr_b16 v[36:37], v28 offset:20480
    v_mfma_f32_16x16x32_bf16 v[116:119], a[148:151], v[44:47], v[116:119]
    ds_read_b64_tr_b16 v[38:39], v28 offset:20992
    v_mfma_f32_16x16x32_bf16 v[120:123], a[136:139], v[40:43], v[120:123]
    buffer_load_dwordx4 v27, s[20:23], s98 offen offset:3072  lds
    v_mfma_f32_16x16x32_bf16 v[120:123], a[152:155], v[44:47], v[120:123]
    s_add_u32 m0, s62, 69632
    s_xor_b32 s98, s64, 2359424
    v_mfma_f32_16x16x32_bf16 v[124:127], a[140:143], v[40:43], v[124:127]
    v_mfma_f32_16x16x32_bf16 v[124:127], a[156:159], v[44:47], v[124:127]
    v_mfma_f32_16x16x32_bf16 v[96:99], a[160:163], v[48:51], v[96:99]
    ds_read_b64_tr_b16 v[40:41], v29 offset:16384
    v_cvt_pk_bf16_f32 v192, v192, v193
    v_mfma_f32_16x16x32_bf16 v[96:99], a[176:179], v[52:55], v[96:99]
    ds_read_b64_tr_b16 v[42:43], v29 offset:16896
    v_cvt_pk_bf16_f32 v193, v194, v195
    v_mfma_f32_16x16x32_bf16 v[100:103], a[164:167], v[48:51], v[100:103]
    ds_read_b64_tr_b16 v[44:45], v29 offset:20480
    v_cvt_pk_bf16_f32 v194, v196, v197
    v_mfma_f32_16x16x32_bf16 v[100:103], a[180:183], v[52:55], v[100:103]
    ds_read_b64_tr_b16 v[46:47], v29 offset:20992
    v_cvt_pk_bf16_f32 v195, v198, v199
    v_mfma_f32_16x16x32_bf16 v[104:107], a[168:171], v[48:51], v[104:107]
    buffer_load_dwordx4 v24, s[20:23], s98 offen offset:0  lds
    v_mfma_f32_16x16x32_bf16 v[104:107], a[184:187], v[52:55], v[104:107]
    s_xor_b32 s79, s65, 8192
    v_mfma_f32_16x16x32_bf16 v[108:111], a[172:175], v[48:51], v[108:111]
    buffer_store_dwordx4 v[192:195], v1, s[8:11], s79 offen offset:0 sc0 sc1
    v_mfma_f32_16x16x32_bf16 v[108:111], a[188:191], v[52:55], v[108:111]
    s_waitcnt lgkmcnt(4)
    v_mfma_f32_16x16x32_bf16 v[112:115], a[160:163], v[56:59], v[112:115]
    ds_read_b64_tr_b16 v[48:49], v28 offset:24576
    v_mfma_f32_16x16x32_bf16 v[112:115], a[176:179], v[60:63], v[112:115]
    ds_read_b64_tr_b16 v[50:51], v28 offset:25088
    v_mfma_f32_16x16x32_bf16 v[116:119], a[164:167], v[56:59], v[116:119]
    ds_read_b64_tr_b16 v[52:53], v28 offset:28672
    v_mfma_f32_16x16x32_bf16 v[116:119], a[180:183], v[60:63], v[116:119]
    ds_read_b64_tr_b16 v[54:55], v28 offset:29184
    v_mfma_f32_16x16x32_bf16 v[120:123], a[168:171], v[56:59], v[120:123]
    buffer_load_dwordx4 v25, s[20:23], s98 offen offset:1024  lds
    v_mfma_f32_16x16x32_bf16 v[120:123], a[184:187], v[60:63], v[120:123]
    v_mfma_f32_16x16x32_bf16 v[124:127], a[172:175], v[56:59], v[124:127]
    v_mfma_f32_16x16x32_bf16 v[124:127], a[188:191], v[60:63], v[124:127]
    v_mfma_f32_16x16x32_bf16 v[96:99], a[192:195], v[32:35], v[96:99]
    ds_read_b64_tr_b16 v[56:57], v29 offset:24576
    v_mfma_f32_16x16x32_bf16 v[96:99], a[208:211], v[36:39], v[96:99]
    ds_read_b64_tr_b16 v[58:59], v29 offset:25088
    v_cvt_pk_bf16_f32 v200, v200, v201
    v_mfma_f32_16x16x32_bf16 v[100:103], a[196:199], v[32:35], v[100:103]
    ds_read_b64_tr_b16 v[60:61], v29 offset:28672
    v_cvt_pk_bf16_f32 v201, v202, v203
    v_mfma_f32_16x16x32_bf16 v[100:103], a[212:215], v[36:39], v[100:103]
    ds_read_b64_tr_b16 v[62:63], v29 offset:29184
    v_cvt_pk_bf16_f32 v202, v204, v205
    v_mfma_f32_16x16x32_bf16 v[104:107], a[200:203], v[32:35], v[104:107]
    buffer_load_dwordx4 v26, s[20:23], s98 offen offset:2048  lds
    v_mfma_f32_16x16x32_bf16 v[104:107], a[216:219], v[36:39], v[104:107]
    v_cvt_pk_bf16_f32 v203, v206, v207
    v_mfma_f32_16x16x32_bf16 v[108:111], a[204:207], v[32:35], v[108:111]
    v_mfma_f32_16x16x32_bf16 v[108:111], a[220:223], v[36:39], v[108:111]
    s_waitcnt lgkmcnt(4)
    s_xor_b32 s79, s65, 8192
    v_xor_b32 v30, 65536, v30
    v_mfma_f32_16x16x32_bf16 v[112:115], a[192:195], v[40:43], v[112:115]
    ds_read_b64_tr_b16 v[32:33], v30 offset:0
    v_mfma_f32_16x16x32_bf16 v[112:115], a[208:211], v[44:47], v[112:115]
    ds_read_b64_tr_b16 v[34:35], v30 offset:512
    v_mfma_f32_16x16x32_bf16 v[116:119], a[196:199], v[40:43], v[116:119]
    ds_read_b64_tr_b16 v[36:37], v30 offset:4096
    v_mfma_f32_16x16x32_bf16 v[116:119], a[212:215], v[44:47], v[116:119]
    ds_read_b64_tr_b16 v[38:39], v30 offset:4608
    v_mfma_f32_16x16x32_bf16 v[120:123], a[200:203], v[40:43], v[120:123]
    buffer_load_dwordx4 v27, s[20:23], s98 offen offset:3072  lds
    v_mfma_f32_16x16x32_bf16 v[120:123], a[216:219], v[44:47], v[120:123]
    buffer_store_dwordx4 v[200:203], v1, s[8:11], s79 offen offset:1024 sc0 sc1
    v_mfma_f32_16x16x32_bf16 v[124:127], a[204:207], v[40:43], v[124:127]
    v_mfma_f32_16x16x32_bf16 v[124:127], a[220:223], v[44:47], v[124:127]
    s_add_u32 m0, s63, 114688
    s_xor_b32 s98, s0, 1048576
    v_xor_b32 v31, 65536, v31
    v_mfma_f32_16x16x32_bf16 v[96:99], a[224:227], v[48:51], v[96:99]
    ds_read_b64_tr_b16 v[40:41], v31 offset:0
    v_mfma_f32_16x16x32_bf16 v[96:99], a[240:243], v[52:55], v[96:99]
    ds_read_b64_tr_b16 v[42:43], v31 offset:512
    v_mfma_f32_16x16x32_bf16 v[100:103], a[228:231], v[48:51], v[100:103]
    ds_read_b64_tr_b16 v[44:45], v31 offset:4096
    v_cvt_pk_bf16_f32 v208, v208, v209
    v_mfma_f32_16x16x32_bf16 v[100:103], a[244:247], v[52:55], v[100:103]
    ds_read_b64_tr_b16 v[46:47], v31 offset:4608
    v_cvt_pk_bf16_f32 v209, v210, v211
    v_mfma_f32_16x16x32_bf16 v[104:107], a[232:235], v[48:51], v[104:107]
    buffer_load_dwordx4 v20, s[24:27], s98 offen offset:0  lds
    v_mfma_f32_16x16x32_bf16 v[104:107], a[248:251], v[52:55], v[104:107]
    v_cvt_pk_bf16_f32 v210, v212, v213
    v_cvt_pk_bf16_f32 v211, v214, v215
    v_mfma_f32_16x16x32_bf16 v[108:111], a[236:239], v[48:51], v[108:111]
    v_mfma_f32_16x16x32_bf16 v[108:111], a[252:255], v[52:55], v[108:111]
    s_waitcnt lgkmcnt(4)
    v_mfma_f32_16x16x32_bf16 v[112:115], a[224:227], v[56:59], v[112:115]
    s_xor_b32 s79, s65, 8192
    ds_read_b64_tr_b16 v[48:49], v30 offset:8192
    v_mfma_f32_16x16x32_bf16 v[112:115], a[240:243], v[60:63], v[112:115]
    ds_read_b64_tr_b16 v[50:51], v30 offset:8704
    v_mfma_f32_16x16x32_bf16 v[116:119], a[228:231], v[56:59], v[116:119]
    ds_read_b64_tr_b16 v[52:53], v30 offset:12288
    v_mfma_f32_16x16x32_bf16 v[116:119], a[244:247], v[60:63], v[116:119]
    ds_read_b64_tr_b16 v[54:55], v30 offset:12800
    v_mfma_f32_16x16x32_bf16 v[120:123], a[232:235], v[56:59], v[120:123]
    buffer_load_dwordx4 v21, s[24:27], s98 offen offset:1024  lds
    v_mfma_f32_16x16x32_bf16 v[120:123], a[248:251], v[60:63], v[120:123]
    buffer_store_dwordx4 v[208:211], v1, s[8:11], s79 offen offset:2048 sc0 sc1
    v_mfma_f32_16x16x32_bf16 v[124:127], a[236:239], v[56:59], v[124:127]
    v_mfma_f32_16x16x32_bf16 v[124:127], a[252:255], v[60:63], v[124:127]
    v_mfma_f32_16x16x32_bf16 v[64:67], a[128:131], v[32:35], v[64:67]
    ds_read_b64_tr_b16 v[56:57], v31 offset:8192
    v_mfma_f32_16x16x32_bf16 v[64:67], a[144:147], v[36:39], v[64:67]
    ds_read_b64_tr_b16 v[58:59], v31 offset:8704
    v_mfma_f32_16x16x32_bf16 v[68:71], a[132:135], v[32:35], v[68:71]
    ds_read_b64_tr_b16 v[60:61], v31 offset:12288
    v_mfma_f32_16x16x32_bf16 v[68:71], a[148:151], v[36:39], v[68:71]
    ds_read_b64_tr_b16 v[62:63], v31 offset:12800
    v_mfma_f32_16x16x32_bf16 v[72:75], a[136:139], v[32:35], v[72:75]
    buffer_load_dwordx4 v22, s[24:27], s98 offen offset:2048  lds
    v_mfma_f32_16x16x32_bf16 v[72:75], a[152:155], v[36:39], v[72:75]
    v_mfma_f32_16x16x32_bf16 v[76:79], a[140:143], v[32:35], v[76:79]
    v_mfma_f32_16x16x32_bf16 v[76:79], a[156:159], v[36:39], v[76:79]
    s_waitcnt lgkmcnt(4)
    v_mfma_f32_16x16x32_bf16 v[80:83], a[128:131], v[40:43], v[80:83]
    ds_read_b64_tr_b16 v[32:33], v30 offset:16384
    v_cvt_pk_bf16_f32 v96, v96, v97
    v_mfma_f32_16x16x32_bf16 v[80:83], a[144:147], v[44:47], v[80:83]
    ds_read_b64_tr_b16 v[34:35], v30 offset:16896
    v_cvt_pk_bf16_f32 v97, v98, v99
    v_mfma_f32_16x16x32_bf16 v[84:87], a[132:135], v[40:43], v[84:87]
    ds_read_b64_tr_b16 v[36:37], v30 offset:20480
    v_cvt_pk_bf16_f32 v98, v100, v101
    v_mfma_f32_16x16x32_bf16 v[84:87], a[148:151], v[44:47], v[84:87]
    ds_read_b64_tr_b16 v[38:39], v30 offset:20992
    v_cvt_pk_bf16_f32 v99, v102, v103
    v_mfma_f32_16x16x32_bf16 v[88:91], a[136:139], v[40:43], v[88:91]
    buffer_load_dwordx4 v23, s[24:27], s98 offen offset:3072  lds
    v_mfma_f32_16x16x32_bf16 v[88:91], a[152:155], v[44:47], v[88:91]
    s_add_u32 m0, s63, 147456
    s_xor_b32 s98, s0, 1572864
    s_xor_b32 s79, s1, 32768
    v_mfma_f32_16x16x32_bf16 v[92:95], a[140:143], v[40:43], v[92:95]
    buffer_store_dwordx4 v[96:99], v1, s[8:11], s79 offen offset:0 sc0 sc1
    v_mfma_f32_16x16x32_bf16 v[92:95], a[156:159], v[44:47], v[92:95]
    v_mfma_f32_16x16x32_bf16 v[64:67], a[160:163], v[48:51], v[64:67]
    ds_read_b64_tr_b16 v[40:41], v31 offset:16384
    v_mfma_f32_16x16x32_bf16 v[64:67], a[176:179], v[52:55], v[64:67]
    ds_read_b64_tr_b16 v[42:43], v31 offset:16896
    v_mfma_f32_16x16x32_bf16 v[68:71], a[164:167], v[48:51], v[68:71]
    ds_read_b64_tr_b16 v[44:45], v31 offset:20480
    v_mfma_f32_16x16x32_bf16 v[68:71], a[180:183], v[52:55], v[68:71]
    ds_read_b64_tr_b16 v[46:47], v31 offset:20992
    v_mfma_f32_16x16x32_bf16 v[72:75], a[168:171], v[48:51], v[72:75]
    buffer_load_dwordx4 v20, s[24:27], s98 offen offset:0  lds
    v_mfma_f32_16x16x32_bf16 v[72:75], a[184:187], v[52:55], v[72:75]
    v_cvt_pk_bf16_f32 v104, v104, v105
    v_cvt_pk_bf16_f32 v105, v106, v107
    v_mfma_f32_16x16x32_bf16 v[76:79], a[172:175], v[48:51], v[76:79]
    v_cvt_pk_bf16_f32 v106, v108, v109
    v_cvt_pk_bf16_f32 v107, v110, v111
    v_mfma_f32_16x16x32_bf16 v[76:79], a[188:191], v[52:55], v[76:79]
    s_waitcnt lgkmcnt(4)
    v_mfma_f32_16x16x32_bf16 v[80:83], a[160:163], v[56:59], v[80:83]
    s_xor_b32 s79, s1, 40960
    ds_read_b64_tr_b16 v[48:49], v30 offset:24576
    v_mfma_f32_16x16x32_bf16 v[80:83], a[176:179], v[60:63], v[80:83]
    ds_read_b64_tr_b16 v[50:51], v30 offset:25088
    v_mfma_f32_16x16x32_bf16 v[84:87], a[164:167], v[56:59], v[84:87]
    ds_read_b64_tr_b16 v[52:53], v30 offset:28672
    v_mfma_f32_16x16x32_bf16 v[84:87], a[180:183], v[60:63], v[84:87]
    ds_read_b64_tr_b16 v[54:55], v30 offset:29184
    v_mfma_f32_16x16x32_bf16 v[88:91], a[168:171], v[56:59], v[88:91]
    buffer_load_dwordx4 v21, s[24:27], s98 offen offset:1024  lds
    v_mfma_f32_16x16x32_bf16 v[88:91], a[184:187], v[60:63], v[88:91]
    buffer_store_dwordx4 v[104:107], v1, s[8:11], s79 offen offset:0 sc0 sc1
    v_mfma_f32_16x16x32_bf16 v[92:95], a[172:175], v[56:59], v[92:95]
    v_mfma_f32_16x16x32_bf16 v[92:95], a[188:191], v[60:63], v[92:95]
    v_mfma_f32_16x16x32_bf16 v[64:67], a[192:195], v[32:35], v[64:67]
    ds_read_b64_tr_b16 v[56:57], v31 offset:24576
    v_mfma_f32_16x16x32_bf16 v[64:67], a[208:211], v[36:39], v[64:67]
    ds_read_b64_tr_b16 v[58:59], v31 offset:25088
    v_mfma_f32_16x16x32_bf16 v[68:71], a[196:199], v[32:35], v[68:71]
    ds_read_b64_tr_b16 v[60:61], v31 offset:28672
    v_cvt_pk_bf16_f32 v112, v112, v113
    v_mfma_f32_16x16x32_bf16 v[68:71], a[212:215], v[36:39], v[68:71]
    ds_read_b64_tr_b16 v[62:63], v31 offset:29184
    v_cvt_pk_bf16_f32 v113, v114, v115
    v_mfma_f32_16x16x32_bf16 v[72:75], a[200:203], v[32:35], v[72:75]
    buffer_load_dwordx4 v22, s[24:27], s98 offen offset:2048  lds
    v_mfma_f32_16x16x32_bf16 v[72:75], a[216:219], v[36:39], v[72:75]
    v_cvt_pk_bf16_f32 v114, v116, v117
    v_cvt_pk_bf16_f32 v115, v118, v119
    v_mfma_f32_16x16x32_bf16 v[76:79], a[204:207], v[32:35], v[76:79]
    s_waitcnt lgkmcnt(4)
    s_xor_b32 s79, s1, 32768
    v_mfma_f32_16x16x32_bf16 v[76:79], a[220:223], v[36:39], v[76:79]
    buffer_store_dwordx4 v[112:115], v1, s[8:11], s79 offen offset:1024 sc0 sc1
    v_mfma_f32_16x16x32_bf16 v[80:83], a[192:195], v[40:43], v[80:83]
    v_mfma_f32_16x16x32_bf16 v[80:83], a[208:211], v[44:47], v[80:83]
    buffer_load_dwordx4 v23, s[24:27], s98 offen offset:3072  lds
    v_mfma_f32_16x16x32_bf16 v[84:87], a[196:199], v[40:43], v[84:87]
    v_mfma_f32_16x16x32_bf16 v[84:87], a[212:215], v[44:47], v[84:87]
    v_mfma_f32_16x16x32_bf16 v[88:91], a[200:203], v[40:43], v[88:91]
    v_mfma_f32_16x16x32_bf16 v[88:91], a[216:219], v[44:47], v[88:91]
    v_mfma_f32_16x16x32_bf16 v[92:95], a[204:207], v[40:43], v[92:95]
    s_waitcnt lgkmcnt(0)
    s_barrier
    v_mfma_f32_16x16x32_bf16 v[92:95], a[220:223], v[44:47], v[92:95]
    s_add_u32 m0, s63, 0
    s_xor_b32 s98, s0, 2097152
    ds_read_b64_tr_b16 v[32:33], v28 offset:32768
    v_mfma_f32_16x16x32_bf16 v[64:67], a[224:227], v[48:51], v[64:67]
    ds_read_b64_tr_b16 v[34:35], v28 offset:33280
    v_cvt_pk_bf16_f32 v120, v120, v121
    v_mfma_f32_16x16x32_bf16 v[64:67], a[240:243], v[52:55], v[64:67]
    ds_read_b64_tr_b16 v[36:37], v28 offset:36864
    v_cvt_pk_bf16_f32 v121, v122, v123
    v_mfma_f32_16x16x32_bf16 v[68:71], a[228:231], v[48:51], v[68:71]
    ds_read_b64_tr_b16 v[38:39], v28 offset:37376
    v_cvt_pk_bf16_f32 v122, v124, v125
    v_mfma_f32_16x16x32_bf16 v[68:71], a[244:247], v[52:55], v[68:71]
    ds_read_b64_tr_b16 v[40:41], v29 offset:32768
    v_cvt_pk_bf16_f32 v123, v126, v127
    v_mfma_f32_16x16x32_bf16 v[72:75], a[232:235], v[48:51], v[72:75]
    s_xor_b32 s79, s1, 40960
    ds_read_b64_tr_b16 v[42:43], v29 offset:33280
    v_mfma_f32_16x16x32_bf16 v[72:75], a[248:251], v[52:55], v[72:75]
    ds_read_b64_tr_b16 v[44:45], v29 offset:36864
    v_mfma_f32_16x16x32_bf16 v[76:79], a[236:239], v[48:51], v[76:79]
    ds_read_b64_tr_b16 v[46:47], v29 offset:37376
    v_mfma_f32_16x16x32_bf16 v[76:79], a[252:255], v[52:55], v[76:79]
    buffer_load_dwordx4 v20, s[24:27], s98 offen offset:0  lds
    v_mfma_f32_16x16x32_bf16 v[80:83], a[224:227], v[56:59], v[80:83]
    ds_read_b64_tr_b16 v[48:49], v28 offset:40960
    v_mfma_f32_16x16x32_bf16 v[80:83], a[240:243], v[60:63], v[80:83]
    ds_read_b64_tr_b16 v[50:51], v28 offset:41472
    v_mfma_f32_16x16x32_bf16 v[84:87], a[228:231], v[56:59], v[84:87]
    ds_read_b64_tr_b16 v[52:53], v28 offset:45056
    v_mfma_f32_16x16x32_bf16 v[84:87], a[244:247], v[60:63], v[84:87]
    ds_read_b64_tr_b16 v[54:55], v28 offset:45568
    v_mfma_f32_16x16x32_bf16 v[88:91], a[232:235], v[56:59], v[88:91]
    buffer_store_dwordx4 v[120:123], v1, s[8:11], s79 offen offset:1024 sc0 sc1
    v_mfma_f32_16x16x32_bf16 v[88:91], a[248:251], v[60:63], v[88:91]
    buffer_load_dwordx4 v21, s[24:27], s98 offen offset:1024  lds
    v_mfma_f32_16x16x32_bf16 v[92:95], a[236:239], v[56:59], v[92:95]
    v_mfma_f32_16x16x32_bf16 v[92:95], a[252:255], v[60:63], v[92:95]
    s_waitcnt lgkmcnt(5)
    v_mfma_f32_16x16x32_bf16 v[96:99], a[0:3], v[32:35], 0
    ds_read_b64_tr_b16 v[56:57], v29 offset:40960
    v_mfma_f32_16x16x32_bf16 v[96:99], a[16:19], v[36:39], v[96:99]
    ds_read_b64_tr_b16 v[58:59], v29 offset:41472
    v_mfma_f32_16x16x32_bf16 v[100:103], a[4:7], v[32:35], 0
    ds_read_b64_tr_b16 v[60:61], v29 offset:45056
    v_mfma_f32_16x16x32_bf16 v[100:103], a[20:23], v[36:39], v[100:103]
    ds_read_b64_tr_b16 v[62:63], v29 offset:45568
    v_mfma_f32_16x16x32_bf16 v[104:107], a[8:11], v[32:35], 0
    buffer_load_dwordx4 v22, s[24:27], s98 offen offset:2048  lds
    v_mfma_f32_16x16x32_bf16 v[104:107], a[24:27], v[36:39], v[104:107]
    v_mfma_f32_16x16x32_bf16 v[108:111], a[12:15], v[32:35], 0
    v_mfma_f32_16x16x32_bf16 v[108:111], a[28:31], v[36:39], v[108:111]
    v_mfma_f32_16x16x32_bf16 v[112:115], a[0:3], v[40:43], 0
    s_waitcnt lgkmcnt(4)
    ds_read_b64_tr_b16 v[32:33], v28 offset:49152
    v_cvt_pk_bf16_f32 v64, v64, v65
    v_mfma_f32_16x16x32_bf16 v[112:115], a[16:19], v[44:47], v[112:115]
    ds_read_b64_tr_b16 v[34:35], v28 offset:49664
    v_cvt_pk_bf16_f32 v65, v66, v67
    v_mfma_f32_16x16x32_bf16 v[116:119], a[4:7], v[40:43], 0
    ds_read_b64_tr_b16 v[36:37], v28 offset:53248
    v_cvt_pk_bf16_f32 v66, v68, v69
    v_mfma_f32_16x16x32_bf16 v[116:119], a[20:23], v[44:47], v[116:119]
    ds_read_b64_tr_b16 v[38:39], v28 offset:53760
    v_cvt_pk_bf16_f32 v67, v70, v71
    v_mfma_f32_16x16x32_bf16 v[120:123], a[8:11], v[40:43], 0
    buffer_load_dwordx4 v23, s[24:27], s98 offen offset:3072  lds
    v_mfma_f32_16x16x32_bf16 v[120:123], a[24:27], v[44:47], v[120:123]
    s_add_u32 m0, s63, 16384
    s_xor_b32 s98, s0, 2621440
    s_xor_b32 s79, s1, 32768
    v_mfma_f32_16x16x32_bf16 v[124:127], a[12:15], v[40:43], 0
    buffer_store_dwordx4 v[64:67], v1, s[8:11], s79 offen offset:2048 sc0 sc1
    v_mfma_f32_16x16x32_bf16 v[124:127], a[28:31], v[44:47], v[124:127]
    v_mfma_f32_16x16x32_bf16 v[96:99], a[32:35], v[48:51], v[96:99]
    ds_read_b64_tr_b16 v[40:41], v29 offset:49152
    v_mfma_f32_16x16x32_bf16 v[96:99], a[48:51], v[52:55], v[96:99]
    ds_read_b64_tr_b16 v[42:43], v29 offset:49664
    v_mfma_f32_16x16x32_bf16 v[100:103], a[36:39], v[48:51], v[100:103]
    ds_read_b64_tr_b16 v[44:45], v29 offset:53248
    v_mfma_f32_16x16x32_bf16 v[100:103], a[52:55], v[52:55], v[100:103]
    ds_read_b64_tr_b16 v[46:47], v29 offset:53760
    v_mfma_f32_16x16x32_bf16 v[104:107], a[40:43], v[48:51], v[104:107]
    buffer_load_dwordx4 v20, s[24:27], s98 offen offset:0  lds
    v_mfma_f32_16x16x32_bf16 v[104:107], a[56:59], v[52:55], v[104:107]
    v_cvt_pk_bf16_f32 v72, v72, v73
    v_cvt_pk_bf16_f32 v73, v74, v75
    v_mfma_f32_16x16x32_bf16 v[108:111], a[44:47], v[48:51], v[108:111]
    v_cvt_pk_bf16_f32 v74, v76, v77
    v_cvt_pk_bf16_f32 v75, v78, v79
    v_mfma_f32_16x16x32_bf16 v[108:111], a[60:63], v[52:55], v[108:111]
    s_waitcnt lgkmcnt(4)
    v_mfma_f32_16x16x32_bf16 v[112:115], a[32:35], v[56:59], v[112:115]
    s_xor_b32 s79, s1, 40960
    ds_read_b64_tr_b16 v[48:49], v28 offset:57344
    v_mfma_f32_16x16x32_bf16 v[112:115], a[48:51], v[60:63], v[112:115]
    ds_read_b64_tr_b16 v[50:51], v28 offset:57856
    v_mfma_f32_16x16x32_bf16 v[116:119], a[36:39], v[56:59], v[116:119]
    ds_read_b64_tr_b16 v[52:53], v28 offset:61440
    v_mfma_f32_16x16x32_bf16 v[116:119], a[52:55], v[60:63], v[116:119]
    ds_read_b64_tr_b16 v[54:55], v28 offset:61952
    v_mfma_f32_16x16x32_bf16 v[120:123], a[40:43], v[56:59], v[120:123]
    buffer_load_dwordx4 v21, s[24:27], s98 offen offset:1024  lds
    v_mfma_f32_16x16x32_bf16 v[120:123], a[56:59], v[60:63], v[120:123]
    buffer_store_dwordx4 v[72:75], v1, s[8:11], s79 offen offset:2048 sc0 sc1
    v_mfma_f32_16x16x32_bf16 v[124:127], a[44:47], v[56:59], v[124:127]
    v_mfma_f32_16x16x32_bf16 v[124:127], a[60:63], v[60:63], v[124:127]
    v_mfma_f32_16x16x32_bf16 v[96:99], a[64:67], v[32:35], v[96:99]
    ds_read_b64_tr_b16 v[56:57], v29 offset:57344
    v_mfma_f32_16x16x32_bf16 v[96:99], a[80:83], v[36:39], v[96:99]
    ds_read_b64_tr_b16 v[58:59], v29 offset:57856
    v_mfma_f32_16x16x32_bf16 v[100:103], a[68:71], v[32:35], v[100:103]
    ds_read_b64_tr_b16 v[60:61], v29 offset:61440
    v_cvt_pk_bf16_f32 v80, v80, v81
    v_mfma_f32_16x16x32_bf16 v[100:103], a[84:87], v[36:39], v[100:103]
    ds_read_b64_tr_b16 v[62:63], v29 offset:61952
    v_cvt_pk_bf16_f32 v81, v82, v83
    v_mfma_f32_16x16x32_bf16 v[104:107], a[72:75], v[32:35], v[104:107]
    buffer_load_dwordx4 v22, s[24:27], s98 offen offset:2048  lds
    v_mfma_f32_16x16x32_bf16 v[104:107], a[88:91], v[36:39], v[104:107]
    v_cvt_pk_bf16_f32 v82, v84, v85
    v_cvt_pk_bf16_f32 v83, v86, v87
    v_mfma_f32_16x16x32_bf16 v[108:111], a[76:79], v[32:35], v[108:111]
    v_mfma_f32_16x16x32_bf16 v[108:111], a[92:95], v[36:39], v[108:111]
    s_waitcnt lgkmcnt(4)
    v_mfma_f32_16x16x32_bf16 v[112:115], a[64:67], v[40:43], v[112:115]
    s_xor_b32 s79, s1, 32768
    ds_read_b64_tr_b16 v[32:33], v30 offset:32768
    v_mfma_f32_16x16x32_bf16 v[112:115], a[80:83], v[44:47], v[112:115]
    ds_read_b64_tr_b16 v[34:35], v30 offset:33280
    v_mfma_f32_16x16x32_bf16 v[116:119], a[68:71], v[40:43], v[116:119]
    ds_read_b64_tr_b16 v[36:37], v30 offset:36864
    v_mfma_f32_16x16x32_bf16 v[116:119], a[84:87], v[44:47], v[116:119]
    ds_read_b64_tr_b16 v[38:39], v30 offset:37376
    v_mfma_f32_16x16x32_bf16 v[120:123], a[72:75], v[40:43], v[120:123]
    buffer_load_dwordx4 v23, s[24:27], s98 offen offset:3072  lds
    v_mfma_f32_16x16x32_bf16 v[120:123], a[88:91], v[44:47], v[120:123]
    buffer_store_dwordx4 v[80:83], v1, s[8:11], s79 offen offset:3072 sc0 sc1
    v_mfma_f32_16x16x32_bf16 v[124:127], a[76:79], v[40:43], v[124:127]
    v_mfma_f32_16x16x32_bf16 v[124:127], a[92:95], v[44:47], v[124:127]
    v_mfma_f32_16x16x32_bf16 v[96:99], a[96:99], v[48:51], v[96:99]
    ds_read_b64_tr_b16 v[40:41], v31 offset:32768
    v_cvt_pk_bf16_f32 v88, v88, v89
    v_mfma_f32_16x16x32_bf16 v[96:99], a[112:115], v[52:55], v[96:99]
    ds_read_b64_tr_b16 v[42:43], v31 offset:33280
    v_cvt_pk_bf16_f32 v89, v90, v91
    v_mfma_f32_16x16x32_bf16 v[100:103], a[100:103], v[48:51], v[100:103]
    ds_read_b64_tr_b16 v[44:45], v31 offset:36864
    v_cvt_pk_bf16_f32 v90, v92, v93
    v_mfma_f32_16x16x32_bf16 v[100:103], a[116:119], v[52:55], v[100:103]
    ds_read_b64_tr_b16 v[46:47], v31 offset:37376
    v_cvt_pk_bf16_f32 v91, v94, v95
    v_mfma_f32_16x16x32_bf16 v[104:107], a[104:107], v[48:51], v[104:107]
    s_xor_b32 s79, s1, 40960
    v_mfma_f32_16x16x32_bf16 v[104:107], a[120:123], v[52:55], v[104:107]
    buffer_store_dwordx4 v[88:91], v1, s[8:11], s79 offen offset:3072 sc0 sc1
    v_mfma_f32_16x16x32_bf16 v[108:111], a[108:111], v[48:51], v[108:111]
    v_mfma_f32_16x16x32_bf16 v[108:111], a[124:127], v[52:55], v[108:111]
    s_waitcnt lgkmcnt(4)
    v_mfma_f32_16x16x32_bf16 v[112:115], a[96:99], v[56:59], v[112:115]
    ds_read_b64_tr_b16 v[48:49], v30 offset:40960
    v_mfma_f32_16x16x32_bf16 v[112:115], a[112:115], v[60:63], v[112:115]
    ds_read_b64_tr_b16 v[50:51], v30 offset:41472
    v_mfma_f32_16x16x32_bf16 v[116:119], a[100:103], v[56:59], v[116:119]
    ds_read_b64_tr_b16 v[52:53], v30 offset:45056
    v_mfma_f32_16x16x32_bf16 v[116:119], a[116:119], v[60:63], v[116:119]
    ds_read_b64_tr_b16 v[54:55], v30 offset:45568
    v_mfma_f32_16x16x32_bf16 v[120:123], a[104:107], v[56:59], v[120:123]
    v_mfma_f32_16x16x32_bf16 v[120:123], a[120:123], v[60:63], v[120:123]
    v_mfma_f32_16x16x32_bf16 v[124:127], a[108:111], v[56:59], v[124:127]
    v_mfma_f32_16x16x32_bf16 v[124:127], a[124:127], v[60:63], v[124:127]
    v_mfma_f32_16x16x32_bf16 v[64:67], a[0:3], v[32:35], 0
    ds_read_b64_tr_b16 v[56:57], v31 offset:40960
    v_mfma_f32_16x16x32_bf16 v[64:67], a[16:19], v[36:39], v[64:67]
    ds_read_b64_tr_b16 v[58:59], v31 offset:41472
    v_mfma_f32_16x16x32_bf16 v[68:71], a[4:7], v[32:35], 0
    ds_read_b64_tr_b16 v[60:61], v31 offset:45056
    v_cvt_pk_bf16_f32 v216, v216, v217
    v_mfma_f32_16x16x32_bf16 v[68:71], a[20:23], v[36:39], v[68:71]
    ds_read_b64_tr_b16 v[62:63], v31 offset:45568
    v_cvt_pk_bf16_f32 v217, v218, v219
    v_mfma_f32_16x16x32_bf16 v[72:75], a[8:11], v[32:35], 0
    v_cvt_pk_bf16_f32 v218, v220, v221
    v_cvt_pk_bf16_f32 v219, v222, v223
    v_mfma_f32_16x16x32_bf16 v[72:75], a[24:27], v[36:39], v[72:75]
    s_xor_b32 s79, s65, 8192
    v_mfma_f32_16x16x32_bf16 v[76:79], a[12:15], v[32:35], 0
    buffer_store_dwordx4 v[216:219], v1, s[8:11], s79 offen offset:3072 sc0 sc1
    v_mfma_f32_16x16x32_bf16 v[76:79], a[28:31], v[36:39], v[76:79]
    s_waitcnt lgkmcnt(4)
    v_mfma_f32_16x16x32_bf16 v[80:83], a[0:3], v[40:43], 0
    ds_read_b64_tr_b16 v[32:33], v30 offset:49152
    v_mfma_f32_16x16x32_bf16 v[80:83], a[16:19], v[44:47], v[80:83]
    ds_read_b64_tr_b16 v[34:35], v30 offset:49664
    v_mfma_f32_16x16x32_bf16 v[84:87], a[4:7], v[40:43], 0
    ds_read_b64_tr_b16 v[36:37], v30 offset:53248
    v_mfma_f32_16x16x32_bf16 v[84:87], a[20:23], v[44:47], v[84:87]
    ds_read_b64_tr_b16 v[38:39], v30 offset:53760
    v_mfma_f32_16x16x32_bf16 v[88:91], a[8:11], v[40:43], 0
    v_mfma_f32_16x16x32_bf16 v[88:91], a[24:27], v[44:47], v[88:91]
    v_mfma_f32_16x16x32_bf16 v[92:95], a[12:15], v[40:43], 0
    v_mfma_f32_16x16x32_bf16 v[92:95], a[28:31], v[44:47], v[92:95]
    v_mfma_f32_16x16x32_bf16 v[64:67], a[32:35], v[48:51], v[64:67]
    ds_read_b64_tr_b16 v[40:41], v31 offset:49152
    v_mfma_f32_16x16x32_bf16 v[64:67], a[48:51], v[52:55], v[64:67]
    ds_read_b64_tr_b16 v[42:43], v31 offset:49664
    v_mfma_f32_16x16x32_bf16 v[68:71], a[36:39], v[48:51], v[68:71]
    ds_read_b64_tr_b16 v[44:45], v31 offset:53248
    v_mfma_f32_16x16x32_bf16 v[68:71], a[52:55], v[52:55], v[68:71]
    ds_read_b64_tr_b16 v[46:47], v31 offset:53760
    v_mfma_f32_16x16x32_bf16 v[72:75], a[40:43], v[48:51], v[72:75]
    buffer_load_dword v3, v16, s[8:11], s78 offen sc0 sc1
    v_mfma_f32_16x16x32_bf16 v[72:75], a[56:59], v[52:55], v[72:75]
    v_mfma_f32_16x16x32_bf16 v[76:79], a[44:47], v[48:51], v[76:79]
    v_mfma_f32_16x16x32_bf16 v[76:79], a[60:63], v[52:55], v[76:79]
    s_waitcnt lgkmcnt(4)
    v_mfma_f32_16x16x32_bf16 v[80:83], a[32:35], v[56:59], v[80:83]
    ds_read_b64_tr_b16 v[48:49], v30 offset:57344
    v_cvt_pk_bf16_f32 v224, v224, v225
    v_mfma_f32_16x16x32_bf16 v[80:83], a[48:51], v[60:63], v[80:83]
    ds_read_b64_tr_b16 v[50:51], v30 offset:57856
    v_cvt_pk_bf16_f32 v225, v226, v227
    v_mfma_f32_16x16x32_bf16 v[84:87], a[36:39], v[56:59], v[84:87]
    ds_read_b64_tr_b16 v[52:53], v30 offset:61440
    v_cvt_pk_bf16_f32 v226, v228, v229
    v_mfma_f32_16x16x32_bf16 v[84:87], a[52:55], v[60:63], v[84:87]
    ds_read_b64_tr_b16 v[54:55], v30 offset:61952
    v_cvt_pk_bf16_f32 v227, v230, v231
    v_mfma_f32_16x16x32_bf16 v[88:91], a[40:43], v[56:59], v[88:91]
    s_xor_b32 s79, s65, 12288
    v_mfma_f32_16x16x32_bf16 v[88:91], a[56:59], v[60:63], v[88:91]
    buffer_store_dwordx4 v[224:227], v1, s[8:11], s79 offen offset:0 sc0 sc1
    v_mfma_f32_16x16x32_bf16 v[92:95], a[44:47], v[56:59], v[92:95]
    v_mfma_f32_16x16x32_bf16 v[92:95], a[60:63], v[60:63], v[92:95]
    v_mfma_f32_16x16x32_bf16 v[64:67], a[64:67], v[32:35], v[64:67]
    ds_read_b64_tr_b16 v[56:57], v31 offset:57344
    v_mfma_f32_16x16x32_bf16 v[64:67], a[80:83], v[36:39], v[64:67]
    ds_read_b64_tr_b16 v[58:59], v31 offset:57856
    v_mfma_f32_16x16x32_bf16 v[68:71], a[68:71], v[32:35], v[68:71]
    ds_read_b64_tr_b16 v[60:61], v31 offset:61440
    v_mfma_f32_16x16x32_bf16 v[68:71], a[84:87], v[36:39], v[68:71]
    ds_read_b64_tr_b16 v[62:63], v31 offset:61952
    v_mfma_f32_16x16x32_bf16 v[72:75], a[72:75], v[32:35], v[72:75]
    v_mfma_f32_16x16x32_bf16 v[72:75], a[88:91], v[36:39], v[72:75]
    v_mfma_f32_16x16x32_bf16 v[76:79], a[76:79], v[32:35], v[76:79]
    v_mfma_f32_16x16x32_bf16 v[76:79], a[92:95], v[36:39], v[76:79]
    s_waitcnt lgkmcnt(4)
    v_mfma_f32_16x16x32_bf16 v[80:83], a[64:67], v[40:43], v[80:83]
    v_mfma_f32_16x16x32_bf16 v[80:83], a[80:83], v[44:47], v[80:83]
    v_mfma_f32_16x16x32_bf16 v[84:87], a[68:71], v[40:43], v[84:87]
    v_mfma_f32_16x16x32_bf16 v[84:87], a[84:87], v[44:47], v[84:87]
    v_mfma_f32_16x16x32_bf16 v[88:91], a[72:75], v[40:43], v[88:91]
    v_mfma_f32_16x16x32_bf16 v[88:91], a[88:91], v[44:47], v[88:91]
    v_mfma_f32_16x16x32_bf16 v[92:95], a[76:79], v[40:43], v[92:95]
    v_xor_b32 v28, 65536, v28
    v_cvt_pk_bf16_f32 v232, v232, v233
    s_waitcnt vmcnt(29) lgkmcnt(0)
    s_barrier
    v_mfma_f32_16x16x32_bf16 v[92:95], a[92:95], v[44:47], v[92:95]
    s_add_u32 m0, s63, 32768
    ds_read_b64_tr_b16 v[32:33], v28 offset:0
    v_xor_b32 v29, 65536, v29
    v_mfma_f32_16x16x32_bf16 v[64:67], a[96:99], v[48:51], v[64:67]
    s_xor_b32 s98, s0, 3145728
    ds_read_b64_tr_b16 v[34:35], v28 offset:512
    v_cvt_pk_bf16_f32 v233, v234, v235
    v_mfma_f32_16x16x32_bf16 v[64:67], a[112:115], v[52:55], v[64:67]
    ds_read_b64_tr_b16 v[36:37], v28 offset:4096
    v_cvt_pk_bf16_f32 v234, v236, v237
    v_mfma_f32_16x16x32_bf16 v[68:71], a[100:103], v[48:51], v[68:71]
    ds_read_b64_tr_b16 v[38:39], v28 offset:4608
    v_cvt_pk_bf16_f32 v235, v238, v239
    v_mfma_f32_16x16x32_bf16 v[68:71], a[116:119], v[52:55], v[68:71]
    s_xor_b32 s79, s65, 12288
    ds_read_b64_tr_b16 v[40:41], v29 offset:0
    v_mfma_f32_16x16x32_bf16 v[72:75], a[104:107], v[48:51], v[72:75]
    ds_read_b64_tr_b16 v[42:43], v29 offset:512
    v_mfma_f32_16x16x32_bf16 v[72:75], a[120:123], v[52:55], v[72:75]
    ds_read_b64_tr_b16 v[44:45], v29 offset:4096
    v_mfma_f32_16x16x32_bf16 v[76:79], a[108:111], v[48:51], v[76:79]
    ds_read_b64_tr_b16 v[46:47], v29 offset:4608
    v_mfma_f32_16x16x32_bf16 v[76:79], a[124:127], v[52:55], v[76:79]
    buffer_load_dwordx4 v20, s[24:27], s98 offen offset:0  lds
    v_mfma_f32_16x16x32_bf16 v[80:83], a[96:99], v[56:59], v[80:83]
    ds_read_b64_tr_b16 v[48:49], v28 offset:8192
    v_mfma_f32_16x16x32_bf16 v[80:83], a[112:115], v[60:63], v[80:83]
    ds_read_b64_tr_b16 v[50:51], v28 offset:8704
    v_mfma_f32_16x16x32_bf16 v[84:87], a[100:103], v[56:59], v[84:87]
    ds_read_b64_tr_b16 v[52:53], v28 offset:12288
    v_mfma_f32_16x16x32_bf16 v[84:87], a[116:119], v[60:63], v[84:87]
    ds_read_b64_tr_b16 v[54:55], v28 offset:12800
    v_mfma_f32_16x16x32_bf16 v[88:91], a[104:107], v[56:59], v[88:91]
    buffer_store_dwordx4 v[232:235], v1, s[8:11], s79 offen offset:1024 sc0 sc1
    v_mfma_f32_16x16x32_bf16 v[88:91], a[120:123], v[60:63], v[88:91]
    buffer_load_dwordx4 v21, s[24:27], s98 offen offset:1024  lds
    v_mfma_f32_16x16x32_bf16 v[92:95], a[108:111], v[56:59], v[92:95]
    v_mfma_f32_16x16x32_bf16 v[92:95], a[124:127], v[60:63], v[92:95]
    s_waitcnt lgkmcnt(5)
    v_mfma_f32_16x16x32_bf16 v[96:99], a[128:131], v[32:35], v[96:99]
    ds_read_b64_tr_b16 v[56:57], v29 offset:8192
    s_waitcnt vmcnt(4)
    v_cmp_ne_u32 vcc, 0, v3
    s_cmp_eq_u64 vcc, -1
    s_cbranch_scc0 L_H_slow_3
L_H_ok_4:
    v_mfma_f32_16x16x32_bf16 v[96:99], a[144:147], v[36:39], v[96:99]
    ds_read_b64_tr_b16 v[58:59], v29 offset:8704
    v_mfma_f32_16x16x32_bf16 v[100:103], a[132:135], v[32:35], v[100:103]
    s_xor_b32 s80, s75, 0
    ds_read_b64_tr_b16 v[60:61], v29 offset:12288
    v_mfma_f32_16x16x32_bf16 v[100:103], a[148:151], v[36:39], v[100:103]
    ds_read_b64_tr_b16 v[62:63], v29 offset:12800
    v_mfma_f32_16x16x32_bf16 v[104:107], a[136:139], v[32:35], v[104:107]
    buffer_load_dwordx4 v22, s[24:27], s98 offen offset:2048  lds
    v_mfma_f32_16x16x32_bf16 v[104:107], a[152:155], v[36:39], v[104:107]
    v_cvt_pk_bf16_f32 v240, v240, v241
    v_cvt_pk_bf16_f32 v241, v242, v243
    v_mfma_f32_16x16x32_bf16 v[108:111], a[140:143], v[32:35], v[108:111]
    v_cvt_pk_bf16_f32 v242, v244, v245
    v_cvt_pk_bf16_f32 v243, v246, v247
    v_mfma_f32_16x16x32_bf16 v[108:111], a[156:159], v[36:39], v[108:111]
    buffer_load_dwordx4 a[0:3], v1, s[8:11], s80 offen offset:0
    v_mfma_f32_16x16x32_bf16 v[112:115], a[128:131], v[40:43], v[112:115]
    s_waitcnt lgkmcnt(4)
    s_xor_b32 s79, s65, 12288
    s_xor_b32 s80, s75, 16384
    ds_read_b64_tr_b16 v[32:33], v28 offset:16384
    v_mfma_f32_16x16x32_bf16 v[112:115], a[144:147], v[44:47], v[112:115]
    ds_read_b64_tr_b16 v[34:35], v28 offset:16896
    v_mfma_f32_16x16x32_bf16 v[116:119], a[132:135], v[40:43], v[116:119]
    ds_read_b64_tr_b16 v[36:37], v28 offset:20480
    v_mfma_f32_16x16x32_bf16 v[116:119], a[148:151], v[44:47], v[116:119]
    ds_read_b64_tr_b16 v[38:39], v28 offset:20992
    v_mfma_f32_16x16x32_bf16 v[120:123], a[136:139], v[40:43], v[120:123]
    buffer_load_dwordx4 v23, s[24:27], s98 offen offset:3072  lds
    v_mfma_f32_16x16x32_bf16 v[120:123], a[152:155], v[44:47], v[120:123]
    s_add_u32 m0, s63, 49152
    s_xor_b32 s98, s0, 3670016
    v_mfma_f32_16x16x32_bf16 v[124:127], a[140:143], v[40:43], v[124:127]
    buffer_store_dwordx4 v[240:243], v1, s[8:11], s79 offen offset:2048 sc0 sc1
    v_mfma_f32_16x16x32_bf16 v[124:127], a[156:159], v[44:47], v[124:127]
    buffer_load_dwordx4 a[4:7], v1, s[8:11], s80 offen offset:0
    v_mfma_f32_16x16x32_bf16 v[96:99], a[160:163], v[48:51], v[96:99]
    s_xor_b32 s80, s76, 0
    ds_read_b64_tr_b16 v[40:41], v29 offset:16384
    v_mfma_f32_16x16x32_bf16 v[96:99], a[176:179], v[52:55], v[96:99]
    ds_read_b64_tr_b16 v[42:43], v29 offset:16896
    v_mfma_f32_16x16x32_bf16 v[100:103], a[164:167], v[48:51], v[100:103]
    ds_read_b64_tr_b16 v[44:45], v29 offset:20480
    v_mfma_f32_16x16x32_bf16 v[100:103], a[180:183], v[52:55], v[100:103]
    ds_read_b64_tr_b16 v[46:47], v29 offset:20992
    v_mfma_f32_16x16x32_bf16 v[104:107], a[168:171], v[48:51], v[104:107]
    buffer_load_dwordx4 v20, s[24:27], s98 offen offset:0  lds
    v_mfma_f32_16x16x32_bf16 v[104:107], a[184:187], v[52:55], v[104:107]
    buffer_load_dwordx4 a[8:11], v1, s[8:11], s80 offen offset:0
    v_mfma_f32_16x16x32_bf16 v[108:111], a[172:175], v[48:51], v[108:111]
    v_mfma_f32_16x16x32_bf16 v[108:111], a[188:191], v[52:55], v[108:111]
    s_waitcnt lgkmcnt(4)
    v_mfma_f32_16x16x32_bf16 v[112:115], a[160:163], v[56:59], v[112:115]
    s_xor_b32 s80, s76, 16384
    ds_read_b64_tr_b16 v[48:49], v28 offset:24576
    v_mfma_f32_16x16x32_bf16 v[112:115], a[176:179], v[60:63], v[112:115]
    ds_read_b64_tr_b16 v[50:51], v28 offset:25088
    v_mfma_f32_16x16x32_bf16 v[116:119], a[164:167], v[56:59], v[116:119]
    ds_read_b64_tr_b16 v[52:53], v28 offset:28672
    v_cvt_pk_bf16_f32 v248, v248, v249
    v_mfma_f32_16x16x32_bf16 v[116:119], a[180:183], v[60:63], v[116:119]
    ds_read_b64_tr_b16 v[54:55], v28 offset:29184
    v_cvt_pk_bf16_f32 v249, v250, v251
    v_mfma_f32_16x16x32_bf16 v[120:123], a[168:171], v[56:59], v[120:123]
    buffer_load_dwordx4 v21, s[24:27], s98 offen offset:1024  lds
    v_mfma_f32_16x16x32_bf16 v[120:123], a[184:187], v[60:63], v[120:123]
    v_cvt_pk_bf16_f32 v250, v252, v253
    v_cvt_pk_bf16_f32 v251, v254, v255
    v_mfma_f32_16x16x32_bf16 v[124:127], a[172:175], v[56:59], v[124:127]
    buffer_load_dwordx4 a[12:15], v1, s[8:11], s80 offen offset:0
    v_mfma_f32_16x16x32_bf16 v[124:127], a[188:191], v[60:63], v[124:127]
    v_mfma_f32_16x16x32_bf16 v[96:99], a[192:195], v[32:35], v[96:99]
    s_xor_b32 s79, s65, 12288
    s_xor_b32 s80, s75, 0
    ds_read_b64_tr_b16 v[56:57], v29 offset:24576
    v_mfma_f32_16x16x32_bf16 v[96:99], a[208:211], v[36:39], v[96:99]
    ds_read_b64_tr_b16 v[58:59], v29 offset:25088
    v_mfma_f32_16x16x32_bf16 v[100:103], a[196:199], v[32:35], v[100:103]
    ds_read_b64_tr_b16 v[60:61], v29 offset:28672
    v_mfma_f32_16x16x32_bf16 v[100:103], a[212:215], v[36:39], v[100:103]
    ds_read_b64_tr_b16 v[62:63], v29 offset:29184
    v_mfma_f32_16x16x32_bf16 v[104:107], a[200:203], v[32:35], v[104:107]
    buffer_load_dwordx4 v22, s[24:27], s98 offen offset:2048  lds
    v_mfma_f32_16x16x32_bf16 v[104:107], a[216:219], v[36:39], v[104:107]
    buffer_store_dwordx4 v[248:251], v1, s[8:11], s79 offen offset:3072 sc0 sc1
    v_mfma_f32_16x16x32_bf16 v[108:111], a[204:207], v[32:35], v[108:111]
    buffer_load_dwordx4 a[16:19], v1, s[8:11], s80 offen offset:1024
    v_mfma_f32_16x16x32_bf16 v[108:111], a[220:223], v[36:39], v[108:111]
    s_waitcnt lgkmcnt(4)
    s_xor_b32 s80, s75, 16384
    v_xor_b32 v30, 65536, v30
    v_mfma_f32_16x16x32_bf16 v[112:115], a[192:195], v[40:43], v[112:115]
    ds_read_b64_tr_b16 v[32:33], v30 offset:0
    v_mfma_f32_16x16x32_bf16 v[112:115], a[208:211], v[44:47], v[112:115]
    ds_read_b64_tr_b16 v[34:35], v30 offset:512
    v_mfma_f32_16x16x32_bf16 v[116:119], a[196:199], v[40:43], v[116:119]
    ds_read_b64_tr_b16 v[36:37], v30 offset:4096
    v_mfma_f32_16x16x32_bf16 v[116:119], a[212:215], v[44:47], v[116:119]
    ds_read_b64_tr_b16 v[38:39], v30 offset:4608
    v_mfma_f32_16x16x32_bf16 v[120:123], a[200:203], v[40:43], v[120:123]
    buffer_load_dwordx4 v23, s[24:27], s98 offen offset:3072  lds
    v_mfma_f32_16x16x32_bf16 v[120:123], a[216:219], v[44:47], v[120:123]
    buffer_load_dwordx4 a[20:23], v1, s[8:11], s80 offen offset:1024
    v_mfma_f32_16x16x32_bf16 v[124:127], a[204:207], v[40:43], v[124:127]
    v_mfma_f32_16x16x32_bf16 v[124:127], a[220:223], v[44:47], v[124:127]
    s_xor_b32 s80, s76, 0
    v_xor_b32 v31, 65536, v31
    v_mfma_f32_16x16x32_bf16 v[96:99], a[224:227], v[48:51], v[96:99]
    ds_read_b64_tr_b16 v[40:41], v31 offset:0
    v_mfma_f32_16x16x32_bf16 v[96:99], a[240:243], v[52:55], v[96:99]
    ds_read_b64_tr_b16 v[42:43], v31 offset:512
    v_mfma_f32_16x16x32_bf16 v[100:103], a[228:231], v[48:51], v[100:103]
    ds_read_b64_tr_b16 v[44:45], v31 offset:4096
    v_mfma_f32_16x16x32_bf16 v[100:103], a[244:247], v[52:55], v[100:103]
    ds_read_b64_tr_b16 v[46:47], v31 offset:4608
    v_mfma_f32_16x16x32_bf16 v[104:107], a[232:235], v[48:51], v[104:107]
    buffer_load_dwordx4 a[24:27], v1, s[8:11], s80 offen offset:1024
    v_mfma_f32_16x16x32_bf16 v[104:107], a[248:251], v[52:55], v[104:107]
    s_xor_b32 s80, s76, 16384
    v_mfma_f32_16x16x32_bf16 v[108:111], a[236:239], v[48:51], v[108:111]
    buffer_load_dwordx4 a[28:31], v1, s[8:11], s80 offen offset:1024
    v_mfma_f32_16x16x32_bf16 v[108:111], a[252:255], v[52:55], v[108:111]
    s_waitcnt lgkmcnt(4)
    v_mfma_f32_16x16x32_bf16 v[112:115], a[224:227], v[56:59], v[112:115]
    ds_read_b64_tr_b16 v[48:49], v30 offset:8192
    v_mfma_f32_16x16x32_bf16 v[112:115], a[240:243], v[60:63], v[112:115]
    s_xor_b32 s80, s75, 2048
    ds_read_b64_tr_b16 v[50:51], v30 offset:8704
    v_mfma_f32_16x16x32_bf16 v[116:119], a[228:231], v[56:59], v[116:119]
    ds_read_b64_tr_b16 v[52:53], v30 offset:12288
    v_mfma_f32_16x16x32_bf16 v[116:119], a[244:247], v[60:63], v[116:119]
    ds_read_b64_tr_b16 v[54:55], v30 offset:12800
    v_mfma_f32_16x16x32_bf16 v[120:123], a[232:235], v[56:59], v[120:123]
    buffer_load_dwordx4 a[32:35], v1, s[8:11], s80 offen offset:0
    v_mfma_f32_16x16x32_bf16 v[120:123], a[248:251], v[60:63], v[120:123]
    v_mfma_f32_16x16x32_bf16 v[124:127], a[236:239], v[56:59], v[124:127]
    v_mfma_f32_16x16x32_bf16 v[124:127], a[252:255], v[60:63], v[124:127]
    v_mfma_f32_16x16x32_bf16 v[64:67], a[128:131], v[32:35], v[64:67]
    s_xor_b32 s80, s75, 18432
    ds_read_b64_tr_b16 v[56:57], v31 offset:8192
    v_mfma_f32_16x16x32_bf16 v[64:67], a[144:147], v[36:39], v[64:67]
    ds_read_b64_tr_b16 v[58:59], v31 offset:8704
    v_mfma_f32_16x16x32_bf16 v[68:71], a[132:135], v[32:35], v[68:71]
    ds_read_b64_tr_b16 v[60:61], v31 offset:12288
    v_mfma_f32_16x16x32_bf16 v[68:71], a[148:151], v[36:39], v[68:71]
    ds_read_b64_tr_b16 v[62:63], v31 offset:12800
    v_mfma_f32_16x16x32_bf16 v[72:75], a[136:139], v[32:35], v[72:75]
    buffer_load_dwordx4 a[36:39], v1, s[8:11], s80 offen offset:0
    v_mfma_f32_16x16x32_bf16 v[72:75], a[152:155], v[36:39], v[72:75]
    v_mfma_f32_16x16x32_bf16 v[76:79], a[140:143], v[32:35], v[76:79]
    v_mfma_f32_16x16x32_bf16 v[76:79], a[156:159], v[36:39], v[76:79]
    s_waitcnt lgkmcnt(4)
    v_mfma_f32_16x16x32_bf16 v[80:83], a[128:131], v[40:43], v[80:83]
    s_xor_b32 s80, s76, 2048
    ds_read_b64_tr_b16 v[32:33], v30 offset:16384
    v_cvt_pk_bf16_f32 v96, v96, v97
    v_mfma_f32_16x16x32_bf16 v[80:83], a[144:147], v[44:47], v[80:83]
    ds_read_b64_tr_b16 v[34:35], v30 offset:16896
    v_cvt_pk_bf16_f32 v97, v98, v99
    v_mfma_f32_16x16x32_bf16 v[84:87], a[132:135], v[40:43], v[84:87]
    ds_read_b64_tr_b16 v[36:37], v30 offset:20480
    v_cvt_pk_bf16_f32 v98, v100, v101
    v_mfma_f32_16x16x32_bf16 v[84:87], a[148:151], v[44:47], v[84:87]
    ds_read_b64_tr_b16 v[38:39], v30 offset:20992
    v_cvt_pk_bf16_f32 v99, v102, v103
    v_mfma_f32_16x16x32_bf16 v[88:91], a[136:139], v[40:43], v[88:91]
    s_xor_b32 s79, s1, 36864
    v_mfma_f32_16x16x32_bf16 v[88:91], a[152:155], v[44:47], v[88:91]
    buffer_store_dwordx4 v[96:99], v1, s[8:11], s79 offen offset:0 sc0 sc1
    v_mfma_f32_16x16x32_bf16 v[92:95], a[140:143], v[40:43], v[92:95]
    buffer_load_dwordx4 a[40:43], v1, s[8:11], s80 offen offset:0
    v_mfma_f32_16x16x32_bf16 v[92:95], a[156:159], v[44:47], v[92:95]
    v_mfma_f32_16x16x32_bf16 v[64:67], a[160:163], v[48:51], v[64:67]
    s_xor_b32 s80, s76, 18432
    ds_read_b64_tr_b16 v[40:41], v31 offset:16384
    v_mfma_f32_16x16x32_bf16 v[64:67], a[176:179], v[52:55], v[64:67]
    ds_read_b64_tr_b16 v[42:43], v31 offset:16896
    v_mfma_f32_16x16x32_bf16 v[68:71], a[164:167], v[48:51], v[68:71]
    ds_read_b64_tr_b16 v[44:45], v31 offset:20480
    v_mfma_f32_16x16x32_bf16 v[68:71], a[180:183], v[52:55], v[68:71]
    ds_read_b64_tr_b16 v[46:47], v31 offset:20992
    v_mfma_f32_16x16x32_bf16 v[72:75], a[168:171], v[48:51], v[72:75]
    buffer_load_dwordx4 a[44:47], v1, s[8:11], s80 offen offset:0
    v_mfma_f32_16x16x32_bf16 v[72:75], a[184:187], v[52:55], v[72:75]
    s_xor_b32 s80, s75, 2048
    v_mfma_f32_16x16x32_bf16 v[76:79], a[172:175], v[48:51], v[76:79]
    buffer_load_dwordx4 a[48:51], v1, s[8:11], s80 offen offset:1024
    v_mfma_f32_16x16x32_bf16 v[76:79], a[188:191], v[52:55], v[76:79]
    s_waitcnt lgkmcnt(4)
    v_mfma_f32_16x16x32_bf16 v[80:83], a[160:163], v[56:59], v[80:83]
    ds_read_b64_tr_b16 v[48:49], v30 offset:24576
    v_cvt_pk_bf16_f32 v104, v104, v105
    v_mfma_f32_16x16x32_bf16 v[80:83], a[176:179], v[60:63], v[80:83]
    ds_read_b64_tr_b16 v[50:51], v30 offset:25088
    v_cvt_pk_bf16_f32 v105, v106, v107
    v_mfma_f32_16x16x32_bf16 v[84:87], a[164:167], v[56:59], v[84:87]
    ds_read_b64_tr_b16 v[52:53], v30 offset:28672
    v_cvt_pk_bf16_f32 v106, v108, v109
    v_mfma_f32_16x16x32_bf16 v[84:87], a[180:183], v[60:63], v[84:87]
    ds_read_b64_tr_b16 v[54:55], v30 offset:29184
    v_cvt_pk_bf16_f32 v107, v110, v111
    v_mfma_f32_16x16x32_bf16 v[88:91], a[168:171], v[56:59], v[88:91]
    s_xor_b32 s79, s1, 45056
    s_xor_b32 s80, s75, 18432
    v_mfma_f32_16x16x32_bf16 v[88:91], a[184:187], v[60:63], v[88:91]
    buffer_store_dwordx4 v[104:107], v1, s[8:11], s79 offen offset:0 sc0 sc1
    v_mfma_f32_16x16x32_bf16 v[92:95], a[172:175], v[56:59], v[92:95]
    buffer_load_dwordx4 a[52:55], v1, s[8:11], s80 offen offset:1024
    v_mfma_f32_16x16x32_bf16 v[92:95], a[188:191], v[60:63], v[92:95]
    v_mfma_f32_16x16x32_bf16 v[64:67], a[192:195], v[32:35], v[64:67]
    ds_read_b64_tr_b16 v[56:57], v31 offset:24576
    v_mfma_f32_16x16x32_bf16 v[64:67], a[208:211], v[36:39], v[64:67]
    ds_read_b64_tr_b16 v[58:59], v31 offset:25088
    v_mfma_f32_16x16x32_bf16 v[68:71], a[196:199], v[32:35], v[68:71]
    ds_read_b64_tr_b16 v[60:61], v31 offset:28672
    v_mfma_f32_16x16x32_bf16 v[68:71], a[212:215], v[36:39], v[68:71]
    s_xor_b32 s80, s76, 2048
    ds_read_b64_tr_b16 v[62:63], v31 offset:29184
    v_mfma_f32_16x16x32_bf16 v[72:75], a[200:203], v[32:35], v[72:75]
    buffer_load_dwordx4 a[56:59], v1, s[8:11], s80 offen offset:1024
    v_mfma_f32_16x16x32_bf16 v[72:75], a[216:219], v[36:39], v[72:75]
    v_mfma_f32_16x16x32_bf16 v[76:79], a[204:207], v[32:35], v[76:79]
    v_cvt_pk_bf16_f32 v112, v112, v113
    v_cvt_pk_bf16_f32 v113, v114, v115
    v_mfma_f32_16x16x32_bf16 v[76:79], a[220:223], v[36:39], v[76:79]
    s_waitcnt lgkmcnt(4)
    v_cvt_pk_bf16_f32 v114, v116, v117
    v_cvt_pk_bf16_f32 v115, v118, v119
    v_mfma_f32_16x16x32_bf16 v[80:83], a[192:195], v[40:43], v[80:83]
    s_xor_b32 s79, s1, 36864
    v_mfma_f32_16x16x32_bf16 v[80:83], a[208:211], v[44:47], v[80:83]
    buffer_store_dwordx4 v[112:115], v1, s[8:11], s79 offen offset:1024 sc0 sc1
    v_mfma_f32_16x16x32_bf16 v[84:87], a[196:199], v[40:43], v[84:87]
    s_xor_b32 s80, s76, 18432
    v_mfma_f32_16x16x32_bf16 v[84:87], a[212:215], v[44:47], v[84:87]
    buffer_load_dwordx4 a[60:63], v1, s[8:11], s80 offen offset:1024
    v_mfma_f32_16x16x32_bf16 v[88:91], a[200:203], v[40:43], v[88:91]
    v_mfma_f32_16x16x32_bf16 v[88:91], a[216:219], v[44:47], v[88:91]
    v_mfma_f32_16x16x32_bf16 v[92:95], a[204:207], v[40:43], v[92:95]
    s_waitcnt lgkmcnt(0)
    s_barrier
    v_mfma_f32_16x16x32_bf16 v[92:95], a[220:223], v[44:47], v[92:95]
    ds_read_b64_tr_b16 v[32:33], v8 offset:32768
    v_mfma_f32_16x16x32_bf16 v[64:67], a[224:227], v[48:51], v[64:67]
    ds_read_b64_tr_b16 v[34:35], v8 offset:33792
    v_mfma_f32_16x16x32_bf16 v[64:67], a[240:243], v[52:55], v[64:67]
    s_xor_b32 s80, s75, 4096
    ds_read_b64_tr_b16 v[36:37], v9 offset:32768
    v_mfma_f32_16x16x32_bf16 v[68:71], a[228:231], v[48:51], v[68:71]
    ds_read_b64_tr_b16 v[38:39], v9 offset:33792
    v_mfma_f32_16x16x32_bf16 v[68:71], a[244:247], v[52:55], v[68:71]
    ds_read_b64_tr_b16 v[40:41], v10 offset:32768
    v_mfma_f32_16x16x32_bf16 v[72:75], a[232:235], v[48:51], v[72:75]
    ds_read_b64_tr_b16 v[42:43], v10 offset:33792
    v_mfma_f32_16x16x32_bf16 v[72:75], a[248:251], v[52:55], v[72:75]
    ds_read_b64_tr_b16 v[44:45], v11 offset:32768
    v_mfma_f32_16x16x32_bf16 v[76:79], a[236:239], v[48:51], v[76:79]
    ds_read_b64_tr_b16 v[46:47], v11 offset:33792
    v_cvt_pk_bf16_f32 v120, v120, v121
    v_mfma_f32_16x16x32_bf16 v[76:79], a[252:255], v[52:55], v[76:79]
    buffer_load_dwordx4 a[64:67], v1, s[8:11], s80 offen offset:0
    v_mfma_f32_16x16x32_bf16 v[80:83], a[224:227], v[56:59], v[80:83]
    s_xor_b32 s80, s75, 20480
    ds_read_b64_tr_b16 v[48:49], v12 offset:32768
    v_cvt_pk_bf16_f32 v121, v122, v123
    v_mfma_f32_16x16x32_bf16 v[80:83], a[240:243], v[60:63], v[80:83]
    ds_read_b64_tr_b16 v[50:51], v12 offset:33792
    v_cvt_pk_bf16_f32 v122, v124, v125
    v_mfma_f32_16x16x32_bf16 v[84:87], a[228:231], v[56:59], v[84:87]
    ds_read_b64_tr_b16 v[52:53], v13 offset:32768
    v_cvt_pk_bf16_f32 v123, v126, v127
    v_mfma_f32_16x16x32_bf16 v[84:87], a[244:247], v[60:63], v[84:87]
    s_xor_b32 s79, s1, 45056
    ds_read_b64_tr_b16 v[54:55], v13 offset:33792
    v_mfma_f32_16x16x32_bf16 v[88:91], a[232:235], v[56:59], v[88:91]
    buffer_store_dwordx4 v[120:123], v1, s[8:11], s79 offen offset:1024 sc0 sc1
    v_mfma_f32_16x16x32_bf16 v[88:91], a[248:251], v[60:63], v[88:91]
    buffer_load_dwordx4 a[68:71], v1, s[8:11], s80 offen offset:0
    v_mfma_f32_16x16x32_bf16 v[92:95], a[236:239], v[56:59], v[92:95]
    v_mfma_f32_16x16x32_bf16 v[92:95], a[252:255], v[60:63], v[92:95]
    s_waitcnt vmcnt(28) lgkmcnt(5)
    v_mfma_f32_16x16x32_bf16 v[128:131], v[32:35], a[0:3], 0
    s_waitcnt vmcnt(25)
    s_xor_b32 s80, s76, 4096
    ds_read_b64_tr_b16 v[56:57], v14 offset:32768
    v_mfma_f32_16x16x32_bf16 v[160:163], v[32:35], a[4:7], 0
    s_waitcnt vmcnt(23)
    ds_read_b64_tr_b16 v[58:59], v14 offset:33792
    v_mfma_f32_16x16x32_bf16 v[192:195], v[32:35], a[8:11], 0
    s_waitcnt vmcnt(21)
    ds_read_b64_tr_b16 v[60:61], v15 offset:32768
    v_mfma_f32_16x16x32_bf16 v[224:227], v[32:35], a[12:15], 0
    ds_read_b64_tr_b16 v[62:63], v15 offset:33792
    v_mfma_f32_16x16x32_bf16 v[132:135], v[36:39], a[0:3], 0
    ds_read_b64_tr_b16 v[32:33], v8 offset:40960
    v_mfma_f32_16x16x32_bf16 v[164:167], v[36:39], a[4:7], 0
    ds_read_b64_tr_b16 v[34:35], v8 offset:41984
    v_mfma_f32_16x16x32_bf16 v[196:199], v[36:39], a[8:11], 0
    buffer_load_dwordx4 a[72:75], v1, s[8:11], s80 offen offset:0
    v_mfma_f32_16x16x32_bf16 v[228:231], v[36:39], a[12:15], 0
    v_mfma_f32_16x16x32_bf16 v[136:139], v[40:43], a[0:3], 0
    s_xor_b32 s80, s76, 20480
    ds_read_b64_tr_b16 v[36:37], v9 offset:40960
    v_cvt_pk_bf16_f32 v64, v64, v65
    v_mfma_f32_16x16x32_bf16 v[168:171], v[40:43], a[4:7], 0
    ds_read_b64_tr_b16 v[38:39], v9 offset:41984
    v_cvt_pk_bf16_f32 v65, v66, v67
    v_mfma_f32_16x16x32_bf16 v[200:203], v[40:43], a[8:11], 0
    s_waitcnt lgkmcnt(7)
    v_cvt_pk_bf16_f32 v66, v68, v69
    v_cvt_pk_bf16_f32 v67, v70, v71
    v_mfma_f32_16x16x32_bf16 v[232:235], v[40:43], a[12:15], 0
    buffer_load_dwordx4 a[76:79], v1, s[8:11], s80 offen offset:0
    v_mfma_f32_16x16x32_bf16 v[140:143], v[44:47], a[0:3], 0
    s_xor_b32 s79, s1, 36864
    ds_read_b64_tr_b16 v[40:41], v10 offset:40960
    v_mfma_f32_16x16x32_bf16 v[172:175], v[44:47], a[4:7], 0
    s_xor_b32 s80, s75, 4096
    ds_read_b64_tr_b16 v[42:43], v10 offset:41984
    v_mfma_f32_16x16x32_bf16 v[204:207], v[44:47], a[8:11], 0
    buffer_store_dwordx4 v[64:67], v1, s[8:11], s79 offen offset:2048 sc0 sc1
    v_mfma_f32_16x16x32_bf16 v[236:239], v[44:47], a[12:15], 0
    buffer_load_dwordx4 a[80:83], v1, s[8:11], s80 offen offset:1024
    v_mfma_f32_16x16x32_bf16 v[144:147], v[48:51], a[0:3], 0
    ds_read_b64_tr_b16 v[44:45], v11 offset:40960
    v_mfma_f32_16x16x32_bf16 v[176:179], v[48:51], a[4:7], 0
    ds_read_b64_tr_b16 v[46:47], v11 offset:41984
    v_mfma_f32_16x16x32_bf16 v[208:211], v[48:51], a[8:11], 0
    v_mfma_f32_16x16x32_bf16 v[240:243], v[48:51], a[12:15], 0
    v_mfma_f32_16x16x32_bf16 v[148:151], v[52:55], a[0:3], 0
    s_xor_b32 s80, s75, 20480
    ds_read_b64_tr_b16 v[48:49], v12 offset:40960
    v_mfma_f32_16x16x32_bf16 v[180:183], v[52:55], a[4:7], 0
    ds_read_b64_tr_b16 v[50:51], v12 offset:41984
    v_mfma_f32_16x16x32_bf16 v[212:215], v[52:55], a[8:11], 0
    buffer_load_dwordx4 a[84:87], v1, s[8:11], s80 offen offset:1024
    v_mfma_f32_16x16x32_bf16 v[244:247], v[52:55], a[12:15], 0
    s_waitcnt lgkmcnt(4)
    v_mfma_f32_16x16x32_bf16 v[152:155], v[56:59], a[0:3], 0
    ds_read_b64_tr_b16 v[52:53], v13 offset:40960
    v_cvt_pk_bf16_f32 v72, v72, v73
    v_mfma_f32_16x16x32_bf16 v[184:187], v[56:59], a[4:7], 0
    ds_read_b64_tr_b16 v[54:55], v13 offset:41984
    v_cvt_pk_bf16_f32 v73, v74, v75
    v_mfma_f32_16x16x32_bf16 v[216:219], v[56:59], a[8:11], 0
    v_cvt_pk_bf16_f32 v74, v76, v77
    v_cvt_pk_bf16_f32 v75, v78, v79
    v_mfma_f32_16x16x32_bf16 v[248:251], v[56:59], a[12:15], 0
    v_mfma_f32_16x16x32_bf16 v[156:159], v[60:63], a[0:3], 0
    s_xor_b32 s79, s1, 45056
    s_xor_b32 s80, s76, 4096
    ds_read_b64_tr_b16 v[56:57], v14 offset:40960
    v_mfma_f32_16x16x32_bf16 v[188:191], v[60:63], a[4:7], 0
    s_waitcnt vmcnt(23)
    ds_read_b64_tr_b16 v[58:59], v14 offset:41984
    v_mfma_f32_16x16x32_bf16 v[220:223], v[60:63], a[8:11], 0
    buffer_store_dwordx4 v[72:75], v1, s[8:11], s79 offen offset:2048 sc0 sc1
    v_mfma_f32_16x16x32_bf16 v[252:255], v[60:63], a[12:15], 0
    buffer_load_dwordx4 a[88:91], v1, s[8:11], s80 offen offset:1024
    v_mfma_f32_16x16x32_bf16 v[128:131], v[32:35], a[16:19], v[128:131]
    s_waitcnt vmcnt(23)
    ds_read_b64_tr_b16 v[60:61], v15 offset:40960
    v_mfma_f32_16x16x32_bf16 v[160:163], v[32:35], a[20:23], v[160:163]
    s_waitcnt vmcnt(22)
    ds_read_b64_tr_b16 v[62:63], v15 offset:41984
    v_mfma_f32_16x16x32_bf16 v[192:195], v[32:35], a[24:27], v[192:195]
    s_waitcnt vmcnt(21)
    v_mfma_f32_16x16x32_bf16 v[224:227], v[32:35], a[28:31], v[224:227]
    v_mfma_f32_16x16x32_bf16 v[132:135], v[36:39], a[16:19], v[132:135]
    s_xor_b32 s80, s76, 20480
    ds_read_b64_tr_b16 v[32:33], v8 offset:0
    v_mfma_f32_16x16x32_bf16 v[164:167], v[36:39], a[20:23], v[164:167]
    ds_read_b64_tr_b16 v[34:35], v8 offset:1024
    v_mfma_f32_16x16x32_bf16 v[196:199], v[36:39], a[24:27], v[196:199]
    buffer_load_dwordx4 a[92:95], v1, s[8:11], s80 offen offset:1024
    v_mfma_f32_16x16x32_bf16 v[228:231], v[36:39], a[28:31], v[228:231]
    v_mfma_f32_16x16x32_bf16 v[136:139], v[40:43], a[16:19], v[136:139]
    ds_read_b64_tr_b16 v[36:37], v9 offset:0
    v_cvt_pk_bf16_f32 v80, v80, v81
    v_mfma_f32_16x16x32_bf16 v[168:171], v[40:43], a[20:23], v[168:171]
    s_xor_b32 s80, s75, 6144
    ds_read_b64_tr_b16 v[38:39], v9 offset:1024
    v_cvt_pk_bf16_f32 v81, v82, v83
    v_mfma_f32_16x16x32_bf16 v[200:203], v[40:43], a[24:27], v[200:203]
    s_waitcnt lgkmcnt(5)
    v_cvt_pk_bf16_f32 v82, v84, v85
    v_cvt_pk_bf16_f32 v83, v86, v87
    v_mfma_f32_16x16x32_bf16 v[232:235], v[40:43], a[28:31], v[232:235]
    buffer_load_dwordx4 a[96:99], v1, s[8:11], s80 offen offset:0
    v_mfma_f32_16x16x32_bf16 v[140:143], v[44:47], a[16:19], v[140:143]
    s_xor_b32 s79, s1, 36864
    ds_read_b64_tr_b16 v[40:41], v10 offset:0
    v_mfma_f32_16x16x32_bf16 v[172:175], v[44:47], a[20:23], v[172:175]
    ds_read_b64_tr_b16 v[42:43], v10 offset:1024
    v_mfma_f32_16x16x32_bf16 v[204:207], v[44:47], a[24:27], v[204:207]
    buffer_store_dwordx4 v[80:83], v1, s[8:11], s79 offen offset:3072 sc0 sc1
    v_mfma_f32_16x16x32_bf16 v[236:239], v[44:47], a[28:31], v[236:239]
    v_mfma_f32_16x16x32_bf16 v[144:147], v[48:51], a[16:19], v[144:147]
    s_xor_b32 s80, s75, 22528
    ds_read_b64_tr_b16 v[44:45], v11 offset:0
    v_mfma_f32_16x16x32_bf16 v[176:179], v[48:51], a[20:23], v[176:179]
    ds_read_b64_tr_b16 v[46:47], v11 offset:1024
    v_mfma_f32_16x16x32_bf16 v[208:211], v[48:51], a[24:27], v[208:211]
    buffer_load_dwordx4 a[100:103], v1, s[8:11], s80 offen offset:0
    v_mfma_f32_16x16x32_bf16 v[240:243], v[48:51], a[28:31], v[240:243]
    v_mfma_f32_16x16x32_bf16 v[148:151], v[52:55], a[16:19], v[148:151]
    ds_read_b64_tr_b16 v[48:49], v12 offset:0
    v_mfma_f32_16x16x32_bf16 v[180:183], v[52:55], a[20:23], v[180:183]
    ds_read_b64_tr_b16 v[50:51], v12 offset:1024
    v_mfma_f32_16x16x32_bf16 v[212:215], v[52:55], a[24:27], v[212:215]
    v_mfma_f32_16x16x32_bf16 v[244:247], v[52:55], a[28:31], v[244:247]
    v_mfma_f32_16x16x32_bf16 v[152:155], v[56:59], a[16:19], v[152:155]
    s_xor_b32 s80, s76, 6144
    ds_read_b64_tr_b16 v[52:53], v13 offset:0
    v_cvt_pk_bf16_f32 v88, v88, v89
    v_mfma_f32_16x16x32_bf16 v[184:187], v[56:59], a[20:23], v[184:187]
    ds_read_b64_tr_b16 v[54:55], v13 offset:1024
    v_cvt_pk_bf16_f32 v89, v90, v91
    v_mfma_f32_16x16x32_bf16 v[216:219], v[56:59], a[24:27], v[216:219]
    s_waitcnt lgkmcnt(5)
    v_cvt_pk_bf16_f32 v90, v92, v93
    v_cvt_pk_bf16_f32 v91, v94, v95
    v_mfma_f32_16x16x32_bf16 v[248:251], v[56:59], a[28:31], v[248:251]
    buffer_load_dwordx4 a[104:107], v1, s[8:11], s80 offen offset:0
    v_mfma_f32_16x16x32_bf16 v[156:159], v[60:63], a[16:19], v[156:159]
    s_xor_b32 s79, s1, 45056
    ds_read_b64_tr_b16 v[56:57], v14 offset:0
    v_mfma_f32_16x16x32_bf16 v[188:191], v[60:63], a[20:23], v[188:191]
    ds_read_b64_tr_b16 v[58:59], v14 offset:1024
    v_mfma_f32_16x16x32_bf16 v[220:223], v[60:63], a[24:27], v[220:223]
    buffer_store_dwordx4 v[88:91], v1, s[8:11], s79 offen offset:3072 sc0 sc1
    v_mfma_f32_16x16x32_bf16 v[252:255], v[60:63], a[28:31], v[252:255]
    s_waitcnt vmcnt(26)
    v_mfma_f32_16x16x32_bf16 v[128:131], v[32:35], a[32:35], v[128:131]
    s_waitcnt vmcnt(25)
    s_xor_b32 s80, s76, 22528
    ds_read_b64_tr_b16 v[60:61], v15 offset:0
    v_mfma_f32_16x16x32_bf16 v[160:163], v[32:35], a[36:39], v[160:163]
    s_waitcnt vmcnt(22)
    ds_read_b64_tr_b16 v[62:63], v15 offset:1024
    v_mfma_f32_16x16x32_bf16 v[192:195], v[32:35], a[40:43], v[192:195]
    buffer_load_dwordx4 a[108:111], v1, s[8:11], s80 offen offset:0
    v_mfma_f32_16x16x32_bf16 v[224:227], v[32:35], a[44:47], v[224:227]
    v_mfma_f32_16x16x32_bf16 v[132:135], v[36:39], a[32:35], v[132:135]
    ds_read_b64_tr_b16 v[32:33], v8 offset:8192
    v_mfma_f32_16x16x32_bf16 v[164:167], v[36:39], a[36:39], v[164:167]
    s_xor_b32 s80, s75, 6144
    ds_read_b64_tr_b16 v[34:35], v8 offset:9216
    v_mfma_f32_16x16x32_bf16 v[196:199], v[36:39], a[40:43], v[196:199]
    buffer_load_dwordx4 a[112:115], v1, s[8:11], s80 offen offset:1024
    v_mfma_f32_16x16x32_bf16 v[228:231], v[36:39], a[44:47], v[228:231]
    v_mfma_f32_16x16x32_bf16 v[136:139], v[40:43], a[32:35], v[136:139]
    ds_read_b64_tr_b16 v[36:37], v9 offset:8192
    v_mfma_f32_16x16x32_bf16 v[168:171], v[40:43], a[36:39], v[168:171]
    ds_read_b64_tr_b16 v[38:39], v9 offset:9216
    v_mfma_f32_16x16x32_bf16 v[200:203], v[40:43], a[40:43], v[200:203]
    v_mfma_f32_16x16x32_bf16 v[232:235], v[40:43], a[44:47], v[232:235]
    s_waitcnt lgkmcnt(4)
    v_mfma_f32_16x16x32_bf16 v[140:143], v[44:47], a[32:35], v[140:143]
    s_xor_b32 s80, s75, 22528
    ds_read_b64_tr_b16 v[40:41], v10 offset:8192
    v_mfma_f32_16x16x32_bf16 v[172:175], v[44:47], a[36:39], v[172:175]
    ds_read_b64_tr_b16 v[42:43], v10 offset:9216
    v_mfma_f32_16x16x32_bf16 v[204:207], v[44:47], a[40:43], v[204:207]
    buffer_load_dwordx4 a[116:119], v1, s[8:11], s80 offen offset:1024
    v_mfma_f32_16x16x32_bf16 v[236:239], v[44:47], a[44:47], v[236:239]
    v_mfma_f32_16x16x32_bf16 v[144:147], v[48:51], a[32:35], v[144:147]
    ds_read_b64_tr_b16 v[44:45], v11 offset:8192
    v_mfma_f32_16x16x32_bf16 v[176:179], v[48:51], a[36:39], v[176:179]
    ds_read_b64_tr_b16 v[46:47], v11 offset:9216
    v_mfma_f32_16x16x32_bf16 v[208:211], v[48:51], a[40:43], v[208:211]
    v_mfma_f32_16x16x32_bf16 v[240:243], v[48:51], a[44:47], v[240:243]
    v_mfma_f32_16x16x32_bf16 v[148:151], v[52:55], a[32:35], v[148:151]
    s_xor_b32 s80, s76, 6144
    ds_read_b64_tr_b16 v[48:49], v12 offset:8192
    v_mfma_f32_16x16x32_bf16 v[180:183], v[52:55], a[36:39], v[180:183]
    ds_read_b64_tr_b16 v[50:51], v12 offset:9216
    v_mfma_f32_16x16x32_bf16 v[212:215], v[52:55], a[40:43], v[212:215]
    buffer_load_dwordx4 a[120:123], v1, s[8:11], s80 offen offset:1024
    v_mfma_f32_16x16x32_bf16 v[244:247], v[52:55], a[44:47], v[244:247]
    v_mfma_f32_16x16x32_bf16 v[152:155], v[56:59], a[32:35], v[152:155]
    ds_read_b64_tr_b16 v[52:53], v13 offset:8192
    v_mfma_f32_16x16x32_bf16 v[184:187], v[56:59], a[36:39], v[184:187]
    ds_read_b64_tr_b16 v[54:55], v13 offset:9216
    v_mfma_f32_16x16x32_bf16 v[216:219], v[56:59], a[40:43], v[216:219]
    v_mfma_f32_16x16x32_bf16 v[248:251], v[56:59], a[44:47], v[248:251]
    v_mfma_f32_16x16x32_bf16 v[156:159], v[60:63], a[32:35], v[156:159]
    s_xor_b32 s80, s76, 22528
    ds_read_b64_tr_b16 v[56:57], v14 offset:8192
    v_mfma_f32_16x16x32_bf16 v[188:191], v[60:63], a[36:39], v[188:191]
    ds_read_b64_tr_b16 v[58:59], v14 offset:9216
    v_mfma_f32_16x16x32_bf16 v[220:223], v[60:63], a[40:43], v[220:223]
    buffer_load_dwordx4 a[124:127], v1, s[8:11], s80 offen offset:1024
    v_mfma_f32_16x16x32_bf16 v[252:255], v[60:63], a[44:47], v[252:255]
    s_waitcnt vmcnt(26) lgkmcnt(4)
    v_mfma_f32_16x16x32_bf16 v[128:131], v[32:35], a[48:51], v[128:131]
    s_waitcnt vmcnt(24)
    ds_read_b64_tr_b16 v[60:61], v15 offset:8192
    v_mfma_f32_16x16x32_bf16 v[160:163], v[32:35], a[52:55], v[160:163]
    s_waitcnt vmcnt(21)
    s_xor_b32 s80, s75, 8192
    ds_read_b64_tr_b16 v[62:63], v15 offset:9216
    v_mfma_f32_16x16x32_bf16 v[192:195], v[32:35], a[56:59], v[192:195]
    buffer_load_dwordx4 a[128:131], v1, s[8:11], s80 offen offset:0
    v_mfma_f32_16x16x32_bf16 v[224:227], v[32:35], a[60:63], v[224:227]
    v_mfma_f32_16x16x32_bf16 v[132:135], v[36:39], a[48:51], v[132:135]
    ds_read_b64_tr_b16 v[32:33], v8 offset:16384
    v_mfma_f32_16x16x32_bf16 v[164:167], v[36:39], a[52:55], v[164:167]
    ds_read_b64_tr_b16 v[34:35], v8 offset:17408
    v_mfma_f32_16x16x32_bf16 v[196:199], v[36:39], a[56:59], v[196:199]
    v_mfma_f32_16x16x32_bf16 v[228:231], v[36:39], a[60:63], v[228:231]
    v_mfma_f32_16x16x32_bf16 v[136:139], v[40:43], a[48:51], v[136:139]
    s_xor_b32 s80, s75, 24576
    ds_read_b64_tr_b16 v[36:37], v9 offset:16384
    v_mfma_f32_16x16x32_bf16 v[168:171], v[40:43], a[52:55], v[168:171]
    ds_read_b64_tr_b16 v[38:39], v9 offset:17408
    v_mfma_f32_16x16x32_bf16 v[200:203], v[40:43], a[56:59], v[200:203]
    buffer_load_dwordx4 a[132:135], v1, s[8:11], s80 offen offset:0
    v_mfma_f32_16x16x32_bf16 v[232:235], v[40:43], a[60:63], v[232:235]
    v_mfma_f32_16x16x32_bf16 v[140:143], v[44:47], a[48:51], v[140:143]
    ds_read_b64_tr_b16 v[40:41], v10 offset:16384
    v_mfma_f32_16x16x32_bf16 v[172:175], v[44:47], a[52:55], v[172:175]
    ds_read_b64_tr_b16 v[42:43], v10 offset:17408
    v_mfma_f32_16x16x32_bf16 v[204:207], v[44:47], a[56:59], v[204:207]
    v_mfma_f32_16x16x32_bf16 v[236:239], v[44:47], a[60:63], v[236:239]
    v_mfma_f32_16x16x32_bf16 v[144:147], v[48:51], a[48:51], v[144:147]
    s_xor_b32 s80, s76, 8192
    ds_read_b64_tr_b16 v[44:45], v11 offset:16384
    v_mfma_f32_16x16x32_bf16 v[176:179], v[48:51], a[52:55], v[176:179]
    ds_read_b64_tr_b16 v[46:47], v11 offset:17408
    v_mfma_f32_16x16x32_bf16 v[208:211], v[48:51], a[56:59], v[208:211]
    buffer_load_dwordx4 a[136:139], v1, s[8:11], s80 offen offset:0
    v_mfma_f32_16x16x32_bf16 v[240:243], v[48:51], a[60:63], v[240:243]
    s_waitcnt lgkmcnt(4)
    v_mfma_f32_16x16x32_bf16 v[148:151], v[52:55], a[48:51], v[148:151]
    ds_read_b64_tr_b16 v[48:49], v12 offset:16384
    v_mfma_f32_16x16x32_bf16 v[180:183], v[52:55], a[52:55], v[180:183]
    ds_read_b64_tr_b16 v[50:51], v12 offset:17408
    v_mfma_f32_16x16x32_bf16 v[212:215], v[52:55], a[56:59], v[212:215]
    v_mfma_f32_16x16x32_bf16 v[244:247], v[52:55], a[60:63], v[244:247]
    v_mfma_f32_16x16x32_bf16 v[152:155], v[56:59], a[48:51], v[152:155]
    s_xor_b32 s80, s76, 24576
    ds_read_b64_tr_b16 v[52:53], v13 offset:16384
    v_mfma_f32_16x16x32_bf16 v[184:187], v[56:59], a[52:55], v[184:187]
    ds_read_b64_tr_b16 v[54:55], v13 offset:17408
    v_mfma_f32_16x16x32_bf16 v[216:219], v[56:59], a[56:59], v[216:219]
    buffer_load_dwordx4 a[140:143], v1, s[8:11], s80 offen offset:0
    s_waitcnt vmcnt(9)
    v_mfma_f32_16x16x32_bf16 v[248:251], v[56:59], a[60:63], v[248:251]
    buffer_store_dword v6, v5, s[8:11], s73 offen sc0 sc1
    v_mfma_f32_16x16x32_bf16 v[156:159], v[60:63], a[48:51], v[156:159]
    ds_read_b64_tr_b16 v[56:57], v14 offset:16384
    v_mfma_f32_16x16x32_bf16 v[188:191], v[60:63], a[52:55], v[188:191]
    s_xor_b32 s80, s75, 8192
    ds_read_b64_tr_b16 v[58:59], v14 offset:17408
    v_mfma_f32_16x16x32_bf16 v[220:223], v[60:63], a[56:59], v[220:223]
    buffer_load_dwordx4 a[144:147], v1, s[8:11], s80 offen offset:1024
    v_mfma_f32_16x16x32_bf16 v[252:255], v[60:63], a[60:63], v[252:255]
    v_mfma_f32_16x16x32_bf16 v[128:131], v[32:35], a[64:67], v[128:131]
    ds_read_b64_tr_b16 v[60:61], v15 offset:16384
    v_mfma_f32_16x16x32_bf16 v[160:163], v[32:35], a[68:71], v[160:163]
    ds_read_b64_tr_b16 v[62:63], v15 offset:17408
    v_mfma_f32_16x16x32_bf16 v[192:195], v[32:35], a[72:75], v[192:195]
    v_mfma_f32_16x16x32_bf16 v[224:227], v[32:35], a[76:79], v[224:227]
    v_mfma_f32_16x16x32_bf16 v[132:135], v[36:39], a[64:67], v[132:135]
    s_xor_b32 s80, s75, 24576
    ds_read_b64_tr_b16 v[32:33], v8 offset:24576
    v_mfma_f32_16x16x32_bf16 v[164:167], v[36:39], a[68:71], v[164:167]
    ds_read_b64_tr_b16 v[34:35], v8 offset:25600
    v_mfma_f32_16x16x32_bf16 v[196:199], v[36:39], a[72:75], v[196:199]
    buffer_load_dwordx4 a[148:151], v1, s[8:11], s80 offen offset:1024
    v_mfma_f32_16x16x32_bf16 v[228:231], v[36:39], a[76:79], v[228:231]
    s_waitcnt lgkmcnt(4)
    v_mfma_f32_16x16x32_bf16 v[136:139], v[40:43], a[64:67], v[136:139]
    ds_read_b64_tr_b16 v[36:37], v9 offset:24576
    v_mfma_f32_16x16x32_bf16 v[168:171], v[40:43], a[68:71], v[168:171]
    ds_read_b64_tr_b16 v[38:39], v9 offset:25600
    v_mfma_f32_16x16x32_bf16 v[200:203], v[40:43], a[72:75], v[200:203]
    v_mfma_f32_16x16x32_bf16 v[232:235], v[40:43], a[76:79], v[232:235]
    v_mfma_f32_16x16x32_bf16 v[140:143], v[44:47], a[64:67], v[140:143]
    s_xor_b32 s80, s76, 8192
    ds_read_b64_tr_b16 v[40:41], v10 offset:24576
    v_mfma_f32_16x16x32_bf16 v[172:175], v[44:47], a[68:71], v[172:175]
    ds_read_b64_tr_b16 v[42:43], v10 offset:25600
    v_mfma_f32_16x16x32_bf16 v[204:207], v[44:47], a[72:75], v[204:207]
    buffer_load_dwordx4 a[152:155], v1, s[8:11], s80 offen offset:1024
    v_mfma_f32_16x16x32_bf16 v[236:239], v[44:47], a[76:79], v[236:239]
    v_mfma_f32_16x16x32_bf16 v[144:147], v[48:51], a[64:67], v[144:147]
    ds_read_b64_tr_b16 v[44:45], v11 offset:24576
    v_mfma_f32_16x16x32_bf16 v[176:179], v[48:51], a[68:71], v[176:179]
    ds_read_b64_tr_b16 v[46:47], v11 offset:25600
    v_mfma_f32_16x16x32_bf16 v[208:211], v[48:51], a[72:75], v[208:211]
    v_mfma_f32_16x16x32_bf16 v[240:243], v[48:51], a[76:79], v[240:243]
    v_mfma_f32_16x16x32_bf16 v[148:151], v[52:55], a[64:67], v[148:151]
    s_xor_b32 s80, s76, 24576
    ds_read_b64_tr_b16 v[48:49], v12 offset:24576
    v_mfma_f32_16x16x32_bf16 v[180:183], v[52:55], a[68:71], v[180:183]
    ds_read_b64_tr_b16 v[50:51], v12 offset:25600
    v_mfma_f32_16x16x32_bf16 v[212:215], v[52:55], a[72:75], v[212:215]
    buffer_load_dwordx4 a[156:159], v1, s[8:11], s80 offen offset:1024
    v_mfma_f32_16x16x32_bf16 v[244:247], v[52:55], a[76:79], v[244:247]
    v_mfma_f32_16x16x32_bf16 v[152:155], v[56:59], a[64:67], v[152:155]
    ds_read_b64_tr_b16 v[52:53], v13 offset:24576
    v_lshlrev_b32 v116, 2, v0
    v_mfma_f32_16x16x32_bf16 v[184:187], v[56:59], a[68:71], v[184:187]
    s_xor_b32 s80, s75, 10240
    ds_read_b64_tr_b16 v[54:55], v13 offset:25600
    v_cmp_gt_u32 vcc, 8, v0
    v_mfma_f32_16x16x32_bf16 v[216:219], v[56:59], a[72:75], v[216:219]
    buffer_load_dwordx4 a[160:163], v1, s[8:11], s80 offen offset:0
    v_mfma_f32_16x16x32_bf16 v[248:251], v[56:59], a[76:79], v[248:251]
    s_waitcnt lgkmcnt(4)
    v_mov_b32 v117, 2147479552
    v_cndmask_b32 v116, v117, v116, vcc
    v_mfma_f32_16x16x32_bf16 v[156:159], v[60:63], a[64:67], v[156:159]
    s_lshl_b32 s70, s2, 5
    s_add_u32 s70, s70, 20480
    ds_read_b64_tr_b16 v[56:57], v14 offset:24576
    v_mfma_f32_16x16x32_bf16 v[188:191], v[60:63], a[68:71], v[188:191]
    ds_read_b64_tr_b16 v[58:59], v14 offset:25600
    v_and_b32 v119, 3, v2
    v_mfma_f32_16x16x32_bf16 v[220:223], v[60:63], a[72:75], v[220:223]
    v_lshlrev_b32 v119, 9, v119
    v_mfma_f32_16x16x32_bf16 v[252:255], v[60:63], a[76:79], v[252:255]
    v_mfma_f32_16x16x32_bf16 v[128:131], v[32:35], a[80:83], v[128:131]
    s_xor_b32 s80, s75, 26624
    s_lshr_b32 s69, s2, 6
    ds_read_b64_tr_b16 v[60:61], v15 offset:24576
    v_mfma_f32_16x16x32_bf16 v[160:163], v[32:35], a[84:87], v[160:163]
    s_add_u32 s69, s69, 4
    s_lshl_b32 s69, s69, 5
    ds_read_b64_tr_b16 v[62:63], v15 offset:25600
    v_mfma_f32_16x16x32_bf16 v[192:195], v[32:35], a[88:91], v[192:195]
    buffer_load_dwordx4 a[164:167], v1, s[8:11], s80 offen offset:0
    v_mfma_f32_16x16x32_bf16 v[224:227], v[32:35], a[92:95], v[224:227]
    s_bfe_u32 s68, s2, 196611
    s_add_u32 s69, s69, s68
    s_lshl_b32 s69, s69, 6
    v_mfma_f32_16x16x32_bf16 v[132:135], v[36:39], a[80:83], v[132:135]
    s_add_u32 s69, s69, 1310720
    s_and_b32 s100, s3, 1
    ds_read_b64_tr_b16 v[32:33], v8 offset:49152
    v_mfma_f32_16x16x32_bf16 v[164:167], v[36:39], a[84:87], v[164:167]
    s_lshr_b32 s101, s3, 1
    s_lshl_b32 s19, s100, 13
    ds_read_b64_tr_b16 v[34:35], v8 offset:50176
    v_mfma_f32_16x16x32_bf16 v[196:199], v[36:39], a[88:91], v[196:199]
    buffer_load_dword v118, v119, s[8:11], s69 offen sc0 sc1
    v_mfma_f32_16x16x32_bf16 v[228:231], v[36:39], a[92:95], v[228:231]
    s_add_u32 s19, s19, 65536
    v_add_u32 v18, s19, v1
    v_mfma_f32_16x16x32_bf16 v[136:139], v[40:43], a[80:83], v[136:139]
    s_xor_b32 s80, s76, 10240
    s_mul_i32 s19, s100, 12288
    ds_read_b64_tr_b16 v[36:37], v9 offset:49152
    v_mfma_f32_16x16x32_bf16 v[168:171], v[40:43], a[84:87], v[168:171]
    s_add_u32 s19, s19, 98304
    ds_read_b64_tr_b16 v[38:39], v9 offset:50176
    v_add_u32 v19, s19, v1
    v_mfma_f32_16x16x32_bf16 v[200:203], v[40:43], a[88:91], v[200:203]
    buffer_load_dwordx4 a[168:171], v1, s[8:11], s80 offen offset:0
    v_mfma_f32_16x16x32_bf16 v[232:235], v[40:43], a[92:95], v[232:235]
    v_mfma_f32_16x16x32_bf16 v[140:143], v[44:47], a[80:83], v[140:143]
    s_lshl_b32 s19, s100, 12
    s_add_u32 s19, s19, 98304
    ds_read_b64_tr_b16 v[40:41], v10 offset:49152
    v_mfma_f32_16x16x32_bf16 v[172:175], v[44:47], a[84:87], v[172:175]
    ds_read_b64_tr_b16 v[42:43], v10 offset:50176
    v_add_u32 v20, s19, v1
    v_mfma_f32_16x16x32_bf16 v[204:207], v[44:47], a[88:91], v[204:207]
    v_and_b32 v23, 15, v2
    v_lshrrev_b32 v24, 4, v2
    v_mfma_f32_16x16x32_bf16 v[236:239], v[44:47], a[92:95], v[236:239]
    s_waitcnt lgkmcnt(4)
    v_mfma_f32_16x16x32_bf16 v[144:147], v[48:51], a[80:83], v[144:147]
    s_xor_b32 s80, s76, 26624
    ds_read_b64_tr_b16 v[44:45], v11 offset:49152
    v_lshlrev_b32 v25, 2, v24
    v_mfma_f32_16x16x32_bf16 v[176:179], v[48:51], a[84:87], v[176:179]
    ds_read_b64_tr_b16 v[46:47], v11 offset:50176
    v_sub_u32 v25, v23, v25
    v_mfma_f32_16x16x32_bf16 v[208:211], v[48:51], a[88:91], v[208:211]
    buffer_load_dwordx4 a[172:175], v1, s[8:11], s80 offen offset:0
    v_mfma_f32_16x16x32_bf16 v[240:243], v[48:51], a[92:95], v[240:243]
    v_mfma_f32_16x16x32_bf16 v[148:151], v[52:55], a[80:83], v[148:151]
    s_sub_i32 s19, s101, s100
    s_lshl_b32 s19, s19, 5
    ds_read_b64_tr_b16 v[48:49], v12 offset:49152
    v_mfma_f32_16x16x32_bf16 v[180:183], v[52:55], a[84:87], v[180:183]
    s_xor_b32 s80, s75, 10240
    ds_read_b64_tr_b16 v[50:51], v12 offset:50176
    v_add_u32 v21, s19, v25
    v_mfma_f32_16x16x32_bf16 v[212:215], v[52:55], a[88:91], v[212:215]
    buffer_load_dwordx4 a[176:179], v1, s[8:11], s80 offen offset:1024
    v_mfma_f32_16x16x32_bf16 v[244:247], v[52:55], a[92:95], v[244:247]
    v_mfma_f32_16x16x32_bf16 v[152:155], v[56:59], a[80:83], v[152:155]
    s_add_u32 s19, s101, s100
    s_sub_i32 s19, 1, s19
    ds_read_b64_tr_b16 v[52:53], v13 offset:49152
    v_mfma_f32_16x16x32_bf16 v[184:187], v[56:59], a[84:87], v[184:187]
    s_lshl_b32 s19, s19, 5
    ds_read_b64_tr_b16 v[54:55], v13 offset:50176
    v_add_u32 v22, s19, v25
    v_mfma_f32_16x16x32_bf16 v[216:219], v[56:59], a[88:91], v[216:219]
    v_cvt_f32_i32 v21, v21
    v_cvt_f32_i32 v22, v22
    v_mfma_f32_16x16x32_bf16 v[248:251], v[56:59], a[92:95], v[248:251]
    v_mfma_f32_16x16x32_bf16 v[156:159], v[60:63], a[80:83], v[156:159]
    s_xor_b32 s80, s75, 26624
    ds_read_b64_tr_b16 v[56:57], v14 offset:49152
    v_add_f32 v21, 0.5, v21
    v_mfma_f32_16x16x32_bf16 v[188:191], v[60:63], a[84:87], v[188:191]
    ds_read_b64_tr_b16 v[58:59], v14 offset:50176
    v_add_f32 v22, 0.5, v22
    v_mfma_f32_16x16x32_bf16 v[220:223], v[60:63], a[88:91], v[220:223]
    buffer_load_dwordx4 a[180:183], v1, s[8:11], s80 offen offset:1024
    v_mfma_f32_16x16x32_bf16 v[252:255], v[60:63], a[92:95], v[252:255]
    v_mul_f32 v21, 0x71800000, v21
    v_mul_f32 v22, 0x71800000, v22
    v_mfma_f32_16x16x32_bf16 v[128:131], v[32:35], a[96:99], v[128:131]
    ds_read_b64_tr_b16 v[60:61], v15 offset:49152
    v_lshrrev_b32 v25, 2, v23
    v_mfma_f32_16x16x32_bf16 v[160:163], v[32:35], a[100:103], v[160:163]
    ds_read_b64_tr_b16 v[62:63], v15 offset:50176
    v_and_b32 v23, 3, v23
    v_mfma_f32_16x16x32_bf16 v[192:195], v[32:35], a[104:107], v[192:195]
    s_waitcnt vmcnt(20)
    v_lshlrev_b32 v23, 6, v23
    v_lshl_add_u32 v23, v25, 15, v23
    v_mfma_f32_16x16x32_bf16 v[224:227], v[32:35], a[108:111], v[224:227]
    s_waitcnt lgkmcnt(4)
    v_mfma_f32_16x16x32_bf16 v[132:135], v[36:39], a[96:99], v[132:135]
    s_xor_b32 s80, s76, 10240
    ds_read_b64_tr_b16 v[32:33], v8 offset:57344
    v_lshl_add_u32 v23, v24, 4, v23
    v_mfma_f32_16x16x32_bf16 v[164:167], v[36:39], a[100:103], v[164:167]
    s_lshl_b32 s18, s6, 20
    s_lshl_b32 s19, s3, 18
    ds_read_b64_tr_b16 v[34:35], v8 offset:58368
    v_mfma_f32_16x16x32_bf16 v[196:199], v[36:39], a[104:107], v[196:199]
    buffer_load_dwordx4 a[184:187], v1, s[8:11], s80 offen offset:1024
    v_mfma_f32_16x16x32_bf16 v[228:231], v[36:39], a[108:111], v[228:231]
    s_add_u32 s18, s18, s19
    s_lshl_b32 s19, s7, 10
    s_add_u32 s18, s18, s19
    v_mfma_f32_16x16x32_bf16 v[136:139], v[40:43], a[96:99], v[136:139]
    s_add_u32 s18, s18, 67108864
    s_mov_b32 s13, s60
    ds_read_b64_tr_b16 v[36:37], v9 offset:57344
    v_mfma_f32_16x16x32_bf16 v[168:171], v[40:43], a[100:103], v[168:171]
    s_mov_b32 s12, 2
    s_mov_b32 s25, 0
    ds_read_b64_tr_b16 v[38:39], v9 offset:58368
    v_mfma_f32_16x16x32_bf16 v[200:203], v[40:43], a[104:107], v[200:203]
    s_mov_b32 s26, 28
    s_mov_b32 s64, 128
    s_lshl_b32 s65, s5, 1
    v_mfma_f32_16x16x32_bf16 v[232:235], v[40:43], a[108:111], v[232:235]
    v_mfma_f32_16x16x32_bf16 v[140:143], v[44:47], a[96:99], v[140:143]
    s_xor_b32 s80, s76, 26624
    s_and_b32 s65, s65, 7
    ds_read_b64_tr_b16 v[40:41], v10 offset:57344
    v_mfma_f32_16x16x32_bf16 v[172:175], v[44:47], a[100:103], v[172:175]
    s_xor_b32 s65, s65, s3
    s_lshl_b32 s65, s65, 16
    ds_read_b64_tr_b16 v[42:43], v10 offset:58368
    v_mfma_f32_16x16x32_bf16 v[204:207], v[44:47], a[104:107], v[204:207]
    buffer_load_dwordx4 a[188:191], v1, s[8:11], s80 offen offset:1024
    v_mfma_f32_16x16x32_bf16 v[236:239], v[44:47], a[108:111], v[236:239]
    s_add_u32 s15, s62, 65536
    s_add_u32 s16, s62, 0
    s_lshl_b32 s20, s7, 13
    v_mfma_f32_16x16x32_bf16 v[144:147], v[48:51], a[96:99], v[144:147]
    s_lshl_b32 s19, s100, 11
    s_add_u32 s20, s20, s19
    ds_read_b64_tr_b16 v[44:45], v11 offset:57344
    v_mfma_f32_16x16x32_bf16 v[176:179], v[48:51], a[100:103], v[176:179]
    s_xor_b32 s80, s75, 12288
    s_add_u32 s20, s20, 50331648
    ds_read_b64_tr_b16 v[46:47], v11 offset:58368
    v_mfma_f32_16x16x32_bf16 v[208:211], v[48:51], a[104:107], v[208:211]
    buffer_load_dwordx4 a[192:195], v1, s[8:11], s80 offen offset:0
    v_mfma_f32_16x16x32_bf16 v[240:243], v[48:51], a[108:111], v[240:243]
    s_sub_u32 s19, 3, s101
    s_lshl_b32 s19, s19, 18
    s_add_u32 s21, s20, s19
    v_mfma_f32_16x16x32_bf16 v[148:151], v[52:55], a[96:99], v[148:151]
    s_lshl_b32 s19, s101, 18
    s_add_u32 s20, s20, s19
    ds_read_b64_tr_b16 v[48:49], v12 offset:57344
    v_mfma_f32_16x16x32_bf16 v[180:183], v[52:55], a[100:103], v[180:183]
    s_add_u32 s22, s72, 131072
    s_and_b32 s23, s2, 231
    ds_read_b64_tr_b16 v[50:51], v12 offset:58368
    v_mfma_f32_16x16x32_bf16 v[212:215], v[52:55], a[104:107], v[212:215]
    s_lshl_b32 s23, s23, 8
    s_sub_u32 s19, 3, s3
    s_min_u32 s19, s19, s3
    v_mfma_f32_16x16x32_bf16 v[244:247], v[52:55], a[108:111], v[244:247]
    s_waitcnt lgkmcnt(4)
    v_mfma_f32_16x16x32_bf16 v[152:155], v[56:59], a[96:99], v[152:155]
    s_xor_b32 s80, s75, 28672
    s_lshl_b32 s19, s19, 7
    ds_read_b64_tr_b16 v[52:53], v13 offset:57344
    s_waitcnt vmcnt(7)
    v_cmp_ne_u32 vcc, 0, v118
    s_cmp_eq_u64 vcc, -1
    s_cbranch_scc0 L_E2_slow_5
L_E2_ok_6:
    v_mfma_f32_16x16x32_bf16 v[184:187], v[56:59], a[100:103], v[184:187]
    s_add_u32 s23, s23, s19
    s_add_u32 s23, s23, 1179648
    ds_read_b64_tr_b16 v[54:55], v13 offset:58368
    v_mfma_f32_16x16x32_bf16 v[216:219], v[56:59], a[104:107], v[216:219]
    buffer_load_dwordx4 a[196:199], v1, s[8:11], s80 offen offset:0
    v_mfma_f32_16x16x32_bf16 v[248:251], v[56:59], a[108:111], v[248:251]
    buffer_load_dword v112, v116, s[8:11], s70 offen
    v_mfma_f32_16x16x32_bf16 v[156:159], v[60:63], a[96:99], v[156:159]
    s_add_u32 s70, s70, 12288
    s_lshl_b32 s71, s2, 2
    ds_read_b64_tr_b16 v[56:57], v14 offset:57344
    v_mfma_f32_16x16x32_bf16 v[188:191], v[60:63], a[100:103], v[188:191]
    s_add_u32 s71, s71, s3
    s_and_b32 s100, s71, 31
    ds_read_b64_tr_b16 v[58:59], v14 offset:58368
    v_mfma_f32_16x16x32_bf16 v[220:223], v[60:63], a[104:107], v[220:223]
    buffer_load_dword v113, v116, s[8:11], s70 offen
    v_mfma_f32_16x16x32_bf16 v[252:255], v[60:63], a[108:111], v[252:255]
    s_lshr_b32 s101, s71, 5
    s_sub_u32 s101, s101, 4
    s_and_b32 s101, s101, 31
    v_mfma_f32_16x16x32_bf16 v[128:131], v[32:35], a[112:115], v[128:131]
    s_xor_b32 s80, s76, 12288
    s_add_u32 s70, s70, 12288
    ds_read_b64_tr_b16 v[60:61], v15 offset:57344
    v_mfma_f32_16x16x32_bf16 v[160:163], v[32:35], a[116:119], v[160:163]
    ds_read_b64_tr_b16 v[62:63], v15 offset:58368
    v_and_b32 v121, 7, v2
    v_mfma_f32_16x16x32_bf16 v[192:195], v[32:35], a[120:123], v[192:195]
    buffer_load_dwordx4 a[200:203], v1, s[8:11], s80 offen offset:0
    v_mfma_f32_16x16x32_bf16 v[224:227], v[32:35], a[124:127], v[224:227]
    buffer_load_dword v114, v116, s[8:11], s70 offen
    v_mfma_f32_16x16x32_bf16 v[132:135], v[36:39], a[112:115], v[132:135]
    s_add_u32 s70, s70, 12288
    v_and_b32 v120, 4, v121
    v_and_b32 v122, 2, v121
    v_mfma_f32_16x16x32_bf16 v[164:167], v[36:39], a[116:119], v[164:167]
    buffer_load_dword v115, v116, s[8:11], s70 offen
    v_mfma_f32_16x16x32_bf16 v[196:199], v[36:39], a[120:123], v[196:199]
    s_add_u32 s70, s70, 12288
    v_lshl_add_u32 v120, v122, 3, v120
    v_and_b32 v122, 1, v121
    v_mfma_f32_16x16x32_bf16 v[228:231], v[36:39], a[124:127], v[228:231]
    v_lshl_add_u32 v120, v122, 1, v120
    v_mul_u32_u24 v120, 3584, v120
    v_mfma_f32_16x16x32_bf16 v[136:139], v[40:43], a[112:115], v[136:139]
    s_xor_b32 s80, s76, 28672
    v_subrev_u32 v8, 98304, v8
    v_subrev_u32 v9, 98304, v9
    s_waitcnt lgkmcnt(0)
    s_barrier
    v_mfma_f32_16x16x32_bf16 v[168:171], v[40:43], a[116:119], v[168:171]
    ds_read_b64_tr_b16 v[32:33], v8 offset:0
    v_lshrrev_b32 v122, 3, v2
    v_mfma_f32_16x16x32_bf16 v[200:203], v[40:43], a[120:123], v[200:203]
    ds_read_b64_tr_b16 v[34:35], v8 offset:1024
    v_lshl_add_u32 v120, v122, 4, v120
    v_mfma_f32_16x16x32_bf16 v[232:235], v[40:43], a[124:127], v[232:235]
    ds_read_b64_tr_b16 v[36:37], v9 offset:0
    v_subrev_u32 v10, 98304, v10
    v_mfma_f32_16x16x32_bf16 v[140:143], v[44:47], a[112:115], v[140:143]
    ds_read_b64_tr_b16 v[38:39], v9 offset:1024
    v_lshlrev_b32 v121, 13, v121
    v_mfma_f32_16x16x32_bf16 v[172:175], v[44:47], a[116:119], v[172:175]
    ds_read_b64_tr_b16 v[40:41], v10 offset:0
    v_lshl_add_u32 v121, v122, 4, v121
    v_mfma_f32_16x16x32_bf16 v[204:207], v[44:47], a[120:123], v[204:207]
    s_lshr_b32 s71, s100, 1
    s_lshl_b32 s71, s71, 2
    ds_read_b64_tr_b16 v[42:43], v10 offset:1024
    v_mfma_f32_16x16x32_bf16 v[236:239], v[44:47], a[124:127], v[236:239]
    s_and_b32 s100, s100, 1
    s_add_u32 s71, s71, s100
    v_subrev_u32 v11, 98304, v11
    v_mfma_f32_16x16x32_bf16 v[144:147], v[48:51], a[112:115], v[144:147]
    s_mul_i32 s71, s71, 28672
    s_lshl_b32 s100, s101, 7
    ds_read_b64_tr_b16 v[44:45], v11 offset:0
    v_mfma_f32_16x16x32_bf16 v[176:179], v[48:51], a[116:119], v[176:179]
    s_add_u32 s71, s71, s100
    s_cmp_lt_u32 s101, 28
    s_cselect_b32 s71, s71, 2147479552
    ds_read_b64_tr_b16 v[46:47], v11 offset:1024
    v_mfma_f32_16x16x32_bf16 v[208:211], v[48:51], a[120:123], v[208:211]
    buffer_load_dwordx4 a[204:207], v1, s[8:11], s80 offen offset:0
    v_mfma_f32_16x16x32_bf16 v[240:243], v[48:51], a[124:127], v[240:243]
    s_xor_b32 s80, s75, 12288
    v_subrev_u32 v12, 98304, v12
    v_mfma_f32_16x16x32_bf16 v[148:151], v[52:55], a[112:115], v[148:151]
    ds_read_b64_tr_b16 v[48:49], v12 offset:0
    v_mfma_f32_16x16x32_bf16 v[180:183], v[52:55], a[116:119], v[180:183]
    ds_read_b64_tr_b16 v[50:51], v12 offset:1024
    v_mfma_f32_16x16x32_bf16 v[212:215], v[52:55], a[120:123], v[212:215]
    buffer_load_dwordx4 a[208:211], v1, s[8:11], s80 offen offset:1024
    v_mfma_f32_16x16x32_bf16 v[244:247], v[52:55], a[124:127], v[244:247]
    s_xor_b32 s80, s75, 28672
    v_subrev_u32 v13, 98304, v13
    v_mfma_f32_16x16x32_bf16 v[152:155], v[56:59], a[112:115], v[152:155]
    ds_read_b64_tr_b16 v[52:53], v13 offset:0
    v_mfma_f32_16x16x32_bf16 v[184:187], v[56:59], a[116:119], v[184:187]
    ds_read_b64_tr_b16 v[54:55], v13 offset:1024
    v_mfma_f32_16x16x32_bf16 v[216:219], v[56:59], a[120:123], v[216:219]
    buffer_load_dwordx4 a[212:215], v1, s[8:11], s80 offen offset:1024
    v_mfma_f32_16x16x32_bf16 v[248:251], v[56:59], a[124:127], v[248:251]
    s_xor_b32 s80, s76, 12288
    v_subrev_u32 v14, 98304, v14
    v_mfma_f32_16x16x32_bf16 v[156:159], v[60:63], a[112:115], v[156:159]
    ds_read_b64_tr_b16 v[56:57], v14 offset:0
    v_mfma_f32_16x16x32_bf16 v[188:191], v[60:63], a[116:119], v[188:191]
    ds_read_b64_tr_b16 v[58:59], v14 offset:1024
    v_mfma_f32_16x16x32_bf16 v[220:223], v[60:63], a[120:123], v[220:223]
    buffer_load_dwordx4 a[216:219], v1, s[8:11], s80 offen offset:1024
    v_mfma_f32_16x16x32_bf16 v[252:255], v[60:63], a[124:127], v[252:255]
    s_waitcnt lgkmcnt(4)
    v_subrev_u32 v15, 98304, v15
    v_mfma_f32_16x16x32_bf16 v[128:131], v[32:35], a[128:131], v[128:131]
    ds_read_b64_tr_b16 v[60:61], v15 offset:0
    v_mfma_f32_16x16x32_bf16 v[160:163], v[32:35], a[132:135], v[160:163]
    ds_read_b64_tr_b16 v[62:63], v15 offset:1024
    v_mfma_f32_16x16x32_bf16 v[192:195], v[32:35], a[136:139], v[192:195]
    buffer_load_dword v3, v17, s[8:11], s74 offen sc0 sc1
    v_mfma_f32_16x16x32_bf16 v[224:227], v[32:35], a[140:143], v[224:227]
    v_mfma_f32_16x16x32_bf16 v[132:135], v[36:39], a[128:131], v[132:135]
    s_xor_b32 s80, s76, 28672
    ds_read_b64_tr_b16 v[32:33], v8 offset:8192
    v_mfma_f32_16x16x32_bf16 v[164:167], v[36:39], a[132:135], v[164:167]
    ds_read_b64_tr_b16 v[34:35], v8 offset:9216
    v_mfma_f32_16x16x32_bf16 v[196:199], v[36:39], a[136:139], v[196:199]
    buffer_load_dwordx4 a[220:223], v1, s[8:11], s80 offen offset:1024
    v_mfma_f32_16x16x32_bf16 v[228:231], v[36:39], a[140:143], v[228:231]
    v_mfma_f32_16x16x32_bf16 v[136:139], v[40:43], a[128:131], v[136:139]
    ds_read_b64_tr_b16 v[36:37], v9 offset:8192
    v_mfma_f32_16x16x32_bf16 v[168:171], v[40:43], a[132:135], v[168:171]
    s_xor_b32 s80, s75, 14336
    ds_read_b64_tr_b16 v[38:39], v9 offset:9216
    v_mfma_f32_16x16x32_bf16 v[200:203], v[40:43], a[136:139], v[200:203]
    buffer_load_dwordx4 a[224:227], v1, s[8:11], s80 offen offset:0
    v_mfma_f32_16x16x32_bf16 v[232:235], v[40:43], a[140:143], v[232:235]
    v_mfma_f32_16x16x32_bf16 v[140:143], v[44:47], a[128:131], v[140:143]
    ds_read_b64_tr_b16 v[40:41], v10 offset:8192
    v_mfma_f32_16x16x32_bf16 v[172:175], v[44:47], a[132:135], v[172:175]
    ds_read_b64_tr_b16 v[42:43], v10 offset:9216
    v_mfma_f32_16x16x32_bf16 v[204:207], v[44:47], a[136:139], v[204:207]
    v_mfma_f32_16x16x32_bf16 v[236:239], v[44:47], a[140:143], v[236:239]
    v_mfma_f32_16x16x32_bf16 v[144:147], v[48:51], a[128:131], v[144:147]
    s_xor_b32 s80, s75, 30720
    ds_read_b64_tr_b16 v[44:45], v11 offset:8192
    v_mfma_f32_16x16x32_bf16 v[176:179], v[48:51], a[132:135], v[176:179]
    ds_read_b64_tr_b16 v[46:47], v11 offset:9216
    v_mfma_f32_16x16x32_bf16 v[208:211], v[48:51], a[136:139], v[208:211]
    buffer_load_dwordx4 a[228:231], v1, s[8:11], s80 offen offset:0
    v_mfma_f32_16x16x32_bf16 v[240:243], v[48:51], a[140:143], v[240:243]
    s_waitcnt lgkmcnt(4)
    v_mfma_f32_16x16x32_bf16 v[148:151], v[52:55], a[128:131], v[148:151]
    ds_read_b64_tr_b16 v[48:49], v12 offset:8192
    v_mfma_f32_16x16x32_bf16 v[180:183], v[52:55], a[132:135], v[180:183]
    ds_read_b64_tr_b16 v[50:51], v12 offset:9216
    v_mfma_f32_16x16x32_bf16 v[212:215], v[52:55], a[136:139], v[212:215]
    v_mfma_f32_16x16x32_bf16 v[244:247], v[52:55], a[140:143], v[244:247]
    v_mfma_f32_16x16x32_bf16 v[152:155], v[56:59], a[128:131], v[152:155]
    s_xor_b32 s80, s76, 14336
    ds_read_b64_tr_b16 v[52:53], v13 offset:8192
    v_mfma_f32_16x16x32_bf16 v[184:187], v[56:59], a[132:135], v[184:187]
    ds_read_b64_tr_b16 v[54:55], v13 offset:9216
    v_mfma_f32_16x16x32_bf16 v[216:219], v[56:59], a[136:139], v[216:219]
    buffer_load_dwordx4 a[232:235], v1, s[8:11], s80 offen offset:0
    s_waitcnt vmcnt(4)
    v_cmp_ne_u32 vcc, 0, v3
    s_cmp_eq_u64 vcc, -1
    s_cbranch_scc0 L_KV_slow_7
L_KV_ok_8:
    v_mfma_f32_16x16x32_bf16 v[248:251], v[56:59], a[140:143], v[248:251]
    v_mfma_f32_16x16x32_bf16 v[156:159], v[60:63], a[128:131], v[156:159]
    s_add_u32 m0, s62, 65536
    s_add_u32 s98, s81, 0
    ds_read_b64_tr_b16 v[56:57], v14 offset:8192
    v_mfma_f32_16x16x32_bf16 v[188:191], v[60:63], a[132:135], v[188:191]
    ds_read_b64_tr_b16 v[58:59], v14 offset:9216
    v_add_u32 v16, s62, v1
    v_mfma_f32_16x16x32_bf16 v[220:223], v[60:63], a[136:139], v[220:223]
    buffer_load_dwordx4 v1, s[8:11], s98 offen offset:0  lds
    v_mfma_f32_16x16x32_bf16 v[252:255], v[60:63], a[140:143], v[252:255]
    v_and_b32 v17, 4294959103, v16
    v_mov_b32 v24, -1
    v_mfma_f32_16x16x32_bf16 v[128:131], v[32:35], a[144:147], v[128:131]
    s_xor_b32 s80, s76, 30720
    ds_read_b64_tr_b16 v[60:61], v15 offset:8192
    v_mov_b32 v28, 0x3f803f80
    v_mfma_f32_16x16x32_bf16 v[160:163], v[32:35], a[148:151], v[160:163]
    ds_read_b64_tr_b16 v[62:63], v15 offset:9216
    v_mov_b32 v25, -1
    v_mfma_f32_16x16x32_bf16 v[192:195], v[32:35], a[152:155], v[192:195]
    buffer_load_dwordx4 a[236:239], v1, s[8:11], s80 offen offset:0
    v_mfma_f32_16x16x32_bf16 v[224:227], v[32:35], a[156:159], v[224:227]
    buffer_load_dwordx4 v1, s[8:11], s98 offen offset:1024  lds
    v_mfma_f32_16x16x32_bf16 v[132:135], v[36:39], a[144:147], v[132:135]
    ds_read_b64_tr_b16 v[32:33], v8 offset:16384
    v_add_f32 v112, v112, v113
    v_mfma_f32_16x16x32_bf16 v[164:167], v[36:39], a[148:151], v[164:167]
    s_xor_b32 s80, s75, 14336
    ds_read_b64_tr_b16 v[34:35], v8 offset:17408
    v_add_f32 v114, v114, v115
    v_mfma_f32_16x16x32_bf16 v[196:199], v[36:39], a[152:155], v[196:199]
    buffer_load_dwordx4 a[240:243], v1, s[8:11], s80 offen offset:1024
    v_mfma_f32_16x16x32_bf16 v[228:231], v[36:39], a[156:159], v[228:231]
    s_waitcnt lgkmcnt(4)
    ds_read_b64_tr_b16 a[24:25], v8 offset:49152
    v_add_f32 v112, v112, v114
    v_mfma_f32_16x16x32_bf16 v[136:139], v[40:43], a[144:147], v[136:139]
    ds_read_b64_tr_b16 v[36:37], v9 offset:16384
    v_cvt_pk_bf16_f32 v112, v112, v112
    v_mfma_f32_16x16x32_bf16 v[168:171], v[40:43], a[148:151], v[168:171]
    ds_read_b64_tr_b16 v[38:39], v9 offset:17408
    v_and_b32 v112, 0xffff0000, v112
    v_mfma_f32_16x16x32_bf16 v[200:203], v[40:43], a[152:155], v[200:203]
    s_lshr_b32 s70, s2, 6
    s_cmp_eq_u32 s70, 2
    s_cselect_b32 s70, 1.0, 0
    ds_read_b64_tr_b16 a[26:27], v8 offset:50176
    v_mfma_f32_16x16x32_bf16 v[232:235], v[40:43], a[156:159], v[232:235]
    buffer_load_dwordx4 v1, s[8:11], s98 offen offset:2048  lds
    v_mfma_f32_16x16x32_bf16 v[140:143], v[44:47], a[144:147], v[140:143]
    s_xor_b32 s80, s75, 30720
    ds_read_b64_tr_b16 v[40:41], v10 offset:16384
    v_add_f32 v112, s70, v112
    v_mfma_f32_16x16x32_bf16 v[172:175], v[44:47], a[148:151], v[172:175]
    ds_read_b64_tr_b16 v[42:43], v10 offset:17408
    v_cvt_pk_bf16_f32 v112, v112, v112
    v_mfma_f32_16x16x32_bf16 v[204:207], v[44:47], a[152:155], v[204:207]
    ds_read_b64_tr_b16 a[28:29], v9 offset:49152
    v_and_b32 v112, 0xffff0000, v112
    v_mfma_f32_16x16x32_bf16 v[236:239], v[44:47], a[156:159], v[236:239]
    buffer_load_dwordx4 a[244:247], v1, s[8:11], s80 offen offset:1024
    v_mfma_f32_16x16x32_bf16 v[144:147], v[48:51], a[144:147], v[144:147]
    s_lshl_b32 s70, s2, 5
    s_add_u32 s70, s70, 4096
    ds_read_b64_tr_b16 v[44:45], v11 offset:16384
    v_mfma_f32_16x16x32_bf16 v[176:179], v[48:51], a[148:151], v[176:179]
    ds_read_b64_tr_b16 v[46:47], v11 offset:17408
    v_mov_b32 v29, 0x3f803f80
    v_mfma_f32_16x16x32_bf16 v[208:211], v[48:51], a[152:155], v[208:211]
    ds_read_b64_tr_b16 a[30:31], v9 offset:50176
    v_mov_b32 v26, -1
    v_mfma_f32_16x16x32_bf16 v[240:243], v[48:51], a[156:159], v[240:243]
    buffer_store_dword v112, v116, s[8:11], s70 offen sc0 sc1
    v_mfma_f32_16x16x32_bf16 v[148:151], v[52:55], a[144:147], v[148:151]
    s_xor_b32 s80, s76, 14336
    ds_read_b64_tr_b16 v[48:49], v12 offset:16384
    v_mov_b32 v30, 0x3f803f80
    v_mfma_f32_16x16x32_bf16 v[180:183], v[52:55], a[148:151], v[180:183]
    ds_read_b64_tr_b16 v[50:51], v12 offset:17408
    v_mov_b32 v27, -1
    v_mfma_f32_16x16x32_bf16 v[212:215], v[52:55], a[152:155], v[212:215]
    ds_read_b64_tr_b16 a[32:33], v10 offset:49152
    v_mov_b32 v31, 0x3f803f80
    v_mfma_f32_16x16x32_bf16 v[244:247], v[52:55], a[156:159], v[244:247]
    buffer_load_dwordx4 a[248:251], v1, s[8:11], s80 offen offset:1024
    v_mfma_f32_16x16x32_bf16 v[152:155], v[56:59], a[144:147], v[152:155]
    ds_read_b64_tr_b16 v[52:53], v13 offset:16384
    v_mov_b32 v64, 0
    v_mfma_f32_16x16x32_bf16 v[184:187], v[56:59], a[148:151], v[184:187]
    ds_read_b64_tr_b16 v[54:55], v13 offset:17408
    v_mov_b32 v65, 0
    v_mfma_f32_16x16x32_bf16 v[216:219], v[56:59], a[152:155], v[216:219]
    s_waitcnt lgkmcnt(7)
    s_xor_b32 s80, s76, 30720
    ds_read_b64_tr_b16 a[34:35], v10 offset:50176
    v_mov_b32 v66, 0
    v_mfma_f32_16x16x32_bf16 v[248:251], v[56:59], a[156:159], v[248:251]
    buffer_load_dwordx4 a[252:255], v1, s[8:11], s80 offen offset:1024
    v_mfma_f32_16x16x32_bf16 v[156:159], v[60:63], a[144:147], v[156:159]
    ds_read_b64_tr_b16 v[56:57], v14 offset:16384
    v_mov_b32 v67, 0
    v_mfma_f32_16x16x32_bf16 v[188:191], v[60:63], a[148:151], v[188:191]
    ds_read_b64_tr_b16 v[58:59], v14 offset:17408
    v_mov_b32 v68, 0
    v_mfma_f32_16x16x32_bf16 v[220:223], v[60:63], a[152:155], v[220:223]
    ds_read_b64_tr_b16 a[36:37], v11 offset:49152
    v_mov_b32 v69, 0
    v_mfma_f32_16x16x32_bf16 v[252:255], v[60:63], a[156:159], v[252:255]
    buffer_load_dwordx4 v1, s[8:11], s98 offen offset:3072  lds
    v_mfma_f32_16x16x32_bf16 v[128:131], v[32:35], a[160:163], v[128:131]
    s_add_u32 m0, s62, 69632
    s_add_u32 s98, s81, 4096
    ds_read_b64_tr_b16 v[60:61], v15 offset:16384
    v_mfma_f32_16x16x32_bf16 v[160:163], v[32:35], a[164:167], v[160:163]
    ds_read_b64_tr_b16 v[62:63], v15 offset:17408
    v_mov_b32 v70, 0
    v_mfma_f32_16x16x32_bf16 v[192:195], v[32:35], a[168:171], v[192:195]
    ds_read_b64_tr_b16 a[38:39], v11 offset:50176
    v_mov_b32 v71, 0
    v_mfma_f32_16x16x32_bf16 v[224:227], v[32:35], a[172:175], v[224:227]
    buffer_load_dwordx4 v1, s[8:11], s98 offen offset:0  lds
    v_mfma_f32_16x16x32_bf16 v[132:135], v[36:39], a[160:163], v[132:135]
    ds_read_b64_tr_b16 v[32:33], v8 offset:24576
    v_mov_b32 v72, 0
    v_mfma_f32_16x16x32_bf16 v[164:167], v[36:39], a[164:167], v[164:167]
    ds_read_b64_tr_b16 v[34:35], v8 offset:25600
    v_mov_b32 v73, 0
    v_mfma_f32_16x16x32_bf16 v[196:199], v[36:39], a[168:171], v[196:199]
    ds_read_b64_tr_b16 a[40:41], v12 offset:49152
    v_mov_b32 v74, 0
    v_mfma_f32_16x16x32_bf16 v[228:231], v[36:39], a[172:175], v[228:231]
    buffer_load_dwordx4 v1, s[8:11], s98 offen offset:1024  lds
    v_mfma_f32_16x16x32_bf16 v[136:139], v[40:43], a[160:163], v[136:139]
    ds_read_b64_tr_b16 v[36:37], v9 offset:24576
    v_mov_b32 v75, 0
    v_mfma_f32_16x16x32_bf16 v[168:171], v[40:43], a[164:167], v[168:171]
    ds_read_b64_tr_b16 v[38:39], v9 offset:25600
    v_mov_b32 v76, 0
    v_mfma_f32_16x16x32_bf16 v[200:203], v[40:43], a[168:171], v[200:203]
    s_waitcnt lgkmcnt(7)
    ds_read_b64_tr_b16 a[42:43], v12 offset:50176
    v_mov_b32 v77, 0
    v_mfma_f32_16x16x32_bf16 v[232:235], v[40:43], a[172:175], v[232:235]
    buffer_load_dwordx4 v1, s[8:11], s98 offen offset:2048  lds
    v_mfma_f32_16x16x32_bf16 v[140:143], v[44:47], a[160:163], v[140:143]
    ds_read_b64_tr_b16 v[40:41], v10 offset:24576
    v_mov_b32 v78, 0
    v_mfma_f32_16x16x32_bf16 v[172:175], v[44:47], a[164:167], v[172:175]
    ds_read_b64_tr_b16 v[42:43], v10 offset:25600
    v_mov_b32 v79, 0
    v_mfma_f32_16x16x32_bf16 v[204:207], v[44:47], a[168:171], v[204:207]
    s_cmp_eq_u32 s60, 0
    s_cselect_b32 s19, 0, 0x76800000
    ds_read_b64_tr_b16 a[44:45], v13 offset:49152
    v_add_f32 v3, s19, v21
    v_mfma_f32_16x16x32_bf16 v[236:239], v[44:47], a[172:175], v[236:239]
    buffer_load_dwordx4 v1, s[8:11], s98 offen offset:3072  lds
    v_mfma_f32_16x16x32_bf16 v[144:147], v[48:51], a[160:163], v[144:147]
    s_add_u32 m0, s62, 98304
    s_add_u32 s98, s81, 32768
    ds_read_b64_tr_b16 v[44:45], v11 offset:24576
    v_mfma_f32_16x16x32_bf16 v[176:179], v[48:51], a[164:167], v[176:179]
    ds_read_b64_tr_b16 v[46:47], v11 offset:25600
    v_add_f32 v96, 0, v3
    v_mfma_f32_16x16x32_bf16 v[208:211], v[48:51], a[168:171], v[208:211]
    ds_read_b64_tr_b16 a[46:47], v13 offset:50176
    v_min_f32 v96, v96, v64
    v_mfma_f32_16x16x32_bf16 v[240:243], v[48:51], a[172:175], v[240:243]
    buffer_load_dwordx4 v1, s[8:11], s98 offen offset:0  lds
    v_mfma_f32_16x16x32_bf16 v[148:151], v[52:55], a[160:163], v[148:151]
    ds_read_b64_tr_b16 v[48:49], v12 offset:24576
    v_add_f32 v97, 0xf1800000, v3
    v_mfma_f32_16x16x32_bf16 v[180:183], v[52:55], a[164:167], v[180:183]
    ds_read_b64_tr_b16 v[50:51], v12 offset:25600
    v_min_f32 v97, v97, v65
    v_mfma_f32_16x16x32_bf16 v[212:215], v[52:55], a[168:171], v[212:215]
    ds_read_b64_tr_b16 a[48:49], v14 offset:49152
    v_add_f32 v98, 0xf2000000, v3
    v_mfma_f32_16x16x32_bf16 v[244:247], v[52:55], a[172:175], v[244:247]
    buffer_load_dwordx4 v1, s[8:11], s98 offen offset:1024  lds
    v_mfma_f32_16x16x32_bf16 v[152:155], v[56:59], a[160:163], v[152:155]
    ds_read_b64_tr_b16 v[52:53], v13 offset:24576
    v_min_f32 v98, v98, v66
    v_mfma_f32_16x16x32_bf16 v[184:187], v[56:59], a[164:167], v[184:187]
    ds_read_b64_tr_b16 v[54:55], v13 offset:25600
    v_add_f32 v99, 0xf2400000, v3
    v_mfma_f32_16x16x32_bf16 v[216:219], v[56:59], a[168:171], v[216:219]
    s_waitcnt lgkmcnt(7)
    ds_read_b64_tr_b16 a[50:51], v14 offset:50176
    v_min_f32 v99, v99, v67
    v_mfma_f32_16x16x32_bf16 v[248:251], v[56:59], a[172:175], v[248:251]
    buffer_load_dwordx4 v1, s[8:11], s98 offen offset:2048  lds
    v_mfma_f32_16x16x32_bf16 v[156:159], v[60:63], a[160:163], v[156:159]
    ds_read_b64_tr_b16 v[56:57], v14 offset:24576
    v_add_f32 v100, 0xf3800000, v3
    v_mfma_f32_16x16x32_bf16 v[188:191], v[60:63], a[164:167], v[188:191]
    ds_read_b64_tr_b16 v[58:59], v14 offset:25600
    v_min_f32 v100, v100, v64
    v_mfma_f32_16x16x32_bf16 v[220:223], v[60:63], a[168:171], v[220:223]
    ds_read_b64_tr_b16 a[52:53], v15 offset:49152
    v_add_f32 v101, 0xf3880000, v3
    v_mfma_f32_16x16x32_bf16 v[252:255], v[60:63], a[172:175], v[252:255]
    buffer_load_dwordx4 v1, s[8:11], s98 offen offset:3072  lds
    v_mfma_f32_16x16x32_bf16 v[128:131], v[32:35], a[176:179], v[128:131]
    s_add_u32 m0, s62, 102400
    s_add_u32 s98, s81, 36864
    ds_read_b64_tr_b16 v[60:61], v15 offset:24576
    v_mfma_f32_16x16x32_bf16 v[160:163], v[32:35], a[180:183], v[160:163]
    ds_read_b64_tr_b16 v[62:63], v15 offset:25600
    v_min_f32 v101, v101, v65
    v_mfma_f32_16x16x32_bf16 v[192:195], v[32:35], a[184:187], v[192:195]
    ds_read_b64_tr_b16 a[54:55], v15 offset:50176
    v_add_f32 v102, 0xf3900000, v3
    v_mfma_f32_16x16x32_bf16 v[224:227], v[32:35], a[188:191], v[224:227]
    buffer_load_dwordx4 v1, s[8:11], s98 offen offset:0  lds
    v_mfma_f32_16x16x32_bf16 v[132:135], v[36:39], a[176:179], v[132:135]
    ds_read_b64_tr_b16 v[32:33], v8 offset:32768
    v_min_f32 v102, v102, v66
    v_mfma_f32_16x16x32_bf16 v[164:167], v[36:39], a[180:183], v[164:167]
    ds_read_b64_tr_b16 v[34:35], v8 offset:33792
    v_add_f32 v103, 0xf3980000, v3
    v_mfma_f32_16x16x32_bf16 v[196:199], v[36:39], a[184:187], v[196:199]
    ds_read_b64_tr_b16 a[64:65], v8 offset:57344
    v_min_f32 v103, v103, v67
    v_mfma_f32_16x16x32_bf16 v[228:231], v[36:39], a[188:191], v[228:231]
    buffer_load_dwordx4 v1, s[8:11], s98 offen offset:1024  lds
    v_mfma_f32_16x16x32_bf16 v[136:139], v[40:43], a[176:179], v[136:139]
    ds_read_b64_tr_b16 v[36:37], v9 offset:32768
    v_add_f32 v104, 0x73800000, v3
    v_mfma_f32_16x16x32_bf16 v[168:171], v[40:43], a[180:183], v[168:171]
    ds_read_b64_tr_b16 v[38:39], v9 offset:33792
    v_min_f32 v104, v104, v68
    v_mfma_f32_16x16x32_bf16 v[200:203], v[40:43], a[184:187], v[200:203]
    s_waitcnt lgkmcnt(7)
    ds_read_b64_tr_b16 a[66:67], v8 offset:58368
    v_add_f32 v105, 0x73700000, v3
    v_mfma_f32_16x16x32_bf16 v[232:235], v[40:43], a[188:191], v[232:235]
    buffer_load_dwordx4 v1, s[8:11], s98 offen offset:2048  lds
    v_mfma_f32_16x16x32_bf16 v[140:143], v[44:47], a[176:179], v[140:143]
    ds_read_b64_tr_b16 v[40:41], v10 offset:32768
    v_min_f32 v105, v105, v69
    v_mfma_f32_16x16x32_bf16 v[172:175], v[44:47], a[180:183], v[172:175]
    ds_read_b64_tr_b16 v[42:43], v10 offset:33792
    v_add_f32 v106, 0x73600000, v3
    v_mfma_f32_16x16x32_bf16 v[204:207], v[44:47], a[184:187], v[204:207]
    ds_read_b64_tr_b16 a[68:69], v9 offset:57344
    v_min_f32 v106, v106, v70
    v_mfma_f32_16x16x32_bf16 v[236:239], v[44:47], a[188:191], v[236:239]
    buffer_load_dwordx4 v1, s[8:11], s98 offen offset:3072  lds
    v_mfma_f32_16x16x32_bf16 v[144:147], v[48:51], a[176:179], v[144:147]
    s_add_u32 m0, s62, 131072
    s_add_u32 s98, s82, 0
    ds_read_b64_tr_b16 v[44:45], v11 offset:32768
    v_mfma_f32_16x16x32_bf16 v[176:179], v[48:51], a[180:183], v[176:179]
    ds_read_b64_tr_b16 v[46:47], v11 offset:33792
    v_add_f32 v107, 0x73500000, v3
    v_mfma_f32_16x16x32_bf16 v[208:211], v[48:51], a[184:187], v[208:211]
    ds_read_b64_tr_b16 a[70:71], v9 offset:58368
    v_min_f32 v107, v107, v71
    v_mfma_f32_16x16x32_bf16 v[240:243], v[48:51], a[188:191], v[240:243]
    buffer_load_dwordx4 v1, s[8:11], s98 offen offset:0  lds
    v_mfma_f32_16x16x32_bf16 v[148:151], v[52:55], a[176:179], v[148:151]
    ds_read_b64_tr_b16 v[48:49], v12 offset:32768
    v_add_f32 v108, 0, v3
    v_mfma_f32_16x16x32_bf16 v[180:183], v[52:55], a[180:183], v[180:183]
    ds_read_b64_tr_b16 v[50:51], v12 offset:33792
    v_min_f32 v108, v108, v68
    v_mfma_f32_16x16x32_bf16 v[212:215], v[52:55], a[184:187], v[212:215]
    ds_read_b64_tr_b16 a[72:73], v10 offset:57344
    v_add_f32 v109, 0xf1800000, v3
    v_mfma_f32_16x16x32_bf16 v[244:247], v[52:55], a[188:191], v[244:247]
    buffer_load_dwordx4 v1, s[8:11], s98 offen offset:1024  lds
    v_mfma_f32_16x16x32_bf16 v[152:155], v[56:59], a[176:179], v[152:155]
    ds_read_b64_tr_b16 v[52:53], v13 offset:32768
    v_min_f32 v109, v109, v69
    v_mfma_f32_16x16x32_bf16 v[184:187], v[56:59], a[180:183], v[184:187]
    ds_read_b64_tr_b16 v[54:55], v13 offset:33792
    v_add_f32 v110, 0xf2000000, v3
    v_mfma_f32_16x16x32_bf16 v[216:219], v[56:59], a[184:187], v[216:219]
    s_waitcnt lgkmcnt(7)
    ds_read_b64_tr_b16 a[74:75], v10 offset:58368
    v_min_f32 v110, v110, v70
    v_mfma_f32_16x16x32_bf16 v[248:251], v[56:59], a[188:191], v[248:251]
    buffer_load_dwordx4 v1, s[8:11], s98 offen offset:2048  lds
    v_mfma_f32_16x16x32_bf16 v[156:159], v[60:63], a[176:179], v[156:159]
    ds_read_b64_tr_b16 v[56:57], v14 offset:32768
    v_add_f32 v111, 0xf2400000, v3
    v_mfma_f32_16x16x32_bf16 v[188:191], v[60:63], a[180:183], v[188:191]
    ds_read_b64_tr_b16 v[58:59], v14 offset:33792
    v_min_f32 v111, v111, v71
    v_mfma_f32_16x16x32_bf16 v[220:223], v[60:63], a[184:187], v[220:223]
    s_cmp_eq_u32 s60, 0
    s_cselect_b32 s19, 1.0, 0
    ds_read_b64_tr_b16 a[76:77], v11 offset:57344
    v_sub_f32 v3, v22, v21
    v_mfma_f32_16x16x32_bf16 v[252:255], v[60:63], a[188:191], v[252:255]
    buffer_load_dwordx4 v1, s[8:11], s98 offen offset:3072  lds
    v_mfma_f32_16x16x32_bf16 v[128:131], v[32:35], a[192:195], v[128:131]
    s_add_u32 m0, s62, 135168
    s_add_u32 s98, s82, 4096
    ds_read_b64_tr_b16 v[60:61], v15 offset:32768
    v_mfma_f32_16x16x32_bf16 v[160:163], v[32:35], a[196:199], v[160:163]
    ds_read_b64_tr_b16 v[62:63], v15 offset:33792
    v_fma_f32 v3, s19, v3, v21
    v_mfma_f32_16x16x32_bf16 v[192:195], v[32:35], a[200:203], v[192:195]
    ds_read_b64_tr_b16 a[78:79], v11 offset:58368
    v_add_f32 v80, 0, v3
    v_mfma_f32_16x16x32_bf16 v[224:227], v[32:35], a[204:207], v[224:227]
    buffer_load_dwordx4 v1, s[8:11], s98 offen offset:0  lds
    v_mfma_f32_16x16x32_bf16 v[132:135], v[36:39], a[192:195], v[132:135]
    ds_read_b64_tr_b16 v[32:33], v8 offset:40960
    v_min_f32 v80, v80, v64
    v_mfma_f32_16x16x32_bf16 v[164:167], v[36:39], a[196:199], v[164:167]
    ds_read_b64_tr_b16 v[34:35], v8 offset:41984
    v_add_f32 v81, 0xf1800000, v3
    v_mfma_f32_16x16x32_bf16 v[196:199], v[36:39], a[200:203], v[196:199]
    ds_read_b64_tr_b16 a[80:81], v12 offset:57344
    v_min_f32 v81, v81, v65
    v_mfma_f32_16x16x32_bf16 v[228:231], v[36:39], a[204:207], v[228:231]
    buffer_load_dwordx4 v1, s[8:11], s98 offen offset:1024  lds
    v_mfma_f32_16x16x32_bf16 v[136:139], v[40:43], a[192:195], v[136:139]
    ds_read_b64_tr_b16 v[36:37], v9 offset:40960
    v_add_f32 v82, 0xf2000000, v3
    v_mfma_f32_16x16x32_bf16 v[168:171], v[40:43], a[196:199], v[168:171]
    ds_read_b64_tr_b16 v[38:39], v9 offset:41984
    v_min_f32 v82, v82, v66
    v_mfma_f32_16x16x32_bf16 v[200:203], v[40:43], a[200:203], v[200:203]
    s_waitcnt lgkmcnt(7)
    ds_read_b64_tr_b16 a[82:83], v12 offset:58368
    v_add_f32 v83, 0xf2400000, v3
    v_mfma_f32_16x16x32_bf16 v[232:235], v[40:43], a[204:207], v[232:235]
    buffer_load_dwordx4 v1, s[8:11], s98 offen offset:2048  lds
    v_mfma_f32_16x16x32_bf16 v[140:143], v[44:47], a[192:195], v[140:143]
    ds_read_b64_tr_b16 v[40:41], v10 offset:40960
    v_min_f32 v83, v83, v67
    v_mfma_f32_16x16x32_bf16 v[172:175], v[44:47], a[196:199], v[172:175]
    ds_read_b64_tr_b16 v[42:43], v10 offset:41984
    v_add_f32 v84, 0xf3800000, v3
    v_mfma_f32_16x16x32_bf16 v[204:207], v[44:47], a[200:203], v[204:207]
    ds_read_b64_tr_b16 a[84:85], v13 offset:57344
    v_min_f32 v84, v84, v64
    v_mfma_f32_16x16x32_bf16 v[236:239], v[44:47], a[204:207], v[236:239]
    buffer_load_dwordx4 v1, s[8:11], s98 offen offset:3072  lds
    v_mfma_f32_16x16x32_bf16 v[144:147], v[48:51], a[192:195], v[144:147]
    ds_read_b64_tr_b16 v[44:45], v11 offset:40960
    v_add_f32 v85, 0xf3880000, v3
    v_mfma_f32_16x16x32_bf16 v[176:179], v[48:51], a[196:199], v[176:179]
    ds_read_b64_tr_b16 v[46:47], v11 offset:41984
    v_min_f32 v85, v85, v65
    v_mfma_f32_16x16x32_bf16 v[208:211], v[48:51], a[200:203], v[208:211]
    ds_read_b64_tr_b16 a[86:87], v13 offset:58368
    v_add_f32 v86, 0xf3900000, v3
    v_mfma_f32_16x16x32_bf16 v[240:243], v[48:51], a[204:207], v[240:243]
    buffer_load_dwordx4 a[0:3], v120, s[40:43], s71 offen
    v_mfma_f32_16x16x32_bf16 v[148:151], v[52:55], a[192:195], v[148:151]
    ds_read_b64_tr_b16 v[48:49], v12 offset:40960
    v_min_f32 v86, v86, v66
    v_mfma_f32_16x16x32_bf16 v[180:183], v[52:55], a[196:199], v[180:183]
    ds_read_b64_tr_b16 v[50:51], v12 offset:41984
    v_add_f32 v87, 0xf3980000, v3
    v_mfma_f32_16x16x32_bf16 v[212:215], v[52:55], a[200:203], v[212:215]
    ds_read_b64_tr_b16 a[88:89], v14 offset:57344
    v_min_f32 v87, v87, v67
    v_mfma_f32_16x16x32_bf16 v[244:247], v[52:55], a[204:207], v[244:247]
    buffer_load_dwordx4 a[4:7], v120, s[40:43], s71 offen offset:3584
    v_mfma_f32_16x16x32_bf16 v[152:155], v[56:59], a[192:195], v[152:155]
    ds_read_b64_tr_b16 v[52:53], v13 offset:40960
    v_add_f32 v88, 0x73800000, v3
    v_mfma_f32_16x16x32_bf16 v[184:187], v[56:59], a[196:199], v[184:187]
    ds_read_b64_tr_b16 v[54:55], v13 offset:41984
    v_min_f32 v88, v88, v68
    v_mfma_f32_16x16x32_bf16 v[216:219], v[56:59], a[200:203], v[216:219]
    s_waitcnt lgkmcnt(7)
    ds_read_b64_tr_b16 a[90:91], v14 offset:58368
    v_add_f32 v89, 0x73700000, v3
    v_mfma_f32_16x16x32_bf16 v[248:251], v[56:59], a[204:207], v[248:251]
    buffer_load_dwordx4 a[8:11], v120, s[44:47], s71 offen
    v_mfma_f32_16x16x32_bf16 v[156:159], v[60:63], a[192:195], v[156:159]
    ds_read_b64_tr_b16 v[56:57], v14 offset:40960
    v_min_f32 v89, v89, v69
    v_mfma_f32_16x16x32_bf16 v[188:191], v[60:63], a[196:199], v[188:191]
    ds_read_b64_tr_b16 v[58:59], v14 offset:41984
    v_add_f32 v90, 0x73600000, v3
    v_mfma_f32_16x16x32_bf16 v[220:223], v[60:63], a[200:203], v[220:223]
    ds_read_b64_tr_b16 a[92:93], v15 offset:57344
    v_min_f32 v90, v90, v70
    v_mfma_f32_16x16x32_bf16 v[252:255], v[60:63], a[204:207], v[252:255]
    buffer_load_dwordx4 a[12:15], v120, s[44:47], s71 offen offset:3584
    v_mfma_f32_16x16x32_bf16 v[192:195], v[32:35], a[216:219], v[192:195]
    s_waitcnt vmcnt(34)
    s_lshl_b32 s71, s101, 16
    ds_read_b64_tr_b16 v[60:61], v15 offset:40960
    v_add_f32 v91, 0x73500000, v3
    v_mfma_f32_16x16x32_bf16 v[192:195], a[24:27], a[232:235], v[192:195]
    s_waitcnt vmcnt(26)
    s_lshl_b32 s100, s3, 11
    ds_read_b64_tr_b16 v[62:63], v15 offset:41984
    v_min_f32 v91, v91, v71
    v_mfma_f32_16x16x32_bf16 v[192:195], a[64:67], a[248:251], v[192:195]
    s_add_u32 s71, s71, s100
    ds_read_b64_tr_b16 a[94:95], v15 offset:58368
    v_add_f32 v92, 0, v3
    v_mfma_f32_16x16x32_bf16 v[196:199], v[36:39], a[216:219], v[196:199]
    s_lshl_b32 s100, s4, 7
    v_min_f32 v92, v92, v68
    v_add_f32 v93, 0xf1800000, v3
    v_mfma_f32_16x16x32_bf16 v[196:199], a[28:31], a[232:235], v[196:199]
    s_add_u32 s71, s71, s100
    v_min_f32 v93, v93, v69
    v_add_f32 v94, 0xf2000000, v3
    v_mfma_f32_16x16x32_bf16 v[196:199], a[68:71], a[248:251], v[196:199]
    v_min_f32 v94, v94, v70
    v_add_f32 v95, 0xf2400000, v3
    v_mfma_f32_16x16x32_bf16 v[224:227], v[32:35], a[220:223], v[224:227]
    buffer_load_dwordx4 a[16:19], v121, s[48:51], s71 offen
    v_mfma_f32_16x16x32_bf16 v[224:227], a[24:27], a[236:239], v[224:227]
    s_waitcnt vmcnt(26)
    v_min_f32 v95, v95, v71
    s_waitcnt lgkmcnt(0)
    s_barrier
    v_mfma_f32_16x16x32_bf16 v[224:227], a[64:67], a[252:255], v[224:227]
    buffer_load_dwordx4 a[20:23], v121, s[48:51], s71 offen offset:1024
    v_mfma_f32_16x16x32_bf16 v[228:231], v[36:39], a[220:223], v[228:231]
    v_cvt_pk_bf16_f32 v192, v192, v193
    v_cvt_pk_bf16_f32 v193, v194, v195
    v_mfma_f32_16x16x32_bf16 v[228:231], a[28:31], a[236:239], v[228:231]
    v_cvt_pk_bf16_f32 v194, v196, v197
    v_cvt_pk_bf16_f32 v195, v198, v199
    v_mfma_f32_16x16x32_bf16 v[228:231], a[68:71], a[252:255], v[228:231]
    ds_write_b128 v16, v[192:195] offset:32768
    v_lshrrev_b32 v121, 1, v2
    v_mfma_f32_16x16x32_bf16 v[128:131], v[32:35], a[208:211], v[128:131]
    v_and_b32 v121, 15, v121
    v_lshlrev_b32 v121, 10, v121
    v_mfma_f32_16x16x32_bf16 v[128:131], a[24:27], a[224:227], v[128:131]
    v_and_b32 v122, 1, v2
    v_lshl_add_u32 v121, v122, 7, v121
    v_mfma_f32_16x16x32_bf16 v[128:131], a[64:67], a[240:243], v[128:131]
    v_mfma_f32_16x16x32_bf16 v[132:135], v[36:39], a[208:211], v[132:135]
    s_lshl_b32 s71, s6, 2
    v_cvt_pk_bf16_f32 v224, v224, v225
    v_cvt_pk_bf16_f32 v225, v226, v227
    v_mfma_f32_16x16x32_bf16 v[132:135], a[28:31], a[224:227], v[132:135]
    s_add_u32 s71, s71, s3
    v_cvt_pk_bf16_f32 v226, v228, v229
    v_cvt_pk_bf16_f32 v227, v230, v231
    v_mfma_f32_16x16x32_bf16 v[132:135], a[68:71], a[240:243], v[132:135]
    s_lshl_b32 s71, s71, 14
    ds_write_b128 v16, v[224:227] offset:36864
    v_mfma_f32_16x16x32_bf16 v[160:163], v[32:35], a[212:215], v[160:163]
    buffer_load_dword a60, v121, s[28:31], s71 offen
    v_mfma_f32_16x16x32_bf16 v[160:163], a[24:27], a[228:231], v[160:163]
    v_mfma_f32_16x16x32_bf16 v[160:163], a[64:67], a[244:247], v[160:163]
    s_getpc_b64 s[100:101]
L_ct2:
    s_lshr_b32 s99, s2, 3
    s_lshl_b32 s99, s99, 2
    s_add_u32 s99, s99, s3
    s_mul_i32 s99, s99, 4
    v_min_u32 v123, 3, v2
    v_add_u32 v123, s99, v123
    v_lshlrev_b32 v123, 7, v123
    v_add_u32 v123, L_attn-L_ct2, v123
    v_min_u32 v123, L_code_end-L_ct2, v123
    global_load_dword a61, v123, s[100:101]
    v_mfma_f32_16x16x32_bf16 v[164:167], v[36:39], a[212:215], v[164:167]
    v_cvt_pk_bf16_f32 v128, v128, v129
    v_cvt_pk_bf16_f32 v129, v130, v131
    v_mfma_f32_16x16x32_bf16 v[164:167], a[28:31], a[228:231], v[164:167]
    v_cvt_pk_bf16_f32 v130, v132, v133
    v_cvt_pk_bf16_f32 v131, v134, v135
    v_mfma_f32_16x16x32_bf16 v[164:167], a[68:71], a[244:247], v[164:167]
    ds_write_b128 v16, v[128:131] offset:0
    v_mfma_f32_16x16x32_bf16 v[200:203], v[40:43], a[216:219], v[200:203]
    v_mfma_f32_16x16x32_bf16 v[200:203], a[32:35], a[232:235], v[200:203]
    v_mfma_f32_16x16x32_bf16 v[200:203], a[72:75], a[248:251], v[200:203]
    v_mfma_f32_16x16x32_bf16 v[204:207], v[44:47], a[216:219], v[204:207]
    v_cvt_pk_bf16_f32 v160, v160, v161
    v_cvt_pk_bf16_f32 v161, v162, v163
    v_mfma_f32_16x16x32_bf16 v[204:207], a[36:39], a[232:235], v[204:207]
    v_cvt_pk_bf16_f32 v162, v164, v165
    v_cvt_pk_bf16_f32 v163, v166, v167
    v_mfma_f32_16x16x32_bf16 v[204:207], a[76:79], a[248:251], v[204:207]
    ds_write_b128 v16, v[160:163] offset:4096
    v_mfma_f32_16x16x32_bf16 v[232:235], v[40:43], a[220:223], v[232:235]
    v_mfma_f32_16x16x32_bf16 v[232:235], a[32:35], a[236:239], v[232:235]
    v_mfma_f32_16x16x32_bf16 v[232:235], a[72:75], a[252:255], v[232:235]
    v_mfma_f32_16x16x32_bf16 v[236:239], v[44:47], a[220:223], v[236:239]
    v_cvt_pk_bf16_f32 v200, v200, v201
    v_cvt_pk_bf16_f32 v201, v202, v203
    v_mfma_f32_16x16x32_bf16 v[236:239], a[36:39], a[236:239], v[236:239]
    v_cvt_pk_bf16_f32 v202, v204, v205
    v_cvt_pk_bf16_f32 v203, v206, v207
    v_mfma_f32_16x16x32_bf16 v[236:239], a[76:79], a[252:255], v[236:239]
    ds_write_b128 v16, v[200:203] offset:33792
    v_mfma_f32_16x16x32_bf16 v[136:139], v[40:43], a[208:211], v[136:139]
    v_mfma_f32_16x16x32_bf16 v[136:139], a[32:35], a[224:227], v[136:139]
    v_mfma_f32_16x16x32_bf16 v[136:139], a[72:75], a[240:243], v[136:139]
    v_mfma_f32_16x16x32_bf16 v[140:143], v[44:47], a[208:211], v[140:143]
    v_cvt_pk_bf16_f32 v232, v232, v233
    v_cvt_pk_bf16_f32 v233, v234, v235
    v_mfma_f32_16x16x32_bf16 v[140:143], a[36:39], a[224:227], v[140:143]
    v_cvt_pk_bf16_f32 v234, v236, v237
    v_cvt_pk_bf16_f32 v235, v238, v239
    v_mfma_f32_16x16x32_bf16 v[140:143], a[76:79], a[240:243], v[140:143]
    ds_write_b128 v16, v[232:235] offset:37888
    v_mfma_f32_16x16x32_bf16 v[168:171], v[40:43], a[212:215], v[168:171]
    v_mfma_f32_16x16x32_bf16 v[168:171], a[32:35], a[228:231], v[168:171]
    v_mfma_f32_16x16x32_bf16 v[168:171], a[72:75], a[244:247], v[168:171]
    v_mfma_f32_16x16x32_bf16 v[172:175], v[44:47], a[212:215], v[172:175]
    v_cvt_pk_bf16_f32 v136, v136, v137
    v_cvt_pk_bf16_f32 v137, v138, v139
    v_mfma_f32_16x16x32_bf16 v[172:175], a[36:39], a[228:231], v[172:175]
    v_cvt_pk_bf16_f32 v138, v140, v141
    v_cvt_pk_bf16_f32 v139, v142, v143
    v_mfma_f32_16x16x32_bf16 v[172:175], a[76:79], a[244:247], v[172:175]
    ds_write_b128 v16, v[136:139] offset:1024
    v_mfma_f32_16x16x32_bf16 v[208:211], v[48:51], a[216:219], v[208:211]
    v_mfma_f32_16x16x32_bf16 v[208:211], a[40:43], a[232:235], v[208:211]
    v_mfma_f32_16x16x32_bf16 v[208:211], a[80:83], a[248:251], v[208:211]
    v_mfma_f32_16x16x32_bf16 v[212:215], v[52:55], a[216:219], v[212:215]
    v_cvt_pk_bf16_f32 v168, v168, v169
    v_cvt_pk_bf16_f32 v169, v170, v171
    v_mfma_f32_16x16x32_bf16 v[212:215], a[44:47], a[232:235], v[212:215]
    v_cvt_pk_bf16_f32 v170, v172, v173
    v_cvt_pk_bf16_f32 v171, v174, v175
    v_mfma_f32_16x16x32_bf16 v[212:215], a[84:87], a[248:251], v[212:215]
    ds_write_b128 v16, v[168:171] offset:5120
    v_mfma_f32_16x16x32_bf16 v[240:243], v[48:51], a[220:223], v[240:243]
    v_mfma_f32_16x16x32_bf16 v[240:243], a[40:43], a[236:239], v[240:243]
    v_mfma_f32_16x16x32_bf16 v[240:243], a[80:83], a[252:255], v[240:243]
    v_mfma_f32_16x16x32_bf16 v[244:247], v[52:55], a[220:223], v[244:247]
    v_cvt_pk_bf16_f32 v208, v208, v209
    v_cvt_pk_bf16_f32 v209, v210, v211
    v_mfma_f32_16x16x32_bf16 v[244:247], a[44:47], a[236:239], v[244:247]
    v_cvt_pk_bf16_f32 v210, v212, v213
    v_cvt_pk_bf16_f32 v211, v214, v215
    v_mfma_f32_16x16x32_bf16 v[244:247], a[84:87], a[252:255], v[244:247]
    ds_write_b128 v16, v[208:211] offset:34816
    v_mfma_f32_16x16x32_bf16 v[144:147], v[48:51], a[208:211], v[144:147]
    v_mfma_f32_16x16x32_bf16 v[144:147], a[40:43], a[224:227], v[144:147]
    v_mfma_f32_16x16x32_bf16 v[144:147], a[80:83], a[240:243], v[144:147]
    v_mfma_f32_16x16x32_bf16 v[148:151], v[52:55], a[208:211], v[148:151]
    v_cvt_pk_bf16_f32 v240, v240, v241
    v_cvt_pk_bf16_f32 v241, v242, v243
    v_mfma_f32_16x16x32_bf16 v[148:151], a[44:47], a[224:227], v[148:151]
    v_cvt_pk_bf16_f32 v242, v244, v245
    v_cvt_pk_bf16_f32 v243, v246, v247
    v_mfma_f32_16x16x32_bf16 v[148:151], a[84:87], a[240:243], v[148:151]
    ds_write_b128 v16, v[240:243] offset:38912
    v_mfma_f32_16x16x32_bf16 v[176:179], v[48:51], a[212:215], v[176:179]
    v_mfma_f32_16x16x32_bf16 v[176:179], a[40:43], a[228:231], v[176:179]
    v_mfma_f32_16x16x32_bf16 v[176:179], a[80:83], a[244:247], v[176:179]
    v_mfma_f32_16x16x32_bf16 v[180:183], v[52:55], a[212:215], v[180:183]
    v_cvt_pk_bf16_f32 v144, v144, v145
    v_cvt_pk_bf16_f32 v145, v146, v147
    v_mfma_f32_16x16x32_bf16 v[180:183], a[44:47], a[228:231], v[180:183]
    v_cvt_pk_bf16_f32 v146, v148, v149
    v_cvt_pk_bf16_f32 v147, v150, v151
    v_mfma_f32_16x16x32_bf16 v[180:183], a[84:87], a[244:247], v[180:183]
    ds_write_b128 v16, v[144:147] offset:2048
    v_mfma_f32_16x16x32_bf16 v[216:219], v[56:59], a[216:219], v[216:219]
    v_mfma_f32_16x16x32_bf16 v[216:219], a[48:51], a[232:235], v[216:219]
    v_mfma_f32_16x16x32_bf16 v[216:219], a[88:91], a[248:251], v[216:219]
    v_mfma_f32_16x16x32_bf16 v[220:223], v[60:63], a[216:219], v[220:223]
    v_cvt_pk_bf16_f32 v176, v176, v177
    v_cvt_pk_bf16_f32 v177, v178, v179
    v_mfma_f32_16x16x32_bf16 v[220:223], a[52:55], a[232:235], v[220:223]
    v_cvt_pk_bf16_f32 v178, v180, v181
    v_cvt_pk_bf16_f32 v179, v182, v183
    v_mfma_f32_16x16x32_bf16 v[220:223], a[92:95], a[248:251], v[220:223]
    ds_write_b128 v16, v[176:179] offset:6144
    v_mfma_f32_16x16x32_bf16 v[248:251], v[56:59], a[220:223], v[248:251]
    v_mfma_f32_16x16x32_bf16 v[248:251], a[48:51], a[236:239], v[248:251]
    v_mfma_f32_16x16x32_bf16 v[248:251], a[88:91], a[252:255], v[248:251]
    v_mfma_f32_16x16x32_bf16 v[252:255], v[60:63], a[220:223], v[252:255]
    v_cvt_pk_bf16_f32 v216, v216, v217
    v_cvt_pk_bf16_f32 v217, v218, v219
    v_mfma_f32_16x16x32_bf16 v[252:255], a[52:55], a[236:239], v[252:255]
    v_cvt_pk_bf16_f32 v218, v220, v221
    v_cvt_pk_bf16_f32 v219, v222, v223
    v_mfma_f32_16x16x32_bf16 v[252:255], a[92:95], a[252:255], v[252:255]
    ds_write_b128 v16, v[216:219] offset:35840
    v_mfma_f32_16x16x32_bf16 v[152:155], v[56:59], a[208:211], v[152:155]
    v_mfma_f32_16x16x32_bf16 v[152:155], a[48:51], a[224:227], v[152:155]
    v_mfma_f32_16x16x32_bf16 v[152:155], a[88:91], a[240:243], v[152:155]
    v_mfma_f32_16x16x32_bf16 v[156:159], v[60:63], a[208:211], v[156:159]
    v_cvt_pk_bf16_f32 v248, v248, v249
    v_cvt_pk_bf16_f32 v249, v250, v251
    v_mfma_f32_16x16x32_bf16 v[156:159], a[52:55], a[224:227], v[156:159]
    v_cvt_pk_bf16_f32 v250, v252, v253
    v_cvt_pk_bf16_f32 v251, v254, v255
    v_mfma_f32_16x16x32_bf16 v[156:159], a[92:95], a[240:243], v[156:159]
    ds_write_b128 v16, v[248:251] offset:39936
    v_mfma_f32_16x16x32_bf16 v[184:187], v[56:59], a[212:215], v[184:187]
    v_mfma_f32_16x16x32_bf16 v[184:187], a[48:51], a[228:231], v[184:187]
    v_mfma_f32_16x16x32_bf16 v[184:187], a[88:91], a[244:247], v[184:187]
    v_mfma_f32_16x16x32_bf16 v[188:191], v[60:63], a[212:215], v[188:191]
    v_cvt_pk_bf16_f32 v152, v152, v153
    v_cvt_pk_bf16_f32 v153, v154, v155
    v_mfma_f32_16x16x32_bf16 v[188:191], a[52:55], a[228:231], v[188:191]
    v_cvt_pk_bf16_f32 v154, v156, v157
    v_cvt_pk_bf16_f32 v155, v158, v159
    v_mfma_f32_16x16x32_bf16 v[188:191], a[92:95], a[244:247], v[188:191]
    ds_write_b128 v16, v[152:155] offset:3072
L_attn:
    v_add_u32 v15, 4096, v1
    v_cvt_pk_bf16_f32 v184, v184, v185
    v_cvt_pk_bf16_f32 v185, v186, v187
    s_nop 3
    v_cvt_pk_bf16_f32 v186, v188, v189
    v_cvt_pk_bf16_f32 v187, v190, v191
    ds_write_b128 v16, v[184:187] offset:7168
    s_waitcnt vmcnt(24) lgkmcnt(0)
    s_barrier
    ds_read_b128 a[64:67], v17 offset:0
    ds_read_b128 a[128:131], v18 offset:0
    ds_read_b128 a[68:71], v17 offset:1024
    ds_read_b128 a[132:135], v18 offset:1024
    ds_read_b128 a[72:75], v17 offset:2048
    ds_read_b128 a[136:139], v18 offset:2048
    ds_read_b128 a[76:79], v17 offset:3072
    ds_read_b128 a[140:143], v18 offset:3072
    ds_read_b128 a[144:147], v18 offset:4096
    ds_read_b128 a[148:151], v18 offset:5120
    ds_read_b128 a[152:155], v18 offset:6144
    ds_read_b128 a[156:159], v18 offset:7168
    ds_read_b128 a[80:83], v17 offset:4096
    ds_read_b128 a[84:87], v17 offset:5120
    ds_read_b128 a[88:91], v17 offset:6144
    ds_read_b128 a[92:95], v17 offset:7168
    s_waitcnt lgkmcnt(14)
    v_mfma_f32_16x16x32_bf16 v[96:99], a[128:131], a[64:67], v[96:99]
    s_waitcnt lgkmcnt(12)
    s_add_u32 s19, s82, 32768
    s_sub_u32 s82, s12, s13
    ds_read_b128 a[96:99], v17 offset:8192
    v_mfma_f32_16x16x32_bf16 v[96:99], a[132:135], a[68:71], v[96:99]
    s_waitcnt lgkmcnt(11)
    s_sub_u32 s82, s82, 1
    s_cmp_gt_u32 s12, s13
    s_cselect_b32 s82, s82, s12
    ds_read_b128 a[100:103], v17 offset:9216
    v_mfma_f32_16x16x32_bf16 v[96:99], a[136:139], a[72:75], v[96:99]
    s_waitcnt lgkmcnt(10)
    s_lshl_b32 s82, s82, 16
    s_add_u32 s82, s82, s81
    ds_read_b128 a[104:107], v17 offset:10240
    v_mfma_f32_16x16x32_bf16 v[96:99], a[140:143], a[76:79], v[96:99]
    s_waitcnt lgkmcnt(10)
    s_cmp_ge_u32 s12, 17
    s_cselect_b32 s82, 2147471360, s82
    s_add_u32 s12, s12, 1
    ds_read_b128 a[108:111], v17 offset:11264
    v_mfma_f32_16x16x32_bf16 v[100:103], a[144:147], a[64:67], v[100:103]
    s_waitcnt lgkmcnt(10)
    s_sub_u32 s14, s60, 1
    ds_read_b128 a[112:115], v17 offset:12288
    v_mfma_f32_16x16x32_bf16 v[100:103], a[148:151], a[68:71], v[100:103]
    s_waitcnt lgkmcnt(10)
    ds_read_b128 a[116:119], v17 offset:13312
    v_mfma_f32_16x16x32_bf16 v[100:103], a[152:155], a[72:75], v[100:103]
    s_waitcnt lgkmcnt(10)
    ds_read_b128 a[120:123], v17 offset:14336
    v_mfma_f32_16x16x32_bf16 v[100:103], a[156:159], a[76:79], v[100:103]
    s_waitcnt lgkmcnt(10)
    ds_read_b128 a[124:127], v17 offset:15360
    v_mfma_f32_16x16x32_bf16 v[104:107], a[128:131], a[80:83], v[104:107]
    s_waitcnt lgkmcnt(10)
    ds_read_b128 a[192:195], v17 offset:32768
    v_exp_f32 v96, v96
    v_mfma_f32_16x16x32_bf16 v[104:107], a[132:135], a[84:87], v[104:107]
    s_waitcnt lgkmcnt(10)
    ds_read_b128 a[196:199], v17 offset:33792
    v_exp_f32 v97, v97
    v_mfma_f32_16x16x32_bf16 v[104:107], a[136:139], a[88:91], v[104:107]
    s_waitcnt lgkmcnt(10)
    ds_read_b128 a[200:203], v17 offset:34816
    v_exp_f32 v98, v98
    v_mfma_f32_16x16x32_bf16 v[104:107], a[140:143], a[92:95], v[104:107]
    ds_read_b128 a[204:207], v17 offset:35840
    v_exp_f32 v99, v99
    v_mfma_f32_16x16x32_bf16 v[108:111], a[144:147], a[80:83], v[108:111]
    ds_read_b128 a[208:211], v17 offset:36864
    v_exp_f32 v100, v100
    v_mfma_f32_16x16x32_bf16 v[108:111], a[148:151], a[84:87], v[108:111]
    ds_read_b128 a[212:215], v17 offset:37888
    v_exp_f32 v101, v101
    v_mfma_f32_16x16x32_bf16 v[108:111], a[152:155], a[88:91], v[108:111]
    ds_read_b128 a[216:219], v17 offset:38912
    v_exp_f32 v102, v102
    v_mfma_f32_16x16x32_bf16 v[108:111], a[156:159], a[92:95], v[108:111]
    s_waitcnt lgkmcnt(14)
    ds_read_b128 a[220:223], v17 offset:39936
    v_exp_f32 v103, v103
    v_mfma_f32_16x16x32_bf16 v[112:115], a[128:131], a[96:99], v[72:75]
    s_waitcnt lgkmcnt(14)
    ds_read_b128 a[224:227], v17 offset:40960
    v_exp_f32 v104, v104
    v_mfma_f32_16x16x32_bf16 v[112:115], a[132:135], a[100:103], v[112:115]
    s_waitcnt lgkmcnt(14)
    ds_read_b128 a[228:231], v17 offset:41984
    v_exp_f32 v105, v105
    v_mfma_f32_16x16x32_bf16 v[112:115], a[136:139], a[104:107], v[112:115]
    s_waitcnt lgkmcnt(14)
    ds_read_b128 a[232:235], v17 offset:43008
    v_exp_f32 v106, v106
    v_mfma_f32_16x16x32_bf16 v[112:115], a[140:143], a[108:111], v[112:115]
    s_waitcnt lgkmcnt(14)
    ds_read_b128 a[236:239], v17 offset:44032
    v_exp_f32 v107, v107
    v_mfma_f32_16x16x32_bf16 v[120:123], a[128:131], a[112:115], v[76:79]
    s_waitcnt lgkmcnt(14)
    ds_read_b128 a[240:243], v17 offset:45056
    v_exp_f32 v108, v108
    v_mfma_f32_16x16x32_bf16 v[120:123], a[132:135], a[116:119], v[120:123]
    s_waitcnt lgkmcnt(14)
    ds_read_b128 a[244:247], v17 offset:46080
    v_exp_f32 v109, v109
    v_mfma_f32_16x16x32_bf16 v[120:123], a[136:139], a[120:123], v[120:123]
    s_waitcnt lgkmcnt(14)
    ds_read_b128 a[248:251], v17 offset:47104
    v_exp_f32 v110, v110
    v_mfma_f32_16x16x32_bf16 v[120:123], a[140:143], a[124:127], v[120:123]
    ds_read_b128 a[252:255], v17 offset:48128
    v_exp_f32 v111, v111
    v_mfma_f32_16x16x32_bf16 v[116:119], a[144:147], a[96:99], v[72:75]
    ds_read_b128 a[128:131], v18 offset:16384
    v_cvt_pk_bf16_f32 v48, v96, v97
    v_mfma_f32_16x16x32_bf16 v[116:119], a[148:151], a[100:103], v[116:119]
    ds_read_b128 a[132:135], v18 offset:17408
    v_cvt_pk_bf16_f32 v49, v98, v99
    v_mfma_f32_16x16x32_bf16 v[116:119], a[152:155], a[104:107], v[116:119]
    ds_read_b128 a[136:139], v18 offset:18432
    v_cvt_pk_bf16_f32 v50, v100, v101
    v_mfma_f32_16x16x32_bf16 v[116:119], a[156:159], a[108:111], v[116:119]
    ds_read_b128 a[140:143], v18 offset:19456
    v_cvt_pk_bf16_f32 v51, v102, v103
    v_mfma_f32_16x16x32_bf16 v[124:127], a[144:147], a[112:115], v[76:79]
    ds_read_b128 a[144:147], v18 offset:20480
    v_cvt_pk_bf16_f32 v52, v104, v105
    v_mfma_f32_16x16x32_bf16 v[124:127], a[148:151], a[116:119], v[124:127]
    ds_read_b128 a[148:151], v18 offset:21504
    v_cvt_pk_bf16_f32 v53, v106, v107
    v_mfma_f32_16x16x32_bf16 v[124:127], a[152:155], a[120:123], v[124:127]
    ds_read_b128 a[152:155], v18 offset:22528
    v_cvt_pk_bf16_f32 v54, v108, v109
    v_mfma_f32_16x16x32_bf16 v[124:127], a[156:159], a[124:127], v[124:127]
    ds_read_b128 a[156:159], v18 offset:23552
    v_cvt_pk_bf16_f32 v55, v110, v111
    v_xor_b32 v18, 196608, v18
    v_lshrrev_b32 v17, 4, v2
    v_lshlrev_b32 v17, 15, v17
    v_and_b32 v14, 255, v1
    v_add_u32 v17, v17, v14
L_t1_p1:
    s_waitcnt vmcnt(8) lgkmcnt(0)
    s_barrier
    s_cmp_eq_u32 s60, 0
    s_cbranch_scc1 L_t1_zero
    v_mfma_f32_16x16x32_bf16 v[96:99], a[128:131], a[64:67], v[64:67]
    s_add_u32 m0, s15, 0
    ds_read_b128 a[160:163], v19 offset:0
    v_mfma_f32_16x16x32_bf16 v[96:99], a[132:135], a[68:71], v[96:99]
    ds_read_b128 a[164:167], v19 offset:1024
    v_mfma_f32_16x16x32_bf16 v[96:99], a[136:139], a[72:75], v[96:99]
    v_exp_f32 v112, v112
    v_mfma_f32_16x16x32_bf16 v[96:99], a[140:143], a[76:79], v[96:99]
    buffer_load_dwordx4 v1, s[8:11], s82 offen offset:0 lds
    v_mfma_f32_16x16x32_bf16 v[104:107], a[128:131], a[80:83], v[68:71]
    v_exp_f32 v113, v113
    v_mfma_f32_16x16x32_bf16 v[104:107], a[132:135], a[84:87], v[104:107]
    ds_read_b128 a[168:171], v19 offset:2048
    v_cvt_pk_bf16_f32 v56, v112, v113
    v_mfma_f32_16x16x32_bf16 v[104:107], a[136:139], a[88:91], v[104:107]
    v_exp_f32 v114, v114
    v_mfma_f32_16x16x32_bf16 v[104:107], a[140:143], a[92:95], v[104:107]
    buffer_load_dwordx4 v1, s[8:11], s82 offen offset:1024 lds
    v_mfma_f32_16x16x32_bf16 v[100:103], a[144:147], a[64:67], v[64:67]
    v_exp_f32 v115, v115
    v_mfma_f32_16x16x32_bf16 v[100:103], a[148:151], a[68:71], v[100:103]
    ds_read_b128 a[172:175], v19 offset:3072
    v_cvt_pk_bf16_f32 v57, v114, v115
    v_mfma_f32_16x16x32_bf16 v[100:103], a[152:155], a[72:75], v[100:103]
    v_exp_f32 v116, v116
    v_mfma_f32_16x16x32_bf16 v[100:103], a[156:159], a[76:79], v[100:103]
    buffer_load_dwordx4 v1, s[8:11], s82 offen offset:2048 lds
    v_mfma_f32_16x16x32_bf16 v[108:111], a[144:147], a[80:83], v[68:71]
    v_exp_f32 v117, v117
    v_mfma_f32_16x16x32_bf16 v[108:111], a[148:151], a[84:87], v[108:111]
    ds_read_b128 a[176:179], v20 offset:4096
    v_cvt_pk_bf16_f32 v58, v116, v117
    v_mfma_f32_16x16x32_bf16 v[108:111], a[152:155], a[88:91], v[108:111]
    v_exp_f32 v118, v118
    v_mfma_f32_16x16x32_bf16 v[108:111], a[156:159], a[92:95], v[108:111]
    buffer_load_dwordx4 v1, s[8:11], s82 offen offset:3072 lds
    v_mfma_f32_16x16x32_bf16 v[32:35], v[28:31], v[48:51], 0
    s_add_u32 m0, s15, 4096
    v_exp_f32 v119, v119
    v_mfma_f32_16x16x32_bf16 v[36:39], v[28:31], v[52:55], 0
    s_waitcnt lgkmcnt(4)
    ds_read_b128 a[180:183], v20 offset:5120
    v_cvt_pk_bf16_f32 v59, v118, v119
    v_mfma_f32_16x16x32_bf16 v[128:131], a[160:163], v[48:51], 0
    v_exp_f32 v120, v120
    v_mfma_f32_16x16x32_bf16 v[160:163], a[160:163], v[52:55], 0
    s_waitcnt lgkmcnt(4)
    v_mfma_f32_16x16x32_bf16 v[132:135], a[164:167], v[48:51], 0
    v_exp_f32 v121, v121
    v_mfma_f32_16x16x32_bf16 v[164:167], a[164:167], v[52:55], 0
    s_waitcnt lgkmcnt(3)
    ds_read_b128 a[184:187], v20 offset:6144
    v_cvt_pk_bf16_f32 v60, v120, v121
    v_mfma_f32_16x16x32_bf16 v[136:139], a[168:171], v[48:51], 0
    s_waitcnt lgkmcnt(3)
    v_exp_f32 v122, v122
    v_mfma_f32_16x16x32_bf16 v[168:171], a[168:171], v[52:55], 0
    buffer_load_dwordx4 v15, s[8:11], s82 offen offset:0 lds
    v_mfma_f32_16x16x32_bf16 v[140:143], a[172:175], v[48:51], 0
    v_exp_f32 v123, v123
    v_mfma_f32_16x16x32_bf16 v[172:175], a[172:175], v[52:55], 0
    s_waitcnt lgkmcnt(2)
    ds_read_b128 a[188:191], v20 offset:7168
    v_cvt_pk_bf16_f32 v61, v122, v123
    v_mfma_f32_16x16x32_bf16 v[144:147], a[176:179], v[48:51], 0
    s_waitcnt lgkmcnt(2)
    v_exp_f32 v124, v124
    v_mfma_f32_16x16x32_bf16 v[176:179], a[176:179], v[52:55], 0
    buffer_load_dwordx4 v15, s[8:11], s82 offen offset:1024 lds
    v_mfma_f32_16x16x32_bf16 v[148:151], a[180:183], v[48:51], 0
    v_exp_f32 v125, v125
    v_mfma_f32_16x16x32_bf16 v[180:183], a[180:183], v[52:55], 0
    s_waitcnt lgkmcnt(1)
    v_cvt_pk_bf16_f32 v62, v124, v125
    v_mfma_f32_16x16x32_bf16 v[152:155], a[184:187], v[48:51], 0
    s_waitcnt lgkmcnt(0)
    v_exp_f32 v126, v126
    v_mfma_f32_16x16x32_bf16 v[184:187], a[184:187], v[52:55], 0
    buffer_load_dwordx4 v15, s[8:11], s82 offen offset:2048 lds
    v_mfma_f32_16x16x32_bf16 v[156:159], a[188:191], v[48:51], 0
    v_exp_f32 v127, v127
    v_mfma_f32_16x16x32_bf16 v[188:191], a[188:191], v[52:55], 0
    v_cvt_pk_bf16_f32 v63, v126, v127
    v_mfma_f32_16x16x32_bf16 v[112:115], a[128:131], a[96:99], v[72:75]
    v_mfma_f32_16x16x32_bf16 v[112:115], a[132:135], a[100:103], v[112:115]
    v_mfma_f32_16x16x32_bf16 v[112:115], a[136:139], a[104:107], v[112:115]
    v_exp_f32 v96, v96
    v_mfma_f32_16x16x32_bf16 v[112:115], a[140:143], a[108:111], v[112:115]
    buffer_load_dwordx4 v15, s[8:11], s82 offen offset:3072 lds
    v_mfma_f32_16x16x32_bf16 v[120:123], a[128:131], a[112:115], v[76:79]
    s_xor_b32 s15, s15, 196608
    v_exp_f32 v97, v97
    v_mfma_f32_16x16x32_bf16 v[120:123], a[132:135], a[116:119], v[120:123]
    s_add_u32 m0, s16, 0
    ds_read_b128 a[128:131], v18 offset:0
    v_cvt_pk_bf16_f32 v48, v96, v97
    v_mfma_f32_16x16x32_bf16 v[120:123], a[136:139], a[120:123], v[120:123]
    v_exp_f32 v98, v98
    v_mfma_f32_16x16x32_bf16 v[120:123], a[140:143], a[124:127], v[120:123]
    buffer_load_dwordx4 v1, s[8:11], s19 offen offset:0 lds
    v_mfma_f32_16x16x32_bf16 v[116:119], a[144:147], a[96:99], v[72:75]
    v_exp_f32 v99, v99
    v_mfma_f32_16x16x32_bf16 v[116:119], a[148:151], a[100:103], v[116:119]
    ds_read_b128 a[132:135], v18 offset:1024
    v_cvt_pk_bf16_f32 v49, v98, v99
    v_mfma_f32_16x16x32_bf16 v[116:119], a[152:155], a[104:107], v[116:119]
    v_exp_f32 v100, v100
    v_mfma_f32_16x16x32_bf16 v[116:119], a[156:159], a[108:111], v[116:119]
    buffer_load_dwordx4 v1, s[8:11], s19 offen offset:1024 lds
    v_mfma_f32_16x16x32_bf16 v[124:127], a[144:147], a[112:115], v[76:79]
    v_exp_f32 v101, v101
    v_mfma_f32_16x16x32_bf16 v[124:127], a[148:151], a[116:119], v[124:127]
    ds_read_b128 a[136:139], v18 offset:2048
    v_cvt_pk_bf16_f32 v50, v100, v101
    v_mfma_f32_16x16x32_bf16 v[124:127], a[152:155], a[120:123], v[124:127]
    v_exp_f32 v102, v102
    v_mfma_f32_16x16x32_bf16 v[124:127], a[156:159], a[124:127], v[124:127]
    buffer_load_dwordx4 v1, s[8:11], s19 offen offset:2048 lds
    v_mfma_f32_16x16x32_bf16 v[40:43], v[28:31], v[56:59], 0
    v_exp_f32 v103, v103
    v_mfma_f32_16x16x32_bf16 v[44:47], v[28:31], v[60:63], 0
    ds_read_b128 a[140:143], v18 offset:3072
    v_cvt_pk_bf16_f32 v51, v102, v103
    v_mfma_f32_16x16x32_bf16 v[192:195], a[160:163], v[56:59], 0
    v_exp_f32 v104, v104
    v_mfma_f32_16x16x32_bf16 v[224:227], a[160:163], v[60:63], 0
    v_mfma_f32_16x16x32_bf16 v[196:199], a[164:167], v[56:59], 0
    v_exp_f32 v105, v105
    v_mfma_f32_16x16x32_bf16 v[228:231], a[164:167], v[60:63], 0
    ds_read_b128 a[144:147], v18 offset:4096
    v_cvt_pk_bf16_f32 v52, v104, v105
    v_mfma_f32_16x16x32_bf16 v[200:203], a[168:171], v[56:59], 0
    v_exp_f32 v106, v106
    v_mfma_f32_16x16x32_bf16 v[232:235], a[168:171], v[60:63], 0
    buffer_load_dwordx4 v1, s[8:11], s19 offen offset:3072 lds
    v_mfma_f32_16x16x32_bf16 v[204:207], a[172:175], v[56:59], 0
    s_add_u32 m0, s16, 4096
    v_exp_f32 v107, v107
    v_mfma_f32_16x16x32_bf16 v[236:239], a[172:175], v[60:63], 0
    ds_read_b128 a[148:151], v18 offset:5120
    v_cvt_pk_bf16_f32 v53, v106, v107
    v_mfma_f32_16x16x32_bf16 v[208:211], a[176:179], v[56:59], 0
    v_exp_f32 v108, v108
    v_mfma_f32_16x16x32_bf16 v[240:243], a[176:179], v[60:63], 0
    buffer_load_dwordx4 v15, s[8:11], s19 offen offset:0 lds
    v_mfma_f32_16x16x32_bf16 v[212:215], a[180:183], v[56:59], 0
    v_exp_f32 v109, v109
    v_mfma_f32_16x16x32_bf16 v[244:247], a[180:183], v[60:63], 0
    ds_read_b128 a[152:155], v18 offset:6144
    v_cvt_pk_bf16_f32 v54, v108, v109
    v_mfma_f32_16x16x32_bf16 v[216:219], a[184:187], v[56:59], 0
    v_exp_f32 v110, v110
    v_mfma_f32_16x16x32_bf16 v[248:251], a[184:187], v[60:63], 0
    buffer_load_dwordx4 v15, s[8:11], s19 offen offset:1024 lds
    v_mfma_f32_16x16x32_bf16 v[220:223], a[188:191], v[56:59], 0
    v_exp_f32 v111, v111
    v_mfma_f32_16x16x32_bf16 v[252:255], a[188:191], v[60:63], 0
    ds_read_b128 a[156:159], v18 offset:7168
    v_cvt_pk_bf16_f32 v55, v110, v111
    s_cmp_eq_u32 s14, 0
    s_cbranch_scc1 L_t1_diag
.p2align 3
L_t1_loop:
    s_waitcnt lgkmcnt(7)
    v_mfma_f32_16x16x32_bf16 v[96:99], a[128:131], a[64:67], v[64:67]
    s_waitcnt lgkmcnt(6)
    ds_read_b128 a[160:163], v19 offset:16384
    v_mfma_f32_16x16x32_bf16 v[96:99], a[132:135], a[68:71], v[96:99]
    s_waitcnt lgkmcnt(6)
    ds_read_b128 a[164:167], v19 offset:17408
    v_mfma_f32_16x16x32_bf16 v[96:99], a[136:139], a[72:75], v[96:99]
    s_waitcnt lgkmcnt(6)
    v_exp_f32 v112, v112
    v_mfma_f32_16x16x32_bf16 v[96:99], a[140:143], a[76:79], v[96:99]
    buffer_load_dwordx4 v15, s[8:11], s19 offen offset:2048 lds
    v_mfma_f32_16x16x32_bf16 v[104:107], a[128:131], a[80:83], v[68:71]
    v_exp_f32 v113, v113
    v_mfma_f32_16x16x32_bf16 v[104:107], a[132:135], a[84:87], v[104:107]
    ds_read_b128 a[168:171], v19 offset:18432
    v_cvt_pk_bf16_f32 v56, v112, v113
    v_mfma_f32_16x16x32_bf16 v[104:107], a[136:139], a[88:91], v[104:107]
    s_waitcnt lgkmcnt(6)
    v_exp_f32 v114, v114
    v_mfma_f32_16x16x32_bf16 v[104:107], a[140:143], a[92:95], v[104:107]
    buffer_load_dwordx4 v15, s[8:11], s19 offen offset:3072 lds
    v_mfma_f32_16x16x32_bf16 v[100:103], a[144:147], a[64:67], v[64:67]
    s_waitcnt lgkmcnt(5)
    s_xor_b32 s16, s16, 98304
    v_exp_f32 v115, v115
    v_mfma_f32_16x16x32_bf16 v[100:103], a[148:151], a[68:71], v[100:103]
    s_waitcnt lgkmcnt(4)
    ds_read_b128 a[172:175], v19 offset:19456
    v_cvt_pk_bf16_f32 v57, v114, v115
    v_mfma_f32_16x16x32_bf16 v[100:103], a[152:155], a[72:75], v[100:103]
    s_waitcnt lgkmcnt(4)
    v_exp_f32 v116, v116
    v_mfma_f32_16x16x32_bf16 v[100:103], a[156:159], a[76:79], v[100:103]
    v_mfma_f32_16x16x32_bf16 v[108:111], a[144:147], a[80:83], v[68:71]
    v_exp_f32 v117, v117
    v_mfma_f32_16x16x32_bf16 v[108:111], a[148:151], a[84:87], v[108:111]
    ds_read_b128 a[176:179], v20 offset:20480
    v_cvt_pk_bf16_f32 v58, v116, v117
    v_mfma_f32_16x16x32_bf16 v[108:111], a[152:155], a[88:91], v[108:111]
    v_exp_f32 v118, v118
    v_mfma_f32_16x16x32_bf16 v[108:111], a[156:159], a[92:95], v[108:111]
    v_mfma_f32_16x16x32_bf16 v[32:35], v[28:31], v[48:51], v[32:35]
    v_exp_f32 v119, v119
    v_mfma_f32_16x16x32_bf16 v[36:39], v[28:31], v[52:55], v[36:39]
    s_waitcnt lgkmcnt(4)
    ds_read_b128 a[180:183], v20 offset:21504
    v_cvt_pk_bf16_f32 v59, v118, v119
    v_mfma_f32_16x16x32_bf16 v[128:131], a[160:163], v[48:51], v[128:131]
    v_exp_f32 v120, v120
    v_mfma_f32_16x16x32_bf16 v[160:163], a[160:163], v[52:55], v[160:163]
    s_waitcnt lgkmcnt(4)
    v_mfma_f32_16x16x32_bf16 v[132:135], a[164:167], v[48:51], v[132:135]
    v_exp_f32 v121, v121
    v_mfma_f32_16x16x32_bf16 v[164:167], a[164:167], v[52:55], v[164:167]
    s_waitcnt lgkmcnt(3)
    ds_read_b128 a[184:187], v20 offset:22528
    v_cvt_pk_bf16_f32 v60, v120, v121
    v_mfma_f32_16x16x32_bf16 v[136:139], a[168:171], v[48:51], v[136:139]
    v_exp_f32 v122, v122
    v_mfma_f32_16x16x32_bf16 v[168:171], a[168:171], v[52:55], v[168:171]
    s_waitcnt lgkmcnt(3)
    v_mfma_f32_16x16x32_bf16 v[140:143], a[172:175], v[48:51], v[140:143]
    v_exp_f32 v123, v123
    v_mfma_f32_16x16x32_bf16 v[172:175], a[172:175], v[52:55], v[172:175]
    s_waitcnt lgkmcnt(2)
    ds_read_b128 a[188:191], v20 offset:23552
    v_cvt_pk_bf16_f32 v61, v122, v123
    v_mfma_f32_16x16x32_bf16 v[144:147], a[176:179], v[48:51], v[144:147]
    v_exp_f32 v124, v124
    v_mfma_f32_16x16x32_bf16 v[176:179], a[176:179], v[52:55], v[176:179]
    s_waitcnt lgkmcnt(2)
    v_mfma_f32_16x16x32_bf16 v[148:151], a[180:183], v[48:51], v[148:151]
    v_exp_f32 v125, v125
    v_mfma_f32_16x16x32_bf16 v[180:183], a[180:183], v[52:55], v[180:183]
    s_waitcnt lgkmcnt(1)
    v_cvt_pk_bf16_f32 v62, v124, v125
    v_xor_b32 v19, 98304, v19
    v_mfma_f32_16x16x32_bf16 v[152:155], a[184:187], v[48:51], v[152:155]
    v_exp_f32 v126, v126
    v_mfma_f32_16x16x32_bf16 v[184:187], a[184:187], v[52:55], v[184:187]
    s_waitcnt lgkmcnt(0)
    v_xor_b32 v20, 98304, v20
    v_mfma_f32_16x16x32_bf16 v[156:159], a[188:191], v[48:51], v[156:159]
    v_exp_f32 v127, v127
    v_mfma_f32_16x16x32_bf16 v[188:191], a[188:191], v[52:55], v[188:191]
    v_cvt_pk_bf16_f32 v63, v126, v127
    v_mfma_f32_16x16x32_bf16 v[112:115], a[128:131], a[96:99], v[72:75]
    v_exp_f32 v96, v96
    v_mfma_f32_16x16x32_bf16 v[112:115], a[132:135], a[100:103], v[112:115]
    v_mfma_f32_16x16x32_bf16 v[112:115], a[136:139], a[104:107], v[112:115]
    v_exp_f32 v97, v97
    v_mfma_f32_16x16x32_bf16 v[112:115], a[140:143], a[108:111], v[112:115]
    v_cvt_pk_bf16_f32 v48, v96, v97
    v_mfma_f32_16x16x32_bf16 v[120:123], a[128:131], a[112:115], v[76:79]
    v_exp_f32 v98, v98
    v_mfma_f32_16x16x32_bf16 v[120:123], a[132:135], a[116:119], v[120:123]
    v_mfma_f32_16x16x32_bf16 v[120:123], a[136:139], a[120:123], v[120:123]
    v_exp_f32 v99, v99
    v_mfma_f32_16x16x32_bf16 v[120:123], a[140:143], a[124:127], v[120:123]
    v_mfma_f32_16x16x32_bf16 v[116:119], a[144:147], a[96:99], v[72:75]
    v_exp_f32 v100, v100
    v_mfma_f32_16x16x32_bf16 v[116:119], a[148:151], a[100:103], v[116:119]
    ds_read_b128 a[128:131], v18 offset:16384
    v_cvt_pk_bf16_f32 v49, v98, v99
    v_mfma_f32_16x16x32_bf16 v[116:119], a[152:155], a[104:107], v[116:119]
    s_add_u32 s19, s82, 32768
    v_exp_f32 v101, v101
    v_mfma_f32_16x16x32_bf16 v[116:119], a[156:159], a[108:111], v[116:119]
    s_sub_u32 s82, s12, s13
    ds_read_b128 a[132:135], v18 offset:17408
    v_cvt_pk_bf16_f32 v50, v100, v101
    v_mfma_f32_16x16x32_bf16 v[124:127], a[144:147], a[112:115], v[76:79]
    s_sub_u32 s82, s82, 1
    v_exp_f32 v102, v102
    v_mfma_f32_16x16x32_bf16 v[124:127], a[148:151], a[116:119], v[124:127]
    s_cmp_gt_u32 s12, s13
    s_cselect_b32 s82, s82, s12
    s_lshl_b32 s82, s82, 16
    ds_read_b128 a[136:139], v18 offset:18432
    v_mfma_f32_16x16x32_bf16 v[124:127], a[152:155], a[120:123], v[124:127]
    s_add_u32 s82, s82, s81
    v_exp_f32 v103, v103
    v_mfma_f32_16x16x32_bf16 v[124:127], a[156:159], a[124:127], v[124:127]
    s_cmp_ge_u32 s12, 17
    s_cselect_b32 s82, 2147471360, s82
    ds_read_b128 a[140:143], v18 offset:19456
    v_cvt_pk_bf16_f32 v51, v102, v103
    v_mfma_f32_16x16x32_bf16 v[40:43], v[28:31], v[56:59], v[40:43]
    s_add_u32 s12, s12, 1
    v_exp_f32 v104, v104
    v_mfma_f32_16x16x32_bf16 v[44:47], v[28:31], v[60:63], v[44:47]
    ds_read_b128 a[144:147], v18 offset:20480
    v_mfma_f32_16x16x32_bf16 v[192:195], a[160:163], v[56:59], v[192:195]
    v_exp_f32 v105, v105
    v_mfma_f32_16x16x32_bf16 v[224:227], a[160:163], v[60:63], v[224:227]
    ds_read_b128 a[148:151], v18 offset:21504
    v_cvt_pk_bf16_f32 v52, v104, v105
    v_mfma_f32_16x16x32_bf16 v[196:199], a[164:167], v[56:59], v[196:199]
    v_exp_f32 v106, v106
    v_mfma_f32_16x16x32_bf16 v[228:231], a[164:167], v[60:63], v[228:231]
    ds_read_b128 a[152:155], v18 offset:22528
    v_mfma_f32_16x16x32_bf16 v[200:203], a[168:171], v[56:59], v[200:203]
    v_exp_f32 v107, v107
    v_mfma_f32_16x16x32_bf16 v[232:235], a[168:171], v[60:63], v[232:235]
    ds_read_b128 a[156:159], v18 offset:23552
    v_cvt_pk_bf16_f32 v53, v106, v107
    v_mfma_f32_16x16x32_bf16 v[204:207], a[172:175], v[56:59], v[204:207]
    v_exp_f32 v108, v108
    v_mfma_f32_16x16x32_bf16 v[236:239], a[172:175], v[60:63], v[236:239]
    v_mfma_f32_16x16x32_bf16 v[208:211], a[176:179], v[56:59], v[208:211]
    v_exp_f32 v109, v109
    v_mfma_f32_16x16x32_bf16 v[240:243], a[176:179], v[60:63], v[240:243]
    v_cvt_pk_bf16_f32 v54, v108, v109
    v_xor_b32 v18, 196608, v18
    v_mfma_f32_16x16x32_bf16 v[212:215], a[180:183], v[56:59], v[212:215]
    v_exp_f32 v110, v110
    v_mfma_f32_16x16x32_bf16 v[244:247], a[180:183], v[60:63], v[244:247]
    v_mfma_f32_16x16x32_bf16 v[216:219], a[184:187], v[56:59], v[216:219]
    v_exp_f32 v111, v111
    v_mfma_f32_16x16x32_bf16 v[248:251], a[184:187], v[60:63], v[248:251]
    v_cvt_pk_bf16_f32 v55, v110, v111
    v_mfma_f32_16x16x32_bf16 v[220:223], a[188:191], v[56:59], v[220:223]
    v_mfma_f32_16x16x32_bf16 v[252:255], a[188:191], v[60:63], v[252:255]
    s_waitcnt vmcnt(0) lgkmcnt(0)
    s_barrier
    v_mfma_f32_16x16x32_bf16 v[96:99], a[128:131], a[64:67], v[64:67]
    s_add_u32 m0, s15, 0
    ds_read_b128 a[160:163], v19 offset:0
    v_mfma_f32_16x16x32_bf16 v[96:99], a[132:135], a[68:71], v[96:99]
    ds_read_b128 a[164:167], v19 offset:1024
    v_mfma_f32_16x16x32_bf16 v[96:99], a[136:139], a[72:75], v[96:99]
    v_exp_f32 v112, v112
    v_mfma_f32_16x16x32_bf16 v[96:99], a[140:143], a[76:79], v[96:99]
    buffer_load_dwordx4 v1, s[8:11], s82 offen offset:0 lds
    v_mfma_f32_16x16x32_bf16 v[104:107], a[128:131], a[80:83], v[68:71]
    v_exp_f32 v113, v113
    v_mfma_f32_16x16x32_bf16 v[104:107], a[132:135], a[84:87], v[104:107]
    ds_read_b128 a[168:171], v19 offset:2048
    v_cvt_pk_bf16_f32 v56, v112, v113
    v_mfma_f32_16x16x32_bf16 v[104:107], a[136:139], a[88:91], v[104:107]
    v_exp_f32 v114, v114
    v_mfma_f32_16x16x32_bf16 v[104:107], a[140:143], a[92:95], v[104:107]
    buffer_load_dwordx4 v1, s[8:11], s82 offen offset:1024 lds
    v_mfma_f32_16x16x32_bf16 v[100:103], a[144:147], a[64:67], v[64:67]
    v_exp_f32 v115, v115
    v_mfma_f32_16x16x32_bf16 v[100:103], a[148:151], a[68:71], v[100:103]
    ds_read_b128 a[172:175], v19 offset:3072
    v_cvt_pk_bf16_f32 v57, v114, v115
    v_mfma_f32_16x16x32_bf16 v[100:103], a[152:155], a[72:75], v[100:103]
    v_exp_f32 v116, v116
    v_mfma_f32_16x16x32_bf16 v[100:103], a[156:159], a[76:79], v[100:103]
    buffer_load_dwordx4 v1, s[8:11], s82 offen offset:2048 lds
    v_mfma_f32_16x16x32_bf16 v[108:111], a[144:147], a[80:83], v[68:71]
    v_exp_f32 v117, v117
    v_mfma_f32_16x16x32_bf16 v[108:111], a[148:151], a[84:87], v[108:111]
    ds_read_b128 a[176:179], v20 offset:4096
    v_cvt_pk_bf16_f32 v58, v116, v117
    v_mfma_f32_16x16x32_bf16 v[108:111], a[152:155], a[88:91], v[108:111]
    v_exp_f32 v118, v118
    v_mfma_f32_16x16x32_bf16 v[108:111], a[156:159], a[92:95], v[108:111]
    buffer_load_dwordx4 v1, s[8:11], s82 offen offset:3072 lds
    v_mfma_f32_16x16x32_bf16 v[32:35], v[28:31], v[48:51], v[32:35]
    s_add_u32 m0, s15, 4096
    v_exp_f32 v119, v119
    v_mfma_f32_16x16x32_bf16 v[36:39], v[28:31], v[52:55], v[36:39]
    s_waitcnt lgkmcnt(4)
    ds_read_b128 a[180:183], v20 offset:5120
    v_cvt_pk_bf16_f32 v59, v118, v119
    v_mfma_f32_16x16x32_bf16 v[128:131], a[160:163], v[48:51], v[128:131]
    v_exp_f32 v120, v120
    v_mfma_f32_16x16x32_bf16 v[160:163], a[160:163], v[52:55], v[160:163]
    s_waitcnt lgkmcnt(4)
    v_mfma_f32_16x16x32_bf16 v[132:135], a[164:167], v[48:51], v[132:135]
    v_exp_f32 v121, v121
    v_mfma_f32_16x16x32_bf16 v[164:167], a[164:167], v[52:55], v[164:167]
    s_waitcnt lgkmcnt(3)
    ds_read_b128 a[184:187], v20 offset:6144
    v_cvt_pk_bf16_f32 v60, v120, v121
    v_mfma_f32_16x16x32_bf16 v[136:139], a[168:171], v[48:51], v[136:139]
    s_waitcnt lgkmcnt(3)
    v_exp_f32 v122, v122
    v_mfma_f32_16x16x32_bf16 v[168:171], a[168:171], v[52:55], v[168:171]
    buffer_load_dwordx4 v15, s[8:11], s82 offen offset:0 lds
    v_mfma_f32_16x16x32_bf16 v[140:143], a[172:175], v[48:51], v[140:143]
    v_exp_f32 v123, v123
    v_mfma_f32_16x16x32_bf16 v[172:175], a[172:175], v[52:55], v[172:175]
    s_waitcnt lgkmcnt(2)
    ds_read_b128 a[188:191], v20 offset:7168
    v_cvt_pk_bf16_f32 v61, v122, v123
    v_mfma_f32_16x16x32_bf16 v[144:147], a[176:179], v[48:51], v[144:147]
    s_waitcnt lgkmcnt(2)
    v_exp_f32 v124, v124
    v_mfma_f32_16x16x32_bf16 v[176:179], a[176:179], v[52:55], v[176:179]
    buffer_load_dwordx4 v15, s[8:11], s82 offen offset:1024 lds
    v_mfma_f32_16x16x32_bf16 v[148:151], a[180:183], v[48:51], v[148:151]
    v_exp_f32 v125, v125
    v_mfma_f32_16x16x32_bf16 v[180:183], a[180:183], v[52:55], v[180:183]
    s_waitcnt lgkmcnt(1)
    v_cvt_pk_bf16_f32 v62, v124, v125
    v_mfma_f32_16x16x32_bf16 v[152:155], a[184:187], v[48:51], v[152:155]
    s_waitcnt lgkmcnt(0)
    v_exp_f32 v126, v126
    v_mfma_f32_16x16x32_bf16 v[184:187], a[184:187], v[52:55], v[184:187]
    buffer_load_dwordx4 v15, s[8:11], s82 offen offset:2048 lds
    v_mfma_f32_16x16x32_bf16 v[156:159], a[188:191], v[48:51], v[156:159]
    v_exp_f32 v127, v127
    v_mfma_f32_16x16x32_bf16 v[188:191], a[188:191], v[52:55], v[188:191]
    v_cvt_pk_bf16_f32 v63, v126, v127
    v_mfma_f32_16x16x32_bf16 v[112:115], a[128:131], a[96:99], v[72:75]
    v_mfma_f32_16x16x32_bf16 v[112:115], a[132:135], a[100:103], v[112:115]
    v_mfma_f32_16x16x32_bf16 v[112:115], a[136:139], a[104:107], v[112:115]
    v_exp_f32 v96, v96
    v_mfma_f32_16x16x32_bf16 v[112:115], a[140:143], a[108:111], v[112:115]
    buffer_load_dwordx4 v15, s[8:11], s82 offen offset:3072 lds
    v_mfma_f32_16x16x32_bf16 v[120:123], a[128:131], a[112:115], v[76:79]
    s_xor_b32 s15, s15, 196608
    v_exp_f32 v97, v97
    v_mfma_f32_16x16x32_bf16 v[120:123], a[132:135], a[116:119], v[120:123]
    s_add_u32 m0, s16, 0
    ds_read_b128 a[128:131], v18 offset:0
    v_cvt_pk_bf16_f32 v48, v96, v97
    v_mfma_f32_16x16x32_bf16 v[120:123], a[136:139], a[120:123], v[120:123]
    v_exp_f32 v98, v98
    v_mfma_f32_16x16x32_bf16 v[120:123], a[140:143], a[124:127], v[120:123]
    buffer_load_dwordx4 v1, s[8:11], s19 offen offset:0 lds
    v_mfma_f32_16x16x32_bf16 v[116:119], a[144:147], a[96:99], v[72:75]
    v_exp_f32 v99, v99
    v_mfma_f32_16x16x32_bf16 v[116:119], a[148:151], a[100:103], v[116:119]
    ds_read_b128 a[132:135], v18 offset:1024
    v_cvt_pk_bf16_f32 v49, v98, v99
    v_mfma_f32_16x16x32_bf16 v[116:119], a[152:155], a[104:107], v[116:119]
    v_exp_f32 v100, v100
    v_mfma_f32_16x16x32_bf16 v[116:119], a[156:159], a[108:111], v[116:119]
    buffer_load_dwordx4 v1, s[8:11], s19 offen offset:1024 lds
    v_mfma_f32_16x16x32_bf16 v[124:127], a[144:147], a[112:115], v[76:79]
    v_exp_f32 v101, v101
    v_mfma_f32_16x16x32_bf16 v[124:127], a[148:151], a[116:119], v[124:127]
    ds_read_b128 a[136:139], v18 offset:2048
    v_cvt_pk_bf16_f32 v50, v100, v101
    v_mfma_f32_16x16x32_bf16 v[124:127], a[152:155], a[120:123], v[124:127]
    v_exp_f32 v102, v102
    v_mfma_f32_16x16x32_bf16 v[124:127], a[156:159], a[124:127], v[124:127]
    buffer_load_dwordx4 v1, s[8:11], s19 offen offset:2048 lds
    v_mfma_f32_16x16x32_bf16 v[40:43], v[28:31], v[56:59], v[40:43]
    v_exp_f32 v103, v103
    v_mfma_f32_16x16x32_bf16 v[44:47], v[28:31], v[60:63], v[44:47]
    ds_read_b128 a[140:143], v18 offset:3072
    v_cvt_pk_bf16_f32 v51, v102, v103
    v_mfma_f32_16x16x32_bf16 v[192:195], a[160:163], v[56:59], v[192:195]
    v_exp_f32 v104, v104
    v_mfma_f32_16x16x32_bf16 v[224:227], a[160:163], v[60:63], v[224:227]
    v_mfma_f32_16x16x32_bf16 v[196:199], a[164:167], v[56:59], v[196:199]
    v_exp_f32 v105, v105
    v_mfma_f32_16x16x32_bf16 v[228:231], a[164:167], v[60:63], v[228:231]
    ds_read_b128 a[144:147], v18 offset:4096
    v_cvt_pk_bf16_f32 v52, v104, v105
    v_mfma_f32_16x16x32_bf16 v[200:203], a[168:171], v[56:59], v[200:203]
    v_exp_f32 v106, v106
    v_mfma_f32_16x16x32_bf16 v[232:235], a[168:171], v[60:63], v[232:235]
    buffer_load_dwordx4 v1, s[8:11], s19 offen offset:3072 lds
    v_mfma_f32_16x16x32_bf16 v[204:207], a[172:175], v[56:59], v[204:207]
    s_add_u32 m0, s16, 4096
    v_exp_f32 v107, v107
    v_mfma_f32_16x16x32_bf16 v[236:239], a[172:175], v[60:63], v[236:239]
    ds_read_b128 a[148:151], v18 offset:5120
    v_cvt_pk_bf16_f32 v53, v106, v107
    v_mfma_f32_16x16x32_bf16 v[208:211], a[176:179], v[56:59], v[208:211]
    s_sub_u32 s14, s14, 1
    v_exp_f32 v108, v108
    v_mfma_f32_16x16x32_bf16 v[240:243], a[176:179], v[60:63], v[240:243]
    buffer_load_dwordx4 v15, s[8:11], s19 offen offset:0 lds
    v_mfma_f32_16x16x32_bf16 v[212:215], a[180:183], v[56:59], v[212:215]
    v_exp_f32 v109, v109
    v_mfma_f32_16x16x32_bf16 v[244:247], a[180:183], v[60:63], v[244:247]
    ds_read_b128 a[152:155], v18 offset:6144
    v_cvt_pk_bf16_f32 v54, v108, v109
    v_mfma_f32_16x16x32_bf16 v[216:219], a[184:187], v[56:59], v[216:219]
    v_exp_f32 v110, v110
    v_mfma_f32_16x16x32_bf16 v[248:251], a[184:187], v[60:63], v[248:251]
    buffer_load_dwordx4 v15, s[8:11], s19 offen offset:1024 lds
    v_mfma_f32_16x16x32_bf16 v[220:223], a[188:191], v[56:59], v[220:223]
    v_exp_f32 v111, v111
    v_mfma_f32_16x16x32_bf16 v[252:255], a[188:191], v[60:63], v[252:255]
    ds_read_b128 a[156:159], v18 offset:7168
    v_cvt_pk_bf16_f32 v55, v110, v111
    s_cmp_lg_u32 s14, 0
    s_cbranch_scc1 L_t1_loop
L_t1_diag:
    s_waitcnt lgkmcnt(7)
    v_mfma_f32_16x16x32_bf16 v[96:99], a[128:131], a[64:67], v[80:83]
    s_waitcnt lgkmcnt(6)
    ds_read_b128 a[160:163], v19 offset:16384
    v_mfma_f32_16x16x32_bf16 v[96:99], a[132:135], a[68:71], v[96:99]
    s_waitcnt lgkmcnt(6)
    ds_read_b128 a[164:167], v19 offset:17408
    v_mfma_f32_16x16x32_bf16 v[96:99], a[136:139], a[72:75], v[96:99]
    s_waitcnt lgkmcnt(6)
    v_exp_f32 v112, v112
    v_mfma_f32_16x16x32_bf16 v[96:99], a[140:143], a[76:79], v[96:99]
    buffer_load_dwordx4 v15, s[8:11], s19 offen offset:2048 lds
    v_mfma_f32_16x16x32_bf16 v[104:107], a[128:131], a[80:83], v[88:91]
    v_exp_f32 v113, v113
    v_mfma_f32_16x16x32_bf16 v[104:107], a[132:135], a[84:87], v[104:107]
    ds_read_b128 a[168:171], v19 offset:18432
    v_cvt_pk_bf16_f32 v56, v112, v113
    v_mfma_f32_16x16x32_bf16 v[104:107], a[136:139], a[88:91], v[104:107]
    s_waitcnt lgkmcnt(6)
    v_exp_f32 v114, v114
    v_mfma_f32_16x16x32_bf16 v[104:107], a[140:143], a[92:95], v[104:107]
    buffer_load_dwordx4 v15, s[8:11], s19 offen offset:3072 lds
    v_mfma_f32_16x16x32_bf16 v[100:103], a[144:147], a[64:67], v[84:87]
    s_waitcnt lgkmcnt(5)
    s_xor_b32 s16, s16, 98304
    v_exp_f32 v115, v115
    v_mfma_f32_16x16x32_bf16 v[100:103], a[148:151], a[68:71], v[100:103]
    s_waitcnt lgkmcnt(4)
    ds_read_b128 a[172:175], v19 offset:19456
    v_cvt_pk_bf16_f32 v57, v114, v115
    v_mfma_f32_16x16x32_bf16 v[100:103], a[152:155], a[72:75], v[100:103]
    s_waitcnt lgkmcnt(4)
    v_exp_f32 v116, v116
    v_mfma_f32_16x16x32_bf16 v[100:103], a[156:159], a[76:79], v[100:103]
    v_mfma_f32_16x16x32_bf16 v[108:111], a[144:147], a[80:83], v[92:95]
    v_exp_f32 v117, v117
    v_mfma_f32_16x16x32_bf16 v[108:111], a[148:151], a[84:87], v[108:111]
    ds_read_b128 a[176:179], v20 offset:20480
    v_cvt_pk_bf16_f32 v58, v116, v117
    v_mfma_f32_16x16x32_bf16 v[108:111], a[152:155], a[88:91], v[108:111]
    v_exp_f32 v118, v118
    v_mfma_f32_16x16x32_bf16 v[108:111], a[156:159], a[92:95], v[108:111]
    v_mfma_f32_16x16x32_bf16 v[32:35], v[28:31], v[48:51], v[32:35]
    v_exp_f32 v119, v119
    v_mfma_f32_16x16x32_bf16 v[36:39], v[28:31], v[52:55], v[36:39]
    s_waitcnt lgkmcnt(4)
    ds_read_b128 a[180:183], v20 offset:21504
    v_cvt_pk_bf16_f32 v59, v118, v119
    v_mfma_f32_16x16x32_bf16 v[128:131], a[160:163], v[48:51], v[128:131]
    v_exp_f32 v120, v120
    v_mfma_f32_16x16x32_bf16 v[160:163], a[160:163], v[52:55], v[160:163]
    s_waitcnt lgkmcnt(4)
    v_add_f32 v80, 0, v22
    v_min_f32 v80, v80, v72
    v_mfma_f32_16x16x32_bf16 v[132:135], a[164:167], v[48:51], v[132:135]
    v_exp_f32 v121, v121
    v_mfma_f32_16x16x32_bf16 v[164:167], a[164:167], v[52:55], v[164:167]
    s_waitcnt lgkmcnt(3)
    ds_read_b128 a[184:187], v20 offset:22528
    v_cvt_pk_bf16_f32 v60, v120, v121
    v_mfma_f32_16x16x32_bf16 v[136:139], a[168:171], v[48:51], v[136:139]
    v_exp_f32 v122, v122
    v_mfma_f32_16x16x32_bf16 v[168:171], a[168:171], v[52:55], v[168:171]
    s_waitcnt lgkmcnt(3)
    v_add_f32 v81, 0xf1800000, v22
    v_min_f32 v81, v81, v73
    v_mfma_f32_16x16x32_bf16 v[140:143], a[172:175], v[48:51], v[140:143]
    v_exp_f32 v123, v123
    v_mfma_f32_16x16x32_bf16 v[172:175], a[172:175], v[52:55], v[172:175]
    s_waitcnt lgkmcnt(2)
    ds_read_b128 a[188:191], v20 offset:23552
    v_cvt_pk_bf16_f32 v61, v122, v123
    v_mfma_f32_16x16x32_bf16 v[144:147], a[176:179], v[48:51], v[144:147]
    v_exp_f32 v124, v124
    v_mfma_f32_16x16x32_bf16 v[176:179], a[176:179], v[52:55], v[176:179]
    s_waitcnt lgkmcnt(2)
    v_add_f32 v82, 0xf2000000, v22
    v_min_f32 v82, v82, v74
    v_mfma_f32_16x16x32_bf16 v[148:151], a[180:183], v[48:51], v[148:151]
    v_exp_f32 v125, v125
    v_mfma_f32_16x16x32_bf16 v[180:183], a[180:183], v[52:55], v[180:183]
    s_waitcnt lgkmcnt(1)
    v_cvt_pk_bf16_f32 v62, v124, v125
    v_xor_b32 v19, 98304, v19
    v_mfma_f32_16x16x32_bf16 v[152:155], a[184:187], v[48:51], v[152:155]
    v_exp_f32 v126, v126
    v_mfma_f32_16x16x32_bf16 v[184:187], a[184:187], v[52:55], v[184:187]
    s_waitcnt lgkmcnt(0)
    v_xor_b32 v20, 98304, v20
    v_add_f32 v83, 0xf2400000, v22
    v_mfma_f32_16x16x32_bf16 v[156:159], a[188:191], v[48:51], v[156:159]
    v_exp_f32 v127, v127
    v_mfma_f32_16x16x32_bf16 v[188:191], a[188:191], v[52:55], v[188:191]
    v_cvt_pk_bf16_f32 v63, v126, v127
    v_min_f32 v83, v83, v75
    v_add_f32 v84, 0xf3800000, v22
    v_min_f32 v84, v84, v72
    v_mfma_f32_16x16x32_bf16 v[112:115], a[128:131], a[96:99], v[72:75]
    v_exp_f32 v96, v96
    v_mfma_f32_16x16x32_bf16 v[112:115], a[132:135], a[100:103], v[112:115]
    v_mfma_f32_16x16x32_bf16 v[112:115], a[136:139], a[104:107], v[112:115]
    v_exp_f32 v97, v97
    v_mfma_f32_16x16x32_bf16 v[112:115], a[140:143], a[108:111], v[112:115]
    v_cvt_pk_bf16_f32 v48, v96, v97
    v_add_f32 v85, 0xf3880000, v22
    v_mfma_f32_16x16x32_bf16 v[120:123], a[128:131], a[112:115], v[76:79]
    v_exp_f32 v98, v98
    v_mfma_f32_16x16x32_bf16 v[120:123], a[132:135], a[116:119], v[120:123]
    v_min_f32 v85, v85, v73
    v_add_f32 v86, 0xf3900000, v22
    v_mfma_f32_16x16x32_bf16 v[120:123], a[136:139], a[120:123], v[120:123]
    v_exp_f32 v99, v99
    v_mfma_f32_16x16x32_bf16 v[120:123], a[140:143], a[124:127], v[120:123]
    v_min_f32 v86, v86, v74
    v_add_f32 v87, 0xf3980000, v22
    v_mfma_f32_16x16x32_bf16 v[116:119], a[144:147], a[96:99], v[72:75]
    v_exp_f32 v100, v100
    v_mfma_f32_16x16x32_bf16 v[116:119], a[148:151], a[100:103], v[116:119]
    ds_read_b128 a[128:131], v18 offset:16384
    v_cvt_pk_bf16_f32 v49, v98, v99
    v_mfma_f32_16x16x32_bf16 v[116:119], a[152:155], a[104:107], v[116:119]
    s_add_u32 s19, s82, 32768
    v_exp_f32 v101, v101
    v_mfma_f32_16x16x32_bf16 v[116:119], a[156:159], a[108:111], v[116:119]
    s_sub_u32 s82, s12, s13
    ds_read_b128 a[132:135], v18 offset:17408
    v_cvt_pk_bf16_f32 v50, v100, v101
    v_mfma_f32_16x16x32_bf16 v[124:127], a[144:147], a[112:115], v[76:79]
    s_sub_u32 s82, s82, 1
    v_exp_f32 v102, v102
    v_mfma_f32_16x16x32_bf16 v[124:127], a[148:151], a[116:119], v[124:127]
    s_cmp_gt_u32 s12, s13
    s_cselect_b32 s82, s82, s12
    s_lshl_b32 s82, s82, 16
    ds_read_b128 a[136:139], v18 offset:18432
    v_mfma_f32_16x16x32_bf16 v[124:127], a[152:155], a[120:123], v[124:127]
    s_add_u32 s82, s82, s81
    v_exp_f32 v103, v103
    v_mfma_f32_16x16x32_bf16 v[124:127], a[156:159], a[124:127], v[124:127]
    s_cmp_ge_u32 s12, 17
    s_cselect_b32 s82, 2147471360, s82
    ds_read_b128 a[140:143], v18 offset:19456
    v_cvt_pk_bf16_f32 v51, v102, v103
    v_mfma_f32_16x16x32_bf16 v[40:43], v[28:31], v[56:59], v[40:43]
    s_add_u32 s12, s12, 1
    v_exp_f32 v104, v104
    v_mfma_f32_16x16x32_bf16 v[44:47], v[28:31], v[60:63], v[44:47]
    ds_read_b128 a[144:147], v18 offset:20480
    v_min_f32 v87, v87, v75
    v_mfma_f32_16x16x32_bf16 v[192:195], a[160:163], v[56:59], v[192:195]
    v_exp_f32 v105, v105
    v_mfma_f32_16x16x32_bf16 v[224:227], a[160:163], v[60:63], v[224:227]
    ds_read_b128 a[148:151], v18 offset:21504
    v_cvt_pk_bf16_f32 v52, v104, v105
    v_mfma_f32_16x16x32_bf16 v[196:199], a[164:167], v[56:59], v[196:199]
    v_exp_f32 v106, v106
    v_mfma_f32_16x16x32_bf16 v[228:231], a[164:167], v[60:63], v[228:231]
    ds_read_b128 a[152:155], v18 offset:22528
    v_add_f32 v88, 0x73800000, v22
    v_mfma_f32_16x16x32_bf16 v[200:203], a[168:171], v[56:59], v[200:203]
    v_exp_f32 v107, v107
    v_mfma_f32_16x16x32_bf16 v[232:235], a[168:171], v[60:63], v[232:235]
    ds_read_b128 a[156:159], v18 offset:23552
    v_cvt_pk_bf16_f32 v53, v106, v107
    v_mfma_f32_16x16x32_bf16 v[204:207], a[172:175], v[56:59], v[204:207]
    v_exp_f32 v108, v108
    v_mfma_f32_16x16x32_bf16 v[236:239], a[172:175], v[60:63], v[236:239]
    v_min_f32 v88, v88, v76
    v_add_f32 v89, 0x73700000, v22
    v_mfma_f32_16x16x32_bf16 v[208:211], a[176:179], v[56:59], v[208:211]
    v_exp_f32 v109, v109
    v_mfma_f32_16x16x32_bf16 v[240:243], a[176:179], v[60:63], v[240:243]
    v_cvt_pk_bf16_f32 v54, v108, v109
    v_xor_b32 v18, 196608, v18
    v_mfma_f32_16x16x32_bf16 v[212:215], a[180:183], v[56:59], v[212:215]
    v_exp_f32 v110, v110
    v_mfma_f32_16x16x32_bf16 v[244:247], a[180:183], v[60:63], v[244:247]
    v_min_f32 v89, v89, v77
    v_add_f32 v90, 0x73600000, v22
    v_mfma_f32_16x16x32_bf16 v[216:219], a[184:187], v[56:59], v[216:219]
    v_exp_f32 v111, v111
    v_mfma_f32_16x16x32_bf16 v[248:251], a[184:187], v[60:63], v[248:251]
    v_cvt_pk_bf16_f32 v55, v110, v111
    v_min_f32 v90, v90, v78
    v_mfma_f32_16x16x32_bf16 v[220:223], a[188:191], v[56:59], v[220:223]
    v_add_f32 v91, 0x73500000, v22
    v_min_f32 v91, v91, v79
    v_mfma_f32_16x16x32_bf16 v[252:255], a[188:191], v[60:63], v[252:255]
    v_add_f32 v92, 0, v22
    v_min_f32 v92, v92, v76
    v_add_f32 v93, 0xf1800000, v22
    v_min_f32 v93, v93, v77
    v_add_f32 v94, 0xf2000000, v22
    v_min_f32 v94, v94, v78
    v_add_f32 v95, 0xf2400000, v22
    v_min_f32 v95, v95, v79
    s_waitcnt vmcnt(0) lgkmcnt(0)
    s_barrier
    v_mfma_f32_16x16x32_bf16 v[96:99], a[128:131], a[96:99], v[80:83]
    s_xor_b32 s100, s16, 8192
    ds_read_b128 a[176:179], v20 offset:4096
    v_lshrrev_b32 v13, 1, v1
    v_mfma_f32_16x16x32_bf16 v[96:99], a[132:135], a[100:103], v[96:99]
    s_add_u32 m0, s15, 0
    ds_read_b128 a[180:183], v20 offset:5120
    v_add_u32 v12, s100, v13
    v_mfma_f32_16x16x32_bf16 v[96:99], a[136:139], a[104:107], v[96:99]
    buffer_load_dwordx4 v1, s[8:11], s82 offen offset:0 lds
    v_exp_f32 v112, v112
    v_mfma_f32_16x16x32_bf16 v[96:99], a[140:143], a[108:111], v[96:99]
    v_exp_f32 v113, v113
    v_mfma_f32_16x16x32_bf16 v[100:103], a[144:147], a[96:99], v[84:87]
    ds_read_b128 a[184:187], v20 offset:6144
    v_cvt_pk_bf16_f32 v56, v112, v113
    v_mfma_f32_16x16x32_bf16 v[100:103], a[148:151], a[100:103], v[100:103]
    v_exp_f32 v114, v114
    v_mfma_f32_16x16x32_bf16 v[100:103], a[152:155], a[104:107], v[100:103]
    buffer_load_dwordx4 v1, s[8:11], s82 offen offset:1024 lds
    v_exp_f32 v115, v115
    v_mfma_f32_16x16x32_bf16 v[100:103], a[156:159], a[108:111], v[100:103]
    ds_read_b128 a[188:191], v20 offset:7168
    v_cvt_pk_bf16_f32 v57, v114, v115
    v_mfma_f32_16x16x32_bf16 v[104:107], a[128:131], a[112:115], v[88:91]
    v_exp_f32 v116, v116
    v_mfma_f32_16x16x32_bf16 v[104:107], a[132:135], a[116:119], v[104:107]
    v_exp_f32 v117, v117
    v_mfma_f32_16x16x32_bf16 v[104:107], a[136:139], a[120:123], v[104:107]
    ds_read_b128 a[160:163], v19 offset:0
    v_cvt_pk_bf16_f32 v58, v116, v117
    v_mfma_f32_16x16x32_bf16 v[104:107], a[140:143], a[124:127], v[104:107]
    buffer_load_dwordx4 v1, s[8:11], s82 offen offset:2048 lds
    v_exp_f32 v118, v118
    v_mfma_f32_16x16x32_bf16 v[108:111], a[144:147], a[112:115], v[92:95]
    v_exp_f32 v119, v119
    v_mfma_f32_16x16x32_bf16 v[108:111], a[148:151], a[116:119], v[108:111]
    ds_read_b128 a[164:167], v19 offset:1024
    v_cvt_pk_bf16_f32 v59, v118, v119
    v_mfma_f32_16x16x32_bf16 v[108:111], a[152:155], a[120:123], v[108:111]
    v_exp_f32 v120, v120
    v_mfma_f32_16x16x32_bf16 v[108:111], a[156:159], a[124:127], v[108:111]
    buffer_load_dwordx4 v1, s[8:11], s82 offen offset:3072 lds
    v_exp_f32 v121, v121
    v_mfma_f32_16x16x32_bf16 v[32:35], v[28:31], v[48:51], v[32:35]
    s_add_u32 m0, s15, 4096
    ds_read_b128 a[168:171], v19 offset:2048
    v_cvt_pk_bf16_f32 v60, v120, v121
    v_mfma_f32_16x16x32_bf16 v[36:39], v[28:31], v[52:55], v[36:39]
    s_waitcnt lgkmcnt(6)
    v_exp_f32 v122, v122
    v_mfma_f32_16x16x32_bf16 v[144:147], a[176:179], v[48:51], v[144:147]
    v_exp_f32 v123, v123
    v_mfma_f32_16x16x32_bf16 v[176:179], a[176:179], v[52:55], v[176:179]
    s_waitcnt lgkmcnt(5)
    ds_read_b128 a[172:175], v19 offset:3072
    v_cvt_pk_bf16_f32 v61, v122, v123
    v_mfma_f32_16x16x32_bf16 v[148:151], a[180:183], v[48:51], v[148:151]
    buffer_load_dwordx4 v15, s[8:11], s82 offen offset:0 lds
    v_exp_f32 v124, v124
    v_mfma_f32_16x16x32_bf16 v[180:183], a[180:183], v[52:55], v[180:183]
    s_waitcnt lgkmcnt(5)
    v_exp_f32 v125, v125
    v_mfma_f32_16x16x32_bf16 v[152:155], a[184:187], v[48:51], v[152:155]
    s_waitcnt lgkmcnt(4)
    v_exp_f32 v126, v126
    v_mfma_f32_16x16x32_bf16 v[184:187], a[184:187], v[52:55], v[184:187]
    buffer_load_dwordx4 v15, s[8:11], s82 offen offset:1024 lds
    v_exp_f32 v127, v127
    v_mfma_f32_16x16x32_bf16 v[156:159], a[188:191], v[48:51], v[156:159]
    ds_write_b128 v16, v[144:147] offset:32768
    v_cvt_pk_bf16_f32 v62, v124, v125
    v_mfma_f32_16x16x32_bf16 v[188:191], a[188:191], v[52:55], v[188:191]
    s_waitcnt lgkmcnt(4)
    v_exp_f32 v96, v96
    v_mfma_f32_16x16x32_bf16 v[128:131], a[160:163], v[48:51], v[128:131]
    v_exp_f32 v97, v97
    v_mfma_f32_16x16x32_bf16 v[160:163], a[160:163], v[52:55], v[160:163]
    s_waitcnt lgkmcnt(3)
    ds_write_b128 v16, v[176:179] offset:33792
    v_cvt_pk_bf16_f32 v63, v126, v127
    v_mfma_f32_16x16x32_bf16 v[132:135], a[164:167], v[48:51], v[132:135]
    s_waitcnt lgkmcnt(3)
    v_exp_f32 v98, v98
    v_mfma_f32_16x16x32_bf16 v[164:167], a[164:167], v[52:55], v[164:167]
    buffer_load_dwordx4 v15, s[8:11], s82 offen offset:2048 lds
    v_exp_f32 v99, v99
    v_mfma_f32_16x16x32_bf16 v[136:139], a[168:171], v[48:51], v[136:139]
    ds_write_b128 v16, v[148:151] offset:34816
    v_mfma_f32_16x16x32_bf16 v[168:171], a[168:171], v[52:55], v[168:171]
    s_waitcnt lgkmcnt(3)
    v_exp_f32 v100, v100
    v_mfma_f32_16x16x32_bf16 v[140:143], a[172:175], v[48:51], v[140:143]
    v_exp_f32 v101, v101
    v_mfma_f32_16x16x32_bf16 v[172:175], a[172:175], v[52:55], v[172:175]
    ds_write_b128 v16, v[180:183] offset:35840
    v_mov_b32 v33, v36
    v_mfma_f32_16x16x32_bf16 v[40:43], v[28:31], v[56:59], v[40:43]
    buffer_load_dwordx4 v15, s[8:11], s82 offen offset:3072 lds
    v_exp_f32 v102, v102
    v_mfma_f32_16x16x32_bf16 v[44:47], v[28:31], v[60:63], v[44:47]
    s_xor_b32 s15, s15, 196608
    v_exp_f32 v103, v103
    v_mfma_f32_16x16x32_bf16 v[208:211], a[176:179], v[56:59], v[208:211]
    ds_write_b128 v16, v[152:155] offset:36864
    v_cvt_pk_bf16_f32 v48, v96, v97
    v_mfma_f32_16x16x32_bf16 v[240:243], a[176:179], v[60:63], v[240:243]
    ds_read_b128 a[176:179], v20 offset:20480
    v_exp_f32 v104, v104
    v_mfma_f32_16x16x32_bf16 v[212:215], a[180:183], v[56:59], v[212:215]
    v_exp_f32 v105, v105
    v_mfma_f32_16x16x32_bf16 v[244:247], a[180:183], v[60:63], v[244:247]
    ds_read_b128 a[180:183], v20 offset:21504
    v_exp_f32 v106, v106
    v_mfma_f32_16x16x32_bf16 v[216:219], a[184:187], v[56:59], v[216:219]
    ds_write_b128 v16, v[184:187] offset:37888
    v_cvt_pk_bf16_f32 v49, v98, v99
    v_mfma_f32_16x16x32_bf16 v[248:251], a[184:187], v[60:63], v[248:251]
    ds_read_b128 a[184:187], v20 offset:22528
    v_exp_f32 v107, v107
    v_mfma_f32_16x16x32_bf16 v[220:223], a[188:191], v[56:59], v[220:223]
    v_exp_f32 v108, v108
    v_mfma_f32_16x16x32_bf16 v[252:255], a[188:191], v[60:63], v[252:255]
    ds_read_b128 a[188:191], v20 offset:23552
    v_exp_f32 v109, v109
    v_mfma_f32_16x16x32_bf16 v[192:195], a[160:163], v[56:59], v[192:195]
    ds_write_b128 v16, v[156:159] offset:38912
    v_cvt_pk_bf16_f32 v50, v100, v101
    v_mfma_f32_16x16x32_bf16 v[224:227], a[160:163], v[60:63], v[224:227]
    ds_read_b128 a[160:163], v19 offset:16384
    v_exp_f32 v110, v110
    v_mfma_f32_16x16x32_bf16 v[196:199], a[164:167], v[56:59], v[196:199]
    v_exp_f32 v111, v111
    v_mfma_f32_16x16x32_bf16 v[228:231], a[164:167], v[60:63], v[228:231]
    ds_read_b128 a[164:167], v19 offset:17408
    v_cvt_pk_bf16_f32 v51, v102, v103
    v_mfma_f32_16x16x32_bf16 v[200:203], a[168:171], v[56:59], v[200:203]
    ds_write_b128 v16, v[188:191] offset:39936
    v_cvt_pk_bf16_f32 v52, v104, v105
    v_mfma_f32_16x16x32_bf16 v[232:235], a[168:171], v[60:63], v[232:235]
    ds_read_b128 a[168:171], v19 offset:18432
    v_cvt_pk_bf16_f32 v53, v106, v107
    v_mfma_f32_16x16x32_bf16 v[204:207], a[172:175], v[56:59], v[204:207]
    v_cvt_pk_bf16_f32 v54, v108, v109
    v_cvt_pk_bf16_f32 v55, v110, v111
    v_mfma_f32_16x16x32_bf16 v[236:239], a[172:175], v[60:63], v[236:239]
    ds_read_b128 a[172:175], v19 offset:19456
    ds_write_b64 v12, v[32:33]
    s_xor_b32 s101, s16, 98304
    v_xor_b32 v12, 8192, v12
    v_add_u32 v9, s101, v1
    v_xor_b32 v8, 8192, v16
    v_xor_b32 v10, 8192, v9
L_t1_join:
    v_xor_b32 v19, 98304, v19
    v_xor_b32 v20, 98304, v20
    s_waitcnt lgkmcnt(0)
    s_barrier
    v_mfma_f32_16x16x32_bf16 v[40:43], v[28:31], v[48:51], v[40:43]
    s_lshl_b32 s100, s60, 20
    s_add_u32 s101, s100, s21
    ds_read_b64 v[120:121], v12
    v_mfma_f32_16x16x32_bf16 v[44:47], v[28:31], v[52:55], v[44:47]
    s_add_u32 s100, s100, s20
    ds_read_b128 v[144:147], v8 offset:32768
    v_lshrrev_b32 v11, 4, v2
    v_mfma_f32_16x16x32_bf16 v[208:211], a[176:179], v[48:51], v[208:211]
    ds_read_b128 v[176:179], v8 offset:33792
    v_lshrrev_b32 v13, 2, v1
    v_mfma_f32_16x16x32_bf16 v[240:243], a[176:179], v[52:55], v[240:243]
    ds_read_b128 v[148:151], v8 offset:34816
    v_add_u32 v13, 32768, v13
    v_mfma_f32_16x16x32_bf16 v[212:215], a[180:183], v[48:51], v[212:215]
    s_xor_b32 s99, s62, 8192
    ds_read_b128 v[180:183], v8 offset:35840
    v_add_u32 v14, s99, v13
    v_mfma_f32_16x16x32_bf16 v[244:247], a[180:183], v[52:55], v[244:247]
    ds_read_b128 v[152:155], v8 offset:36864
    v_cmp_eq_u32 vcc, 1, v11
    v_mfma_f32_16x16x32_bf16 v[216:219], a[184:187], v[48:51], v[216:219]
    ds_read_b128 v[184:187], v8 offset:37888
    s_waitcnt lgkmcnt(6)
    v_add_f32 v112, v120, v32
    v_mfma_f32_16x16x32_bf16 v[248:251], a[184:187], v[52:55], v[248:251]
    ds_read_b128 v[156:159], v8 offset:38912
    v_add_f32 v114, v121, v36
    v_mfma_f32_16x16x32_bf16 v[220:223], a[188:191], v[48:51], v[220:223]
    ds_read_b128 v[188:191], v8 offset:39936
    v_cndmask_b32 v12, v32, v36, vcc
    v_mfma_f32_16x16x32_bf16 v[252:255], a[188:191], v[52:55], v[252:255]
    v_rcp_f32 v112, v112
    v_mfma_f32_16x16x32_bf16 v[192:195], a[160:163], v[48:51], v[192:195]
    v_rcp_f32 v114, v114
    v_mfma_f32_16x16x32_bf16 v[224:227], a[160:163], v[52:55], v[224:227]
    v_cmp_eq_u32 vcc, 2, v11
    v_cmp_eq_u32 s[96:97], 3, v11
    v_mfma_f32_16x16x32_bf16 v[196:199], a[164:167], v[48:51], v[196:199]
    ds_write_b128 v9, v[208:211] offset:0
    v_mfma_f32_16x16x32_bf16 v[228:231], a[164:167], v[52:55], v[228:231]
    v_mfma_f32_16x16x32_bf16 v[200:203], a[168:171], v[48:51], v[200:203]
    ds_write_b128 v9, v[240:243] offset:1024
    v_mfma_f32_16x16x32_bf16 v[232:235], a[168:171], v[52:55], v[232:235]
    v_mfma_f32_16x16x32_bf16 v[204:207], a[172:175], v[48:51], v[204:207]
    ds_write_b128 v9, v[212:215] offset:2048
    v_mfma_f32_16x16x32_bf16 v[236:239], a[172:175], v[52:55], v[236:239]
    v_cndmask_b32 v12, v12, v40, vcc
    v_cndmask_b32 v12, v12, v44, s[96:97]
    ds_write_b128 v9, v[244:247] offset:3072
    s_waitcnt lgkmcnt(11)
    v_pk_add_f32 v[128:129], v[128:129], v[144:145]
    v_pk_add_f32 v[130:131], v[130:131], v[146:147]
    s_waitcnt lgkmcnt(9)
    v_pk_add_f32 v[132:133], v[132:133], v[148:149]
    v_pk_add_f32 v[134:135], v[134:135], v[150:151]
    v_pk_mul_f32 v[128:129], v[128:129], v[112:113] op_sel_hi:[1,0]
    v_pk_mul_f32 v[130:131], v[130:131], v[112:113] op_sel_hi:[1,0]
    v_pk_mul_f32 v[132:133], v[132:133], v[112:113] op_sel_hi:[1,0]
    v_pk_mul_f32 v[134:135], v[134:135], v[112:113] op_sel_hi:[1,0]
    v_cvt_pk_bf16_f32 v128, v128, v129
    v_cvt_pk_bf16_f32 v129, v130, v131
    v_cvt_pk_bf16_f32 v130, v132, v133
    s_add_u32 m0, s16, 0
    ds_write_b128 v9, v[216:219] offset:4096
    v_cvt_pk_bf16_f32 v131, v134, v135
    buffer_store_dwordx4 v[128:131], v1, s[8:11], s100 offen offset:0 sc0 sc1
    s_waitcnt lgkmcnt(8)
    v_pk_add_f32 v[136:137], v[136:137], v[152:153]
    v_pk_add_f32 v[138:139], v[138:139], v[154:155]
    s_waitcnt lgkmcnt(6)
    v_pk_add_f32 v[140:141], v[140:141], v[156:157]
    v_pk_add_f32 v[142:143], v[142:143], v[158:159]
    v_pk_mul_f32 v[136:137], v[136:137], v[112:113] op_sel_hi:[1,0]
    v_pk_mul_f32 v[138:139], v[138:139], v[112:113] op_sel_hi:[1,0]
    v_pk_mul_f32 v[140:141], v[140:141], v[112:113] op_sel_hi:[1,0]
    v_pk_mul_f32 v[142:143], v[142:143], v[112:113] op_sel_hi:[1,0]
    v_cvt_pk_bf16_f32 v136, v136, v137
    buffer_load_dwordx4 v1, s[8:11], s19 offen offset:0 lds
    ds_write_b128 v9, v[248:251] offset:5120
    v_cvt_pk_bf16_f32 v137, v138, v139
    v_cvt_pk_bf16_f32 v138, v140, v141
    v_cvt_pk_bf16_f32 v139, v142, v143
    buffer_store_dwordx4 v[136:139], v1, s[8:11], s100 offen offset:1024 sc0 sc1
    v_pk_add_f32 v[160:161], v[160:161], v[176:177]
    v_pk_add_f32 v[162:163], v[162:163], v[178:179]
    v_pk_add_f32 v[164:165], v[164:165], v[180:181]
    v_pk_add_f32 v[166:167], v[166:167], v[182:183]
    v_pk_mul_f32 v[160:161], v[160:161], v[114:115] op_sel_hi:[1,0]
    v_pk_mul_f32 v[162:163], v[162:163], v[114:115] op_sel_hi:[1,0]
    v_pk_mul_f32 v[164:165], v[164:165], v[114:115] op_sel_hi:[1,0]
    buffer_load_dwordx4 v1, s[8:11], s19 offen offset:1024 lds
    ds_write_b128 v9, v[220:223] offset:6144
    v_pk_mul_f32 v[166:167], v[166:167], v[114:115] op_sel_hi:[1,0]
    v_cvt_pk_bf16_f32 v160, v160, v161
    v_cvt_pk_bf16_f32 v161, v162, v163
    v_cvt_pk_bf16_f32 v162, v164, v165
    v_cvt_pk_bf16_f32 v163, v166, v167
    buffer_store_dwordx4 v[160:163], v15, s[8:11], s100 offen offset:0 sc0 sc1
    v_pk_add_f32 v[168:169], v[168:169], v[184:185]
    v_pk_add_f32 v[170:171], v[170:171], v[186:187]
    s_waitcnt lgkmcnt(7)
    v_pk_add_f32 v[172:173], v[172:173], v[188:189]
    v_pk_add_f32 v[174:175], v[174:175], v[190:191]
    v_pk_mul_f32 v[168:169], v[168:169], v[114:115] op_sel_hi:[1,0]
    buffer_load_dwordx4 v1, s[8:11], s19 offen offset:2048 lds
    ds_write_b128 v9, v[252:255] offset:7168
    v_pk_mul_f32 v[170:171], v[170:171], v[114:115] op_sel_hi:[1,0]
    v_pk_mul_f32 v[172:173], v[172:173], v[114:115] op_sel_hi:[1,0]
    v_pk_mul_f32 v[174:175], v[174:175], v[114:115] op_sel_hi:[1,0]
    v_cvt_pk_bf16_f32 v168, v168, v169
    v_cvt_pk_bf16_f32 v169, v170, v171
    v_cvt_pk_bf16_f32 v170, v172, v173
    v_cvt_pk_bf16_f32 v171, v174, v175
    buffer_store_dwordx4 v[168:171], v15, s[8:11], s100 offen offset:1024 sc0 sc1
    buffer_load_dwordx4 v1, s[8:11], s19 offen offset:3072 lds
    ds_write_b32 v14, v12
    v_and_b32 v14, 4294967103, v13
    v_add_u32 v14, s62, v14
    s_waitcnt lgkmcnt(0)
    s_barrier
    ds_read_b32 v116, v14 offset:128
    ds_read_b32 v118, v14 offset:192
    ds_read_b128 v[208:211], v10 offset:0
    ds_read_b128 v[212:215], v10 offset:2048
    ds_read_b128 v[216:219], v10 offset:4096
    ds_read_b128 v[220:223], v10 offset:6144
    ds_read_b128 v[240:243], v10 offset:1024
    ds_read_b128 v[244:247], v10 offset:3072
    ds_read_b128 v[248:251], v10 offset:5120
    ds_read_b128 v[252:255], v10 offset:7168
    ds_read_b32 v120, v13 offset:0
    ds_read_b32 v121, v13 offset:8192
    ds_read_b32 v122, v13 offset:16384
    ds_read_b32 v123, v13 offset:24576
    s_waitcnt lgkmcnt(13)
    v_add_f32 v116, v116, v40
    s_waitcnt lgkmcnt(12)
    v_add_f32 v118, v118, v44
    v_rcp_f32 v116, v116
    v_rcp_f32 v118, v118
    s_waitcnt lgkmcnt(11)
    v_pk_add_f32 v[192:193], v[192:193], v[208:209]
    v_pk_add_f32 v[194:195], v[194:195], v[210:211]
    s_waitcnt lgkmcnt(10)
    v_pk_add_f32 v[196:197], v[196:197], v[212:213]
    v_pk_add_f32 v[198:199], v[198:199], v[214:215]
    v_pk_mul_f32 v[192:193], v[192:193], v[116:117] op_sel_hi:[1,0]
    v_pk_mul_f32 v[194:195], v[194:195], v[116:117] op_sel_hi:[1,0]
    v_pk_mul_f32 v[196:197], v[196:197], v[116:117] op_sel_hi:[1,0]
    v_pk_mul_f32 v[198:199], v[198:199], v[116:117] op_sel_hi:[1,0]
    v_cvt_pk_bf16_f32 v192, v192, v193
    v_cvt_pk_bf16_f32 v193, v194, v195
    v_cvt_pk_bf16_f32 v194, v196, v197
    v_cvt_pk_bf16_f32 v195, v198, v199
    buffer_store_dwordx4 v[192:195], v1, s[8:11], s101 offen offset:0 sc0 sc1
    s_add_u32 m0, s16, 4096
    s_waitcnt lgkmcnt(9)
    v_pk_add_f32 v[200:201], v[200:201], v[216:217]
    v_pk_add_f32 v[202:203], v[202:203], v[218:219]
    s_waitcnt lgkmcnt(8)
    v_pk_add_f32 v[204:205], v[204:205], v[220:221]
    v_pk_add_f32 v[206:207], v[206:207], v[222:223]
    v_pk_mul_f32 v[200:201], v[200:201], v[116:117] op_sel_hi:[1,0]
    v_pk_mul_f32 v[202:203], v[202:203], v[116:117] op_sel_hi:[1,0]
    v_pk_mul_f32 v[204:205], v[204:205], v[116:117] op_sel_hi:[1,0]
    v_pk_mul_f32 v[206:207], v[206:207], v[116:117] op_sel_hi:[1,0]
    v_cvt_pk_bf16_f32 v200, v200, v201
    v_cvt_pk_bf16_f32 v201, v202, v203
    v_cvt_pk_bf16_f32 v202, v204, v205
    v_cvt_pk_bf16_f32 v203, v206, v207
    buffer_store_dwordx4 v[200:203], v1, s[8:11], s101 offen offset:1024 sc0 sc1
    buffer_load_dwordx4 v15, s[8:11], s19 offen offset:0 lds
    buffer_load_dwordx4 v15, s[8:11], s19 offen offset:1024 lds
    s_waitcnt lgkmcnt(2)
    v_add_f32 v120, v120, v121
    s_waitcnt lgkmcnt(0)
    v_add_f32 v122, v122, v123
    v_min_f32 v124, v120, v122
    v_add_f32 v120, v120, v122
    v_cmp_le_f32 vcc, 0x1f800000, v124
    s_mov_b64 s[96:97], vcc
    v_cmp_ge_f32 vcc, 0x67800000, v120
    s_and_b64 s[96:97], s[96:97], vcc
    s_cmp_eq_u64 s[96:97], -1
    s_cselect_b32 s96, s25, 1
    s_cmp_lg_u32 s96, 0
    s_cbranch_scc1 L_t1_redo
L_t1_safe:
    v_pk_add_f32 v[224:225], v[224:225], v[240:241]
    v_pk_add_f32 v[226:227], v[226:227], v[242:243]
    v_pk_add_f32 v[228:229], v[228:229], v[244:245]
    v_pk_add_f32 v[230:231], v[230:231], v[246:247]
    v_pk_mul_f32 v[224:225], v[224:225], v[118:119] op_sel_hi:[1,0]
    v_pk_mul_f32 v[226:227], v[226:227], v[118:119] op_sel_hi:[1,0]
    v_pk_mul_f32 v[228:229], v[228:229], v[118:119] op_sel_hi:[1,0]
    v_pk_mul_f32 v[230:231], v[230:231], v[118:119] op_sel_hi:[1,0]
    v_cvt_pk_bf16_f32 v224, v224, v225
    v_cvt_pk_bf16_f32 v225, v226, v227
    v_cvt_pk_bf16_f32 v226, v228, v229
    v_cvt_pk_bf16_f32 v227, v230, v231
    buffer_store_dwordx4 v[224:227], v15, s[8:11], s101 offen offset:0 sc0 sc1
    buffer_load_dwordx4 v15, s[8:11], s19 offen offset:2048 lds
    ds_read_b128 a[128:131], v18 offset:0
    ds_read_b128 a[132:135], v18 offset:1024
    ds_read_b128 a[136:139], v18 offset:2048
    ds_read_b128 a[140:143], v18 offset:3072
    v_pk_add_f32 v[232:233], v[232:233], v[248:249]
    v_pk_add_f32 v[234:235], v[234:235], v[250:251]
    v_pk_add_f32 v[236:237], v[236:237], v[252:253]
    v_pk_add_f32 v[238:239], v[238:239], v[254:255]
    v_pk_mul_f32 v[232:233], v[232:233], v[118:119] op_sel_hi:[1,0]
    v_pk_mul_f32 v[234:235], v[234:235], v[118:119] op_sel_hi:[1,0]
    v_pk_mul_f32 v[236:237], v[236:237], v[118:119] op_sel_hi:[1,0]
    v_pk_mul_f32 v[238:239], v[238:239], v[118:119] op_sel_hi:[1,0]
    v_cvt_pk_bf16_f32 v232, v232, v233
    v_cvt_pk_bf16_f32 v233, v234, v235
    v_cvt_pk_bf16_f32 v234, v236, v237
    v_cvt_pk_bf16_f32 v235, v238, v239
    buffer_store_dwordx4 v[232:235], v15, s[8:11], s101 offen offset:1024 sc0 sc1
    buffer_load_dwordx4 v15, s[8:11], s19 offen offset:3072 lds
    s_xor_b32 s16, s16, 98304
    ds_read_b128 a[144:147], v18 offset:4096
    ds_read_b128 a[148:151], v18 offset:5120
    ds_read_b128 a[152:155], v18 offset:6144
    ds_read_b128 a[156:159], v18 offset:7168
L_t2_start:
    s_waitcnt lgkmcnt(7)
    v_mfma_f32_16x16x32_bf16 v[96:99], a[128:131], a[192:195], v[64:67]
    s_waitcnt lgkmcnt(6)
    s_add_u32 s19, s82, 32768
    s_sub_u32 s82, s12, s13
    s_sub_u32 s82, s82, 1
    v_mfma_f32_16x16x32_bf16 v[96:99], a[132:135], a[196:199], v[96:99]
    s_waitcnt lgkmcnt(5)
    s_cmp_gt_u32 s12, s13
    s_cselect_b32 s82, s82, s12
    s_lshl_b32 s82, s82, 16
    s_add_u32 s82, s82, s81
    v_mfma_f32_16x16x32_bf16 v[96:99], a[136:139], a[200:203], v[96:99]
    s_waitcnt lgkmcnt(4)
    s_cmp_ge_u32 s12, 17
    s_cselect_b32 s82, 2147471360, s82
    s_add_u32 s12, s12, 1
    s_sub_u32 s14, s61, 8
    v_mfma_f32_16x16x32_bf16 v[96:99], a[140:143], a[204:207], v[96:99]
    s_waitcnt lgkmcnt(3)
    v_mfma_f32_16x16x32_bf16 v[100:103], a[144:147], a[192:195], v[64:67]
    s_waitcnt lgkmcnt(2)
    v_mfma_f32_16x16x32_bf16 v[100:103], a[148:151], a[196:199], v[100:103]
    s_waitcnt lgkmcnt(1)
    v_mfma_f32_16x16x32_bf16 v[100:103], a[152:155], a[200:203], v[100:103]
    s_waitcnt lgkmcnt(0)
    v_mfma_f32_16x16x32_bf16 v[100:103], a[156:159], a[204:207], v[100:103]
    v_mfma_f32_16x16x32_bf16 v[104:107], a[128:131], a[208:211], v[68:71]
    v_exp_f32 v96, v96
    v_mfma_f32_16x16x32_bf16 v[104:107], a[132:135], a[212:215], v[104:107]
    v_exp_f32 v97, v97
    v_mfma_f32_16x16x32_bf16 v[104:107], a[136:139], a[216:219], v[104:107]
    v_exp_f32 v98, v98
    v_mfma_f32_16x16x32_bf16 v[104:107], a[140:143], a[220:223], v[104:107]
    v_exp_f32 v99, v99
    v_mfma_f32_16x16x32_bf16 v[108:111], a[144:147], a[208:211], v[68:71]
    v_exp_f32 v100, v100
    v_mfma_f32_16x16x32_bf16 v[108:111], a[148:151], a[212:215], v[108:111]
    v_exp_f32 v101, v101
    v_mfma_f32_16x16x32_bf16 v[108:111], a[152:155], a[216:219], v[108:111]
    v_exp_f32 v102, v102
    v_mfma_f32_16x16x32_bf16 v[108:111], a[156:159], a[220:223], v[108:111]
    v_exp_f32 v103, v103
    v_mfma_f32_16x16x32_bf16 v[112:115], a[128:131], a[224:227], v[72:75]
    v_exp_f32 v104, v104
    v_mfma_f32_16x16x32_bf16 v[112:115], a[132:135], a[228:231], v[112:115]
    v_exp_f32 v105, v105
    v_mfma_f32_16x16x32_bf16 v[112:115], a[136:139], a[232:235], v[112:115]
    v_exp_f32 v106, v106
    v_mfma_f32_16x16x32_bf16 v[112:115], a[140:143], a[236:239], v[112:115]
    v_exp_f32 v107, v107
    v_mfma_f32_16x16x32_bf16 v[120:123], a[128:131], a[240:243], v[76:79]
    v_exp_f32 v108, v108
    v_mfma_f32_16x16x32_bf16 v[120:123], a[132:135], a[244:247], v[120:123]
    v_exp_f32 v109, v109
    v_mfma_f32_16x16x32_bf16 v[120:123], a[136:139], a[248:251], v[120:123]
    v_exp_f32 v110, v110
    v_mfma_f32_16x16x32_bf16 v[120:123], a[140:143], a[252:255], v[120:123]
    v_exp_f32 v111, v111
    v_mfma_f32_16x16x32_bf16 v[116:119], a[144:147], a[224:227], v[72:75]
    ds_read_b128 a[128:131], v18 offset:16384
    v_cvt_pk_bf16_f32 v48, v96, v97
    v_mfma_f32_16x16x32_bf16 v[116:119], a[148:151], a[228:231], v[116:119]
    ds_read_b128 a[132:135], v18 offset:17408
    v_cvt_pk_bf16_f32 v49, v98, v99
    v_mfma_f32_16x16x32_bf16 v[116:119], a[152:155], a[232:235], v[116:119]
    ds_read_b128 a[136:139], v18 offset:18432
    v_cvt_pk_bf16_f32 v50, v100, v101
    v_mfma_f32_16x16x32_bf16 v[116:119], a[156:159], a[236:239], v[116:119]
    ds_read_b128 a[140:143], v18 offset:19456
    v_cvt_pk_bf16_f32 v51, v102, v103
    v_mfma_f32_16x16x32_bf16 v[124:127], a[144:147], a[240:243], v[76:79]
    ds_read_b128 a[144:147], v18 offset:20480
    v_cvt_pk_bf16_f32 v52, v104, v105
    v_mfma_f32_16x16x32_bf16 v[124:127], a[148:151], a[244:247], v[124:127]
    ds_read_b128 a[148:151], v18 offset:21504
    v_cvt_pk_bf16_f32 v53, v106, v107
    v_mfma_f32_16x16x32_bf16 v[124:127], a[152:155], a[248:251], v[124:127]
    ds_read_b128 a[152:155], v18 offset:22528
    v_cvt_pk_bf16_f32 v54, v108, v109
    v_mfma_f32_16x16x32_bf16 v[124:127], a[156:159], a[252:255], v[124:127]
    ds_read_b128 a[156:159], v18 offset:23552
    v_cvt_pk_bf16_f32 v55, v110, v111
    v_xor_b32 v18, 196608, v18
    s_waitcnt vmcnt(0) lgkmcnt(0)
    s_barrier
    v_mfma_f32_16x16x32_bf16 v[96:99], a[128:131], a[192:195], v[64:67]
    s_add_u32 m0, s15, 0
    ds_read_b128 a[160:163], v19 offset:0
    v_mfma_f32_16x16x32_bf16 v[96:99], a[132:135], a[196:199], v[96:99]
    ds_read_b128 a[164:167], v19 offset:1024
    v_mfma_f32_16x16x32_bf16 v[96:99], a[136:139], a[200:203], v[96:99]
    v_exp_f32 v112, v112
    v_mfma_f32_16x16x32_bf16 v[96:99], a[140:143], a[204:207], v[96:99]
    buffer_load_dwordx4 v1, s[8:11], s82 offen offset:0 lds
    v_mfma_f32_16x16x32_bf16 v[104:107], a[128:131], a[208:211], v[68:71]
    v_exp_f32 v113, v113
    v_mfma_f32_16x16x32_bf16 v[104:107], a[132:135], a[212:215], v[104:107]
    ds_read_b128 a[168:171], v19 offset:2048
    v_cvt_pk_bf16_f32 v56, v112, v113
    v_mfma_f32_16x16x32_bf16 v[104:107], a[136:139], a[216:219], v[104:107]
    v_exp_f32 v114, v114
    v_mfma_f32_16x16x32_bf16 v[104:107], a[140:143], a[220:223], v[104:107]
    buffer_load_dwordx4 v1, s[8:11], s82 offen offset:1024 lds
    v_mfma_f32_16x16x32_bf16 v[100:103], a[144:147], a[192:195], v[64:67]
    v_exp_f32 v115, v115
    v_mfma_f32_16x16x32_bf16 v[100:103], a[148:151], a[196:199], v[100:103]
    ds_read_b128 a[172:175], v19 offset:3072
    v_cvt_pk_bf16_f32 v57, v114, v115
    v_mfma_f32_16x16x32_bf16 v[100:103], a[152:155], a[200:203], v[100:103]
    v_exp_f32 v116, v116
    v_mfma_f32_16x16x32_bf16 v[100:103], a[156:159], a[204:207], v[100:103]
    buffer_load_dwordx4 v1, s[8:11], s82 offen offset:2048 lds
    v_mfma_f32_16x16x32_bf16 v[108:111], a[144:147], a[208:211], v[68:71]
    v_exp_f32 v117, v117
    v_mfma_f32_16x16x32_bf16 v[108:111], a[148:151], a[212:215], v[108:111]
    ds_read_b128 a[176:179], v20 offset:4096
    v_cvt_pk_bf16_f32 v58, v116, v117
    v_mfma_f32_16x16x32_bf16 v[108:111], a[152:155], a[216:219], v[108:111]
    v_exp_f32 v118, v118
    v_mfma_f32_16x16x32_bf16 v[108:111], a[156:159], a[220:223], v[108:111]
    buffer_load_dwordx4 v1, s[8:11], s82 offen offset:3072 lds
    v_mfma_f32_16x16x32_bf16 v[32:35], v[28:31], v[48:51], 0
    s_add_u32 m0, s15, 4096
    v_exp_f32 v119, v119
    v_mfma_f32_16x16x32_bf16 v[36:39], v[28:31], v[52:55], 0
    s_waitcnt lgkmcnt(4)
    ds_read_b128 a[180:183], v20 offset:5120
    v_cvt_pk_bf16_f32 v59, v118, v119
    v_mfma_f32_16x16x32_bf16 v[128:131], a[160:163], v[48:51], 0
    v_exp_f32 v120, v120
    v_mfma_f32_16x16x32_bf16 v[160:163], a[160:163], v[52:55], 0
    s_waitcnt lgkmcnt(4)
    v_mfma_f32_16x16x32_bf16 v[132:135], a[164:167], v[48:51], 0
    v_exp_f32 v121, v121
    v_mfma_f32_16x16x32_bf16 v[164:167], a[164:167], v[52:55], 0
    s_waitcnt lgkmcnt(3)
    ds_read_b128 a[184:187], v20 offset:6144
    v_cvt_pk_bf16_f32 v60, v120, v121
    v_mfma_f32_16x16x32_bf16 v[136:139], a[168:171], v[48:51], 0
    s_waitcnt lgkmcnt(3)
    v_exp_f32 v122, v122
    v_mfma_f32_16x16x32_bf16 v[168:171], a[168:171], v[52:55], 0
    buffer_load_dwordx4 v15, s[8:11], s82 offen offset:0 lds
    v_mfma_f32_16x16x32_bf16 v[140:143], a[172:175], v[48:51], 0
    v_exp_f32 v123, v123
    v_mfma_f32_16x16x32_bf16 v[172:175], a[172:175], v[52:55], 0
    s_waitcnt lgkmcnt(2)
    ds_read_b128 a[188:191], v20 offset:7168
    v_cvt_pk_bf16_f32 v61, v122, v123
    v_mfma_f32_16x16x32_bf16 v[144:147], a[176:179], v[48:51], 0
    s_waitcnt lgkmcnt(2)
    v_exp_f32 v124, v124
    v_mfma_f32_16x16x32_bf16 v[176:179], a[176:179], v[52:55], 0
    buffer_load_dwordx4 v15, s[8:11], s82 offen offset:1024 lds
    v_mfma_f32_16x16x32_bf16 v[148:151], a[180:183], v[48:51], 0
    v_exp_f32 v125, v125
    v_mfma_f32_16x16x32_bf16 v[180:183], a[180:183], v[52:55], 0
    s_waitcnt lgkmcnt(1)
    v_cvt_pk_bf16_f32 v62, v124, v125
    v_mfma_f32_16x16x32_bf16 v[152:155], a[184:187], v[48:51], 0
    s_waitcnt lgkmcnt(0)
    v_exp_f32 v126, v126
    v_mfma_f32_16x16x32_bf16 v[184:187], a[184:187], v[52:55], 0
    buffer_load_dwordx4 v15, s[8:11], s82 offen offset:2048 lds
    v_mfma_f32_16x16x32_bf16 v[156:159], a[188:191], v[48:51], 0
    v_exp_f32 v127, v127
    v_mfma_f32_16x16x32_bf16 v[188:191], a[188:191], v[52:55], 0
    v_cvt_pk_bf16_f32 v63, v126, v127
    v_mfma_f32_16x16x32_bf16 v[112:115], a[128:131], a[224:227], v[72:75]
    v_mfma_f32_16x16x32_bf16 v[112:115], a[132:135], a[228:231], v[112:115]
    v_mfma_f32_16x16x32_bf16 v[112:115], a[136:139], a[232:235], v[112:115]
    v_exp_f32 v96, v96
    v_mfma_f32_16x16x32_bf16 v[112:115], a[140:143], a[236:239], v[112:115]
    buffer_load_dwordx4 v15, s[8:11], s82 offen offset:3072 lds
    v_mfma_f32_16x16x32_bf16 v[120:123], a[128:131], a[240:243], v[76:79]
    s_xor_b32 s15, s15, 196608
    v_exp_f32 v97, v97
    v_mfma_f32_16x16x32_bf16 v[120:123], a[132:135], a[244:247], v[120:123]
    s_add_u32 m0, s16, 0
    ds_read_b128 a[128:131], v18 offset:0
    v_cvt_pk_bf16_f32 v48, v96, v97
    v_mfma_f32_16x16x32_bf16 v[120:123], a[136:139], a[248:251], v[120:123]
    v_exp_f32 v98, v98
    v_mfma_f32_16x16x32_bf16 v[120:123], a[140:143], a[252:255], v[120:123]
    buffer_load_dwordx4 v1, s[8:11], s19 offen offset:0 lds
    v_mfma_f32_16x16x32_bf16 v[116:119], a[144:147], a[224:227], v[72:75]
    v_exp_f32 v99, v99
    v_mfma_f32_16x16x32_bf16 v[116:119], a[148:151], a[228:231], v[116:119]
    ds_read_b128 a[132:135], v18 offset:1024
    v_cvt_pk_bf16_f32 v49, v98, v99
    v_mfma_f32_16x16x32_bf16 v[116:119], a[152:155], a[232:235], v[116:119]
    v_exp_f32 v100, v100
    v_mfma_f32_16x16x32_bf16 v[116:119], a[156:159], a[236:239], v[116:119]
    buffer_load_dwordx4 v1, s[8:11], s19 offen offset:1024 lds
    v_mfma_f32_16x16x32_bf16 v[124:127], a[144:147], a[240:243], v[76:79]
    v_exp_f32 v101, v101
    v_mfma_f32_16x16x32_bf16 v[124:127], a[148:151], a[244:247], v[124:127]
    ds_read_b128 a[136:139], v18 offset:2048
    v_cvt_pk_bf16_f32 v50, v100, v101
    v_mfma_f32_16x16x32_bf16 v[124:127], a[152:155], a[248:251], v[124:127]
    v_exp_f32 v102, v102
    v_mfma_f32_16x16x32_bf16 v[124:127], a[156:159], a[252:255], v[124:127]
    buffer_load_dwordx4 v1, s[8:11], s19 offen offset:2048 lds
    v_mfma_f32_16x16x32_bf16 v[40:43], v[28:31], v[56:59], 0
    v_exp_f32 v103, v103
    v_mfma_f32_16x16x32_bf16 v[44:47], v[28:31], v[60:63], 0
    ds_read_b128 a[140:143], v18 offset:3072
    v_cvt_pk_bf16_f32 v51, v102, v103
    v_mfma_f32_16x16x32_bf16 v[192:195], a[160:163], v[56:59], 0
    v_exp_f32 v104, v104
    v_mfma_f32_16x16x32_bf16 v[224:227], a[160:163], v[60:63], 0
    v_mfma_f32_16x16x32_bf16 v[196:199], a[164:167], v[56:59], 0
    v_exp_f32 v105, v105
    v_mfma_f32_16x16x32_bf16 v[228:231], a[164:167], v[60:63], 0
    ds_read_b128 a[144:147], v18 offset:4096
    v_cvt_pk_bf16_f32 v52, v104, v105
    v_mfma_f32_16x16x32_bf16 v[200:203], a[168:171], v[56:59], 0
    v_exp_f32 v106, v106
    v_mfma_f32_16x16x32_bf16 v[232:235], a[168:171], v[60:63], 0
    buffer_load_dwordx4 v1, s[8:11], s19 offen offset:3072 lds
    v_mfma_f32_16x16x32_bf16 v[204:207], a[172:175], v[56:59], 0
    s_add_u32 m0, s16, 4096
    v_exp_f32 v107, v107
    v_mfma_f32_16x16x32_bf16 v[236:239], a[172:175], v[60:63], 0
    ds_read_b128 a[148:151], v18 offset:5120
    v_cvt_pk_bf16_f32 v53, v106, v107
    v_mfma_f32_16x16x32_bf16 v[208:211], a[176:179], v[56:59], 0
    v_exp_f32 v108, v108
    v_mfma_f32_16x16x32_bf16 v[240:243], a[176:179], v[60:63], 0
    buffer_load_dwordx4 v15, s[8:11], s19 offen offset:0 lds
    v_mfma_f32_16x16x32_bf16 v[212:215], a[180:183], v[56:59], 0
    v_exp_f32 v109, v109
    v_mfma_f32_16x16x32_bf16 v[244:247], a[180:183], v[60:63], 0
    ds_read_b128 a[152:155], v18 offset:6144
    v_cvt_pk_bf16_f32 v54, v108, v109
    v_mfma_f32_16x16x32_bf16 v[216:219], a[184:187], v[56:59], 0
    v_exp_f32 v110, v110
    v_mfma_f32_16x16x32_bf16 v[248:251], a[184:187], v[60:63], 0
    buffer_load_dwordx4 v15, s[8:11], s19 offen offset:1024 lds
    v_mfma_f32_16x16x32_bf16 v[220:223], a[188:191], v[56:59], 0
    v_exp_f32 v111, v111
    v_mfma_f32_16x16x32_bf16 v[252:255], a[188:191], v[60:63], 0
    ds_read_b128 a[156:159], v18 offset:7168
    v_cvt_pk_bf16_f32 v55, v110, v111
    s_waitcnt lgkmcnt(7)
    v_mfma_f32_16x16x32_bf16 v[96:99], a[128:131], a[192:195], v[64:67]
    s_waitcnt lgkmcnt(6)
    s_lshr_b32 s101, s2, 3
    s_sub_u32 s101, s101, 4
    ds_read_b128 a[160:163], v19 offset:16384
    v_mfma_f32_16x16x32_bf16 v[96:99], a[132:135], a[196:199], v[96:99]
    s_waitcnt lgkmcnt(6)
    s_and_b32 s101, s101, 31
    ds_read_b128 a[164:167], v19 offset:17408
    v_and_b32 v14, 7, v2
    v_mfma_f32_16x16x32_bf16 v[96:99], a[136:139], a[200:203], v[96:99]
    s_waitcnt lgkmcnt(6)
    v_exp_f32 v112, v112
    v_mfma_f32_16x16x32_bf16 v[96:99], a[140:143], a[204:207], v[96:99]
    buffer_load_dwordx4 v15, s[8:11], s19 offen offset:2048 lds
    v_mfma_f32_16x16x32_bf16 v[104:107], a[128:131], a[208:211], v[68:71]
    v_exp_f32 v113, v113
    v_mfma_f32_16x16x32_bf16 v[104:107], a[132:135], a[212:215], v[104:107]
    ds_read_b128 a[168:171], v19 offset:18432
    v_cvt_pk_bf16_f32 v56, v112, v113
    v_mfma_f32_16x16x32_bf16 v[104:107], a[136:139], a[216:219], v[104:107]
    s_waitcnt lgkmcnt(6)
    v_exp_f32 v114, v114
    v_mfma_f32_16x16x32_bf16 v[104:107], a[140:143], a[220:223], v[104:107]
    buffer_load_dwordx4 v15, s[8:11], s19 offen offset:3072 lds
    v_mfma_f32_16x16x32_bf16 v[100:103], a[144:147], a[192:195], v[64:67]
    s_waitcnt lgkmcnt(5)
    s_xor_b32 s16, s16, 98304
    v_exp_f32 v115, v115
    v_mfma_f32_16x16x32_bf16 v[100:103], a[148:151], a[196:199], v[100:103]
    s_waitcnt lgkmcnt(4)
    s_add_u32 s27, s18, 0
    ds_read_b128 a[172:175], v19 offset:19456
    v_cvt_pk_bf16_f32 v57, v114, v115
    v_mfma_f32_16x16x32_bf16 v[100:103], a[152:155], a[200:203], v[100:103]
    s_waitcnt lgkmcnt(4)
    v_exp_f32 v116, v116
    v_mfma_f32_16x16x32_bf16 v[100:103], a[156:159], a[204:207], v[100:103]
    buffer_store_dwordx4 v[24:27], v17, s[8:11], s27 offen offset:0 sc0 sc1
    v_mfma_f32_16x16x32_bf16 v[108:111], a[144:147], a[208:211], v[68:71]
    s_add_u32 s27, s18, 131072
    v_exp_f32 v117, v117
    v_mfma_f32_16x16x32_bf16 v[108:111], a[148:151], a[212:215], v[108:111]
    ds_read_b128 a[176:179], v20 offset:20480
    v_cvt_pk_bf16_f32 v58, v116, v117
    v_mfma_f32_16x16x32_bf16 v[108:111], a[152:155], a[216:219], v[108:111]
    v_exp_f32 v118, v118
    v_mfma_f32_16x16x32_bf16 v[108:111], a[156:159], a[220:223], v[108:111]
    buffer_store_dwordx4 v[24:27], v17, s[8:11], s27 offen offset:0 sc0 sc1
    v_mfma_f32_16x16x32_bf16 v[32:35], v[28:31], v[48:51], v[32:35]
    v_exp_f32 v119, v119
    v_mfma_f32_16x16x32_bf16 v[36:39], v[28:31], v[52:55], v[36:39]
    s_waitcnt lgkmcnt(4)
    ds_read_b128 a[180:183], v20 offset:21504
    v_cvt_pk_bf16_f32 v59, v118, v119
    v_mfma_f32_16x16x32_bf16 v[128:131], a[160:163], v[48:51], v[128:131]
    v_exp_f32 v120, v120
    v_mfma_f32_16x16x32_bf16 v[160:163], a[160:163], v[52:55], v[160:163]
    s_waitcnt lgkmcnt(4)
    v_lshlrev_b32 v14, 4, v14
    v_lshrrev_b32 v13, 3, v2
    v_mfma_f32_16x16x32_bf16 v[132:135], a[164:167], v[48:51], v[132:135]
    v_exp_f32 v121, v121
    v_mfma_f32_16x16x32_bf16 v[164:167], a[164:167], v[52:55], v[164:167]
    s_waitcnt lgkmcnt(3)
    ds_read_b128 a[184:187], v20 offset:22528
    v_cvt_pk_bf16_f32 v60, v120, v121
    v_mfma_f32_16x16x32_bf16 v[136:139], a[168:171], v[48:51], v[136:139]
    v_exp_f32 v122, v122
    v_mfma_f32_16x16x32_bf16 v[168:171], a[168:171], v[52:55], v[168:171]
    s_waitcnt lgkmcnt(3)
    v_lshl_add_u32 v12, v13, 13, v14
    v_mul_u32_u24 v13, 28672, v13
    v_mfma_f32_16x16x32_bf16 v[140:143], a[172:175], v[48:51], v[140:143]
    v_exp_f32 v123, v123
    v_mfma_f32_16x16x32_bf16 v[172:175], a[172:175], v[52:55], v[172:175]
    s_waitcnt lgkmcnt(2)
    ds_read_b128 a[188:191], v20 offset:23552
    v_cvt_pk_bf16_f32 v61, v122, v123
    v_mfma_f32_16x16x32_bf16 v[144:147], a[176:179], v[48:51], v[144:147]
    v_exp_f32 v124, v124
    v_mfma_f32_16x16x32_bf16 v[176:179], a[176:179], v[52:55], v[176:179]
    s_waitcnt lgkmcnt(2)
    v_add_u32 v13, v13, v14
    v_mfma_f32_16x16x32_bf16 v[148:151], a[180:183], v[48:51], v[148:151]
    s_lshl_b32 s17, s4, 2
    v_exp_f32 v125, v125
    v_mfma_f32_16x16x32_bf16 v[180:183], a[180:183], v[52:55], v[180:183]
    s_waitcnt lgkmcnt(1)
    s_add_u32 s17, s17, s3
    v_cvt_pk_bf16_f32 v62, v124, v125
    v_xor_b32 v19, 98304, v19
    v_mfma_f32_16x16x32_bf16 v[152:155], a[184:187], v[48:51], v[152:155]
    s_lshl_b32 s17, s17, 7
    v_exp_f32 v126, v126
    v_mfma_f32_16x16x32_bf16 v[184:187], a[184:187], v[52:55], v[184:187]
    s_waitcnt lgkmcnt(0)
    s_lshl_b32 s100, s101, 16
    s_add_u32 s17, s17, s100
    v_xor_b32 v20, 98304, v20
    v_mfma_f32_16x16x32_bf16 v[156:159], a[188:191], v[48:51], v[156:159]
    s_add_u32 s17, s17, 4194304
    v_exp_f32 v127, v127
    v_mfma_f32_16x16x32_bf16 v[188:191], a[188:191], v[52:55], v[188:191]
    s_cmp_lt_u32 s101, s26
    s_cselect_b32 s17, s17, 2143285248
    v_cvt_pk_bf16_f32 v63, v126, v127
    buffer_store_dwordx4 a[0:3], v12, s[8:11], s17 offen sc0 sc1
    v_mfma_f32_16x16x32_bf16 v[112:115], a[128:131], a[224:227], v[72:75]
    s_add_u32 s17, s17, 4096
    v_exp_f32 v96, v96
    v_mfma_f32_16x16x32_bf16 v[112:115], a[132:135], a[228:231], v[112:115]
    buffer_store_dwordx4 a[4:7], v12, s[8:11], s17 offen sc0 sc1
    v_mfma_f32_16x16x32_bf16 v[112:115], a[136:139], a[232:235], v[112:115]
    s_add_u32 s27, s18, 0
    v_exp_f32 v97, v97
    v_mfma_f32_16x16x32_bf16 v[112:115], a[140:143], a[236:239], v[112:115]
    v_cvt_pk_bf16_f32 v48, v96, v97
    v_lshrrev_b32 v9, 1, v2
    v_mfma_f32_16x16x32_bf16 v[120:123], a[128:131], a[240:243], v[76:79]
    v_exp_f32 v98, v98
    v_mfma_f32_16x16x32_bf16 v[120:123], a[132:135], a[244:247], v[120:123]
    buffer_store_dwordx4 v[24:27], v17, s[8:11], s27 offen offset:256 sc0 sc1
    v_mfma_f32_16x16x32_bf16 v[120:123], a[136:139], a[248:251], v[120:123]
    s_add_u32 s27, s18, 131072
    v_exp_f32 v99, v99
    v_mfma_f32_16x16x32_bf16 v[120:123], a[140:143], a[252:255], v[120:123]
    buffer_store_dwordx4 v[24:27], v17, s[8:11], s27 offen offset:256 sc0 sc1
    v_mfma_f32_16x16x32_bf16 v[116:119], a[144:147], a[224:227], v[72:75]
    s_add_u32 s27, s18, 0
    v_exp_f32 v100, v100
    v_mfma_f32_16x16x32_bf16 v[116:119], a[148:151], a[228:231], v[116:119]
    ds_read_b128 a[128:131], v18 offset:16384
    v_cvt_pk_bf16_f32 v49, v98, v99
    v_mfma_f32_16x16x32_bf16 v[116:119], a[152:155], a[232:235], v[116:119]
    s_add_u32 s19, s82, 32768
    v_exp_f32 v101, v101
    v_mfma_f32_16x16x32_bf16 v[116:119], a[156:159], a[236:239], v[116:119]
    s_sub_u32 s82, s12, s13
    ds_read_b128 a[132:135], v18 offset:17408
    v_cvt_pk_bf16_f32 v50, v100, v101
    v_mfma_f32_16x16x32_bf16 v[124:127], a[144:147], a[240:243], v[76:79]
    s_sub_u32 s82, s82, 1
    v_exp_f32 v102, v102
    v_mfma_f32_16x16x32_bf16 v[124:127], a[148:151], a[244:247], v[124:127]
    s_cmp_gt_u32 s12, s13
    s_cselect_b32 s82, s82, s12
    s_lshl_b32 s82, s82, 16
    ds_read_b128 a[136:139], v18 offset:18432
    v_mfma_f32_16x16x32_bf16 v[124:127], a[152:155], a[248:251], v[124:127]
    s_add_u32 s82, s82, s81
    v_exp_f32 v103, v103
    v_mfma_f32_16x16x32_bf16 v[124:127], a[156:159], a[252:255], v[124:127]
    s_cmp_ge_u32 s12, 17
    s_cselect_b32 s82, 2147471360, s82
    ds_read_b128 a[140:143], v18 offset:19456
    v_cvt_pk_bf16_f32 v51, v102, v103
    v_mfma_f32_16x16x32_bf16 v[40:43], v[28:31], v[56:59], v[40:43]
    s_add_u32 s12, s12, 1
    v_exp_f32 v104, v104
    v_mfma_f32_16x16x32_bf16 v[44:47], v[28:31], v[60:63], v[44:47]
    ds_read_b128 a[144:147], v18 offset:20480
    v_lshrrev_b32 v10, 4, v2
    v_mfma_f32_16x16x32_bf16 v[192:195], a[160:163], v[56:59], v[192:195]
    v_exp_f32 v105, v105
    v_mfma_f32_16x16x32_bf16 v[224:227], a[160:163], v[60:63], v[224:227]
    ds_read_b128 a[148:151], v18 offset:21504
    v_cvt_pk_bf16_f32 v52, v104, v105
    v_mfma_f32_16x16x32_bf16 v[196:199], a[164:167], v[56:59], v[196:199]
    v_exp_f32 v106, v106
    v_mfma_f32_16x16x32_bf16 v[228:231], a[164:167], v[60:63], v[228:231]
    ds_read_b128 a[152:155], v18 offset:22528
    v_xor_b32 v9, v9, v10
    v_mfma_f32_16x16x32_bf16 v[200:203], a[168:171], v[56:59], v[200:203]
    v_exp_f32 v107, v107
    v_mfma_f32_16x16x32_bf16 v[232:235], a[168:171], v[60:63], v[232:235]
    ds_read_b128 a[156:159], v18 offset:23552
    v_cvt_pk_bf16_f32 v53, v106, v107
    v_mfma_f32_16x16x32_bf16 v[204:207], a[172:175], v[56:59], v[204:207]
    v_exp_f32 v108, v108
    v_mfma_f32_16x16x32_bf16 v[236:239], a[172:175], v[60:63], v[236:239]
    buffer_store_dwordx4 v[24:27], v17, s[8:11], s27 offen offset:512 sc0 sc1
    v_mfma_f32_16x16x32_bf16 v[208:211], a[176:179], v[56:59], v[208:211]
    s_add_u32 s27, s18, 131072
    v_exp_f32 v109, v109
    v_mfma_f32_16x16x32_bf16 v[240:243], a[176:179], v[60:63], v[240:243]
    v_cvt_pk_bf16_f32 v54, v108, v109
    v_xor_b32 v18, 196608, v18
    v_mfma_f32_16x16x32_bf16 v[212:215], a[180:183], v[56:59], v[212:215]
    v_exp_f32 v110, v110
    v_mfma_f32_16x16x32_bf16 v[244:247], a[180:183], v[60:63], v[244:247]
    buffer_store_dwordx4 v[24:27], v17, s[8:11], s27 offen offset:512 sc0 sc1
    v_mfma_f32_16x16x32_bf16 v[216:219], a[184:187], v[56:59], v[216:219]
    s_add_u32 s27, s18, 0
    v_exp_f32 v111, v111
    v_mfma_f32_16x16x32_bf16 v[248:251], a[184:187], v[60:63], v[248:251]
    v_cvt_pk_bf16_f32 v55, v110, v111
    v_and_b32 v9, 3, v9
    v_mfma_f32_16x16x32_bf16 v[220:223], a[188:191], v[56:59], v[220:223]
    buffer_store_dwordx4 v[24:27], v17, s[8:11], s27 offen offset:768 sc0 sc1
    v_mfma_f32_16x16x32_bf16 v[252:255], a[188:191], v[60:63], v[252:255]
    v_lshlrev_b32 v9, 5, v9
    v_and_b32 v10, 1, v2
    v_lshl_add_u32 v9, v10, 4, v9
    v_lshrrev_b32 v8, 3, v2
    s_waitcnt vmcnt(9) lgkmcnt(0)
    s_barrier
    buffer_store_dword v6, v5, s[8:11], s22 offen sc0 sc1
    v_mfma_f32_16x16x32_bf16 v[96:99], a[128:131], a[192:195], v[64:67]
    s_add_u32 m0, s15, 0
    ds_read_b128 a[160:163], v19 offset:0
    v_mfma_f32_16x16x32_bf16 v[96:99], a[132:135], a[196:199], v[96:99]
    ds_read_b128 a[164:167], v19 offset:1024
    v_mfma_f32_16x16x32_bf16 v[96:99], a[136:139], a[200:203], v[96:99]
    v_exp_f32 v112, v112
    v_mfma_f32_16x16x32_bf16 v[96:99], a[140:143], a[204:207], v[96:99]
    buffer_load_dwordx4 v1, s[8:11], s82 offen offset:0 lds
    v_mfma_f32_16x16x32_bf16 v[104:107], a[128:131], a[208:211], v[68:71]
    v_exp_f32 v113, v113
    v_mfma_f32_16x16x32_bf16 v[104:107], a[132:135], a[212:215], v[104:107]
    ds_read_b128 a[168:171], v19 offset:2048
    v_cvt_pk_bf16_f32 v56, v112, v113
    v_mfma_f32_16x16x32_bf16 v[104:107], a[136:139], a[216:219], v[104:107]
    v_exp_f32 v114, v114
    v_mfma_f32_16x16x32_bf16 v[104:107], a[140:143], a[220:223], v[104:107]
    buffer_load_dwordx4 v1, s[8:11], s82 offen offset:1024 lds
    v_mfma_f32_16x16x32_bf16 v[100:103], a[144:147], a[192:195], v[64:67]
    v_exp_f32 v115, v115
    v_mfma_f32_16x16x32_bf16 v[100:103], a[148:151], a[196:199], v[100:103]
    ds_read_b128 a[172:175], v19 offset:3072
    v_cvt_pk_bf16_f32 v57, v114, v115
    v_mfma_f32_16x16x32_bf16 v[100:103], a[152:155], a[200:203], v[100:103]
    v_exp_f32 v116, v116
    v_mfma_f32_16x16x32_bf16 v[100:103], a[156:159], a[204:207], v[100:103]
    buffer_load_dwordx4 v1, s[8:11], s82 offen offset:2048 lds
    v_mfma_f32_16x16x32_bf16 v[108:111], a[144:147], a[208:211], v[68:71]
    v_exp_f32 v117, v117
    v_mfma_f32_16x16x32_bf16 v[108:111], a[148:151], a[212:215], v[108:111]
    ds_read_b128 a[176:179], v20 offset:4096
    v_cvt_pk_bf16_f32 v58, v116, v117
    v_mfma_f32_16x16x32_bf16 v[108:111], a[152:155], a[216:219], v[108:111]
    v_exp_f32 v118, v118
    v_mfma_f32_16x16x32_bf16 v[108:111], a[156:159], a[220:223], v[108:111]
    buffer_load_dwordx4 v1, s[8:11], s82 offen offset:3072 lds
    v_mfma_f32_16x16x32_bf16 v[32:35], v[28:31], v[48:51], v[32:35]
    s_add_u32 m0, s15, 4096
    v_exp_f32 v119, v119
    v_mfma_f32_16x16x32_bf16 v[36:39], v[28:31], v[52:55], v[36:39]
    s_waitcnt lgkmcnt(4)
    ds_read_b128 a[180:183], v20 offset:5120
    v_cvt_pk_bf16_f32 v59, v118, v119
    v_mfma_f32_16x16x32_bf16 v[128:131], a[160:163], v[48:51], v[128:131]
    v_exp_f32 v120, v120
    v_mfma_f32_16x16x32_bf16 v[160:163], a[160:163], v[52:55], v[160:163]
    s_waitcnt lgkmcnt(4)
    v_mfma_f32_16x16x32_bf16 v[132:135], a[164:167], v[48:51], v[132:135]
    v_exp_f32 v121, v121
    v_mfma_f32_16x16x32_bf16 v[164:167], a[164:167], v[52:55], v[164:167]
    s_waitcnt lgkmcnt(3)
    ds_read_b128 a[184:187], v20 offset:6144
    v_cvt_pk_bf16_f32 v60, v120, v121
    v_mfma_f32_16x16x32_bf16 v[136:139], a[168:171], v[48:51], v[136:139]
    s_waitcnt lgkmcnt(3)
    v_exp_f32 v122, v122
    v_mfma_f32_16x16x32_bf16 v[168:171], a[168:171], v[52:55], v[168:171]
    buffer_load_dwordx4 v15, s[8:11], s82 offen offset:0 lds
    v_mfma_f32_16x16x32_bf16 v[140:143], a[172:175], v[48:51], v[140:143]
    v_exp_f32 v123, v123
    v_mfma_f32_16x16x32_bf16 v[172:175], a[172:175], v[52:55], v[172:175]
    s_waitcnt lgkmcnt(2)
    ds_read_b128 a[188:191], v20 offset:7168
    v_cvt_pk_bf16_f32 v61, v122, v123
    v_mfma_f32_16x16x32_bf16 v[144:147], a[176:179], v[48:51], v[144:147]
    s_waitcnt lgkmcnt(2)
    v_exp_f32 v124, v124
    v_mfma_f32_16x16x32_bf16 v[176:179], a[176:179], v[52:55], v[176:179]
    buffer_load_dwordx4 v15, s[8:11], s82 offen offset:1024 lds
    v_mfma_f32_16x16x32_bf16 v[148:151], a[180:183], v[48:51], v[148:151]
    v_exp_f32 v125, v125
    v_mfma_f32_16x16x32_bf16 v[180:183], a[180:183], v[52:55], v[180:183]
    s_waitcnt lgkmcnt(1)
    v_cvt_pk_bf16_f32 v62, v124, v125
    v_mfma_f32_16x16x32_bf16 v[152:155], a[184:187], v[48:51], v[152:155]
    s_waitcnt lgkmcnt(0)
    v_exp_f32 v126, v126
    v_mfma_f32_16x16x32_bf16 v[184:187], a[184:187], v[52:55], v[184:187]
    buffer_load_dwordx4 v15, s[8:11], s82 offen offset:2048 lds
    v_mfma_f32_16x16x32_bf16 v[156:159], a[188:191], v[48:51], v[156:159]
    v_exp_f32 v127, v127
    v_mfma_f32_16x16x32_bf16 v[188:191], a[188:191], v[52:55], v[188:191]
    v_cvt_pk_bf16_f32 v63, v126, v127
    v_mfma_f32_16x16x32_bf16 v[112:115], a[128:131], a[224:227], v[72:75]
    v_mfma_f32_16x16x32_bf16 v[112:115], a[132:135], a[228:231], v[112:115]
    v_mfma_f32_16x16x32_bf16 v[112:115], a[136:139], a[232:235], v[112:115]
    v_exp_f32 v96, v96
    v_mfma_f32_16x16x32_bf16 v[112:115], a[140:143], a[236:239], v[112:115]
    buffer_load_dwordx4 v15, s[8:11], s82 offen offset:3072 lds
    v_mfma_f32_16x16x32_bf16 v[120:123], a[128:131], a[240:243], v[76:79]
    s_xor_b32 s15, s15, 196608
    v_exp_f32 v97, v97
    v_mfma_f32_16x16x32_bf16 v[120:123], a[132:135], a[244:247], v[120:123]
    s_add_u32 m0, s16, 0
    ds_read_b128 a[128:131], v18 offset:0
    v_cvt_pk_bf16_f32 v48, v96, v97
    v_mfma_f32_16x16x32_bf16 v[120:123], a[136:139], a[248:251], v[120:123]
    v_exp_f32 v98, v98
    v_mfma_f32_16x16x32_bf16 v[120:123], a[140:143], a[252:255], v[120:123]
    buffer_load_dwordx4 v1, s[8:11], s19 offen offset:0 lds
    v_mfma_f32_16x16x32_bf16 v[116:119], a[144:147], a[224:227], v[72:75]
    v_exp_f32 v99, v99
    v_mfma_f32_16x16x32_bf16 v[116:119], a[148:151], a[228:231], v[116:119]
    ds_read_b128 a[132:135], v18 offset:1024
    v_cvt_pk_bf16_f32 v49, v98, v99
    v_mfma_f32_16x16x32_bf16 v[116:119], a[152:155], a[232:235], v[116:119]
    v_exp_f32 v100, v100
    v_mfma_f32_16x16x32_bf16 v[116:119], a[156:159], a[236:239], v[116:119]
    buffer_load_dwordx4 v1, s[8:11], s19 offen offset:1024 lds
    v_mfma_f32_16x16x32_bf16 v[124:127], a[144:147], a[240:243], v[76:79]
    v_exp_f32 v101, v101
    v_mfma_f32_16x16x32_bf16 v[124:127], a[148:151], a[244:247], v[124:127]
    ds_read_b128 a[136:139], v18 offset:2048
    v_cvt_pk_bf16_f32 v50, v100, v101
    v_mfma_f32_16x16x32_bf16 v[124:127], a[152:155], a[248:251], v[124:127]
    v_exp_f32 v102, v102
    v_mfma_f32_16x16x32_bf16 v[124:127], a[156:159], a[252:255], v[124:127]
    buffer_load_dwordx4 v1, s[8:11], s19 offen offset:2048 lds
    v_mfma_f32_16x16x32_bf16 v[40:43], v[28:31], v[56:59], v[40:43]
    v_exp_f32 v103, v103
    v_mfma_f32_16x16x32_bf16 v[44:47], v[28:31], v[60:63], v[44:47]
    ds_read_b128 a[140:143], v18 offset:3072
    v_cvt_pk_bf16_f32 v51, v102, v103
    v_mfma_f32_16x16x32_bf16 v[192:195], a[160:163], v[56:59], v[192:195]
    v_exp_f32 v104, v104
    v_mfma_f32_16x16x32_bf16 v[224:227], a[160:163], v[60:63], v[224:227]
    v_mfma_f32_16x16x32_bf16 v[196:199], a[164:167], v[56:59], v[196:199]
    v_exp_f32 v105, v105
    v_mfma_f32_16x16x32_bf16 v[228:231], a[164:167], v[60:63], v[228:231]
    ds_read_b128 a[144:147], v18 offset:4096
    v_cvt_pk_bf16_f32 v52, v104, v105
    v_mfma_f32_16x16x32_bf16 v[200:203], a[168:171], v[56:59], v[200:203]
    v_exp_f32 v106, v106
    v_mfma_f32_16x16x32_bf16 v[232:235], a[168:171], v[60:63], v[232:235]
    buffer_load_dwordx4 v1, s[8:11], s19 offen offset:3072 lds
    v_mfma_f32_16x16x32_bf16 v[204:207], a[172:175], v[56:59], v[204:207]
    s_add_u32 m0, s16, 4096
    v_exp_f32 v107, v107
    v_mfma_f32_16x16x32_bf16 v[236:239], a[172:175], v[60:63], v[236:239]
    ds_read_b128 a[148:151], v18 offset:5120
    v_cvt_pk_bf16_f32 v53, v106, v107
    v_mfma_f32_16x16x32_bf16 v[208:211], a[176:179], v[56:59], v[208:211]
    v_exp_f32 v108, v108
    v_mfma_f32_16x16x32_bf16 v[240:243], a[176:179], v[60:63], v[240:243]
    buffer_load_dwordx4 v15, s[8:11], s19 offen offset:0 lds
    v_mfma_f32_16x16x32_bf16 v[212:215], a[180:183], v[56:59], v[212:215]
    v_exp_f32 v109, v109
    v_mfma_f32_16x16x32_bf16 v[244:247], a[180:183], v[60:63], v[244:247]
    ds_read_b128 a[152:155], v18 offset:6144
    v_cvt_pk_bf16_f32 v54, v108, v109
    v_mfma_f32_16x16x32_bf16 v[216:219], a[184:187], v[56:59], v[216:219]
    v_exp_f32 v110, v110
    v_mfma_f32_16x16x32_bf16 v[248:251], a[184:187], v[60:63], v[248:251]
    buffer_load_dwordx4 v15, s[8:11], s19 offen offset:1024 lds
    v_mfma_f32_16x16x32_bf16 v[220:223], a[188:191], v[56:59], v[220:223]
    v_exp_f32 v111, v111
    v_mfma_f32_16x16x32_bf16 v[252:255], a[188:191], v[60:63], v[252:255]
    ds_read_b128 a[156:159], v18 offset:7168
    v_cvt_pk_bf16_f32 v55, v110, v111
    s_waitcnt lgkmcnt(7)
    v_mfma_f32_16x16x32_bf16 v[96:99], a[128:131], a[192:195], v[64:67]
    s_waitcnt lgkmcnt(6)
    ds_read_b128 a[160:163], v19 offset:16384
    v_mfma_f32_16x16x32_bf16 v[96:99], a[132:135], a[196:199], v[96:99]
    s_waitcnt lgkmcnt(6)
    ds_read_b128 a[164:167], v19 offset:17408
    v_mfma_f32_16x16x32_bf16 v[96:99], a[136:139], a[200:203], v[96:99]
    s_waitcnt lgkmcnt(6)
    v_exp_f32 v112, v112
    v_mfma_f32_16x16x32_bf16 v[96:99], a[140:143], a[204:207], v[96:99]
    buffer_load_dwordx4 v15, s[8:11], s19 offen offset:2048 lds
    v_mfma_f32_16x16x32_bf16 v[104:107], a[128:131], a[208:211], v[68:71]
    v_exp_f32 v113, v113
    v_mfma_f32_16x16x32_bf16 v[104:107], a[132:135], a[212:215], v[104:107]
    ds_read_b128 a[168:171], v19 offset:18432
    v_cvt_pk_bf16_f32 v56, v112, v113
    v_mfma_f32_16x16x32_bf16 v[104:107], a[136:139], a[216:219], v[104:107]
    s_waitcnt lgkmcnt(6)
    v_exp_f32 v114, v114
    v_mfma_f32_16x16x32_bf16 v[104:107], a[140:143], a[220:223], v[104:107]
    buffer_load_dwordx4 v15, s[8:11], s19 offen offset:3072 lds
    v_mfma_f32_16x16x32_bf16 v[100:103], a[144:147], a[192:195], v[64:67]
    s_waitcnt lgkmcnt(5)
    s_xor_b32 s16, s16, 98304
    v_exp_f32 v115, v115
    v_mfma_f32_16x16x32_bf16 v[100:103], a[148:151], a[196:199], v[100:103]
    s_waitcnt lgkmcnt(4)
    s_add_u32 s17, s17, 2093056
    ds_read_b128 a[172:175], v19 offset:19456
    v_cvt_pk_bf16_f32 v57, v114, v115
    v_mfma_f32_16x16x32_bf16 v[100:103], a[152:155], a[200:203], v[100:103]
    s_waitcnt lgkmcnt(4)
    v_exp_f32 v116, v116
    v_mfma_f32_16x16x32_bf16 v[100:103], a[156:159], a[204:207], v[100:103]
    buffer_store_dwordx4 a[8:11], v12, s[8:11], s17 offen sc0 sc1
    v_mfma_f32_16x16x32_bf16 v[108:111], a[144:147], a[208:211], v[68:71]
    s_add_u32 s27, s18, 131072
    v_exp_f32 v117, v117
    v_mfma_f32_16x16x32_bf16 v[108:111], a[148:151], a[212:215], v[108:111]
    ds_read_b128 a[176:179], v20 offset:20480
    v_cvt_pk_bf16_f32 v58, v116, v117
    v_mfma_f32_16x16x32_bf16 v[108:111], a[152:155], a[216:219], v[108:111]
    v_exp_f32 v118, v118
    v_mfma_f32_16x16x32_bf16 v[108:111], a[156:159], a[220:223], v[108:111]
    buffer_store_dwordx4 v[24:27], v17, s[8:11], s27 offen offset:768 sc0 sc1
    v_mfma_f32_16x16x32_bf16 v[32:35], v[28:31], v[48:51], v[32:35]
    s_add_u32 s27, s18, 8388608
    v_exp_f32 v119, v119
    v_mfma_f32_16x16x32_bf16 v[36:39], v[28:31], v[52:55], v[36:39]
    s_waitcnt lgkmcnt(4)
    ds_read_b128 a[180:183], v20 offset:21504
    v_cvt_pk_bf16_f32 v59, v118, v119
    v_mfma_f32_16x16x32_bf16 v[128:131], a[160:163], v[48:51], v[128:131]
    s_waitcnt lgkmcnt(4)
    v_exp_f32 v120, v120
    v_mfma_f32_16x16x32_bf16 v[160:163], a[160:163], v[52:55], v[160:163]
    buffer_store_dwordx4 v[24:27], v17, s[8:11], s27 offen offset:0 sc0 sc1
    v_mfma_f32_16x16x32_bf16 v[132:135], a[164:167], v[48:51], v[132:135]
    s_add_u32 s27, s18, 8519680
    v_exp_f32 v121, v121
    v_mfma_f32_16x16x32_bf16 v[164:167], a[164:167], v[52:55], v[164:167]
    s_waitcnt lgkmcnt(3)
    ds_read_b128 a[184:187], v20 offset:22528
    v_cvt_pk_bf16_f32 v60, v120, v121
    v_mfma_f32_16x16x32_bf16 v[136:139], a[168:171], v[48:51], v[136:139]
    s_waitcnt lgkmcnt(3)
    v_exp_f32 v122, v122
    v_mfma_f32_16x16x32_bf16 v[168:171], a[168:171], v[52:55], v[168:171]
    buffer_store_dwordx4 v[24:27], v17, s[8:11], s27 offen offset:0 sc0 sc1
    v_mfma_f32_16x16x32_bf16 v[140:143], a[172:175], v[48:51], v[140:143]
    v_exp_f32 v123, v123
    v_mfma_f32_16x16x32_bf16 v[172:175], a[172:175], v[52:55], v[172:175]
    s_waitcnt lgkmcnt(2)
    ds_read_b128 a[188:191], v20 offset:23552
    v_cvt_pk_bf16_f32 v61, v122, v123
    v_mfma_f32_16x16x32_bf16 v[144:147], a[176:179], v[48:51], v[144:147]
    v_exp_f32 v124, v124
    v_mfma_f32_16x16x32_bf16 v[176:179], a[176:179], v[52:55], v[176:179]
    s_waitcnt lgkmcnt(2)
    v_mfma_f32_16x16x32_bf16 v[148:151], a[180:183], v[48:51], v[148:151]
    v_exp_f32 v125, v125
    v_mfma_f32_16x16x32_bf16 v[180:183], a[180:183], v[52:55], v[180:183]
    s_waitcnt lgkmcnt(1)
    v_cvt_pk_bf16_f32 v62, v124, v125
    v_xor_b32 v19, 98304, v19
    v_mfma_f32_16x16x32_bf16 v[152:155], a[184:187], v[48:51], v[152:155]
    v_exp_f32 v126, v126
    v_mfma_f32_16x16x32_bf16 v[184:187], a[184:187], v[52:55], v[184:187]
    s_waitcnt lgkmcnt(0)
    v_xor_b32 v20, 98304, v20
    v_mfma_f32_16x16x32_bf16 v[156:159], a[188:191], v[48:51], v[156:159]
    v_exp_f32 v127, v127
    v_mfma_f32_16x16x32_bf16 v[188:191], a[188:191], v[52:55], v[188:191]
    v_cvt_pk_bf16_f32 v63, v126, v127
    v_mfma_f32_16x16x32_bf16 v[112:115], a[128:131], a[224:227], v[72:75]
    s_add_u32 s17, s17, 4096
    v_exp_f32 v96, v96
    v_mfma_f32_16x16x32_bf16 v[112:115], a[132:135], a[228:231], v[112:115]
    buffer_store_dwordx4 a[12:15], v12, s[8:11], s17 offen sc0 sc1
    v_mfma_f32_16x16x32_bf16 v[112:115], a[136:139], a[232:235], v[112:115]
    s_add_u32 s27, s18, 8388608
    v_exp_f32 v97, v97
    v_mfma_f32_16x16x32_bf16 v[112:115], a[140:143], a[236:239], v[112:115]
    v_cvt_pk_bf16_f32 v48, v96, v97
    v_lshl_add_u32 v8, v8, 10, v9
    v_mfma_f32_16x16x32_bf16 v[120:123], a[128:131], a[240:243], v[76:79]
    v_exp_f32 v98, v98
    v_mfma_f32_16x16x32_bf16 v[120:123], a[132:135], a[244:247], v[120:123]
    buffer_store_dwordx4 v[24:27], v17, s[8:11], s27 offen offset:256 sc0 sc1
    v_mfma_f32_16x16x32_bf16 v[120:123], a[136:139], a[248:251], v[120:123]
    s_add_u32 s27, s18, 8519680
    v_exp_f32 v99, v99
    v_mfma_f32_16x16x32_bf16 v[120:123], a[140:143], a[252:255], v[120:123]
    buffer_store_dwordx4 v[24:27], v17, s[8:11], s27 offen offset:256 sc0 sc1
    v_mfma_f32_16x16x32_bf16 v[116:119], a[144:147], a[224:227], v[72:75]
    s_add_u32 s27, s18, 8388608
    v_exp_f32 v100, v100
    v_mfma_f32_16x16x32_bf16 v[116:119], a[148:151], a[228:231], v[116:119]
    ds_read_b128 a[128:131], v18 offset:16384
    v_cvt_pk_bf16_f32 v49, v98, v99
    v_mfma_f32_16x16x32_bf16 v[116:119], a[152:155], a[232:235], v[116:119]
    s_add_u32 s19, s82, 32768
    v_exp_f32 v101, v101
    v_mfma_f32_16x16x32_bf16 v[116:119], a[156:159], a[236:239], v[116:119]
    s_sub_u32 s82, s12, s13
    ds_read_b128 a[132:135], v18 offset:17408
    v_cvt_pk_bf16_f32 v50, v100, v101
    v_mfma_f32_16x16x32_bf16 v[124:127], a[144:147], a[240:243], v[76:79]
    s_sub_u32 s82, s82, 1
    v_exp_f32 v102, v102
    v_mfma_f32_16x16x32_bf16 v[124:127], a[148:151], a[244:247], v[124:127]
    s_cmp_gt_u32 s12, s13
    s_cselect_b32 s82, s82, s12
    s_lshl_b32 s82, s82, 16
    ds_read_b128 a[136:139], v18 offset:18432
    v_mfma_f32_16x16x32_bf16 v[124:127], a[152:155], a[248:251], v[124:127]
    s_add_u32 s82, s82, s81
    v_exp_f32 v103, v103
    v_mfma_f32_16x16x32_bf16 v[124:127], a[156:159], a[252:255], v[124:127]
    s_cmp_ge_u32 s12, 17
    s_cselect_b32 s82, 2147471360, s82
    ds_read_b128 a[140:143], v18 offset:19456
    v_cvt_pk_bf16_f32 v51, v102, v103
    v_mfma_f32_16x16x32_bf16 v[40:43], v[28:31], v[56:59], v[40:43]
    s_add_u32 s12, s12, 1
    v_exp_f32 v104, v104
    v_mfma_f32_16x16x32_bf16 v[44:47], v[28:31], v[60:63], v[44:47]
    ds_read_b128 a[144:147], v18 offset:20480
    v_bfe_u32 v4, v2, 1, 2
    v_mfma_f32_16x16x32_bf16 v[192:195], a[160:163], v[56:59], v[192:195]
    v_exp_f32 v105, v105
    v_mfma_f32_16x16x32_bf16 v[224:227], a[160:163], v[60:63], v[224:227]
    ds_read_b128 a[148:151], v18 offset:21504
    v_cvt_pk_bf16_f32 v52, v104, v105
    v_mfma_f32_16x16x32_bf16 v[196:199], a[164:167], v[56:59], v[196:199]
    v_exp_f32 v106, v106
    v_mfma_f32_16x16x32_bf16 v[228:231], a[164:167], v[60:63], v[228:231]
    ds_read_b128 a[152:155], v18 offset:22528
    v_lshlrev_b32 v4, 11, v4
    v_mfma_f32_16x16x32_bf16 v[200:203], a[168:171], v[56:59], v[200:203]
    v_exp_f32 v107, v107
    v_mfma_f32_16x16x32_bf16 v[232:235], a[168:171], v[60:63], v[232:235]
    ds_read_b128 a[156:159], v18 offset:23552
    v_cvt_pk_bf16_f32 v53, v106, v107
    v_mfma_f32_16x16x32_bf16 v[204:207], a[172:175], v[56:59], v[204:207]
    v_exp_f32 v108, v108
    v_mfma_f32_16x16x32_bf16 v[236:239], a[172:175], v[60:63], v[236:239]
    buffer_store_dwordx4 v[24:27], v17, s[8:11], s27 offen offset:512 sc0 sc1
    v_mfma_f32_16x16x32_bf16 v[208:211], a[176:179], v[56:59], v[208:211]
    s_add_u32 s27, s18, 8519680
    v_exp_f32 v109, v109
    v_mfma_f32_16x16x32_bf16 v[240:243], a[176:179], v[60:63], v[240:243]
    v_cvt_pk_bf16_f32 v54, v108, v109
    v_xor_b32 v18, 196608, v18
    v_mfma_f32_16x16x32_bf16 v[212:215], a[180:183], v[56:59], v[212:215]
    v_exp_f32 v110, v110
    v_mfma_f32_16x16x32_bf16 v[244:247], a[180:183], v[60:63], v[244:247]
    buffer_store_dwordx4 v[24:27], v17, s[8:11], s27 offen offset:512 sc0 sc1
    v_mfma_f32_16x16x32_bf16 v[216:219], a[184:187], v[56:59], v[216:219]
    v_exp_f32 v111, v111
    v_mfma_f32_16x16x32_bf16 v[248:251], a[184:187], v[60:63], v[248:251]
    v_cvt_pk_bf16_f32 v55, v110, v111
    v_lshl_add_u32 v4, v10, 6, v4
    v_mfma_f32_16x16x32_bf16 v[220:223], a[188:191], v[56:59], v[220:223]
    v_add_u32 v9, 7168, v8
    v_add_u32 v10, 14336, v8
    v_mfma_f32_16x16x32_bf16 v[252:255], a[188:191], v[60:63], v[252:255]
    v_add_u32 v11, 21504, v8
    s_waitcnt vmcnt(9) lgkmcnt(0)
    s_barrier
    v_mfma_f32_16x16x32_bf16 v[96:99], a[128:131], a[192:195], v[64:67]
    s_add_u32 m0, s15, 0
    ds_read_b128 a[160:163], v19 offset:0
    v_mfma_f32_16x16x32_bf16 v[96:99], a[132:135], a[196:199], v[96:99]
    ds_read_b128 a[164:167], v19 offset:1024
    v_mfma_f32_16x16x32_bf16 v[96:99], a[136:139], a[200:203], v[96:99]
    v_exp_f32 v112, v112
    v_mfma_f32_16x16x32_bf16 v[96:99], a[140:143], a[204:207], v[96:99]
    buffer_load_dwordx4 v1, s[8:11], s82 offen offset:0 lds
    v_mfma_f32_16x16x32_bf16 v[104:107], a[128:131], a[208:211], v[68:71]
    v_exp_f32 v113, v113
    v_mfma_f32_16x16x32_bf16 v[104:107], a[132:135], a[212:215], v[104:107]
    ds_read_b128 a[168:171], v19 offset:2048
    v_cvt_pk_bf16_f32 v56, v112, v113
    v_mfma_f32_16x16x32_bf16 v[104:107], a[136:139], a[216:219], v[104:107]
    v_exp_f32 v114, v114
    v_mfma_f32_16x16x32_bf16 v[104:107], a[140:143], a[220:223], v[104:107]
    buffer_load_dwordx4 v1, s[8:11], s82 offen offset:1024 lds
    v_mfma_f32_16x16x32_bf16 v[100:103], a[144:147], a[192:195], v[64:67]
    v_exp_f32 v115, v115
    v_mfma_f32_16x16x32_bf16 v[100:103], a[148:151], a[196:199], v[100:103]
    ds_read_b128 a[172:175], v19 offset:3072
    v_cvt_pk_bf16_f32 v57, v114, v115
    v_mfma_f32_16x16x32_bf16 v[100:103], a[152:155], a[200:203], v[100:103]
    v_exp_f32 v116, v116
    v_mfma_f32_16x16x32_bf16 v[100:103], a[156:159], a[204:207], v[100:103]
    buffer_load_dwordx4 v1, s[8:11], s82 offen offset:2048 lds
    v_mfma_f32_16x16x32_bf16 v[108:111], a[144:147], a[208:211], v[68:71]
    v_exp_f32 v117, v117
    v_mfma_f32_16x16x32_bf16 v[108:111], a[148:151], a[212:215], v[108:111]
    ds_read_b128 a[176:179], v20 offset:4096
    v_cvt_pk_bf16_f32 v58, v116, v117
    v_mfma_f32_16x16x32_bf16 v[108:111], a[152:155], a[216:219], v[108:111]
    v_exp_f32 v118, v118
    v_mfma_f32_16x16x32_bf16 v[108:111], a[156:159], a[220:223], v[108:111]
    buffer_load_dwordx4 v1, s[8:11], s82 offen offset:3072 lds
    v_mfma_f32_16x16x32_bf16 v[32:35], v[28:31], v[48:51], v[32:35]
    s_add_u32 m0, s15, 4096
    v_exp_f32 v119, v119
    v_mfma_f32_16x16x32_bf16 v[36:39], v[28:31], v[52:55], v[36:39]
    s_waitcnt lgkmcnt(4)
    ds_read_b128 a[180:183], v20 offset:5120
    v_cvt_pk_bf16_f32 v59, v118, v119
    v_mfma_f32_16x16x32_bf16 v[128:131], a[160:163], v[48:51], v[128:131]
    v_exp_f32 v120, v120
    v_mfma_f32_16x16x32_bf16 v[160:163], a[160:163], v[52:55], v[160:163]
    s_waitcnt lgkmcnt(4)
    v_mfma_f32_16x16x32_bf16 v[132:135], a[164:167], v[48:51], v[132:135]
    v_exp_f32 v121, v121
    v_mfma_f32_16x16x32_bf16 v[164:167], a[164:167], v[52:55], v[164:167]
    s_waitcnt lgkmcnt(3)
    ds_read_b128 a[184:187], v20 offset:6144
    v_cvt_pk_bf16_f32 v60, v120, v121
    v_mfma_f32_16x16x32_bf16 v[136:139], a[168:171], v[48:51], v[136:139]
    s_waitcnt lgkmcnt(3)
    v_exp_f32 v122, v122
    v_mfma_f32_16x16x32_bf16 v[168:171], a[168:171], v[52:55], v[168:171]
    buffer_load_dwordx4 v15, s[8:11], s82 offen offset:0 lds
    v_mfma_f32_16x16x32_bf16 v[140:143], a[172:175], v[48:51], v[140:143]
    v_exp_f32 v123, v123
    v_mfma_f32_16x16x32_bf16 v[172:175], a[172:175], v[52:55], v[172:175]
    s_waitcnt lgkmcnt(2)
    ds_read_b128 a[188:191], v20 offset:7168
    v_cvt_pk_bf16_f32 v61, v122, v123
    v_mfma_f32_16x16x32_bf16 v[144:147], a[176:179], v[48:51], v[144:147]
    s_waitcnt lgkmcnt(2)
    v_exp_f32 v124, v124
    v_mfma_f32_16x16x32_bf16 v[176:179], a[176:179], v[52:55], v[176:179]
    buffer_load_dwordx4 v15, s[8:11], s82 offen offset:1024 lds
    v_mfma_f32_16x16x32_bf16 v[148:151], a[180:183], v[48:51], v[148:151]
    v_exp_f32 v125, v125
    v_mfma_f32_16x16x32_bf16 v[180:183], a[180:183], v[52:55], v[180:183]
    s_waitcnt lgkmcnt(1)
    v_cvt_pk_bf16_f32 v62, v124, v125
    v_mfma_f32_16x16x32_bf16 v[152:155], a[184:187], v[48:51], v[152:155]
    s_waitcnt lgkmcnt(0)
    v_exp_f32 v126, v126
    v_mfma_f32_16x16x32_bf16 v[184:187], a[184:187], v[52:55], v[184:187]
    buffer_load_dwordx4 v15, s[8:11], s82 offen offset:2048 lds
    v_mfma_f32_16x16x32_bf16 v[156:159], a[188:191], v[48:51], v[156:159]
    v_exp_f32 v127, v127
    v_mfma_f32_16x16x32_bf16 v[188:191], a[188:191], v[52:55], v[188:191]
    v_cvt_pk_bf16_f32 v63, v126, v127
    v_mfma_f32_16x16x32_bf16 v[112:115], a[128:131], a[224:227], v[72:75]
    v_mfma_f32_16x16x32_bf16 v[112:115], a[132:135], a[228:231], v[112:115]
    v_mfma_f32_16x16x32_bf16 v[112:115], a[136:139], a[232:235], v[112:115]
    v_exp_f32 v96, v96
    v_mfma_f32_16x16x32_bf16 v[112:115], a[140:143], a[236:239], v[112:115]
    buffer_load_dwordx4 v15, s[8:11], s82 offen offset:3072 lds
    v_mfma_f32_16x16x32_bf16 v[120:123], a[128:131], a[240:243], v[76:79]
    s_xor_b32 s15, s15, 196608
    v_exp_f32 v97, v97
    v_mfma_f32_16x16x32_bf16 v[120:123], a[132:135], a[244:247], v[120:123]
    s_add_u32 m0, s16, 0
    ds_read_b128 a[128:131], v18 offset:0
    v_cvt_pk_bf16_f32 v48, v96, v97
    v_mfma_f32_16x16x32_bf16 v[120:123], a[136:139], a[248:251], v[120:123]
    v_exp_f32 v98, v98
    v_mfma_f32_16x16x32_bf16 v[120:123], a[140:143], a[252:255], v[120:123]
    buffer_load_dwordx4 v1, s[8:11], s19 offen offset:0 lds
    v_mfma_f32_16x16x32_bf16 v[116:119], a[144:147], a[224:227], v[72:75]
    v_exp_f32 v99, v99
    v_mfma_f32_16x16x32_bf16 v[116:119], a[148:151], a[228:231], v[116:119]
    ds_read_b128 a[132:135], v18 offset:1024
    v_cvt_pk_bf16_f32 v49, v98, v99
    v_mfma_f32_16x16x32_bf16 v[116:119], a[152:155], a[232:235], v[116:119]
    v_exp_f32 v100, v100
    v_mfma_f32_16x16x32_bf16 v[116:119], a[156:159], a[236:239], v[116:119]
    buffer_load_dwordx4 v1, s[8:11], s19 offen offset:1024 lds
    v_mfma_f32_16x16x32_bf16 v[124:127], a[144:147], a[240:243], v[76:79]
    v_exp_f32 v101, v101
    v_mfma_f32_16x16x32_bf16 v[124:127], a[148:151], a[244:247], v[124:127]
    ds_read_b128 a[136:139], v18 offset:2048
    v_cvt_pk_bf16_f32 v50, v100, v101
    v_mfma_f32_16x16x32_bf16 v[124:127], a[152:155], a[248:251], v[124:127]
    v_exp_f32 v102, v102
    v_mfma_f32_16x16x32_bf16 v[124:127], a[156:159], a[252:255], v[124:127]
    buffer_load_dwordx4 v1, s[8:11], s19 offen offset:2048 lds
    v_mfma_f32_16x16x32_bf16 v[40:43], v[28:31], v[56:59], v[40:43]
    v_exp_f32 v103, v103
    v_mfma_f32_16x16x32_bf16 v[44:47], v[28:31], v[60:63], v[44:47]
    ds_read_b128 a[140:143], v18 offset:3072
    v_cvt_pk_bf16_f32 v51, v102, v103
    v_mfma_f32_16x16x32_bf16 v[192:195], a[160:163], v[56:59], v[192:195]
    v_exp_f32 v104, v104
    v_mfma_f32_16x16x32_bf16 v[224:227], a[160:163], v[60:63], v[224:227]
    v_mfma_f32_16x16x32_bf16 v[196:199], a[164:167], v[56:59], v[196:199]
    v_exp_f32 v105, v105
    v_mfma_f32_16x16x32_bf16 v[228:231], a[164:167], v[60:63], v[228:231]
    ds_read_b128 a[144:147], v18 offset:4096
    v_cvt_pk_bf16_f32 v52, v104, v105
    v_mfma_f32_16x16x32_bf16 v[200:203], a[168:171], v[56:59], v[200:203]
    v_exp_f32 v106, v106
    v_mfma_f32_16x16x32_bf16 v[232:235], a[168:171], v[60:63], v[232:235]
    buffer_load_dwordx4 v1, s[8:11], s19 offen offset:3072 lds
    v_mfma_f32_16x16x32_bf16 v[204:207], a[172:175], v[56:59], v[204:207]
    s_add_u32 m0, s16, 4096
    v_exp_f32 v107, v107
    v_mfma_f32_16x16x32_bf16 v[236:239], a[172:175], v[60:63], v[236:239]
    ds_read_b128 a[148:151], v18 offset:5120
    v_cvt_pk_bf16_f32 v53, v106, v107
    v_mfma_f32_16x16x32_bf16 v[208:211], a[176:179], v[56:59], v[208:211]
    v_exp_f32 v108, v108
    v_mfma_f32_16x16x32_bf16 v[240:243], a[176:179], v[60:63], v[240:243]
    buffer_load_dwordx4 v15, s[8:11], s19 offen offset:0 lds
    v_mfma_f32_16x16x32_bf16 v[212:215], a[180:183], v[56:59], v[212:215]
    v_exp_f32 v109, v109
    v_mfma_f32_16x16x32_bf16 v[244:247], a[180:183], v[60:63], v[244:247]
    ds_read_b128 a[152:155], v18 offset:6144
    v_cvt_pk_bf16_f32 v54, v108, v109
    v_mfma_f32_16x16x32_bf16 v[216:219], a[184:187], v[56:59], v[216:219]
    v_exp_f32 v110, v110
    v_mfma_f32_16x16x32_bf16 v[248:251], a[184:187], v[60:63], v[248:251]
    buffer_load_dwordx4 v15, s[8:11], s19 offen offset:1024 lds
    v_mfma_f32_16x16x32_bf16 v[220:223], a[188:191], v[56:59], v[220:223]
    v_exp_f32 v111, v111
    v_mfma_f32_16x16x32_bf16 v[252:255], a[188:191], v[60:63], v[252:255]
    ds_read_b128 a[156:159], v18 offset:7168
    v_cvt_pk_bf16_f32 v55, v110, v111
    s_waitcnt lgkmcnt(7)
    v_mfma_f32_16x16x32_bf16 v[96:99], a[128:131], a[192:195], v[64:67]
    s_waitcnt lgkmcnt(6)
    s_mul_i32 s17, s4, 229376
    s_mul_i32 s100, s3, 7168
    ds_read_b128 a[160:163], v19 offset:16384
    v_mfma_f32_16x16x32_bf16 v[96:99], a[132:135], a[196:199], v[96:99]
    s_waitcnt lgkmcnt(6)
    s_add_u32 s17, s17, s100
    s_lshl_b32 s100, s101, 7
    ds_read_b128 a[164:167], v19 offset:17408
    v_mfma_f32_16x16x32_bf16 v[96:99], a[136:139], a[200:203], v[96:99]
    s_waitcnt lgkmcnt(6)
    s_add_u32 s17, s17, s100
    v_exp_f32 v112, v112
    v_mfma_f32_16x16x32_bf16 v[96:99], a[140:143], a[204:207], v[96:99]
    buffer_load_dwordx4 v15, s[8:11], s19 offen offset:2048 lds
    v_mfma_f32_16x16x32_bf16 v[104:107], a[128:131], a[208:211], v[68:71]
    s_add_u32 s17, s17, 8388608
    v_exp_f32 v113, v113
    v_mfma_f32_16x16x32_bf16 v[104:107], a[132:135], a[212:215], v[104:107]
    s_cmp_lt_u32 s101, s26
    s_cselect_b32 s17, s17, 2147479552
    ds_read_b128 a[168:171], v19 offset:18432
    v_cvt_pk_bf16_f32 v56, v112, v113
    v_mfma_f32_16x16x32_bf16 v[104:107], a[136:139], a[216:219], v[104:107]
    s_waitcnt lgkmcnt(6)
    v_exp_f32 v114, v114
    v_mfma_f32_16x16x32_bf16 v[104:107], a[140:143], a[220:223], v[104:107]
    buffer_load_dwordx4 v15, s[8:11], s19 offen offset:3072 lds
    v_mfma_f32_16x16x32_bf16 v[100:103], a[144:147], a[192:195], v[64:67]
    s_waitcnt lgkmcnt(5)
    s_xor_b32 s16, s16, 98304
    v_exp_f32 v115, v115
    v_mfma_f32_16x16x32_bf16 v[100:103], a[148:151], a[196:199], v[100:103]
    s_waitcnt lgkmcnt(4)
    ds_read_b128 a[172:175], v19 offset:19456
    v_cvt_pk_bf16_f32 v57, v114, v115
    v_mfma_f32_16x16x32_bf16 v[100:103], a[152:155], a[200:203], v[100:103]
    s_waitcnt lgkmcnt(4)
    v_exp_f32 v116, v116
    v_mfma_f32_16x16x32_bf16 v[100:103], a[156:159], a[204:207], v[100:103]
    buffer_store_dwordx4 a[16:19], v13, s[8:11], s17 offen sc0 sc1
    v_mfma_f32_16x16x32_bf16 v[108:111], a[144:147], a[208:211], v[68:71]
    s_add_u32 s27, s18, 8388608
    v_exp_f32 v117, v117
    v_mfma_f32_16x16x32_bf16 v[108:111], a[148:151], a[212:215], v[108:111]
    ds_read_b128 a[176:179], v20 offset:20480
    v_cvt_pk_bf16_f32 v58, v116, v117
    v_mfma_f32_16x16x32_bf16 v[108:111], a[152:155], a[216:219], v[108:111]
    v_exp_f32 v118, v118
    v_mfma_f32_16x16x32_bf16 v[108:111], a[156:159], a[220:223], v[108:111]
    buffer_store_dwordx4 v[24:27], v17, s[8:11], s27 offen offset:768 sc0 sc1
    v_mfma_f32_16x16x32_bf16 v[32:35], v[28:31], v[48:51], v[32:35]
    s_add_u32 s27, s18, 8519680
    v_exp_f32 v119, v119
    v_mfma_f32_16x16x32_bf16 v[36:39], v[28:31], v[52:55], v[36:39]
    s_waitcnt lgkmcnt(4)
    ds_read_b128 a[180:183], v20 offset:21504
    v_cvt_pk_bf16_f32 v59, v118, v119
    v_mfma_f32_16x16x32_bf16 v[128:131], a[160:163], v[48:51], v[128:131]
    s_waitcnt lgkmcnt(4)
    v_exp_f32 v120, v120
    v_mfma_f32_16x16x32_bf16 v[160:163], a[160:163], v[52:55], v[160:163]
    buffer_store_dwordx4 v[24:27], v17, s[8:11], s27 offen offset:768 sc0 sc1
    v_mfma_f32_16x16x32_bf16 v[132:135], a[164:167], v[48:51], v[132:135]
    v_exp_f32 v121, v121
    v_mfma_f32_16x16x32_bf16 v[164:167], a[164:167], v[52:55], v[164:167]
    s_waitcnt lgkmcnt(3)
    ds_read_b128 a[184:187], v20 offset:22528
    v_cvt_pk_bf16_f32 v60, v120, v121
    v_mfma_f32_16x16x32_bf16 v[136:139], a[168:171], v[48:51], v[136:139]
    s_waitcnt lgkmcnt(3)
    v_exp_f32 v122, v122
    v_mfma_f32_16x16x32_bf16 v[168:171], a[168:171], v[52:55], v[168:171]
    buffer_load_dword v3, v4, s[8:11], s23 offen sc0 sc1
    v_mfma_f32_16x16x32_bf16 v[140:143], a[172:175], v[48:51], v[140:143]
    v_exp_f32 v123, v123
    v_mfma_f32_16x16x32_bf16 v[172:175], a[172:175], v[52:55], v[172:175]
    s_waitcnt lgkmcnt(2)
    ds_read_b128 a[188:191], v20 offset:23552
    v_cvt_pk_bf16_f32 v61, v122, v123
    v_mfma_f32_16x16x32_bf16 v[144:147], a[176:179], v[48:51], v[144:147]
    v_exp_f32 v124, v124
    v_mfma_f32_16x16x32_bf16 v[176:179], a[176:179], v[52:55], v[176:179]
    s_waitcnt lgkmcnt(2)
    v_mfma_f32_16x16x32_bf16 v[148:151], a[180:183], v[48:51], v[148:151]
    v_exp_f32 v125, v125
    v_mfma_f32_16x16x32_bf16 v[180:183], a[180:183], v[52:55], v[180:183]
    s_waitcnt lgkmcnt(1)
    v_cvt_pk_bf16_f32 v62, v124, v125
    v_xor_b32 v19, 98304, v19
    v_mfma_f32_16x16x32_bf16 v[152:155], a[184:187], v[48:51], v[152:155]
    v_exp_f32 v126, v126
    v_mfma_f32_16x16x32_bf16 v[184:187], a[184:187], v[52:55], v[184:187]
    s_waitcnt lgkmcnt(0)
    v_xor_b32 v20, 98304, v20
    v_mfma_f32_16x16x32_bf16 v[156:159], a[188:191], v[48:51], v[156:159]
    v_exp_f32 v127, v127
    v_mfma_f32_16x16x32_bf16 v[188:191], a[188:191], v[52:55], v[188:191]
    v_cvt_pk_bf16_f32 v63, v126, v127
    v_mfma_f32_16x16x32_bf16 v[112:115], a[128:131], a[224:227], v[72:75]
    v_exp_f32 v96, v96
    v_mfma_f32_16x16x32_bf16 v[112:115], a[132:135], a[228:231], v[112:115]
    buffer_store_dwordx4 a[20:23], v13, s[8:11], s17 offen offset:3584 sc0 sc1
    v_mfma_f32_16x16x32_bf16 v[112:115], a[136:139], a[232:235], v[112:115]
    v_exp_f32 v97, v97
    v_mfma_f32_16x16x32_bf16 v[112:115], a[140:143], a[236:239], v[112:115]
    v_cvt_pk_bf16_f32 v48, v96, v97
    v_lshlrev_b32 v12, 3, v0
    v_mfma_f32_16x16x32_bf16 v[120:123], a[128:131], a[240:243], v[76:79]
    s_lshl_b32 s101, s2, 11
    v_exp_f32 v98, v98
    v_mfma_f32_16x16x32_bf16 v[120:123], a[132:135], a[244:247], v[120:123]
    v_add_f32 v80, 0, v21
    v_min_f32 v80, v80, v64
    v_mfma_f32_16x16x32_bf16 v[120:123], a[136:139], a[248:251], v[120:123]
    s_add_u32 s101, s101, 524288
    v_exp_f32 v99, v99
    v_mfma_f32_16x16x32_bf16 v[120:123], a[140:143], a[252:255], v[120:123]
    buffer_store_dwordx2 v[24:25], v12, s[8:11], s101 offen sc0 sc1
    v_mfma_f32_16x16x32_bf16 v[116:119], a[144:147], a[224:227], v[72:75]
    s_lshl_b32 s101, s2, 6
    v_exp_f32 v100, v100
    v_mfma_f32_16x16x32_bf16 v[116:119], a[148:151], a[228:231], v[116:119]
    s_add_u32 s101, s101, 65536
    ds_read_b128 a[128:131], v18 offset:16384
    v_cvt_pk_bf16_f32 v49, v98, v99
    v_mfma_f32_16x16x32_bf16 v[116:119], a[152:155], a[232:235], v[116:119]
    s_add_u32 s19, s82, 32768
    v_exp_f32 v101, v101
    v_mfma_f32_16x16x32_bf16 v[116:119], a[156:159], a[236:239], v[116:119]
    s_sub_u32 s82, s12, s13
    ds_read_b128 a[132:135], v18 offset:17408
    v_cvt_pk_bf16_f32 v50, v100, v101
    v_mfma_f32_16x16x32_bf16 v[124:127], a[144:147], a[240:243], v[76:79]
    s_sub_u32 s82, s82, 1
    v_exp_f32 v102, v102
    v_mfma_f32_16x16x32_bf16 v[124:127], a[148:151], a[244:247], v[124:127]
    s_cmp_gt_u32 s12, s13
    s_cselect_b32 s82, s82, s12
    s_lshl_b32 s82, s82, 16
    ds_read_b128 a[136:139], v18 offset:18432
    v_mfma_f32_16x16x32_bf16 v[124:127], a[152:155], a[248:251], v[124:127]
    s_add_u32 s82, s82, s81
    v_exp_f32 v103, v103
    v_mfma_f32_16x16x32_bf16 v[124:127], a[156:159], a[252:255], v[124:127]
    s_cmp_ge_u32 s12, 17
    s_cselect_b32 s82, 2147471360, s82
    ds_read_b128 a[140:143], v18 offset:19456
    v_cvt_pk_bf16_f32 v51, v102, v103
    v_mfma_f32_16x16x32_bf16 v[40:43], v[28:31], v[56:59], v[40:43]
    s_add_u32 s12, s12, 1
    v_exp_f32 v104, v104
    v_mfma_f32_16x16x32_bf16 v[44:47], v[28:31], v[60:63], v[44:47]
    ds_read_b128 a[144:147], v18 offset:20480
    v_mov_b32 v13, 0
    v_mfma_f32_16x16x32_bf16 v[192:195], a[160:163], v[56:59], v[192:195]
    v_exp_f32 v105, v105
    v_mfma_f32_16x16x32_bf16 v[224:227], a[160:163], v[60:63], v[224:227]
    ds_read_b128 a[148:151], v18 offset:21504
    v_cvt_pk_bf16_f32 v52, v104, v105
    v_mfma_f32_16x16x32_bf16 v[196:199], a[164:167], v[56:59], v[196:199]
    v_exp_f32 v106, v106
    v_mfma_f32_16x16x32_bf16 v[228:231], a[164:167], v[60:63], v[228:231]
    ds_read_b128 a[152:155], v18 offset:22528
    v_add_f32 v81, 0xf1800000, v21
    v_mfma_f32_16x16x32_bf16 v[200:203], a[168:171], v[56:59], v[200:203]
    v_exp_f32 v107, v107
    v_mfma_f32_16x16x32_bf16 v[232:235], a[168:171], v[60:63], v[232:235]
    ds_read_b128 a[156:159], v18 offset:23552
    v_cvt_pk_bf16_f32 v53, v106, v107
    v_mfma_f32_16x16x32_bf16 v[204:207], a[172:175], v[56:59], v[204:207]
    v_exp_f32 v108, v108
    v_mfma_f32_16x16x32_bf16 v[236:239], a[172:175], v[60:63], v[236:239]
    buffer_store_dword v13, v7, s[8:11], s101 offen sc0 sc1
    v_mfma_f32_16x16x32_bf16 v[208:211], a[176:179], v[56:59], v[208:211]
    s_lshl_b32 s101, s66, 6
    v_exp_f32 v109, v109
    v_mfma_f32_16x16x32_bf16 v[240:243], a[176:179], v[60:63], v[240:243]
    s_add_u32 s101, s101, 81920
    v_cvt_pk_bf16_f32 v54, v108, v109
    v_xor_b32 v18, 196608, v18
    v_mfma_f32_16x16x32_bf16 v[212:215], a[180:183], v[56:59], v[212:215]
    v_exp_f32 v110, v110
    v_mfma_f32_16x16x32_bf16 v[244:247], a[180:183], v[60:63], v[244:247]
    buffer_store_dwordx4 v[24:27], v7, s[8:11], s101 offen sc0 sc1
    v_mfma_f32_16x16x32_bf16 v[216:219], a[184:187], v[56:59], v[216:219]
    v_exp_f32 v111, v111
    v_mfma_f32_16x16x32_bf16 v[248:251], a[184:187], v[60:63], v[248:251]
    v_cvt_pk_bf16_f32 v55, v110, v111
    v_min_f32 v81, v81, v65
    v_mfma_f32_16x16x32_bf16 v[220:223], a[188:191], v[56:59], v[220:223]
    buffer_store_dwordx4 v[24:27], v7, s[8:11], s101 offen offset:16 sc0 sc1
    v_mfma_f32_16x16x32_bf16 v[252:255], a[188:191], v[60:63], v[252:255]
    v_add_f32 v82, 0xf2000000, v21
    v_min_f32 v82, v82, v66
    s_waitcnt vmcnt(9) lgkmcnt(0)
    s_barrier
    v_mfma_f32_16x16x32_bf16 v[96:99], a[128:131], a[192:195], v[64:67]
    s_add_u32 m0, s15, 0
    ds_read_b128 a[160:163], v19 offset:0
    v_mfma_f32_16x16x32_bf16 v[96:99], a[132:135], a[196:199], v[96:99]
    ds_read_b128 a[164:167], v19 offset:1024
    v_mfma_f32_16x16x32_bf16 v[96:99], a[136:139], a[200:203], v[96:99]
    v_exp_f32 v112, v112
    v_mfma_f32_16x16x32_bf16 v[96:99], a[140:143], a[204:207], v[96:99]
    buffer_load_dwordx4 v1, s[8:11], s82 offen offset:0 lds
    v_mfma_f32_16x16x32_bf16 v[104:107], a[128:131], a[208:211], v[68:71]
    v_exp_f32 v113, v113
    v_mfma_f32_16x16x32_bf16 v[104:107], a[132:135], a[212:215], v[104:107]
    ds_read_b128 a[168:171], v19 offset:2048
    v_cvt_pk_bf16_f32 v56, v112, v113
    v_mfma_f32_16x16x32_bf16 v[104:107], a[136:139], a[216:219], v[104:107]
    v_exp_f32 v114, v114
    v_mfma_f32_16x16x32_bf16 v[104:107], a[140:143], a[220:223], v[104:107]
    buffer_load_dwordx4 v1, s[8:11], s82 offen offset:1024 lds
    v_mfma_f32_16x16x32_bf16 v[100:103], a[144:147], a[192:195], v[64:67]
    v_exp_f32 v115, v115
    v_mfma_f32_16x16x32_bf16 v[100:103], a[148:151], a[196:199], v[100:103]
    ds_read_b128 a[172:175], v19 offset:3072
    v_cvt_pk_bf16_f32 v57, v114, v115
    v_mfma_f32_16x16x32_bf16 v[100:103], a[152:155], a[200:203], v[100:103]
    v_exp_f32 v116, v116
    v_mfma_f32_16x16x32_bf16 v[100:103], a[156:159], a[204:207], v[100:103]
    buffer_load_dwordx4 v1, s[8:11], s82 offen offset:2048 lds
    v_mfma_f32_16x16x32_bf16 v[108:111], a[144:147], a[208:211], v[68:71]
    v_exp_f32 v117, v117
    v_mfma_f32_16x16x32_bf16 v[108:111], a[148:151], a[212:215], v[108:111]
    ds_read_b128 a[176:179], v20 offset:4096
    v_cvt_pk_bf16_f32 v58, v116, v117
    v_mfma_f32_16x16x32_bf16 v[108:111], a[152:155], a[216:219], v[108:111]
    v_exp_f32 v118, v118
    v_mfma_f32_16x16x32_bf16 v[108:111], a[156:159], a[220:223], v[108:111]
    buffer_load_dwordx4 v1, s[8:11], s82 offen offset:3072 lds
    v_mfma_f32_16x16x32_bf16 v[32:35], v[28:31], v[48:51], v[32:35]
    s_add_u32 m0, s15, 4096
    v_exp_f32 v119, v119
    v_mfma_f32_16x16x32_bf16 v[36:39], v[28:31], v[52:55], v[36:39]
    s_waitcnt lgkmcnt(4)
    ds_read_b128 a[180:183], v20 offset:5120
    v_cvt_pk_bf16_f32 v59, v118, v119
    v_mfma_f32_16x16x32_bf16 v[128:131], a[160:163], v[48:51], v[128:131]
    v_exp_f32 v120, v120
    v_mfma_f32_16x16x32_bf16 v[160:163], a[160:163], v[52:55], v[160:163]
    s_waitcnt lgkmcnt(4)
    v_mfma_f32_16x16x32_bf16 v[132:135], a[164:167], v[48:51], v[132:135]
    v_exp_f32 v121, v121
    v_mfma_f32_16x16x32_bf16 v[164:167], a[164:167], v[52:55], v[164:167]
    s_waitcnt lgkmcnt(3)
    ds_read_b128 a[184:187], v20 offset:6144
    v_cvt_pk_bf16_f32 v60, v120, v121
    v_mfma_f32_16x16x32_bf16 v[136:139], a[168:171], v[48:51], v[136:139]
    s_waitcnt lgkmcnt(3)
    v_exp_f32 v122, v122
    v_mfma_f32_16x16x32_bf16 v[168:171], a[168:171], v[52:55], v[168:171]
    buffer_load_dwordx4 v15, s[8:11], s82 offen offset:0 lds
    v_mfma_f32_16x16x32_bf16 v[140:143], a[172:175], v[48:51], v[140:143]
    v_exp_f32 v123, v123
    v_mfma_f32_16x16x32_bf16 v[172:175], a[172:175], v[52:55], v[172:175]
    s_waitcnt lgkmcnt(2)
    ds_read_b128 a[188:191], v20 offset:7168
    v_cvt_pk_bf16_f32 v61, v122, v123
    v_mfma_f32_16x16x32_bf16 v[144:147], a[176:179], v[48:51], v[144:147]
    s_waitcnt lgkmcnt(2)
    v_exp_f32 v124, v124
    v_mfma_f32_16x16x32_bf16 v[176:179], a[176:179], v[52:55], v[176:179]
    buffer_load_dwordx4 v15, s[8:11], s82 offen offset:1024 lds
    v_mfma_f32_16x16x32_bf16 v[148:151], a[180:183], v[48:51], v[148:151]
    v_exp_f32 v125, v125
    v_mfma_f32_16x16x32_bf16 v[180:183], a[180:183], v[52:55], v[180:183]
    s_waitcnt lgkmcnt(1)
    v_cvt_pk_bf16_f32 v62, v124, v125
    v_mfma_f32_16x16x32_bf16 v[152:155], a[184:187], v[48:51], v[152:155]
    s_waitcnt lgkmcnt(0)
    v_exp_f32 v126, v126
    v_mfma_f32_16x16x32_bf16 v[184:187], a[184:187], v[52:55], v[184:187]
    buffer_load_dwordx4 v15, s[8:11], s82 offen offset:2048 lds
    v_mfma_f32_16x16x32_bf16 v[156:159], a[188:191], v[48:51], v[156:159]
    v_exp_f32 v127, v127
    v_mfma_f32_16x16x32_bf16 v[188:191], a[188:191], v[52:55], v[188:191]
    v_cvt_pk_bf16_f32 v63, v126, v127
    v_mfma_f32_16x16x32_bf16 v[112:115], a[128:131], a[224:227], v[72:75]
    v_mfma_f32_16x16x32_bf16 v[112:115], a[132:135], a[228:231], v[112:115]
    v_mfma_f32_16x16x32_bf16 v[112:115], a[136:139], a[232:235], v[112:115]
    v_exp_f32 v96, v96
    v_mfma_f32_16x16x32_bf16 v[112:115], a[140:143], a[236:239], v[112:115]
    buffer_load_dwordx4 v15, s[8:11], s82 offen offset:3072 lds
    v_mfma_f32_16x16x32_bf16 v[120:123], a[128:131], a[240:243], v[76:79]
    s_xor_b32 s15, s15, 196608
    v_exp_f32 v97, v97
    v_mfma_f32_16x16x32_bf16 v[120:123], a[132:135], a[244:247], v[120:123]
    s_add_u32 m0, s16, 0
    ds_read_b128 a[128:131], v18 offset:0
    v_cvt_pk_bf16_f32 v48, v96, v97
    v_mfma_f32_16x16x32_bf16 v[120:123], a[136:139], a[248:251], v[120:123]
    v_exp_f32 v98, v98
    v_mfma_f32_16x16x32_bf16 v[120:123], a[140:143], a[252:255], v[120:123]
    buffer_load_dwordx4 v1, s[8:11], s19 offen offset:0 lds
    v_mfma_f32_16x16x32_bf16 v[116:119], a[144:147], a[224:227], v[72:75]
    v_exp_f32 v99, v99
    v_mfma_f32_16x16x32_bf16 v[116:119], a[148:151], a[228:231], v[116:119]
    ds_read_b128 a[132:135], v18 offset:1024
    v_cvt_pk_bf16_f32 v49, v98, v99
    v_mfma_f32_16x16x32_bf16 v[116:119], a[152:155], a[232:235], v[116:119]
    v_exp_f32 v100, v100
    v_mfma_f32_16x16x32_bf16 v[116:119], a[156:159], a[236:239], v[116:119]
    buffer_load_dwordx4 v1, s[8:11], s19 offen offset:1024 lds
    v_mfma_f32_16x16x32_bf16 v[124:127], a[144:147], a[240:243], v[76:79]
    v_exp_f32 v101, v101
    v_mfma_f32_16x16x32_bf16 v[124:127], a[148:151], a[244:247], v[124:127]
    ds_read_b128 a[136:139], v18 offset:2048
    v_cvt_pk_bf16_f32 v50, v100, v101
    v_mfma_f32_16x16x32_bf16 v[124:127], a[152:155], a[248:251], v[124:127]
    v_exp_f32 v102, v102
    v_mfma_f32_16x16x32_bf16 v[124:127], a[156:159], a[252:255], v[124:127]
    buffer_load_dwordx4 v1, s[8:11], s19 offen offset:2048 lds
    v_mfma_f32_16x16x32_bf16 v[40:43], v[28:31], v[56:59], v[40:43]
    v_exp_f32 v103, v103
    v_mfma_f32_16x16x32_bf16 v[44:47], v[28:31], v[60:63], v[44:47]
    ds_read_b128 a[140:143], v18 offset:3072
    v_cvt_pk_bf16_f32 v51, v102, v103
    v_mfma_f32_16x16x32_bf16 v[192:195], a[160:163], v[56:59], v[192:195]
    v_exp_f32 v104, v104
    v_mfma_f32_16x16x32_bf16 v[224:227], a[160:163], v[60:63], v[224:227]
    v_mfma_f32_16x16x32_bf16 v[196:199], a[164:167], v[56:59], v[196:199]
    v_exp_f32 v105, v105
    v_mfma_f32_16x16x32_bf16 v[228:231], a[164:167], v[60:63], v[228:231]
    ds_read_b128 a[144:147], v18 offset:4096
    v_cvt_pk_bf16_f32 v52, v104, v105
    v_mfma_f32_16x16x32_bf16 v[200:203], a[168:171], v[56:59], v[200:203]
    v_exp_f32 v106, v106
    v_mfma_f32_16x16x32_bf16 v[232:235], a[168:171], v[60:63], v[232:235]
    buffer_load_dwordx4 v1, s[8:11], s19 offen offset:3072 lds
    v_mfma_f32_16x16x32_bf16 v[204:207], a[172:175], v[56:59], v[204:207]
    s_add_u32 m0, s16, 4096
    v_exp_f32 v107, v107
    v_mfma_f32_16x16x32_bf16 v[236:239], a[172:175], v[60:63], v[236:239]
    ds_read_b128 a[148:151], v18 offset:5120
    v_cvt_pk_bf16_f32 v53, v106, v107
    v_mfma_f32_16x16x32_bf16 v[208:211], a[176:179], v[56:59], v[208:211]
    v_exp_f32 v108, v108
    v_mfma_f32_16x16x32_bf16 v[240:243], a[176:179], v[60:63], v[240:243]
    buffer_load_dwordx4 v15, s[8:11], s19 offen offset:0 lds
    v_mfma_f32_16x16x32_bf16 v[212:215], a[180:183], v[56:59], v[212:215]
    v_exp_f32 v109, v109
    v_mfma_f32_16x16x32_bf16 v[244:247], a[180:183], v[60:63], v[244:247]
    ds_read_b128 a[152:155], v18 offset:6144
    v_cvt_pk_bf16_f32 v54, v108, v109
    v_mfma_f32_16x16x32_bf16 v[216:219], a[184:187], v[56:59], v[216:219]
    v_exp_f32 v110, v110
    v_mfma_f32_16x16x32_bf16 v[248:251], a[184:187], v[60:63], v[248:251]
    buffer_load_dwordx4 v15, s[8:11], s19 offen offset:1024 lds
    v_mfma_f32_16x16x32_bf16 v[220:223], a[188:191], v[56:59], v[220:223]
    v_exp_f32 v111, v111
    v_mfma_f32_16x16x32_bf16 v[252:255], a[188:191], v[60:63], v[252:255]
    ds_read_b128 a[156:159], v18 offset:7168
    v_cvt_pk_bf16_f32 v55, v110, v111
    s_waitcnt lgkmcnt(7)
    v_mfma_f32_16x16x32_bf16 v[96:99], a[128:131], a[192:195], v[64:67]
    s_waitcnt lgkmcnt(6)
    s_lshl_b32 s24, s60, 2
    s_add_u32 s24, s24, s3
    ds_read_b128 a[160:163], v19 offset:16384
    v_mfma_f32_16x16x32_bf16 v[96:99], a[132:135], a[196:199], v[96:99]
    s_waitcnt lgkmcnt(6)
    s_lshl_b32 s24, s24, 3
    s_add_u32 s24, s24, s4
    ds_read_b128 a[164:167], v19 offset:17408
    v_mfma_f32_16x16x32_bf16 v[96:99], a[136:139], a[200:203], v[96:99]
    s_waitcnt lgkmcnt(6)
    s_lshl_b32 s24, s24, 2
    v_exp_f32 v112, v112
    v_mfma_f32_16x16x32_bf16 v[96:99], a[140:143], a[204:207], v[96:99]
    buffer_load_dwordx4 v15, s[8:11], s19 offen offset:2048 lds
    v_mfma_f32_16x16x32_bf16 v[104:107], a[128:131], a[208:211], v[68:71]
    s_add_u32 s24, s24, s5
    v_exp_f32 v113, v113
    v_mfma_f32_16x16x32_bf16 v[104:107], a[132:135], a[212:215], v[104:107]
    s_lshl_b32 s24, s24, 13
    ds_read_b128 a[168:171], v19 offset:18432
    v_cvt_pk_bf16_f32 v56, v112, v113
    v_mfma_f32_16x16x32_bf16 v[104:107], a[136:139], a[216:219], v[104:107]
    s_waitcnt lgkmcnt(6)
    s_add_u32 s24, s24, 50331648
    v_exp_f32 v114, v114
    s_waitcnt vmcnt(20)
    v_cmp_ne_u32 vcc, 0, v3
    s_cmp_eq_u64 vcc, -1
    s_cbranch_scc0 L_C1_slow_9
L_C1_ok_10:
    v_mfma_f32_16x16x32_bf16 v[104:107], a[140:143], a[220:223], v[104:107]
    buffer_load_dwordx4 v15, s[8:11], s19 offen offset:3072 lds
    v_mfma_f32_16x16x32_bf16 v[100:103], a[144:147], a[192:195], v[64:67]
    s_waitcnt lgkmcnt(5)
    s_xor_b32 s16, s16, 98304
    v_exp_f32 v115, v115
    v_mfma_f32_16x16x32_bf16 v[100:103], a[148:151], a[196:199], v[100:103]
    s_waitcnt lgkmcnt(4)
    s_xor_b32 s74, s24, 0
    ds_read_b128 a[172:175], v19 offset:19456
    v_cvt_pk_bf16_f32 v57, v114, v115
    v_mfma_f32_16x16x32_bf16 v[100:103], a[152:155], a[200:203], v[100:103]
    s_waitcnt lgkmcnt(4)
    v_exp_f32 v116, v116
    v_mfma_f32_16x16x32_bf16 v[100:103], a[156:159], a[204:207], v[100:103]
    buffer_load_dwordx4 a[64:67], v1, s[8:11], s74 offen offset:0
    v_mfma_f32_16x16x32_bf16 v[108:111], a[144:147], a[208:211], v[68:71]
    s_xor_b32 s74, s24, 0
    v_exp_f32 v117, v117
    v_mfma_f32_16x16x32_bf16 v[108:111], a[148:151], a[212:215], v[108:111]
    ds_read_b128 a[176:179], v20 offset:20480
    v_cvt_pk_bf16_f32 v58, v116, v117
    v_mfma_f32_16x16x32_bf16 v[108:111], a[152:155], a[216:219], v[108:111]
    v_exp_f32 v118, v118
    v_mfma_f32_16x16x32_bf16 v[108:111], a[156:159], a[220:223], v[108:111]
    buffer_load_dwordx4 a[68:71], v1, s[8:11], s74 offen offset:1024
    v_mfma_f32_16x16x32_bf16 v[32:35], v[28:31], v[48:51], v[32:35]
    s_xor_b32 s74, s24, 0
    v_exp_f32 v119, v119
    v_mfma_f32_16x16x32_bf16 v[36:39], v[28:31], v[52:55], v[36:39]
    s_waitcnt lgkmcnt(4)
    ds_read_b128 a[180:183], v20 offset:21504
    v_cvt_pk_bf16_f32 v59, v118, v119
    v_mfma_f32_16x16x32_bf16 v[128:131], a[160:163], v[48:51], v[128:131]
    s_waitcnt lgkmcnt(4)
    v_exp_f32 v120, v120
    v_mfma_f32_16x16x32_bf16 v[160:163], a[160:163], v[52:55], v[160:163]
    buffer_load_dwordx4 a[72:75], v1, s[8:11], s74 offen offset:2048
    v_mfma_f32_16x16x32_bf16 v[132:135], a[164:167], v[48:51], v[132:135]
    s_xor_b32 s74, s24, 0
    v_exp_f32 v121, v121
    v_mfma_f32_16x16x32_bf16 v[164:167], a[164:167], v[52:55], v[164:167]
    s_waitcnt lgkmcnt(3)
    ds_read_b128 a[184:187], v20 offset:22528
    v_cvt_pk_bf16_f32 v60, v120, v121
    v_mfma_f32_16x16x32_bf16 v[136:139], a[168:171], v[48:51], v[136:139]
    s_waitcnt lgkmcnt(3)
    v_exp_f32 v122, v122
    v_mfma_f32_16x16x32_bf16 v[168:171], a[168:171], v[52:55], v[168:171]
    buffer_load_dwordx4 a[76:79], v1, s[8:11], s74 offen offset:3072
    v_mfma_f32_16x16x32_bf16 v[140:143], a[172:175], v[48:51], v[140:143]
    s_xor_b32 s74, s24, 4096
    v_exp_f32 v123, v123
    v_mfma_f32_16x16x32_bf16 v[172:175], a[172:175], v[52:55], v[172:175]
    s_waitcnt lgkmcnt(2)
    ds_read_b128 a[188:191], v20 offset:23552
    v_cvt_pk_bf16_f32 v61, v122, v123
    v_mfma_f32_16x16x32_bf16 v[144:147], a[176:179], v[48:51], v[144:147]
    s_waitcnt lgkmcnt(2)
    v_exp_f32 v124, v124
    v_mfma_f32_16x16x32_bf16 v[176:179], a[176:179], v[52:55], v[176:179]
    buffer_load_dwordx4 a[80:83], v1, s[8:11], s74 offen offset:0
    v_mfma_f32_16x16x32_bf16 v[148:151], a[180:183], v[48:51], v[148:151]
    v_exp_f32 v125, v125
    v_mfma_f32_16x16x32_bf16 v[180:183], a[180:183], v[52:55], v[180:183]
    s_waitcnt lgkmcnt(1)
    v_cvt_pk_bf16_f32 v62, v124, v125
    v_xor_b32 v19, 98304, v19
    v_mfma_f32_16x16x32_bf16 v[152:155], a[184:187], v[48:51], v[152:155]
    v_exp_f32 v126, v126
    v_mfma_f32_16x16x32_bf16 v[184:187], a[184:187], v[52:55], v[184:187]
    s_waitcnt lgkmcnt(0)
    v_xor_b32 v20, 98304, v20
    v_mfma_f32_16x16x32_bf16 v[156:159], a[188:191], v[48:51], v[156:159]
    v_exp_f32 v127, v127
    v_mfma_f32_16x16x32_bf16 v[188:191], a[188:191], v[52:55], v[188:191]
    v_cvt_pk_bf16_f32 v63, v126, v127
    v_mfma_f32_16x16x32_bf16 v[112:115], a[128:131], a[224:227], v[72:75]
    s_add_u32 m0, s62, 32768
    v_exp_f32 v96, v96
    v_mfma_f32_16x16x32_bf16 v[112:115], a[132:135], a[228:231], v[112:115]
    v_add_f32 v83, 0xf2400000, v21
    v_min_f32 v83, v83, v67
    v_mfma_f32_16x16x32_bf16 v[112:115], a[136:139], a[232:235], v[112:115]
    s_xor_b32 s98, s65, 0
    v_exp_f32 v97, v97
    v_mfma_f32_16x16x32_bf16 v[112:115], a[140:143], a[236:239], v[112:115]
    v_cvt_pk_bf16_f32 v48, v96, v97
    v_add_f32 v84, 0xf3800000, v21
    v_mfma_f32_16x16x32_bf16 v[120:123], a[128:131], a[240:243], v[76:79]
    v_exp_f32 v98, v98
    v_mfma_f32_16x16x32_bf16 v[120:123], a[132:135], a[244:247], v[120:123]
    buffer_load_dwordx4 v8, s[28:31], s98 offen offset:0  lds
    v_mfma_f32_16x16x32_bf16 v[120:123], a[136:139], a[248:251], v[120:123]
    v_exp_f32 v99, v99
    v_mfma_f32_16x16x32_bf16 v[120:123], a[140:143], a[252:255], v[120:123]
    buffer_load_dwordx4 v9, s[28:31], s98 offen offset:1024  lds
    v_mfma_f32_16x16x32_bf16 v[116:119], a[144:147], a[224:227], v[72:75]
    v_exp_f32 v100, v100
    v_mfma_f32_16x16x32_bf16 v[116:119], a[148:151], a[228:231], v[116:119]
    ds_read_b128 a[128:131], v18 offset:16384
    v_cvt_pk_bf16_f32 v49, v98, v99
    v_mfma_f32_16x16x32_bf16 v[116:119], a[152:155], a[232:235], v[116:119]
    s_add_u32 s19, s82, 32768
    v_exp_f32 v101, v101
    v_mfma_f32_16x16x32_bf16 v[116:119], a[156:159], a[236:239], v[116:119]
    s_sub_u32 s82, s12, s13
    ds_read_b128 a[132:135], v18 offset:17408
    v_cvt_pk_bf16_f32 v50, v100, v101
    v_mfma_f32_16x16x32_bf16 v[124:127], a[144:147], a[240:243], v[76:79]
    s_sub_u32 s82, s82, 1
    v_exp_f32 v102, v102
    v_mfma_f32_16x16x32_bf16 v[124:127], a[148:151], a[244:247], v[124:127]
    s_cmp_gt_u32 s12, s13
    s_cselect_b32 s82, s82, s12
    s_lshl_b32 s82, s82, 16
    ds_read_b128 a[136:139], v18 offset:18432
    v_mfma_f32_16x16x32_bf16 v[124:127], a[152:155], a[248:251], v[124:127]
    s_add_u32 s82, s82, s81
    v_exp_f32 v103, v103
    v_mfma_f32_16x16x32_bf16 v[124:127], a[156:159], a[252:255], v[124:127]
    s_cmp_ge_u32 s12, 17
    s_cselect_b32 s82, 2147471360, s82
    ds_read_b128 a[140:143], v18 offset:19456
    v_cvt_pk_bf16_f32 v51, v102, v103
    v_mfma_f32_16x16x32_bf16 v[40:43], v[28:31], v[56:59], v[40:43]
    s_add_u32 s12, s12, 1
    v_exp_f32 v104, v104
    v_mfma_f32_16x16x32_bf16 v[44:47], v[28:31], v[60:63], v[44:47]
    ds_read_b128 a[144:147], v18 offset:20480
    v_min_f32 v84, v84, v64
    v_mfma_f32_16x16x32_bf16 v[192:195], a[160:163], v[56:59], v[192:195]
    v_exp_f32 v105, v105
    v_mfma_f32_16x16x32_bf16 v[224:227], a[160:163], v[60:63], v[224:227]
    ds_read_b128 a[148:151], v18 offset:21504
    v_cvt_pk_bf16_f32 v52, v104, v105
    v_mfma_f32_16x16x32_bf16 v[196:199], a[164:167], v[56:59], v[196:199]
    v_exp_f32 v106, v106
    v_mfma_f32_16x16x32_bf16 v[228:231], a[164:167], v[60:63], v[228:231]
    ds_read_b128 a[152:155], v18 offset:22528
    v_add_f32 v85, 0xf3880000, v21
    v_mfma_f32_16x16x32_bf16 v[200:203], a[168:171], v[56:59], v[200:203]
    v_exp_f32 v107, v107
    v_mfma_f32_16x16x32_bf16 v[232:235], a[168:171], v[60:63], v[232:235]
    ds_read_b128 a[156:159], v18 offset:23552
    v_cvt_pk_bf16_f32 v53, v106, v107
    v_mfma_f32_16x16x32_bf16 v[204:207], a[172:175], v[56:59], v[204:207]
    v_exp_f32 v108, v108
    v_mfma_f32_16x16x32_bf16 v[236:239], a[172:175], v[60:63], v[236:239]
    buffer_load_dwordx4 v10, s[28:31], s98 offen offset:2048  lds
    v_mfma_f32_16x16x32_bf16 v[208:211], a[176:179], v[56:59], v[208:211]
    v_exp_f32 v109, v109
    v_mfma_f32_16x16x32_bf16 v[240:243], a[176:179], v[60:63], v[240:243]
    v_cvt_pk_bf16_f32 v54, v108, v109
    v_xor_b32 v18, 196608, v18
    v_mfma_f32_16x16x32_bf16 v[212:215], a[180:183], v[56:59], v[212:215]
    v_exp_f32 v110, v110
    v_mfma_f32_16x16x32_bf16 v[244:247], a[180:183], v[60:63], v[244:247]
    buffer_load_dwordx4 v11, s[28:31], s98 offen offset:3072  lds
    v_mfma_f32_16x16x32_bf16 v[216:219], a[184:187], v[56:59], v[216:219]
    s_xor_b32 s74, s24, 4096
    v_exp_f32 v111, v111
    v_mfma_f32_16x16x32_bf16 v[248:251], a[184:187], v[60:63], v[248:251]
    v_cvt_pk_bf16_f32 v55, v110, v111
    v_min_f32 v85, v85, v65
    v_mfma_f32_16x16x32_bf16 v[220:223], a[188:191], v[56:59], v[220:223]
    buffer_load_dwordx4 a[84:87], v1, s[8:11], s74 offen offset:1024
    v_mfma_f32_16x16x32_bf16 v[252:255], a[188:191], v[60:63], v[252:255]
    s_xor_b32 s74, s24, 4096
    buffer_load_dwordx4 a[88:91], v1, s[8:11], s74 offen offset:2048
    s_xor_b32 s74, s24, 4096
    buffer_load_dwordx4 a[92:95], v1, s[8:11], s74 offen offset:3072
    s_waitcnt vmcnt(12) lgkmcnt(0)
    s_barrier
    v_mfma_f32_16x16x32_bf16 v[96:99], a[128:131], a[192:195], v[64:67]
    s_add_u32 m0, s15, 0
    ds_read_b128 a[160:163], v19 offset:0
    v_mfma_f32_16x16x32_bf16 v[96:99], a[132:135], a[196:199], v[96:99]
    ds_read_b128 a[164:167], v19 offset:1024
    v_mfma_f32_16x16x32_bf16 v[96:99], a[136:139], a[200:203], v[96:99]
    v_exp_f32 v112, v112
    v_mfma_f32_16x16x32_bf16 v[96:99], a[140:143], a[204:207], v[96:99]
    buffer_load_dwordx4 v1, s[8:11], s82 offen offset:0 lds
    v_mfma_f32_16x16x32_bf16 v[104:107], a[128:131], a[208:211], v[68:71]
    v_exp_f32 v113, v113
    v_mfma_f32_16x16x32_bf16 v[104:107], a[132:135], a[212:215], v[104:107]
    ds_read_b128 a[168:171], v19 offset:2048
    v_cvt_pk_bf16_f32 v56, v112, v113
    v_mfma_f32_16x16x32_bf16 v[104:107], a[136:139], a[216:219], v[104:107]
    v_exp_f32 v114, v114
    v_mfma_f32_16x16x32_bf16 v[104:107], a[140:143], a[220:223], v[104:107]
    buffer_load_dwordx4 v1, s[8:11], s82 offen offset:1024 lds
    v_mfma_f32_16x16x32_bf16 v[100:103], a[144:147], a[192:195], v[64:67]
    v_exp_f32 v115, v115
    v_mfma_f32_16x16x32_bf16 v[100:103], a[148:151], a[196:199], v[100:103]
    ds_read_b128 a[172:175], v19 offset:3072
    v_cvt_pk_bf16_f32 v57, v114, v115
    v_mfma_f32_16x16x32_bf16 v[100:103], a[152:155], a[200:203], v[100:103]
    v_exp_f32 v116, v116
    v_mfma_f32_16x16x32_bf16 v[100:103], a[156:159], a[204:207], v[100:103]
    buffer_load_dwordx4 v1, s[8:11], s82 offen offset:2048 lds
    v_mfma_f32_16x16x32_bf16 v[108:111], a[144:147], a[208:211], v[68:71]
    v_exp_f32 v117, v117
    v_mfma_f32_16x16x32_bf16 v[108:111], a[148:151], a[212:215], v[108:111]
    ds_read_b128 a[176:179], v20 offset:4096
    v_cvt_pk_bf16_f32 v58, v116, v117
    v_mfma_f32_16x16x32_bf16 v[108:111], a[152:155], a[216:219], v[108:111]
    v_exp_f32 v118, v118
    v_mfma_f32_16x16x32_bf16 v[108:111], a[156:159], a[220:223], v[108:111]
    buffer_load_dwordx4 v1, s[8:11], s82 offen offset:3072 lds
    v_mfma_f32_16x16x32_bf16 v[32:35], v[28:31], v[48:51], v[32:35]
    s_add_u32 m0, s15, 4096
    v_exp_f32 v119, v119
    v_mfma_f32_16x16x32_bf16 v[36:39], v[28:31], v[52:55], v[36:39]
    s_waitcnt lgkmcnt(4)
    ds_read_b128 a[180:183], v20 offset:5120
    v_cvt_pk_bf16_f32 v59, v118, v119
    v_mfma_f32_16x16x32_bf16 v[128:131], a[160:163], v[48:51], v[128:131]
    v_exp_f32 v120, v120
    v_mfma_f32_16x16x32_bf16 v[160:163], a[160:163], v[52:55], v[160:163]
    s_waitcnt lgkmcnt(4)
    v_mfma_f32_16x16x32_bf16 v[132:135], a[164:167], v[48:51], v[132:135]
    v_exp_f32 v121, v121
    v_mfma_f32_16x16x32_bf16 v[164:167], a[164:167], v[52:55], v[164:167]
    s_waitcnt lgkmcnt(3)
    ds_read_b128 a[184:187], v20 offset:6144
    v_cvt_pk_bf16_f32 v60, v120, v121
    v_mfma_f32_16x16x32_bf16 v[136:139], a[168:171], v[48:51], v[136:139]
    s_waitcnt lgkmcnt(3)
    v_exp_f32 v122, v122
    v_mfma_f32_16x16x32_bf16 v[168:171], a[168:171], v[52:55], v[168:171]
    buffer_load_dwordx4 v15, s[8:11], s82 offen offset:0 lds
    v_mfma_f32_16x16x32_bf16 v[140:143], a[172:175], v[48:51], v[140:143]
    v_exp_f32 v123, v123
    v_mfma_f32_16x16x32_bf16 v[172:175], a[172:175], v[52:55], v[172:175]
    s_waitcnt lgkmcnt(2)
    ds_read_b128 a[188:191], v20 offset:7168
    v_cvt_pk_bf16_f32 v61, v122, v123
    v_mfma_f32_16x16x32_bf16 v[144:147], a[176:179], v[48:51], v[144:147]
    s_waitcnt lgkmcnt(2)
    v_exp_f32 v124, v124
    v_mfma_f32_16x16x32_bf16 v[176:179], a[176:179], v[52:55], v[176:179]
    buffer_load_dwordx4 v15, s[8:11], s82 offen offset:1024 lds
    v_mfma_f32_16x16x32_bf16 v[148:151], a[180:183], v[48:51], v[148:151]
    v_exp_f32 v125, v125
    v_mfma_f32_16x16x32_bf16 v[180:183], a[180:183], v[52:55], v[180:183]
    s_waitcnt lgkmcnt(1)
    v_cvt_pk_bf16_f32 v62, v124, v125
    v_mfma_f32_16x16x32_bf16 v[152:155], a[184:187], v[48:51], v[152:155]
    s_waitcnt lgkmcnt(0)
    v_exp_f32 v126, v126
    v_mfma_f32_16x16x32_bf16 v[184:187], a[184:187], v[52:55], v[184:187]
    buffer_load_dwordx4 v15, s[8:11], s82 offen offset:2048 lds
    v_mfma_f32_16x16x32_bf16 v[156:159], a[188:191], v[48:51], v[156:159]
    v_exp_f32 v127, v127
    v_mfma_f32_16x16x32_bf16 v[188:191], a[188:191], v[52:55], v[188:191]
    v_cvt_pk_bf16_f32 v63, v126, v127
    v_mfma_f32_16x16x32_bf16 v[112:115], a[128:131], a[224:227], v[72:75]
    v_mfma_f32_16x16x32_bf16 v[112:115], a[132:135], a[228:231], v[112:115]
    v_mfma_f32_16x16x32_bf16 v[112:115], a[136:139], a[232:235], v[112:115]
    v_exp_f32 v96, v96
    v_mfma_f32_16x16x32_bf16 v[112:115], a[140:143], a[236:239], v[112:115]
    buffer_load_dwordx4 v15, s[8:11], s82 offen offset:3072 lds
    v_mfma_f32_16x16x32_bf16 v[120:123], a[128:131], a[240:243], v[76:79]
    s_xor_b32 s15, s15, 196608
    v_exp_f32 v97, v97
    v_mfma_f32_16x16x32_bf16 v[120:123], a[132:135], a[244:247], v[120:123]
    s_add_u32 m0, s16, 0
    ds_read_b128 a[128:131], v18 offset:0
    v_cvt_pk_bf16_f32 v48, v96, v97
    v_mfma_f32_16x16x32_bf16 v[120:123], a[136:139], a[248:251], v[120:123]
    v_exp_f32 v98, v98
    v_mfma_f32_16x16x32_bf16 v[120:123], a[140:143], a[252:255], v[120:123]
    buffer_load_dwordx4 v1, s[8:11], s19 offen offset:0 lds
    v_mfma_f32_16x16x32_bf16 v[116:119], a[144:147], a[224:227], v[72:75]
    v_exp_f32 v99, v99
    v_mfma_f32_16x16x32_bf16 v[116:119], a[148:151], a[228:231], v[116:119]
    ds_read_b128 a[132:135], v18 offset:1024
    v_cvt_pk_bf16_f32 v49, v98, v99
    v_mfma_f32_16x16x32_bf16 v[116:119], a[152:155], a[232:235], v[116:119]
    v_exp_f32 v100, v100
    v_mfma_f32_16x16x32_bf16 v[116:119], a[156:159], a[236:239], v[116:119]
    buffer_load_dwordx4 v1, s[8:11], s19 offen offset:1024 lds
    v_mfma_f32_16x16x32_bf16 v[124:127], a[144:147], a[240:243], v[76:79]
    v_exp_f32 v101, v101
    v_mfma_f32_16x16x32_bf16 v[124:127], a[148:151], a[244:247], v[124:127]
    ds_read_b128 a[136:139], v18 offset:2048
    v_cvt_pk_bf16_f32 v50, v100, v101
    v_mfma_f32_16x16x32_bf16 v[124:127], a[152:155], a[248:251], v[124:127]
    v_exp_f32 v102, v102
    v_mfma_f32_16x16x32_bf16 v[124:127], a[156:159], a[252:255], v[124:127]
    buffer_load_dwordx4 v1, s[8:11], s19 offen offset:2048 lds
    v_mfma_f32_16x16x32_bf16 v[40:43], v[28:31], v[56:59], v[40:43]
    v_exp_f32 v103, v103
    v_mfma_f32_16x16x32_bf16 v[44:47], v[28:31], v[60:63], v[44:47]
    ds_read_b128 a[140:143], v18 offset:3072
    v_cvt_pk_bf16_f32 v51, v102, v103
    v_mfma_f32_16x16x32_bf16 v[192:195], a[160:163], v[56:59], v[192:195]
    v_exp_f32 v104, v104
    v_mfma_f32_16x16x32_bf16 v[224:227], a[160:163], v[60:63], v[224:227]
    v_mfma_f32_16x16x32_bf16 v[196:199], a[164:167], v[56:59], v[196:199]
    v_exp_f32 v105, v105
    v_mfma_f32_16x16x32_bf16 v[228:231], a[164:167], v[60:63], v[228:231]
    ds_read_b128 a[144:147], v18 offset:4096
    v_cvt_pk_bf16_f32 v52, v104, v105
    v_mfma_f32_16x16x32_bf16 v[200:203], a[168:171], v[56:59], v[200:203]
    v_exp_f32 v106, v106
    v_mfma_f32_16x16x32_bf16 v[232:235], a[168:171], v[60:63], v[232:235]
    buffer_load_dwordx4 v1, s[8:11], s19 offen offset:3072 lds
    v_mfma_f32_16x16x32_bf16 v[204:207], a[172:175], v[56:59], v[204:207]
    s_add_u32 m0, s16, 4096
    v_exp_f32 v107, v107
    v_mfma_f32_16x16x32_bf16 v[236:239], a[172:175], v[60:63], v[236:239]
    ds_read_b128 a[148:151], v18 offset:5120
    v_cvt_pk_bf16_f32 v53, v106, v107
    v_mfma_f32_16x16x32_bf16 v[208:211], a[176:179], v[56:59], v[208:211]
    v_exp_f32 v108, v108
    v_mfma_f32_16x16x32_bf16 v[240:243], a[176:179], v[60:63], v[240:243]
    buffer_load_dwordx4 v15, s[8:11], s19 offen offset:0 lds
    v_mfma_f32_16x16x32_bf16 v[212:215], a[180:183], v[56:59], v[212:215]
    v_exp_f32 v109, v109
    v_mfma_f32_16x16x32_bf16 v[244:247], a[180:183], v[60:63], v[244:247]
    ds_read_b128 a[152:155], v18 offset:6144
    v_cvt_pk_bf16_f32 v54, v108, v109
    v_mfma_f32_16x16x32_bf16 v[216:219], a[184:187], v[56:59], v[216:219]
    v_exp_f32 v110, v110
    v_mfma_f32_16x16x32_bf16 v[248:251], a[184:187], v[60:63], v[248:251]
    buffer_load_dwordx4 v15, s[8:11], s19 offen offset:1024 lds
    v_mfma_f32_16x16x32_bf16 v[220:223], a[188:191], v[56:59], v[220:223]
    v_exp_f32 v111, v111
    v_mfma_f32_16x16x32_bf16 v[252:255], a[188:191], v[60:63], v[252:255]
    ds_read_b128 a[156:159], v18 offset:7168
    v_cvt_pk_bf16_f32 v55, v110, v111
    s_waitcnt lgkmcnt(7)
    v_mfma_f32_16x16x32_bf16 v[96:99], a[128:131], a[192:195], v[64:67]
    s_waitcnt lgkmcnt(6)
    ds_read_b128 a[160:163], v19 offset:16384
    v_mfma_f32_16x16x32_bf16 v[96:99], a[132:135], a[196:199], v[96:99]
    s_waitcnt lgkmcnt(6)
    ds_read_b128 a[164:167], v19 offset:17408
    v_mfma_f32_16x16x32_bf16 v[96:99], a[136:139], a[200:203], v[96:99]
    s_waitcnt lgkmcnt(6)
    v_exp_f32 v112, v112
    v_mfma_f32_16x16x32_bf16 v[96:99], a[140:143], a[204:207], v[96:99]
    buffer_load_dwordx4 v15, s[8:11], s19 offen offset:2048 lds
    v_mfma_f32_16x16x32_bf16 v[104:107], a[128:131], a[208:211], v[68:71]
    v_exp_f32 v113, v113
    v_mfma_f32_16x16x32_bf16 v[104:107], a[132:135], a[212:215], v[104:107]
    ds_read_b128 a[168:171], v19 offset:18432
    v_cvt_pk_bf16_f32 v56, v112, v113
    v_mfma_f32_16x16x32_bf16 v[104:107], a[136:139], a[216:219], v[104:107]
    s_waitcnt lgkmcnt(6)
    v_exp_f32 v114, v114
    v_mfma_f32_16x16x32_bf16 v[104:107], a[140:143], a[220:223], v[104:107]
    buffer_load_dwordx4 v15, s[8:11], s19 offen offset:3072 lds
    v_mfma_f32_16x16x32_bf16 v[100:103], a[144:147], a[192:195], v[64:67]
    s_waitcnt lgkmcnt(5)
    s_xor_b32 s16, s16, 98304
    v_exp_f32 v115, v115
    v_mfma_f32_16x16x32_bf16 v[100:103], a[148:151], a[196:199], v[100:103]
    s_waitcnt lgkmcnt(4)
    s_lshl_b32 s64, s2, 6
    ds_read_b128 a[172:175], v19 offset:19456
    v_cvt_pk_bf16_f32 v57, v114, v115
    v_mfma_f32_16x16x32_bf16 v[100:103], a[152:155], a[200:203], v[100:103]
    s_waitcnt lgkmcnt(4)
    s_add_u32 s64, s64, 1327104
    v_exp_f32 v116, v116
    v_mfma_f32_16x16x32_bf16 v[100:103], a[156:159], a[204:207], v[100:103]
    buffer_store_dword v6, v7, s[8:11], s64 offen sc0 sc1
    v_mfma_f32_16x16x32_bf16 v[108:111], a[144:147], a[208:211], v[68:71]
    s_xor_b32 s74, s24, 8192
    v_exp_f32 v117, v117
    v_mfma_f32_16x16x32_bf16 v[108:111], a[148:151], a[212:215], v[108:111]
    ds_read_b128 a[176:179], v20 offset:20480
    v_cvt_pk_bf16_f32 v58, v116, v117
    v_mfma_f32_16x16x32_bf16 v[108:111], a[152:155], a[216:219], v[108:111]
    v_exp_f32 v118, v118
    v_mfma_f32_16x16x32_bf16 v[108:111], a[156:159], a[220:223], v[108:111]
    buffer_load_dwordx4 a[96:99], v1, s[8:11], s74 offen offset:0
    v_mfma_f32_16x16x32_bf16 v[32:35], v[28:31], v[48:51], v[32:35]
    s_xor_b32 s74, s24, 8192
    v_exp_f32 v119, v119
    v_mfma_f32_16x16x32_bf16 v[36:39], v[28:31], v[52:55], v[36:39]
    s_waitcnt lgkmcnt(4)
    ds_read_b128 a[180:183], v20 offset:21504
    v_cvt_pk_bf16_f32 v59, v118, v119
    v_mfma_f32_16x16x32_bf16 v[128:131], a[160:163], v[48:51], v[128:131]
    s_waitcnt lgkmcnt(4)
    v_exp_f32 v120, v120
    v_mfma_f32_16x16x32_bf16 v[160:163], a[160:163], v[52:55], v[160:163]
    buffer_load_dwordx4 a[100:103], v1, s[8:11], s74 offen offset:1024
    v_mfma_f32_16x16x32_bf16 v[132:135], a[164:167], v[48:51], v[132:135]
    s_xor_b32 s74, s24, 8192
    v_exp_f32 v121, v121
    v_mfma_f32_16x16x32_bf16 v[164:167], a[164:167], v[52:55], v[164:167]
    s_waitcnt lgkmcnt(3)
    ds_read_b128 a[184:187], v20 offset:22528
    v_cvt_pk_bf16_f32 v60, v120, v121
    v_mfma_f32_16x16x32_bf16 v[136:139], a[168:171], v[48:51], v[136:139]
    s_waitcnt lgkmcnt(3)
    v_exp_f32 v122, v122
    v_mfma_f32_16x16x32_bf16 v[168:171], a[168:171], v[52:55], v[168:171]
    buffer_load_dwordx4 a[104:107], v1, s[8:11], s74 offen offset:2048
    v_mfma_f32_16x16x32_bf16 v[140:143], a[172:175], v[48:51], v[140:143]
    s_xor_b32 s74, s24, 8192
    v_exp_f32 v123, v123
    v_mfma_f32_16x16x32_bf16 v[172:175], a[172:175], v[52:55], v[172:175]
    s_waitcnt lgkmcnt(2)
    ds_read_b128 a[188:191], v20 offset:23552
    v_cvt_pk_bf16_f32 v61, v122, v123
    v_mfma_f32_16x16x32_bf16 v[144:147], a[176:179], v[48:51], v[144:147]
    s_waitcnt lgkmcnt(2)
    v_exp_f32 v124, v124
    v_mfma_f32_16x16x32_bf16 v[176:179], a[176:179], v[52:55], v[176:179]
    buffer_load_dwordx4 a[108:111], v1, s[8:11], s74 offen offset:3072
    v_mfma_f32_16x16x32_bf16 v[148:151], a[180:183], v[48:51], v[148:151]
    s_xor_b32 s74, s24, 12288
    v_exp_f32 v125, v125
    v_mfma_f32_16x16x32_bf16 v[180:183], a[180:183], v[52:55], v[180:183]
    s_waitcnt lgkmcnt(1)
    v_cvt_pk_bf16_f32 v62, v124, v125
    v_xor_b32 v19, 98304, v19
    v_mfma_f32_16x16x32_bf16 v[152:155], a[184:187], v[48:51], v[152:155]
    buffer_load_dwordx4 a[112:115], v1, s[8:11], s74 offen offset:0
    v_exp_f32 v126, v126
    v_mfma_f32_16x16x32_bf16 v[184:187], a[184:187], v[52:55], v[184:187]
    s_waitcnt lgkmcnt(0)
    v_xor_b32 v20, 98304, v20
    v_mfma_f32_16x16x32_bf16 v[156:159], a[188:191], v[48:51], v[156:159]
    v_exp_f32 v127, v127
    v_mfma_f32_16x16x32_bf16 v[188:191], a[188:191], v[52:55], v[188:191]
    v_cvt_pk_bf16_f32 v63, v126, v127
    v_mfma_f32_16x16x32_bf16 v[112:115], a[128:131], a[224:227], v[72:75]
    s_add_u32 m0, s62, 36864
    v_exp_f32 v96, v96
    v_mfma_f32_16x16x32_bf16 v[112:115], a[132:135], a[228:231], v[112:115]
    v_add_f32 v86, 0xf3900000, v21
    v_min_f32 v86, v86, v66
    v_mfma_f32_16x16x32_bf16 v[112:115], a[136:139], a[232:235], v[112:115]
    s_xor_b32 s98, s65, 32768
    v_exp_f32 v97, v97
    v_mfma_f32_16x16x32_bf16 v[112:115], a[140:143], a[236:239], v[112:115]
    v_cvt_pk_bf16_f32 v48, v96, v97
    v_add_f32 v87, 0xf3980000, v21
    v_mfma_f32_16x16x32_bf16 v[120:123], a[128:131], a[240:243], v[76:79]
    v_exp_f32 v98, v98
    v_mfma_f32_16x16x32_bf16 v[120:123], a[132:135], a[244:247], v[120:123]
    buffer_load_dwordx4 v8, s[28:31], s98 offen offset:0  lds
    v_mfma_f32_16x16x32_bf16 v[120:123], a[136:139], a[248:251], v[120:123]
    v_exp_f32 v99, v99
    v_mfma_f32_16x16x32_bf16 v[120:123], a[140:143], a[252:255], v[120:123]
    buffer_load_dwordx4 v9, s[28:31], s98 offen offset:1024  lds
    v_mfma_f32_16x16x32_bf16 v[116:119], a[144:147], a[224:227], v[72:75]
    v_exp_f32 v100, v100
    v_mfma_f32_16x16x32_bf16 v[116:119], a[148:151], a[228:231], v[116:119]
    ds_read_b128 a[128:131], v18 offset:16384
    v_cvt_pk_bf16_f32 v49, v98, v99
    v_mfma_f32_16x16x32_bf16 v[116:119], a[152:155], a[232:235], v[116:119]
    s_add_u32 s19, s82, 32768
    v_exp_f32 v101, v101
    v_mfma_f32_16x16x32_bf16 v[116:119], a[156:159], a[236:239], v[116:119]
    s_sub_u32 s82, s12, s13
    ds_read_b128 a[132:135], v18 offset:17408
    v_cvt_pk_bf16_f32 v50, v100, v101
    v_mfma_f32_16x16x32_bf16 v[124:127], a[144:147], a[240:243], v[76:79]
    s_sub_u32 s82, s82, 1
    v_exp_f32 v102, v102
    v_mfma_f32_16x16x32_bf16 v[124:127], a[148:151], a[244:247], v[124:127]
    s_cmp_gt_u32 s12, s13
    s_cselect_b32 s82, s82, s12
    s_lshl_b32 s82, s82, 16
    ds_read_b128 a[136:139], v18 offset:18432
    v_mfma_f32_16x16x32_bf16 v[124:127], a[152:155], a[248:251], v[124:127]
    s_add_u32 s82, s82, s81
    v_exp_f32 v103, v103
    v_mfma_f32_16x16x32_bf16 v[124:127], a[156:159], a[252:255], v[124:127]
    s_cmp_ge_u32 s12, 17
    s_cselect_b32 s82, 2147471360, s82
    ds_read_b128 a[140:143], v18 offset:19456
    v_cvt_pk_bf16_f32 v51, v102, v103
    v_mfma_f32_16x16x32_bf16 v[40:43], v[28:31], v[56:59], v[40:43]
    s_add_u32 s12, s12, 1
    v_exp_f32 v104, v104
    v_mfma_f32_16x16x32_bf16 v[44:47], v[28:31], v[60:63], v[44:47]
    ds_read_b128 a[144:147], v18 offset:20480
    v_min_f32 v87, v87, v67
    v_mfma_f32_16x16x32_bf16 v[192:195], a[160:163], v[56:59], v[192:195]
    v_exp_f32 v105, v105
    v_mfma_f32_16x16x32_bf16 v[224:227], a[160:163], v[60:63], v[224:227]
    ds_read_b128 a[148:151], v18 offset:21504
    v_cvt_pk_bf16_f32 v52, v104, v105
    v_mfma_f32_16x16x32_bf16 v[196:199], a[164:167], v[56:59], v[196:199]
    v_exp_f32 v106, v106
    v_mfma_f32_16x16x32_bf16 v[228:231], a[164:167], v[60:63], v[228:231]
    ds_read_b128 a[152:155], v18 offset:22528
    v_add_f32 v88, 0x73800000, v21
    v_mfma_f32_16x16x32_bf16 v[200:203], a[168:171], v[56:59], v[200:203]
    v_exp_f32 v107, v107
    v_mfma_f32_16x16x32_bf16 v[232:235], a[168:171], v[60:63], v[232:235]
    ds_read_b128 a[156:159], v18 offset:23552
    v_cvt_pk_bf16_f32 v53, v106, v107
    v_mfma_f32_16x16x32_bf16 v[204:207], a[172:175], v[56:59], v[204:207]
    v_exp_f32 v108, v108
    v_mfma_f32_16x16x32_bf16 v[236:239], a[172:175], v[60:63], v[236:239]
    buffer_load_dwordx4 v10, s[28:31], s98 offen offset:2048  lds
    v_mfma_f32_16x16x32_bf16 v[208:211], a[176:179], v[56:59], v[208:211]
    v_exp_f32 v109, v109
    v_mfma_f32_16x16x32_bf16 v[240:243], a[176:179], v[60:63], v[240:243]
    v_cvt_pk_bf16_f32 v54, v108, v109
    v_xor_b32 v18, 196608, v18
    v_mfma_f32_16x16x32_bf16 v[212:215], a[180:183], v[56:59], v[212:215]
    v_exp_f32 v110, v110
    v_mfma_f32_16x16x32_bf16 v[244:247], a[180:183], v[60:63], v[244:247]
    buffer_load_dwordx4 v11, s[28:31], s98 offen offset:3072  lds
    v_mfma_f32_16x16x32_bf16 v[216:219], a[184:187], v[56:59], v[216:219]
    s_xor_b32 s74, s24, 12288
    v_exp_f32 v111, v111
    v_mfma_f32_16x16x32_bf16 v[248:251], a[184:187], v[60:63], v[248:251]
    v_cvt_pk_bf16_f32 v55, v110, v111
    v_min_f32 v88, v88, v68
    v_mfma_f32_16x16x32_bf16 v[220:223], a[188:191], v[56:59], v[220:223]
    buffer_load_dwordx4 a[116:119], v1, s[8:11], s74 offen offset:1024
    v_mfma_f32_16x16x32_bf16 v[252:255], a[188:191], v[60:63], v[252:255]
    s_xor_b32 s74, s24, 12288
    buffer_load_dwordx4 a[120:123], v1, s[8:11], s74 offen offset:2048
    s_xor_b32 s74, s24, 12288
    buffer_load_dwordx4 a[124:127], v1, s[8:11], s74 offen offset:3072
    s_waitcnt vmcnt(13) lgkmcnt(0)
    s_barrier
    v_mfma_f32_16x16x32_bf16 v[96:99], a[128:131], a[192:195], v[64:67]
    s_add_u32 m0, s15, 0
    ds_read_b128 a[160:163], v19 offset:0
    v_mfma_f32_16x16x32_bf16 v[96:99], a[132:135], a[196:199], v[96:99]
    ds_read_b128 a[164:167], v19 offset:1024
    v_mfma_f32_16x16x32_bf16 v[96:99], a[136:139], a[200:203], v[96:99]
    v_exp_f32 v112, v112
    v_mfma_f32_16x16x32_bf16 v[96:99], a[140:143], a[204:207], v[96:99]
    buffer_load_dwordx4 v1, s[8:11], s82 offen offset:0 lds
    v_mfma_f32_16x16x32_bf16 v[104:107], a[128:131], a[208:211], v[68:71]
    v_exp_f32 v113, v113
    v_mfma_f32_16x16x32_bf16 v[104:107], a[132:135], a[212:215], v[104:107]
    ds_read_b128 a[168:171], v19 offset:2048
    v_cvt_pk_bf16_f32 v56, v112, v113
    v_mfma_f32_16x16x32_bf16 v[104:107], a[136:139], a[216:219], v[104:107]
    v_exp_f32 v114, v114
    v_mfma_f32_16x16x32_bf16 v[104:107], a[140:143], a[220:223], v[104:107]
    buffer_load_dwordx4 v1, s[8:11], s82 offen offset:1024 lds
    v_mfma_f32_16x16x32_bf16 v[100:103], a[144:147], a[192:195], v[64:67]
    v_exp_f32 v115, v115
    v_mfma_f32_16x16x32_bf16 v[100:103], a[148:151], a[196:199], v[100:103]
    ds_read_b128 a[172:175], v19 offset:3072
    v_cvt_pk_bf16_f32 v57, v114, v115
    v_mfma_f32_16x16x32_bf16 v[100:103], a[152:155], a[200:203], v[100:103]
    v_exp_f32 v116, v116
    v_mfma_f32_16x16x32_bf16 v[100:103], a[156:159], a[204:207], v[100:103]
    buffer_load_dwordx4 v1, s[8:11], s82 offen offset:2048 lds
    v_mfma_f32_16x16x32_bf16 v[108:111], a[144:147], a[208:211], v[68:71]
    v_exp_f32 v117, v117
    v_mfma_f32_16x16x32_bf16 v[108:111], a[148:151], a[212:215], v[108:111]
    ds_read_b128 a[176:179], v20 offset:4096
    v_cvt_pk_bf16_f32 v58, v116, v117
    v_mfma_f32_16x16x32_bf16 v[108:111], a[152:155], a[216:219], v[108:111]
    v_exp_f32 v118, v118
    v_mfma_f32_16x16x32_bf16 v[108:111], a[156:159], a[220:223], v[108:111]
    buffer_load_dwordx4 v1, s[8:11], s82 offen offset:3072 lds
    v_mfma_f32_16x16x32_bf16 v[32:35], v[28:31], v[48:51], v[32:35]
    s_add_u32 m0, s15, 4096
    v_exp_f32 v119, v119
    v_mfma_f32_16x16x32_bf16 v[36:39], v[28:31], v[52:55], v[36:39]
    s_waitcnt lgkmcnt(4)
    ds_read_b128 a[180:183], v20 offset:5120
    v_cvt_pk_bf16_f32 v59, v118, v119
    v_mfma_f32_16x16x32_bf16 v[128:131], a[160:163], v[48:51], v[128:131]
    v_exp_f32 v120, v120
    v_mfma_f32_16x16x32_bf16 v[160:163], a[160:163], v[52:55], v[160:163]
    s_waitcnt lgkmcnt(4)
    v_mfma_f32_16x16x32_bf16 v[132:135], a[164:167], v[48:51], v[132:135]
    v_exp_f32 v121, v121
    v_mfma_f32_16x16x32_bf16 v[164:167], a[164:167], v[52:55], v[164:167]
    s_waitcnt lgkmcnt(3)
    ds_read_b128 a[184:187], v20 offset:6144
    v_cvt_pk_bf16_f32 v60, v120, v121
    v_mfma_f32_16x16x32_bf16 v[136:139], a[168:171], v[48:51], v[136:139]
    s_waitcnt lgkmcnt(3)
    v_exp_f32 v122, v122
    v_mfma_f32_16x16x32_bf16 v[168:171], a[168:171], v[52:55], v[168:171]
    buffer_load_dwordx4 v15, s[8:11], s82 offen offset:0 lds
    v_mfma_f32_16x16x32_bf16 v[140:143], a[172:175], v[48:51], v[140:143]
    v_exp_f32 v123, v123
    v_mfma_f32_16x16x32_bf16 v[172:175], a[172:175], v[52:55], v[172:175]
    s_waitcnt lgkmcnt(2)
    ds_read_b128 a[188:191], v20 offset:7168
    v_cvt_pk_bf16_f32 v61, v122, v123
    v_mfma_f32_16x16x32_bf16 v[144:147], a[176:179], v[48:51], v[144:147]
    s_waitcnt lgkmcnt(2)
    v_exp_f32 v124, v124
    v_mfma_f32_16x16x32_bf16 v[176:179], a[176:179], v[52:55], v[176:179]
    buffer_load_dwordx4 v15, s[8:11], s82 offen offset:1024 lds
    v_mfma_f32_16x16x32_bf16 v[148:151], a[180:183], v[48:51], v[148:151]
    v_exp_f32 v125, v125
    v_mfma_f32_16x16x32_bf16 v[180:183], a[180:183], v[52:55], v[180:183]
    s_waitcnt lgkmcnt(1)
    v_cvt_pk_bf16_f32 v62, v124, v125
    v_mfma_f32_16x16x32_bf16 v[152:155], a[184:187], v[48:51], v[152:155]
    s_waitcnt lgkmcnt(0)
    v_exp_f32 v126, v126
    v_mfma_f32_16x16x32_bf16 v[184:187], a[184:187], v[52:55], v[184:187]
    buffer_load_dwordx4 v15, s[8:11], s82 offen offset:2048 lds
    v_mfma_f32_16x16x32_bf16 v[156:159], a[188:191], v[48:51], v[156:159]
    v_exp_f32 v127, v127
    v_mfma_f32_16x16x32_bf16 v[188:191], a[188:191], v[52:55], v[188:191]
    v_cvt_pk_bf16_f32 v63, v126, v127
    v_mfma_f32_16x16x32_bf16 v[112:115], a[128:131], a[224:227], v[72:75]
    v_mfma_f32_16x16x32_bf16 v[112:115], a[132:135], a[228:231], v[112:115]
    v_mfma_f32_16x16x32_bf16 v[112:115], a[136:139], a[232:235], v[112:115]
    v_exp_f32 v96, v96
    v_mfma_f32_16x16x32_bf16 v[112:115], a[140:143], a[236:239], v[112:115]
    buffer_load_dwordx4 v15, s[8:11], s82 offen offset:3072 lds
    v_mfma_f32_16x16x32_bf16 v[120:123], a[128:131], a[240:243], v[76:79]
    s_xor_b32 s15, s15, 196608
    v_exp_f32 v97, v97
    v_mfma_f32_16x16x32_bf16 v[120:123], a[132:135], a[244:247], v[120:123]
    s_add_u32 m0, s16, 0
    ds_read_b128 a[128:131], v18 offset:0
    v_cvt_pk_bf16_f32 v48, v96, v97
    v_mfma_f32_16x16x32_bf16 v[120:123], a[136:139], a[248:251], v[120:123]
    v_exp_f32 v98, v98
    v_mfma_f32_16x16x32_bf16 v[120:123], a[140:143], a[252:255], v[120:123]
    buffer_load_dwordx4 v1, s[8:11], s19 offen offset:0 lds
    v_mfma_f32_16x16x32_bf16 v[116:119], a[144:147], a[224:227], v[72:75]
    v_exp_f32 v99, v99
    v_mfma_f32_16x16x32_bf16 v[116:119], a[148:151], a[228:231], v[116:119]
    ds_read_b128 a[132:135], v18 offset:1024
    v_cvt_pk_bf16_f32 v49, v98, v99
    v_mfma_f32_16x16x32_bf16 v[116:119], a[152:155], a[232:235], v[116:119]
    v_exp_f32 v100, v100
    v_mfma_f32_16x16x32_bf16 v[116:119], a[156:159], a[236:239], v[116:119]
    buffer_load_dwordx4 v1, s[8:11], s19 offen offset:1024 lds
    v_mfma_f32_16x16x32_bf16 v[124:127], a[144:147], a[240:243], v[76:79]
    v_exp_f32 v101, v101
    v_mfma_f32_16x16x32_bf16 v[124:127], a[148:151], a[244:247], v[124:127]
    ds_read_b128 a[136:139], v18 offset:2048
    v_cvt_pk_bf16_f32 v50, v100, v101
    v_mfma_f32_16x16x32_bf16 v[124:127], a[152:155], a[248:251], v[124:127]
    v_exp_f32 v102, v102
    v_mfma_f32_16x16x32_bf16 v[124:127], a[156:159], a[252:255], v[124:127]
    buffer_load_dwordx4 v1, s[8:11], s19 offen offset:2048 lds
    v_mfma_f32_16x16x32_bf16 v[40:43], v[28:31], v[56:59], v[40:43]
    v_exp_f32 v103, v103
    v_mfma_f32_16x16x32_bf16 v[44:47], v[28:31], v[60:63], v[44:47]
    ds_read_b128 a[140:143], v18 offset:3072
    v_cvt_pk_bf16_f32 v51, v102, v103
    v_mfma_f32_16x16x32_bf16 v[192:195], a[160:163], v[56:59], v[192:195]
    v_exp_f32 v104, v104
    v_mfma_f32_16x16x32_bf16 v[224:227], a[160:163], v[60:63], v[224:227]
    v_mfma_f32_16x16x32_bf16 v[196:199], a[164:167], v[56:59], v[196:199]
    v_exp_f32 v105, v105
    v_mfma_f32_16x16x32_bf16 v[228:231], a[164:167], v[60:63], v[228:231]
    ds_read_b128 a[144:147], v18 offset:4096
    v_cvt_pk_bf16_f32 v52, v104, v105
    v_mfma_f32_16x16x32_bf16 v[200:203], a[168:171], v[56:59], v[200:203]
    v_exp_f32 v106, v106
    v_mfma_f32_16x16x32_bf16 v[232:235], a[168:171], v[60:63], v[232:235]
    buffer_load_dwordx4 v1, s[8:11], s19 offen offset:3072 lds
    v_mfma_f32_16x16x32_bf16 v[204:207], a[172:175], v[56:59], v[204:207]
    s_add_u32 m0, s16, 4096
    v_exp_f32 v107, v107
    v_mfma_f32_16x16x32_bf16 v[236:239], a[172:175], v[60:63], v[236:239]
    ds_read_b128 a[148:151], v18 offset:5120
    v_cvt_pk_bf16_f32 v53, v106, v107
    v_mfma_f32_16x16x32_bf16 v[208:211], a[176:179], v[56:59], v[208:211]
    v_exp_f32 v108, v108
    v_mfma_f32_16x16x32_bf16 v[240:243], a[176:179], v[60:63], v[240:243]
    buffer_load_dwordx4 v15, s[8:11], s19 offen offset:0 lds
    v_mfma_f32_16x16x32_bf16 v[212:215], a[180:183], v[56:59], v[212:215]
    v_exp_f32 v109, v109
    v_mfma_f32_16x16x32_bf16 v[244:247], a[180:183], v[60:63], v[244:247]
    ds_read_b128 a[152:155], v18 offset:6144
    v_cvt_pk_bf16_f32 v54, v108, v109
    v_mfma_f32_16x16x32_bf16 v[216:219], a[184:187], v[56:59], v[216:219]
    v_exp_f32 v110, v110
    v_mfma_f32_16x16x32_bf16 v[248:251], a[184:187], v[60:63], v[248:251]
    buffer_load_dwordx4 v15, s[8:11], s19 offen offset:1024 lds
    v_mfma_f32_16x16x32_bf16 v[220:223], a[188:191], v[56:59], v[220:223]
    v_exp_f32 v111, v111
    v_mfma_f32_16x16x32_bf16 v[252:255], a[188:191], v[60:63], v[252:255]
    ds_read_b128 a[156:159], v18 offset:7168
    v_cvt_pk_bf16_f32 v55, v110, v111
    s_waitcnt lgkmcnt(7)
    v_mfma_f32_16x16x32_bf16 v[96:99], a[128:131], a[192:195], v[64:67]
    s_waitcnt lgkmcnt(6)
    ds_read_b128 a[160:163], v19 offset:16384
    v_mfma_f32_16x16x32_bf16 v[96:99], a[132:135], a[196:199], v[96:99]
    s_waitcnt lgkmcnt(6)
    ds_read_b128 a[164:167], v19 offset:17408
    v_mfma_f32_16x16x32_bf16 v[96:99], a[136:139], a[200:203], v[96:99]
    s_waitcnt lgkmcnt(6)
    v_exp_f32 v112, v112
    v_mfma_f32_16x16x32_bf16 v[96:99], a[140:143], a[204:207], v[96:99]
    buffer_load_dwordx4 v15, s[8:11], s19 offen offset:2048 lds
    v_mfma_f32_16x16x32_bf16 v[104:107], a[128:131], a[208:211], v[68:71]
    v_exp_f32 v113, v113
    v_mfma_f32_16x16x32_bf16 v[104:107], a[132:135], a[212:215], v[104:107]
    ds_read_b128 a[168:171], v19 offset:18432
    v_cvt_pk_bf16_f32 v56, v112, v113
    v_mfma_f32_16x16x32_bf16 v[104:107], a[136:139], a[216:219], v[104:107]
    s_waitcnt lgkmcnt(6)
    v_exp_f32 v114, v114
    v_mfma_f32_16x16x32_bf16 v[104:107], a[140:143], a[220:223], v[104:107]
    buffer_load_dwordx4 v15, s[8:11], s19 offen offset:3072 lds
    v_mfma_f32_16x16x32_bf16 v[100:103], a[144:147], a[192:195], v[64:67]
    s_waitcnt lgkmcnt(5)
    s_xor_b32 s16, s16, 98304
    v_exp_f32 v115, v115
    v_mfma_f32_16x16x32_bf16 v[100:103], a[148:151], a[196:199], v[100:103]
    s_waitcnt lgkmcnt(4)
    s_xor_b32 s74, s24, 16384
    ds_read_b128 a[172:175], v19 offset:19456
    v_cvt_pk_bf16_f32 v57, v114, v115
    v_mfma_f32_16x16x32_bf16 v[100:103], a[152:155], a[200:203], v[100:103]
    s_waitcnt lgkmcnt(4)
    v_exp_f32 v116, v116
    v_mfma_f32_16x16x32_bf16 v[100:103], a[156:159], a[204:207], v[100:103]
    buffer_load_dwordx4 a[0:3], v1, s[8:11], s74 offen offset:0
    v_mfma_f32_16x16x32_bf16 v[108:111], a[144:147], a[208:211], v[68:71]
    s_xor_b32 s74, s24, 16384
    v_exp_f32 v117, v117
    v_mfma_f32_16x16x32_bf16 v[108:111], a[148:151], a[212:215], v[108:111]
    ds_read_b128 a[176:179], v20 offset:20480
    v_cvt_pk_bf16_f32 v58, v116, v117
    v_mfma_f32_16x16x32_bf16 v[108:111], a[152:155], a[216:219], v[108:111]
    v_exp_f32 v118, v118
    v_mfma_f32_16x16x32_bf16 v[108:111], a[156:159], a[220:223], v[108:111]
    buffer_load_dwordx4 a[4:7], v1, s[8:11], s74 offen offset:1024
    v_mfma_f32_16x16x32_bf16 v[32:35], v[28:31], v[48:51], v[32:35]
    s_xor_b32 s74, s24, 16384
    v_exp_f32 v119, v119
    v_mfma_f32_16x16x32_bf16 v[36:39], v[28:31], v[52:55], v[36:39]
    s_waitcnt lgkmcnt(4)
    ds_read_b128 a[180:183], v20 offset:21504
    v_cvt_pk_bf16_f32 v59, v118, v119
    v_mfma_f32_16x16x32_bf16 v[128:131], a[160:163], v[48:51], v[128:131]
    s_waitcnt lgkmcnt(4)
    v_exp_f32 v120, v120
    v_mfma_f32_16x16x32_bf16 v[160:163], a[160:163], v[52:55], v[160:163]
    buffer_load_dwordx4 a[8:11], v1, s[8:11], s74 offen offset:2048
    v_mfma_f32_16x16x32_bf16 v[132:135], a[164:167], v[48:51], v[132:135]
    s_xor_b32 s74, s24, 16384
    v_exp_f32 v121, v121
    v_mfma_f32_16x16x32_bf16 v[164:167], a[164:167], v[52:55], v[164:167]
    s_waitcnt lgkmcnt(3)
    ds_read_b128 a[184:187], v20 offset:22528
    v_cvt_pk_bf16_f32 v60, v120, v121
    v_mfma_f32_16x16x32_bf16 v[136:139], a[168:171], v[48:51], v[136:139]
    s_waitcnt lgkmcnt(3)
    v_exp_f32 v122, v122
    v_mfma_f32_16x16x32_bf16 v[168:171], a[168:171], v[52:55], v[168:171]
    buffer_load_dwordx4 a[12:15], v1, s[8:11], s74 offen offset:3072
    v_mfma_f32_16x16x32_bf16 v[140:143], a[172:175], v[48:51], v[140:143]
    s_xor_b32 s74, s24, 20480
    v_exp_f32 v123, v123
    v_mfma_f32_16x16x32_bf16 v[172:175], a[172:175], v[52:55], v[172:175]
    s_waitcnt lgkmcnt(2)
    ds_read_b128 a[188:191], v20 offset:23552
    v_cvt_pk_bf16_f32 v61, v122, v123
    v_mfma_f32_16x16x32_bf16 v[144:147], a[176:179], v[48:51], v[144:147]
    s_waitcnt lgkmcnt(2)
    v_exp_f32 v124, v124
    v_mfma_f32_16x16x32_bf16 v[176:179], a[176:179], v[52:55], v[176:179]
    buffer_load_dwordx4 a[16:19], v1, s[8:11], s74 offen offset:0
    v_mfma_f32_16x16x32_bf16 v[148:151], a[180:183], v[48:51], v[148:151]
    s_xor_b32 s74, s24, 20480
    v_exp_f32 v125, v125
    v_mfma_f32_16x16x32_bf16 v[180:183], a[180:183], v[52:55], v[180:183]
    s_waitcnt lgkmcnt(1)
    v_cvt_pk_bf16_f32 v62, v124, v125
    v_xor_b32 v19, 98304, v19
    v_mfma_f32_16x16x32_bf16 v[152:155], a[184:187], v[48:51], v[152:155]
    buffer_load_dwordx4 a[20:23], v1, s[8:11], s74 offen offset:1024
    v_exp_f32 v126, v126
    v_mfma_f32_16x16x32_bf16 v[184:187], a[184:187], v[52:55], v[184:187]
    s_waitcnt lgkmcnt(0)
    v_xor_b32 v20, 98304, v20
    v_mfma_f32_16x16x32_bf16 v[156:159], a[188:191], v[48:51], v[156:159]
    v_exp_f32 v127, v127
    v_mfma_f32_16x16x32_bf16 v[188:191], a[188:191], v[52:55], v[188:191]
    v_cvt_pk_bf16_f32 v63, v126, v127
    v_mfma_f32_16x16x32_bf16 v[112:115], a[128:131], a[224:227], v[72:75]
    s_xor_b32 s74, s24, 20480
    v_exp_f32 v96, v96
    v_mfma_f32_16x16x32_bf16 v[112:115], a[132:135], a[228:231], v[112:115]
    buffer_load_dwordx4 a[24:27], v1, s[8:11], s74 offen offset:2048
    v_mfma_f32_16x16x32_bf16 v[112:115], a[136:139], a[232:235], v[112:115]
    s_xor_b32 s74, s24, 20480
    v_exp_f32 v97, v97
    v_mfma_f32_16x16x32_bf16 v[112:115], a[140:143], a[236:239], v[112:115]
    v_cvt_pk_bf16_f32 v48, v96, v97
    v_add_f32 v89, 0x73700000, v21
    v_mfma_f32_16x16x32_bf16 v[120:123], a[128:131], a[240:243], v[76:79]
    v_exp_f32 v98, v98
    v_mfma_f32_16x16x32_bf16 v[120:123], a[132:135], a[244:247], v[120:123]
    buffer_load_dwordx4 a[28:31], v1, s[8:11], s74 offen offset:3072
    v_mfma_f32_16x16x32_bf16 v[120:123], a[136:139], a[248:251], v[120:123]
    s_xor_b32 s74, s24, 24576
    v_exp_f32 v99, v99
    v_mfma_f32_16x16x32_bf16 v[120:123], a[140:143], a[252:255], v[120:123]
    buffer_load_dwordx4 a[32:35], v1, s[8:11], s74 offen offset:0
    v_mfma_f32_16x16x32_bf16 v[116:119], a[144:147], a[224:227], v[72:75]
    s_xor_b32 s74, s24, 24576
    v_exp_f32 v100, v100
    v_mfma_f32_16x16x32_bf16 v[116:119], a[148:151], a[228:231], v[116:119]
    ds_read_b128 a[128:131], v18 offset:16384
    v_cvt_pk_bf16_f32 v49, v98, v99
    v_mfma_f32_16x16x32_bf16 v[116:119], a[152:155], a[232:235], v[116:119]
    s_add_u32 s19, s82, 32768
    v_exp_f32 v101, v101
    v_mfma_f32_16x16x32_bf16 v[116:119], a[156:159], a[236:239], v[116:119]
    s_sub_u32 s82, s12, s13
    ds_read_b128 a[132:135], v18 offset:17408
    v_cvt_pk_bf16_f32 v50, v100, v101
    v_mfma_f32_16x16x32_bf16 v[124:127], a[144:147], a[240:243], v[76:79]
    s_sub_u32 s82, s82, 1
    v_exp_f32 v102, v102
    v_mfma_f32_16x16x32_bf16 v[124:127], a[148:151], a[244:247], v[124:127]
    s_cmp_gt_u32 s12, s13
    s_cselect_b32 s82, s82, s12
    s_lshl_b32 s82, s82, 16
    ds_read_b128 a[136:139], v18 offset:18432
    v_mfma_f32_16x16x32_bf16 v[124:127], a[152:155], a[248:251], v[124:127]
    s_add_u32 s82, s82, s81
    v_exp_f32 v103, v103
    v_mfma_f32_16x16x32_bf16 v[124:127], a[156:159], a[252:255], v[124:127]
    s_cmp_ge_u32 s12, 17
    s_cselect_b32 s82, 2147471360, s82
    ds_read_b128 a[140:143], v18 offset:19456
    v_cvt_pk_bf16_f32 v51, v102, v103
    v_mfma_f32_16x16x32_bf16 v[40:43], v[28:31], v[56:59], v[40:43]
    s_add_u32 s12, s12, 1
    v_exp_f32 v104, v104
    v_mfma_f32_16x16x32_bf16 v[44:47], v[28:31], v[60:63], v[44:47]
    ds_read_b128 a[144:147], v18 offset:20480
    v_min_f32 v89, v89, v69
    v_mfma_f32_16x16x32_bf16 v[192:195], a[160:163], v[56:59], v[192:195]
    v_exp_f32 v105, v105
    v_mfma_f32_16x16x32_bf16 v[224:227], a[160:163], v[60:63], v[224:227]
    ds_read_b128 a[148:151], v18 offset:21504
    v_cvt_pk_bf16_f32 v52, v104, v105
    v_mfma_f32_16x16x32_bf16 v[196:199], a[164:167], v[56:59], v[196:199]
    v_exp_f32 v106, v106
    v_mfma_f32_16x16x32_bf16 v[228:231], a[164:167], v[60:63], v[228:231]
    ds_read_b128 a[152:155], v18 offset:22528
    v_add_f32 v90, 0x73600000, v21
    v_mfma_f32_16x16x32_bf16 v[200:203], a[168:171], v[56:59], v[200:203]
    v_exp_f32 v107, v107
    v_mfma_f32_16x16x32_bf16 v[232:235], a[168:171], v[60:63], v[232:235]
    ds_read_b128 a[156:159], v18 offset:23552
    v_cvt_pk_bf16_f32 v53, v106, v107
    v_mfma_f32_16x16x32_bf16 v[204:207], a[172:175], v[56:59], v[204:207]
    v_exp_f32 v108, v108
    v_mfma_f32_16x16x32_bf16 v[236:239], a[172:175], v[60:63], v[236:239]
    buffer_load_dwordx4 a[36:39], v1, s[8:11], s74 offen offset:1024
    v_mfma_f32_16x16x32_bf16 v[208:211], a[176:179], v[56:59], v[208:211]
    s_xor_b32 s74, s24, 24576
    v_exp_f32 v109, v109
    v_mfma_f32_16x16x32_bf16 v[240:243], a[176:179], v[60:63], v[240:243]
    v_cvt_pk_bf16_f32 v54, v108, v109
    v_xor_b32 v18, 196608, v18
    v_mfma_f32_16x16x32_bf16 v[212:215], a[180:183], v[56:59], v[212:215]
    v_exp_f32 v110, v110
    v_mfma_f32_16x16x32_bf16 v[244:247], a[180:183], v[60:63], v[244:247]
    buffer_load_dwordx4 a[40:43], v1, s[8:11], s74 offen offset:2048
    v_mfma_f32_16x16x32_bf16 v[216:219], a[184:187], v[56:59], v[216:219]
    s_xor_b32 s74, s24, 24576
    v_exp_f32 v111, v111
    v_mfma_f32_16x16x32_bf16 v[248:251], a[184:187], v[60:63], v[248:251]
    v_cvt_pk_bf16_f32 v55, v110, v111
    v_min_f32 v90, v90, v70
    v_mfma_f32_16x16x32_bf16 v[220:223], a[188:191], v[56:59], v[220:223]
    buffer_load_dwordx4 a[44:47], v1, s[8:11], s74 offen offset:3072
    v_mfma_f32_16x16x32_bf16 v[252:255], a[188:191], v[60:63], v[252:255]
    v_add_f32 v91, 0x73500000, v21
    v_min_f32 v91, v91, v71
    v_add_f32 v92, 0, v21
    v_min_f32 v92, v92, v68
    s_waitcnt vmcnt(12) lgkmcnt(0)
    s_barrier
    v_mfma_f32_16x16x32_bf16 v[96:99], a[128:131], a[192:195], v[64:67]
    s_add_u32 m0, s15, 0
    ds_read_b128 a[160:163], v19 offset:0
    v_mfma_f32_16x16x32_bf16 v[96:99], a[132:135], a[196:199], v[96:99]
    ds_read_b128 a[164:167], v19 offset:1024
    v_mfma_f32_16x16x32_bf16 v[96:99], a[136:139], a[200:203], v[96:99]
    v_exp_f32 v112, v112
    v_mfma_f32_16x16x32_bf16 v[96:99], a[140:143], a[204:207], v[96:99]
    buffer_load_dwordx4 v1, s[8:11], s82 offen offset:0 lds
    v_mfma_f32_16x16x32_bf16 v[104:107], a[128:131], a[208:211], v[68:71]
    v_exp_f32 v113, v113
    v_mfma_f32_16x16x32_bf16 v[104:107], a[132:135], a[212:215], v[104:107]
    ds_read_b128 a[168:171], v19 offset:2048
    v_cvt_pk_bf16_f32 v56, v112, v113
    v_mfma_f32_16x16x32_bf16 v[104:107], a[136:139], a[216:219], v[104:107]
    v_exp_f32 v114, v114
    v_mfma_f32_16x16x32_bf16 v[104:107], a[140:143], a[220:223], v[104:107]
    buffer_load_dwordx4 v1, s[8:11], s82 offen offset:1024 lds
    v_mfma_f32_16x16x32_bf16 v[100:103], a[144:147], a[192:195], v[64:67]
    v_exp_f32 v115, v115
    v_mfma_f32_16x16x32_bf16 v[100:103], a[148:151], a[196:199], v[100:103]
    ds_read_b128 a[172:175], v19 offset:3072
    v_cvt_pk_bf16_f32 v57, v114, v115
    v_mfma_f32_16x16x32_bf16 v[100:103], a[152:155], a[200:203], v[100:103]
    v_exp_f32 v116, v116
    v_mfma_f32_16x16x32_bf16 v[100:103], a[156:159], a[204:207], v[100:103]
    buffer_load_dwordx4 v1, s[8:11], s82 offen offset:2048 lds
    v_mfma_f32_16x16x32_bf16 v[108:111], a[144:147], a[208:211], v[68:71]
    v_exp_f32 v117, v117
    v_mfma_f32_16x16x32_bf16 v[108:111], a[148:151], a[212:215], v[108:111]
    ds_read_b128 a[176:179], v20 offset:4096
    v_cvt_pk_bf16_f32 v58, v116, v117
    v_mfma_f32_16x16x32_bf16 v[108:111], a[152:155], a[216:219], v[108:111]
    v_exp_f32 v118, v118
    v_mfma_f32_16x16x32_bf16 v[108:111], a[156:159], a[220:223], v[108:111]
    buffer_load_dwordx4 v1, s[8:11], s82 offen offset:3072 lds
    v_mfma_f32_16x16x32_bf16 v[32:35], v[28:31], v[48:51], v[32:35]
    s_add_u32 m0, s15, 4096
    v_exp_f32 v119, v119
    v_mfma_f32_16x16x32_bf16 v[36:39], v[28:31], v[52:55], v[36:39]
    s_waitcnt lgkmcnt(4)
    ds_read_b128 a[180:183], v20 offset:5120
    v_cvt_pk_bf16_f32 v59, v118, v119
    v_mfma_f32_16x16x32_bf16 v[128:131], a[160:163], v[48:51], v[128:131]
    v_exp_f32 v120, v120
    v_mfma_f32_16x16x32_bf16 v[160:163], a[160:163], v[52:55], v[160:163]
    s_waitcnt lgkmcnt(4)
    v_mfma_f32_16x16x32_bf16 v[132:135], a[164:167], v[48:51], v[132:135]
    v_exp_f32 v121, v121
    v_mfma_f32_16x16x32_bf16 v[164:167], a[164:167], v[52:55], v[164:167]
    s_waitcnt lgkmcnt(3)
    ds_read_b128 a[184:187], v20 offset:6144
    v_cvt_pk_bf16_f32 v60, v120, v121
    v_mfma_f32_16x16x32_bf16 v[136:139], a[168:171], v[48:51], v[136:139]
    s_waitcnt lgkmcnt(3)
    v_exp_f32 v122, v122
    v_mfma_f32_16x16x32_bf16 v[168:171], a[168:171], v[52:55], v[168:171]
    buffer_load_dwordx4 v15, s[8:11], s82 offen offset:0 lds
    v_mfma_f32_16x16x32_bf16 v[140:143], a[172:175], v[48:51], v[140:143]
    v_exp_f32 v123, v123
    v_mfma_f32_16x16x32_bf16 v[172:175], a[172:175], v[52:55], v[172:175]
    s_waitcnt lgkmcnt(2)
    ds_read_b128 a[188:191], v20 offset:7168
    v_cvt_pk_bf16_f32 v61, v122, v123
    v_mfma_f32_16x16x32_bf16 v[144:147], a[176:179], v[48:51], v[144:147]
    s_waitcnt lgkmcnt(2)
    v_exp_f32 v124, v124
    v_mfma_f32_16x16x32_bf16 v[176:179], a[176:179], v[52:55], v[176:179]
    buffer_load_dwordx4 v15, s[8:11], s82 offen offset:1024 lds
    v_mfma_f32_16x16x32_bf16 v[148:151], a[180:183], v[48:51], v[148:151]
    v_exp_f32 v125, v125
    v_mfma_f32_16x16x32_bf16 v[180:183], a[180:183], v[52:55], v[180:183]
    s_waitcnt lgkmcnt(1)
    v_cvt_pk_bf16_f32 v62, v124, v125
    v_mfma_f32_16x16x32_bf16 v[152:155], a[184:187], v[48:51], v[152:155]
    s_waitcnt lgkmcnt(0)
    v_exp_f32 v126, v126
    v_mfma_f32_16x16x32_bf16 v[184:187], a[184:187], v[52:55], v[184:187]
    buffer_load_dwordx4 v15, s[8:11], s82 offen offset:2048 lds
    v_mfma_f32_16x16x32_bf16 v[156:159], a[188:191], v[48:51], v[156:159]
    v_exp_f32 v127, v127
    v_mfma_f32_16x16x32_bf16 v[188:191], a[188:191], v[52:55], v[188:191]
    v_cvt_pk_bf16_f32 v63, v126, v127
    v_mfma_f32_16x16x32_bf16 v[112:115], a[128:131], a[224:227], v[72:75]
    v_mfma_f32_16x16x32_bf16 v[112:115], a[132:135], a[228:231], v[112:115]
    v_mfma_f32_16x16x32_bf16 v[112:115], a[136:139], a[232:235], v[112:115]
    v_exp_f32 v96, v96
    v_mfma_f32_16x16x32_bf16 v[112:115], a[140:143], a[236:239], v[112:115]
    buffer_load_dwordx4 v15, s[8:11], s82 offen offset:3072 lds
    v_mfma_f32_16x16x32_bf16 v[120:123], a[128:131], a[240:243], v[76:79]
    s_xor_b32 s15, s15, 196608
    v_exp_f32 v97, v97
    v_mfma_f32_16x16x32_bf16 v[120:123], a[132:135], a[244:247], v[120:123]
    s_add_u32 m0, s16, 0
    ds_read_b128 a[128:131], v18 offset:0
    v_cvt_pk_bf16_f32 v48, v96, v97
    v_mfma_f32_16x16x32_bf16 v[120:123], a[136:139], a[248:251], v[120:123]
    v_exp_f32 v98, v98
    v_mfma_f32_16x16x32_bf16 v[120:123], a[140:143], a[252:255], v[120:123]
    buffer_load_dwordx4 v1, s[8:11], s19 offen offset:0 lds
    v_mfma_f32_16x16x32_bf16 v[116:119], a[144:147], a[224:227], v[72:75]
    v_exp_f32 v99, v99
    v_mfma_f32_16x16x32_bf16 v[116:119], a[148:151], a[228:231], v[116:119]
    ds_read_b128 a[132:135], v18 offset:1024
    v_cvt_pk_bf16_f32 v49, v98, v99
    v_mfma_f32_16x16x32_bf16 v[116:119], a[152:155], a[232:235], v[116:119]
    v_exp_f32 v100, v100
    v_mfma_f32_16x16x32_bf16 v[116:119], a[156:159], a[236:239], v[116:119]
    buffer_load_dwordx4 v1, s[8:11], s19 offen offset:1024 lds
    v_mfma_f32_16x16x32_bf16 v[124:127], a[144:147], a[240:243], v[76:79]
    v_exp_f32 v101, v101
    v_mfma_f32_16x16x32_bf16 v[124:127], a[148:151], a[244:247], v[124:127]
    ds_read_b128 a[136:139], v18 offset:2048
    v_cvt_pk_bf16_f32 v50, v100, v101
    v_mfma_f32_16x16x32_bf16 v[124:127], a[152:155], a[248:251], v[124:127]
    v_exp_f32 v102, v102
    v_mfma_f32_16x16x32_bf16 v[124:127], a[156:159], a[252:255], v[124:127]
    buffer_load_dwordx4 v1, s[8:11], s19 offen offset:2048 lds
    v_mfma_f32_16x16x32_bf16 v[40:43], v[28:31], v[56:59], v[40:43]
    v_exp_f32 v103, v103
    v_mfma_f32_16x16x32_bf16 v[44:47], v[28:31], v[60:63], v[44:47]
    ds_read_b128 a[140:143], v18 offset:3072
    v_cvt_pk_bf16_f32 v51, v102, v103
    v_mfma_f32_16x16x32_bf16 v[192:195], a[160:163], v[56:59], v[192:195]
    v_exp_f32 v104, v104
    v_mfma_f32_16x16x32_bf16 v[224:227], a[160:163], v[60:63], v[224:227]
    v_mfma_f32_16x16x32_bf16 v[196:199], a[164:167], v[56:59], v[196:199]
    v_exp_f32 v105, v105
    v_mfma_f32_16x16x32_bf16 v[228:231], a[164:167], v[60:63], v[228:231]
    ds_read_b128 a[144:147], v18 offset:4096
    v_cvt_pk_bf16_f32 v52, v104, v105
    v_mfma_f32_16x16x32_bf16 v[200:203], a[168:171], v[56:59], v[200:203]
    v_exp_f32 v106, v106
    v_mfma_f32_16x16x32_bf16 v[232:235], a[168:171], v[60:63], v[232:235]
    buffer_load_dwordx4 v1, s[8:11], s19 offen offset:3072 lds
    v_mfma_f32_16x16x32_bf16 v[204:207], a[172:175], v[56:59], v[204:207]
    s_add_u32 m0, s16, 4096
    v_exp_f32 v107, v107
    v_mfma_f32_16x16x32_bf16 v[236:239], a[172:175], v[60:63], v[236:239]
    ds_read_b128 a[148:151], v18 offset:5120
    v_cvt_pk_bf16_f32 v53, v106, v107
    v_mfma_f32_16x16x32_bf16 v[208:211], a[176:179], v[56:59], v[208:211]
    v_exp_f32 v108, v108
    v_mfma_f32_16x16x32_bf16 v[240:243], a[176:179], v[60:63], v[240:243]
    buffer_load_dwordx4 v15, s[8:11], s19 offen offset:0 lds
    v_mfma_f32_16x16x32_bf16 v[212:215], a[180:183], v[56:59], v[212:215]
    v_exp_f32 v109, v109
    v_mfma_f32_16x16x32_bf16 v[244:247], a[180:183], v[60:63], v[244:247]
    ds_read_b128 a[152:155], v18 offset:6144
    v_cvt_pk_bf16_f32 v54, v108, v109
    v_mfma_f32_16x16x32_bf16 v[216:219], a[184:187], v[56:59], v[216:219]
    v_exp_f32 v110, v110
    v_mfma_f32_16x16x32_bf16 v[248:251], a[184:187], v[60:63], v[248:251]
    buffer_load_dwordx4 v15, s[8:11], s19 offen offset:1024 lds
    v_mfma_f32_16x16x32_bf16 v[220:223], a[188:191], v[56:59], v[220:223]
    v_exp_f32 v111, v111
    v_mfma_f32_16x16x32_bf16 v[252:255], a[188:191], v[60:63], v[252:255]
    ds_read_b128 a[156:159], v18 offset:7168
    v_cvt_pk_bf16_f32 v55, v110, v111
    s_waitcnt lgkmcnt(7)
    v_mfma_f32_16x16x32_bf16 v[96:99], a[128:131], a[192:195], v[64:67]
    s_waitcnt lgkmcnt(6)
    ds_read_b128 a[160:163], v19 offset:16384
    v_add_f32 v93, 0xf1800000, v21
    v_mfma_f32_16x16x32_bf16 v[96:99], a[132:135], a[196:199], v[96:99]
    s_waitcnt lgkmcnt(6)
    ds_read_b128 a[164:167], v19 offset:17408
    v_min_f32 v93, v93, v69
    v_mfma_f32_16x16x32_bf16 v[96:99], a[136:139], a[200:203], v[96:99]
    s_waitcnt lgkmcnt(6)
    v_exp_f32 v112, v112
    v_mfma_f32_16x16x32_bf16 v[96:99], a[140:143], a[204:207], v[96:99]
    buffer_load_dwordx4 v15, s[8:11], s19 offen offset:2048 lds
    v_mfma_f32_16x16x32_bf16 v[104:107], a[128:131], a[208:211], v[68:71]
    v_exp_f32 v113, v113
    v_mfma_f32_16x16x32_bf16 v[104:107], a[132:135], a[212:215], v[104:107]
    ds_read_b128 a[168:171], v19 offset:18432
    v_cvt_pk_bf16_f32 v56, v112, v113
    v_mfma_f32_16x16x32_bf16 v[104:107], a[136:139], a[216:219], v[104:107]
    s_waitcnt lgkmcnt(6)
    v_exp_f32 v114, v114
    v_mfma_f32_16x16x32_bf16 v[104:107], a[140:143], a[220:223], v[104:107]
    buffer_load_dwordx4 v15, s[8:11], s19 offen offset:3072 lds
    v_mfma_f32_16x16x32_bf16 v[100:103], a[144:147], a[192:195], v[64:67]
    s_waitcnt lgkmcnt(5)
    s_xor_b32 s16, s16, 98304
    v_exp_f32 v115, v115
    v_mfma_f32_16x16x32_bf16 v[100:103], a[148:151], a[196:199], v[100:103]
    s_waitcnt lgkmcnt(4)
    s_xor_b32 s74, s24, 28672
    ds_read_b128 a[172:175], v19 offset:19456
    v_cvt_pk_bf16_f32 v57, v114, v115
    v_mfma_f32_16x16x32_bf16 v[100:103], a[152:155], a[200:203], v[100:103]
    s_waitcnt lgkmcnt(4)
    v_exp_f32 v116, v116
    v_mfma_f32_16x16x32_bf16 v[100:103], a[156:159], a[204:207], v[100:103]
    buffer_load_dwordx4 a[48:51], v1, s[8:11], s74 offen offset:0
    v_mfma_f32_16x16x32_bf16 v[108:111], a[144:147], a[208:211], v[68:71]
    s_xor_b32 s74, s24, 28672
    v_exp_f32 v117, v117
    v_mfma_f32_16x16x32_bf16 v[108:111], a[148:151], a[212:215], v[108:111]
    ds_read_b128 a[176:179], v20 offset:20480
    v_cvt_pk_bf16_f32 v58, v116, v117
    v_mfma_f32_16x16x32_bf16 v[108:111], a[152:155], a[216:219], v[108:111]
    v_exp_f32 v118, v118
    v_mfma_f32_16x16x32_bf16 v[108:111], a[156:159], a[220:223], v[108:111]
    buffer_load_dwordx4 a[52:55], v1, s[8:11], s74 offen offset:1024
    v_mfma_f32_16x16x32_bf16 v[32:35], v[28:31], v[48:51], v[32:35]
    s_xor_b32 s74, s24, 28672
    v_exp_f32 v119, v119
    v_mfma_f32_16x16x32_bf16 v[36:39], v[28:31], v[52:55], v[36:39]
    s_waitcnt lgkmcnt(4)
    ds_read_b128 a[180:183], v20 offset:21504
    v_cvt_pk_bf16_f32 v59, v118, v119
    v_mfma_f32_16x16x32_bf16 v[128:131], a[160:163], v[48:51], v[128:131]
    s_waitcnt lgkmcnt(4)
    v_exp_f32 v120, v120
    v_mfma_f32_16x16x32_bf16 v[160:163], a[160:163], v[52:55], v[160:163]
    buffer_load_dwordx4 a[56:59], v1, s[8:11], s74 offen offset:2048
    v_mfma_f32_16x16x32_bf16 v[132:135], a[164:167], v[48:51], v[132:135]
    s_xor_b32 s74, s24, 28672
    v_exp_f32 v121, v121
    v_mfma_f32_16x16x32_bf16 v[164:167], a[164:167], v[52:55], v[164:167]
    s_waitcnt lgkmcnt(3)
    ds_read_b128 a[184:187], v20 offset:22528
    v_cvt_pk_bf16_f32 v60, v120, v121
    v_mfma_f32_16x16x32_bf16 v[136:139], a[168:171], v[48:51], v[136:139]
    s_waitcnt lgkmcnt(3)
    v_exp_f32 v122, v122
    v_mfma_f32_16x16x32_bf16 v[168:171], a[168:171], v[52:55], v[168:171]
    buffer_load_dwordx4 a[60:63], v1, s[8:11], s74 offen offset:3072
    v_mfma_f32_16x16x32_bf16 v[140:143], a[172:175], v[48:51], v[140:143]
    v_exp_f32 v123, v123
    v_mfma_f32_16x16x32_bf16 v[172:175], a[172:175], v[52:55], v[172:175]
    s_waitcnt lgkmcnt(2)
    ds_read_b128 a[188:191], v20 offset:23552
    v_cvt_pk_bf16_f32 v61, v122, v123
    v_mfma_f32_16x16x32_bf16 v[144:147], a[176:179], v[48:51], v[144:147]
    v_exp_f32 v124, v124
    v_mfma_f32_16x16x32_bf16 v[176:179], a[176:179], v[52:55], v[176:179]
    s_waitcnt lgkmcnt(2)
    v_add_f32 v94, 0xf2000000, v21
    v_min_f32 v94, v94, v70
    v_mfma_f32_16x16x32_bf16 v[148:151], a[180:183], v[48:51], v[148:151]
    v_exp_f32 v125, v125
    v_mfma_f32_16x16x32_bf16 v[180:183], a[180:183], v[52:55], v[180:183]
    s_waitcnt lgkmcnt(1)
    v_cvt_pk_bf16_f32 v62, v124, v125
    v_xor_b32 v19, 98304, v19
    v_mfma_f32_16x16x32_bf16 v[152:155], a[184:187], v[48:51], v[152:155]
    v_exp_f32 v126, v126
    v_mfma_f32_16x16x32_bf16 v[184:187], a[184:187], v[52:55], v[184:187]
    s_waitcnt lgkmcnt(0)
    v_xor_b32 v20, 98304, v20
    v_add_f32 v95, 0xf2400000, v21
    v_mfma_f32_16x16x32_bf16 v[156:159], a[188:191], v[48:51], v[156:159]
    v_exp_f32 v127, v127
    v_mfma_f32_16x16x32_bf16 v[188:191], a[188:191], v[52:55], v[188:191]
    v_cvt_pk_bf16_f32 v63, v126, v127
    v_min_f32 v95, v95, v71
    v_mfma_f32_16x16x32_bf16 v[112:115], a[128:131], a[224:227], v[72:75]
    v_exp_f32 v96, v96
    v_mfma_f32_16x16x32_bf16 v[112:115], a[132:135], a[228:231], v[112:115]
    v_mfma_f32_16x16x32_bf16 v[112:115], a[136:139], a[232:235], v[112:115]
    v_exp_f32 v97, v97
    v_mfma_f32_16x16x32_bf16 v[112:115], a[140:143], a[236:239], v[112:115]
    v_cvt_pk_bf16_f32 v48, v96, v97
    v_mfma_f32_16x16x32_bf16 v[120:123], a[128:131], a[240:243], v[76:79]
    v_exp_f32 v98, v98
    v_mfma_f32_16x16x32_bf16 v[120:123], a[132:135], a[244:247], v[120:123]
    v_mfma_f32_16x16x32_bf16 v[120:123], a[136:139], a[248:251], v[120:123]
    v_exp_f32 v99, v99
    v_mfma_f32_16x16x32_bf16 v[120:123], a[140:143], a[252:255], v[120:123]
    v_mfma_f32_16x16x32_bf16 v[116:119], a[144:147], a[224:227], v[72:75]
    v_exp_f32 v100, v100
    v_mfma_f32_16x16x32_bf16 v[116:119], a[148:151], a[228:231], v[116:119]
    ds_read_b128 a[128:131], v18 offset:16384
    v_cvt_pk_bf16_f32 v49, v98, v99
    v_mfma_f32_16x16x32_bf16 v[116:119], a[152:155], a[232:235], v[116:119]
    s_add_u32 s19, s82, 32768
    v_exp_f32 v101, v101
    v_mfma_f32_16x16x32_bf16 v[116:119], a[156:159], a[236:239], v[116:119]
    s_sub_u32 s82, s12, s13
    ds_read_b128 a[132:135], v18 offset:17408
    v_cvt_pk_bf16_f32 v50, v100, v101
    v_mfma_f32_16x16x32_bf16 v[124:127], a[144:147], a[240:243], v[76:79]
    s_sub_u32 s82, s82, 1
    v_exp_f32 v102, v102
    v_mfma_f32_16x16x32_bf16 v[124:127], a[148:151], a[244:247], v[124:127]
    s_cmp_gt_u32 s12, s13
    s_cselect_b32 s82, s82, s12
    s_lshl_b32 s82, s82, 16
    ds_read_b128 a[136:139], v18 offset:18432
    v_mfma_f32_16x16x32_bf16 v[124:127], a[152:155], a[248:251], v[124:127]
    s_add_u32 s82, s82, s81
    v_exp_f32 v103, v103
    v_mfma_f32_16x16x32_bf16 v[124:127], a[156:159], a[252:255], v[124:127]
    s_cmp_ge_u32 s12, 17
    s_cselect_b32 s82, 2147471360, s82
    ds_read_b128 a[140:143], v18 offset:19456
    v_cvt_pk_bf16_f32 v51, v102, v103
    v_mfma_f32_16x16x32_bf16 v[40:43], v[28:31], v[56:59], v[40:43]
    s_add_u32 s12, s12, 1
    v_exp_f32 v104, v104
    v_mfma_f32_16x16x32_bf16 v[44:47], v[28:31], v[60:63], v[44:47]
    ds_read_b128 a[144:147], v18 offset:20480
    v_mfma_f32_16x16x32_bf16 v[192:195], a[160:163], v[56:59], v[192:195]
    v_exp_f32 v105, v105
    v_mfma_f32_16x16x32_bf16 v[224:227], a[160:163], v[60:63], v[224:227]
    ds_read_b128 a[148:151], v18 offset:21504
    v_cvt_pk_bf16_f32 v52, v104, v105
    v_mfma_f32_16x16x32_bf16 v[196:199], a[164:167], v[56:59], v[196:199]
    v_exp_f32 v106, v106
    v_mfma_f32_16x16x32_bf16 v[228:231], a[164:167], v[60:63], v[228:231]
    ds_read_b128 a[152:155], v18 offset:22528
    v_mfma_f32_16x16x32_bf16 v[200:203], a[168:171], v[56:59], v[200:203]
    v_exp_f32 v107, v107
    v_mfma_f32_16x16x32_bf16 v[232:235], a[168:171], v[60:63], v[232:235]
    ds_read_b128 a[156:159], v18 offset:23552
    v_cvt_pk_bf16_f32 v53, v106, v107
    v_mfma_f32_16x16x32_bf16 v[204:207], a[172:175], v[56:59], v[204:207]
    v_exp_f32 v108, v108
    v_mfma_f32_16x16x32_bf16 v[236:239], a[172:175], v[60:63], v[236:239]
    v_mfma_f32_16x16x32_bf16 v[208:211], a[176:179], v[56:59], v[208:211]
    v_exp_f32 v109, v109
    v_mfma_f32_16x16x32_bf16 v[240:243], a[176:179], v[60:63], v[240:243]
    v_cvt_pk_bf16_f32 v54, v108, v109
    v_xor_b32 v18, 196608, v18
    v_mfma_f32_16x16x32_bf16 v[212:215], a[180:183], v[56:59], v[212:215]
    v_exp_f32 v110, v110
    v_mfma_f32_16x16x32_bf16 v[244:247], a[180:183], v[60:63], v[244:247]
    v_mfma_f32_16x16x32_bf16 v[216:219], a[184:187], v[56:59], v[216:219]
    v_exp_f32 v111, v111
    v_mfma_f32_16x16x32_bf16 v[248:251], a[184:187], v[60:63], v[248:251]
    v_cvt_pk_bf16_f32 v55, v110, v111
    v_mfma_f32_16x16x32_bf16 v[220:223], a[188:191], v[56:59], v[220:223]
    v_mfma_f32_16x16x32_bf16 v[252:255], a[188:191], v[60:63], v[252:255]
    s_waitcnt vmcnt(4) lgkmcnt(0)
    s_barrier
    v_mfma_f32_16x16x32_bf16 v[96:99], a[128:131], a[192:195], v[64:67]
    s_add_u32 m0, s15, 0
    ds_read_b128 a[160:163], v19 offset:0
    v_mfma_f32_16x16x32_bf16 v[96:99], a[132:135], a[196:199], v[96:99]
    ds_read_b128 a[164:167], v19 offset:1024
    v_mfma_f32_16x16x32_bf16 v[96:99], a[136:139], a[200:203], v[96:99]
    v_exp_f32 v112, v112
    v_mfma_f32_16x16x32_bf16 v[96:99], a[140:143], a[204:207], v[96:99]
    buffer_load_dwordx4 v1, s[8:11], s82 offen offset:0 lds
    v_mfma_f32_16x16x32_bf16 v[104:107], a[128:131], a[208:211], v[68:71]
    v_exp_f32 v113, v113
    v_mfma_f32_16x16x32_bf16 v[104:107], a[132:135], a[212:215], v[104:107]
    ds_read_b128 a[168:171], v19 offset:2048
    v_cvt_pk_bf16_f32 v56, v112, v113
    v_mfma_f32_16x16x32_bf16 v[104:107], a[136:139], a[216:219], v[104:107]
    v_exp_f32 v114, v114
    v_mfma_f32_16x16x32_bf16 v[104:107], a[140:143], a[220:223], v[104:107]
    buffer_load_dwordx4 v1, s[8:11], s82 offen offset:1024 lds
    v_mfma_f32_16x16x32_bf16 v[100:103], a[144:147], a[192:195], v[64:67]
    v_exp_f32 v115, v115
    v_mfma_f32_16x16x32_bf16 v[100:103], a[148:151], a[196:199], v[100:103]
    ds_read_b128 a[172:175], v19 offset:3072
    v_cvt_pk_bf16_f32 v57, v114, v115
    v_mfma_f32_16x16x32_bf16 v[100:103], a[152:155], a[200:203], v[100:103]
    v_exp_f32 v116, v116
    v_mfma_f32_16x16x32_bf16 v[100:103], a[156:159], a[204:207], v[100:103]
    buffer_load_dwordx4 v1, s[8:11], s82 offen offset:2048 lds
    v_mfma_f32_16x16x32_bf16 v[108:111], a[144:147], a[208:211], v[68:71]
    v_exp_f32 v117, v117
    v_mfma_f32_16x16x32_bf16 v[108:111], a[148:151], a[212:215], v[108:111]
    ds_read_b128 a[176:179], v20 offset:4096
    v_cvt_pk_bf16_f32 v58, v116, v117
    v_mfma_f32_16x16x32_bf16 v[108:111], a[152:155], a[216:219], v[108:111]
    v_exp_f32 v118, v118
    v_mfma_f32_16x16x32_bf16 v[108:111], a[156:159], a[220:223], v[108:111]
    buffer_load_dwordx4 v1, s[8:11], s82 offen offset:3072 lds
    v_mfma_f32_16x16x32_bf16 v[32:35], v[28:31], v[48:51], v[32:35]
    s_add_u32 m0, s15, 4096
    v_exp_f32 v119, v119
    v_mfma_f32_16x16x32_bf16 v[36:39], v[28:31], v[52:55], v[36:39]
    s_waitcnt lgkmcnt(4)
    ds_read_b128 a[180:183], v20 offset:5120
    v_cvt_pk_bf16_f32 v59, v118, v119
    v_mfma_f32_16x16x32_bf16 v[128:131], a[160:163], v[48:51], v[128:131]
    v_exp_f32 v120, v120
    v_mfma_f32_16x16x32_bf16 v[160:163], a[160:163], v[52:55], v[160:163]
    s_waitcnt lgkmcnt(4)
    v_mfma_f32_16x16x32_bf16 v[132:135], a[164:167], v[48:51], v[132:135]
    v_exp_f32 v121, v121
    v_mfma_f32_16x16x32_bf16 v[164:167], a[164:167], v[52:55], v[164:167]
    s_waitcnt lgkmcnt(3)
    ds_read_b128 a[184:187], v20 offset:6144
    v_cvt_pk_bf16_f32 v60, v120, v121
    v_mfma_f32_16x16x32_bf16 v[136:139], a[168:171], v[48:51], v[136:139]
    s_waitcnt lgkmcnt(3)
    v_exp_f32 v122, v122
    v_mfma_f32_16x16x32_bf16 v[168:171], a[168:171], v[52:55], v[168:171]
    buffer_load_dwordx4 v15, s[8:11], s82 offen offset:0 lds
    v_mfma_f32_16x16x32_bf16 v[140:143], a[172:175], v[48:51], v[140:143]
    v_exp_f32 v123, v123
    v_mfma_f32_16x16x32_bf16 v[172:175], a[172:175], v[52:55], v[172:175]
    s_waitcnt lgkmcnt(2)
    ds_read_b128 a[188:191], v20 offset:7168
    v_cvt_pk_bf16_f32 v61, v122, v123
    v_mfma_f32_16x16x32_bf16 v[144:147], a[176:179], v[48:51], v[144:147]
    s_waitcnt lgkmcnt(2)
    v_exp_f32 v124, v124
    v_mfma_f32_16x16x32_bf16 v[176:179], a[176:179], v[52:55], v[176:179]
    buffer_load_dwordx4 v15, s[8:11], s82 offen offset:1024 lds
    v_mfma_f32_16x16x32_bf16 v[148:151], a[180:183], v[48:51], v[148:151]
    v_exp_f32 v125, v125
    v_mfma_f32_16x16x32_bf16 v[180:183], a[180:183], v[52:55], v[180:183]
    s_waitcnt lgkmcnt(1)
    v_cvt_pk_bf16_f32 v62, v124, v125
    v_mfma_f32_16x16x32_bf16 v[152:155], a[184:187], v[48:51], v[152:155]
    s_waitcnt lgkmcnt(0)
    v_exp_f32 v126, v126
    v_mfma_f32_16x16x32_bf16 v[184:187], a[184:187], v[52:55], v[184:187]
    buffer_load_dwordx4 v15, s[8:11], s82 offen offset:2048 lds
    v_mfma_f32_16x16x32_bf16 v[156:159], a[188:191], v[48:51], v[156:159]
    v_exp_f32 v127, v127
    v_mfma_f32_16x16x32_bf16 v[188:191], a[188:191], v[52:55], v[188:191]
    v_cvt_pk_bf16_f32 v63, v126, v127
    v_mfma_f32_16x16x32_bf16 v[112:115], a[128:131], a[224:227], v[72:75]
    v_mfma_f32_16x16x32_bf16 v[112:115], a[132:135], a[228:231], v[112:115]
    v_mfma_f32_16x16x32_bf16 v[112:115], a[136:139], a[232:235], v[112:115]
    v_exp_f32 v96, v96
    v_mfma_f32_16x16x32_bf16 v[112:115], a[140:143], a[236:239], v[112:115]
    buffer_load_dwordx4 v15, s[8:11], s82 offen offset:3072 lds
    v_mfma_f32_16x16x32_bf16 v[120:123], a[128:131], a[240:243], v[76:79]
    s_xor_b32 s15, s15, 196608
    v_exp_f32 v97, v97
    v_mfma_f32_16x16x32_bf16 v[120:123], a[132:135], a[244:247], v[120:123]
    s_add_u32 m0, s16, 0
    ds_read_b128 a[128:131], v18 offset:0
    v_cvt_pk_bf16_f32 v48, v96, v97
    v_mfma_f32_16x16x32_bf16 v[120:123], a[136:139], a[248:251], v[120:123]
    v_exp_f32 v98, v98
    v_mfma_f32_16x16x32_bf16 v[120:123], a[140:143], a[252:255], v[120:123]
    buffer_load_dwordx4 v1, s[8:11], s19 offen offset:0 lds
    v_mfma_f32_16x16x32_bf16 v[116:119], a[144:147], a[224:227], v[72:75]
    v_exp_f32 v99, v99
    v_mfma_f32_16x16x32_bf16 v[116:119], a[148:151], a[228:231], v[116:119]
    ds_read_b128 a[132:135], v18 offset:1024
    v_cvt_pk_bf16_f32 v49, v98, v99
    v_mfma_f32_16x16x32_bf16 v[116:119], a[152:155], a[232:235], v[116:119]
    v_exp_f32 v100, v100
    v_mfma_f32_16x16x32_bf16 v[116:119], a[156:159], a[236:239], v[116:119]
    buffer_load_dwordx4 v1, s[8:11], s19 offen offset:1024 lds
    v_mfma_f32_16x16x32_bf16 v[124:127], a[144:147], a[240:243], v[76:79]
    v_exp_f32 v101, v101
    v_mfma_f32_16x16x32_bf16 v[124:127], a[148:151], a[244:247], v[124:127]
    ds_read_b128 a[136:139], v18 offset:2048
    v_cvt_pk_bf16_f32 v50, v100, v101
    v_mfma_f32_16x16x32_bf16 v[124:127], a[152:155], a[248:251], v[124:127]
    v_exp_f32 v102, v102
    v_mfma_f32_16x16x32_bf16 v[124:127], a[156:159], a[252:255], v[124:127]
    buffer_load_dwordx4 v1, s[8:11], s19 offen offset:2048 lds
    v_mfma_f32_16x16x32_bf16 v[40:43], v[28:31], v[56:59], v[40:43]
    v_exp_f32 v103, v103
    v_mfma_f32_16x16x32_bf16 v[44:47], v[28:31], v[60:63], v[44:47]
    ds_read_b128 a[140:143], v18 offset:3072
    v_cvt_pk_bf16_f32 v51, v102, v103
    v_mfma_f32_16x16x32_bf16 v[192:195], a[160:163], v[56:59], v[192:195]
    v_exp_f32 v104, v104
    v_mfma_f32_16x16x32_bf16 v[224:227], a[160:163], v[60:63], v[224:227]
    v_mfma_f32_16x16x32_bf16 v[196:199], a[164:167], v[56:59], v[196:199]
    v_exp_f32 v105, v105
    v_mfma_f32_16x16x32_bf16 v[228:231], a[164:167], v[60:63], v[228:231]
    ds_read_b128 a[144:147], v18 offset:4096
    v_cvt_pk_bf16_f32 v52, v104, v105
    v_mfma_f32_16x16x32_bf16 v[200:203], a[168:171], v[56:59], v[200:203]
    v_exp_f32 v106, v106
    v_mfma_f32_16x16x32_bf16 v[232:235], a[168:171], v[60:63], v[232:235]
    buffer_load_dwordx4 v1, s[8:11], s19 offen offset:3072 lds
    v_mfma_f32_16x16x32_bf16 v[204:207], a[172:175], v[56:59], v[204:207]
    s_add_u32 m0, s16, 4096
    v_exp_f32 v107, v107
    v_mfma_f32_16x16x32_bf16 v[236:239], a[172:175], v[60:63], v[236:239]
    ds_read_b128 a[148:151], v18 offset:5120
    v_cvt_pk_bf16_f32 v53, v106, v107
    v_mfma_f32_16x16x32_bf16 v[208:211], a[176:179], v[56:59], v[208:211]
    v_exp_f32 v108, v108
    v_mfma_f32_16x16x32_bf16 v[240:243], a[176:179], v[60:63], v[240:243]
    buffer_load_dwordx4 v15, s[8:11], s19 offen offset:0 lds
    v_mfma_f32_16x16x32_bf16 v[212:215], a[180:183], v[56:59], v[212:215]
    v_exp_f32 v109, v109
    v_mfma_f32_16x16x32_bf16 v[244:247], a[180:183], v[60:63], v[244:247]
    ds_read_b128 a[152:155], v18 offset:6144
    v_cvt_pk_bf16_f32 v54, v108, v109
    v_mfma_f32_16x16x32_bf16 v[216:219], a[184:187], v[56:59], v[216:219]
    v_exp_f32 v110, v110
    v_mfma_f32_16x16x32_bf16 v[248:251], a[184:187], v[60:63], v[248:251]
    buffer_load_dwordx4 v15, s[8:11], s19 offen offset:1024 lds
    v_mfma_f32_16x16x32_bf16 v[220:223], a[188:191], v[56:59], v[220:223]
    v_exp_f32 v111, v111
    v_mfma_f32_16x16x32_bf16 v[252:255], a[188:191], v[60:63], v[252:255]
    ds_read_b128 a[156:159], v18 offset:7168
    v_cvt_pk_bf16_f32 v55, v110, v111
    s_cmp_eq_u32 s14, 0
    s_cbranch_scc1 L_t2_diag
.p2align 3
L_t2_loop:
    s_waitcnt lgkmcnt(7)
    v_mfma_f32_16x16x32_bf16 v[96:99], a[128:131], a[192:195], v[64:67]
    s_waitcnt lgkmcnt(6)
    ds_read_b128 a[160:163], v19 offset:16384
    v_mfma_f32_16x16x32_bf16 v[96:99], a[132:135], a[196:199], v[96:99]
    s_waitcnt lgkmcnt(6)
    ds_read_b128 a[164:167], v19 offset:17408
    v_mfma_f32_16x16x32_bf16 v[96:99], a[136:139], a[200:203], v[96:99]
    s_waitcnt lgkmcnt(6)
    v_exp_f32 v112, v112
    v_mfma_f32_16x16x32_bf16 v[96:99], a[140:143], a[204:207], v[96:99]
    buffer_load_dwordx4 v15, s[8:11], s19 offen offset:2048 lds
    v_mfma_f32_16x16x32_bf16 v[104:107], a[128:131], a[208:211], v[68:71]
    v_exp_f32 v113, v113
    v_mfma_f32_16x16x32_bf16 v[104:107], a[132:135], a[212:215], v[104:107]
    ds_read_b128 a[168:171], v19 offset:18432
    v_cvt_pk_bf16_f32 v56, v112, v113
    v_mfma_f32_16x16x32_bf16 v[104:107], a[136:139], a[216:219], v[104:107]
    s_waitcnt lgkmcnt(6)
    v_exp_f32 v114, v114
    v_mfma_f32_16x16x32_bf16 v[104:107], a[140:143], a[220:223], v[104:107]
    buffer_load_dwordx4 v15, s[8:11], s19 offen offset:3072 lds
    v_mfma_f32_16x16x32_bf16 v[100:103], a[144:147], a[192:195], v[64:67]
    s_waitcnt lgkmcnt(5)
    s_xor_b32 s16, s16, 98304
    v_exp_f32 v115, v115
    v_mfma_f32_16x16x32_bf16 v[100:103], a[148:151], a[196:199], v[100:103]
    s_waitcnt lgkmcnt(4)
    ds_read_b128 a[172:175], v19 offset:19456
    v_cvt_pk_bf16_f32 v57, v114, v115
    v_mfma_f32_16x16x32_bf16 v[100:103], a[152:155], a[200:203], v[100:103]
    s_waitcnt lgkmcnt(4)
    v_exp_f32 v116, v116
    v_mfma_f32_16x16x32_bf16 v[100:103], a[156:159], a[204:207], v[100:103]
    v_mfma_f32_16x16x32_bf16 v[108:111], a[144:147], a[208:211], v[68:71]
    v_exp_f32 v117, v117
    v_mfma_f32_16x16x32_bf16 v[108:111], a[148:151], a[212:215], v[108:111]
    ds_read_b128 a[176:179], v20 offset:20480
    v_cvt_pk_bf16_f32 v58, v116, v117
    v_mfma_f32_16x16x32_bf16 v[108:111], a[152:155], a[216:219], v[108:111]
    v_exp_f32 v118, v118
    v_mfma_f32_16x16x32_bf16 v[108:111], a[156:159], a[220:223], v[108:111]
    v_mfma_f32_16x16x32_bf16 v[32:35], v[28:31], v[48:51], v[32:35]
    v_exp_f32 v119, v119
    v_mfma_f32_16x16x32_bf16 v[36:39], v[28:31], v[52:55], v[36:39]
    s_waitcnt lgkmcnt(4)
    ds_read_b128 a[180:183], v20 offset:21504
    v_cvt_pk_bf16_f32 v59, v118, v119
    v_mfma_f32_16x16x32_bf16 v[128:131], a[160:163], v[48:51], v[128:131]
    v_exp_f32 v120, v120
    v_mfma_f32_16x16x32_bf16 v[160:163], a[160:163], v[52:55], v[160:163]
    s_waitcnt lgkmcnt(4)
    v_mfma_f32_16x16x32_bf16 v[132:135], a[164:167], v[48:51], v[132:135]
    v_exp_f32 v121, v121
    v_mfma_f32_16x16x32_bf16 v[164:167], a[164:167], v[52:55], v[164:167]
    s_waitcnt lgkmcnt(3)
    ds_read_b128 a[184:187], v20 offset:22528
    v_cvt_pk_bf16_f32 v60, v120, v121
    v_mfma_f32_16x16x32_bf16 v[136:139], a[168:171], v[48:51], v[136:139]
    v_exp_f32 v122, v122
    v_mfma_f32_16x16x32_bf16 v[168:171], a[168:171], v[52:55], v[168:171]
    s_waitcnt lgkmcnt(3)
    v_mfma_f32_16x16x32_bf16 v[140:143], a[172:175], v[48:51], v[140:143]
    v_exp_f32 v123, v123
    v_mfma_f32_16x16x32_bf16 v[172:175], a[172:175], v[52:55], v[172:175]
    s_waitcnt lgkmcnt(2)
    ds_read_b128 a[188:191], v20 offset:23552
    v_cvt_pk_bf16_f32 v61, v122, v123
    v_mfma_f32_16x16x32_bf16 v[144:147], a[176:179], v[48:51], v[144:147]
    v_exp_f32 v124, v124
    v_mfma_f32_16x16x32_bf16 v[176:179], a[176:179], v[52:55], v[176:179]
    s_waitcnt lgkmcnt(2)
    v_mfma_f32_16x16x32_bf16 v[148:151], a[180:183], v[48:51], v[148:151]
    v_exp_f32 v125, v125
    v_mfma_f32_16x16x32_bf16 v[180:183], a[180:183], v[52:55], v[180:183]
    s_waitcnt lgkmcnt(1)
    v_cvt_pk_bf16_f32 v62, v124, v125
    v_xor_b32 v19, 98304, v19
    v_mfma_f32_16x16x32_bf16 v[152:155], a[184:187], v[48:51], v[152:155]
    v_exp_f32 v126, v126
    v_mfma_f32_16x16x32_bf16 v[184:187], a[184:187], v[52:55], v[184:187]
    s_waitcnt lgkmcnt(0)
    v_xor_b32 v20, 98304, v20
    v_mfma_f32_16x16x32_bf16 v[156:159], a[188:191], v[48:51], v[156:159]
    v_exp_f32 v127, v127
    v_mfma_f32_16x16x32_bf16 v[188:191], a[188:191], v[52:55], v[188:191]
    v_cvt_pk_bf16_f32 v63, v126, v127
    v_mfma_f32_16x16x32_bf16 v[112:115], a[128:131], a[224:227], v[72:75]
    v_exp_f32 v96, v96
    v_mfma_f32_16x16x32_bf16 v[112:115], a[132:135], a[228:231], v[112:115]
    v_mfma_f32_16x16x32_bf16 v[112:115], a[136:139], a[232:235], v[112:115]
    v_exp_f32 v97, v97
    v_mfma_f32_16x16x32_bf16 v[112:115], a[140:143], a[236:239], v[112:115]
    v_cvt_pk_bf16_f32 v48, v96, v97
    v_mfma_f32_16x16x32_bf16 v[120:123], a[128:131], a[240:243], v[76:79]
    v_exp_f32 v98, v98
    v_mfma_f32_16x16x32_bf16 v[120:123], a[132:135], a[244:247], v[120:123]
    v_mfma_f32_16x16x32_bf16 v[120:123], a[136:139], a[248:251], v[120:123]
    v_exp_f32 v99, v99
    v_mfma_f32_16x16x32_bf16 v[120:123], a[140:143], a[252:255], v[120:123]
    v_mfma_f32_16x16x32_bf16 v[116:119], a[144:147], a[224:227], v[72:75]
    v_exp_f32 v100, v100
    v_mfma_f32_16x16x32_bf16 v[116:119], a[148:151], a[228:231], v[116:119]
    ds_read_b128 a[128:131], v18 offset:16384
    v_cvt_pk_bf16_f32 v49, v98, v99
    v_mfma_f32_16x16x32_bf16 v[116:119], a[152:155], a[232:235], v[116:119]
    s_add_u32 s19, s82, 32768
    v_exp_f32 v101, v101
    v_mfma_f32_16x16x32_bf16 v[116:119], a[156:159], a[236:239], v[116:119]
    s_sub_u32 s82, s12, s13
    ds_read_b128 a[132:135], v18 offset:17408
    v_cvt_pk_bf16_f32 v50, v100, v101
    v_mfma_f32_16x16x32_bf16 v[124:127], a[144:147], a[240:243], v[76:79]
    s_sub_u32 s82, s82, 1
    v_exp_f32 v102, v102
    v_mfma_f32_16x16x32_bf16 v[124:127], a[148:151], a[244:247], v[124:127]
    s_cmp_gt_u32 s12, s13
    s_cselect_b32 s82, s82, s12
    s_lshl_b32 s82, s82, 16
    ds_read_b128 a[136:139], v18 offset:18432
    v_mfma_f32_16x16x32_bf16 v[124:127], a[152:155], a[248:251], v[124:127]
    s_add_u32 s82, s82, s81
    v_exp_f32 v103, v103
    v_mfma_f32_16x16x32_bf16 v[124:127], a[156:159], a[252:255], v[124:127]
    s_cmp_ge_u32 s12, 17
    s_cselect_b32 s82, 2147471360, s82
    ds_read_b128 a[140:143], v18 offset:19456
    v_cvt_pk_bf16_f32 v51, v102, v103
    v_mfma_f32_16x16x32_bf16 v[40:43], v[28:31], v[56:59], v[40:43]
    s_add_u32 s12, s12, 1
    v_exp_f32 v104, v104
    v_mfma_f32_16x16x32_bf16 v[44:47], v[28:31], v[60:63], v[44:47]
    ds_read_b128 a[144:147], v18 offset:20480
    v_mfma_f32_16x16x32_bf16 v[192:195], a[160:163], v[56:59], v[192:195]
    v_exp_f32 v105, v105
    v_mfma_f32_16x16x32_bf16 v[224:227], a[160:163], v[60:63], v[224:227]
    ds_read_b128 a[148:151], v18 offset:21504
    v_cvt_pk_bf16_f32 v52, v104, v105
    v_mfma_f32_16x16x32_bf16 v[196:199], a[164:167], v[56:59], v[196:199]
    v_exp_f32 v106, v106
    v_mfma_f32_16x16x32_bf16 v[228:231], a[164:167], v[60:63], v[228:231]
    ds_read_b128 a[152:155], v18 offset:22528
    v_mfma_f32_16x16x32_bf16 v[200:203], a[168:171], v[56:59], v[200:203]
    v_exp_f32 v107, v107
    v_mfma_f32_16x16x32_bf16 v[232:235], a[168:171], v[60:63], v[232:235]
    ds_read_b128 a[156:159], v18 offset:23552
    v_cvt_pk_bf16_f32 v53, v106, v107
    v_mfma_f32_16x16x32_bf16 v[204:207], a[172:175], v[56:59], v[204:207]
    v_exp_f32 v108, v108
    v_mfma_f32_16x16x32_bf16 v[236:239], a[172:175], v[60:63], v[236:239]
    v_mfma_f32_16x16x32_bf16 v[208:211], a[176:179], v[56:59], v[208:211]
    v_exp_f32 v109, v109
    v_mfma_f32_16x16x32_bf16 v[240:243], a[176:179], v[60:63], v[240:243]
    v_cvt_pk_bf16_f32 v54, v108, v109
    v_xor_b32 v18, 196608, v18
    v_mfma_f32_16x16x32_bf16 v[212:215], a[180:183], v[56:59], v[212:215]
    v_exp_f32 v110, v110
    v_mfma_f32_16x16x32_bf16 v[244:247], a[180:183], v[60:63], v[244:247]
    v_mfma_f32_16x16x32_bf16 v[216:219], a[184:187], v[56:59], v[216:219]
    v_exp_f32 v111, v111
    v_mfma_f32_16x16x32_bf16 v[248:251], a[184:187], v[60:63], v[248:251]
    v_cvt_pk_bf16_f32 v55, v110, v111
    v_mfma_f32_16x16x32_bf16 v[220:223], a[188:191], v[56:59], v[220:223]
    v_mfma_f32_16x16x32_bf16 v[252:255], a[188:191], v[60:63], v[252:255]
    s_waitcnt vmcnt(0) lgkmcnt(0)
    s_barrier
    v_mfma_f32_16x16x32_bf16 v[96:99], a[128:131], a[192:195], v[64:67]
    s_add_u32 m0, s15, 0
    ds_read_b128 a[160:163], v19 offset:0
    v_mfma_f32_16x16x32_bf16 v[96:99], a[132:135], a[196:199], v[96:99]
    ds_read_b128 a[164:167], v19 offset:1024
    v_mfma_f32_16x16x32_bf16 v[96:99], a[136:139], a[200:203], v[96:99]
    v_exp_f32 v112, v112
    v_mfma_f32_16x16x32_bf16 v[96:99], a[140:143], a[204:207], v[96:99]
    buffer_load_dwordx4 v1, s[8:11], s82 offen offset:0 lds
    v_mfma_f32_16x16x32_bf16 v[104:107], a[128:131], a[208:211], v[68:71]
    v_exp_f32 v113, v113
    v_mfma_f32_16x16x32_bf16 v[104:107], a[132:135], a[212:215], v[104:107]
    ds_read_b128 a[168:171], v19 offset:2048
    v_cvt_pk_bf16_f32 v56, v112, v113
    v_mfma_f32_16x16x32_bf16 v[104:107], a[136:139], a[216:219], v[104:107]
    v_exp_f32 v114, v114
    v_mfma_f32_16x16x32_bf16 v[104:107], a[140:143], a[220:223], v[104:107]
    buffer_load_dwordx4 v1, s[8:11], s82 offen offset:1024 lds
    v_mfma_f32_16x16x32_bf16 v[100:103], a[144:147], a[192:195], v[64:67]
    v_exp_f32 v115, v115
    v_mfma_f32_16x16x32_bf16 v[100:103], a[148:151], a[196:199], v[100:103]
    ds_read_b128 a[172:175], v19 offset:3072
    v_cvt_pk_bf16_f32 v57, v114, v115
    v_mfma_f32_16x16x32_bf16 v[100:103], a[152:155], a[200:203], v[100:103]
    v_exp_f32 v116, v116
    v_mfma_f32_16x16x32_bf16 v[100:103], a[156:159], a[204:207], v[100:103]
    buffer_load_dwordx4 v1, s[8:11], s82 offen offset:2048 lds
    v_mfma_f32_16x16x32_bf16 v[108:111], a[144:147], a[208:211], v[68:71]
    v_exp_f32 v117, v117
    v_mfma_f32_16x16x32_bf16 v[108:111], a[148:151], a[212:215], v[108:111]
    ds_read_b128 a[176:179], v20 offset:4096
    v_cvt_pk_bf16_f32 v58, v116, v117
    v_mfma_f32_16x16x32_bf16 v[108:111], a[152:155], a[216:219], v[108:111]
    v_exp_f32 v118, v118
    v_mfma_f32_16x16x32_bf16 v[108:111], a[156:159], a[220:223], v[108:111]
    buffer_load_dwordx4 v1, s[8:11], s82 offen offset:3072 lds
    v_mfma_f32_16x16x32_bf16 v[32:35], v[28:31], v[48:51], v[32:35]
    s_add_u32 m0, s15, 4096
    v_exp_f32 v119, v119
    v_mfma_f32_16x16x32_bf16 v[36:39], v[28:31], v[52:55], v[36:39]
    s_waitcnt lgkmcnt(4)
    ds_read_b128 a[180:183], v20 offset:5120
    v_cvt_pk_bf16_f32 v59, v118, v119
    v_mfma_f32_16x16x32_bf16 v[128:131], a[160:163], v[48:51], v[128:131]
    v_exp_f32 v120, v120
    v_mfma_f32_16x16x32_bf16 v[160:163], a[160:163], v[52:55], v[160:163]
    s_waitcnt lgkmcnt(4)
    v_mfma_f32_16x16x32_bf16 v[132:135], a[164:167], v[48:51], v[132:135]
    v_exp_f32 v121, v121
    v_mfma_f32_16x16x32_bf16 v[164:167], a[164:167], v[52:55], v[164:167]
    s_waitcnt lgkmcnt(3)
    ds_read_b128 a[184:187], v20 offset:6144
    v_cvt_pk_bf16_f32 v60, v120, v121
    v_mfma_f32_16x16x32_bf16 v[136:139], a[168:171], v[48:51], v[136:139]
    s_waitcnt lgkmcnt(3)
    v_exp_f32 v122, v122
    v_mfma_f32_16x16x32_bf16 v[168:171], a[168:171], v[52:55], v[168:171]
    buffer_load_dwordx4 v15, s[8:11], s82 offen offset:0 lds
    v_mfma_f32_16x16x32_bf16 v[140:143], a[172:175], v[48:51], v[140:143]
    v_exp_f32 v123, v123
    v_mfma_f32_16x16x32_bf16 v[172:175], a[172:175], v[52:55], v[172:175]
    s_waitcnt lgkmcnt(2)
    ds_read_b128 a[188:191], v20 offset:7168
    v_cvt_pk_bf16_f32 v61, v122, v123
    v_mfma_f32_16x16x32_bf16 v[144:147], a[176:179], v[48:51], v[144:147]
    s_waitcnt lgkmcnt(2)
    v_exp_f32 v124, v124
    v_mfma_f32_16x16x32_bf16 v[176:179], a[176:179], v[52:55], v[176:179]
    buffer_load_dwordx4 v15, s[8:11], s82 offen offset:1024 lds
    v_mfma_f32_16x16x32_bf16 v[148:151], a[180:183], v[48:51], v[148:151]
    v_exp_f32 v125, v125
    v_mfma_f32_16x16x32_bf16 v[180:183], a[180:183], v[52:55], v[180:183]
    s_waitcnt lgkmcnt(1)
    v_cvt_pk_bf16_f32 v62, v124, v125
    v_mfma_f32_16x16x32_bf16 v[152:155], a[184:187], v[48:51], v[152:155]
    s_waitcnt lgkmcnt(0)
    v_exp_f32 v126, v126
    v_mfma_f32_16x16x32_bf16 v[184:187], a[184:187], v[52:55], v[184:187]
    buffer_load_dwordx4 v15, s[8:11], s82 offen offset:2048 lds
    v_mfma_f32_16x16x32_bf16 v[156:159], a[188:191], v[48:51], v[156:159]
    v_exp_f32 v127, v127
    v_mfma_f32_16x16x32_bf16 v[188:191], a[188:191], v[52:55], v[188:191]
    v_cvt_pk_bf16_f32 v63, v126, v127
    v_mfma_f32_16x16x32_bf16 v[112:115], a[128:131], a[224:227], v[72:75]
    v_mfma_f32_16x16x32_bf16 v[112:115], a[132:135], a[228:231], v[112:115]
    v_mfma_f32_16x16x32_bf16 v[112:115], a[136:139], a[232:235], v[112:115]
    v_exp_f32 v96, v96
    v_mfma_f32_16x16x32_bf16 v[112:115], a[140:143], a[236:239], v[112:115]
    buffer_load_dwordx4 v15, s[8:11], s82 offen offset:3072 lds
    v_mfma_f32_16x16x32_bf16 v[120:123], a[128:131], a[240:243], v[76:79]
    s_xor_b32 s15, s15, 196608
    v_exp_f32 v97, v97
    v_mfma_f32_16x16x32_bf16 v[120:123], a[132:135], a[244:247], v[120:123]
    s_add_u32 m0, s16, 0
    ds_read_b128 a[128:131], v18 offset:0
    v_cvt_pk_bf16_f32 v48, v96, v97
    v_mfma_f32_16x16x32_bf16 v[120:123], a[136:139], a[248:251], v[120:123]
    v_exp_f32 v98, v98
    v_mfma_f32_16x16x32_bf16 v[120:123], a[140:143], a[252:255], v[120:123]
    buffer_load_dwordx4 v1, s[8:11], s19 offen offset:0 lds
    v_mfma_f32_16x16x32_bf16 v[116:119], a[144:147], a[224:227], v[72:75]
    v_exp_f32 v99, v99
    v_mfma_f32_16x16x32_bf16 v[116:119], a[148:151], a[228:231], v[116:119]
    ds_read_b128 a[132:135], v18 offset:1024
    v_cvt_pk_bf16_f32 v49, v98, v99
    v_mfma_f32_16x16x32_bf16 v[116:119], a[152:155], a[232:235], v[116:119]
    v_exp_f32 v100, v100
    v_mfma_f32_16x16x32_bf16 v[116:119], a[156:159], a[236:239], v[116:119]
    buffer_load_dwordx4 v1, s[8:11], s19 offen offset:1024 lds
    v_mfma_f32_16x16x32_bf16 v[124:127], a[144:147], a[240:243], v[76:79]
    v_exp_f32 v101, v101
    v_mfma_f32_16x16x32_bf16 v[124:127], a[148:151], a[244:247], v[124:127]
    ds_read_b128 a[136:139], v18 offset:2048
    v_cvt_pk_bf16_f32 v50, v100, v101
    v_mfma_f32_16x16x32_bf16 v[124:127], a[152:155], a[248:251], v[124:127]
    v_exp_f32 v102, v102
    v_mfma_f32_16x16x32_bf16 v[124:127], a[156:159], a[252:255], v[124:127]
    buffer_load_dwordx4 v1, s[8:11], s19 offen offset:2048 lds
    v_mfma_f32_16x16x32_bf16 v[40:43], v[28:31], v[56:59], v[40:43]
    v_exp_f32 v103, v103
    v_mfma_f32_16x16x32_bf16 v[44:47], v[28:31], v[60:63], v[44:47]
    ds_read_b128 a[140:143], v18 offset:3072
    v_cvt_pk_bf16_f32 v51, v102, v103
    v_mfma_f32_16x16x32_bf16 v[192:195], a[160:163], v[56:59], v[192:195]
    v_exp_f32 v104, v104
    v_mfma_f32_16x16x32_bf16 v[224:227], a[160:163], v[60:63], v[224:227]
    v_mfma_f32_16x16x32_bf16 v[196:199], a[164:167], v[56:59], v[196:199]
    v_exp_f32 v105, v105
    v_mfma_f32_16x16x32_bf16 v[228:231], a[164:167], v[60:63], v[228:231]
    ds_read_b128 a[144:147], v18 offset:4096
    v_cvt_pk_bf16_f32 v52, v104, v105
    v_mfma_f32_16x16x32_bf16 v[200:203], a[168:171], v[56:59], v[200:203]
    v_exp_f32 v106, v106
    v_mfma_f32_16x16x32_bf16 v[232:235], a[168:171], v[60:63], v[232:235]
    buffer_load_dwordx4 v1, s[8:11], s19 offen offset:3072 lds
    v_mfma_f32_16x16x32_bf16 v[204:207], a[172:175], v[56:59], v[204:207]
    s_add_u32 m0, s16, 4096
    v_exp_f32 v107, v107
    v_mfma_f32_16x16x32_bf16 v[236:239], a[172:175], v[60:63], v[236:239]
    ds_read_b128 a[148:151], v18 offset:5120
    v_cvt_pk_bf16_f32 v53, v106, v107
    v_mfma_f32_16x16x32_bf16 v[208:211], a[176:179], v[56:59], v[208:211]
    s_sub_u32 s14, s14, 1
    v_exp_f32 v108, v108
    v_mfma_f32_16x16x32_bf16 v[240:243], a[176:179], v[60:63], v[240:243]
    buffer_load_dwordx4 v15, s[8:11], s19 offen offset:0 lds
    v_mfma_f32_16x16x32_bf16 v[212:215], a[180:183], v[56:59], v[212:215]
    v_exp_f32 v109, v109
    v_mfma_f32_16x16x32_bf16 v[244:247], a[180:183], v[60:63], v[244:247]
    ds_read_b128 a[152:155], v18 offset:6144
    v_cvt_pk_bf16_f32 v54, v108, v109
    v_mfma_f32_16x16x32_bf16 v[216:219], a[184:187], v[56:59], v[216:219]
    v_exp_f32 v110, v110
    v_mfma_f32_16x16x32_bf16 v[248:251], a[184:187], v[60:63], v[248:251]
    buffer_load_dwordx4 v15, s[8:11], s19 offen offset:1024 lds
    v_mfma_f32_16x16x32_bf16 v[220:223], a[188:191], v[56:59], v[220:223]
    v_exp_f32 v111, v111
    v_mfma_f32_16x16x32_bf16 v[252:255], a[188:191], v[60:63], v[252:255]
    ds_read_b128 a[156:159], v18 offset:7168
    v_cvt_pk_bf16_f32 v55, v110, v111
    s_cmp_lg_u32 s14, 0
    s_cbranch_scc1 L_t2_loop
L_t2_diag:
    s_waitcnt lgkmcnt(7)
    v_mfma_f32_16x16x32_bf16 v[96:99], a[128:131], a[192:195], v[80:83]
    s_waitcnt lgkmcnt(6)
    ds_read_b128 a[160:163], v19 offset:16384
    v_mov_b32 v24, v8
    v_mov_b32 v25, v9
    v_mfma_f32_16x16x32_bf16 v[96:99], a[132:135], a[196:199], v[96:99]
    s_waitcnt lgkmcnt(6)
    ds_read_b128 a[164:167], v19 offset:17408
    v_mov_b32 v26, v10
    v_mov_b32 v27, v11
    v_mfma_f32_16x16x32_bf16 v[96:99], a[136:139], a[200:203], v[96:99]
    s_waitcnt lgkmcnt(6)
    v_exp_f32 v112, v112
    v_add_u32 v11, 131072, v16
    v_mfma_f32_16x16x32_bf16 v[96:99], a[140:143], a[204:207], v[96:99]
    buffer_load_dwordx4 v15, s[8:11], s19 offen offset:2048 lds
    v_lshlrev_b32 v12, 6, v0
    v_mfma_f32_16x16x32_bf16 v[104:107], a[128:131], a[208:211], v[88:91]
    s_mov_b32 s71, 1327104
    v_exp_f32 v113, v113
    v_mfma_f32_16x16x32_bf16 v[104:107], a[132:135], a[212:215], v[104:107]
    ds_read_b128 a[168:171], v19 offset:18432
    v_cvt_pk_bf16_f32 v56, v112, v113
    v_mfma_f32_16x16x32_bf16 v[104:107], a[136:139], a[216:219], v[104:107]
    s_waitcnt lgkmcnt(6)
    v_exp_f32 v114, v114
    v_mfma_f32_16x16x32_bf16 v[104:107], a[140:143], a[220:223], v[104:107]
    buffer_load_dwordx4 v15, s[8:11], s19 offen offset:3072 lds
    v_mfma_f32_16x16x32_bf16 v[100:103], a[144:147], a[192:195], v[84:87]
    s_waitcnt lgkmcnt(5)
    s_xor_b32 s16, s16, 98304
    v_exp_f32 v115, v115
    v_mfma_f32_16x16x32_bf16 v[100:103], a[148:151], a[196:199], v[100:103]
    s_waitcnt lgkmcnt(4)
    ds_read_b128 a[172:175], v19 offset:19456
    v_cvt_pk_bf16_f32 v57, v114, v115
    v_mfma_f32_16x16x32_bf16 v[100:103], a[152:155], a[200:203], v[100:103]
    s_waitcnt lgkmcnt(4)
    v_exp_f32 v116, v116
    v_mfma_f32_16x16x32_bf16 v[100:103], a[156:159], a[204:207], v[100:103]
    buffer_load_dword v3, v12, s[8:11], s71 offen sc0 sc1
    v_bfe_u32 v13, v2, 1, 4
    v_mfma_f32_16x16x32_bf16 v[108:111], a[144:147], a[208:211], v[92:95]
    v_exp_f32 v117, v117
    v_lshlrev_b32 v13, 10, v13
    v_mfma_f32_16x16x32_bf16 v[108:111], a[148:151], a[212:215], v[108:111]
    ds_read_b128 a[176:179], v20 offset:20480
    v_cvt_pk_bf16_f32 v58, v116, v117
    v_and_b32 v14, 1, v2
    v_mfma_f32_16x16x32_bf16 v[108:111], a[152:155], a[216:219], v[108:111]
    v_exp_f32 v118, v118
    v_lshl_add_u32 v13, v14, 7, v13
    v_mfma_f32_16x16x32_bf16 v[108:111], a[156:159], a[220:223], v[108:111]
    s_lshl_b32 s74, s6, 2
    s_add_u32 s74, s74, s3
    s_lshl_b32 s74, s74, 14
    v_mfma_f32_16x16x32_bf16 v[32:35], v[28:31], v[48:51], v[32:35]
    v_exp_f32 v119, v119
    v_mfma_f32_16x16x32_bf16 v[36:39], v[28:31], v[52:55], v[36:39]
    s_waitcnt lgkmcnt(4)
    ds_read_b128 a[180:183], v20 offset:21504
    v_cvt_pk_bf16_f32 v59, v118, v119
    v_mfma_f32_16x16x32_bf16 v[128:131], a[160:163], v[48:51], v[128:131]
    s_waitcnt lgkmcnt(4)
    v_exp_f32 v120, v120
    v_mfma_f32_16x16x32_bf16 v[160:163], a[160:163], v[52:55], v[160:163]
    buffer_load_dword v14, v13, s[28:31], s74 offen
    v_mfma_f32_16x16x32_bf16 v[132:135], a[164:167], v[48:51], v[132:135]
    v_exp_f32 v121, v121
    v_mfma_f32_16x16x32_bf16 v[164:167], a[164:167], v[52:55], v[164:167]
    s_waitcnt lgkmcnt(3)
    ds_read_b128 a[184:187], v20 offset:22528
    v_cvt_pk_bf16_f32 v60, v120, v121
    v_mfma_f32_16x16x32_bf16 v[136:139], a[168:171], v[48:51], v[136:139]
    v_exp_f32 v122, v122
    v_mfma_f32_16x16x32_bf16 v[168:171], a[168:171], v[52:55], v[168:171]
    s_waitcnt lgkmcnt(3)
    v_add_f32 v80, 0, v22
    v_min_f32 v80, v80, v72
    v_mfma_f32_16x16x32_bf16 v[140:143], a[172:175], v[48:51], v[140:143]
    v_exp_f32 v123, v123
    v_mfma_f32_16x16x32_bf16 v[172:175], a[172:175], v[52:55], v[172:175]
    s_waitcnt lgkmcnt(2)
    ds_read_b128 a[188:191], v20 offset:23552
    v_cvt_pk_bf16_f32 v61, v122, v123
    v_mfma_f32_16x16x32_bf16 v[144:147], a[176:179], v[48:51], v[144:147]
    v_exp_f32 v124, v124
    v_mfma_f32_16x16x32_bf16 v[176:179], a[176:179], v[52:55], v[176:179]
    s_waitcnt lgkmcnt(2)
    v_add_f32 v81, 0xf1800000, v22
    v_min_f32 v81, v81, v73
    v_mfma_f32_16x16x32_bf16 v[148:151], a[180:183], v[48:51], v[148:151]
    v_exp_f32 v125, v125
    v_mfma_f32_16x16x32_bf16 v[180:183], a[180:183], v[52:55], v[180:183]
    s_waitcnt lgkmcnt(1)
    v_cvt_pk_bf16_f32 v62, v124, v125
    v_xor_b32 v19, 98304, v19
    v_mfma_f32_16x16x32_bf16 v[152:155], a[184:187], v[48:51], v[152:155]
    v_exp_f32 v126, v126
    v_mfma_f32_16x16x32_bf16 v[184:187], a[184:187], v[52:55], v[184:187]
    s_waitcnt lgkmcnt(0)
    v_xor_b32 v20, 98304, v20
    v_add_f32 v82, 0xf2000000, v22
    v_mfma_f32_16x16x32_bf16 v[156:159], a[188:191], v[48:51], v[156:159]
    v_exp_f32 v127, v127
    v_mfma_f32_16x16x32_bf16 v[188:191], a[188:191], v[52:55], v[188:191]
    v_cvt_pk_bf16_f32 v63, v126, v127
    v_min_f32 v82, v82, v74
    v_add_f32 v83, 0xf2400000, v22
    v_min_f32 v83, v83, v75
    v_add_f32 v84, 0xf3800000, v22
    v_min_f32 v84, v84, v72
    v_mfma_f32_16x16x32_bf16 v[112:115], a[128:131], a[224:227], v[72:75]
    v_exp_f32 v96, v96
    v_mfma_f32_16x16x32_bf16 v[112:115], a[132:135], a[228:231], v[112:115]
    v_add_f32 v85, 0xf3880000, v22
    v_min_f32 v85, v85, v73
    s_getpc_b64 s[100:101]
L_ct3:
    s_lshr_b32 s99, s2, 3
    s_lshl_b32 s99, s99, 2
    s_add_u32 s99, s99, s3
    s_mul_i32 s99, s99, 2
    v_min_u32 v13, 1, v2
    v_add_u32 v13, s99, v13
    v_lshlrev_b32 v13, 7, v13
    v_add_u32 v13, L_ct3-L_ct3, v13
    v_min_u32 v13, L_end-L_ct3, v13
    global_load_dword v13, v13, s[100:101]
    v_mfma_f32_16x16x32_bf16 v[112:115], a[136:139], a[232:235], v[112:115]
    v_exp_f32 v97, v97
    v_mfma_f32_16x16x32_bf16 v[112:115], a[140:143], a[236:239], v[112:115]
    v_cvt_pk_bf16_f32 v48, v96, v97
    v_add_f32 v86, 0xf3900000, v22
    v_mfma_f32_16x16x32_bf16 v[120:123], a[128:131], a[240:243], v[76:79]
    v_exp_f32 v98, v98
    v_mfma_f32_16x16x32_bf16 v[120:123], a[132:135], a[244:247], v[120:123]
    v_min_f32 v86, v86, v74
    v_add_f32 v87, 0xf3980000, v22
    v_mfma_f32_16x16x32_bf16 v[120:123], a[136:139], a[248:251], v[120:123]
    v_exp_f32 v99, v99
    v_mfma_f32_16x16x32_bf16 v[120:123], a[140:143], a[252:255], v[120:123]
    v_min_f32 v87, v87, v75
    v_add_f32 v88, 0x73800000, v22
    v_mfma_f32_16x16x32_bf16 v[116:119], a[144:147], a[224:227], v[72:75]
    v_exp_f32 v100, v100
    v_mfma_f32_16x16x32_bf16 v[116:119], a[148:151], a[228:231], v[116:119]
    ds_read_b128 a[128:131], v18 offset:16384
    v_cvt_pk_bf16_f32 v49, v98, v99
    v_mfma_f32_16x16x32_bf16 v[116:119], a[152:155], a[232:235], v[116:119]
    v_exp_f32 v101, v101
    v_mfma_f32_16x16x32_bf16 v[116:119], a[156:159], a[236:239], v[116:119]
    ds_read_b128 a[132:135], v18 offset:17408
    v_cvt_pk_bf16_f32 v50, v100, v101
    v_mfma_f32_16x16x32_bf16 v[124:127], a[144:147], a[240:243], v[76:79]
    v_exp_f32 v102, v102
    v_mfma_f32_16x16x32_bf16 v[124:127], a[148:151], a[244:247], v[124:127]
    ds_read_b128 a[136:139], v18 offset:18432
    v_min_f32 v88, v88, v76
    v_mfma_f32_16x16x32_bf16 v[124:127], a[152:155], a[248:251], v[124:127]
    v_exp_f32 v103, v103
    v_mfma_f32_16x16x32_bf16 v[124:127], a[156:159], a[252:255], v[124:127]
    ds_read_b128 a[140:143], v18 offset:19456
    v_cvt_pk_bf16_f32 v51, v102, v103
    v_mfma_f32_16x16x32_bf16 v[40:43], v[28:31], v[56:59], v[40:43]
    v_exp_f32 v104, v104
    v_mfma_f32_16x16x32_bf16 v[44:47], v[28:31], v[60:63], v[44:47]
    ds_read_b128 a[144:147], v18 offset:20480
    v_add_f32 v89, 0x73700000, v22
    v_mfma_f32_16x16x32_bf16 v[192:195], a[160:163], v[56:59], v[192:195]
    v_exp_f32 v105, v105
    v_mfma_f32_16x16x32_bf16 v[224:227], a[160:163], v[60:63], v[224:227]
    ds_read_b128 a[148:151], v18 offset:21504
    v_cvt_pk_bf16_f32 v52, v104, v105
    v_mfma_f32_16x16x32_bf16 v[196:199], a[164:167], v[56:59], v[196:199]
    v_exp_f32 v106, v106
    v_mfma_f32_16x16x32_bf16 v[228:231], a[164:167], v[60:63], v[228:231]
    ds_read_b128 a[152:155], v18 offset:22528
    v_min_f32 v89, v89, v77
    v_mfma_f32_16x16x32_bf16 v[200:203], a[168:171], v[56:59], v[200:203]
    v_exp_f32 v107, v107
    v_mfma_f32_16x16x32_bf16 v[232:235], a[168:171], v[60:63], v[232:235]
    ds_read_b128 a[156:159], v18 offset:23552
    v_cvt_pk_bf16_f32 v53, v106, v107
    v_mfma_f32_16x16x32_bf16 v[204:207], a[172:175], v[56:59], v[204:207]
    v_exp_f32 v108, v108
    v_mfma_f32_16x16x32_bf16 v[236:239], a[172:175], v[60:63], v[236:239]
    v_add_f32 v90, 0x73600000, v22
    v_min_f32 v90, v90, v78
    v_mfma_f32_16x16x32_bf16 v[208:211], a[176:179], v[56:59], v[208:211]
    v_exp_f32 v109, v109
    v_mfma_f32_16x16x32_bf16 v[240:243], a[176:179], v[60:63], v[240:243]
    v_cvt_pk_bf16_f32 v54, v108, v109
    v_xor_b32 v18, 196608, v18
    v_mfma_f32_16x16x32_bf16 v[212:215], a[180:183], v[56:59], v[212:215]
    v_exp_f32 v110, v110
    v_mfma_f32_16x16x32_bf16 v[244:247], a[180:183], v[60:63], v[244:247]
    v_add_f32 v91, 0x73500000, v22
    v_min_f32 v91, v91, v79
    v_mfma_f32_16x16x32_bf16 v[216:219], a[184:187], v[56:59], v[216:219]
    v_exp_f32 v111, v111
    v_mfma_f32_16x16x32_bf16 v[248:251], a[184:187], v[60:63], v[248:251]
    v_cvt_pk_bf16_f32 v55, v110, v111
    v_add_f32 v92, 0, v22
    s_waitcnt vmcnt(2)
    v_cmp_ne_u32 vcc, 0, v3
    s_cmp_eq_u64 vcc, -1
    s_cbranch_scc0 L_F_slow_11
L_F_ok_12:
    v_mfma_f32_16x16x32_bf16 v[220:223], a[188:191], v[56:59], v[220:223]
    v_min_f32 v92, v92, v76
    v_add_f32 v93, 0xf1800000, v22
    v_mfma_f32_16x16x32_bf16 v[252:255], a[188:191], v[60:63], v[252:255]
    v_min_f32 v93, v93, v77
    v_add_f32 v94, 0xf2000000, v22
    v_min_f32 v94, v94, v78
    v_add_f32 v95, 0xf2400000, v22
    v_min_f32 v95, v95, v79
    s_waitcnt lgkmcnt(0)
    s_barrier
    v_mfma_f32_16x16x32_bf16 v[96:99], a[128:131], a[224:227], v[80:83]
    s_xor_b32 s100, s62, 8192
    s_xor_b32 s98, s65, 262144
    ds_read_b128 a[176:179], v20 offset:4096
    s_waitcnt vmcnt(0)
    v_lshrrev_b32 v13, 1, v1
    v_mfma_f32_16x16x32_bf16 v[96:99], a[132:135], a[228:231], v[96:99]
    s_add_u32 m0, s62, 65536
    ds_read_b128 a[180:183], v20 offset:5120
    v_add_u32 v12, s100, v13
    v_mfma_f32_16x16x32_bf16 v[96:99], a[136:139], a[232:235], v[96:99]
    buffer_load_dwordx4 v24, s[28:31], s98 offen offset:0  lds
    v_exp_f32 v112, v112
    v_mfma_f32_16x16x32_bf16 v[96:99], a[140:143], a[236:239], v[96:99]
    v_exp_f32 v113, v113
    v_mfma_f32_16x16x32_bf16 v[100:103], a[144:147], a[224:227], v[84:87]
    ds_read_b128 a[184:187], v20 offset:6144
    v_cvt_pk_bf16_f32 v56, v112, v113
    v_mfma_f32_16x16x32_bf16 v[100:103], a[148:151], a[228:231], v[100:103]
    v_exp_f32 v114, v114
    v_mfma_f32_16x16x32_bf16 v[100:103], a[152:155], a[232:235], v[100:103]
    buffer_load_dwordx4 v25, s[28:31], s98 offen offset:1024  lds
    v_exp_f32 v115, v115
    v_mfma_f32_16x16x32_bf16 v[100:103], a[156:159], a[236:239], v[100:103]
    ds_read_b128 a[188:191], v20 offset:7168
    v_cvt_pk_bf16_f32 v57, v114, v115
    v_mfma_f32_16x16x32_bf16 v[104:107], a[128:131], a[240:243], v[88:91]
    v_exp_f32 v116, v116
    v_mfma_f32_16x16x32_bf16 v[104:107], a[132:135], a[244:247], v[104:107]
    v_exp_f32 v117, v117
    v_mfma_f32_16x16x32_bf16 v[104:107], a[136:139], a[248:251], v[104:107]
    ds_read_b128 a[160:163], v19 offset:0
    v_cvt_pk_bf16_f32 v58, v116, v117
    v_mfma_f32_16x16x32_bf16 v[104:107], a[140:143], a[252:255], v[104:107]
    buffer_load_dwordx4 v26, s[28:31], s98 offen offset:2048  lds
    v_exp_f32 v118, v118
    v_mfma_f32_16x16x32_bf16 v[108:111], a[144:147], a[240:243], v[92:95]
    v_exp_f32 v119, v119
    v_mfma_f32_16x16x32_bf16 v[108:111], a[148:151], a[244:247], v[108:111]
    ds_read_b128 a[164:167], v19 offset:1024
    v_cvt_pk_bf16_f32 v59, v118, v119
    v_mfma_f32_16x16x32_bf16 v[108:111], a[152:155], a[248:251], v[108:111]
    v_exp_f32 v120, v120
    v_mfma_f32_16x16x32_bf16 v[108:111], a[156:159], a[252:255], v[108:111]
    buffer_load_dwordx4 v27, s[28:31], s98 offen offset:3072  lds
    v_exp_f32 v121, v121
    v_mfma_f32_16x16x32_bf16 v[32:35], v[28:31], v[48:51], v[32:35]
    s_add_u32 m0, s62, 69632
    ds_read_b128 a[168:171], v19 offset:2048
    v_cvt_pk_bf16_f32 v60, v120, v121
    v_mfma_f32_16x16x32_bf16 v[36:39], v[28:31], v[52:55], v[36:39]
    s_waitcnt lgkmcnt(6)
    s_xor_b32 s98, s65, 294912
    v_exp_f32 v122, v122
    v_mfma_f32_16x16x32_bf16 v[144:147], a[176:179], v[48:51], v[144:147]
    v_exp_f32 v123, v123
    v_mfma_f32_16x16x32_bf16 v[176:179], a[176:179], v[52:55], v[176:179]
    s_waitcnt lgkmcnt(5)
    ds_read_b128 a[172:175], v19 offset:3072
    v_cvt_pk_bf16_f32 v61, v122, v123
    v_mfma_f32_16x16x32_bf16 v[148:151], a[180:183], v[48:51], v[148:151]
    buffer_load_dwordx4 v24, s[28:31], s98 offen offset:0  lds
    v_exp_f32 v124, v124
    v_mfma_f32_16x16x32_bf16 v[180:183], a[180:183], v[52:55], v[180:183]
    s_waitcnt lgkmcnt(5)
    v_exp_f32 v125, v125
    v_mfma_f32_16x16x32_bf16 v[152:155], a[184:187], v[48:51], v[152:155]
    s_waitcnt lgkmcnt(4)
    v_exp_f32 v126, v126
    v_mfma_f32_16x16x32_bf16 v[184:187], a[184:187], v[52:55], v[184:187]
    buffer_load_dwordx4 v25, s[28:31], s98 offen offset:1024  lds
    v_exp_f32 v127, v127
    v_mfma_f32_16x16x32_bf16 v[156:159], a[188:191], v[48:51], v[156:159]
    ds_write_b128 v11, v[144:147] offset:0
    v_cvt_pk_bf16_f32 v62, v124, v125
    v_mfma_f32_16x16x32_bf16 v[188:191], a[188:191], v[52:55], v[188:191]
    s_waitcnt lgkmcnt(4)
    v_exp_f32 v96, v96
    v_mfma_f32_16x16x32_bf16 v[128:131], a[160:163], v[48:51], v[128:131]
    v_exp_f32 v97, v97
    v_mfma_f32_16x16x32_bf16 v[160:163], a[160:163], v[52:55], v[160:163]
    s_waitcnt lgkmcnt(3)
    ds_write_b128 v11, v[176:179] offset:1024
    v_cvt_pk_bf16_f32 v63, v126, v127
    v_mfma_f32_16x16x32_bf16 v[132:135], a[164:167], v[48:51], v[132:135]
    s_waitcnt lgkmcnt(3)
    v_exp_f32 v98, v98
    v_mfma_f32_16x16x32_bf16 v[164:167], a[164:167], v[52:55], v[164:167]
    buffer_load_dwordx4 v26, s[28:31], s98 offen offset:2048  lds
    v_exp_f32 v99, v99
    v_mfma_f32_16x16x32_bf16 v[136:139], a[168:171], v[48:51], v[136:139]
    ds_write_b128 v11, v[148:151] offset:2048
    v_mfma_f32_16x16x32_bf16 v[168:171], a[168:171], v[52:55], v[168:171]
    s_waitcnt lgkmcnt(3)
    v_exp_f32 v100, v100
    v_mfma_f32_16x16x32_bf16 v[140:143], a[172:175], v[48:51], v[140:143]
    v_exp_f32 v101, v101
    v_mfma_f32_16x16x32_bf16 v[172:175], a[172:175], v[52:55], v[172:175]
    ds_write_b128 v11, v[180:183] offset:3072
    v_mov_b32 v33, v36
    v_mfma_f32_16x16x32_bf16 v[40:43], v[28:31], v[56:59], v[40:43]
    buffer_load_dwordx4 v27, s[28:31], s98 offen offset:3072  lds
    v_exp_f32 v102, v102
    v_mfma_f32_16x16x32_bf16 v[44:47], v[28:31], v[60:63], v[44:47]
    v_exp_f32 v103, v103
    v_mfma_f32_16x16x32_bf16 v[208:211], a[176:179], v[56:59], v[208:211]
    ds_write_b128 v11, v[152:155] offset:4096
    v_cvt_pk_bf16_f32 v48, v96, v97
    v_mfma_f32_16x16x32_bf16 v[240:243], a[176:179], v[60:63], v[240:243]
    ds_read_b128 a[176:179], v20 offset:20480
    v_exp_f32 v104, v104
    v_mfma_f32_16x16x32_bf16 v[212:215], a[180:183], v[56:59], v[212:215]
    v_exp_f32 v105, v105
    v_mfma_f32_16x16x32_bf16 v[244:247], a[180:183], v[60:63], v[244:247]
    ds_read_b128 a[180:183], v20 offset:21504
    v_exp_f32 v106, v106
    v_mfma_f32_16x16x32_bf16 v[216:219], a[184:187], v[56:59], v[216:219]
    ds_write_b128 v11, v[184:187] offset:5120
    v_cvt_pk_bf16_f32 v49, v98, v99
    v_mfma_f32_16x16x32_bf16 v[248:251], a[184:187], v[60:63], v[248:251]
    ds_read_b128 a[184:187], v20 offset:22528
    v_exp_f32 v107, v107
    v_mfma_f32_16x16x32_bf16 v[220:223], a[188:191], v[56:59], v[220:223]
    v_exp_f32 v108, v108
    v_mfma_f32_16x16x32_bf16 v[252:255], a[188:191], v[60:63], v[252:255]
    ds_read_b128 a[188:191], v20 offset:23552
    v_exp_f32 v109, v109
    v_mfma_f32_16x16x32_bf16 v[192:195], a[160:163], v[56:59], v[192:195]
    ds_write_b128 v11, v[156:159] offset:6144
    v_cvt_pk_bf16_f32 v50, v100, v101
    v_mfma_f32_16x16x32_bf16 v[224:227], a[160:163], v[60:63], v[224:227]
    ds_read_b128 a[160:163], v19 offset:16384
    v_exp_f32 v110, v110
    v_mfma_f32_16x16x32_bf16 v[196:199], a[164:167], v[56:59], v[196:199]
    v_exp_f32 v111, v111
    v_mfma_f32_16x16x32_bf16 v[228:231], a[164:167], v[60:63], v[228:231]
    ds_read_b128 a[164:167], v19 offset:17408
    v_cvt_pk_bf16_f32 v51, v102, v103
    v_mfma_f32_16x16x32_bf16 v[200:203], a[168:171], v[56:59], v[200:203]
    ds_write_b128 v11, v[188:191] offset:7168
    v_cvt_pk_bf16_f32 v52, v104, v105
    v_mfma_f32_16x16x32_bf16 v[232:235], a[168:171], v[60:63], v[232:235]
    ds_read_b128 a[168:171], v19 offset:18432
    v_cvt_pk_bf16_f32 v53, v106, v107
    v_mfma_f32_16x16x32_bf16 v[204:207], a[172:175], v[56:59], v[204:207]
    v_cvt_pk_bf16_f32 v54, v108, v109
    v_cvt_pk_bf16_f32 v55, v110, v111
    v_mfma_f32_16x16x32_bf16 v[236:239], a[172:175], v[60:63], v[236:239]
    ds_read_b128 a[172:175], v19 offset:19456
    ds_write_b64 v12, v[32:33]
    s_add_u32 s101, s62, 98304
    v_xor_b32 v12, 8192, v12
    v_add_u32 v9, s101, v1
    v_xor_b32 v8, 8192, v11
    v_xor_b32 v10, 8192, v9
L_t2_join:
    v_xor_b32 v19, 98304, v19
    v_xor_b32 v20, 98304, v20
    s_waitcnt lgkmcnt(0)
    s_barrier
    v_mfma_f32_16x16x32_bf16 v[40:43], v[28:31], v[48:51], v[40:43]
    s_lshl_b32 s100, s61, 20
    s_add_u32 s101, s100, s21
    ds_read_b64 v[120:121], v12
    v_mfma_f32_16x16x32_bf16 v[44:47], v[28:31], v[52:55], v[44:47]
    s_add_u32 s100, s100, s20
    ds_read_b128 v[144:147], v8 offset:0
    v_lshrrev_b32 v11, 4, v2
    v_mfma_f32_16x16x32_bf16 v[208:211], a[176:179], v[48:51], v[208:211]
    ds_read_b128 v[176:179], v8 offset:1024
    v_lshrrev_b32 v13, 2, v1
    v_mfma_f32_16x16x32_bf16 v[240:243], a[176:179], v[52:55], v[240:243]
    ds_read_b128 v[148:151], v8 offset:2048
    v_add_u32 v13, 131072, v13
    v_mfma_f32_16x16x32_bf16 v[212:215], a[180:183], v[48:51], v[212:215]
    s_xor_b32 s99, s62, 8192
    ds_read_b128 v[180:183], v8 offset:3072
    v_add_u32 v14, s99, v13
    v_mfma_f32_16x16x32_bf16 v[244:247], a[180:183], v[52:55], v[244:247]
    ds_read_b128 v[152:155], v8 offset:4096
    v_cmp_eq_u32 vcc, 1, v11
    v_mfma_f32_16x16x32_bf16 v[216:219], a[184:187], v[48:51], v[216:219]
    ds_read_b128 v[184:187], v8 offset:5120
    s_waitcnt lgkmcnt(6)
    v_add_f32 v112, v120, v32
    v_mfma_f32_16x16x32_bf16 v[248:251], a[184:187], v[52:55], v[248:251]
    ds_read_b128 v[156:159], v8 offset:6144
    v_add_f32 v114, v121, v36
    v_mfma_f32_16x16x32_bf16 v[220:223], a[188:191], v[48:51], v[220:223]
    ds_read_b128 v[188:191], v8 offset:7168
    v_cndmask_b32 v12, v32, v36, vcc
    v_mfma_f32_16x16x32_bf16 v[252:255], a[188:191], v[52:55], v[252:255]
    v_rcp_f32 v112, v112
    v_mfma_f32_16x16x32_bf16 v[192:195], a[160:163], v[48:51], v[192:195]
    v_rcp_f32 v114, v114
    v_mfma_f32_16x16x32_bf16 v[224:227], a[160:163], v[52:55], v[224:227]
    v_cmp_eq_u32 vcc, 2, v11
    v_cmp_eq_u32 s[96:97], 3, v11
    v_mfma_f32_16x16x32_bf16 v[196:199], a[164:167], v[48:51], v[196:199]
    ds_write_b128 v9, v[208:211] offset:0
    v_mfma_f32_16x16x32_bf16 v[228:231], a[164:167], v[52:55], v[228:231]
    v_mfma_f32_16x16x32_bf16 v[200:203], a[168:171], v[48:51], v[200:203]
    ds_write_b128 v9, v[240:243] offset:1024
    v_mfma_f32_16x16x32_bf16 v[232:235], a[168:171], v[52:55], v[232:235]
    v_mfma_f32_16x16x32_bf16 v[204:207], a[172:175], v[48:51], v[204:207]
    ds_write_b128 v9, v[212:215] offset:2048
    v_mfma_f32_16x16x32_bf16 v[236:239], a[172:175], v[52:55], v[236:239]
    v_cndmask_b32 v12, v12, v40, vcc
    v_cndmask_b32 v12, v12, v44, s[96:97]
    ds_write_b128 v9, v[244:247] offset:3072
    s_waitcnt lgkmcnt(11)
    v_pk_add_f32 v[128:129], v[128:129], v[144:145]
    v_pk_add_f32 v[130:131], v[130:131], v[146:147]
    s_waitcnt lgkmcnt(9)
    v_pk_add_f32 v[132:133], v[132:133], v[148:149]
    v_pk_add_f32 v[134:135], v[134:135], v[150:151]
    v_pk_mul_f32 v[128:129], v[128:129], v[112:113] op_sel_hi:[1,0]
    v_pk_mul_f32 v[130:131], v[130:131], v[112:113] op_sel_hi:[1,0]
    v_pk_mul_f32 v[132:133], v[132:133], v[112:113] op_sel_hi:[1,0]
    v_pk_mul_f32 v[134:135], v[134:135], v[112:113] op_sel_hi:[1,0]
    v_cvt_pk_bf16_f32 v128, v128, v129
    v_cvt_pk_bf16_f32 v129, v130, v131
    v_cvt_pk_bf16_f32 v130, v132, v133
    v_lshrrev_b32 v58, 2, v2
    v_and_b32 v57, 3, v2
    ds_write_b128 v9, v[216:219] offset:4096
    v_cvt_pk_bf16_f32 v131, v134, v135
    buffer_store_dwordx4 v[128:131], v1, s[8:11], s100 offen offset:0 sc0 sc1
    s_waitcnt lgkmcnt(8)
    v_pk_add_f32 v[136:137], v[136:137], v[152:153]
    v_pk_add_f32 v[138:139], v[138:139], v[154:155]
    s_waitcnt lgkmcnt(6)
    v_pk_add_f32 v[140:141], v[140:141], v[156:157]
    v_pk_add_f32 v[142:143], v[142:143], v[158:159]
    v_pk_mul_f32 v[136:137], v[136:137], v[112:113] op_sel_hi:[1,0]
    v_pk_mul_f32 v[138:139], v[138:139], v[112:113] op_sel_hi:[1,0]
    v_pk_mul_f32 v[140:141], v[140:141], v[112:113] op_sel_hi:[1,0]
    v_pk_mul_f32 v[142:143], v[142:143], v[112:113] op_sel_hi:[1,0]
    v_cvt_pk_bf16_f32 v136, v136, v137
    v_lshlrev_b32 v56, 7, v58
    v_lshl_add_u32 v56, v57, 3, v56
    v_bfe_u32 v57, v2, 3, 2
    ds_write_b128 v9, v[248:251] offset:5120
    v_cvt_pk_bf16_f32 v137, v138, v139
    v_cvt_pk_bf16_f32 v138, v140, v141
    v_cvt_pk_bf16_f32 v139, v142, v143
    buffer_store_dwordx4 v[136:139], v1, s[8:11], s100 offen offset:1024 sc0 sc1
    v_pk_add_f32 v[160:161], v[160:161], v[176:177]
    v_pk_add_f32 v[162:163], v[162:163], v[178:179]
    v_pk_add_f32 v[164:165], v[164:165], v[180:181]
    v_pk_add_f32 v[166:167], v[166:167], v[182:183]
    v_pk_mul_f32 v[160:161], v[160:161], v[114:115] op_sel_hi:[1,0]
    v_pk_mul_f32 v[162:163], v[162:163], v[114:115] op_sel_hi:[1,0]
    v_pk_mul_f32 v[164:165], v[164:165], v[114:115] op_sel_hi:[1,0]
    v_lshl_add_u32 v56, v57, 5, v56
    v_xor_b32 v57, 32, v56
    ds_write_b128 v9, v[220:223] offset:6144
    v_pk_mul_f32 v[166:167], v[166:167], v[114:115] op_sel_hi:[1,0]
    v_cvt_pk_bf16_f32 v160, v160, v161
    v_cvt_pk_bf16_f32 v161, v162, v163
    v_cvt_pk_bf16_f32 v162, v164, v165
    v_cvt_pk_bf16_f32 v163, v166, v167
    buffer_store_dwordx4 v[160:163], v15, s[8:11], s100 offen offset:0 sc0 sc1
    v_pk_add_f32 v[168:169], v[168:169], v[184:185]
    v_pk_add_f32 v[170:171], v[170:171], v[186:187]
    s_waitcnt lgkmcnt(7)
    v_pk_add_f32 v[172:173], v[172:173], v[188:189]
    v_pk_add_f32 v[174:175], v[174:175], v[190:191]
    v_pk_mul_f32 v[168:169], v[168:169], v[114:115] op_sel_hi:[1,0]
    v_xor_b32 v58, 64, v56
    v_xor_b32 v59, 96, v56
    v_add_u32 v60, 65536, v56
    ds_write_b128 v9, v[252:255] offset:7168
    v_pk_mul_f32 v[170:171], v[170:171], v[114:115] op_sel_hi:[1,0]
    v_pk_mul_f32 v[172:173], v[172:173], v[114:115] op_sel_hi:[1,0]
    v_pk_mul_f32 v[174:175], v[174:175], v[114:115] op_sel_hi:[1,0]
    v_cvt_pk_bf16_f32 v168, v168, v169
    v_cvt_pk_bf16_f32 v169, v170, v171
    v_cvt_pk_bf16_f32 v170, v172, v173
    v_cvt_pk_bf16_f32 v171, v174, v175
    buffer_store_dwordx4 v[168:171], v15, s[8:11], s100 offen offset:1024 sc0 sc1
    v_add_u32 v61, 65536, v57
    v_add_u32 v62, 65536, v58
    v_add_u32 v63, 65536, v59
    ds_write_b32 v14, v12
    v_and_b32 v14, 4294967103, v13
    v_add_u32 v14, s62, v14
    s_waitcnt lgkmcnt(0)
    s_barrier
    ds_read_b32 v116, v14 offset:128
    ds_read_b32 v118, v14 offset:192
    ds_read_b128 v[208:211], v10 offset:0
    ds_read_b128 v[212:215], v10 offset:2048
    ds_read_b128 v[216:219], v10 offset:4096
    ds_read_b128 v[220:223], v10 offset:6144
    ds_read_b128 v[240:243], v10 offset:1024
    ds_read_b128 v[244:247], v10 offset:3072
    ds_read_b128 v[248:251], v10 offset:5120
    ds_read_b128 v[252:255], v10 offset:7168
    ds_read_b32 v120, v13 offset:0
    ds_read_b32 v121, v13 offset:8192
    ds_read_b32 v122, v13 offset:16384
    ds_read_b32 v123, v13 offset:24576
    s_waitcnt lgkmcnt(13)
    v_add_f32 v116, v116, v40
    s_waitcnt lgkmcnt(12)
    v_add_f32 v118, v118, v44
    v_rcp_f32 v116, v116
    v_rcp_f32 v118, v118
    s_waitcnt lgkmcnt(11)
    v_pk_add_f32 v[192:193], v[192:193], v[208:209]
    v_pk_add_f32 v[194:195], v[194:195], v[210:211]
    s_waitcnt lgkmcnt(10)
    v_pk_add_f32 v[196:197], v[196:197], v[212:213]
    v_pk_add_f32 v[198:199], v[198:199], v[214:215]
    v_pk_mul_f32 v[192:193], v[192:193], v[116:117] op_sel_hi:[1,0]
    v_pk_mul_f32 v[194:195], v[194:195], v[116:117] op_sel_hi:[1,0]
    v_pk_mul_f32 v[196:197], v[196:197], v[116:117] op_sel_hi:[1,0]
    v_pk_mul_f32 v[198:199], v[198:199], v[116:117] op_sel_hi:[1,0]
    v_cvt_pk_bf16_f32 v192, v192, v193
    v_cvt_pk_bf16_f32 v193, v194, v195
    v_cvt_pk_bf16_f32 v194, v196, v197
    v_cvt_pk_bf16_f32 v195, v198, v199
    buffer_store_dwordx4 v[192:195], v1, s[8:11], s101 offen offset:0 sc0 sc1
    s_waitcnt lgkmcnt(9)
    v_pk_add_f32 v[200:201], v[200:201], v[216:217]
    v_pk_add_f32 v[202:203], v[202:203], v[218:219]
    s_waitcnt lgkmcnt(8)
    v_pk_add_f32 v[204:205], v[204:205], v[220:221]
    v_pk_add_f32 v[206:207], v[206:207], v[222:223]
    v_pk_mul_f32 v[200:201], v[200:201], v[116:117] op_sel_hi:[1,0]
    v_pk_mul_f32 v[202:203], v[202:203], v[116:117] op_sel_hi:[1,0]
    v_pk_mul_f32 v[204:205], v[204:205], v[116:117] op_sel_hi:[1,0]
    v_pk_mul_f32 v[206:207], v[206:207], v[116:117] op_sel_hi:[1,0]
    v_cvt_pk_bf16_f32 v200, v200, v201
    v_cvt_pk_bf16_f32 v201, v202, v203
    v_cvt_pk_bf16_f32 v202, v204, v205
    v_cvt_pk_bf16_f32 v203, v206, v207
    buffer_store_dwordx4 v[200:203], v1, s[8:11], s101 offen offset:1024 sc0 sc1
    s_waitcnt lgkmcnt(2)
    v_add_f32 v120, v120, v121
    s_waitcnt lgkmcnt(0)
    v_add_f32 v122, v122, v123
    v_min_f32 v124, v120, v122
    v_add_f32 v120, v120, v122
    v_cmp_le_f32 vcc, 0x1f800000, v124
    s_mov_b64 s[96:97], vcc
    v_cmp_ge_f32 vcc, 0x67800000, v120
    s_and_b64 s[96:97], s[96:97], vcc
    s_cmp_eq_u64 s[96:97], -1
    s_cselect_b32 s96, s25, 1
    s_cmp_lg_u32 s96, 0
    s_cbranch_scc1 L_t2_redo
L_t2_safe:
    v_pk_add_f32 v[224:225], v[224:225], v[240:241]
    v_pk_add_f32 v[226:227], v[226:227], v[242:243]
    v_pk_add_f32 v[228:229], v[228:229], v[244:245]
    v_pk_add_f32 v[230:231], v[230:231], v[246:247]
    v_pk_mul_f32 v[224:225], v[224:225], v[118:119] op_sel_hi:[1,0]
    v_pk_mul_f32 v[226:227], v[226:227], v[118:119] op_sel_hi:[1,0]
    v_pk_mul_f32 v[228:229], v[228:229], v[118:119] op_sel_hi:[1,0]
    v_pk_mul_f32 v[230:231], v[230:231], v[118:119] op_sel_hi:[1,0]
    v_cvt_pk_bf16_f32 v224, v224, v225
    v_cvt_pk_bf16_f32 v225, v226, v227
    v_cvt_pk_bf16_f32 v226, v228, v229
    v_cvt_pk_bf16_f32 v227, v230, v231
    buffer_store_dwordx4 v[224:227], v15, s[8:11], s101 offen offset:0 sc0 sc1
    ds_read_b64_tr_b16 a[192:193], v56 offset:32768
    ds_read_b64_tr_b16 a[194:195], v56 offset:34816
    ds_read_b64_tr_b16 a[196:197], v56 offset:36864
    ds_read_b64_tr_b16 a[198:199], v56 offset:38912
    ds_read_b64_tr_b16 a[200:201], v57 offset:32768
    ds_read_b64_tr_b16 a[202:203], v57 offset:34816
    ds_read_b64_tr_b16 a[204:205], v57 offset:36864
    ds_read_b64_tr_b16 a[206:207], v57 offset:38912
    v_pk_add_f32 v[232:233], v[232:233], v[248:249]
    v_pk_add_f32 v[234:235], v[234:235], v[250:251]
    v_pk_add_f32 v[236:237], v[236:237], v[252:253]
    v_pk_add_f32 v[238:239], v[238:239], v[254:255]
    v_pk_mul_f32 v[232:233], v[232:233], v[118:119] op_sel_hi:[1,0]
    v_pk_mul_f32 v[234:235], v[234:235], v[118:119] op_sel_hi:[1,0]
    v_pk_mul_f32 v[236:237], v[236:237], v[118:119] op_sel_hi:[1,0]
    v_pk_mul_f32 v[238:239], v[238:239], v[118:119] op_sel_hi:[1,0]
    v_cvt_pk_bf16_f32 v232, v232, v233
    v_cvt_pk_bf16_f32 v233, v234, v235
    v_cvt_pk_bf16_f32 v234, v236, v237
    v_cvt_pk_bf16_f32 v235, v238, v239
    buffer_store_dwordx4 v[232:235], v15, s[8:11], s101 offen offset:1024 sc0 sc1
    ds_read_b64_tr_b16 a[208:209], v56 offset:40960
    ds_read_b64_tr_b16 a[210:211], v56 offset:43008
    ds_read_b64_tr_b16 a[212:213], v56 offset:45056
    ds_read_b64_tr_b16 a[214:215], v56 offset:47104
    ds_read_b64_tr_b16 a[216:217], v57 offset:40960
    ds_read_b64_tr_b16 a[218:219], v57 offset:43008
    ds_read_b64_tr_b16 a[220:221], v57 offset:45056
    ds_read_b64_tr_b16 a[222:223], v57 offset:47104
    s_waitcnt lgkmcnt(14)
    v_mfma_f32_16x16x32_bf16 v[64:67], a[192:195], a[64:67], 0
    s_waitcnt lgkmcnt(12)
    s_add_u32 m0, s62, 0
    ds_read_b64_tr_b16 a[224:225], v56 offset:49152
    v_mfma_f32_16x16x32_bf16 v[64:67], a[196:199], a[68:71], v[64:67]
    s_xor_b32 s98, s65, 128
    ds_read_b64_tr_b16 a[226:227], v56 offset:51200
    v_mfma_f32_16x16x32_bf16 v[72:75], a[192:195], a[80:83], 0
    buffer_load_dwordx4 v24, s[28:31], s98 offen offset:0  lds
    v_mfma_f32_16x16x32_bf16 v[72:75], a[196:199], a[84:87], v[72:75]
    s_waitcnt lgkmcnt(12)
    ds_read_b64_tr_b16 a[228:229], v56 offset:53248
    v_mfma_f32_16x16x32_bf16 v[68:71], a[200:203], a[64:67], 0
    s_waitcnt lgkmcnt(11)
    s_add_u32 s22, s22, 65536
    ds_read_b64_tr_b16 a[230:231], v56 offset:55296
    v_mfma_f32_16x16x32_bf16 v[68:71], a[204:207], a[68:71], v[68:71]
    s_add_u32 s23, s23, 65536
    ds_read_b64_tr_b16 a[232:233], v57 offset:49152
    v_mfma_f32_16x16x32_bf16 v[76:79], a[200:203], a[80:83], 0
    buffer_load_dwordx4 v25, s[28:31], s98 offen offset:1024  lds
    v_mfma_f32_16x16x32_bf16 v[76:79], a[204:207], a[84:87], v[76:79]
    s_waitcnt lgkmcnt(11)
    s_lshl_b32 s24, s61, 2
    ds_read_b64_tr_b16 a[234:235], v57 offset:51200
    v_mfma_f32_16x16x32_bf16 v[64:67], a[208:211], a[72:75], v[64:67]
    s_waitcnt lgkmcnt(10)
    s_add_u32 s24, s24, s3
    ds_read_b64_tr_b16 a[236:237], v57 offset:53248
    v_mfma_f32_16x16x32_bf16 v[64:67], a[212:215], a[76:79], v[64:67]
    s_lshl_b32 s24, s24, 3
    ds_read_b64_tr_b16 a[238:239], v57 offset:55296
    v_mfma_f32_16x16x32_bf16 v[72:75], a[208:211], a[88:91], v[72:75]
    buffer_load_dwordx4 v26, s[28:31], s98 offen offset:2048  lds
    v_mfma_f32_16x16x32_bf16 v[72:75], a[212:215], a[92:95], v[72:75]
    s_waitcnt lgkmcnt(6)
    s_add_u32 s24, s24, s4
    ds_read_b64_tr_b16 a[240:241], v56 offset:57344
    v_mfma_f32_16x16x32_bf16 v[68:71], a[216:219], a[72:75], v[68:71]
    s_lshl_b32 s24, s24, 2
    ds_read_b64_tr_b16 a[242:243], v56 offset:59392
    v_mfma_f32_16x16x32_bf16 v[68:71], a[220:223], a[76:79], v[68:71]
    s_add_u32 s24, s24, s5
    ds_read_b64_tr_b16 a[244:245], v56 offset:61440
    v_mfma_f32_16x16x32_bf16 v[76:79], a[216:219], a[88:91], v[76:79]
    buffer_load_dwordx4 v27, s[28:31], s98 offen offset:3072  lds
    v_mfma_f32_16x16x32_bf16 v[76:79], a[220:223], a[92:95], v[76:79]
    s_add_u32 m0, s62, 4096
    ds_read_b64_tr_b16 a[246:247], v56 offset:63488
    v_mfma_f32_16x16x32_bf16 v[64:67], a[224:227], a[96:99], v[64:67]
    s_waitcnt lgkmcnt(7)
    s_xor_b32 s98, s65, 32896
    ds_read_b64_tr_b16 a[248:249], v57 offset:57344
    v_mfma_f32_16x16x32_bf16 v[64:67], a[228:231], a[100:103], v[64:67]
    s_lshl_b32 s24, s24, 13
    ds_read_b64_tr_b16 a[250:251], v57 offset:59392
    v_mfma_f32_16x16x32_bf16 v[72:75], a[224:227], a[112:115], v[72:75]
    buffer_load_dwordx4 v24, s[28:31], s98 offen offset:0  lds
    v_mfma_f32_16x16x32_bf16 v[72:75], a[228:231], a[116:119], v[72:75]
    s_waitcnt lgkmcnt(6)
    s_add_u32 s24, s24, 50331648
    ds_read_b64_tr_b16 a[252:253], v57 offset:61440
    v_mfma_f32_16x16x32_bf16 v[68:71], a[232:235], a[96:99], v[68:71]
    ds_read_b64_tr_b16 a[254:255], v57 offset:63488
    v_mfma_f32_16x16x32_bf16 v[68:71], a[236:239], a[100:103], v[68:71]
    ds_read_b64_tr_b16 a[192:193], v58 offset:32768
    v_mfma_f32_16x16x32_bf16 v[76:79], a[232:235], a[112:115], v[76:79]
    buffer_load_dwordx4 v25, s[28:31], s98 offen offset:1024  lds
    v_mfma_f32_16x16x32_bf16 v[76:79], a[236:239], a[116:119], v[76:79]
    s_waitcnt lgkmcnt(6)
    ds_read_b64_tr_b16 a[194:195], v58 offset:34816
    v_mfma_f32_16x16x32_bf16 v[64:67], a[240:243], a[104:107], v[64:67]
    s_waitcnt lgkmcnt(6)
    ds_read_b64_tr_b16 a[196:197], v58 offset:36864
    v_mfma_f32_16x16x32_bf16 v[64:67], a[244:247], a[108:111], v[64:67]
    ds_read_b64_tr_b16 a[198:199], v58 offset:38912
    v_mfma_f32_16x16x32_bf16 v[72:75], a[240:243], a[120:123], v[72:75]
    buffer_load_dwordx4 v26, s[28:31], s98 offen offset:2048  lds
    v_mfma_f32_16x16x32_bf16 v[72:75], a[244:247], a[124:127], v[72:75]
    s_waitcnt lgkmcnt(6)
    ds_read_b64_tr_b16 a[200:201], v59 offset:32768
    v_mfma_f32_16x16x32_bf16 v[68:71], a[248:251], a[104:107], v[68:71]
    s_waitcnt lgkmcnt(5)
    ds_read_b64_tr_b16 a[202:203], v59 offset:34816
    v_mfma_f32_16x16x32_bf16 v[68:71], a[252:255], a[108:111], v[68:71]
    ds_read_b64_tr_b16 a[204:205], v59 offset:36864
    v_mfma_f32_16x16x32_bf16 v[76:79], a[248:251], a[120:123], v[76:79]
    buffer_load_dwordx4 v27, s[28:31], s98 offen offset:3072  lds
    ds_read_b64_tr_b16 a[206:207], v59 offset:38912
    v_mfma_f32_16x16x32_bf16 v[76:79], a[252:255], a[124:127], v[76:79]
    s_waitcnt lgkmcnt(6)
    ds_read_b64_tr_b16 a[208:209], v58 offset:40960
    v_mfma_f32_16x16x32_bf16 v[80:83], a[192:195], a[64:67], 0
    s_waitcnt lgkmcnt(5)
    ds_read_b64_tr_b16 a[210:211], v58 offset:43008
    v_mfma_f32_16x16x32_bf16 v[80:83], a[196:199], a[68:71], v[80:83]
    ds_read_b64_tr_b16 a[212:213], v58 offset:45056
    v_mfma_f32_16x16x32_bf16 v[88:91], a[192:195], a[80:83], 0
    ds_read_b64_tr_b16 a[214:215], v58 offset:47104
    s_waitcnt vmcnt(16)
    s_barrier
    v_mfma_f32_16x16x32_bf16 v[88:91], a[196:199], a[84:87], v[88:91]
    s_waitcnt lgkmcnt(6)
    s_add_u32 m0, s62, 98304
    ds_read_b64_tr_b16 a[216:217], v59 offset:40960
    v_mfma_f32_16x16x32_bf16 v[84:87], a[200:203], a[64:67], 0
    s_waitcnt lgkmcnt(5)
    s_xor_b32 s98, s65, 262272
    ds_read_b64_tr_b16 a[218:219], v59 offset:43008
    v_mfma_f32_16x16x32_bf16 v[84:87], a[204:207], a[68:71], v[84:87]
    buffer_load_dwordx4 v24, s[28:31], s98 offen offset:0  lds
    ds_read_b64_tr_b16 a[220:221], v59 offset:45056
    v_mfma_f32_16x16x32_bf16 v[92:95], a[200:203], a[80:83], 0
    ds_read_b64_tr_b16 a[222:223], v59 offset:47104
    v_mfma_f32_16x16x32_bf16 v[92:95], a[204:207], a[84:87], v[92:95]
    s_waitcnt lgkmcnt(6)
    ds_read_b64_tr_b16 a[224:225], v58 offset:49152
    v_mfma_f32_16x16x32_bf16 v[80:83], a[208:211], a[72:75], v[80:83]
    s_waitcnt lgkmcnt(5)
    ds_read_b64_tr_b16 a[226:227], v58 offset:51200
    v_mfma_f32_16x16x32_bf16 v[80:83], a[212:215], a[76:79], v[80:83]
    buffer_load_dwordx4 v25, s[28:31], s98 offen offset:1024  lds
    v_mfma_f32_16x16x32_bf16 v[88:91], a[208:211], a[88:91], v[88:91]
    ds_read_b64_tr_b16 a[228:229], v58 offset:53248
    v_mfma_f32_16x16x32_bf16 v[88:91], a[212:215], a[92:95], v[88:91]
    s_waitcnt lgkmcnt(5)
    ds_read_b64_tr_b16 a[230:231], v58 offset:55296
    v_mfma_f32_16x16x32_bf16 v[84:87], a[216:219], a[72:75], v[84:87]
    s_waitcnt lgkmcnt(4)
    ds_read_b64_tr_b16 a[232:233], v59 offset:49152
    v_mfma_f32_16x16x32_bf16 v[84:87], a[220:223], a[76:79], v[84:87]
    buffer_load_dwordx4 v26, s[28:31], s98 offen offset:2048  lds
    ds_read_b64_tr_b16 a[234:235], v59 offset:51200
    v_mfma_f32_16x16x32_bf16 v[92:95], a[216:219], a[88:91], v[92:95]
    ds_read_b64_tr_b16 a[236:237], v59 offset:53248
    v_mfma_f32_16x16x32_bf16 v[92:95], a[220:223], a[92:95], v[92:95]
    s_waitcnt lgkmcnt(5)
    ds_read_b64_tr_b16 a[238:239], v59 offset:55296
    v_mfma_f32_16x16x32_bf16 v[80:83], a[224:227], a[96:99], v[80:83]
    s_waitcnt lgkmcnt(4)
    ds_read_b64_tr_b16 a[240:241], v58 offset:57344
    v_mfma_f32_16x16x32_bf16 v[80:83], a[228:231], a[100:103], v[80:83]
    buffer_load_dwordx4 v27, s[28:31], s98 offen offset:3072  lds
    v_mfma_f32_16x16x32_bf16 v[88:91], a[224:227], a[112:115], v[88:91]
    s_add_u32 m0, s62, 102400
    ds_read_b64_tr_b16 a[242:243], v58 offset:59392
    v_mfma_f32_16x16x32_bf16 v[88:91], a[228:231], a[116:119], v[88:91]
    s_waitcnt lgkmcnt(4)
    s_xor_b32 s98, s65, 295040
    ds_read_b64_tr_b16 a[244:245], v58 offset:61440
    v_mfma_f32_16x16x32_bf16 v[84:87], a[232:235], a[96:99], v[84:87]
    s_waitcnt lgkmcnt(3)
    ds_read_b64_tr_b16 a[246:247], v58 offset:63488
    v_mfma_f32_16x16x32_bf16 v[84:87], a[236:239], a[100:103], v[84:87]
    buffer_load_dwordx4 v24, s[28:31], s98 offen offset:0  lds
    ds_read_b64_tr_b16 a[248:249], v59 offset:57344
    v_mfma_f32_16x16x32_bf16 v[92:95], a[232:235], a[112:115], v[92:95]
    ds_read_b64_tr_b16 a[250:251], v59 offset:59392
    v_mfma_f32_16x16x32_bf16 v[92:95], a[236:239], a[116:119], v[92:95]
    s_waitcnt lgkmcnt(4)
    ds_read_b64_tr_b16 a[252:253], v59 offset:61440
    v_mfma_f32_16x16x32_bf16 v[80:83], a[240:243], a[104:107], v[80:83]
    s_waitcnt lgkmcnt(3)
    ds_read_b64_tr_b16 a[254:255], v59 offset:63488
    v_mfma_f32_16x16x32_bf16 v[80:83], a[244:247], a[108:111], v[80:83]
    buffer_load_dwordx4 v25, s[28:31], s98 offen offset:1024  lds
    v_mfma_f32_16x16x32_bf16 v[88:91], a[240:243], a[120:123], v[88:91]
    ds_read_b64_tr_b16 a[192:193], v60 offset:0
    v_mfma_f32_16x16x32_bf16 v[88:91], a[244:247], a[124:127], v[88:91]
    s_waitcnt lgkmcnt(3)
    ds_read_b64_tr_b16 a[194:195], v60 offset:2048
    v_mfma_f32_16x16x32_bf16 v[84:87], a[248:251], a[104:107], v[84:87]
    s_waitcnt lgkmcnt(2)
    ds_read_b64_tr_b16 a[196:197], v60 offset:4096
    v_mfma_f32_16x16x32_bf16 v[84:87], a[252:255], a[108:111], v[84:87]
    buffer_load_dwordx4 v26, s[28:31], s98 offen offset:2048  lds
    ds_read_b64_tr_b16 a[198:199], v60 offset:6144
    v_mfma_f32_16x16x32_bf16 v[92:95], a[248:251], a[120:123], v[92:95]
    ds_read_b64_tr_b16 a[200:201], v61 offset:0
    v_mfma_f32_16x16x32_bf16 v[92:95], a[252:255], a[124:127], v[92:95]
    s_waitcnt lgkmcnt(3)
    ds_read_b64_tr_b16 a[202:203], v61 offset:2048
    v_mfma_f32_16x16x32_bf16 v[64:67], a[192:195], a[0:3], v[64:67]
    s_waitcnt lgkmcnt(2)
    ds_read_b64_tr_b16 a[204:205], v61 offset:4096
    v_mfma_f32_16x16x32_bf16 v[64:67], a[196:199], a[4:7], v[64:67]
    buffer_load_dwordx4 v27, s[28:31], s98 offen offset:3072  lds
    ds_read_b64_tr_b16 a[206:207], v61 offset:6144
    v_mfma_f32_16x16x32_bf16 v[72:75], a[192:195], a[16:19], v[72:75]
    ds_read_b64_tr_b16 a[208:209], v60 offset:8192
    v_mfma_f32_16x16x32_bf16 v[72:75], a[196:199], a[20:23], v[72:75]
    s_waitcnt lgkmcnt(3)
    ds_read_b64_tr_b16 a[210:211], v60 offset:10240
    v_mfma_f32_16x16x32_bf16 v[68:71], a[200:203], a[0:3], v[68:71]
    s_waitcnt lgkmcnt(2)
    ds_read_b64_tr_b16 a[212:213], v60 offset:12288
    v_mfma_f32_16x16x32_bf16 v[68:71], a[204:207], a[4:7], v[68:71]
    ds_read_b64_tr_b16 a[214:215], v60 offset:14336
    v_mfma_f32_16x16x32_bf16 v[76:79], a[200:203], a[16:19], v[76:79]
    ds_read_b64_tr_b16 a[216:217], v61 offset:8192
    v_mfma_f32_16x16x32_bf16 v[76:79], a[204:207], a[20:23], v[76:79]
    s_waitcnt lgkmcnt(3)
    ds_read_b64_tr_b16 a[218:219], v61 offset:10240
    v_mfma_f32_16x16x32_bf16 v[64:67], a[208:211], a[8:11], v[64:67]
    s_waitcnt lgkmcnt(2)
    ds_read_b64_tr_b16 a[220:221], v61 offset:12288
    v_mfma_f32_16x16x32_bf16 v[64:67], a[212:215], a[12:15], v[64:67]
    ds_read_b64_tr_b16 a[222:223], v61 offset:14336
    v_mfma_f32_16x16x32_bf16 v[72:75], a[208:211], a[24:27], v[72:75]
    ds_read_b64_tr_b16 a[224:225], v60 offset:16384
    v_mfma_f32_16x16x32_bf16 v[72:75], a[212:215], a[28:31], v[72:75]
    s_waitcnt lgkmcnt(3)
    ds_read_b64_tr_b16 a[226:227], v60 offset:18432
    v_mfma_f32_16x16x32_bf16 v[68:71], a[216:219], a[8:11], v[68:71]
    s_waitcnt lgkmcnt(2)
    ds_read_b64_tr_b16 a[228:229], v60 offset:20480
    v_mfma_f32_16x16x32_bf16 v[68:71], a[220:223], a[12:15], v[68:71]
    ds_read_b64_tr_b16 a[230:231], v60 offset:22528
    v_mfma_f32_16x16x32_bf16 v[76:79], a[216:219], a[24:27], v[76:79]
    ds_read_b64_tr_b16 a[232:233], v61 offset:16384
    v_mfma_f32_16x16x32_bf16 v[76:79], a[220:223], a[28:31], v[76:79]
    s_waitcnt lgkmcnt(3)
    ds_read_b64_tr_b16 a[234:235], v61 offset:18432
    v_mfma_f32_16x16x32_bf16 v[64:67], a[224:227], a[32:35], v[64:67]
    s_waitcnt lgkmcnt(2)
    ds_read_b64_tr_b16 a[236:237], v61 offset:20480
    s_waitcnt vmcnt(16)
    v_mfma_f32_16x16x32_bf16 v[64:67], a[228:231], a[36:39], v[64:67]
    buffer_store_dword v6, v5, s[8:11], s22 offen sc0 sc1
    ds_read_b64_tr_b16 a[238:239], v61 offset:22528
    v_mfma_f32_16x16x32_bf16 v[72:75], a[224:227], a[48:51], v[72:75]
    ds_read_b64_tr_b16 a[240:241], v60 offset:24576
    v_mfma_f32_16x16x32_bf16 v[72:75], a[228:231], a[52:55], v[72:75]
    s_waitcnt lgkmcnt(3)
    ds_read_b64_tr_b16 a[242:243], v60 offset:26624
    v_mfma_f32_16x16x32_bf16 v[68:71], a[232:235], a[32:35], v[68:71]
    s_waitcnt lgkmcnt(2)
    ds_read_b64_tr_b16 a[244:245], v60 offset:28672
    v_mfma_f32_16x16x32_bf16 v[68:71], a[236:239], a[36:39], v[68:71]
    ds_read_b64_tr_b16 a[246:247], v60 offset:30720
    v_mfma_f32_16x16x32_bf16 v[76:79], a[232:235], a[48:51], v[76:79]
    ds_read_b64_tr_b16 a[248:249], v61 offset:24576
    v_mfma_f32_16x16x32_bf16 v[76:79], a[236:239], a[52:55], v[76:79]
    s_waitcnt lgkmcnt(3)
    ds_read_b64_tr_b16 a[250:251], v61 offset:26624
    v_mfma_f32_16x16x32_bf16 v[64:67], a[240:243], a[40:43], v[64:67]
    s_waitcnt lgkmcnt(2)
    ds_read_b64_tr_b16 a[252:253], v61 offset:28672
    v_mfma_f32_16x16x32_bf16 v[64:67], a[244:247], a[44:47], v[64:67]
    ds_read_b64_tr_b16 a[254:255], v61 offset:30720
    v_mfma_f32_16x16x32_bf16 v[72:75], a[240:243], a[56:59], v[72:75]
    ds_read_b64_tr_b16 a[192:193], v62 offset:0
    v_mfma_f32_16x16x32_bf16 v[72:75], a[244:247], a[60:63], v[72:75]
    s_waitcnt lgkmcnt(3)
    ds_read_b64_tr_b16 a[194:195], v62 offset:2048
    v_mfma_f32_16x16x32_bf16 v[68:71], a[248:251], a[40:43], v[68:71]
    s_waitcnt lgkmcnt(2)
    ds_read_b64_tr_b16 a[196:197], v62 offset:4096
    s_waitcnt vmcnt(1)
    s_barrier
    v_mfma_f32_16x16x32_bf16 v[68:71], a[252:255], a[44:47], v[68:71]
    s_xor_b32 s74, s24, 0
    ds_read_b64_tr_b16 a[198:199], v62 offset:6144
    v_mfma_f32_16x16x32_bf16 v[76:79], a[248:251], a[56:59], v[76:79]
    buffer_load_dwordx4 v[128:131], v1, s[8:11], s74 offen offset:0
    ds_read_b64_tr_b16 a[200:201], v63 offset:0
    v_mfma_f32_16x16x32_bf16 v[76:79], a[252:255], a[60:63], v[76:79]
    s_waitcnt lgkmcnt(3)
    s_xor_b32 s74, s24, 4096
    ds_read_b64_tr_b16 a[202:203], v63 offset:2048
    v_mfma_f32_16x16x32_bf16 v[80:83], a[192:195], a[0:3], v[80:83]
    s_waitcnt lgkmcnt(2)
    ds_read_b64_tr_b16 a[204:205], v63 offset:4096
    ds_read_b64_tr_b16 a[240:241], v62 offset:24576
    v_mfma_f32_16x16x32_bf16 v[80:83], a[196:199], a[4:7], v[80:83]
    buffer_load_dwordx4 v[144:147], v1, s[8:11], s74 offen offset:0
    ds_read_b64_tr_b16 a[206:207], v63 offset:6144
    v_mfma_f32_16x16x32_bf16 v[88:91], a[192:195], a[16:19], v[88:91]
    s_xor_b32 s74, s24, 0
    ds_read_b64_tr_b16 a[208:209], v62 offset:8192
    v_mfma_f32_16x16x32_bf16 v[88:91], a[196:199], a[20:23], v[88:91]
    s_waitcnt lgkmcnt(1)
    ds_read_b64_tr_b16 a[210:211], v62 offset:10240
    ds_read_b64_tr_b16 a[242:243], v62 offset:26624
    v_mfma_f32_16x16x32_bf16 v[84:87], a[200:203], a[0:3], v[84:87]
    buffer_load_dwordx4 v[132:135], v1, s[8:11], s74 offen offset:1024
    ds_read_b64_tr_b16 a[212:213], v62 offset:12288
    v_mfma_f32_16x16x32_bf16 v[84:87], a[204:207], a[4:7], v[84:87]
    s_xor_b32 s74, s24, 4096
    ds_read_b64_tr_b16 a[214:215], v62 offset:14336
    v_mfma_f32_16x16x32_bf16 v[92:95], a[200:203], a[16:19], v[92:95]
    s_waitcnt lgkmcnt(3)
    ds_read_b64_tr_b16 a[216:217], v63 offset:8192
    v_cvt_pk_bf16_f32 v64, v64, v65
    v_mfma_f32_16x16x32_bf16 v[92:95], a[204:207], a[20:23], v[92:95]
    buffer_load_dwordx4 v[148:151], v1, s[8:11], s74 offen offset:1024
    ds_read_b64_tr_b16 a[218:219], v63 offset:10240
    v_mfma_f32_16x16x32_bf16 v[80:83], a[208:211], a[8:11], v[80:83]
    s_waitcnt lgkmcnt(2)
    s_xor_b32 s74, s24, 0
    ds_read_b64_tr_b16 a[220:221], v63 offset:12288
    v_lshrrev_b32 v46, 2, v2
    v_mfma_f32_16x16x32_bf16 v[80:83], a[212:215], a[12:15], v[80:83]
    ds_read_b64_tr_b16 a[222:223], v63 offset:14336
    v_and_b32 v45, 3, v2
    v_mfma_f32_16x16x32_bf16 v[88:91], a[208:211], a[24:27], v[88:91]
    buffer_load_dwordx4 v[136:139], v1, s[8:11], s74 offen offset:2048
    ds_read_b64_tr_b16 a[244:245], v62 offset:28672
    v_mfma_f32_16x16x32_bf16 v[88:91], a[212:215], a[28:31], v[88:91]
    s_waitcnt lgkmcnt(3)
    s_xor_b32 s74, s24, 4096
    ds_read_b64_tr_b16 a[224:225], v62 offset:16384
    v_lshlrev_b32 v44, 8, v46
    v_mfma_f32_16x16x32_bf16 v[84:87], a[216:219], a[8:11], v[84:87]
    s_waitcnt lgkmcnt(2)
    ds_read_b64_tr_b16 a[226:227], v62 offset:18432
    v_lshl_add_u32 v44, v45, 4, v44
    v_mfma_f32_16x16x32_bf16 v[84:87], a[220:223], a[12:15], v[84:87]
    buffer_load_dwordx4 v[152:155], v1, s[8:11], s74 offen offset:2048
    ds_read_b64_tr_b16 a[228:229], v62 offset:20480
    v_mfma_f32_16x16x32_bf16 v[92:95], a[216:219], a[24:27], v[92:95]
    s_xor_b32 s74, s24, 0
    ds_read_b64_tr_b16 a[230:231], v62 offset:22528
    v_lshlrev_b32 v45, 3, v45
    v_mfma_f32_16x16x32_bf16 v[92:95], a[220:223], a[28:31], v[92:95]
    s_waitcnt lgkmcnt(0)
    ds_read_b64_tr_b16 a[232:233], v63 offset:16384
    v_lshl_add_u32 v45, v46, 6, v45
    v_mfma_f32_16x16x32_bf16 v[80:83], a[224:227], a[32:35], v[80:83]
    buffer_load_dwordx4 v[140:143], v1, s[8:11], s74 offen offset:3072
    ds_read_b64_tr_b16 a[234:235], v63 offset:18432
    v_mfma_f32_16x16x32_bf16 v[80:83], a[228:231], a[36:39], v[80:83]
    s_xor_b32 s74, s24, 4096
    ds_read_b64_tr_b16 a[236:237], v63 offset:20480
    v_lshlrev_b32 v46, 1, v45
    v_mfma_f32_16x16x32_bf16 v[88:91], a[224:227], a[48:51], v[88:91]
    s_waitcnt lgkmcnt(1)
    s_lshl_b32 s70, s2, 15
    ds_read_b64_tr_b16 a[238:239], v63 offset:22528
    v_cvt_pk_bf16_f32 v65, v66, v67
    v_mfma_f32_16x16x32_bf16 v[88:91], a[228:231], a[52:55], v[88:91]
    buffer_load_dwordx4 v[156:159], v1, s[8:11], s74 offen offset:3072
    ds_read_b64_tr_b16 a[246:247], v62 offset:30720
    v_mfma_f32_16x16x32_bf16 v[84:87], a[232:235], a[32:35], v[84:87]
    s_waitcnt lgkmcnt(1)
    s_lshl_b32 s100, s3, 6
    ds_read_b64_tr_b16 a[248:249], v63 offset:24576
    v_cvt_pk_bf16_f32 v66, v68, v69
    v_mfma_f32_16x16x32_bf16 v[84:87], a[236:239], a[36:39], v[84:87]
    s_add_u32 s70, s70, s100
    ds_read_b64_tr_b16 a[250:251], v63 offset:26624
    v_cvt_pk_bf16_f32 v67, v70, v71
    v_mfma_f32_16x16x32_bf16 v[92:95], a[232:235], a[48:51], v[92:95]
    s_add_u32 s70, s70, 67108864
    ds_read_b64_tr_b16 a[252:253], v63 offset:28672
    v_min_u32 v64, -2, v64
    v_mfma_f32_16x16x32_bf16 v[92:95], a[236:239], a[52:55], v[92:95]
    s_and_b32 s68, s2, 31
    ds_read_b64_tr_b16 a[254:255], v63 offset:30720
    v_min_u32 v65, -2, v65
    v_mfma_f32_16x16x32_bf16 v[80:83], a[240:243], a[40:43], v[80:83]
    s_waitcnt lgkmcnt(4)
    s_lshl_b32 s68, s68, 2
    ds_read_b64_tr_b16 a[192:193], v56 offset:0
    v_min_u32 v66, -2, v66
    v_mfma_f32_16x16x32_bf16 v[80:83], a[244:247], a[44:47], v[80:83]
    s_add_u32 s68, s68, s3
    ds_read_b64_tr_b16 a[194:195], v56 offset:2048
    v_min_u32 v67, -2, v67
    v_mfma_f32_16x16x32_bf16 v[88:91], a[240:243], a[56:59], v[88:91]
    s_lshl_b32 s69, s61, 7
    ds_read_b64_tr_b16 a[196:197], v56 offset:4096
    v_mfma_f32_16x16x32_bf16 v[88:91], a[244:247], a[60:63], v[88:91]
    s_waitcnt lgkmcnt(5)
    s_add_u32 s69, s69, s68
    ds_read_b64_tr_b16 a[198:199], v56 offset:6144
    v_mfma_f32_16x16x32_bf16 v[84:87], a[248:251], a[40:43], v[84:87]
    s_waitcnt lgkmcnt(4)
    s_lshl_b32 s100, s60, 7
    ds_read_b64_tr_b16 a[200:201], v57 offset:0
    v_mfma_f32_16x16x32_bf16 v[84:87], a[252:255], a[44:47], v[84:87]
    s_add_u32 s68, s68, s100
    ds_read_b64_tr_b16 a[202:203], v57 offset:2048
    v_mfma_f32_16x16x32_bf16 v[92:95], a[248:251], a[56:59], v[92:95]
    s_lshl_b32 s100, s68, 10
    ds_read_b64_tr_b16 a[204:205], v57 offset:4096
    v_mfma_f32_16x16x32_bf16 v[92:95], a[252:255], a[60:63], v[92:95]
    s_waitcnt lgkmcnt(5)
    s_lshl_b32 s101, s69, 10
    ds_read_b64_tr_b16 a[206:207], v57 offset:6144
    v_mfma_f32_16x16x32_bf16 v[96:99], a[192:195], a[64:67], 0
    s_waitcnt lgkmcnt(4)
    s_add_u32 s75, s18, 0
    ds_read_b64_tr_b16 a[208:209], v56 offset:8192
    v_mfma_f32_16x16x32_bf16 v[96:99], a[196:199], a[68:71], v[96:99]
    buffer_store_dwordx4 v[64:67], v23, s[8:11], s75 offen offset:0 sc0 sc1
    v_mfma_f32_16x16x32_bf16 v[104:107], a[192:195], a[80:83], 0
    buffer_load_dword v3, v4, s[8:11], s23 offen sc0 sc1
    v_mfma_f32_16x16x32_bf16 v[104:107], a[196:199], a[84:87], v[104:107]
    s_waitcnt lgkmcnt(3)
    ds_read_b64_tr_b16 a[210:211], v56 offset:10240
    v_cvt_pk_bf16_f32 v72, v72, v73
    v_mfma_f32_16x16x32_bf16 v[100:103], a[200:203], a[64:67], 0
    s_waitcnt lgkmcnt(2)
    ds_read_b64_tr_b16 a[212:213], v56 offset:12288
    v_cvt_pk_bf16_f32 v73, v74, v75
    v_mfma_f32_16x16x32_bf16 v[100:103], a[204:207], a[68:71], v[100:103]
    ds_read_b64_tr_b16 a[214:215], v56 offset:14336
    v_cvt_pk_bf16_f32 v74, v76, v77
    v_mfma_f32_16x16x32_bf16 v[108:111], a[200:203], a[80:83], 0
    ds_read_b64_tr_b16 a[216:217], v57 offset:8192
    v_cvt_pk_bf16_f32 v75, v78, v79
    v_mfma_f32_16x16x32_bf16 v[108:111], a[204:207], a[84:87], v[108:111]
    s_waitcnt lgkmcnt(3)
    ds_read_b64_tr_b16 a[218:219], v57 offset:10240
    v_min_u32 v72, -2, v72
    v_mfma_f32_16x16x32_bf16 v[96:99], a[208:211], a[72:75], v[96:99]
    s_waitcnt lgkmcnt(2)
    ds_read_b64_tr_b16 a[220:221], v57 offset:12288
    v_min_u32 v73, -2, v73
    v_mfma_f32_16x16x32_bf16 v[96:99], a[212:215], a[76:79], v[96:99]
    ds_read_b64_tr_b16 a[222:223], v57 offset:14336
    v_min_u32 v74, -2, v74
    v_mfma_f32_16x16x32_bf16 v[104:107], a[208:211], a[88:91], v[104:107]
    ds_read_b64_tr_b16 a[224:225], v56 offset:16384
    v_min_u32 v75, -2, v75
    v_mfma_f32_16x16x32_bf16 v[104:107], a[212:215], a[92:95], v[104:107]
    s_waitcnt lgkmcnt(1)
    s_add_u32 s75, s18, 131072
    ds_read_b64_tr_b16 a[226:227], v56 offset:18432
    v_cvt_pk_bf16_f32 v80, v80, v81
    v_mfma_f32_16x16x32_bf16 v[100:103], a[216:219], a[72:75], v[100:103]
    buffer_store_dwordx4 v[72:75], v23, s[8:11], s75 offen offset:0 sc0 sc1
    ds_read_b64_tr_b16 a[228:229], v56 offset:20480
    v_mfma_f32_16x16x32_bf16 v[100:103], a[220:223], a[76:79], v[100:103]
    ds_read_b64_tr_b16 a[230:231], v56 offset:22528
    v_cvt_pk_bf16_f32 v81, v82, v83
    v_mfma_f32_16x16x32_bf16 v[108:111], a[216:219], a[88:91], v[108:111]
    ds_read_b64_tr_b16 a[232:233], v57 offset:16384
    v_cvt_pk_bf16_f32 v82, v84, v85
    v_mfma_f32_16x16x32_bf16 v[108:111], a[220:223], a[92:95], v[108:111]
    s_waitcnt lgkmcnt(3)
    ds_read_b64_tr_b16 a[234:235], v57 offset:18432
    v_cvt_pk_bf16_f32 v83, v86, v87
    v_mfma_f32_16x16x32_bf16 v[96:99], a[224:227], a[96:99], v[96:99]
    s_waitcnt lgkmcnt(2)
    ds_read_b64_tr_b16 a[236:237], v57 offset:20480
    v_min_u32 v80, -2, v80
    v_mfma_f32_16x16x32_bf16 v[96:99], a[228:231], a[100:103], v[96:99]
    ds_read_b64_tr_b16 a[238:239], v57 offset:22528
    v_min_u32 v81, -2, v81
    v_mfma_f32_16x16x32_bf16 v[104:107], a[224:227], a[112:115], v[104:107]
    ds_read_b64_tr_b16 a[240:241], v56 offset:24576
    v_min_u32 v82, -2, v82
    v_mfma_f32_16x16x32_bf16 v[104:107], a[228:231], a[116:119], v[104:107]
    s_waitcnt lgkmcnt(3)
    ds_read_b64_tr_b16 a[242:243], v56 offset:26624
    v_min_u32 v83, -2, v83
    v_mfma_f32_16x16x32_bf16 v[100:103], a[232:235], a[96:99], v[100:103]
    s_waitcnt lgkmcnt(2)
    s_add_u32 s75, s18, 0
    ds_read_b64_tr_b16 a[244:245], v56 offset:28672
    v_mfma_f32_16x16x32_bf16 v[100:103], a[236:239], a[100:103], v[100:103]
    buffer_store_dwordx4 v[80:83], v23, s[8:11], s75 offen offset:256 sc0 sc1
    ds_read_b64_tr_b16 a[246:247], v56 offset:30720
    v_mfma_f32_16x16x32_bf16 v[108:111], a[232:235], a[112:115], v[108:111]
    ds_read_b64_tr_b16 a[248:249], v57 offset:24576
    v_cvt_pk_bf16_f32 v88, v88, v89
    v_mfma_f32_16x16x32_bf16 v[108:111], a[236:239], a[116:119], v[108:111]
    s_waitcnt lgkmcnt(3)
    ds_read_b64_tr_b16 a[250:251], v57 offset:26624
    v_cvt_pk_bf16_f32 v89, v90, v91
    v_mfma_f32_16x16x32_bf16 v[96:99], a[240:243], a[104:107], v[96:99]
    s_waitcnt lgkmcnt(2)
    ds_read_b64_tr_b16 a[252:253], v57 offset:28672
    v_cvt_pk_bf16_f32 v90, v92, v93
    v_mfma_f32_16x16x32_bf16 v[96:99], a[244:247], a[108:111], v[96:99]
    ds_read_b64_tr_b16 a[254:255], v57 offset:30720
    v_cvt_pk_bf16_f32 v91, v94, v95
    v_mfma_f32_16x16x32_bf16 v[104:107], a[240:243], a[120:123], v[104:107]
    ds_read_b64_tr_b16 a[192:193], v60 offset:32768
    v_min_u32 v88, -2, v88
    v_mfma_f32_16x16x32_bf16 v[104:107], a[244:247], a[124:127], v[104:107]
    s_waitcnt lgkmcnt(3)
    ds_read_b64_tr_b16 a[194:195], v60 offset:34816
    v_min_u32 v89, -2, v89
    v_mfma_f32_16x16x32_bf16 v[100:103], a[248:251], a[104:107], v[100:103]
    s_waitcnt lgkmcnt(2)
    ds_read_b64_tr_b16 a[196:197], v60 offset:36864
    v_min_u32 v90, -2, v90
    v_mfma_f32_16x16x32_bf16 v[100:103], a[252:255], a[108:111], v[100:103]
    ds_read_b64_tr_b16 a[198:199], v60 offset:38912
    v_min_u32 v91, -2, v91
    v_mfma_f32_16x16x32_bf16 v[108:111], a[248:251], a[120:123], v[108:111]
    ds_read_b64_tr_b16 a[200:201], v61 offset:32768
    v_mfma_f32_16x16x32_bf16 v[108:111], a[252:255], a[124:127], v[108:111]
    s_waitcnt lgkmcnt(3)
    ds_read_b64_tr_b16 a[202:203], v61 offset:34816
    v_mfma_f32_16x16x32_bf16 v[96:99], a[192:195], a[0:3], v[96:99]
    s_waitcnt lgkmcnt(2)
    s_add_u32 s75, s18, 131072
    ds_read_b64_tr_b16 a[204:205], v61 offset:36864
    s_waitcnt vmcnt(2)
    v_cmp_ne_u32 vcc, 0, v3
    s_cmp_eq_u64 vcc, -1
    s_cbranch_scc0 L_C2_slow_13
L_C2_ok_14:
    v_mfma_f32_16x16x32_bf16 v[96:99], a[196:199], a[4:7], v[96:99]
    s_xor_b32 s74, s24, 8192
    ds_read_b64_tr_b16 a[206:207], v61 offset:38912
    v_mfma_f32_16x16x32_bf16 v[104:107], a[192:195], a[16:19], v[104:107]
    buffer_load_dwordx4 v[160:163], v1, s[8:11], s74 offen offset:0
    v_mfma_f32_16x16x32_bf16 v[104:107], a[196:199], a[20:23], v[104:107]
    s_waitcnt lgkmcnt(0)
    s_xor_b32 s74, s24, 12288
    ds_read_b64_tr_b16 a[208:209], v60 offset:40960
    v_mfma_f32_16x16x32_bf16 v[100:103], a[200:203], a[0:3], v[100:103]
    buffer_store_dwordx4 v[88:91], v23, s[8:11], s75 offen offset:256 sc0 sc1
    ds_read_b64_tr_b16 a[210:211], v60 offset:43008
    v_mfma_f32_16x16x32_bf16 v[100:103], a[204:207], a[4:7], v[100:103]
    ds_read_b64_tr_b16 a[212:213], v60 offset:45056
    v_mfma_f32_16x16x32_bf16 v[108:111], a[200:203], a[16:19], v[108:111]
    buffer_load_dwordx4 v[176:179], v1, s[8:11], s74 offen offset:0
    ds_read_b64_tr_b16 a[214:215], v60 offset:47104
    v_mfma_f32_16x16x32_bf16 v[108:111], a[204:207], a[20:23], v[108:111]
    s_waitcnt lgkmcnt(2)
    s_xor_b32 s74, s24, 8192
    ds_read_b64_tr_b16 a[216:217], v61 offset:40960
    v_mfma_f32_16x16x32_bf16 v[96:99], a[208:211], a[8:11], v[96:99]
    s_waitcnt lgkmcnt(1)
    ds_read_b64_tr_b16 a[218:219], v61 offset:43008
    v_mfma_f32_16x16x32_bf16 v[96:99], a[212:215], a[12:15], v[96:99]
    ds_read_b64_tr_b16 a[220:221], v61 offset:45056
    v_mfma_f32_16x16x32_bf16 v[104:107], a[208:211], a[24:27], v[104:107]
    buffer_load_dwordx4 v[164:167], v1, s[8:11], s74 offen offset:1024
    ds_read_b64_tr_b16 a[222:223], v61 offset:47104
    v_mfma_f32_16x16x32_bf16 v[104:107], a[212:215], a[28:31], v[104:107]
    s_waitcnt lgkmcnt(2)
    s_xor_b32 s74, s24, 12288
    ds_read_b64_tr_b16 a[224:225], v60 offset:49152
    v_mfma_f32_16x16x32_bf16 v[100:103], a[216:219], a[8:11], v[100:103]
    s_waitcnt lgkmcnt(1)
    ds_read_b64_tr_b16 a[226:227], v60 offset:51200
    v_mfma_f32_16x16x32_bf16 v[100:103], a[220:223], a[12:15], v[100:103]
    ds_read_b64_tr_b16 a[228:229], v60 offset:53248
    v_mfma_f32_16x16x32_bf16 v[108:111], a[216:219], a[24:27], v[108:111]
    buffer_load_dwordx4 v[180:183], v1, s[8:11], s74 offen offset:1024
    ds_read_b64_tr_b16 a[230:231], v60 offset:55296
    v_mfma_f32_16x16x32_bf16 v[108:111], a[220:223], a[28:31], v[108:111]
    s_waitcnt lgkmcnt(2)
    s_xor_b32 s74, s24, 8192
    ds_read_b64_tr_b16 a[232:233], v61 offset:49152
    v_mfma_f32_16x16x32_bf16 v[96:99], a[224:227], a[32:35], v[96:99]
    s_waitcnt lgkmcnt(1)
    ds_read_b64_tr_b16 a[234:235], v61 offset:51200
    v_mfma_f32_16x16x32_bf16 v[96:99], a[228:231], a[36:39], v[96:99]
    ds_read_b64_tr_b16 a[236:237], v61 offset:53248
    v_mfma_f32_16x16x32_bf16 v[104:107], a[224:227], a[48:51], v[104:107]
    buffer_load_dwordx4 v[168:171], v1, s[8:11], s74 offen offset:2048
    ds_read_b64_tr_b16 a[238:239], v61 offset:55296
    v_mfma_f32_16x16x32_bf16 v[104:107], a[228:231], a[52:55], v[104:107]
    s_waitcnt lgkmcnt(2)
    s_xor_b32 s74, s24, 12288
    ds_read_b64_tr_b16 a[240:241], v60 offset:57344
    v_mfma_f32_16x16x32_bf16 v[100:103], a[232:235], a[32:35], v[100:103]
    s_waitcnt lgkmcnt(1)
    ds_read_b64_tr_b16 a[242:243], v60 offset:59392
    v_mfma_f32_16x16x32_bf16 v[100:103], a[236:239], a[36:39], v[100:103]
    ds_read_b64_tr_b16 a[244:245], v60 offset:61440
    v_mfma_f32_16x16x32_bf16 v[108:111], a[232:235], a[48:51], v[108:111]
    buffer_load_dwordx4 v[184:187], v1, s[8:11], s74 offen offset:2048
    ds_read_b64_tr_b16 a[246:247], v60 offset:63488
    v_mfma_f32_16x16x32_bf16 v[108:111], a[236:239], a[52:55], v[108:111]
    s_waitcnt lgkmcnt(2)
    s_xor_b32 s74, s24, 8192
    ds_read_b64_tr_b16 a[248:249], v61 offset:57344
    v_mfma_f32_16x16x32_bf16 v[96:99], a[240:243], a[40:43], v[96:99]
    s_waitcnt lgkmcnt(1)
    ds_read_b64_tr_b16 a[250:251], v61 offset:59392
    v_mfma_f32_16x16x32_bf16 v[96:99], a[244:247], a[44:47], v[96:99]
    ds_read_b64_tr_b16 a[252:253], v61 offset:61440
    v_mfma_f32_16x16x32_bf16 v[104:107], a[240:243], a[56:59], v[104:107]
    buffer_load_dwordx4 v[172:175], v1, s[8:11], s74 offen offset:3072
    ds_read_b64_tr_b16 a[254:255], v61 offset:63488
    v_mfma_f32_16x16x32_bf16 v[104:107], a[244:247], a[60:63], v[104:107]
    s_waitcnt lgkmcnt(2)
    s_xor_b32 s74, s24, 12288
    ds_read_b64_tr_b16 a[192:193], v58 offset:0
    v_mfma_f32_16x16x32_bf16 v[100:103], a[248:251], a[40:43], v[100:103]
    s_waitcnt lgkmcnt(1)
    ds_read_b64_tr_b16 a[194:195], v58 offset:2048
    v_mfma_f32_16x16x32_bf16 v[100:103], a[252:255], a[44:47], v[100:103]
    ds_read_b64_tr_b16 a[196:197], v58 offset:4096
    v_mfma_f32_16x16x32_bf16 v[108:111], a[248:251], a[56:59], v[108:111]
    buffer_load_dwordx4 v[188:191], v1, s[8:11], s74 offen offset:3072
    ds_read_b64_tr_b16 a[198:199], v58 offset:6144
    v_mfma_f32_16x16x32_bf16 v[108:111], a[252:255], a[60:63], v[108:111]
    s_waitcnt lgkmcnt(2)
    s_xor_b32 s74, s24, 16384
    ds_read_b64_tr_b16 a[200:201], v59 offset:0
    v_mfma_f32_16x16x32_bf16 v[112:115], a[192:195], a[64:67], 0
    s_waitcnt lgkmcnt(1)
    ds_read_b64_tr_b16 a[202:203], v59 offset:2048
    v_mfma_f32_16x16x32_bf16 v[112:115], a[196:199], a[68:71], v[112:115]
    ds_read_b64_tr_b16 a[204:205], v59 offset:4096
    v_mfma_f32_16x16x32_bf16 v[120:123], a[192:195], a[80:83], 0
    buffer_load_dwordx4 v[192:195], v1, s[8:11], s74 offen offset:0
    ds_read_b64_tr_b16 a[206:207], v59 offset:6144
    v_mfma_f32_16x16x32_bf16 v[120:123], a[196:199], a[84:87], v[120:123]
    s_waitcnt lgkmcnt(2)
    s_xor_b32 s74, s24, 20480
    ds_read_b64_tr_b16 a[208:209], v58 offset:8192
    v_mfma_f32_16x16x32_bf16 v[116:119], a[200:203], a[64:67], 0
    s_waitcnt lgkmcnt(1)
    ds_read_b64_tr_b16 a[210:211], v58 offset:10240
    v_mfma_f32_16x16x32_bf16 v[116:119], a[204:207], a[68:71], v[116:119]
    ds_read_b64_tr_b16 a[212:213], v58 offset:12288
    v_mfma_f32_16x16x32_bf16 v[124:127], a[200:203], a[80:83], 0
    buffer_load_dwordx4 v[208:211], v1, s[8:11], s74 offen offset:0
    ds_read_b64_tr_b16 a[214:215], v58 offset:14336
    v_mfma_f32_16x16x32_bf16 v[124:127], a[204:207], a[84:87], v[124:127]
    s_waitcnt lgkmcnt(2)
    s_xor_b32 s74, s24, 16384
    ds_read_b64_tr_b16 a[216:217], v59 offset:8192
    v_cvt_pk_bf16_f32 v96, v96, v97
    v_mfma_f32_16x16x32_bf16 v[112:115], a[208:211], a[72:75], v[112:115]
    s_waitcnt lgkmcnt(1)
    ds_read_b64_tr_b16 a[218:219], v59 offset:10240
    v_cvt_pk_bf16_f32 v97, v98, v99
    v_mfma_f32_16x16x32_bf16 v[112:115], a[212:215], a[76:79], v[112:115]
    ds_read_b64_tr_b16 a[220:221], v59 offset:12288
    v_cvt_pk_bf16_f32 v98, v100, v101
    v_mfma_f32_16x16x32_bf16 v[120:123], a[208:211], a[88:91], v[120:123]
    buffer_load_dwordx4 v[196:199], v1, s[8:11], s74 offen offset:1024
    ds_read_b64_tr_b16 a[222:223], v59 offset:14336
    v_mfma_f32_16x16x32_bf16 v[120:123], a[212:215], a[92:95], v[120:123]
    s_waitcnt lgkmcnt(2)
    s_xor_b32 s74, s24, 20480
    ds_read_b64_tr_b16 a[224:225], v58 offset:16384
    v_cvt_pk_bf16_f32 v99, v102, v103
    v_mfma_f32_16x16x32_bf16 v[116:119], a[216:219], a[72:75], v[116:119]
    s_waitcnt lgkmcnt(1)
    ds_read_b64_tr_b16 a[226:227], v58 offset:18432
    v_min_u32 v96, -2, v96
    v_mfma_f32_16x16x32_bf16 v[116:119], a[220:223], a[76:79], v[116:119]
    ds_read_b64_tr_b16 a[228:229], v58 offset:20480
    v_min_u32 v97, -2, v97
    v_mfma_f32_16x16x32_bf16 v[124:127], a[216:219], a[88:91], v[124:127]
    buffer_load_dwordx4 v[212:215], v1, s[8:11], s74 offen offset:1024
    ds_read_b64_tr_b16 a[230:231], v58 offset:22528
    v_mfma_f32_16x16x32_bf16 v[124:127], a[220:223], a[92:95], v[124:127]
    s_waitcnt lgkmcnt(2)
    s_xor_b32 s74, s24, 16384
    ds_read_b64_tr_b16 a[232:233], v59 offset:16384
    v_min_u32 v98, -2, v98
    v_mfma_f32_16x16x32_bf16 v[112:115], a[224:227], a[96:99], v[112:115]
    s_waitcnt lgkmcnt(1)
    ds_read_b64_tr_b16 a[234:235], v59 offset:18432
    v_min_u32 v99, -2, v99
    v_mfma_f32_16x16x32_bf16 v[112:115], a[228:231], a[100:103], v[112:115]
    s_add_u32 s75, s18, 0
    ds_read_b64_tr_b16 a[236:237], v59 offset:20480
    v_mfma_f32_16x16x32_bf16 v[120:123], a[224:227], a[112:115], v[120:123]
    buffer_load_dwordx4 v[200:203], v1, s[8:11], s74 offen offset:2048
    ds_read_b64_tr_b16 a[238:239], v59 offset:22528
    v_mfma_f32_16x16x32_bf16 v[120:123], a[228:231], a[116:119], v[120:123]
    s_waitcnt lgkmcnt(0)
    s_xor_b32 s74, s24, 20480
    ds_read_b64_tr_b16 a[240:241], v58 offset:24576
    v_mfma_f32_16x16x32_bf16 v[116:119], a[232:235], a[96:99], v[116:119]
    buffer_store_dwordx4 v[96:99], v23, s[8:11], s75 offen offset:512 sc0 sc1
    ds_read_b64_tr_b16 a[242:243], v58 offset:26624
    v_mfma_f32_16x16x32_bf16 v[116:119], a[236:239], a[100:103], v[116:119]
    ds_read_b64_tr_b16 a[244:245], v58 offset:28672
    v_cvt_pk_bf16_f32 v104, v104, v105
    v_mfma_f32_16x16x32_bf16 v[124:127], a[232:235], a[112:115], v[124:127]
    buffer_load_dwordx4 v[216:219], v1, s[8:11], s74 offen offset:2048
    ds_read_b64_tr_b16 a[246:247], v58 offset:30720
    v_mfma_f32_16x16x32_bf16 v[124:127], a[236:239], a[116:119], v[124:127]
    s_waitcnt lgkmcnt(2)
    s_xor_b32 s74, s24, 16384
    ds_read_b64_tr_b16 a[248:249], v59 offset:24576
    v_cvt_pk_bf16_f32 v105, v106, v107
    v_mfma_f32_16x16x32_bf16 v[112:115], a[240:243], a[104:107], v[112:115]
    s_waitcnt lgkmcnt(1)
    ds_read_b64_tr_b16 a[250:251], v59 offset:26624
    v_cvt_pk_bf16_f32 v106, v108, v109
    v_mfma_f32_16x16x32_bf16 v[112:115], a[244:247], a[108:111], v[112:115]
    ds_read_b64_tr_b16 a[252:253], v59 offset:28672
    v_cvt_pk_bf16_f32 v107, v110, v111
    v_mfma_f32_16x16x32_bf16 v[120:123], a[240:243], a[120:123], v[120:123]
    buffer_load_dwordx4 v[204:207], v1, s[8:11], s74 offen offset:3072
    ds_read_b64_tr_b16 a[254:255], v59 offset:30720
    v_mfma_f32_16x16x32_bf16 v[120:123], a[244:247], a[124:127], v[120:123]
    s_waitcnt lgkmcnt(2)
    s_xor_b32 s74, s24, 20480
    ds_read_b64_tr_b16 a[192:193], v62 offset:32768
    v_min_u32 v104, -2, v104
    v_mfma_f32_16x16x32_bf16 v[116:119], a[248:251], a[104:107], v[116:119]
    s_waitcnt lgkmcnt(1)
    ds_read_b64_tr_b16 a[194:195], v62 offset:34816
    v_min_u32 v105, -2, v105
    v_mfma_f32_16x16x32_bf16 v[116:119], a[252:255], a[108:111], v[116:119]
    ds_read_b64_tr_b16 a[196:197], v62 offset:36864
    v_min_u32 v106, -2, v106
    v_mfma_f32_16x16x32_bf16 v[124:127], a[248:251], a[120:123], v[124:127]
    buffer_load_dwordx4 v[220:223], v1, s[8:11], s74 offen offset:3072
    ds_read_b64_tr_b16 a[198:199], v62 offset:38912
    v_mfma_f32_16x16x32_bf16 v[124:127], a[252:255], a[124:127], v[124:127]
    s_waitcnt lgkmcnt(2)
    s_xor_b32 s74, s24, 24576
    ds_read_b64_tr_b16 a[200:201], v63 offset:32768
    v_min_u32 v107, -2, v107
    v_mfma_f32_16x16x32_bf16 v[112:115], a[192:195], a[0:3], v[112:115]
    s_waitcnt lgkmcnt(1)
    s_add_u32 s75, s18, 131072
    ds_read_b64_tr_b16 a[202:203], v63 offset:34816
    v_mfma_f32_16x16x32_bf16 v[112:115], a[196:199], a[4:7], v[112:115]
    buffer_store_dwordx4 v[104:107], v23, s[8:11], s75 offen offset:512 sc0 sc1
    ds_read_b64_tr_b16 a[204:205], v63 offset:36864
    v_mfma_f32_16x16x32_bf16 v[120:123], a[192:195], a[16:19], v[120:123]
    buffer_load_dwordx4 v[224:227], v1, s[8:11], s74 offen offset:0
    ds_read_b64_tr_b16 a[206:207], v63 offset:38912
    v_mfma_f32_16x16x32_bf16 v[120:123], a[196:199], a[20:23], v[120:123]
    s_waitcnt lgkmcnt(2)
    s_xor_b32 s74, s24, 28672
    ds_read_b64_tr_b16 a[208:209], v62 offset:40960
    v_mfma_f32_16x16x32_bf16 v[116:119], a[200:203], a[0:3], v[116:119]
    s_waitcnt lgkmcnt(1)
    ds_read_b64_tr_b16 a[210:211], v62 offset:43008
    v_mfma_f32_16x16x32_bf16 v[116:119], a[204:207], a[4:7], v[116:119]
    ds_read_b64_tr_b16 a[212:213], v62 offset:45056
    v_mfma_f32_16x16x32_bf16 v[124:127], a[200:203], a[16:19], v[124:127]
    buffer_load_dwordx4 v[240:243], v1, s[8:11], s74 offen offset:0
    ds_read_b64_tr_b16 a[214:215], v62 offset:47104
    v_mfma_f32_16x16x32_bf16 v[124:127], a[204:207], a[20:23], v[124:127]
    s_waitcnt lgkmcnt(2)
    s_xor_b32 s74, s24, 24576
    ds_read_b64_tr_b16 a[216:217], v63 offset:40960
    v_mfma_f32_16x16x32_bf16 v[112:115], a[208:211], a[8:11], v[112:115]
    s_waitcnt lgkmcnt(1)
    ds_read_b64_tr_b16 a[218:219], v63 offset:43008
    v_mfma_f32_16x16x32_bf16 v[112:115], a[212:215], a[12:15], v[112:115]
    ds_read_b64_tr_b16 a[220:221], v63 offset:45056
    v_mfma_f32_16x16x32_bf16 v[120:123], a[208:211], a[24:27], v[120:123]
    buffer_load_dwordx4 v[228:231], v1, s[8:11], s74 offen offset:1024
    ds_read_b64_tr_b16 a[222:223], v63 offset:47104
    v_mfma_f32_16x16x32_bf16 v[120:123], a[212:215], a[28:31], v[120:123]
    s_waitcnt lgkmcnt(2)
    s_xor_b32 s74, s24, 28672
    ds_read_b64_tr_b16 a[224:225], v62 offset:49152
    v_mfma_f32_16x16x32_bf16 v[116:119], a[216:219], a[8:11], v[116:119]
    s_waitcnt lgkmcnt(1)
    ds_read_b64_tr_b16 a[226:227], v62 offset:51200
    v_mfma_f32_16x16x32_bf16 v[116:119], a[220:223], a[12:15], v[116:119]
    ds_read_b64_tr_b16 a[228:229], v62 offset:53248
    v_mfma_f32_16x16x32_bf16 v[124:127], a[216:219], a[24:27], v[124:127]
    buffer_load_dwordx4 v[244:247], v1, s[8:11], s74 offen offset:1024
    ds_read_b64_tr_b16 a[230:231], v62 offset:55296
    v_mfma_f32_16x16x32_bf16 v[124:127], a[220:223], a[28:31], v[124:127]
    s_waitcnt lgkmcnt(2)
    s_xor_b32 s74, s24, 24576
    ds_read_b64_tr_b16 a[232:233], v63 offset:49152
    v_mfma_f32_16x16x32_bf16 v[112:115], a[224:227], a[32:35], v[112:115]
    s_waitcnt lgkmcnt(1)
    ds_read_b64_tr_b16 a[234:235], v63 offset:51200
    ds_read_b64_tr_b16 a[208:209], v56 offset:40960
    v_mfma_f32_16x16x32_bf16 v[112:115], a[228:231], a[36:39], v[112:115]
    ds_read_b64_tr_b16 a[236:237], v63 offset:53248
    ds_read_b64_tr_b16 a[210:211], v56 offset:43008
    v_mfma_f32_16x16x32_bf16 v[120:123], a[224:227], a[48:51], v[120:123]
    buffer_load_dwordx4 v[232:235], v1, s[8:11], s74 offen offset:2048
    ds_read_b64_tr_b16 a[238:239], v63 offset:55296
    v_mfma_f32_16x16x32_bf16 v[120:123], a[228:231], a[52:55], v[120:123]
    s_waitcnt lgkmcnt(4)
    s_xor_b32 s74, s24, 28672
    ds_read_b64_tr_b16 a[240:241], v62 offset:57344
    v_mfma_f32_16x16x32_bf16 v[116:119], a[232:235], a[32:35], v[116:119]
    s_waitcnt lgkmcnt(1)
    ds_read_b64_tr_b16 a[242:243], v62 offset:59392
    ds_read_b64_tr_b16 a[212:213], v56 offset:45056
    v_mfma_f32_16x16x32_bf16 v[116:119], a[236:239], a[36:39], v[116:119]
    ds_read_b64_tr_b16 a[244:245], v62 offset:61440
    ds_read_b64_tr_b16 a[214:215], v56 offset:47104
    v_mfma_f32_16x16x32_bf16 v[124:127], a[232:235], a[48:51], v[124:127]
    buffer_load_dwordx4 v[248:251], v1, s[8:11], s74 offen offset:2048
    ds_read_b64_tr_b16 a[246:247], v62 offset:63488
    v_mfma_f32_16x16x32_bf16 v[124:127], a[236:239], a[52:55], v[124:127]
    s_waitcnt lgkmcnt(4)
    s_xor_b32 s74, s24, 24576
    ds_read_b64_tr_b16 a[248:249], v63 offset:57344
    v_mfma_f32_16x16x32_bf16 v[112:115], a[240:243], a[40:43], v[112:115]
    s_waitcnt lgkmcnt(1)
    ds_read_b64_tr_b16 a[250:251], v63 offset:59392
    ds_read_b64_tr_b16 a[216:217], v57 offset:40960
    v_mfma_f32_16x16x32_bf16 v[112:115], a[244:247], a[44:47], v[112:115]
    ds_read_b64_tr_b16 a[252:253], v63 offset:61440
    ds_read_b64_tr_b16 a[218:219], v57 offset:43008
    v_mfma_f32_16x16x32_bf16 v[120:123], a[240:243], a[56:59], v[120:123]
    buffer_load_dwordx4 v[236:239], v1, s[8:11], s74 offen offset:3072
    ds_read_b64_tr_b16 a[254:255], v63 offset:63488
    v_mfma_f32_16x16x32_bf16 v[120:123], a[244:247], a[60:63], v[120:123]
    s_waitcnt lgkmcnt(4)
    s_xor_b32 s74, s24, 28672
    ds_read_b64_tr_b16 a[192:193], v56 offset:32768
    v_mfma_f32_16x16x32_bf16 v[116:119], a[248:251], a[40:43], v[116:119]
    s_waitcnt lgkmcnt(1)
    ds_read_b64_tr_b16 a[194:195], v56 offset:34816
    ds_read_b64_tr_b16 a[220:221], v57 offset:45056
    v_mfma_f32_16x16x32_bf16 v[116:119], a[252:255], a[44:47], v[116:119]
    s_waitcnt lgkmcnt(1)
    ds_read_b64_tr_b16 a[196:197], v56 offset:36864
    ds_read_b64_tr_b16 a[222:223], v57 offset:47104
    v_mfma_f32_16x16x32_bf16 v[124:127], a[248:251], a[56:59], v[124:127]
    buffer_load_dwordx4 v[252:255], v1, s[8:11], s74 offen offset:3072
    ds_read_b64_tr_b16 a[198:199], v56 offset:38912
    v_mfma_f32_16x16x32_bf16 v[124:127], a[252:255], a[60:63], v[124:127]
    buffer_load_dwordx2 v[32:33], v45, s[32:35], s100 offen
    ds_read_b64_tr_b16 a[200:201], v57 offset:32768
    v_mfma_f32_16x16x32_bf16 v[64:67], a[192:195], v[128:131], 0
    s_waitcnt lgkmcnt(1)
    ds_read_b64_tr_b16 a[202:203], v57 offset:34816
    v_mfma_f32_16x16x32_bf16 v[64:67], a[196:199], v[132:135], v[64:67]
    ds_read_b64_tr_b16 a[204:205], v57 offset:36864
    v_mfma_f32_16x16x32_bf16 v[72:75], a[192:195], v[144:147], 0
    s_waitcnt lgkmcnt(1)
    ds_read_b64_tr_b16 a[206:207], v57 offset:38912
    v_mfma_f32_16x16x32_bf16 v[72:75], a[196:199], v[148:151], v[72:75]
    buffer_load_dwordx2 v[34:35], v45, s[32:35], s100 offen offset:32
    v_mfma_f32_16x16x32_bf16 v[68:71], a[200:203], v[128:131], 0
    s_waitcnt lgkmcnt(0)
    ds_read_b64_tr_b16 a[224:225], v56 offset:49152
    v_mfma_f32_16x16x32_bf16 v[68:71], a[204:207], v[132:135], v[68:71]
    ds_read_b64_tr_b16 a[226:227], v56 offset:51200
    v_mfma_f32_16x16x32_bf16 v[76:79], a[200:203], v[144:147], 0
    ds_read_b64_tr_b16 a[228:229], v56 offset:53248
    v_cvt_pk_bf16_f32 v112, v112, v113
    v_mfma_f32_16x16x32_bf16 v[76:79], a[204:207], v[148:151], v[76:79]
    buffer_load_dwordx2 v[36:37], v45, s[32:35], s101 offen
    v_mfma_f32_16x16x32_bf16 v[64:67], a[208:211], v[136:139], v[64:67]
    ds_read_b64_tr_b16 a[230:231], v56 offset:55296
    v_cvt_pk_bf16_f32 v113, v114, v115
    v_mfma_f32_16x16x32_bf16 v[64:67], a[212:215], v[140:143], v[64:67]
    ds_read_b64_tr_b16 a[232:233], v57 offset:49152
    v_cvt_pk_bf16_f32 v114, v116, v117
    v_mfma_f32_16x16x32_bf16 v[72:75], a[208:211], v[152:155], v[72:75]
    ds_read_b64_tr_b16 a[234:235], v57 offset:51200
    v_cvt_pk_bf16_f32 v115, v118, v119
    v_mfma_f32_16x16x32_bf16 v[72:75], a[212:215], v[156:159], v[72:75]
    buffer_load_dwordx2 v[38:39], v45, s[32:35], s101 offen offset:32
    ds_read_b64_tr_b16 a[236:237], v57 offset:53248
    v_mfma_f32_16x16x32_bf16 v[68:71], a[216:219], v[136:139], v[68:71]
    ds_read_b64_tr_b16 a[238:239], v57 offset:55296
    v_min_u32 v112, -2, v112
    v_mfma_f32_16x16x32_bf16 v[68:71], a[220:223], v[140:143], v[68:71]
    ds_read_b64_tr_b16 a[240:241], v56 offset:57344
    v_min_u32 v113, -2, v113
    v_mfma_f32_16x16x32_bf16 v[76:79], a[216:219], v[152:155], v[76:79]
    s_waitcnt vmcnt(30) lgkmcnt(7)
    ds_read_b64_tr_b16 a[242:243], v56 offset:59392
    v_min_u32 v114, -2, v114
    v_mfma_f32_16x16x32_bf16 v[76:79], a[220:223], v[156:159], v[76:79]
    buffer_load_dwordx2 v[40:41], v45, s[56:59], 0 offen
    v_mfma_f32_16x16x32_bf16 v[64:67], a[224:227], v[160:163], v[64:67]
    s_waitcnt vmcnt(28) lgkmcnt(6)
    ds_read_b64_tr_b16 a[244:245], v56 offset:61440
    v_min_u32 v115, -2, v115
    v_mfma_f32_16x16x32_bf16 v[64:67], a[228:231], v[164:167], v[64:67]
    s_waitcnt vmcnt(27) lgkmcnt(5)
    s_add_u32 s75, s18, 0
    ds_read_b64_tr_b16 a[246:247], v56 offset:63488
    v_mfma_f32_16x16x32_bf16 v[72:75], a[224:227], v[176:179], v[72:75]
    buffer_store_dwordx4 v[112:115], v23, s[8:11], s75 offen offset:768 sc0 sc1
    ds_read_b64_tr_b16 a[248:249], v57 offset:57344
    v_mfma_f32_16x16x32_bf16 v[72:75], a[228:231], v[180:183], v[72:75]
    buffer_load_dwordx2 v[42:43], v45, s[56:59], 0 offen offset:32
    ds_read_b64_tr_b16 a[250:251], v57 offset:59392
    v_mfma_f32_16x16x32_bf16 v[68:71], a[232:235], v[160:163], v[68:71]
    s_waitcnt lgkmcnt(6)
    ds_read_b64_tr_b16 a[252:253], v57 offset:61440
    v_cvt_pk_bf16_f32 v120, v120, v121
    v_mfma_f32_16x16x32_bf16 v[68:71], a[236:239], v[164:167], v[68:71]
    ds_read_b64_tr_b16 a[254:255], v57 offset:63488
    v_cvt_pk_bf16_f32 v121, v122, v123
    v_mfma_f32_16x16x32_bf16 v[76:79], a[232:235], v[176:179], v[76:79]
    ds_read_b64_tr_b16 a[192:193], v58 offset:32768
    v_cvt_pk_bf16_f32 v122, v124, v125
    v_mfma_f32_16x16x32_bf16 v[76:79], a[236:239], v[180:183], v[76:79]
    s_waitcnt vmcnt(28) lgkmcnt(7)
    ds_read_b64_tr_b16 a[194:195], v58 offset:34816
    v_cvt_pk_bf16_f32 v123, v126, v127
    v_mfma_f32_16x16x32_bf16 v[64:67], a[240:243], v[168:171], v[64:67]
    s_waitcnt vmcnt(26) lgkmcnt(6)
    ds_read_b64_tr_b16 a[196:197], v58 offset:36864
    v_min_u32 v120, -2, v120
    v_mfma_f32_16x16x32_bf16 v[64:67], a[244:247], v[172:175], v[64:67]
    ds_read_b64_tr_b16 a[198:199], v58 offset:38912
    v_min_u32 v121, -2, v121
    v_mfma_f32_16x16x32_bf16 v[72:75], a[240:243], v[184:187], v[72:75]
    s_waitcnt vmcnt(25)
    ds_read_b64_tr_b16 a[200:201], v59 offset:32768
    v_min_u32 v122, -2, v122
    v_mfma_f32_16x16x32_bf16 v[72:75], a[244:247], v[188:191], v[72:75]
    s_waitcnt lgkmcnt(7)
    ds_read_b64_tr_b16 a[202:203], v59 offset:34816
    v_min_u32 v123, -2, v123
    v_mfma_f32_16x16x32_bf16 v[68:71], a[248:251], v[168:171], v[68:71]
    s_waitcnt lgkmcnt(6)
    s_add_u32 s75, s18, 131072
    ds_read_b64_tr_b16 a[204:205], v59 offset:36864
    v_mfma_f32_16x16x32_bf16 v[68:71], a[252:255], v[172:175], v[68:71]
    buffer_store_dwordx4 v[120:123], v23, s[8:11], s75 offen offset:768 sc0 sc1
    ds_read_b64_tr_b16 a[206:207], v59 offset:38912
    v_mfma_f32_16x16x32_bf16 v[76:79], a[248:251], v[184:187], v[76:79]
    ds_read_b64_tr_b16 a[208:209], v58 offset:40960
    v_mfma_f32_16x16x32_bf16 v[76:79], a[252:255], v[188:191], v[76:79]
    s_waitcnt lgkmcnt(7)
    ds_read_b64_tr_b16 a[210:211], v58 offset:43008
    v_mfma_f32_16x16x32_bf16 v[80:83], a[192:195], v[128:131], 0
    s_waitcnt lgkmcnt(6)
    ds_read_b64_tr_b16 a[212:213], v58 offset:45056
    v_mfma_f32_16x16x32_bf16 v[80:83], a[196:199], v[132:135], v[80:83]
    ds_read_b64_tr_b16 a[214:215], v58 offset:47104
    v_mfma_f32_16x16x32_bf16 v[88:91], a[192:195], v[144:147], 0
    ds_read_b64_tr_b16 a[216:217], v59 offset:40960
    v_mfma_f32_16x16x32_bf16 v[88:91], a[196:199], v[148:151], v[88:91]
    s_waitcnt lgkmcnt(7)
    ds_read_b64_tr_b16 a[218:219], v59 offset:43008
    v_mfma_f32_16x16x32_bf16 v[84:87], a[200:203], v[128:131], 0
    s_waitcnt lgkmcnt(6)
    ds_read_b64_tr_b16 a[220:221], v59 offset:45056
    v_mfma_f32_16x16x32_bf16 v[84:87], a[204:207], v[132:135], v[84:87]
    ds_read_b64_tr_b16 a[222:223], v59 offset:47104
    v_mfma_f32_16x16x32_bf16 v[92:95], a[200:203], v[144:147], 0
    ds_read_b64_tr_b16 a[224:225], v58 offset:49152
    v_mfma_f32_16x16x32_bf16 v[92:95], a[204:207], v[148:151], v[92:95]
    s_waitcnt lgkmcnt(7)
    ds_read_b64_tr_b16 a[226:227], v58 offset:51200
    v_mfma_f32_16x16x32_bf16 v[80:83], a[208:211], v[136:139], v[80:83]
    s_waitcnt lgkmcnt(6)
    ds_read_b64_tr_b16 a[228:229], v58 offset:53248
    v_mfma_f32_16x16x32_bf16 v[80:83], a[212:215], v[140:143], v[80:83]
    ds_read_b64_tr_b16 a[230:231], v58 offset:55296
    v_mfma_f32_16x16x32_bf16 v[88:91], a[208:211], v[152:155], v[88:91]
    ds_read_b64_tr_b16 a[232:233], v59 offset:49152
    v_mfma_f32_16x16x32_bf16 v[88:91], a[212:215], v[156:159], v[88:91]
    s_waitcnt lgkmcnt(7)
    ds_read_b64_tr_b16 a[234:235], v59 offset:51200
    v_mfma_f32_16x16x32_bf16 v[84:87], a[216:219], v[136:139], v[84:87]
    s_waitcnt lgkmcnt(6)
    ds_read_b64_tr_b16 a[236:237], v59 offset:53248
    v_mfma_f32_16x16x32_bf16 v[84:87], a[220:223], v[140:143], v[84:87]
    ds_read_b64_tr_b16 a[238:239], v59 offset:55296
    v_mfma_f32_16x16x32_bf16 v[92:95], a[216:219], v[152:155], v[92:95]
    ds_read_b64_tr_b16 a[240:241], v58 offset:57344
    v_mfma_f32_16x16x32_bf16 v[92:95], a[220:223], v[156:159], v[92:95]
    s_waitcnt lgkmcnt(7)
    ds_read_b64_tr_b16 a[242:243], v58 offset:59392
    v_mfma_f32_16x16x32_bf16 v[80:83], a[224:227], v[160:163], v[80:83]
    s_waitcnt lgkmcnt(6)
    ds_read_b64_tr_b16 a[244:245], v58 offset:61440
    v_mfma_f32_16x16x32_bf16 v[80:83], a[228:231], v[164:167], v[80:83]
    ds_read_b64_tr_b16 a[246:247], v58 offset:63488
    v_mfma_f32_16x16x32_bf16 v[88:91], a[224:227], v[176:179], v[88:91]
    ds_read_b64_tr_b16 a[248:249], v59 offset:57344
    v_mfma_f32_16x16x32_bf16 v[88:91], a[228:231], v[180:183], v[88:91]
    s_waitcnt lgkmcnt(7)
    ds_read_b64_tr_b16 a[250:251], v59 offset:59392
    v_mfma_f32_16x16x32_bf16 v[84:87], a[232:235], v[160:163], v[84:87]
    s_waitcnt lgkmcnt(6)
    ds_read_b64_tr_b16 a[252:253], v59 offset:61440
    v_mfma_f32_16x16x32_bf16 v[84:87], a[236:239], v[164:167], v[84:87]
    ds_read_b64_tr_b16 a[254:255], v59 offset:63488
    v_mfma_f32_16x16x32_bf16 v[92:95], a[232:235], v[176:179], v[92:95]
    ds_read_b64_tr_b16 a[192:193], v56 offset:0
    v_mfma_f32_16x16x32_bf16 v[92:95], a[236:239], v[180:183], v[92:95]
    s_waitcnt lgkmcnt(7)
    ds_read_b64_tr_b16 a[194:195], v56 offset:2048
    v_mfma_f32_16x16x32_bf16 v[80:83], a[240:243], v[168:171], v[80:83]
    s_waitcnt lgkmcnt(6)
    ds_read_b64_tr_b16 a[196:197], v56 offset:4096
    v_mfma_f32_16x16x32_bf16 v[80:83], a[244:247], v[172:175], v[80:83]
    ds_read_b64_tr_b16 a[198:199], v56 offset:6144
    v_mfma_f32_16x16x32_bf16 v[88:91], a[240:243], v[184:187], v[88:91]
    ds_read_b64_tr_b16 a[200:201], v57 offset:0
    v_mfma_f32_16x16x32_bf16 v[88:91], a[244:247], v[188:191], v[88:91]
    s_waitcnt lgkmcnt(7)
    ds_read_b64_tr_b16 a[202:203], v57 offset:2048
    v_mfma_f32_16x16x32_bf16 v[84:87], a[248:251], v[168:171], v[84:87]
    s_waitcnt lgkmcnt(6)
    ds_read_b64_tr_b16 a[204:205], v57 offset:4096
    v_mfma_f32_16x16x32_bf16 v[84:87], a[252:255], v[172:175], v[84:87]
    ds_read_b64_tr_b16 a[206:207], v57 offset:6144
    v_mfma_f32_16x16x32_bf16 v[92:95], a[248:251], v[184:187], v[92:95]
    ds_read_b64_tr_b16 a[208:209], v56 offset:8192
    v_mfma_f32_16x16x32_bf16 v[92:95], a[252:255], v[188:191], v[92:95]
    s_waitcnt lgkmcnt(7)
    ds_read_b64_tr_b16 a[210:211], v56 offset:10240
    v_mfma_f32_16x16x32_bf16 v[96:99], a[192:195], v[128:131], 0
    s_waitcnt lgkmcnt(6)
    ds_read_b64_tr_b16 a[212:213], v56 offset:12288
    v_mfma_f32_16x16x32_bf16 v[96:99], a[196:199], v[132:135], v[96:99]
    ds_read_b64_tr_b16 a[214:215], v56 offset:14336
    v_mfma_f32_16x16x32_bf16 v[104:107], a[192:195], v[144:147], 0
    ds_read_b64_tr_b16 a[216:217], v57 offset:8192
    v_mfma_f32_16x16x32_bf16 v[104:107], a[196:199], v[148:151], v[104:107]
    s_waitcnt lgkmcnt(7)
    ds_read_b64_tr_b16 a[218:219], v57 offset:10240
    v_mfma_f32_16x16x32_bf16 v[100:103], a[200:203], v[128:131], 0
    s_waitcnt lgkmcnt(6)
    ds_read_b64_tr_b16 a[220:221], v57 offset:12288
    v_mfma_f32_16x16x32_bf16 v[100:103], a[204:207], v[132:135], v[100:103]
    ds_read_b64_tr_b16 a[222:223], v57 offset:14336
    v_mfma_f32_16x16x32_bf16 v[108:111], a[200:203], v[144:147], 0
    ds_read_b64_tr_b16 a[224:225], v56 offset:16384
    v_mfma_f32_16x16x32_bf16 v[108:111], a[204:207], v[148:151], v[108:111]
    s_waitcnt lgkmcnt(7)
    ds_read_b64_tr_b16 a[226:227], v56 offset:18432
    v_mfma_f32_16x16x32_bf16 v[96:99], a[208:211], v[136:139], v[96:99]
    s_waitcnt lgkmcnt(6)
    ds_read_b64_tr_b16 a[228:229], v56 offset:20480
    v_mfma_f32_16x16x32_bf16 v[96:99], a[212:215], v[140:143], v[96:99]
    ds_read_b64_tr_b16 a[230:231], v56 offset:22528
    v_mfma_f32_16x16x32_bf16 v[104:107], a[208:211], v[152:155], v[104:107]
    ds_read_b64_tr_b16 a[232:233], v57 offset:16384
    v_mfma_f32_16x16x32_bf16 v[104:107], a[212:215], v[156:159], v[104:107]
    s_waitcnt lgkmcnt(7)
    ds_read_b64_tr_b16 a[234:235], v57 offset:18432
    v_mfma_f32_16x16x32_bf16 v[100:103], a[216:219], v[136:139], v[100:103]
    s_waitcnt lgkmcnt(6)
    ds_read_b64_tr_b16 a[236:237], v57 offset:20480
    v_mfma_f32_16x16x32_bf16 v[100:103], a[220:223], v[140:143], v[100:103]
    ds_read_b64_tr_b16 a[238:239], v57 offset:22528
    v_mfma_f32_16x16x32_bf16 v[108:111], a[216:219], v[152:155], v[108:111]
    ds_read_b64_tr_b16 a[240:241], v56 offset:24576
    v_mfma_f32_16x16x32_bf16 v[108:111], a[220:223], v[156:159], v[108:111]
    s_waitcnt lgkmcnt(7)
    ds_read_b64_tr_b16 a[242:243], v56 offset:26624
    v_mfma_f32_16x16x32_bf16 v[96:99], a[224:227], v[160:163], v[96:99]
    s_waitcnt lgkmcnt(6)
    ds_read_b64_tr_b16 a[244:245], v56 offset:28672
    v_mfma_f32_16x16x32_bf16 v[96:99], a[228:231], v[164:167], v[96:99]
    ds_read_b64_tr_b16 a[246:247], v56 offset:30720
    v_mfma_f32_16x16x32_bf16 v[104:107], a[224:227], v[176:179], v[104:107]
    ds_read_b64_tr_b16 a[248:249], v57 offset:24576
    v_mfma_f32_16x16x32_bf16 v[104:107], a[228:231], v[180:183], v[104:107]
    s_waitcnt lgkmcnt(7)
    ds_read_b64_tr_b16 a[250:251], v57 offset:26624
    v_mfma_f32_16x16x32_bf16 v[100:103], a[232:235], v[160:163], v[100:103]
    s_waitcnt lgkmcnt(6)
    ds_read_b64_tr_b16 a[252:253], v57 offset:28672
    v_mfma_f32_16x16x32_bf16 v[100:103], a[236:239], v[164:167], v[100:103]
    ds_read_b64_tr_b16 a[254:255], v57 offset:30720
    v_mfma_f32_16x16x32_bf16 v[108:111], a[232:235], v[176:179], v[108:111]
    ds_read_b64_tr_b16 a[192:193], v58 offset:0
    v_mfma_f32_16x16x32_bf16 v[108:111], a[236:239], v[180:183], v[108:111]
    s_waitcnt lgkmcnt(7)
    ds_read_b64_tr_b16 a[194:195], v58 offset:2048
    v_mfma_f32_16x16x32_bf16 v[96:99], a[240:243], v[168:171], v[96:99]
    s_waitcnt lgkmcnt(6)
    ds_read_b64_tr_b16 a[196:197], v58 offset:4096
    v_mfma_f32_16x16x32_bf16 v[96:99], a[244:247], v[172:175], v[96:99]
    ds_read_b64_tr_b16 a[198:199], v58 offset:6144
    v_mfma_f32_16x16x32_bf16 v[104:107], a[240:243], v[184:187], v[104:107]
    ds_read_b64_tr_b16 a[200:201], v59 offset:0
    v_mfma_f32_16x16x32_bf16 v[104:107], a[244:247], v[188:191], v[104:107]
    s_waitcnt lgkmcnt(7)
    ds_read_b64_tr_b16 a[202:203], v59 offset:2048
    v_mfma_f32_16x16x32_bf16 v[100:103], a[248:251], v[168:171], v[100:103]
    s_waitcnt lgkmcnt(6)
    ds_read_b64_tr_b16 a[204:205], v59 offset:4096
    v_mfma_f32_16x16x32_bf16 v[100:103], a[252:255], v[172:175], v[100:103]
    ds_read_b64_tr_b16 a[206:207], v59 offset:6144
    v_mfma_f32_16x16x32_bf16 v[108:111], a[248:251], v[184:187], v[108:111]
    ds_read_b64_tr_b16 a[208:209], v58 offset:8192
    v_mfma_f32_16x16x32_bf16 v[108:111], a[252:255], v[188:191], v[108:111]
    s_waitcnt lgkmcnt(7)
    ds_read_b64_tr_b16 a[210:211], v58 offset:10240
    v_mfma_f32_16x16x32_bf16 v[112:115], a[192:195], v[128:131], 0
    s_waitcnt lgkmcnt(6)
    ds_read_b64_tr_b16 a[212:213], v58 offset:12288
    v_mfma_f32_16x16x32_bf16 v[112:115], a[196:199], v[132:135], v[112:115]
    ds_read_b64_tr_b16 a[214:215], v58 offset:14336
    v_mfma_f32_16x16x32_bf16 v[120:123], a[192:195], v[144:147], 0
    ds_read_b64_tr_b16 a[216:217], v59 offset:8192
    v_mfma_f32_16x16x32_bf16 v[120:123], a[196:199], v[148:151], v[120:123]
    s_waitcnt lgkmcnt(7)
    ds_read_b64_tr_b16 a[218:219], v59 offset:10240
    v_mfma_f32_16x16x32_bf16 v[116:119], a[200:203], v[128:131], 0
    s_waitcnt lgkmcnt(6)
    ds_read_b64_tr_b16 a[220:221], v59 offset:12288
    v_mfma_f32_16x16x32_bf16 v[116:119], a[204:207], v[132:135], v[116:119]
    ds_read_b64_tr_b16 a[222:223], v59 offset:14336
    v_mfma_f32_16x16x32_bf16 v[124:127], a[200:203], v[144:147], 0
    ds_read_b64_tr_b16 a[224:225], v58 offset:16384
    v_mfma_f32_16x16x32_bf16 v[124:127], a[204:207], v[148:151], v[124:127]
    s_waitcnt lgkmcnt(7)
    ds_read_b64_tr_b16 a[226:227], v58 offset:18432
    v_mfma_f32_16x16x32_bf16 v[112:115], a[208:211], v[136:139], v[112:115]
    s_waitcnt lgkmcnt(6)
    ds_read_b64_tr_b16 a[228:229], v58 offset:20480
    v_mfma_f32_16x16x32_bf16 v[112:115], a[212:215], v[140:143], v[112:115]
    ds_read_b64_tr_b16 a[230:231], v58 offset:22528
    v_mfma_f32_16x16x32_bf16 v[120:123], a[208:211], v[152:155], v[120:123]
    ds_read_b64_tr_b16 a[232:233], v59 offset:16384
    v_mfma_f32_16x16x32_bf16 v[120:123], a[212:215], v[156:159], v[120:123]
    s_waitcnt lgkmcnt(7)
    ds_read_b64_tr_b16 a[234:235], v59 offset:18432
    v_mfma_f32_16x16x32_bf16 v[116:119], a[216:219], v[136:139], v[116:119]
    s_waitcnt lgkmcnt(6)
    ds_read_b64_tr_b16 a[236:237], v59 offset:20480
    v_mfma_f32_16x16x32_bf16 v[116:119], a[220:223], v[140:143], v[116:119]
    ds_read_b64_tr_b16 a[238:239], v59 offset:22528
    v_mfma_f32_16x16x32_bf16 v[124:127], a[216:219], v[152:155], v[124:127]
    ds_read_b64_tr_b16 a[240:241], v58 offset:24576
    v_mfma_f32_16x16x32_bf16 v[124:127], a[220:223], v[156:159], v[124:127]
    s_waitcnt lgkmcnt(7)
    ds_read_b64_tr_b16 a[242:243], v58 offset:26624
    v_mfma_f32_16x16x32_bf16 v[112:115], a[224:227], v[160:163], v[112:115]
    s_waitcnt lgkmcnt(6)
    ds_read_b64_tr_b16 a[244:245], v58 offset:28672
    v_mfma_f32_16x16x32_bf16 v[112:115], a[228:231], v[164:167], v[112:115]
    ds_read_b64_tr_b16 a[246:247], v58 offset:30720
    v_mfma_f32_16x16x32_bf16 v[120:123], a[224:227], v[176:179], v[120:123]
    ds_read_b64_tr_b16 a[248:249], v59 offset:24576
    v_mfma_f32_16x16x32_bf16 v[120:123], a[228:231], v[180:183], v[120:123]
    s_waitcnt lgkmcnt(7)
    ds_read_b64_tr_b16 a[250:251], v59 offset:26624
    v_mfma_f32_16x16x32_bf16 v[116:119], a[232:235], v[160:163], v[116:119]
    s_waitcnt lgkmcnt(6)
    ds_read_b64_tr_b16 a[252:253], v59 offset:28672
    v_mfma_f32_16x16x32_bf16 v[116:119], a[236:239], v[164:167], v[116:119]
    ds_read_b64_tr_b16 a[254:255], v59 offset:30720
    v_mfma_f32_16x16x32_bf16 v[124:127], a[232:235], v[176:179], v[124:127]
    ds_read_b64_tr_b16 a[192:193], v60 offset:0
    v_mfma_f32_16x16x32_bf16 v[124:127], a[236:239], v[180:183], v[124:127]
    s_waitcnt lgkmcnt(7)
    ds_read_b64_tr_b16 a[194:195], v60 offset:2048
    v_mfma_f32_16x16x32_bf16 v[112:115], a[240:243], v[168:171], v[112:115]
    s_waitcnt lgkmcnt(6)
    ds_read_b64_tr_b16 a[196:197], v60 offset:4096
    v_mfma_f32_16x16x32_bf16 v[112:115], a[244:247], v[172:175], v[112:115]
    ds_read_b64_tr_b16 a[198:199], v60 offset:6144
    v_mfma_f32_16x16x32_bf16 v[120:123], a[240:243], v[184:187], v[120:123]
    ds_read_b64_tr_b16 a[200:201], v61 offset:0
    v_mfma_f32_16x16x32_bf16 v[120:123], a[244:247], v[188:191], v[120:123]
    s_waitcnt lgkmcnt(7)
    ds_read_b64_tr_b16 a[202:203], v61 offset:2048
    v_mfma_f32_16x16x32_bf16 v[116:119], a[248:251], v[168:171], v[116:119]
    s_waitcnt lgkmcnt(6)
    ds_read_b64_tr_b16 a[204:205], v61 offset:4096
    v_mfma_f32_16x16x32_bf16 v[116:119], a[252:255], v[172:175], v[116:119]
    ds_read_b64_tr_b16 a[206:207], v61 offset:6144
    v_mfma_f32_16x16x32_bf16 v[124:127], a[248:251], v[184:187], v[124:127]
    ds_read_b64_tr_b16 a[208:209], v60 offset:8192
    v_mfma_f32_16x16x32_bf16 v[124:127], a[252:255], v[188:191], v[124:127]
    s_waitcnt vmcnt(25) lgkmcnt(7)
    ds_read_b64_tr_b16 a[210:211], v60 offset:10240
    v_mfma_f32_16x16x32_bf16 v[64:67], a[192:195], v[192:195], v[64:67]
    s_waitcnt vmcnt(23) lgkmcnt(6)
    ds_read_b64_tr_b16 a[212:213], v60 offset:12288
    v_mfma_f32_16x16x32_bf16 v[64:67], a[196:199], v[196:199], v[64:67]
    ds_read_b64_tr_b16 a[214:215], v60 offset:14336
    v_mfma_f32_16x16x32_bf16 v[72:75], a[192:195], v[208:211], v[72:75]
    s_waitcnt vmcnt(22) lgkmcnt(6)
    s_mov_b32 s74, 4096
    ds_read_b64_tr_b16 a[216:217], v61 offset:8192
    v_mfma_f32_16x16x32_bf16 v[72:75], a[196:199], v[212:215], v[72:75]
    buffer_load_dwordx4 v[160:163], v46, s[8:11], s74 offen
    ds_read_b64_tr_b16 a[218:219], v61 offset:10240
    v_mfma_f32_16x16x32_bf16 v[68:71], a[200:203], v[192:195], v[68:71]
    s_waitcnt lgkmcnt(6)
    ds_read_b64_tr_b16 a[220:221], v61 offset:12288
    v_mfma_f32_16x16x32_bf16 v[68:71], a[204:207], v[196:199], v[68:71]
    ds_read_b64_tr_b16 a[222:223], v61 offset:14336
    v_mfma_f32_16x16x32_bf16 v[76:79], a[200:203], v[208:211], v[76:79]
    buffer_load_dwordx4 v[164:167], v46, s[8:11], s74 offen offset:64
    v_mfma_f32_16x16x32_bf16 v[76:79], a[204:207], v[212:215], v[76:79]
    s_waitcnt vmcnt(23) lgkmcnt(6)
    s_mov_b32 s74, 8192
    ds_read_b64_tr_b16 a[224:225], v60 offset:16384
    v_mfma_f32_16x16x32_bf16 v[64:67], a[208:211], v[200:203], v[64:67]
    s_waitcnt vmcnt(20) lgkmcnt(5)
    ds_read_b64_tr_b16 a[226:227], v60 offset:18432
    v_mfma_f32_16x16x32_bf16 v[64:67], a[212:215], v[204:207], v[64:67]
    buffer_load_dwordx4 v[168:171], v46, s[8:11], s74 offen
    v_mfma_f32_16x16x32_bf16 v[72:75], a[208:211], v[216:219], v[72:75]
    s_waitcnt vmcnt(20)
    ds_read_b64_tr_b16 a[228:229], v60 offset:20480
    v_mfma_f32_16x16x32_bf16 v[72:75], a[212:215], v[220:223], v[72:75]
    s_waitcnt lgkmcnt(3)
    ds_read_b64_tr_b16 a[230:231], v60 offset:22528
    v_mfma_f32_16x16x32_bf16 v[68:71], a[216:219], v[200:203], v[68:71]
    buffer_load_dwordx4 v[172:175], v46, s[8:11], s74 offen offset:64
    ds_read_b64_tr_b16 a[232:233], v61 offset:16384
    v_mfma_f32_16x16x32_bf16 v[68:71], a[220:223], v[204:207], v[68:71]
    s_mov_b32 s74, 6144
    ds_read_b64_tr_b16 a[234:235], v61 offset:18432
    v_mfma_f32_16x16x32_bf16 v[76:79], a[216:219], v[216:219], v[76:79]
    s_waitcnt vmcnt(19) lgkmcnt(4)
    ds_read_b64_tr_b16 a[236:237], v61 offset:20480
    v_mfma_f32_16x16x32_bf16 v[76:79], a[220:223], v[220:223], v[76:79]
    buffer_load_dwordx4 v[176:179], v46, s[8:11], s74 offen
    ds_read_b64_tr_b16 a[238:239], v61 offset:22528
    v_mfma_f32_16x16x32_bf16 v[64:67], a[224:227], v[224:227], v[64:67]
    s_waitcnt vmcnt(18) lgkmcnt(4)
    ds_read_b64_tr_b16 a[240:241], v60 offset:24576
    v_mfma_f32_16x16x32_bf16 v[64:67], a[228:231], v[228:231], v[64:67]
    s_waitcnt vmcnt(17)
    ds_read_b64_tr_b16 a[242:243], v60 offset:26624
    v_mfma_f32_16x16x32_bf16 v[72:75], a[224:227], v[240:243], v[72:75]
    buffer_load_dwordx4 v[180:183], v46, s[8:11], s74 offen offset:64
    v_mfma_f32_16x16x32_bf16 v[72:75], a[228:231], v[244:247], v[72:75]
    s_waitcnt lgkmcnt(4)
    s_mov_b32 s74, 10240
    ds_read_b64_tr_b16 a[244:245], v60 offset:28672
    v_mfma_f32_16x16x32_bf16 v[68:71], a[232:235], v[224:227], v[68:71]
    s_waitcnt lgkmcnt(3)
    ds_read_b64_tr_b16 a[246:247], v60 offset:30720
    v_mfma_f32_16x16x32_bf16 v[68:71], a[236:239], v[228:231], v[68:71]
    buffer_load_dwordx4 v[184:187], v46, s[8:11], s74 offen
    ds_read_b64_tr_b16 a[248:249], v61 offset:24576
    v_mfma_f32_16x16x32_bf16 v[76:79], a[232:235], v[240:243], v[76:79]
    ds_read_b64_tr_b16 a[250:251], v61 offset:26624
    v_mfma_f32_16x16x32_bf16 v[76:79], a[236:239], v[244:247], v[76:79]
    s_waitcnt vmcnt(16) lgkmcnt(2)
    ds_read_b64_tr_b16 a[252:253], v61 offset:28672
    v_mfma_f32_16x16x32_bf16 v[64:67], a[240:243], v[232:235], v[64:67]
    buffer_load_dwordx4 v[188:191], v46, s[8:11], s74 offen offset:64
    ds_read_b64_tr_b16 a[254:255], v61 offset:30720
    v_mfma_f32_16x16x32_bf16 v[64:67], a[244:247], v[236:239], v[64:67]
    ds_read_b64_tr_b16 a[192:193], v62 offset:0
    v_mfma_f32_16x16x32_bf16 v[72:75], a[240:243], v[248:251], v[72:75]
    s_waitcnt vmcnt(16)
    ds_read_b64_tr_b16 a[194:195], v62 offset:2048
    v_mfma_f32_16x16x32_bf16 v[72:75], a[244:247], v[252:255], v[72:75]
    s_waitcnt lgkmcnt(4)
    ds_read_b64_tr_b16 a[196:197], v62 offset:4096
    v_mfma_f32_16x16x32_bf16 v[68:71], a[248:251], v[232:235], v[68:71]
    s_waitcnt lgkmcnt(3)
    ds_read_b64_tr_b16 a[198:199], v62 offset:6144
    v_mfma_f32_16x16x32_bf16 v[68:71], a[252:255], v[236:239], v[68:71]
    ds_read_b64_tr_b16 a[200:201], v63 offset:0
    v_mfma_f32_16x16x32_bf16 v[76:79], a[248:251], v[248:251], v[76:79]
    ds_read_b64_tr_b16 a[202:203], v63 offset:2048
    v_mfma_f32_16x16x32_bf16 v[76:79], a[252:255], v[252:255], v[76:79]
    s_waitcnt lgkmcnt(4)
    ds_read_b64_tr_b16 a[204:205], v63 offset:4096
    v_mfma_f32_16x16x32_bf16 v[80:83], a[192:195], v[192:195], v[80:83]
    s_waitcnt lgkmcnt(3)
    ds_read_b64_tr_b16 a[206:207], v63 offset:6144
    v_mfma_f32_16x16x32_bf16 v[80:83], a[196:199], v[196:199], v[80:83]
    ds_read_b64_tr_b16 a[208:209], v62 offset:8192
    v_mfma_f32_16x16x32_bf16 v[88:91], a[192:195], v[208:211], v[88:91]
    ds_read_b64_tr_b16 a[210:211], v62 offset:10240
    v_mfma_f32_16x16x32_bf16 v[88:91], a[196:199], v[212:215], v[88:91]
    s_waitcnt lgkmcnt(4)
    ds_read_b64_tr_b16 a[212:213], v62 offset:12288
    v_mfma_f32_16x16x32_bf16 v[84:87], a[200:203], v[192:195], v[84:87]
    s_waitcnt lgkmcnt(3)
    ds_read_b64_tr_b16 a[214:215], v62 offset:14336
    v_mfma_f32_16x16x32_bf16 v[84:87], a[204:207], v[196:199], v[84:87]
    ds_read_b64_tr_b16 a[216:217], v63 offset:8192
    v_mfma_f32_16x16x32_bf16 v[92:95], a[200:203], v[208:211], v[92:95]
    ds_read_b64_tr_b16 a[218:219], v63 offset:10240
    v_cvt_pk_bf16_f32 v64, v64, v65
    v_mfma_f32_16x16x32_bf16 v[92:95], a[204:207], v[212:215], v[92:95]
    s_waitcnt lgkmcnt(4)
    ds_read_b64_tr_b16 a[220:221], v63 offset:12288
    v_cvt_pk_bf16_f32 v65, v66, v67
    v_mfma_f32_16x16x32_bf16 v[80:83], a[208:211], v[200:203], v[80:83]
    s_waitcnt lgkmcnt(3)
    ds_read_b64_tr_b16 a[222:223], v63 offset:14336
    v_cvt_pk_bf16_f32 v66, v68, v69
    v_mfma_f32_16x16x32_bf16 v[80:83], a[212:215], v[204:207], v[80:83]
    ds_read_b64_tr_b16 a[224:225], v62 offset:16384
    v_cvt_pk_bf16_f32 v67, v70, v71
    v_mfma_f32_16x16x32_bf16 v[88:91], a[208:211], v[216:219], v[88:91]
    ds_read_b64_tr_b16 a[226:227], v62 offset:18432
    v_min_u32 v64, -2, v64
    v_mfma_f32_16x16x32_bf16 v[88:91], a[212:215], v[220:223], v[88:91]
    s_waitcnt lgkmcnt(4)
    ds_read_b64_tr_b16 a[228:229], v62 offset:20480
    v_min_u32 v65, -2, v65
    v_mfma_f32_16x16x32_bf16 v[84:87], a[216:219], v[200:203], v[84:87]
    s_waitcnt lgkmcnt(3)
    ds_read_b64_tr_b16 a[230:231], v62 offset:22528
    v_min_u32 v66, -2, v66
    v_mfma_f32_16x16x32_bf16 v[84:87], a[220:223], v[204:207], v[84:87]
    ds_read_b64_tr_b16 a[232:233], v63 offset:16384
    v_min_u32 v67, -2, v67
    v_mfma_f32_16x16x32_bf16 v[92:95], a[216:219], v[216:219], v[92:95]
    s_waitcnt lgkmcnt(3)
    s_add_u32 s75, s18, 8388608
    ds_read_b64_tr_b16 a[234:235], v63 offset:18432
    v_mfma_f32_16x16x32_bf16 v[92:95], a[220:223], v[220:223], v[92:95]
    buffer_store_dwordx4 v[64:67], v23, s[8:11], s75 offen offset:0 sc0 sc1
    ds_read_b64_tr_b16 a[236:237], v63 offset:20480
    v_mfma_f32_16x16x32_bf16 v[80:83], a[224:227], v[224:227], v[80:83]
    s_waitcnt lgkmcnt(3)
    ds_read_b64_tr_b16 a[238:239], v63 offset:22528
    v_cvt_pk_bf16_f32 v72, v72, v73
    v_mfma_f32_16x16x32_bf16 v[80:83], a[228:231], v[228:231], v[80:83]
    ds_read_b64_tr_b16 a[240:241], v62 offset:24576
    v_cvt_pk_bf16_f32 v73, v74, v75
    v_mfma_f32_16x16x32_bf16 v[88:91], a[224:227], v[240:243], v[88:91]
    ds_read_b64_tr_b16 a[242:243], v62 offset:26624
    v_cvt_pk_bf16_f32 v74, v76, v77
    v_mfma_f32_16x16x32_bf16 v[88:91], a[228:231], v[244:247], v[88:91]
    s_waitcnt lgkmcnt(4)
    ds_read_b64_tr_b16 a[244:245], v62 offset:28672
    v_cvt_pk_bf16_f32 v75, v78, v79
    v_mfma_f32_16x16x32_bf16 v[84:87], a[232:235], v[224:227], v[84:87]
    s_waitcnt lgkmcnt(3)
    ds_read_b64_tr_b16 a[246:247], v62 offset:30720
    v_min_u32 v72, -2, v72
    v_mfma_f32_16x16x32_bf16 v[84:87], a[236:239], v[228:231], v[84:87]
    ds_read_b64_tr_b16 a[248:249], v63 offset:24576
    v_min_u32 v73, -2, v73
    v_mfma_f32_16x16x32_bf16 v[92:95], a[232:235], v[240:243], v[92:95]
    ds_read_b64_tr_b16 a[250:251], v63 offset:26624
    v_min_u32 v74, -2, v74
    v_mfma_f32_16x16x32_bf16 v[92:95], a[236:239], v[244:247], v[92:95]
    s_waitcnt lgkmcnt(4)
    ds_read_b64_tr_b16 a[252:253], v63 offset:28672
    v_min_u32 v75, -2, v75
    v_mfma_f32_16x16x32_bf16 v[80:83], a[240:243], v[232:235], v[80:83]
    s_waitcnt lgkmcnt(3)
    s_add_u32 s75, s18, 8519680
    ds_read_b64_tr_b16 a[254:255], v63 offset:30720
    v_mfma_f32_16x16x32_bf16 v[80:83], a[244:247], v[236:239], v[80:83]
    buffer_store_dwordx4 v[72:75], v23, s[8:11], s75 offen offset:0 sc0 sc1
    v_mfma_f32_16x16x32_bf16 v[88:91], a[240:243], v[248:251], v[88:91]
    ds_read_b64_tr_b16 a[192:193], v60 offset:32768
    v_mfma_f32_16x16x32_bf16 v[88:91], a[244:247], v[252:255], v[88:91]
    s_waitcnt lgkmcnt(3)
    ds_read_b64_tr_b16 a[194:195], v60 offset:34816
    v_mfma_f32_16x16x32_bf16 v[84:87], a[248:251], v[232:235], v[84:87]
    s_waitcnt lgkmcnt(2)
    ds_read_b64_tr_b16 a[196:197], v60 offset:36864
    s_waitcnt vmcnt(13)
    v_lshlrev_b32 v48, 16, v40
    v_mfma_f32_16x16x32_bf16 v[84:87], a[252:255], v[236:239], v[84:87]
    ds_read_b64_tr_b16 a[198:199], v60 offset:38912
    v_and_b32 v49, 0xffff0000, v40
    v_mfma_f32_16x16x32_bf16 v[92:95], a[248:251], v[248:251], v[92:95]
    ds_read_b64_tr_b16 a[200:201], v61 offset:32768
    v_lshlrev_b32 v50, 16, v41
    v_mfma_f32_16x16x32_bf16 v[92:95], a[252:255], v[252:255], v[92:95]
    s_waitcnt lgkmcnt(3)
    ds_read_b64_tr_b16 a[202:203], v61 offset:34816
    v_and_b32 v51, 0xffff0000, v41
    v_mfma_f32_16x16x32_bf16 v[96:99], a[192:195], v[192:195], v[96:99]
    s_waitcnt lgkmcnt(2)
    ds_read_b64_tr_b16 a[204:205], v61 offset:36864
    s_waitcnt vmcnt(11)
    v_lshlrev_b32 v52, 16, v42
    v_mfma_f32_16x16x32_bf16 v[96:99], a[196:199], v[196:199], v[96:99]
    ds_read_b64_tr_b16 a[206:207], v61 offset:38912
    v_and_b32 v53, 0xffff0000, v42
    v_mfma_f32_16x16x32_bf16 v[104:107], a[192:195], v[208:211], v[104:107]
    ds_read_b64_tr_b16 a[208:209], v60 offset:40960
    v_lshlrev_b32 v54, 16, v43
    v_mfma_f32_16x16x32_bf16 v[104:107], a[196:199], v[212:215], v[104:107]
    s_waitcnt lgkmcnt(3)
    ds_read_b64_tr_b16 a[210:211], v60 offset:43008
    v_and_b32 v55, 0xffff0000, v43
    v_mfma_f32_16x16x32_bf16 v[100:103], a[200:203], v[192:195], v[100:103]
    s_waitcnt lgkmcnt(2)
    ds_read_b64_tr_b16 a[212:213], v60 offset:45056
    s_waitcnt vmcnt(7)
    v_mul_f32 v8, v48, v168
    v_mfma_f32_16x16x32_bf16 v[100:103], a[204:207], v[196:199], v[100:103]
    ds_read_b64_tr_b16 a[214:215], v60 offset:47104
    v_mul_f32 v9, v49, v169
    v_mfma_f32_16x16x32_bf16 v[108:111], a[200:203], v[208:211], v[108:111]
    ds_read_b64_tr_b16 a[216:217], v61 offset:40960
    v_cvt_pk_bf16_f32 v80, v80, v81
    v_mfma_f32_16x16x32_bf16 v[108:111], a[204:207], v[212:215], v[108:111]
    s_waitcnt lgkmcnt(3)
    ds_read_b64_tr_b16 a[218:219], v61 offset:43008
    v_cvt_pk_bf16_f32 v81, v82, v83
    v_mfma_f32_16x16x32_bf16 v[96:99], a[208:211], v[200:203], v[96:99]
    s_waitcnt lgkmcnt(2)
    ds_read_b64_tr_b16 a[220:221], v61 offset:45056
    v_cvt_pk_bf16_f32 v82, v84, v85
    v_mfma_f32_16x16x32_bf16 v[96:99], a[212:215], v[204:207], v[96:99]
    ds_read_b64_tr_b16 a[222:223], v61 offset:47104
    v_cvt_pk_bf16_f32 v83, v86, v87
    v_mfma_f32_16x16x32_bf16 v[104:107], a[208:211], v[216:219], v[104:107]
    ds_read_b64_tr_b16 a[224:225], v60 offset:49152
    v_min_u32 v80, -2, v80
    v_mfma_f32_16x16x32_bf16 v[104:107], a[212:215], v[220:223], v[104:107]
    s_waitcnt lgkmcnt(3)
    ds_read_b64_tr_b16 a[226:227], v60 offset:51200
    v_min_u32 v81, -2, v81
    v_mfma_f32_16x16x32_bf16 v[100:103], a[216:219], v[200:203], v[100:103]
    s_waitcnt lgkmcnt(2)
    ds_read_b64_tr_b16 a[228:229], v60 offset:53248
    v_min_u32 v82, -2, v82
    v_mfma_f32_16x16x32_bf16 v[100:103], a[220:223], v[204:207], v[100:103]
    ds_read_b64_tr_b16 a[230:231], v60 offset:55296
    v_min_u32 v83, -2, v83
    v_mfma_f32_16x16x32_bf16 v[108:111], a[216:219], v[216:219], v[108:111]
    s_waitcnt lgkmcnt(2)
    s_add_u32 s75, s18, 8388608
    ds_read_b64_tr_b16 a[232:233], v61 offset:49152
    v_mul_f32 v10, v50, v170
    v_mfma_f32_16x16x32_bf16 v[108:111], a[220:223], v[220:223], v[108:111]
    buffer_store_dwordx4 v[80:83], v23, s[8:11], s75 offen offset:256 sc0 sc1
    ds_read_b64_tr_b16 a[234:235], v61 offset:51200
    v_mfma_f32_16x16x32_bf16 v[96:99], a[224:227], v[224:227], v[96:99]
    s_waitcnt lgkmcnt(2)
    ds_read_b64_tr_b16 a[236:237], v61 offset:53248
    v_cvt_pk_bf16_f32 v88, v88, v89
    v_mfma_f32_16x16x32_bf16 v[96:99], a[228:231], v[228:231], v[96:99]
    ds_read_b64_tr_b16 a[238:239], v61 offset:55296
    v_cvt_pk_bf16_f32 v89, v90, v91
    v_mfma_f32_16x16x32_bf16 v[104:107], a[224:227], v[240:243], v[104:107]
    ds_read_b64_tr_b16 a[240:241], v60 offset:57344
    v_cvt_pk_bf16_f32 v90, v92, v93
    v_mfma_f32_16x16x32_bf16 v[104:107], a[228:231], v[244:247], v[104:107]
    s_waitcnt lgkmcnt(3)
    ds_read_b64_tr_b16 a[242:243], v60 offset:59392
    v_cvt_pk_bf16_f32 v91, v94, v95
    v_mfma_f32_16x16x32_bf16 v[100:103], a[232:235], v[224:227], v[100:103]
    s_waitcnt lgkmcnt(2)
    ds_read_b64_tr_b16 a[244:245], v60 offset:61440
    v_min_u32 v88, -2, v88
    v_mfma_f32_16x16x32_bf16 v[100:103], a[236:239], v[228:231], v[100:103]
    ds_read_b64_tr_b16 a[246:247], v60 offset:63488
    v_min_u32 v89, -2, v89
    v_mfma_f32_16x16x32_bf16 v[108:111], a[232:235], v[240:243], v[108:111]
    ds_read_b64_tr_b16 a[248:249], v61 offset:57344
    v_min_u32 v90, -2, v90
    v_mfma_f32_16x16x32_bf16 v[108:111], a[236:239], v[244:247], v[108:111]
    s_waitcnt lgkmcnt(3)
    ds_read_b64_tr_b16 a[250:251], v61 offset:59392
    v_mul_f32 v11, v51, v171
    v_mfma_f32_16x16x32_bf16 v[96:99], a[240:243], v[232:235], v[96:99]
    s_waitcnt lgkmcnt(2)
    s_add_u32 s74, s70, 0
    ds_read_b64_tr_b16 a[252:253], v61 offset:61440
    v_min_u32 v91, -2, v91
    v_mfma_f32_16x16x32_bf16 v[96:99], a[244:247], v[236:239], v[96:99]
    buffer_load_dwordx4 v[128:131], v44, s[8:11], s74 offen sc0 sc1
    ds_read_b64_tr_b16 a[254:255], v61 offset:63488
    v_mfma_f32_16x16x32_bf16 v[104:107], a[240:243], v[248:251], v[104:107]
    s_add_u32 s74, s70, 4096
    ds_read_b64_tr_b16 a[192:193], v62 offset:32768
    s_waitcnt vmcnt(8)
    v_mul_f32 v12, v52, v172
    v_mfma_f32_16x16x32_bf16 v[104:107], a[244:247], v[252:255], v[104:107]
    s_waitcnt lgkmcnt(1)
    s_add_u32 s75, s18, 8519680
    ds_read_b64_tr_b16 a[194:195], v62 offset:34816
    v_mul_f32 v13, v53, v173
    v_mfma_f32_16x16x32_bf16 v[100:103], a[248:251], v[232:235], v[100:103]
    buffer_store_dwordx4 v[88:91], v23, s[8:11], s75 offen offset:256 sc0 sc1
    ds_read_b64_tr_b16 a[196:197], v62 offset:36864
    v_mfma_f32_16x16x32_bf16 v[100:103], a[252:255], v[236:239], v[100:103]
    buffer_load_dwordx4 v[132:135], v44, s[8:11], s74 offen sc0 sc1
    ds_read_b64_tr_b16 a[198:199], v62 offset:38912
    v_mfma_f32_16x16x32_bf16 v[108:111], a[248:251], v[248:251], v[108:111]
    s_add_u32 s74, s70, 8192
    ds_read_b64_tr_b16 a[200:201], v63 offset:32768
    v_mul_f32 v14, v54, v174
    v_mfma_f32_16x16x32_bf16 v[108:111], a[252:255], v[252:255], v[108:111]
    s_waitcnt lgkmcnt(3)
    ds_read_b64_tr_b16 a[202:203], v63 offset:34816
    v_mul_f32 v15, v55, v175
    v_mfma_f32_16x16x32_bf16 v[112:115], a[192:195], v[192:195], v[112:115]
    s_waitcnt lgkmcnt(2)
    ds_read_b64_tr_b16 a[204:205], v63 offset:36864
    s_waitcnt vmcnt(9)
    v_mul_f32 v16, v48, v176
    v_mfma_f32_16x16x32_bf16 v[112:115], a[196:199], v[196:199], v[112:115]
    buffer_load_dwordx4 v[136:139], v44, s[8:11], s74 offen sc0 sc1
    ds_read_b64_tr_b16 a[206:207], v63 offset:38912
    v_mfma_f32_16x16x32_bf16 v[120:123], a[192:195], v[208:211], v[120:123]
    s_add_u32 s74, s70, 12288
    ds_read_b64_tr_b16 a[208:209], v62 offset:40960
    v_fmac_f32 v16, v49, v177
    v_mfma_f32_16x16x32_bf16 v[120:123], a[196:199], v[212:215], v[120:123]
    s_waitcnt lgkmcnt(3)
    ds_read_b64_tr_b16 a[210:211], v62 offset:43008
    v_fmac_f32 v16, v50, v178
    v_mfma_f32_16x16x32_bf16 v[116:119], a[200:203], v[192:195], v[116:119]
    s_waitcnt lgkmcnt(2)
    ds_read_b64_tr_b16 a[212:213], v62 offset:45056
    v_fmac_f32 v16, v51, v179
    v_mfma_f32_16x16x32_bf16 v[116:119], a[204:207], v[196:199], v[116:119]
    buffer_load_dwordx4 v[140:143], v44, s[8:11], s74 offen sc0 sc1
    ds_read_b64_tr_b16 a[214:215], v62 offset:47104
    v_mfma_f32_16x16x32_bf16 v[124:127], a[200:203], v[208:211], v[124:127]
    s_add_u32 s74, s70, 16384
    ds_read_b64_tr_b16 a[216:217], v63 offset:40960
    v_cvt_pk_bf16_f32 v96, v96, v97
    v_mfma_f32_16x16x32_bf16 v[124:127], a[204:207], v[212:215], v[124:127]
    s_waitcnt lgkmcnt(3)
    ds_read_b64_tr_b16 a[218:219], v63 offset:43008
    v_cvt_pk_bf16_f32 v97, v98, v99
    v_mfma_f32_16x16x32_bf16 v[112:115], a[208:211], v[200:203], v[112:115]
    s_waitcnt lgkmcnt(2)
    ds_read_b64_tr_b16 a[220:221], v63 offset:45056
    v_cvt_pk_bf16_f32 v98, v100, v101
    v_mfma_f32_16x16x32_bf16 v[112:115], a[212:215], v[204:207], v[112:115]
    buffer_load_dwordx4 v[144:147], v44, s[8:11], s74 offen sc0 sc1
    ds_read_b64_tr_b16 a[222:223], v63 offset:47104
    v_mfma_f32_16x16x32_bf16 v[120:123], a[208:211], v[216:219], v[120:123]
    s_add_u32 s74, s70, 20480
    ds_read_b64_tr_b16 a[224:225], v62 offset:49152
    v_cvt_pk_bf16_f32 v99, v102, v103
    v_mfma_f32_16x16x32_bf16 v[120:123], a[212:215], v[220:223], v[120:123]
    s_waitcnt lgkmcnt(3)
    ds_read_b64_tr_b16 a[226:227], v62 offset:51200
    v_min_u32 v96, -2, v96
    v_mfma_f32_16x16x32_bf16 v[116:119], a[216:219], v[200:203], v[116:119]
    s_waitcnt lgkmcnt(2)
    ds_read_b64_tr_b16 a[228:229], v62 offset:53248
    v_min_u32 v97, -2, v97
    v_mfma_f32_16x16x32_bf16 v[116:119], a[220:223], v[204:207], v[116:119]
    buffer_load_dwordx4 v[148:151], v44, s[8:11], s74 offen sc0 sc1
    ds_read_b64_tr_b16 a[230:231], v62 offset:55296
    v_mfma_f32_16x16x32_bf16 v[124:127], a[216:219], v[216:219], v[124:127]
    s_add_u32 s74, s70, 24576
    ds_read_b64_tr_b16 a[232:233], v63 offset:49152
    v_min_u32 v98, -2, v98
    v_mfma_f32_16x16x32_bf16 v[124:127], a[220:223], v[220:223], v[124:127]
    s_waitcnt lgkmcnt(3)
    ds_read_b64_tr_b16 a[234:235], v63 offset:51200
    v_min_u32 v99, -2, v99
    v_mfma_f32_16x16x32_bf16 v[112:115], a[224:227], v[224:227], v[112:115]
    s_waitcnt lgkmcnt(2)
    s_add_u32 s75, s18, 8388608
    ds_read_b64_tr_b16 a[236:237], v63 offset:53248
    s_waitcnt vmcnt(12)
    v_fmac_f32 v16, v52, v180
    v_mfma_f32_16x16x32_bf16 v[112:115], a[228:231], v[228:231], v[112:115]
    buffer_load_dwordx4 v[152:155], v44, s[8:11], s74 offen sc0 sc1
    ds_read_b64_tr_b16 a[238:239], v63 offset:55296
    v_mfma_f32_16x16x32_bf16 v[120:123], a[224:227], v[240:243], v[120:123]
    s_waitcnt lgkmcnt(2)
    s_add_u32 s74, s70, 28672
    ds_read_b64_tr_b16 a[240:241], v62 offset:57344
    v_fmac_f32 v16, v53, v181
    v_mfma_f32_16x16x32_bf16 v[120:123], a[228:231], v[244:247], v[120:123]
    buffer_store_dwordx4 v[96:99], v23, s[8:11], s75 offen offset:512 sc0 sc1
    ds_read_b64_tr_b16 a[242:243], v62 offset:59392
    v_mfma_f32_16x16x32_bf16 v[116:119], a[232:235], v[224:227], v[116:119]
    s_waitcnt lgkmcnt(2)
    ds_read_b64_tr_b16 a[244:245], v62 offset:61440
    v_cvt_pk_bf16_f32 v104, v104, v105
    v_mfma_f32_16x16x32_bf16 v[116:119], a[236:239], v[228:231], v[116:119]
    buffer_load_dwordx4 v[156:159], v44, s[8:11], s74 offen sc0 sc1
    ds_read_b64_tr_b16 a[246:247], v62 offset:63488
    v_mfma_f32_16x16x32_bf16 v[124:127], a[232:235], v[240:243], v[124:127]
    ds_read_b64_tr_b16 a[248:249], v63 offset:57344
    v_cvt_pk_bf16_f32 v105, v106, v107
    v_mfma_f32_16x16x32_bf16 v[124:127], a[236:239], v[244:247], v[124:127]
    s_waitcnt lgkmcnt(3)
    ds_read_b64_tr_b16 a[250:251], v63 offset:59392
    v_cvt_pk_bf16_f32 v106, v108, v109
    v_mfma_f32_16x16x32_bf16 v[112:115], a[240:243], v[232:235], v[112:115]
    s_waitcnt lgkmcnt(2)
    ds_read_b64_tr_b16 a[252:253], v63 offset:61440
    v_cvt_pk_bf16_f32 v107, v110, v111
    v_mfma_f32_16x16x32_bf16 v[112:115], a[244:247], v[236:239], v[112:115]
    ds_read_b64_tr_b16 a[254:255], v63 offset:63488
    v_min_u32 v104, -2, v104
    v_mfma_f32_16x16x32_bf16 v[120:123], a[240:243], v[248:251], v[120:123]
    v_min_u32 v105, -2, v105
    v_mfma_f32_16x16x32_bf16 v[120:123], a[244:247], v[252:255], v[120:123]
    s_waitcnt lgkmcnt(2)
    v_min_u32 v106, -2, v106
    v_mfma_f32_16x16x32_bf16 v[116:119], a[248:251], v[232:235], v[116:119]
    s_waitcnt lgkmcnt(0)
    v_min_u32 v107, -2, v107
    v_mfma_f32_16x16x32_bf16 v[116:119], a[252:255], v[236:239], v[116:119]
    s_add_u32 s75, s18, 8519680
    v_fmac_f32 v16, v54, v182
    v_mfma_f32_16x16x32_bf16 v[124:127], a[248:251], v[248:251], v[124:127]
    buffer_store_dwordx4 v[104:107], v23, s[8:11], s75 offen offset:512 sc0 sc1
    v_mfma_f32_16x16x32_bf16 v[124:127], a[252:255], v[252:255], v[124:127]
    v_fmac_f32 v16, v55, v183
    s_nop 1
    v_add_f32_dpp v16, v16, v16 quad_perm:[1,0,3,2] row_mask:0xf bank_mask:0xf
    s_nop 1
    v_add_f32_dpp v16, v16, v16 quad_perm:[2,3,0,1] row_mask:0xf bank_mask:0xf
    s_nop 1
    v_add_f32_dpp v16, v16, v16 row_half_mirror row_mask:0xf bank_mask:0xf
    s_nop 1
    v_add_f32_dpp v16, v16, v16 row_mirror row_mask:0xf bank_mask:0xf
    v_mov_b32 v19, v16
    s_nop 1
    v_permlane16_swap_b32 v16, v19
    v_add_f32 v16, v16, v19
    v_mov_b32 v19, v16
    s_nop 1
    v_permlane32_swap_b32 v16, v19
    v_add_f32 v16, v16, v19
    v_cvt_pk_bf16_f32 v112, v112, v113
    v_cvt_pk_bf16_f32 v113, v114, v115
    v_cvt_pk_bf16_f32 v114, v116, v117
    v_cvt_pk_bf16_f32 v115, v118, v119
    v_min_u32 v112, -2, v112
    v_min_u32 v113, -2, v113
    v_min_u32 v114, -2, v114
    v_min_u32 v115, -2, v115
    s_add_u32 s75, s18, 8388608
    buffer_store_dwordx4 v[112:115], v23, s[8:11], s75 offen offset:768 sc0 sc1
    v_cvt_pk_bf16_f32 v120, v120, v121
    v_cvt_pk_bf16_f32 v121, v122, v123
    v_cvt_pk_bf16_f32 v122, v124, v125
    v_cvt_pk_bf16_f32 v123, v126, v127
    v_min_u32 v120, -2, v120
    v_min_u32 v121, -2, v121
    v_min_u32 v122, -2, v122
    v_min_u32 v123, -2, v123
    s_add_u32 s75, s18, 8519680
    buffer_store_dwordx4 v[120:123], v23, s[8:11], s75 offen offset:768 sc0 sc1
    s_mov_b32 s12, 0xf000f0
    s_mov_b32 s13, 0xf000f0
    v_mov_b64 v[192:193], -1
    v_mov_b64 v[194:195], -1
    v_mov_b64 v[196:197], -1
    v_mov_b64 v[198:199], -1
    v_mov_b64 v[200:201], -1
    v_mov_b64 v[202:203], -1
    v_mov_b64 v[204:205], -1
    v_mov_b64 v[206:207], -1
    v_mov_b64 v[208:209], -1
    v_mov_b64 v[210:211], -1
    v_mov_b64 v[212:213], -1
    v_mov_b64 v[214:215], -1
    v_mov_b64 v[216:217], -1
    v_mov_b64 v[218:219], -1
    v_mov_b64 v[220:221], -1
    v_mov_b64 v[222:223], -1
    s_mov_b64 exec, s[12:13]
    s_add_u32 s74, s70, 8388608
    buffer_load_dwordx4 v[192:195], v44, s[8:11], s74 offen sc0 sc1
    s_add_u32 s74, s70, 8392704
    buffer_load_dwordx4 v[196:199], v44, s[8:11], s74 offen sc0 sc1
    s_add_u32 s74, s70, 8396800
    buffer_load_dwordx4 v[200:203], v44, s[8:11], s74 offen sc0 sc1
    s_add_u32 s74, s70, 8400896
    buffer_load_dwordx4 v[204:207], v44, s[8:11], s74 offen sc0 sc1
    s_add_u32 s74, s70, 8404992
    buffer_load_dwordx4 v[208:211], v44, s[8:11], s74 offen sc0 sc1
    s_add_u32 s74, s70, 8409088
    buffer_load_dwordx4 v[212:215], v44, s[8:11], s74 offen sc0 sc1
    s_add_u32 s74, s70, 8413184
    buffer_load_dwordx4 v[216:219], v44, s[8:11], s74 offen sc0 sc1
    s_add_u32 s74, s70, 8417280
    buffer_load_dwordx4 v[220:223], v44, s[8:11], s74 offen sc0 sc1
    s_mov_b64 exec, -1
    v_mov_b32 v100, 0x3f80
    v_mov_b32 v101, 0x3f800000
    v_lshlrev_b32 v72, 16, v32
    v_and_b32 v73, 0xffff0000, v32
    v_lshlrev_b32 v74, 16, v33
    v_and_b32 v75, 0xffff0000, v33
    v_lshlrev_b32 v76, 16, v34
    v_and_b32 v77, 0xffff0000, v34
    v_lshlrev_b32 v78, 16, v35
    v_and_b32 v79, 0xffff0000, v35
    v_lshlrev_b32 v88, 16, v36
    v_and_b32 v89, 0xffff0000, v36
    v_lshlrev_b32 v90, 16, v37
    v_and_b32 v91, 0xffff0000, v37
    v_lshlrev_b32 v92, 16, v38
    v_and_b32 v93, 0xffff0000, v38
    v_lshlrev_b32 v94, 16, v39
    v_and_b32 v95, 0xffff0000, v39
    s_waitcnt vmcnt(20)
    v_max_u32 v3, v128, v129
    v_max3_u32 v3, v3, v130, v131
    s_waitcnt vmcnt(18)
    v_max3_u32 v3, v3, v132, v133
    v_max3_u32 v3, v3, v134, v135
    s_waitcnt vmcnt(17)
    v_max3_u32 v3, v3, v136, v137
    v_max3_u32 v3, v3, v138, v139
    s_waitcnt vmcnt(16)
    v_max3_u32 v3, v3, v140, v141
    v_max3_u32 v3, v3, v142, v143
    s_waitcnt vmcnt(15)
    v_max3_u32 v3, v3, v144, v145
    v_max3_u32 v3, v3, v146, v147
    s_waitcnt vmcnt(14)
    v_max3_u32 v3, v3, v148, v149
    v_max3_u32 v3, v3, v150, v151
    s_waitcnt vmcnt(13)
    v_max3_u32 v3, v3, v152, v153
    v_max3_u32 v3, v3, v154, v155
    s_waitcnt vmcnt(11)
    v_max3_u32 v3, v3, v156, v157
    v_max3_u32 v3, v3, v158, v159
    v_cmp_eq_u32 vcc, -1, v3
    s_cbranch_vccnz L_P1_slow_15
L_P1_ok_16:
    v_lshlrev_b32 v64, 16, v128
    v_and_b32 v65, 0xffff0000, v128
    v_lshlrev_b32 v66, 16, v129
    v_and_b32 v67, 0xffff0000, v129
    v_lshlrev_b32 v68, 16, v130
    v_and_b32 v69, 0xffff0000, v130
    v_lshlrev_b32 v70, 16, v131
    v_and_b32 v71, 0xffff0000, v131
    v_dot2c_f32_bf16 v64, v132, v100
    v_dot2c_f32_bf16 v65, v132, v101
    v_dot2c_f32_bf16 v66, v133, v100
    v_dot2c_f32_bf16 v67, v133, v101
    v_dot2c_f32_bf16 v68, v134, v100
    v_dot2c_f32_bf16 v69, v134, v101
    v_dot2c_f32_bf16 v70, v135, v100
    v_dot2c_f32_bf16 v71, v135, v101
    v_dot2c_f32_bf16 v64, v136, v100
    v_dot2c_f32_bf16 v65, v136, v101
    v_dot2c_f32_bf16 v66, v137, v100
    v_dot2c_f32_bf16 v67, v137, v101
    v_dot2c_f32_bf16 v68, v138, v100
    v_dot2c_f32_bf16 v69, v138, v101
    v_dot2c_f32_bf16 v70, v139, v100
    v_dot2c_f32_bf16 v71, v139, v101
    v_dot2c_f32_bf16 v64, v140, v100
    v_dot2c_f32_bf16 v65, v140, v101
    v_dot2c_f32_bf16 v66, v141, v100
    v_dot2c_f32_bf16 v67, v141, v101
    v_dot2c_f32_bf16 v68, v142, v100
    v_dot2c_f32_bf16 v69, v142, v101
    v_dot2c_f32_bf16 v70, v143, v100
    v_dot2c_f32_bf16 v71, v143, v101
    v_dot2c_f32_bf16 v64, v144, v100
    v_dot2c_f32_bf16 v65, v144, v101
    v_dot2c_f32_bf16 v66, v145, v100
    v_dot2c_f32_bf16 v67, v145, v101
    v_dot2c_f32_bf16 v68, v146, v100
    v_dot2c_f32_bf16 v69, v146, v101
    v_dot2c_f32_bf16 v70, v147, v100
    v_dot2c_f32_bf16 v71, v147, v101
    v_dot2c_f32_bf16 v64, v148, v100
    v_dot2c_f32_bf16 v65, v148, v101
    v_dot2c_f32_bf16 v66, v149, v100
    v_dot2c_f32_bf16 v67, v149, v101
    v_dot2c_f32_bf16 v68, v150, v100
    v_dot2c_f32_bf16 v69, v150, v101
    v_dot2c_f32_bf16 v70, v151, v100
    v_dot2c_f32_bf16 v71, v151, v101
    v_dot2c_f32_bf16 v64, v152, v100
    v_dot2c_f32_bf16 v65, v152, v101
    v_dot2c_f32_bf16 v66, v153, v100
    v_dot2c_f32_bf16 v67, v153, v101
    v_dot2c_f32_bf16 v68, v154, v100
    v_dot2c_f32_bf16 v69, v154, v101
    v_dot2c_f32_bf16 v70, v155, v100
    v_dot2c_f32_bf16 v71, v155, v101
    v_dot2c_f32_bf16 v64, v156, v100
    v_dot2c_f32_bf16 v65, v156, v101
    v_dot2c_f32_bf16 v66, v157, v100
    v_dot2c_f32_bf16 v67, v157, v101
    v_dot2c_f32_bf16 v68, v158, v100
    v_dot2c_f32_bf16 v69, v158, v101
    v_dot2c_f32_bf16 v70, v159, v100
    v_dot2c_f32_bf16 v71, v159, v101
    v_pk_fma_f32 v[64:65], v[64:65], v[160:161], v[72:73]
    v_pk_fma_f32 v[66:67], v[66:67], v[162:163], v[74:75]
    v_pk_fma_f32 v[68:69], v[68:69], v[164:165], v[76:77]
    v_pk_fma_f32 v[70:71], v[70:71], v[166:167], v[78:79]
    v_cvt_pk_bf16_f32 v32, v64, v65
    v_cvt_pk_bf16_f32 v33, v66, v67
    v_cvt_pk_bf16_f32 v34, v68, v69
    v_cvt_pk_bf16_f32 v35, v70, v71
    v_lshlrev_b32 v64, 16, v32
    v_and_b32 v65, 0xffff0000, v32
    v_lshlrev_b32 v66, 16, v33
    v_and_b32 v67, 0xffff0000, v33
    v_lshlrev_b32 v68, 16, v34
    v_and_b32 v69, 0xffff0000, v34
    v_lshlrev_b32 v70, 16, v35
    v_and_b32 v71, 0xffff0000, v35
    v_pk_add_f32 v[48:49], v[64:65], v[66:67]
    v_pk_add_f32 v[50:51], v[68:69], v[70:71]
    v_pk_add_f32 v[48:49], v[48:49], v[50:51]
    v_add_f32 v48, v48, v49
    s_nop 1
    v_add_f32_dpp v48, v48, v48 quad_perm:[1,0,3,2] row_mask:0xf bank_mask:0xf
    s_nop 1
    v_add_f32_dpp v48, v48, v48 quad_perm:[2,3,0,1] row_mask:0xf bank_mask:0xf
    s_nop 1
    v_add_f32_dpp v48, v48, v48 row_half_mirror row_mask:0xf bank_mask:0xf
    s_nop 1
    v_add_f32_dpp v48, v48, v48 row_mirror row_mask:0xf bank_mask:0xf
    v_mov_b32 v49, v48
    s_nop 1
    v_permlane16_swap_b32 v48, v49
    v_add_f32 v48, v48, v49
    v_mov_b32 v49, v48
    s_nop 1
    v_permlane32_swap_b32 v48, v49
    v_add_f32 v48, v48, v49
    v_mul_f32 v48, 0xbb000000, v48
    v_pk_add_f32 v[72:73], v[64:65], v[48:49] op_sel_hi:[1,0]
    v_pk_add_f32 v[74:75], v[66:67], v[48:49] op_sel_hi:[1,0]
    v_pk_add_f32 v[76:77], v[68:69], v[48:49] op_sel_hi:[1,0]
    v_pk_add_f32 v[78:79], v[70:71], v[48:49] op_sel_hi:[1,0]
    v_pk_mul_f32 v[50:51], v[72:73], v[72:73]
    v_pk_mul_f32 v[52:53], v[72:73], v[8:9]
    v_pk_fma_f32 v[50:51], v[74:75], v[74:75], v[50:51]
    v_pk_fma_f32 v[52:53], v[74:75], v[10:11], v[52:53]
    v_pk_fma_f32 v[50:51], v[76:77], v[76:77], v[50:51]
    v_pk_fma_f32 v[52:53], v[76:77], v[12:13], v[52:53]
    v_pk_fma_f32 v[50:51], v[78:79], v[78:79], v[50:51]
    v_pk_fma_f32 v[52:53], v[78:79], v[14:15], v[52:53]
    v_add_f32 v50, v50, v51
    v_add_f32 v52, v52, v53
    s_nop 0
    v_add_f32_dpp v50, v50, v50 quad_perm:[1,0,3,2] row_mask:0xf bank_mask:0xf
    v_add_f32_dpp v52, v52, v52 quad_perm:[1,0,3,2] row_mask:0xf bank_mask:0xf
    s_nop 0
    v_add_f32_dpp v50, v50, v50 quad_perm:[2,3,0,1] row_mask:0xf bank_mask:0xf
    v_add_f32_dpp v52, v52, v52 quad_perm:[2,3,0,1] row_mask:0xf bank_mask:0xf
    s_nop 0
    v_add_f32_dpp v50, v50, v50 row_half_mirror row_mask:0xf bank_mask:0xf
    v_add_f32_dpp v52, v52, v52 row_half_mirror row_mask:0xf bank_mask:0xf
    s_nop 0
    v_add_f32_dpp v50, v50, v50 row_mirror row_mask:0xf bank_mask:0xf
    v_add_f32_dpp v52, v52, v52 row_mirror row_mask:0xf bank_mask:0xf
    v_mov_b32 v51, v50
    v_mov_b32 v53, v52
    s_nop 0
    v_permlane16_swap_b32 v50, v51
    v_permlane16_swap_b32 v52, v53
    v_add_f32 v50, v50, v51
    v_add_f32 v52, v52, v53
    v_mov_b32 v51, v50
    v_mov_b32 v53, v52
    s_nop 0
    v_permlane32_swap_b32 v50, v51
    v_permlane32_swap_b32 v52, v53
    v_add_f32 v50, v50, v51
    v_add_f32 v52, v52, v53
    v_mov_b32 v48, 0x3727c5ac
    v_fmac_f32 v48, 0x3b000000, v50
    v_rsq_f32 v48, v48
    s_nop 0
    v_fma_f32 v52, v52, v48, v16
    v_ashrrev_i32 v53, 31, v52
    v_or_b32 v53, 0x80000000, v53
    v_xor_b32 v53, v53, v52
    v_and_b32 v53, 0xfffff800, v53
    v_or_b32 v17, s68, v53
    v_pk_mul_f32 v[72:73], v[72:73], v[48:49] op_sel_hi:[1,0]
    v_pk_mul_f32 v[74:75], v[74:75], v[48:49] op_sel_hi:[1,0]
    v_pk_mul_f32 v[76:77], v[76:77], v[48:49] op_sel_hi:[1,0]
    v_pk_mul_f32 v[78:79], v[78:79], v[48:49] op_sel_hi:[1,0]
    v_pk_fma_f32 v[72:73], v[72:73], v[168:169], v[176:177]
    v_pk_fma_f32 v[74:75], v[74:75], v[170:171], v[178:179]
    v_pk_fma_f32 v[76:77], v[76:77], v[172:173], v[180:181]
    v_pk_fma_f32 v[78:79], v[78:79], v[174:175], v[182:183]
    v_cvt_pk_bf16_f32 v20, v72, v73
    v_cvt_pk_bf16_f32 v21, v74, v75
    v_cvt_pk_bf16_f32 v22, v76, v77
    v_cvt_pk_bf16_f32 v23, v78, v79
    v_lshlrev_b32 v98, 4, v0
    v_cmp_gt_u32 vcc, 224, v0
    v_mov_b32 v99, 2147479552
    s_nop 0
    v_cndmask_b32 v99, v99, v98, vcc
    s_lshl_b32 s17, s66, 13
    s_add_u32 s17, s17, 4194304
    s_cmp_lt_u32 s66, 224
    s_cselect_b32 s17, s17, 2143285248
    s_lshl_b32 s100, s3, 2
    v_mov_b32 v47, s100
    v_mov_b32 v102, 0
    s_lshl_b32 s100, s2, 6
    s_add_u32 s100, s100, 65536
    s_lshl_b32 s101, s2, 11
    s_add_u32 s101, s101, 524288
    s_mov_b32 s99, 0
L_P2_l_17:
    s_waitcnt vmcnt(0)
    v_max_u32 v48, v192, v193
    v_max3_u32 v48, v48, v194, v195
    v_max_u32 v49, v196, v197
    v_max3_u32 v49, v49, v198, v199
    v_max_u32 v50, v200, v201
    v_max3_u32 v50, v50, v202, v203
    v_max_u32 v51, v204, v205
    v_max3_u32 v51, v51, v206, v207
    v_max_u32 v52, v208, v209
    v_max3_u32 v52, v52, v210, v211
    v_max_u32 v53, v212, v213
    v_max3_u32 v53, v53, v214, v215
    v_max_u32 v54, v216, v217
    v_max3_u32 v54, v54, v218, v219
    v_max_u32 v55, v220, v221
    v_max3_u32 v55, v55, v222, v223
    v_max3_u32 v3, v48, v49, v50
    v_max3_u32 v3, v3, v51, v52
    v_max3_u32 v3, v3, v53, v54
    v_max_u32 v3, v3, v55
    v_cmp_eq_u32 vcc, -1, v3
    s_add_u32 s99, s99, 1
    s_cbranch_vccz L_P2_ok_18
    s_cmp_ge_u32 s99, 200000
    s_cbranch_scc1 L_P2_ok_18
    s_sleep 1
    v_cmp_eq_u32 vcc, -1, v48
    s_cbranch_vccz L_P2_s_19
    s_and_b64 s[96:97], vcc, s[12:13]
    s_cselect_b64 exec, s[96:97], vcc
    s_add_u32 s74, s70, 8388608
    buffer_load_dwordx4 v[192:195], v44, s[8:11], s74 offen sc0 sc1
    s_mov_b64 exec, -1
L_P2_s_19:
    v_cmp_eq_u32 vcc, -1, v49
    s_cbranch_vccz L_P2_s_20
    s_and_b64 s[96:97], vcc, s[12:13]
    s_cselect_b64 exec, s[96:97], vcc
    s_add_u32 s74, s70, 8392704
    buffer_load_dwordx4 v[196:199], v44, s[8:11], s74 offen sc0 sc1
    s_mov_b64 exec, -1
L_P2_s_20:
    v_cmp_eq_u32 vcc, -1, v50
    s_cbranch_vccz L_P2_s_21
    s_and_b64 s[96:97], vcc, s[12:13]
    s_cselect_b64 exec, s[96:97], vcc
    s_add_u32 s74, s70, 8396800
    buffer_load_dwordx4 v[200:203], v44, s[8:11], s74 offen sc0 sc1
    s_mov_b64 exec, -1
L_P2_s_21:
    v_cmp_eq_u32 vcc, -1, v51
    s_cbranch_vccz L_P2_s_22
    s_and_b64 s[96:97], vcc, s[12:13]
    s_cselect_b64 exec, s[96:97], vcc
    s_add_u32 s74, s70, 8400896
    buffer_load_dwordx4 v[204:207], v44, s[8:11], s74 offen sc0 sc1
    s_mov_b64 exec, -1
L_P2_s_22:
    v_cmp_eq_u32 vcc, -1, v52
    s_cbranch_vccz L_P2_s_23
    s_and_b64 s[96:97], vcc, s[12:13]
    s_cselect_b64 exec, s[96:97], vcc
    s_add_u32 s74, s70, 8404992
    buffer_load_dwordx4 v[208:211], v44, s[8:11], s74 offen sc0 sc1
    s_mov_b64 exec, -1
L_P2_s_23:
    v_cmp_eq_u32 vcc, -1, v53
    s_cbranch_vccz L_P2_s_24
    s_and_b64 s[96:97], vcc, s[12:13]
    s_cselect_b64 exec, s[96:97], vcc
    s_add_u32 s74, s70, 8409088
    buffer_load_dwordx4 v[212:215], v44, s[8:11], s74 offen sc0 sc1
    s_mov_b64 exec, -1
L_P2_s_24:
    v_cmp_eq_u32 vcc, -1, v54
    s_cbranch_vccz L_P2_s_25
    s_and_b64 s[96:97], vcc, s[12:13]
    s_cselect_b64 exec, s[96:97], vcc
    s_add_u32 s74, s70, 8413184
    buffer_load_dwordx4 v[216:219], v44, s[8:11], s74 offen sc0 sc1
    s_mov_b64 exec, -1
L_P2_s_25:
    v_cmp_eq_u32 vcc, -1, v55
    s_cbranch_vccz L_P2_s_26
    s_and_b64 s[96:97], vcc, s[12:13]
    s_cselect_b64 exec, s[96:97], vcc
    s_add_u32 s74, s70, 8417280
    buffer_load_dwordx4 v[220:223], v44, s[8:11], s74 offen sc0 sc1
    s_mov_b64 exec, -1
L_P2_s_26:
    s_branch L_P2_l_17
L_P2_ok_18:
    v_lshlrev_b32 v80, 16, v192
    v_and_b32 v81, 0xffff0000, v192
    v_lshlrev_b32 v82, 16, v193
    v_and_b32 v83, 0xffff0000, v193
    v_lshlrev_b32 v84, 16, v194
    v_and_b32 v85, 0xffff0000, v194
    v_lshlrev_b32 v86, 16, v195
    v_and_b32 v87, 0xffff0000, v195
    v_dot2c_f32_bf16 v80, v196, v100
    v_dot2c_f32_bf16 v81, v196, v101
    v_dot2c_f32_bf16 v82, v197, v100
    v_dot2c_f32_bf16 v83, v197, v101
    v_dot2c_f32_bf16 v84, v198, v100
    v_dot2c_f32_bf16 v85, v198, v101
    v_dot2c_f32_bf16 v86, v199, v100
    v_dot2c_f32_bf16 v87, v199, v101
    v_dot2c_f32_bf16 v80, v200, v100
    v_dot2c_f32_bf16 v81, v200, v101
    v_dot2c_f32_bf16 v82, v201, v100
    v_dot2c_f32_bf16 v83, v201, v101
    v_dot2c_f32_bf16 v84, v202, v100
    v_dot2c_f32_bf16 v85, v202, v101
    v_dot2c_f32_bf16 v86, v203, v100
    v_dot2c_f32_bf16 v87, v203, v101
    v_dot2c_f32_bf16 v80, v204, v100
    v_dot2c_f32_bf16 v81, v204, v101
    v_dot2c_f32_bf16 v82, v205, v100
    v_dot2c_f32_bf16 v83, v205, v101
    v_dot2c_f32_bf16 v84, v206, v100
    v_dot2c_f32_bf16 v85, v206, v101
    v_dot2c_f32_bf16 v86, v207, v100
    v_dot2c_f32_bf16 v87, v207, v101
    v_dot2c_f32_bf16 v80, v208, v100
    v_dot2c_f32_bf16 v81, v208, v101
    v_dot2c_f32_bf16 v82, v209, v100
    v_dot2c_f32_bf16 v83, v209, v101
    v_dot2c_f32_bf16 v84, v210, v100
    v_dot2c_f32_bf16 v85, v210, v101
    v_dot2c_f32_bf16 v86, v211, v100
    v_dot2c_f32_bf16 v87, v211, v101
    v_dot2c_f32_bf16 v80, v212, v100
    v_dot2c_f32_bf16 v81, v212, v101
    v_dot2c_f32_bf16 v82, v213, v100
    v_dot2c_f32_bf16 v83, v213, v101
    v_dot2c_f32_bf16 v84, v214, v100
    v_dot2c_f32_bf16 v85, v214, v101
    v_dot2c_f32_bf16 v86, v215, v100
    v_dot2c_f32_bf16 v87, v215, v101
    v_dot2c_f32_bf16 v80, v216, v100
    v_dot2c_f32_bf16 v81, v216, v101
    v_dot2c_f32_bf16 v82, v217, v100
    v_dot2c_f32_bf16 v83, v217, v101
    v_dot2c_f32_bf16 v84, v218, v100
    v_dot2c_f32_bf16 v85, v218, v101
    v_dot2c_f32_bf16 v86, v219, v100
    v_dot2c_f32_bf16 v87, v219, v101
    v_dot2c_f32_bf16 v80, v220, v100
    v_dot2c_f32_bf16 v81, v220, v101
    v_dot2c_f32_bf16 v82, v221, v100
    v_dot2c_f32_bf16 v83, v221, v101
    v_dot2c_f32_bf16 v84, v222, v100
    v_dot2c_f32_bf16 v85, v222, v101
    v_dot2c_f32_bf16 v86, v223, v100
    v_dot2c_f32_bf16 v87, v223, v101
    v_pk_fma_f32 v[80:81], v[80:81], v[160:161], v[88:89]
    v_pk_fma_f32 v[82:83], v[82:83], v[162:163], v[90:91]
    v_pk_fma_f32 v[84:85], v[84:85], v[164:165], v[92:93]
    v_pk_fma_f32 v[86:87], v[86:87], v[166:167], v[94:95]
    v_cvt_pk_bf16_f32 v36, v80, v81
    v_cvt_pk_bf16_f32 v37, v82, v83
    v_cvt_pk_bf16_f32 v38, v84, v85
    v_cvt_pk_bf16_f32 v39, v86, v87
    v_lshlrev_b32 v80, 16, v36
    v_and_b32 v81, 0xffff0000, v36
    v_lshlrev_b32 v82, 16, v37
    v_and_b32 v83, 0xffff0000, v37
    v_lshlrev_b32 v84, 16, v38
    v_and_b32 v85, 0xffff0000, v38
    v_lshlrev_b32 v86, 16, v39
    v_and_b32 v87, 0xffff0000, v39
    v_pk_add_f32 v[48:49], v[80:81], v[82:83]
    v_pk_add_f32 v[50:51], v[84:85], v[86:87]
    v_pk_add_f32 v[48:49], v[48:49], v[50:51]
    v_add_f32 v48, v48, v49
    s_nop 1
    v_add_f32_dpp v48, v48, v48 quad_perm:[1,0,3,2] row_mask:0xf bank_mask:0xf
    s_nop 1
    v_add_f32_dpp v48, v48, v48 quad_perm:[2,3,0,1] row_mask:0xf bank_mask:0xf
    s_nop 1
    v_add_f32_dpp v48, v48, v48 row_half_mirror row_mask:0xf bank_mask:0xf
    s_nop 1
    v_add_f32_dpp v48, v48, v48 row_mirror row_mask:0xf bank_mask:0xf
    v_mov_b32 v49, v48
    s_nop 1
    v_permlane16_swap_b32 v48, v49
    v_add_f32 v48, v48, v49
    v_mov_b32 v49, v48
    s_nop 1
    v_permlane32_swap_b32 v48, v49
    v_add_f32 v48, v48, v49
    v_mul_f32 v48, 0xbb000000, v48
    v_pk_add_f32 v[88:89], v[80:81], v[48:49] op_sel_hi:[1,0]
    v_pk_add_f32 v[90:91], v[82:83], v[48:49] op_sel_hi:[1,0]
    v_pk_add_f32 v[92:93], v[84:85], v[48:49] op_sel_hi:[1,0]
    v_pk_add_f32 v[94:95], v[86:87], v[48:49] op_sel_hi:[1,0]
    v_pk_mul_f32 v[50:51], v[88:89], v[88:89]
    v_pk_mul_f32 v[52:53], v[88:89], v[8:9]
    v_pk_fma_f32 v[50:51], v[90:91], v[90:91], v[50:51]
    v_pk_fma_f32 v[52:53], v[90:91], v[10:11], v[52:53]
    v_pk_fma_f32 v[50:51], v[92:93], v[92:93], v[50:51]
    v_pk_fma_f32 v[52:53], v[92:93], v[12:13], v[52:53]
    v_pk_fma_f32 v[50:51], v[94:95], v[94:95], v[50:51]
    v_pk_fma_f32 v[52:53], v[94:95], v[14:15], v[52:53]
    v_add_f32 v50, v50, v51
    v_add_f32 v52, v52, v53
    s_nop 0
    v_add_f32_dpp v50, v50, v50 quad_perm:[1,0,3,2] row_mask:0xf bank_mask:0xf
    v_add_f32_dpp v52, v52, v52 quad_perm:[1,0,3,2] row_mask:0xf bank_mask:0xf
    s_nop 0
    v_add_f32_dpp v50, v50, v50 quad_perm:[2,3,0,1] row_mask:0xf bank_mask:0xf
    v_add_f32_dpp v52, v52, v52 quad_perm:[2,3,0,1] row_mask:0xf bank_mask:0xf
    s_nop 0
    v_add_f32_dpp v50, v50, v50 row_half_mirror row_mask:0xf bank_mask:0xf
    v_add_f32_dpp v52, v52, v52 row_half_mirror row_mask:0xf bank_mask:0xf
    s_nop 0
    v_add_f32_dpp v50, v50, v50 row_mirror row_mask:0xf bank_mask:0xf
    v_add_f32_dpp v52, v52, v52 row_mirror row_mask:0xf bank_mask:0xf
    v_mov_b32 v51, v50
    v_mov_b32 v53, v52
    s_nop 0
    v_permlane16_swap_b32 v50, v51
    v_permlane16_swap_b32 v52, v53
    v_add_f32 v50, v50, v51
    v_add_f32 v52, v52, v53
    v_mov_b32 v51, v50
    v_mov_b32 v53, v52
    s_nop 0
    v_permlane32_swap_b32 v50, v51
    v_permlane32_swap_b32 v52, v53
    v_add_f32 v50, v50, v51
    v_add_f32 v52, v52, v53
    v_mov_b32 v48, 0x3727c5ac
    v_fmac_f32 v48, 0x3b000000, v50
    v_rsq_f32 v48, v48
    s_nop 0
    v_fma_f32 v52, v52, v48, v16
    v_ashrrev_i32 v53, 31, v52
    v_or_b32 v53, 0x80000000, v53
    v_xor_b32 v53, v53, v52
    v_and_b32 v53, 0xfffff800, v53
    v_or_b32 v18, s69, v53
    v_max3_u32 v19, v17, v18, 1
    ds_write_b32 v47, v19
    s_waitcnt lgkmcnt(0)
    s_barrier
    ds_read_b128 v[52:55], v102
    v_pk_mul_f32 v[88:89], v[88:89], v[48:49] op_sel_hi:[1,0]
    v_pk_mul_f32 v[90:91], v[90:91], v[48:49] op_sel_hi:[1,0]
    v_pk_mul_f32 v[92:93], v[92:93], v[48:49] op_sel_hi:[1,0]
    v_pk_mul_f32 v[94:95], v[94:95], v[48:49] op_sel_hi:[1,0]
    v_pk_fma_f32 v[88:89], v[88:89], v[168:169], v[176:177]
    v_pk_fma_f32 v[90:91], v[90:91], v[170:171], v[178:179]
    v_pk_fma_f32 v[92:93], v[92:93], v[172:173], v[180:181]
    v_pk_fma_f32 v[94:95], v[94:95], v[174:175], v[182:183]
    v_cvt_pk_bf16_f32 v24, v88, v89
    v_cvt_pk_bf16_f32 v25, v90, v91
    v_cvt_pk_bf16_f32 v26, v92, v93
    v_cvt_pk_bf16_f32 v27, v94, v95
    s_waitcnt lgkmcnt(0)
    v_max_u32 v52, v52, v53
    v_max3_u32 v52, v52, v54, v55
    v_cmp_eq_u32 vcc, v52, v19
    s_cbranch_vccz L_notbest
    buffer_store_dword v19, v5, s[8:11], s100 offen sc0 sc1
    v_cmp_gt_u32 vcc, v17, v18
    s_nop 1
    v_cndmask_b32 v28, v24, v20, vcc
    v_cndmask_b32 v40, v36, v32, vcc
    v_cndmask_b32 v29, v25, v21, vcc
    v_cndmask_b32 v41, v37, v33, vcc
    v_cndmask_b32 v30, v26, v22, vcc
    v_cndmask_b32 v42, v38, v34, vcc
    v_cndmask_b32 v31, v27, v23, vcc
    v_cndmask_b32 v43, v39, v35, vcc
    v_min_u32 v28, -2, v28
    v_min_u32 v40, -2, v40
    v_min_u32 v29, -2, v29
    v_min_u32 v41, -2, v41
    v_min_u32 v30, -2, v30
    v_min_u32 v42, -2, v42
    v_min_u32 v31, -2, v31
    v_min_u32 v43, -2, v43
    buffer_store_dwordx4 v[28:31], v1, s[8:11], s101 offen sc0 sc1
    buffer_store_dwordx4 v[40:43], v1, s[8:11], s101 offen offset:1024 sc0 sc1
L_notbest:
    buffer_load_dwordx4 v[112:115], v98, s[8:11], s17 offen
    s_add_u32 s17, s17, 4096
    buffer_load_dwordx4 v[116:119], v98, s[8:11], s17 offen
    s_add_u32 s17, s17, 2093056
    buffer_load_dwordx4 v[120:123], v98, s[8:11], s17 offen
    s_add_u32 s17, s17, 4096
    buffer_load_dwordx4 v[124:127], v98, s[8:11], s17 offen
    s_mul_i32 s17, s67, 28672
    s_add_u32 s17, s17, 8388608
    s_cmp_lt_u32 s67, 64
    s_cselect_b32 s17, s17, 2143285248
    buffer_load_dwordx4 v[128:131], v99, s[8:11], s17 offen offset:0
    buffer_load_dwordx4 v[132:135], v99, s[8:11], s17 offen offset:3584
    s_add_u32 s17, s17, 7168
    buffer_load_dwordx4 v[136:139], v99, s[8:11], s17 offen offset:0
    buffer_load_dwordx4 v[140:143], v99, s[8:11], s17 offen offset:3584
    s_add_u32 s17, s17, 7168
    buffer_load_dwordx4 v[144:147], v99, s[8:11], s17 offen offset:0
    buffer_load_dwordx4 v[148:151], v99, s[8:11], s17 offen offset:3584
    s_add_u32 s17, s17, 7168
    buffer_load_dwordx4 v[152:155], v99, s[8:11], s17 offen offset:0
    buffer_load_dwordx4 v[156:159], v99, s[8:11], s17 offen offset:3584
    v_lshlrev_b32 v72, 16, v20
    v_and_b32 v73, 0xffff0000, v20
    v_lshlrev_b32 v74, 16, v21
    v_and_b32 v75, 0xffff0000, v21
    v_lshlrev_b32 v76, 16, v22
    v_and_b32 v77, 0xffff0000, v22
    v_lshlrev_b32 v78, 16, v23
    v_and_b32 v79, 0xffff0000, v23
    v_pk_mul_f32 v[72:73], v[72:73], v[184:185]
    v_pk_mul_f32 v[74:75], v[74:75], v[186:187]
    v_pk_mul_f32 v[76:77], v[76:77], v[188:189]
    v_pk_mul_f32 v[78:79], v[78:79], v[190:191]
    v_cvt_pk_bf16_f32 v56, v72, v73
    v_cvt_pk_bf16_f32 v57, v74, v75
    v_cvt_pk_bf16_f32 v58, v76, v77
    v_cvt_pk_bf16_f32 v59, v78, v79
    v_lshlrev_b32 v72, 16, v56
    v_and_b32 v73, 0xffff0000, v56
    v_lshlrev_b32 v74, 16, v57
    v_and_b32 v75, 0xffff0000, v57
    v_lshlrev_b32 v76, 16, v58
    v_and_b32 v77, 0xffff0000, v58
    v_lshlrev_b32 v78, 16, v59
    v_and_b32 v79, 0xffff0000, v59
    v_pk_add_f32 v[72:73], v[72:73], v[64:65]
    v_pk_add_f32 v[74:75], v[74:75], v[66:67]
    v_pk_add_f32 v[76:77], v[76:77], v[68:69]
    v_pk_add_f32 v[78:79], v[78:79], v[70:71]
    v_cvt_pk_bf16_f32 v56, v72, v73
    v_cvt_pk_bf16_f32 v57, v74, v75
    v_cvt_pk_bf16_f32 v58, v76, v77
    v_cvt_pk_bf16_f32 v59, v78, v79
    v_lshlrev_b32 v88, 16, v24
    v_and_b32 v89, 0xffff0000, v24
    v_lshlrev_b32 v90, 16, v25
    v_and_b32 v91, 0xffff0000, v25
    v_lshlrev_b32 v92, 16, v26
    v_and_b32 v93, 0xffff0000, v26
    v_lshlrev_b32 v94, 16, v27
    v_and_b32 v95, 0xffff0000, v27
    v_pk_mul_f32 v[88:89], v[88:89], v[184:185]
    v_pk_mul_f32 v[90:91], v[90:91], v[186:187]
    v_pk_mul_f32 v[92:93], v[92:93], v[188:189]
    v_pk_mul_f32 v[94:95], v[94:95], v[190:191]
    v_cvt_pk_bf16_f32 v60, v88, v89
    v_cvt_pk_bf16_f32 v61, v90, v91
    v_cvt_pk_bf16_f32 v62, v92, v93
    v_cvt_pk_bf16_f32 v63, v94, v95
    v_lshlrev_b32 v88, 16, v60
    v_and_b32 v89, 0xffff0000, v60
    v_lshlrev_b32 v90, 16, v61
    v_and_b32 v91, 0xffff0000, v61
    v_lshlrev_b32 v92, 16, v62
    v_and_b32 v93, 0xffff0000, v62
    v_lshlrev_b32 v94, 16, v63
    v_and_b32 v95, 0xffff0000, v63
    v_pk_add_f32 v[88:89], v[88:89], v[80:81]
    v_pk_add_f32 v[90:91], v[90:91], v[82:83]
    v_pk_add_f32 v[92:93], v[92:93], v[84:85]
    v_pk_add_f32 v[94:95], v[94:95], v[86:87]
    v_cvt_pk_bf16_f32 v60, v88, v89
    v_cvt_pk_bf16_f32 v61, v90, v91
    v_cvt_pk_bf16_f32 v62, v92, v93
    v_cvt_pk_bf16_f32 v63, v94, v95
    v_lshlrev_b32 v4, 6, v0
    s_mov_b32 s71, 65536
    s_mov_b32 s99, 0
L_kl:
    buffer_load_dword v3, v4, s[8:11], s71 offen sc0 sc1
    s_add_u32 s99, s99, 1
    s_waitcnt vmcnt(0)
    v_cmp_eq_u32 vcc, 0, v3
    s_cbranch_vccz L_kd
    s_cmp_ge_u32 s99, 200000
    s_cbranch_scc1 L_kd
    s_mov_b64 exec, vcc
    s_sleep 2
    s_branch L_kl
L_kd:
    s_mov_b64 exec, -1
    v_max_u32_dpp v3, v3, v3 quad_perm:[1,0,3,2] row_mask:0xf bank_mask:0xf
    s_nop 1
    v_max_u32_dpp v3, v3, v3 quad_perm:[2,3,0,1] row_mask:0xf bank_mask:0xf
    s_nop 1
    v_max_u32_dpp v3, v3, v3 row_half_mirror row_mask:0xf bank_mask:0xf
    s_nop 1
    v_max_u32_dpp v3, v3, v3 row_mirror row_mask:0xf bank_mask:0xf
    v_mov_b32 v19, v3
    s_nop 1
    v_permlane16_swap_b32 v3, v19
    v_max_u32 v3, v3, v19
    v_mov_b32 v19, v3
    s_nop 1
    v_permlane32_swap_b32 v3, v19
    v_max_u32 v3, v3, v19
    ds_write_b32 v47, v3 offset:64
    s_waitcnt lgkmcnt(0)
    s_barrier
    ds_read_b128 v[52:55], v102 offset:64
    v_lshlrev_b32 v4, 2, v0
    s_waitcnt lgkmcnt(0)
    v_max_u32 v52, v52, v53
    v_max3_u32 v52, v52, v54, v55
    s_nop 0
    v_readfirstlane_b32 s71, v52
    s_and_b32 s72, s71, 2047
    s_lshr_b32 s100, s72, 7
    s_sub_u32 s101, 15, s100
    s_min_u32 s100, s100, s101
    s_lshl_b32 s100, s100, 16
    s_and_b32 s73, s72, 124
    s_lshl_b32 s73, s73, 9
    s_add_u32 s73, s73, s100
    s_add_u32 s73, s73, 524288
    buffer_load_dword v19, v4, s[8:11], s73 offen sc0 sc1
    s_lshl_b32 s100, s68, 10
    s_cmp_eq_u32 s68, s72
    s_cselect_b32 s100, 2147479552, s100
    buffer_store_dwordx2 v[56:57], v45, s[52:55], s100 offen
    buffer_store_dwordx2 v[58:59], v45, s[52:55], s100 offen offset:32
    s_lshl_b32 s100, s69, 10
    s_cmp_eq_u32 s69, s72
    s_cselect_b32 s100, 2147479552, s100
    buffer_store_dwordx2 v[60:61], v45, s[52:55], s100 offen
    buffer_store_dwordx2 v[62:63], v45, s[52:55], s100 offen offset:32
    s_cmp_ge_u32 s66, 224
    s_cbranch_scc1 L_nprod
    v_lshlrev_b32 v160, 16, v112
    v_and_b32 v161, 0xffff0000, v112
    v_lshlrev_b32 v162, 16, v113
    v_and_b32 v163, 0xffff0000, v113
    v_lshlrev_b32 v164, 16, v114
    v_and_b32 v165, 0xffff0000, v114
    v_lshlrev_b32 v166, 16, v115
    v_and_b32 v167, 0xffff0000, v115
    v_lshlrev_b32 v168, 16, v116
    v_and_b32 v169, 0xffff0000, v116
    v_lshlrev_b32 v170, 16, v117
    v_and_b32 v171, 0xffff0000, v117
    v_lshlrev_b32 v172, 16, v118
    v_and_b32 v173, 0xffff0000, v118
    v_lshlrev_b32 v174, 16, v119
    v_and_b32 v175, 0xffff0000, v119
    v_lshlrev_b32 v176, 16, v120
    v_and_b32 v177, 0xffff0000, v120
    v_lshlrev_b32 v178, 16, v121
    v_and_b32 v179, 0xffff0000, v121
    v_lshlrev_b32 v180, 16, v122
    v_and_b32 v181, 0xffff0000, v122
    v_lshlrev_b32 v182, 16, v123
    v_and_b32 v183, 0xffff0000, v123
    v_lshlrev_b32 v184, 16, v124
    v_and_b32 v185, 0xffff0000, v124
    v_lshlrev_b32 v186, 16, v125
    v_and_b32 v187, 0xffff0000, v125
    v_lshlrev_b32 v188, 16, v126
    v_and_b32 v189, 0xffff0000, v126
    v_lshlrev_b32 v190, 16, v127
    v_and_b32 v191, 0xffff0000, v127
    s_mov_b32 s99, 0
    s_waitcnt vmcnt(4)
L_hl:
    v_cmp_eq_u32 vcc, -1, v19
    s_add_u32 s99, s99, 1
    s_cbranch_vccz L_hok
    s_cmp_ge_u32 s99, 200000
    s_cbranch_scc1 L_hok
    buffer_load_dword v19, v4, s[8:11], s73 offen sc0 sc1
    s_waitcnt vmcnt(0)
    s_branch L_hl
L_hok:
    v_lshlrev_b32 v48, 16, v19
    v_and_b32 v50, 0xffff0000, v19
    v_pk_mul_f32 v[64:65], v[160:161], v[48:49] op_sel_hi:[1,0]
    v_pk_mul_f32 v[66:67], v[162:163], v[48:49] op_sel_hi:[1,0]
    v_pk_mul_f32 v[68:69], v[164:165], v[48:49] op_sel_hi:[1,0]
    v_pk_mul_f32 v[70:71], v[166:167], v[48:49] op_sel_hi:[1,0]
    v_pk_mul_f32 v[72:73], v[176:177], v[48:49] op_sel_hi:[1,0]
    v_pk_mul_f32 v[74:75], v[178:179], v[48:49] op_sel_hi:[1,0]
    v_pk_mul_f32 v[76:77], v[180:181], v[48:49] op_sel_hi:[1,0]
    v_pk_mul_f32 v[78:79], v[182:183], v[48:49] op_sel_hi:[1,0]
    v_pk_fma_f32 v[64:65], v[168:169], v[50:51], v[64:65] op_sel_hi:[1,0,1]
    v_pk_fma_f32 v[66:67], v[170:171], v[50:51], v[66:67] op_sel_hi:[1,0,1]
    v_pk_fma_f32 v[68:69], v[172:173], v[50:51], v[68:69] op_sel_hi:[1,0,1]
    v_pk_fma_f32 v[70:71], v[174:175], v[50:51], v[70:71] op_sel_hi:[1,0,1]
    v_pk_fma_f32 v[72:73], v[184:185], v[50:51], v[72:73] op_sel_hi:[1,0,1]
    v_pk_fma_f32 v[74:75], v[186:187], v[50:51], v[74:75] op_sel_hi:[1,0,1]
    v_pk_fma_f32 v[76:77], v[188:189], v[50:51], v[76:77] op_sel_hi:[1,0,1]
    v_pk_fma_f32 v[78:79], v[190:191], v[50:51], v[78:79] op_sel_hi:[1,0,1]
    v_permlane32_swap_b32 v64, v72
    v_permlane32_swap_b32 v65, v73
    v_permlane32_swap_b32 v66, v74
    v_permlane32_swap_b32 v67, v75
    v_permlane32_swap_b32 v68, v76
    v_permlane32_swap_b32 v69, v77
    v_permlane32_swap_b32 v70, v78
    v_permlane32_swap_b32 v71, v79
    v_add_f32 v64, v64, v72
    v_add_f32 v65, v65, v73
    v_add_f32 v66, v66, v74
    v_add_f32 v67, v67, v75
    v_add_f32 v68, v68, v76
    v_add_f32 v69, v69, v77
    v_add_f32 v70, v70, v78
    v_add_f32 v71, v71, v79
    v_permlane16_swap_b32 v64, v68
    v_permlane16_swap_b32 v65, v69
    v_permlane16_swap_b32 v66, v70
    v_permlane16_swap_b32 v67, v71
    v_add_f32 v64, v64, v68
    v_add_f32 v65, v65, v69
    v_add_f32 v66, v66, v70
    v_add_f32 v67, v67, v71
    v_add_f32_dpp v64, v64, v64 quad_perm:[1,0,3,2] row_mask:0xf bank_mask:0xf
    v_add_f32_dpp v65, v65, v65 quad_perm:[1,0,3,2] row_mask:0xf bank_mask:0xf
    v_add_f32_dpp v66, v66, v66 quad_perm:[1,0,3,2] row_mask:0xf bank_mask:0xf
    v_add_f32_dpp v67, v67, v67 quad_perm:[1,0,3,2] row_mask:0xf bank_mask:0xf
    v_add_f32_dpp v64, v64, v64 quad_perm:[2,3,0,1] row_mask:0xf bank_mask:0xf
    v_add_f32_dpp v65, v65, v65 quad_perm:[2,3,0,1] row_mask:0xf bank_mask:0xf
    v_add_f32_dpp v66, v66, v66 quad_perm:[2,3,0,1] row_mask:0xf bank_mask:0xf
    v_add_f32_dpp v67, v67, v67 quad_perm:[2,3,0,1] row_mask:0xf bank_mask:0xf
    v_add_f32_dpp v64, v64, v64 row_half_mirror row_mask:0xf bank_mask:0xf
    v_add_f32_dpp v65, v65, v65 row_half_mirror row_mask:0xf bank_mask:0xf
    v_add_f32_dpp v66, v66, v66 row_half_mirror row_mask:0xf bank_mask:0xf
    v_add_f32_dpp v67, v67, v67 row_half_mirror row_mask:0xf bank_mask:0xf
    v_add_f32_dpp v64, v64, v64 row_mirror row_mask:0xf bank_mask:0xf
    v_add_f32_dpp v65, v65, v65 row_mirror row_mask:0xf bank_mask:0xf
    v_add_f32_dpp v66, v66, v66 row_mirror row_mask:0xf bank_mask:0xf
    v_add_f32_dpp v67, v67, v67 row_mirror row_mask:0xf bank_mask:0xf
    v_and_b32 v50, 15, v2
    v_cmp_eq_u32 vcc, 0, v50
    v_mov_b32 v51, 1024
    s_nop 0
    v_cndmask_b32 v51, v51, v0, vcc
    ds_write_b128 v51, v[64:67] offset:256
    v_lshlrev_b32 v50, 2, v50
    s_waitcnt lgkmcnt(0)
    s_barrier
    s_cmp_lg_u32 s3, 0
    s_cbranch_scc1 L_nprod
    ds_read_b32 v64, v50 offset:256
    ds_read_b32 v65, v50 offset:320
    ds_read_b32 v66, v50 offset:384
    ds_read_b32 v67, v50 offset:448
    v_cmp_gt_u32 vcc, 8, v2
    v_mov_b32 v51, 2147479552
    s_nop 0
    v_cndmask_b32 v51, v51, v50, vcc
    s_lshl_b32 s100, s66, 6
    s_add_u32 s100, s100, 81920
    s_waitcnt lgkmcnt(2)
    v_add_f32 v64, v64, v65
    s_waitcnt lgkmcnt(0)
    v_add_f32 v66, v66, v67
    v_add_f32 v64, v64, v66
    v_cvt_pk_bf16_f32 v64, v64, v64
    v_and_b32 v64, 0xffff0000, v64
    s_nop 1
    v_mov_b32_dpp v65, v64 row_ror:8 row_mask:0xf bank_mask:0xf
    v_mul_f32 v66, 0xbfb8aa3b, v64
    v_exp_f32 v66, v66
    s_nop 0
    v_add_f32 v66, 1.0, v66
    v_rcp_f32 v66, v66
    s_nop 0
    v_mul_f32 v64, v64, v66
    v_cvt_pk_bf16_f32 v64, v64, v64
    v_and_b32 v64, 0xffff0000, v64
    v_mul_f32 v64, v64, v65
    v_cvt_pk_bf16_f32 v64, v64, v64
    v_and_b32 v64, 0xffff0000, v64
    buffer_store_dword v64, v51, s[8:11], s100 offen sc0 sc1
L_nprod:
    s_cmp_ge_u32 s67, 64
    s_cbranch_scc1 L_fin
    v_lshlrev_b32 v4, 6, v0
    v_cmp_gt_u32 vcc, 224, v0
    v_mov_b32 v51, 2147479552
    s_nop 0
    v_cndmask_b32 v4, v51, v4, vcc
    s_mov_b32 s100, 81920
    v_and_b32 v52, 7, v2
    s_lshl_b32 s101, s67, 3
    v_add_u32 v52, s101, v52
    v_lshrrev_b32 v53, 5, v52
    v_lshlrev_b32 v53, 6, v53
    v_and_b32 v54, 12, v52
    v_lshl_add_u32 v53, v54, 2, v53
    v_bfe_u32 v54, v52, 4, 1
    v_lshl_add_u32 v53, v54, 3, v53
    v_and_b32 v54, 2, v52
    v_lshl_add_u32 v53, v54, 1, v53
    v_lshlrev_b32 v54, 2, v52
    s_mov_b32 s101, 10240
    buffer_load_dword v55, v54, s[8:11], s101 offen
    buffer_load_dword v88, v53, s[8:11], s73 offen sc0 sc1
    buffer_load_dword v89, v53, s[8:11], s73 offen offset:1024 sc0 sc1
    v_lshlrev_b32 v192, 16, v128
    v_and_b32 v193, 0xffff0000, v128
    v_lshlrev_b32 v194, 16, v129
    v_and_b32 v195, 0xffff0000, v129
    v_lshlrev_b32 v196, 16, v130
    v_and_b32 v197, 0xffff0000, v130
    v_lshlrev_b32 v198, 16, v131
    v_and_b32 v199, 0xffff0000, v131
    v_lshlrev_b32 v200, 16, v132
    v_and_b32 v201, 0xffff0000, v132
    v_lshlrev_b32 v202, 16, v133
    v_and_b32 v203, 0xffff0000, v133
    v_lshlrev_b32 v204, 16, v134
    v_and_b32 v205, 0xffff0000, v134
    v_lshlrev_b32 v206, 16, v135
    v_and_b32 v207, 0xffff0000, v135
    v_lshlrev_b32 v208, 16, v136
    v_and_b32 v209, 0xffff0000, v136
    v_lshlrev_b32 v210, 16, v137
    v_and_b32 v211, 0xffff0000, v137
    v_lshlrev_b32 v212, 16, v138
    v_and_b32 v213, 0xffff0000, v138
    v_lshlrev_b32 v214, 16, v139
    v_and_b32 v215, 0xffff0000, v139
    v_lshlrev_b32 v216, 16, v140
    v_and_b32 v217, 0xffff0000, v140
    v_lshlrev_b32 v218, 16, v141
    v_and_b32 v219, 0xffff0000, v141
    v_lshlrev_b32 v220, 16, v142
    v_and_b32 v221, 0xffff0000, v142
    v_lshlrev_b32 v222, 16, v143
    v_and_b32 v223, 0xffff0000, v143
    v_lshlrev_b32 v224, 16, v144
    v_and_b32 v225, 0xffff0000, v144
    v_lshlrev_b32 v226, 16, v145
    v_and_b32 v227, 0xffff0000, v145
    v_lshlrev_b32 v228, 16, v146
    v_and_b32 v229, 0xffff0000, v146
    v_lshlrev_b32 v230, 16, v147
    v_and_b32 v231, 0xffff0000, v147
    v_lshlrev_b32 v232, 16, v148
    v_and_b32 v233, 0xffff0000, v148
    v_lshlrev_b32 v234, 16, v149
    v_and_b32 v235, 0xffff0000, v149
    v_lshlrev_b32 v236, 16, v150
    v_and_b32 v237, 0xffff0000, v150
    v_lshlrev_b32 v238, 16, v151
    v_and_b32 v239, 0xffff0000, v151
    v_lshlrev_b32 v240, 16, v152
    v_and_b32 v241, 0xffff0000, v152
    v_lshlrev_b32 v242, 16, v153
    v_and_b32 v243, 0xffff0000, v153
    v_lshlrev_b32 v244, 16, v154
    v_and_b32 v245, 0xffff0000, v154
    v_lshlrev_b32 v246, 16, v155
    v_and_b32 v247, 0xffff0000, v155
    v_lshlrev_b32 v248, 16, v156
    v_and_b32 v249, 0xffff0000, v156
    v_lshlrev_b32 v250, 16, v157
    v_and_b32 v251, 0xffff0000, v157
    v_lshlrev_b32 v252, 16, v158
    v_and_b32 v253, 0xffff0000, v158
    v_lshlrev_b32 v254, 16, v159
    v_and_b32 v255, 0xffff0000, v159
    s_and_b32 s101, s71, 0xfffff800
    s_or_b32 s101, s101, 0x400
    v_mov_b32 v90, s101
    v_not_b32 v91, v90
    v_ashrrev_i32 v91, 31, v91
    v_or_b32 v91, 0x80000000, v91
    v_xor_b32 v90, v90, v91
    v_cvt_pk_bf16_f32 v90, v90, v90
    v_and_b32 v90, 0xffff0000, v90
    v_mul_f32 v90, 0xbfb8aa3b, v90
    v_exp_f32 v90, v90
    s_nop 0
    v_add_f32 v90, 1.0, v90
    v_rcp_f32 v90, v90
    s_nop 0
    v_cvt_pk_bf16_f32 v90, v90, v90
    v_and_b32 v90, 0xffff0000, v90
    s_mov_b32 s99, 0
L_CND_l_27:
    s_waitcnt vmcnt(0)
    v_max_u32 v3, v88, v89
    v_cmp_eq_u32 vcc, -1, v3
    s_add_u32 s99, s99, 1
    s_cbranch_vccz L_CND_ok_28
    s_cmp_ge_u32 s99, 200000
    s_cbranch_scc1 L_CND_ok_28
    s_mov_b64 exec, vcc
    s_sleep 1
    buffer_load_dword v88, v53, s[8:11], s73 offen sc0 sc1
    buffer_load_dword v89, v53, s[8:11], s73 offen offset:1024 sc0 sc1
    s_branch L_CND_l_27
L_CND_ok_28:
    s_mov_b64 exec, -1
    v_and_b32 v51, 1, v52
    v_cmp_eq_u32 vcc, 0, v51
    v_lshlrev_b32 v91, 16, v88
    v_and_b32 v88, 0xffff0000, v88
    v_cndmask_b32 v88, v88, v91, vcc
    v_lshlrev_b32 v91, 16, v89
    v_and_b32 v89, 0xffff0000, v89
    v_cndmask_b32 v89, v89, v91, vcc
    v_and_b32 v50, 15, v2
    v_cmp_eq_u32 vcc, 0, v50
    v_lshrrev_b32 v51, 1, v0
    v_mov_b32 v50, 1024
    v_cndmask_b32 v51, v50, v51, vcc
    v_and_b32 v50, 7, v2
    v_lshlrev_b32 v50, 2, v50
    v_cmp_gt_u32 vcc, 8, v2
    v_lshlrev_b32 v52, 1, v52
    v_mov_b32 v53, 2147479552
    v_cndmask_b32 v52, v53, v52, vcc
    s_cmp_lt_u32 s66, 224
    s_cbranch_scc1 L_asl
    s_sleep 16
L_asl:
    s_sleep 7
    buffer_load_dwordx4 v[80:83], v4, s[8:11], s100 offen sc0 sc1
    buffer_load_dwordx4 v[84:87], v4, s[8:11], s100 offen offset:16 sc0 sc1
    s_mov_b32 s99, 0
L_ACT_l_29:
    s_waitcnt vmcnt(0)
    v_max_u32 v3, v80, v81
    v_max3_u32 v3, v3, v82, v83
    v_max3_u32 v3, v3, v84, v85
    v_max3_u32 v3, v3, v86, v87
    v_cmp_eq_u32 vcc, -1, v3
    s_add_u32 s99, s99, 1
    s_cbranch_vccz L_ACT_ok_30
    s_cmp_ge_u32 s99, 200000
    s_cbranch_scc1 L_ACT_ok_30
    s_mov_b64 exec, vcc
    s_sleep 2
    buffer_load_dwordx4 v[80:83], v4, s[8:11], s100 offen sc0 sc1
    buffer_load_dwordx4 v[84:87], v4, s[8:11], s100 offen offset:16 sc0 sc1
    s_branch L_ACT_l_29
L_ACT_ok_30:
    s_mov_b64 exec, -1
    v_pk_mul_f32 v[64:65], v[192:193], v[80:81] op_sel_hi:[1,0]
    v_pk_mul_f32 v[66:67], v[194:195], v[80:81] op_sel_hi:[1,0]
    v_pk_mul_f32 v[68:69], v[196:197], v[80:81] op_sel_hi:[1,0]
    v_pk_mul_f32 v[70:71], v[198:199], v[80:81] op_sel_hi:[1,0]
    v_pk_fma_f32 v[64:65], v[200:201], v[80:81], v[64:65] op_sel:[0,1,0] op_sel_hi:[1,1,1]
    v_pk_fma_f32 v[66:67], v[202:203], v[80:81], v[66:67] op_sel:[0,1,0] op_sel_hi:[1,1,1]
    v_pk_fma_f32 v[68:69], v[204:205], v[80:81], v[68:69] op_sel:[0,1,0] op_sel_hi:[1,1,1]
    v_pk_fma_f32 v[70:71], v[206:207], v[80:81], v[70:71] op_sel:[0,1,0] op_sel_hi:[1,1,1]
    v_pk_fma_f32 v[64:65], v[208:209], v[82:83], v[64:65] op_sel:[0,0,0] op_sel_hi:[1,0,1]
    v_pk_fma_f32 v[66:67], v[210:211], v[82:83], v[66:67] op_sel:[0,0,0] op_sel_hi:[1,0,1]
    v_pk_fma_f32 v[68:69], v[212:213], v[82:83], v[68:69] op_sel:[0,0,0] op_sel_hi:[1,0,1]
    v_pk_fma_f32 v[70:71], v[214:215], v[82:83], v[70:71] op_sel:[0,0,0] op_sel_hi:[1,0,1]
    v_pk_fma_f32 v[64:65], v[216:217], v[82:83], v[64:65] op_sel:[0,1,0] op_sel_hi:[1,1,1]
    v_pk_fma_f32 v[66:67], v[218:219], v[82:83], v[66:67] op_sel:[0,1,0] op_sel_hi:[1,1,1]
    v_pk_fma_f32 v[68:69], v[220:221], v[82:83], v[68:69] op_sel:[0,1,0] op_sel_hi:[1,1,1]
    v_pk_fma_f32 v[70:71], v[222:223], v[82:83], v[70:71] op_sel:[0,1,0] op_sel_hi:[1,1,1]
    v_pk_fma_f32 v[64:65], v[224:225], v[84:85], v[64:65] op_sel:[0,0,0] op_sel_hi:[1,0,1]
    v_pk_fma_f32 v[66:67], v[226:227], v[84:85], v[66:67] op_sel:[0,0,0] op_sel_hi:[1,0,1]
    v_pk_fma_f32 v[68:69], v[228:229], v[84:85], v[68:69] op_sel:[0,0,0] op_sel_hi:[1,0,1]
    v_pk_fma_f32 v[70:71], v[230:231], v[84:85], v[70:71] op_sel:[0,0,0] op_sel_hi:[1,0,1]
    v_pk_fma_f32 v[64:65], v[232:233], v[84:85], v[64:65] op_sel:[0,1,0] op_sel_hi:[1,1,1]
    v_pk_fma_f32 v[66:67], v[234:235], v[84:85], v[66:67] op_sel:[0,1,0] op_sel_hi:[1,1,1]
    v_pk_fma_f32 v[68:69], v[236:237], v[84:85], v[68:69] op_sel:[0,1,0] op_sel_hi:[1,1,1]
    v_pk_fma_f32 v[70:71], v[238:239], v[84:85], v[70:71] op_sel:[0,1,0] op_sel_hi:[1,1,1]
    v_pk_fma_f32 v[64:65], v[240:241], v[86:87], v[64:65] op_sel:[0,0,0] op_sel_hi:[1,0,1]
    v_pk_fma_f32 v[66:67], v[242:243], v[86:87], v[66:67] op_sel:[0,0,0] op_sel_hi:[1,0,1]
    v_pk_fma_f32 v[68:69], v[244:245], v[86:87], v[68:69] op_sel:[0,0,0] op_sel_hi:[1,0,1]
    v_pk_fma_f32 v[70:71], v[246:247], v[86:87], v[70:71] op_sel:[0,0,0] op_sel_hi:[1,0,1]
    v_pk_fma_f32 v[64:65], v[248:249], v[86:87], v[64:65] op_sel:[0,1,0] op_sel_hi:[1,1,1]
    v_pk_fma_f32 v[66:67], v[250:251], v[86:87], v[66:67] op_sel:[0,1,0] op_sel_hi:[1,1,1]
    v_pk_fma_f32 v[68:69], v[252:253], v[86:87], v[68:69] op_sel:[0,1,0] op_sel_hi:[1,1,1]
    v_pk_fma_f32 v[70:71], v[254:255], v[86:87], v[70:71] op_sel:[0,1,0] op_sel_hi:[1,1,1]
    s_nop 0
    v_permlane32_swap_b32 v64, v68
    v_permlane32_swap_b32 v65, v69
    v_permlane32_swap_b32 v66, v70
    v_permlane32_swap_b32 v67, v71
    v_add_f32 v64, v64, v68
    v_add_f32 v65, v65, v69
    v_add_f32 v66, v66, v70
    v_add_f32 v67, v67, v71
    s_nop 0
    v_permlane16_swap_b32 v64, v66
    v_permlane16_swap_b32 v65, v67
    v_add_f32 v64, v64, v66
    v_add_f32 v65, v65, v67
    s_nop 0
    v_add_f32_dpp v64, v64, v64 quad_perm:[1,0,3,2] row_mask:0xf bank_mask:0xf
    v_add_f32_dpp v65, v65, v65 quad_perm:[1,0,3,2] row_mask:0xf bank_mask:0xf
    s_nop 0
    v_add_f32_dpp v64, v64, v64 quad_perm:[2,3,0,1] row_mask:0xf bank_mask:0xf
    v_add_f32_dpp v65, v65, v65 quad_perm:[2,3,0,1] row_mask:0xf bank_mask:0xf
    s_nop 0
    v_add_f32_dpp v64, v64, v64 row_half_mirror row_mask:0xf bank_mask:0xf
    v_add_f32_dpp v65, v65, v65 row_half_mirror row_mask:0xf bank_mask:0xf
    s_nop 0
    v_add_f32_dpp v64, v64, v64 row_mirror row_mask:0xf bank_mask:0xf
    v_add_f32_dpp v65, v65, v65 row_mirror row_mask:0xf bank_mask:0xf
    ds_write_b64 v51, v[64:65] offset:2048
    s_waitcnt lgkmcnt(0)
    s_barrier
    s_cmp_lg_u32 s3, 0
    s_cbranch_scc1 L_fin
    ds_read_b32 v64, v50 offset:2048
    ds_read_b32 v65, v50 offset:2080
    ds_read_b32 v66, v50 offset:2112
    ds_read_b32 v67, v50 offset:2144
    s_lshl_b32 s100, s72, 10
    s_waitcnt lgkmcnt(2)
    v_add_f32 v64, v64, v65
    s_waitcnt lgkmcnt(0)
    v_add_f32 v66, v66, v67
    v_add_f32 v64, v64, v66
    v_cvt_pk_bf16_f32 v64, v64, v64
    v_and_b32 v64, 0xffff0000, v64
    v_mul_f32 v64, v64, v90
    v_cvt_pk_bf16_f32 v64, v64, v64
    v_and_b32 v64, 0xffff0000, v64
    v_add_f32 v64, v64, v88
    v_cvt_pk_bf16_f32 v64, v64, v64
    v_and_b32 v64, 0xffff0000, v64
    v_mul_f32 v64, v64, v55
    v_cvt_pk_bf16_f32 v64, v64, v64
    v_and_b32 v64, 0xffff0000, v64
    v_add_f32 v64, v64, v89
    v_cvt_pk_bf16_f32 v64, v64, v64
    buffer_store_short v64, v52, s[52:55], s100 offen
L_fin:
L_end:
    s_endpgm
L_E_slow_1:
    s_mov_b32 s99, 0
L_E_slow_1_l:
    s_sleep 4
    buffer_load_dword v3, v4, s[36:39], s67 offen sc0 sc1
    s_add_u32 s99, s99, 1
    s_waitcnt vmcnt(0)
    v_cmp_le_u32 vcc, s68, v3
    s_cmp_eq_u64 vcc, -1
    s_cbranch_scc1 L_E_ok_2
    s_cmp_lt_u32 s99, 200000
    s_cbranch_scc1 L_E_slow_1_l
    s_branch L_E_ok_2
L_H_slow_3:
    s_mov_b32 s99, 0
L_H_slow_3_l:
    s_sleep 4
    buffer_load_dword v3, v16, s[8:11], s78 offen sc0 sc1
    s_add_u32 s99, s99, 1
    s_waitcnt vmcnt(0)
    v_cmp_ne_u32 vcc, 0, v3
    s_cmp_eq_u64 vcc, -1
    s_cbranch_scc1 L_H_ok_4
    s_cmp_lt_u32 s99, 200000
    s_cbranch_scc1 L_H_slow_3_l
    s_branch L_H_ok_4
L_E2_slow_5:
    s_mov_b32 s99, 0
L_E2_slow_5_l:
    s_sleep 4
    buffer_load_dword v118, v119, s[8:11], s69 offen sc0 sc1
    s_add_u32 s99, s99, 1
    s_waitcnt vmcnt(0)
    v_cmp_ne_u32 vcc, 0, v118
    s_cmp_eq_u64 vcc, -1
    s_cbranch_scc1 L_E2_ok_6
    s_cmp_lt_u32 s99, 200000
    s_cbranch_scc1 L_E2_slow_5_l
    s_branch L_E2_ok_6
L_KV_slow_7:
    s_mov_b32 s99, 0
L_KV_slow_7_l:
    s_sleep 4
    buffer_load_dword v3, v17, s[8:11], s74 offen sc0 sc1
    s_add_u32 s99, s99, 1
    s_waitcnt vmcnt(0)
    v_cmp_ne_u32 vcc, 0, v3
    s_cmp_eq_u64 vcc, -1
    s_cbranch_scc1 L_KV_ok_8
    s_cmp_lt_u32 s99, 200000
    s_cbranch_scc1 L_KV_slow_7_l
    s_branch L_KV_ok_8
L_t1_start:
    v_mfma_f32_16x16x32_bf16 v[96:99], a[128:131], a[64:67], v[96:99]
    s_add_u32 s19, s82, 32768
    s_sub_u32 s82, s12, s13
    s_sub_u32 s82, s82, 1
    v_mfma_f32_16x16x32_bf16 v[96:99], a[132:135], a[68:71], v[96:99]
    s_cmp_gt_u32 s12, s13
    s_cselect_b32 s82, s82, s12
    s_lshl_b32 s82, s82, 16
    s_add_u32 s82, s82, s81
    v_mfma_f32_16x16x32_bf16 v[96:99], a[136:139], a[72:75], v[96:99]
    s_cmp_ge_u32 s12, 17
    s_cselect_b32 s82, 2147471360, s82
    s_add_u32 s12, s12, 1
    s_sub_u32 s14, s60, 1
    v_mfma_f32_16x16x32_bf16 v[96:99], a[140:143], a[76:79], v[96:99]
    v_mfma_f32_16x16x32_bf16 v[100:103], a[144:147], a[64:67], v[100:103]
    v_mfma_f32_16x16x32_bf16 v[100:103], a[148:151], a[68:71], v[100:103]
    v_mfma_f32_16x16x32_bf16 v[100:103], a[152:155], a[72:75], v[100:103]
    v_mfma_f32_16x16x32_bf16 v[100:103], a[156:159], a[76:79], v[100:103]
    v_mfma_f32_16x16x32_bf16 v[104:107], a[128:131], a[80:83], v[104:107]
    s_nop 2
    v_exp_f32 v96, v96
    v_mfma_f32_16x16x32_bf16 v[104:107], a[132:135], a[84:87], v[104:107]
    v_exp_f32 v97, v97
    v_mfma_f32_16x16x32_bf16 v[104:107], a[136:139], a[88:91], v[104:107]
    v_exp_f32 v98, v98
    v_mfma_f32_16x16x32_bf16 v[104:107], a[140:143], a[92:95], v[104:107]
    v_exp_f32 v99, v99
    v_mfma_f32_16x16x32_bf16 v[108:111], a[144:147], a[80:83], v[108:111]
    v_exp_f32 v100, v100
    v_mfma_f32_16x16x32_bf16 v[108:111], a[148:151], a[84:87], v[108:111]
    v_exp_f32 v101, v101
    v_mfma_f32_16x16x32_bf16 v[108:111], a[152:155], a[88:91], v[108:111]
    v_exp_f32 v102, v102
    v_mfma_f32_16x16x32_bf16 v[108:111], a[156:159], a[92:95], v[108:111]
    v_exp_f32 v103, v103
    v_mfma_f32_16x16x32_bf16 v[112:115], a[128:131], a[96:99], v[72:75]
    v_exp_f32 v104, v104
    v_mfma_f32_16x16x32_bf16 v[112:115], a[132:135], a[100:103], v[112:115]
    v_exp_f32 v105, v105
    v_mfma_f32_16x16x32_bf16 v[112:115], a[136:139], a[104:107], v[112:115]
    v_exp_f32 v106, v106
    v_mfma_f32_16x16x32_bf16 v[112:115], a[140:143], a[108:111], v[112:115]
    v_exp_f32 v107, v107
    v_mfma_f32_16x16x32_bf16 v[120:123], a[128:131], a[112:115], v[76:79]
    v_exp_f32 v108, v108
    v_mfma_f32_16x16x32_bf16 v[120:123], a[132:135], a[116:119], v[120:123]
    v_exp_f32 v109, v109
    v_mfma_f32_16x16x32_bf16 v[120:123], a[136:139], a[120:123], v[120:123]
    v_exp_f32 v110, v110
    v_mfma_f32_16x16x32_bf16 v[120:123], a[140:143], a[124:127], v[120:123]
    v_exp_f32 v111, v111
    v_mfma_f32_16x16x32_bf16 v[116:119], a[144:147], a[96:99], v[72:75]
    ds_read_b128 a[128:131], v18 offset:16384
    v_cvt_pk_bf16_f32 v48, v96, v97
    v_mfma_f32_16x16x32_bf16 v[116:119], a[148:151], a[100:103], v[116:119]
    ds_read_b128 a[132:135], v18 offset:17408
    v_cvt_pk_bf16_f32 v49, v98, v99
    v_mfma_f32_16x16x32_bf16 v[116:119], a[152:155], a[104:107], v[116:119]
    ds_read_b128 a[136:139], v18 offset:18432
    v_cvt_pk_bf16_f32 v50, v100, v101
    v_mfma_f32_16x16x32_bf16 v[116:119], a[156:159], a[108:111], v[116:119]
    ds_read_b128 a[140:143], v18 offset:19456
    v_cvt_pk_bf16_f32 v51, v102, v103
    v_mfma_f32_16x16x32_bf16 v[124:127], a[144:147], a[112:115], v[76:79]
    ds_read_b128 a[144:147], v18 offset:20480
    v_cvt_pk_bf16_f32 v52, v104, v105
    v_mfma_f32_16x16x32_bf16 v[124:127], a[148:151], a[116:119], v[124:127]
    ds_read_b128 a[148:151], v18 offset:21504
    v_cvt_pk_bf16_f32 v53, v106, v107
    v_mfma_f32_16x16x32_bf16 v[124:127], a[152:155], a[120:123], v[124:127]
    ds_read_b128 a[152:155], v18 offset:22528
    v_cvt_pk_bf16_f32 v54, v108, v109
    v_mfma_f32_16x16x32_bf16 v[124:127], a[156:159], a[124:127], v[124:127]
    ds_read_b128 a[156:159], v18 offset:23552
    v_cvt_pk_bf16_f32 v55, v110, v111
    v_xor_b32 v18, 196608, v18
    s_branch L_t1_p1
L_t1_zero:
    v_mfma_f32_16x16x32_bf16 v[96:99], a[128:131], a[96:99], v[80:83]
    s_xor_b32 s100, s16, 8192
    ds_read_b128 a[176:179], v20 offset:4096
    v_lshrrev_b32 v13, 1, v1
    v_mfma_f32_16x16x32_bf16 v[96:99], a[132:135], a[100:103], v[96:99]
    s_add_u32 m0, s15, 0
    ds_read_b128 a[180:183], v20 offset:5120
    v_add_u32 v12, s100, v13
    v_mfma_f32_16x16x32_bf16 v[96:99], a[136:139], a[104:107], v[96:99]
    buffer_load_dwordx4 v1, s[8:11], s82 offen offset:0 lds
    v_exp_f32 v112, v112
    v_mfma_f32_16x16x32_bf16 v[96:99], a[140:143], a[108:111], v[96:99]
    v_exp_f32 v113, v113
    v_mfma_f32_16x16x32_bf16 v[100:103], a[144:147], a[96:99], v[84:87]
    ds_read_b128 a[184:187], v20 offset:6144
    v_cvt_pk_bf16_f32 v56, v112, v113
    v_mfma_f32_16x16x32_bf16 v[100:103], a[148:151], a[100:103], v[100:103]
    v_exp_f32 v114, v114
    v_mfma_f32_16x16x32_bf16 v[100:103], a[152:155], a[104:107], v[100:103]
    buffer_load_dwordx4 v1, s[8:11], s82 offen offset:1024 lds
    v_exp_f32 v115, v115
    v_mfma_f32_16x16x32_bf16 v[100:103], a[156:159], a[108:111], v[100:103]
    ds_read_b128 a[188:191], v20 offset:7168
    v_cvt_pk_bf16_f32 v57, v114, v115
    v_mfma_f32_16x16x32_bf16 v[104:107], a[128:131], a[112:115], v[88:91]
    v_exp_f32 v116, v116
    v_mfma_f32_16x16x32_bf16 v[104:107], a[132:135], a[116:119], v[104:107]
    v_exp_f32 v117, v117
    v_mfma_f32_16x16x32_bf16 v[104:107], a[136:139], a[120:123], v[104:107]
    ds_read_b128 a[160:163], v19 offset:0
    v_cvt_pk_bf16_f32 v58, v116, v117
    v_mfma_f32_16x16x32_bf16 v[104:107], a[140:143], a[124:127], v[104:107]
    buffer_load_dwordx4 v1, s[8:11], s82 offen offset:2048 lds
    v_exp_f32 v118, v118
    v_mfma_f32_16x16x32_bf16 v[108:111], a[144:147], a[112:115], v[92:95]
    v_exp_f32 v119, v119
    v_mfma_f32_16x16x32_bf16 v[108:111], a[148:151], a[116:119], v[108:111]
    ds_read_b128 a[164:167], v19 offset:1024
    v_cvt_pk_bf16_f32 v59, v118, v119
    v_mfma_f32_16x16x32_bf16 v[108:111], a[152:155], a[120:123], v[108:111]
    v_exp_f32 v120, v120
    v_mfma_f32_16x16x32_bf16 v[108:111], a[156:159], a[124:127], v[108:111]
    buffer_load_dwordx4 v1, s[8:11], s82 offen offset:3072 lds
    v_exp_f32 v121, v121
    v_mfma_f32_16x16x32_bf16 v[32:35], v[28:31], v[48:51], 0
    s_add_u32 m0, s15, 4096
    ds_read_b128 a[168:171], v19 offset:2048
    v_cvt_pk_bf16_f32 v60, v120, v121
    v_mfma_f32_16x16x32_bf16 v[36:39], v[28:31], v[52:55], 0
    s_waitcnt lgkmcnt(6)
    v_exp_f32 v122, v122
    v_mfma_f32_16x16x32_bf16 v[144:147], a[176:179], v[48:51], 0
    v_exp_f32 v123, v123
    v_mfma_f32_16x16x32_bf16 v[176:179], a[176:179], v[52:55], 0
    s_waitcnt lgkmcnt(5)
    ds_read_b128 a[172:175], v19 offset:3072
    v_cvt_pk_bf16_f32 v61, v122, v123
    v_mfma_f32_16x16x32_bf16 v[148:151], a[180:183], v[48:51], 0
    buffer_load_dwordx4 v15, s[8:11], s82 offen offset:0 lds
    v_exp_f32 v124, v124
    v_mfma_f32_16x16x32_bf16 v[180:183], a[180:183], v[52:55], 0
    s_waitcnt lgkmcnt(5)
    v_exp_f32 v125, v125
    v_mfma_f32_16x16x32_bf16 v[152:155], a[184:187], v[48:51], 0
    s_waitcnt lgkmcnt(4)
    v_exp_f32 v126, v126
    v_mfma_f32_16x16x32_bf16 v[184:187], a[184:187], v[52:55], 0
    buffer_load_dwordx4 v15, s[8:11], s82 offen offset:1024 lds
    v_exp_f32 v127, v127
    v_mfma_f32_16x16x32_bf16 v[156:159], a[188:191], v[48:51], 0
    ds_write_b128 v16, v[144:147] offset:32768
    v_cvt_pk_bf16_f32 v62, v124, v125
    v_mfma_f32_16x16x32_bf16 v[188:191], a[188:191], v[52:55], 0
    s_waitcnt lgkmcnt(4)
    v_exp_f32 v96, v96
    v_mfma_f32_16x16x32_bf16 v[128:131], a[160:163], v[48:51], 0
    v_exp_f32 v97, v97
    v_mfma_f32_16x16x32_bf16 v[160:163], a[160:163], v[52:55], 0
    s_waitcnt lgkmcnt(3)
    ds_write_b128 v16, v[176:179] offset:33792
    v_cvt_pk_bf16_f32 v63, v126, v127
    v_mfma_f32_16x16x32_bf16 v[132:135], a[164:167], v[48:51], 0
    s_waitcnt lgkmcnt(3)
    v_exp_f32 v98, v98
    v_mfma_f32_16x16x32_bf16 v[164:167], a[164:167], v[52:55], 0
    buffer_load_dwordx4 v15, s[8:11], s82 offen offset:2048 lds
    v_exp_f32 v99, v99
    v_mfma_f32_16x16x32_bf16 v[136:139], a[168:171], v[48:51], 0
    ds_write_b128 v16, v[148:151] offset:34816
    v_mfma_f32_16x16x32_bf16 v[168:171], a[168:171], v[52:55], 0
    s_waitcnt lgkmcnt(3)
    v_exp_f32 v100, v100
    v_mfma_f32_16x16x32_bf16 v[140:143], a[172:175], v[48:51], 0
    v_exp_f32 v101, v101
    v_mfma_f32_16x16x32_bf16 v[172:175], a[172:175], v[52:55], 0
    ds_write_b128 v16, v[180:183] offset:35840
    v_mov_b32 v33, v36
    v_mfma_f32_16x16x32_bf16 v[40:43], v[28:31], v[56:59], 0
    buffer_load_dwordx4 v15, s[8:11], s82 offen offset:3072 lds
    v_exp_f32 v102, v102
    v_mfma_f32_16x16x32_bf16 v[44:47], v[28:31], v[60:63], 0
    s_xor_b32 s15, s15, 196608
    v_exp_f32 v103, v103
    v_mfma_f32_16x16x32_bf16 v[208:211], a[176:179], v[56:59], 0
    ds_write_b128 v16, v[152:155] offset:36864
    v_cvt_pk_bf16_f32 v48, v96, v97
    v_mfma_f32_16x16x32_bf16 v[240:243], a[176:179], v[60:63], 0
    ds_read_b128 a[176:179], v20 offset:20480
    v_exp_f32 v104, v104
    v_mfma_f32_16x16x32_bf16 v[212:215], a[180:183], v[56:59], 0
    v_exp_f32 v105, v105
    v_mfma_f32_16x16x32_bf16 v[244:247], a[180:183], v[60:63], 0
    ds_read_b128 a[180:183], v20 offset:21504
    v_exp_f32 v106, v106
    v_mfma_f32_16x16x32_bf16 v[216:219], a[184:187], v[56:59], 0
    ds_write_b128 v16, v[184:187] offset:37888
    v_cvt_pk_bf16_f32 v49, v98, v99
    v_mfma_f32_16x16x32_bf16 v[248:251], a[184:187], v[60:63], 0
    ds_read_b128 a[184:187], v20 offset:22528
    v_exp_f32 v107, v107
    v_mfma_f32_16x16x32_bf16 v[220:223], a[188:191], v[56:59], 0
    v_exp_f32 v108, v108
    v_mfma_f32_16x16x32_bf16 v[252:255], a[188:191], v[60:63], 0
    ds_read_b128 a[188:191], v20 offset:23552
    v_exp_f32 v109, v109
    v_mfma_f32_16x16x32_bf16 v[192:195], a[160:163], v[56:59], 0
    ds_write_b128 v16, v[156:159] offset:38912
    v_cvt_pk_bf16_f32 v50, v100, v101
    v_mfma_f32_16x16x32_bf16 v[224:227], a[160:163], v[60:63], 0
    ds_read_b128 a[160:163], v19 offset:16384
    v_exp_f32 v110, v110
    v_mfma_f32_16x16x32_bf16 v[196:199], a[164:167], v[56:59], 0
    v_exp_f32 v111, v111
    v_mfma_f32_16x16x32_bf16 v[228:231], a[164:167], v[60:63], 0
    ds_read_b128 a[164:167], v19 offset:17408
    v_cvt_pk_bf16_f32 v51, v102, v103
    v_mfma_f32_16x16x32_bf16 v[200:203], a[168:171], v[56:59], 0
    ds_write_b128 v16, v[188:191] offset:39936
    v_cvt_pk_bf16_f32 v52, v104, v105
    v_mfma_f32_16x16x32_bf16 v[232:235], a[168:171], v[60:63], 0
    ds_read_b128 a[168:171], v19 offset:18432
    v_cvt_pk_bf16_f32 v53, v106, v107
    v_mfma_f32_16x16x32_bf16 v[204:207], a[172:175], v[56:59], 0
    v_cvt_pk_bf16_f32 v54, v108, v109
    v_cvt_pk_bf16_f32 v55, v110, v111
    v_mfma_f32_16x16x32_bf16 v[236:239], a[172:175], v[60:63], 0
    ds_read_b128 a[172:175], v19 offset:19456
    ds_write_b64 v12, v[32:33]
    s_xor_b32 s101, s16, 98304
    v_xor_b32 v12, 8192, v12
    v_add_u32 v9, s101, v1
    v_xor_b32 v8, 8192, v16
    v_xor_b32 v10, 8192, v9
    s_branch L_t1_join
L_t1_redo:
    s_cmp_eq_u32 s25, 0
    s_cbranch_scc1 L_t1_max
    s_mov_b32 s25, 0
    v_mov_b32 v64, 0
    v_mov_b32 v65, 0
    v_mov_b32 v66, 0
    v_mov_b32 v67, 0
    v_mov_b32 v68, 0
    v_mov_b32 v69, 0
    v_mov_b32 v70, 0
    v_mov_b32 v71, 0
    v_mov_b32 v72, 0
    v_mov_b32 v73, 0
    v_mov_b32 v74, 0
    v_mov_b32 v75, 0
    v_mov_b32 v76, 0
    v_mov_b32 v77, 0
    v_mov_b32 v78, 0
    v_mov_b32 v79, 0
    s_nop 1
    s_branch L_t1_safe
L_t1_max:
    s_waitcnt vmcnt(0) lgkmcnt(0)
    s_barrier
    s_mov_b32 s25, 1
    s_and_b32 s100, s3, 1
    s_lshl_b32 s100, s100, 13
    s_sub_u32 s101, s81, s62
    s_add_u32 s101, s101, s100
    s_mov_b32 s14, s60
    v_mov_b32 v48, 0xff800000
    v_mov_b32 v49, 0xff800000
    v_mov_b32 v50, 0xff800000
    v_mov_b32 v51, 0xff800000
L_t1_maxl:
    s_cmp_eq_u32 s14, 0
    s_cbranch_scc1 L_t1_maxd
    s_add_u32 s100, s101, 0
    buffer_load_dwordx4 a[128:131], v1, s[8:11], s100 offen offset:0
    buffer_load_dwordx4 a[132:135], v1, s[8:11], s100 offen offset:1024
    buffer_load_dwordx4 a[136:139], v1, s[8:11], s100 offen offset:2048
    buffer_load_dwordx4 a[140:143], v1, s[8:11], s100 offen offset:3072
    buffer_load_dwordx4 a[144:147], v15, s[8:11], s100 offen offset:0
    buffer_load_dwordx4 a[148:151], v15, s[8:11], s100 offen offset:1024
    buffer_load_dwordx4 a[152:155], v15, s[8:11], s100 offen offset:2048
    buffer_load_dwordx4 a[156:159], v15, s[8:11], s100 offen offset:3072
    s_waitcnt vmcnt(7)
    v_mfma_f32_16x16x32_bf16 v[96:99], a[128:131], a[64:67], v[64:67]
    s_waitcnt vmcnt(6)
    v_mfma_f32_16x16x32_bf16 v[96:99], a[132:135], a[68:71], v[96:99]
    s_waitcnt vmcnt(5)
    v_mfma_f32_16x16x32_bf16 v[96:99], a[136:139], a[72:75], v[96:99]
    s_waitcnt vmcnt(4)
    v_mfma_f32_16x16x32_bf16 v[96:99], a[140:143], a[76:79], v[96:99]
    v_mfma_f32_16x16x32_bf16 v[104:107], a[128:131], a[80:83], v[68:71]
    v_mfma_f32_16x16x32_bf16 v[104:107], a[132:135], a[84:87], v[104:107]
    v_mfma_f32_16x16x32_bf16 v[104:107], a[136:139], a[88:91], v[104:107]
    v_mfma_f32_16x16x32_bf16 v[104:107], a[140:143], a[92:95], v[104:107]
    s_waitcnt vmcnt(3)
    v_mfma_f32_16x16x32_bf16 v[100:103], a[144:147], a[64:67], v[64:67]
    s_waitcnt vmcnt(2)
    v_mfma_f32_16x16x32_bf16 v[100:103], a[148:151], a[68:71], v[100:103]
    s_waitcnt vmcnt(1)
    v_mfma_f32_16x16x32_bf16 v[100:103], a[152:155], a[72:75], v[100:103]
    s_waitcnt vmcnt(0)
    v_mfma_f32_16x16x32_bf16 v[100:103], a[156:159], a[76:79], v[100:103]
    v_mfma_f32_16x16x32_bf16 v[108:111], a[144:147], a[80:83], v[68:71]
    v_mfma_f32_16x16x32_bf16 v[108:111], a[148:151], a[84:87], v[108:111]
    v_mfma_f32_16x16x32_bf16 v[108:111], a[152:155], a[88:91], v[108:111]
    v_mfma_f32_16x16x32_bf16 v[108:111], a[156:159], a[92:95], v[108:111]
    v_mfma_f32_16x16x32_bf16 v[112:115], a[128:131], a[96:99], v[72:75]
    v_mfma_f32_16x16x32_bf16 v[112:115], a[132:135], a[100:103], v[112:115]
    v_mfma_f32_16x16x32_bf16 v[112:115], a[136:139], a[104:107], v[112:115]
    v_mfma_f32_16x16x32_bf16 v[112:115], a[140:143], a[108:111], v[112:115]
    v_mfma_f32_16x16x32_bf16 v[120:123], a[128:131], a[112:115], v[76:79]
    v_mfma_f32_16x16x32_bf16 v[120:123], a[132:135], a[116:119], v[120:123]
    v_mfma_f32_16x16x32_bf16 v[120:123], a[136:139], a[120:123], v[120:123]
    v_mfma_f32_16x16x32_bf16 v[120:123], a[140:143], a[124:127], v[120:123]
    v_mfma_f32_16x16x32_bf16 v[116:119], a[144:147], a[96:99], v[72:75]
    v_mfma_f32_16x16x32_bf16 v[116:119], a[148:151], a[100:103], v[116:119]
    v_mfma_f32_16x16x32_bf16 v[116:119], a[152:155], a[104:107], v[116:119]
    v_mfma_f32_16x16x32_bf16 v[116:119], a[156:159], a[108:111], v[116:119]
    v_mfma_f32_16x16x32_bf16 v[124:127], a[144:147], a[112:115], v[76:79]
    v_mfma_f32_16x16x32_bf16 v[124:127], a[148:151], a[116:119], v[124:127]
    v_mfma_f32_16x16x32_bf16 v[124:127], a[152:155], a[120:123], v[124:127]
    v_mfma_f32_16x16x32_bf16 v[124:127], a[156:159], a[124:127], v[124:127]
    v_max3_f32 v48, v48, v96, v97
    v_max3_f32 v48, v48, v98, v99
    v_max3_f32 v48, v48, v100, v101
    v_max3_f32 v48, v48, v102, v103
    v_max3_f32 v49, v49, v104, v105
    v_max3_f32 v49, v49, v106, v107
    v_max3_f32 v49, v49, v108, v109
    v_max3_f32 v49, v49, v110, v111
    v_max3_f32 v50, v50, v112, v113
    v_max3_f32 v50, v50, v114, v115
    v_max3_f32 v50, v50, v116, v117
    v_max3_f32 v50, v50, v118, v119
    v_max3_f32 v51, v51, v120, v121
    v_max3_f32 v51, v51, v122, v123
    v_max3_f32 v51, v51, v124, v125
    v_max3_f32 v51, v51, v126, v127
    s_add_u32 s100, s101, 16384
    buffer_load_dwordx4 a[128:131], v1, s[8:11], s100 offen offset:0
    buffer_load_dwordx4 a[132:135], v1, s[8:11], s100 offen offset:1024
    buffer_load_dwordx4 a[136:139], v1, s[8:11], s100 offen offset:2048
    buffer_load_dwordx4 a[140:143], v1, s[8:11], s100 offen offset:3072
    buffer_load_dwordx4 a[144:147], v15, s[8:11], s100 offen offset:0
    buffer_load_dwordx4 a[148:151], v15, s[8:11], s100 offen offset:1024
    buffer_load_dwordx4 a[152:155], v15, s[8:11], s100 offen offset:2048
    buffer_load_dwordx4 a[156:159], v15, s[8:11], s100 offen offset:3072
    s_waitcnt vmcnt(7)
    v_mfma_f32_16x16x32_bf16 v[96:99], a[128:131], a[64:67], v[64:67]
    s_waitcnt vmcnt(6)
    v_mfma_f32_16x16x32_bf16 v[96:99], a[132:135], a[68:71], v[96:99]
    s_waitcnt vmcnt(5)
    v_mfma_f32_16x16x32_bf16 v[96:99], a[136:139], a[72:75], v[96:99]
    s_waitcnt vmcnt(4)
    v_mfma_f32_16x16x32_bf16 v[96:99], a[140:143], a[76:79], v[96:99]
    v_mfma_f32_16x16x32_bf16 v[104:107], a[128:131], a[80:83], v[68:71]
    v_mfma_f32_16x16x32_bf16 v[104:107], a[132:135], a[84:87], v[104:107]
    v_mfma_f32_16x16x32_bf16 v[104:107], a[136:139], a[88:91], v[104:107]
    v_mfma_f32_16x16x32_bf16 v[104:107], a[140:143], a[92:95], v[104:107]
    s_waitcnt vmcnt(3)
    v_mfma_f32_16x16x32_bf16 v[100:103], a[144:147], a[64:67], v[64:67]
    s_waitcnt vmcnt(2)
    v_mfma_f32_16x16x32_bf16 v[100:103], a[148:151], a[68:71], v[100:103]
    s_waitcnt vmcnt(1)
    v_mfma_f32_16x16x32_bf16 v[100:103], a[152:155], a[72:75], v[100:103]
    s_waitcnt vmcnt(0)
    v_mfma_f32_16x16x32_bf16 v[100:103], a[156:159], a[76:79], v[100:103]
    v_mfma_f32_16x16x32_bf16 v[108:111], a[144:147], a[80:83], v[68:71]
    v_mfma_f32_16x16x32_bf16 v[108:111], a[148:151], a[84:87], v[108:111]
    v_mfma_f32_16x16x32_bf16 v[108:111], a[152:155], a[88:91], v[108:111]
    v_mfma_f32_16x16x32_bf16 v[108:111], a[156:159], a[92:95], v[108:111]
    v_mfma_f32_16x16x32_bf16 v[112:115], a[128:131], a[96:99], v[72:75]
    v_mfma_f32_16x16x32_bf16 v[112:115], a[132:135], a[100:103], v[112:115]
    v_mfma_f32_16x16x32_bf16 v[112:115], a[136:139], a[104:107], v[112:115]
    v_mfma_f32_16x16x32_bf16 v[112:115], a[140:143], a[108:111], v[112:115]
    v_mfma_f32_16x16x32_bf16 v[120:123], a[128:131], a[112:115], v[76:79]
    v_mfma_f32_16x16x32_bf16 v[120:123], a[132:135], a[116:119], v[120:123]
    v_mfma_f32_16x16x32_bf16 v[120:123], a[136:139], a[120:123], v[120:123]
    v_mfma_f32_16x16x32_bf16 v[120:123], a[140:143], a[124:127], v[120:123]
    v_mfma_f32_16x16x32_bf16 v[116:119], a[144:147], a[96:99], v[72:75]
    v_mfma_f32_16x16x32_bf16 v[116:119], a[148:151], a[100:103], v[116:119]
    v_mfma_f32_16x16x32_bf16 v[116:119], a[152:155], a[104:107], v[116:119]
    v_mfma_f32_16x16x32_bf16 v[116:119], a[156:159], a[108:111], v[116:119]
    v_mfma_f32_16x16x32_bf16 v[124:127], a[144:147], a[112:115], v[76:79]
    v_mfma_f32_16x16x32_bf16 v[124:127], a[148:151], a[116:119], v[124:127]
    v_mfma_f32_16x16x32_bf16 v[124:127], a[152:155], a[120:123], v[124:127]
    v_mfma_f32_16x16x32_bf16 v[124:127], a[156:159], a[124:127], v[124:127]
    v_max3_f32 v48, v48, v96, v97
    v_max3_f32 v48, v48, v98, v99
    v_max3_f32 v48, v48, v100, v101
    v_max3_f32 v48, v48, v102, v103
    v_max3_f32 v49, v49, v104, v105
    v_max3_f32 v49, v49, v106, v107
    v_max3_f32 v49, v49, v108, v109
    v_max3_f32 v49, v49, v110, v111
    v_max3_f32 v50, v50, v112, v113
    v_max3_f32 v50, v50, v114, v115
    v_max3_f32 v50, v50, v116, v117
    v_max3_f32 v50, v50, v118, v119
    v_max3_f32 v51, v51, v120, v121
    v_max3_f32 v51, v51, v122, v123
    v_max3_f32 v51, v51, v124, v125
    v_max3_f32 v51, v51, v126, v127
    s_add_u32 s101, s101, 65536
    s_sub_u32 s14, s14, 1
    s_nop 7
    s_branch L_t1_maxl
L_t1_maxd:
    s_add_u32 s100, s101, 0
    buffer_load_dwordx4 a[128:131], v1, s[8:11], s100 offen offset:0
    buffer_load_dwordx4 a[132:135], v1, s[8:11], s100 offen offset:1024
    buffer_load_dwordx4 a[136:139], v1, s[8:11], s100 offen offset:2048
    buffer_load_dwordx4 a[140:143], v1, s[8:11], s100 offen offset:3072
    buffer_load_dwordx4 a[144:147], v15, s[8:11], s100 offen offset:0
    buffer_load_dwordx4 a[148:151], v15, s[8:11], s100 offen offset:1024
    buffer_load_dwordx4 a[152:155], v15, s[8:11], s100 offen offset:2048
    buffer_load_dwordx4 a[156:159], v15, s[8:11], s100 offen offset:3072
    v_add_f32 v80, 0, v21
    v_min_f32 v80, v80, v64
    v_add_f32 v81, 0xf1800000, v21
    v_min_f32 v81, v81, v65
    v_add_f32 v82, 0xf2000000, v21
    v_min_f32 v82, v82, v66
    v_add_f32 v83, 0xf2400000, v21
    v_min_f32 v83, v83, v67
    v_add_f32 v84, 0xf3800000, v21
    v_min_f32 v84, v84, v64
    v_add_f32 v85, 0xf3880000, v21
    v_min_f32 v85, v85, v65
    v_add_f32 v86, 0xf3900000, v21
    v_min_f32 v86, v86, v66
    v_add_f32 v87, 0xf3980000, v21
    v_min_f32 v87, v87, v67
    v_add_f32 v88, 0x73800000, v21
    v_min_f32 v88, v88, v68
    v_add_f32 v89, 0x73700000, v21
    v_min_f32 v89, v89, v69
    v_add_f32 v90, 0x73600000, v21
    v_min_f32 v90, v90, v70
    v_add_f32 v91, 0x73500000, v21
    v_min_f32 v91, v91, v71
    v_add_f32 v92, 0, v21
    v_min_f32 v92, v92, v68
    v_add_f32 v93, 0xf1800000, v21
    v_min_f32 v93, v93, v69
    v_add_f32 v94, 0xf2000000, v21
    v_min_f32 v94, v94, v70
    v_add_f32 v95, 0xf2400000, v21
    v_min_f32 v95, v95, v71
    s_waitcnt vmcnt(7)
    v_mfma_f32_16x16x32_bf16 v[96:99], a[128:131], a[64:67], v[80:83]
    s_waitcnt vmcnt(6)
    v_mfma_f32_16x16x32_bf16 v[96:99], a[132:135], a[68:71], v[96:99]
    s_waitcnt vmcnt(5)
    v_mfma_f32_16x16x32_bf16 v[96:99], a[136:139], a[72:75], v[96:99]
    s_waitcnt vmcnt(4)
    v_mfma_f32_16x16x32_bf16 v[96:99], a[140:143], a[76:79], v[96:99]
    v_mfma_f32_16x16x32_bf16 v[104:107], a[128:131], a[80:83], v[88:91]
    v_mfma_f32_16x16x32_bf16 v[104:107], a[132:135], a[84:87], v[104:107]
    v_mfma_f32_16x16x32_bf16 v[104:107], a[136:139], a[88:91], v[104:107]
    v_mfma_f32_16x16x32_bf16 v[104:107], a[140:143], a[92:95], v[104:107]
    s_waitcnt vmcnt(3)
    v_mfma_f32_16x16x32_bf16 v[100:103], a[144:147], a[64:67], v[84:87]
    s_waitcnt vmcnt(2)
    v_mfma_f32_16x16x32_bf16 v[100:103], a[148:151], a[68:71], v[100:103]
    s_waitcnt vmcnt(1)
    v_mfma_f32_16x16x32_bf16 v[100:103], a[152:155], a[72:75], v[100:103]
    s_waitcnt vmcnt(0)
    v_mfma_f32_16x16x32_bf16 v[100:103], a[156:159], a[76:79], v[100:103]
    v_mfma_f32_16x16x32_bf16 v[108:111], a[144:147], a[80:83], v[92:95]
    v_mfma_f32_16x16x32_bf16 v[108:111], a[148:151], a[84:87], v[108:111]
    v_mfma_f32_16x16x32_bf16 v[108:111], a[152:155], a[88:91], v[108:111]
    v_mfma_f32_16x16x32_bf16 v[108:111], a[156:159], a[92:95], v[108:111]
    v_mfma_f32_16x16x32_bf16 v[112:115], a[128:131], a[96:99], v[72:75]
    v_mfma_f32_16x16x32_bf16 v[112:115], a[132:135], a[100:103], v[112:115]
    v_mfma_f32_16x16x32_bf16 v[112:115], a[136:139], a[104:107], v[112:115]
    v_mfma_f32_16x16x32_bf16 v[112:115], a[140:143], a[108:111], v[112:115]
    v_mfma_f32_16x16x32_bf16 v[120:123], a[128:131], a[112:115], v[76:79]
    v_mfma_f32_16x16x32_bf16 v[120:123], a[132:135], a[116:119], v[120:123]
    v_mfma_f32_16x16x32_bf16 v[120:123], a[136:139], a[120:123], v[120:123]
    v_mfma_f32_16x16x32_bf16 v[120:123], a[140:143], a[124:127], v[120:123]
    v_mfma_f32_16x16x32_bf16 v[116:119], a[144:147], a[96:99], v[72:75]
    v_mfma_f32_16x16x32_bf16 v[116:119], a[148:151], a[100:103], v[116:119]
    v_mfma_f32_16x16x32_bf16 v[116:119], a[152:155], a[104:107], v[116:119]
    v_mfma_f32_16x16x32_bf16 v[116:119], a[156:159], a[108:111], v[116:119]
    v_mfma_f32_16x16x32_bf16 v[124:127], a[144:147], a[112:115], v[76:79]
    v_mfma_f32_16x16x32_bf16 v[124:127], a[148:151], a[116:119], v[124:127]
    v_mfma_f32_16x16x32_bf16 v[124:127], a[152:155], a[120:123], v[124:127]
    v_mfma_f32_16x16x32_bf16 v[124:127], a[156:159], a[124:127], v[124:127]
    v_max3_f32 v48, v48, v96, v97
    v_max3_f32 v48, v48, v98, v99
    v_max3_f32 v48, v48, v100, v101
    v_max3_f32 v48, v48, v102, v103
    v_max3_f32 v49, v49, v104, v105
    v_max3_f32 v49, v49, v106, v107
    v_max3_f32 v49, v49, v108, v109
    v_max3_f32 v49, v49, v110, v111
    v_max3_f32 v50, v50, v112, v113
    v_max3_f32 v50, v50, v114, v115
    v_max3_f32 v50, v50, v116, v117
    v_max3_f32 v50, v50, v118, v119
    v_max3_f32 v51, v51, v120, v121
    v_max3_f32 v51, v51, v122, v123
    v_max3_f32 v51, v51, v124, v125
    v_max3_f32 v51, v51, v126, v127
    s_add_u32 s100, s101, 16384
    buffer_load_dwordx4 a[128:131], v1, s[8:11], s100 offen offset:0
    buffer_load_dwordx4 a[132:135], v1, s[8:11], s100 offen offset:1024
    buffer_load_dwordx4 a[136:139], v1, s[8:11], s100 offen offset:2048
    buffer_load_dwordx4 a[140:143], v1, s[8:11], s100 offen offset:3072
    buffer_load_dwordx4 a[144:147], v15, s[8:11], s100 offen offset:0
    buffer_load_dwordx4 a[148:151], v15, s[8:11], s100 offen offset:1024
    buffer_load_dwordx4 a[152:155], v15, s[8:11], s100 offen offset:2048
    buffer_load_dwordx4 a[156:159], v15, s[8:11], s100 offen offset:3072
    v_add_f32 v80, 0, v22
    v_min_f32 v80, v80, v72
    v_add_f32 v81, 0xf1800000, v22
    v_min_f32 v81, v81, v73
    v_add_f32 v82, 0xf2000000, v22
    v_min_f32 v82, v82, v74
    v_add_f32 v83, 0xf2400000, v22
    v_min_f32 v83, v83, v75
    v_add_f32 v84, 0xf3800000, v22
    v_min_f32 v84, v84, v72
    v_add_f32 v85, 0xf3880000, v22
    v_min_f32 v85, v85, v73
    v_add_f32 v86, 0xf3900000, v22
    v_min_f32 v86, v86, v74
    v_add_f32 v87, 0xf3980000, v22
    v_min_f32 v87, v87, v75
    v_add_f32 v88, 0x73800000, v22
    v_min_f32 v88, v88, v76
    v_add_f32 v89, 0x73700000, v22
    v_min_f32 v89, v89, v77
    v_add_f32 v90, 0x73600000, v22
    v_min_f32 v90, v90, v78
    v_add_f32 v91, 0x73500000, v22
    v_min_f32 v91, v91, v79
    v_add_f32 v92, 0, v22
    v_min_f32 v92, v92, v76
    v_add_f32 v93, 0xf1800000, v22
    v_min_f32 v93, v93, v77
    v_add_f32 v94, 0xf2000000, v22
    v_min_f32 v94, v94, v78
    v_add_f32 v95, 0xf2400000, v22
    v_min_f32 v95, v95, v79
    s_waitcnt vmcnt(7)
    v_mfma_f32_16x16x32_bf16 v[96:99], a[128:131], a[96:99], v[80:83]
    s_waitcnt vmcnt(6)
    v_mfma_f32_16x16x32_bf16 v[96:99], a[132:135], a[100:103], v[96:99]
    s_waitcnt vmcnt(5)
    v_mfma_f32_16x16x32_bf16 v[96:99], a[136:139], a[104:107], v[96:99]
    s_waitcnt vmcnt(4)
    v_mfma_f32_16x16x32_bf16 v[96:99], a[140:143], a[108:111], v[96:99]
    v_mfma_f32_16x16x32_bf16 v[104:107], a[128:131], a[112:115], v[88:91]
    v_mfma_f32_16x16x32_bf16 v[104:107], a[132:135], a[116:119], v[104:107]
    v_mfma_f32_16x16x32_bf16 v[104:107], a[136:139], a[120:123], v[104:107]
    v_mfma_f32_16x16x32_bf16 v[104:107], a[140:143], a[124:127], v[104:107]
    s_waitcnt vmcnt(3)
    v_mfma_f32_16x16x32_bf16 v[100:103], a[144:147], a[96:99], v[84:87]
    s_waitcnt vmcnt(2)
    v_mfma_f32_16x16x32_bf16 v[100:103], a[148:151], a[100:103], v[100:103]
    s_waitcnt vmcnt(1)
    v_mfma_f32_16x16x32_bf16 v[100:103], a[152:155], a[104:107], v[100:103]
    s_waitcnt vmcnt(0)
    v_mfma_f32_16x16x32_bf16 v[100:103], a[156:159], a[108:111], v[100:103]
    v_mfma_f32_16x16x32_bf16 v[108:111], a[144:147], a[112:115], v[92:95]
    v_mfma_f32_16x16x32_bf16 v[108:111], a[148:151], a[116:119], v[108:111]
    v_mfma_f32_16x16x32_bf16 v[108:111], a[152:155], a[120:123], v[108:111]
    v_mfma_f32_16x16x32_bf16 v[108:111], a[156:159], a[124:127], v[108:111]
    v_max3_f32 v50, v50, v96, v97
    v_max3_f32 v50, v50, v98, v99
    s_nop 1
    v_max3_f32 v50, v50, v100, v101
    v_max3_f32 v50, v50, v102, v103
    v_max3_f32 v51, v51, v104, v105
    v_max3_f32 v51, v51, v106, v107
    v_max3_f32 v51, v51, v108, v109
    v_max3_f32 v51, v51, v110, v111
    v_mov_b32 v52, v48
    v_mov_b32 v53, v49
    v_mov_b32 v54, v50
    v_mov_b32 v55, v51
    v_permlane16_swap_b32 v48, v52
    v_permlane16_swap_b32 v49, v53
    v_permlane16_swap_b32 v50, v54
    v_permlane16_swap_b32 v51, v55
    v_max_f32 v48, v48, v52
    v_max_f32 v49, v49, v53
    v_max_f32 v50, v50, v54
    v_max_f32 v51, v51, v55
    v_mov_b32 v52, v48
    v_mov_b32 v53, v49
    v_mov_b32 v54, v50
    v_mov_b32 v55, v51
    v_permlane32_swap_b32 v48, v52
    v_permlane32_swap_b32 v49, v53
    v_permlane32_swap_b32 v50, v54
    v_permlane32_swap_b32 v51, v55
    v_max_f32 v48, v48, v52
    v_max_f32 v49, v49, v53
    v_max_f32 v50, v50, v54
    v_max_f32 v51, v51, v55
    ds_write_b128 v16, v[48:51] offset:32768
    v_xor_b32 v8, 8192, v16
    s_waitcnt lgkmcnt(0)
    s_barrier
    ds_read_b128 v[52:55], v8 offset:32768
    s_waitcnt lgkmcnt(0)
    v_max_f32 v48, v48, v52
    v_max_f32 v49, v49, v53
    v_max_f32 v50, v50, v54
    v_max_f32 v51, v51, v55
    v_sub_f32 v64, 0, v48
    v_sub_f32 v65, 0, v48
    v_sub_f32 v66, 0, v48
    v_sub_f32 v67, 0, v48
    v_sub_f32 v68, 0, v49
    v_sub_f32 v69, 0, v49
    v_sub_f32 v70, 0, v49
    v_sub_f32 v71, 0, v49
    v_sub_f32 v72, 0, v50
    v_sub_f32 v73, 0, v50
    v_sub_f32 v74, 0, v50
    v_sub_f32 v75, 0, v50
    v_sub_f32 v76, 0, v51
    v_sub_f32 v77, 0, v51
    v_sub_f32 v78, 0, v51
    v_sub_f32 v79, 0, v51
    s_mov_b32 s12, 0
    s_and_b32 s100, s12, 1
    s_mul_i32 s15, s100, 196608
    s_xor_b32 s15, s15, 65536
    s_mul_i32 s16, s100, 98304
    s_xor_b32 s16, s16, 98304
    v_and_b32 v18, 0x7fff, v18
    v_or_b32 v18, s15, v18
    v_and_b32 v19, 0x7fff, v19
    v_or_b32 v19, s16, v19
    v_and_b32 v20, 0x7fff, v20
    v_or_b32 v20, s16, v20
    s_add_u32 s15, s15, s62
    s_add_u32 s16, s16, s62
    s_add_u32 s12, s12, 2
    s_mov_b32 s82, s81
    s_add_u32 s19, s81, 32768
    s_add_u32 m0, s15, 0
    s_nop 0
    buffer_load_dwordx4 v1, s[8:11], s82 offen offset:0 lds
    buffer_load_dwordx4 v1, s[8:11], s82 offen offset:1024 lds
    buffer_load_dwordx4 v1, s[8:11], s82 offen offset:2048 lds
    buffer_load_dwordx4 v1, s[8:11], s82 offen offset:3072 lds
    s_add_u32 m0, s15, 4096
    s_nop 0
    buffer_load_dwordx4 v15, s[8:11], s82 offen offset:0 lds
    buffer_load_dwordx4 v15, s[8:11], s82 offen offset:1024 lds
    buffer_load_dwordx4 v15, s[8:11], s82 offen offset:2048 lds
    buffer_load_dwordx4 v15, s[8:11], s82 offen offset:3072 lds
    s_xor_b32 s15, s15, 196608
    s_add_u32 m0, s16, 0
    s_nop 0
    buffer_load_dwordx4 v1, s[8:11], s19 offen offset:0 lds
    buffer_load_dwordx4 v1, s[8:11], s19 offen offset:1024 lds
    buffer_load_dwordx4 v1, s[8:11], s19 offen offset:2048 lds
    buffer_load_dwordx4 v1, s[8:11], s19 offen offset:3072 lds
    s_add_u32 m0, s16, 4096
    s_nop 0
    buffer_load_dwordx4 v15, s[8:11], s19 offen offset:0 lds
    buffer_load_dwordx4 v15, s[8:11], s19 offen offset:1024 lds
    buffer_load_dwordx4 v15, s[8:11], s19 offen offset:2048 lds
    buffer_load_dwordx4 v15, s[8:11], s19 offen offset:3072 lds
    s_xor_b32 s16, s16, 98304
    s_min_u32 s82, s60, 1
    s_lshl_b32 s82, s82, 16
    s_add_u32 s82, s82, s81
    s_add_u32 m0, s15, 0
    s_nop 0
    buffer_load_dwordx4 v1, s[8:11], s82 offen offset:0 lds
    buffer_load_dwordx4 v1, s[8:11], s82 offen offset:1024 lds
    buffer_load_dwordx4 v1, s[8:11], s82 offen offset:2048 lds
    buffer_load_dwordx4 v1, s[8:11], s82 offen offset:3072 lds
    s_add_u32 m0, s15, 4096
    s_nop 0
    buffer_load_dwordx4 v15, s[8:11], s82 offen offset:0 lds
    buffer_load_dwordx4 v15, s[8:11], s82 offen offset:1024 lds
    buffer_load_dwordx4 v15, s[8:11], s82 offen offset:2048 lds
    buffer_load_dwordx4 v15, s[8:11], s82 offen offset:3072 lds
    s_xor_b32 s15, s15, 196608
    s_cmp_eq_u32 s60, 0
    s_cselect_b32 s19, 0, 0x76800000
    v_add_f32 v3, s19, v21
    v_add_f32 v96, 0, v3
    v_min_f32 v96, v96, v64
    v_add_f32 v97, 0xf1800000, v3
    v_min_f32 v97, v97, v65
    v_add_f32 v98, 0xf2000000, v3
    v_min_f32 v98, v98, v66
    v_add_f32 v99, 0xf2400000, v3
    v_min_f32 v99, v99, v67
    v_add_f32 v100, 0xf3800000, v3
    v_min_f32 v100, v100, v64
    v_add_f32 v101, 0xf3880000, v3
    v_min_f32 v101, v101, v65
    v_add_f32 v102, 0xf3900000, v3
    v_min_f32 v102, v102, v66
    v_add_f32 v103, 0xf3980000, v3
    v_min_f32 v103, v103, v67
    v_add_f32 v104, 0x73800000, v3
    v_min_f32 v104, v104, v68
    v_add_f32 v105, 0x73700000, v3
    v_min_f32 v105, v105, v69
    v_add_f32 v106, 0x73600000, v3
    v_min_f32 v106, v106, v70
    v_add_f32 v107, 0x73500000, v3
    v_min_f32 v107, v107, v71
    v_add_f32 v108, 0, v3
    v_min_f32 v108, v108, v68
    v_add_f32 v109, 0xf1800000, v3
    v_min_f32 v109, v109, v69
    v_add_f32 v110, 0xf2000000, v3
    v_min_f32 v110, v110, v70
    v_add_f32 v111, 0xf2400000, v3
    v_min_f32 v111, v111, v71
    v_add_f32 v80, 0, v22
    v_min_f32 v80, v80, v72
    v_add_f32 v81, 0xf1800000, v22
    v_min_f32 v81, v81, v73
    v_add_f32 v82, 0xf2000000, v22
    v_min_f32 v82, v82, v74
    v_add_f32 v83, 0xf2400000, v22
    v_min_f32 v83, v83, v75
    v_add_f32 v84, 0xf3800000, v22
    v_min_f32 v84, v84, v72
    v_add_f32 v85, 0xf3880000, v22
    v_min_f32 v85, v85, v73
    v_add_f32 v86, 0xf3900000, v22
    v_min_f32 v86, v86, v74
    v_add_f32 v87, 0xf3980000, v22
    v_min_f32 v87, v87, v75
    v_add_f32 v88, 0x73800000, v22
    v_min_f32 v88, v88, v76
    v_add_f32 v89, 0x73700000, v22
    v_min_f32 v89, v89, v77
    v_add_f32 v90, 0x73600000, v22
    v_min_f32 v90, v90, v78
    v_add_f32 v91, 0x73500000, v22
    v_min_f32 v91, v91, v79
    v_add_f32 v92, 0, v22
    v_min_f32 v92, v92, v76
    v_add_f32 v93, 0xf1800000, v22
    v_min_f32 v93, v93, v77
    v_add_f32 v94, 0xf2000000, v22
    v_min_f32 v94, v94, v78
    v_add_f32 v95, 0xf2400000, v22
    v_min_f32 v95, v95, v79
    s_cmp_eq_u32 s60, 0
    s_cbranch_scc1 L_t1_mk
    v_add_f32 v80, 0, v21
    v_min_f32 v80, v80, v64
    v_add_f32 v81, 0xf1800000, v21
    v_min_f32 v81, v81, v65
    v_add_f32 v82, 0xf2000000, v21
    v_min_f32 v82, v82, v66
    v_add_f32 v83, 0xf2400000, v21
    v_min_f32 v83, v83, v67
    v_add_f32 v84, 0xf3800000, v21
    v_min_f32 v84, v84, v64
    v_add_f32 v85, 0xf3880000, v21
    v_min_f32 v85, v85, v65
    v_add_f32 v86, 0xf3900000, v21
    v_min_f32 v86, v86, v66
    v_add_f32 v87, 0xf3980000, v21
    v_min_f32 v87, v87, v67
    v_add_f32 v88, 0x73800000, v21
    v_min_f32 v88, v88, v68
    v_add_f32 v89, 0x73700000, v21
    v_min_f32 v89, v89, v69
    v_add_f32 v90, 0x73600000, v21
    v_min_f32 v90, v90, v70
    v_add_f32 v91, 0x73500000, v21
    v_min_f32 v91, v91, v71
    v_add_f32 v92, 0, v21
    v_min_f32 v92, v92, v68
    v_add_f32 v93, 0xf1800000, v21
    v_min_f32 v93, v93, v69
    v_add_f32 v94, 0xf2000000, v21
    v_min_f32 v94, v94, v70
    v_add_f32 v95, 0xf2400000, v21
    v_min_f32 v95, v95, v71
L_t1_mk:
    s_waitcnt vmcnt(0) lgkmcnt(0)
    s_barrier
    ds_read_b128 a[128:131], v18 offset:0
    ds_read_b128 a[132:135], v18 offset:1024
    ds_read_b128 a[136:139], v18 offset:2048
    ds_read_b128 a[140:143], v18 offset:3072
    ds_read_b128 a[144:147], v18 offset:4096
    ds_read_b128 a[148:151], v18 offset:5120
    ds_read_b128 a[152:155], v18 offset:6144
    ds_read_b128 a[156:159], v18 offset:7168
    s_waitcnt lgkmcnt(0)
    s_branch L_t1_start
L_C1_slow_9:
    s_mov_b32 s99, 0
L_C1_slow_9_l:
    s_sleep 4
    buffer_load_dword v3, v4, s[8:11], s23 offen sc0 sc1
    s_add_u32 s99, s99, 1
    s_waitcnt vmcnt(0)
    v_cmp_ne_u32 vcc, 0, v3
    s_cmp_eq_u64 vcc, -1
    s_cbranch_scc1 L_C1_ok_10
    s_cmp_lt_u32 s99, 200000
    s_cbranch_scc1 L_C1_slow_9_l
    s_branch L_C1_ok_10
L_F_slow_11:
    s_mov_b32 s99, 0
L_F_slow_11_l:
    s_sleep 4
    buffer_load_dword v3, v12, s[8:11], s71 offen sc0 sc1
    s_add_u32 s99, s99, 1
    s_waitcnt vmcnt(0)
    v_cmp_ne_u32 vcc, 0, v3
    s_cmp_eq_u64 vcc, -1
    s_cbranch_scc1 L_F_ok_12
    s_cmp_lt_u32 s99, 200000
    s_cbranch_scc1 L_F_slow_11_l
    s_branch L_F_ok_12
L_t2_redo:
    s_cmp_eq_u32 s25, 0
    s_cbranch_scc1 L_t2_max
    s_mov_b32 s25, 0
    v_mov_b32 v64, 0
    v_mov_b32 v65, 0
    v_mov_b32 v66, 0
    v_mov_b32 v67, 0
    v_mov_b32 v68, 0
    v_mov_b32 v69, 0
    v_mov_b32 v70, 0
    v_mov_b32 v71, 0
    v_mov_b32 v72, 0
    v_mov_b32 v73, 0
    v_mov_b32 v74, 0
    v_mov_b32 v75, 0
    v_mov_b32 v76, 0
    v_mov_b32 v77, 0
    v_mov_b32 v78, 0
    v_mov_b32 v79, 0
    s_nop 1
    s_branch L_t2_safe
L_t2_max:
    s_waitcnt vmcnt(0) lgkmcnt(0)
    s_barrier
    s_mov_b32 s25, 1
    s_and_b32 s100, s3, 1
    s_lshl_b32 s100, s100, 13
    s_sub_u32 s101, s81, s62
    s_add_u32 s101, s101, s100
    s_mov_b32 s14, s61
    s_mov_b32 s26, 0
    v_mov_b32 v24, -1
    v_mov_b32 v25, -1
    v_mov_b32 v26, -1
    v_mov_b32 v27, -1
    v_mov_b32 v48, 0xff800000
    v_mov_b32 v49, 0xff800000
    v_mov_b32 v50, 0xff800000
    v_mov_b32 v51, 0xff800000
L_t2_maxl:
    s_cmp_eq_u32 s14, 0
    s_cbranch_scc1 L_t2_maxd
    s_add_u32 s100, s101, 0
    buffer_load_dwordx4 a[128:131], v1, s[8:11], s100 offen offset:0
    buffer_load_dwordx4 a[132:135], v1, s[8:11], s100 offen offset:1024
    buffer_load_dwordx4 a[136:139], v1, s[8:11], s100 offen offset:2048
    buffer_load_dwordx4 a[140:143], v1, s[8:11], s100 offen offset:3072
    buffer_load_dwordx4 a[144:147], v15, s[8:11], s100 offen offset:0
    buffer_load_dwordx4 a[148:151], v15, s[8:11], s100 offen offset:1024
    buffer_load_dwordx4 a[152:155], v15, s[8:11], s100 offen offset:2048
    buffer_load_dwordx4 a[156:159], v15, s[8:11], s100 offen offset:3072
    s_waitcnt vmcnt(7)
    v_mfma_f32_16x16x32_bf16 v[96:99], a[128:131], a[192:195], v[64:67]
    s_waitcnt vmcnt(6)
    v_mfma_f32_16x16x32_bf16 v[96:99], a[132:135], a[196:199], v[96:99]
    s_waitcnt vmcnt(5)
    v_mfma_f32_16x16x32_bf16 v[96:99], a[136:139], a[200:203], v[96:99]
    s_waitcnt vmcnt(4)
    v_mfma_f32_16x16x32_bf16 v[96:99], a[140:143], a[204:207], v[96:99]
    v_mfma_f32_16x16x32_bf16 v[104:107], a[128:131], a[208:211], v[68:71]
    v_mfma_f32_16x16x32_bf16 v[104:107], a[132:135], a[212:215], v[104:107]
    v_mfma_f32_16x16x32_bf16 v[104:107], a[136:139], a[216:219], v[104:107]
    v_mfma_f32_16x16x32_bf16 v[104:107], a[140:143], a[220:223], v[104:107]
    s_waitcnt vmcnt(3)
    v_mfma_f32_16x16x32_bf16 v[100:103], a[144:147], a[192:195], v[64:67]
    s_waitcnt vmcnt(2)
    v_mfma_f32_16x16x32_bf16 v[100:103], a[148:151], a[196:199], v[100:103]
    s_waitcnt vmcnt(1)
    v_mfma_f32_16x16x32_bf16 v[100:103], a[152:155], a[200:203], v[100:103]
    s_waitcnt vmcnt(0)
    v_mfma_f32_16x16x32_bf16 v[100:103], a[156:159], a[204:207], v[100:103]
    v_mfma_f32_16x16x32_bf16 v[108:111], a[144:147], a[208:211], v[68:71]
    v_mfma_f32_16x16x32_bf16 v[108:111], a[148:151], a[212:215], v[108:111]
    v_mfma_f32_16x16x32_bf16 v[108:111], a[152:155], a[216:219], v[108:111]
    v_mfma_f32_16x16x32_bf16 v[108:111], a[156:159], a[220:223], v[108:111]
    v_mfma_f32_16x16x32_bf16 v[112:115], a[128:131], a[224:227], v[72:75]
    v_mfma_f32_16x16x32_bf16 v[112:115], a[132:135], a[228:231], v[112:115]
    v_mfma_f32_16x16x32_bf16 v[112:115], a[136:139], a[232:235], v[112:115]
    v_mfma_f32_16x16x32_bf16 v[112:115], a[140:143], a[236:239], v[112:115]
    v_mfma_f32_16x16x32_bf16 v[120:123], a[128:131], a[240:243], v[76:79]
    v_mfma_f32_16x16x32_bf16 v[120:123], a[132:135], a[244:247], v[120:123]
    v_mfma_f32_16x16x32_bf16 v[120:123], a[136:139], a[248:251], v[120:123]
    v_mfma_f32_16x16x32_bf16 v[120:123], a[140:143], a[252:255], v[120:123]
    v_mfma_f32_16x16x32_bf16 v[116:119], a[144:147], a[224:227], v[72:75]
    v_mfma_f32_16x16x32_bf16 v[116:119], a[148:151], a[228:231], v[116:119]
    v_mfma_f32_16x16x32_bf16 v[116:119], a[152:155], a[232:235], v[116:119]
    v_mfma_f32_16x16x32_bf16 v[116:119], a[156:159], a[236:239], v[116:119]
    v_mfma_f32_16x16x32_bf16 v[124:127], a[144:147], a[240:243], v[76:79]
    v_mfma_f32_16x16x32_bf16 v[124:127], a[148:151], a[244:247], v[124:127]
    v_mfma_f32_16x16x32_bf16 v[124:127], a[152:155], a[248:251], v[124:127]
    v_mfma_f32_16x16x32_bf16 v[124:127], a[156:159], a[252:255], v[124:127]
    v_max3_f32 v48, v48, v96, v97
    v_max3_f32 v48, v48, v98, v99
    v_max3_f32 v48, v48, v100, v101
    v_max3_f32 v48, v48, v102, v103
    v_max3_f32 v49, v49, v104, v105
    v_max3_f32 v49, v49, v106, v107
    v_max3_f32 v49, v49, v108, v109
    v_max3_f32 v49, v49, v110, v111
    v_max3_f32 v50, v50, v112, v113
    v_max3_f32 v50, v50, v114, v115
    v_max3_f32 v50, v50, v116, v117
    v_max3_f32 v50, v50, v118, v119
    v_max3_f32 v51, v51, v120, v121
    v_max3_f32 v51, v51, v122, v123
    v_max3_f32 v51, v51, v124, v125
    v_max3_f32 v51, v51, v126, v127
    s_add_u32 s100, s101, 16384
    buffer_load_dwordx4 a[128:131], v1, s[8:11], s100 offen offset:0
    buffer_load_dwordx4 a[132:135], v1, s[8:11], s100 offen offset:1024
    buffer_load_dwordx4 a[136:139], v1, s[8:11], s100 offen offset:2048
    buffer_load_dwordx4 a[140:143], v1, s[8:11], s100 offen offset:3072
    buffer_load_dwordx4 a[144:147], v15, s[8:11], s100 offen offset:0
    buffer_load_dwordx4 a[148:151], v15, s[8:11], s100 offen offset:1024
    buffer_load_dwordx4 a[152:155], v15, s[8:11], s100 offen offset:2048
    buffer_load_dwordx4 a[156:159], v15, s[8:11], s100 offen offset:3072
    s_waitcnt vmcnt(7)
    v_mfma_f32_16x16x32_bf16 v[96:99], a[128:131], a[192:195], v[64:67]
    s_waitcnt vmcnt(6)
    v_mfma_f32_16x16x32_bf16 v[96:99], a[132:135], a[196:199], v[96:99]
    s_waitcnt vmcnt(5)
    v_mfma_f32_16x16x32_bf16 v[96:99], a[136:139], a[200:203], v[96:99]
    s_waitcnt vmcnt(4)
    v_mfma_f32_16x16x32_bf16 v[96:99], a[140:143], a[204:207], v[96:99]
    v_mfma_f32_16x16x32_bf16 v[104:107], a[128:131], a[208:211], v[68:71]
    v_mfma_f32_16x16x32_bf16 v[104:107], a[132:135], a[212:215], v[104:107]
    v_mfma_f32_16x16x32_bf16 v[104:107], a[136:139], a[216:219], v[104:107]
    v_mfma_f32_16x16x32_bf16 v[104:107], a[140:143], a[220:223], v[104:107]
    s_waitcnt vmcnt(3)
    v_mfma_f32_16x16x32_bf16 v[100:103], a[144:147], a[192:195], v[64:67]
    s_waitcnt vmcnt(2)
    v_mfma_f32_16x16x32_bf16 v[100:103], a[148:151], a[196:199], v[100:103]
    s_waitcnt vmcnt(1)
    v_mfma_f32_16x16x32_bf16 v[100:103], a[152:155], a[200:203], v[100:103]
    s_waitcnt vmcnt(0)
    v_mfma_f32_16x16x32_bf16 v[100:103], a[156:159], a[204:207], v[100:103]
    v_mfma_f32_16x16x32_bf16 v[108:111], a[144:147], a[208:211], v[68:71]
    v_mfma_f32_16x16x32_bf16 v[108:111], a[148:151], a[212:215], v[108:111]
    v_mfma_f32_16x16x32_bf16 v[108:111], a[152:155], a[216:219], v[108:111]
    v_mfma_f32_16x16x32_bf16 v[108:111], a[156:159], a[220:223], v[108:111]
    v_mfma_f32_16x16x32_bf16 v[112:115], a[128:131], a[224:227], v[72:75]
    v_mfma_f32_16x16x32_bf16 v[112:115], a[132:135], a[228:231], v[112:115]
    v_mfma_f32_16x16x32_bf16 v[112:115], a[136:139], a[232:235], v[112:115]
    v_mfma_f32_16x16x32_bf16 v[112:115], a[140:143], a[236:239], v[112:115]
    v_mfma_f32_16x16x32_bf16 v[120:123], a[128:131], a[240:243], v[76:79]
    v_mfma_f32_16x16x32_bf16 v[120:123], a[132:135], a[244:247], v[120:123]
    v_mfma_f32_16x16x32_bf16 v[120:123], a[136:139], a[248:251], v[120:123]
    v_mfma_f32_16x16x32_bf16 v[120:123], a[140:143], a[252:255], v[120:123]
    v_mfma_f32_16x16x32_bf16 v[116:119], a[144:147], a[224:227], v[72:75]
    v_mfma_f32_16x16x32_bf16 v[116:119], a[148:151], a[228:231], v[116:119]
    v_mfma_f32_16x16x32_bf16 v[116:119], a[152:155], a[232:235], v[116:119]
    v_mfma_f32_16x16x32_bf16 v[116:119], a[156:159], a[236:239], v[116:119]
    v_mfma_f32_16x16x32_bf16 v[124:127], a[144:147], a[240:243], v[76:79]
    v_mfma_f32_16x16x32_bf16 v[124:127], a[148:151], a[244:247], v[124:127]
    v_mfma_f32_16x16x32_bf16 v[124:127], a[152:155], a[248:251], v[124:127]
    v_mfma_f32_16x16x32_bf16 v[124:127], a[156:159], a[252:255], v[124:127]
    v_max3_f32 v48, v48, v96, v97
    v_max3_f32 v48, v48, v98, v99
    v_max3_f32 v48, v48, v100, v101
    v_max3_f32 v48, v48, v102, v103
    v_max3_f32 v49, v49, v104, v105
    v_max3_f32 v49, v49, v106, v107
    v_max3_f32 v49, v49, v108, v109
    v_max3_f32 v49, v49, v110, v111
    v_max3_f32 v50, v50, v112, v113
    v_max3_f32 v50, v50, v114, v115
    v_max3_f32 v50, v50, v116, v117
    v_max3_f32 v50, v50, v118, v119
    v_max3_f32 v51, v51, v120, v121
    v_max3_f32 v51, v51, v122, v123
    v_max3_f32 v51, v51, v124, v125
    v_max3_f32 v51, v51, v126, v127
    s_add_u32 s101, s101, 65536
    s_sub_u32 s14, s14, 1
    s_nop 7
    s_branch L_t2_maxl
L_t2_maxd:
    s_add_u32 s100, s101, 0
    buffer_load_dwordx4 a[128:131], v1, s[8:11], s100 offen offset:0
    buffer_load_dwordx4 a[132:135], v1, s[8:11], s100 offen offset:1024
    buffer_load_dwordx4 a[136:139], v1, s[8:11], s100 offen offset:2048
    buffer_load_dwordx4 a[140:143], v1, s[8:11], s100 offen offset:3072
    buffer_load_dwordx4 a[144:147], v15, s[8:11], s100 offen offset:0
    buffer_load_dwordx4 a[148:151], v15, s[8:11], s100 offen offset:1024
    buffer_load_dwordx4 a[152:155], v15, s[8:11], s100 offen offset:2048
    buffer_load_dwordx4 a[156:159], v15, s[8:11], s100 offen offset:3072
    v_add_f32 v80, 0, v21
    v_min_f32 v80, v80, v64
    v_add_f32 v81, 0xf1800000, v21
    v_min_f32 v81, v81, v65
    v_add_f32 v82, 0xf2000000, v21
    v_min_f32 v82, v82, v66
    v_add_f32 v83, 0xf2400000, v21
    v_min_f32 v83, v83, v67
    v_add_f32 v84, 0xf3800000, v21
    v_min_f32 v84, v84, v64
    v_add_f32 v85, 0xf3880000, v21
    v_min_f32 v85, v85, v65
    v_add_f32 v86, 0xf3900000, v21
    v_min_f32 v86, v86, v66
    v_add_f32 v87, 0xf3980000, v21
    v_min_f32 v87, v87, v67
    v_add_f32 v88, 0x73800000, v21
    v_min_f32 v88, v88, v68
    v_add_f32 v89, 0x73700000, v21
    v_min_f32 v89, v89, v69
    v_add_f32 v90, 0x73600000, v21
    v_min_f32 v90, v90, v70
    v_add_f32 v91, 0x73500000, v21
    v_min_f32 v91, v91, v71
    v_add_f32 v92, 0, v21
    v_min_f32 v92, v92, v68
    v_add_f32 v93, 0xf1800000, v21
    v_min_f32 v93, v93, v69
    v_add_f32 v94, 0xf2000000, v21
    v_min_f32 v94, v94, v70
    v_add_f32 v95, 0xf2400000, v21
    v_min_f32 v95, v95, v71
    s_waitcnt vmcnt(7)
    v_mfma_f32_16x16x32_bf16 v[96:99], a[128:131], a[192:195], v[80:83]
    s_waitcnt vmcnt(6)
    v_mfma_f32_16x16x32_bf16 v[96:99], a[132:135], a[196:199], v[96:99]
    s_waitcnt vmcnt(5)
    v_mfma_f32_16x16x32_bf16 v[96:99], a[136:139], a[200:203], v[96:99]
    s_waitcnt vmcnt(4)
    v_mfma_f32_16x16x32_bf16 v[96:99], a[140:143], a[204:207], v[96:99]
    v_mfma_f32_16x16x32_bf16 v[104:107], a[128:131], a[208:211], v[88:91]
    v_mfma_f32_16x16x32_bf16 v[104:107], a[132:135], a[212:215], v[104:107]
    v_mfma_f32_16x16x32_bf16 v[104:107], a[136:139], a[216:219], v[104:107]
    v_mfma_f32_16x16x32_bf16 v[104:107], a[140:143], a[220:223], v[104:107]
    s_waitcnt vmcnt(3)
    v_mfma_f32_16x16x32_bf16 v[100:103], a[144:147], a[192:195], v[84:87]
    s_waitcnt vmcnt(2)
    v_mfma_f32_16x16x32_bf16 v[100:103], a[148:151], a[196:199], v[100:103]
    s_waitcnt vmcnt(1)
    v_mfma_f32_16x16x32_bf16 v[100:103], a[152:155], a[200:203], v[100:103]
    s_waitcnt vmcnt(0)
    v_mfma_f32_16x16x32_bf16 v[100:103], a[156:159], a[204:207], v[100:103]
    v_mfma_f32_16x16x32_bf16 v[108:111], a[144:147], a[208:211], v[92:95]
    v_mfma_f32_16x16x32_bf16 v[108:111], a[148:151], a[212:215], v[108:111]
    v_mfma_f32_16x16x32_bf16 v[108:111], a[152:155], a[216:219], v[108:111]
    v_mfma_f32_16x16x32_bf16 v[108:111], a[156:159], a[220:223], v[108:111]
    v_mfma_f32_16x16x32_bf16 v[112:115], a[128:131], a[224:227], v[72:75]
    v_mfma_f32_16x16x32_bf16 v[112:115], a[132:135], a[228:231], v[112:115]
    v_mfma_f32_16x16x32_bf16 v[112:115], a[136:139], a[232:235], v[112:115]
    v_mfma_f32_16x16x32_bf16 v[112:115], a[140:143], a[236:239], v[112:115]
    v_mfma_f32_16x16x32_bf16 v[120:123], a[128:131], a[240:243], v[76:79]
    v_mfma_f32_16x16x32_bf16 v[120:123], a[132:135], a[244:247], v[120:123]
    v_mfma_f32_16x16x32_bf16 v[120:123], a[136:139], a[248:251], v[120:123]
    v_mfma_f32_16x16x32_bf16 v[120:123], a[140:143], a[252:255], v[120:123]
    v_mfma_f32_16x16x32_bf16 v[116:119], a[144:147], a[224:227], v[72:75]
    v_mfma_f32_16x16x32_bf16 v[116:119], a[148:151], a[228:231], v[116:119]
    v_mfma_f32_16x16x32_bf16 v[116:119], a[152:155], a[232:235], v[116:119]
    v_mfma_f32_16x16x32_bf16 v[116:119], a[156:159], a[236:239], v[116:119]
    v_mfma_f32_16x16x32_bf16 v[124:127], a[144:147], a[240:243], v[76:79]
    v_mfma_f32_16x16x32_bf16 v[124:127], a[148:151], a[244:247], v[124:127]
    v_mfma_f32_16x16x32_bf16 v[124:127], a[152:155], a[248:251], v[124:127]
    v_mfma_f32_16x16x32_bf16 v[124:127], a[156:159], a[252:255], v[124:127]
    v_max3_f32 v48, v48, v96, v97
    v_max3_f32 v48, v48, v98, v99
    v_max3_f32 v48, v48, v100, v101
    v_max3_f32 v48, v48, v102, v103
    v_max3_f32 v49, v49, v104, v105
    v_max3_f32 v49, v49, v106, v107
    v_max3_f32 v49, v49, v108, v109
    v_max3_f32 v49, v49, v110, v111
    v_max3_f32 v50, v50, v112, v113
    v_max3_f32 v50, v50, v114, v115
    v_max3_f32 v50, v50, v116, v117
    v_max3_f32 v50, v50, v118, v119
    v_max3_f32 v51, v51, v120, v121
    v_max3_f32 v51, v51, v122, v123
    v_max3_f32 v51, v51, v124, v125
    v_max3_f32 v51, v51, v126, v127
    s_add_u32 s100, s101, 16384
    buffer_load_dwordx4 a[128:131], v1, s[8:11], s100 offen offset:0
    buffer_load_dwordx4 a[132:135], v1, s[8:11], s100 offen offset:1024
    buffer_load_dwordx4 a[136:139], v1, s[8:11], s100 offen offset:2048
    buffer_load_dwordx4 a[140:143], v1, s[8:11], s100 offen offset:3072
    buffer_load_dwordx4 a[144:147], v15, s[8:11], s100 offen offset:0
    buffer_load_dwordx4 a[148:151], v15, s[8:11], s100 offen offset:1024
    buffer_load_dwordx4 a[152:155], v15, s[8:11], s100 offen offset:2048
    buffer_load_dwordx4 a[156:159], v15, s[8:11], s100 offen offset:3072
    v_add_f32 v80, 0, v22
    v_min_f32 v80, v80, v72
    v_add_f32 v81, 0xf1800000, v22
    v_min_f32 v81, v81, v73
    v_add_f32 v82, 0xf2000000, v22
    v_min_f32 v82, v82, v74
    v_add_f32 v83, 0xf2400000, v22
    v_min_f32 v83, v83, v75
    v_add_f32 v84, 0xf3800000, v22
    v_min_f32 v84, v84, v72
    v_add_f32 v85, 0xf3880000, v22
    v_min_f32 v85, v85, v73
    v_add_f32 v86, 0xf3900000, v22
    v_min_f32 v86, v86, v74
    v_add_f32 v87, 0xf3980000, v22
    v_min_f32 v87, v87, v75
    v_add_f32 v88, 0x73800000, v22
    v_min_f32 v88, v88, v76
    v_add_f32 v89, 0x73700000, v22
    v_min_f32 v89, v89, v77
    v_add_f32 v90, 0x73600000, v22
    v_min_f32 v90, v90, v78
    v_add_f32 v91, 0x73500000, v22
    v_min_f32 v91, v91, v79
    v_add_f32 v92, 0, v22
    v_min_f32 v92, v92, v76
    v_add_f32 v93, 0xf1800000, v22
    v_min_f32 v93, v93, v77
    v_add_f32 v94, 0xf2000000, v22
    v_min_f32 v94, v94, v78
    v_add_f32 v95, 0xf2400000, v22
    v_min_f32 v95, v95, v79
    s_waitcnt vmcnt(7)
    v_mfma_f32_16x16x32_bf16 v[96:99], a[128:131], a[224:227], v[80:83]
    s_waitcnt vmcnt(6)
    v_mfma_f32_16x16x32_bf16 v[96:99], a[132:135], a[228:231], v[96:99]
    s_waitcnt vmcnt(5)
    v_mfma_f32_16x16x32_bf16 v[96:99], a[136:139], a[232:235], v[96:99]
    s_waitcnt vmcnt(4)
    v_mfma_f32_16x16x32_bf16 v[96:99], a[140:143], a[236:239], v[96:99]
    v_mfma_f32_16x16x32_bf16 v[104:107], a[128:131], a[240:243], v[88:91]
    v_mfma_f32_16x16x32_bf16 v[104:107], a[132:135], a[244:247], v[104:107]
    v_mfma_f32_16x16x32_bf16 v[104:107], a[136:139], a[248:251], v[104:107]
    v_mfma_f32_16x16x32_bf16 v[104:107], a[140:143], a[252:255], v[104:107]
    s_waitcnt vmcnt(3)
    v_mfma_f32_16x16x32_bf16 v[100:103], a[144:147], a[224:227], v[84:87]
    s_waitcnt vmcnt(2)
    v_mfma_f32_16x16x32_bf16 v[100:103], a[148:151], a[228:231], v[100:103]
    s_waitcnt vmcnt(1)
    v_mfma_f32_16x16x32_bf16 v[100:103], a[152:155], a[232:235], v[100:103]
    s_waitcnt vmcnt(0)
    v_mfma_f32_16x16x32_bf16 v[100:103], a[156:159], a[236:239], v[100:103]
    v_mfma_f32_16x16x32_bf16 v[108:111], a[144:147], a[240:243], v[92:95]
    v_mfma_f32_16x16x32_bf16 v[108:111], a[148:151], a[244:247], v[108:111]
    v_mfma_f32_16x16x32_bf16 v[108:111], a[152:155], a[248:251], v[108:111]
    v_mfma_f32_16x16x32_bf16 v[108:111], a[156:159], a[252:255], v[108:111]
    v_max3_f32 v50, v50, v96, v97
    v_max3_f32 v50, v50, v98, v99
    s_nop 1
    v_max3_f32 v50, v50, v100, v101
    v_max3_f32 v50, v50, v102, v103
    v_max3_f32 v51, v51, v104, v105
    v_max3_f32 v51, v51, v106, v107
    v_max3_f32 v51, v51, v108, v109
    v_max3_f32 v51, v51, v110, v111
    v_mov_b32 v52, v48
    v_mov_b32 v53, v49
    v_mov_b32 v54, v50
    v_mov_b32 v55, v51
    v_permlane16_swap_b32 v48, v52
    v_permlane16_swap_b32 v49, v53
    v_permlane16_swap_b32 v50, v54
    v_permlane16_swap_b32 v51, v55
    v_max_f32 v48, v48, v52
    v_max_f32 v49, v49, v53
    v_max_f32 v50, v50, v54
    v_max_f32 v51, v51, v55
    v_mov_b32 v52, v48
    v_mov_b32 v53, v49
    v_mov_b32 v54, v50
    v_mov_b32 v55, v51
    v_permlane32_swap_b32 v48, v52
    v_permlane32_swap_b32 v49, v53
    v_permlane32_swap_b32 v50, v54
    v_permlane32_swap_b32 v51, v55
    v_max_f32 v48, v48, v52
    v_max_f32 v49, v49, v53
    v_max_f32 v50, v50, v54
    v_max_f32 v51, v51, v55
    ds_write_b128 v16, v[48:51] offset:32768
    v_xor_b32 v8, 8192, v16
    s_waitcnt lgkmcnt(0)
    s_barrier
    ds_read_b128 v[52:55], v8 offset:32768
    s_waitcnt lgkmcnt(0)
    v_max_f32 v48, v48, v52
    v_max_f32 v49, v49, v53
    v_max_f32 v50, v50, v54
    v_max_f32 v51, v51, v55
    v_sub_f32 v64, 0, v48
    v_sub_f32 v65, 0, v48
    v_sub_f32 v66, 0, v48
    v_sub_f32 v67, 0, v48
    v_sub_f32 v68, 0, v49
    v_sub_f32 v69, 0, v49
    v_sub_f32 v70, 0, v49
    v_sub_f32 v71, 0, v49
    v_sub_f32 v72, 0, v50
    v_sub_f32 v73, 0, v50
    v_sub_f32 v74, 0, v50
    v_sub_f32 v75, 0, v50
    v_sub_f32 v76, 0, v51
    v_sub_f32 v77, 0, v51
    v_sub_f32 v78, 0, v51
    v_sub_f32 v79, 0, v51
    s_add_u32 s12, s13, 1
    s_and_b32 s100, s12, 1
    s_mul_i32 s15, s100, 196608
    s_xor_b32 s15, s15, 65536
    s_mul_i32 s16, s100, 98304
    s_xor_b32 s16, s16, 98304
    v_and_b32 v18, 0x7fff, v18
    v_or_b32 v18, s15, v18
    v_and_b32 v19, 0x7fff, v19
    v_or_b32 v19, s16, v19
    v_and_b32 v20, 0x7fff, v20
    v_or_b32 v20, s16, v20
    s_add_u32 s15, s15, s62
    s_add_u32 s16, s16, s62
    s_add_u32 s12, s12, 2
    s_mov_b32 s82, s81
    s_add_u32 s19, s81, 32768
    s_add_u32 m0, s15, 0
    s_nop 0
    buffer_load_dwordx4 v1, s[8:11], s82 offen offset:0 lds
    buffer_load_dwordx4 v1, s[8:11], s82 offen offset:1024 lds
    buffer_load_dwordx4 v1, s[8:11], s82 offen offset:2048 lds
    buffer_load_dwordx4 v1, s[8:11], s82 offen offset:3072 lds
    s_add_u32 m0, s15, 4096
    s_nop 0
    buffer_load_dwordx4 v15, s[8:11], s82 offen offset:0 lds
    buffer_load_dwordx4 v15, s[8:11], s82 offen offset:1024 lds
    buffer_load_dwordx4 v15, s[8:11], s82 offen offset:2048 lds
    buffer_load_dwordx4 v15, s[8:11], s82 offen offset:3072 lds
    s_xor_b32 s15, s15, 196608
    s_add_u32 m0, s16, 0
    s_nop 0
    buffer_load_dwordx4 v1, s[8:11], s19 offen offset:0 lds
    buffer_load_dwordx4 v1, s[8:11], s19 offen offset:1024 lds
    buffer_load_dwordx4 v1, s[8:11], s19 offen offset:2048 lds
    buffer_load_dwordx4 v1, s[8:11], s19 offen offset:3072 lds
    s_add_u32 m0, s16, 4096
    s_nop 0
    buffer_load_dwordx4 v15, s[8:11], s19 offen offset:0 lds
    buffer_load_dwordx4 v15, s[8:11], s19 offen offset:1024 lds
    buffer_load_dwordx4 v15, s[8:11], s19 offen offset:2048 lds
    buffer_load_dwordx4 v15, s[8:11], s19 offen offset:3072 lds
    s_xor_b32 s16, s16, 98304
    s_min_u32 s82, s61, 1
    s_lshl_b32 s82, s82, 16
    s_add_u32 s82, s82, s81
    s_add_u32 m0, s15, 0
    s_nop 0
    buffer_load_dwordx4 v1, s[8:11], s82 offen offset:0 lds
    buffer_load_dwordx4 v1, s[8:11], s82 offen offset:1024 lds
    buffer_load_dwordx4 v1, s[8:11], s82 offen offset:2048 lds
    buffer_load_dwordx4 v1, s[8:11], s82 offen offset:3072 lds
    s_add_u32 m0, s15, 4096
    s_nop 0
    buffer_load_dwordx4 v15, s[8:11], s82 offen offset:0 lds
    buffer_load_dwordx4 v15, s[8:11], s82 offen offset:1024 lds
    buffer_load_dwordx4 v15, s[8:11], s82 offen offset:2048 lds
    buffer_load_dwordx4 v15, s[8:11], s82 offen offset:3072 lds
    s_xor_b32 s15, s15, 196608
    s_waitcnt vmcnt(0) lgkmcnt(0)
    s_barrier
    ds_read_b128 a[128:131], v18 offset:0
    ds_read_b128 a[132:135], v18 offset:1024
    ds_read_b128 a[136:139], v18 offset:2048
    ds_read_b128 a[140:143], v18 offset:3072
    ds_read_b128 a[144:147], v18 offset:4096
    ds_read_b128 a[148:151], v18 offset:5120
    ds_read_b128 a[152:155], v18 offset:6144
    ds_read_b128 a[156:159], v18 offset:7168
    s_waitcnt lgkmcnt(0)
    s_branch L_t2_start
L_C2_slow_13:
    s_mov_b32 s99, 0
L_C2_slow_13_l:
    s_sleep 4
    buffer_load_dword v3, v4, s[8:11], s23 offen sc0 sc1
    s_add_u32 s99, s99, 1
    s_waitcnt vmcnt(0)
    v_cmp_ne_u32 vcc, 0, v3
    s_cmp_eq_u64 vcc, -1
    s_cbranch_scc1 L_C2_ok_14
    s_cmp_lt_u32 s99, 200000
    s_cbranch_scc1 L_C2_slow_13_l
    s_branch L_C2_ok_14
L_P1_slow_15:
    s_mov_b32 s99, 0
L_P2_l_5001:
    s_waitcnt vmcnt(0)
    v_max_u32 v48, v128, v129
    v_max3_u32 v48, v48, v130, v131
    v_max_u32 v49, v132, v133
    v_max3_u32 v49, v49, v134, v135
    v_max_u32 v50, v136, v137
    v_max3_u32 v50, v50, v138, v139
    v_max_u32 v51, v140, v141
    v_max3_u32 v51, v51, v142, v143
    v_max_u32 v52, v144, v145
    v_max3_u32 v52, v52, v146, v147
    v_max_u32 v53, v148, v149
    v_max3_u32 v53, v53, v150, v151
    v_max_u32 v54, v152, v153
    v_max3_u32 v54, v54, v154, v155
    v_max_u32 v55, v156, v157
    v_max3_u32 v55, v55, v158, v159
    v_max3_u32 v3, v48, v49, v50
    v_max3_u32 v3, v3, v51, v52
    v_max3_u32 v3, v3, v53, v54
    v_max_u32 v3, v3, v55
    v_cmp_eq_u32 vcc, -1, v3
    s_add_u32 s99, s99, 1
    s_cbranch_vccz L_P2_ok_5002
    s_cmp_ge_u32 s99, 200000
    s_cbranch_scc1 L_P2_ok_5002
    s_sleep 1
    v_cmp_eq_u32 vcc, -1, v48
    s_cbranch_vccz L_P2_s_5003
    s_and_b64 s[96:97], vcc, s[12:13]
    s_cselect_b64 exec, s[96:97], vcc
    s_add_u32 s74, s70, 0
    buffer_load_dwordx4 v[128:131], v44, s[8:11], s74 offen sc0 sc1
    s_mov_b64 exec, -1
L_P2_s_5003:
    v_cmp_eq_u32 vcc, -1, v49
    s_cbranch_vccz L_P2_s_5004
    s_and_b64 s[96:97], vcc, s[12:13]
    s_cselect_b64 exec, s[96:97], vcc
    s_add_u32 s74, s70, 4096
    buffer_load_dwordx4 v[132:135], v44, s[8:11], s74 offen sc0 sc1
    s_mov_b64 exec, -1
L_P2_s_5004:
    v_cmp_eq_u32 vcc, -1, v50
    s_cbranch_vccz L_P2_s_5005
    s_and_b64 s[96:97], vcc, s[12:13]
    s_cselect_b64 exec, s[96:97], vcc
    s_add_u32 s74, s70, 8192
    buffer_load_dwordx4 v[136:139], v44, s[8:11], s74 offen sc0 sc1
    s_mov_b64 exec, -1
L_P2_s_5005:
    v_cmp_eq_u32 vcc, -1, v51
    s_cbranch_vccz L_P2_s_5006
    s_and_b64 s[96:97], vcc, s[12:13]
    s_cselect_b64 exec, s[96:97], vcc
    s_add_u32 s74, s70, 12288
    buffer_load_dwordx4 v[140:143], v44, s[8:11], s74 offen sc0 sc1
    s_mov_b64 exec, -1
L_P2_s_5006:
    v_cmp_eq_u32 vcc, -1, v52
    s_cbranch_vccz L_P2_s_5007
    s_and_b64 s[96:97], vcc, s[12:13]
    s_cselect_b64 exec, s[96:97], vcc
    s_add_u32 s74, s70, 16384
    buffer_load_dwordx4 v[144:147], v44, s[8:11], s74 offen sc0 sc1
    s_mov_b64 exec, -1
L_P2_s_5007:
    v_cmp_eq_u32 vcc, -1, v53
    s_cbranch_vccz L_P2_s_5008
    s_and_b64 s[96:97], vcc, s[12:13]
    s_cselect_b64 exec, s[96:97], vcc
    s_add_u32 s74, s70, 20480
    buffer_load_dwordx4 v[148:151], v44, s[8:11], s74 offen sc0 sc1
    s_mov_b64 exec, -1
L_P2_s_5008:
    v_cmp_eq_u32 vcc, -1, v54
    s_cbranch_vccz L_P2_s_5009
    s_and_b64 s[96:97], vcc, s[12:13]
    s_cselect_b64 exec, s[96:97], vcc
    s_add_u32 s74, s70, 24576
    buffer_load_dwordx4 v[152:155], v44, s[8:11], s74 offen sc0 sc1
    s_mov_b64 exec, -1
L_P2_s_5009:
    v_cmp_eq_u32 vcc, -1, v55
    s_cbranch_vccz L_P2_s_5010
    s_and_b64 s[96:97], vcc, s[12:13]
    s_cselect_b64 exec, s[96:97], vcc
    s_add_u32 s74, s70, 28672
    buffer_load_dwordx4 v[156:159], v44, s[8:11], s74 offen sc0 sc1
    s_mov_b64 exec, -1
L_P2_s_5010:
    s_branch L_P2_l_5001
L_P2_ok_5002:
    s_branch L_P1_ok_16
L_code_end:
    s_endpgm
.section .rodata,"a"
.p2align 6
.amdhsa_kernel adaLN_cond__compressed_kv_cla__moe_arch_mod__prompt_kernel
  .amdhsa_next_free_vgpr 512
  .amdhsa_next_free_sgpr 102
  .amdhsa_accum_offset 256
  .amdhsa_group_segment_fixed_size 0
  .amdhsa_kernarg_size 128
  .amdhsa_user_sgpr_count 2
  .amdhsa_user_sgpr_kernarg_segment_ptr 1
  .amdhsa_system_sgpr_workgroup_id_x 1
.end_amdhsa_kernel
```

```asm
; @launch grid=(256,1,1) block=(256,1,1) lds=163840
.amdgcn_target "amdgcn-amd-amdhsa--gfx950"
.text
.globl adaLN_cond__compressed_kv_cla__moe_arch_mod__prompt_kernel
.p2align 8
.type adaLN_cond__compressed_kv_cla__moe_arch_mod__prompt_kernel,@function
adaLN_cond__compressed_kv_cla__moe_arch_mod__prompt_kernel:
    s_cmp_ge_u32 s2, 256
    s_cbranch_scc1 L_end
    s_load_dwordx16 s[64:79], s[0:1], 0
    s_load_dwordx16 s[80:95], s[0:1], 64
    s_getpc_b64 s[100:101]
L_pf1:
    v_lshrrev_b32 v3, 6, v0
    v_and_b32 v2, 63, v0
    s_lshr_b32 s5, s2, 3
    s_mul_i32 s98, s5, 24
    v_min_u32 v5, 5, v2
    v_mad_u32_u24 v5, v3, 6, v5
    v_add_u32 v5, s98, v5
    v_lshlrev_b32 v5, 7, v5
    v_min_u32 v5, L_code_end-L_pf1, v5
    global_load_dword a255, v5, s[100:101]
    v_readfirstlane_b32 s3, v3
    v_lshlrev_b32 v1, 4, v2
    s_and_b32 s4, s2, 7
    s_and_b32 s5, s5, 3
    s_lshr_b32 s6, s2, 5
    s_lshl_b32 s7, s4, 2
    s_add_u32 s7, s7, s5
    s_mov_b32 s60, s6
    s_sub_u32 s61, 15, s6
    v_lshrrev_b32 v3, 3, v2
    v_lshrrev_b32 v4, 4, v2
    v_and_b32 v5, 7, v2
    v_xor_b32 v5, v5, v4
    v_lshlrev_b32 v5, 4, v5
    v_lshl_add_u32 v16, v3, 10, v5
    v_xor_b32 v17, 64, v16
    v_add_u32 v17, 7168, v17
    v_add_u32 v18, 14336, v16
    v_add_u32 v19, 14336, v17
    v_bfe_u32 v5, v2, 1, 3
    v_xor_b32 v5, v5, v4
    v_lshlrev_b32 v5, 5, v5
    v_and_b32 v6, 1, v2
    v_lshl_add_u32 v5, v6, 4, v5
    v_lshl_add_u32 v20, v4, 13, v5
    v_add_u32 v21, 31744, v20
    v_xor_b32 v22, 128, v20
    v_add_u32 v22, 63488, v22
    v_add_u32 v23, 31744, v22
    s_lshl_b32 s62, s3, 13
    s_lshl_b32 s63, s3, 12
    s_lshl_b32 s96, s6, 18
    s_lshl_b32 s98, s3, 16
    s_add_u32 s96, s96, s98
    s_lshl_b32 s97, s3, 17
    s_lshl_b32 s99, s5, 0
    s_xor_b32 s99, s99, s6
    s_lshl_b32 s99, s99, 3
    s_and_b32 s99, s99, 7
    s_lshl_b32 s98, s99, 7
    s_add_u32 s96, s96, s98
    s_lshl_b32 s98, s99, 19
    s_add_u32 s97, s97, s98
    v_and_b32 v84, 7, v2
    v_lshrrev_b32 v65, 3, v0
    v_mul_u32_u24 v64, 24576, v65
    v_lshl_add_u32 v64, v84, 4, v64
    v_lshlrev_b32 v65, 3, v65
    v_lshrrev_b32 v85, 3, v2
    v_lshlrev_b32 v86, 10, v84
    v_lshl_add_u32 v86, v85, 4, v86
    s_lshl_b32 s100, s7, 8
    s_waitcnt lgkmcnt(0)
    s_add_u32 s16, s70, s100
    s_addc_u32 s17, s71, 0
    s_sub_u32 s18, 4194304, s100
    s_mov_b32 s19, 0x00020000
    s_mov_b32 s12, s66
    s_mov_b32 s13, s67
    s_mov_b32 s14, 2097152
    s_mov_b32 s15, 0x00020000
    s_add_u32 m0, s63, 98304
    s_xor_b32 s98, s97, 0
    buffer_load_dwordx4 v20, s[16:19], s98 offen offset:0  lds
    buffer_load_dwordx4 v21, s[16:19], s98 offen offset:1024  lds
    buffer_load_dwordx4 v22, s[16:19], s98 offen offset:2048  lds
    buffer_load_dwordx4 v23, s[16:19], s98 offen offset:3072  lds
    s_add_u32 m0, s62, 0
    s_xor_b32 s98, s96, 0
    buffer_load_dwordx4 v16, s[12:15], s98 offen offset:0  lds
    buffer_load_dwordx4 v17, s[12:15], s98 offen offset:1024  lds
    buffer_load_dwordx4 v18, s[12:15], s98 offen offset:2048  lds
    buffer_load_dwordx4 v19, s[12:15], s98 offen offset:3072  lds
    s_add_u32 m0, s62, 4096
    s_xor_b32 s98, s96, 32768
    buffer_load_dwordx4 v16, s[12:15], s98 offen offset:0  lds
    buffer_load_dwordx4 v17, s[12:15], s98 offen offset:1024  lds
    buffer_load_dwordx4 v18, s[12:15], s98 offen offset:2048  lds
    buffer_load_dwordx4 v19, s[12:15], s98 offen offset:3072  lds
    s_mov_b32 s40, s88
    s_mov_b32 s41, s89
    s_mov_b32 s42, 3145728
    s_mov_b32 s43, 0x00020000
    s_mov_b32 s44, s86
    s_mov_b32 s45, s87
    s_mov_b32 s46, 1024
    s_mov_b32 s47, 0x00020000
    s_mov_b32 s32, s64
    s_mov_b32 s33, s65
    s_mov_b32 s34, 2097152
    s_mov_b32 s35, 0x00020000
    s_mov_b32 s8, s94
    s_mov_b32 s9, s95
    s_mov_b32 s10, 268435456
    s_mov_b32 s11, 0x00020000
    s_add_u32 s20, s72, s100
    s_addc_u32 s21, s73, 0
    s_sub_u32 s22, 4194304, s100
    s_mov_b32 s23, 0x00020000
    s_add_u32 s24, s68, s100
    s_addc_u32 s25, s69, 0
    s_sub_u32 s26, 4194304, s100
    s_mov_b32 s27, 0x00020000
    s_mov_b32 s36, s92
    s_mov_b32 s37, s93
    s_mov_b32 s38, 256
    s_mov_b32 s39, 0x00020000
    s_lshl_b32 s100, s4, 19
    s_lshl_b32 s99, s5, 8
    s_add_u32 s100, s100, s99
    s_add_u32 s28, s74, s100
    s_addc_u32 s29, s75, 0
    s_sub_u32 s30, 4194304, s100
    s_mov_b32 s31, 0x00020000
    s_mov_b32 s48, s84
    s_mov_b32 s49, s85
    s_mov_b32 s50, 1835008
    s_mov_b32 s51, 0x00020000
    s_mov_b32 s52, s90
    s_mov_b32 s53, s91
    s_mov_b32 s54, 2097152
    s_mov_b32 s55, 0x00020000
    s_mov_b64 s[92:93], s[80:81]
    s_mov_b64 s[94:95], s[82:83]
    s_mov_b32 s56, s78
    s_mov_b32 s57, s79
    s_mov_b32 s58, 1024
    s_mov_b32 s59, 0x00020000
    s_load_dword s90, s[36:37], 64
    s_load_dword s91, s[8:9], 0x3f00
    s_lshl_b32 s64, s3, 19
    s_and_b32 s100, s97, 3670016
    s_xor_b32 s64, s64, s100
    s_lshr_b32 s100, s6, 1
    s_and_b32 s100, s100, 0
    s_lshl_b32 s1, s100, 12
    s_lshl_b32 s100, s100, 7
    s_add_u32 s64, s64, s100
    s_lshl_b32 s100, s5, 1
    s_xor_b32 s100, s100, s6
    s_and_b32 s100, s100, 0
    s_lshl_b32 s68, s100, 11
    s_lshl_b32 s100, s100, 19
    s_lshl_b32 s0, s3, 17
    s_add_u32 s0, s0, s100
    s_lshl_b32 s81, s7, 20
    s_add_u32 s81, s81, 16777216
    s_lshl_b32 s100, s6, 17
    s_add_u32 s65, s81, s100
    s_lshr_b32 s100, s3, 1
    s_lshl_b32 s100, s100, 16
    s_add_u32 s65, s65, s100
    s_and_b32 s100, s3, 1
    s_lshl_b32 s100, s100, 14
    s_add_u32 s65, s65, s100
    s_add_u32 s81, s81, s62
    s_min_u32 s82, s60, 1
    s_lshl_b32 s82, s82, 16
    s_add_u32 s82, s82, s81
    s_sub_u32 s100, s6, 2
    s_lshl_b32 s69, s100, 7
    s_lshl_b32 s100, s100, 3
    s_add_u32 s100, s100, s4
    s_lshl_b32 s100, s100, 8
    s_mul_i32 s101, s5, 12288
    s_add_u32 s100, s100, s101
    s_add_u32 s100, s100, 16384
    s_cmp_ge_u32 s6, 2
    s_cselect_b32 s66, s100, 2147479552
    s_cselect_b32 s69, s69, 2147479552
    s_cmp_eq_u32 s3, 0
    s_cselect_b32 s66, s66, 2147479552
    s_lshl_b32 s70, s3, 9
    s_add_u32 s70, s70, 16384
    s_lshr_b32 s71, s2, 1
    s_lshl_b32 s71, s71, 14
    s_and_b32 s100, s2, 1
    s_lshl_b32 s100, s100, 7
    s_add_u32 s71, s71, s100
    s_add_u32 s71, s71, s63
    s_add_u32 s71, s71, 2097152
    s_lshl_b32 s72, s2, 2
    s_add_u32 s72, s72, s3
    s_lshl_b32 s72, s72, 6
    s_add_u32 s72, s72, 1048576
    s_lshl_b32 s74, s7, 11
    s_add_u32 s74, s74, 1114112
    s_lshl_b32 s73, s6, 2
    s_add_u32 s73, s73, s3
    s_lshl_b32 s73, s73, 6
    s_add_u32 s73, s73, s74
    s_lshr_b32 s100, s3, 1
    s_sub_u32 s101, 3, s100
    s_and_b32 s98, s3, 1
    s_cselect_b32 s100, s101, s100
    s_lshl_b32 s75, s60, 2
    s_add_u32 s75, s75, s100
    s_lshl_b32 s76, s61, 2
    s_add_u32 s76, s76, s100
    s_sub_u32 s77, s76, s75
    s_lshl_b32 s77, s77, 10
    s_lshl_b32 s78, s75, 10
    s_add_u32 s78, s78, 983040
    s_lshl_b32 s75, s75, 15
    s_add_u32 s75, s75, 2097152
    s_add_u32 s75, s75, s68
    s_lshl_b32 s76, s76, 15
    s_add_u32 s76, s76, 2097152
    s_add_u32 s76, s76, s68
    s_add_u32 s1, s1, s65
    s_cmp_eq_u32 s3, 0
    s_cselect_b32 s68, 32, 0
    s_cselect_b32 s67, 0, 2147479552
    v_and_b32 v48, 15, v2
    v_lshrrev_b32 v49, 4, v2
    v_lshrrev_b32 v50, 1, v48
    v_xor_b32 v50, v50, v49
    v_lshlrev_b32 v50, 4, v50
    v_lshl_add_u32 v28, v48, 7, v50
    v_add_u32 v28, s62, v28
    v_xor_b32 v29, 64, v28
    v_add_u32 v30, 65536, v28
    v_add_u32 v31, 65536, v29
    v_lshrrev_b32 v50, 2, v48
    v_and_b32 v51, 3, v48
    v_lshl_add_u32 v52, v49, 3, v50
    v_lshlrev_b32 v53, 8, v52
    v_lshl_add_u32 v53, v51, 3, v53
    v_add_u32 v53, 98304, v53
    v_and_b32 v54, 1, v49
    v_lshl_add_u32 v54, v54, 2, v50
    v_xor_b32 v55, 0, v54
    v_lshl_add_u32 v8, v55, 5, v53
    v_xor_b32 v55, 1, v54
    v_lshl_add_u32 v9, v55, 5, v53
    v_xor_b32 v55, 2, v54
    v_lshl_add_u32 v10, v55, 5, v53
    v_xor_b32 v55, 3, v54
    v_lshl_add_u32 v11, v55, 5, v53
    v_xor_b32 v55, 4, v54
    v_lshl_add_u32 v12, v55, 5, v53
    v_xor_b32 v55, 5, v54
    v_lshl_add_u32 v13, v55, 5, v53
    v_xor_b32 v55, 6, v54
    v_lshl_add_u32 v14, v55, 5, v53
    v_xor_b32 v55, 7, v54
    v_lshl_add_u32 v15, v55, 5, v53
    v_bfe_u32 v49, v2, 1, 2
    v_bfe_u32 v50, v2, 4, 1
    v_xor_b32 v49, v49, v50
    v_lshlrev_b32 v49, 5, v49
    v_and_b32 v50, 1, v2
    v_lshl_add_u32 v49, v50, 4, v49
    v_lshl_add_u32 v24, v85, 13, v49
    v_xor_b32 v25, 64, v24
    v_add_u32 v25, 64512, v25
    v_add_u32 v26, 129024, v24
    v_add_u32 v27, 129024, v25
    v_cmp_eq_u32 vcc, 0, v2
    v_mov_b32 v6, 2147479552
    s_nop 0
    v_cndmask_b32 v5, v6, v2, vcc
    v_cmp_eq_u32 vcc, 0, v0
    s_nop 1
    v_cndmask_b32 v7, v6, v0, vcc
    v_and_b32 v48, 8, v2
    v_cmp_eq_u32 vcc, 0, v48
    v_lshlrev_b32 v48, 5, v84
    v_lshrrev_b32 v49, 1, v2
    v_and_b32 v49, 24, v49
    v_add_u32 v48, v48, v49
    s_lshl_b32 s100, s3, 8
    s_add_u32 s100, s100, 147456
    v_add_u32 v48, s100, v48
    v_mov_b32 v49, 148480
    v_cndmask_b32 v98, v49, v48, vcc
    v_lshlrev_b32 v99, 5, v84
    v_add_u32 v99, 149504, v99
    s_lshl_b32 s100, s3, 3
    v_add_u32 v100, s100, v99
    v_lshlrev_b32 v106, 5, v85
    v_lshlrev_b32 v107, 8, v85
    v_lshl_add_u32 v107, v84, 4, v107
    s_sub_u32 s100, s2, 64
    s_lshl_b32 s80, s100, 12
    s_add_u32 s80, s80, 1048576
    s_cmp_lt_u32 s100, 64
    s_cselect_b32 s80, s80, 2147479552
    s_mul_i32 s99, s5, 786432
    s_sub_u32 s79, s6, 2
    s_lshl_b32 s79, s79, 3
    s_add_u32 s79, s79, s4
    s_lshl_b32 s79, s79, 7
    s_add_u32 s79, s79, s99
    s_cmp_ge_u32 s6, 2
    s_cselect_b32 s79, s79, 2147414016
    s_lshl_b32 s100, s5, 8
    v_add_u32 v65, s100, v65
    v_mov_b32 v6, 1
    v_and_b32 v4, 1, v2
    v_lshlrev_b32 v4, 7, v4
    buffer_load_dwordx2 v[66:67], v65, s[44:47], 0 offen
    buffer_load_dwordx4 v[68:71], v64, s[40:43], s79 offen
    s_add_u32 s79, s79, 6144
    buffer_load_dwordx4 v[72:75], v64, s[40:43], s79 offen
    s_add_u32 s79, s79, 6144
    buffer_load_dwordx4 v[76:79], v64, s[40:43], s79 offen
    s_add_u32 s79, s79, 6144
    buffer_load_dwordx4 v[80:83], v64, s[40:43], s79 offen
    s_lshl_b32 s79, s2, 5
    s_add_u32 s79, s79, s3
    s_lshl_b32 s79, s79, 8
    buffer_load_dwordx4 v[88:91], v86, s[32:35], s79 offen
    buffer_load_dwordx4 v[92:95], v86, s[32:35], s79 offen offset:128
    s_add_u32 m0, s63, 114688
    s_xor_b32 s98, s97, 524288
    buffer_load_dwordx4 v20, s[16:19], s98 offen offset:0  lds
    buffer_load_dwordx4 v21, s[16:19], s98 offen offset:1024  lds
    buffer_load_dwordx4 v22, s[16:19], s98 offen offset:2048  lds
    buffer_load_dwordx4 v23, s[16:19], s98 offen offset:3072  lds
    s_add_u32 m0, s62, 32768
    s_xor_b32 s98, s96, 128
    buffer_load_dwordx4 v16, s[12:15], s98 offen offset:0  lds
    buffer_load_dwordx4 v17, s[12:15], s98 offen offset:1024  lds
    buffer_load_dwordx4 v18, s[12:15], s98 offen offset:2048  lds
    buffer_load_dwordx4 v19, s[12:15], s98 offen offset:3072  lds
    s_add_u32 m0, s62, 36864
    s_xor_b32 s98, s96, 32896
    buffer_load_dwordx4 v16, s[12:15], s98 offen offset:0  lds
    buffer_load_dwordx4 v17, s[12:15], s98 offen offset:1024  lds
    buffer_load_dwordx4 v18, s[12:15], s98 offen offset:2048  lds
    buffer_load_dwordx4 v19, s[12:15], s98 offen offset:3072  lds
    s_waitcnt vmcnt(19) lgkmcnt(0)
    s_barrier
    ds_read_b64_tr_b16 v[32:33], v8 offset:0
    ds_read_b64_tr_b16 v[34:35], v8 offset:1024
    ds_read_b128 a[0:3], v28 offset:0
    ds_read_b128 a[4:7], v28 offset:2048
    ds_read_b128 a[8:11], v28 offset:4096
    ds_read_b128 a[12:15], v28 offset:6144
    ds_read_b64_tr_b16 v[36:37], v9 offset:0
    ds_read_b64_tr_b16 v[38:39], v9 offset:1024
    ds_read_b64_tr_b16 v[40:41], v10 offset:0
    ds_read_b64_tr_b16 v[42:43], v10 offset:1024
    ds_read_b64_tr_b16 v[44:45], v11 offset:0
    ds_read_b64_tr_b16 v[46:47], v11 offset:1024
    ds_read_b64_tr_b16 v[48:49], v12 offset:0
    ds_read_b64_tr_b16 v[50:51], v12 offset:1024
    ds_read_b64_tr_b16 v[52:53], v13 offset:0
    ds_read_b64_tr_b16 v[54:55], v13 offset:1024
    ds_read_b64_tr_b16 v[56:57], v14 offset:0
    ds_read_b64_tr_b16 v[58:59], v14 offset:1024
    ds_read_b64_tr_b16 v[60:61], v15 offset:0
    ds_read_b64_tr_b16 v[62:63], v15 offset:1024
    s_waitcnt lgkmcnt(15)
    v_mfma_f32_16x16x32_bf16 v[128:131], v[32:35], a[0:3], 0
    v_mfma_f32_16x16x32_bf16 v[160:163], v[32:35], a[4:7], 0
    v_mfma_f32_16x16x32_bf16 v[192:195], v[32:35], a[8:11], 0
    s_waitcnt lgkmcnt(14)
    s_add_u32 m0, s63, 131072
    s_xor_b32 s98, s97, 1048576
    ds_read_b128 a[16:19], v29 offset:0
    v_mfma_f32_16x16x32_bf16 v[224:227], v[32:35], a[12:15], 0
    s_waitcnt lgkmcnt(13)
    ds_read_b128 a[20:23], v29 offset:2048
    v_mfma_f32_16x16x32_bf16 v[132:135], v[36:39], a[0:3], 0
    ds_read_b64_tr_b16 v[32:33], v8 offset:8192
    v_mfma_f32_16x16x32_bf16 v[164:167], v[36:39], a[4:7], 0
    ds_read_b64_tr_b16 v[34:35], v8 offset:9216
    v_mfma_f32_16x16x32_bf16 v[196:199], v[36:39], a[8:11], 0
    ds_read_b128 a[24:27], v29 offset:4096
    v_mfma_f32_16x16x32_bf16 v[228:231], v[36:39], a[12:15], 0
    s_waitcnt lgkmcnt(15)
    ds_read_b128 a[28:31], v29 offset:6144
    v_mfma_f32_16x16x32_bf16 v[136:139], v[40:43], a[0:3], 0
    ds_read_b64_tr_b16 v[36:37], v9 offset:8192
    v_mfma_f32_16x16x32_bf16 v[168:171], v[40:43], a[4:7], 0
    s_waitcnt lgkmcnt(7)
    ds_read_b64_tr_b16 v[38:39], v9 offset:9216
    v_mfma_f32_16x16x32_bf16 v[200:203], v[40:43], a[8:11], 0
    buffer_load_dwordx4 v20, s[16:19], s98 offen offset:0  lds
    v_mfma_f32_16x16x32_bf16 v[232:235], v[40:43], a[12:15], 0
    buffer_load_dwordx4 v21, s[16:19], s98 offen offset:1024  lds
    v_mfma_f32_16x16x32_bf16 v[140:143], v[44:47], a[0:3], 0
    ds_read_b64_tr_b16 v[40:41], v10 offset:8192
    v_mfma_f32_16x16x32_bf16 v[172:175], v[44:47], a[4:7], 0
    ds_read_b64_tr_b16 v[42:43], v10 offset:9216
    v_mfma_f32_16x16x32_bf16 v[204:207], v[44:47], a[8:11], 0
    buffer_load_dwordx4 v22, s[16:19], s98 offen offset:2048  lds
    v_mfma_f32_16x16x32_bf16 v[236:239], v[44:47], a[12:15], 0
    buffer_load_dwordx4 v23, s[16:19], s98 offen offset:3072  lds
    v_mfma_f32_16x16x32_bf16 v[144:147], v[48:51], a[0:3], 0
    s_add_u32 m0, s62, 65536
    s_xor_b32 s98, s96, 256
    ds_read_b64_tr_b16 v[44:45], v11 offset:8192
    v_mfma_f32_16x16x32_bf16 v[176:179], v[48:51], a[4:7], 0
    ds_read_b64_tr_b16 v[46:47], v11 offset:9216
    v_mfma_f32_16x16x32_bf16 v[208:211], v[48:51], a[8:11], 0
    buffer_load_dwordx4 v16, s[12:15], s98 offen offset:0  lds
    v_mfma_f32_16x16x32_bf16 v[240:243], v[48:51], a[12:15], 0
    buffer_load_dwordx4 v17, s[12:15], s98 offen offset:1024  lds
    v_mfma_f32_16x16x32_bf16 v[148:151], v[52:55], a[0:3], 0
    ds_read_b64_tr_b16 v[48:49], v12 offset:8192
    v_mfma_f32_16x16x32_bf16 v[180:183], v[52:55], a[4:7], 0
    ds_read_b64_tr_b16 v[50:51], v12 offset:9216
    v_mfma_f32_16x16x32_bf16 v[212:215], v[52:55], a[8:11], 0
    buffer_load_dwordx4 v18, s[12:15], s98 offen offset:2048  lds
    v_mfma_f32_16x16x32_bf16 v[244:247], v[52:55], a[12:15], 0
    buffer_load_dwordx4 v19, s[12:15], s98 offen offset:3072  lds
    v_mfma_f32_16x16x32_bf16 v[152:155], v[56:59], a[0:3], 0
    s_add_u32 m0, s62, 69632
    s_xor_b32 s98, s96, 33024
    ds_read_b64_tr_b16 v[52:53], v13 offset:8192
    v_mfma_f32_16x16x32_bf16 v[184:187], v[56:59], a[4:7], 0
    ds_read_b64_tr_b16 v[54:55], v13 offset:9216
    v_mfma_f32_16x16x32_bf16 v[216:219], v[56:59], a[8:11], 0
    buffer_load_dwordx4 v16, s[12:15], s98 offen offset:0  lds
    v_mfma_f32_16x16x32_bf16 v[248:251], v[56:59], a[12:15], 0
    buffer_load_dwordx4 v17, s[12:15], s98 offen offset:1024  lds
    v_mfma_f32_16x16x32_bf16 v[156:159], v[60:63], a[0:3], 0
    ds_read_b64_tr_b16 v[56:57], v14 offset:8192
    v_mfma_f32_16x16x32_bf16 v[188:191], v[60:63], a[4:7], 0
    s_waitcnt lgkmcnt(5)
    ds_read_b64_tr_b16 v[58:59], v14 offset:9216
    v_mfma_f32_16x16x32_bf16 v[220:223], v[60:63], a[8:11], 0
    buffer_load_dwordx4 v18, s[12:15], s98 offen offset:2048  lds
    v_mfma_f32_16x16x32_bf16 v[252:255], v[60:63], a[12:15], 0
    buffer_load_dwordx4 v19, s[12:15], s98 offen offset:3072  lds
    v_mfma_f32_16x16x32_bf16 v[128:131], v[32:35], a[16:19], v[128:131]
    ds_read_b64_tr_b16 v[60:61], v15 offset:8192
    v_mfma_f32_16x16x32_bf16 v[160:163], v[32:35], a[20:23], v[160:163]
    ds_read_b64_tr_b16 v[62:63], v15 offset:9216
    v_mfma_f32_16x16x32_bf16 v[192:195], v[32:35], a[24:27], v[192:195]
    v_mfma_f32_16x16x32_bf16 v[224:227], v[32:35], a[28:31], v[224:227]
    v_mfma_f32_16x16x32_bf16 v[132:135], v[36:39], a[16:19], v[132:135]
    v_mfma_f32_16x16x32_bf16 v[164:167], v[36:39], a[20:23], v[164:167]
    v_mfma_f32_16x16x32_bf16 v[196:199], v[36:39], a[24:27], v[196:199]
    v_mfma_f32_16x16x32_bf16 v[228:231], v[36:39], a[28:31], v[228:231]
    v_mfma_f32_16x16x32_bf16 v[136:139], v[40:43], a[16:19], v[136:139]
    s_waitcnt vmcnt(12) lgkmcnt(0)
    s_barrier
    v_mfma_f32_16x16x32_bf16 v[168:171], v[40:43], a[20:23], v[168:171]
    s_add_u32 m0, s63, 98304
    s_xor_b32 s98, s97, 1572864
    ds_read_b64_tr_b16 v[32:33], v8 offset:16384
    v_lshlrev_b32 v102, 16, v66
    v_and_b32 v103, 0xffff0000, v66
    v_lshlrev_b32 v104, 16, v67
    v_mfma_f32_16x16x32_bf16 v[200:203], v[40:43], a[24:27], v[200:203]
    ds_read_b64_tr_b16 v[34:35], v8 offset:17408
    v_and_b32 v105, 0xffff0000, v67
    v_mul_f32 v108, 0xbfb8aa3b, v102
    v_mul_f32 v109, 0xbfb8aa3b, v103
    v_mfma_f32_16x16x32_bf16 v[232:235], v[40:43], a[28:31], v[232:235]
    ds_read_b64_tr_b16 v[36:37], v9 offset:16384
    v_mul_f32 v110, 0xbfb8aa3b, v104
    v_mul_f32 v111, 0xbfb8aa3b, v105
    v_mfma_f32_16x16x32_bf16 v[140:143], v[44:47], a[16:19], v[140:143]
    ds_read_b64_tr_b16 v[38:39], v9 offset:17408
    v_exp_f32 v108, v108
    v_mfma_f32_16x16x32_bf16 v[172:175], v[44:47], a[20:23], v[172:175]
    ds_read_b64_tr_b16 v[40:41], v10 offset:16384
    v_exp_f32 v109, v109
    v_mfma_f32_16x16x32_bf16 v[204:207], v[44:47], a[24:27], v[204:207]
    ds_read_b64_tr_b16 v[42:43], v10 offset:17408
    v_exp_f32 v110, v110
    v_mfma_f32_16x16x32_bf16 v[236:239], v[44:47], a[28:31], v[236:239]
    ds_read_b128 a[32:35], v28 offset:32768
    v_exp_f32 v111, v111
    v_add_f32 v108, 1.0, v108
    v_mfma_f32_16x16x32_bf16 v[144:147], v[48:51], a[16:19], v[144:147]
    ds_read_b64_tr_b16 v[44:45], v11 offset:16384
    v_add_f32 v109, 1.0, v109
    v_add_f32 v110, 1.0, v110
    v_add_f32 v111, 1.0, v111
    v_mfma_f32_16x16x32_bf16 v[176:179], v[48:51], a[20:23], v[176:179]
    ds_read_b64_tr_b16 v[46:47], v11 offset:17408
    v_rcp_f32 v108, v108
    v_mfma_f32_16x16x32_bf16 v[208:211], v[48:51], a[24:27], v[208:211]
    ds_read_b128 a[36:39], v28 offset:34816
    v_mov_b32 v112, 0
    v_rcp_f32 v109, v109
    v_mfma_f32_16x16x32_bf16 v[240:243], v[48:51], a[28:31], v[240:243]
    ds_read_b128 a[40:43], v28 offset:36864
    v_mov_b32 v113, 0
    v_rcp_f32 v110, v110
    v_mfma_f32_16x16x32_bf16 v[148:151], v[52:55], a[16:19], v[148:151]
    ds_read_b64_tr_b16 v[48:49], v12 offset:16384
    v_mov_b32 v114, 0
    v_rcp_f32 v111, v111
    v_mfma_f32_16x16x32_bf16 v[180:183], v[52:55], a[20:23], v[180:183]
    ds_read_b64_tr_b16 v[50:51], v12 offset:17408
    v_mov_b32 v115, 0
    v_mul_f32 v102, v102, v108
    v_mul_f32 v103, v103, v109
    v_mfma_f32_16x16x32_bf16 v[212:215], v[52:55], a[24:27], v[212:215]
    ds_read_b128 a[44:47], v28 offset:38912
    v_lshlrev_b32 v116, 4, v0
    v_mul_f32 v104, v104, v110
    v_mul_f32 v105, v105, v111
    v_mfma_f32_16x16x32_bf16 v[244:247], v[52:55], a[28:31], v[244:247]
    buffer_load_dwordx4 v20, s[16:19], s98 offen offset:0  lds
    v_cvt_pk_bf16_f32 v108, v102, v103
    v_cvt_pk_bf16_f32 v109, v104, v105
    v_mfma_f32_16x16x32_bf16 v[152:155], v[56:59], a[16:19], v[152:155]
    ds_read_b64_tr_b16 v[52:53], v13 offset:16384
    v_lshlrev_b32 v102, 16, v108
    v_and_b32 v103, 0xffff0000, v108
    v_lshlrev_b32 v104, 16, v109
    v_mfma_f32_16x16x32_bf16 v[184:187], v[56:59], a[20:23], v[184:187]
    ds_read_b64_tr_b16 v[54:55], v13 offset:17408
    v_and_b32 v105, 0xffff0000, v109
    v_lshlrev_b32 v108, 16, v68
    v_and_b32 v109, 0xffff0000, v68
    v_mfma_f32_16x16x32_bf16 v[216:219], v[56:59], a[24:27], v[216:219]
    buffer_load_dwordx4 v21, s[16:19], s98 offen offset:1024  lds
    v_mul_f32 v120, v108, v102
    v_mul_f32 v121, v109, v102
    v_mfma_f32_16x16x32_bf16 v[248:251], v[56:59], a[28:31], v[248:251]
    buffer_store_dwordx4 v[112:115], v116, s[8:11], s80 offen sc0 sc1
    v_lshlrev_b32 v110, 16, v69
    v_and_b32 v111, 0xffff0000, v69
    v_mfma_f32_16x16x32_bf16 v[156:159], v[60:63], a[16:19], v[156:159]
    ds_read_b64_tr_b16 v[56:57], v14 offset:16384
    v_lshlrev_b32 v117, 13, v2
    v_mul_f32 v122, v110, v102
    v_mul_f32 v123, v111, v102
    v_mfma_f32_16x16x32_bf16 v[188:191], v[60:63], a[20:23], v[188:191]
    s_lshl_b32 s100, s6, 19
    s_and_b32 s101, s3, 1
    ds_read_b64_tr_b16 v[58:59], v14 offset:17408
    v_lshlrev_b32 v108, 16, v70
    v_and_b32 v109, 0xffff0000, v70
    v_mul_f32 v124, v108, v102
    v_mfma_f32_16x16x32_bf16 v[220:223], v[60:63], a[24:27], v[220:223]
    buffer_load_dwordx4 v22, s[16:19], s98 offen offset:2048  lds
    v_mul_f32 v125, v109, v102
    v_lshlrev_b32 v110, 16, v71
    v_mfma_f32_16x16x32_bf16 v[252:255], v[60:63], a[28:31], v[252:255]
    s_waitcnt lgkmcnt(5)
    s_lshl_b32 s101, s101, 7
    s_add_u32 s100, s100, s101
    v_min_u32 v116, 496, v116
    v_and_b32 v111, 0xffff0000, v71
    v_mul_f32 v126, v110, v102
    v_mul_f32 v127, v111, v102
    v_mfma_f32_16x16x32_bf16 v[128:131], v[32:35], a[32:35], v[128:131]
    s_sub_u32 s80, s80, 1048576
    s_lshr_b32 s80, s80, 3
    ds_read_b64_tr_b16 v[60:61], v15 offset:16384
    v_lshlrev_b32 v108, 16, v72
    v_and_b32 v109, 0xffff0000, v72
    v_fmac_f32 v120, v108, v103
    v_mfma_f32_16x16x32_bf16 v[160:163], v[32:35], a[36:39], v[160:163]
    s_add_u32 s80, s80, 1310720
    s_cmp_lt_u32 s80, 1343488
    s_cselect_b32 s80, s80, 2147479552
    ds_read_b64_tr_b16 v[62:63], v15 offset:17408
    v_fmac_f32 v121, v109, v103
    v_lshlrev_b32 v110, 16, v73
    v_and_b32 v111, 0xffff0000, v73
    v_mfma_f32_16x16x32_bf16 v[192:195], v[32:35], a[40:43], v[192:195]
    s_waitcnt lgkmcnt(5)
    ds_read_b128 a[48:51], v29 offset:32768
    v_fmac_f32 v122, v110, v103
    v_fmac_f32 v123, v111, v103
    v_lshlrev_b32 v108, 16, v74
    v_mfma_f32_16x16x32_bf16 v[224:227], v[32:35], a[44:47], v[224:227]
    ds_read_b128 a[52:55], v29 offset:34816
    v_and_b32 v109, 0xffff0000, v74
    v_fmac_f32 v124, v108, v103
    v_fmac_f32 v125, v109, v103
    v_mfma_f32_16x16x32_bf16 v[132:135], v[36:39], a[32:35], v[132:135]
    ds_read_b64_tr_b16 v[32:33], v8 offset:24576
    v_lshlrev_b32 v110, 16, v75
    v_and_b32 v111, 0xffff0000, v75
    v_fmac_f32 v126, v110, v103
    v_mfma_f32_16x16x32_bf16 v[164:167], v[36:39], a[36:39], v[164:167]
    ds_read_b64_tr_b16 v[34:35], v8 offset:25600
    v_fmac_f32 v127, v111, v103
    v_lshlrev_b32 v108, 16, v76
    v_and_b32 v109, 0xffff0000, v76
    v_mfma_f32_16x16x32_bf16 v[196:199], v[36:39], a[40:43], v[196:199]
    ds_read_b128 a[56:59], v29 offset:36864
    v_fmac_f32 v120, v108, v104
    v_fmac_f32 v121, v109, v104
    v_lshlrev_b32 v110, 16, v77
    v_mfma_f32_16x16x32_bf16 v[228:231], v[36:39], a[44:47], v[228:231]
    ds_read_b128 a[60:63], v29 offset:38912
    v_and_b32 v111, 0xffff0000, v77
    v_fmac_f32 v122, v110, v104
    v_fmac_f32 v123, v111, v104
    v_mfma_f32_16x16x32_bf16 v[136:139], v[40:43], a[32:35], v[136:139]
    ds_read_b64_tr_b16 v[36:37], v9 offset:24576
    v_lshlrev_b32 v108, 16, v78
    v_and_b32 v109, 0xffff0000, v78
    v_fmac_f32 v124, v108, v104
    v_mfma_f32_16x16x32_bf16 v[168:171], v[40:43], a[36:39], v[168:171]
    ds_read_b64_tr_b16 v[38:39], v9 offset:25600
    v_fmac_f32 v125, v109, v104
    v_lshlrev_b32 v110, 16, v79
    v_and_b32 v111, 0xffff0000, v79
    v_mfma_f32_16x16x32_bf16 v[200:203], v[40:43], a[40:43], v[200:203]
    buffer_load_dwordx4 v23, s[16:19], s98 offen offset:3072  lds
    v_fmac_f32 v126, v110, v104
    v_fmac_f32 v127, v111, v104
    v_mfma_f32_16x16x32_bf16 v[232:235], v[40:43], a[44:47], v[232:235]
    buffer_store_dwordx4 v[112:115], v116, s[8:11], s80 offen sc0 sc1
    v_lshlrev_b32 v108, 16, v80
    v_and_b32 v109, 0xffff0000, v80
    v_mfma_f32_16x16x32_bf16 v[140:143], v[44:47], a[32:35], v[140:143]
    s_add_u32 m0, s62, 0
    s_xor_b32 s98, s96, 384
    ds_read_b64_tr_b16 v[40:41], v10 offset:24576
    v_fmac_f32 v120, v108, v105
    v_fmac_f32 v121, v109, v105
    v_lshlrev_b32 v110, 16, v81
    v_mfma_f32_16x16x32_bf16 v[172:175], v[44:47], a[36:39], v[172:175]
    ds_read_b64_tr_b16 v[42:43], v10 offset:25600
    v_and_b32 v111, 0xffff0000, v81
    v_fmac_f32 v122, v110, v105
    v_fmac_f32 v123, v111, v105
    v_mfma_f32_16x16x32_bf16 v[204:207], v[44:47], a[40:43], v[204:207]
    buffer_load_dwordx4 v16, s[12:15], s98 offen offset:0  lds
    v_lshlrev_b32 v108, 16, v82
    v_and_b32 v109, 0xffff0000, v82
    v_mfma_f32_16x16x32_bf16 v[236:239], v[44:47], a[44:47], v[236:239]
    v_fmac_f32 v124, v108, v105
    v_fmac_f32 v125, v109, v105
    v_lshlrev_b32 v110, 16, v83
    v_and_b32 v111, 0xffff0000, v83
    v_mfma_f32_16x16x32_bf16 v[144:147], v[48:51], a[32:35], v[144:147]
    ds_read_b64_tr_b16 v[44:45], v11 offset:24576
    v_fmac_f32 v126, v110, v105
    v_fmac_f32 v127, v111, v105
    v_permlane32_swap_b32 v120, v124
    v_mfma_f32_16x16x32_bf16 v[176:179], v[48:51], a[36:39], v[176:179]
    ds_read_b64_tr_b16 v[46:47], v11 offset:25600
    v_permlane32_swap_b32 v121, v125
    v_permlane32_swap_b32 v122, v126
    v_permlane32_swap_b32 v123, v127
    v_mfma_f32_16x16x32_bf16 v[208:211], v[48:51], a[40:43], v[208:211]
    buffer_load_dwordx4 v17, s[12:15], s98 offen offset:1024  lds
    v_add_f32 v120, v120, v124
    v_add_f32 v121, v121, v125
    v_mfma_f32_16x16x32_bf16 v[240:243], v[48:51], a[44:47], v[240:243]
    s_waitcnt lgkmcnt(4)
    v_add_f32 v122, v122, v126
    v_add_f32 v123, v123, v127
    s_nop 0
    v_permlane16_swap_b32 v120, v122
    v_permlane16_swap_b32 v121, v123
    v_mfma_f32_16x16x32_bf16 v[148:151], v[52:55], a[32:35], v[148:151]
    ds_read_b64_tr_b16 v[48:49], v12 offset:24576
    v_add_f32 v120, v120, v122
    v_add_f32 v121, v121, v123
    s_nop 0
    v_add_f32_dpp v120, v120, v120 row_ror:8 row_mask:0xf bank_mask:0xf
    v_mfma_f32_16x16x32_bf16 v[180:183], v[52:55], a[36:39], v[180:183]
    ds_read_b64_tr_b16 v[50:51], v12 offset:25600
    v_add_f32_dpp v121, v121, v121 row_ror:8 row_mask:0xf bank_mask:0xf
    v_mfma_f32_16x16x32_bf16 v[212:215], v[52:55], a[40:43], v[212:215]
    buffer_load_dwordx4 v18, s[12:15], s98 offen offset:2048  lds
    ds_write_b64 v98, v[120:121]
    v_mfma_f32_16x16x32_bf16 v[244:247], v[52:55], a[44:47], v[244:247]
    v_mfma_f32_16x16x32_bf16 v[152:155], v[56:59], a[32:35], v[152:155]
    ds_read_b64_tr_b16 v[52:53], v13 offset:24576
    v_lshlrev_b32 v64, 16, v88
    v_mfma_f32_16x16x32_bf16 v[184:187], v[56:59], a[36:39], v[184:187]
    ds_read_b64_tr_b16 v[54:55], v13 offset:25600
    v_and_b32 v65, 0xffff0000, v88
    v_mfma_f32_16x16x32_bf16 v[216:219], v[56:59], a[40:43], v[216:219]
    buffer_load_dwordx4 v19, s[12:15], s98 offen offset:3072  lds
    v_mfma_f32_16x16x32_bf16 v[248:251], v[56:59], a[44:47], v[248:251]
    v_lshlrev_b32 v66, 16, v89
    v_and_b32 v67, 0xffff0000, v89
    v_mfma_f32_16x16x32_bf16 v[156:159], v[60:63], a[32:35], v[156:159]
    s_add_u32 m0, s62, 4096
    s_xor_b32 s98, s96, 33152
    ds_read_b64_tr_b16 v[56:57], v14 offset:24576
    v_mfma_f32_16x16x32_bf16 v[188:191], v[60:63], a[36:39], v[188:191]
    ds_read_b64_tr_b16 v[58:59], v14 offset:25600
    v_lshlrev_b32 v68, 16, v90
    v_mfma_f32_16x16x32_bf16 v[220:223], v[60:63], a[40:43], v[220:223]
    buffer_load_dwordx4 v16, s[12:15], s98 offen offset:0  lds
    v_mfma_f32_16x16x32_bf16 v[252:255], v[60:63], a[44:47], v[252:255]
    v_and_b32 v69, 0xffff0000, v90
    v_lshlrev_b32 v70, 16, v91
    v_mfma_f32_16x16x32_bf16 v[128:131], v[32:35], a[48:51], v[128:131]
    ds_read_b64_tr_b16 v[60:61], v15 offset:24576
    v_and_b32 v71, 0xffff0000, v91
    v_mfma_f32_16x16x32_bf16 v[160:163], v[32:35], a[52:55], v[160:163]
    ds_read_b64_tr_b16 v[62:63], v15 offset:25600
    v_lshlrev_b32 v72, 16, v92
    v_mfma_f32_16x16x32_bf16 v[192:195], v[32:35], a[56:59], v[192:195]
    buffer_load_dwordx4 v17, s[12:15], s98 offen offset:1024  lds
    v_mfma_f32_16x16x32_bf16 v[224:227], v[32:35], a[60:63], v[224:227]
    v_and_b32 v73, 0xffff0000, v92
    v_lshlrev_b32 v74, 16, v93
    v_mfma_f32_16x16x32_bf16 v[132:135], v[36:39], a[48:51], v[132:135]
    buffer_load_dwordx4 v18, s[12:15], s98 offen offset:2048  lds
    v_mfma_f32_16x16x32_bf16 v[164:167], v[36:39], a[52:55], v[164:167]
    v_and_b32 v75, 0xffff0000, v93
    v_lshlrev_b32 v76, 16, v94
    v_mfma_f32_16x16x32_bf16 v[196:199], v[36:39], a[56:59], v[196:199]
    buffer_load_dwordx4 v19, s[12:15], s98 offen offset:3072  lds
    s_cmp_eq_u32 s3, 0
    s_cselect_b32 s101, s100, 2147479552
    buffer_load_dword a241, v117, s[20:23], s101 offen offset:4
    v_mfma_f32_16x16x32_bf16 v[228:231], v[36:39], a[60:63], v[228:231]
    s_waitcnt lgkmcnt(2)
    v_and_b32 v77, 0xffff0000, v94
    v_lshlrev_b32 v78, 16, v95
    s_waitcnt vmcnt(9)
    v_mfma_f32_16x16x32_bf16 v[136:139], v[40:43], a[48:51], v[136:139]
    v_and_b32 v79, 0xffff0000, v95
    v_add_f32 v108, v64, v65
    s_waitcnt lgkmcnt(0)
    s_barrier
    v_mfma_f32_16x16x32_bf16 v[168:171], v[40:43], a[52:55], v[168:171]
    s_add_u32 m0, s63, 114688
    s_xor_b32 s98, s97, 2097152
    ds_read_b64_tr_b16 v[32:33], v8 offset:32768
    v_lshrrev_b32 v87, 2, v1
    v_add_u32 v101, 147456, v87
    v_mfma_f32_16x16x32_bf16 v[200:203], v[40:43], a[56:59], v[200:203]
    ds_read_b64_tr_b16 v[34:35], v8 offset:33792
    ds_read_b32 v102, v101
    v_mfma_f32_16x16x32_bf16 v[232:235], v[40:43], a[60:63], v[232:235]
    ds_read_b64_tr_b16 v[36:37], v9 offset:32768
    ds_read_b32 v103, v101 offset:256
    v_mfma_f32_16x16x32_bf16 v[140:143], v[44:47], a[48:51], v[140:143]
    ds_read_b64_tr_b16 v[38:39], v9 offset:33792
    ds_read_b32 v104, v101 offset:512
    v_mfma_f32_16x16x32_bf16 v[172:175], v[44:47], a[52:55], v[172:175]
    ds_read_b64_tr_b16 v[40:41], v10 offset:32768
    ds_read_b32 v105, v101 offset:768
    v_mfma_f32_16x16x32_bf16 v[204:207], v[44:47], a[56:59], v[204:207]
    ds_read_b64_tr_b16 v[42:43], v10 offset:33792
    v_add_f32 v109, v66, v67
    v_mfma_f32_16x16x32_bf16 v[236:239], v[44:47], a[60:63], v[236:239]
    ds_read_b128 a[64:67], v30 offset:0
    v_add_f32 v108, v108, v68
    v_mfma_f32_16x16x32_bf16 v[144:147], v[48:51], a[48:51], v[144:147]
    ds_read_b64_tr_b16 v[44:45], v11 offset:32768
    v_add_f32 v109, v109, v69
    v_mfma_f32_16x16x32_bf16 v[176:179], v[48:51], a[52:55], v[176:179]
    ds_read_b64_tr_b16 v[46:47], v11 offset:33792
    v_add_f32 v108, v108, v70
    v_mfma_f32_16x16x32_bf16 v[208:211], v[48:51], a[56:59], v[208:211]
    ds_read_b128 a[68:71], v30 offset:2048
    v_add_f32 v109, v109, v71
    v_mfma_f32_16x16x32_bf16 v[240:243], v[48:51], a[60:63], v[240:243]
    ds_read_b128 a[72:75], v30 offset:4096
    s_waitcnt lgkmcnt(10)
    v_add_f32 v102, v102, v103
    v_mfma_f32_16x16x32_bf16 v[148:151], v[52:55], a[48:51], v[148:151]
    ds_read_b64_tr_b16 v[48:49], v12 offset:32768
    s_waitcnt lgkmcnt(7)
    v_add_f32 v104, v104, v105
    v_mfma_f32_16x16x32_bf16 v[180:183], v[52:55], a[52:55], v[180:183]
    ds_read_b64_tr_b16 v[50:51], v12 offset:33792
    v_add_f32 v102, v102, v104
    buffer_store_dword v102, v87, s[8:11], s66 offen sc0 sc1
    v_mfma_f32_16x16x32_bf16 v[212:215], v[52:55], a[56:59], v[212:215]
    ds_read_b128 a[76:79], v30 offset:6144
    v_add_f32 v108, v108, v72
    v_mfma_f32_16x16x32_bf16 v[244:247], v[52:55], a[60:63], v[244:247]
    buffer_load_dwordx4 v20, s[16:19], s98 offen offset:0  lds
    v_mfma_f32_16x16x32_bf16 v[152:155], v[56:59], a[48:51], v[152:155]
    s_mov_b32 s40, s92
    s_mov_b32 s41, s93
    ds_read_b64_tr_b16 v[52:53], v13 offset:32768
    v_mfma_f32_16x16x32_bf16 v[184:187], v[56:59], a[52:55], v[184:187]
    s_mov_b32 s42, 1835008
    s_mov_b32 s44, s94
    ds_read_b64_tr_b16 v[54:55], v13 offset:33792
    v_mfma_f32_16x16x32_bf16 v[216:219], v[56:59], a[56:59], v[216:219]
    s_mov_b32 s45, s95
    s_mov_b32 s46, 1835008
    v_add_f32 v109, v109, v73
    v_mfma_f32_16x16x32_bf16 v[248:251], v[56:59], a[60:63], v[248:251]
    buffer_load_dwordx4 v21, s[16:19], s98 offen offset:1024  lds
    v_mfma_f32_16x16x32_bf16 v[156:159], v[60:63], a[48:51], v[156:159]
    ds_read_b64_tr_b16 v[56:57], v14 offset:32768
    v_add_f32 v108, v108, v74
    v_mfma_f32_16x16x32_bf16 v[188:191], v[60:63], a[52:55], v[188:191]
    ds_read_b64_tr_b16 v[58:59], v14 offset:33792
    v_add_f32 v109, v109, v75
    v_mfma_f32_16x16x32_bf16 v[220:223], v[60:63], a[56:59], v[220:223]
    buffer_load_dwordx4 v22, s[16:19], s98 offen offset:2048  lds
    v_mfma_f32_16x16x32_bf16 v[252:255], v[60:63], a[60:63], v[252:255]
    s_waitcnt lgkmcnt(5)
    v_add_f32 v108, v108, v76
    v_add_f32 v109, v109, v77
    v_mfma_f32_16x16x32_bf16 v[128:131], v[32:35], a[64:67], v[128:131]
    ds_read_b64_tr_b16 v[60:61], v15 offset:32768
    v_add_f32 v108, v108, v78
    v_mfma_f32_16x16x32_bf16 v[160:163], v[32:35], a[68:71], v[160:163]
    ds_read_b64_tr_b16 v[62:63], v15 offset:33792
    v_add_f32 v109, v109, v79
    v_mfma_f32_16x16x32_bf16 v[192:195], v[32:35], a[72:75], v[192:195]
    s_waitcnt lgkmcnt(5)
    ds_read_b128 a[80:83], v31 offset:0
    v_add_f32 v108, v108, v109
    v_mfma_f32_16x16x32_bf16 v[224:227], v[32:35], a[76:79], v[224:227]
    ds_read_b128 a[84:87], v31 offset:2048
    v_add_f32_dpp v108, v108, v108 row_ror:8 row_mask:0xf bank_mask:0xf
    v_mfma_f32_16x16x32_bf16 v[132:135], v[36:39], a[64:67], v[132:135]
    ds_read_b64_tr_b16 v[32:33], v8 offset:40960
    v_mov_b32 v110, v108
    v_mfma_f32_16x16x32_bf16 v[164:167], v[36:39], a[68:71], v[164:167]
    ds_read_b64_tr_b16 v[34:35], v8 offset:41984
    v_permlane16_swap_b32 v108, v110
    v_mfma_f32_16x16x32_bf16 v[196:199], v[36:39], a[72:75], v[196:199]
    ds_read_b128 a[88:91], v31 offset:4096
    v_add_f32 v108, v108, v110
    v_mfma_f32_16x16x32_bf16 v[228:231], v[36:39], a[76:79], v[228:231]
    ds_read_b128 a[92:95], v31 offset:6144
    v_mov_b32 v110, v108
    v_mfma_f32_16x16x32_bf16 v[136:139], v[40:43], a[64:67], v[136:139]
    ds_read_b64_tr_b16 v[36:37], v9 offset:40960
    v_permlane32_swap_b32 v108, v110
    v_mfma_f32_16x16x32_bf16 v[168:171], v[40:43], a[68:71], v[168:171]
    ds_read_b64_tr_b16 v[38:39], v9 offset:41984
    v_add_f32 v108, v108, v110
    v_mfma_f32_16x16x32_bf16 v[200:203], v[40:43], a[72:75], v[200:203]
    buffer_load_dwordx4 v23, s[16:19], s98 offen offset:3072  lds
    v_mfma_f32_16x16x32_bf16 v[232:235], v[40:43], a[76:79], v[232:235]
    v_mul_f32 v108, 0x3c000000, v108
    v_sub_f32 v110, v64, v108
    v_mfma_f32_16x16x32_bf16 v[140:143], v[44:47], a[64:67], v[140:143]
    s_add_u32 m0, s62, 32768
    s_xor_b32 s98, s96, 512
    ds_read_b64_tr_b16 v[40:41], v10 offset:40960
    v_mfma_f32_16x16x32_bf16 v[172:175], v[44:47], a[68:71], v[172:175]
    ds_read_b64_tr_b16 v[42:43], v10 offset:41984
    v_mul_f32 v109, v110, v110
    v_mfma_f32_16x16x32_bf16 v[204:207], v[44:47], a[72:75], v[204:207]
    buffer_load_dwordx4 v16, s[12:15], s98 offen offset:0  lds
    v_mfma_f32_16x16x32_bf16 v[236:239], v[44:47], a[76:79], v[236:239]
    v_sub_f32 v111, v65, v108
    v_fmac_f32 v109, v111, v111
    v_mfma_f32_16x16x32_bf16 v[144:147], v[48:51], a[64:67], v[144:147]
    ds_read_b64_tr_b16 v[44:45], v11 offset:40960
    v_sub_f32 v110, v66, v108
    v_mfma_f32_16x16x32_bf16 v[176:179], v[48:51], a[68:71], v[176:179]
    ds_read_b64_tr_b16 v[46:47], v11 offset:41984
    v_fmac_f32 v109, v110, v110
    v_mfma_f32_16x16x32_bf16 v[208:211], v[48:51], a[72:75], v[208:211]
    buffer_load_dwordx4 v17, s[12:15], s98 offen offset:1024  lds
    v_mfma_f32_16x16x32_bf16 v[240:243], v[48:51], a[76:79], v[240:243]
    s_waitcnt lgkmcnt(4)
    v_sub_f32 v111, v67, v108
    v_fmac_f32 v109, v111, v111
    v_mfma_f32_16x16x32_bf16 v[148:151], v[52:55], a[64:67], v[148:151]
    ds_read_b64_tr_b16 v[48:49], v12 offset:40960
    v_sub_f32 v110, v68, v108
    v_mfma_f32_16x16x32_bf16 v[180:183], v[52:55], a[68:71], v[180:183]
    ds_read_b64_tr_b16 v[50:51], v12 offset:41984
    v_fmac_f32 v109, v110, v110
    v_mfma_f32_16x16x32_bf16 v[212:215], v[52:55], a[72:75], v[212:215]
    buffer_load_dwordx4 v18, s[12:15], s98 offen offset:2048  lds
    v_mfma_f32_16x16x32_bf16 v[244:247], v[52:55], a[76:79], v[244:247]
    v_sub_f32 v111, v69, v108
    v_fmac_f32 v109, v111, v111
    v_mfma_f32_16x16x32_bf16 v[152:155], v[56:59], a[64:67], v[152:155]
    ds_read_b64_tr_b16 v[52:53], v13 offset:40960
    v_sub_f32 v110, v70, v108
    v_mfma_f32_16x16x32_bf16 v[184:187], v[56:59], a[68:71], v[184:187]
    ds_read_b64_tr_b16 v[54:55], v13 offset:41984
    v_fmac_f32 v109, v110, v110
    v_mfma_f32_16x16x32_bf16 v[216:219], v[56:59], a[72:75], v[216:219]
    buffer_load_dwordx4 v19, s[12:15], s98 offen offset:3072  lds
    v_mfma_f32_16x16x32_bf16 v[248:251], v[56:59], a[76:79], v[248:251]
    v_sub_f32 v111, v71, v108
    v_fmac_f32 v109, v111, v111
    v_mfma_f32_16x16x32_bf16 v[156:159], v[60:63], a[64:67], v[156:159]
    s_add_u32 m0, s62, 36864
    s_xor_b32 s98, s96, 33280
    ds_read_b64_tr_b16 v[56:57], v14 offset:40960
    v_mfma_f32_16x16x32_bf16 v[188:191], v[60:63], a[68:71], v[188:191]
    ds_read_b64_tr_b16 v[58:59], v14 offset:41984
    v_sub_f32 v110, v72, v108
    v_mfma_f32_16x16x32_bf16 v[220:223], v[60:63], a[72:75], v[220:223]
    buffer_load_dwordx4 v16, s[12:15], s98 offen offset:0  lds
    v_mfma_f32_16x16x32_bf16 v[252:255], v[60:63], a[76:79], v[252:255]
    v_fmac_f32 v109, v110, v110
    v_sub_f32 v111, v73, v108
    v_mfma_f32_16x16x32_bf16 v[128:131], v[32:35], a[80:83], v[128:131]
    ds_read_b64_tr_b16 v[60:61], v15 offset:40960
    v_fmac_f32 v109, v111, v111
    v_mfma_f32_16x16x32_bf16 v[160:163], v[32:35], a[84:87], v[160:163]
    ds_read_b64_tr_b16 v[62:63], v15 offset:41984
    v_sub_f32 v110, v74, v108
    v_mfma_f32_16x16x32_bf16 v[192:195], v[32:35], a[88:91], v[192:195]
    buffer_load_dwordx4 v17, s[12:15], s98 offen offset:1024  lds
    v_mfma_f32_16x16x32_bf16 v[224:227], v[32:35], a[92:95], v[224:227]
    v_fmac_f32 v109, v110, v110
    v_sub_f32 v111, v75, v108
    v_mfma_f32_16x16x32_bf16 v[132:135], v[36:39], a[80:83], v[132:135]
    buffer_load_dwordx4 v18, s[12:15], s98 offen offset:2048  lds
    v_mfma_f32_16x16x32_bf16 v[164:167], v[36:39], a[84:87], v[164:167]
    v_fmac_f32 v109, v111, v111
    v_sub_f32 v110, v76, v108
    v_mfma_f32_16x16x32_bf16 v[196:199], v[36:39], a[88:91], v[196:199]
    buffer_load_dwordx4 v19, s[12:15], s98 offen offset:3072  lds
    s_cmp_eq_u32 s3, 1
    s_cselect_b32 s101, s100, 2147479552
    buffer_load_dword a243, v117, s[20:23], s101 offen offset:4
    v_mfma_f32_16x16x32_bf16 v[228:231], v[36:39], a[92:95], v[228:231]
    s_waitcnt lgkmcnt(2)
    v_fmac_f32 v109, v110, v110
    v_sub_f32 v111, v77, v108
    v_mfma_f32_16x16x32_bf16 v[136:139], v[40:43], a[80:83], v[136:139]
    v_fmac_f32 v109, v111, v111
    v_sub_f32 v110, v78, v108
    s_waitcnt vmcnt(15) lgkmcnt(0)
    s_barrier
    v_mfma_f32_16x16x32_bf16 v[168:171], v[40:43], a[84:87], v[168:171]
    s_add_u32 m0, s63, 131072
    s_xor_b32 s98, s97, 2621440
    ds_read_b64_tr_b16 v[32:33], v8 offset:0
    v_mfma_f32_16x16x32_bf16 v[200:203], v[40:43], a[88:91], v[200:203]
    ds_read_b64_tr_b16 v[34:35], v8 offset:1024
    v_fmac_f32 v109, v110, v110
    v_mfma_f32_16x16x32_bf16 v[232:235], v[40:43], a[92:95], v[232:235]
    ds_read_b64_tr_b16 v[36:37], v9 offset:0
    v_sub_f32 v111, v79, v108
    v_mfma_f32_16x16x32_bf16 v[140:143], v[44:47], a[80:83], v[140:143]
    ds_read_b64_tr_b16 v[38:39], v9 offset:1024
    v_fmac_f32 v109, v111, v111
    v_mfma_f32_16x16x32_bf16 v[172:175], v[44:47], a[84:87], v[172:175]
    ds_read_b64_tr_b16 v[40:41], v10 offset:0
    v_add_f32_dpp v109, v109, v109 row_ror:8 row_mask:0xf bank_mask:0xf
    v_mfma_f32_16x16x32_bf16 v[204:207], v[44:47], a[88:91], v[204:207]
    ds_read_b64_tr_b16 v[42:43], v10 offset:1024
    v_mov_b32 v110, v109
    v_mfma_f32_16x16x32_bf16 v[236:239], v[44:47], a[92:95], v[236:239]
    ds_read_b128 a[96:99], v28 offset:0
    v_permlane16_swap_b32 v109, v110
    v_mfma_f32_16x16x32_bf16 v[144:147], v[48:51], a[80:83], v[144:147]
    ds_read_b64_tr_b16 v[44:45], v11 offset:0
    v_add_f32 v109, v109, v110
    v_mfma_f32_16x16x32_bf16 v[176:179], v[48:51], a[84:87], v[176:179]
    ds_read_b64_tr_b16 v[46:47], v11 offset:1024
    v_mov_b32 v110, v109
    s_waitcnt vmcnt(13)
    buffer_atomic_add v6, v7, s[36:39], s69 offen sc1
    v_mfma_f32_16x16x32_bf16 v[208:211], v[48:51], a[88:91], v[208:211]
    ds_read_b128 a[100:103], v28 offset:2048
    v_permlane32_swap_b32 v109, v110
    v_mfma_f32_16x16x32_bf16 v[240:243], v[48:51], a[92:95], v[240:243]
    ds_read_b128 a[104:107], v28 offset:4096
    v_add_f32 v109, v109, v110
    v_mfma_f32_16x16x32_bf16 v[148:151], v[52:55], a[80:83], v[148:151]
    ds_read_b64_tr_b16 v[48:49], v12 offset:0
    v_mfma_f32_16x16x32_bf16 v[180:183], v[52:55], a[84:87], v[180:183]
    ds_read_b64_tr_b16 v[50:51], v12 offset:1024
    v_mfma_f32_16x16x32_bf16 v[212:215], v[52:55], a[88:91], v[212:215]
    ds_read_b128 a[108:111], v28 offset:6144
    v_mfma_f32_16x16x32_bf16 v[244:247], v[52:55], a[92:95], v[244:247]
    buffer_load_dwordx4 v20, s[16:19], s98 offen offset:0  lds
    v_mfma_f32_16x16x32_bf16 v[152:155], v[56:59], a[80:83], v[152:155]
    ds_read_b64_tr_b16 v[52:53], v13 offset:0
    v_mfma_f32_16x16x32_bf16 v[184:187], v[56:59], a[84:87], v[184:187]
    ds_read_b64_tr_b16 v[54:55], v13 offset:1024
    v_mfma_f32_16x16x32_bf16 v[216:219], v[56:59], a[88:91], v[216:219]
    buffer_load_dwordx4 v21, s[16:19], s98 offen offset:1024  lds
    v_mfma_f32_16x16x32_bf16 v[248:251], v[56:59], a[92:95], v[248:251]
    ds_write_b64 v100, v[108:109]
    v_mfma_f32_16x16x32_bf16 v[156:159], v[60:63], a[80:83], v[156:159]
    ds_read_b64_tr_b16 v[56:57], v14 offset:0
    v_mfma_f32_16x16x32_bf16 v[188:191], v[60:63], a[84:87], v[188:191]
    ds_read_b64_tr_b16 v[58:59], v14 offset:1024
    v_mfma_f32_16x16x32_bf16 v[220:223], v[60:63], a[88:91], v[220:223]
    buffer_load_dwordx4 v22, s[16:19], s98 offen offset:2048  lds
    v_mfma_f32_16x16x32_bf16 v[252:255], v[60:63], a[92:95], v[252:255]
    s_waitcnt lgkmcnt(6)
    v_mfma_f32_16x16x32_bf16 v[128:131], v[32:35], a[96:99], v[128:131]
    ds_read_b64_tr_b16 v[60:61], v15 offset:0
    v_mfma_f32_16x16x32_bf16 v[160:163], v[32:35], a[100:103], v[160:163]
    ds_read_b64_tr_b16 v[62:63], v15 offset:1024
    v_mfma_f32_16x16x32_bf16 v[192:195], v[32:35], a[104:107], v[192:195]
    s_waitcnt lgkmcnt(6)
    ds_read_b128 a[112:115], v29 offset:0
    v_mfma_f32_16x16x32_bf16 v[224:227], v[32:35], a[108:111], v[224:227]
    ds_read_b128 a[116:119], v29 offset:2048
    v_mfma_f32_16x16x32_bf16 v[132:135], v[36:39], a[96:99], v[132:135]
    ds_read_b64_tr_b16 v[32:33], v8 offset:8192
    v_mfma_f32_16x16x32_bf16 v[164:167], v[36:39], a[100:103], v[164:167]
    ds_read_b64_tr_b16 v[34:35], v8 offset:9216
    v_mfma_f32_16x16x32_bf16 v[196:199], v[36:39], a[104:107], v[196:199]
    ds_read_b128 a[120:123], v29 offset:4096
    v_mfma_f32_16x16x32_bf16 v[228:231], v[36:39], a[108:111], v[228:231]
    ds_read_b128 a[124:127], v29 offset:6144
    v_mfma_f32_16x16x32_bf16 v[136:139], v[40:43], a[96:99], v[136:139]
    ds_read_b64_tr_b16 v[36:37], v9 offset:8192
    v_mfma_f32_16x16x32_bf16 v[168:171], v[40:43], a[100:103], v[168:171]
    ds_read_b64_tr_b16 v[38:39], v9 offset:9216
    v_mfma_f32_16x16x32_bf16 v[200:203], v[40:43], a[104:107], v[200:203]
    buffer_load_dwordx4 v23, s[16:19], s98 offen offset:3072  lds
    v_mfma_f32_16x16x32_bf16 v[232:235], v[40:43], a[108:111], v[232:235]
    v_mfma_f32_16x16x32_bf16 v[140:143], v[44:47], a[96:99], v[140:143]
    s_add_u32 m0, s62, 65536
    s_xor_b32 s98, s96, 640
    ds_read_b64_tr_b16 v[40:41], v10 offset:8192
    v_mfma_f32_16x16x32_bf16 v[172:175], v[44:47], a[100:103], v[172:175]
    ds_read_b64_tr_b16 v[42:43], v10 offset:9216
    v_mfma_f32_16x16x32_bf16 v[204:207], v[44:47], a[104:107], v[204:207]
    buffer_load_dwordx4 v16, s[12:15], s98 offen offset:0  lds
    v_mfma_f32_16x16x32_bf16 v[236:239], v[44:47], a[108:111], v[236:239]
    v_mfma_f32_16x16x32_bf16 v[144:147], v[48:51], a[96:99], v[144:147]
    ds_read_b64_tr_b16 v[44:45], v11 offset:8192
    v_mfma_f32_16x16x32_bf16 v[176:179], v[48:51], a[100:103], v[176:179]
    ds_read_b64_tr_b16 v[46:47], v11 offset:9216
    v_mfma_f32_16x16x32_bf16 v[208:211], v[48:51], a[104:107], v[208:211]
    buffer_load_dwordx4 v17, s[12:15], s98 offen offset:1024  lds
    v_mfma_f32_16x16x32_bf16 v[240:243], v[48:51], a[108:111], v[240:243]
    s_waitcnt lgkmcnt(4)
    v_mfma_f32_16x16x32_bf16 v[148:151], v[52:55], a[96:99], v[148:151]
    ds_read_b64_tr_b16 v[48:49], v12 offset:8192
    v_mfma_f32_16x16x32_bf16 v[180:183], v[52:55], a[100:103], v[180:183]
    ds_read_b64_tr_b16 v[50:51], v12 offset:9216
    v_mfma_f32_16x16x32_bf16 v[212:215], v[52:55], a[104:107], v[212:215]
    buffer_load_dwordx4 v18, s[12:15], s98 offen offset:2048  lds
    v_mfma_f32_16x16x32_bf16 v[244:247], v[52:55], a[108:111], v[244:247]
    v_mfma_f32_16x16x32_bf16 v[152:155], v[56:59], a[96:99], v[152:155]
    ds_read_b64_tr_b16 v[52:53], v13 offset:8192
    v_mfma_f32_16x16x32_bf16 v[184:187], v[56:59], a[100:103], v[184:187]
    ds_read_b64_tr_b16 v[54:55], v13 offset:9216
    v_mfma_f32_16x16x32_bf16 v[216:219], v[56:59], a[104:107], v[216:219]
    buffer_load_dwordx4 v19, s[12:15], s98 offen offset:3072  lds
    v_mfma_f32_16x16x32_bf16 v[248:251], v[56:59], a[108:111], v[248:251]
    v_mfma_f32_16x16x32_bf16 v[156:159], v[60:63], a[96:99], v[156:159]
    s_add_u32 m0, s62, 69632
    s_xor_b32 s98, s96, 33408
    ds_read_b64_tr_b16 v[56:57], v14 offset:8192
    v_mfma_f32_16x16x32_bf16 v[188:191], v[60:63], a[100:103], v[188:191]
    ds_read_b64_tr_b16 v[58:59], v14 offset:9216
    v_mfma_f32_16x16x32_bf16 v[220:223], v[60:63], a[104:107], v[220:223]
    buffer_load_dwordx4 v16, s[12:15], s98 offen offset:0  lds
    v_mfma_f32_16x16x32_bf16 v[252:255], v[60:63], a[108:111], v[252:255]
    v_mfma_f32_16x16x32_bf16 v[128:131], v[32:35], a[112:115], v[128:131]
    ds_read_b64_tr_b16 v[60:61], v15 offset:8192
    v_mfma_f32_16x16x32_bf16 v[160:163], v[32:35], a[116:119], v[160:163]
    ds_read_b64_tr_b16 v[62:63], v15 offset:9216
    v_mfma_f32_16x16x32_bf16 v[192:195], v[32:35], a[120:123], v[192:195]
    buffer_load_dwordx4 v17, s[12:15], s98 offen offset:1024  lds
    v_mfma_f32_16x16x32_bf16 v[224:227], v[32:35], a[124:127], v[224:227]
    v_mfma_f32_16x16x32_bf16 v[132:135], v[36:39], a[112:115], v[132:135]
    buffer_load_dwordx4 v18, s[12:15], s98 offen offset:2048  lds
    v_mfma_f32_16x16x32_bf16 v[164:167], v[36:39], a[116:119], v[164:167]
    v_mfma_f32_16x16x32_bf16 v[196:199], v[36:39], a[120:123], v[196:199]
    buffer_load_dwordx4 v19, s[12:15], s98 offen offset:3072  lds
    s_cmp_eq_u32 s3, 2
    s_cselect_b32 s101, s100, 2147479552
    buffer_load_dword a245, v117, s[24:27], s101 offen offset:4
    v_mfma_f32_16x16x32_bf16 v[228:231], v[36:39], a[124:127], v[228:231]
    s_waitcnt lgkmcnt(2)
    v_mfma_f32_16x16x32_bf16 v[136:139], v[40:43], a[112:115], v[136:139]
    s_waitcnt vmcnt(15) lgkmcnt(0)
    s_barrier
    v_mfma_f32_16x16x32_bf16 v[168:171], v[40:43], a[116:119], v[168:171]
    s_add_u32 m0, s63, 98304
    s_xor_b32 s98, s97, 3145728
    ds_read_b64_tr_b16 v[32:33], v8 offset:16384
    v_mfma_f32_16x16x32_bf16 v[200:203], v[40:43], a[120:123], v[200:203]
    ds_read_b64_tr_b16 v[34:35], v8 offset:17408
    v_mfma_f32_16x16x32_bf16 v[232:235], v[40:43], a[124:127], v[232:235]
    ds_read_b64_tr_b16 v[36:37], v9 offset:16384
    v_mfma_f32_16x16x32_bf16 v[140:143], v[44:47], a[112:115], v[140:143]
    ds_read_b64_tr_b16 v[38:39], v9 offset:17408
    v_mfma_f32_16x16x32_bf16 v[172:175], v[44:47], a[116:119], v[172:175]
    ds_read_b64_tr_b16 v[40:41], v10 offset:16384
    v_mfma_f32_16x16x32_bf16 v[204:207], v[44:47], a[120:123], v[204:207]
    ds_read_b64_tr_b16 v[42:43], v10 offset:17408
    v_mfma_f32_16x16x32_bf16 v[236:239], v[44:47], a[124:127], v[236:239]
    ds_read_b128 a[128:131], v28 offset:32768
    v_mfma_f32_16x16x32_bf16 v[144:147], v[48:51], a[112:115], v[144:147]
    ds_read_b64_tr_b16 v[44:45], v11 offset:16384
    v_mfma_f32_16x16x32_bf16 v[176:179], v[48:51], a[116:119], v[176:179]
    ds_read_b64_tr_b16 v[46:47], v11 offset:17408
    v_mfma_f32_16x16x32_bf16 v[208:211], v[48:51], a[120:123], v[208:211]
    ds_read_b128 a[132:135], v28 offset:34816
    v_mfma_f32_16x16x32_bf16 v[240:243], v[48:51], a[124:127], v[240:243]
    ds_read_b128 a[136:139], v28 offset:36864
    v_mfma_f32_16x16x32_bf16 v[148:151], v[52:55], a[112:115], v[148:151]
    ds_read_b64_tr_b16 v[48:49], v12 offset:16384
    v_mfma_f32_16x16x32_bf16 v[180:183], v[52:55], a[116:119], v[180:183]
    ds_read_b64_tr_b16 v[50:51], v12 offset:17408
    v_mfma_f32_16x16x32_bf16 v[212:215], v[52:55], a[120:123], v[212:215]
    ds_read_b128 a[140:143], v28 offset:38912
    v_mfma_f32_16x16x32_bf16 v[244:247], v[52:55], a[124:127], v[244:247]
    buffer_load_dwordx4 v20, s[16:19], s98 offen offset:0  lds
    v_mfma_f32_16x16x32_bf16 v[152:155], v[56:59], a[112:115], v[152:155]
    ds_read_b64_tr_b16 v[52:53], v13 offset:16384
    v_mfma_f32_16x16x32_bf16 v[184:187], v[56:59], a[116:119], v[184:187]
    ds_read_b64_tr_b16 v[54:55], v13 offset:17408
    v_mfma_f32_16x16x32_bf16 v[216:219], v[56:59], a[120:123], v[216:219]
    buffer_load_dwordx4 v21, s[16:19], s98 offen offset:1024  lds
    v_mfma_f32_16x16x32_bf16 v[248:251], v[56:59], a[124:127], v[248:251]
    ds_read_b128 v[88:91], v99
    v_mfma_f32_16x16x32_bf16 v[156:159], v[60:63], a[112:115], v[156:159]
    ds_read_b64_tr_b16 v[56:57], v14 offset:16384
    v_mfma_f32_16x16x32_bf16 v[188:191], v[60:63], a[116:119], v[188:191]
    ds_read_b64_tr_b16 v[58:59], v14 offset:17408
    v_mfma_f32_16x16x32_bf16 v[220:223], v[60:63], a[120:123], v[220:223]
    buffer_load_dwordx4 v22, s[16:19], s98 offen offset:2048  lds
    v_mfma_f32_16x16x32_bf16 v[252:255], v[60:63], a[124:127], v[252:255]
    s_waitcnt lgkmcnt(6)
    ds_read_b128 v[92:95], v99 offset:16
    v_mfma_f32_16x16x32_bf16 v[128:131], v[32:35], a[128:131], v[128:131]
    ds_read_b64_tr_b16 v[60:61], v15 offset:16384
    v_mfma_f32_16x16x32_bf16 v[160:163], v[32:35], a[132:135], v[160:163]
    ds_read_b64_tr_b16 v[62:63], v15 offset:17408
    v_mfma_f32_16x16x32_bf16 v[192:195], v[32:35], a[136:139], v[192:195]
    s_waitcnt lgkmcnt(7)
    ds_read_b128 a[144:147], v29 offset:32768
    v_mfma_f32_16x16x32_bf16 v[224:227], v[32:35], a[140:143], v[224:227]
    ds_read_b128 a[148:151], v29 offset:34816
    v_mfma_f32_16x16x32_bf16 v[132:135], v[36:39], a[128:131], v[132:135]
    ds_read_b64_tr_b16 v[32:33], v8 offset:24576
    v_mfma_f32_16x16x32_bf16 v[164:167], v[36:39], a[132:135], v[164:167]
    ds_read_b64_tr_b16 v[34:35], v8 offset:25600
    v_mfma_f32_16x16x32_bf16 v[196:199], v[36:39], a[136:139], v[196:199]
    ds_read_b128 a[152:155], v29 offset:36864
    v_mfma_f32_16x16x32_bf16 v[228:231], v[36:39], a[140:143], v[228:231]
    ds_read_b128 a[156:159], v29 offset:38912
    s_waitcnt lgkmcnt(11)
    v_add_f32 v108, v88, v90
    v_mfma_f32_16x16x32_bf16 v[136:139], v[40:43], a[128:131], v[136:139]
    ds_read_b64_tr_b16 v[36:37], v9 offset:24576
    s_waitcnt lgkmcnt(9)
    v_add_f32 v109, v92, v94
    v_mfma_f32_16x16x32_bf16 v[168:171], v[40:43], a[132:135], v[168:171]
    ds_read_b64_tr_b16 v[38:39], v9 offset:25600
    v_add_f32 v108, v108, v109
    v_mfma_f32_16x16x32_bf16 v[200:203], v[40:43], a[136:139], v[200:203]
    buffer_load_dwordx4 v23, s[16:19], s98 offen offset:3072  lds
    v_mfma_f32_16x16x32_bf16 v[232:235], v[40:43], a[140:143], v[232:235]
    v_mul_f32 v108, 0x3e800000, v108
    v_add_f32 v109, v89, v91
    v_mfma_f32_16x16x32_bf16 v[140:143], v[44:47], a[128:131], v[140:143]
    s_add_u32 m0, s62, 0
    s_xor_b32 s98, s96, 768
    ds_read_b64_tr_b16 v[40:41], v10 offset:24576
    v_mfma_f32_16x16x32_bf16 v[172:175], v[44:47], a[132:135], v[172:175]
    ds_read_b64_tr_b16 v[42:43], v10 offset:25600
    v_add_f32 v110, v93, v95
    v_mfma_f32_16x16x32_bf16 v[204:207], v[44:47], a[136:139], v[204:207]
    buffer_load_dwordx4 v16, s[12:15], s98 offen offset:0  lds
    v_mfma_f32_16x16x32_bf16 v[236:239], v[44:47], a[140:143], v[236:239]
    v_add_f32 v109, v109, v110
    v_sub_f32 v88, v88, v108
    v_mfma_f32_16x16x32_bf16 v[144:147], v[48:51], a[128:131], v[144:147]
    ds_read_b64_tr_b16 v[44:45], v11 offset:24576
    v_sub_f32 v90, v90, v108
    v_mfma_f32_16x16x32_bf16 v[176:179], v[48:51], a[132:135], v[176:179]
    ds_read_b64_tr_b16 v[46:47], v11 offset:25600
    v_sub_f32 v92, v92, v108
    v_mfma_f32_16x16x32_bf16 v[208:211], v[48:51], a[136:139], v[208:211]
    buffer_load_dwordx4 v17, s[12:15], s98 offen offset:1024  lds
    v_mfma_f32_16x16x32_bf16 v[240:243], v[48:51], a[140:143], v[240:243]
    v_sub_f32 v94, v94, v108
    v_mul_f32 v110, v88, v88
    v_mfma_f32_16x16x32_bf16 v[148:151], v[52:55], a[128:131], v[148:151]
    ds_read_b64_tr_b16 v[48:49], v12 offset:24576
    v_fmac_f32 v110, v90, v90
    v_mfma_f32_16x16x32_bf16 v[180:183], v[52:55], a[132:135], v[180:183]
    ds_read_b64_tr_b16 v[50:51], v12 offset:25600
    v_fmac_f32 v110, v92, v92
    v_mfma_f32_16x16x32_bf16 v[212:215], v[52:55], a[136:139], v[212:215]
    buffer_load_dwordx4 v18, s[12:15], s98 offen offset:2048  lds
    v_mfma_f32_16x16x32_bf16 v[244:247], v[52:55], a[140:143], v[244:247]
    v_fmac_f32 v110, v94, v94
    v_fmac_f32 v109, 0x43000000, v110
    v_mfma_f32_16x16x32_bf16 v[152:155], v[56:59], a[128:131], v[152:155]
    ds_read_b64_tr_b16 v[52:53], v13 offset:24576
    v_mov_b32 v110, 0x3727c5ac
    v_mfma_f32_16x16x32_bf16 v[184:187], v[56:59], a[132:135], v[184:187]
    ds_read_b64_tr_b16 v[54:55], v13 offset:25600
    v_fmac_f32 v110, 0x3b000000, v109
    v_mfma_f32_16x16x32_bf16 v[216:219], v[56:59], a[136:139], v[216:219]
    buffer_load_dwordx4 v19, s[12:15], s98 offen offset:3072  lds
    v_mfma_f32_16x16x32_bf16 v[248:251], v[56:59], a[140:143], v[248:251]
    s_waitcnt lgkmcnt(4)
    v_rsq_f32 v110, v110
    v_mfma_f32_16x16x32_bf16 v[156:159], v[60:63], a[128:131], v[156:159]
    s_add_u32 m0, s62, 4096
    s_xor_b32 s98, s96, 33536
    ds_read_b64_tr_b16 v[56:57], v14 offset:24576
    v_mfma_f32_16x16x32_bf16 v[188:191], v[60:63], a[132:135], v[188:191]
    ds_read_b64_tr_b16 v[58:59], v14 offset:25600
    v_sub_f32 v64, v64, v108
    v_mfma_f32_16x16x32_bf16 v[220:223], v[60:63], a[136:139], v[220:223]
    buffer_load_dwordx4 v16, s[12:15], s98 offen offset:0  lds
    v_mfma_f32_16x16x32_bf16 v[252:255], v[60:63], a[140:143], v[252:255]
    v_sub_f32 v65, v65, v108
    v_sub_f32 v66, v66, v108
    v_mfma_f32_16x16x32_bf16 v[128:131], v[32:35], a[144:147], v[128:131]
    ds_read_b64_tr_b16 v[60:61], v15 offset:24576
    v_sub_f32 v67, v67, v108
    v_mfma_f32_16x16x32_bf16 v[160:163], v[32:35], a[148:151], v[160:163]
    ds_read_b64_tr_b16 v[62:63], v15 offset:25600
    v_sub_f32 v68, v68, v108
    v_mfma_f32_16x16x32_bf16 v[192:195], v[32:35], a[152:155], v[192:195]
    buffer_load_dwordx4 v17, s[12:15], s98 offen offset:1024  lds
    v_mfma_f32_16x16x32_bf16 v[224:227], v[32:35], a[156:159], v[224:227]
    v_sub_f32 v69, v69, v108
    v_sub_f32 v70, v70, v108
    v_mfma_f32_16x16x32_bf16 v[132:135], v[36:39], a[144:147], v[132:135]
    buffer_load_dwordx4 v18, s[12:15], s98 offen offset:2048  lds
    v_mfma_f32_16x16x32_bf16 v[164:167], v[36:39], a[148:151], v[164:167]
    v_sub_f32 v71, v71, v108
    v_sub_f32 v72, v72, v108
    v_mfma_f32_16x16x32_bf16 v[196:199], v[36:39], a[152:155], v[196:199]
    buffer_load_dwordx4 v19, s[12:15], s98 offen offset:3072  lds
    s_cmp_eq_u32 s3, 3
    s_cselect_b32 s101, s100, 2147479552
    buffer_load_dword a247, v117, s[24:27], s101 offen offset:4
    v_mfma_f32_16x16x32_bf16 v[228:231], v[36:39], a[156:159], v[228:231]
    v_sub_f32 v73, v73, v108
    v_sub_f32 v74, v74, v108
    v_mfma_f32_16x16x32_bf16 v[136:139], v[40:43], a[144:147], v[136:139]
    v_sub_f32 v75, v75, v108
    v_sub_f32 v76, v76, v108
    s_waitcnt vmcnt(14) lgkmcnt(0)
    s_barrier
    v_mfma_f32_16x16x32_bf16 v[168:171], v[40:43], a[148:151], v[168:171]
    s_add_u32 m0, s63, 114688
    s_xor_b32 s98, s97, 3670016
    ds_read_b64_tr_b16 v[32:33], v8 offset:32768
    v_mfma_f32_16x16x32_bf16 v[200:203], v[40:43], a[152:155], v[200:203]
    ds_read_b64_tr_b16 v[34:35], v8 offset:33792
    v_sub_f32 v77, v77, v108
    v_mfma_f32_16x16x32_bf16 v[232:235], v[40:43], a[156:159], v[232:235]
    ds_read_b64_tr_b16 v[36:37], v9 offset:32768
    v_sub_f32 v78, v78, v108
    v_mfma_f32_16x16x32_bf16 v[140:143], v[44:47], a[144:147], v[140:143]
    ds_read_b64_tr_b16 v[38:39], v9 offset:33792
    v_sub_f32 v79, v79, v108
    v_mfma_f32_16x16x32_bf16 v[172:175], v[44:47], a[148:151], v[172:175]
    ds_read_b64_tr_b16 v[40:41], v10 offset:32768
    v_mul_f32 v64, v64, v110
    v_mfma_f32_16x16x32_bf16 v[204:207], v[44:47], a[152:155], v[204:207]
    ds_read_b64_tr_b16 v[42:43], v10 offset:33792
    v_mul_f32 v65, v65, v110
    v_mfma_f32_16x16x32_bf16 v[236:239], v[44:47], a[156:159], v[236:239]
    ds_read_b128 a[160:163], v30 offset:0
    v_mul_f32 v66, v66, v110
    v_mfma_f32_16x16x32_bf16 v[144:147], v[48:51], a[144:147], v[144:147]
    ds_read_b64_tr_b16 v[44:45], v11 offset:32768
    v_mul_f32 v67, v67, v110
    v_mfma_f32_16x16x32_bf16 v[176:179], v[48:51], a[148:151], v[176:179]
    ds_read_b64_tr_b16 v[46:47], v11 offset:33792
    v_mul_f32 v68, v68, v110
    v_mfma_f32_16x16x32_bf16 v[208:211], v[48:51], a[152:155], v[208:211]
    ds_read_b128 a[164:167], v30 offset:2048
    v_mul_f32 v69, v69, v110
    v_mfma_f32_16x16x32_bf16 v[240:243], v[48:51], a[156:159], v[240:243]
    ds_read_b128 a[168:171], v30 offset:4096
    v_mul_f32 v70, v70, v110
    v_mfma_f32_16x16x32_bf16 v[148:151], v[52:55], a[144:147], v[148:151]
    ds_read_b64_tr_b16 v[48:49], v12 offset:32768
    v_mul_f32 v71, v71, v110
    v_mfma_f32_16x16x32_bf16 v[180:183], v[52:55], a[148:151], v[180:183]
    ds_read_b64_tr_b16 v[50:51], v12 offset:33792
    v_mul_f32 v72, v72, v110
    v_mfma_f32_16x16x32_bf16 v[212:215], v[52:55], a[152:155], v[212:215]
    ds_read_b128 a[172:175], v30 offset:6144
    v_mul_f32 v73, v73, v110
    buffer_load_dword v3, v4, s[36:39], s67 offen sc0 sc1
    v_mfma_f32_16x16x32_bf16 v[244:247], v[52:55], a[156:159], v[244:247]
    buffer_load_dwordx4 v20, s[16:19], s98 offen offset:0  lds
    v_mfma_f32_16x16x32_bf16 v[152:155], v[56:59], a[144:147], v[152:155]
    ds_read_b64_tr_b16 v[52:53], v13 offset:32768
    v_mul_f32 v74, v74, v110
    v_mfma_f32_16x16x32_bf16 v[184:187], v[56:59], a[148:151], v[184:187]
    ds_read_b64_tr_b16 v[54:55], v13 offset:33792
    v_mul_f32 v75, v75, v110
    v_mfma_f32_16x16x32_bf16 v[216:219], v[56:59], a[152:155], v[216:219]
    buffer_load_dwordx4 v21, s[16:19], s98 offen offset:1024  lds
    v_mfma_f32_16x16x32_bf16 v[248:251], v[56:59], a[156:159], v[248:251]
    v_mul_f32 v76, v76, v110
    v_mul_f32 v77, v77, v110
    v_mfma_f32_16x16x32_bf16 v[156:159], v[60:63], a[144:147], v[156:159]
    ds_read_b64_tr_b16 v[56:57], v14 offset:32768
    v_mul_f32 v78, v78, v110
    v_mfma_f32_16x16x32_bf16 v[188:191], v[60:63], a[148:151], v[188:191]
    ds_read_b64_tr_b16 v[58:59], v14 offset:33792
    v_mul_f32 v79, v79, v110
    v_mfma_f32_16x16x32_bf16 v[220:223], v[60:63], a[152:155], v[220:223]
    buffer_load_dwordx4 v22, s[16:19], s98 offen offset:2048  lds
    v_mfma_f32_16x16x32_bf16 v[252:255], v[60:63], a[156:159], v[252:255]
    s_waitcnt lgkmcnt(5)
    v_mfma_f32_16x16x32_bf16 v[128:131], v[32:35], a[160:163], v[128:131]
    ds_read_b64_tr_b16 v[60:61], v15 offset:32768
    v_and_b32 v96, 31, v2
    v_mfma_f32_16x16x32_bf16 v[160:163], v[32:35], a[164:167], v[160:163]
    ds_read_b64_tr_b16 v[62:63], v15 offset:33792
    v_lshlrev_b32 v96, 4, v96
    v_mfma_f32_16x16x32_bf16 v[192:195], v[32:35], a[168:171], v[192:195]
    s_waitcnt lgkmcnt(5)
    ds_read_b128 a[176:179], v31 offset:0
    v_lshrrev_b32 v97, 5, v2
    v_mfma_f32_16x16x32_bf16 v[224:227], v[32:35], a[172:175], v[224:227]
    ds_read_b128 a[180:183], v31 offset:2048
    v_lshl_add_u32 v96, v97, 11, v96
    v_mfma_f32_16x16x32_bf16 v[132:135], v[36:39], a[160:163], v[132:135]
    ds_read_b64_tr_b16 v[32:33], v8 offset:40960
    v_mfma_f32_16x16x32_bf16 v[164:167], v[36:39], a[164:167], v[164:167]
    ds_read_b64_tr_b16 v[34:35], v8 offset:41984
    v_mfma_f32_16x16x32_bf16 v[196:199], v[36:39], a[168:171], v[196:199]
    ds_read_b128 a[184:187], v31 offset:4096
    v_mfma_f32_16x16x32_bf16 v[228:231], v[36:39], a[172:175], v[228:231]
    ds_read_b128 a[188:191], v31 offset:6144
    v_mfma_f32_16x16x32_bf16 v[136:139], v[40:43], a[160:163], v[136:139]
    ds_read_b64_tr_b16 v[36:37], v9 offset:40960
    v_mfma_f32_16x16x32_bf16 v[168:171], v[40:43], a[164:167], v[168:171]
    ds_read_b64_tr_b16 v[38:39], v9 offset:41984
    v_mfma_f32_16x16x32_bf16 v[200:203], v[40:43], a[168:171], v[200:203]
    buffer_load_dwordx4 v23, s[16:19], s98 offen offset:3072  lds
    v_mfma_f32_16x16x32_bf16 v[232:235], v[40:43], a[172:175], v[232:235]
    v_mfma_f32_16x16x32_bf16 v[140:143], v[44:47], a[160:163], v[140:143]
    s_add_u32 m0, s62, 32768
    s_xor_b32 s98, s96, 896
    ds_read_b64_tr_b16 v[40:41], v10 offset:40960
    v_mfma_f32_16x16x32_bf16 v[172:175], v[44:47], a[164:167], v[172:175]
    ds_read_b64_tr_b16 v[42:43], v10 offset:41984
    v_mfma_f32_16x16x32_bf16 v[204:207], v[44:47], a[168:171], v[204:207]
    buffer_load_dwordx4 v16, s[12:15], s98 offen offset:0  lds
    v_mfma_f32_16x16x32_bf16 v[236:239], v[44:47], a[172:175], v[236:239]
    v_mfma_f32_16x16x32_bf16 v[144:147], v[48:51], a[160:163], v[144:147]
    ds_read_b64_tr_b16 v[44:45], v11 offset:40960
    v_mfma_f32_16x16x32_bf16 v[176:179], v[48:51], a[164:167], v[176:179]
    ds_read_b64_tr_b16 v[46:47], v11 offset:41984
    v_mfma_f32_16x16x32_bf16 v[208:211], v[48:51], a[168:171], v[208:211]
    buffer_load_dwordx4 v17, s[12:15], s98 offen offset:1024  lds
    v_mfma_f32_16x16x32_bf16 v[240:243], v[48:51], a[172:175], v[240:243]
    s_waitcnt lgkmcnt(4)
    v_mfma_f32_16x16x32_bf16 v[148:151], v[52:55], a[160:163], v[148:151]
    ds_read_b64_tr_b16 v[48:49], v12 offset:40960
    v_mfma_f32_16x16x32_bf16 v[180:183], v[52:55], a[164:167], v[180:183]
    ds_read_b64_tr_b16 v[50:51], v12 offset:41984
    v_mfma_f32_16x16x32_bf16 v[212:215], v[52:55], a[168:171], v[212:215]
    buffer_load_dwordx4 v18, s[12:15], s98 offen offset:2048  lds
    v_mfma_f32_16x16x32_bf16 v[244:247], v[52:55], a[172:175], v[244:247]
    v_mfma_f32_16x16x32_bf16 v[152:155], v[56:59], a[160:163], v[152:155]
    ds_read_b64_tr_b16 v[52:53], v13 offset:40960
    v_mfma_f32_16x16x32_bf16 v[184:187], v[56:59], a[164:167], v[184:187]
    ds_read_b64_tr_b16 v[54:55], v13 offset:41984
    v_mfma_f32_16x16x32_bf16 v[216:219], v[56:59], a[168:171], v[216:219]
    buffer_load_dwordx4 v19, s[12:15], s98 offen offset:3072  lds
    v_mfma_f32_16x16x32_bf16 v[248:251], v[56:59], a[172:175], v[248:251]
    v_mfma_f32_16x16x32_bf16 v[156:159], v[60:63], a[160:163], v[156:159]
    s_add_u32 m0, s62, 36864
    s_xor_b32 s98, s96, 33664
    ds_read_b64_tr_b16 v[56:57], v14 offset:40960
    v_mfma_f32_16x16x32_bf16 v[188:191], v[60:63], a[164:167], v[188:191]
    ds_read_b64_tr_b16 v[58:59], v14 offset:41984
    v_mfma_f32_16x16x32_bf16 v[220:223], v[60:63], a[168:171], v[220:223]
    buffer_load_dwordx4 v16, s[12:15], s98 offen offset:0  lds
    v_mfma_f32_16x16x32_bf16 v[252:255], v[60:63], a[172:175], v[252:255]
    v_mfma_f32_16x16x32_bf16 v[128:131], v[32:35], a[176:179], v[128:131]
    ds_read_b64_tr_b16 v[60:61], v15 offset:40960
    v_mfma_f32_16x16x32_bf16 v[160:163], v[32:35], a[180:183], v[160:163]
    ds_read_b64_tr_b16 v[62:63], v15 offset:41984
    v_mfma_f32_16x16x32_bf16 v[192:195], v[32:35], a[184:187], v[192:195]
    buffer_load_dwordx4 v17, s[12:15], s98 offen offset:1024  lds
    v_mfma_f32_16x16x32_bf16 v[224:227], v[32:35], a[188:191], v[224:227]
    v_mfma_f32_16x16x32_bf16 v[132:135], v[36:39], a[176:179], v[132:135]
    buffer_load_dwordx4 v18, s[12:15], s98 offen offset:2048  lds
    v_mfma_f32_16x16x32_bf16 v[164:167], v[36:39], a[180:183], v[164:167]
    v_mfma_f32_16x16x32_bf16 v[196:199], v[36:39], a[184:187], v[196:199]
    buffer_load_dwordx4 v19, s[12:15], s98 offen offset:3072  lds
    v_mfma_f32_16x16x32_bf16 v[228:231], v[36:39], a[188:191], v[228:231]
    s_waitcnt lgkmcnt(2)
    s_waitcnt vmcnt(12)
    v_cmp_le_u32 vcc, s68, v3
    s_cmp_eq_u64 vcc, -1
    s_cbranch_scc0 L_E_slow_1
L_E_ok_2:
    v_mfma_f32_16x16x32_bf16 v[136:139], v[40:43], a[176:179], v[136:139]
    s_waitcnt lgkmcnt(0)
    s_barrier
    v_mfma_f32_16x16x32_bf16 v[168:171], v[40:43], a[180:183], v[168:171]
    s_add_u32 m0, s62, 65536
    s_xor_b32 s98, s64, 0
    ds_read_b64_tr_b16 v[32:33], v8 offset:0
    v_mfma_f32_16x16x32_bf16 v[200:203], v[40:43], a[184:187], v[200:203]
    ds_read_b64_tr_b16 v[34:35], v8 offset:1024
    v_mov_b32 v18, v106
    v_mfma_f32_16x16x32_bf16 v[232:235], v[40:43], a[188:191], v[232:235]
    ds_read_b64_tr_b16 v[36:37], v9 offset:0
    v_mov_b32 v19, v107
    v_mfma_f32_16x16x32_bf16 v[140:143], v[44:47], a[176:179], v[140:143]
    ds_read_b64_tr_b16 v[38:39], v9 offset:1024
    v_mfma_f32_16x16x32_bf16 v[172:175], v[44:47], a[180:183], v[172:175]
    ds_read_b64_tr_b16 v[40:41], v10 offset:0
    v_mfma_f32_16x16x32_bf16 v[204:207], v[44:47], a[184:187], v[204:207]
    ds_read_b64_tr_b16 v[42:43], v10 offset:1024
    v_mfma_f32_16x16x32_bf16 v[236:239], v[44:47], a[188:191], v[236:239]
    ds_read_b128 a[192:195], v28 offset:0
    v_mfma_f32_16x16x32_bf16 v[144:147], v[48:51], a[176:179], v[144:147]
    ds_read_b64_tr_b16 v[44:45], v11 offset:0
    v_mfma_f32_16x16x32_bf16 v[176:179], v[48:51], a[180:183], v[176:179]
    ds_read_b64_tr_b16 v[46:47], v11 offset:1024
    v_mfma_f32_16x16x32_bf16 v[208:211], v[48:51], a[184:187], v[208:211]
    ds_read_b128 a[196:199], v28 offset:2048
    v_mfma_f32_16x16x32_bf16 v[240:243], v[48:51], a[188:191], v[240:243]
    ds_read_b128 a[200:203], v28 offset:4096
    v_mfma_f32_16x16x32_bf16 v[148:151], v[52:55], a[176:179], v[148:151]
    ds_read_b64_tr_b16 v[48:49], v12 offset:0
    v_mfma_f32_16x16x32_bf16 v[180:183], v[52:55], a[180:183], v[180:183]
    ds_read_b64_tr_b16 v[50:51], v12 offset:1024
    v_mfma_f32_16x16x32_bf16 v[212:215], v[52:55], a[184:187], v[212:215]
    ds_read_b128 a[204:207], v28 offset:6144
    v_mfma_f32_16x16x32_bf16 v[244:247], v[52:55], a[188:191], v[244:247]
    buffer_load_dwordx4 v24, s[20:23], s98 offen offset:0  lds
    v_mfma_f32_16x16x32_bf16 v[152:155], v[56:59], a[176:179], v[152:155]
    ds_read_b64_tr_b16 v[52:53], v13 offset:0
    v_mfma_f32_16x16x32_bf16 v[184:187], v[56:59], a[180:183], v[184:187]
    ds_read_b64_tr_b16 v[54:55], v13 offset:1024
    v_mfma_f32_16x16x32_bf16 v[216:219], v[56:59], a[184:187], v[216:219]
    buffer_load_dwordx4 v[80:83], v96, s[8:11], s70 offen
    v_mfma_f32_16x16x32_bf16 v[248:251], v[56:59], a[188:191], v[248:251]
    buffer_load_dwordx4 v25, s[20:23], s98 offen offset:1024  lds
    v_mfma_f32_16x16x32_bf16 v[156:159], v[60:63], a[176:179], v[156:159]
    s_lshl_b32 s80, s2, 6
    s_add_u32 s80, s80, 1310720
    ds_read_b64_tr_b16 v[56:57], v14 offset:0
    v_mfma_f32_16x16x32_bf16 v[188:191], v[60:63], a[180:183], v[188:191]
    s_waitcnt lgkmcnt(6)
    s_add_u32 s70, s70, 12288
    ds_read_b64_tr_b16 v[58:59], v14 offset:1024
    v_mfma_f32_16x16x32_bf16 v[220:223], v[60:63], a[184:187], v[220:223]
    buffer_store_dword v6, v7, s[8:11], s80 offen sc0 sc1
    v_mfma_f32_16x16x32_bf16 v[252:255], v[60:63], a[188:191], v[252:255]
    buffer_load_dwordx4 v26, s[20:23], s98 offen offset:2048  lds
    v_mfma_f32_16x16x32_bf16 v[128:131], v[32:35], a[192:195], v[128:131]
    ds_read_b64_tr_b16 v[60:61], v15 offset:0
    v_mfma_f32_16x16x32_bf16 v[160:163], v[32:35], a[196:199], v[160:163]
    ds_read_b64_tr_b16 v[62:63], v15 offset:1024
    v_mfma_f32_16x16x32_bf16 v[192:195], v[32:35], a[200:203], v[192:195]
    s_waitcnt lgkmcnt(5)
    ds_read_b128 a[208:211], v29 offset:0
    v_mfma_f32_16x16x32_bf16 v[224:227], v[32:35], a[204:207], v[224:227]
    ds_read_b128 a[212:215], v29 offset:2048
    v_mfma_f32_16x16x32_bf16 v[132:135], v[36:39], a[192:195], v[132:135]
    ds_read_b64_tr_b16 v[32:33], v8 offset:8192
    v_mfma_f32_16x16x32_bf16 v[164:167], v[36:39], a[196:199], v[164:167]
    ds_read_b64_tr_b16 v[34:35], v8 offset:9216
    v_mfma_f32_16x16x32_bf16 v[196:199], v[36:39], a[200:203], v[196:199]
    ds_read_b128 a[216:219], v29 offset:4096
    v_mfma_f32_16x16x32_bf16 v[228:231], v[36:39], a[204:207], v[228:231]
    ds_read_b128 a[220:223], v29 offset:6144
    v_mfma_f32_16x16x32_bf16 v[136:139], v[40:43], a[192:195], v[136:139]
    ds_read_b64_tr_b16 v[36:37], v9 offset:8192
    v_mfma_f32_16x16x32_bf16 v[168:171], v[40:43], a[196:199], v[168:171]
    ds_read_b64_tr_b16 v[38:39], v9 offset:9216
    v_mfma_f32_16x16x32_bf16 v[200:203], v[40:43], a[200:203], v[200:203]
    buffer_load_dwordx4 v27, s[20:23], s98 offen offset:3072  lds
    v_mfma_f32_16x16x32_bf16 v[232:235], v[40:43], a[204:207], v[232:235]
    buffer_load_dwordx4 v[84:87], v96, s[8:11], s70 offen
    v_mfma_f32_16x16x32_bf16 v[140:143], v[44:47], a[192:195], v[140:143]
    s_add_u32 m0, s62, 69632
    s_xor_b32 s98, s64, 262144
    ds_read_b64_tr_b16 v[40:41], v10 offset:8192
    v_mfma_f32_16x16x32_bf16 v[172:175], v[44:47], a[196:199], v[172:175]
    s_add_u32 s70, s70, 12288
    ds_read_b64_tr_b16 v[42:43], v10 offset:9216
    v_mfma_f32_16x16x32_bf16 v[204:207], v[44:47], a[200:203], v[204:207]
    buffer_load_dwordx4 v24, s[20:23], s98 offen offset:0  lds
    v_mfma_f32_16x16x32_bf16 v[236:239], v[44:47], a[204:207], v[236:239]
    buffer_load_dwordx4 v[88:91], v96, s[8:11], s70 offen
    v_mfma_f32_16x16x32_bf16 v[144:147], v[48:51], a[192:195], v[144:147]
    s_add_u32 s70, s70, 12288
    ds_read_b64_tr_b16 v[44:45], v11 offset:8192
    v_mfma_f32_16x16x32_bf16 v[176:179], v[48:51], a[196:199], v[176:179]
    s_waitcnt lgkmcnt(5)
    ds_read_b64_tr_b16 v[46:47], v11 offset:9216
    v_mfma_f32_16x16x32_bf16 v[208:211], v[48:51], a[200:203], v[208:211]
    buffer_load_dwordx4 v25, s[20:23], s98 offen offset:1024  lds
    v_mfma_f32_16x16x32_bf16 v[240:243], v[48:51], a[204:207], v[240:243]
    buffer_load_dwordx4 v[92:95], v96, s[8:11], s70 offen
    v_mfma_f32_16x16x32_bf16 v[148:151], v[52:55], a[192:195], v[148:151]
    ds_read_b64_tr_b16 v[48:49], v12 offset:8192
    v_mfma_f32_16x16x32_bf16 v[180:183], v[52:55], a[196:199], v[180:183]
    ds_read_b64_tr_b16 v[50:51], v12 offset:9216
    v_mfma_f32_16x16x32_bf16 v[212:215], v[52:55], a[200:203], v[212:215]
    buffer_load_dwordx4 v26, s[20:23], s98 offen offset:2048  lds
    v_mfma_f32_16x16x32_bf16 v[244:247], v[52:55], a[204:207], v[244:247]
    v_mfma_f32_16x16x32_bf16 v[152:155], v[56:59], a[192:195], v[152:155]
    ds_read_b64_tr_b16 v[52:53], v13 offset:8192
    v_mfma_f32_16x16x32_bf16 v[184:187], v[56:59], a[196:199], v[184:187]
    ds_read_b64_tr_b16 v[54:55], v13 offset:9216
    v_mfma_f32_16x16x32_bf16 v[216:219], v[56:59], a[200:203], v[216:219]
    buffer_load_dwordx4 v27, s[20:23], s98 offen offset:3072  lds
    v_mfma_f32_16x16x32_bf16 v[248:251], v[56:59], a[204:207], v[248:251]
    v_mfma_f32_16x16x32_bf16 v[156:159], v[60:63], a[192:195], v[156:159]
    ds_read_b64_tr_b16 v[56:57], v14 offset:8192
    v_mfma_f32_16x16x32_bf16 v[188:191], v[60:63], a[196:199], v[188:191]
    ds_read_b64_tr_b16 v[58:59], v14 offset:9216
    v_mfma_f32_16x16x32_bf16 v[220:223], v[60:63], a[200:203], v[220:223]
    v_mfma_f32_16x16x32_bf16 v[252:255], v[60:63], a[204:207], v[252:255]
    v_mfma_f32_16x16x32_bf16 v[128:131], v[32:35], a[208:211], v[128:131]
    ds_read_b64_tr_b16 v[60:61], v15 offset:8192
    v_mfma_f32_16x16x32_bf16 v[160:163], v[32:35], a[212:215], v[160:163]
    ds_read_b64_tr_b16 v[62:63], v15 offset:9216
    v_mfma_f32_16x16x32_bf16 v[192:195], v[32:35], a[216:219], v[192:195]
    s_getpc_b64 s[100:101]
L_ct1:
    s_lshr_b32 s99, s2, 3
    s_lshl_b32 s99, s99, 2
    s_add_u32 s99, s99, s3
    s_mul_i32 s99, s99, 2
    v_min_u32 v119, 1, v2
    v_add_u32 v119, s99, v119
    v_lshlrev_b32 v119, 7, v119
    v_add_u32 v119, L_ct1-L_ct1, v119
    v_min_u32 v119, L_attn-L_ct1, v119
    global_load_dword v119, v119, s[100:101]
    v_mfma_f32_16x16x32_bf16 v[224:227], v[32:35], a[220:223], v[224:227]
    s_waitcnt lgkmcnt(4)
    v_mfma_f32_16x16x32_bf16 v[132:135], v[36:39], a[208:211], v[132:135]
    v_mfma_f32_16x16x32_bf16 v[164:167], v[36:39], a[212:215], v[164:167]
    v_mfma_f32_16x16x32_bf16 v[196:199], v[36:39], a[216:219], v[196:199]
    v_mfma_f32_16x16x32_bf16 v[228:231], v[36:39], a[220:223], v[228:231]
    v_mfma_f32_16x16x32_bf16 v[136:139], v[40:43], a[208:211], v[136:139]
    s_waitcnt vmcnt(14) lgkmcnt(0)
    s_barrier
    v_mfma_f32_16x16x32_bf16 v[168:171], v[40:43], a[212:215], v[168:171]
    s_add_u32 m0, s62, 0
    s_xor_b32 s98, s64, 2097152
    ds_read_b64_tr_b16 v[32:33], v8 offset:16384
    v_mfma_f32_16x16x32_bf16 v[200:203], v[40:43], a[216:219], v[200:203]
    ds_read_b64_tr_b16 v[34:35], v8 offset:17408
    v_mfma_f32_16x16x32_bf16 v[232:235], v[40:43], a[220:223], v[232:235]
    ds_read_b64_tr_b16 v[36:37], v9 offset:16384
    v_mfma_f32_16x16x32_bf16 v[140:143], v[44:47], a[208:211], v[140:143]
    ds_read_b64_tr_b16 v[38:39], v9 offset:17408
    v_mfma_f32_16x16x32_bf16 v[172:175], v[44:47], a[212:215], v[172:175]
    ds_read_b64_tr_b16 v[40:41], v10 offset:16384
    v_mfma_f32_16x16x32_bf16 v[204:207], v[44:47], a[216:219], v[204:207]
    ds_read_b64_tr_b16 v[42:43], v10 offset:17408
    v_mfma_f32_16x16x32_bf16 v[236:239], v[44:47], a[220:223], v[236:239]
    ds_read_b128 a[224:227], v28 offset:32768
    v_mfma_f32_16x16x32_bf16 v[144:147], v[48:51], a[208:211], v[144:147]
    ds_read_b64_tr_b16 v[44:45], v11 offset:16384
    v_mfma_f32_16x16x32_bf16 v[176:179], v[48:51], a[212:215], v[176:179]
    ds_read_b64_tr_b16 v[46:47], v11 offset:17408
    v_mfma_f32_16x16x32_bf16 v[208:211], v[48:51], a[216:219], v[208:211]
    ds_read_b128 a[228:231], v28 offset:34816
    v_mfma_f32_16x16x32_bf16 v[240:243], v[48:51], a[220:223], v[240:243]
    ds_read_b128 a[232:235], v28 offset:36864
    v_mfma_f32_16x16x32_bf16 v[148:151], v[52:55], a[208:211], v[148:151]
    ds_read_b64_tr_b16 v[48:49], v12 offset:16384
    v_mfma_f32_16x16x32_bf16 v[180:183], v[52:55], a[212:215], v[180:183]
    ds_read_b64_tr_b16 v[50:51], v12 offset:17408
    v_mfma_f32_16x16x32_bf16 v[212:215], v[52:55], a[216:219], v[212:215]
    ds_read_b128 a[236:239], v28 offset:38912
    v_mfma_f32_16x16x32_bf16 v[244:247], v[52:55], a[220:223], v[244:247]
    buffer_load_dwordx4 v24, s[20:23], s98 offen offset:0  lds
    v_mfma_f32_16x16x32_bf16 v[152:155], v[56:59], a[208:211], v[152:155]
    ds_read_b64_tr_b16 v[52:53], v13 offset:16384
    v_mfma_f32_16x16x32_bf16 v[184:187], v[56:59], a[212:215], v[184:187]
    ds_read_b64_tr_b16 v[54:55], v13 offset:17408
    v_mfma_f32_16x16x32_bf16 v[216:219], v[56:59], a[216:219], v[216:219]
    v_mfma_f32_16x16x32_bf16 v[248:251], v[56:59], a[220:223], v[248:251]
    buffer_load_dwordx4 v25, s[20:23], s98 offen offset:1024  lds
    v_mfma_f32_16x16x32_bf16 v[156:159], v[60:63], a[208:211], v[156:159]
    ds_read_b64_tr_b16 v[56:57], v14 offset:16384
    v_mfma_f32_16x16x32_bf16 v[188:191], v[60:63], a[212:215], v[188:191]
    ds_read_b64_tr_b16 v[58:59], v14 offset:17408
    v_mfma_f32_16x16x32_bf16 v[220:223], v[60:63], a[216:219], v[220:223]
    s_waitcnt lgkmcnt(6)
    v_mfma_f32_16x16x32_bf16 v[252:255], v[60:63], a[220:223], v[252:255]
    buffer_load_dwordx4 v26, s[20:23], s98 offen offset:2048  lds
    v_mfma_f32_16x16x32_bf16 v[128:131], v[32:35], a[224:227], v[128:131]
    ds_read_b64_tr_b16 v[60:61], v15 offset:16384
    v_mfma_f32_16x16x32_bf16 v[160:163], v[32:35], a[228:231], v[160:163]
    ds_read_b64_tr_b16 v[62:63], v15 offset:17408
    v_mfma_f32_16x16x32_bf16 v[192:195], v[32:35], a[232:235], v[192:195]
    s_waitcnt lgkmcnt(5)
    ds_read_b128 a[240:243], v29 offset:32768
    v_mfma_f32_16x16x32_bf16 v[224:227], v[32:35], a[236:239], v[224:227]
    ds_read_b128 a[244:247], v29 offset:34816
    v_mfma_f32_16x16x32_bf16 v[132:135], v[36:39], a[224:227], v[132:135]
    ds_read_b64_tr_b16 v[32:33], v8 offset:24576
    v_mfma_f32_16x16x32_bf16 v[164:167], v[36:39], a[228:231], v[164:167]
    ds_read_b64_tr_b16 v[34:35], v8 offset:25600
    s_waitcnt vmcnt(10)
    v_add_f32 v80, v80, v84
    s_waitcnt vmcnt(6)
    v_add_f32 v88, v88, v92
    v_mfma_f32_16x16x32_bf16 v[196:199], v[36:39], a[232:235], v[196:199]
    ds_read_b128 a[248:251], v29 offset:36864
    v_add_f32 v81, v81, v85
    v_add_f32 v89, v89, v93
    v_mfma_f32_16x16x32_bf16 v[228:231], v[36:39], a[236:239], v[228:231]
    ds_read_b128 a[252:255], v29 offset:38912
    v_add_f32 v82, v82, v86
    v_add_f32 v90, v90, v94
    v_mfma_f32_16x16x32_bf16 v[136:139], v[40:43], a[224:227], v[136:139]
    ds_read_b64_tr_b16 v[36:37], v9 offset:24576
    v_and_b32 v16, 15, v2
    v_add_f32 v83, v83, v87
    v_mfma_f32_16x16x32_bf16 v[168:171], v[40:43], a[228:231], v[168:171]
    ds_read_b64_tr_b16 v[38:39], v9 offset:25600
    v_lshrrev_b32 v17, 4, v2
    v_add_f32 v91, v91, v95
    v_mfma_f32_16x16x32_bf16 v[200:203], v[40:43], a[232:235], v[200:203]
    v_lshrrev_b32 v29, 2, v16
    v_and_b32 v16, 3, v16
    v_add_f32 v80, v80, v88
    v_mfma_f32_16x16x32_bf16 v[232:235], v[40:43], a[236:239], v[232:235]
    buffer_load_dwordx4 v27, s[20:23], s98 offen offset:3072  lds
    v_add_f32 v81, v81, v89
    v_mfma_f32_16x16x32_bf16 v[140:143], v[44:47], a[224:227], v[140:143]
    s_add_u32 m0, s62, 4096
    ds_read_b64_tr_b16 v[40:41], v10 offset:24576
    v_lshl_add_u32 v28, v17, 3, v29
    v_add_f32 v82, v82, v90
    v_mfma_f32_16x16x32_bf16 v[172:175], v[44:47], a[228:231], v[172:175]
    s_xor_b32 s98, s64, 2359296
    ds_read_b64_tr_b16 v[42:43], v10 offset:25600
    v_lshlrev_b32 v28, 7, v28
    v_add_f32 v83, v83, v91
    v_mfma_f32_16x16x32_bf16 v[204:207], v[44:47], a[232:235], v[204:207]
    v_lshl_add_u32 v28, v16, 3, v28
    v_and_b32 v17, 1, v17
    v_lshrrev_b32 v88, 5, v2
    v_mfma_f32_16x16x32_bf16 v[236:239], v[44:47], a[236:239], v[236:239]
    buffer_load_dwordx4 v24, s[20:23], s98 offen offset:0  lds
    v_cvt_f32_u32 v88, v88
    v_mfma_f32_16x16x32_bf16 v[144:147], v[48:51], a[224:227], v[144:147]
    ds_read_b64_tr_b16 v[44:45], v11 offset:24576
    v_lshrrev_b32 v29, 1, v29
    v_cvt_pk_bf16_f32 v84, v80, v81
    v_mfma_f32_16x16x32_bf16 v[176:179], v[48:51], a[228:231], v[176:179]
    ds_read_b64_tr_b16 v[46:47], v11 offset:25600
    v_lshl_add_u32 v29, v17, 1, v29
    v_cvt_pk_bf16_f32 v85, v82, v83
    v_mfma_f32_16x16x32_bf16 v[208:211], v[48:51], a[232:235], v[208:211]
    s_waitcnt lgkmcnt(5)
    v_lshl_add_u32 v28, v29, 5, v28
    v_add_u32 v28, 65536, v28
    v_lshlrev_b32 v80, 16, v84
    v_mfma_f32_16x16x32_bf16 v[240:243], v[48:51], a[236:239], v[240:243]
    buffer_load_dwordx4 v25, s[20:23], s98 offen offset:1024  lds
    v_and_b32 v81, 0xffff0000, v84
    v_mfma_f32_16x16x32_bf16 v[148:151], v[52:55], a[224:227], v[148:151]
    ds_read_b64_tr_b16 v[48:49], v12 offset:24576
    v_xor_b32 v29, 32, v28
    v_lshlrev_b32 v82, 16, v85
    v_mfma_f32_16x16x32_bf16 v[180:183], v[52:55], a[228:231], v[180:183]
    ds_read_b64_tr_b16 v[50:51], v12 offset:25600
    v_xor_b32 v30, 64, v28
    v_and_b32 v83, 0xffff0000, v85
    v_mfma_f32_16x16x32_bf16 v[212:215], v[52:55], a[232:235], v[212:215]
    v_xor_b32 v31, 96, v28
    v_and_b32 v16, 15, v2
    v_add_f32 v80, v80, v88
    v_mfma_f32_16x16x32_bf16 v[244:247], v[52:55], a[236:239], v[244:247]
    buffer_load_dwordx4 v26, s[20:23], s98 offen offset:2048  lds
    v_add_f32 v81, v81, v88
    v_mfma_f32_16x16x32_bf16 v[152:155], v[56:59], a[224:227], v[152:155]
    ds_read_b64_tr_b16 v[52:53], v13 offset:24576
    v_lshlrev_b32 v16, 6, v16
    v_add_f32 v82, v82, v88
    v_mfma_f32_16x16x32_bf16 v[184:187], v[56:59], a[228:231], v[184:187]
    ds_read_b64_tr_b16 v[54:55], v13 offset:25600
    v_add_u32 v16, 65536, v16
    v_add_f32 v83, v83, v88
    v_mfma_f32_16x16x32_bf16 v[216:219], v[56:59], a[232:235], v[216:219]
    v_mad_i32_i24 v16, v17, s77, v16
    v_and_b32 v17, 31, v2
    v_cvt_pk_bf16_f32 v84, v80, v81
    v_mfma_f32_16x16x32_bf16 v[248:251], v[56:59], a[236:239], v[248:251]
    buffer_load_dwordx4 v27, s[20:23], s98 offen offset:3072  lds
    v_cvt_pk_bf16_f32 v85, v82, v83
    v_mfma_f32_16x16x32_bf16 v[156:159], v[60:63], a[224:227], v[156:159]
    ds_read_b64_tr_b16 v[56:57], v14 offset:24576
    v_lshlrev_b32 v17, 6, v17
    v_lshlrev_b32 v80, 16, v84
    v_mfma_f32_16x16x32_bf16 v[188:191], v[60:63], a[228:231], v[188:191]
    ds_read_b64_tr_b16 v[58:59], v14 offset:25600
    v_and_b32 v81, 0xffff0000, v84
    v_lshlrev_b32 v82, 16, v85
    v_mfma_f32_16x16x32_bf16 v[220:223], v[60:63], a[232:235], v[220:223]
    v_and_b32 v83, 0xffff0000, v85
    v_mul_f32 v80, 0x3e0293ee, v80
    v_mul_f32 v81, 0x3e0293ee, v81
    v_mfma_f32_16x16x32_bf16 v[252:255], v[60:63], a[236:239], v[252:255]
    v_mul_f32 v82, 0x3e0293ee, v82
    v_mul_f32 v83, 0x3e0293ee, v83
    v_mfma_f32_16x16x32_bf16 v[128:131], v[32:35], a[240:243], v[128:131]
    s_lshl_b32 s70, s3, 10
    s_add_u32 s70, s70, 151552
    ds_read_b64_tr_b16 v[60:61], v15 offset:24576
    v_add_u32 v88, s70, v1
    v_add_u32 v18, s70, v18
    v_mfma_f32_16x16x32_bf16 v[160:163], v[32:35], a[244:247], v[160:163]
    ds_read_b64_tr_b16 v[62:63], v15 offset:25600
    ds_write_b128 v88, v[80:83]
    v_mfma_f32_16x16x32_bf16 v[192:195], v[32:35], a[248:251], v[192:195]
    v_mfma_f32_16x16x32_bf16 v[224:227], v[32:35], a[252:255], v[224:227]
    s_waitcnt lgkmcnt(5)
    v_mfma_f32_16x16x32_bf16 v[132:135], v[36:39], a[240:243], v[132:135]
    v_mfma_f32_16x16x32_bf16 v[164:167], v[36:39], a[244:247], v[164:167]
    v_mfma_f32_16x16x32_bf16 v[196:199], v[36:39], a[248:251], v[196:199]
    v_mfma_f32_16x16x32_bf16 v[228:231], v[36:39], a[252:255], v[228:231]
    ds_read_b128 v[80:83], v18 offset:0
    v_mfma_f32_16x16x32_bf16 v[136:139], v[40:43], a[240:243], v[136:139]
    ds_read_b128 v[84:87], v18 offset:16
    s_waitcnt vmcnt(9) lgkmcnt(0)
    s_barrier
    v_mfma_f32_16x16x32_bf16 v[168:171], v[40:43], a[244:247], v[168:171]
    s_add_u32 m0, s62, 32768
    s_xor_b32 s98, s64, 128
    ds_read_b64_tr_b16 v[32:33], v28 offset:0
    v_mfma_f32_16x16x32_bf16 v[200:203], v[40:43], a[248:251], v[200:203]
    ds_read_b64_tr_b16 v[34:35], v28 offset:512
    v_mfma_f32_16x16x32_bf16 v[232:235], v[40:43], a[252:255], v[232:235]
    ds_read_b64_tr_b16 v[36:37], v28 offset:4096
    v_mfma_f32_16x16x32_bf16 v[140:143], v[44:47], a[240:243], v[140:143]
    ds_read_b64_tr_b16 v[38:39], v28 offset:4608
    v_mfma_f32_16x16x32_bf16 v[172:175], v[44:47], a[244:247], v[172:175]
    ds_read_b64_tr_b16 v[40:41], v29 offset:0
    v_mfma_f32_16x16x32_bf16 v[204:207], v[44:47], a[248:251], v[204:207]
    ds_read_b64_tr_b16 v[42:43], v29 offset:512
    v_mfma_f32_16x16x32_bf16 v[236:239], v[44:47], a[252:255], v[236:239]
    buffer_load_dwordx4 v24, s[20:23], s98 offen offset:0  lds
    v_mfma_f32_16x16x32_bf16 v[144:147], v[48:51], a[240:243], v[144:147]
    ds_read_b64_tr_b16 v[44:45], v29 offset:4096
    v_mfma_f32_16x16x32_bf16 v[176:179], v[48:51], a[244:247], v[176:179]
    ds_read_b64_tr_b16 v[46:47], v29 offset:4608
    v_mfma_f32_16x16x32_bf16 v[208:211], v[48:51], a[248:251], v[208:211]
    ds_read_b128 v[88:91], v18 offset:512
    v_mfma_f32_16x16x32_bf16 v[240:243], v[48:51], a[252:255], v[240:243]
    buffer_load_dwordx4 v25, s[20:23], s98 offen offset:1024  lds
    v_mfma_f32_16x16x32_bf16 v[148:151], v[52:55], a[240:243], v[148:151]
    ds_read_b64_tr_b16 v[48:49], v28 offset:8192
    v_mfma_f32_16x16x32_bf16 v[180:183], v[52:55], a[244:247], v[180:183]
    ds_read_b64_tr_b16 v[50:51], v28 offset:8704
    v_mfma_f32_16x16x32_bf16 v[212:215], v[52:55], a[248:251], v[212:215]
    ds_read_b128 v[92:95], v18 offset:528
    v_mfma_f32_16x16x32_bf16 v[244:247], v[52:55], a[252:255], v[244:247]
    buffer_load_dwordx4 v26, s[20:23], s98 offen offset:2048  lds
    v_mfma_f32_16x16x32_bf16 v[152:155], v[56:59], a[240:243], v[152:155]
    ds_read_b64_tr_b16 v[52:53], v28 offset:12288
    v_mfma_f32_16x16x32_bf16 v[184:187], v[56:59], a[244:247], v[184:187]
    ds_read_b64_tr_b16 v[54:55], v28 offset:12800
    v_mfma_f32_16x16x32_bf16 v[216:219], v[56:59], a[248:251], v[216:219]
    v_mfma_f32_16x16x32_bf16 v[248:251], v[56:59], a[252:255], v[248:251]
    buffer_load_dwordx4 v27, s[20:23], s98 offen offset:3072  lds
    v_mfma_f32_16x16x32_bf16 v[156:159], v[60:63], a[240:243], v[156:159]
    s_add_u32 m0, s62, 36864
    s_xor_b32 s98, s64, 262272
    ds_read_b64_tr_b16 v[56:57], v29 offset:8192
    v_mfma_f32_16x16x32_bf16 v[188:191], v[60:63], a[244:247], v[188:191]
    ds_read_b64_tr_b16 v[58:59], v29 offset:8704
    s_waitcnt lgkmcnt(7)
    v_fma_f32 v64, v64, v88, v80
    v_mfma_f32_16x16x32_bf16 v[220:223], v[60:63], a[248:251], v[220:223]
    v_fma_f32 v65, v65, v89, v81
    v_fma_f32 v66, v66, v90, v82
    v_mfma_f32_16x16x32_bf16 v[252:255], v[60:63], a[252:255], v[252:255]
    buffer_load_dwordx4 v24, s[20:23], s98 offen offset:0  lds
    v_mfma_f32_16x16x32_bf16 v[96:99], a[0:3], v[32:35], 0
    ds_read_b64_tr_b16 v[60:61], v29 offset:12288
    v_fma_f32 v67, v67, v91, v83
    v_mfma_f32_16x16x32_bf16 v[96:99], a[16:19], v[36:39], v[96:99]
    ds_read_b64_tr_b16 v[62:63], v29 offset:12800
    s_waitcnt lgkmcnt(6)
    v_fma_f32 v68, v68, v92, v84
    v_mfma_f32_16x16x32_bf16 v[100:103], a[4:7], v[32:35], 0
    v_fma_f32 v69, v69, v93, v85
    v_fma_f32 v70, v70, v94, v86
    v_mfma_f32_16x16x32_bf16 v[100:103], a[20:23], v[36:39], v[100:103]
    buffer_load_dwordx4 v25, s[20:23], s98 offen offset:1024  lds
    v_mfma_f32_16x16x32_bf16 v[104:107], a[8:11], v[32:35], 0
    v_fma_f32 v71, v71, v95, v87
    v_mfma_f32_16x16x32_bf16 v[104:107], a[24:27], v[36:39], v[104:107]
    v_cvt_pk_bf16_f32 v64, v64, v65
    v_cvt_pk_bf16_f32 v65, v66, v67
    v_mfma_f32_16x16x32_bf16 v[108:111], a[12:15], v[32:35], 0
    v_cvt_pk_bf16_f32 v66, v68, v69
    v_cvt_pk_bf16_f32 v67, v70, v71
    v_mfma_f32_16x16x32_bf16 v[108:111], a[28:31], v[36:39], v[108:111]
    buffer_load_dwordx4 v26, s[20:23], s98 offen offset:2048  lds
    v_mfma_f32_16x16x32_bf16 v[112:115], a[0:3], v[40:43], 0
    ds_read_b64_tr_b16 v[32:33], v28 offset:16384
    v_cvt_pk_bf16_f32 v128, v128, v129
    v_mfma_f32_16x16x32_bf16 v[112:115], a[16:19], v[44:47], v[112:115]
    s_waitcnt vmcnt(15)
    ds_read_b64_tr_b16 v[34:35], v28 offset:16896
    v_cvt_pk_bf16_f32 v129, v130, v131
    v_mfma_f32_16x16x32_bf16 v[116:119], a[4:7], v[40:43], 0
    ds_read_b64_tr_b16 v[36:37], v28 offset:20480
    v_cvt_pk_bf16_f32 v130, v132, v133
    v_mfma_f32_16x16x32_bf16 v[116:119], a[20:23], v[44:47], v[116:119]
    ds_read_b64_tr_b16 v[38:39], v28 offset:20992
    v_cvt_pk_bf16_f32 v131, v134, v135
    v_mfma_f32_16x16x32_bf16 v[120:123], a[8:11], v[40:43], 0
    buffer_load_dwordx4 v27, s[20:23], s98 offen offset:3072  lds
    v_mfma_f32_16x16x32_bf16 v[120:123], a[24:27], v[44:47], v[120:123]
    s_add_u32 m0, s63, 131072
    s_xor_b32 s98, s0, 0
    ds_read_b128 v[80:83], v18 offset:256
    v_mfma_f32_16x16x32_bf16 v[124:127], a[12:15], v[40:43], 0
    buffer_store_dwordx4 v[64:67], v19, s[8:11], s71 offen offset:0 sc0 sc1
    v_mfma_f32_16x16x32_bf16 v[124:127], a[28:31], v[44:47], v[124:127]
    s_xor_b32 s79, s65, 0
    ds_read_b128 v[84:87], v18 offset:272
    v_mfma_f32_16x16x32_bf16 v[96:99], a[32:35], v[48:51], v[96:99]
    s_waitcnt lgkmcnt(6)
    ds_read_b64_tr_b16 v[40:41], v29 offset:16384
    v_mfma_f32_16x16x32_bf16 v[96:99], a[48:51], v[52:55], v[96:99]
    ds_read_b64_tr_b16 v[42:43], v29 offset:16896
    v_mfma_f32_16x16x32_bf16 v[100:103], a[36:39], v[48:51], v[100:103]
    ds_read_b64_tr_b16 v[44:45], v29 offset:20480
    v_mfma_f32_16x16x32_bf16 v[100:103], a[52:55], v[52:55], v[100:103]
    ds_read_b64_tr_b16 v[46:47], v29 offset:20992
    v_mfma_f32_16x16x32_bf16 v[104:107], a[40:43], v[48:51], v[104:107]
    buffer_load_dwordx4 v20, s[24:27], s98 offen offset:0  lds
    v_mfma_f32_16x16x32_bf16 v[104:107], a[56:59], v[52:55], v[104:107]
    s_lshr_b32 s100, s2, 3
    s_mul_i32 s66, s4, 28
    ds_read_b128 v[88:91], v18 offset:768
    v_mfma_f32_16x16x32_bf16 v[108:111], a[44:47], v[48:51], v[108:111]
    s_add_u32 s66, s66, s100
    s_cmp_lt_u32 s100, 28
    s_cselect_b32 s66, s66, 255
    ds_read_b128 v[92:95], v18 offset:784
    v_mfma_f32_16x16x32_bf16 v[108:111], a[60:63], v[52:55], v[108:111]
    buffer_store_dwordx4 v[128:131], v1, s[8:11], s79 offen offset:0 sc0 sc1
    v_mfma_f32_16x16x32_bf16 v[112:115], a[32:35], v[56:59], v[112:115]
    s_lshl_b32 s67, s4, 3
    s_add_u32 s67, s67, s100
    ds_read_b64_tr_b16 v[48:49], v28 offset:24576
    v_mfma_f32_16x16x32_bf16 v[112:115], a[48:51], v[60:63], v[112:115]
    s_sub_u32 s67, s67, 24
    ds_read_b64_tr_b16 v[50:51], v28 offset:25088
    v_cvt_pk_bf16_f32 v136, v136, v137
    v_mfma_f32_16x16x32_bf16 v[116:119], a[36:39], v[56:59], v[116:119]
    s_cmp_ge_u32 s100, 24
    s_cselect_b32 s67, s67, 255
    ds_read_b64_tr_b16 v[52:53], v28 offset:28672
    v_cvt_pk_bf16_f32 v137, v138, v139
    v_mfma_f32_16x16x32_bf16 v[116:119], a[52:55], v[60:63], v[116:119]
    ds_read_b64_tr_b16 v[54:55], v28 offset:29184
    v_cvt_pk_bf16_f32 v138, v140, v141
    v_mfma_f32_16x16x32_bf16 v[120:123], a[40:43], v[56:59], v[120:123]
    buffer_load_dwordx4 v21, s[24:27], s98 offen offset:1024  lds
    v_mfma_f32_16x16x32_bf16 v[120:123], a[56:59], v[60:63], v[120:123]
    s_waitcnt lgkmcnt(5)
    v_fma_f32 v72, v72, v88, v80
    v_fma_f32 v73, v73, v89, v81
    v_mfma_f32_16x16x32_bf16 v[124:127], a[44:47], v[56:59], v[124:127]
    v_fma_f32 v74, v74, v90, v82
    v_fma_f32 v75, v75, v91, v83
    v_mfma_f32_16x16x32_bf16 v[124:127], a[60:63], v[60:63], v[124:127]
    v_cvt_pk_bf16_f32 v139, v142, v143
    v_mfma_f32_16x16x32_bf16 v[96:99], a[64:67], v[32:35], v[96:99]
    s_xor_b32 s79, s65, 0
    ds_read_b64_tr_b16 v[56:57], v29 offset:24576
    s_waitcnt lgkmcnt(5)
    v_fma_f32 v76, v76, v92, v84
    v_mfma_f32_16x16x32_bf16 v[96:99], a[80:83], v[36:39], v[96:99]
    ds_read_b64_tr_b16 v[58:59], v29 offset:25088
    v_fma_f32 v77, v77, v93, v85
    v_mfma_f32_16x16x32_bf16 v[100:103], a[68:71], v[32:35], v[100:103]
    ds_read_b64_tr_b16 v[60:61], v29 offset:28672
    v_fma_f32 v78, v78, v94, v86
    v_mfma_f32_16x16x32_bf16 v[100:103], a[84:87], v[36:39], v[100:103]
    ds_read_b64_tr_b16 v[62:63], v29 offset:29184
    v_fma_f32 v79, v79, v95, v87
    v_mfma_f32_16x16x32_bf16 v[104:107], a[72:75], v[32:35], v[104:107]
    buffer_load_dwordx4 v22, s[24:27], s98 offen offset:2048  lds
    v_mfma_f32_16x16x32_bf16 v[104:107], a[88:91], v[36:39], v[104:107]
    v_cvt_pk_bf16_f32 v72, v72, v73
    v_cvt_pk_bf16_f32 v73, v74, v75
    v_mfma_f32_16x16x32_bf16 v[108:111], a[76:79], v[32:35], v[108:111]
    v_cvt_pk_bf16_f32 v74, v76, v77
    v_cvt_pk_bf16_f32 v75, v78, v79
    v_mfma_f32_16x16x32_bf16 v[108:111], a[92:95], v[36:39], v[108:111]
    buffer_store_dwordx4 v[72:75], v19, s[8:11], s71 offen offset:2048 sc0 sc1
    v_mfma_f32_16x16x32_bf16 v[112:115], a[64:67], v[40:43], v[112:115]
    ds_read_b64_tr_b16 v[32:33], v30 offset:0
    v_mfma_f32_16x16x32_bf16 v[112:115], a[80:83], v[44:47], v[112:115]
    ds_read_b64_tr_b16 v[34:35], v30 offset:512
    v_mfma_f32_16x16x32_bf16 v[116:119], a[68:71], v[40:43], v[116:119]
    ds_read_b64_tr_b16 v[36:37], v30 offset:4096
    v_mfma_f32_16x16x32_bf16 v[116:119], a[84:87], v[44:47], v[116:119]
    ds_read_b64_tr_b16 v[38:39], v30 offset:4608
    v_mfma_f32_16x16x32_bf16 v[120:123], a[72:75], v[40:43], v[120:123]
    buffer_load_dwordx4 v23, s[24:27], s98 offen offset:3072  lds
    v_mfma_f32_16x16x32_bf16 v[120:123], a[88:91], v[44:47], v[120:123]
    s_add_u32 m0, s63, 98304
    s_xor_b32 s98, s0, 524288
    v_mfma_f32_16x16x32_bf16 v[124:127], a[76:79], v[40:43], v[124:127]
    buffer_store_dwordx4 v[136:139], v1, s[8:11], s79 offen offset:1024 sc0 sc1
    v_mfma_f32_16x16x32_bf16 v[124:127], a[92:95], v[44:47], v[124:127]
    s_waitcnt lgkmcnt(4)
    v_mfma_f32_16x16x32_bf16 v[96:99], a[96:99], v[48:51], v[96:99]
    ds_read_b64_tr_b16 v[40:41], v31 offset:0
    v_cvt_pk_bf16_f32 v144, v144, v145
    v_mfma_f32_16x16x32_bf16 v[96:99], a[112:115], v[52:55], v[96:99]
    ds_read_b64_tr_b16 v[42:43], v31 offset:512
    v_cvt_pk_bf16_f32 v145, v146, v147
    v_mfma_f32_16x16x32_bf16 v[100:103], a[100:103], v[48:51], v[100:103]
    ds_read_b64_tr_b16 v[44:45], v31 offset:4096
    v_cvt_pk_bf16_f32 v146, v148, v149
    v_mfma_f32_16x16x32_bf16 v[100:103], a[116:119], v[52:55], v[100:103]
    ds_read_b64_tr_b16 v[46:47], v31 offset:4608
    v_cvt_pk_bf16_f32 v147, v150, v151
    v_mfma_f32_16x16x32_bf16 v[104:107], a[104:107], v[48:51], v[104:107]
    buffer_load_dwordx4 v20, s[24:27], s98 offen offset:0  lds
    v_mfma_f32_16x16x32_bf16 v[104:107], a[120:123], v[52:55], v[104:107]
    s_xor_b32 s79, s65, 0
    v_mfma_f32_16x16x32_bf16 v[108:111], a[108:111], v[48:51], v[108:111]
    buffer_store_dwordx4 v[144:147], v1, s[8:11], s79 offen offset:2048 sc0 sc1
    v_mfma_f32_16x16x32_bf16 v[108:111], a[124:127], v[52:55], v[108:111]
    v_mfma_f32_16x16x32_bf16 v[112:115], a[96:99], v[56:59], v[112:115]
    ds_read_b64_tr_b16 v[48:49], v30 offset:8192
    v_mfma_f32_16x16x32_bf16 v[112:115], a[112:115], v[60:63], v[112:115]
    ds_read_b64_tr_b16 v[50:51], v30 offset:8704
    v_mfma_f32_16x16x32_bf16 v[116:119], a[100:103], v[56:59], v[116:119]
    ds_read_b64_tr_b16 v[52:53], v30 offset:12288
    v_mfma_f32_16x16x32_bf16 v[116:119], a[116:119], v[60:63], v[116:119]
    ds_read_b64_tr_b16 v[54:55], v30 offset:12800
    v_cvt_pk_bf16_f32 v152, v152, v153
    v_mfma_f32_16x16x32_bf16 v[120:123], a[104:107], v[56:59], v[120:123]
    buffer_load_dwordx4 v21, s[24:27], s98 offen offset:1024  lds
    v_mfma_f32_16x16x32_bf16 v[120:123], a[120:123], v[60:63], v[120:123]
    v_cvt_pk_bf16_f32 v153, v154, v155
    v_cvt_pk_bf16_f32 v154, v156, v157
    v_mfma_f32_16x16x32_bf16 v[124:127], a[108:111], v[56:59], v[124:127]
    v_cvt_pk_bf16_f32 v155, v158, v159
    v_mfma_f32_16x16x32_bf16 v[124:127], a[124:127], v[60:63], v[124:127]
    s_waitcnt lgkmcnt(4)
    v_mfma_f32_16x16x32_bf16 v[64:67], a[0:3], v[32:35], 0
    s_xor_b32 s79, s65, 0
    ds_read_b64_tr_b16 v[56:57], v31 offset:8192
    v_mfma_f32_16x16x32_bf16 v[64:67], a[16:19], v[36:39], v[64:67]
    ds_read_b64_tr_b16 v[58:59], v31 offset:8704
    v_mfma_f32_16x16x32_bf16 v[68:71], a[4:7], v[32:35], 0
    ds_read_b64_tr_b16 v[60:61], v31 offset:12288
    v_mfma_f32_16x16x32_bf16 v[68:71], a[20:23], v[36:39], v[68:71]
    ds_read_b64_tr_b16 v[62:63], v31 offset:12800
    v_mfma_f32_16x16x32_bf16 v[72:75], a[8:11], v[32:35], 0
    buffer_load_dwordx4 v22, s[24:27], s98 offen offset:2048  lds
    v_mfma_f32_16x16x32_bf16 v[72:75], a[24:27], v[36:39], v[72:75]
    buffer_store_dwordx4 v[152:155], v1, s[8:11], s79 offen offset:3072 sc0 sc1
    v_mfma_f32_16x16x32_bf16 v[76:79], a[12:15], v[32:35], 0
    v_mfma_f32_16x16x32_bf16 v[76:79], a[28:31], v[36:39], v[76:79]
    v_mfma_f32_16x16x32_bf16 v[80:83], a[0:3], v[40:43], 0
    ds_read_b64_tr_b16 v[32:33], v30 offset:16384
    v_mfma_f32_16x16x32_bf16 v[80:83], a[16:19], v[44:47], v[80:83]
    ds_read_b64_tr_b16 v[34:35], v30 offset:16896
    v_mfma_f32_16x16x32_bf16 v[84:87], a[4:7], v[40:43], 0
    ds_read_b64_tr_b16 v[36:37], v30 offset:20480
    v_mfma_f32_16x16x32_bf16 v[84:87], a[20:23], v[44:47], v[84:87]
    ds_read_b64_tr_b16 v[38:39], v30 offset:20992
    v_mfma_f32_16x16x32_bf16 v[88:91], a[8:11], v[40:43], 0
    buffer_load_dwordx4 v23, s[24:27], s98 offen offset:3072  lds
    v_mfma_f32_16x16x32_bf16 v[88:91], a[24:27], v[44:47], v[88:91]
    v_cvt_pk_bf16_f32 v160, v160, v161
    v_cvt_pk_bf16_f32 v161, v162, v163
    v_mfma_f32_16x16x32_bf16 v[92:95], a[12:15], v[40:43], 0
    v_cvt_pk_bf16_f32 v162, v164, v165
    v_cvt_pk_bf16_f32 v163, v166, v167
    v_mfma_f32_16x16x32_bf16 v[92:95], a[28:31], v[44:47], v[92:95]
    s_waitcnt lgkmcnt(4)
    v_mfma_f32_16x16x32_bf16 v[64:67], a[32:35], v[48:51], v[64:67]
    s_xor_b32 s79, s65, 4096
    ds_read_b64_tr_b16 v[40:41], v31 offset:16384
    v_mfma_f32_16x16x32_bf16 v[64:67], a[48:51], v[52:55], v[64:67]
    ds_read_b64_tr_b16 v[42:43], v31 offset:16896
    v_mfma_f32_16x16x32_bf16 v[68:71], a[36:39], v[48:51], v[68:71]
    ds_read_b64_tr_b16 v[44:45], v31 offset:20480
    v_mfma_f32_16x16x32_bf16 v[68:71], a[52:55], v[52:55], v[68:71]
    ds_read_b64_tr_b16 v[46:47], v31 offset:20992
    v_mfma_f32_16x16x32_bf16 v[72:75], a[40:43], v[48:51], v[72:75]
    buffer_store_dwordx4 v[160:163], v1, s[8:11], s79 offen offset:0 sc0 sc1
    v_mfma_f32_16x16x32_bf16 v[72:75], a[56:59], v[52:55], v[72:75]
    v_mfma_f32_16x16x32_bf16 v[76:79], a[44:47], v[48:51], v[76:79]
    v_mfma_f32_16x16x32_bf16 v[76:79], a[60:63], v[52:55], v[76:79]
    v_mfma_f32_16x16x32_bf16 v[80:83], a[32:35], v[56:59], v[80:83]
    ds_read_b64_tr_b16 v[48:49], v30 offset:24576
    v_mfma_f32_16x16x32_bf16 v[80:83], a[48:51], v[60:63], v[80:83]
    ds_read_b64_tr_b16 v[50:51], v30 offset:25088
    v_mfma_f32_16x16x32_bf16 v[84:87], a[36:39], v[56:59], v[84:87]
    ds_read_b64_tr_b16 v[52:53], v30 offset:28672
    v_mfma_f32_16x16x32_bf16 v[84:87], a[52:55], v[60:63], v[84:87]
    ds_read_b64_tr_b16 v[54:55], v30 offset:29184
    v_mfma_f32_16x16x32_bf16 v[88:91], a[40:43], v[56:59], v[88:91]
    v_mfma_f32_16x16x32_bf16 v[88:91], a[56:59], v[60:63], v[88:91]
    v_cvt_pk_bf16_f32 v168, v168, v169
    v_cvt_pk_bf16_f32 v169, v170, v171
    v_mfma_f32_16x16x32_bf16 v[92:95], a[44:47], v[56:59], v[92:95]
    v_cvt_pk_bf16_f32 v170, v172, v173
    v_cvt_pk_bf16_f32 v171, v174, v175
    v_mfma_f32_16x16x32_bf16 v[92:95], a[60:63], v[60:63], v[92:95]
    s_waitcnt lgkmcnt(4)
    v_mfma_f32_16x16x32_bf16 v[64:67], a[64:67], v[32:35], v[64:67]
    s_xor_b32 s79, s65, 4096
    ds_read_b64_tr_b16 v[56:57], v31 offset:24576
    v_mfma_f32_16x16x32_bf16 v[64:67], a[80:83], v[36:39], v[64:67]
    ds_read_b64_tr_b16 v[58:59], v31 offset:25088
    v_mfma_f32_16x16x32_bf16 v[68:71], a[68:71], v[32:35], v[68:71]
    ds_read_b64_tr_b16 v[60:61], v31 offset:28672
    v_mfma_f32_16x16x32_bf16 v[68:71], a[84:87], v[36:39], v[68:71]
    ds_read_b64_tr_b16 v[62:63], v31 offset:29184
    v_mfma_f32_16x16x32_bf16 v[72:75], a[72:75], v[32:35], v[72:75]
    buffer_store_dwordx4 v[168:171], v1, s[8:11], s79 offen offset:1024 sc0 sc1
    v_mfma_f32_16x16x32_bf16 v[72:75], a[88:91], v[36:39], v[72:75]
    v_mfma_f32_16x16x32_bf16 v[76:79], a[76:79], v[32:35], v[76:79]
    v_mfma_f32_16x16x32_bf16 v[76:79], a[92:95], v[36:39], v[76:79]
    v_mfma_f32_16x16x32_bf16 v[80:83], a[64:67], v[40:43], v[80:83]
    v_mfma_f32_16x16x32_bf16 v[80:83], a[80:83], v[44:47], v[80:83]
    v_mfma_f32_16x16x32_bf16 v[84:87], a[68:71], v[40:43], v[84:87]
    v_mfma_f32_16x16x32_bf16 v[84:87], a[84:87], v[44:47], v[84:87]
    v_mfma_f32_16x16x32_bf16 v[88:91], a[72:75], v[40:43], v[88:91]
    v_mfma_f32_16x16x32_bf16 v[88:91], a[88:91], v[44:47], v[88:91]
    s_waitcnt vmcnt(10)
    v_mfma_f32_16x16x32_bf16 v[92:95], a[76:79], v[40:43], v[92:95]
    v_xor_b32 v28, 65536, v28
    v_cvt_pk_bf16_f32 v176, v176, v177
    s_waitcnt lgkmcnt(0)
    s_barrier
    v_mfma_f32_16x16x32_bf16 v[92:95], a[92:95], v[44:47], v[92:95]
    s_add_u32 m0, s62, 65536
    ds_read_b64_tr_b16 v[32:33], v28 offset:0
    v_xor_b32 v29, 65536, v29
    v_mfma_f32_16x16x32_bf16 v[64:67], a[96:99], v[48:51], v[64:67]
    s_xor_b32 s98, s64, 2097280
    ds_read_b64_tr_b16 v[34:35], v28 offset:512
    v_cvt_pk_bf16_f32 v177, v178, v179
    v_mfma_f32_16x16x32_bf16 v[64:67], a[112:115], v[52:55], v[64:67]
    ds_read_b64_tr_b16 v[36:37], v28 offset:4096
    v_cvt_pk_bf16_f32 v178, v180, v181
    v_mfma_f32_16x16x32_bf16 v[68:71], a[100:103], v[48:51], v[68:71]
    ds_read_b64_tr_b16 v[38:39], v28 offset:4608
    v_cvt_pk_bf16_f32 v179, v182, v183
    v_mfma_f32_16x16x32_bf16 v[68:71], a[116:119], v[52:55], v[68:71]
    s_xor_b32 s79, s65, 4096
    ds_read_b64_tr_b16 v[40:41], v29 offset:0
    v_mfma_f32_16x16x32_bf16 v[72:75], a[104:107], v[48:51], v[72:75]
    ds_read_b64_tr_b16 v[42:43], v29 offset:512
    v_mfma_f32_16x16x32_bf16 v[72:75], a[120:123], v[52:55], v[72:75]
    ds_read_b64_tr_b16 v[44:45], v29 offset:4096
    v_mfma_f32_16x16x32_bf16 v[76:79], a[108:111], v[48:51], v[76:79]
    ds_read_b64_tr_b16 v[46:47], v29 offset:4608
    v_mfma_f32_16x16x32_bf16 v[76:79], a[124:127], v[52:55], v[76:79]
    buffer_load_dwordx4 v24, s[20:23], s98 offen offset:0  lds
    v_mfma_f32_16x16x32_bf16 v[80:83], a[96:99], v[56:59], v[80:83]
    ds_read_b64_tr_b16 v[48:49], v28 offset:8192
    v_mfma_f32_16x16x32_bf16 v[80:83], a[112:115], v[60:63], v[80:83]
    ds_read_b64_tr_b16 v[50:51], v28 offset:8704
    v_mfma_f32_16x16x32_bf16 v[84:87], a[100:103], v[56:59], v[84:87]
    ds_read_b64_tr_b16 v[52:53], v28 offset:12288
    v_mfma_f32_16x16x32_bf16 v[84:87], a[116:119], v[60:63], v[84:87]
    ds_read_b64_tr_b16 v[54:55], v28 offset:12800
    v_mfma_f32_16x16x32_bf16 v[88:91], a[104:107], v[56:59], v[88:91]
    buffer_load_dwordx4 v25, s[20:23], s98 offen offset:1024  lds
    v_mfma_f32_16x16x32_bf16 v[88:91], a[120:123], v[60:63], v[88:91]
    buffer_store_dword v6, v5, s[8:11], s72 offen sc0 sc1
    v_mfma_f32_16x16x32_bf16 v[92:95], a[108:111], v[56:59], v[92:95]
    buffer_store_dwordx4 v[176:179], v1, s[8:11], s79 offen offset:2048 sc0 sc1
    v_mfma_f32_16x16x32_bf16 v[92:95], a[124:127], v[60:63], v[92:95]
    s_waitcnt lgkmcnt(5)
    v_mfma_f32_16x16x32_bf16 v[96:99], a[128:131], v[32:35], v[96:99]
    ds_read_b64_tr_b16 v[56:57], v29 offset:8192
    v_cvt_pk_bf16_f32 v184, v184, v185
    v_mfma_f32_16x16x32_bf16 v[96:99], a[144:147], v[36:39], v[96:99]
    ds_read_b64_tr_b16 v[58:59], v29 offset:8704
    v_cvt_pk_bf16_f32 v185, v186, v187
    v_mfma_f32_16x16x32_bf16 v[100:103], a[132:135], v[32:35], v[100:103]
    ds_read_b64_tr_b16 v[60:61], v29 offset:12288
    v_cvt_pk_bf16_f32 v186, v188, v189
    v_mfma_f32_16x16x32_bf16 v[100:103], a[148:151], v[36:39], v[100:103]
    ds_read_b64_tr_b16 v[62:63], v29 offset:12800
    v_cvt_pk_bf16_f32 v187, v190, v191
    v_mfma_f32_16x16x32_bf16 v[104:107], a[136:139], v[32:35], v[104:107]
    buffer_load_dwordx4 v26, s[20:23], s98 offen offset:2048  lds
    v_mfma_f32_16x16x32_bf16 v[104:107], a[152:155], v[36:39], v[104:107]
    s_xor_b32 s79, s65, 4096
    v_mfma_f32_16x16x32_bf16 v[108:111], a[140:143], v[32:35], v[108:111]
    buffer_store_dwordx4 v[184:187], v1, s[8:11], s79 offen offset:3072 sc0 sc1
    v_mfma_f32_16x16x32_bf16 v[108:111], a[156:159], v[36:39], v[108:111]
    v_mfma_f32_16x16x32_bf16 v[112:115], a[128:131], v[40:43], v[112:115]
    s_waitcnt lgkmcnt(4)
    ds_read_b64_tr_b16 v[32:33], v28 offset:16384
    v_mfma_f32_16x16x32_bf16 v[112:115], a[144:147], v[44:47], v[112:115]
    ds_read_b64_tr_b16 v[34:35], v28 offset:16896
    v_mfma_f32_16x16x32_bf16 v[116:119], a[132:135], v[40:43], v[116:119]
    ds_read_b64_tr_b16 v[36:37], v28 offset:20480
    v_mfma_f32_16x16x32_bf16 v[116:119], a[148:151], v[44:47], v[116:119]
    ds_read_b64_tr_b16 v[38:39], v28 offset:20992
    v_mfma_f32_16x16x32_bf16 v[120:123], a[136:139], v[40:43], v[120:123]
    buffer_load_dwordx4 v27, s[20:23], s98 offen offset:3072  lds
    v_mfma_f32_16x16x32_bf16 v[120:123], a[152:155], v[44:47], v[120:123]
    s_add_u32 m0, s62, 69632
    s_xor_b32 s98, s64, 2359424
    v_mfma_f32_16x16x32_bf16 v[124:127], a[140:143], v[40:43], v[124:127]
    v_mfma_f32_16x16x32_bf16 v[124:127], a[156:159], v[44:47], v[124:127]
    v_mfma_f32_16x16x32_bf16 v[96:99], a[160:163], v[48:51], v[96:99]
    ds_read_b64_tr_b16 v[40:41], v29 offset:16384
    v_cvt_pk_bf16_f32 v192, v192, v193
    v_mfma_f32_16x16x32_bf16 v[96:99], a[176:179], v[52:55], v[96:99]
    ds_read_b64_tr_b16 v[42:43], v29 offset:16896
    v_cvt_pk_bf16_f32 v193, v194, v195
    v_mfma_f32_16x16x32_bf16 v[100:103], a[164:167], v[48:51], v[100:103]
    ds_read_b64_tr_b16 v[44:45], v29 offset:20480
    v_cvt_pk_bf16_f32 v194, v196, v197
    v_mfma_f32_16x16x32_bf16 v[100:103], a[180:183], v[52:55], v[100:103]
    ds_read_b64_tr_b16 v[46:47], v29 offset:20992
    v_cvt_pk_bf16_f32 v195, v198, v199
    v_mfma_f32_16x16x32_bf16 v[104:107], a[168:171], v[48:51], v[104:107]
    buffer_load_dwordx4 v24, s[20:23], s98 offen offset:0  lds
    v_mfma_f32_16x16x32_bf16 v[104:107], a[184:187], v[52:55], v[104:107]
    s_xor_b32 s79, s65, 8192
    v_mfma_f32_16x16x32_bf16 v[108:111], a[172:175], v[48:51], v[108:111]
    buffer_store_dwordx4 v[192:195], v1, s[8:11], s79 offen offset:0 sc0 sc1
    v_mfma_f32_16x16x32_bf16 v[108:111], a[188:191], v[52:55], v[108:111]
    s_waitcnt lgkmcnt(4)
    v_mfma_f32_16x16x32_bf16 v[112:115], a[160:163], v[56:59], v[112:115]
    ds_read_b64_tr_b16 v[48:49], v28 offset:24576
    v_mfma_f32_16x16x32_bf16 v[112:115], a[176:179], v[60:63], v[112:115]
    ds_read_b64_tr_b16 v[50:51], v28 offset:25088
    v_mfma_f32_16x16x32_bf16 v[116:119], a[164:167], v[56:59], v[116:119]
    ds_read_b64_tr_b16 v[52:53], v28 offset:28672
    v_mfma_f32_16x16x32_bf16 v[116:119], a[180:183], v[60:63], v[116:119]
    ds_read_b64_tr_b16 v[54:55], v28 offset:29184
    v_mfma_f32_16x16x32_bf16 v[120:123], a[168:171], v[56:59], v[120:123]
    buffer_load_dwordx4 v25, s[20:23], s98 offen offset:1024  lds
    v_mfma_f32_16x16x32_bf16 v[120:123], a[184:187], v[60:63], v[120:123]
    v_mfma_f32_16x16x32_bf16 v[124:127], a[172:175], v[56:59], v[124:127]
    v_mfma_f32_16x16x32_bf16 v[124:127], a[188:191], v[60:63], v[124:127]
    v_mfma_f32_16x16x32_bf16 v[96:99], a[192:195], v[32:35], v[96:99]
    ds_read_b64_tr_b16 v[56:57], v29 offset:24576
    v_mfma_f32_16x16x32_bf16 v[96:99], a[208:211], v[36:39], v[96:99]
    ds_read_b64_tr_b16 v[58:59], v29 offset:25088
    v_cvt_pk_bf16_f32 v200, v200, v201
    v_mfma_f32_16x16x32_bf16 v[100:103], a[196:199], v[32:35], v[100:103]
    ds_read_b64_tr_b16 v[60:61], v29 offset:28672
    v_cvt_pk_bf16_f32 v201, v202, v203
    v_mfma_f32_16x16x32_bf16 v[100:103], a[212:215], v[36:39], v[100:103]
    ds_read_b64_tr_b16 v[62:63], v29 offset:29184
    v_cvt_pk_bf16_f32 v202, v204, v205
    v_mfma_f32_16x16x32_bf16 v[104:107], a[200:203], v[32:35], v[104:107]
    buffer_load_dwordx4 v26, s[20:23], s98 offen offset:2048  lds
    v_mfma_f32_16x16x32_bf16 v[104:107], a[216:219], v[36:39], v[104:107]
    v_cvt_pk_bf16_f32 v203, v206, v207
    v_mfma_f32_16x16x32_bf16 v[108:111], a[204:207], v[32:35], v[108:111]
    v_mfma_f32_16x16x32_bf16 v[108:111], a[220:223], v[36:39], v[108:111]
    s_waitcnt lgkmcnt(4)
    s_xor_b32 s79, s65, 8192
    v_xor_b32 v30, 65536, v30
    v_mfma_f32_16x16x32_bf16 v[112:115], a[192:195], v[40:43], v[112:115]
    ds_read_b64_tr_b16 v[32:33], v30 offset:0
    v_mfma_f32_16x16x32_bf16 v[112:115], a[208:211], v[44:47], v[112:115]
    ds_read_b64_tr_b16 v[34:35], v30 offset:512
    v_mfma_f32_16x16x32_bf16 v[116:119], a[196:199], v[40:43], v[116:119]
    ds_read_b64_tr_b16 v[36:37], v30 offset:4096
    v_mfma_f32_16x16x32_bf16 v[116:119], a[212:215], v[44:47], v[116:119]
    ds_read_b64_tr_b16 v[38:39], v30 offset:4608
    v_mfma_f32_16x16x32_bf16 v[120:123], a[200:203], v[40:43], v[120:123]
    buffer_load_dwordx4 v27, s[20:23], s98 offen offset:3072  lds
    v_mfma_f32_16x16x32_bf16 v[120:123], a[216:219], v[44:47], v[120:123]
    buffer_store_dwordx4 v[200:203], v1, s[8:11], s79 offen offset:1024 sc0 sc1
    v_mfma_f32_16x16x32_bf16 v[124:127], a[204:207], v[40:43], v[124:127]
    v_mfma_f32_16x16x32_bf16 v[124:127], a[220:223], v[44:47], v[124:127]
    s_add_u32 m0, s63, 114688
    s_xor_b32 s98, s0, 1048576
    v_xor_b32 v31, 65536, v31
    v_mfma_f32_16x16x32_bf16 v[96:99], a[224:227], v[48:51], v[96:99]
    ds_read_b64_tr_b16 v[40:41], v31 offset:0
    v_mfma_f32_16x16x32_bf16 v[96:99], a[240:243], v[52:55], v[96:99]
    ds_read_b64_tr_b16 v[42:43], v31 offset:512
    v_mfma_f32_16x16x32_bf16 v[100:103], a[228:231], v[48:51], v[100:103]
    ds_read_b64_tr_b16 v[44:45], v31 offset:4096
    v_cvt_pk_bf16_f32 v208, v208, v209
    v_mfma_f32_16x16x32_bf16 v[100:103], a[244:247], v[52:55], v[100:103]
    ds_read_b64_tr_b16 v[46:47], v31 offset:4608
    v_cvt_pk_bf16_f32 v209, v210, v211
    v_mfma_f32_16x16x32_bf16 v[104:107], a[232:235], v[48:51], v[104:107]
    buffer_load_dwordx4 v20, s[24:27], s98 offen offset:0  lds
    v_mfma_f32_16x16x32_bf16 v[104:107], a[248:251], v[52:55], v[104:107]
    v_cvt_pk_bf16_f32 v210, v212, v213
    v_cvt_pk_bf16_f32 v211, v214, v215
    v_mfma_f32_16x16x32_bf16 v[108:111], a[236:239], v[48:51], v[108:111]
    v_mfma_f32_16x16x32_bf16 v[108:111], a[252:255], v[52:55], v[108:111]
    s_waitcnt lgkmcnt(4)
    v_mfma_f32_16x16x32_bf16 v[112:115], a[224:227], v[56:59], v[112:115]
    s_xor_b32 s79, s65, 8192
    ds_read_b64_tr_b16 v[48:49], v30 offset:8192
    v_mfma_f32_16x16x32_bf16 v[112:115], a[240:243], v[60:63], v[112:115]
    ds_read_b64_tr_b16 v[50:51], v30 offset:8704
    v_mfma_f32_16x16x32_bf16 v[116:119], a[228:231], v[56:59], v[116:119]
    ds_read_b64_tr_b16 v[52:53], v30 offset:12288
    v_mfma_f32_16x16x32_bf16 v[116:119], a[244:247], v[60:63], v[116:119]
    ds_read_b64_tr_b16 v[54:55], v30 offset:12800
    v_mfma_f32_16x16x32_bf16 v[120:123], a[232:235], v[56:59], v[120:123]
    buffer_load_dwordx4 v21, s[24:27], s98 offen offset:1024  lds
    v_mfma_f32_16x16x32_bf16 v[120:123], a[248:251], v[60:63], v[120:123]
    buffer_store_dwordx4 v[208:211], v1, s[8:11], s79 offen offset:2048 sc0 sc1
    v_mfma_f32_16x16x32_bf16 v[124:127], a[236:239], v[56:59], v[124:127]
    v_mfma_f32_16x16x32_bf16 v[124:127], a[252:255], v[60:63], v[124:127]
    v_mfma_f32_16x16x32_bf16 v[64:67], a[128:131], v[32:35], v[64:67]
    ds_read_b64_tr_b16 v[56:57], v31 offset:8192
    v_mfma_f32_16x16x32_bf16 v[64:67], a[144:147], v[36:39], v[64:67]
    ds_read_b64_tr_b16 v[58:59], v31 offset:8704
    v_mfma_f32_16x16x32_bf16 v[68:71], a[132:135], v[32:35], v[68:71]
    ds_read_b64_tr_b16 v[60:61], v31 offset:12288
    v_mfma_f32_16x16x32_bf16 v[68:71], a[148:151], v[36:39], v[68:71]
    ds_read_b64_tr_b16 v[62:63], v31 offset:12800
    v_mfma_f32_16x16x32_bf16 v[72:75], a[136:139], v[32:35], v[72:75]
    buffer_load_dwordx4 v22, s[24:27], s98 offen offset:2048  lds
    v_mfma_f32_16x16x32_bf16 v[72:75], a[152:155], v[36:39], v[72:75]
    v_mfma_f32_16x16x32_bf16 v[76:79], a[140:143], v[32:35], v[76:79]
    v_mfma_f32_16x16x32_bf16 v[76:79], a[156:159], v[36:39], v[76:79]
    s_waitcnt lgkmcnt(4)
    v_mfma_f32_16x16x32_bf16 v[80:83], a[128:131], v[40:43], v[80:83]
    ds_read_b64_tr_b16 v[32:33], v30 offset:16384
    v_cvt_pk_bf16_f32 v96, v96, v97
    v_mfma_f32_16x16x32_bf16 v[80:83], a[144:147], v[44:47], v[80:83]
    ds_read_b64_tr_b16 v[34:35], v30 offset:16896
    v_cvt_pk_bf16_f32 v97, v98, v99
    v_mfma_f32_16x16x32_bf16 v[84:87], a[132:135], v[40:43], v[84:87]
    ds_read_b64_tr_b16 v[36:37], v30 offset:20480
    v_cvt_pk_bf16_f32 v98, v100, v101
    v_mfma_f32_16x16x32_bf16 v[84:87], a[148:151], v[44:47], v[84:87]
    ds_read_b64_tr_b16 v[38:39], v30 offset:20992
    v_cvt_pk_bf16_f32 v99, v102, v103
    v_mfma_f32_16x16x32_bf16 v[88:91], a[136:139], v[40:43], v[88:91]
    buffer_load_dwordx4 v23, s[24:27], s98 offen offset:3072  lds
    v_mfma_f32_16x16x32_bf16 v[88:91], a[152:155], v[44:47], v[88:91]
    s_add_u32 m0, s63, 147456
    s_xor_b32 s98, s0, 1572864
    s_xor_b32 s79, s1, 32768
    v_mfma_f32_16x16x32_bf16 v[92:95], a[140:143], v[40:43], v[92:95]
    buffer_store_dwordx4 v[96:99], v1, s[8:11], s79 offen offset:0 sc0 sc1
    v_mfma_f32_16x16x32_bf16 v[92:95], a[156:159], v[44:47], v[92:95]
    v_mfma_f32_16x16x32_bf16 v[64:67], a[160:163], v[48:51], v[64:67]
    ds_read_b64_tr_b16 v[40:41], v31 offset:16384
    v_mfma_f32_16x16x32_bf16 v[64:67], a[176:179], v[52:55], v[64:67]
    ds_read_b64_tr_b16 v[42:43], v31 offset:16896
    v_mfma_f32_16x16x32_bf16 v[68:71], a[164:167], v[48:51], v[68:71]
    ds_read_b64_tr_b16 v[44:45], v31 offset:20480
    v_mfma_f32_16x16x32_bf16 v[68:71], a[180:183], v[52:55], v[68:71]
    ds_read_b64_tr_b16 v[46:47], v31 offset:20992
    v_mfma_f32_16x16x32_bf16 v[72:75], a[168:171], v[48:51], v[72:75]
    buffer_load_dwordx4 v20, s[24:27], s98 offen offset:0  lds
    v_mfma_f32_16x16x32_bf16 v[72:75], a[184:187], v[52:55], v[72:75]
    v_cvt_pk_bf16_f32 v104, v104, v105
    v_cvt_pk_bf16_f32 v105, v106, v107
    v_mfma_f32_16x16x32_bf16 v[76:79], a[172:175], v[48:51], v[76:79]
    v_cvt_pk_bf16_f32 v106, v108, v109
    v_cvt_pk_bf16_f32 v107, v110, v111
    v_mfma_f32_16x16x32_bf16 v[76:79], a[188:191], v[52:55], v[76:79]
    s_waitcnt lgkmcnt(4)
    v_mfma_f32_16x16x32_bf16 v[80:83], a[160:163], v[56:59], v[80:83]
    s_xor_b32 s79, s1, 40960
    ds_read_b64_tr_b16 v[48:49], v30 offset:24576
    v_mfma_f32_16x16x32_bf16 v[80:83], a[176:179], v[60:63], v[80:83]
    ds_read_b64_tr_b16 v[50:51], v30 offset:25088
    v_mfma_f32_16x16x32_bf16 v[84:87], a[164:167], v[56:59], v[84:87]
    ds_read_b64_tr_b16 v[52:53], v30 offset:28672
    v_mfma_f32_16x16x32_bf16 v[84:87], a[180:183], v[60:63], v[84:87]
    ds_read_b64_tr_b16 v[54:55], v30 offset:29184
    v_mfma_f32_16x16x32_bf16 v[88:91], a[168:171], v[56:59], v[88:91]
    buffer_load_dwordx4 v21, s[24:27], s98 offen offset:1024  lds
    v_mfma_f32_16x16x32_bf16 v[88:91], a[184:187], v[60:63], v[88:91]
    buffer_store_dwordx4 v[104:107], v1, s[8:11], s79 offen offset:0 sc0 sc1
    v_mfma_f32_16x16x32_bf16 v[92:95], a[172:175], v[56:59], v[92:95]
    v_mfma_f32_16x16x32_bf16 v[92:95], a[188:191], v[60:63], v[92:95]
    v_mfma_f32_16x16x32_bf16 v[64:67], a[192:195], v[32:35], v[64:67]
    ds_read_b64_tr_b16 v[56:57], v31 offset:24576
    v_mfma_f32_16x16x32_bf16 v[64:67], a[208:211], v[36:39], v[64:67]
    ds_read_b64_tr_b16 v[58:59], v31 offset:25088
    v_mfma_f32_16x16x32_bf16 v[68:71], a[196:199], v[32:35], v[68:71]
    ds_read_b64_tr_b16 v[60:61], v31 offset:28672
    v_cvt_pk_bf16_f32 v112, v112, v113
    v_mfma_f32_16x16x32_bf16 v[68:71], a[212:215], v[36:39], v[68:71]
    ds_read_b64_tr_b16 v[62:63], v31 offset:29184
    v_cvt_pk_bf16_f32 v113, v114, v115
    v_mfma_f32_16x16x32_bf16 v[72:75], a[200:203], v[32:35], v[72:75]
    buffer_load_dwordx4 v22, s[24:27], s98 offen offset:2048  lds
    v_mfma_f32_16x16x32_bf16 v[72:75], a[216:219], v[36:39], v[72:75]
    v_cvt_pk_bf16_f32 v114, v116, v117
    v_cvt_pk_bf16_f32 v115, v118, v119
    v_mfma_f32_16x16x32_bf16 v[76:79], a[204:207], v[32:35], v[76:79]
    s_waitcnt lgkmcnt(4)
    s_xor_b32 s79, s1, 32768
    v_mfma_f32_16x16x32_bf16 v[76:79], a[220:223], v[36:39], v[76:79]
    buffer_store_dwordx4 v[112:115], v1, s[8:11], s79 offen offset:1024 sc0 sc1
    v_mfma_f32_16x16x32_bf16 v[80:83], a[192:195], v[40:43], v[80:83]
    v_mfma_f32_16x16x32_bf16 v[80:83], a[208:211], v[44:47], v[80:83]
    buffer_load_dwordx4 v23, s[24:27], s98 offen offset:3072  lds
    v_mfma_f32_16x16x32_bf16 v[84:87], a[196:199], v[40:43], v[84:87]
    v_mfma_f32_16x16x32_bf16 v[84:87], a[212:215], v[44:47], v[84:87]
    v_mfma_f32_16x16x32_bf16 v[88:91], a[200:203], v[40:43], v[88:91]
    v_mfma_f32_16x16x32_bf16 v[88:91], a[216:219], v[44:47], v[88:91]
    v_mfma_f32_16x16x32_bf16 v[92:95], a[204:207], v[40:43], v[92:95]
    s_waitcnt lgkmcnt(0)
    s_barrier
    v_mfma_f32_16x16x32_bf16 v[92:95], a[220:223], v[44:47], v[92:95]
    s_add_u32 m0, s63, 0
    s_xor_b32 s98, s0, 2097152
    ds_read_b64_tr_b16 v[32:33], v28 offset:32768
    v_mfma_f32_16x16x32_bf16 v[64:67], a[224:227], v[48:51], v[64:67]
    ds_read_b64_tr_b16 v[34:35], v28 offset:33280
    v_cvt_pk_bf16_f32 v120, v120, v121
    v_mfma_f32_16x16x32_bf16 v[64:67], a[240:243], v[52:55], v[64:67]
    ds_read_b64_tr_b16 v[36:37], v28 offset:36864
    v_cvt_pk_bf16_f32 v121, v122, v123
    v_mfma_f32_16x16x32_bf16 v[68:71], a[228:231], v[48:51], v[68:71]
    ds_read_b64_tr_b16 v[38:39], v28 offset:37376
    v_cvt_pk_bf16_f32 v122, v124, v125
    v_mfma_f32_16x16x32_bf16 v[68:71], a[244:247], v[52:55], v[68:71]
    ds_read_b64_tr_b16 v[40:41], v29 offset:32768
    v_cvt_pk_bf16_f32 v123, v126, v127
    v_mfma_f32_16x16x32_bf16 v[72:75], a[232:235], v[48:51], v[72:75]
    s_xor_b32 s79, s1, 40960
    ds_read_b64_tr_b16 v[42:43], v29 offset:33280
    v_mfma_f32_16x16x32_bf16 v[72:75], a[248:251], v[52:55], v[72:75]
    ds_read_b64_tr_b16 v[44:45], v29 offset:36864
    v_mfma_f32_16x16x32_bf16 v[76:79], a[236:239], v[48:51], v[76:79]
    ds_read_b64_tr_b16 v[46:47], v29 offset:37376
    v_mfma_f32_16x16x32_bf16 v[76:79], a[252:255], v[52:55], v[76:79]
    buffer_load_dwordx4 v20, s[24:27], s98 offen offset:0  lds
    v_mfma_f32_16x16x32_bf16 v[80:83], a[224:227], v[56:59], v[80:83]
    ds_read_b64_tr_b16 v[48:49], v28 offset:40960
    v_mfma_f32_16x16x32_bf16 v[80:83], a[240:243], v[60:63], v[80:83]
    ds_read_b64_tr_b16 v[50:51], v28 offset:41472
    v_mfma_f32_16x16x32_bf16 v[84:87], a[228:231], v[56:59], v[84:87]
    ds_read_b64_tr_b16 v[52:53], v28 offset:45056
    v_mfma_f32_16x16x32_bf16 v[84:87], a[244:247], v[60:63], v[84:87]
    ds_read_b64_tr_b16 v[54:55], v28 offset:45568
    v_mfma_f32_16x16x32_bf16 v[88:91], a[232:235], v[56:59], v[88:91]
    buffer_store_dwordx4 v[120:123], v1, s[8:11], s79 offen offset:1024 sc0 sc1
    v_mfma_f32_16x16x32_bf16 v[88:91], a[248:251], v[60:63], v[88:91]
    buffer_load_dwordx4 v21, s[24:27], s98 offen offset:1024  lds
    v_mfma_f32_16x16x32_bf16 v[92:95], a[236:239], v[56:59], v[92:95]
    v_mfma_f32_16x16x32_bf16 v[92:95], a[252:255], v[60:63], v[92:95]
    s_waitcnt lgkmcnt(5)
    v_mfma_f32_16x16x32_bf16 v[96:99], a[0:3], v[32:35], 0
    ds_read_b64_tr_b16 v[56:57], v29 offset:40960
    v_mfma_f32_16x16x32_bf16 v[96:99], a[16:19], v[36:39], v[96:99]
    ds_read_b64_tr_b16 v[58:59], v29 offset:41472
    v_mfma_f32_16x16x32_bf16 v[100:103], a[4:7], v[32:35], 0
    ds_read_b64_tr_b16 v[60:61], v29 offset:45056
    v_mfma_f32_16x16x32_bf16 v[100:103], a[20:23], v[36:39], v[100:103]
    ds_read_b64_tr_b16 v[62:63], v29 offset:45568
    v_mfma_f32_16x16x32_bf16 v[104:107], a[8:11], v[32:35], 0
    buffer_load_dwordx4 v22, s[24:27], s98 offen offset:2048  lds
    v_mfma_f32_16x16x32_bf16 v[104:107], a[24:27], v[36:39], v[104:107]
    v_mfma_f32_16x16x32_bf16 v[108:111], a[12:15], v[32:35], 0
    v_mfma_f32_16x16x32_bf16 v[108:111], a[28:31], v[36:39], v[108:111]
    v_mfma_f32_16x16x32_bf16 v[112:115], a[0:3], v[40:43], 0
    s_waitcnt lgkmcnt(4)
    ds_read_b64_tr_b16 v[32:33], v28 offset:49152
    v_cvt_pk_bf16_f32 v64, v64, v65
    v_mfma_f32_16x16x32_bf16 v[112:115], a[16:19], v[44:47], v[112:115]
    ds_read_b64_tr_b16 v[34:35], v28 offset:49664
    v_cvt_pk_bf16_f32 v65, v66, v67
    v_mfma_f32_16x16x32_bf16 v[116:119], a[4:7], v[40:43], 0
    ds_read_b64_tr_b16 v[36:37], v28 offset:53248
    v_cvt_pk_bf16_f32 v66, v68, v69
    v_mfma_f32_16x16x32_bf16 v[116:119], a[20:23], v[44:47], v[116:119]
    ds_read_b64_tr_b16 v[38:39], v28 offset:53760
    v_cvt_pk_bf16_f32 v67, v70, v71
    v_mfma_f32_16x16x32_bf16 v[120:123], a[8:11], v[40:43], 0
    buffer_load_dwordx4 v23, s[24:27], s98 offen offset:3072  lds
    v_mfma_f32_16x16x32_bf16 v[120:123], a[24:27], v[44:47], v[120:123]
    s_add_u32 m0, s63, 16384
    s_xor_b32 s98, s0, 2621440
    s_xor_b32 s79, s1, 32768
    v_mfma_f32_16x16x32_bf16 v[124:127], a[12:15], v[40:43], 0
    buffer_store_dwordx4 v[64:67], v1, s[8:11], s79 offen offset:2048 sc0 sc1
    v_mfma_f32_16x16x32_bf16 v[124:127], a[28:31], v[44:47], v[124:127]
    v_mfma_f32_16x16x32_bf16 v[96:99], a[32:35], v[48:51], v[96:99]
    ds_read_b64_tr_b16 v[40:41], v29 offset:49152
    v_mfma_f32_16x16x32_bf16 v[96:99], a[48:51], v[52:55], v[96:99]
    ds_read_b64_tr_b16 v[42:43], v29 offset:49664
    v_mfma_f32_16x16x32_bf16 v[100:103], a[36:39], v[48:51], v[100:103]
    ds_read_b64_tr_b16 v[44:45], v29 offset:53248
    v_mfma_f32_16x16x32_bf16 v[100:103], a[52:55], v[52:55], v[100:103]
    ds_read_b64_tr_b16 v[46:47], v29 offset:53760
    v_mfma_f32_16x16x32_bf16 v[104:107], a[40:43], v[48:51], v[104:107]
    buffer_load_dwordx4 v20, s[24:27], s98 offen offset:0  lds
    v_mfma_f32_16x16x32_bf16 v[104:107], a[56:59], v[52:55], v[104:107]
    v_cvt_pk_bf16_f32 v72, v72, v73
    v_cvt_pk_bf16_f32 v73, v74, v75
    v_mfma_f32_16x16x32_bf16 v[108:111], a[44:47], v[48:51], v[108:111]
    v_cvt_pk_bf16_f32 v74, v76, v77
    v_cvt_pk_bf16_f32 v75, v78, v79
    v_mfma_f32_16x16x32_bf16 v[108:111], a[60:63], v[52:55], v[108:111]
    s_waitcnt lgkmcnt(4)
    v_mfma_f32_16x16x32_bf16 v[112:115], a[32:35], v[56:59], v[112:115]
    s_xor_b32 s79, s1, 40960
    ds_read_b64_tr_b16 v[48:49], v28 offset:57344
    v_mfma_f32_16x16x32_bf16 v[112:115], a[48:51], v[60:63], v[112:115]
    ds_read_b64_tr_b16 v[50:51], v28 offset:57856
    v_mfma_f32_16x16x32_bf16 v[116:119], a[36:39], v[56:59], v[116:119]
    ds_read_b64_tr_b16 v[52:53], v28 offset:61440
    v_mfma_f32_16x16x32_bf16 v[116:119], a[52:55], v[60:63], v[116:119]
    ds_read_b64_tr_b16 v[54:55], v28 offset:61952
    v_mfma_f32_16x16x32_bf16 v[120:123], a[40:43], v[56:59], v[120:123]
    buffer_load_dwordx4 v21, s[24:27], s98 offen offset:1024  lds
    v_mfma_f32_16x16x32_bf16 v[120:123], a[56:59], v[60:63], v[120:123]
    buffer_store_dwordx4 v[72:75], v1, s[8:11], s79 offen offset:2048 sc0 sc1
    v_mfma_f32_16x16x32_bf16 v[124:127], a[44:47], v[56:59], v[124:127]
    v_mfma_f32_16x16x32_bf16 v[124:127], a[60:63], v[60:63], v[124:127]
    v_mfma_f32_16x16x32_bf16 v[96:99], a[64:67], v[32:35], v[96:99]
    ds_read_b64_tr_b16 v[56:57], v29 offset:57344
    v_mfma_f32_16x16x32_bf16 v[96:99], a[80:83], v[36:39], v[96:99]
    ds_read_b64_tr_b16 v[58:59], v29 offset:57856
    v_mfma_f32_16x16x32_bf16 v[100:103], a[68:71], v[32:35], v[100:103]
    ds_read_b64_tr_b16 v[60:61], v29 offset:61440
    v_cvt_pk_bf16_f32 v80, v80, v81
    v_mfma_f32_16x16x32_bf16 v[100:103], a[84:87], v[36:39], v[100:103]
    ds_read_b64_tr_b16 v[62:63], v29 offset:61952
    v_cvt_pk_bf16_f32 v81, v82, v83
    v_mfma_f32_16x16x32_bf16 v[104:107], a[72:75], v[32:35], v[104:107]
    buffer_load_dwordx4 v22, s[24:27], s98 offen offset:2048  lds
    v_mfma_f32_16x16x32_bf16 v[104:107], a[88:91], v[36:39], v[104:107]
    v_cvt_pk_bf16_f32 v82, v84, v85
    v_cvt_pk_bf16_f32 v83, v86, v87
    v_mfma_f32_16x16x32_bf16 v[108:111], a[76:79], v[32:35], v[108:111]
    v_mfma_f32_16x16x32_bf16 v[108:111], a[92:95], v[36:39], v[108:111]
    s_waitcnt lgkmcnt(4)
    v_mfma_f32_16x16x32_bf16 v[112:115], a[64:67], v[40:43], v[112:115]
    s_xor_b32 s79, s1, 32768
    ds_read_b64_tr_b16 v[32:33], v30 offset:32768
    v_mfma_f32_16x16x32_bf16 v[112:115], a[80:83], v[44:47], v[112:115]
    ds_read_b64_tr_b16 v[34:35], v30 offset:33280
    v_mfma_f32_16x16x32_bf16 v[116:119], a[68:71], v[40:43], v[116:119]
    ds_read_b64_tr_b16 v[36:37], v30 offset:36864
    v_mfma_f32_16x16x32_bf16 v[116:119], a[84:87], v[44:47], v[116:119]
    ds_read_b64_tr_b16 v[38:39], v30 offset:37376
    v_mfma_f32_16x16x32_bf16 v[120:123], a[72:75], v[40:43], v[120:123]
    buffer_load_dwordx4 v23, s[24:27], s98 offen offset:3072  lds
    v_mfma_f32_16x16x32_bf16 v[120:123], a[88:91], v[44:47], v[120:123]
    buffer_store_dwordx4 v[80:83], v1, s[8:11], s79 offen offset:3072 sc0 sc1
    v_mfma_f32_16x16x32_bf16 v[124:127], a[76:79], v[40:43], v[124:127]
    v_mfma_f32_16x16x32_bf16 v[124:127], a[92:95], v[44:47], v[124:127]
    v_mfma_f32_16x16x32_bf16 v[96:99], a[96:99], v[48:51], v[96:99]
    ds_read_b64_tr_b16 v[40:41], v31 offset:32768
    v_cvt_pk_bf16_f32 v88, v88, v89
    v_mfma_f32_16x16x32_bf16 v[96:99], a[112:115], v[52:55], v[96:99]
    ds_read_b64_tr_b16 v[42:43], v31 offset:33280
    v_cvt_pk_bf16_f32 v89, v90, v91
    v_mfma_f32_16x16x32_bf16 v[100:103], a[100:103], v[48:51], v[100:103]
    ds_read_b64_tr_b16 v[44:45], v31 offset:36864
    v_cvt_pk_bf16_f32 v90, v92, v93
    v_mfma_f32_16x16x32_bf16 v[100:103], a[116:119], v[52:55], v[100:103]
    ds_read_b64_tr_b16 v[46:47], v31 offset:37376
    v_cvt_pk_bf16_f32 v91, v94, v95
    v_mfma_f32_16x16x32_bf16 v[104:107], a[104:107], v[48:51], v[104:107]
    s_xor_b32 s79, s1, 40960
    v_mfma_f32_16x16x32_bf16 v[104:107], a[120:123], v[52:55], v[104:107]
    buffer_store_dwordx4 v[88:91], v1, s[8:11], s79 offen offset:3072 sc0 sc1
    v_mfma_f32_16x16x32_bf16 v[108:111], a[108:111], v[48:51], v[108:111]
    v_mfma_f32_16x16x32_bf16 v[108:111], a[124:127], v[52:55], v[108:111]
    s_waitcnt lgkmcnt(4)
    v_mfma_f32_16x16x32_bf16 v[112:115], a[96:99], v[56:59], v[112:115]
    ds_read_b64_tr_b16 v[48:49], v30 offset:40960
    v_mfma_f32_16x16x32_bf16 v[112:115], a[112:115], v[60:63], v[112:115]
    ds_read_b64_tr_b16 v[50:51], v30 offset:41472
    v_mfma_f32_16x16x32_bf16 v[116:119], a[100:103], v[56:59], v[116:119]
    ds_read_b64_tr_b16 v[52:53], v30 offset:45056
    v_mfma_f32_16x16x32_bf16 v[116:119], a[116:119], v[60:63], v[116:119]
    ds_read_b64_tr_b16 v[54:55], v30 offset:45568
    v_mfma_f32_16x16x32_bf16 v[120:123], a[104:107], v[56:59], v[120:123]
    v_mfma_f32_16x16x32_bf16 v[120:123], a[120:123], v[60:63], v[120:123]
    v_mfma_f32_16x16x32_bf16 v[124:127], a[108:111], v[56:59], v[124:127]
    v_mfma_f32_16x16x32_bf16 v[124:127], a[124:127], v[60:63], v[124:127]
    v_mfma_f32_16x16x32_bf16 v[64:67], a[0:3], v[32:35], 0
    ds_read_b64_tr_b16 v[56:57], v31 offset:40960
    v_mfma_f32_16x16x32_bf16 v[64:67], a[16:19], v[36:39], v[64:67]
    ds_read_b64_tr_b16 v[58:59], v31 offset:41472
    v_mfma_f32_16x16x32_bf16 v[68:71], a[4:7], v[32:35], 0
    ds_read_b64_tr_b16 v[60:61], v31 offset:45056
    v_cvt_pk_bf16_f32 v216, v216, v217
    v_mfma_f32_16x16x32_bf16 v[68:71], a[20:23], v[36:39], v[68:71]
    ds_read_b64_tr_b16 v[62:63], v31 offset:45568
    v_cvt_pk_bf16_f32 v217, v218, v219
    v_mfma_f32_16x16x32_bf16 v[72:75], a[8:11], v[32:35], 0
    v_cvt_pk_bf16_f32 v218, v220, v221
    v_cvt_pk_bf16_f32 v219, v222, v223
    v_mfma_f32_16x16x32_bf16 v[72:75], a[24:27], v[36:39], v[72:75]
    s_xor_b32 s79, s65, 8192
    v_mfma_f32_16x16x32_bf16 v[76:79], a[12:15], v[32:35], 0
    buffer_store_dwordx4 v[216:219], v1, s[8:11], s79 offen offset:3072 sc0 sc1
    v_mfma_f32_16x16x32_bf16 v[76:79], a[28:31], v[36:39], v[76:79]
    s_waitcnt lgkmcnt(4)
    v_mfma_f32_16x16x32_bf16 v[80:83], a[0:3], v[40:43], 0
    ds_read_b64_tr_b16 v[32:33], v30 offset:49152
    v_mfma_f32_16x16x32_bf16 v[80:83], a[16:19], v[44:47], v[80:83]
    ds_read_b64_tr_b16 v[34:35], v30 offset:49664
    v_mfma_f32_16x16x32_bf16 v[84:87], a[4:7], v[40:43], 0
    ds_read_b64_tr_b16 v[36:37], v30 offset:53248
    v_mfma_f32_16x16x32_bf16 v[84:87], a[20:23], v[44:47], v[84:87]
    ds_read_b64_tr_b16 v[38:39], v30 offset:53760
    v_mfma_f32_16x16x32_bf16 v[88:91], a[8:11], v[40:43], 0
    v_mfma_f32_16x16x32_bf16 v[88:91], a[24:27], v[44:47], v[88:91]
    v_mfma_f32_16x16x32_bf16 v[92:95], a[12:15], v[40:43], 0
    v_mfma_f32_16x16x32_bf16 v[92:95], a[28:31], v[44:47], v[92:95]
    v_mfma_f32_16x16x32_bf16 v[64:67], a[32:35], v[48:51], v[64:67]
    ds_read_b64_tr_b16 v[40:41], v31 offset:49152
    v_mfma_f32_16x16x32_bf16 v[64:67], a[48:51], v[52:55], v[64:67]
    ds_read_b64_tr_b16 v[42:43], v31 offset:49664
    v_mfma_f32_16x16x32_bf16 v[68:71], a[36:39], v[48:51], v[68:71]
    ds_read_b64_tr_b16 v[44:45], v31 offset:53248
    v_mfma_f32_16x16x32_bf16 v[68:71], a[52:55], v[52:55], v[68:71]
    ds_read_b64_tr_b16 v[46:47], v31 offset:53760
    v_mfma_f32_16x16x32_bf16 v[72:75], a[40:43], v[48:51], v[72:75]
    buffer_load_dword v3, v16, s[8:11], s78 offen sc0 sc1
    v_mfma_f32_16x16x32_bf16 v[72:75], a[56:59], v[52:55], v[72:75]
    v_mfma_f32_16x16x32_bf16 v[76:79], a[44:47], v[48:51], v[76:79]
    v_mfma_f32_16x16x32_bf16 v[76:79], a[60:63], v[52:55], v[76:79]
    s_waitcnt lgkmcnt(4)
    v_mfma_f32_16x16x32_bf16 v[80:83], a[32:35], v[56:59], v[80:83]
    ds_read_b64_tr_b16 v[48:49], v30 offset:57344
    v_cvt_pk_bf16_f32 v224, v224, v225
    v_mfma_f32_16x16x32_bf16 v[80:83], a[48:51], v[60:63], v[80:83]
    ds_read_b64_tr_b16 v[50:51], v30 offset:57856
    v_cvt_pk_bf16_f32 v225, v226, v227
    v_mfma_f32_16x16x32_bf16 v[84:87], a[36:39], v[56:59], v[84:87]
    ds_read_b64_tr_b16 v[52:53], v30 offset:61440
    v_cvt_pk_bf16_f32 v226, v228, v229
    v_mfma_f32_16x16x32_bf16 v[84:87], a[52:55], v[60:63], v[84:87]
    ds_read_b64_tr_b16 v[54:55], v30 offset:61952
    v_cvt_pk_bf16_f32 v227, v230, v231
    v_mfma_f32_16x16x32_bf16 v[88:91], a[40:43], v[56:59], v[88:91]
    s_xor_b32 s79, s65, 12288
    v_mfma_f32_16x16x32_bf16 v[88:91], a[56:59], v[60:63], v[88:91]
    buffer_store_dwordx4 v[224:227], v1, s[8:11], s79 offen offset:0 sc0 sc1
    v_mfma_f32_16x16x32_bf16 v[92:95], a[44:47], v[56:59], v[92:95]
    v_mfma_f32_16x16x32_bf16 v[92:95], a[60:63], v[60:63], v[92:95]
    v_mfma_f32_16x16x32_bf16 v[64:67], a[64:67], v[32:35], v[64:67]
    ds_read_b64_tr_b16 v[56:57], v31 offset:57344
    v_mfma_f32_16x16x32_bf16 v[64:67], a[80:83], v[36:39], v[64:67]
    ds_read_b64_tr_b16 v[58:59], v31 offset:57856
    v_mfma_f32_16x16x32_bf16 v[68:71], a[68:71], v[32:35], v[68:71]
    ds_read_b64_tr_b16 v[60:61], v31 offset:61440
    v_mfma_f32_16x16x32_bf16 v[68:71], a[84:87], v[36:39], v[68:71]
    ds_read_b64_tr_b16 v[62:63], v31 offset:61952
    v_mfma_f32_16x16x32_bf16 v[72:75], a[72:75], v[32:35], v[72:75]
    v_mfma_f32_16x16x32_bf16 v[72:75], a[88:91], v[36:39], v[72:75]
    v_mfma_f32_16x16x32_bf16 v[76:79], a[76:79], v[32:35], v[76:79]
    v_mfma_f32_16x16x32_bf16 v[76:79], a[92:95], v[36:39], v[76:79]
    s_waitcnt lgkmcnt(4)
    v_mfma_f32_16x16x32_bf16 v[80:83], a[64:67], v[40:43], v[80:83]
    v_mfma_f32_16x16x32_bf16 v[80:83], a[80:83], v[44:47], v[80:83]
    v_mfma_f32_16x16x32_bf16 v[84:87], a[68:71], v[40:43], v[84:87]
    v_mfma_f32_16x16x32_bf16 v[84:87], a[84:87], v[44:47], v[84:87]
    v_mfma_f32_16x16x32_bf16 v[88:91], a[72:75], v[40:43], v[88:91]
    v_mfma_f32_16x16x32_bf16 v[88:91], a[88:91], v[44:47], v[88:91]
    v_mfma_f32_16x16x32_bf16 v[92:95], a[76:79], v[40:43], v[92:95]
    v_xor_b32 v28, 65536, v28
    v_cvt_pk_bf16_f32 v232, v232, v233
    s_waitcnt vmcnt(29) lgkmcnt(0)
    s_barrier
    v_mfma_f32_16x16x32_bf16 v[92:95], a[92:95], v[44:47], v[92:95]
    s_add_u32 m0, s63, 32768
    ds_read_b64_tr_b16 v[32:33], v28 offset:0
    v_xor_b32 v29, 65536, v29
    v_mfma_f32_16x16x32_bf16 v[64:67], a[96:99], v[48:51], v[64:67]
    s_xor_b32 s98, s0, 3145728
    ds_read_b64_tr_b16 v[34:35], v28 offset:512
    v_cvt_pk_bf16_f32 v233, v234, v235
    v_mfma_f32_16x16x32_bf16 v[64:67], a[112:115], v[52:55], v[64:67]
    ds_read_b64_tr_b16 v[36:37], v28 offset:4096
    v_cvt_pk_bf16_f32 v234, v236, v237
    v_mfma_f32_16x16x32_bf16 v[68:71], a[100:103], v[48:51], v[68:71]
    ds_read_b64_tr_b16 v[38:39], v28 offset:4608
    v_cvt_pk_bf16_f32 v235, v238, v239
    v_mfma_f32_16x16x32_bf16 v[68:71], a[116:119], v[52:55], v[68:71]
    s_xor_b32 s79, s65, 12288
    ds_read_b64_tr_b16 v[40:41], v29 offset:0
    v_mfma_f32_16x16x32_bf16 v[72:75], a[104:107], v[48:51], v[72:75]
    ds_read_b64_tr_b16 v[42:43], v29 offset:512
    v_mfma_f32_16x16x32_bf16 v[72:75], a[120:123], v[52:55], v[72:75]
    ds_read_b64_tr_b16 v[44:45], v29 offset:4096
    v_mfma_f32_16x16x32_bf16 v[76:79], a[108:111], v[48:51], v[76:79]
    ds_read_b64_tr_b16 v[46:47], v29 offset:4608
    v_mfma_f32_16x16x32_bf16 v[76:79], a[124:127], v[52:55], v[76:79]
    buffer_load_dwordx4 v20, s[24:27], s98 offen offset:0  lds
    v_mfma_f32_16x16x32_bf16 v[80:83], a[96:99], v[56:59], v[80:83]
    ds_read_b64_tr_b16 v[48:49], v28 offset:8192
    v_mfma_f32_16x16x32_bf16 v[80:83], a[112:115], v[60:63], v[80:83]
    ds_read_b64_tr_b16 v[50:51], v28 offset:8704
    v_mfma_f32_16x16x32_bf16 v[84:87], a[100:103], v[56:59], v[84:87]
    ds_read_b64_tr_b16 v[52:53], v28 offset:12288
    v_mfma_f32_16x16x32_bf16 v[84:87], a[116:119], v[60:63], v[84:87]
    ds_read_b64_tr_b16 v[54:55], v28 offset:12800
    v_mfma_f32_16x16x32_bf16 v[88:91], a[104:107], v[56:59], v[88:91]
    buffer_store_dwordx4 v[232:235], v1, s[8:11], s79 offen offset:1024 sc0 sc1
    v_mfma_f32_16x16x32_bf16 v[88:91], a[120:123], v[60:63], v[88:91]
    buffer_load_dwordx4 v21, s[24:27], s98 offen offset:1024  lds
    v_mfma_f32_16x16x32_bf16 v[92:95], a[108:111], v[56:59], v[92:95]
    v_mfma_f32_16x16x32_bf16 v[92:95], a[124:127], v[60:63], v[92:95]
    s_waitcnt lgkmcnt(5)
    v_mfma_f32_16x16x32_bf16 v[96:99], a[128:131], v[32:35], v[96:99]
    ds_read_b64_tr_b16 v[56:57], v29 offset:8192
    s_waitcnt vmcnt(4)
    v_cmp_ne_u32 vcc, 0, v3
    s_cmp_eq_u64 vcc, -1
    s_cbranch_scc0 L_H_slow_3
L_H_ok_4:
    v_mfma_f32_16x16x32_bf16 v[96:99], a[144:147], v[36:39], v[96:99]
    ds_read_b64_tr_b16 v[58:59], v29 offset:8704
    v_mfma_f32_16x16x32_bf16 v[100:103], a[132:135], v[32:35], v[100:103]
    s_xor_b32 s80, s75, 0
    ds_read_b64_tr_b16 v[60:61], v29 offset:12288
    v_mfma_f32_16x16x32_bf16 v[100:103], a[148:151], v[36:39], v[100:103]
    ds_read_b64_tr_b16 v[62:63], v29 offset:12800
    v_mfma_f32_16x16x32_bf16 v[104:107], a[136:139], v[32:35], v[104:107]
    buffer_load_dwordx4 v22, s[24:27], s98 offen offset:2048  lds
    v_mfma_f32_16x16x32_bf16 v[104:107], a[152:155], v[36:39], v[104:107]
    v_cvt_pk_bf16_f32 v240, v240, v241
    v_cvt_pk_bf16_f32 v241, v242, v243
    v_mfma_f32_16x16x32_bf16 v[108:111], a[140:143], v[32:35], v[108:111]
    v_cvt_pk_bf16_f32 v242, v244, v245
    v_cvt_pk_bf16_f32 v243, v246, v247
    v_mfma_f32_16x16x32_bf16 v[108:111], a[156:159], v[36:39], v[108:111]
    buffer_load_dwordx4 a[0:3], v1, s[8:11], s80 offen offset:0
    v_mfma_f32_16x16x32_bf16 v[112:115], a[128:131], v[40:43], v[112:115]
    s_waitcnt lgkmcnt(4)
    s_xor_b32 s79, s65, 12288
    s_xor_b32 s80, s75, 16384
    ds_read_b64_tr_b16 v[32:33], v28 offset:16384
    v_mfma_f32_16x16x32_bf16 v[112:115], a[144:147], v[44:47], v[112:115]
    ds_read_b64_tr_b16 v[34:35], v28 offset:16896
    v_mfma_f32_16x16x32_bf16 v[116:119], a[132:135], v[40:43], v[116:119]
    ds_read_b64_tr_b16 v[36:37], v28 offset:20480
    v_mfma_f32_16x16x32_bf16 v[116:119], a[148:151], v[44:47], v[116:119]
    ds_read_b64_tr_b16 v[38:39], v28 offset:20992
    v_mfma_f32_16x16x32_bf16 v[120:123], a[136:139], v[40:43], v[120:123]
    buffer_load_dwordx4 v23, s[24:27], s98 offen offset:3072  lds
    v_mfma_f32_16x16x32_bf16 v[120:123], a[152:155], v[44:47], v[120:123]
    s_add_u32 m0, s63, 49152
    s_xor_b32 s98, s0, 3670016
    v_mfma_f32_16x16x32_bf16 v[124:127], a[140:143], v[40:43], v[124:127]
    buffer_store_dwordx4 v[240:243], v1, s[8:11], s79 offen offset:2048 sc0 sc1
    v_mfma_f32_16x16x32_bf16 v[124:127], a[156:159], v[44:47], v[124:127]
    buffer_load_dwordx4 a[4:7], v1, s[8:11], s80 offen offset:0
    v_mfma_f32_16x16x32_bf16 v[96:99], a[160:163], v[48:51], v[96:99]
    s_xor_b32 s80, s76, 0
    ds_read_b64_tr_b16 v[40:41], v29 offset:16384
    v_mfma_f32_16x16x32_bf16 v[96:99], a[176:179], v[52:55], v[96:99]
    ds_read_b64_tr_b16 v[42:43], v29 offset:16896
    v_mfma_f32_16x16x32_bf16 v[100:103], a[164:167], v[48:51], v[100:103]
    ds_read_b64_tr_b16 v[44:45], v29 offset:20480
    v_mfma_f32_16x16x32_bf16 v[100:103], a[180:183], v[52:55], v[100:103]
    ds_read_b64_tr_b16 v[46:47], v29 offset:20992
    v_mfma_f32_16x16x32_bf16 v[104:107], a[168:171], v[48:51], v[104:107]
    buffer_load_dwordx4 v20, s[24:27], s98 offen offset:0  lds
    v_mfma_f32_16x16x32_bf16 v[104:107], a[184:187], v[52:55], v[104:107]
    buffer_load_dwordx4 a[8:11], v1, s[8:11], s80 offen offset:0
    v_mfma_f32_16x16x32_bf16 v[108:111], a[172:175], v[48:51], v[108:111]
    v_mfma_f32_16x16x32_bf16 v[108:111], a[188:191], v[52:55], v[108:111]
    s_waitcnt lgkmcnt(4)
    v_mfma_f32_16x16x32_bf16 v[112:115], a[160:163], v[56:59], v[112:115]
    s_xor_b32 s80, s76, 16384
    ds_read_b64_tr_b16 v[48:49], v28 offset:24576
    v_mfma_f32_16x16x32_bf16 v[112:115], a[176:179], v[60:63], v[112:115]
    ds_read_b64_tr_b16 v[50:51], v28 offset:25088
    v_mfma_f32_16x16x32_bf16 v[116:119], a[164:167], v[56:59], v[116:119]
    ds_read_b64_tr_b16 v[52:53], v28 offset:28672
    v_cvt_pk_bf16_f32 v248, v248, v249
    v_mfma_f32_16x16x32_bf16 v[116:119], a[180:183], v[60:63], v[116:119]
    ds_read_b64_tr_b16 v[54:55], v28 offset:29184
    v_cvt_pk_bf16_f32 v249, v250, v251
    v_mfma_f32_16x16x32_bf16 v[120:123], a[168:171], v[56:59], v[120:123]
    buffer_load_dwordx4 v21, s[24:27], s98 offen offset:1024  lds
    v_mfma_f32_16x16x32_bf16 v[120:123], a[184:187], v[60:63], v[120:123]
    v_cvt_pk_bf16_f32 v250, v252, v253
    v_cvt_pk_bf16_f32 v251, v254, v255
    v_mfma_f32_16x16x32_bf16 v[124:127], a[172:175], v[56:59], v[124:127]
    buffer_load_dwordx4 a[12:15], v1, s[8:11], s80 offen offset:0
    v_mfma_f32_16x16x32_bf16 v[124:127], a[188:191], v[60:63], v[124:127]
    v_mfma_f32_16x16x32_bf16 v[96:99], a[192:195], v[32:35], v[96:99]
    s_xor_b32 s79, s65, 12288
    s_xor_b32 s80, s75, 0
    ds_read_b64_tr_b16 v[56:57], v29 offset:24576
    v_mfma_f32_16x16x32_bf16 v[96:99], a[208:211], v[36:39], v[96:99]
    ds_read_b64_tr_b16 v[58:59], v29 offset:25088
    v_mfma_f32_16x16x32_bf16 v[100:103], a[196:199], v[32:35], v[100:103]
    ds_read_b64_tr_b16 v[60:61], v29 offset:28672
    v_mfma_f32_16x16x32_bf16 v[100:103], a[212:215], v[36:39], v[100:103]
    ds_read_b64_tr_b16 v[62:63], v29 offset:29184
    v_mfma_f32_16x16x32_bf16 v[104:107], a[200:203], v[32:35], v[104:107]
    buffer_load_dwordx4 v22, s[24:27], s98 offen offset:2048  lds
    v_mfma_f32_16x16x32_bf16 v[104:107], a[216:219], v[36:39], v[104:107]
    buffer_store_dwordx4 v[248:251], v1, s[8:11], s79 offen offset:3072 sc0 sc1
    v_mfma_f32_16x16x32_bf16 v[108:111], a[204:207], v[32:35], v[108:111]
    buffer_load_dwordx4 a[16:19], v1, s[8:11], s80 offen offset:1024
    v_mfma_f32_16x16x32_bf16 v[108:111], a[220:223], v[36:39], v[108:111]
    s_waitcnt lgkmcnt(4)
    s_xor_b32 s80, s75, 16384
    v_xor_b32 v30, 65536, v30
    v_mfma_f32_16x16x32_bf16 v[112:115], a[192:195], v[40:43], v[112:115]
    ds_read_b64_tr_b16 v[32:33], v30 offset:0
    v_mfma_f32_16x16x32_bf16 v[112:115], a[208:211], v[44:47], v[112:115]
    ds_read_b64_tr_b16 v[34:35], v30 offset:512
    v_mfma_f32_16x16x32_bf16 v[116:119], a[196:199], v[40:43], v[116:119]
    ds_read_b64_tr_b16 v[36:37], v30 offset:4096
    v_mfma_f32_16x16x32_bf16 v[116:119], a[212:215], v[44:47], v[116:119]
    ds_read_b64_tr_b16 v[38:39], v30 offset:4608
    v_mfma_f32_16x16x32_bf16 v[120:123], a[200:203], v[40:43], v[120:123]
    buffer_load_dwordx4 v23, s[24:27], s98 offen offset:3072  lds
    v_mfma_f32_16x16x32_bf16 v[120:123], a[216:219], v[44:47], v[120:123]
    buffer_load_dwordx4 a[20:23], v1, s[8:11], s80 offen offset:1024
    v_mfma_f32_16x16x32_bf16 v[124:127], a[204:207], v[40:43], v[124:127]
    v_mfma_f32_16x16x32_bf16 v[124:127], a[220:223], v[44:47], v[124:127]
    s_xor_b32 s80, s76, 0
    v_xor_b32 v31, 65536, v31
    v_mfma_f32_16x16x32_bf16 v[96:99], a[224:227], v[48:51], v[96:99]
    ds_read_b64_tr_b16 v[40:41], v31 offset:0
    v_mfma_f32_16x16x32_bf16 v[96:99], a[240:243], v[52:55], v[96:99]
    ds_read_b64_tr_b16 v[42:43], v31 offset:512
    v_mfma_f32_16x16x32_bf16 v[100:103], a[228:231], v[48:51], v[100:103]
    ds_read_b64_tr_b16 v[44:45], v31 offset:4096
    v_mfma_f32_16x16x32_bf16 v[100:103], a[244:247], v[52:55], v[100:103]
    ds_read_b64_tr_b16 v[46:47], v31 offset:4608
    v_mfma_f32_16x16x32_bf16 v[104:107], a[232:235], v[48:51], v[104:107]
    buffer_load_dwordx4 a[24:27], v1, s[8:11], s80 offen offset:1024
    v_mfma_f32_16x16x32_bf16 v[104:107], a[248:251], v[52:55], v[104:107]
    s_xor_b32 s80, s76, 16384
    v_mfma_f32_16x16x32_bf16 v[108:111], a[236:239], v[48:51], v[108:111]
    buffer_load_dwordx4 a[28:31], v1, s[8:11], s80 offen offset:1024
    v_mfma_f32_16x16x32_bf16 v[108:111], a[252:255], v[52:55], v[108:111]
    s_waitcnt lgkmcnt(4)
    v_mfma_f32_16x16x32_bf16 v[112:115], a[224:227], v[56:59], v[112:115]
    ds_read_b64_tr_b16 v[48:49], v30 offset:8192
    v_mfma_f32_16x16x32_bf16 v[112:115], a[240:243], v[60:63], v[112:115]
    s_xor_b32 s80, s75, 2048
    ds_read_b64_tr_b16 v[50:51], v30 offset:8704
    v_mfma_f32_16x16x32_bf16 v[116:119], a[228:231], v[56:59], v[116:119]
    ds_read_b64_tr_b16 v[52:53], v30 offset:12288
    v_mfma_f32_16x16x32_bf16 v[116:119], a[244:247], v[60:63], v[116:119]
    ds_read_b64_tr_b16 v[54:55], v30 offset:12800
    v_mfma_f32_16x16x32_bf16 v[120:123], a[232:235], v[56:59], v[120:123]
    buffer_load_dwordx4 a[32:35], v1, s[8:11], s80 offen offset:0
    v_mfma_f32_16x16x32_bf16 v[120:123], a[248:251], v[60:63], v[120:123]
    v_mfma_f32_16x16x32_bf16 v[124:127], a[236:239], v[56:59], v[124:127]
    v_mfma_f32_16x16x32_bf16 v[124:127], a[252:255], v[60:63], v[124:127]
    v_mfma_f32_16x16x32_bf16 v[64:67], a[128:131], v[32:35], v[64:67]
    s_xor_b32 s80, s75, 18432
    ds_read_b64_tr_b16 v[56:57], v31 offset:8192
    v_mfma_f32_16x16x32_bf16 v[64:67], a[144:147], v[36:39], v[64:67]
    ds_read_b64_tr_b16 v[58:59], v31 offset:8704
    v_mfma_f32_16x16x32_bf16 v[68:71], a[132:135], v[32:35], v[68:71]
    ds_read_b64_tr_b16 v[60:61], v31 offset:12288
    v_mfma_f32_16x16x32_bf16 v[68:71], a[148:151], v[36:39], v[68:71]
    ds_read_b64_tr_b16 v[62:63], v31 offset:12800
    v_mfma_f32_16x16x32_bf16 v[72:75], a[136:139], v[32:35], v[72:75]
    buffer_load_dwordx4 a[36:39], v1, s[8:11], s80 offen offset:0
    v_mfma_f32_16x16x32_bf16 v[72:75], a[152:155], v[36:39], v[72:75]
    v_mfma_f32_16x16x32_bf16 v[76:79], a[140:143], v[32:35], v[76:79]
    v_mfma_f32_16x16x32_bf16 v[76:79], a[156:159], v[36:39], v[76:79]
    s_waitcnt lgkmcnt(4)
    v_mfma_f32_16x16x32_bf16 v[80:83], a[128:131], v[40:43], v[80:83]
    s_xor_b32 s80, s76, 2048
    ds_read_b64_tr_b16 v[32:33], v30 offset:16384
    v_cvt_pk_bf16_f32 v96, v96, v97
    v_mfma_f32_16x16x32_bf16 v[80:83], a[144:147], v[44:47], v[80:83]
    ds_read_b64_tr_b16 v[34:35], v30 offset:16896
    v_cvt_pk_bf16_f32 v97, v98, v99
    v_mfma_f32_16x16x32_bf16 v[84:87], a[132:135], v[40:43], v[84:87]
    ds_read_b64_tr_b16 v[36:37], v30 offset:20480
    v_cvt_pk_bf16_f32 v98, v100, v101
    v_mfma_f32_16x16x32_bf16 v[84:87], a[148:151], v[44:47], v[84:87]
    ds_read_b64_tr_b16 v[38:39], v30 offset:20992
    v_cvt_pk_bf16_f32 v99, v102, v103
    v_mfma_f32_16x16x32_bf16 v[88:91], a[136:139], v[40:43], v[88:91]
    s_xor_b32 s79, s1, 36864
    v_mfma_f32_16x16x32_bf16 v[88:91], a[152:155], v[44:47], v[88:91]
    buffer_store_dwordx4 v[96:99], v1, s[8:11], s79 offen offset:0 sc0 sc1
    v_mfma_f32_16x16x32_bf16 v[92:95], a[140:143], v[40:43], v[92:95]
    buffer_load_dwordx4 a[40:43], v1, s[8:11], s80 offen offset:0
    v_mfma_f32_16x16x32_bf16 v[92:95], a[156:159], v[44:47], v[92:95]
    v_mfma_f32_16x16x32_bf16 v[64:67], a[160:163], v[48:51], v[64:67]
    s_xor_b32 s80, s76, 18432
    ds_read_b64_tr_b16 v[40:41], v31 offset:16384
    v_mfma_f32_16x16x32_bf16 v[64:67], a[176:179], v[52:55], v[64:67]
    ds_read_b64_tr_b16 v[42:43], v31 offset:16896
    v_mfma_f32_16x16x32_bf16 v[68:71], a[164:167], v[48:51], v[68:71]
    ds_read_b64_tr_b16 v[44:45], v31 offset:20480
    v_mfma_f32_16x16x32_bf16 v[68:71], a[180:183], v[52:55], v[68:71]
    ds_read_b64_tr_b16 v[46:47], v31 offset:20992
    v_mfma_f32_16x16x32_bf16 v[72:75], a[168:171], v[48:51], v[72:75]
    buffer_load_dwordx4 a[44:47], v1, s[8:11], s80 offen offset:0
    v_mfma_f32_16x16x32_bf16 v[72:75], a[184:187], v[52:55], v[72:75]
    s_xor_b32 s80, s75, 2048
    v_mfma_f32_16x16x32_bf16 v[76:79], a[172:175], v[48:51], v[76:79]
    buffer_load_dwordx4 a[48:51], v1, s[8:11], s80 offen offset:1024
    v_mfma_f32_16x16x32_bf16 v[76:79], a[188:191], v[52:55], v[76:79]
    s_waitcnt lgkmcnt(4)
    v_mfma_f32_16x16x32_bf16 v[80:83], a[160:163], v[56:59], v[80:83]
    ds_read_b64_tr_b16 v[48:49], v30 offset:24576
    v_cvt_pk_bf16_f32 v104, v104, v105
    v_mfma_f32_16x16x32_bf16 v[80:83], a[176:179], v[60:63], v[80:83]
    ds_read_b64_tr_b16 v[50:51], v30 offset:25088
    v_cvt_pk_bf16_f32 v105, v106, v107
    v_mfma_f32_16x16x32_bf16 v[84:87], a[164:167], v[56:59], v[84:87]
    ds_read_b64_tr_b16 v[52:53], v30 offset:28672
    v_cvt_pk_bf16_f32 v106, v108, v109
    v_mfma_f32_16x16x32_bf16 v[84:87], a[180:183], v[60:63], v[84:87]
    ds_read_b64_tr_b16 v[54:55], v30 offset:29184
    v_cvt_pk_bf16_f32 v107, v110, v111
    v_mfma_f32_16x16x32_bf16 v[88:91], a[168:171], v[56:59], v[88:91]
    s_xor_b32 s79, s1, 45056
    s_xor_b32 s80, s75, 18432
    v_mfma_f32_16x16x32_bf16 v[88:91], a[184:187], v[60:63], v[88:91]
    buffer_store_dwordx4 v[104:107], v1, s[8:11], s79 offen offset:0 sc0 sc1
    v_mfma_f32_16x16x32_bf16 v[92:95], a[172:175], v[56:59], v[92:95]
    buffer_load_dwordx4 a[52:55], v1, s[8:11], s80 offen offset:1024
    v_mfma_f32_16x16x32_bf16 v[92:95], a[188:191], v[60:63], v[92:95]
    v_mfma_f32_16x16x32_bf16 v[64:67], a[192:195], v[32:35], v[64:67]
    ds_read_b64_tr_b16 v[56:57], v31 offset:24576
    v_mfma_f32_16x16x32_bf16 v[64:67], a[208:211], v[36:39], v[64:67]
    ds_read_b64_tr_b16 v[58:59], v31 offset:25088
    v_mfma_f32_16x16x32_bf16 v[68:71], a[196:199], v[32:35], v[68:71]
    ds_read_b64_tr_b16 v[60:61], v31 offset:28672
    v_mfma_f32_16x16x32_bf16 v[68:71], a[212:215], v[36:39], v[68:71]
    s_xor_b32 s80, s76, 2048
    ds_read_b64_tr_b16 v[62:63], v31 offset:29184
    v_mfma_f32_16x16x32_bf16 v[72:75], a[200:203], v[32:35], v[72:75]
    buffer_load_dwordx4 a[56:59], v1, s[8:11], s80 offen offset:1024
    v_mfma_f32_16x16x32_bf16 v[72:75], a[216:219], v[36:39], v[72:75]
    v_mfma_f32_16x16x32_bf16 v[76:79], a[204:207], v[32:35], v[76:79]
    v_cvt_pk_bf16_f32 v112, v112, v113
    v_cvt_pk_bf16_f32 v113, v114, v115
    v_mfma_f32_16x16x32_bf16 v[76:79], a[220:223], v[36:39], v[76:79]
    s_waitcnt lgkmcnt(4)
    v_cvt_pk_bf16_f32 v114, v116, v117
    v_cvt_pk_bf16_f32 v115, v118, v119
    v_mfma_f32_16x16x32_bf16 v[80:83], a[192:195], v[40:43], v[80:83]
    s_xor_b32 s79, s1, 36864
    v_mfma_f32_16x16x32_bf16 v[80:83], a[208:211], v[44:47], v[80:83]
    buffer_store_dwordx4 v[112:115], v1, s[8:11], s79 offen offset:1024 sc0 sc1
    v_mfma_f32_16x16x32_bf16 v[84:87], a[196:199], v[40:43], v[84:87]
    s_xor_b32 s80, s76, 18432
    v_mfma_f32_16x16x32_bf16 v[84:87], a[212:215], v[44:47], v[84:87]
    buffer_load_dwordx4 a[60:63], v1, s[8:11], s80 offen offset:1024
    v_mfma_f32_16x16x32_bf16 v[88:91], a[200:203], v[40:43], v[88:91]
    v_mfma_f32_16x16x32_bf16 v[88:91], a[216:219], v[44:47], v[88:91]
    v_mfma_f32_16x16x32_bf16 v[92:95], a[204:207], v[40:43], v[92:95]
    s_waitcnt lgkmcnt(0)
    s_barrier
    v_mfma_f32_16x16x32_bf16 v[92:95], a[220:223], v[44:47], v[92:95]
    ds_read_b64_tr_b16 v[32:33], v8 offset:32768
    v_mfma_f32_16x16x32_bf16 v[64:67], a[224:227], v[48:51], v[64:67]
    ds_read_b64_tr_b16 v[34:35], v8 offset:33792
    v_mfma_f32_16x16x32_bf16 v[64:67], a[240:243], v[52:55], v[64:67]
    s_xor_b32 s80, s75, 4096
    ds_read_b64_tr_b16 v[36:37], v9 offset:32768
    v_mfma_f32_16x16x32_bf16 v[68:71], a[228:231], v[48:51], v[68:71]
    ds_read_b64_tr_b16 v[38:39], v9 offset:33792
    v_mfma_f32_16x16x32_bf16 v[68:71], a[244:247], v[52:55], v[68:71]
    ds_read_b64_tr_b16 v[40:41], v10 offset:32768
    v_mfma_f32_16x16x32_bf16 v[72:75], a[232:235], v[48:51], v[72:75]
    ds_read_b64_tr_b16 v[42:43], v10 offset:33792
    v_mfma_f32_16x16x32_bf16 v[72:75], a[248:251], v[52:55], v[72:75]
    ds_read_b64_tr_b16 v[44:45], v11 offset:32768
    v_mfma_f32_16x16x32_bf16 v[76:79], a[236:239], v[48:51], v[76:79]
    ds_read_b64_tr_b16 v[46:47], v11 offset:33792
    v_cvt_pk_bf16_f32 v120, v120, v121
    v_mfma_f32_16x16x32_bf16 v[76:79], a[252:255], v[52:55], v[76:79]
    buffer_load_dwordx4 a[64:67], v1, s[8:11], s80 offen offset:0
    v_mfma_f32_16x16x32_bf16 v[80:83], a[224:227], v[56:59], v[80:83]
    s_xor_b32 s80, s75, 20480
    ds_read_b64_tr_b16 v[48:49], v12 offset:32768
    v_cvt_pk_bf16_f32 v121, v122, v123
    v_mfma_f32_16x16x32_bf16 v[80:83], a[240:243], v[60:63], v[80:83]
    ds_read_b64_tr_b16 v[50:51], v12 offset:33792
    v_cvt_pk_bf16_f32 v122, v124, v125
    v_mfma_f32_16x16x32_bf16 v[84:87], a[228:231], v[56:59], v[84:87]
    ds_read_b64_tr_b16 v[52:53], v13 offset:32768
    v_cvt_pk_bf16_f32 v123, v126, v127
    v_mfma_f32_16x16x32_bf16 v[84:87], a[244:247], v[60:63], v[84:87]
    s_xor_b32 s79, s1, 45056
    ds_read_b64_tr_b16 v[54:55], v13 offset:33792
    v_mfma_f32_16x16x32_bf16 v[88:91], a[232:235], v[56:59], v[88:91]
    buffer_store_dwordx4 v[120:123], v1, s[8:11], s79 offen offset:1024 sc0 sc1
    v_mfma_f32_16x16x32_bf16 v[88:91], a[248:251], v[60:63], v[88:91]
    buffer_load_dwordx4 a[68:71], v1, s[8:11], s80 offen offset:0
    v_mfma_f32_16x16x32_bf16 v[92:95], a[236:239], v[56:59], v[92:95]
    v_mfma_f32_16x16x32_bf16 v[92:95], a[252:255], v[60:63], v[92:95]
    s_waitcnt vmcnt(28) lgkmcnt(5)
    v_mfma_f32_16x16x32_bf16 v[128:131], v[32:35], a[0:3], 0
    s_waitcnt vmcnt(25)
    s_xor_b32 s80, s76, 4096
    ds_read_b64_tr_b16 v[56:57], v14 offset:32768
    v_mfma_f32_16x16x32_bf16 v[160:163], v[32:35], a[4:7], 0
    s_waitcnt vmcnt(23)
    ds_read_b64_tr_b16 v[58:59], v14 offset:33792
    v_mfma_f32_16x16x32_bf16 v[192:195], v[32:35], a[8:11], 0
    s_waitcnt vmcnt(21)
    ds_read_b64_tr_b16 v[60:61], v15 offset:32768
    v_mfma_f32_16x16x32_bf16 v[224:227], v[32:35], a[12:15], 0
    ds_read_b64_tr_b16 v[62:63], v15 offset:33792
    v_mfma_f32_16x16x32_bf16 v[132:135], v[36:39], a[0:3], 0
    ds_read_b64_tr_b16 v[32:33], v8 offset:40960
    v_mfma_f32_16x16x32_bf16 v[164:167], v[36:39], a[4:7], 0
    ds_read_b64_tr_b16 v[34:35], v8 offset:41984
    v_mfma_f32_16x16x32_bf16 v[196:199], v[36:39], a[8:11], 0
    buffer_load_dwordx4 a[72:75], v1, s[8:11], s80 offen offset:0
    v_mfma_f32_16x16x32_bf16 v[228:231], v[36:39], a[12:15], 0
    v_mfma_f32_16x16x32_bf16 v[136:139], v[40:43], a[0:3], 0
    s_xor_b32 s80, s76, 20480
    ds_read_b64_tr_b16 v[36:37], v9 offset:40960
    v_cvt_pk_bf16_f32 v64, v64, v65
    v_mfma_f32_16x16x32_bf16 v[168:171], v[40:43], a[4:7], 0
    ds_read_b64_tr_b16 v[38:39], v9 offset:41984
    v_cvt_pk_bf16_f32 v65, v66, v67
    v_mfma_f32_16x16x32_bf16 v[200:203], v[40:43], a[8:11], 0
    s_waitcnt lgkmcnt(7)
    v_cvt_pk_bf16_f32 v66, v68, v69
    v_cvt_pk_bf16_f32 v67, v70, v71
    v_mfma_f32_16x16x32_bf16 v[232:235], v[40:43], a[12:15], 0
    buffer_load_dwordx4 a[76:79], v1, s[8:11], s80 offen offset:0
    v_mfma_f32_16x16x32_bf16 v[140:143], v[44:47], a[0:3], 0
    s_xor_b32 s79, s1, 36864
    ds_read_b64_tr_b16 v[40:41], v10 offset:40960
    v_mfma_f32_16x16x32_bf16 v[172:175], v[44:47], a[4:7], 0
    s_xor_b32 s80, s75, 4096
    ds_read_b64_tr_b16 v[42:43], v10 offset:41984
    v_mfma_f32_16x16x32_bf16 v[204:207], v[44:47], a[8:11], 0
    buffer_store_dwordx4 v[64:67], v1, s[8:11], s79 offen offset:2048 sc0 sc1
    v_mfma_f32_16x16x32_bf16 v[236:239], v[44:47], a[12:15], 0
    buffer_load_dwordx4 a[80:83], v1, s[8:11], s80 offen offset:1024
    v_mfma_f32_16x16x32_bf16 v[144:147], v[48:51], a[0:3], 0
    ds_read_b64_tr_b16 v[44:45], v11 offset:40960
    v_mfma_f32_16x16x32_bf16 v[176:179], v[48:51], a[4:7], 0
    ds_read_b64_tr_b16 v[46:47], v11 offset:41984
    v_mfma_f32_16x16x32_bf16 v[208:211], v[48:51], a[8:11], 0
    v_mfma_f32_16x16x32_bf16 v[240:243], v[48:51], a[12:15], 0
    v_mfma_f32_16x16x32_bf16 v[148:151], v[52:55], a[0:3], 0
    s_xor_b32 s80, s75, 20480
    ds_read_b64_tr_b16 v[48:49], v12 offset:40960
    v_mfma_f32_16x16x32_bf16 v[180:183], v[52:55], a[4:7], 0
    ds_read_b64_tr_b16 v[50:51], v12 offset:41984
    v_mfma_f32_16x16x32_bf16 v[212:215], v[52:55], a[8:11], 0
    buffer_load_dwordx4 a[84:87], v1, s[8:11], s80 offen offset:1024
    v_mfma_f32_16x16x32_bf16 v[244:247], v[52:55], a[12:15], 0
    s_waitcnt lgkmcnt(4)
    v_mfma_f32_16x16x32_bf16 v[152:155], v[56:59], a[0:3], 0
    ds_read_b64_tr_b16 v[52:53], v13 offset:40960
    v_cvt_pk_bf16_f32 v72, v72, v73
    v_mfma_f32_16x16x32_bf16 v[184:187], v[56:59], a[4:7], 0
    ds_read_b64_tr_b16 v[54:55], v13 offset:41984
    v_cvt_pk_bf16_f32 v73, v74, v75
    v_mfma_f32_16x16x32_bf16 v[216:219], v[56:59], a[8:11], 0
    v_cvt_pk_bf16_f32 v74, v76, v77
    v_cvt_pk_bf16_f32 v75, v78, v79
    v_mfma_f32_16x16x32_bf16 v[248:251], v[56:59], a[12:15], 0
    v_mfma_f32_16x16x32_bf16 v[156:159], v[60:63], a[0:3], 0
    s_xor_b32 s79, s1, 45056
    s_xor_b32 s80, s76, 4096
    ds_read_b64_tr_b16 v[56:57], v14 offset:40960
    v_mfma_f32_16x16x32_bf16 v[188:191], v[60:63], a[4:7], 0
    s_waitcnt vmcnt(23)
    ds_read_b64_tr_b16 v[58:59], v14 offset:41984
    v_mfma_f32_16x16x32_bf16 v[220:223], v[60:63], a[8:11], 0
    buffer_store_dwordx4 v[72:75], v1, s[8:11], s79 offen offset:2048 sc0 sc1
    v_mfma_f32_16x16x32_bf16 v[252:255], v[60:63], a[12:15], 0
    buffer_load_dwordx4 a[88:91], v1, s[8:11], s80 offen offset:1024
    v_mfma_f32_16x16x32_bf16 v[128:131], v[32:35], a[16:19], v[128:131]
    s_waitcnt vmcnt(23)
    ds_read_b64_tr_b16 v[60:61], v15 offset:40960
    v_mfma_f32_16x16x32_bf16 v[160:163], v[32:35], a[20:23], v[160:163]
    s_waitcnt vmcnt(22)
    ds_read_b64_tr_b16 v[62:63], v15 offset:41984
    v_mfma_f32_16x16x32_bf16 v[192:195], v[32:35], a[24:27], v[192:195]
    s_waitcnt vmcnt(21)
    v_mfma_f32_16x16x32_bf16 v[224:227], v[32:35], a[28:31], v[224:227]
    v_mfma_f32_16x16x32_bf16 v[132:135], v[36:39], a[16:19], v[132:135]
    s_xor_b32 s80, s76, 20480
    ds_read_b64_tr_b16 v[32:33], v8 offset:0
    v_mfma_f32_16x16x32_bf16 v[164:167], v[36:39], a[20:23], v[164:167]
    ds_read_b64_tr_b16 v[34:35], v8 offset:1024
    v_mfma_f32_16x16x32_bf16 v[196:199], v[36:39], a[24:27], v[196:199]
    buffer_load_dwordx4 a[92:95], v1, s[8:11], s80 offen offset:1024
    v_mfma_f32_16x16x32_bf16 v[228:231], v[36:39], a[28:31], v[228:231]
    v_mfma_f32_16x16x32_bf16 v[136:139], v[40:43], a[16:19], v[136:139]
    ds_read_b64_tr_b16 v[36:37], v9 offset:0
    v_cvt_pk_bf16_f32 v80, v80, v81
    v_mfma_f32_16x16x32_bf16 v[168:171], v[40:43], a[20:23], v[168:171]
    s_xor_b32 s80, s75, 6144
    ds_read_b64_tr_b16 v[38:39], v9 offset:1024
    v_cvt_pk_bf16_f32 v81, v82, v83
    v_mfma_f32_16x16x32_bf16 v[200:203], v[40:43], a[24:27], v[200:203]
    s_waitcnt lgkmcnt(5)
    v_cvt_pk_bf16_f32 v82, v84, v85
    v_cvt_pk_bf16_f32 v83, v86, v87
    v_mfma_f32_16x16x32_bf16 v[232:235], v[40:43], a[28:31], v[232:235]
    buffer_load_dwordx4 a[96:99], v1, s[8:11], s80 offen offset:0
    v_mfma_f32_16x16x32_bf16 v[140:143], v[44:47], a[16:19], v[140:143]
    s_xor_b32 s79, s1, 36864
    ds_read_b64_tr_b16 v[40:41], v10 offset:0
    v_mfma_f32_16x16x32_bf16 v[172:175], v[44:47], a[20:23], v[172:175]
    ds_read_b64_tr_b16 v[42:43], v10 offset:1024
    v_mfma_f32_16x16x32_bf16 v[204:207], v[44:47], a[24:27], v[204:207]
    buffer_store_dwordx4 v[80:83], v1, s[8:11], s79 offen offset:3072 sc0 sc1
    v_mfma_f32_16x16x32_bf16 v[236:239], v[44:47], a[28:31], v[236:239]
    v_mfma_f32_16x16x32_bf16 v[144:147], v[48:51], a[16:19], v[144:147]
    s_xor_b32 s80, s75, 22528
    ds_read_b64_tr_b16 v[44:45], v11 offset:0
    v_mfma_f32_16x16x32_bf16 v[176:179], v[48:51], a[20:23], v[176:179]
    ds_read_b64_tr_b16 v[46:47], v11 offset:1024
    v_mfma_f32_16x16x32_bf16 v[208:211], v[48:51], a[24:27], v[208:211]
    buffer_load_dwordx4 a[100:103], v1, s[8:11], s80 offen offset:0
    v_mfma_f32_16x16x32_bf16 v[240:243], v[48:51], a[28:31], v[240:243]
    v_mfma_f32_16x16x32_bf16 v[148:151], v[52:55], a[16:19], v[148:151]
    ds_read_b64_tr_b16 v[48:49], v12 offset:0
    v_mfma_f32_16x16x32_bf16 v[180:183], v[52:55], a[20:23], v[180:183]
    ds_read_b64_tr_b16 v[50:51], v12 offset:1024
    v_mfma_f32_16x16x32_bf16 v[212:215], v[52:55], a[24:27], v[212:215]
    v_mfma_f32_16x16x32_bf16 v[244:247], v[52:55], a[28:31], v[244:247]
    v_mfma_f32_16x16x32_bf16 v[152:155], v[56:59], a[16:19], v[152:155]
    s_xor_b32 s80, s76, 6144
    ds_read_b64_tr_b16 v[52:53], v13 offset:0
    v_cvt_pk_bf16_f32 v88, v88, v89
    v_mfma_f32_16x16x32_bf16 v[184:187], v[56:59], a[20:23], v[184:187]
    ds_read_b64_tr_b16 v[54:55], v13 offset:1024
    v_cvt_pk_bf16_f32 v89, v90, v91
    v_mfma_f32_16x16x32_bf16 v[216:219], v[56:59], a[24:27], v[216:219]
    s_waitcnt lgkmcnt(5)
    v_cvt_pk_bf16_f32 v90, v92, v93
    v_cvt_pk_bf16_f32 v91, v94, v95
    v_mfma_f32_16x16x32_bf16 v[248:251], v[56:59], a[28:31], v[248:251]
    buffer_load_dwordx4 a[104:107], v1, s[8:11], s80 offen offset:0
    v_mfma_f32_16x16x32_bf16 v[156:159], v[60:63], a[16:19], v[156:159]
    s_xor_b32 s79, s1, 45056
    ds_read_b64_tr_b16 v[56:57], v14 offset:0
    v_mfma_f32_16x16x32_bf16 v[188:191], v[60:63], a[20:23], v[188:191]
    ds_read_b64_tr_b16 v[58:59], v14 offset:1024
    v_mfma_f32_16x16x32_bf16 v[220:223], v[60:63], a[24:27], v[220:223]
    buffer_store_dwordx4 v[88:91], v1, s[8:11], s79 offen offset:3072 sc0 sc1
    v_mfma_f32_16x16x32_bf16 v[252:255], v[60:63], a[28:31], v[252:255]
    s_waitcnt vmcnt(26)
    v_mfma_f32_16x16x32_bf16 v[128:131], v[32:35], a[32:35], v[128:131]
    s_waitcnt vmcnt(25)
    s_xor_b32 s80, s76, 22528
    ds_read_b64_tr_b16 v[60:61], v15 offset:0
    v_mfma_f32_16x16x32_bf16 v[160:163], v[32:35], a[36:39], v[160:163]
    s_waitcnt vmcnt(22)
    ds_read_b64_tr_b16 v[62:63], v15 offset:1024
    v_mfma_f32_16x16x32_bf16 v[192:195], v[32:35], a[40:43], v[192:195]
    buffer_load_dwordx4 a[108:111], v1, s[8:11], s80 offen offset:0
    v_mfma_f32_16x16x32_bf16 v[224:227], v[32:35], a[44:47], v[224:227]
    v_mfma_f32_16x16x32_bf16 v[132:135], v[36:39], a[32:35], v[132:135]
    ds_read_b64_tr_b16 v[32:33], v8 offset:8192
    v_mfma_f32_16x16x32_bf16 v[164:167], v[36:39], a[36:39], v[164:167]
    s_xor_b32 s80, s75, 6144
    ds_read_b64_tr_b16 v[34:35], v8 offset:9216
    v_mfma_f32_16x16x32_bf16 v[196:199], v[36:39], a[40:43], v[196:199]
    buffer_load_dwordx4 a[112:115], v1, s[8:11], s80 offen offset:1024
    v_mfma_f32_16x16x32_bf16 v[228:231], v[36:39], a[44:47], v[228:231]
    v_mfma_f32_16x16x32_bf16 v[136:139], v[40:43], a[32:35], v[136:139]
    ds_read_b64_tr_b16 v[36:37], v9 offset:8192
    v_mfma_f32_16x16x32_bf16 v[168:171], v[40:43], a[36:39], v[168:171]
    ds_read_b64_tr_b16 v[38:39], v9 offset:9216
    v_mfma_f32_16x16x32_bf16 v[200:203], v[40:43], a[40:43], v[200:203]
    v_mfma_f32_16x16x32_bf16 v[232:235], v[40:43], a[44:47], v[232:235]
    s_waitcnt lgkmcnt(4)
    v_mfma_f32_16x16x32_bf16 v[140:143], v[44:47], a[32:35], v[140:143]
    s_xor_b32 s80, s75, 22528
    ds_read_b64_tr_b16 v[40:41], v10 offset:8192
    v_mfma_f32_16x16x32_bf16 v[172:175], v[44:47], a[36:39], v[172:175]
    ds_read_b64_tr_b16 v[42:43], v10 offset:9216
    v_mfma_f32_16x16x32_bf16 v[204:207], v[44:47], a[40:43], v[204:207]
    buffer_load_dwordx4 a[116:119], v1, s[8:11], s80 offen offset:1024
    v_mfma_f32_16x16x32_bf16 v[236:239], v[44:47], a[44:47], v[236:239]
    v_mfma_f32_16x16x32_bf16 v[144:147], v[48:51], a[32:35], v[144:147]
    ds_read_b64_tr_b16 v[44:45], v11 offset:8192
    v_mfma_f32_16x16x32_bf16 v[176:179], v[48:51], a[36:39], v[176:179]
    ds_read_b64_tr_b16 v[46:47], v11 offset:9216
    v_mfma_f32_16x16x32_bf16 v[208:211], v[48:51], a[40:43], v[208:211]
    v_mfma_f32_16x16x32_bf16 v[240:243], v[48:51], a[44:47], v[240:243]
    v_mfma_f32_16x16x32_bf16 v[148:151], v[52:55], a[32:35], v[148:151]
    s_xor_b32 s80, s76, 6144
    ds_read_b64_tr_b16 v[48:49], v12 offset:8192
    v_mfma_f32_16x16x32_bf16 v[180:183], v[52:55], a[36:39], v[180:183]
    ds_read_b64_tr_b16 v[50:51], v12 offset:9216
    v_mfma_f32_16x16x32_bf16 v[212:215], v[52:55], a[40:43], v[212:215]
    buffer_load_dwordx4 a[120:123], v1, s[8:11], s80 offen offset:1024
    v_mfma_f32_16x16x32_bf16 v[244:247], v[52:55], a[44:47], v[244:247]
    v_mfma_f32_16x16x32_bf16 v[152:155], v[56:59], a[32:35], v[152:155]
    ds_read_b64_tr_b16 v[52:53], v13 offset:8192
    v_mfma_f32_16x16x32_bf16 v[184:187], v[56:59], a[36:39], v[184:187]
    ds_read_b64_tr_b16 v[54:55], v13 offset:9216
    v_mfma_f32_16x16x32_bf16 v[216:219], v[56:59], a[40:43], v[216:219]
    v_mfma_f32_16x16x32_bf16 v[248:251], v[56:59], a[44:47], v[248:251]
    v_mfma_f32_16x16x32_bf16 v[156:159], v[60:63], a[32:35], v[156:159]
    s_xor_b32 s80, s76, 22528
    ds_read_b64_tr_b16 v[56:57], v14 offset:8192
    v_mfma_f32_16x16x32_bf16 v[188:191], v[60:63], a[36:39], v[188:191]
    ds_read_b64_tr_b16 v[58:59], v14 offset:9216
    v_mfma_f32_16x16x32_bf16 v[220:223], v[60:63], a[40:43], v[220:223]
    buffer_load_dwordx4 a[124:127], v1, s[8:11], s80 offen offset:1024
    v_mfma_f32_16x16x32_bf16 v[252:255], v[60:63], a[44:47], v[252:255]
    s_waitcnt vmcnt(26) lgkmcnt(4)
    v_mfma_f32_16x16x32_bf16 v[128:131], v[32:35], a[48:51], v[128:131]
    s_waitcnt vmcnt(24)
    ds_read_b64_tr_b16 v[60:61], v15 offset:8192
    v_mfma_f32_16x16x32_bf16 v[160:163], v[32:35], a[52:55], v[160:163]
    s_waitcnt vmcnt(21)
    s_xor_b32 s80, s75, 8192
    ds_read_b64_tr_b16 v[62:63], v15 offset:9216
    v_mfma_f32_16x16x32_bf16 v[192:195], v[32:35], a[56:59], v[192:195]
    buffer_load_dwordx4 a[128:131], v1, s[8:11], s80 offen offset:0
    v_mfma_f32_16x16x32_bf16 v[224:227], v[32:35], a[60:63], v[224:227]
    v_mfma_f32_16x16x32_bf16 v[132:135], v[36:39], a[48:51], v[132:135]
    ds_read_b64_tr_b16 v[32:33], v8 offset:16384
    v_mfma_f32_16x16x32_bf16 v[164:167], v[36:39], a[52:55], v[164:167]
    ds_read_b64_tr_b16 v[34:35], v8 offset:17408
    v_mfma_f32_16x16x32_bf16 v[196:199], v[36:39], a[56:59], v[196:199]
    v_mfma_f32_16x16x32_bf16 v[228:231], v[36:39], a[60:63], v[228:231]
    v_mfma_f32_16x16x32_bf16 v[136:139], v[40:43], a[48:51], v[136:139]
    s_xor_b32 s80, s75, 24576
    ds_read_b64_tr_b16 v[36:37], v9 offset:16384
    v_mfma_f32_16x16x32_bf16 v[168:171], v[40:43], a[52:55], v[168:171]
    ds_read_b64_tr_b16 v[38:39], v9 offset:17408
    v_mfma_f32_16x16x32_bf16 v[200:203], v[40:43], a[56:59], v[200:203]
    buffer_load_dwordx4 a[132:135], v1, s[8:11], s80 offen offset:0
    v_mfma_f32_16x16x32_bf16 v[232:235], v[40:43], a[60:63], v[232:235]
    v_mfma_f32_16x16x32_bf16 v[140:143], v[44:47], a[48:51], v[140:143]
    ds_read_b64_tr_b16 v[40:41], v10 offset:16384
    v_mfma_f32_16x16x32_bf16 v[172:175], v[44:47], a[52:55], v[172:175]
    ds_read_b64_tr_b16 v[42:43], v10 offset:17408
    v_mfma_f32_16x16x32_bf16 v[204:207], v[44:47], a[56:59], v[204:207]
    v_mfma_f32_16x16x32_bf16 v[236:239], v[44:47], a[60:63], v[236:239]
    v_mfma_f32_16x16x32_bf16 v[144:147], v[48:51], a[48:51], v[144:147]
    s_xor_b32 s80, s76, 8192
    ds_read_b64_tr_b16 v[44:45], v11 offset:16384
    v_mfma_f32_16x16x32_bf16 v[176:179], v[48:51], a[52:55], v[176:179]
    ds_read_b64_tr_b16 v[46:47], v11 offset:17408
    v_mfma_f32_16x16x32_bf16 v[208:211], v[48:51], a[56:59], v[208:211]
    buffer_load_dwordx4 a[136:139], v1, s[8:11], s80 offen offset:0
    v_mfma_f32_16x16x32_bf16 v[240:243], v[48:51], a[60:63], v[240:243]
    s_waitcnt lgkmcnt(4)
    v_mfma_f32_16x16x32_bf16 v[148:151], v[52:55], a[48:51], v[148:151]
    ds_read_b64_tr_b16 v[48:49], v12 offset:16384
    v_mfma_f32_16x16x32_bf16 v[180:183], v[52:55], a[52:55], v[180:183]
    ds_read_b64_tr_b16 v[50:51], v12 offset:17408
    v_mfma_f32_16x16x32_bf16 v[212:215], v[52:55], a[56:59], v[212:215]
    v_mfma_f32_16x16x32_bf16 v[244:247], v[52:55], a[60:63], v[244:247]
    v_mfma_f32_16x16x32_bf16 v[152:155], v[56:59], a[48:51], v[152:155]
    s_xor_b32 s80, s76, 24576
    ds_read_b64_tr_b16 v[52:53], v13 offset:16384
    v_mfma_f32_16x16x32_bf16 v[184:187], v[56:59], a[52:55], v[184:187]
    ds_read_b64_tr_b16 v[54:55], v13 offset:17408
    v_mfma_f32_16x16x32_bf16 v[216:219], v[56:59], a[56:59], v[216:219]
    buffer_load_dwordx4 a[140:143], v1, s[8:11], s80 offen offset:0
    s_waitcnt vmcnt(9)
    v_mfma_f32_16x16x32_bf16 v[248:251], v[56:59], a[60:63], v[248:251]
    buffer_store_dword v6, v5, s[8:11], s73 offen sc0 sc1
    v_mfma_f32_16x16x32_bf16 v[156:159], v[60:63], a[48:51], v[156:159]
    ds_read_b64_tr_b16 v[56:57], v14 offset:16384
    v_mfma_f32_16x16x32_bf16 v[188:191], v[60:63], a[52:55], v[188:191]
    s_xor_b32 s80, s75, 8192
    ds_read_b64_tr_b16 v[58:59], v14 offset:17408
    v_mfma_f32_16x16x32_bf16 v[220:223], v[60:63], a[56:59], v[220:223]
    buffer_load_dwordx4 a[144:147], v1, s[8:11], s80 offen offset:1024
    v_mfma_f32_16x16x32_bf16 v[252:255], v[60:63], a[60:63], v[252:255]
    v_mfma_f32_16x16x32_bf16 v[128:131], v[32:35], a[64:67], v[128:131]
    ds_read_b64_tr_b16 v[60:61], v15 offset:16384
    v_mfma_f32_16x16x32_bf16 v[160:163], v[32:35], a[68:71], v[160:163]
    ds_read_b64_tr_b16 v[62:63], v15 offset:17408
    v_mfma_f32_16x16x32_bf16 v[192:195], v[32:35], a[72:75], v[192:195]
    v_mfma_f32_16x16x32_bf16 v[224:227], v[32:35], a[76:79], v[224:227]
    v_mfma_f32_16x16x32_bf16 v[132:135], v[36:39], a[64:67], v[132:135]
    s_xor_b32 s80, s75, 24576
    ds_read_b64_tr_b16 v[32:33], v8 offset:24576
    v_mfma_f32_16x16x32_bf16 v[164:167], v[36:39], a[68:71], v[164:167]
    ds_read_b64_tr_b16 v[34:35], v8 offset:25600
    v_mfma_f32_16x16x32_bf16 v[196:199], v[36:39], a[72:75], v[196:199]
    buffer_load_dwordx4 a[148:151], v1, s[8:11], s80 offen offset:1024
    v_mfma_f32_16x16x32_bf16 v[228:231], v[36:39], a[76:79], v[228:231]
    s_waitcnt lgkmcnt(4)
    v_mfma_f32_16x16x32_bf16 v[136:139], v[40:43], a[64:67], v[136:139]
    ds_read_b64_tr_b16 v[36:37], v9 offset:24576
    v_mfma_f32_16x16x32_bf16 v[168:171], v[40:43], a[68:71], v[168:171]
    ds_read_b64_tr_b16 v[38:39], v9 offset:25600
    v_mfma_f32_16x16x32_bf16 v[200:203], v[40:43], a[72:75], v[200:203]
    v_mfma_f32_16x16x32_bf16 v[232:235], v[40:43], a[76:79], v[232:235]
    v_mfma_f32_16x16x32_bf16 v[140:143], v[44:47], a[64:67], v[140:143]
    s_xor_b32 s80, s76, 8192
    ds_read_b64_tr_b16 v[40:41], v10 offset:24576
    v_mfma_f32_16x16x32_bf16 v[172:175], v[44:47], a[68:71], v[172:175]
    ds_read_b64_tr_b16 v[42:43], v10 offset:25600
    v_mfma_f32_16x16x32_bf16 v[204:207], v[44:47], a[72:75], v[204:207]
    buffer_load_dwordx4 a[152:155], v1, s[8:11], s80 offen offset:1024
    v_mfma_f32_16x16x32_bf16 v[236:239], v[44:47], a[76:79], v[236:239]
    v_mfma_f32_16x16x32_bf16 v[144:147], v[48:51], a[64:67], v[144:147]
    ds_read_b64_tr_b16 v[44:45], v11 offset:24576
    v_mfma_f32_16x16x32_bf16 v[176:179], v[48:51], a[68:71], v[176:179]
    ds_read_b64_tr_b16 v[46:47], v11 offset:25600
    v_mfma_f32_16x16x32_bf16 v[208:211], v[48:51], a[72:75], v[208:211]
    v_mfma_f32_16x16x32_bf16 v[240:243], v[48:51], a[76:79], v[240:243]
    v_mfma_f32_16x16x32_bf16 v[148:151], v[52:55], a[64:67], v[148:151]
    s_xor_b32 s80, s76, 24576
    ds_read_b64_tr_b16 v[48:49], v12 offset:24576
    v_mfma_f32_16x16x32_bf16 v[180:183], v[52:55], a[68:71], v[180:183]
    ds_read_b64_tr_b16 v[50:51], v12 offset:25600
    v_mfma_f32_16x16x32_bf16 v[212:215], v[52:55], a[72:75], v[212:215]
    buffer_load_dwordx4 a[156:159], v1, s[8:11], s80 offen offset:1024
    v_mfma_f32_16x16x32_bf16 v[244:247], v[52:55], a[76:79], v[244:247]
    v_mfma_f32_16x16x32_bf16 v[152:155], v[56:59], a[64:67], v[152:155]
    ds_read_b64_tr_b16 v[52:53], v13 offset:24576
    v_lshlrev_b32 v116, 2, v0
    v_mfma_f32_16x16x32_bf16 v[184:187], v[56:59], a[68:71], v[184:187]
    s_xor_b32 s80, s75, 10240
    ds_read_b64_tr_b16 v[54:55], v13 offset:25600
    v_cmp_gt_u32 vcc, 8, v0
    v_mfma_f32_16x16x32_bf16 v[216:219], v[56:59], a[72:75], v[216:219]
    buffer_load_dwordx4 a[160:163], v1, s[8:11], s80 offen offset:0
    v_mfma_f32_16x16x32_bf16 v[248:251], v[56:59], a[76:79], v[248:251]
    s_waitcnt lgkmcnt(4)
    v_mov_b32 v117, 2147479552
    v_cndmask_b32 v116, v117, v116, vcc
    v_mfma_f32_16x16x32_bf16 v[156:159], v[60:63], a[64:67], v[156:159]
    s_lshl_b32 s70, s2, 5
    s_add_u32 s70, s70, 20480
    ds_read_b64_tr_b16 v[56:57], v14 offset:24576
    v_mfma_f32_16x16x32_bf16 v[188:191], v[60:63], a[68:71], v[188:191]
    ds_read_b64_tr_b16 v[58:59], v14 offset:25600
    v_and_b32 v119, 3, v2
    v_mfma_f32_16x16x32_bf16 v[220:223], v[60:63], a[72:75], v[220:223]
    v_lshlrev_b32 v119, 9, v119
    v_mfma_f32_16x16x32_bf16 v[252:255], v[60:63], a[76:79], v[252:255]
    v_mfma_f32_16x16x32_bf16 v[128:131], v[32:35], a[80:83], v[128:131]
    s_xor_b32 s80, s75, 26624
    s_lshr_b32 s69, s2, 6
    ds_read_b64_tr_b16 v[60:61], v15 offset:24576
    v_mfma_f32_16x16x32_bf16 v[160:163], v[32:35], a[84:87], v[160:163]
    s_add_u32 s69, s69, 4
    s_lshl_b32 s69, s69, 5
    ds_read_b64_tr_b16 v[62:63], v15 offset:25600
    v_mfma_f32_16x16x32_bf16 v[192:195], v[32:35], a[88:91], v[192:195]
    buffer_load_dwordx4 a[164:167], v1, s[8:11], s80 offen offset:0
    v_mfma_f32_16x16x32_bf16 v[224:227], v[32:35], a[92:95], v[224:227]
    s_bfe_u32 s68, s2, 196611
    s_add_u32 s69, s69, s68
    s_lshl_b32 s69, s69, 6
    v_mfma_f32_16x16x32_bf16 v[132:135], v[36:39], a[80:83], v[132:135]
    s_add_u32 s69, s69, 1310720
    s_and_b32 s100, s3, 1
    ds_read_b64_tr_b16 v[32:33], v8 offset:49152
    v_mfma_f32_16x16x32_bf16 v[164:167], v[36:39], a[84:87], v[164:167]
    s_lshr_b32 s101, s3, 1
    s_lshl_b32 s19, s100, 13
    ds_read_b64_tr_b16 v[34:35], v8 offset:50176
    v_mfma_f32_16x16x32_bf16 v[196:199], v[36:39], a[88:91], v[196:199]
    buffer_load_dword v118, v119, s[8:11], s69 offen sc0 sc1
    v_mfma_f32_16x16x32_bf16 v[228:231], v[36:39], a[92:95], v[228:231]
    s_add_u32 s19, s19, 65536
    v_add_u32 v18, s19, v1
    v_mfma_f32_16x16x32_bf16 v[136:139], v[40:43], a[80:83], v[136:139]
    s_xor_b32 s80, s76, 10240
    s_mul_i32 s19, s100, 12288
    ds_read_b64_tr_b16 v[36:37], v9 offset:49152
    v_mfma_f32_16x16x32_bf16 v[168:171], v[40:43], a[84:87], v[168:171]
    s_add_u32 s19, s19, 98304
    ds_read_b64_tr_b16 v[38:39], v9 offset:50176
    v_add_u32 v19, s19, v1
    v_mfma_f32_16x16x32_bf16 v[200:203], v[40:43], a[88:91], v[200:203]
    buffer_load_dwordx4 a[168:171], v1, s[8:11], s80 offen offset:0
    v_mfma_f32_16x16x32_bf16 v[232:235], v[40:43], a[92:95], v[232:235]
    v_mfma_f32_16x16x32_bf16 v[140:143], v[44:47], a[80:83], v[140:143]
    s_lshl_b32 s19, s100, 12
    s_add_u32 s19, s19, 98304
    ds_read_b64_tr_b16 v[40:41], v10 offset:49152
    v_mfma_f32_16x16x32_bf16 v[172:175], v[44:47], a[84:87], v[172:175]
    ds_read_b64_tr_b16 v[42:43], v10 offset:50176
    v_add_u32 v20, s19, v1
    v_mfma_f32_16x16x32_bf16 v[204:207], v[44:47], a[88:91], v[204:207]
    v_and_b32 v23, 15, v2
    v_lshrrev_b32 v24, 4, v2
    v_mfma_f32_16x16x32_bf16 v[236:239], v[44:47], a[92:95], v[236:239]
    s_waitcnt lgkmcnt(4)
    v_mfma_f32_16x16x32_bf16 v[144:147], v[48:51], a[80:83], v[144:147]
    s_xor_b32 s80, s76, 26624
    ds_read_b64_tr_b16 v[44:45], v11 offset:49152
    v_lshlrev_b32 v25, 2, v24
    v_mfma_f32_16x16x32_bf16 v[176:179], v[48:51], a[84:87], v[176:179]
    ds_read_b64_tr_b16 v[46:47], v11 offset:50176
    v_sub_u32 v25, v23, v25
    v_mfma_f32_16x16x32_bf16 v[208:211], v[48:51], a[88:91], v[208:211]
    buffer_load_dwordx4 a[172:175], v1, s[8:11], s80 offen offset:0
    v_mfma_f32_16x16x32_bf16 v[240:243], v[48:51], a[92:95], v[240:243]
    v_mfma_f32_16x16x32_bf16 v[148:151], v[52:55], a[80:83], v[148:151]
    s_sub_i32 s19, s101, s100
    s_lshl_b32 s19, s19, 5
    ds_read_b64_tr_b16 v[48:49], v12 offset:49152
    v_mfma_f32_16x16x32_bf16 v[180:183], v[52:55], a[84:87], v[180:183]
    s_xor_b32 s80, s75, 10240
    ds_read_b64_tr_b16 v[50:51], v12 offset:50176
    v_add_u32 v21, s19, v25
    v_mfma_f32_16x16x32_bf16 v[212:215], v[52:55], a[88:91], v[212:215]
    buffer_load_dwordx4 a[176:179], v1, s[8:11], s80 offen offset:1024
    v_mfma_f32_16x16x32_bf16 v[244:247], v[52:55], a[92:95], v[244:247]
    v_mfma_f32_16x16x32_bf16 v[152:155], v[56:59], a[80:83], v[152:155]
    s_add_u32 s19, s101, s100
    s_sub_i32 s19, 1, s19
    ds_read_b64_tr_b16 v[52:53], v13 offset:49152
    v_mfma_f32_16x16x32_bf16 v[184:187], v[56:59], a[84:87], v[184:187]
    s_lshl_b32 s19, s19, 5
    ds_read_b64_tr_b16 v[54:55], v13 offset:50176
    v_add_u32 v22, s19, v25
    v_mfma_f32_16x16x32_bf16 v[216:219], v[56:59], a[88:91], v[216:219]
    v_cvt_f32_i32 v21, v21
    v_cvt_f32_i32 v22, v22
    v_mfma_f32_16x16x32_bf16 v[248:251], v[56:59], a[92:95], v[248:251]
    v_mfma_f32_16x16x32_bf16 v[156:159], v[60:63], a[80:83], v[156:159]
    s_xor_b32 s80, s75, 26624
    ds_read_b64_tr_b16 v[56:57], v14 offset:49152
    v_add_f32 v21, 0.5, v21
    v_mfma_f32_16x16x32_bf16 v[188:191], v[60:63], a[84:87], v[188:191]
    ds_read_b64_tr_b16 v[58:59], v14 offset:50176
    v_add_f32 v22, 0.5, v22
    v_mfma_f32_16x16x32_bf16 v[220:223], v[60:63], a[88:91], v[220:223]
    buffer_load_dwordx4 a[180:183], v1, s[8:11], s80 offen offset:1024
    v_mfma_f32_16x16x32_bf16 v[252:255], v[60:63], a[92:95], v[252:255]
    v_mul_f32 v21, 0x71800000, v21
    v_mul_f32 v22, 0x71800000, v22
    v_mfma_f32_16x16x32_bf16 v[128:131], v[32:35], a[96:99], v[128:131]
    ds_read_b64_tr_b16 v[60:61], v15 offset:49152
    v_lshrrev_b32 v25, 2, v23
    v_mfma_f32_16x16x32_bf16 v[160:163], v[32:35], a[100:103], v[160:163]
    ds_read_b64_tr_b16 v[62:63], v15 offset:50176
    v_and_b32 v23, 3, v23
    v_mfma_f32_16x16x32_bf16 v[192:195], v[32:35], a[104:107], v[192:195]
    s_waitcnt vmcnt(20)
    v_lshlrev_b32 v23, 6, v23
    v_lshl_add_u32 v23, v25, 15, v23
    v_mfma_f32_16x16x32_bf16 v[224:227], v[32:35], a[108:111], v[224:227]
    s_waitcnt lgkmcnt(4)
    v_mfma_f32_16x16x32_bf16 v[132:135], v[36:39], a[96:99], v[132:135]
    s_xor_b32 s80, s76, 10240
    ds_read_b64_tr_b16 v[32:33], v8 offset:57344
    v_lshl_add_u32 v23, v24, 4, v23
    v_mfma_f32_16x16x32_bf16 v[164:167], v[36:39], a[100:103], v[164:167]
    s_lshl_b32 s18, s6, 20
    s_lshl_b32 s19, s3, 18
    ds_read_b64_tr_b16 v[34:35], v8 offset:58368
    v_mfma_f32_16x16x32_bf16 v[196:199], v[36:39], a[104:107], v[196:199]
    buffer_load_dwordx4 a[184:187], v1, s[8:11], s80 offen offset:1024
    v_mfma_f32_16x16x32_bf16 v[228:231], v[36:39], a[108:111], v[228:231]
    s_add_u32 s18, s18, s19
    s_lshl_b32 s19, s7, 10
    s_add_u32 s18, s18, s19
    v_mfma_f32_16x16x32_bf16 v[136:139], v[40:43], a[96:99], v[136:139]
    s_add_u32 s18, s18, 67108864
    s_mov_b32 s13, s60
    ds_read_b64_tr_b16 v[36:37], v9 offset:57344
    v_mfma_f32_16x16x32_bf16 v[168:171], v[40:43], a[100:103], v[168:171]
    s_mov_b32 s12, 2
    s_mov_b32 s25, 0
    ds_read_b64_tr_b16 v[38:39], v9 offset:58368
    v_mfma_f32_16x16x32_bf16 v[200:203], v[40:43], a[104:107], v[200:203]
    s_mov_b32 s26, 28
    s_mov_b32 s64, 128
    s_lshl_b32 s65, s5, 1
    v_mfma_f32_16x16x32_bf16 v[232:235], v[40:43], a[108:111], v[232:235]
    v_mfma_f32_16x16x32_bf16 v[140:143], v[44:47], a[96:99], v[140:143]
    s_xor_b32 s80, s76, 26624
    s_and_b32 s65, s65, 7
    ds_read_b64_tr_b16 v[40:41], v10 offset:57344
    v_mfma_f32_16x16x32_bf16 v[172:175], v[44:47], a[100:103], v[172:175]
    s_xor_b32 s65, s65, s3
    s_lshl_b32 s65, s65, 16
    ds_read_b64_tr_b16 v[42:43], v10 offset:58368
    v_mfma_f32_16x16x32_bf16 v[204:207], v[44:47], a[104:107], v[204:207]
    buffer_load_dwordx4 a[188:191], v1, s[8:11], s80 offen offset:1024
    v_mfma_f32_16x16x32_bf16 v[236:239], v[44:47], a[108:111], v[236:239]
    s_add_u32 s15, s62, 65536
    s_add_u32 s16, s62, 0
    s_lshl_b32 s20, s7, 13
    v_mfma_f32_16x16x32_bf16 v[144:147], v[48:51], a[96:99], v[144:147]
    s_lshl_b32 s19, s100, 11
    s_add_u32 s20, s20, s19
    ds_read_b64_tr_b16 v[44:45], v11 offset:57344
    v_mfma_f32_16x16x32_bf16 v[176:179], v[48:51], a[100:103], v[176:179]
    s_xor_b32 s80, s75, 12288
    s_add_u32 s20, s20, 50331648
    ds_read_b64_tr_b16 v[46:47], v11 offset:58368
    v_mfma_f32_16x16x32_bf16 v[208:211], v[48:51], a[104:107], v[208:211]
    buffer_load_dwordx4 a[192:195], v1, s[8:11], s80 offen offset:0
    v_mfma_f32_16x16x32_bf16 v[240:243], v[48:51], a[108:111], v[240:243]
    s_sub_u32 s19, 3, s101
    s_lshl_b32 s19, s19, 18
    s_add_u32 s21, s20, s19
    v_mfma_f32_16x16x32_bf16 v[148:151], v[52:55], a[96:99], v[148:151]
    s_lshl_b32 s19, s101, 18
    s_add_u32 s20, s20, s19
    ds_read_b64_tr_b16 v[48:49], v12 offset:57344
    v_mfma_f32_16x16x32_bf16 v[180:183], v[52:55], a[100:103], v[180:183]
    s_add_u32 s22, s72, 131072
    s_and_b32 s23, s2, 231
    ds_read_b64_tr_b16 v[50:51], v12 offset:58368
    v_mfma_f32_16x16x32_bf16 v[212:215], v[52:55], a[104:107], v[212:215]
    s_lshl_b32 s23, s23, 8
    s_sub_u32 s19, 3, s3
    s_min_u32 s19, s19, s3
    v_mfma_f32_16x16x32_bf16 v[244:247], v[52:55], a[108:111], v[244:247]
    s_waitcnt lgkmcnt(4)
    v_mfma_f32_16x16x32_bf16 v[152:155], v[56:59], a[96:99], v[152:155]
    s_xor_b32 s80, s75, 28672
    s_lshl_b32 s19, s19, 7
    ds_read_b64_tr_b16 v[52:53], v13 offset:57344
    s_waitcnt vmcnt(7)
    v_cmp_ne_u32 vcc, 0, v118
    s_cmp_eq_u64 vcc, -1
    s_cbranch_scc0 L_E2_slow_5
L_E2_ok_6:
    v_mfma_f32_16x16x32_bf16 v[184:187], v[56:59], a[100:103], v[184:187]
    s_add_u32 s23, s23, s19
    s_add_u32 s23, s23, 1179648
    ds_read_b64_tr_b16 v[54:55], v13 offset:58368
    v_mfma_f32_16x16x32_bf16 v[216:219], v[56:59], a[104:107], v[216:219]
    buffer_load_dwordx4 a[196:199], v1, s[8:11], s80 offen offset:0
    v_mfma_f32_16x16x32_bf16 v[248:251], v[56:59], a[108:111], v[248:251]
    buffer_load_dword v112, v116, s[8:11], s70 offen
    v_mfma_f32_16x16x32_bf16 v[156:159], v[60:63], a[96:99], v[156:159]
    s_add_u32 s70, s70, 12288
    s_lshl_b32 s71, s2, 2
    ds_read_b64_tr_b16 v[56:57], v14 offset:57344
    v_mfma_f32_16x16x32_bf16 v[188:191], v[60:63], a[100:103], v[188:191]
    s_add_u32 s71, s71, s3
    s_and_b32 s100, s71, 31
    ds_read_b64_tr_b16 v[58:59], v14 offset:58368
    v_mfma_f32_16x16x32_bf16 v[220:223], v[60:63], a[104:107], v[220:223]
    buffer_load_dword v113, v116, s[8:11], s70 offen
    v_mfma_f32_16x16x32_bf16 v[252:255], v[60:63], a[108:111], v[252:255]
    s_lshr_b32 s101, s71, 5
    s_sub_u32 s101, s101, 4
    s_and_b32 s101, s101, 31
    v_mfma_f32_16x16x32_bf16 v[128:131], v[32:35], a[112:115], v[128:131]
    s_xor_b32 s80, s76, 12288
    s_add_u32 s70, s70, 12288
    ds_read_b64_tr_b16 v[60:61], v15 offset:57344
    v_mfma_f32_16x16x32_bf16 v[160:163], v[32:35], a[116:119], v[160:163]
    ds_read_b64_tr_b16 v[62:63], v15 offset:58368
    v_and_b32 v121, 7, v2
    v_mfma_f32_16x16x32_bf16 v[192:195], v[32:35], a[120:123], v[192:195]
    buffer_load_dwordx4 a[200:203], v1, s[8:11], s80 offen offset:0
    v_mfma_f32_16x16x32_bf16 v[224:227], v[32:35], a[124:127], v[224:227]
    buffer_load_dword v114, v116, s[8:11], s70 offen
    v_mfma_f32_16x16x32_bf16 v[132:135], v[36:39], a[112:115], v[132:135]
    s_add_u32 s70, s70, 12288
    v_and_b32 v120, 4, v121
    v_and_b32 v122, 2, v121
    v_mfma_f32_16x16x32_bf16 v[164:167], v[36:39], a[116:119], v[164:167]
    buffer_load_dword v115, v116, s[8:11], s70 offen
    v_mfma_f32_16x16x32_bf16 v[196:199], v[36:39], a[120:123], v[196:199]
    s_add_u32 s70, s70, 12288
    v_lshl_add_u32 v120, v122, 3, v120
    v_and_b32 v122, 1, v121
    v_mfma_f32_16x16x32_bf16 v[228:231], v[36:39], a[124:127], v[228:231]
    v_lshl_add_u32 v120, v122, 1, v120
    v_mul_u32_u24 v120, 3584, v120
    v_mfma_f32_16x16x32_bf16 v[136:139], v[40:43], a[112:115], v[136:139]
    s_xor_b32 s80, s76, 28672
    v_subrev_u32 v8, 98304, v8
    v_subrev_u32 v9, 98304, v9
    s_waitcnt lgkmcnt(0)
    s_barrier
    v_mfma_f32_16x16x32_bf16 v[168:171], v[40:43], a[116:119], v[168:171]
    ds_read_b64_tr_b16 v[32:33], v8 offset:0
    v_lshrrev_b32 v122, 3, v2
    v_mfma_f32_16x16x32_bf16 v[200:203], v[40:43], a[120:123], v[200:203]
    ds_read_b64_tr_b16 v[34:35], v8 offset:1024
    v_lshl_add_u32 v120, v122, 4, v120
    v_mfma_f32_16x16x32_bf16 v[232:235], v[40:43], a[124:127], v[232:235]
    ds_read_b64_tr_b16 v[36:37], v9 offset:0
    v_subrev_u32 v10, 98304, v10
    v_mfma_f32_16x16x32_bf16 v[140:143], v[44:47], a[112:115], v[140:143]
    ds_read_b64_tr_b16 v[38:39], v9 offset:1024
    v_lshlrev_b32 v121, 13, v121
    v_mfma_f32_16x16x32_bf16 v[172:175], v[44:47], a[116:119], v[172:175]
    ds_read_b64_tr_b16 v[40:41], v10 offset:0
    v_lshl_add_u32 v121, v122, 4, v121
    v_mfma_f32_16x16x32_bf16 v[204:207], v[44:47], a[120:123], v[204:207]
    s_lshr_b32 s71, s100, 1
    s_lshl_b32 s71, s71, 2
    ds_read_b64_tr_b16 v[42:43], v10 offset:1024
    v_mfma_f32_16x16x32_bf16 v[236:239], v[44:47], a[124:127], v[236:239]
    s_and_b32 s100, s100, 1
    s_add_u32 s71, s71, s100
    v_subrev_u32 v11, 98304, v11
    v_mfma_f32_16x16x32_bf16 v[144:147], v[48:51], a[112:115], v[144:147]
    s_mul_i32 s71, s71, 28672
    s_lshl_b32 s100, s101, 7
    ds_read_b64_tr_b16 v[44:45], v11 offset:0
    v_mfma_f32_16x16x32_bf16 v[176:179], v[48:51], a[116:119], v[176:179]
    s_add_u32 s71, s71, s100
    s_cmp_lt_u32 s101, 28
    s_cselect_b32 s71, s71, 2147479552
    ds_read_b64_tr_b16 v[46:47], v11 offset:1024
    v_mfma_f32_16x16x32_bf16 v[208:211], v[48:51], a[120:123], v[208:211]
    buffer_load_dwordx4 a[204:207], v1, s[8:11], s80 offen offset:0
    v_mfma_f32_16x16x32_bf16 v[240:243], v[48:51], a[124:127], v[240:243]
    s_xor_b32 s80, s75, 12288
    v_subrev_u32 v12, 98304, v12
    v_mfma_f32_16x16x32_bf16 v[148:151], v[52:55], a[112:115], v[148:151]
    ds_read_b64_tr_b16 v[48:49], v12 offset:0
    v_mfma_f32_16x16x32_bf16 v[180:183], v[52:55], a[116:119], v[180:183]
    ds_read_b64_tr_b16 v[50:51], v12 offset:1024
    v_mfma_f32_16x16x32_bf16 v[212:215], v[52:55], a[120:123], v[212:215]
    buffer_load_dwordx4 a[208:211], v1, s[8:11], s80 offen offset:1024
    v_mfma_f32_16x16x32_bf16 v[244:247], v[52:55], a[124:127], v[244:247]
    s_xor_b32 s80, s75, 28672
    v_subrev_u32 v13, 98304, v13
    v_mfma_f32_16x16x32_bf16 v[152:155], v[56:59], a[112:115], v[152:155]
    ds_read_b64_tr_b16 v[52:53], v13 offset:0
    v_mfma_f32_16x16x32_bf16 v[184:187], v[56:59], a[116:119], v[184:187]
    ds_read_b64_tr_b16 v[54:55], v13 offset:1024
    v_mfma_f32_16x16x32_bf16 v[216:219], v[56:59], a[120:123], v[216:219]
    buffer_load_dwordx4 a[212:215], v1, s[8:11], s80 offen offset:1024
    v_mfma_f32_16x16x32_bf16 v[248:251], v[56:59], a[124:127], v[248:251]
    s_xor_b32 s80, s76, 12288
    v_subrev_u32 v14, 98304, v14
    v_mfma_f32_16x16x32_bf16 v[156:159], v[60:63], a[112:115], v[156:159]
    ds_read_b64_tr_b16 v[56:57], v14 offset:0
    v_mfma_f32_16x16x32_bf16 v[188:191], v[60:63], a[116:119], v[188:191]
    ds_read_b64_tr_b16 v[58:59], v14 offset:1024
    v_mfma_f32_16x16x32_bf16 v[220:223], v[60:63], a[120:123], v[220:223]
    buffer_load_dwordx4 a[216:219], v1, s[8:11], s80 offen offset:1024
    v_mfma_f32_16x16x32_bf16 v[252:255], v[60:63], a[124:127], v[252:255]
    s_waitcnt lgkmcnt(4)
    v_subrev_u32 v15, 98304, v15
    v_mfma_f32_16x16x32_bf16 v[128:131], v[32:35], a[128:131], v[128:131]
    ds_read_b64_tr_b16 v[60:61], v15 offset:0
    v_mfma_f32_16x16x32_bf16 v[160:163], v[32:35], a[132:135], v[160:163]
    ds_read_b64_tr_b16 v[62:63], v15 offset:1024
    v_mfma_f32_16x16x32_bf16 v[192:195], v[32:35], a[136:139], v[192:195]
    buffer_load_dword v3, v17, s[8:11], s74 offen sc0 sc1
    v_mfma_f32_16x16x32_bf16 v[224:227], v[32:35], a[140:143], v[224:227]
    v_mfma_f32_16x16x32_bf16 v[132:135], v[36:39], a[128:131], v[132:135]
    s_xor_b32 s80, s76, 28672
    ds_read_b64_tr_b16 v[32:33], v8 offset:8192
    v_mfma_f32_16x16x32_bf16 v[164:167], v[36:39], a[132:135], v[164:167]
    ds_read_b64_tr_b16 v[34:35], v8 offset:9216
    v_mfma_f32_16x16x32_bf16 v[196:199], v[36:39], a[136:139], v[196:199]
    buffer_load_dwordx4 a[220:223], v1, s[8:11], s80 offen offset:1024
    v_mfma_f32_16x16x32_bf16 v[228:231], v[36:39], a[140:143], v[228:231]
    v_mfma_f32_16x16x32_bf16 v[136:139], v[40:43], a[128:131], v[136:139]
    ds_read_b64_tr_b16 v[36:37], v9 offset:8192
    v_mfma_f32_16x16x32_bf16 v[168:171], v[40:43], a[132:135], v[168:171]
    s_xor_b32 s80, s75, 14336
    ds_read_b64_tr_b16 v[38:39], v9 offset:9216
    v_mfma_f32_16x16x32_bf16 v[200:203], v[40:43], a[136:139], v[200:203]
    buffer_load_dwordx4 a[224:227], v1, s[8:11], s80 offen offset:0
    v_mfma_f32_16x16x32_bf16 v[232:235], v[40:43], a[140:143], v[232:235]
    v_mfma_f32_16x16x32_bf16 v[140:143], v[44:47], a[128:131], v[140:143]
    ds_read_b64_tr_b16 v[40:41], v10 offset:8192
    v_mfma_f32_16x16x32_bf16 v[172:175], v[44:47], a[132:135], v[172:175]
    ds_read_b64_tr_b16 v[42:43], v10 offset:9216
    v_mfma_f32_16x16x32_bf16 v[204:207], v[44:47], a[136:139], v[204:207]
    v_mfma_f32_16x16x32_bf16 v[236:239], v[44:47], a[140:143], v[236:239]
    v_mfma_f32_16x16x32_bf16 v[144:147], v[48:51], a[128:131], v[144:147]
    s_xor_b32 s80, s75, 30720
    ds_read_b64_tr_b16 v[44:45], v11 offset:8192
    v_mfma_f32_16x16x32_bf16 v[176:179], v[48:51], a[132:135], v[176:179]
    ds_read_b64_tr_b16 v[46:47], v11 offset:9216
    v_mfma_f32_16x16x32_bf16 v[208:211], v[48:51], a[136:139], v[208:211]
    buffer_load_dwordx4 a[228:231], v1, s[8:11], s80 offen offset:0
    v_mfma_f32_16x16x32_bf16 v[240:243], v[48:51], a[140:143], v[240:243]
    s_waitcnt lgkmcnt(4)
    v_mfma_f32_16x16x32_bf16 v[148:151], v[52:55], a[128:131], v[148:151]
    ds_read_b64_tr_b16 v[48:49], v12 offset:8192
    v_mfma_f32_16x16x32_bf16 v[180:183], v[52:55], a[132:135], v[180:183]
    ds_read_b64_tr_b16 v[50:51], v12 offset:9216
    v_mfma_f32_16x16x32_bf16 v[212:215], v[52:55], a[136:139], v[212:215]
    v_mfma_f32_16x16x32_bf16 v[244:247], v[52:55], a[140:143], v[244:247]
    v_mfma_f32_16x16x32_bf16 v[152:155], v[56:59], a[128:131], v[152:155]
    s_xor_b32 s80, s76, 14336
    ds_read_b64_tr_b16 v[52:53], v13 offset:8192
    v_mfma_f32_16x16x32_bf16 v[184:187], v[56:59], a[132:135], v[184:187]
    ds_read_b64_tr_b16 v[54:55], v13 offset:9216
    v_mfma_f32_16x16x32_bf16 v[216:219], v[56:59], a[136:139], v[216:219]
    buffer_load_dwordx4 a[232:235], v1, s[8:11], s80 offen offset:0
    s_waitcnt vmcnt(4)
    v_cmp_ne_u32 vcc, 0, v3
    s_cmp_eq_u64 vcc, -1
    s_cbranch_scc0 L_KV_slow_7
L_KV_ok_8:
    v_mfma_f32_16x16x32_bf16 v[248:251], v[56:59], a[140:143], v[248:251]
    v_mfma_f32_16x16x32_bf16 v[156:159], v[60:63], a[128:131], v[156:159]
    s_add_u32 m0, s62, 65536
    s_add_u32 s98, s81, 0
    ds_read_b64_tr_b16 v[56:57], v14 offset:8192
    v_mfma_f32_16x16x32_bf16 v[188:191], v[60:63], a[132:135], v[188:191]
    ds_read_b64_tr_b16 v[58:59], v14 offset:9216
    v_add_u32 v16, s62, v1
    v_mfma_f32_16x16x32_bf16 v[220:223], v[60:63], a[136:139], v[220:223]
    buffer_load_dwordx4 v1, s[8:11], s98 offen offset:0  lds
    v_mfma_f32_16x16x32_bf16 v[252:255], v[60:63], a[140:143], v[252:255]
    v_and_b32 v17, 4294959103, v16
    v_mov_b32 v24, -1
    v_mfma_f32_16x16x32_bf16 v[128:131], v[32:35], a[144:147], v[128:131]
    s_xor_b32 s80, s76, 30720
    ds_read_b64_tr_b16 v[60:61], v15 offset:8192
    v_mov_b32 v28, 0x3f803f80
    v_mfma_f32_16x16x32_bf16 v[160:163], v[32:35], a[148:151], v[160:163]
    ds_read_b64_tr_b16 v[62:63], v15 offset:9216
    v_mov_b32 v25, -1
    v_mfma_f32_16x16x32_bf16 v[192:195], v[32:35], a[152:155], v[192:195]
    buffer_load_dwordx4 a[236:239], v1, s[8:11], s80 offen offset:0
    v_mfma_f32_16x16x32_bf16 v[224:227], v[32:35], a[156:159], v[224:227]
    buffer_load_dwordx4 v1, s[8:11], s98 offen offset:1024  lds
    v_mfma_f32_16x16x32_bf16 v[132:135], v[36:39], a[144:147], v[132:135]
    ds_read_b64_tr_b16 v[32:33], v8 offset:16384
    v_add_f32 v112, v112, v113
    v_mfma_f32_16x16x32_bf16 v[164:167], v[36:39], a[148:151], v[164:167]
    s_xor_b32 s80, s75, 14336
    ds_read_b64_tr_b16 v[34:35], v8 offset:17408
    v_add_f32 v114, v114, v115
    v_mfma_f32_16x16x32_bf16 v[196:199], v[36:39], a[152:155], v[196:199]
    buffer_load_dwordx4 a[240:243], v1, s[8:11], s80 offen offset:1024
    v_mfma_f32_16x16x32_bf16 v[228:231], v[36:39], a[156:159], v[228:231]
    s_waitcnt lgkmcnt(4)
    ds_read_b64_tr_b16 a[24:25], v8 offset:49152
    v_add_f32 v112, v112, v114
    v_mfma_f32_16x16x32_bf16 v[136:139], v[40:43], a[144:147], v[136:139]
    ds_read_b64_tr_b16 v[36:37], v9 offset:16384
    v_cvt_pk_bf16_f32 v112, v112, v112
    v_mfma_f32_16x16x32_bf16 v[168:171], v[40:43], a[148:151], v[168:171]
    ds_read_b64_tr_b16 v[38:39], v9 offset:17408
    v_and_b32 v112, 0xffff0000, v112
    v_mfma_f32_16x16x32_bf16 v[200:203], v[40:43], a[152:155], v[200:203]
    s_lshr_b32 s70, s2, 6
    s_cmp_eq_u32 s70, 2
    s_cselect_b32 s70, 1.0, 0
    ds_read_b64_tr_b16 a[26:27], v8 offset:50176
    v_mfma_f32_16x16x32_bf16 v[232:235], v[40:43], a[156:159], v[232:235]
    buffer_load_dwordx4 v1, s[8:11], s98 offen offset:2048  lds
    v_mfma_f32_16x16x32_bf16 v[140:143], v[44:47], a[144:147], v[140:143]
    s_xor_b32 s80, s75, 30720
    ds_read_b64_tr_b16 v[40:41], v10 offset:16384
    v_add_f32 v112, s70, v112
    v_mfma_f32_16x16x32_bf16 v[172:175], v[44:47], a[148:151], v[172:175]
    ds_read_b64_tr_b16 v[42:43], v10 offset:17408
    v_cvt_pk_bf16_f32 v112, v112, v112
    v_mfma_f32_16x16x32_bf16 v[204:207], v[44:47], a[152:155], v[204:207]
    ds_read_b64_tr_b16 a[28:29], v9 offset:49152
    v_and_b32 v112, 0xffff0000, v112
    v_mfma_f32_16x16x32_bf16 v[236:239], v[44:47], a[156:159], v[236:239]
    buffer_load_dwordx4 a[244:247], v1, s[8:11], s80 offen offset:1024
    v_mfma_f32_16x16x32_bf16 v[144:147], v[48:51], a[144:147], v[144:147]
    s_lshl_b32 s70, s2, 5
    s_add_u32 s70, s70, 4096
    ds_read_b64_tr_b16 v[44:45], v11 offset:16384
    v_mfma_f32_16x16x32_bf16 v[176:179], v[48:51], a[148:151], v[176:179]
    ds_read_b64_tr_b16 v[46:47], v11 offset:17408
    v_mov_b32 v29, 0x3f803f80
    v_mfma_f32_16x16x32_bf16 v[208:211], v[48:51], a[152:155], v[208:211]
    ds_read_b64_tr_b16 a[30:31], v9 offset:50176
    v_mov_b32 v26, -1
    v_mfma_f32_16x16x32_bf16 v[240:243], v[48:51], a[156:159], v[240:243]
    buffer_store_dword v112, v116, s[8:11], s70 offen sc0 sc1
    v_mfma_f32_16x16x32_bf16 v[148:151], v[52:55], a[144:147], v[148:151]
    s_xor_b32 s80, s76, 14336
    ds_read_b64_tr_b16 v[48:49], v12 offset:16384
    v_mov_b32 v30, 0x3f803f80
    v_mfma_f32_16x16x32_bf16 v[180:183], v[52:55], a[148:151], v[180:183]
    ds_read_b64_tr_b16 v[50:51], v12 offset:17408
    v_mov_b32 v27, -1
    v_mfma_f32_16x16x32_bf16 v[212:215], v[52:55], a[152:155], v[212:215]
    ds_read_b64_tr_b16 a[32:33], v10 offset:49152
    v_mov_b32 v31, 0x3f803f80
    v_mfma_f32_16x16x32_bf16 v[244:247], v[52:55], a[156:159], v[244:247]
    buffer_load_dwordx4 a[248:251], v1, s[8:11], s80 offen offset:1024
    v_mfma_f32_16x16x32_bf16 v[152:155], v[56:59], a[144:147], v[152:155]
    ds_read_b64_tr_b16 v[52:53], v13 offset:16384
    v_mov_b32 v64, 0
    v_mfma_f32_16x16x32_bf16 v[184:187], v[56:59], a[148:151], v[184:187]
    ds_read_b64_tr_b16 v[54:55], v13 offset:17408
    v_mov_b32 v65, 0
    v_mfma_f32_16x16x32_bf16 v[216:219], v[56:59], a[152:155], v[216:219]
    s_waitcnt lgkmcnt(7)
    s_xor_b32 s80, s76, 30720
    ds_read_b64_tr_b16 a[34:35], v10 offset:50176
    v_mov_b32 v66, 0
    v_mfma_f32_16x16x32_bf16 v[248:251], v[56:59], a[156:159], v[248:251]
    buffer_load_dwordx4 a[252:255], v1, s[8:11], s80 offen offset:1024
    v_mfma_f32_16x16x32_bf16 v[156:159], v[60:63], a[144:147], v[156:159]
    ds_read_b64_tr_b16 v[56:57], v14 offset:16384
    v_mov_b32 v67, 0
    v_mfma_f32_16x16x32_bf16 v[188:191], v[60:63], a[148:151], v[188:191]
    ds_read_b64_tr_b16 v[58:59], v14 offset:17408
    v_mov_b32 v68, 0
    v_mfma_f32_16x16x32_bf16 v[220:223], v[60:63], a[152:155], v[220:223]
    ds_read_b64_tr_b16 a[36:37], v11 offset:49152
    v_mov_b32 v69, 0
    v_mfma_f32_16x16x32_bf16 v[252:255], v[60:63], a[156:159], v[252:255]
    buffer_load_dwordx4 v1, s[8:11], s98 offen offset:3072  lds
    v_mfma_f32_16x16x32_bf16 v[128:131], v[32:35], a[160:163], v[128:131]
    s_add_u32 m0, s62, 69632
    s_add_u32 s98, s81, 4096
    ds_read_b64_tr_b16 v[60:61], v15 offset:16384
    v_mfma_f32_16x16x32_bf16 v[160:163], v[32:35], a[164:167], v[160:163]
    ds_read_b64_tr_b16 v[62:63], v15 offset:17408
    v_mov_b32 v70, 0
    v_mfma_f32_16x16x32_bf16 v[192:195], v[32:35], a[168:171], v[192:195]
    ds_read_b64_tr_b16 a[38:39], v11 offset:50176
    v_mov_b32 v71, 0
    v_mfma_f32_16x16x32_bf16 v[224:227], v[32:35], a[172:175], v[224:227]
    buffer_load_dwordx4 v1, s[8:11], s98 offen offset:0  lds
    v_mfma_f32_16x16x32_bf16 v[132:135], v[36:39], a[160:163], v[132:135]
    ds_read_b64_tr_b16 v[32:33], v8 offset:24576
    v_mov_b32 v72, 0
    v_mfma_f32_16x16x32_bf16 v[164:167], v[36:39], a[164:167], v[164:167]
    ds_read_b64_tr_b16 v[34:35], v8 offset:25600
    v_mov_b32 v73, 0
    v_mfma_f32_16x16x32_bf16 v[196:199], v[36:39], a[168:171], v[196:199]
    ds_read_b64_tr_b16 a[40:41], v12 offset:49152
    v_mov_b32 v74, 0
    v_mfma_f32_16x16x32_bf16 v[228:231], v[36:39], a[172:175], v[228:231]
    buffer_load_dwordx4 v1, s[8:11], s98 offen offset:1024  lds
    v_mfma_f32_16x16x32_bf16 v[136:139], v[40:43], a[160:163], v[136:139]
    ds_read_b64_tr_b16 v[36:37], v9 offset:24576
    v_mov_b32 v75, 0
    v_mfma_f32_16x16x32_bf16 v[168:171], v[40:43], a[164:167], v[168:171]
    ds_read_b64_tr_b16 v[38:39], v9 offset:25600
    v_mov_b32 v76, 0
    v_mfma_f32_16x16x32_bf16 v[200:203], v[40:43], a[168:171], v[200:203]
    s_waitcnt lgkmcnt(7)
    ds_read_b64_tr_b16 a[42:43], v12 offset:50176
    v_mov_b32 v77, 0
    v_mfma_f32_16x16x32_bf16 v[232:235], v[40:43], a[172:175], v[232:235]
    buffer_load_dwordx4 v1, s[8:11], s98 offen offset:2048  lds
    v_mfma_f32_16x16x32_bf16 v[140:143], v[44:47], a[160:163], v[140:143]
    ds_read_b64_tr_b16 v[40:41], v10 offset:24576
    v_mov_b32 v78, 0
    v_mfma_f32_16x16x32_bf16 v[172:175], v[44:47], a[164:167], v[172:175]
    ds_read_b64_tr_b16 v[42:43], v10 offset:25600
    v_mov_b32 v79, 0
    v_mfma_f32_16x16x32_bf16 v[204:207], v[44:47], a[168:171], v[204:207]
    s_cmp_eq_u32 s60, 0
    s_cselect_b32 s19, 0, 0x76800000
    ds_read_b64_tr_b16 a[44:45], v13 offset:49152
    v_add_f32 v3, s19, v21
    v_mfma_f32_16x16x32_bf16 v[236:239], v[44:47], a[172:175], v[236:239]
    buffer_load_dwordx4 v1, s[8:11], s98 offen offset:3072  lds
    v_mfma_f32_16x16x32_bf16 v[144:147], v[48:51], a[160:163], v[144:147]
    s_add_u32 m0, s62, 98304
    s_add_u32 s98, s81, 32768
    ds_read_b64_tr_b16 v[44:45], v11 offset:24576
    v_mfma_f32_16x16x32_bf16 v[176:179], v[48:51], a[164:167], v[176:179]
    ds_read_b64_tr_b16 v[46:47], v11 offset:25600
    v_add_f32 v96, 0, v3
    v_mfma_f32_16x16x32_bf16 v[208:211], v[48:51], a[168:171], v[208:211]
    ds_read_b64_tr_b16 a[46:47], v13 offset:50176
    v_min_f32 v96, v96, v64
    v_mfma_f32_16x16x32_bf16 v[240:243], v[48:51], a[172:175], v[240:243]
    buffer_load_dwordx4 v1, s[8:11], s98 offen offset:0  lds
    v_mfma_f32_16x16x32_bf16 v[148:151], v[52:55], a[160:163], v[148:151]
    ds_read_b64_tr_b16 v[48:49], v12 offset:24576
    v_add_f32 v97, 0xf1800000, v3
    v_mfma_f32_16x16x32_bf16 v[180:183], v[52:55], a[164:167], v[180:183]
    ds_read_b64_tr_b16 v[50:51], v12 offset:25600
    v_min_f32 v97, v97, v65
    v_mfma_f32_16x16x32_bf16 v[212:215], v[52:55], a[168:171], v[212:215]
    ds_read_b64_tr_b16 a[48:49], v14 offset:49152
    v_add_f32 v98, 0xf2000000, v3
    v_mfma_f32_16x16x32_bf16 v[244:247], v[52:55], a[172:175], v[244:247]
    buffer_load_dwordx4 v1, s[8:11], s98 offen offset:1024  lds
    v_mfma_f32_16x16x32_bf16 v[152:155], v[56:59], a[160:163], v[152:155]
    ds_read_b64_tr_b16 v[52:53], v13 offset:24576
    v_min_f32 v98, v98, v66
    v_mfma_f32_16x16x32_bf16 v[184:187], v[56:59], a[164:167], v[184:187]
    ds_read_b64_tr_b16 v[54:55], v13 offset:25600
    v_add_f32 v99, 0xf2400000, v3
    v_mfma_f32_16x16x32_bf16 v[216:219], v[56:59], a[168:171], v[216:219]
    s_waitcnt lgkmcnt(7)
    ds_read_b64_tr_b16 a[50:51], v14 offset:50176
    v_min_f32 v99, v99, v67
    v_mfma_f32_16x16x32_bf16 v[248:251], v[56:59], a[172:175], v[248:251]
    buffer_load_dwordx4 v1, s[8:11], s98 offen offset:2048  lds
    v_mfma_f32_16x16x32_bf16 v[156:159], v[60:63], a[160:163], v[156:159]
    ds_read_b64_tr_b16 v[56:57], v14 offset:24576
    v_add_f32 v100, 0xf3800000, v3
    v_mfma_f32_16x16x32_bf16 v[188:191], v[60:63], a[164:167], v[188:191]
    ds_read_b64_tr_b16 v[58:59], v14 offset:25600
    v_min_f32 v100, v100, v64
    v_mfma_f32_16x16x32_bf16 v[220:223], v[60:63], a[168:171], v[220:223]
    ds_read_b64_tr_b16 a[52:53], v15 offset:49152
    v_add_f32 v101, 0xf3880000, v3
    v_mfma_f32_16x16x32_bf16 v[252:255], v[60:63], a[172:175], v[252:255]
    buffer_load_dwordx4 v1, s[8:11], s98 offen offset:3072  lds
    v_mfma_f32_16x16x32_bf16 v[128:131], v[32:35], a[176:179], v[128:131]
    s_add_u32 m0, s62, 102400
    s_add_u32 s98, s81, 36864
    ds_read_b64_tr_b16 v[60:61], v15 offset:24576
    v_mfma_f32_16x16x32_bf16 v[160:163], v[32:35], a[180:183], v[160:163]
    ds_read_b64_tr_b16 v[62:63], v15 offset:25600
    v_min_f32 v101, v101, v65
    v_mfma_f32_16x16x32_bf16 v[192:195], v[32:35], a[184:187], v[192:195]
    ds_read_b64_tr_b16 a[54:55], v15 offset:50176
    v_add_f32 v102, 0xf3900000, v3
    v_mfma_f32_16x16x32_bf16 v[224:227], v[32:35], a[188:191], v[224:227]
    buffer_load_dwordx4 v1, s[8:11], s98 offen offset:0  lds
    v_mfma_f32_16x16x32_bf16 v[132:135], v[36:39], a[176:179], v[132:135]
    ds_read_b64_tr_b16 v[32:33], v8 offset:32768
    v_min_f32 v102, v102, v66
    v_mfma_f32_16x16x32_bf16 v[164:167], v[36:39], a[180:183], v[164:167]
    ds_read_b64_tr_b16 v[34:35], v8 offset:33792
    v_add_f32 v103, 0xf3980000, v3
    v_mfma_f32_16x16x32_bf16 v[196:199], v[36:39], a[184:187], v[196:199]
    ds_read_b64_tr_b16 a[64:65], v8 offset:57344
    v_min_f32 v103, v103, v67
    v_mfma_f32_16x16x32_bf16 v[228:231], v[36:39], a[188:191], v[228:231]
    buffer_load_dwordx4 v1, s[8:11], s98 offen offset:1024  lds
    v_mfma_f32_16x16x32_bf16 v[136:139], v[40:43], a[176:179], v[136:139]
    ds_read_b64_tr_b16 v[36:37], v9 offset:32768
    v_add_f32 v104, 0x73800000, v3
    v_mfma_f32_16x16x32_bf16 v[168:171], v[40:43], a[180:183], v[168:171]
    ds_read_b64_tr_b16 v[38:39], v9 offset:33792
    v_min_f32 v104, v104, v68
    v_mfma_f32_16x16x32_bf16 v[200:203], v[40:43], a[184:187], v[200:203]
    s_waitcnt lgkmcnt(7)
    ds_read_b64_tr_b16 a[66:67], v8 offset:58368
    v_add_f32 v105, 0x73700000, v3
    v_mfma_f32_16x16x32_bf16 v[232:235], v[40:43], a[188:191], v[232:235]
    buffer_load_dwordx4 v1, s[8:11], s98 offen offset:2048  lds
    v_mfma_f32_16x16x32_bf16 v[140:143], v[44:47], a[176:179], v[140:143]
    ds_read_b64_tr_b16 v[40:41], v10 offset:32768
    v_min_f32 v105, v105, v69
    v_mfma_f32_16x16x32_bf16 v[172:175], v[44:47], a[180:183], v[172:175]
    ds_read_b64_tr_b16 v[42:43], v10 offset:33792
    v_add_f32 v106, 0x73600000, v3
    v_mfma_f32_16x16x32_bf16 v[204:207], v[44:47], a[184:187], v[204:207]
    ds_read_b64_tr_b16 a[68:69], v9 offset:57344
    v_min_f32 v106, v106, v70
    v_mfma_f32_16x16x32_bf16 v[236:239], v[44:47], a[188:191], v[236:239]
    buffer_load_dwordx4 v1, s[8:11], s98 offen offset:3072  lds
    v_mfma_f32_16x16x32_bf16 v[144:147], v[48:51], a[176:179], v[144:147]
    s_add_u32 m0, s62, 131072
    s_add_u32 s98, s82, 0
    ds_read_b64_tr_b16 v[44:45], v11 offset:32768
    v_mfma_f32_16x16x32_bf16 v[176:179], v[48:51], a[180:183], v[176:179]
    ds_read_b64_tr_b16 v[46:47], v11 offset:33792
    v_add_f32 v107, 0x73500000, v3
    v_mfma_f32_16x16x32_bf16 v[208:211], v[48:51], a[184:187], v[208:211]
    ds_read_b64_tr_b16 a[70:71], v9 offset:58368
    v_min_f32 v107, v107, v71
    v_mfma_f32_16x16x32_bf16 v[240:243], v[48:51], a[188:191], v[240:243]
    buffer_load_dwordx4 v1, s[8:11], s98 offen offset:0  lds
    v_mfma_f32_16x16x32_bf16 v[148:151], v[52:55], a[176:179], v[148:151]
    ds_read_b64_tr_b16 v[48:49], v12 offset:32768
    v_add_f32 v108, 0, v3
    v_mfma_f32_16x16x32_bf16 v[180:183], v[52:55], a[180:183], v[180:183]
    ds_read_b64_tr_b16 v[50:51], v12 offset:33792
    v_min_f32 v108, v108, v68
    v_mfma_f32_16x16x32_bf16 v[212:215], v[52:55], a[184:187], v[212:215]
    ds_read_b64_tr_b16 a[72:73], v10 offset:57344
    v_add_f32 v109, 0xf1800000, v3
    v_mfma_f32_16x16x32_bf16 v[244:247], v[52:55], a[188:191], v[244:247]
    buffer_load_dwordx4 v1, s[8:11], s98 offen offset:1024  lds
    v_mfma_f32_16x16x32_bf16 v[152:155], v[56:59], a[176:179], v[152:155]
    ds_read_b64_tr_b16 v[52:53], v13 offset:32768
    v_min_f32 v109, v109, v69
    v_mfma_f32_16x16x32_bf16 v[184:187], v[56:59], a[180:183], v[184:187]
    ds_read_b64_tr_b16 v[54:55], v13 offset:33792
    v_add_f32 v110, 0xf2000000, v3
    v_mfma_f32_16x16x32_bf16 v[216:219], v[56:59], a[184:187], v[216:219]
    s_waitcnt lgkmcnt(7)
    ds_read_b64_tr_b16 a[74:75], v10 offset:58368
    v_min_f32 v110, v110, v70
    v_mfma_f32_16x16x32_bf16 v[248:251], v[56:59], a[188:191], v[248:251]
    buffer_load_dwordx4 v1, s[8:11], s98 offen offset:2048  lds
    v_mfma_f32_16x16x32_bf16 v[156:159], v[60:63], a[176:179], v[156:159]
    ds_read_b64_tr_b16 v[56:57], v14 offset:32768
    v_add_f32 v111, 0xf2400000, v3
    v_mfma_f32_16x16x32_bf16 v[188:191], v[60:63], a[180:183], v[188:191]
    ds_read_b64_tr_b16 v[58:59], v14 offset:33792
    v_min_f32 v111, v111, v71
    v_mfma_f32_16x16x32_bf16 v[220:223], v[60:63], a[184:187], v[220:223]
    s_cmp_eq_u32 s60, 0
    s_cselect_b32 s19, 1.0, 0
    ds_read_b64_tr_b16 a[76:77], v11 offset:57344
    v_sub_f32 v3, v22, v21
    v_mfma_f32_16x16x32_bf16 v[252:255], v[60:63], a[188:191], v[252:255]
    buffer_load_dwordx4 v1, s[8:11], s98 offen offset:3072  lds
    v_mfma_f32_16x16x32_bf16 v[128:131], v[32:35], a[192:195], v[128:131]
    s_add_u32 m0, s62, 135168
    s_add_u32 s98, s82, 4096
    ds_read_b64_tr_b16 v[60:61], v15 offset:32768
    v_mfma_f32_16x16x32_bf16 v[160:163], v[32:35], a[196:199], v[160:163]
    ds_read_b64_tr_b16 v[62:63], v15 offset:33792
    v_fma_f32 v3, s19, v3, v21
    v_mfma_f32_16x16x32_bf16 v[192:195], v[32:35], a[200:203], v[192:195]
    ds_read_b64_tr_b16 a[78:79], v11 offset:58368
    v_add_f32 v80, 0, v3
    v_mfma_f32_16x16x32_bf16 v[224:227], v[32:35], a[204:207], v[224:227]
    buffer_load_dwordx4 v1, s[8:11], s98 offen offset:0  lds
    v_mfma_f32_16x16x32_bf16 v[132:135], v[36:39], a[192:195], v[132:135]
    ds_read_b64_tr_b16 v[32:33], v8 offset:40960
    v_min_f32 v80, v80, v64
    v_mfma_f32_16x16x32_bf16 v[164:167], v[36:39], a[196:199], v[164:167]
    ds_read_b64_tr_b16 v[34:35], v8 offset:41984
    v_add_f32 v81, 0xf1800000, v3
    v_mfma_f32_16x16x32_bf16 v[196:199], v[36:39], a[200:203], v[196:199]
    ds_read_b64_tr_b16 a[80:81], v12 offset:57344
    v_min_f32 v81, v81, v65
    v_mfma_f32_16x16x32_bf16 v[228:231], v[36:39], a[204:207], v[228:231]
    buffer_load_dwordx4 v1, s[8:11], s98 offen offset:1024  lds
    v_mfma_f32_16x16x32_bf16 v[136:139], v[40:43], a[192:195], v[136:139]
    ds_read_b64_tr_b16 v[36:37], v9 offset:40960
    v_add_f32 v82, 0xf2000000, v3
    v_mfma_f32_16x16x32_bf16 v[168:171], v[40:43], a[196:199], v[168:171]
    ds_read_b64_tr_b16 v[38:39], v9 offset:41984
    v_min_f32 v82, v82, v66
    v_mfma_f32_16x16x32_bf16 v[200:203], v[40:43], a[200:203], v[200:203]
    s_waitcnt lgkmcnt(7)
    ds_read_b64_tr_b16 a[82:83], v12 offset:58368
    v_add_f32 v83, 0xf2400000, v3
    v_mfma_f32_16x16x32_bf16 v[232:235], v[40:43], a[204:207], v[232:235]
    buffer_load_dwordx4 v1, s[8:11], s98 offen offset:2048  lds
    v_mfma_f32_16x16x32_bf16 v[140:143], v[44:47], a[192:195], v[140:143]
    ds_read_b64_tr_b16 v[40:41], v10 offset:40960
    v_min_f32 v83, v83, v67
    v_mfma_f32_16x16x32_bf16 v[172:175], v[44:47], a[196:199], v[172:175]
    ds_read_b64_tr_b16 v[42:43], v10 offset:41984
    v_add_f32 v84, 0xf3800000, v3
    v_mfma_f32_16x16x32_bf16 v[204:207], v[44:47], a[200:203], v[204:207]
    ds_read_b64_tr_b16 a[84:85], v13 offset:57344
    v_min_f32 v84, v84, v64
    v_mfma_f32_16x16x32_bf16 v[236:239], v[44:47], a[204:207], v[236:239]
    buffer_load_dwordx4 v1, s[8:11], s98 offen offset:3072  lds
    v_mfma_f32_16x16x32_bf16 v[144:147], v[48:51], a[192:195], v[144:147]
    ds_read_b64_tr_b16 v[44:45], v11 offset:40960
    v_add_f32 v85, 0xf3880000, v3
    v_mfma_f32_16x16x32_bf16 v[176:179], v[48:51], a[196:199], v[176:179]
    ds_read_b64_tr_b16 v[46:47], v11 offset:41984
    v_min_f32 v85, v85, v65
    v_mfma_f32_16x16x32_bf16 v[208:211], v[48:51], a[200:203], v[208:211]
    ds_read_b64_tr_b16 a[86:87], v13 offset:58368
    v_add_f32 v86, 0xf3900000, v3
    v_mfma_f32_16x16x32_bf16 v[240:243], v[48:51], a[204:207], v[240:243]
    buffer_load_dwordx4 a[0:3], v120, s[40:43], s71 offen
    v_mfma_f32_16x16x32_bf16 v[148:151], v[52:55], a[192:195], v[148:151]
    ds_read_b64_tr_b16 v[48:49], v12 offset:40960
    v_min_f32 v86, v86, v66
    v_mfma_f32_16x16x32_bf16 v[180:183], v[52:55], a[196:199], v[180:183]
    ds_read_b64_tr_b16 v[50:51], v12 offset:41984
    v_add_f32 v87, 0xf3980000, v3
    v_mfma_f32_16x16x32_bf16 v[212:215], v[52:55], a[200:203], v[212:215]
    ds_read_b64_tr_b16 a[88:89], v14 offset:57344
    v_min_f32 v87, v87, v67
    v_mfma_f32_16x16x32_bf16 v[244:247], v[52:55], a[204:207], v[244:247]
    buffer_load_dwordx4 a[4:7], v120, s[40:43], s71 offen offset:3584
    v_mfma_f32_16x16x32_bf16 v[152:155], v[56:59], a[192:195], v[152:155]
    ds_read_b64_tr_b16 v[52:53], v13 offset:40960
    v_add_f32 v88, 0x73800000, v3
    v_mfma_f32_16x16x32_bf16 v[184:187], v[56:59], a[196:199], v[184:187]
    ds_read_b64_tr_b16 v[54:55], v13 offset:41984
    v_min_f32 v88, v88, v68
    v_mfma_f32_16x16x32_bf16 v[216:219], v[56:59], a[200:203], v[216:219]
    s_waitcnt lgkmcnt(7)
    ds_read_b64_tr_b16 a[90:91], v14 offset:58368
    v_add_f32 v89, 0x73700000, v3
    v_mfma_f32_16x16x32_bf16 v[248:251], v[56:59], a[204:207], v[248:251]
    buffer_load_dwordx4 a[8:11], v120, s[44:47], s71 offen
    v_mfma_f32_16x16x32_bf16 v[156:159], v[60:63], a[192:195], v[156:159]
    ds_read_b64_tr_b16 v[56:57], v14 offset:40960
    v_min_f32 v89, v89, v69
    v_mfma_f32_16x16x32_bf16 v[188:191], v[60:63], a[196:199], v[188:191]
    ds_read_b64_tr_b16 v[58:59], v14 offset:41984
    v_add_f32 v90, 0x73600000, v3
    v_mfma_f32_16x16x32_bf16 v[220:223], v[60:63], a[200:203], v[220:223]
    ds_read_b64_tr_b16 a[92:93], v15 offset:57344
    v_min_f32 v90, v90, v70
    v_mfma_f32_16x16x32_bf16 v[252:255], v[60:63], a[204:207], v[252:255]
    buffer_load_dwordx4 a[12:15], v120, s[44:47], s71 offen offset:3584
    v_mfma_f32_16x16x32_bf16 v[192:195], v[32:35], a[216:219], v[192:195]
    s_waitcnt vmcnt(34)
    s_lshl_b32 s71, s101, 16
    ds_read_b64_tr_b16 v[60:61], v15 offset:40960
    v_add_f32 v91, 0x73500000, v3
    v_mfma_f32_16x16x32_bf16 v[192:195], a[24:27], a[232:235], v[192:195]
    s_waitcnt vmcnt(26)
    s_lshl_b32 s100, s3, 11
    ds_read_b64_tr_b16 v[62:63], v15 offset:41984
    v_min_f32 v91, v91, v71
    v_mfma_f32_16x16x32_bf16 v[192:195], a[64:67], a[248:251], v[192:195]
    s_add_u32 s71, s71, s100
    ds_read_b64_tr_b16 a[94:95], v15 offset:58368
    v_add_f32 v92, 0, v3
    v_mfma_f32_16x16x32_bf16 v[196:199], v[36:39], a[216:219], v[196:199]
    s_lshl_b32 s100, s4, 7
    v_min_f32 v92, v92, v68
    v_add_f32 v93, 0xf1800000, v3
    v_mfma_f32_16x16x32_bf16 v[196:199], a[28:31], a[232:235], v[196:199]
    s_add_u32 s71, s71, s100
    v_min_f32 v93, v93, v69
    v_add_f32 v94, 0xf2000000, v3
    v_mfma_f32_16x16x32_bf16 v[196:199], a[68:71], a[248:251], v[196:199]
    v_min_f32 v94, v94, v70
    v_add_f32 v95, 0xf2400000, v3
    v_mfma_f32_16x16x32_bf16 v[224:227], v[32:35], a[220:223], v[224:227]
    buffer_load_dwordx4 a[16:19], v121, s[48:51], s71 offen
    v_mfma_f32_16x16x32_bf16 v[224:227], a[24:27], a[236:239], v[224:227]
    s_waitcnt vmcnt(26)
    v_min_f32 v95, v95, v71
    s_waitcnt lgkmcnt(0)
    s_barrier
    v_mfma_f32_16x16x32_bf16 v[224:227], a[64:67], a[252:255], v[224:227]
    buffer_load_dwordx4 a[20:23], v121, s[48:51], s71 offen offset:1024
    v_mfma_f32_16x16x32_bf16 v[228:231], v[36:39], a[220:223], v[228:231]
    v_cvt_pk_bf16_f32 v192, v192, v193
    v_cvt_pk_bf16_f32 v193, v194, v195
    v_mfma_f32_16x16x32_bf16 v[228:231], a[28:31], a[236:239], v[228:231]
    v_cvt_pk_bf16_f32 v194, v196, v197
    v_cvt_pk_bf16_f32 v195, v198, v199
    v_mfma_f32_16x16x32_bf16 v[228:231], a[68:71], a[252:255], v[228:231]
    ds_write_b128 v16, v[192:195] offset:32768
    v_lshrrev_b32 v121, 1, v2
    v_mfma_f32_16x16x32_bf16 v[128:131], v[32:35], a[208:211], v[128:131]
    v_and_b32 v121, 15, v121
    v_lshlrev_b32 v121, 10, v121
    v_mfma_f32_16x16x32_bf16 v[128:131], a[24:27], a[224:227], v[128:131]
    v_and_b32 v122, 1, v2
    v_lshl_add_u32 v121, v122, 7, v121
    v_mfma_f32_16x16x32_bf16 v[128:131], a[64:67], a[240:243], v[128:131]
    v_mfma_f32_16x16x32_bf16 v[132:135], v[36:39], a[208:211], v[132:135]
    s_lshl_b32 s71, s6, 2
    v_cvt_pk_bf16_f32 v224, v224, v225
    v_cvt_pk_bf16_f32 v225, v226, v227
    v_mfma_f32_16x16x32_bf16 v[132:135], a[28:31], a[224:227], v[132:135]
    s_add_u32 s71, s71, s3
    v_cvt_pk_bf16_f32 v226, v228, v229
    v_cvt_pk_bf16_f32 v227, v230, v231
    v_mfma_f32_16x16x32_bf16 v[132:135], a[68:71], a[240:243], v[132:135]
    s_lshl_b32 s71, s71, 14
    ds_write_b128 v16, v[224:227] offset:36864
    v_mfma_f32_16x16x32_bf16 v[160:163], v[32:35], a[212:215], v[160:163]
    buffer_load_dword a60, v121, s[28:31], s71 offen
    v_mfma_f32_16x16x32_bf16 v[160:163], a[24:27], a[228:231], v[160:163]
    v_mfma_f32_16x16x32_bf16 v[160:163], a[64:67], a[244:247], v[160:163]
    s_getpc_b64 s[100:101]
L_ct2:
    s_lshr_b32 s99, s2, 3
    s_lshl_b32 s99, s99, 2
    s_add_u32 s99, s99, s3
    s_mul_i32 s99, s99, 4
    v_min_u32 v123, 3, v2
    v_add_u32 v123, s99, v123
    v_lshlrev_b32 v123, 7, v123
    v_add_u32 v123, L_attn-L_ct2, v123
    v_min_u32 v123, L_code_end-L_ct2, v123
    global_load_dword a61, v123, s[100:101]
    v_mfma_f32_16x16x32_bf16 v[164:167], v[36:39], a[212:215], v[164:167]
    v_cvt_pk_bf16_f32 v128, v128, v129
    v_cvt_pk_bf16_f32 v129, v130, v131
    v_mfma_f32_16x16x32_bf16 v[164:167], a[28:31], a[228:231], v[164:167]
    v_cvt_pk_bf16_f32 v130, v132, v133
    v_cvt_pk_bf16_f32 v131, v134, v135
    v_mfma_f32_16x16x32_bf16 v[164:167], a[68:71], a[244:247], v[164:167]
    ds_write_b128 v16, v[128:131] offset:0
    v_mfma_f32_16x16x32_bf16 v[200:203], v[40:43], a[216:219], v[200:203]
    v_mfma_f32_16x16x32_bf16 v[200:203], a[32:35], a[232:235], v[200:203]
    v_mfma_f32_16x16x32_bf16 v[200:203], a[72:75], a[248:251], v[200:203]
    v_mfma_f32_16x16x32_bf16 v[204:207], v[44:47], a[216:219], v[204:207]
    v_cvt_pk_bf16_f32 v160, v160, v161
    v_cvt_pk_bf16_f32 v161, v162, v163
    v_mfma_f32_16x16x32_bf16 v[204:207], a[36:39], a[232:235], v[204:207]
    v_cvt_pk_bf16_f32 v162, v164, v165
    v_cvt_pk_bf16_f32 v163, v166, v167
    v_mfma_f32_16x16x32_bf16 v[204:207], a[76:79], a[248:251], v[204:207]
    ds_write_b128 v16, v[160:163] offset:4096
    v_mfma_f32_16x16x32_bf16 v[232:235], v[40:43], a[220:223], v[232:235]
    v_mfma_f32_16x16x32_bf16 v[232:235], a[32:35], a[236:239], v[232:235]
    v_mfma_f32_16x16x32_bf16 v[232:235], a[72:75], a[252:255], v[232:235]
    v_mfma_f32_16x16x32_bf16 v[236:239], v[44:47], a[220:223], v[236:239]
    v_cvt_pk_bf16_f32 v200, v200, v201
    v_cvt_pk_bf16_f32 v201, v202, v203
    v_mfma_f32_16x16x32_bf16 v[236:239], a[36:39], a[236:239], v[236:239]
    v_cvt_pk_bf16_f32 v202, v204, v205
    v_cvt_pk_bf16_f32 v203, v206, v207
    v_mfma_f32_16x16x32_bf16 v[236:239], a[76:79], a[252:255], v[236:239]
    ds_write_b128 v16, v[200:203] offset:33792
    v_mfma_f32_16x16x32_bf16 v[136:139], v[40:43], a[208:211], v[136:139]
    v_mfma_f32_16x16x32_bf16 v[136:139], a[32:35], a[224:227], v[136:139]
    v_mfma_f32_16x16x32_bf16 v[136:139], a[72:75], a[240:243], v[136:139]
    v_mfma_f32_16x16x32_bf16 v[140:143], v[44:47], a[208:211], v[140:143]
    v_cvt_pk_bf16_f32 v232, v232, v233
    v_cvt_pk_bf16_f32 v233, v234, v235
    v_mfma_f32_16x16x32_bf16 v[140:143], a[36:39], a[224:227], v[140:143]
    v_cvt_pk_bf16_f32 v234, v236, v237
    v_cvt_pk_bf16_f32 v235, v238, v239
    v_mfma_f32_16x16x32_bf16 v[140:143], a[76:79], a[240:243], v[140:143]
    ds_write_b128 v16, v[232:235] offset:37888
    v_mfma_f32_16x16x32_bf16 v[168:171], v[40:43], a[212:215], v[168:171]
    v_mfma_f32_16x16x32_bf16 v[168:171], a[32:35], a[228:231], v[168:171]
    v_mfma_f32_16x16x32_bf16 v[168:171], a[72:75], a[244:247], v[168:171]
    v_mfma_f32_16x16x32_bf16 v[172:175], v[44:47], a[212:215], v[172:175]
    v_cvt_pk_bf16_f32 v136, v136, v137
    v_cvt_pk_bf16_f32 v137, v138, v139
    v_mfma_f32_16x16x32_bf16 v[172:175], a[36:39], a[228:231], v[172:175]
    v_cvt_pk_bf16_f32 v138, v140, v141
    v_cvt_pk_bf16_f32 v139, v142, v143
    v_mfma_f32_16x16x32_bf16 v[172:175], a[76:79], a[244:247], v[172:175]
    ds_write_b128 v16, v[136:139] offset:1024
    v_mfma_f32_16x16x32_bf16 v[208:211], v[48:51], a[216:219], v[208:211]
    v_mfma_f32_16x16x32_bf16 v[208:211], a[40:43], a[232:235], v[208:211]
    v_mfma_f32_16x16x32_bf16 v[208:211], a[80:83], a[248:251], v[208:211]
    v_mfma_f32_16x16x32_bf16 v[212:215], v[52:55], a[216:219], v[212:215]
    v_cvt_pk_bf16_f32 v168, v168, v169
    v_cvt_pk_bf16_f32 v169, v170, v171
    v_mfma_f32_16x16x32_bf16 v[212:215], a[44:47], a[232:235], v[212:215]
    v_cvt_pk_bf16_f32 v170, v172, v173
    v_cvt_pk_bf16_f32 v171, v174, v175
    v_mfma_f32_16x16x32_bf16 v[212:215], a[84:87], a[248:251], v[212:215]
    ds_write_b128 v16, v[168:171] offset:5120
    v_mfma_f32_16x16x32_bf16 v[240:243], v[48:51], a[220:223], v[240:243]
    v_mfma_f32_16x16x32_bf16 v[240:243], a[40:43], a[236:239], v[240:243]
    v_mfma_f32_16x16x32_bf16 v[240:243], a[80:83], a[252:255], v[240:243]
    v_mfma_f32_16x16x32_bf16 v[244:247], v[52:55], a[220:223], v[244:247]
    v_cvt_pk_bf16_f32 v208, v208, v209
    v_cvt_pk_bf16_f32 v209, v210, v211
    v_mfma_f32_16x16x32_bf16 v[244:247], a[44:47], a[236:239], v[244:247]
    v_cvt_pk_bf16_f32 v210, v212, v213
    v_cvt_pk_bf16_f32 v211, v214, v215
    v_mfma_f32_16x16x32_bf16 v[244:247], a[84:87], a[252:255], v[244:247]
    ds_write_b128 v16, v[208:211] offset:34816
    v_mfma_f32_16x16x32_bf16 v[144:147], v[48:51], a[208:211], v[144:147]
    v_mfma_f32_16x16x32_bf16 v[144:147], a[40:43], a[224:227], v[144:147]
    v_mfma_f32_16x16x32_bf16 v[144:147], a[80:83], a[240:243], v[144:147]
    v_mfma_f32_16x16x32_bf16 v[148:151], v[52:55], a[208:211], v[148:151]
    v_cvt_pk_bf16_f32 v240, v240, v241
    v_cvt_pk_bf16_f32 v241, v242, v243
    v_mfma_f32_16x16x32_bf16 v[148:151], a[44:47], a[224:227], v[148:151]
    v_cvt_pk_bf16_f32 v242, v244, v245
    v_cvt_pk_bf16_f32 v243, v246, v247
    v_mfma_f32_16x16x32_bf16 v[148:151], a[84:87], a[240:243], v[148:151]
    ds_write_b128 v16, v[240:243] offset:38912
    v_mfma_f32_16x16x32_bf16 v[176:179], v[48:51], a[212:215], v[176:179]
    v_mfma_f32_16x16x32_bf16 v[176:179], a[40:43], a[228:231], v[176:179]
    v_mfma_f32_16x16x32_bf16 v[176:179], a[80:83], a[244:247], v[176:179]
    v_mfma_f32_16x16x32_bf16 v[180:183], v[52:55], a[212:215], v[180:183]
    v_cvt_pk_bf16_f32 v144, v144, v145
    v_cvt_pk_bf16_f32 v145, v146, v147
    v_mfma_f32_16x16x32_bf16 v[180:183], a[44:47], a[228:231], v[180:183]
    v_cvt_pk_bf16_f32 v146, v148, v149
    v_cvt_pk_bf16_f32 v147, v150, v151
    v_mfma_f32_16x16x32_bf16 v[180:183], a[84:87], a[244:247], v[180:183]
    ds_write_b128 v16, v[144:147] offset:2048
    v_mfma_f32_16x16x32_bf16 v[216:219], v[56:59], a[216:219], v[216:219]
    v_mfma_f32_16x16x32_bf16 v[216:219], a[48:51], a[232:235], v[216:219]
    v_mfma_f32_16x16x32_bf16 v[216:219], a[88:91], a[248:251], v[216:219]
    v_mfma_f32_16x16x32_bf16 v[220:223], v[60:63], a[216:219], v[220:223]
    v_cvt_pk_bf16_f32 v176, v176, v177
    v_cvt_pk_bf16_f32 v177, v178, v179
    v_mfma_f32_16x16x32_bf16 v[220:223], a[52:55], a[232:235], v[220:223]
    v_cvt_pk_bf16_f32 v178, v180, v181
    v_cvt_pk_bf16_f32 v179, v182, v183
    v_mfma_f32_16x16x32_bf16 v[220:223], a[92:95], a[248:251], v[220:223]
    ds_write_b128 v16, v[176:179] offset:6144
    v_mfma_f32_16x16x32_bf16 v[248:251], v[56:59], a[220:223], v[248:251]
    v_mfma_f32_16x16x32_bf16 v[248:251], a[48:51], a[236:239], v[248:251]
    v_mfma_f32_16x16x32_bf16 v[248:251], a[88:91], a[252:255], v[248:251]
    v_mfma_f32_16x16x32_bf16 v[252:255], v[60:63], a[220:223], v[252:255]
    v_cvt_pk_bf16_f32 v216, v216, v217
    v_cvt_pk_bf16_f32 v217, v218, v219
    v_mfma_f32_16x16x32_bf16 v[252:255], a[52:55], a[236:239], v[252:255]
    v_cvt_pk_bf16_f32 v218, v220, v221
    v_cvt_pk_bf16_f32 v219, v222, v223
    v_mfma_f32_16x16x32_bf16 v[252:255], a[92:95], a[252:255], v[252:255]
    ds_write_b128 v16, v[216:219] offset:35840
    v_mfma_f32_16x16x32_bf16 v[152:155], v[56:59], a[208:211], v[152:155]
    v_mfma_f32_16x16x32_bf16 v[152:155], a[48:51], a[224:227], v[152:155]
    v_mfma_f32_16x16x32_bf16 v[152:155], a[88:91], a[240:243], v[152:155]
    v_mfma_f32_16x16x32_bf16 v[156:159], v[60:63], a[208:211], v[156:159]
    v_cvt_pk_bf16_f32 v248, v248, v249
    v_cvt_pk_bf16_f32 v249, v250, v251
    v_mfma_f32_16x16x32_bf16 v[156:159], a[52:55], a[224:227], v[156:159]
    v_cvt_pk_bf16_f32 v250, v252, v253
    v_cvt_pk_bf16_f32 v251, v254, v255
    v_mfma_f32_16x16x32_bf16 v[156:159], a[92:95], a[240:243], v[156:159]
    ds_write_b128 v16, v[248:251] offset:39936
    v_mfma_f32_16x16x32_bf16 v[184:187], v[56:59], a[212:215], v[184:187]
    v_mfma_f32_16x16x32_bf16 v[184:187], a[48:51], a[228:231], v[184:187]
    v_mfma_f32_16x16x32_bf16 v[184:187], a[88:91], a[244:247], v[184:187]
    v_mfma_f32_16x16x32_bf16 v[188:191], v[60:63], a[212:215], v[188:191]
    v_cvt_pk_bf16_f32 v152, v152, v153
    v_cvt_pk_bf16_f32 v153, v154, v155
    v_mfma_f32_16x16x32_bf16 v[188:191], a[52:55], a[228:231], v[188:191]
    v_cvt_pk_bf16_f32 v154, v156, v157
    v_cvt_pk_bf16_f32 v155, v158, v159
    v_mfma_f32_16x16x32_bf16 v[188:191], a[92:95], a[244:247], v[188:191]
    ds_write_b128 v16, v[152:155] offset:3072
L_attn:
    v_add_u32 v15, 4096, v1
    v_cvt_pk_bf16_f32 v184, v184, v185
    v_cvt_pk_bf16_f32 v185, v186, v187
    s_nop 3
    v_cvt_pk_bf16_f32 v186, v188, v189
    v_cvt_pk_bf16_f32 v187, v190, v191
    ds_write_b128 v16, v[184:187] offset:7168
    s_waitcnt vmcnt(24) lgkmcnt(0)
    s_barrier
    ds_read_b128 a[64:67], v17 offset:0
    ds_read_b128 a[128:131], v18 offset:0
    ds_read_b128 a[68:71], v17 offset:1024
    ds_read_b128 a[132:135], v18 offset:1024
    ds_read_b128 a[72:75], v17 offset:2048
    ds_read_b128 a[136:139], v18 offset:2048
    ds_read_b128 a[76:79], v17 offset:3072
    ds_read_b128 a[140:143], v18 offset:3072
    ds_read_b128 a[144:147], v18 offset:4096
    ds_read_b128 a[148:151], v18 offset:5120
    ds_read_b128 a[152:155], v18 offset:6144
    ds_read_b128 a[156:159], v18 offset:7168
    ds_read_b128 a[80:83], v17 offset:4096
    ds_read_b128 a[84:87], v17 offset:5120
    ds_read_b128 a[88:91], v17 offset:6144
    ds_read_b128 a[92:95], v17 offset:7168
    s_waitcnt lgkmcnt(14)
    v_mfma_f32_16x16x32_bf16 v[96:99], a[128:131], a[64:67], v[96:99]
    s_waitcnt lgkmcnt(12)
    s_add_u32 s19, s82, 32768
    s_sub_u32 s82, s12, s13
    ds_read_b128 a[96:99], v17 offset:8192
    v_mfma_f32_16x16x32_bf16 v[96:99], a[132:135], a[68:71], v[96:99]
    s_waitcnt lgkmcnt(11)
    s_sub_u32 s82, s82, 1
    s_cmp_gt_u32 s12, s13
    s_cselect_b32 s82, s82, s12
    ds_read_b128 a[100:103], v17 offset:9216
    v_mfma_f32_16x16x32_bf16 v[96:99], a[136:139], a[72:75], v[96:99]
    s_waitcnt lgkmcnt(10)
    s_lshl_b32 s82, s82, 16
    s_add_u32 s82, s82, s81
    ds_read_b128 a[104:107], v17 offset:10240
    v_mfma_f32_16x16x32_bf16 v[96:99], a[140:143], a[76:79], v[96:99]
    s_waitcnt lgkmcnt(10)
    s_cmp_ge_u32 s12, 17
    s_cselect_b32 s82, 2147471360, s82
    s_add_u32 s12, s12, 1
    ds_read_b128 a[108:111], v17 offset:11264
    v_mfma_f32_16x16x32_bf16 v[100:103], a[144:147], a[64:67], v[100:103]
    s_waitcnt lgkmcnt(10)
    s_sub_u32 s14, s60, 1
    ds_read_b128 a[112:115], v17 offset:12288
    v_mfma_f32_16x16x32_bf16 v[100:103], a[148:151], a[68:71], v[100:103]
    s_waitcnt lgkmcnt(10)
    ds_read_b128 a[116:119], v17 offset:13312
    v_mfma_f32_16x16x32_bf16 v[100:103], a[152:155], a[72:75], v[100:103]
    s_waitcnt lgkmcnt(10)
    ds_read_b128 a[120:123], v17 offset:14336
    v_mfma_f32_16x16x32_bf16 v[100:103], a[156:159], a[76:79], v[100:103]
    s_waitcnt lgkmcnt(10)
    ds_read_b128 a[124:127], v17 offset:15360
    v_mfma_f32_16x16x32_bf16 v[104:107], a[128:131], a[80:83], v[104:107]
    s_waitcnt lgkmcnt(10)
    ds_read_b128 a[192:195], v17 offset:32768
    v_exp_f32 v96, v96
    v_mfma_f32_16x16x32_bf16 v[104:107], a[132:135], a[84:87], v[104:107]
    s_waitcnt lgkmcnt(10)
    ds_read_b128 a[196:199], v17 offset:33792
    v_exp_f32 v97, v97
    v_mfma_f32_16x16x32_bf16 v[104:107], a[136:139], a[88:91], v[104:107]
    s_waitcnt lgkmcnt(10)
    ds_read_b128 a[200:203], v17 offset:34816
    v_exp_f32 v98, v98
    v_mfma_f32_16x16x32_bf16 v[104:107], a[140:143], a[92:95], v[104:107]
    ds_read_b128 a[204:207], v17 offset:35840
    v_exp_f32 v99, v99
    v_mfma_f32_16x16x32_bf16 v[108:111], a[144:147], a[80:83], v[108:111]
    ds_read_b128 a[208:211], v17 offset:36864
    v_exp_f32 v100, v100
    v_mfma_f32_16x16x32_bf16 v[108:111], a[148:151], a[84:87], v[108:111]
    ds_read_b128 a[212:215], v17 offset:37888
    v_exp_f32 v101, v101
    v_mfma_f32_16x16x32_bf16 v[108:111], a[152:155], a[88:91], v[108:111]
    ds_read_b128 a[216:219], v17 offset:38912
    v_exp_f32 v102, v102
    v_mfma_f32_16x16x32_bf16 v[108:111], a[156:159], a[92:95], v[108:111]
    s_waitcnt lgkmcnt(14)
    ds_read_b128 a[220:223], v17 offset:39936
    v_exp_f32 v103, v103
    v_mfma_f32_16x16x32_bf16 v[112:115], a[128:131], a[96:99], v[72:75]
    s_waitcnt lgkmcnt(14)
    ds_read_b128 a[224:227], v17 offset:40960
    v_exp_f32 v104, v104
    v_mfma_f32_16x16x32_bf16 v[112:115], a[132:135], a[100:103], v[112:115]
    s_waitcnt lgkmcnt(14)
    ds_read_b128 a[228:231], v17 offset:41984
    v_exp_f32 v105, v105
    v_mfma_f32_16x16x32_bf16 v[112:115], a[136:139], a[104:107], v[112:115]
    s_waitcnt lgkmcnt(14)
    ds_read_b128 a[232:235], v17 offset:43008
    v_exp_f32 v106, v106
    v_mfma_f32_16x16x32_bf16 v[112:115], a[140:143], a[108:111], v[112:115]
    s_waitcnt lgkmcnt(14)
    ds_read_b128 a[236:239], v17 offset:44032
    v_exp_f32 v107, v107
    v_mfma_f32_16x16x32_bf16 v[120:123], a[128:131], a[112:115], v[76:79]
    s_waitcnt lgkmcnt(14)
    ds_read_b128 a[240:243], v17 offset:45056
    v_exp_f32 v108, v108
    v_mfma_f32_16x16x32_bf16 v[120:123], a[132:135], a[116:119], v[120:123]
    s_waitcnt lgkmcnt(14)
    ds_read_b128 a[244:247], v17 offset:46080
    v_exp_f32 v109, v109
    v_mfma_f32_16x16x32_bf16 v[120:123], a[136:139], a[120:123], v[120:123]
    s_waitcnt lgkmcnt(14)
    ds_read_b128 a[248:251], v17 offset:47104
    v_exp_f32 v110, v110
    v_mfma_f32_16x16x32_bf16 v[120:123], a[140:143], a[124:127], v[120:123]
    ds_read_b128 a[252:255], v17 offset:48128
    v_exp_f32 v111, v111
    v_mfma_f32_16x16x32_bf16 v[116:119], a[144:147], a[96:99], v[72:75]
    ds_read_b128 a[128:131], v18 offset:16384
    v_cvt_pk_bf16_f32 v48, v96, v97
    v_mfma_f32_16x16x32_bf16 v[116:119], a[148:151], a[100:103], v[116:119]
    ds_read_b128 a[132:135], v18 offset:17408
    v_cvt_pk_bf16_f32 v49, v98, v99
    v_mfma_f32_16x16x32_bf16 v[116:119], a[152:155], a[104:107], v[116:119]
    ds_read_b128 a[136:139], v18 offset:18432
    v_cvt_pk_bf16_f32 v50, v100, v101
    v_mfma_f32_16x16x32_bf16 v[116:119], a[156:159], a[108:111], v[116:119]
    ds_read_b128 a[140:143], v18 offset:19456
    v_cvt_pk_bf16_f32 v51, v102, v103
    v_mfma_f32_16x16x32_bf16 v[124:127], a[144:147], a[112:115], v[76:79]
    ds_read_b128 a[144:147], v18 offset:20480
    v_cvt_pk_bf16_f32 v52, v104, v105
    v_mfma_f32_16x16x32_bf16 v[124:127], a[148:151], a[116:119], v[124:127]
    ds_read_b128 a[148:151], v18 offset:21504
    v_cvt_pk_bf16_f32 v53, v106, v107
    v_mfma_f32_16x16x32_bf16 v[124:127], a[152:155], a[120:123], v[124:127]
    ds_read_b128 a[152:155], v18 offset:22528
    v_cvt_pk_bf16_f32 v54, v108, v109
    v_mfma_f32_16x16x32_bf16 v[124:127], a[156:159], a[124:127], v[124:127]
    ds_read_b128 a[156:159], v18 offset:23552
    v_cvt_pk_bf16_f32 v55, v110, v111
    v_xor_b32 v18, 196608, v18
    v_lshrrev_b32 v17, 4, v2
    v_lshlrev_b32 v17, 15, v17
    v_and_b32 v14, 255, v1
    v_add_u32 v17, v17, v14
L_t1_p1:
    s_waitcnt vmcnt(8) lgkmcnt(0)
    s_barrier
    s_cmp_eq_u32 s60, 0
    s_cbranch_scc1 L_t1_zero
    v_mfma_f32_16x16x32_bf16 v[96:99], a[128:131], a[64:67], v[64:67]
    s_add_u32 m0, s15, 0
    ds_read_b128 a[160:163], v19 offset:0
    v_mfma_f32_16x16x32_bf16 v[96:99], a[132:135], a[68:71], v[96:99]
    ds_read_b128 a[164:167], v19 offset:1024
    v_mfma_f32_16x16x32_bf16 v[96:99], a[136:139], a[72:75], v[96:99]
    v_exp_f32 v112, v112
    v_mfma_f32_16x16x32_bf16 v[96:99], a[140:143], a[76:79], v[96:99]
    buffer_load_dwordx4 v1, s[8:11], s82 offen offset:0 lds
    v_mfma_f32_16x16x32_bf16 v[104:107], a[128:131], a[80:83], v[68:71]
    v_exp_f32 v113, v113
    v_mfma_f32_16x16x32_bf16 v[104:107], a[132:135], a[84:87], v[104:107]
    ds_read_b128 a[168:171], v19 offset:2048
    v_cvt_pk_bf16_f32 v56, v112, v113
    v_mfma_f32_16x16x32_bf16 v[104:107], a[136:139], a[88:91], v[104:107]
    v_exp_f32 v114, v114
    v_mfma_f32_16x16x32_bf16 v[104:107], a[140:143], a[92:95], v[104:107]
    buffer_load_dwordx4 v1, s[8:11], s82 offen offset:1024 lds
    v_mfma_f32_16x16x32_bf16 v[100:103], a[144:147], a[64:67], v[64:67]
    v_exp_f32 v115, v115
    v_mfma_f32_16x16x32_bf16 v[100:103], a[148:151], a[68:71], v[100:103]
    ds_read_b128 a[172:175], v19 offset:3072
    v_cvt_pk_bf16_f32 v57, v114, v115
    v_mfma_f32_16x16x32_bf16 v[100:103], a[152:155], a[72:75], v[100:103]
    v_exp_f32 v116, v116
    v_mfma_f32_16x16x32_bf16 v[100:103], a[156:159], a[76:79], v[100:103]
    buffer_load_dwordx4 v1, s[8:11], s82 offen offset:2048 lds
    v_mfma_f32_16x16x32_bf16 v[108:111], a[144:147], a[80:83], v[68:71]
    v_exp_f32 v117, v117
    v_mfma_f32_16x16x32_bf16 v[108:111], a[148:151], a[84:87], v[108:111]
    ds_read_b128 a[176:179], v20 offset:4096
    v_cvt_pk_bf16_f32 v58, v116, v117
    v_mfma_f32_16x16x32_bf16 v[108:111], a[152:155], a[88:91], v[108:111]
    v_exp_f32 v118, v118
    v_mfma_f32_16x16x32_bf16 v[108:111], a[156:159], a[92:95], v[108:111]
    buffer_load_dwordx4 v1, s[8:11], s82 offen offset:3072 lds
    v_mfma_f32_16x16x32_bf16 v[32:35], v[28:31], v[48:51], 0
    s_add_u32 m0, s15, 4096
    v_exp_f32 v119, v119
    v_mfma_f32_16x16x32_bf16 v[36:39], v[28:31], v[52:55], 0
    s_waitcnt lgkmcnt(4)
    ds_read_b128 a[180:183], v20 offset:5120
    v_cvt_pk_bf16_f32 v59, v118, v119
    v_mfma_f32_16x16x32_bf16 v[128:131], a[160:163], v[48:51], 0
    v_exp_f32 v120, v120
    v_mfma_f32_16x16x32_bf16 v[160:163], a[160:163], v[52:55], 0
    s_waitcnt lgkmcnt(4)
    v_mfma_f32_16x16x32_bf16 v[132:135], a[164:167], v[48:51], 0
    v_exp_f32 v121, v121
    v_mfma_f32_16x16x32_bf16 v[164:167], a[164:167], v[52:55], 0
    s_waitcnt lgkmcnt(3)
    ds_read_b128 a[184:187], v20 offset:6144
    v_cvt_pk_bf16_f32 v60, v120, v121
    v_mfma_f32_16x16x32_bf16 v[136:139], a[168:171], v[48:51], 0
    s_waitcnt lgkmcnt(3)
    v_exp_f32 v122, v122
    v_mfma_f32_16x16x32_bf16 v[168:171], a[168:171], v[52:55], 0
    buffer_load_dwordx4 v15, s[8:11], s82 offen offset:0 lds
    v_mfma_f32_16x16x32_bf16 v[140:143], a[172:175], v[48:51], 0
    v_exp_f32 v123, v123
    v_mfma_f32_16x16x32_bf16 v[172:175], a[172:175], v[52:55], 0
    s_waitcnt lgkmcnt(2)
    ds_read_b128 a[188:191], v20 offset:7168
    v_cvt_pk_bf16_f32 v61, v122, v123
    v_mfma_f32_16x16x32_bf16 v[144:147], a[176:179], v[48:51], 0
    s_waitcnt lgkmcnt(2)
    v_exp_f32 v124, v124
    v_mfma_f32_16x16x32_bf16 v[176:179], a[176:179], v[52:55], 0
    buffer_load_dwordx4 v15, s[8:11], s82 offen offset:1024 lds
    v_mfma_f32_16x16x32_bf16 v[148:151], a[180:183], v[48:51], 0
    v_exp_f32 v125, v125
    v_mfma_f32_16x16x32_bf16 v[180:183], a[180:183], v[52:55], 0
    s_waitcnt lgkmcnt(1)
    v_cvt_pk_bf16_f32 v62, v124, v125
    v_mfma_f32_16x16x32_bf16 v[152:155], a[184:187], v[48:51], 0
    s_waitcnt lgkmcnt(0)
    v_exp_f32 v126, v126
    v_mfma_f32_16x16x32_bf16 v[184:187], a[184:187], v[52:55], 0
    buffer_load_dwordx4 v15, s[8:11], s82 offen offset:2048 lds
    v_mfma_f32_16x16x32_bf16 v[156:159], a[188:191], v[48:51], 0
    v_exp_f32 v127, v127
    v_mfma_f32_16x16x32_bf16 v[188:191], a[188:191], v[52:55], 0
    v_cvt_pk_bf16_f32 v63, v126, v127
    v_mfma_f32_16x16x32_bf16 v[112:115], a[128:131], a[96:99], v[72:75]
    v_mfma_f32_16x16x32_bf16 v[112:115], a[132:135], a[100:103], v[112:115]
    v_mfma_f32_16x16x32_bf16 v[112:115], a[136:139], a[104:107], v[112:115]
    v_exp_f32 v96, v96
    v_mfma_f32_16x16x32_bf16 v[112:115], a[140:143], a[108:111], v[112:115]
    buffer_load_dwordx4 v15, s[8:11], s82 offen offset:3072 lds
    v_mfma_f32_16x16x32_bf16 v[120:123], a[128:131], a[112:115], v[76:79]
    s_xor_b32 s15, s15, 196608
    v_exp_f32 v97, v97
    v_mfma_f32_16x16x32_bf16 v[120:123], a[132:135], a[116:119], v[120:123]
    s_add_u32 m0, s16, 0
    ds_read_b128 a[128:131], v18 offset:0
    v_cvt_pk_bf16_f32 v48, v96, v97
    v_mfma_f32_16x16x32_bf16 v[120:123], a[136:139], a[120:123], v[120:123]
    v_exp_f32 v98, v98
    v_mfma_f32_16x16x32_bf16 v[120:123], a[140:143], a[124:127], v[120:123]
    buffer_load_dwordx4 v1, s[8:11], s19 offen offset:0 lds
    v_mfma_f32_16x16x32_bf16 v[116:119], a[144:147], a[96:99], v[72:75]
    v_exp_f32 v99, v99
    v_mfma_f32_16x16x32_bf16 v[116:119], a[148:151], a[100:103], v[116:119]
    ds_read_b128 a[132:135], v18 offset:1024
    v_cvt_pk_bf16_f32 v49, v98, v99
    v_mfma_f32_16x16x32_bf16 v[116:119], a[152:155], a[104:107], v[116:119]
    v_exp_f32 v100, v100
    v_mfma_f32_16x16x32_bf16 v[116:119], a[156:159], a[108:111], v[116:119]
    buffer_load_dwordx4 v1, s[8:11], s19 offen offset:1024 lds
    v_mfma_f32_16x16x32_bf16 v[124:127], a[144:147], a[112:115], v[76:79]
    v_exp_f32 v101, v101
    v_mfma_f32_16x16x32_bf16 v[124:127], a[148:151], a[116:119], v[124:127]
    ds_read_b128 a[136:139], v18 offset:2048
    v_cvt_pk_bf16_f32 v50, v100, v101
    v_mfma_f32_16x16x32_bf16 v[124:127], a[152:155], a[120:123], v[124:127]
    v_exp_f32 v102, v102
    v_mfma_f32_16x16x32_bf16 v[124:127], a[156:159], a[124:127], v[124:127]
    buffer_load_dwordx4 v1, s[8:11], s19 offen offset:2048 lds
    v_mfma_f32_16x16x32_bf16 v[40:43], v[28:31], v[56:59], 0
    v_exp_f32 v103, v103
    v_mfma_f32_16x16x32_bf16 v[44:47], v[28:31], v[60:63], 0
    ds_read_b128 a[140:143], v18 offset:3072
    v_cvt_pk_bf16_f32 v51, v102, v103
    v_mfma_f32_16x16x32_bf16 v[192:195], a[160:163], v[56:59], 0
    v_exp_f32 v104, v104
    v_mfma_f32_16x16x32_bf16 v[224:227], a[160:163], v[60:63], 0
    v_mfma_f32_16x16x32_bf16 v[196:199], a[164:167], v[56:59], 0
    v_exp_f32 v105, v105
    v_mfma_f32_16x16x32_bf16 v[228:231], a[164:167], v[60:63], 0
    ds_read_b128 a[144:147], v18 offset:4096
    v_cvt_pk_bf16_f32 v52, v104, v105
    v_mfma_f32_16x16x32_bf16 v[200:203], a[168:171], v[56:59], 0
    v_exp_f32 v106, v106
    v_mfma_f32_16x16x32_bf16 v[232:235], a[168:171], v[60:63], 0
    buffer_load_dwordx4 v1, s[8:11], s19 offen offset:3072 lds
    v_mfma_f32_16x16x32_bf16 v[204:207], a[172:175], v[56:59], 0
    s_add_u32 m0, s16, 4096
    v_exp_f32 v107, v107
    v_mfma_f32_16x16x32_bf16 v[236:239], a[172:175], v[60:63], 0
    ds_read_b128 a[148:151], v18 offset:5120
    v_cvt_pk_bf16_f32 v53, v106, v107
    v_mfma_f32_16x16x32_bf16 v[208:211], a[176:179], v[56:59], 0
    v_exp_f32 v108, v108
    v_mfma_f32_16x16x32_bf16 v[240:243], a[176:179], v[60:63], 0
    buffer_load_dwordx4 v15, s[8:11], s19 offen offset:0 lds
    v_mfma_f32_16x16x32_bf16 v[212:215], a[180:183], v[56:59], 0
    v_exp_f32 v109, v109
    v_mfma_f32_16x16x32_bf16 v[244:247], a[180:183], v[60:63], 0
    ds_read_b128 a[152:155], v18 offset:6144
    v_cvt_pk_bf16_f32 v54, v108, v109
    v_mfma_f32_16x16x32_bf16 v[216:219], a[184:187], v[56:59], 0
    v_exp_f32 v110, v110
    v_mfma_f32_16x16x32_bf16 v[248:251], a[184:187], v[60:63], 0
    buffer_load_dwordx4 v15, s[8:11], s19 offen offset:1024 lds
    v_mfma_f32_16x16x32_bf16 v[220:223], a[188:191], v[56:59], 0
    v_exp_f32 v111, v111
    v_mfma_f32_16x16x32_bf16 v[252:255], a[188:191], v[60:63], 0
    ds_read_b128 a[156:159], v18 offset:7168
    v_cvt_pk_bf16_f32 v55, v110, v111
    s_cmp_eq_u32 s14, 0
    s_cbranch_scc1 L_t1_diag
.p2align 3
L_t1_loop:
    s_waitcnt lgkmcnt(7)
    v_mfma_f32_16x16x32_bf16 v[96:99], a[128:131], a[64:67], v[64:67]
    s_waitcnt lgkmcnt(6)
    ds_read_b128 a[160:163], v19 offset:16384
    v_mfma_f32_16x16x32_bf16 v[96:99], a[132:135], a[68:71], v[96:99]
    s_waitcnt lgkmcnt(6)
    ds_read_b128 a[164:167], v19 offset:17408
    v_mfma_f32_16x16x32_bf16 v[96:99], a[136:139], a[72:75], v[96:99]
    s_waitcnt lgkmcnt(6)
    v_exp_f32 v112, v112
    v_mfma_f32_16x16x32_bf16 v[96:99], a[140:143], a[76:79], v[96:99]
    buffer_load_dwordx4 v15, s[8:11], s19 offen offset:2048 lds
    v_mfma_f32_16x16x32_bf16 v[104:107], a[128:131], a[80:83], v[68:71]
    v_exp_f32 v113, v113
    v_mfma_f32_16x16x32_bf16 v[104:107], a[132:135], a[84:87], v[104:107]
    ds_read_b128 a[168:171], v19 offset:18432
    v_cvt_pk_bf16_f32 v56, v112, v113
    v_mfma_f32_16x16x32_bf16 v[104:107], a[136:139], a[88:91], v[104:107]
    s_waitcnt lgkmcnt(6)
    v_exp_f32 v114, v114
    v_mfma_f32_16x16x32_bf16 v[104:107], a[140:143], a[92:95], v[104:107]
    buffer_load_dwordx4 v15, s[8:11], s19 offen offset:3072 lds
    v_mfma_f32_16x16x32_bf16 v[100:103], a[144:147], a[64:67], v[64:67]
    s_waitcnt lgkmcnt(5)
    s_xor_b32 s16, s16, 98304
    v_exp_f32 v115, v115
    v_mfma_f32_16x16x32_bf16 v[100:103], a[148:151], a[68:71], v[100:103]
    s_waitcnt lgkmcnt(4)
    ds_read_b128 a[172:175], v19 offset:19456
    v_cvt_pk_bf16_f32 v57, v114, v115
    v_mfma_f32_16x16x32_bf16 v[100:103], a[152:155], a[72:75], v[100:103]
    s_waitcnt lgkmcnt(4)
    v_exp_f32 v116, v116
    v_mfma_f32_16x16x32_bf16 v[100:103], a[156:159], a[76:79], v[100:103]
    v_mfma_f32_16x16x32_bf16 v[108:111], a[144:147], a[80:83], v[68:71]
    v_exp_f32 v117, v117
    v_mfma_f32_16x16x32_bf16 v[108:111], a[148:151], a[84:87], v[108:111]
    ds_read_b128 a[176:179], v20 offset:20480
    v_cvt_pk_bf16_f32 v58, v116, v117
    v_mfma_f32_16x16x32_bf16 v[108:111], a[152:155], a[88:91], v[108:111]
    v_exp_f32 v118, v118
    v_mfma_f32_16x16x32_bf16 v[108:111], a[156:159], a[92:95], v[108:111]
    v_mfma_f32_16x16x32_bf16 v[32:35], v[28:31], v[48:51], v[32:35]
    v_exp_f32 v119, v119
    v_mfma_f32_16x16x32_bf16 v[36:39], v[28:31], v[52:55], v[36:39]
    s_waitcnt lgkmcnt(4)
    ds_read_b128 a[180:183], v20 offset:21504
    v_cvt_pk_bf16_f32 v59, v118, v119
    v_mfma_f32_16x16x32_bf16 v[128:131], a[160:163], v[48:51], v[128:131]
    v_exp_f32 v120, v120
    v_mfma_f32_16x16x32_bf16 v[160:163], a[160:163], v[52:55], v[160:163]
    s_waitcnt lgkmcnt(4)
    v_mfma_f32_16x16x32_bf16 v[132:135], a[164:167], v[48:51], v[132:135]
    v_exp_f32 v121, v121
    v_mfma_f32_16x16x32_bf16 v[164:167], a[164:167], v[52:55], v[164:167]
    s_waitcnt lgkmcnt(3)
    ds_read_b128 a[184:187], v20 offset:22528
    v_cvt_pk_bf16_f32 v60, v120, v121
    v_mfma_f32_16x16x32_bf16 v[136:139], a[168:171], v[48:51], v[136:139]
    v_exp_f32 v122, v122
    v_mfma_f32_16x16x32_bf16 v[168:171], a[168:171], v[52:55], v[168:171]
    s_waitcnt lgkmcnt(3)
    v_mfma_f32_16x16x32_bf16 v[140:143], a[172:175], v[48:51], v[140:143]
    v_exp_f32 v123, v123
    v_mfma_f32_16x16x32_bf16 v[172:175], a[172:175], v[52:55], v[172:175]
    s_waitcnt lgkmcnt(2)
    ds_read_b128 a[188:191], v20 offset:23552
    v_cvt_pk_bf16_f32 v61, v122, v123
    v_mfma_f32_16x16x32_bf16 v[144:147], a[176:179], v[48:51], v[144:147]
    v_exp_f32 v124, v124
    v_mfma_f32_16x16x32_bf16 v[176:179], a[176:179], v[52:55], v[176:179]
    s_waitcnt lgkmcnt(2)
    v_mfma_f32_16x16x32_bf16 v[148:151], a[180:183], v[48:51], v[148:151]
    v_exp_f32 v125, v125
    v_mfma_f32_16x16x32_bf16 v[180:183], a[180:183], v[52:55], v[180:183]
    s_waitcnt lgkmcnt(1)
    v_cvt_pk_bf16_f32 v62, v124, v125
    v_xor_b32 v19, 98304, v19
    v_mfma_f32_16x16x32_bf16 v[152:155], a[184:187], v[48:51], v[152:155]
    v_exp_f32 v126, v126
    v_mfma_f32_16x16x32_bf16 v[184:187], a[184:187], v[52:55], v[184:187]
    s_waitcnt lgkmcnt(0)
    v_xor_b32 v20, 98304, v20
    v_mfma_f32_16x16x32_bf16 v[156:159], a[188:191], v[48:51], v[156:159]
    v_exp_f32 v127, v127
    v_mfma_f32_16x16x32_bf16 v[188:191], a[188:191], v[52:55], v[188:191]
    v_cvt_pk_bf16_f32 v63, v126, v127
    v_mfma_f32_16x16x32_bf16 v[112:115], a[128:131], a[96:99], v[72:75]
    v_exp_f32 v96, v96
    v_mfma_f32_16x16x32_bf16 v[112:115], a[132:135], a[100:103], v[112:115]
    v_mfma_f32_16x16x32_bf16 v[112:115], a[136:139], a[104:107], v[112:115]
    v_exp_f32 v97, v97
    v_mfma_f32_16x16x32_bf16 v[112:115], a[140:143], a[108:111], v[112:115]
    v_cvt_pk_bf16_f32 v48, v96, v97
    v_mfma_f32_16x16x32_bf16 v[120:123], a[128:131], a[112:115], v[76:79]
    v_exp_f32 v98, v98
    v_mfma_f32_16x16x32_bf16 v[120:123], a[132:135], a[116:119], v[120:123]
    v_mfma_f32_16x16x32_bf16 v[120:123], a[136:139], a[120:123], v[120:123]
    v_exp_f32 v99, v99
    v_mfma_f32_16x16x32_bf16 v[120:123], a[140:143], a[124:127], v[120:123]
    v_mfma_f32_16x16x32_bf16 v[116:119], a[144:147], a[96:99], v[72:75]
    v_exp_f32 v100, v100
    v_mfma_f32_16x16x32_bf16 v[116:119], a[148:151], a[100:103], v[116:119]
    ds_read_b128 a[128:131], v18 offset:16384
    v_cvt_pk_bf16_f32 v49, v98, v99
    v_mfma_f32_16x16x32_bf16 v[116:119], a[152:155], a[104:107], v[116:119]
    s_add_u32 s19, s82, 32768
    v_exp_f32 v101, v101
    v_mfma_f32_16x16x32_bf16 v[116:119], a[156:159], a[108:111], v[116:119]
    s_sub_u32 s82, s12, s13
    ds_read_b128 a[132:135], v18 offset:17408
    v_cvt_pk_bf16_f32 v50, v100, v101
    v_mfma_f32_16x16x32_bf16 v[124:127], a[144:147], a[112:115], v[76:79]
    s_sub_u32 s82, s82, 1
    v_exp_f32 v102, v102
    v_mfma_f32_16x16x32_bf16 v[124:127], a[148:151], a[116:119], v[124:127]
    s_cmp_gt_u32 s12, s13
    s_cselect_b32 s82, s82, s12
    s_lshl_b32 s82, s82, 16
    ds_read_b128 a[136:139], v18 offset:18432
    v_mfma_f32_16x16x32_bf16 v[124:127], a[152:155], a[120:123], v[124:127]
    s_add_u32 s82, s82, s81
    v_exp_f32 v103, v103
    v_mfma_f32_16x16x32_bf16 v[124:127], a[156:159], a[124:127], v[124:127]
    s_cmp_ge_u32 s12, 17
    s_cselect_b32 s82, 2147471360, s82
    ds_read_b128 a[140:143], v18 offset:19456
    v_cvt_pk_bf16_f32 v51, v102, v103
    v_mfma_f32_16x16x32_bf16 v[40:43], v[28:31], v[56:59], v[40:43]
    s_add_u32 s12, s12, 1
    v_exp_f32 v104, v104
    v_mfma_f32_16x16x32_bf16 v[44:47], v[28:31], v[60:63], v[44:47]
    ds_read_b128 a[144:147], v18 offset:20480
    v_mfma_f32_16x16x32_bf16 v[192:195], a[160:163], v[56:59], v[192:195]
    v_exp_f32 v105, v105
    v_mfma_f32_16x16x32_bf16 v[224:227], a[160:163], v[60:63], v[224:227]
    ds_read_b128 a[148:151], v18 offset:21504
    v_cvt_pk_bf16_f32 v52, v104, v105
    v_mfma_f32_16x16x32_bf16 v[196:199], a[164:167], v[56:59], v[196:199]
    v_exp_f32 v106, v106
    v_mfma_f32_16x16x32_bf16 v[228:231], a[164:167], v[60:63], v[228:231]
    ds_read_b128 a[152:155], v18 offset:22528
    v_mfma_f32_16x16x32_bf16 v[200:203], a[168:171], v[56:59], v[200:203]
    v_exp_f32 v107, v107
    v_mfma_f32_16x16x32_bf16 v[232:235], a[168:171], v[60:63], v[232:235]
    ds_read_b128 a[156:159], v18 offset:23552
    v_cvt_pk_bf16_f32 v53, v106, v107
    v_mfma_f32_16x16x32_bf16 v[204:207], a[172:175], v[56:59], v[204:207]
    v_exp_f32 v108, v108
    v_mfma_f32_16x16x32_bf16 v[236:239], a[172:175], v[60:63], v[236:239]
    v_mfma_f32_16x16x32_bf16 v[208:211], a[176:179], v[56:59], v[208:211]
    v_exp_f32 v109, v109
    v_mfma_f32_16x16x32_bf16 v[240:243], a[176:179], v[60:63], v[240:243]
    v_cvt_pk_bf16_f32 v54, v108, v109
    v_xor_b32 v18, 196608, v18
    v_mfma_f32_16x16x32_bf16 v[212:215], a[180:183], v[56:59], v[212:215]
    v_exp_f32 v110, v110
    v_mfma_f32_16x16x32_bf16 v[244:247], a[180:183], v[60:63], v[244:247]
    v_mfma_f32_16x16x32_bf16 v[216:219], a[184:187], v[56:59], v[216:219]
    v_exp_f32 v111, v111
    v_mfma_f32_16x16x32_bf16 v[248:251], a[184:187], v[60:63], v[248:251]
    v_cvt_pk_bf16_f32 v55, v110, v111
    v_mfma_f32_16x16x32_bf16 v[220:223], a[188:191], v[56:59], v[220:223]
    v_mfma_f32_16x16x32_bf16 v[252:255], a[188:191], v[60:63], v[252:255]
    s_waitcnt vmcnt(0) lgkmcnt(0)
    s_barrier
    v_mfma_f32_16x16x32_bf16 v[96:99], a[128:131], a[64:67], v[64:67]
    s_add_u32 m0, s15, 0
    ds_read_b128 a[160:163], v19 offset:0
    v_mfma_f32_16x16x32_bf16 v[96:99], a[132:135], a[68:71], v[96:99]
    ds_read_b128 a[164:167], v19 offset:1024
    v_mfma_f32_16x16x32_bf16 v[96:99], a[136:139], a[72:75], v[96:99]
    v_exp_f32 v112, v112
    v_mfma_f32_16x16x32_bf16 v[96:99], a[140:143], a[76:79], v[96:99]
    buffer_load_dwordx4 v1, s[8:11], s82 offen offset:0 lds
    v_mfma_f32_16x16x32_bf16 v[104:107], a[128:131], a[80:83], v[68:71]
    v_exp_f32 v113, v113
    v_mfma_f32_16x16x32_bf16 v[104:107], a[132:135], a[84:87], v[104:107]
    ds_read_b128 a[168:171], v19 offset:2048
    v_cvt_pk_bf16_f32 v56, v112, v113
    v_mfma_f32_16x16x32_bf16 v[104:107], a[136:139], a[88:91], v[104:107]
    v_exp_f32 v114, v114
    v_mfma_f32_16x16x32_bf16 v[104:107], a[140:143], a[92:95], v[104:107]
    buffer_load_dwordx4 v1, s[8:11], s82 offen offset:1024 lds
    v_mfma_f32_16x16x32_bf16 v[100:103], a[144:147], a[64:67], v[64:67]
    v_exp_f32 v115, v115
    v_mfma_f32_16x16x32_bf16 v[100:103], a[148:151], a[68:71], v[100:103]
    ds_read_b128 a[172:175], v19 offset:3072
    v_cvt_pk_bf16_f32 v57, v114, v115
    v_mfma_f32_16x16x32_bf16 v[100:103], a[152:155], a[72:75], v[100:103]
    v_exp_f32 v116, v116
    v_mfma_f32_16x16x32_bf16 v[100:103], a[156:159], a[76:79], v[100:103]
    buffer_load_dwordx4 v1, s[8:11], s82 offen offset:2048 lds
    v_mfma_f32_16x16x32_bf16 v[108:111], a[144:147], a[80:83], v[68:71]
    v_exp_f32 v117, v117
    v_mfma_f32_16x16x32_bf16 v[108:111], a[148:151], a[84:87], v[108:111]
    ds_read_b128 a[176:179], v20 offset:4096
    v_cvt_pk_bf16_f32 v58, v116, v117
    v_mfma_f32_16x16x32_bf16 v[108:111], a[152:155], a[88:91], v[108:111]
    v_exp_f32 v118, v118
    v_mfma_f32_16x16x32_bf16 v[108:111], a[156:159], a[92:95], v[108:111]
    buffer_load_dwordx4 v1, s[8:11], s82 offen offset:3072 lds
    v_mfma_f32_16x16x32_bf16 v[32:35], v[28:31], v[48:51], v[32:35]
    s_add_u32 m0, s15, 4096
    v_exp_f32 v119, v119
    v_mfma_f32_16x16x32_bf16 v[36:39], v[28:31], v[52:55], v[36:39]
    s_waitcnt lgkmcnt(4)
    ds_read_b128 a[180:183], v20 offset:5120
    v_cvt_pk_bf16_f32 v59, v118, v119
    v_mfma_f32_16x16x32_bf16 v[128:131], a[160:163], v[48:51], v[128:131]
    v_exp_f32 v120, v120
    v_mfma_f32_16x16x32_bf16 v[160:163], a[160:163], v[52:55], v[160:163]
    s_waitcnt lgkmcnt(4)
    v_mfma_f32_16x16x32_bf16 v[132:135], a[164:167], v[48:51], v[132:135]
    v_exp_f32 v121, v121
    v_mfma_f32_16x16x32_bf16 v[164:167], a[164:167], v[52:55], v[164:167]
    s_waitcnt lgkmcnt(3)
    ds_read_b128 a[184:187], v20 offset:6144
    v_cvt_pk_bf16_f32 v60, v120, v121
    v_mfma_f32_16x16x32_bf16 v[136:139], a[168:171], v[48:51], v[136:139]
    s_waitcnt lgkmcnt(3)
    v_exp_f32 v122, v122
    v_mfma_f32_16x16x32_bf16 v[168:171], a[168:171], v[52:55], v[168:171]
    buffer_load_dwordx4 v15, s[8:11], s82 offen offset:0 lds
    v_mfma_f32_16x16x32_bf16 v[140:143], a[172:175], v[48:51], v[140:143]
    v_exp_f32 v123, v123
    v_mfma_f32_16x16x32_bf16 v[172:175], a[172:175], v[52:55], v[172:175]
    s_waitcnt lgkmcnt(2)
    ds_read_b128 a[188:191], v20 offset:7168
    v_cvt_pk_bf16_f32 v61, v122, v123
    v_mfma_f32_16x16x32_bf16 v[144:147], a[176:179], v[48:51], v[144:147]
    s_waitcnt lgkmcnt(2)
    v_exp_f32 v124, v124
    v_mfma_f32_16x16x32_bf16 v[176:179], a[176:179], v[52:55], v[176:179]
    buffer_load_dwordx4 v15, s[8:11], s82 offen offset:1024 lds
    v_mfma_f32_16x16x32_bf16 v[148:151], a[180:183], v[48:51], v[148:151]
    v_exp_f32 v125, v125
    v_mfma_f32_16x16x32_bf16 v[180:183], a[180:183], v[52:55], v[180:183]
    s_waitcnt lgkmcnt(1)
    v_cvt_pk_bf16_f32 v62, v124, v125
    v_mfma_f32_16x16x32_bf16 v[152:155], a[184:187], v[48:51], v[152:155]
    s_waitcnt lgkmcnt(0)
    v_exp_f32 v126, v126
    v_mfma_f32_16x16x32_bf16 v[184:187], a[184:187], v[52:55], v[184:187]
    buffer_load_dwordx4 v15, s[8:11], s82 offen offset:2048 lds
    v_mfma_f32_16x16x32_bf16 v[156:159], a[188:191], v[48:51], v[156:159]
    v_exp_f32 v127, v127
    v_mfma_f32_16x16x32_bf16 v[188:191], a[188:191], v[52:55], v[188:191]
    v_cvt_pk_bf16_f32 v63, v126, v127
    v_mfma_f32_16x16x32_bf16 v[112:115], a[128:131], a[96:99], v[72:75]
    v_mfma_f32_16x16x32_bf16 v[112:115], a[132:135], a[100:103], v[112:115]
    v_mfma_f32_16x16x32_bf16 v[112:115], a[136:139], a[104:107], v[112:115]
    v_exp_f32 v96, v96
    v_mfma_f32_16x16x32_bf16 v[112:115], a[140:143], a[108:111], v[112:115]
    buffer_load_dwordx4 v15, s[8:11], s82 offen offset:3072 lds
    v_mfma_f32_16x16x32_bf16 v[120:123], a[128:131], a[112:115], v[76:79]
    s_xor_b32 s15, s15, 196608
    v_exp_f32 v97, v97
    v_mfma_f32_16x16x32_bf16 v[120:123], a[132:135], a[116:119], v[120:123]
    s_add_u32 m0, s16, 0
    ds_read_b128 a[128:131], v18 offset:0
    v_cvt_pk_bf16_f32 v48, v96, v97
    v_mfma_f32_16x16x32_bf16 v[120:123], a[136:139], a[120:123], v[120:123]
    v_exp_f32 v98, v98
    v_mfma_f32_16x16x32_bf16 v[120:123], a[140:143], a[124:127], v[120:123]
    buffer_load_dwordx4 v1, s[8:11], s19 offen offset:0 lds
    v_mfma_f32_16x16x32_bf16 v[116:119], a[144:147], a[96:99], v[72:75]
    v_exp_f32 v99, v99
    v_mfma_f32_16x16x32_bf16 v[116:119], a[148:151], a[100:103], v[116:119]
    ds_read_b128 a[132:135], v18 offset:1024
    v_cvt_pk_bf16_f32 v49, v98, v99
    v_mfma_f32_16x16x32_bf16 v[116:119], a[152:155], a[104:107], v[116:119]
    v_exp_f32 v100, v100
    v_mfma_f32_16x16x32_bf16 v[116:119], a[156:159], a[108:111], v[116:119]
    buffer_load_dwordx4 v1, s[8:11], s19 offen offset:1024 lds
    v_mfma_f32_16x16x32_bf16 v[124:127], a[144:147], a[112:115], v[76:79]
    v_exp_f32 v101, v101
    v_mfma_f32_16x16x32_bf16 v[124:127], a[148:151], a[116:119], v[124:127]
    ds_read_b128 a[136:139], v18 offset:2048
    v_cvt_pk_bf16_f32 v50, v100, v101
    v_mfma_f32_16x16x32_bf16 v[124:127], a[152:155], a[120:123], v[124:127]
    v_exp_f32 v102, v102
    v_mfma_f32_16x16x32_bf16 v[124:127], a[156:159], a[124:127], v[124:127]
    buffer_load_dwordx4 v1, s[8:11], s19 offen offset:2048 lds
    v_mfma_f32_16x16x32_bf16 v[40:43], v[28:31], v[56:59], v[40:43]
    v_exp_f32 v103, v103
    v_mfma_f32_16x16x32_bf16 v[44:47], v[28:31], v[60:63], v[44:47]
    ds_read_b128 a[140:143], v18 offset:3072
    v_cvt_pk_bf16_f32 v51, v102, v103
    v_mfma_f32_16x16x32_bf16 v[192:195], a[160:163], v[56:59], v[192:195]
    v_exp_f32 v104, v104
    v_mfma_f32_16x16x32_bf16 v[224:227], a[160:163], v[60:63], v[224:227]
    v_mfma_f32_16x16x32_bf16 v[196:199], a[164:167], v[56:59], v[196:199]
    v_exp_f32 v105, v105
    v_mfma_f32_16x16x32_bf16 v[228:231], a[164:167], v[60:63], v[228:231]
    ds_read_b128 a[144:147], v18 offset:4096
    v_cvt_pk_bf16_f32 v52, v104, v105
    v_mfma_f32_16x16x32_bf16 v[200:203], a[168:171], v[56:59], v[200:203]
    v_exp_f32 v106, v106
    v_mfma_f32_16x16x32_bf16 v[232:235], a[168:171], v[60:63], v[232:235]
    buffer_load_dwordx4 v1, s[8:11], s19 offen offset:3072 lds
    v_mfma_f32_16x16x32_bf16 v[204:207], a[172:175], v[56:59], v[204:207]
    s_add_u32 m0, s16, 4096
    v_exp_f32 v107, v107
    v_mfma_f32_16x16x32_bf16 v[236:239], a[172:175], v[60:63], v[236:239]
    ds_read_b128 a[148:151], v18 offset:5120
    v_cvt_pk_bf16_f32 v53, v106, v107
    v_mfma_f32_16x16x32_bf16 v[208:211], a[176:179], v[56:59], v[208:211]
    s_sub_u32 s14, s14, 1
    v_exp_f32 v108, v108
    v_mfma_f32_16x16x32_bf16 v[240:243], a[176:179], v[60:63], v[240:243]
    buffer_load_dwordx4 v15, s[8:11], s19 offen offset:0 lds
    v_mfma_f32_16x16x32_bf16 v[212:215], a[180:183], v[56:59], v[212:215]
    v_exp_f32 v109, v109
    v_mfma_f32_16x16x32_bf16 v[244:247], a[180:183], v[60:63], v[244:247]
    ds_read_b128 a[152:155], v18 offset:6144
    v_cvt_pk_bf16_f32 v54, v108, v109
    v_mfma_f32_16x16x32_bf16 v[216:219], a[184:187], v[56:59], v[216:219]
    v_exp_f32 v110, v110
    v_mfma_f32_16x16x32_bf16 v[248:251], a[184:187], v[60:63], v[248:251]
    buffer_load_dwordx4 v15, s[8:11], s19 offen offset:1024 lds
    v_mfma_f32_16x16x32_bf16 v[220:223], a[188:191], v[56:59], v[220:223]
    v_exp_f32 v111, v111
    v_mfma_f32_16x16x32_bf16 v[252:255], a[188:191], v[60:63], v[252:255]
    ds_read_b128 a[156:159], v18 offset:7168
    v_cvt_pk_bf16_f32 v55, v110, v111
    s_cmp_lg_u32 s14, 0
    s_cbranch_scc1 L_t1_loop
L_t1_diag:
    s_waitcnt lgkmcnt(7)
    v_mfma_f32_16x16x32_bf16 v[96:99], a[128:131], a[64:67], v[80:83]
    s_waitcnt lgkmcnt(6)
    ds_read_b128 a[160:163], v19 offset:16384
    v_mfma_f32_16x16x32_bf16 v[96:99], a[132:135], a[68:71], v[96:99]
    s_waitcnt lgkmcnt(6)
    ds_read_b128 a[164:167], v19 offset:17408
    v_mfma_f32_16x16x32_bf16 v[96:99], a[136:139], a[72:75], v[96:99]
    s_waitcnt lgkmcnt(6)
    v_exp_f32 v112, v112
    v_mfma_f32_16x16x32_bf16 v[96:99], a[140:143], a[76:79], v[96:99]
    buffer_load_dwordx4 v15, s[8:11], s19 offen offset:2048 lds
    v_mfma_f32_16x16x32_bf16 v[104:107], a[128:131], a[80:83], v[88:91]
    v_exp_f32 v113, v113
    v_mfma_f32_16x16x32_bf16 v[104:107], a[132:135], a[84:87], v[104:107]
    ds_read_b128 a[168:171], v19 offset:18432
    v_cvt_pk_bf16_f32 v56, v112, v113
    v_mfma_f32_16x16x32_bf16 v[104:107], a[136:139], a[88:91], v[104:107]
    s_waitcnt lgkmcnt(6)
    v_exp_f32 v114, v114
    v_mfma_f32_16x16x32_bf16 v[104:107], a[140:143], a[92:95], v[104:107]
    buffer_load_dwordx4 v15, s[8:11], s19 offen offset:3072 lds
    v_mfma_f32_16x16x32_bf16 v[100:103], a[144:147], a[64:67], v[84:87]
    s_waitcnt lgkmcnt(5)
    s_xor_b32 s16, s16, 98304
    v_exp_f32 v115, v115
    v_mfma_f32_16x16x32_bf16 v[100:103], a[148:151], a[68:71], v[100:103]
    s_waitcnt lgkmcnt(4)
    ds_read_b128 a[172:175], v19 offset:19456
    v_cvt_pk_bf16_f32 v57, v114, v115
    v_mfma_f32_16x16x32_bf16 v[100:103], a[152:155], a[72:75], v[100:103]
    s_waitcnt lgkmcnt(4)
    v_exp_f32 v116, v116
    v_mfma_f32_16x16x32_bf16 v[100:103], a[156:159], a[76:79], v[100:103]
    v_mfma_f32_16x16x32_bf16 v[108:111], a[144:147], a[80:83], v[92:95]
    v_exp_f32 v117, v117
    v_mfma_f32_16x16x32_bf16 v[108:111], a[148:151], a[84:87], v[108:111]
    ds_read_b128 a[176:179], v20 offset:20480
    v_cvt_pk_bf16_f32 v58, v116, v117
    v_mfma_f32_16x16x32_bf16 v[108:111], a[152:155], a[88:91], v[108:111]
    v_exp_f32 v118, v118
    v_mfma_f32_16x16x32_bf16 v[108:111], a[156:159], a[92:95], v[108:111]
    v_mfma_f32_16x16x32_bf16 v[32:35], v[28:31], v[48:51], v[32:35]
    v_exp_f32 v119, v119
    v_mfma_f32_16x16x32_bf16 v[36:39], v[28:31], v[52:55], v[36:39]
    s_waitcnt lgkmcnt(4)
    ds_read_b128 a[180:183], v20 offset:21504
    v_cvt_pk_bf16_f32 v59, v118, v119
    v_mfma_f32_16x16x32_bf16 v[128:131], a[160:163], v[48:51], v[128:131]
    v_exp_f32 v120, v120
    v_mfma_f32_16x16x32_bf16 v[160:163], a[160:163], v[52:55], v[160:163]
    s_waitcnt lgkmcnt(4)
    v_add_f32 v80, 0, v22
    v_min_f32 v80, v80, v72
    v_mfma_f32_16x16x32_bf16 v[132:135], a[164:167], v[48:51], v[132:135]
    v_exp_f32 v121, v121
    v_mfma_f32_16x16x32_bf16 v[164:167], a[164:167], v[52:55], v[164:167]
    s_waitcnt lgkmcnt(3)
    ds_read_b128 a[184:187], v20 offset:22528
    v_cvt_pk_bf16_f32 v60, v120, v121
    v_mfma_f32_16x16x32_bf16 v[136:139], a[168:171], v[48:51], v[136:139]
    v_exp_f32 v122, v122
    v_mfma_f32_16x16x32_bf16 v[168:171], a[168:171], v[52:55], v[168:171]
    s_waitcnt lgkmcnt(3)
    v_add_f32 v81, 0xf1800000, v22
    v_min_f32 v81, v81, v73
    v_mfma_f32_16x16x32_bf16 v[140:143], a[172:175], v[48:51], v[140:143]
    v_exp_f32 v123, v123
    v_mfma_f32_16x16x32_bf16 v[172:175], a[172:175], v[52:55], v[172:175]
    s_waitcnt lgkmcnt(2)
    ds_read_b128 a[188:191], v20 offset:23552
    v_cvt_pk_bf16_f32 v61, v122, v123
    v_mfma_f32_16x16x32_bf16 v[144:147], a[176:179], v[48:51], v[144:147]
    v_exp_f32 v124, v124
    v_mfma_f32_16x16x32_bf16 v[176:179], a[176:179], v[52:55], v[176:179]
    s_waitcnt lgkmcnt(2)
    v_add_f32 v82, 0xf2000000, v22
    v_min_f32 v82, v82, v74
    v_mfma_f32_16x16x32_bf16 v[148:151], a[180:183], v[48:51], v[148:151]
    v_exp_f32 v125, v125
    v_mfma_f32_16x16x32_bf16 v[180:183], a[180:183], v[52:55], v[180:183]
    s_waitcnt lgkmcnt(1)
    v_cvt_pk_bf16_f32 v62, v124, v125
    v_xor_b32 v19, 98304, v19
    v_mfma_f32_16x16x32_bf16 v[152:155], a[184:187], v[48:51], v[152:155]
    v_exp_f32 v126, v126
    v_mfma_f32_16x16x32_bf16 v[184:187], a[184:187], v[52:55], v[184:187]
    s_waitcnt lgkmcnt(0)
    v_xor_b32 v20, 98304, v20
    v_add_f32 v83, 0xf2400000, v22
    v_mfma_f32_16x16x32_bf16 v[156:159], a[188:191], v[48:51], v[156:159]
    v_exp_f32 v127, v127
    v_mfma_f32_16x16x32_bf16 v[188:191], a[188:191], v[52:55], v[188:191]
    v_cvt_pk_bf16_f32 v63, v126, v127
    v_min_f32 v83, v83, v75
    v_add_f32 v84, 0xf3800000, v22
    v_min_f32 v84, v84, v72
    v_mfma_f32_16x16x32_bf16 v[112:115], a[128:131], a[96:99], v[72:75]
    v_exp_f32 v96, v96
    v_mfma_f32_16x16x32_bf16 v[112:115], a[132:135], a[100:103], v[112:115]
    v_mfma_f32_16x16x32_bf16 v[112:115], a[136:139], a[104:107], v[112:115]
    v_exp_f32 v97, v97
    v_mfma_f32_16x16x32_bf16 v[112:115], a[140:143], a[108:111], v[112:115]
    v_cvt_pk_bf16_f32 v48, v96, v97
    v_add_f32 v85, 0xf3880000, v22
    v_mfma_f32_16x16x32_bf16 v[120:123], a[128:131], a[112:115], v[76:79]
    v_exp_f32 v98, v98
    v_mfma_f32_16x16x32_bf16 v[120:123], a[132:135], a[116:119], v[120:123]
    v_min_f32 v85, v85, v73
    v_add_f32 v86, 0xf3900000, v22
    v_mfma_f32_16x16x32_bf16 v[120:123], a[136:139], a[120:123], v[120:123]
    v_exp_f32 v99, v99
    v_mfma_f32_16x16x32_bf16 v[120:123], a[140:143], a[124:127], v[120:123]
    v_min_f32 v86, v86, v74
    v_add_f32 v87, 0xf3980000, v22
    v_mfma_f32_16x16x32_bf16 v[116:119], a[144:147], a[96:99], v[72:75]
    v_exp_f32 v100, v100
    v_mfma_f32_16x16x32_bf16 v[116:119], a[148:151], a[100:103], v[116:119]
    ds_read_b128 a[128:131], v18 offset:16384
    v_cvt_pk_bf16_f32 v49, v98, v99
    v_mfma_f32_16x16x32_bf16 v[116:119], a[152:155], a[104:107], v[116:119]
    s_add_u32 s19, s82, 32768
    v_exp_f32 v101, v101
    v_mfma_f32_16x16x32_bf16 v[116:119], a[156:159], a[108:111], v[116:119]
    s_sub_u32 s82, s12, s13
    ds_read_b128 a[132:135], v18 offset:17408
    v_cvt_pk_bf16_f32 v50, v100, v101
    v_mfma_f32_16x16x32_bf16 v[124:127], a[144:147], a[112:115], v[76:79]
    s_sub_u32 s82, s82, 1
    v_exp_f32 v102, v102
    v_mfma_f32_16x16x32_bf16 v[124:127], a[148:151], a[116:119], v[124:127]
    s_cmp_gt_u32 s12, s13
    s_cselect_b32 s82, s82, s12
    s_lshl_b32 s82, s82, 16
    ds_read_b128 a[136:139], v18 offset:18432
    v_mfma_f32_16x16x32_bf16 v[124:127], a[152:155], a[120:123], v[124:127]
    s_add_u32 s82, s82, s81
    v_exp_f32 v103, v103
    v_mfma_f32_16x16x32_bf16 v[124:127], a[156:159], a[124:127], v[124:127]
    s_cmp_ge_u32 s12, 17
    s_cselect_b32 s82, 2147471360, s82
    ds_read_b128 a[140:143], v18 offset:19456
    v_cvt_pk_bf16_f32 v51, v102, v103
    v_mfma_f32_16x16x32_bf16 v[40:43], v[28:31], v[56:59], v[40:43]
    s_add_u32 s12, s12, 1
    v_exp_f32 v104, v104
    v_mfma_f32_16x16x32_bf16 v[44:47], v[28:31], v[60:63], v[44:47]
    ds_read_b128 a[144:147], v18 offset:20480
    v_min_f32 v87, v87, v75
    v_mfma_f32_16x16x32_bf16 v[192:195], a[160:163], v[56:59], v[192:195]
    v_exp_f32 v105, v105
    v_mfma_f32_16x16x32_bf16 v[224:227], a[160:163], v[60:63], v[224:227]
    ds_read_b128 a[148:151], v18 offset:21504
    v_cvt_pk_bf16_f32 v52, v104, v105
    v_mfma_f32_16x16x32_bf16 v[196:199], a[164:167], v[56:59], v[196:199]
    v_exp_f32 v106, v106
    v_mfma_f32_16x16x32_bf16 v[228:231], a[164:167], v[60:63], v[228:231]
    ds_read_b128 a[152:155], v18 offset:22528
    v_add_f32 v88, 0x73800000, v22
    v_mfma_f32_16x16x32_bf16 v[200:203], a[168:171], v[56:59], v[200:203]
    v_exp_f32 v107, v107
    v_mfma_f32_16x16x32_bf16 v[232:235], a[168:171], v[60:63], v[232:235]
    ds_read_b128 a[156:159], v18 offset:23552
    v_cvt_pk_bf16_f32 v53, v106, v107
    v_mfma_f32_16x16x32_bf16 v[204:207], a[172:175], v[56:59], v[204:207]
    v_exp_f32 v108, v108
    v_mfma_f32_16x16x32_bf16 v[236:239], a[172:175], v[60:63], v[236:239]
    v_min_f32 v88, v88, v76
    v_add_f32 v89, 0x73700000, v22
    v_mfma_f32_16x16x32_bf16 v[208:211], a[176:179], v[56:59], v[208:211]
    v_exp_f32 v109, v109
    v_mfma_f32_16x16x32_bf16 v[240:243], a[176:179], v[60:63], v[240:243]
    v_cvt_pk_bf16_f32 v54, v108, v109
    v_xor_b32 v18, 196608, v18
    v_mfma_f32_16x16x32_bf16 v[212:215], a[180:183], v[56:59], v[212:215]
    v_exp_f32 v110, v110
    v_mfma_f32_16x16x32_bf16 v[244:247], a[180:183], v[60:63], v[244:247]
    v_min_f32 v89, v89, v77
    v_add_f32 v90, 0x73600000, v22
    v_mfma_f32_16x16x32_bf16 v[216:219], a[184:187], v[56:59], v[216:219]
    v_exp_f32 v111, v111
    v_mfma_f32_16x16x32_bf16 v[248:251], a[184:187], v[60:63], v[248:251]
    v_cvt_pk_bf16_f32 v55, v110, v111
    v_min_f32 v90, v90, v78
    v_mfma_f32_16x16x32_bf16 v[220:223], a[188:191], v[56:59], v[220:223]
    v_add_f32 v91, 0x73500000, v22
    v_min_f32 v91, v91, v79
    v_mfma_f32_16x16x32_bf16 v[252:255], a[188:191], v[60:63], v[252:255]
    v_add_f32 v92, 0, v22
    v_min_f32 v92, v92, v76
    v_add_f32 v93, 0xf1800000, v22
    v_min_f32 v93, v93, v77
    v_add_f32 v94, 0xf2000000, v22
    v_min_f32 v94, v94, v78
    v_add_f32 v95, 0xf2400000, v22
    v_min_f32 v95, v95, v79
    s_waitcnt vmcnt(0) lgkmcnt(0)
    s_barrier
    v_mfma_f32_16x16x32_bf16 v[96:99], a[128:131], a[96:99], v[80:83]
    s_xor_b32 s100, s16, 8192
    ds_read_b128 a[176:179], v20 offset:4096
    v_lshrrev_b32 v13, 1, v1
    v_mfma_f32_16x16x32_bf16 v[96:99], a[132:135], a[100:103], v[96:99]
    s_add_u32 m0, s15, 0
    ds_read_b128 a[180:183], v20 offset:5120
    v_add_u32 v12, s100, v13
    v_mfma_f32_16x16x32_bf16 v[96:99], a[136:139], a[104:107], v[96:99]
    buffer_load_dwordx4 v1, s[8:11], s82 offen offset:0 lds
    v_exp_f32 v112, v112
    v_mfma_f32_16x16x32_bf16 v[96:99], a[140:143], a[108:111], v[96:99]
    v_exp_f32 v113, v113
    v_mfma_f32_16x16x32_bf16 v[100:103], a[144:147], a[96:99], v[84:87]
    ds_read_b128 a[184:187], v20 offset:6144
    v_cvt_pk_bf16_f32 v56, v112, v113
    v_mfma_f32_16x16x32_bf16 v[100:103], a[148:151], a[100:103], v[100:103]
    v_exp_f32 v114, v114
    v_mfma_f32_16x16x32_bf16 v[100:103], a[152:155], a[104:107], v[100:103]
    buffer_load_dwordx4 v1, s[8:11], s82 offen offset:1024 lds
    v_exp_f32 v115, v115
    v_mfma_f32_16x16x32_bf16 v[100:103], a[156:159], a[108:111], v[100:103]
    ds_read_b128 a[188:191], v20 offset:7168
    v_cvt_pk_bf16_f32 v57, v114, v115
    v_mfma_f32_16x16x32_bf16 v[104:107], a[128:131], a[112:115], v[88:91]
    v_exp_f32 v116, v116
    v_mfma_f32_16x16x32_bf16 v[104:107], a[132:135], a[116:119], v[104:107]
    v_exp_f32 v117, v117
    v_mfma_f32_16x16x32_bf16 v[104:107], a[136:139], a[120:123], v[104:107]
    ds_read_b128 a[160:163], v19 offset:0
    v_cvt_pk_bf16_f32 v58, v116, v117
    v_mfma_f32_16x16x32_bf16 v[104:107], a[140:143], a[124:127], v[104:107]
    buffer_load_dwordx4 v1, s[8:11], s82 offen offset:2048 lds
    v_exp_f32 v118, v118
    v_mfma_f32_16x16x32_bf16 v[108:111], a[144:147], a[112:115], v[92:95]
    v_exp_f32 v119, v119
    v_mfma_f32_16x16x32_bf16 v[108:111], a[148:151], a[116:119], v[108:111]
    ds_read_b128 a[164:167], v19 offset:1024
    v_cvt_pk_bf16_f32 v59, v118, v119
    v_mfma_f32_16x16x32_bf16 v[108:111], a[152:155], a[120:123], v[108:111]
    v_exp_f32 v120, v120
    v_mfma_f32_16x16x32_bf16 v[108:111], a[156:159], a[124:127], v[108:111]
    buffer_load_dwordx4 v1, s[8:11], s82 offen offset:3072 lds
    v_exp_f32 v121, v121
    v_mfma_f32_16x16x32_bf16 v[32:35], v[28:31], v[48:51], v[32:35]
    s_add_u32 m0, s15, 4096
    ds_read_b128 a[168:171], v19 offset:2048
    v_cvt_pk_bf16_f32 v60, v120, v121
    v_mfma_f32_16x16x32_bf16 v[36:39], v[28:31], v[52:55], v[36:39]
    s_waitcnt lgkmcnt(6)
    v_exp_f32 v122, v122
    v_mfma_f32_16x16x32_bf16 v[144:147], a[176:179], v[48:51], v[144:147]
    v_exp_f32 v123, v123
    v_mfma_f32_16x16x32_bf16 v[176:179], a[176:179], v[52:55], v[176:179]
    s_waitcnt lgkmcnt(5)
    ds_read_b128 a[172:175], v19 offset:3072
    v_cvt_pk_bf16_f32 v61, v122, v123
    v_mfma_f32_16x16x32_bf16 v[148:151], a[180:183], v[48:51], v[148:151]
    buffer_load_dwordx4 v15, s[8:11], s82 offen offset:0 lds
    v_exp_f32 v124, v124
    v_mfma_f32_16x16x32_bf16 v[180:183], a[180:183], v[52:55], v[180:183]
    s_waitcnt lgkmcnt(5)
    v_exp_f32 v125, v125
    v_mfma_f32_16x16x32_bf16 v[152:155], a[184:187], v[48:51], v[152:155]
    s_waitcnt lgkmcnt(4)
    v_exp_f32 v126, v126
    v_mfma_f32_16x16x32_bf16 v[184:187], a[184:187], v[52:55], v[184:187]
    buffer_load_dwordx4 v15, s[8:11], s82 offen offset:1024 lds
    v_exp_f32 v127, v127
    v_mfma_f32_16x16x32_bf16 v[156:159], a[188:191], v[48:51], v[156:159]
    ds_write_b128 v16, v[144:147] offset:32768
    v_cvt_pk_bf16_f32 v62, v124, v125
    v_mfma_f32_16x16x32_bf16 v[188:191], a[188:191], v[52:55], v[188:191]
    s_waitcnt lgkmcnt(4)
    v_exp_f32 v96, v96
    v_mfma_f32_16x16x32_bf16 v[128:131], a[160:163], v[48:51], v[128:131]
    v_exp_f32 v97, v97
    v_mfma_f32_16x16x32_bf16 v[160:163], a[160:163], v[52:55], v[160:163]
    s_waitcnt lgkmcnt(3)
    ds_write_b128 v16, v[176:179] offset:33792
    v_cvt_pk_bf16_f32 v63, v126, v127
    v_mfma_f32_16x16x32_bf16 v[132:135], a[164:167], v[48:51], v[132:135]
    s_waitcnt lgkmcnt(3)
    v_exp_f32 v98, v98
    v_mfma_f32_16x16x32_bf16 v[164:167], a[164:167], v[52:55], v[164:167]
    buffer_load_dwordx4 v15, s[8:11], s82 offen offset:2048 lds
    v_exp_f32 v99, v99
    v_mfma_f32_16x16x32_bf16 v[136:139], a[168:171], v[48:51], v[136:139]
    ds_write_b128 v16, v[148:151] offset:34816
    v_mfma_f32_16x16x32_bf16 v[168:171], a[168:171], v[52:55], v[168:171]
    s_waitcnt lgkmcnt(3)
    v_exp_f32 v100, v100
    v_mfma_f32_16x16x32_bf16 v[140:143], a[172:175], v[48:51], v[140:143]
    v_exp_f32 v101, v101
    v_mfma_f32_16x16x32_bf16 v[172:175], a[172:175], v[52:55], v[172:175]
    ds_write_b128 v16, v[180:183] offset:35840
    v_mov_b32 v33, v36
    v_mfma_f32_16x16x32_bf16 v[40:43], v[28:31], v[56:59], v[40:43]
    buffer_load_dwordx4 v15, s[8:11], s82 offen offset:3072 lds
    v_exp_f32 v102, v102
    v_mfma_f32_16x16x32_bf16 v[44:47], v[28:31], v[60:63], v[44:47]
    s_xor_b32 s15, s15, 196608
    v_exp_f32 v103, v103
    v_mfma_f32_16x16x32_bf16 v[208:211], a[176:179], v[56:59], v[208:211]
    ds_write_b128 v16, v[152:155] offset:36864
    v_cvt_pk_bf16_f32 v48, v96, v97
    v_mfma_f32_16x16x32_bf16 v[240:243], a[176:179], v[60:63], v[240:243]
    ds_read_b128 a[176:179], v20 offset:20480
    v_exp_f32 v104, v104
    v_mfma_f32_16x16x32_bf16 v[212:215], a[180:183], v[56:59], v[212:215]
    v_exp_f32 v105, v105
    v_mfma_f32_16x16x32_bf16 v[244:247], a[180:183], v[60:63], v[244:247]
    ds_read_b128 a[180:183], v20 offset:21504
    v_exp_f32 v106, v106
    v_mfma_f32_16x16x32_bf16 v[216:219], a[184:187], v[56:59], v[216:219]
    ds_write_b128 v16, v[184:187] offset:37888
    v_cvt_pk_bf16_f32 v49, v98, v99
    v_mfma_f32_16x16x32_bf16 v[248:251], a[184:187], v[60:63], v[248:251]
    ds_read_b128 a[184:187], v20 offset:22528
    v_exp_f32 v107, v107
    v_mfma_f32_16x16x32_bf16 v[220:223], a[188:191], v[56:59], v[220:223]
    v_exp_f32 v108, v108
    v_mfma_f32_16x16x32_bf16 v[252:255], a[188:191], v[60:63], v[252:255]
    ds_read_b128 a[188:191], v20 offset:23552
    v_exp_f32 v109, v109
    v_mfma_f32_16x16x32_bf16 v[192:195], a[160:163], v[56:59], v[192:195]
    ds_write_b128 v16, v[156:159] offset:38912
    v_cvt_pk_bf16_f32 v50, v100, v101
    v_mfma_f32_16x16x32_bf16 v[224:227], a[160:163], v[60:63], v[224:227]
    ds_read_b128 a[160:163], v19 offset:16384
    v_exp_f32 v110, v110
    v_mfma_f32_16x16x32_bf16 v[196:199], a[164:167], v[56:59], v[196:199]
    v_exp_f32 v111, v111
    v_mfma_f32_16x16x32_bf16 v[228:231], a[164:167], v[60:63], v[228:231]
    ds_read_b128 a[164:167], v19 offset:17408
    v_cvt_pk_bf16_f32 v51, v102, v103
    v_mfma_f32_16x16x32_bf16 v[200:203], a[168:171], v[56:59], v[200:203]
    ds_write_b128 v16, v[188:191] offset:39936
    v_cvt_pk_bf16_f32 v52, v104, v105
    v_mfma_f32_16x16x32_bf16 v[232:235], a[168:171], v[60:63], v[232:235]
    ds_read_b128 a[168:171], v19 offset:18432
    v_cvt_pk_bf16_f32 v53, v106, v107
    v_mfma_f32_16x16x32_bf16 v[204:207], a[172:175], v[56:59], v[204:207]
    v_cvt_pk_bf16_f32 v54, v108, v109
    v_cvt_pk_bf16_f32 v55, v110, v111
    v_mfma_f32_16x16x32_bf16 v[236:239], a[172:175], v[60:63], v[236:239]
    ds_read_b128 a[172:175], v19 offset:19456
    ds_write_b64 v12, v[32:33]
    s_xor_b32 s101, s16, 98304
    v_xor_b32 v12, 8192, v12
    v_add_u32 v9, s101, v1
    v_xor_b32 v8, 8192, v16
    v_xor_b32 v10, 8192, v9
L_t1_join:
    v_xor_b32 v19, 98304, v19
    v_xor_b32 v20, 98304, v20
    s_waitcnt lgkmcnt(0)
    s_barrier
    v_mfma_f32_16x16x32_bf16 v[40:43], v[28:31], v[48:51], v[40:43]
    s_lshl_b32 s100, s60, 20
    s_add_u32 s101, s100, s21
    ds_read_b64 v[120:121], v12
    v_mfma_f32_16x16x32_bf16 v[44:47], v[28:31], v[52:55], v[44:47]
    s_add_u32 s100, s100, s20
    ds_read_b128 v[144:147], v8 offset:32768
    v_lshrrev_b32 v11, 4, v2
    v_mfma_f32_16x16x32_bf16 v[208:211], a[176:179], v[48:51], v[208:211]
    ds_read_b128 v[176:179], v8 offset:33792
    v_lshrrev_b32 v13, 2, v1
    v_mfma_f32_16x16x32_bf16 v[240:243], a[176:179], v[52:55], v[240:243]
    ds_read_b128 v[148:151], v8 offset:34816
    v_add_u32 v13, 32768, v13
    v_mfma_f32_16x16x32_bf16 v[212:215], a[180:183], v[48:51], v[212:215]
    s_xor_b32 s99, s62, 8192
    ds_read_b128 v[180:183], v8 offset:35840
    v_add_u32 v14, s99, v13
    v_mfma_f32_16x16x32_bf16 v[244:247], a[180:183], v[52:55], v[244:247]
    ds_read_b128 v[152:155], v8 offset:36864
    v_cmp_eq_u32 vcc, 1, v11
    v_mfma_f32_16x16x32_bf16 v[216:219], a[184:187], v[48:51], v[216:219]
    ds_read_b128 v[184:187], v8 offset:37888
    s_waitcnt lgkmcnt(6)
    v_add_f32 v112, v120, v32
    v_mfma_f32_16x16x32_bf16 v[248:251], a[184:187], v[52:55], v[248:251]
    ds_read_b128 v[156:159], v8 offset:38912
    v_add_f32 v114, v121, v36
    v_mfma_f32_16x16x32_bf16 v[220:223], a[188:191], v[48:51], v[220:223]
    ds_read_b128 v[188:191], v8 offset:39936
    v_cndmask_b32 v12, v32, v36, vcc
    v_mfma_f32_16x16x32_bf16 v[252:255], a[188:191], v[52:55], v[252:255]
    v_rcp_f32 v112, v112
    v_mfma_f32_16x16x32_bf16 v[192:195], a[160:163], v[48:51], v[192:195]
    v_rcp_f32 v114, v114
    v_mfma_f32_16x16x32_bf16 v[224:227], a[160:163], v[52:55], v[224:227]
    v_cmp_eq_u32 vcc, 2, v11
    v_cmp_eq_u32 s[96:97], 3, v11
    v_mfma_f32_16x16x32_bf16 v[196:199], a[164:167], v[48:51], v[196:199]
    ds_write_b128 v9, v[208:211] offset:0
    v_mfma_f32_16x16x32_bf16 v[228:231], a[164:167], v[52:55], v[228:231]
    v_mfma_f32_16x16x32_bf16 v[200:203], a[168:171], v[48:51], v[200:203]
    ds_write_b128 v9, v[240:243] offset:1024
    v_mfma_f32_16x16x32_bf16 v[232:235], a[168:171], v[52:55], v[232:235]
    v_mfma_f32_16x16x32_bf16 v[204:207], a[172:175], v[48:51], v[204:207]
    ds_write_b128 v9, v[212:215] offset:2048
    v_mfma_f32_16x16x32_bf16 v[236:239], a[172:175], v[52:55], v[236:239]
    v_cndmask_b32 v12, v12, v40, vcc
    v_cndmask_b32 v12, v12, v44, s[96:97]
    ds_write_b128 v9, v[244:247] offset:3072
    s_waitcnt lgkmcnt(11)
    v_pk_add_f32 v[128:129], v[128:129], v[144:145]
    v_pk_add_f32 v[130:131], v[130:131], v[146:147]
    s_waitcnt lgkmcnt(9)
    v_pk_add_f32 v[132:133], v[132:133], v[148:149]
    v_pk_add_f32 v[134:135], v[134:135], v[150:151]
    v_pk_mul_f32 v[128:129], v[128:129], v[112:113] op_sel_hi:[1,0]
    v_pk_mul_f32 v[130:131], v[130:131], v[112:113] op_sel_hi:[1,0]
    v_pk_mul_f32 v[132:133], v[132:133], v[112:113] op_sel_hi:[1,0]
    v_pk_mul_f32 v[134:135], v[134:135], v[112:113] op_sel_hi:[1,0]
    v_cvt_pk_bf16_f32 v128, v128, v129
    v_cvt_pk_bf16_f32 v129, v130, v131
    v_cvt_pk_bf16_f32 v130, v132, v133
    s_add_u32 m0, s16, 0
    ds_write_b128 v9, v[216:219] offset:4096
    v_cvt_pk_bf16_f32 v131, v134, v135
    buffer_store_dwordx4 v[128:131], v1, s[8:11], s100 offen offset:0 sc0 sc1
    s_waitcnt lgkmcnt(8)
    v_pk_add_f32 v[136:137], v[136:137], v[152:153]
    v_pk_add_f32 v[138:139], v[138:139], v[154:155]
    s_waitcnt lgkmcnt(6)
    v_pk_add_f32 v[140:141], v[140:141], v[156:157]
    v_pk_add_f32 v[142:143], v[142:143], v[158:159]
    v_pk_mul_f32 v[136:137], v[136:137], v[112:113] op_sel_hi:[1,0]
    v_pk_mul_f32 v[138:139], v[138:139], v[112:113] op_sel_hi:[1,0]
    v_pk_mul_f32 v[140:141], v[140:141], v[112:113] op_sel_hi:[1,0]
    v_pk_mul_f32 v[142:143], v[142:143], v[112:113] op_sel_hi:[1,0]
    v_cvt_pk_bf16_f32 v136, v136, v137
    buffer_load_dwordx4 v1, s[8:11], s19 offen offset:0 lds
    ds_write_b128 v9, v[248:251] offset:5120
    v_cvt_pk_bf16_f32 v137, v138, v139
    v_cvt_pk_bf16_f32 v138, v140, v141
    v_cvt_pk_bf16_f32 v139, v142, v143
    buffer_store_dwordx4 v[136:139], v1, s[8:11], s100 offen offset:1024 sc0 sc1
    v_pk_add_f32 v[160:161], v[160:161], v[176:177]
    v_pk_add_f32 v[162:163], v[162:163], v[178:179]
    v_pk_add_f32 v[164:165], v[164:165], v[180:181]
    v_pk_add_f32 v[166:167], v[166:167], v[182:183]
    v_pk_mul_f32 v[160:161], v[160:161], v[114:115] op_sel_hi:[1,0]
    v_pk_mul_f32 v[162:163], v[162:163], v[114:115] op_sel_hi:[1,0]
    v_pk_mul_f32 v[164:165], v[164:165], v[114:115] op_sel_hi:[1,0]
    buffer_load_dwordx4 v1, s[8:11], s19 offen offset:1024 lds
    ds_write_b128 v9, v[220:223] offset:6144
    v_pk_mul_f32 v[166:167], v[166:167], v[114:115] op_sel_hi:[1,0]
    v_cvt_pk_bf16_f32 v160, v160, v161
    v_cvt_pk_bf16_f32 v161, v162, v163
    v_cvt_pk_bf16_f32 v162, v164, v165
    v_cvt_pk_bf16_f32 v163, v166, v167
    buffer_store_dwordx4 v[160:163], v15, s[8:11], s100 offen offset:0 sc0 sc1
    v_pk_add_f32 v[168:169], v[168:169], v[184:185]
    v_pk_add_f32 v[170:171], v[170:171], v[186:187]
    s_waitcnt lgkmcnt(7)
    v_pk_add_f32 v[172:173], v[172:173], v[188:189]
    v_pk_add_f32 v[174:175], v[174:175], v[190:191]
    v_pk_mul_f32 v[168:169], v[168:169], v[114:115] op_sel_hi:[1,0]
    buffer_load_dwordx4 v1, s[8:11], s19 offen offset:2048 lds
    ds_write_b128 v9, v[252:255] offset:7168
    v_pk_mul_f32 v[170:171], v[170:171], v[114:115] op_sel_hi:[1,0]
    v_pk_mul_f32 v[172:173], v[172:173], v[114:115] op_sel_hi:[1,0]
    v_pk_mul_f32 v[174:175], v[174:175], v[114:115] op_sel_hi:[1,0]
    v_cvt_pk_bf16_f32 v168, v168, v169
    v_cvt_pk_bf16_f32 v169, v170, v171
    v_cvt_pk_bf16_f32 v170, v172, v173
    v_cvt_pk_bf16_f32 v171, v174, v175
    buffer_store_dwordx4 v[168:171], v15, s[8:11], s100 offen offset:1024 sc0 sc1
    buffer_load_dwordx4 v1, s[8:11], s19 offen offset:3072 lds
    ds_write_b32 v14, v12
    v_and_b32 v14, 4294967103, v13
    v_add_u32 v14, s62, v14
    s_waitcnt lgkmcnt(0)
    s_barrier
    ds_read_b32 v116, v14 offset:128
    ds_read_b32 v118, v14 offset:192
    ds_read_b128 v[208:211], v10 offset:0
    ds_read_b128 v[212:215], v10 offset:2048
    ds_read_b128 v[216:219], v10 offset:4096
    ds_read_b128 v[220:223], v10 offset:6144
    ds_read_b128 v[240:243], v10 offset:1024
    ds_read_b128 v[244:247], v10 offset:3072
    ds_read_b128 v[248:251], v10 offset:5120
    ds_read_b128 v[252:255], v10 offset:7168
    ds_read_b32 v120, v13 offset:0
    ds_read_b32 v121, v13 offset:8192
    ds_read_b32 v122, v13 offset:16384
    ds_read_b32 v123, v13 offset:24576
    s_waitcnt lgkmcnt(13)
    v_add_f32 v116, v116, v40
    s_waitcnt lgkmcnt(12)
    v_add_f32 v118, v118, v44
    v_rcp_f32 v116, v116
    v_rcp_f32 v118, v118
    s_waitcnt lgkmcnt(11)
    v_pk_add_f32 v[192:193], v[192:193], v[208:209]
    v_pk_add_f32 v[194:195], v[194:195], v[210:211]
    s_waitcnt lgkmcnt(10)
    v_pk_add_f32 v[196:197], v[196:197], v[212:213]
    v_pk_add_f32 v[198:199], v[198:199], v[214:215]
    v_pk_mul_f32 v[192:193], v[192:193], v[116:117] op_sel_hi:[1,0]
    v_pk_mul_f32 v[194:195], v[194:195], v[116:117] op_sel_hi:[1,0]
    v_pk_mul_f32 v[196:197], v[196:197], v[116:117] op_sel_hi:[1,0]
    v_pk_mul_f32 v[198:199], v[198:199], v[116:117] op_sel_hi:[1,0]
    v_cvt_pk_bf16_f32 v192, v192, v193
    v_cvt_pk_bf16_f32 v193, v194, v195
    v_cvt_pk_bf16_f32 v194, v196, v197
    v_cvt_pk_bf16_f32 v195, v198, v199
    buffer_store_dwordx4 v[192:195], v1, s[8:11], s101 offen offset:0 sc0 sc1
    s_add_u32 m0, s16, 4096
    s_waitcnt lgkmcnt(9)
    v_pk_add_f32 v[200:201], v[200:201], v[216:217]
    v_pk_add_f32 v[202:203], v[202:203], v[218:219]
    s_waitcnt lgkmcnt(8)
    v_pk_add_f32 v[204:205], v[204:205], v[220:221]
    v_pk_add_f32 v[206:207], v[206:207], v[222:223]
    v_pk_mul_f32 v[200:201], v[200:201], v[116:117] op_sel_hi:[1,0]
    v_pk_mul_f32 v[202:203], v[202:203], v[116:117] op_sel_hi:[1,0]
    v_pk_mul_f32 v[204:205], v[204:205], v[116:117] op_sel_hi:[1,0]
    v_pk_mul_f32 v[206:207], v[206:207], v[116:117] op_sel_hi:[1,0]
    v_cvt_pk_bf16_f32 v200, v200, v201
    v_cvt_pk_bf16_f32 v201, v202, v203
    v_cvt_pk_bf16_f32 v202, v204, v205
    v_cvt_pk_bf16_f32 v203, v206, v207
    buffer_store_dwordx4 v[200:203], v1, s[8:11], s101 offen offset:1024 sc0 sc1
    buffer_load_dwordx4 v15, s[8:11], s19 offen offset:0 lds
    buffer_load_dwordx4 v15, s[8:11], s19 offen offset:1024 lds
    s_waitcnt lgkmcnt(2)
    v_add_f32 v120, v120, v121
    s_waitcnt lgkmcnt(0)
    v_add_f32 v122, v122, v123
    v_min_f32 v124, v120, v122
    v_add_f32 v120, v120, v122
    v_cmp_le_f32 vcc, 0x1f800000, v124
    s_mov_b64 s[96:97], vcc
    v_cmp_ge_f32 vcc, 0x67800000, v120
    s_and_b64 s[96:97], s[96:97], vcc
    s_cmp_eq_u64 s[96:97], -1
    s_cselect_b32 s96, s25, 1
    s_cmp_lg_u32 s96, 0
    s_cbranch_scc1 L_t1_redo
L_t1_safe:
    v_pk_add_f32 v[224:225], v[224:225], v[240:241]
    v_pk_add_f32 v[226:227], v[226:227], v[242:243]
    v_pk_add_f32 v[228:229], v[228:229], v[244:245]
    v_pk_add_f32 v[230:231], v[230:231], v[246:247]
    v_pk_mul_f32 v[224:225], v[224:225], v[118:119] op_sel_hi:[1,0]
    v_pk_mul_f32 v[226:227], v[226:227], v[118:119] op_sel_hi:[1,0]
    v_pk_mul_f32 v[228:229], v[228:229], v[118:119] op_sel_hi:[1,0]
    v_pk_mul_f32 v[230:231], v[230:231], v[118:119] op_sel_hi:[1,0]
    v_cvt_pk_bf16_f32 v224, v224, v225
    v_cvt_pk_bf16_f32 v225, v226, v227
    v_cvt_pk_bf16_f32 v226, v228, v229
    v_cvt_pk_bf16_f32 v227, v230, v231
    buffer_store_dwordx4 v[224:227], v15, s[8:11], s101 offen offset:0 sc0 sc1
    buffer_load_dwordx4 v15, s[8:11], s19 offen offset:2048 lds
    ds_read_b128 a[128:131], v18 offset:0
    ds_read_b128 a[132:135], v18 offset:1024
    ds_read_b128 a[136:139], v18 offset:2048
    ds_read_b128 a[140:143], v18 offset:3072
    v_pk_add_f32 v[232:233], v[232:233], v[248:249]
    v_pk_add_f32 v[234:235], v[234:235], v[250:251]
    v_pk_add_f32 v[236:237], v[236:237], v[252:253]
    v_pk_add_f32 v[238:239], v[238:239], v[254:255]
    v_pk_mul_f32 v[232:233], v[232:233], v[118:119] op_sel_hi:[1,0]
    v_pk_mul_f32 v[234:235], v[234:235], v[118:119] op_sel_hi:[1,0]
    v_pk_mul_f32 v[236:237], v[236:237], v[118:119] op_sel_hi:[1,0]
    v_pk_mul_f32 v[238:239], v[238:239], v[118:119] op_sel_hi:[1,0]
    v_cvt_pk_bf16_f32 v232, v232, v233
    v_cvt_pk_bf16_f32 v233, v234, v235
    v_cvt_pk_bf16_f32 v234, v236, v237
    v_cvt_pk_bf16_f32 v235, v238, v239
    buffer_store_dwordx4 v[232:235], v15, s[8:11], s101 offen offset:1024 sc0 sc1
    buffer_load_dwordx4 v15, s[8:11], s19 offen offset:3072 lds
    s_xor_b32 s16, s16, 98304
    ds_read_b128 a[144:147], v18 offset:4096
    ds_read_b128 a[148:151], v18 offset:5120
    ds_read_b128 a[152:155], v18 offset:6144
    ds_read_b128 a[156:159], v18 offset:7168
L_t2_start:
    s_waitcnt lgkmcnt(7)
    v_mfma_f32_16x16x32_bf16 v[96:99], a[128:131], a[192:195], v[64:67]
    s_waitcnt lgkmcnt(6)
    s_add_u32 s19, s82, 32768
    s_sub_u32 s82, s12, s13
    s_sub_u32 s82, s82, 1
    v_mfma_f32_16x16x32_bf16 v[96:99], a[132:135], a[196:199], v[96:99]
    s_waitcnt lgkmcnt(5)
    s_cmp_gt_u32 s12, s13
    s_cselect_b32 s82, s82, s12
    s_lshl_b32 s82, s82, 16
    s_add_u32 s82, s82, s81
    v_mfma_f32_16x16x32_bf16 v[96:99], a[136:139], a[200:203], v[96:99]
    s_waitcnt lgkmcnt(4)
    s_cmp_ge_u32 s12, 17
    s_cselect_b32 s82, 2147471360, s82
    s_add_u32 s12, s12, 1
    s_sub_u32 s14, s61, 8
    v_mfma_f32_16x16x32_bf16 v[96:99], a[140:143], a[204:207], v[96:99]
    s_waitcnt lgkmcnt(3)
    v_mfma_f32_16x16x32_bf16 v[100:103], a[144:147], a[192:195], v[64:67]
    s_waitcnt lgkmcnt(2)
    v_mfma_f32_16x16x32_bf16 v[100:103], a[148:151], a[196:199], v[100:103]
    s_waitcnt lgkmcnt(1)
    v_mfma_f32_16x16x32_bf16 v[100:103], a[152:155], a[200:203], v[100:103]
    s_waitcnt lgkmcnt(0)
    v_mfma_f32_16x16x32_bf16 v[100:103], a[156:159], a[204:207], v[100:103]
    v_mfma_f32_16x16x32_bf16 v[104:107], a[128:131], a[208:211], v[68:71]
    v_exp_f32 v96, v96
    v_mfma_f32_16x16x32_bf16 v[104:107], a[132:135], a[212:215], v[104:107]
    v_exp_f32 v97, v97
    v_mfma_f32_16x16x32_bf16 v[104:107], a[136:139], a[216:219], v[104:107]
    v_exp_f32 v98, v98
    v_mfma_f32_16x16x32_bf16 v[104:107], a[140:143], a[220:223], v[104:107]
    v_exp_f32 v99, v99
    v_mfma_f32_16x16x32_bf16 v[108:111], a[144:147], a[208:211], v[68:71]
    v_exp_f32 v100, v100
    v_mfma_f32_16x16x32_bf16 v[108:111], a[148:151], a[212:215], v[108:111]
    v_exp_f32 v101, v101
    v_mfma_f32_16x16x32_bf16 v[108:111], a[152:155], a[216:219], v[108:111]
    v_exp_f32 v102, v102
    v_mfma_f32_16x16x32_bf16 v[108:111], a[156:159], a[220:223], v[108:111]
    v_exp_f32 v103, v103
    v_mfma_f32_16x16x32_bf16 v[112:115], a[128:131], a[224:227], v[72:75]
    v_exp_f32 v104, v104
    v_mfma_f32_16x16x32_bf16 v[112:115], a[132:135], a[228:231], v[112:115]
    v_exp_f32 v105, v105
    v_mfma_f32_16x16x32_bf16 v[112:115], a[136:139], a[232:235], v[112:115]
    v_exp_f32 v106, v106
    v_mfma_f32_16x16x32_bf16 v[112:115], a[140:143], a[236:239], v[112:115]
    v_exp_f32 v107, v107
    v_mfma_f32_16x16x32_bf16 v[120:123], a[128:131], a[240:243], v[76:79]
    v_exp_f32 v108, v108
    v_mfma_f32_16x16x32_bf16 v[120:123], a[132:135], a[244:247], v[120:123]
    v_exp_f32 v109, v109
    v_mfma_f32_16x16x32_bf16 v[120:123], a[136:139], a[248:251], v[120:123]
    v_exp_f32 v110, v110
    v_mfma_f32_16x16x32_bf16 v[120:123], a[140:143], a[252:255], v[120:123]
    v_exp_f32 v111, v111
    v_mfma_f32_16x16x32_bf16 v[116:119], a[144:147], a[224:227], v[72:75]
    ds_read_b128 a[128:131], v18 offset:16384
    v_cvt_pk_bf16_f32 v48, v96, v97
    v_mfma_f32_16x16x32_bf16 v[116:119], a[148:151], a[228:231], v[116:119]
    ds_read_b128 a[132:135], v18 offset:17408
    v_cvt_pk_bf16_f32 v49, v98, v99
    v_mfma_f32_16x16x32_bf16 v[116:119], a[152:155], a[232:235], v[116:119]
    ds_read_b128 a[136:139], v18 offset:18432
    v_cvt_pk_bf16_f32 v50, v100, v101
    v_mfma_f32_16x16x32_bf16 v[116:119], a[156:159], a[236:239], v[116:119]
    ds_read_b128 a[140:143], v18 offset:19456
    v_cvt_pk_bf16_f32 v51, v102, v103
    v_mfma_f32_16x16x32_bf16 v[124:127], a[144:147], a[240:243], v[76:79]
    ds_read_b128 a[144:147], v18 offset:20480
    v_cvt_pk_bf16_f32 v52, v104, v105
    v_mfma_f32_16x16x32_bf16 v[124:127], a[148:151], a[244:247], v[124:127]
    ds_read_b128 a[148:151], v18 offset:21504
    v_cvt_pk_bf16_f32 v53, v106, v107
    v_mfma_f32_16x16x32_bf16 v[124:127], a[152:155], a[248:251], v[124:127]
    ds_read_b128 a[152:155], v18 offset:22528
    v_cvt_pk_bf16_f32 v54, v108, v109
    v_mfma_f32_16x16x32_bf16 v[124:127], a[156:159], a[252:255], v[124:127]
    ds_read_b128 a[156:159], v18 offset:23552
    v_cvt_pk_bf16_f32 v55, v110, v111
    v_xor_b32 v18, 196608, v18
    s_waitcnt vmcnt(0) lgkmcnt(0)
    s_barrier
    v_mfma_f32_16x16x32_bf16 v[96:99], a[128:131], a[192:195], v[64:67]
    s_add_u32 m0, s15, 0
    ds_read_b128 a[160:163], v19 offset:0
    v_mfma_f32_16x16x32_bf16 v[96:99], a[132:135], a[196:199], v[96:99]
    ds_read_b128 a[164:167], v19 offset:1024
    v_mfma_f32_16x16x32_bf16 v[96:99], a[136:139], a[200:203], v[96:99]
    v_exp_f32 v112, v112
    v_mfma_f32_16x16x32_bf16 v[96:99], a[140:143], a[204:207], v[96:99]
    buffer_load_dwordx4 v1, s[8:11], s82 offen offset:0 lds
    v_mfma_f32_16x16x32_bf16 v[104:107], a[128:131], a[208:211], v[68:71]
    v_exp_f32 v113, v113
    v_mfma_f32_16x16x32_bf16 v[104:107], a[132:135], a[212:215], v[104:107]
    ds_read_b128 a[168:171], v19 offset:2048
    v_cvt_pk_bf16_f32 v56, v112, v113
    v_mfma_f32_16x16x32_bf16 v[104:107], a[136:139], a[216:219], v[104:107]
    v_exp_f32 v114, v114
    v_mfma_f32_16x16x32_bf16 v[104:107], a[140:143], a[220:223], v[104:107]
    buffer_load_dwordx4 v1, s[8:11], s82 offen offset:1024 lds
    v_mfma_f32_16x16x32_bf16 v[100:103], a[144:147], a[192:195], v[64:67]
    v_exp_f32 v115, v115
    v_mfma_f32_16x16x32_bf16 v[100:103], a[148:151], a[196:199], v[100:103]
    ds_read_b128 a[172:175], v19 offset:3072
    v_cvt_pk_bf16_f32 v57, v114, v115
    v_mfma_f32_16x16x32_bf16 v[100:103], a[152:155], a[200:203], v[100:103]
    v_exp_f32 v116, v116
    v_mfma_f32_16x16x32_bf16 v[100:103], a[156:159], a[204:207], v[100:103]
    buffer_load_dwordx4 v1, s[8:11], s82 offen offset:2048 lds
    v_mfma_f32_16x16x32_bf16 v[108:111], a[144:147], a[208:211], v[68:71]
    v_exp_f32 v117, v117
    v_mfma_f32_16x16x32_bf16 v[108:111], a[148:151], a[212:215], v[108:111]
    ds_read_b128 a[176:179], v20 offset:4096
    v_cvt_pk_bf16_f32 v58, v116, v117
    v_mfma_f32_16x16x32_bf16 v[108:111], a[152:155], a[216:219], v[108:111]
    v_exp_f32 v118, v118
    v_mfma_f32_16x16x32_bf16 v[108:111], a[156:159], a[220:223], v[108:111]
    buffer_load_dwordx4 v1, s[8:11], s82 offen offset:3072 lds
    v_mfma_f32_16x16x32_bf16 v[32:35], v[28:31], v[48:51], 0
    s_add_u32 m0, s15, 4096
    v_exp_f32 v119, v119
    v_mfma_f32_16x16x32_bf16 v[36:39], v[28:31], v[52:55], 0
    s_waitcnt lgkmcnt(4)
    ds_read_b128 a[180:183], v20 offset:5120
    v_cvt_pk_bf16_f32 v59, v118, v119
    v_mfma_f32_16x16x32_bf16 v[128:131], a[160:163], v[48:51], 0
    v_exp_f32 v120, v120
    v_mfma_f32_16x16x32_bf16 v[160:163], a[160:163], v[52:55], 0
    s_waitcnt lgkmcnt(4)
    v_mfma_f32_16x16x32_bf16 v[132:135], a[164:167], v[48:51], 0
    v_exp_f32 v121, v121
    v_mfma_f32_16x16x32_bf16 v[164:167], a[164:167], v[52:55], 0
    s_waitcnt lgkmcnt(3)
    ds_read_b128 a[184:187], v20 offset:6144
    v_cvt_pk_bf16_f32 v60, v120, v121
    v_mfma_f32_16x16x32_bf16 v[136:139], a[168:171], v[48:51], 0
    s_waitcnt lgkmcnt(3)
    v_exp_f32 v122, v122
    v_mfma_f32_16x16x32_bf16 v[168:171], a[168:171], v[52:55], 0
    buffer_load_dwordx4 v15, s[8:11], s82 offen offset:0 lds
    v_mfma_f32_16x16x32_bf16 v[140:143], a[172:175], v[48:51], 0
    v_exp_f32 v123, v123
    v_mfma_f32_16x16x32_bf16 v[172:175], a[172:175], v[52:55], 0
    s_waitcnt lgkmcnt(2)
    ds_read_b128 a[188:191], v20 offset:7168
    v_cvt_pk_bf16_f32 v61, v122, v123
    v_mfma_f32_16x16x32_bf16 v[144:147], a[176:179], v[48:51], 0
    s_waitcnt lgkmcnt(2)
    v_exp_f32 v124, v124
    v_mfma_f32_16x16x32_bf16 v[176:179], a[176:179], v[52:55], 0
    buffer_load_dwordx4 v15, s[8:11], s82 offen offset:1024 lds
    v_mfma_f32_16x16x32_bf16 v[148:151], a[180:183], v[48:51], 0
    v_exp_f32 v125, v125
    v_mfma_f32_16x16x32_bf16 v[180:183], a[180:183], v[52:55], 0
    s_waitcnt lgkmcnt(1)
    v_cvt_pk_bf16_f32 v62, v124, v125
    v_mfma_f32_16x16x32_bf16 v[152:155], a[184:187], v[48:51], 0
    s_waitcnt lgkmcnt(0)
    v_exp_f32 v126, v126
    v_mfma_f32_16x16x32_bf16 v[184:187], a[184:187], v[52:55], 0
    buffer_load_dwordx4 v15, s[8:11], s82 offen offset:2048 lds
    v_mfma_f32_16x16x32_bf16 v[156:159], a[188:191], v[48:51], 0
    v_exp_f32 v127, v127
    v_mfma_f32_16x16x32_bf16 v[188:191], a[188:191], v[52:55], 0
    v_cvt_pk_bf16_f32 v63, v126, v127
    v_mfma_f32_16x16x32_bf16 v[112:115], a[128:131], a[224:227], v[72:75]
    v_mfma_f32_16x16x32_bf16 v[112:115], a[132:135], a[228:231], v[112:115]
    v_mfma_f32_16x16x32_bf16 v[112:115], a[136:139], a[232:235], v[112:115]
    v_exp_f32 v96, v96
    v_mfma_f32_16x16x32_bf16 v[112:115], a[140:143], a[236:239], v[112:115]
    buffer_load_dwordx4 v15, s[8:11], s82 offen offset:3072 lds
    v_mfma_f32_16x16x32_bf16 v[120:123], a[128:131], a[240:243], v[76:79]
    s_xor_b32 s15, s15, 196608
    v_exp_f32 v97, v97
    v_mfma_f32_16x16x32_bf16 v[120:123], a[132:135], a[244:247], v[120:123]
    s_add_u32 m0, s16, 0
    ds_read_b128 a[128:131], v18 offset:0
    v_cvt_pk_bf16_f32 v48, v96, v97
    v_mfma_f32_16x16x32_bf16 v[120:123], a[136:139], a[248:251], v[120:123]
    v_exp_f32 v98, v98
    v_mfma_f32_16x16x32_bf16 v[120:123], a[140:143], a[252:255], v[120:123]
    buffer_load_dwordx4 v1, s[8:11], s19 offen offset:0 lds
    v_mfma_f32_16x16x32_bf16 v[116:119], a[144:147], a[224:227], v[72:75]
    v_exp_f32 v99, v99
    v_mfma_f32_16x16x32_bf16 v[116:119], a[148:151], a[228:231], v[116:119]
    ds_read_b128 a[132:135], v18 offset:1024
    v_cvt_pk_bf16_f32 v49, v98, v99
    v_mfma_f32_16x16x32_bf16 v[116:119], a[152:155], a[232:235], v[116:119]
    v_exp_f32 v100, v100
    v_mfma_f32_16x16x32_bf16 v[116:119], a[156:159], a[236:239], v[116:119]
    buffer_load_dwordx4 v1, s[8:11], s19 offen offset:1024 lds
    v_mfma_f32_16x16x32_bf16 v[124:127], a[144:147], a[240:243], v[76:79]
    v_exp_f32 v101, v101
    v_mfma_f32_16x16x32_bf16 v[124:127], a[148:151], a[244:247], v[124:127]
    ds_read_b128 a[136:139], v18 offset:2048
    v_cvt_pk_bf16_f32 v50, v100, v101
    v_mfma_f32_16x16x32_bf16 v[124:127], a[152:155], a[248:251], v[124:127]
    v_exp_f32 v102, v102
    v_mfma_f32_16x16x32_bf16 v[124:127], a[156:159], a[252:255], v[124:127]
    buffer_load_dwordx4 v1, s[8:11], s19 offen offset:2048 lds
    v_mfma_f32_16x16x32_bf16 v[40:43], v[28:31], v[56:59], 0
    v_exp_f32 v103, v103
    v_mfma_f32_16x16x32_bf16 v[44:47], v[28:31], v[60:63], 0
    ds_read_b128 a[140:143], v18 offset:3072
    v_cvt_pk_bf16_f32 v51, v102, v103
    v_mfma_f32_16x16x32_bf16 v[192:195], a[160:163], v[56:59], 0
    v_exp_f32 v104, v104
    v_mfma_f32_16x16x32_bf16 v[224:227], a[160:163], v[60:63], 0
    v_mfma_f32_16x16x32_bf16 v[196:199], a[164:167], v[56:59], 0
    v_exp_f32 v105, v105
    v_mfma_f32_16x16x32_bf16 v[228:231], a[164:167], v[60:63], 0
    ds_read_b128 a[144:147], v18 offset:4096
    v_cvt_pk_bf16_f32 v52, v104, v105
    v_mfma_f32_16x16x32_bf16 v[200:203], a[168:171], v[56:59], 0
    v_exp_f32 v106, v106
    v_mfma_f32_16x16x32_bf16 v[232:235], a[168:171], v[60:63], 0
    buffer_load_dwordx4 v1, s[8:11], s19 offen offset:3072 lds
    v_mfma_f32_16x16x32_bf16 v[204:207], a[172:175], v[56:59], 0
    s_add_u32 m0, s16, 4096
    v_exp_f32 v107, v107
    v_mfma_f32_16x16x32_bf16 v[236:239], a[172:175], v[60:63], 0
    ds_read_b128 a[148:151], v18 offset:5120
    v_cvt_pk_bf16_f32 v53, v106, v107
    v_mfma_f32_16x16x32_bf16 v[208:211], a[176:179], v[56:59], 0
    v_exp_f32 v108, v108
    v_mfma_f32_16x16x32_bf16 v[240:243], a[176:179], v[60:63], 0
    buffer_load_dwordx4 v15, s[8:11], s19 offen offset:0 lds
    v_mfma_f32_16x16x32_bf16 v[212:215], a[180:183], v[56:59], 0
    v_exp_f32 v109, v109
    v_mfma_f32_16x16x32_bf16 v[244:247], a[180:183], v[60:63], 0
    ds_read_b128 a[152:155], v18 offset:6144
    v_cvt_pk_bf16_f32 v54, v108, v109
    v_mfma_f32_16x16x32_bf16 v[216:219], a[184:187], v[56:59], 0
    v_exp_f32 v110, v110
    v_mfma_f32_16x16x32_bf16 v[248:251], a[184:187], v[60:63], 0
    buffer_load_dwordx4 v15, s[8:11], s19 offen offset:1024 lds
    v_mfma_f32_16x16x32_bf16 v[220:223], a[188:191], v[56:59], 0
    v_exp_f32 v111, v111
    v_mfma_f32_16x16x32_bf16 v[252:255], a[188:191], v[60:63], 0
    ds_read_b128 a[156:159], v18 offset:7168
    v_cvt_pk_bf16_f32 v55, v110, v111
    s_waitcnt lgkmcnt(7)
    v_mfma_f32_16x16x32_bf16 v[96:99], a[128:131], a[192:195], v[64:67]
    s_waitcnt lgkmcnt(6)
    s_lshr_b32 s101, s2, 3
    s_sub_u32 s101, s101, 4
    ds_read_b128 a[160:163], v19 offset:16384
    v_mfma_f32_16x16x32_bf16 v[96:99], a[132:135], a[196:199], v[96:99]
    s_waitcnt lgkmcnt(6)
    s_and_b32 s101, s101, 31
    ds_read_b128 a[164:167], v19 offset:17408
    v_and_b32 v14, 7, v2
    v_mfma_f32_16x16x32_bf16 v[96:99], a[136:139], a[200:203], v[96:99]
    s_waitcnt lgkmcnt(6)
    v_exp_f32 v112, v112
    v_mfma_f32_16x16x32_bf16 v[96:99], a[140:143], a[204:207], v[96:99]
    buffer_load_dwordx4 v15, s[8:11], s19 offen offset:2048 lds
    v_mfma_f32_16x16x32_bf16 v[104:107], a[128:131], a[208:211], v[68:71]
    v_exp_f32 v113, v113
    v_mfma_f32_16x16x32_bf16 v[104:107], a[132:135], a[212:215], v[104:107]
    ds_read_b128 a[168:171], v19 offset:18432
    v_cvt_pk_bf16_f32 v56, v112, v113
    v_mfma_f32_16x16x32_bf16 v[104:107], a[136:139], a[216:219], v[104:107]
    s_waitcnt lgkmcnt(6)
    v_exp_f32 v114, v114
    v_mfma_f32_16x16x32_bf16 v[104:107], a[140:143], a[220:223], v[104:107]
    buffer_load_dwordx4 v15, s[8:11], s19 offen offset:3072 lds
    v_mfma_f32_16x16x32_bf16 v[100:103], a[144:147], a[192:195], v[64:67]
    s_waitcnt lgkmcnt(5)
    s_xor_b32 s16, s16, 98304
    v_exp_f32 v115, v115
    v_mfma_f32_16x16x32_bf16 v[100:103], a[148:151], a[196:199], v[100:103]
    s_waitcnt lgkmcnt(4)
    s_add_u32 s27, s18, 0
    ds_read_b128 a[172:175], v19 offset:19456
    v_cvt_pk_bf16_f32 v57, v114, v115
    v_mfma_f32_16x16x32_bf16 v[100:103], a[152:155], a[200:203], v[100:103]
    s_waitcnt lgkmcnt(4)
    v_exp_f32 v116, v116
    v_mfma_f32_16x16x32_bf16 v[100:103], a[156:159], a[204:207], v[100:103]
    buffer_store_dwordx4 v[24:27], v17, s[8:11], s27 offen offset:0 sc0 sc1
    v_mfma_f32_16x16x32_bf16 v[108:111], a[144:147], a[208:211], v[68:71]
    s_add_u32 s27, s18, 131072
    v_exp_f32 v117, v117
    v_mfma_f32_16x16x32_bf16 v[108:111], a[148:151], a[212:215], v[108:111]
    ds_read_b128 a[176:179], v20 offset:20480
    v_cvt_pk_bf16_f32 v58, v116, v117
    v_mfma_f32_16x16x32_bf16 v[108:111], a[152:155], a[216:219], v[108:111]
    v_exp_f32 v118, v118
    v_mfma_f32_16x16x32_bf16 v[108:111], a[156:159], a[220:223], v[108:111]
    buffer_store_dwordx4 v[24:27], v17, s[8:11], s27 offen offset:0 sc0 sc1
    v_mfma_f32_16x16x32_bf16 v[32:35], v[28:31], v[48:51], v[32:35]
    v_exp_f32 v119, v119
    v_mfma_f32_16x16x32_bf16 v[36:39], v[28:31], v[52:55], v[36:39]
    s_waitcnt lgkmcnt(4)
    ds_read_b128 a[180:183], v20 offset:21504
    v_cvt_pk_bf16_f32 v59, v118, v119
    v_mfma_f32_16x16x32_bf16 v[128:131], a[160:163], v[48:51], v[128:131]
    v_exp_f32 v120, v120
    v_mfma_f32_16x16x32_bf16 v[160:163], a[160:163], v[52:55], v[160:163]
    s_waitcnt lgkmcnt(4)
    v_lshlrev_b32 v14, 4, v14
    v_lshrrev_b32 v13, 3, v2
    v_mfma_f32_16x16x32_bf16 v[132:135], a[164:167], v[48:51], v[132:135]
    v_exp_f32 v121, v121
    v_mfma_f32_16x16x32_bf16 v[164:167], a[164:167], v[52:55], v[164:167]
    s_waitcnt lgkmcnt(3)
    ds_read_b128 a[184:187], v20 offset:22528
    v_cvt_pk_bf16_f32 v60, v120, v121
    v_mfma_f32_16x16x32_bf16 v[136:139], a[168:171], v[48:51], v[136:139]
    v_exp_f32 v122, v122
    v_mfma_f32_16x16x32_bf16 v[168:171], a[168:171], v[52:55], v[168:171]
    s_waitcnt lgkmcnt(3)
    v_lshl_add_u32 v12, v13, 13, v14
    v_mul_u32_u24 v13, 28672, v13
    v_mfma_f32_16x16x32_bf16 v[140:143], a[172:175], v[48:51], v[140:143]
    v_exp_f32 v123, v123
    v_mfma_f32_16x16x32_bf16 v[172:175], a[172:175], v[52:55], v[172:175]
    s_waitcnt lgkmcnt(2)
    ds_read_b128 a[188:191], v20 offset:23552
    v_cvt_pk_bf16_f32 v61, v122, v123
    v_mfma_f32_16x16x32_bf16 v[144:147], a[176:179], v[48:51], v[144:147]
    v_exp_f32 v124, v124
    v_mfma_f32_16x16x32_bf16 v[176:179], a[176:179], v[52:55], v[176:179]
    s_waitcnt lgkmcnt(2)
    v_add_u32 v13, v13, v14
    v_mfma_f32_16x16x32_bf16 v[148:151], a[180:183], v[48:51], v[148:151]
    s_lshl_b32 s17, s4, 2
    v_exp_f32 v125, v125
    v_mfma_f32_16x16x32_bf16 v[180:183], a[180:183], v[52:55], v[180:183]
    s_waitcnt lgkmcnt(1)
    s_add_u32 s17, s17, s3
    v_cvt_pk_bf16_f32 v62, v124, v125
    v_xor_b32 v19, 98304, v19
    v_mfma_f32_16x16x32_bf16 v[152:155], a[184:187], v[48:51], v[152:155]
    s_lshl_b32 s17, s17, 7
    v_exp_f32 v126, v126
    v_mfma_f32_16x16x32_bf16 v[184:187], a[184:187], v[52:55], v[184:187]
    s_waitcnt lgkmcnt(0)
    s_lshl_b32 s100, s101, 16
    s_add_u32 s17, s17, s100
    v_xor_b32 v20, 98304, v20
    v_mfma_f32_16x16x32_bf16 v[156:159], a[188:191], v[48:51], v[156:159]
    s_add_u32 s17, s17, 4194304
    v_exp_f32 v127, v127
    v_mfma_f32_16x16x32_bf16 v[188:191], a[188:191], v[52:55], v[188:191]
    s_cmp_lt_u32 s101, s26
    s_cselect_b32 s17, s17, 2143285248
    v_cvt_pk_bf16_f32 v63, v126, v127
    buffer_store_dwordx4 a[0:3], v12, s[8:11], s17 offen sc0 sc1
    v_mfma_f32_16x16x32_bf16 v[112:115], a[128:131], a[224:227], v[72:75]
    s_add_u32 s17, s17, 4096
    v_exp_f32 v96, v96
    v_mfma_f32_16x16x32_bf16 v[112:115], a[132:135], a[228:231], v[112:115]
    buffer_store_dwordx4 a[4:7], v12, s[8:11], s17 offen sc0 sc1
    v_mfma_f32_16x16x32_bf16 v[112:115], a[136:139], a[232:235], v[112:115]
    s_add_u32 s27, s18, 0
    v_exp_f32 v97, v97
    v_mfma_f32_16x16x32_bf16 v[112:115], a[140:143], a[236:239], v[112:115]
    v_cvt_pk_bf16_f32 v48, v96, v97
    v_lshrrev_b32 v9, 1, v2
    v_mfma_f32_16x16x32_bf16 v[120:123], a[128:131], a[240:243], v[76:79]
    v_exp_f32 v98, v98
    v_mfma_f32_16x16x32_bf16 v[120:123], a[132:135], a[244:247], v[120:123]
    buffer_store_dwordx4 v[24:27], v17, s[8:11], s27 offen offset:256 sc0 sc1
    v_mfma_f32_16x16x32_bf16 v[120:123], a[136:139], a[248:251], v[120:123]
    s_add_u32 s27, s18, 131072
    v_exp_f32 v99, v99
    v_mfma_f32_16x16x32_bf16 v[120:123], a[140:143], a[252:255], v[120:123]
    buffer_store_dwordx4 v[24:27], v17, s[8:11], s27 offen offset:256 sc0 sc1
    v_mfma_f32_16x16x32_bf16 v[116:119], a[144:147], a[224:227], v[72:75]
    s_add_u32 s27, s18, 0
    v_exp_f32 v100, v100
    v_mfma_f32_16x16x32_bf16 v[116:119], a[148:151], a[228:231], v[116:119]
    ds_read_b128 a[128:131], v18 offset:16384
    v_cvt_pk_bf16_f32 v49, v98, v99
    v_mfma_f32_16x16x32_bf16 v[116:119], a[152:155], a[232:235], v[116:119]
    s_add_u32 s19, s82, 32768
    v_exp_f32 v101, v101
    v_mfma_f32_16x16x32_bf16 v[116:119], a[156:159], a[236:239], v[116:119]
    s_sub_u32 s82, s12, s13
    ds_read_b128 a[132:135], v18 offset:17408
    v_cvt_pk_bf16_f32 v50, v100, v101
    v_mfma_f32_16x16x32_bf16 v[124:127], a[144:147], a[240:243], v[76:79]
    s_sub_u32 s82, s82, 1
    v_exp_f32 v102, v102
    v_mfma_f32_16x16x32_bf16 v[124:127], a[148:151], a[244:247], v[124:127]
    s_cmp_gt_u32 s12, s13
    s_cselect_b32 s82, s82, s12
    s_lshl_b32 s82, s82, 16
    ds_read_b128 a[136:139], v18 offset:18432
    v_mfma_f32_16x16x32_bf16 v[124:127], a[152:155], a[248:251], v[124:127]
    s_add_u32 s82, s82, s81
    v_exp_f32 v103, v103
    v_mfma_f32_16x16x32_bf16 v[124:127], a[156:159], a[252:255], v[124:127]
    s_cmp_ge_u32 s12, 17
    s_cselect_b32 s82, 2147471360, s82
    ds_read_b128 a[140:143], v18 offset:19456
    v_cvt_pk_bf16_f32 v51, v102, v103
    v_mfma_f32_16x16x32_bf16 v[40:43], v[28:31], v[56:59], v[40:43]
    s_add_u32 s12, s12, 1
    v_exp_f32 v104, v104
    v_mfma_f32_16x16x32_bf16 v[44:47], v[28:31], v[60:63], v[44:47]
    ds_read_b128 a[144:147], v18 offset:20480
    v_lshrrev_b32 v10, 4, v2
    v_mfma_f32_16x16x32_bf16 v[192:195], a[160:163], v[56:59], v[192:195]
    v_exp_f32 v105, v105
    v_mfma_f32_16x16x32_bf16 v[224:227], a[160:163], v[60:63], v[224:227]
    ds_read_b128 a[148:151], v18 offset:21504
    v_cvt_pk_bf16_f32 v52, v104, v105
    v_mfma_f32_16x16x32_bf16 v[196:199], a[164:167], v[56:59], v[196:199]
    v_exp_f32 v106, v106
    v_mfma_f32_16x16x32_bf16 v[228:231], a[164:167], v[60:63], v[228:231]
    ds_read_b128 a[152:155], v18 offset:22528
    v_xor_b32 v9, v9, v10
    v_mfma_f32_16x16x32_bf16 v[200:203], a[168:171], v[56:59], v[200:203]
    v_exp_f32 v107, v107
    v_mfma_f32_16x16x32_bf16 v[232:235], a[168:171], v[60:63], v[232:235]
    ds_read_b128 a[156:159], v18 offset:23552
    v_cvt_pk_bf16_f32 v53, v106, v107
    v_mfma_f32_16x16x32_bf16 v[204:207], a[172:175], v[56:59], v[204:207]
    v_exp_f32 v108, v108
    v_mfma_f32_16x16x32_bf16 v[236:239], a[172:175], v[60:63], v[236:239]
    buffer_store_dwordx4 v[24:27], v17, s[8:11], s27 offen offset:512 sc0 sc1
    v_mfma_f32_16x16x32_bf16 v[208:211], a[176:179], v[56:59], v[208:211]
    s_add_u32 s27, s18, 131072
    v_exp_f32 v109, v109
    v_mfma_f32_16x16x32_bf16 v[240:243], a[176:179], v[60:63], v[240:243]
    v_cvt_pk_bf16_f32 v54, v108, v109
    v_xor_b32 v18, 196608, v18
    v_mfma_f32_16x16x32_bf16 v[212:215], a[180:183], v[56:59], v[212:215]
    v_exp_f32 v110, v110
    v_mfma_f32_16x16x32_bf16 v[244:247], a[180:183], v[60:63], v[244:247]
    buffer_store_dwordx4 v[24:27], v17, s[8:11], s27 offen offset:512 sc0 sc1
    v_mfma_f32_16x16x32_bf16 v[216:219], a[184:187], v[56:59], v[216:219]
    s_add_u32 s27, s18, 0
    v_exp_f32 v111, v111
    v_mfma_f32_16x16x32_bf16 v[248:251], a[184:187], v[60:63], v[248:251]
    v_cvt_pk_bf16_f32 v55, v110, v111
    v_and_b32 v9, 3, v9
    v_mfma_f32_16x16x32_bf16 v[220:223], a[188:191], v[56:59], v[220:223]
    buffer_store_dwordx4 v[24:27], v17, s[8:11], s27 offen offset:768 sc0 sc1
    v_mfma_f32_16x16x32_bf16 v[252:255], a[188:191], v[60:63], v[252:255]
    v_lshlrev_b32 v9, 5, v9
    v_and_b32 v10, 1, v2
    v_lshl_add_u32 v9, v10, 4, v9
    v_lshrrev_b32 v8, 3, v2
    s_waitcnt vmcnt(9) lgkmcnt(0)
    s_barrier
    buffer_store_dword v6, v5, s[8:11], s22 offen sc0 sc1
    v_mfma_f32_16x16x32_bf16 v[96:99], a[128:131], a[192:195], v[64:67]
    s_add_u32 m0, s15, 0
    ds_read_b128 a[160:163], v19 offset:0
    v_mfma_f32_16x16x32_bf16 v[96:99], a[132:135], a[196:199], v[96:99]
    ds_read_b128 a[164:167], v19 offset:1024
    v_mfma_f32_16x16x32_bf16 v[96:99], a[136:139], a[200:203], v[96:99]
    v_exp_f32 v112, v112
    v_mfma_f32_16x16x32_bf16 v[96:99], a[140:143], a[204:207], v[96:99]
    buffer_load_dwordx4 v1, s[8:11], s82 offen offset:0 lds
    v_mfma_f32_16x16x32_bf16 v[104:107], a[128:131], a[208:211], v[68:71]
    v_exp_f32 v113, v113
    v_mfma_f32_16x16x32_bf16 v[104:107], a[132:135], a[212:215], v[104:107]
    ds_read_b128 a[168:171], v19 offset:2048
    v_cvt_pk_bf16_f32 v56, v112, v113
    v_mfma_f32_16x16x32_bf16 v[104:107], a[136:139], a[216:219], v[104:107]
    v_exp_f32 v114, v114
    v_mfma_f32_16x16x32_bf16 v[104:107], a[140:143], a[220:223], v[104:107]
    buffer_load_dwordx4 v1, s[8:11], s82 offen offset:1024 lds
    v_mfma_f32_16x16x32_bf16 v[100:103], a[144:147], a[192:195], v[64:67]
    v_exp_f32 v115, v115
    v_mfma_f32_16x16x32_bf16 v[100:103], a[148:151], a[196:199], v[100:103]
    ds_read_b128 a[172:175], v19 offset:3072
    v_cvt_pk_bf16_f32 v57, v114, v115
    v_mfma_f32_16x16x32_bf16 v[100:103], a[152:155], a[200:203], v[100:103]
    v_exp_f32 v116, v116
    v_mfma_f32_16x16x32_bf16 v[100:103], a[156:159], a[204:207], v[100:103]
    buffer_load_dwordx4 v1, s[8:11], s82 offen offset:2048 lds
    v_mfma_f32_16x16x32_bf16 v[108:111], a[144:147], a[208:211], v[68:71]
    v_exp_f32 v117, v117
    v_mfma_f32_16x16x32_bf16 v[108:111], a[148:151], a[212:215], v[108:111]
    ds_read_b128 a[176:179], v20 offset:4096
    v_cvt_pk_bf16_f32 v58, v116, v117
    v_mfma_f32_16x16x32_bf16 v[108:111], a[152:155], a[216:219], v[108:111]
    v_exp_f32 v118, v118
    v_mfma_f32_16x16x32_bf16 v[108:111], a[156:159], a[220:223], v[108:111]
    buffer_load_dwordx4 v1, s[8:11], s82 offen offset:3072 lds
    v_mfma_f32_16x16x32_bf16 v[32:35], v[28:31], v[48:51], v[32:35]
    s_add_u32 m0, s15, 4096
    v_exp_f32 v119, v119
    v_mfma_f32_16x16x32_bf16 v[36:39], v[28:31], v[52:55], v[36:39]
    s_waitcnt lgkmcnt(4)
    ds_read_b128 a[180:183], v20 offset:5120
    v_cvt_pk_bf16_f32 v59, v118, v119
    v_mfma_f32_16x16x32_bf16 v[128:131], a[160:163], v[48:51], v[128:131]
    v_exp_f32 v120, v120
    v_mfma_f32_16x16x32_bf16 v[160:163], a[160:163], v[52:55], v[160:163]
    s_waitcnt lgkmcnt(4)
    v_mfma_f32_16x16x32_bf16 v[132:135], a[164:167], v[48:51], v[132:135]
    v_exp_f32 v121, v121
    v_mfma_f32_16x16x32_bf16 v[164:167], a[164:167], v[52:55], v[164:167]
    s_waitcnt lgkmcnt(3)
    ds_read_b128 a[184:187], v20 offset:6144
    v_cvt_pk_bf16_f32 v60, v120, v121
    v_mfma_f32_16x16x32_bf16 v[136:139], a[168:171], v[48:51], v[136:139]
    s_waitcnt lgkmcnt(3)
    v_exp_f32 v122, v122
    v_mfma_f32_16x16x32_bf16 v[168:171], a[168:171], v[52:55], v[168:171]
    buffer_load_dwordx4 v15, s[8:11], s82 offen offset:0 lds
    v_mfma_f32_16x16x32_bf16 v[140:143], a[172:175], v[48:51], v[140:143]
    v_exp_f32 v123, v123
    v_mfma_f32_16x16x32_bf16 v[172:175], a[172:175], v[52:55], v[172:175]
    s_waitcnt lgkmcnt(2)
    ds_read_b128 a[188:191], v20 offset:7168
    v_cvt_pk_bf16_f32 v61, v122, v123
    v_mfma_f32_16x16x32_bf16 v[144:147], a[176:179], v[48:51], v[144:147]
    s_waitcnt lgkmcnt(2)
    v_exp_f32 v124, v124
    v_mfma_f32_16x16x32_bf16 v[176:179], a[176:179], v[52:55], v[176:179]
    buffer_load_dwordx4 v15, s[8:11], s82 offen offset:1024 lds
    v_mfma_f32_16x16x32_bf16 v[148:151], a[180:183], v[48:51], v[148:151]
    v_exp_f32 v125, v125
    v_mfma_f32_16x16x32_bf16 v[180:183], a[180:183], v[52:55], v[180:183]
    s_waitcnt lgkmcnt(1)
    v_cvt_pk_bf16_f32 v62, v124, v125
    v_mfma_f32_16x16x32_bf16 v[152:155], a[184:187], v[48:51], v[152:155]
    s_waitcnt lgkmcnt(0)
    v_exp_f32 v126, v126
    v_mfma_f32_16x16x32_bf16 v[184:187], a[184:187], v[52:55], v[184:187]
    buffer_load_dwordx4 v15, s[8:11], s82 offen offset:2048 lds
    v_mfma_f32_16x16x32_bf16 v[156:159], a[188:191], v[48:51], v[156:159]
    v_exp_f32 v127, v127
    v_mfma_f32_16x16x32_bf16 v[188:191], a[188:191], v[52:55], v[188:191]
    v_cvt_pk_bf16_f32 v63, v126, v127
    v_mfma_f32_16x16x32_bf16 v[112:115], a[128:131], a[224:227], v[72:75]
    v_mfma_f32_16x16x32_bf16 v[112:115], a[132:135], a[228:231], v[112:115]
    v_mfma_f32_16x16x32_bf16 v[112:115], a[136:139], a[232:235], v[112:115]
    v_exp_f32 v96, v96
    v_mfma_f32_16x16x32_bf16 v[112:115], a[140:143], a[236:239], v[112:115]
    buffer_load_dwordx4 v15, s[8:11], s82 offen offset:3072 lds
    v_mfma_f32_16x16x32_bf16 v[120:123], a[128:131], a[240:243], v[76:79]
    s_xor_b32 s15, s15, 196608
    v_exp_f32 v97, v97
    v_mfma_f32_16x16x32_bf16 v[120:123], a[132:135], a[244:247], v[120:123]
    s_add_u32 m0, s16, 0
    ds_read_b128 a[128:131], v18 offset:0
    v_cvt_pk_bf16_f32 v48, v96, v97
    v_mfma_f32_16x16x32_bf16 v[120:123], a[136:139], a[248:251], v[120:123]
    v_exp_f32 v98, v98
    v_mfma_f32_16x16x32_bf16 v[120:123], a[140:143], a[252:255], v[120:123]
    buffer_load_dwordx4 v1, s[8:11], s19 offen offset:0 lds
    v_mfma_f32_16x16x32_bf16 v[116:119], a[144:147], a[224:227], v[72:75]
    v_exp_f32 v99, v99
    v_mfma_f32_16x16x32_bf16 v[116:119], a[148:151], a[228:231], v[116:119]
    ds_read_b128 a[132:135], v18 offset:1024
    v_cvt_pk_bf16_f32 v49, v98, v99
    v_mfma_f32_16x16x32_bf16 v[116:119], a[152:155], a[232:235], v[116:119]
    v_exp_f32 v100, v100
    v_mfma_f32_16x16x32_bf16 v[116:119], a[156:159], a[236:239], v[116:119]
    buffer_load_dwordx4 v1, s[8:11], s19 offen offset:1024 lds
    v_mfma_f32_16x16x32_bf16 v[124:127], a[144:147], a[240:243], v[76:79]
    v_exp_f32 v101, v101
    v_mfma_f32_16x16x32_bf16 v[124:127], a[148:151], a[244:247], v[124:127]
    ds_read_b128 a[136:139], v18 offset:2048
    v_cvt_pk_bf16_f32 v50, v100, v101
    v_mfma_f32_16x16x32_bf16 v[124:127], a[152:155], a[248:251], v[124:127]
    v_exp_f32 v102, v102
    v_mfma_f32_16x16x32_bf16 v[124:127], a[156:159], a[252:255], v[124:127]
    buffer_load_dwordx4 v1, s[8:11], s19 offen offset:2048 lds
    v_mfma_f32_16x16x32_bf16 v[40:43], v[28:31], v[56:59], v[40:43]
    v_exp_f32 v103, v103
    v_mfma_f32_16x16x32_bf16 v[44:47], v[28:31], v[60:63], v[44:47]
    ds_read_b128 a[140:143], v18 offset:3072
    v_cvt_pk_bf16_f32 v51, v102, v103
    v_mfma_f32_16x16x32_bf16 v[192:195], a[160:163], v[56:59], v[192:195]
    v_exp_f32 v104, v104
    v_mfma_f32_16x16x32_bf16 v[224:227], a[160:163], v[60:63], v[224:227]
    v_mfma_f32_16x16x32_bf16 v[196:199], a[164:167], v[56:59], v[196:199]
    v_exp_f32 v105, v105
    v_mfma_f32_16x16x32_bf16 v[228:231], a[164:167], v[60:63], v[228:231]
    ds_read_b128 a[144:147], v18 offset:4096
    v_cvt_pk_bf16_f32 v52, v104, v105
    v_mfma_f32_16x16x32_bf16 v[200:203], a[168:171], v[56:59], v[200:203]
    v_exp_f32 v106, v106
    v_mfma_f32_16x16x32_bf16 v[232:235], a[168:171], v[60:63], v[232:235]
    buffer_load_dwordx4 v1, s[8:11], s19 offen offset:3072 lds
    v_mfma_f32_16x16x32_bf16 v[204:207], a[172:175], v[56:59], v[204:207]
    s_add_u32 m0, s16, 4096
    v_exp_f32 v107, v107
    v_mfma_f32_16x16x32_bf16 v[236:239], a[172:175], v[60:63], v[236:239]
    ds_read_b128 a[148:151], v18 offset:5120
    v_cvt_pk_bf16_f32 v53, v106, v107
    v_mfma_f32_16x16x32_bf16 v[208:211], a[176:179], v[56:59], v[208:211]
    v_exp_f32 v108, v108
    v_mfma_f32_16x16x32_bf16 v[240:243], a[176:179], v[60:63], v[240:243]
    buffer_load_dwordx4 v15, s[8:11], s19 offen offset:0 lds
    v_mfma_f32_16x16x32_bf16 v[212:215], a[180:183], v[56:59], v[212:215]
    v_exp_f32 v109, v109
    v_mfma_f32_16x16x32_bf16 v[244:247], a[180:183], v[60:63], v[244:247]
    ds_read_b128 a[152:155], v18 offset:6144
    v_cvt_pk_bf16_f32 v54, v108, v109
    v_mfma_f32_16x16x32_bf16 v[216:219], a[184:187], v[56:59], v[216:219]
    v_exp_f32 v110, v110
    v_mfma_f32_16x16x32_bf16 v[248:251], a[184:187], v[60:63], v[248:251]
    buffer_load_dwordx4 v15, s[8:11], s19 offen offset:1024 lds
    v_mfma_f32_16x16x32_bf16 v[220:223], a[188:191], v[56:59], v[220:223]
    v_exp_f32 v111, v111
    v_mfma_f32_16x16x32_bf16 v[252:255], a[188:191], v[60:63], v[252:255]
    ds_read_b128 a[156:159], v18 offset:7168
    v_cvt_pk_bf16_f32 v55, v110, v111
    s_waitcnt lgkmcnt(7)
    v_mfma_f32_16x16x32_bf16 v[96:99], a[128:131], a[192:195], v[64:67]
    s_waitcnt lgkmcnt(6)
    ds_read_b128 a[160:163], v19 offset:16384
    v_mfma_f32_16x16x32_bf16 v[96:99], a[132:135], a[196:199], v[96:99]
    s_waitcnt lgkmcnt(6)
    ds_read_b128 a[164:167], v19 offset:17408
    v_mfma_f32_16x16x32_bf16 v[96:99], a[136:139], a[200:203], v[96:99]
    s_waitcnt lgkmcnt(6)
    v_exp_f32 v112, v112
    v_mfma_f32_16x16x32_bf16 v[96:99], a[140:143], a[204:207], v[96:99]
    buffer_load_dwordx4 v15, s[8:11], s19 offen offset:2048 lds
    v_mfma_f32_16x16x32_bf16 v[104:107], a[128:131], a[208:211], v[68:71]
    v_exp_f32 v113, v113
    v_mfma_f32_16x16x32_bf16 v[104:107], a[132:135], a[212:215], v[104:107]
    ds_read_b128 a[168:171], v19 offset:18432
    v_cvt_pk_bf16_f32 v56, v112, v113
    v_mfma_f32_16x16x32_bf16 v[104:107], a[136:139], a[216:219], v[104:107]
    s_waitcnt lgkmcnt(6)
    v_exp_f32 v114, v114
    v_mfma_f32_16x16x32_bf16 v[104:107], a[140:143], a[220:223], v[104:107]
    buffer_load_dwordx4 v15, s[8:11], s19 offen offset:3072 lds
    v_mfma_f32_16x16x32_bf16 v[100:103], a[144:147], a[192:195], v[64:67]
    s_waitcnt lgkmcnt(5)
    s_xor_b32 s16, s16, 98304
    v_exp_f32 v115, v115
    v_mfma_f32_16x16x32_bf16 v[100:103], a[148:151], a[196:199], v[100:103]
    s_waitcnt lgkmcnt(4)
    s_add_u32 s17, s17, 2093056
    ds_read_b128 a[172:175], v19 offset:19456
    v_cvt_pk_bf16_f32 v57, v114, v115
    v_mfma_f32_16x16x32_bf16 v[100:103], a[152:155], a[200:203], v[100:103]
    s_waitcnt lgkmcnt(4)
    v_exp_f32 v116, v116
    v_mfma_f32_16x16x32_bf16 v[100:103], a[156:159], a[204:207], v[100:103]
    buffer_store_dwordx4 a[8:11], v12, s[8:11], s17 offen sc0 sc1
    v_mfma_f32_16x16x32_bf16 v[108:111], a[144:147], a[208:211], v[68:71]
    s_add_u32 s27, s18, 131072
    v_exp_f32 v117, v117
    v_mfma_f32_16x16x32_bf16 v[108:111], a[148:151], a[212:215], v[108:111]
    ds_read_b128 a[176:179], v20 offset:20480
    v_cvt_pk_bf16_f32 v58, v116, v117
    v_mfma_f32_16x16x32_bf16 v[108:111], a[152:155], a[216:219], v[108:111]
    v_exp_f32 v118, v118
    v_mfma_f32_16x16x32_bf16 v[108:111], a[156:159], a[220:223], v[108:111]
    buffer_store_dwordx4 v[24:27], v17, s[8:11], s27 offen offset:768 sc0 sc1
    v_mfma_f32_16x16x32_bf16 v[32:35], v[28:31], v[48:51], v[32:35]
    s_add_u32 s27, s18, 8388608
    v_exp_f32 v119, v119
    v_mfma_f32_16x16x32_bf16 v[36:39], v[28:31], v[52:55], v[36:39]
    s_waitcnt lgkmcnt(4)
    ds_read_b128 a[180:183], v20 offset:21504
    v_cvt_pk_bf16_f32 v59, v118, v119
    v_mfma_f32_16x16x32_bf16 v[128:131], a[160:163], v[48:51], v[128:131]
    s_waitcnt lgkmcnt(4)
    v_exp_f32 v120, v120
    v_mfma_f32_16x16x32_bf16 v[160:163], a[160:163], v[52:55], v[160:163]
    buffer_store_dwordx4 v[24:27], v17, s[8:11], s27 offen offset:0 sc0 sc1
    v_mfma_f32_16x16x32_bf16 v[132:135], a[164:167], v[48:51], v[132:135]
    s_add_u32 s27, s18, 8519680
    v_exp_f32 v121, v121
    v_mfma_f32_16x16x32_bf16 v[164:167], a[164:167], v[52:55], v[164:167]
    s_waitcnt lgkmcnt(3)
    ds_read_b128 a[184:187], v20 offset:22528
    v_cvt_pk_bf16_f32 v60, v120, v121
    v_mfma_f32_16x16x32_bf16 v[136:139], a[168:171], v[48:51], v[136:139]
    s_waitcnt lgkmcnt(3)
    v_exp_f32 v122, v122
    v_mfma_f32_16x16x32_bf16 v[168:171], a[168:171], v[52:55], v[168:171]
    buffer_store_dwordx4 v[24:27], v17, s[8:11], s27 offen offset:0 sc0 sc1
    v_mfma_f32_16x16x32_bf16 v[140:143], a[172:175], v[48:51], v[140:143]
    v_exp_f32 v123, v123
    v_mfma_f32_16x16x32_bf16 v[172:175], a[172:175], v[52:55], v[172:175]
    s_waitcnt lgkmcnt(2)
    ds_read_b128 a[188:191], v20 offset:23552
    v_cvt_pk_bf16_f32 v61, v122, v123
    v_mfma_f32_16x16x32_bf16 v[144:147], a[176:179], v[48:51], v[144:147]
    v_exp_f32 v124, v124
    v_mfma_f32_16x16x32_bf16 v[176:179], a[176:179], v[52:55], v[176:179]
    s_waitcnt lgkmcnt(2)
    v_mfma_f32_16x16x32_bf16 v[148:151], a[180:183], v[48:51], v[148:151]
    v_exp_f32 v125, v125
    v_mfma_f32_16x16x32_bf16 v[180:183], a[180:183], v[52:55], v[180:183]
    s_waitcnt lgkmcnt(1)
    v_cvt_pk_bf16_f32 v62, v124, v125
    v_xor_b32 v19, 98304, v19
    v_mfma_f32_16x16x32_bf16 v[152:155], a[184:187], v[48:51], v[152:155]
    v_exp_f32 v126, v126
    v_mfma_f32_16x16x32_bf16 v[184:187], a[184:187], v[52:55], v[184:187]
    s_waitcnt lgkmcnt(0)
    v_xor_b32 v20, 98304, v20
    v_mfma_f32_16x16x32_bf16 v[156:159], a[188:191], v[48:51], v[156:159]
    v_exp_f32 v127, v127
    v_mfma_f32_16x16x32_bf16 v[188:191], a[188:191], v[52:55], v[188:191]
    v_cvt_pk_bf16_f32 v63, v126, v127
    v_mfma_f32_16x16x32_bf16 v[112:115], a[128:131], a[224:227], v[72:75]
    s_add_u32 s17, s17, 4096
    v_exp_f32 v96, v96
    v_mfma_f32_16x16x32_bf16 v[112:115], a[132:135], a[228:231], v[112:115]
    buffer_store_dwordx4 a[12:15], v12, s[8:11], s17 offen sc0 sc1
    v_mfma_f32_16x16x32_bf16 v[112:115], a[136:139], a[232:235], v[112:115]
    s_add_u32 s27, s18, 8388608
    v_exp_f32 v97, v97
    v_mfma_f32_16x16x32_bf16 v[112:115], a[140:143], a[236:239], v[112:115]
    v_cvt_pk_bf16_f32 v48, v96, v97
    v_lshl_add_u32 v8, v8, 10, v9
    v_mfma_f32_16x16x32_bf16 v[120:123], a[128:131], a[240:243], v[76:79]
    v_exp_f32 v98, v98
    v_mfma_f32_16x16x32_bf16 v[120:123], a[132:135], a[244:247], v[120:123]
    buffer_store_dwordx4 v[24:27], v17, s[8:11], s27 offen offset:256 sc0 sc1
    v_mfma_f32_16x16x32_bf16 v[120:123], a[136:139], a[248:251], v[120:123]
    s_add_u32 s27, s18, 8519680
    v_exp_f32 v99, v99
    v_mfma_f32_16x16x32_bf16 v[120:123], a[140:143], a[252:255], v[120:123]
    buffer_store_dwordx4 v[24:27], v17, s[8:11], s27 offen offset:256 sc0 sc1
    v_mfma_f32_16x16x32_bf16 v[116:119], a[144:147], a[224:227], v[72:75]
    s_add_u32 s27, s18, 8388608
    v_exp_f32 v100, v100
    v_mfma_f32_16x16x32_bf16 v[116:119], a[148:151], a[228:231], v[116:119]
    ds_read_b128 a[128:131], v18 offset:16384
    v_cvt_pk_bf16_f32 v49, v98, v99
    v_mfma_f32_16x16x32_bf16 v[116:119], a[152:155], a[232:235], v[116:119]
    s_add_u32 s19, s82, 32768
    v_exp_f32 v101, v101
    v_mfma_f32_16x16x32_bf16 v[116:119], a[156:159], a[236:239], v[116:119]
    s_sub_u32 s82, s12, s13
    ds_read_b128 a[132:135], v18 offset:17408
    v_cvt_pk_bf16_f32 v50, v100, v101
    v_mfma_f32_16x16x32_bf16 v[124:127], a[144:147], a[240:243], v[76:79]
    s_sub_u32 s82, s82, 1
    v_exp_f32 v102, v102
    v_mfma_f32_16x16x32_bf16 v[124:127], a[148:151], a[244:247], v[124:127]
    s_cmp_gt_u32 s12, s13
    s_cselect_b32 s82, s82, s12
    s_lshl_b32 s82, s82, 16
    ds_read_b128 a[136:139], v18 offset:18432
    v_mfma_f32_16x16x32_bf16 v[124:127], a[152:155], a[248:251], v[124:127]
    s_add_u32 s82, s82, s81
    v_exp_f32 v103, v103
    v_mfma_f32_16x16x32_bf16 v[124:127], a[156:159], a[252:255], v[124:127]
    s_cmp_ge_u32 s12, 17
    s_cselect_b32 s82, 2147471360, s82
    ds_read_b128 a[140:143], v18 offset:19456
    v_cvt_pk_bf16_f32 v51, v102, v103
    v_mfma_f32_16x16x32_bf16 v[40:43], v[28:31], v[56:59], v[40:43]
    s_add_u32 s12, s12, 1
    v_exp_f32 v104, v104
    v_mfma_f32_16x16x32_bf16 v[44:47], v[28:31], v[60:63], v[44:47]
    ds_read_b128 a[144:147], v18 offset:20480
    v_bfe_u32 v4, v2, 1, 2
    v_mfma_f32_16x16x32_bf16 v[192:195], a[160:163], v[56:59], v[192:195]
    v_exp_f32 v105, v105
    v_mfma_f32_16x16x32_bf16 v[224:227], a[160:163], v[60:63], v[224:227]
    ds_read_b128 a[148:151], v18 offset:21504
    v_cvt_pk_bf16_f32 v52, v104, v105
    v_mfma_f32_16x16x32_bf16 v[196:199], a[164:167], v[56:59], v[196:199]
    v_exp_f32 v106, v106
    v_mfma_f32_16x16x32_bf16 v[228:231], a[164:167], v[60:63], v[228:231]
    ds_read_b128 a[152:155], v18 offset:22528
    v_lshlrev_b32 v4, 11, v4
    v_mfma_f32_16x16x32_bf16 v[200:203], a[168:171], v[56:59], v[200:203]
    v_exp_f32 v107, v107
    v_mfma_f32_16x16x32_bf16 v[232:235], a[168:171], v[60:63], v[232:235]
    ds_read_b128 a[156:159], v18 offset:23552
    v_cvt_pk_bf16_f32 v53, v106, v107
    v_mfma_f32_16x16x32_bf16 v[204:207], a[172:175], v[56:59], v[204:207]
    v_exp_f32 v108, v108
    v_mfma_f32_16x16x32_bf16 v[236:239], a[172:175], v[60:63], v[236:239]
    buffer_store_dwordx4 v[24:27], v17, s[8:11], s27 offen offset:512 sc0 sc1
    v_mfma_f32_16x16x32_bf16 v[208:211], a[176:179], v[56:59], v[208:211]
    s_add_u32 s27, s18, 8519680
    v_exp_f32 v109, v109
    v_mfma_f32_16x16x32_bf16 v[240:243], a[176:179], v[60:63], v[240:243]
    v_cvt_pk_bf16_f32 v54, v108, v109
    v_xor_b32 v18, 196608, v18
    v_mfma_f32_16x16x32_bf16 v[212:215], a[180:183], v[56:59], v[212:215]
    v_exp_f32 v110, v110
    v_mfma_f32_16x16x32_bf16 v[244:247], a[180:183], v[60:63], v[244:247]
    buffer_store_dwordx4 v[24:27], v17, s[8:11], s27 offen offset:512 sc0 sc1
    v_mfma_f32_16x16x32_bf16 v[216:219], a[184:187], v[56:59], v[216:219]
    v_exp_f32 v111, v111
    v_mfma_f32_16x16x32_bf16 v[248:251], a[184:187], v[60:63], v[248:251]
    v_cvt_pk_bf16_f32 v55, v110, v111
    v_lshl_add_u32 v4, v10, 6, v4
    v_mfma_f32_16x16x32_bf16 v[220:223], a[188:191], v[56:59], v[220:223]
    v_add_u32 v9, 7168, v8
    v_add_u32 v10, 14336, v8
    v_mfma_f32_16x16x32_bf16 v[252:255], a[188:191], v[60:63], v[252:255]
    v_add_u32 v11, 21504, v8
    s_waitcnt vmcnt(9) lgkmcnt(0)
    s_barrier
    v_mfma_f32_16x16x32_bf16 v[96:99], a[128:131], a[192:195], v[64:67]
    s_add_u32 m0, s15, 0
    ds_read_b128 a[160:163], v19 offset:0
    v_mfma_f32_16x16x32_bf16 v[96:99], a[132:135], a[196:199], v[96:99]
    ds_read_b128 a[164:167], v19 offset:1024
    v_mfma_f32_16x16x32_bf16 v[96:99], a[136:139], a[200:203], v[96:99]
    v_exp_f32 v112, v112
    v_mfma_f32_16x16x32_bf16 v[96:99], a[140:143], a[204:207], v[96:99]
    buffer_load_dwordx4 v1, s[8:11], s82 offen offset:0 lds
    v_mfma_f32_16x16x32_bf16 v[104:107], a[128:131], a[208:211], v[68:71]
    v_exp_f32 v113, v113
    v_mfma_f32_16x16x32_bf16 v[104:107], a[132:135], a[212:215], v[104:107]
    ds_read_b128 a[168:171], v19 offset:2048
    v_cvt_pk_bf16_f32 v56, v112, v113
    v_mfma_f32_16x16x32_bf16 v[104:107], a[136:139], a[216:219], v[104:107]
    v_exp_f32 v114, v114
    v_mfma_f32_16x16x32_bf16 v[104:107], a[140:143], a[220:223], v[104:107]
    buffer_load_dwordx4 v1, s[8:11], s82 offen offset:1024 lds
    v_mfma_f32_16x16x32_bf16 v[100:103], a[144:147], a[192:195], v[64:67]
    v_exp_f32 v115, v115
    v_mfma_f32_16x16x32_bf16 v[100:103], a[148:151], a[196:199], v[100:103]
    ds_read_b128 a[172:175], v19 offset:3072
    v_cvt_pk_bf16_f32 v57, v114, v115
    v_mfma_f32_16x16x32_bf16 v[100:103], a[152:155], a[200:203], v[100:103]
    v_exp_f32 v116, v116
    v_mfma_f32_16x16x32_bf16 v[100:103], a[156:159], a[204:207], v[100:103]
    buffer_load_dwordx4 v1, s[8:11], s82 offen offset:2048 lds
    v_mfma_f32_16x16x32_bf16 v[108:111], a[144:147], a[208:211], v[68:71]
    v_exp_f32 v117, v117
    v_mfma_f32_16x16x32_bf16 v[108:111], a[148:151], a[212:215], v[108:111]
    ds_read_b128 a[176:179], v20 offset:4096
    v_cvt_pk_bf16_f32 v58, v116, v117
    v_mfma_f32_16x16x32_bf16 v[108:111], a[152:155], a[216:219], v[108:111]
    v_exp_f32 v118, v118
    v_mfma_f32_16x16x32_bf16 v[108:111], a[156:159], a[220:223], v[108:111]
    buffer_load_dwordx4 v1, s[8:11], s82 offen offset:3072 lds
    v_mfma_f32_16x16x32_bf16 v[32:35], v[28:31], v[48:51], v[32:35]
    s_add_u32 m0, s15, 4096
    v_exp_f32 v119, v119
    v_mfma_f32_16x16x32_bf16 v[36:39], v[28:31], v[52:55], v[36:39]
    s_waitcnt lgkmcnt(4)
    ds_read_b128 a[180:183], v20 offset:5120
    v_cvt_pk_bf16_f32 v59, v118, v119
    v_mfma_f32_16x16x32_bf16 v[128:131], a[160:163], v[48:51], v[128:131]
    v_exp_f32 v120, v120
    v_mfma_f32_16x16x32_bf16 v[160:163], a[160:163], v[52:55], v[160:163]
    s_waitcnt lgkmcnt(4)
    v_mfma_f32_16x16x32_bf16 v[132:135], a[164:167], v[48:51], v[132:135]
    v_exp_f32 v121, v121
    v_mfma_f32_16x16x32_bf16 v[164:167], a[164:167], v[52:55], v[164:167]
    s_waitcnt lgkmcnt(3)
    ds_read_b128 a[184:187], v20 offset:6144
    v_cvt_pk_bf16_f32 v60, v120, v121
    v_mfma_f32_16x16x32_bf16 v[136:139], a[168:171], v[48:51], v[136:139]
    s_waitcnt lgkmcnt(3)
    v_exp_f32 v122, v122
    v_mfma_f32_16x16x32_bf16 v[168:171], a[168:171], v[52:55], v[168:171]
    buffer_load_dwordx4 v15, s[8:11], s82 offen offset:0 lds
    v_mfma_f32_16x16x32_bf16 v[140:143], a[172:175], v[48:51], v[140:143]
    v_exp_f32 v123, v123
    v_mfma_f32_16x16x32_bf16 v[172:175], a[172:175], v[52:55], v[172:175]
    s_waitcnt lgkmcnt(2)
    ds_read_b128 a[188:191], v20 offset:7168
    v_cvt_pk_bf16_f32 v61, v122, v123
    v_mfma_f32_16x16x32_bf16 v[144:147], a[176:179], v[48:51], v[144:147]
    s_waitcnt lgkmcnt(2)
    v_exp_f32 v124, v124
    v_mfma_f32_16x16x32_bf16 v[176:179], a[176:179], v[52:55], v[176:179]
    buffer_load_dwordx4 v15, s[8:11], s82 offen offset:1024 lds
    v_mfma_f32_16x16x32_bf16 v[148:151], a[180:183], v[48:51], v[148:151]
    v_exp_f32 v125, v125
    v_mfma_f32_16x16x32_bf16 v[180:183], a[180:183], v[52:55], v[180:183]
    s_waitcnt lgkmcnt(1)
    v_cvt_pk_bf16_f32 v62, v124, v125
    v_mfma_f32_16x16x32_bf16 v[152:155], a[184:187], v[48:51], v[152:155]
    s_waitcnt lgkmcnt(0)
    v_exp_f32 v126, v126
    v_mfma_f32_16x16x32_bf16 v[184:187], a[184:187], v[52:55], v[184:187]
    buffer_load_dwordx4 v15, s[8:11], s82 offen offset:2048 lds
    v_mfma_f32_16x16x32_bf16 v[156:159], a[188:191], v[48:51], v[156:159]
    v_exp_f32 v127, v127
    v_mfma_f32_16x16x32_bf16 v[188:191], a[188:191], v[52:55], v[188:191]
    v_cvt_pk_bf16_f32 v63, v126, v127
    v_mfma_f32_16x16x32_bf16 v[112:115], a[128:131], a[224:227], v[72:75]
    v_mfma_f32_16x16x32_bf16 v[112:115], a[132:135], a[228:231], v[112:115]
    v_mfma_f32_16x16x32_bf16 v[112:115], a[136:139], a[232:235], v[112:115]
    v_exp_f32 v96, v96
    v_mfma_f32_16x16x32_bf16 v[112:115], a[140:143], a[236:239], v[112:115]
    buffer_load_dwordx4 v15, s[8:11], s82 offen offset:3072 lds
    v_mfma_f32_16x16x32_bf16 v[120:123], a[128:131], a[240:243], v[76:79]
    s_xor_b32 s15, s15, 196608
    v_exp_f32 v97, v97
    v_mfma_f32_16x16x32_bf16 v[120:123], a[132:135], a[244:247], v[120:123]
    s_add_u32 m0, s16, 0
    ds_read_b128 a[128:131], v18 offset:0
    v_cvt_pk_bf16_f32 v48, v96, v97
    v_mfma_f32_16x16x32_bf16 v[120:123], a[136:139], a[248:251], v[120:123]
    v_exp_f32 v98, v98
    v_mfma_f32_16x16x32_bf16 v[120:123], a[140:143], a[252:255], v[120:123]
    buffer_load_dwordx4 v1, s[8:11], s19 offen offset:0 lds
    v_mfma_f32_16x16x32_bf16 v[116:119], a[144:147], a[224:227], v[72:75]
    v_exp_f32 v99, v99
    v_mfma_f32_16x16x32_bf16 v[116:119], a[148:151], a[228:231], v[116:119]
    ds_read_b128 a[132:135], v18 offset:1024
    v_cvt_pk_bf16_f32 v49, v98, v99
    v_mfma_f32_16x16x32_bf16 v[116:119], a[152:155], a[232:235], v[116:119]
    v_exp_f32 v100, v100
    v_mfma_f32_16x16x32_bf16 v[116:119], a[156:159], a[236:239], v[116:119]
    buffer_load_dwordx4 v1, s[8:11], s19 offen offset:1024 lds
    v_mfma_f32_16x16x32_bf16 v[124:127], a[144:147], a[240:243], v[76:79]
    v_exp_f32 v101, v101
    v_mfma_f32_16x16x32_bf16 v[124:127], a[148:151], a[244:247], v[124:127]
    ds_read_b128 a[136:139], v18 offset:2048
    v_cvt_pk_bf16_f32 v50, v100, v101
    v_mfma_f32_16x16x32_bf16 v[124:127], a[152:155], a[248:251], v[124:127]
    v_exp_f32 v102, v102
    v_mfma_f32_16x16x32_bf16 v[124:127], a[156:159], a[252:255], v[124:127]
    buffer_load_dwordx4 v1, s[8:11], s19 offen offset:2048 lds
    v_mfma_f32_16x16x32_bf16 v[40:43], v[28:31], v[56:59], v[40:43]
    v_exp_f32 v103, v103
    v_mfma_f32_16x16x32_bf16 v[44:47], v[28:31], v[60:63], v[44:47]
    ds_read_b128 a[140:143], v18 offset:3072
    v_cvt_pk_bf16_f32 v51, v102, v103
    v_mfma_f32_16x16x32_bf16 v[192:195], a[160:163], v[56:59], v[192:195]
    v_exp_f32 v104, v104
    v_mfma_f32_16x16x32_bf16 v[224:227], a[160:163], v[60:63], v[224:227]
    v_mfma_f32_16x16x32_bf16 v[196:199], a[164:167], v[56:59], v[196:199]
    v_exp_f32 v105, v105
    v_mfma_f32_16x16x32_bf16 v[228:231], a[164:167], v[60:63], v[228:231]
    ds_read_b128 a[144:147], v18 offset:4096
    v_cvt_pk_bf16_f32 v52, v104, v105
    v_mfma_f32_16x16x32_bf16 v[200:203], a[168:171], v[56:59], v[200:203]
    v_exp_f32 v106, v106
    v_mfma_f32_16x16x32_bf16 v[232:235], a[168:171], v[60:63], v[232:235]
    buffer_load_dwordx4 v1, s[8:11], s19 offen offset:3072 lds
    v_mfma_f32_16x16x32_bf16 v[204:207], a[172:175], v[56:59], v[204:207]
    s_add_u32 m0, s16, 4096
    v_exp_f32 v107, v107
    v_mfma_f32_16x16x32_bf16 v[236:239], a[172:175], v[60:63], v[236:239]
    ds_read_b128 a[148:151], v18 offset:5120
    v_cvt_pk_bf16_f32 v53, v106, v107
    v_mfma_f32_16x16x32_bf16 v[208:211], a[176:179], v[56:59], v[208:211]
    v_exp_f32 v108, v108
    v_mfma_f32_16x16x32_bf16 v[240:243], a[176:179], v[60:63], v[240:243]
    buffer_load_dwordx4 v15, s[8:11], s19 offen offset:0 lds
    v_mfma_f32_16x16x32_bf16 v[212:215], a[180:183], v[56:59], v[212:215]
    v_exp_f32 v109, v109
    v_mfma_f32_16x16x32_bf16 v[244:247], a[180:183], v[60:63], v[244:247]
    ds_read_b128 a[152:155], v18 offset:6144
    v_cvt_pk_bf16_f32 v54, v108, v109
    v_mfma_f32_16x16x32_bf16 v[216:219], a[184:187], v[56:59], v[216:219]
    v_exp_f32 v110, v110
    v_mfma_f32_16x16x32_bf16 v[248:251], a[184:187], v[60:63], v[248:251]
    buffer_load_dwordx4 v15, s[8:11], s19 offen offset:1024 lds
    v_mfma_f32_16x16x32_bf16 v[220:223], a[188:191], v[56:59], v[220:223]
    v_exp_f32 v111, v111
    v_mfma_f32_16x16x32_bf16 v[252:255], a[188:191], v[60:63], v[252:255]
    ds_read_b128 a[156:159], v18 offset:7168
    v_cvt_pk_bf16_f32 v55, v110, v111
    s_waitcnt lgkmcnt(7)
    v_mfma_f32_16x16x32_bf16 v[96:99], a[128:131], a[192:195], v[64:67]
    s_waitcnt lgkmcnt(6)
    s_mul_i32 s17, s4, 229376
    s_mul_i32 s100, s3, 7168
    ds_read_b128 a[160:163], v19 offset:16384
    v_mfma_f32_16x16x32_bf16 v[96:99], a[132:135], a[196:199], v[96:99]
    s_waitcnt lgkmcnt(6)
    s_add_u32 s17, s17, s100
    s_lshl_b32 s100, s101, 7
    ds_read_b128 a[164:167], v19 offset:17408
    v_mfma_f32_16x16x32_bf16 v[96:99], a[136:139], a[200:203], v[96:99]
    s_waitcnt lgkmcnt(6)
    s_add_u32 s17, s17, s100
    v_exp_f32 v112, v112
    v_mfma_f32_16x16x32_bf16 v[96:99], a[140:143], a[204:207], v[96:99]
    buffer_load_dwordx4 v15, s[8:11], s19 offen offset:2048 lds
    v_mfma_f32_16x16x32_bf16 v[104:107], a[128:131], a[208:211], v[68:71]
    s_add_u32 s17, s17, 8388608
    v_exp_f32 v113, v113
    v_mfma_f32_16x16x32_bf16 v[104:107], a[132:135], a[212:215], v[104:107]
    s_cmp_lt_u32 s101, s26
    s_cselect_b32 s17, s17, 2147479552
    ds_read_b128 a[168:171], v19 offset:18432
    v_cvt_pk_bf16_f32 v56, v112, v113
    v_mfma_f32_16x16x32_bf16 v[104:107], a[136:139], a[216:219], v[104:107]
    s_waitcnt lgkmcnt(6)
    v_exp_f32 v114, v114
    v_mfma_f32_16x16x32_bf16 v[104:107], a[140:143], a[220:223], v[104:107]
    buffer_load_dwordx4 v15, s[8:11], s19 offen offset:3072 lds
    v_mfma_f32_16x16x32_bf16 v[100:103], a[144:147], a[192:195], v[64:67]
    s_waitcnt lgkmcnt(5)
    s_xor_b32 s16, s16, 98304
    v_exp_f32 v115, v115
    v_mfma_f32_16x16x32_bf16 v[100:103], a[148:151], a[196:199], v[100:103]
    s_waitcnt lgkmcnt(4)
    ds_read_b128 a[172:175], v19 offset:19456
    v_cvt_pk_bf16_f32 v57, v114, v115
    v_mfma_f32_16x16x32_bf16 v[100:103], a[152:155], a[200:203], v[100:103]
    s_waitcnt lgkmcnt(4)
    v_exp_f32 v116, v116
    v_mfma_f32_16x16x32_bf16 v[100:103], a[156:159], a[204:207], v[100:103]
    buffer_store_dwordx4 a[16:19], v13, s[8:11], s17 offen sc0 sc1
    v_mfma_f32_16x16x32_bf16 v[108:111], a[144:147], a[208:211], v[68:71]
    s_add_u32 s27, s18, 8388608
    v_exp_f32 v117, v117
    v_mfma_f32_16x16x32_bf16 v[108:111], a[148:151], a[212:215], v[108:111]
    ds_read_b128 a[176:179], v20 offset:20480
    v_cvt_pk_bf16_f32 v58, v116, v117
    v_mfma_f32_16x16x32_bf16 v[108:111], a[152:155], a[216:219], v[108:111]
    v_exp_f32 v118, v118
    v_mfma_f32_16x16x32_bf16 v[108:111], a[156:159], a[220:223], v[108:111]
    buffer_store_dwordx4 v[24:27], v17, s[8:11], s27 offen offset:768 sc0 sc1
    v_mfma_f32_16x16x32_bf16 v[32:35], v[28:31], v[48:51], v[32:35]
    s_add_u32 s27, s18, 8519680
    v_exp_f32 v119, v119
    v_mfma_f32_16x16x32_bf16 v[36:39], v[28:31], v[52:55], v[36:39]
    s_waitcnt lgkmcnt(4)
    ds_read_b128 a[180:183], v20 offset:21504
    v_cvt_pk_bf16_f32 v59, v118, v119
    v_mfma_f32_16x16x32_bf16 v[128:131], a[160:163], v[48:51], v[128:131]
    s_waitcnt lgkmcnt(4)
    v_exp_f32 v120, v120
    v_mfma_f32_16x16x32_bf16 v[160:163], a[160:163], v[52:55], v[160:163]
    buffer_store_dwordx4 v[24:27], v17, s[8:11], s27 offen offset:768 sc0 sc1
    v_mfma_f32_16x16x32_bf16 v[132:135], a[164:167], v[48:51], v[132:135]
    v_exp_f32 v121, v121
    v_mfma_f32_16x16x32_bf16 v[164:167], a[164:167], v[52:55], v[164:167]
    s_waitcnt lgkmcnt(3)
    ds_read_b128 a[184:187], v20 offset:22528
    v_cvt_pk_bf16_f32 v60, v120, v121
    v_mfma_f32_16x16x32_bf16 v[136:139], a[168:171], v[48:51], v[136:139]
    s_waitcnt lgkmcnt(3)
    v_exp_f32 v122, v122
    v_mfma_f32_16x16x32_bf16 v[168:171], a[168:171], v[52:55], v[168:171]
    buffer_load_dword v3, v4, s[8:11], s23 offen sc0 sc1
    v_mfma_f32_16x16x32_bf16 v[140:143], a[172:175], v[48:51], v[140:143]
    v_exp_f32 v123, v123
    v_mfma_f32_16x16x32_bf16 v[172:175], a[172:175], v[52:55], v[172:175]
    s_waitcnt lgkmcnt(2)
    ds_read_b128 a[188:191], v20 offset:23552
    v_cvt_pk_bf16_f32 v61, v122, v123
    v_mfma_f32_16x16x32_bf16 v[144:147], a[176:179], v[48:51], v[144:147]
    v_exp_f32 v124, v124
    v_mfma_f32_16x16x32_bf16 v[176:179], a[176:179], v[52:55], v[176:179]
    s_waitcnt lgkmcnt(2)
    v_mfma_f32_16x16x32_bf16 v[148:151], a[180:183], v[48:51], v[148:151]
    v_exp_f32 v125, v125
    v_mfma_f32_16x16x32_bf16 v[180:183], a[180:183], v[52:55], v[180:183]
    s_waitcnt lgkmcnt(1)
    v_cvt_pk_bf16_f32 v62, v124, v125
    v_xor_b32 v19, 98304, v19
    v_mfma_f32_16x16x32_bf16 v[152:155], a[184:187], v[48:51], v[152:155]
    v_exp_f32 v126, v126
    v_mfma_f32_16x16x32_bf16 v[184:187], a[184:187], v[52:55], v[184:187]
    s_waitcnt lgkmcnt(0)
    v_xor_b32 v20, 98304, v20
    v_mfma_f32_16x16x32_bf16 v[156:159], a[188:191], v[48:51], v[156:159]
    v_exp_f32 v127, v127
    v_mfma_f32_16x16x32_bf16 v[188:191], a[188:191], v[52:55], v[188:191]
    v_cvt_pk_bf16_f32 v63, v126, v127
    v_mfma_f32_16x16x32_bf16 v[112:115], a[128:131], a[224:227], v[72:75]
    v_exp_f32 v96, v96
    v_mfma_f32_16x16x32_bf16 v[112:115], a[132:135], a[228:231], v[112:115]
    buffer_store_dwordx4 a[20:23], v13, s[8:11], s17 offen offset:3584 sc0 sc1
    v_mfma_f32_16x16x32_bf16 v[112:115], a[136:139], a[232:235], v[112:115]
    v_exp_f32 v97, v97
    v_mfma_f32_16x16x32_bf16 v[112:115], a[140:143], a[236:239], v[112:115]
    v_cvt_pk_bf16_f32 v48, v96, v97
    v_lshlrev_b32 v12, 3, v0
    v_mfma_f32_16x16x32_bf16 v[120:123], a[128:131], a[240:243], v[76:79]
    s_lshl_b32 s101, s2, 11
    v_exp_f32 v98, v98
    v_mfma_f32_16x16x32_bf16 v[120:123], a[132:135], a[244:247], v[120:123]
    v_add_f32 v80, 0, v21
    v_min_f32 v80, v80, v64
    v_mfma_f32_16x16x32_bf16 v[120:123], a[136:139], a[248:251], v[120:123]
    s_add_u32 s101, s101, 524288
    v_exp_f32 v99, v99
    v_mfma_f32_16x16x32_bf16 v[120:123], a[140:143], a[252:255], v[120:123]
    buffer_store_dwordx2 v[24:25], v12, s[8:11], s101 offen sc0 sc1
    v_mfma_f32_16x16x32_bf16 v[116:119], a[144:147], a[224:227], v[72:75]
    s_lshl_b32 s101, s2, 6
    v_exp_f32 v100, v100
    v_mfma_f32_16x16x32_bf16 v[116:119], a[148:151], a[228:231], v[116:119]
    s_add_u32 s101, s101, 65536
    ds_read_b128 a[128:131], v18 offset:16384
    v_cvt_pk_bf16_f32 v49, v98, v99
    v_mfma_f32_16x16x32_bf16 v[116:119], a[152:155], a[232:235], v[116:119]
    s_add_u32 s19, s82, 32768
    v_exp_f32 v101, v101
    v_mfma_f32_16x16x32_bf16 v[116:119], a[156:159], a[236:239], v[116:119]
    s_sub_u32 s82, s12, s13
    ds_read_b128 a[132:135], v18 offset:17408
    v_cvt_pk_bf16_f32 v50, v100, v101
    v_mfma_f32_16x16x32_bf16 v[124:127], a[144:147], a[240:243], v[76:79]
    s_sub_u32 s82, s82, 1
    v_exp_f32 v102, v102
    v_mfma_f32_16x16x32_bf16 v[124:127], a[148:151], a[244:247], v[124:127]
    s_cmp_gt_u32 s12, s13
    s_cselect_b32 s82, s82, s12
    s_lshl_b32 s82, s82, 16
    ds_read_b128 a[136:139], v18 offset:18432
    v_mfma_f32_16x16x32_bf16 v[124:127], a[152:155], a[248:251], v[124:127]
    s_add_u32 s82, s82, s81
    v_exp_f32 v103, v103
    v_mfma_f32_16x16x32_bf16 v[124:127], a[156:159], a[252:255], v[124:127]
    s_cmp_ge_u32 s12, 17
    s_cselect_b32 s82, 2147471360, s82
    ds_read_b128 a[140:143], v18 offset:19456
    v_cvt_pk_bf16_f32 v51, v102, v103
    v_mfma_f32_16x16x32_bf16 v[40:43], v[28:31], v[56:59], v[40:43]
    s_add_u32 s12, s12, 1
    v_exp_f32 v104, v104
    v_mfma_f32_16x16x32_bf16 v[44:47], v[28:31], v[60:63], v[44:47]
    ds_read_b128 a[144:147], v18 offset:20480
    v_mov_b32 v13, 0
    v_mfma_f32_16x16x32_bf16 v[192:195], a[160:163], v[56:59], v[192:195]
    v_exp_f32 v105, v105
    v_mfma_f32_16x16x32_bf16 v[224:227], a[160:163], v[60:63], v[224:227]
    ds_read_b128 a[148:151], v18 offset:21504
    v_cvt_pk_bf16_f32 v52, v104, v105
    v_mfma_f32_16x16x32_bf16 v[196:199], a[164:167], v[56:59], v[196:199]
    v_exp_f32 v106, v106
    v_mfma_f32_16x16x32_bf16 v[228:231], a[164:167], v[60:63], v[228:231]
    ds_read_b128 a[152:155], v18 offset:22528
    v_add_f32 v81, 0xf1800000, v21
    v_mfma_f32_16x16x32_bf16 v[200:203], a[168:171], v[56:59], v[200:203]
    v_exp_f32 v107, v107
    v_mfma_f32_16x16x32_bf16 v[232:235], a[168:171], v[60:63], v[232:235]
    ds_read_b128 a[156:159], v18 offset:23552
    v_cvt_pk_bf16_f32 v53, v106, v107
    v_mfma_f32_16x16x32_bf16 v[204:207], a[172:175], v[56:59], v[204:207]
    v_exp_f32 v108, v108
    v_mfma_f32_16x16x32_bf16 v[236:239], a[172:175], v[60:63], v[236:239]
    buffer_store_dword v13, v7, s[8:11], s101 offen sc0 sc1
    v_mfma_f32_16x16x32_bf16 v[208:211], a[176:179], v[56:59], v[208:211]
    s_lshl_b32 s101, s66, 6
    v_exp_f32 v109, v109
    v_mfma_f32_16x16x32_bf16 v[240:243], a[176:179], v[60:63], v[240:243]
    s_add_u32 s101, s101, 81920
    v_cvt_pk_bf16_f32 v54, v108, v109
    v_xor_b32 v18, 196608, v18
    v_mfma_f32_16x16x32_bf16 v[212:215], a[180:183], v[56:59], v[212:215]
    v_exp_f32 v110, v110
    v_mfma_f32_16x16x32_bf16 v[244:247], a[180:183], v[60:63], v[244:247]
    buffer_store_dwordx4 v[24:27], v7, s[8:11], s101 offen sc0 sc1
    v_mfma_f32_16x16x32_bf16 v[216:219], a[184:187], v[56:59], v[216:219]
    v_exp_f32 v111, v111
    v_mfma_f32_16x16x32_bf16 v[248:251], a[184:187], v[60:63], v[248:251]
    v_cvt_pk_bf16_f32 v55, v110, v111
    v_min_f32 v81, v81, v65
    v_mfma_f32_16x16x32_bf16 v[220:223], a[188:191], v[56:59], v[220:223]
    buffer_store_dwordx4 v[24:27], v7, s[8:11], s101 offen offset:16 sc0 sc1
    v_mfma_f32_16x16x32_bf16 v[252:255], a[188:191], v[60:63], v[252:255]
    v_add_f32 v82, 0xf2000000, v21
    v_min_f32 v82, v82, v66
    s_waitcnt vmcnt(9) lgkmcnt(0)
    s_barrier
    v_mfma_f32_16x16x32_bf16 v[96:99], a[128:131], a[192:195], v[64:67]
    s_add_u32 m0, s15, 0
    ds_read_b128 a[160:163], v19 offset:0
    v_mfma_f32_16x16x32_bf16 v[96:99], a[132:135], a[196:199], v[96:99]
    ds_read_b128 a[164:167], v19 offset:1024
    v_mfma_f32_16x16x32_bf16 v[96:99], a[136:139], a[200:203], v[96:99]
    v_exp_f32 v112, v112
    v_mfma_f32_16x16x32_bf16 v[96:99], a[140:143], a[204:207], v[96:99]
    buffer_load_dwordx4 v1, s[8:11], s82 offen offset:0 lds
    v_mfma_f32_16x16x32_bf16 v[104:107], a[128:131], a[208:211], v[68:71]
    v_exp_f32 v113, v113
    v_mfma_f32_16x16x32_bf16 v[104:107], a[132:135], a[212:215], v[104:107]
    ds_read_b128 a[168:171], v19 offset:2048
    v_cvt_pk_bf16_f32 v56, v112, v113
    v_mfma_f32_16x16x32_bf16 v[104:107], a[136:139], a[216:219], v[104:107]
    v_exp_f32 v114, v114
    v_mfma_f32_16x16x32_bf16 v[104:107], a[140:143], a[220:223], v[104:107]
    buffer_load_dwordx4 v1, s[8:11], s82 offen offset:1024 lds
    v_mfma_f32_16x16x32_bf16 v[100:103], a[144:147], a[192:195], v[64:67]
    v_exp_f32 v115, v115
    v_mfma_f32_16x16x32_bf16 v[100:103], a[148:151], a[196:199], v[100:103]
    ds_read_b128 a[172:175], v19 offset:3072
    v_cvt_pk_bf16_f32 v57, v114, v115
    v_mfma_f32_16x16x32_bf16 v[100:103], a[152:155], a[200:203], v[100:103]
    v_exp_f32 v116, v116
    v_mfma_f32_16x16x32_bf16 v[100:103], a[156:159], a[204:207], v[100:103]
    buffer_load_dwordx4 v1, s[8:11], s82 offen offset:2048 lds
    v_mfma_f32_16x16x32_bf16 v[108:111], a[144:147], a[208:211], v[68:71]
    v_exp_f32 v117, v117
    v_mfma_f32_16x16x32_bf16 v[108:111], a[148:151], a[212:215], v[108:111]
    ds_read_b128 a[176:179], v20 offset:4096
    v_cvt_pk_bf16_f32 v58, v116, v117
    v_mfma_f32_16x16x32_bf16 v[108:111], a[152:155], a[216:219], v[108:111]
    v_exp_f32 v118, v118
    v_mfma_f32_16x16x32_bf16 v[108:111], a[156:159], a[220:223], v[108:111]
    buffer_load_dwordx4 v1, s[8:11], s82 offen offset:3072 lds
    v_mfma_f32_16x16x32_bf16 v[32:35], v[28:31], v[48:51], v[32:35]
    s_add_u32 m0, s15, 4096
    v_exp_f32 v119, v119
    v_mfma_f32_16x16x32_bf16 v[36:39], v[28:31], v[52:55], v[36:39]
    s_waitcnt lgkmcnt(4)
    ds_read_b128 a[180:183], v20 offset:5120
    v_cvt_pk_bf16_f32 v59, v118, v119
    v_mfma_f32_16x16x32_bf16 v[128:131], a[160:163], v[48:51], v[128:131]
    v_exp_f32 v120, v120
    v_mfma_f32_16x16x32_bf16 v[160:163], a[160:163], v[52:55], v[160:163]
    s_waitcnt lgkmcnt(4)
    v_mfma_f32_16x16x32_bf16 v[132:135], a[164:167], v[48:51], v[132:135]
    v_exp_f32 v121, v121
    v_mfma_f32_16x16x32_bf16 v[164:167], a[164:167], v[52:55], v[164:167]
    s_waitcnt lgkmcnt(3)
    ds_read_b128 a[184:187], v20 offset:6144
    v_cvt_pk_bf16_f32 v60, v120, v121
    v_mfma_f32_16x16x32_bf16 v[136:139], a[168:171], v[48:51], v[136:139]
    s_waitcnt lgkmcnt(3)
    v_exp_f32 v122, v122
    v_mfma_f32_16x16x32_bf16 v[168:171], a[168:171], v[52:55], v[168:171]
    buffer_load_dwordx4 v15, s[8:11], s82 offen offset:0 lds
    v_mfma_f32_16x16x32_bf16 v[140:143], a[172:175], v[48:51], v[140:143]
    v_exp_f32 v123, v123
    v_mfma_f32_16x16x32_bf16 v[172:175], a[172:175], v[52:55], v[172:175]
    s_waitcnt lgkmcnt(2)
    ds_read_b128 a[188:191], v20 offset:7168
    v_cvt_pk_bf16_f32 v61, v122, v123
    v_mfma_f32_16x16x32_bf16 v[144:147], a[176:179], v[48:51], v[144:147]
    s_waitcnt lgkmcnt(2)
    v_exp_f32 v124, v124
    v_mfma_f32_16x16x32_bf16 v[176:179], a[176:179], v[52:55], v[176:179]
    buffer_load_dwordx4 v15, s[8:11], s82 offen offset:1024 lds
    v_mfma_f32_16x16x32_bf16 v[148:151], a[180:183], v[48:51], v[148:151]
    v_exp_f32 v125, v125
    v_mfma_f32_16x16x32_bf16 v[180:183], a[180:183], v[52:55], v[180:183]
    s_waitcnt lgkmcnt(1)
    v_cvt_pk_bf16_f32 v62, v124, v125
    v_mfma_f32_16x16x32_bf16 v[152:155], a[184:187], v[48:51], v[152:155]
    s_waitcnt lgkmcnt(0)
    v_exp_f32 v126, v126
    v_mfma_f32_16x16x32_bf16 v[184:187], a[184:187], v[52:55], v[184:187]
    buffer_load_dwordx4 v15, s[8:11], s82 offen offset:2048 lds
    v_mfma_f32_16x16x32_bf16 v[156:159], a[188:191], v[48:51], v[156:159]
    v_exp_f32 v127, v127
    v_mfma_f32_16x16x32_bf16 v[188:191], a[188:191], v[52:55], v[188:191]
    v_cvt_pk_bf16_f32 v63, v126, v127
    v_mfma_f32_16x16x32_bf16 v[112:115], a[128:131], a[224:227], v[72:75]
    v_mfma_f32_16x16x32_bf16 v[112:115], a[132:135], a[228:231], v[112:115]
    v_mfma_f32_16x16x32_bf16 v[112:115], a[136:139], a[232:235], v[112:115]
    v_exp_f32 v96, v96
    v_mfma_f32_16x16x32_bf16 v[112:115], a[140:143], a[236:239], v[112:115]
    buffer_load_dwordx4 v15, s[8:11], s82 offen offset:3072 lds
    v_mfma_f32_16x16x32_bf16 v[120:123], a[128:131], a[240:243], v[76:79]
    s_xor_b32 s15, s15, 196608
    v_exp_f32 v97, v97
    v_mfma_f32_16x16x32_bf16 v[120:123], a[132:135], a[244:247], v[120:123]
    s_add_u32 m0, s16, 0
    ds_read_b128 a[128:131], v18 offset:0
    v_cvt_pk_bf16_f32 v48, v96, v97
    v_mfma_f32_16x16x32_bf16 v[120:123], a[136:139], a[248:251], v[120:123]
    v_exp_f32 v98, v98
    v_mfma_f32_16x16x32_bf16 v[120:123], a[140:143], a[252:255], v[120:123]
    buffer_load_dwordx4 v1, s[8:11], s19 offen offset:0 lds
    v_mfma_f32_16x16x32_bf16 v[116:119], a[144:147], a[224:227], v[72:75]
    v_exp_f32 v99, v99
    v_mfma_f32_16x16x32_bf16 v[116:119], a[148:151], a[228:231], v[116:119]
    ds_read_b128 a[132:135], v18 offset:1024
    v_cvt_pk_bf16_f32 v49, v98, v99
    v_mfma_f32_16x16x32_bf16 v[116:119], a[152:155], a[232:235], v[116:119]
    v_exp_f32 v100, v100
    v_mfma_f32_16x16x32_bf16 v[116:119], a[156:159], a[236:239], v[116:119]
    buffer_load_dwordx4 v1, s[8:11], s19 offen offset:1024 lds
    v_mfma_f32_16x16x32_bf16 v[124:127], a[144:147], a[240:243], v[76:79]
    v_exp_f32 v101, v101
    v_mfma_f32_16x16x32_bf16 v[124:127], a[148:151], a[244:247], v[124:127]
    ds_read_b128 a[136:139], v18 offset:2048
    v_cvt_pk_bf16_f32 v50, v100, v101
    v_mfma_f32_16x16x32_bf16 v[124:127], a[152:155], a[248:251], v[124:127]
    v_exp_f32 v102, v102
    v_mfma_f32_16x16x32_bf16 v[124:127], a[156:159], a[252:255], v[124:127]
    buffer_load_dwordx4 v1, s[8:11], s19 offen offset:2048 lds
    v_mfma_f32_16x16x32_bf16 v[40:43], v[28:31], v[56:59], v[40:43]
    v_exp_f32 v103, v103
    v_mfma_f32_16x16x32_bf16 v[44:47], v[28:31], v[60:63], v[44:47]
    ds_read_b128 a[140:143], v18 offset:3072
    v_cvt_pk_bf16_f32 v51, v102, v103
    v_mfma_f32_16x16x32_bf16 v[192:195], a[160:163], v[56:59], v[192:195]
    v_exp_f32 v104, v104
    v_mfma_f32_16x16x32_bf16 v[224:227], a[160:163], v[60:63], v[224:227]
    v_mfma_f32_16x16x32_bf16 v[196:199], a[164:167], v[56:59], v[196:199]
    v_exp_f32 v105, v105
    v_mfma_f32_16x16x32_bf16 v[228:231], a[164:167], v[60:63], v[228:231]
    ds_read_b128 a[144:147], v18 offset:4096
    v_cvt_pk_bf16_f32 v52, v104, v105
    v_mfma_f32_16x16x32_bf16 v[200:203], a[168:171], v[56:59], v[200:203]
    v_exp_f32 v106, v106
    v_mfma_f32_16x16x32_bf16 v[232:235], a[168:171], v[60:63], v[232:235]
    buffer_load_dwordx4 v1, s[8:11], s19 offen offset:3072 lds
    v_mfma_f32_16x16x32_bf16 v[204:207], a[172:175], v[56:59], v[204:207]
    s_add_u32 m0, s16, 4096
    v_exp_f32 v107, v107
    v_mfma_f32_16x16x32_bf16 v[236:239], a[172:175], v[60:63], v[236:239]
    ds_read_b128 a[148:151], v18 offset:5120
    v_cvt_pk_bf16_f32 v53, v106, v107
    v_mfma_f32_16x16x32_bf16 v[208:211], a[176:179], v[56:59], v[208:211]
    v_exp_f32 v108, v108
    v_mfma_f32_16x16x32_bf16 v[240:243], a[176:179], v[60:63], v[240:243]
    buffer_load_dwordx4 v15, s[8:11], s19 offen offset:0 lds
    v_mfma_f32_16x16x32_bf16 v[212:215], a[180:183], v[56:59], v[212:215]
    v_exp_f32 v109, v109
    v_mfma_f32_16x16x32_bf16 v[244:247], a[180:183], v[60:63], v[244:247]
    ds_read_b128 a[152:155], v18 offset:6144
    v_cvt_pk_bf16_f32 v54, v108, v109
    v_mfma_f32_16x16x32_bf16 v[216:219], a[184:187], v[56:59], v[216:219]
    v_exp_f32 v110, v110
    v_mfma_f32_16x16x32_bf16 v[248:251], a[184:187], v[60:63], v[248:251]
    buffer_load_dwordx4 v15, s[8:11], s19 offen offset:1024 lds
    v_mfma_f32_16x16x32_bf16 v[220:223], a[188:191], v[56:59], v[220:223]
    v_exp_f32 v111, v111
    v_mfma_f32_16x16x32_bf16 v[252:255], a[188:191], v[60:63], v[252:255]
    ds_read_b128 a[156:159], v18 offset:7168
    v_cvt_pk_bf16_f32 v55, v110, v111
    s_waitcnt lgkmcnt(7)
    v_mfma_f32_16x16x32_bf16 v[96:99], a[128:131], a[192:195], v[64:67]
    s_waitcnt lgkmcnt(6)
    s_lshl_b32 s24, s60, 2
    s_add_u32 s24, s24, s3
    ds_read_b128 a[160:163], v19 offset:16384
    v_mfma_f32_16x16x32_bf16 v[96:99], a[132:135], a[196:199], v[96:99]
    s_waitcnt lgkmcnt(6)
    s_lshl_b32 s24, s24, 3
    s_add_u32 s24, s24, s4
    ds_read_b128 a[164:167], v19 offset:17408
    v_mfma_f32_16x16x32_bf16 v[96:99], a[136:139], a[200:203], v[96:99]
    s_waitcnt lgkmcnt(6)
    s_lshl_b32 s24, s24, 2
    v_exp_f32 v112, v112
    v_mfma_f32_16x16x32_bf16 v[96:99], a[140:143], a[204:207], v[96:99]
    buffer_load_dwordx4 v15, s[8:11], s19 offen offset:2048 lds
    v_mfma_f32_16x16x32_bf16 v[104:107], a[128:131], a[208:211], v[68:71]
    s_add_u32 s24, s24, s5
    v_exp_f32 v113, v113
    v_mfma_f32_16x16x32_bf16 v[104:107], a[132:135], a[212:215], v[104:107]
    s_lshl_b32 s24, s24, 13
    ds_read_b128 a[168:171], v19 offset:18432
    v_cvt_pk_bf16_f32 v56, v112, v113
    v_mfma_f32_16x16x32_bf16 v[104:107], a[136:139], a[216:219], v[104:107]
    s_waitcnt lgkmcnt(6)
    s_add_u32 s24, s24, 50331648
    v_exp_f32 v114, v114
    s_waitcnt vmcnt(20)
    v_cmp_ne_u32 vcc, 0, v3
    s_cmp_eq_u64 vcc, -1
    s_cbranch_scc0 L_C1_slow_9
L_C1_ok_10:
    v_mfma_f32_16x16x32_bf16 v[104:107], a[140:143], a[220:223], v[104:107]
    buffer_load_dwordx4 v15, s[8:11], s19 offen offset:3072 lds
    v_mfma_f32_16x16x32_bf16 v[100:103], a[144:147], a[192:195], v[64:67]
    s_waitcnt lgkmcnt(5)
    s_xor_b32 s16, s16, 98304
    v_exp_f32 v115, v115
    v_mfma_f32_16x16x32_bf16 v[100:103], a[148:151], a[196:199], v[100:103]
    s_waitcnt lgkmcnt(4)
    s_xor_b32 s74, s24, 0
    ds_read_b128 a[172:175], v19 offset:19456
    v_cvt_pk_bf16_f32 v57, v114, v115
    v_mfma_f32_16x16x32_bf16 v[100:103], a[152:155], a[200:203], v[100:103]
    s_waitcnt lgkmcnt(4)
    v_exp_f32 v116, v116
    v_mfma_f32_16x16x32_bf16 v[100:103], a[156:159], a[204:207], v[100:103]
    buffer_load_dwordx4 a[64:67], v1, s[8:11], s74 offen offset:0
    v_mfma_f32_16x16x32_bf16 v[108:111], a[144:147], a[208:211], v[68:71]
    s_xor_b32 s74, s24, 0
    v_exp_f32 v117, v117
    v_mfma_f32_16x16x32_bf16 v[108:111], a[148:151], a[212:215], v[108:111]
    ds_read_b128 a[176:179], v20 offset:20480
    v_cvt_pk_bf16_f32 v58, v116, v117
    v_mfma_f32_16x16x32_bf16 v[108:111], a[152:155], a[216:219], v[108:111]
    v_exp_f32 v118, v118
    v_mfma_f32_16x16x32_bf16 v[108:111], a[156:159], a[220:223], v[108:111]
    buffer_load_dwordx4 a[68:71], v1, s[8:11], s74 offen offset:1024
    v_mfma_f32_16x16x32_bf16 v[32:35], v[28:31], v[48:51], v[32:35]
    s_xor_b32 s74, s24, 0
    v_exp_f32 v119, v119
    v_mfma_f32_16x16x32_bf16 v[36:39], v[28:31], v[52:55], v[36:39]
    s_waitcnt lgkmcnt(4)
    ds_read_b128 a[180:183], v20 offset:21504
    v_cvt_pk_bf16_f32 v59, v118, v119
    v_mfma_f32_16x16x32_bf16 v[128:131], a[160:163], v[48:51], v[128:131]
    s_waitcnt lgkmcnt(4)
    v_exp_f32 v120, v120
    v_mfma_f32_16x16x32_bf16 v[160:163], a[160:163], v[52:55], v[160:163]
    buffer_load_dwordx4 a[72:75], v1, s[8:11], s74 offen offset:2048
    v_mfma_f32_16x16x32_bf16 v[132:135], a[164:167], v[48:51], v[132:135]
    s_xor_b32 s74, s24, 0
    v_exp_f32 v121, v121
    v_mfma_f32_16x16x32_bf16 v[164:167], a[164:167], v[52:55], v[164:167]
    s_waitcnt lgkmcnt(3)
    ds_read_b128 a[184:187], v20 offset:22528
    v_cvt_pk_bf16_f32 v60, v120, v121
    v_mfma_f32_16x16x32_bf16 v[136:139], a[168:171], v[48:51], v[136:139]
    s_waitcnt lgkmcnt(3)
    v_exp_f32 v122, v122
    v_mfma_f32_16x16x32_bf16 v[168:171], a[168:171], v[52:55], v[168:171]
    buffer_load_dwordx4 a[76:79], v1, s[8:11], s74 offen offset:3072
    v_mfma_f32_16x16x32_bf16 v[140:143], a[172:175], v[48:51], v[140:143]
    s_xor_b32 s74, s24, 4096
    v_exp_f32 v123, v123
    v_mfma_f32_16x16x32_bf16 v[172:175], a[172:175], v[52:55], v[172:175]
    s_waitcnt lgkmcnt(2)
    ds_read_b128 a[188:191], v20 offset:23552
    v_cvt_pk_bf16_f32 v61, v122, v123
    v_mfma_f32_16x16x32_bf16 v[144:147], a[176:179], v[48:51], v[144:147]
    s_waitcnt lgkmcnt(2)
    v_exp_f32 v124, v124
    v_mfma_f32_16x16x32_bf16 v[176:179], a[176:179], v[52:55], v[176:179]
    buffer_load_dwordx4 a[80:83], v1, s[8:11], s74 offen offset:0
    v_mfma_f32_16x16x32_bf16 v[148:151], a[180:183], v[48:51], v[148:151]
    v_exp_f32 v125, v125
    v_mfma_f32_16x16x32_bf16 v[180:183], a[180:183], v[52:55], v[180:183]
    s_waitcnt lgkmcnt(1)
    v_cvt_pk_bf16_f32 v62, v124, v125
    v_xor_b32 v19, 98304, v19
    v_mfma_f32_16x16x32_bf16 v[152:155], a[184:187], v[48:51], v[152:155]
    v_exp_f32 v126, v126
    v_mfma_f32_16x16x32_bf16 v[184:187], a[184:187], v[52:55], v[184:187]
    s_waitcnt lgkmcnt(0)
    v_xor_b32 v20, 98304, v20
    v_mfma_f32_16x16x32_bf16 v[156:159], a[188:191], v[48:51], v[156:159]
    v_exp_f32 v127, v127
    v_mfma_f32_16x16x32_bf16 v[188:191], a[188:191], v[52:55], v[188:191]
    v_cvt_pk_bf16_f32 v63, v126, v127
    v_mfma_f32_16x16x32_bf16 v[112:115], a[128:131], a[224:227], v[72:75]
    s_add_u32 m0, s62, 32768
    v_exp_f32 v96, v96
    v_mfma_f32_16x16x32_bf16 v[112:115], a[132:135], a[228:231], v[112:115]
    v_add_f32 v83, 0xf2400000, v21
    v_min_f32 v83, v83, v67
    v_mfma_f32_16x16x32_bf16 v[112:115], a[136:139], a[232:235], v[112:115]
    s_xor_b32 s98, s65, 0
    v_exp_f32 v97, v97
    v_mfma_f32_16x16x32_bf16 v[112:115], a[140:143], a[236:239], v[112:115]
    v_cvt_pk_bf16_f32 v48, v96, v97
    v_add_f32 v84, 0xf3800000, v21
    v_mfma_f32_16x16x32_bf16 v[120:123], a[128:131], a[240:243], v[76:79]
    v_exp_f32 v98, v98
    v_mfma_f32_16x16x32_bf16 v[120:123], a[132:135], a[244:247], v[120:123]
    buffer_load_dwordx4 v8, s[28:31], s98 offen offset:0  lds
    v_mfma_f32_16x16x32_bf16 v[120:123], a[136:139], a[248:251], v[120:123]
    v_exp_f32 v99, v99
    v_mfma_f32_16x16x32_bf16 v[120:123], a[140:143], a[252:255], v[120:123]
    buffer_load_dwordx4 v9, s[28:31], s98 offen offset:1024  lds
    v_mfma_f32_16x16x32_bf16 v[116:119], a[144:147], a[224:227], v[72:75]
    v_exp_f32 v100, v100
    v_mfma_f32_16x16x32_bf16 v[116:119], a[148:151], a[228:231], v[116:119]
    ds_read_b128 a[128:131], v18 offset:16384
    v_cvt_pk_bf16_f32 v49, v98, v99
    v_mfma_f32_16x16x32_bf16 v[116:119], a[152:155], a[232:235], v[116:119]
    s_add_u32 s19, s82, 32768
    v_exp_f32 v101, v101
    v_mfma_f32_16x16x32_bf16 v[116:119], a[156:159], a[236:239], v[116:119]
    s_sub_u32 s82, s12, s13
    ds_read_b128 a[132:135], v18 offset:17408
    v_cvt_pk_bf16_f32 v50, v100, v101
    v_mfma_f32_16x16x32_bf16 v[124:127], a[144:147], a[240:243], v[76:79]
    s_sub_u32 s82, s82, 1
    v_exp_f32 v102, v102
    v_mfma_f32_16x16x32_bf16 v[124:127], a[148:151], a[244:247], v[124:127]
    s_cmp_gt_u32 s12, s13
    s_cselect_b32 s82, s82, s12
    s_lshl_b32 s82, s82, 16
    ds_read_b128 a[136:139], v18 offset:18432
    v_mfma_f32_16x16x32_bf16 v[124:127], a[152:155], a[248:251], v[124:127]
    s_add_u32 s82, s82, s81
    v_exp_f32 v103, v103
    v_mfma_f32_16x16x32_bf16 v[124:127], a[156:159], a[252:255], v[124:127]
    s_cmp_ge_u32 s12, 17
    s_cselect_b32 s82, 2147471360, s82
    ds_read_b128 a[140:143], v18 offset:19456
    v_cvt_pk_bf16_f32 v51, v102, v103
    v_mfma_f32_16x16x32_bf16 v[40:43], v[28:31], v[56:59], v[40:43]
    s_add_u32 s12, s12, 1
    v_exp_f32 v104, v104
    v_mfma_f32_16x16x32_bf16 v[44:47], v[28:31], v[60:63], v[44:47]
    ds_read_b128 a[144:147], v18 offset:20480
    v_min_f32 v84, v84, v64
    v_mfma_f32_16x16x32_bf16 v[192:195], a[160:163], v[56:59], v[192:195]
    v_exp_f32 v105, v105
    v_mfma_f32_16x16x32_bf16 v[224:227], a[160:163], v[60:63], v[224:227]
    ds_read_b128 a[148:151], v18 offset:21504
    v_cvt_pk_bf16_f32 v52, v104, v105
    v_mfma_f32_16x16x32_bf16 v[196:199], a[164:167], v[56:59], v[196:199]
    v_exp_f32 v106, v106
    v_mfma_f32_16x16x32_bf16 v[228:231], a[164:167], v[60:63], v[228:231]
    ds_read_b128 a[152:155], v18 offset:22528
    v_add_f32 v85, 0xf3880000, v21
    v_mfma_f32_16x16x32_bf16 v[200:203], a[168:171], v[56:59], v[200:203]
    v_exp_f32 v107, v107
    v_mfma_f32_16x16x32_bf16 v[232:235], a[168:171], v[60:63], v[232:235]
    ds_read_b128 a[156:159], v18 offset:23552
    v_cvt_pk_bf16_f32 v53, v106, v107
    v_mfma_f32_16x16x32_bf16 v[204:207], a[172:175], v[56:59], v[204:207]
    v_exp_f32 v108, v108
    v_mfma_f32_16x16x32_bf16 v[236:239], a[172:175], v[60:63], v[236:239]
    buffer_load_dwordx4 v10, s[28:31], s98 offen offset:2048  lds
    v_mfma_f32_16x16x32_bf16 v[208:211], a[176:179], v[56:59], v[208:211]
    v_exp_f32 v109, v109
    v_mfma_f32_16x16x32_bf16 v[240:243], a[176:179], v[60:63], v[240:243]
    v_cvt_pk_bf16_f32 v54, v108, v109
    v_xor_b32 v18, 196608, v18
    v_mfma_f32_16x16x32_bf16 v[212:215], a[180:183], v[56:59], v[212:215]
    v_exp_f32 v110, v110
    v_mfma_f32_16x16x32_bf16 v[244:247], a[180:183], v[60:63], v[244:247]
    buffer_load_dwordx4 v11, s[28:31], s98 offen offset:3072  lds
    v_mfma_f32_16x16x32_bf16 v[216:219], a[184:187], v[56:59], v[216:219]
    s_xor_b32 s74, s24, 4096
    v_exp_f32 v111, v111
    v_mfma_f32_16x16x32_bf16 v[248:251], a[184:187], v[60:63], v[248:251]
    v_cvt_pk_bf16_f32 v55, v110, v111
    v_min_f32 v85, v85, v65
    v_mfma_f32_16x16x32_bf16 v[220:223], a[188:191], v[56:59], v[220:223]
    buffer_load_dwordx4 a[84:87], v1, s[8:11], s74 offen offset:1024
    v_mfma_f32_16x16x32_bf16 v[252:255], a[188:191], v[60:63], v[252:255]
    s_xor_b32 s74, s24, 4096
    buffer_load_dwordx4 a[88:91], v1, s[8:11], s74 offen offset:2048
    s_xor_b32 s74, s24, 4096
    buffer_load_dwordx4 a[92:95], v1, s[8:11], s74 offen offset:3072
    s_waitcnt vmcnt(12) lgkmcnt(0)
    s_barrier
    v_mfma_f32_16x16x32_bf16 v[96:99], a[128:131], a[192:195], v[64:67]
    s_add_u32 m0, s15, 0
    ds_read_b128 a[160:163], v19 offset:0
    v_mfma_f32_16x16x32_bf16 v[96:99], a[132:135], a[196:199], v[96:99]
    ds_read_b128 a[164:167], v19 offset:1024
    v_mfma_f32_16x16x32_bf16 v[96:99], a[136:139], a[200:203], v[96:99]
    v_exp_f32 v112, v112
    v_mfma_f32_16x16x32_bf16 v[96:99], a[140:143], a[204:207], v[96:99]
    buffer_load_dwordx4 v1, s[8:11], s82 offen offset:0 lds
    v_mfma_f32_16x16x32_bf16 v[104:107], a[128:131], a[208:211], v[68:71]
    v_exp_f32 v113, v113
    v_mfma_f32_16x16x32_bf16 v[104:107], a[132:135], a[212:215], v[104:107]
    ds_read_b128 a[168:171], v19 offset:2048
    v_cvt_pk_bf16_f32 v56, v112, v113
    v_mfma_f32_16x16x32_bf16 v[104:107], a[136:139], a[216:219], v[104:107]
    v_exp_f32 v114, v114
    v_mfma_f32_16x16x32_bf16 v[104:107], a[140:143], a[220:223], v[104:107]
    buffer_load_dwordx4 v1, s[8:11], s82 offen offset:1024 lds
    v_mfma_f32_16x16x32_bf16 v[100:103], a[144:147], a[192:195], v[64:67]
    v_exp_f32 v115, v115
    v_mfma_f32_16x16x32_bf16 v[100:103], a[148:151], a[196:199], v[100:103]
    ds_read_b128 a[172:175], v19 offset:3072
    v_cvt_pk_bf16_f32 v57, v114, v115
    v_mfma_f32_16x16x32_bf16 v[100:103], a[152:155], a[200:203], v[100:103]
    v_exp_f32 v116, v116
    v_mfma_f32_16x16x32_bf16 v[100:103], a[156:159], a[204:207], v[100:103]
    buffer_load_dwordx4 v1, s[8:11], s82 offen offset:2048 lds
    v_mfma_f32_16x16x32_bf16 v[108:111], a[144:147], a[208:211], v[68:71]
    v_exp_f32 v117, v117
    v_mfma_f32_16x16x32_bf16 v[108:111], a[148:151], a[212:215], v[108:111]
    ds_read_b128 a[176:179], v20 offset:4096
    v_cvt_pk_bf16_f32 v58, v116, v117
    v_mfma_f32_16x16x32_bf16 v[108:111], a[152:155], a[216:219], v[108:111]
    v_exp_f32 v118, v118
    v_mfma_f32_16x16x32_bf16 v[108:111], a[156:159], a[220:223], v[108:111]
    buffer_load_dwordx4 v1, s[8:11], s82 offen offset:3072 lds
    v_mfma_f32_16x16x32_bf16 v[32:35], v[28:31], v[48:51], v[32:35]
    s_add_u32 m0, s15, 4096
    v_exp_f32 v119, v119
    v_mfma_f32_16x16x32_bf16 v[36:39], v[28:31], v[52:55], v[36:39]
    s_waitcnt lgkmcnt(4)
    ds_read_b128 a[180:183], v20 offset:5120
    v_cvt_pk_bf16_f32 v59, v118, v119
    v_mfma_f32_16x16x32_bf16 v[128:131], a[160:163], v[48:51], v[128:131]
    v_exp_f32 v120, v120
    v_mfma_f32_16x16x32_bf16 v[160:163], a[160:163], v[52:55], v[160:163]
    s_waitcnt lgkmcnt(4)
    v_mfma_f32_16x16x32_bf16 v[132:135], a[164:167], v[48:51], v[132:135]
    v_exp_f32 v121, v121
    v_mfma_f32_16x16x32_bf16 v[164:167], a[164:167], v[52:55], v[164:167]
    s_waitcnt lgkmcnt(3)
    ds_read_b128 a[184:187], v20 offset:6144
    v_cvt_pk_bf16_f32 v60, v120, v121
    v_mfma_f32_16x16x32_bf16 v[136:139], a[168:171], v[48:51], v[136:139]
    s_waitcnt lgkmcnt(3)
    v_exp_f32 v122, v122
    v_mfma_f32_16x16x32_bf16 v[168:171], a[168:171], v[52:55], v[168:171]
    buffer_load_dwordx4 v15, s[8:11], s82 offen offset:0 lds
    v_mfma_f32_16x16x32_bf16 v[140:143], a[172:175], v[48:51], v[140:143]
    v_exp_f32 v123, v123
    v_mfma_f32_16x16x32_bf16 v[172:175], a[172:175], v[52:55], v[172:175]
    s_waitcnt lgkmcnt(2)
    ds_read_b128 a[188:191], v20 offset:7168
    v_cvt_pk_bf16_f32 v61, v122, v123
    v_mfma_f32_16x16x32_bf16 v[144:147], a[176:179], v[48:51], v[144:147]
    s_waitcnt lgkmcnt(2)
    v_exp_f32 v124, v124
    v_mfma_f32_16x16x32_bf16 v[176:179], a[176:179], v[52:55], v[176:179]
    buffer_load_dwordx4 v15, s[8:11], s82 offen offset:1024 lds
    v_mfma_f32_16x16x32_bf16 v[148:151], a[180:183], v[48:51], v[148:151]
    v_exp_f32 v125, v125
    v_mfma_f32_16x16x32_bf16 v[180:183], a[180:183], v[52:55], v[180:183]
    s_waitcnt lgkmcnt(1)
    v_cvt_pk_bf16_f32 v62, v124, v125
    v_mfma_f32_16x16x32_bf16 v[152:155], a[184:187], v[48:51], v[152:155]
    s_waitcnt lgkmcnt(0)
    v_exp_f32 v126, v126
    v_mfma_f32_16x16x32_bf16 v[184:187], a[184:187], v[52:55], v[184:187]
    buffer_load_dwordx4 v15, s[8:11], s82 offen offset:2048 lds
    v_mfma_f32_16x16x32_bf16 v[156:159], a[188:191], v[48:51], v[156:159]
    v_exp_f32 v127, v127
    v_mfma_f32_16x16x32_bf16 v[188:191], a[188:191], v[52:55], v[188:191]
    v_cvt_pk_bf16_f32 v63, v126, v127
    v_mfma_f32_16x16x32_bf16 v[112:115], a[128:131], a[224:227], v[72:75]
    v_mfma_f32_16x16x32_bf16 v[112:115], a[132:135], a[228:231], v[112:115]
    v_mfma_f32_16x16x32_bf16 v[112:115], a[136:139], a[232:235], v[112:115]
    v_exp_f32 v96, v96
    v_mfma_f32_16x16x32_bf16 v[112:115], a[140:143], a[236:239], v[112:115]
    buffer_load_dwordx4 v15, s[8:11], s82 offen offset:3072 lds
    v_mfma_f32_16x16x32_bf16 v[120:123], a[128:131], a[240:243], v[76:79]
    s_xor_b32 s15, s15, 196608
    v_exp_f32 v97, v97
    v_mfma_f32_16x16x32_bf16 v[120:123], a[132:135], a[244:247], v[120:123]
    s_add_u32 m0, s16, 0
    ds_read_b128 a[128:131], v18 offset:0
    v_cvt_pk_bf16_f32 v48, v96, v97
    v_mfma_f32_16x16x32_bf16 v[120:123], a[136:139], a[248:251], v[120:123]
    v_exp_f32 v98, v98
    v_mfma_f32_16x16x32_bf16 v[120:123], a[140:143], a[252:255], v[120:123]
    buffer_load_dwordx4 v1, s[8:11], s19 offen offset:0 lds
    v_mfma_f32_16x16x32_bf16 v[116:119], a[144:147], a[224:227], v[72:75]
    v_exp_f32 v99, v99
    v_mfma_f32_16x16x32_bf16 v[116:119], a[148:151], a[228:231], v[116:119]
    ds_read_b128 a[132:135], v18 offset:1024
    v_cvt_pk_bf16_f32 v49, v98, v99
    v_mfma_f32_16x16x32_bf16 v[116:119], a[152:155], a[232:235], v[116:119]
    v_exp_f32 v100, v100
    v_mfma_f32_16x16x32_bf16 v[116:119], a[156:159], a[236:239], v[116:119]
    buffer_load_dwordx4 v1, s[8:11], s19 offen offset:1024 lds
    v_mfma_f32_16x16x32_bf16 v[124:127], a[144:147], a[240:243], v[76:79]
    v_exp_f32 v101, v101
    v_mfma_f32_16x16x32_bf16 v[124:127], a[148:151], a[244:247], v[124:127]
    ds_read_b128 a[136:139], v18 offset:2048
    v_cvt_pk_bf16_f32 v50, v100, v101
    v_mfma_f32_16x16x32_bf16 v[124:127], a[152:155], a[248:251], v[124:127]
    v_exp_f32 v102, v102
    v_mfma_f32_16x16x32_bf16 v[124:127], a[156:159], a[252:255], v[124:127]
    buffer_load_dwordx4 v1, s[8:11], s19 offen offset:2048 lds
    v_mfma_f32_16x16x32_bf16 v[40:43], v[28:31], v[56:59], v[40:43]
    v_exp_f32 v103, v103
    v_mfma_f32_16x16x32_bf16 v[44:47], v[28:31], v[60:63], v[44:47]
    ds_read_b128 a[140:143], v18 offset:3072
    v_cvt_pk_bf16_f32 v51, v102, v103
    v_mfma_f32_16x16x32_bf16 v[192:195], a[160:163], v[56:59], v[192:195]
    v_exp_f32 v104, v104
    v_mfma_f32_16x16x32_bf16 v[224:227], a[160:163], v[60:63], v[224:227]
    v_mfma_f32_16x16x32_bf16 v[196:199], a[164:167], v[56:59], v[196:199]
    v_exp_f32 v105, v105
    v_mfma_f32_16x16x32_bf16 v[228:231], a[164:167], v[60:63], v[228:231]
    ds_read_b128 a[144:147], v18 offset:4096
    v_cvt_pk_bf16_f32 v52, v104, v105
    v_mfma_f32_16x16x32_bf16 v[200:203], a[168:171], v[56:59], v[200:203]
    v_exp_f32 v106, v106
    v_mfma_f32_16x16x32_bf16 v[232:235], a[168:171], v[60:63], v[232:235]
    buffer_load_dwordx4 v1, s[8:11], s19 offen offset:3072 lds
    v_mfma_f32_16x16x32_bf16 v[204:207], a[172:175], v[56:59], v[204:207]
    s_add_u32 m0, s16, 4096
    v_exp_f32 v107, v107
    v_mfma_f32_16x16x32_bf16 v[236:239], a[172:175], v[60:63], v[236:239]
    ds_read_b128 a[148:151], v18 offset:5120
    v_cvt_pk_bf16_f32 v53, v106, v107
    v_mfma_f32_16x16x32_bf16 v[208:211], a[176:179], v[56:59], v[208:211]
    v_exp_f32 v108, v108
    v_mfma_f32_16x16x32_bf16 v[240:243], a[176:179], v[60:63], v[240:243]
    buffer_load_dwordx4 v15, s[8:11], s19 offen offset:0 lds
    v_mfma_f32_16x16x32_bf16 v[212:215], a[180:183], v[56:59], v[212:215]
    v_exp_f32 v109, v109
    v_mfma_f32_16x16x32_bf16 v[244:247], a[180:183], v[60:63], v[244:247]
    ds_read_b128 a[152:155], v18 offset:6144
    v_cvt_pk_bf16_f32 v54, v108, v109
    v_mfma_f32_16x16x32_bf16 v[216:219], a[184:187], v[56:59], v[216:219]
    v_exp_f32 v110, v110
    v_mfma_f32_16x16x32_bf16 v[248:251], a[184:187], v[60:63], v[248:251]
    buffer_load_dwordx4 v15, s[8:11], s19 offen offset:1024 lds
    v_mfma_f32_16x16x32_bf16 v[220:223], a[188:191], v[56:59], v[220:223]
    v_exp_f32 v111, v111
    v_mfma_f32_16x16x32_bf16 v[252:255], a[188:191], v[60:63], v[252:255]
    ds_read_b128 a[156:159], v18 offset:7168
    v_cvt_pk_bf16_f32 v55, v110, v111
    s_waitcnt lgkmcnt(7)
    v_mfma_f32_16x16x32_bf16 v[96:99], a[128:131], a[192:195], v[64:67]
    s_waitcnt lgkmcnt(6)
    ds_read_b128 a[160:163], v19 offset:16384
    v_mfma_f32_16x16x32_bf16 v[96:99], a[132:135], a[196:199], v[96:99]
    s_waitcnt lgkmcnt(6)
    ds_read_b128 a[164:167], v19 offset:17408
    v_mfma_f32_16x16x32_bf16 v[96:99], a[136:139], a[200:203], v[96:99]
    s_waitcnt lgkmcnt(6)
    v_exp_f32 v112, v112
    v_mfma_f32_16x16x32_bf16 v[96:99], a[140:143], a[204:207], v[96:99]
    buffer_load_dwordx4 v15, s[8:11], s19 offen offset:2048 lds
    v_mfma_f32_16x16x32_bf16 v[104:107], a[128:131], a[208:211], v[68:71]
    v_exp_f32 v113, v113
    v_mfma_f32_16x16x32_bf16 v[104:107], a[132:135], a[212:215], v[104:107]
    ds_read_b128 a[168:171], v19 offset:18432
    v_cvt_pk_bf16_f32 v56, v112, v113
    v_mfma_f32_16x16x32_bf16 v[104:107], a[136:139], a[216:219], v[104:107]
    s_waitcnt lgkmcnt(6)
    v_exp_f32 v114, v114
    v_mfma_f32_16x16x32_bf16 v[104:107], a[140:143], a[220:223], v[104:107]
    buffer_load_dwordx4 v15, s[8:11], s19 offen offset:3072 lds
    v_mfma_f32_16x16x32_bf16 v[100:103], a[144:147], a[192:195], v[64:67]
    s_waitcnt lgkmcnt(5)
    s_xor_b32 s16, s16, 98304
    v_exp_f32 v115, v115
    v_mfma_f32_16x16x32_bf16 v[100:103], a[148:151], a[196:199], v[100:103]
    s_waitcnt lgkmcnt(4)
    s_lshl_b32 s64, s2, 6
    ds_read_b128 a[172:175], v19 offset:19456
    v_cvt_pk_bf16_f32 v57, v114, v115
    v_mfma_f32_16x16x32_bf16 v[100:103], a[152:155], a[200:203], v[100:103]
    s_waitcnt lgkmcnt(4)
    s_add_u32 s64, s64, 1327104
    v_exp_f32 v116, v116
    v_mfma_f32_16x16x32_bf16 v[100:103], a[156:159], a[204:207], v[100:103]
    buffer_store_dword v6, v7, s[8:11], s64 offen sc0 sc1
    v_mfma_f32_16x16x32_bf16 v[108:111], a[144:147], a[208:211], v[68:71]
    s_xor_b32 s74, s24, 8192
    v_exp_f32 v117, v117
    v_mfma_f32_16x16x32_bf16 v[108:111], a[148:151], a[212:215], v[108:111]
    ds_read_b128 a[176:179], v20 offset:20480
    v_cvt_pk_bf16_f32 v58, v116, v117
    v_mfma_f32_16x16x32_bf16 v[108:111], a[152:155], a[216:219], v[108:111]
    v_exp_f32 v118, v118
    v_mfma_f32_16x16x32_bf16 v[108:111], a[156:159], a[220:223], v[108:111]
    buffer_load_dwordx4 a[96:99], v1, s[8:11], s74 offen offset:0
    v_mfma_f32_16x16x32_bf16 v[32:35], v[28:31], v[48:51], v[32:35]
    s_xor_b32 s74, s24, 8192
    v_exp_f32 v119, v119
    v_mfma_f32_16x16x32_bf16 v[36:39], v[28:31], v[52:55], v[36:39]
    s_waitcnt lgkmcnt(4)
    ds_read_b128 a[180:183], v20 offset:21504
    v_cvt_pk_bf16_f32 v59, v118, v119
    v_mfma_f32_16x16x32_bf16 v[128:131], a[160:163], v[48:51], v[128:131]
    s_waitcnt lgkmcnt(4)
    v_exp_f32 v120, v120
    v_mfma_f32_16x16x32_bf16 v[160:163], a[160:163], v[52:55], v[160:163]
    buffer_load_dwordx4 a[100:103], v1, s[8:11], s74 offen offset:1024
    v_mfma_f32_16x16x32_bf16 v[132:135], a[164:167], v[48:51], v[132:135]
    s_xor_b32 s74, s24, 8192
    v_exp_f32 v121, v121
    v_mfma_f32_16x16x32_bf16 v[164:167], a[164:167], v[52:55], v[164:167]
    s_waitcnt lgkmcnt(3)
    ds_read_b128 a[184:187], v20 offset:22528
    v_cvt_pk_bf16_f32 v60, v120, v121
    v_mfma_f32_16x16x32_bf16 v[136:139], a[168:171], v[48:51], v[136:139]
    s_waitcnt lgkmcnt(3)
    v_exp_f32 v122, v122
    v_mfma_f32_16x16x32_bf16 v[168:171], a[168:171], v[52:55], v[168:171]
    buffer_load_dwordx4 a[104:107], v1, s[8:11], s74 offen offset:2048
    v_mfma_f32_16x16x32_bf16 v[140:143], a[172:175], v[48:51], v[140:143]
    s_xor_b32 s74, s24, 8192
    v_exp_f32 v123, v123
    v_mfma_f32_16x16x32_bf16 v[172:175], a[172:175], v[52:55], v[172:175]
    s_waitcnt lgkmcnt(2)
    ds_read_b128 a[188:191], v20 offset:23552
    v_cvt_pk_bf16_f32 v61, v122, v123
    v_mfma_f32_16x16x32_bf16 v[144:147], a[176:179], v[48:51], v[144:147]
    s_waitcnt lgkmcnt(2)
    v_exp_f32 v124, v124
    v_mfma_f32_16x16x32_bf16 v[176:179], a[176:179], v[52:55], v[176:179]
    buffer_load_dwordx4 a[108:111], v1, s[8:11], s74 offen offset:3072
    v_mfma_f32_16x16x32_bf16 v[148:151], a[180:183], v[48:51], v[148:151]
    s_xor_b32 s74, s24, 12288
    v_exp_f32 v125, v125
    v_mfma_f32_16x16x32_bf16 v[180:183], a[180:183], v[52:55], v[180:183]
    s_waitcnt lgkmcnt(1)
    v_cvt_pk_bf16_f32 v62, v124, v125
    v_xor_b32 v19, 98304, v19
    v_mfma_f32_16x16x32_bf16 v[152:155], a[184:187], v[48:51], v[152:155]
    buffer_load_dwordx4 a[112:115], v1, s[8:11], s74 offen offset:0
    v_exp_f32 v126, v126
    v_mfma_f32_16x16x32_bf16 v[184:187], a[184:187], v[52:55], v[184:187]
    s_waitcnt lgkmcnt(0)
    v_xor_b32 v20, 98304, v20
    v_mfma_f32_16x16x32_bf16 v[156:159], a[188:191], v[48:51], v[156:159]
    v_exp_f32 v127, v127
    v_mfma_f32_16x16x32_bf16 v[188:191], a[188:191], v[52:55], v[188:191]
    v_cvt_pk_bf16_f32 v63, v126, v127
    v_mfma_f32_16x16x32_bf16 v[112:115], a[128:131], a[224:227], v[72:75]
    s_add_u32 m0, s62, 36864
    v_exp_f32 v96, v96
    v_mfma_f32_16x16x32_bf16 v[112:115], a[132:135], a[228:231], v[112:115]
    v_add_f32 v86, 0xf3900000, v21
    v_min_f32 v86, v86, v66
    v_mfma_f32_16x16x32_bf16 v[112:115], a[136:139], a[232:235], v[112:115]
    s_xor_b32 s98, s65, 32768
    v_exp_f32 v97, v97
    v_mfma_f32_16x16x32_bf16 v[112:115], a[140:143], a[236:239], v[112:115]
    v_cvt_pk_bf16_f32 v48, v96, v97
    v_add_f32 v87, 0xf3980000, v21
    v_mfma_f32_16x16x32_bf16 v[120:123], a[128:131], a[240:243], v[76:79]
    v_exp_f32 v98, v98
    v_mfma_f32_16x16x32_bf16 v[120:123], a[132:135], a[244:247], v[120:123]
    buffer_load_dwordx4 v8, s[28:31], s98 offen offset:0  lds
    v_mfma_f32_16x16x32_bf16 v[120:123], a[136:139], a[248:251], v[120:123]
    v_exp_f32 v99, v99
    v_mfma_f32_16x16x32_bf16 v[120:123], a[140:143], a[252:255], v[120:123]
    buffer_load_dwordx4 v9, s[28:31], s98 offen offset:1024  lds
    v_mfma_f32_16x16x32_bf16 v[116:119], a[144:147], a[224:227], v[72:75]
    v_exp_f32 v100, v100
    v_mfma_f32_16x16x32_bf16 v[116:119], a[148:151], a[228:231], v[116:119]
    ds_read_b128 a[128:131], v18 offset:16384
    v_cvt_pk_bf16_f32 v49, v98, v99
    v_mfma_f32_16x16x32_bf16 v[116:119], a[152:155], a[232:235], v[116:119]
    s_add_u32 s19, s82, 32768
    v_exp_f32 v101, v101
    v_mfma_f32_16x16x32_bf16 v[116:119], a[156:159], a[236:239], v[116:119]
    s_sub_u32 s82, s12, s13
    ds_read_b128 a[132:135], v18 offset:17408
    v_cvt_pk_bf16_f32 v50, v100, v101
    v_mfma_f32_16x16x32_bf16 v[124:127], a[144:147], a[240:243], v[76:79]
    s_sub_u32 s82, s82, 1
    v_exp_f32 v102, v102
    v_mfma_f32_16x16x32_bf16 v[124:127], a[148:151], a[244:247], v[124:127]
    s_cmp_gt_u32 s12, s13
    s_cselect_b32 s82, s82, s12
    s_lshl_b32 s82, s82, 16
    ds_read_b128 a[136:139], v18 offset:18432
    v_mfma_f32_16x16x32_bf16 v[124:127], a[152:155], a[248:251], v[124:127]
    s_add_u32 s82, s82, s81
    v_exp_f32 v103, v103
    v_mfma_f32_16x16x32_bf16 v[124:127], a[156:159], a[252:255], v[124:127]
    s_cmp_ge_u32 s12, 17
    s_cselect_b32 s82, 2147471360, s82
    ds_read_b128 a[140:143], v18 offset:19456
    v_cvt_pk_bf16_f32 v51, v102, v103
    v_mfma_f32_16x16x32_bf16 v[40:43], v[28:31], v[56:59], v[40:43]
    s_add_u32 s12, s12, 1
    v_exp_f32 v104, v104
    v_mfma_f32_16x16x32_bf16 v[44:47], v[28:31], v[60:63], v[44:47]
    ds_read_b128 a[144:147], v18 offset:20480
    v_min_f32 v87, v87, v67
    v_mfma_f32_16x16x32_bf16 v[192:195], a[160:163], v[56:59], v[192:195]
    v_exp_f32 v105, v105
    v_mfma_f32_16x16x32_bf16 v[224:227], a[160:163], v[60:63], v[224:227]
    ds_read_b128 a[148:151], v18 offset:21504
    v_cvt_pk_bf16_f32 v52, v104, v105
    v_mfma_f32_16x16x32_bf16 v[196:199], a[164:167], v[56:59], v[196:199]
    v_exp_f32 v106, v106
    v_mfma_f32_16x16x32_bf16 v[228:231], a[164:167], v[60:63], v[228:231]
    ds_read_b128 a[152:155], v18 offset:22528
    v_add_f32 v88, 0x73800000, v21
    v_mfma_f32_16x16x32_bf16 v[200:203], a[168:171], v[56:59], v[200:203]
    v_exp_f32 v107, v107
    v_mfma_f32_16x16x32_bf16 v[232:235], a[168:171], v[60:63], v[232:235]
    ds_read_b128 a[156:159], v18 offset:23552
    v_cvt_pk_bf16_f32 v53, v106, v107
    v_mfma_f32_16x16x32_bf16 v[204:207], a[172:175], v[56:59], v[204:207]
    v_exp_f32 v108, v108
    v_mfma_f32_16x16x32_bf16 v[236:239], a[172:175], v[60:63], v[236:239]
    buffer_load_dwordx4 v10, s[28:31], s98 offen offset:2048  lds
    v_mfma_f32_16x16x32_bf16 v[208:211], a[176:179], v[56:59], v[208:211]
    v_exp_f32 v109, v109
    v_mfma_f32_16x16x32_bf16 v[240:243], a[176:179], v[60:63], v[240:243]
    v_cvt_pk_bf16_f32 v54, v108, v109
    v_xor_b32 v18, 196608, v18
    v_mfma_f32_16x16x32_bf16 v[212:215], a[180:183], v[56:59], v[212:215]
    v_exp_f32 v110, v110
    v_mfma_f32_16x16x32_bf16 v[244:247], a[180:183], v[60:63], v[244:247]
    buffer_load_dwordx4 v11, s[28:31], s98 offen offset:3072  lds
    v_mfma_f32_16x16x32_bf16 v[216:219], a[184:187], v[56:59], v[216:219]
    s_xor_b32 s74, s24, 12288
    v_exp_f32 v111, v111
    v_mfma_f32_16x16x32_bf16 v[248:251], a[184:187], v[60:63], v[248:251]
    v_cvt_pk_bf16_f32 v55, v110, v111
    v_min_f32 v88, v88, v68
    v_mfma_f32_16x16x32_bf16 v[220:223], a[188:191], v[56:59], v[220:223]
    buffer_load_dwordx4 a[116:119], v1, s[8:11], s74 offen offset:1024
    v_mfma_f32_16x16x32_bf16 v[252:255], a[188:191], v[60:63], v[252:255]
    s_xor_b32 s74, s24, 12288
    buffer_load_dwordx4 a[120:123], v1, s[8:11], s74 offen offset:2048
    s_xor_b32 s74, s24, 12288
    buffer_load_dwordx4 a[124:127], v1, s[8:11], s74 offen offset:3072
    s_waitcnt vmcnt(13) lgkmcnt(0)
    s_barrier
    v_mfma_f32_16x16x32_bf16 v[96:99], a[128:131], a[192:195], v[64:67]
    s_add_u32 m0, s15, 0
    ds_read_b128 a[160:163], v19 offset:0
    v_mfma_f32_16x16x32_bf16 v[96:99], a[132:135], a[196:199], v[96:99]
    ds_read_b128 a[164:167], v19 offset:1024
    v_mfma_f32_16x16x32_bf16 v[96:99], a[136:139], a[200:203], v[96:99]
    v_exp_f32 v112, v112
    v_mfma_f32_16x16x32_bf16 v[96:99], a[140:143], a[204:207], v[96:99]
    buffer_load_dwordx4 v1, s[8:11], s82 offen offset:0 lds
    v_mfma_f32_16x16x32_bf16 v[104:107], a[128:131], a[208:211], v[68:71]
    v_exp_f32 v113, v113
    v_mfma_f32_16x16x32_bf16 v[104:107], a[132:135], a[212:215], v[104:107]
    ds_read_b128 a[168:171], v19 offset:2048
    v_cvt_pk_bf16_f32 v56, v112, v113
    v_mfma_f32_16x16x32_bf16 v[104:107], a[136:139], a[216:219], v[104:107]
    v_exp_f32 v114, v114
    v_mfma_f32_16x16x32_bf16 v[104:107], a[140:143], a[220:223], v[104:107]
    buffer_load_dwordx4 v1, s[8:11], s82 offen offset:1024 lds
    v_mfma_f32_16x16x32_bf16 v[100:103], a[144:147], a[192:195], v[64:67]
    v_exp_f32 v115, v115
    v_mfma_f32_16x16x32_bf16 v[100:103], a[148:151], a[196:199], v[100:103]
    ds_read_b128 a[172:175], v19 offset:3072
    v_cvt_pk_bf16_f32 v57, v114, v115
    v_mfma_f32_16x16x32_bf16 v[100:103], a[152:155], a[200:203], v[100:103]
    v_exp_f32 v116, v116
    v_mfma_f32_16x16x32_bf16 v[100:103], a[156:159], a[204:207], v[100:103]
    buffer_load_dwordx4 v1, s[8:11], s82 offen offset:2048 lds
    v_mfma_f32_16x16x32_bf16 v[108:111], a[144:147], a[208:211], v[68:71]
    v_exp_f32 v117, v117
    v_mfma_f32_16x16x32_bf16 v[108:111], a[148:151], a[212:215], v[108:111]
    ds_read_b128 a[176:179], v20 offset:4096
    v_cvt_pk_bf16_f32 v58, v116, v117
    v_mfma_f32_16x16x32_bf16 v[108:111], a[152:155], a[216:219], v[108:111]
    v_exp_f32 v118, v118
    v_mfma_f32_16x16x32_bf16 v[108:111], a[156:159], a[220:223], v[108:111]
    buffer_load_dwordx4 v1, s[8:11], s82 offen offset:3072 lds
    v_mfma_f32_16x16x32_bf16 v[32:35], v[28:31], v[48:51], v[32:35]
    s_add_u32 m0, s15, 4096
    v_exp_f32 v119, v119
    v_mfma_f32_16x16x32_bf16 v[36:39], v[28:31], v[52:55], v[36:39]
    s_waitcnt lgkmcnt(4)
    ds_read_b128 a[180:183], v20 offset:5120
    v_cvt_pk_bf16_f32 v59, v118, v119
    v_mfma_f32_16x16x32_bf16 v[128:131], a[160:163], v[48:51], v[128:131]
    v_exp_f32 v120, v120
    v_mfma_f32_16x16x32_bf16 v[160:163], a[160:163], v[52:55], v[160:163]
    s_waitcnt lgkmcnt(4)
    v_mfma_f32_16x16x32_bf16 v[132:135], a[164:167], v[48:51], v[132:135]
    v_exp_f32 v121, v121
    v_mfma_f32_16x16x32_bf16 v[164:167], a[164:167], v[52:55], v[164:167]
    s_waitcnt lgkmcnt(3)
    ds_read_b128 a[184:187], v20 offset:6144
    v_cvt_pk_bf16_f32 v60, v120, v121
    v_mfma_f32_16x16x32_bf16 v[136:139], a[168:171], v[48:51], v[136:139]
    s_waitcnt lgkmcnt(3)
    v_exp_f32 v122, v122
    v_mfma_f32_16x16x32_bf16 v[168:171], a[168:171], v[52:55], v[168:171]
    buffer_load_dwordx4 v15, s[8:11], s82 offen offset:0 lds
    v_mfma_f32_16x16x32_bf16 v[140:143], a[172:175], v[48:51], v[140:143]
    v_exp_f32 v123, v123
    v_mfma_f32_16x16x32_bf16 v[172:175], a[172:175], v[52:55], v[172:175]
    s_waitcnt lgkmcnt(2)
    ds_read_b128 a[188:191], v20 offset:7168
    v_cvt_pk_bf16_f32 v61, v122, v123
    v_mfma_f32_16x16x32_bf16 v[144:147], a[176:179], v[48:51], v[144:147]
    s_waitcnt lgkmcnt(2)
    v_exp_f32 v124, v124
    v_mfma_f32_16x16x32_bf16 v[176:179], a[176:179], v[52:55], v[176:179]
    buffer_load_dwordx4 v15, s[8:11], s82 offen offset:1024 lds
    v_mfma_f32_16x16x32_bf16 v[148:151], a[180:183], v[48:51], v[148:151]
    v_exp_f32 v125, v125
    v_mfma_f32_16x16x32_bf16 v[180:183], a[180:183], v[52:55], v[180:183]
    s_waitcnt lgkmcnt(1)
    v_cvt_pk_bf16_f32 v62, v124, v125
    v_mfma_f32_16x16x32_bf16 v[152:155], a[184:187], v[48:51], v[152:155]
    s_waitcnt lgkmcnt(0)
    v_exp_f32 v126, v126
    v_mfma_f32_16x16x32_bf16 v[184:187], a[184:187], v[52:55], v[184:187]
    buffer_load_dwordx4 v15, s[8:11], s82 offen offset:2048 lds
    v_mfma_f32_16x16x32_bf16 v[156:159], a[188:191], v[48:51], v[156:159]
    v_exp_f32 v127, v127
    v_mfma_f32_16x16x32_bf16 v[188:191], a[188:191], v[52:55], v[188:191]
    v_cvt_pk_bf16_f32 v63, v126, v127
    v_mfma_f32_16x16x32_bf16 v[112:115], a[128:131], a[224:227], v[72:75]
    v_mfma_f32_16x16x32_bf16 v[112:115], a[132:135], a[228:231], v[112:115]
    v_mfma_f32_16x16x32_bf16 v[112:115], a[136:139], a[232:235], v[112:115]
    v_exp_f32 v96, v96
    v_mfma_f32_16x16x32_bf16 v[112:115], a[140:143], a[236:239], v[112:115]
    buffer_load_dwordx4 v15, s[8:11], s82 offen offset:3072 lds
    v_mfma_f32_16x16x32_bf16 v[120:123], a[128:131], a[240:243], v[76:79]
    s_xor_b32 s15, s15, 196608
    v_exp_f32 v97, v97
    v_mfma_f32_16x16x32_bf16 v[120:123], a[132:135], a[244:247], v[120:123]
    s_add_u32 m0, s16, 0
    ds_read_b128 a[128:131], v18 offset:0
    v_cvt_pk_bf16_f32 v48, v96, v97
    v_mfma_f32_16x16x32_bf16 v[120:123], a[136:139], a[248:251], v[120:123]
    v_exp_f32 v98, v98
    v_mfma_f32_16x16x32_bf16 v[120:123], a[140:143], a[252:255], v[120:123]
    buffer_load_dwordx4 v1, s[8:11], s19 offen offset:0 lds
    v_mfma_f32_16x16x32_bf16 v[116:119], a[144:147], a[224:227], v[72:75]
    v_exp_f32 v99, v99
    v_mfma_f32_16x16x32_bf16 v[116:119], a[148:151], a[228:231], v[116:119]
    ds_read_b128 a[132:135], v18 offset:1024
    v_cvt_pk_bf16_f32 v49, v98, v99
    v_mfma_f32_16x16x32_bf16 v[116:119], a[152:155], a[232:235], v[116:119]
    v_exp_f32 v100, v100
    v_mfma_f32_16x16x32_bf16 v[116:119], a[156:159], a[236:239], v[116:119]
    buffer_load_dwordx4 v1, s[8:11], s19 offen offset:1024 lds
    v_mfma_f32_16x16x32_bf16 v[124:127], a[144:147], a[240:243], v[76:79]
    v_exp_f32 v101, v101
    v_mfma_f32_16x16x32_bf16 v[124:127], a[148:151], a[244:247], v[124:127]
    ds_read_b128 a[136:139], v18 offset:2048
    v_cvt_pk_bf16_f32 v50, v100, v101
    v_mfma_f32_16x16x32_bf16 v[124:127], a[152:155], a[248:251], v[124:127]
    v_exp_f32 v102, v102
    v_mfma_f32_16x16x32_bf16 v[124:127], a[156:159], a[252:255], v[124:127]
    buffer_load_dwordx4 v1, s[8:11], s19 offen offset:2048 lds
    v_mfma_f32_16x16x32_bf16 v[40:43], v[28:31], v[56:59], v[40:43]
    v_exp_f32 v103, v103
    v_mfma_f32_16x16x32_bf16 v[44:47], v[28:31], v[60:63], v[44:47]
    ds_read_b128 a[140:143], v18 offset:3072
    v_cvt_pk_bf16_f32 v51, v102, v103
    v_mfma_f32_16x16x32_bf16 v[192:195], a[160:163], v[56:59], v[192:195]
    v_exp_f32 v104, v104
    v_mfma_f32_16x16x32_bf16 v[224:227], a[160:163], v[60:63], v[224:227]
    v_mfma_f32_16x16x32_bf16 v[196:199], a[164:167], v[56:59], v[196:199]
    v_exp_f32 v105, v105
    v_mfma_f32_16x16x32_bf16 v[228:231], a[164:167], v[60:63], v[228:231]
    ds_read_b128 a[144:147], v18 offset:4096
    v_cvt_pk_bf16_f32 v52, v104, v105
    v_mfma_f32_16x16x32_bf16 v[200:203], a[168:171], v[56:59], v[200:203]
    v_exp_f32 v106, v106
    v_mfma_f32_16x16x32_bf16 v[232:235], a[168:171], v[60:63], v[232:235]
    buffer_load_dwordx4 v1, s[8:11], s19 offen offset:3072 lds
    v_mfma_f32_16x16x32_bf16 v[204:207], a[172:175], v[56:59], v[204:207]
    s_add_u32 m0, s16, 4096
    v_exp_f32 v107, v107
    v_mfma_f32_16x16x32_bf16 v[236:239], a[172:175], v[60:63], v[236:239]
    ds_read_b128 a[148:151], v18 offset:5120
    v_cvt_pk_bf16_f32 v53, v106, v107
    v_mfma_f32_16x16x32_bf16 v[208:211], a[176:179], v[56:59], v[208:211]
    v_exp_f32 v108, v108
    v_mfma_f32_16x16x32_bf16 v[240:243], a[176:179], v[60:63], v[240:243]
    buffer_load_dwordx4 v15, s[8:11], s19 offen offset:0 lds
    v_mfma_f32_16x16x32_bf16 v[212:215], a[180:183], v[56:59], v[212:215]
    v_exp_f32 v109, v109
    v_mfma_f32_16x16x32_bf16 v[244:247], a[180:183], v[60:63], v[244:247]
    ds_read_b128 a[152:155], v18 offset:6144
    v_cvt_pk_bf16_f32 v54, v108, v109
    v_mfma_f32_16x16x32_bf16 v[216:219], a[184:187], v[56:59], v[216:219]
    v_exp_f32 v110, v110
    v_mfma_f32_16x16x32_bf16 v[248:251], a[184:187], v[60:63], v[248:251]
    buffer_load_dwordx4 v15, s[8:11], s19 offen offset:1024 lds
    v_mfma_f32_16x16x32_bf16 v[220:223], a[188:191], v[56:59], v[220:223]
    v_exp_f32 v111, v111
    v_mfma_f32_16x16x32_bf16 v[252:255], a[188:191], v[60:63], v[252:255]
    ds_read_b128 a[156:159], v18 offset:7168
    v_cvt_pk_bf16_f32 v55, v110, v111
    s_waitcnt lgkmcnt(7)
    v_mfma_f32_16x16x32_bf16 v[96:99], a[128:131], a[192:195], v[64:67]
    s_waitcnt lgkmcnt(6)
    ds_read_b128 a[160:163], v19 offset:16384
    v_mfma_f32_16x16x32_bf16 v[96:99], a[132:135], a[196:199], v[96:99]
    s_waitcnt lgkmcnt(6)
    ds_read_b128 a[164:167], v19 offset:17408
    v_mfma_f32_16x16x32_bf16 v[96:99], a[136:139], a[200:203], v[96:99]
    s_waitcnt lgkmcnt(6)
    v_exp_f32 v112, v112
    v_mfma_f32_16x16x32_bf16 v[96:99], a[140:143], a[204:207], v[96:99]
    buffer_load_dwordx4 v15, s[8:11], s19 offen offset:2048 lds
    v_mfma_f32_16x16x32_bf16 v[104:107], a[128:131], a[208:211], v[68:71]
    v_exp_f32 v113, v113
    v_mfma_f32_16x16x32_bf16 v[104:107], a[132:135], a[212:215], v[104:107]
    ds_read_b128 a[168:171], v19 offset:18432
    v_cvt_pk_bf16_f32 v56, v112, v113
    v_mfma_f32_16x16x32_bf16 v[104:107], a[136:139], a[216:219], v[104:107]
    s_waitcnt lgkmcnt(6)
    v_exp_f32 v114, v114
    v_mfma_f32_16x16x32_bf16 v[104:107], a[140:143], a[220:223], v[104:107]
    buffer_load_dwordx4 v15, s[8:11], s19 offen offset:3072 lds
    v_mfma_f32_16x16x32_bf16 v[100:103], a[144:147], a[192:195], v[64:67]
    s_waitcnt lgkmcnt(5)
    s_xor_b32 s16, s16, 98304
    v_exp_f32 v115, v115
    v_mfma_f32_16x16x32_bf16 v[100:103], a[148:151], a[196:199], v[100:103]
    s_waitcnt lgkmcnt(4)
    s_xor_b32 s74, s24, 16384
    ds_read_b128 a[172:175], v19 offset:19456
    v_cvt_pk_bf16_f32 v57, v114, v115
    v_mfma_f32_16x16x32_bf16 v[100:103], a[152:155], a[200:203], v[100:103]
    s_waitcnt lgkmcnt(4)
    v_exp_f32 v116, v116
    v_mfma_f32_16x16x32_bf16 v[100:103], a[156:159], a[204:207], v[100:103]
    buffer_load_dwordx4 a[0:3], v1, s[8:11], s74 offen offset:0
    v_mfma_f32_16x16x32_bf16 v[108:111], a[144:147], a[208:211], v[68:71]
    s_xor_b32 s74, s24, 16384
    v_exp_f32 v117, v117
    v_mfma_f32_16x16x32_bf16 v[108:111], a[148:151], a[212:215], v[108:111]
    ds_read_b128 a[176:179], v20 offset:20480
    v_cvt_pk_bf16_f32 v58, v116, v117
    v_mfma_f32_16x16x32_bf16 v[108:111], a[152:155], a[216:219], v[108:111]
    v_exp_f32 v118, v118
    v_mfma_f32_16x16x32_bf16 v[108:111], a[156:159], a[220:223], v[108:111]
    buffer_load_dwordx4 a[4:7], v1, s[8:11], s74 offen offset:1024
    v_mfma_f32_16x16x32_bf16 v[32:35], v[28:31], v[48:51], v[32:35]
    s_xor_b32 s74, s24, 16384
    v_exp_f32 v119, v119
    v_mfma_f32_16x16x32_bf16 v[36:39], v[28:31], v[52:55], v[36:39]
    s_waitcnt lgkmcnt(4)
    ds_read_b128 a[180:183], v20 offset:21504
    v_cvt_pk_bf16_f32 v59, v118, v119
    v_mfma_f32_16x16x32_bf16 v[128:131], a[160:163], v[48:51], v[128:131]
    s_waitcnt lgkmcnt(4)
    v_exp_f32 v120, v120
    v_mfma_f32_16x16x32_bf16 v[160:163], a[160:163], v[52:55], v[160:163]
    buffer_load_dwordx4 a[8:11], v1, s[8:11], s74 offen offset:2048
    v_mfma_f32_16x16x32_bf16 v[132:135], a[164:167], v[48:51], v[132:135]
    s_xor_b32 s74, s24, 16384
    v_exp_f32 v121, v121
    v_mfma_f32_16x16x32_bf16 v[164:167], a[164:167], v[52:55], v[164:167]
    s_waitcnt lgkmcnt(3)
    ds_read_b128 a[184:187], v20 offset:22528
    v_cvt_pk_bf16_f32 v60, v120, v121
    v_mfma_f32_16x16x32_bf16 v[136:139], a[168:171], v[48:51], v[136:139]
    s_waitcnt lgkmcnt(3)
    v_exp_f32 v122, v122
    v_mfma_f32_16x16x32_bf16 v[168:171], a[168:171], v[52:55], v[168:171]
    buffer_load_dwordx4 a[12:15], v1, s[8:11], s74 offen offset:3072
    v_mfma_f32_16x16x32_bf16 v[140:143], a[172:175], v[48:51], v[140:143]
    s_xor_b32 s74, s24, 20480
    v_exp_f32 v123, v123
    v_mfma_f32_16x16x32_bf16 v[172:175], a[172:175], v[52:55], v[172:175]
    s_waitcnt lgkmcnt(2)
    ds_read_b128 a[188:191], v20 offset:23552
    v_cvt_pk_bf16_f32 v61, v122, v123
    v_mfma_f32_16x16x32_bf16 v[144:147], a[176:179], v[48:51], v[144:147]
    s_waitcnt lgkmcnt(2)
    v_exp_f32 v124, v124
    v_mfma_f32_16x16x32_bf16 v[176:179], a[176:179], v[52:55], v[176:179]
    buffer_load_dwordx4 a[16:19], v1, s[8:11], s74 offen offset:0
    v_mfma_f32_16x16x32_bf16 v[148:151], a[180:183], v[48:51], v[148:151]
    s_xor_b32 s74, s24, 20480
    v_exp_f32 v125, v125
    v_mfma_f32_16x16x32_bf16 v[180:183], a[180:183], v[52:55], v[180:183]
    s_waitcnt lgkmcnt(1)
    v_cvt_pk_bf16_f32 v62, v124, v125
    v_xor_b32 v19, 98304, v19
    v_mfma_f32_16x16x32_bf16 v[152:155], a[184:187], v[48:51], v[152:155]
    buffer_load_dwordx4 a[20:23], v1, s[8:11], s74 offen offset:1024
    v_exp_f32 v126, v126
    v_mfma_f32_16x16x32_bf16 v[184:187], a[184:187], v[52:55], v[184:187]
    s_waitcnt lgkmcnt(0)
    v_xor_b32 v20, 98304, v20
    v_mfma_f32_16x16x32_bf16 v[156:159], a[188:191], v[48:51], v[156:159]
    v_exp_f32 v127, v127
    v_mfma_f32_16x16x32_bf16 v[188:191], a[188:191], v[52:55], v[188:191]
    v_cvt_pk_bf16_f32 v63, v126, v127
    v_mfma_f32_16x16x32_bf16 v[112:115], a[128:131], a[224:227], v[72:75]
    s_xor_b32 s74, s24, 20480
    v_exp_f32 v96, v96
    v_mfma_f32_16x16x32_bf16 v[112:115], a[132:135], a[228:231], v[112:115]
    buffer_load_dwordx4 a[24:27], v1, s[8:11], s74 offen offset:2048
    v_mfma_f32_16x16x32_bf16 v[112:115], a[136:139], a[232:235], v[112:115]
    s_xor_b32 s74, s24, 20480
    v_exp_f32 v97, v97
    v_mfma_f32_16x16x32_bf16 v[112:115], a[140:143], a[236:239], v[112:115]
    v_cvt_pk_bf16_f32 v48, v96, v97
    v_add_f32 v89, 0x73700000, v21
    v_mfma_f32_16x16x32_bf16 v[120:123], a[128:131], a[240:243], v[76:79]
    v_exp_f32 v98, v98
    v_mfma_f32_16x16x32_bf16 v[120:123], a[132:135], a[244:247], v[120:123]
    buffer_load_dwordx4 a[28:31], v1, s[8:11], s74 offen offset:3072
    v_mfma_f32_16x16x32_bf16 v[120:123], a[136:139], a[248:251], v[120:123]
    s_xor_b32 s74, s24, 24576
    v_exp_f32 v99, v99
    v_mfma_f32_16x16x32_bf16 v[120:123], a[140:143], a[252:255], v[120:123]
    buffer_load_dwordx4 a[32:35], v1, s[8:11], s74 offen offset:0
    v_mfma_f32_16x16x32_bf16 v[116:119], a[144:147], a[224:227], v[72:75]
    s_xor_b32 s74, s24, 24576
    v_exp_f32 v100, v100
    v_mfma_f32_16x16x32_bf16 v[116:119], a[148:151], a[228:231], v[116:119]
    ds_read_b128 a[128:131], v18 offset:16384
    v_cvt_pk_bf16_f32 v49, v98, v99
    v_mfma_f32_16x16x32_bf16 v[116:119], a[152:155], a[232:235], v[116:119]
    s_add_u32 s19, s82, 32768
    v_exp_f32 v101, v101
    v_mfma_f32_16x16x32_bf16 v[116:119], a[156:159], a[236:239], v[116:119]
    s_sub_u32 s82, s12, s13
    ds_read_b128 a[132:135], v18 offset:17408
    v_cvt_pk_bf16_f32 v50, v100, v101
    v_mfma_f32_16x16x32_bf16 v[124:127], a[144:147], a[240:243], v[76:79]
    s_sub_u32 s82, s82, 1
    v_exp_f32 v102, v102
    v_mfma_f32_16x16x32_bf16 v[124:127], a[148:151], a[244:247], v[124:127]
    s_cmp_gt_u32 s12, s13
    s_cselect_b32 s82, s82, s12
    s_lshl_b32 s82, s82, 16
    ds_read_b128 a[136:139], v18 offset:18432
    v_mfma_f32_16x16x32_bf16 v[124:127], a[152:155], a[248:251], v[124:127]
    s_add_u32 s82, s82, s81
    v_exp_f32 v103, v103
    v_mfma_f32_16x16x32_bf16 v[124:127], a[156:159], a[252:255], v[124:127]
    s_cmp_ge_u32 s12, 17
    s_cselect_b32 s82, 2147471360, s82
    ds_read_b128 a[140:143], v18 offset:19456
    v_cvt_pk_bf16_f32 v51, v102, v103
    v_mfma_f32_16x16x32_bf16 v[40:43], v[28:31], v[56:59], v[40:43]
    s_add_u32 s12, s12, 1
    v_exp_f32 v104, v104
    v_mfma_f32_16x16x32_bf16 v[44:47], v[28:31], v[60:63], v[44:47]
    ds_read_b128 a[144:147], v18 offset:20480
    v_min_f32 v89, v89, v69
    v_mfma_f32_16x16x32_bf16 v[192:195], a[160:163], v[56:59], v[192:195]
    v_exp_f32 v105, v105
    v_mfma_f32_16x16x32_bf16 v[224:227], a[160:163], v[60:63], v[224:227]
    ds_read_b128 a[148:151], v18 offset:21504
    v_cvt_pk_bf16_f32 v52, v104, v105
    v_mfma_f32_16x16x32_bf16 v[196:199], a[164:167], v[56:59], v[196:199]
    v_exp_f32 v106, v106
    v_mfma_f32_16x16x32_bf16 v[228:231], a[164:167], v[60:63], v[228:231]
    ds_read_b128 a[152:155], v18 offset:22528
    v_add_f32 v90, 0x73600000, v21
    v_mfma_f32_16x16x32_bf16 v[200:203], a[168:171], v[56:59], v[200:203]
    v_exp_f32 v107, v107
    v_mfma_f32_16x16x32_bf16 v[232:235], a[168:171], v[60:63], v[232:235]
    ds_read_b128 a[156:159], v18 offset:23552
    v_cvt_pk_bf16_f32 v53, v106, v107
    v_mfma_f32_16x16x32_bf16 v[204:207], a[172:175], v[56:59], v[204:207]
    v_exp_f32 v108, v108
    v_mfma_f32_16x16x32_bf16 v[236:239], a[172:175], v[60:63], v[236:239]
    buffer_load_dwordx4 a[36:39], v1, s[8:11], s74 offen offset:1024
    v_mfma_f32_16x16x32_bf16 v[208:211], a[176:179], v[56:59], v[208:211]
    s_xor_b32 s74, s24, 24576
    v_exp_f32 v109, v109
    v_mfma_f32_16x16x32_bf16 v[240:243], a[176:179], v[60:63], v[240:243]
    v_cvt_pk_bf16_f32 v54, v108, v109
    v_xor_b32 v18, 196608, v18
    v_mfma_f32_16x16x32_bf16 v[212:215], a[180:183], v[56:59], v[212:215]
    v_exp_f32 v110, v110
    v_mfma_f32_16x16x32_bf16 v[244:247], a[180:183], v[60:63], v[244:247]
    buffer_load_dwordx4 a[40:43], v1, s[8:11], s74 offen offset:2048
    v_mfma_f32_16x16x32_bf16 v[216:219], a[184:187], v[56:59], v[216:219]
    s_xor_b32 s74, s24, 24576
    v_exp_f32 v111, v111
    v_mfma_f32_16x16x32_bf16 v[248:251], a[184:187], v[60:63], v[248:251]
    v_cvt_pk_bf16_f32 v55, v110, v111
    v_min_f32 v90, v90, v70
    v_mfma_f32_16x16x32_bf16 v[220:223], a[188:191], v[56:59], v[220:223]
    buffer_load_dwordx4 a[44:47], v1, s[8:11], s74 offen offset:3072
    v_mfma_f32_16x16x32_bf16 v[252:255], a[188:191], v[60:63], v[252:255]
    v_add_f32 v91, 0x73500000, v21
    v_min_f32 v91, v91, v71
    v_add_f32 v92, 0, v21
    v_min_f32 v92, v92, v68
    s_waitcnt vmcnt(12) lgkmcnt(0)
    s_barrier
    v_mfma_f32_16x16x32_bf16 v[96:99], a[128:131], a[192:195], v[64:67]
    s_add_u32 m0, s15, 0
    ds_read_b128 a[160:163], v19 offset:0
    v_mfma_f32_16x16x32_bf16 v[96:99], a[132:135], a[196:199], v[96:99]
    ds_read_b128 a[164:167], v19 offset:1024
    v_mfma_f32_16x16x32_bf16 v[96:99], a[136:139], a[200:203], v[96:99]
    v_exp_f32 v112, v112
    v_mfma_f32_16x16x32_bf16 v[96:99], a[140:143], a[204:207], v[96:99]
    buffer_load_dwordx4 v1, s[8:11], s82 offen offset:0 lds
    v_mfma_f32_16x16x32_bf16 v[104:107], a[128:131], a[208:211], v[68:71]
    v_exp_f32 v113, v113
    v_mfma_f32_16x16x32_bf16 v[104:107], a[132:135], a[212:215], v[104:107]
    ds_read_b128 a[168:171], v19 offset:2048
    v_cvt_pk_bf16_f32 v56, v112, v113
    v_mfma_f32_16x16x32_bf16 v[104:107], a[136:139], a[216:219], v[104:107]
    v_exp_f32 v114, v114
    v_mfma_f32_16x16x32_bf16 v[104:107], a[140:143], a[220:223], v[104:107]
    buffer_load_dwordx4 v1, s[8:11], s82 offen offset:1024 lds
    v_mfma_f32_16x16x32_bf16 v[100:103], a[144:147], a[192:195], v[64:67]
    v_exp_f32 v115, v115
    v_mfma_f32_16x16x32_bf16 v[100:103], a[148:151], a[196:199], v[100:103]
    ds_read_b128 a[172:175], v19 offset:3072
    v_cvt_pk_bf16_f32 v57, v114, v115
    v_mfma_f32_16x16x32_bf16 v[100:103], a[152:155], a[200:203], v[100:103]
    v_exp_f32 v116, v116
    v_mfma_f32_16x16x32_bf16 v[100:103], a[156:159], a[204:207], v[100:103]
    buffer_load_dwordx4 v1, s[8:11], s82 offen offset:2048 lds
    v_mfma_f32_16x16x32_bf16 v[108:111], a[144:147], a[208:211], v[68:71]
    v_exp_f32 v117, v117
    v_mfma_f32_16x16x32_bf16 v[108:111], a[148:151], a[212:215], v[108:111]
    ds_read_b128 a[176:179], v20 offset:4096
    v_cvt_pk_bf16_f32 v58, v116, v117
    v_mfma_f32_16x16x32_bf16 v[108:111], a[152:155], a[216:219], v[108:111]
    v_exp_f32 v118, v118
    v_mfma_f32_16x16x32_bf16 v[108:111], a[156:159], a[220:223], v[108:111]
    buffer_load_dwordx4 v1, s[8:11], s82 offen offset:3072 lds
    v_mfma_f32_16x16x32_bf16 v[32:35], v[28:31], v[48:51], v[32:35]
    s_add_u32 m0, s15, 4096
    v_exp_f32 v119, v119
    v_mfma_f32_16x16x32_bf16 v[36:39], v[28:31], v[52:55], v[36:39]
    s_waitcnt lgkmcnt(4)
    ds_read_b128 a[180:183], v20 offset:5120
    v_cvt_pk_bf16_f32 v59, v118, v119
    v_mfma_f32_16x16x32_bf16 v[128:131], a[160:163], v[48:51], v[128:131]
    v_exp_f32 v120, v120
    v_mfma_f32_16x16x32_bf16 v[160:163], a[160:163], v[52:55], v[160:163]
    s_waitcnt lgkmcnt(4)
    v_mfma_f32_16x16x32_bf16 v[132:135], a[164:167], v[48:51], v[132:135]
    v_exp_f32 v121, v121
    v_mfma_f32_16x16x32_bf16 v[164:167], a[164:167], v[52:55], v[164:167]
    s_waitcnt lgkmcnt(3)
    ds_read_b128 a[184:187], v20 offset:6144
    v_cvt_pk_bf16_f32 v60, v120, v121
    v_mfma_f32_16x16x32_bf16 v[136:139], a[168:171], v[48:51], v[136:139]
    s_waitcnt lgkmcnt(3)
    v_exp_f32 v122, v122
    v_mfma_f32_16x16x32_bf16 v[168:171], a[168:171], v[52:55], v[168:171]
    buffer_load_dwordx4 v15, s[8:11], s82 offen offset:0 lds
    v_mfma_f32_16x16x32_bf16 v[140:143], a[172:175], v[48:51], v[140:143]
    v_exp_f32 v123, v123
    v_mfma_f32_16x16x32_bf16 v[172:175], a[172:175], v[52:55], v[172:175]
    s_waitcnt lgkmcnt(2)
    ds_read_b128 a[188:191], v20 offset:7168
    v_cvt_pk_bf16_f32 v61, v122, v123
    v_mfma_f32_16x16x32_bf16 v[144:147], a[176:179], v[48:51], v[144:147]
    s_waitcnt lgkmcnt(2)
    v_exp_f32 v124, v124
    v_mfma_f32_16x16x32_bf16 v[176:179], a[176:179], v[52:55], v[176:179]
    buffer_load_dwordx4 v15, s[8:11], s82 offen offset:1024 lds
    v_mfma_f32_16x16x32_bf16 v[148:151], a[180:183], v[48:51], v[148:151]
    v_exp_f32 v125, v125
    v_mfma_f32_16x16x32_bf16 v[180:183], a[180:183], v[52:55], v[180:183]
    s_waitcnt lgkmcnt(1)
    v_cvt_pk_bf16_f32 v62, v124, v125
    v_mfma_f32_16x16x32_bf16 v[152:155], a[184:187], v[48:51], v[152:155]
    s_waitcnt lgkmcnt(0)
    v_exp_f32 v126, v126
    v_mfma_f32_16x16x32_bf16 v[184:187], a[184:187], v[52:55], v[184:187]
    buffer_load_dwordx4 v15, s[8:11], s82 offen offset:2048 lds
    v_mfma_f32_16x16x32_bf16 v[156:159], a[188:191], v[48:51], v[156:159]
    v_exp_f32 v127, v127
    v_mfma_f32_16x16x32_bf16 v[188:191], a[188:191], v[52:55], v[188:191]
    v_cvt_pk_bf16_f32 v63, v126, v127
    v_mfma_f32_16x16x32_bf16 v[112:115], a[128:131], a[224:227], v[72:75]
    v_mfma_f32_16x16x32_bf16 v[112:115], a[132:135], a[228:231], v[112:115]
    v_mfma_f32_16x16x32_bf16 v[112:115], a[136:139], a[232:235], v[112:115]
    v_exp_f32 v96, v96
    v_mfma_f32_16x16x32_bf16 v[112:115], a[140:143], a[236:239], v[112:115]
    buffer_load_dwordx4 v15, s[8:11], s82 offen offset:3072 lds
    v_mfma_f32_16x16x32_bf16 v[120:123], a[128:131], a[240:243], v[76:79]
    s_xor_b32 s15, s15, 196608
    v_exp_f32 v97, v97
    v_mfma_f32_16x16x32_bf16 v[120:123], a[132:135], a[244:247], v[120:123]
    s_add_u32 m0, s16, 0
    ds_read_b128 a[128:131], v18 offset:0
    v_cvt_pk_bf16_f32 v48, v96, v97
    v_mfma_f32_16x16x32_bf16 v[120:123], a[136:139], a[248:251], v[120:123]
    v_exp_f32 v98, v98
    v_mfma_f32_16x16x32_bf16 v[120:123], a[140:143], a[252:255], v[120:123]
    buffer_load_dwordx4 v1, s[8:11], s19 offen offset:0 lds
    v_mfma_f32_16x16x32_bf16 v[116:119], a[144:147], a[224:227], v[72:75]
    v_exp_f32 v99, v99
    v_mfma_f32_16x16x32_bf16 v[116:119], a[148:151], a[228:231], v[116:119]
    ds_read_b128 a[132:135], v18 offset:1024
    v_cvt_pk_bf16_f32 v49, v98, v99
    v_mfma_f32_16x16x32_bf16 v[116:119], a[152:155], a[232:235], v[116:119]
    v_exp_f32 v100, v100
    v_mfma_f32_16x16x32_bf16 v[116:119], a[156:159], a[236:239], v[116:119]
    buffer_load_dwordx4 v1, s[8:11], s19 offen offset:1024 lds
    v_mfma_f32_16x16x32_bf16 v[124:127], a[144:147], a[240:243], v[76:79]
    v_exp_f32 v101, v101
    v_mfma_f32_16x16x32_bf16 v[124:127], a[148:151], a[244:247], v[124:127]
    ds_read_b128 a[136:139], v18 offset:2048
    v_cvt_pk_bf16_f32 v50, v100, v101
    v_mfma_f32_16x16x32_bf16 v[124:127], a[152:155], a[248:251], v[124:127]
    v_exp_f32 v102, v102
    v_mfma_f32_16x16x32_bf16 v[124:127], a[156:159], a[252:255], v[124:127]
    buffer_load_dwordx4 v1, s[8:11], s19 offen offset:2048 lds
    v_mfma_f32_16x16x32_bf16 v[40:43], v[28:31], v[56:59], v[40:43]
    v_exp_f32 v103, v103
    v_mfma_f32_16x16x32_bf16 v[44:47], v[28:31], v[60:63], v[44:47]
    ds_read_b128 a[140:143], v18 offset:3072
    v_cvt_pk_bf16_f32 v51, v102, v103
    v_mfma_f32_16x16x32_bf16 v[192:195], a[160:163], v[56:59], v[192:195]
    v_exp_f32 v104, v104
    v_mfma_f32_16x16x32_bf16 v[224:227], a[160:163], v[60:63], v[224:227]
    v_mfma_f32_16x16x32_bf16 v[196:199], a[164:167], v[56:59], v[196:199]
    v_exp_f32 v105, v105
    v_mfma_f32_16x16x32_bf16 v[228:231], a[164:167], v[60:63], v[228:231]
    ds_read_b128 a[144:147], v18 offset:4096
    v_cvt_pk_bf16_f32 v52, v104, v105
    v_mfma_f32_16x16x32_bf16 v[200:203], a[168:171], v[56:59], v[200:203]
    v_exp_f32 v106, v106
    v_mfma_f32_16x16x32_bf16 v[232:235], a[168:171], v[60:63], v[232:235]
    buffer_load_dwordx4 v1, s[8:11], s19 offen offset:3072 lds
    v_mfma_f32_16x16x32_bf16 v[204:207], a[172:175], v[56:59], v[204:207]
    s_add_u32 m0, s16, 4096
    v_exp_f32 v107, v107
    v_mfma_f32_16x16x32_bf16 v[236:239], a[172:175], v[60:63], v[236:239]
    ds_read_b128 a[148:151], v18 offset:5120
    v_cvt_pk_bf16_f32 v53, v106, v107
    v_mfma_f32_16x16x32_bf16 v[208:211], a[176:179], v[56:59], v[208:211]
    v_exp_f32 v108, v108
    v_mfma_f32_16x16x32_bf16 v[240:243], a[176:179], v[60:63], v[240:243]
    buffer_load_dwordx4 v15, s[8:11], s19 offen offset:0 lds
    v_mfma_f32_16x16x32_bf16 v[212:215], a[180:183], v[56:59], v[212:215]
    v_exp_f32 v109, v109
    v_mfma_f32_16x16x32_bf16 v[244:247], a[180:183], v[60:63], v[244:247]
    ds_read_b128 a[152:155], v18 offset:6144
    v_cvt_pk_bf16_f32 v54, v108, v109
    v_mfma_f32_16x16x32_bf16 v[216:219], a[184:187], v[56:59], v[216:219]
    v_exp_f32 v110, v110
    v_mfma_f32_16x16x32_bf16 v[248:251], a[184:187], v[60:63], v[248:251]
    buffer_load_dwordx4 v15, s[8:11], s19 offen offset:1024 lds
    v_mfma_f32_16x16x32_bf16 v[220:223], a[188:191], v[56:59], v[220:223]
    v_exp_f32 v111, v111
    v_mfma_f32_16x16x32_bf16 v[252:255], a[188:191], v[60:63], v[252:255]
    ds_read_b128 a[156:159], v18 offset:7168
    v_cvt_pk_bf16_f32 v55, v110, v111
    s_waitcnt lgkmcnt(7)
    v_mfma_f32_16x16x32_bf16 v[96:99], a[128:131], a[192:195], v[64:67]
    s_waitcnt lgkmcnt(6)
    ds_read_b128 a[160:163], v19 offset:16384
    v_add_f32 v93, 0xf1800000, v21
    v_mfma_f32_16x16x32_bf16 v[96:99], a[132:135], a[196:199], v[96:99]
    s_waitcnt lgkmcnt(6)
    ds_read_b128 a[164:167], v19 offset:17408
    v_min_f32 v93, v93, v69
    v_mfma_f32_16x16x32_bf16 v[96:99], a[136:139], a[200:203], v[96:99]
    s_waitcnt lgkmcnt(6)
    v_exp_f32 v112, v112
    v_mfma_f32_16x16x32_bf16 v[96:99], a[140:143], a[204:207], v[96:99]
    buffer_load_dwordx4 v15, s[8:11], s19 offen offset:2048 lds
    v_mfma_f32_16x16x32_bf16 v[104:107], a[128:131], a[208:211], v[68:71]
    v_exp_f32 v113, v113
    v_mfma_f32_16x16x32_bf16 v[104:107], a[132:135], a[212:215], v[104:107]
    ds_read_b128 a[168:171], v19 offset:18432
    v_cvt_pk_bf16_f32 v56, v112, v113
    v_mfma_f32_16x16x32_bf16 v[104:107], a[136:139], a[216:219], v[104:107]
    s_waitcnt lgkmcnt(6)
    v_exp_f32 v114, v114
    v_mfma_f32_16x16x32_bf16 v[104:107], a[140:143], a[220:223], v[104:107]
    buffer_load_dwordx4 v15, s[8:11], s19 offen offset:3072 lds
    v_mfma_f32_16x16x32_bf16 v[100:103], a[144:147], a[192:195], v[64:67]
    s_waitcnt lgkmcnt(5)
    s_xor_b32 s16, s16, 98304
    v_exp_f32 v115, v115
    v_mfma_f32_16x16x32_bf16 v[100:103], a[148:151], a[196:199], v[100:103]
    s_waitcnt lgkmcnt(4)
    s_xor_b32 s74, s24, 28672
    ds_read_b128 a[172:175], v19 offset:19456
    v_cvt_pk_bf16_f32 v57, v114, v115
    v_mfma_f32_16x16x32_bf16 v[100:103], a[152:155], a[200:203], v[100:103]
    s_waitcnt lgkmcnt(4)
    v_exp_f32 v116, v116
    v_mfma_f32_16x16x32_bf16 v[100:103], a[156:159], a[204:207], v[100:103]
    buffer_load_dwordx4 a[48:51], v1, s[8:11], s74 offen offset:0
    v_mfma_f32_16x16x32_bf16 v[108:111], a[144:147], a[208:211], v[68:71]
    s_xor_b32 s74, s24, 28672
    v_exp_f32 v117, v117
    v_mfma_f32_16x16x32_bf16 v[108:111], a[148:151], a[212:215], v[108:111]
    ds_read_b128 a[176:179], v20 offset:20480
    v_cvt_pk_bf16_f32 v58, v116, v117
    v_mfma_f32_16x16x32_bf16 v[108:111], a[152:155], a[216:219], v[108:111]
    v_exp_f32 v118, v118
    v_mfma_f32_16x16x32_bf16 v[108:111], a[156:159], a[220:223], v[108:111]
    buffer_load_dwordx4 a[52:55], v1, s[8:11], s74 offen offset:1024
    v_mfma_f32_16x16x32_bf16 v[32:35], v[28:31], v[48:51], v[32:35]
    s_xor_b32 s74, s24, 28672
    v_exp_f32 v119, v119
    v_mfma_f32_16x16x32_bf16 v[36:39], v[28:31], v[52:55], v[36:39]
    s_waitcnt lgkmcnt(4)
    ds_read_b128 a[180:183], v20 offset:21504
    v_cvt_pk_bf16_f32 v59, v118, v119
    v_mfma_f32_16x16x32_bf16 v[128:131], a[160:163], v[48:51], v[128:131]
    s_waitcnt lgkmcnt(4)
    v_exp_f32 v120, v120
    v_mfma_f32_16x16x32_bf16 v[160:163], a[160:163], v[52:55], v[160:163]
    buffer_load_dwordx4 a[56:59], v1, s[8:11], s74 offen offset:2048
    v_mfma_f32_16x16x32_bf16 v[132:135], a[164:167], v[48:51], v[132:135]
    s_xor_b32 s74, s24, 28672
    v_exp_f32 v121, v121
    v_mfma_f32_16x16x32_bf16 v[164:167], a[164:167], v[52:55], v[164:167]
    s_waitcnt lgkmcnt(3)
    ds_read_b128 a[184:187], v20 offset:22528
    v_cvt_pk_bf16_f32 v60, v120, v121
    v_mfma_f32_16x16x32_bf16 v[136:139], a[168:171], v[48:51], v[136:139]
    s_waitcnt lgkmcnt(3)
    v_exp_f32 v122, v122
    v_mfma_f32_16x16x32_bf16 v[168:171], a[168:171], v[52:55], v[168:171]
    buffer_load_dwordx4 a[60:63], v1, s[8:11], s74 offen offset:3072
    v_mfma_f32_16x16x32_bf16 v[140:143], a[172:175], v[48:51], v[140:143]
    v_exp_f32 v123, v123
    v_mfma_f32_16x16x32_bf16 v[172:175], a[172:175], v[52:55], v[172:175]
    s_waitcnt lgkmcnt(2)
    ds_read_b128 a[188:191], v20 offset:23552
    v_cvt_pk_bf16_f32 v61, v122, v123
    v_mfma_f32_16x16x32_bf16 v[144:147], a[176:179], v[48:51], v[144:147]
    v_exp_f32 v124, v124
    v_mfma_f32_16x16x32_bf16 v[176:179], a[176:179], v[52:55], v[176:179]
    s_waitcnt lgkmcnt(2)
    v_add_f32 v94, 0xf2000000, v21
    v_min_f32 v94, v94, v70
    v_mfma_f32_16x16x32_bf16 v[148:151], a[180:183], v[48:51], v[148:151]
    v_exp_f32 v125, v125
    v_mfma_f32_16x16x32_bf16 v[180:183], a[180:183], v[52:55], v[180:183]
    s_waitcnt lgkmcnt(1)
    v_cvt_pk_bf16_f32 v62, v124, v125
    v_xor_b32 v19, 98304, v19
    v_mfma_f32_16x16x32_bf16 v[152:155], a[184:187], v[48:51], v[152:155]
    v_exp_f32 v126, v126
    v_mfma_f32_16x16x32_bf16 v[184:187], a[184:187], v[52:55], v[184:187]
    s_waitcnt lgkmcnt(0)
    v_xor_b32 v20, 98304, v20
    v_add_f32 v95, 0xf2400000, v21
    v_mfma_f32_16x16x32_bf16 v[156:159], a[188:191], v[48:51], v[156:159]
    v_exp_f32 v127, v127
    v_mfma_f32_16x16x32_bf16 v[188:191], a[188:191], v[52:55], v[188:191]
    v_cvt_pk_bf16_f32 v63, v126, v127
    v_min_f32 v95, v95, v71
    v_mfma_f32_16x16x32_bf16 v[112:115], a[128:131], a[224:227], v[72:75]
    v_exp_f32 v96, v96
    v_mfma_f32_16x16x32_bf16 v[112:115], a[132:135], a[228:231], v[112:115]
    v_mfma_f32_16x16x32_bf16 v[112:115], a[136:139], a[232:235], v[112:115]
    v_exp_f32 v97, v97
    v_mfma_f32_16x16x32_bf16 v[112:115], a[140:143], a[236:239], v[112:115]
    v_cvt_pk_bf16_f32 v48, v96, v97
    v_mfma_f32_16x16x32_bf16 v[120:123], a[128:131], a[240:243], v[76:79]
    v_exp_f32 v98, v98
    v_mfma_f32_16x16x32_bf16 v[120:123], a[132:135], a[244:247], v[120:123]
    v_mfma_f32_16x16x32_bf16 v[120:123], a[136:139], a[248:251], v[120:123]
    v_exp_f32 v99, v99
    v_mfma_f32_16x16x32_bf16 v[120:123], a[140:143], a[252:255], v[120:123]
    v_mfma_f32_16x16x32_bf16 v[116:119], a[144:147], a[224:227], v[72:75]
    v_exp_f32 v100, v100
    v_mfma_f32_16x16x32_bf16 v[116:119], a[148:151], a[228:231], v[116:119]
    ds_read_b128 a[128:131], v18 offset:16384
    v_cvt_pk_bf16_f32 v49, v98, v99
    v_mfma_f32_16x16x32_bf16 v[116:119], a[152:155], a[232:235], v[116:119]
    s_add_u32 s19, s82, 32768
    v_exp_f32 v101, v101
    v_mfma_f32_16x16x32_bf16 v[116:119], a[156:159], a[236:239], v[116:119]
    s_sub_u32 s82, s12, s13
    ds_read_b128 a[132:135], v18 offset:17408
    v_cvt_pk_bf16_f32 v50, v100, v101
    v_mfma_f32_16x16x32_bf16 v[124:127], a[144:147], a[240:243], v[76:79]
    s_sub_u32 s82, s82, 1
    v_exp_f32 v102, v102
    v_mfma_f32_16x16x32_bf16 v[124:127], a[148:151], a[244:247], v[124:127]
    s_cmp_gt_u32 s12, s13
    s_cselect_b32 s82, s82, s12
    s_lshl_b32 s82, s82, 16
    ds_read_b128 a[136:139], v18 offset:18432
    v_mfma_f32_16x16x32_bf16 v[124:127], a[152:155], a[248:251], v[124:127]
    s_add_u32 s82, s82, s81
    v_exp_f32 v103, v103
    v_mfma_f32_16x16x32_bf16 v[124:127], a[156:159], a[252:255], v[124:127]
    s_cmp_ge_u32 s12, 17
    s_cselect_b32 s82, 2147471360, s82
    ds_read_b128 a[140:143], v18 offset:19456
    v_cvt_pk_bf16_f32 v51, v102, v103
    v_mfma_f32_16x16x32_bf16 v[40:43], v[28:31], v[56:59], v[40:43]
    s_add_u32 s12, s12, 1
    v_exp_f32 v104, v104
    v_mfma_f32_16x16x32_bf16 v[44:47], v[28:31], v[60:63], v[44:47]
    ds_read_b128 a[144:147], v18 offset:20480
    v_mfma_f32_16x16x32_bf16 v[192:195], a[160:163], v[56:59], v[192:195]
    v_exp_f32 v105, v105
    v_mfma_f32_16x16x32_bf16 v[224:227], a[160:163], v[60:63], v[224:227]
    ds_read_b128 a[148:151], v18 offset:21504
    v_cvt_pk_bf16_f32 v52, v104, v105
    v_mfma_f32_16x16x32_bf16 v[196:199], a[164:167], v[56:59], v[196:199]
    v_exp_f32 v106, v106
    v_mfma_f32_16x16x32_bf16 v[228:231], a[164:167], v[60:63], v[228:231]
    ds_read_b128 a[152:155], v18 offset:22528
    v_mfma_f32_16x16x32_bf16 v[200:203], a[168:171], v[56:59], v[200:203]
    v_exp_f32 v107, v107
    v_mfma_f32_16x16x32_bf16 v[232:235], a[168:171], v[60:63], v[232:235]
    ds_read_b128 a[156:159], v18 offset:23552
    v_cvt_pk_bf16_f32 v53, v106, v107
    v_mfma_f32_16x16x32_bf16 v[204:207], a[172:175], v[56:59], v[204:207]
    v_exp_f32 v108, v108
    v_mfma_f32_16x16x32_bf16 v[236:239], a[172:175], v[60:63], v[236:239]
    v_mfma_f32_16x16x32_bf16 v[208:211], a[176:179], v[56:59], v[208:211]
    v_exp_f32 v109, v109
    v_mfma_f32_16x16x32_bf16 v[240:243], a[176:179], v[60:63], v[240:243]
    v_cvt_pk_bf16_f32 v54, v108, v109
    v_xor_b32 v18, 196608, v18
    v_mfma_f32_16x16x32_bf16 v[212:215], a[180:183], v[56:59], v[212:215]
    v_exp_f32 v110, v110
    v_mfma_f32_16x16x32_bf16 v[244:247], a[180:183], v[60:63], v[244:247]
    v_mfma_f32_16x16x32_bf16 v[216:219], a[184:187], v[56:59], v[216:219]
    v_exp_f32 v111, v111
    v_mfma_f32_16x16x32_bf16 v[248:251], a[184:187], v[60:63], v[248:251]
    v_cvt_pk_bf16_f32 v55, v110, v111
    v_mfma_f32_16x16x32_bf16 v[220:223], a[188:191], v[56:59], v[220:223]
    v_mfma_f32_16x16x32_bf16 v[252:255], a[188:191], v[60:63], v[252:255]
    s_waitcnt vmcnt(4) lgkmcnt(0)
    s_barrier
    v_mfma_f32_16x16x32_bf16 v[96:99], a[128:131], a[192:195], v[64:67]
    s_add_u32 m0, s15, 0
    ds_read_b128 a[160:163], v19 offset:0
    v_mfma_f32_16x16x32_bf16 v[96:99], a[132:135], a[196:199], v[96:99]
    ds_read_b128 a[164:167], v19 offset:1024
    v_mfma_f32_16x16x32_bf16 v[96:99], a[136:139], a[200:203], v[96:99]
    v_exp_f32 v112, v112
    v_mfma_f32_16x16x32_bf16 v[96:99], a[140:143], a[204:207], v[96:99]
    buffer_load_dwordx4 v1, s[8:11], s82 offen offset:0 lds
    v_mfma_f32_16x16x32_bf16 v[104:107], a[128:131], a[208:211], v[68:71]
    v_exp_f32 v113, v113
    v_mfma_f32_16x16x32_bf16 v[104:107], a[132:135], a[212:215], v[104:107]
    ds_read_b128 a[168:171], v19 offset:2048
    v_cvt_pk_bf16_f32 v56, v112, v113
    v_mfma_f32_16x16x32_bf16 v[104:107], a[136:139], a[216:219], v[104:107]
    v_exp_f32 v114, v114
    v_mfma_f32_16x16x32_bf16 v[104:107], a[140:143], a[220:223], v[104:107]
    buffer_load_dwordx4 v1, s[8:11], s82 offen offset:1024 lds
    v_mfma_f32_16x16x32_bf16 v[100:103], a[144:147], a[192:195], v[64:67]
    v_exp_f32 v115, v115
    v_mfma_f32_16x16x32_bf16 v[100:103], a[148:151], a[196:199], v[100:103]
    ds_read_b128 a[172:175], v19 offset:3072
    v_cvt_pk_bf16_f32 v57, v114, v115
    v_mfma_f32_16x16x32_bf16 v[100:103], a[152:155], a[200:203], v[100:103]
    v_exp_f32 v116, v116
    v_mfma_f32_16x16x32_bf16 v[100:103], a[156:159], a[204:207], v[100:103]
    buffer_load_dwordx4 v1, s[8:11], s82 offen offset:2048 lds
    v_mfma_f32_16x16x32_bf16 v[108:111], a[144:147], a[208:211], v[68:71]
    v_exp_f32 v117, v117
    v_mfma_f32_16x16x32_bf16 v[108:111], a[148:151], a[212:215], v[108:111]
    ds_read_b128 a[176:179], v20 offset:4096
    v_cvt_pk_bf16_f32 v58, v116, v117
    v_mfma_f32_16x16x32_bf16 v[108:111], a[152:155], a[216:219], v[108:111]
    v_exp_f32 v118, v118
    v_mfma_f32_16x16x32_bf16 v[108:111], a[156:159], a[220:223], v[108:111]
    buffer_load_dwordx4 v1, s[8:11], s82 offen offset:3072 lds
    v_mfma_f32_16x16x32_bf16 v[32:35], v[28:31], v[48:51], v[32:35]
    s_add_u32 m0, s15, 4096
    v_exp_f32 v119, v119
    v_mfma_f32_16x16x32_bf16 v[36:39], v[28:31], v[52:55], v[36:39]
    s_waitcnt lgkmcnt(4)
    ds_read_b128 a[180:183], v20 offset:5120
    v_cvt_pk_bf16_f32 v59, v118, v119
    v_mfma_f32_16x16x32_bf16 v[128:131], a[160:163], v[48:51], v[128:131]
    v_exp_f32 v120, v120
    v_mfma_f32_16x16x32_bf16 v[160:163], a[160:163], v[52:55], v[160:163]
    s_waitcnt lgkmcnt(4)
    v_mfma_f32_16x16x32_bf16 v[132:135], a[164:167], v[48:51], v[132:135]
    v_exp_f32 v121, v121
    v_mfma_f32_16x16x32_bf16 v[164:167], a[164:167], v[52:55], v[164:167]
    s_waitcnt lgkmcnt(3)
    ds_read_b128 a[184:187], v20 offset:6144
    v_cvt_pk_bf16_f32 v60, v120, v121
    v_mfma_f32_16x16x32_bf16 v[136:139], a[168:171], v[48:51], v[136:139]
    s_waitcnt lgkmcnt(3)
    v_exp_f32 v122, v122
    v_mfma_f32_16x16x32_bf16 v[168:171], a[168:171], v[52:55], v[168:171]
    buffer_load_dwordx4 v15, s[8:11], s82 offen offset:0 lds
    v_mfma_f32_16x16x32_bf16 v[140:143], a[172:175], v[48:51], v[140:143]
    v_exp_f32 v123, v123
    v_mfma_f32_16x16x32_bf16 v[172:175], a[172:175], v[52:55], v[172:175]
    s_waitcnt lgkmcnt(2)
    ds_read_b128 a[188:191], v20 offset:7168
    v_cvt_pk_bf16_f32 v61, v122, v123
    v_mfma_f32_16x16x32_bf16 v[144:147], a[176:179], v[48:51], v[144:147]
    s_waitcnt lgkmcnt(2)
    v_exp_f32 v124, v124
    v_mfma_f32_16x16x32_bf16 v[176:179], a[176:179], v[52:55], v[176:179]
    buffer_load_dwordx4 v15, s[8:11], s82 offen offset:1024 lds
    v_mfma_f32_16x16x32_bf16 v[148:151], a[180:183], v[48:51], v[148:151]
    v_exp_f32 v125, v125
    v_mfma_f32_16x16x32_bf16 v[180:183], a[180:183], v[52:55], v[180:183]
    s_waitcnt lgkmcnt(1)
    v_cvt_pk_bf16_f32 v62, v124, v125
    v_mfma_f32_16x16x32_bf16 v[152:155], a[184:187], v[48:51], v[152:155]
    s_waitcnt lgkmcnt(0)
    v_exp_f32 v126, v126
    v_mfma_f32_16x16x32_bf16 v[184:187], a[184:187], v[52:55], v[184:187]
    buffer_load_dwordx4 v15, s[8:11], s82 offen offset:2048 lds
    v_mfma_f32_16x16x32_bf16 v[156:159], a[188:191], v[48:51], v[156:159]
    v_exp_f32 v127, v127
    v_mfma_f32_16x16x32_bf16 v[188:191], a[188:191], v[52:55], v[188:191]
    v_cvt_pk_bf16_f32 v63, v126, v127
    v_mfma_f32_16x16x32_bf16 v[112:115], a[128:131], a[224:227], v[72:75]
    v_mfma_f32_16x16x32_bf16 v[112:115], a[132:135], a[228:231], v[112:115]
    v_mfma_f32_16x16x32_bf16 v[112:115], a[136:139], a[232:235], v[112:115]
    v_exp_f32 v96, v96
    v_mfma_f32_16x16x32_bf16 v[112:115], a[140:143], a[236:239], v[112:115]
    buffer_load_dwordx4 v15, s[8:11], s82 offen offset:3072 lds
    v_mfma_f32_16x16x32_bf16 v[120:123], a[128:131], a[240:243], v[76:79]
    s_xor_b32 s15, s15, 196608
    v_exp_f32 v97, v97
    v_mfma_f32_16x16x32_bf16 v[120:123], a[132:135], a[244:247], v[120:123]
    s_add_u32 m0, s16, 0
    ds_read_b128 a[128:131], v18 offset:0
    v_cvt_pk_bf16_f32 v48, v96, v97
    v_mfma_f32_16x16x32_bf16 v[120:123], a[136:139], a[248:251], v[120:123]
    v_exp_f32 v98, v98
    v_mfma_f32_16x16x32_bf16 v[120:123], a[140:143], a[252:255], v[120:123]
    buffer_load_dwordx4 v1, s[8:11], s19 offen offset:0 lds
    v_mfma_f32_16x16x32_bf16 v[116:119], a[144:147], a[224:227], v[72:75]
    v_exp_f32 v99, v99
    v_mfma_f32_16x16x32_bf16 v[116:119], a[148:151], a[228:231], v[116:119]
    ds_read_b128 a[132:135], v18 offset:1024
    v_cvt_pk_bf16_f32 v49, v98, v99
    v_mfma_f32_16x16x32_bf16 v[116:119], a[152:155], a[232:235], v[116:119]
    v_exp_f32 v100, v100
    v_mfma_f32_16x16x32_bf16 v[116:119], a[156:159], a[236:239], v[116:119]
    buffer_load_dwordx4 v1, s[8:11], s19 offen offset:1024 lds
    v_mfma_f32_16x16x32_bf16 v[124:127], a[144:147], a[240:243], v[76:79]
    v_exp_f32 v101, v101
    v_mfma_f32_16x16x32_bf16 v[124:127], a[148:151], a[244:247], v[124:127]
    ds_read_b128 a[136:139], v18 offset:2048
    v_cvt_pk_bf16_f32 v50, v100, v101
    v_mfma_f32_16x16x32_bf16 v[124:127], a[152:155], a[248:251], v[124:127]
    v_exp_f32 v102, v102
    v_mfma_f32_16x16x32_bf16 v[124:127], a[156:159], a[252:255], v[124:127]
    buffer_load_dwordx4 v1, s[8:11], s19 offen offset:2048 lds
    v_mfma_f32_16x16x32_bf16 v[40:43], v[28:31], v[56:59], v[40:43]
    v_exp_f32 v103, v103
    v_mfma_f32_16x16x32_bf16 v[44:47], v[28:31], v[60:63], v[44:47]
    ds_read_b128 a[140:143], v18 offset:3072
    v_cvt_pk_bf16_f32 v51, v102, v103
    v_mfma_f32_16x16x32_bf16 v[192:195], a[160:163], v[56:59], v[192:195]
    v_exp_f32 v104, v104
    v_mfma_f32_16x16x32_bf16 v[224:227], a[160:163], v[60:63], v[224:227]
    v_mfma_f32_16x16x32_bf16 v[196:199], a[164:167], v[56:59], v[196:199]
    v_exp_f32 v105, v105
    v_mfma_f32_16x16x32_bf16 v[228:231], a[164:167], v[60:63], v[228:231]
    ds_read_b128 a[144:147], v18 offset:4096
    v_cvt_pk_bf16_f32 v52, v104, v105
    v_mfma_f32_16x16x32_bf16 v[200:203], a[168:171], v[56:59], v[200:203]
    v_exp_f32 v106, v106
    v_mfma_f32_16x16x32_bf16 v[232:235], a[168:171], v[60:63], v[232:235]
    buffer_load_dwordx4 v1, s[8:11], s19 offen offset:3072 lds
    v_mfma_f32_16x16x32_bf16 v[204:207], a[172:175], v[56:59], v[204:207]
    s_add_u32 m0, s16, 4096
    v_exp_f32 v107, v107
    v_mfma_f32_16x16x32_bf16 v[236:239], a[172:175], v[60:63], v[236:239]
    ds_read_b128 a[148:151], v18 offset:5120
    v_cvt_pk_bf16_f32 v53, v106, v107
    v_mfma_f32_16x16x32_bf16 v[208:211], a[176:179], v[56:59], v[208:211]
    v_exp_f32 v108, v108
    v_mfma_f32_16x16x32_bf16 v[240:243], a[176:179], v[60:63], v[240:243]
    buffer_load_dwordx4 v15, s[8:11], s19 offen offset:0 lds
    v_mfma_f32_16x16x32_bf16 v[212:215], a[180:183], v[56:59], v[212:215]
    v_exp_f32 v109, v109
    v_mfma_f32_16x16x32_bf16 v[244:247], a[180:183], v[60:63], v[244:247]
    ds_read_b128 a[152:155], v18 offset:6144
    v_cvt_pk_bf16_f32 v54, v108, v109
    v_mfma_f32_16x16x32_bf16 v[216:219], a[184:187], v[56:59], v[216:219]
    v_exp_f32 v110, v110
    v_mfma_f32_16x16x32_bf16 v[248:251], a[184:187], v[60:63], v[248:251]
    buffer_load_dwordx4 v15, s[8:11], s19 offen offset:1024 lds
    v_mfma_f32_16x16x32_bf16 v[220:223], a[188:191], v[56:59], v[220:223]
    v_exp_f32 v111, v111
    v_mfma_f32_16x16x32_bf16 v[252:255], a[188:191], v[60:63], v[252:255]
    ds_read_b128 a[156:159], v18 offset:7168
    v_cvt_pk_bf16_f32 v55, v110, v111
    s_cmp_eq_u32 s14, 0
    s_cbranch_scc1 L_t2_diag
.p2align 3
L_t2_loop:
    s_waitcnt lgkmcnt(7)
    v_mfma_f32_16x16x32_bf16 v[96:99], a[128:131], a[192:195], v[64:67]
    s_waitcnt lgkmcnt(6)
    ds_read_b128 a[160:163], v19 offset:16384
    v_mfma_f32_16x16x32_bf16 v[96:99], a[132:135], a[196:199], v[96:99]
    s_waitcnt lgkmcnt(6)
    ds_read_b128 a[164:167], v19 offset:17408
    v_mfma_f32_16x16x32_bf16 v[96:99], a[136:139], a[200:203], v[96:99]
    s_waitcnt lgkmcnt(6)
    v_exp_f32 v112, v112
    v_mfma_f32_16x16x32_bf16 v[96:99], a[140:143], a[204:207], v[96:99]
    buffer_load_dwordx4 v15, s[8:11], s19 offen offset:2048 lds
    v_mfma_f32_16x16x32_bf16 v[104:107], a[128:131], a[208:211], v[68:71]
    v_exp_f32 v113, v113
    v_mfma_f32_16x16x32_bf16 v[104:107], a[132:135], a[212:215], v[104:107]
    ds_read_b128 a[168:171], v19 offset:18432
    v_cvt_pk_bf16_f32 v56, v112, v113
    v_mfma_f32_16x16x32_bf16 v[104:107], a[136:139], a[216:219], v[104:107]
    s_waitcnt lgkmcnt(6)
    v_exp_f32 v114, v114
    v_mfma_f32_16x16x32_bf16 v[104:107], a[140:143], a[220:223], v[104:107]
    buffer_load_dwordx4 v15, s[8:11], s19 offen offset:3072 lds
    v_mfma_f32_16x16x32_bf16 v[100:103], a[144:147], a[192:195], v[64:67]
    s_waitcnt lgkmcnt(5)
    s_xor_b32 s16, s16, 98304
    v_exp_f32 v115, v115
    v_mfma_f32_16x16x32_bf16 v[100:103], a[148:151], a[196:199], v[100:103]
    s_waitcnt lgkmcnt(4)
    ds_read_b128 a[172:175], v19 offset:19456
    v_cvt_pk_bf16_f32 v57, v114, v115
    v_mfma_f32_16x16x32_bf16 v[100:103], a[152:155], a[200:203], v[100:103]
    s_waitcnt lgkmcnt(4)
    v_exp_f32 v116, v116
    v_mfma_f32_16x16x32_bf16 v[100:103], a[156:159], a[204:207], v[100:103]
    v_mfma_f32_16x16x32_bf16 v[108:111], a[144:147], a[208:211], v[68:71]
    v_exp_f32 v117, v117
    v_mfma_f32_16x16x32_bf16 v[108:111], a[148:151], a[212:215], v[108:111]
    ds_read_b128 a[176:179], v20 offset:20480
    v_cvt_pk_bf16_f32 v58, v116, v117
    v_mfma_f32_16x16x32_bf16 v[108:111], a[152:155], a[216:219], v[108:111]
    v_exp_f32 v118, v118
    v_mfma_f32_16x16x32_bf16 v[108:111], a[156:159], a[220:223], v[108:111]
    v_mfma_f32_16x16x32_bf16 v[32:35], v[28:31], v[48:51], v[32:35]
    v_exp_f32 v119, v119
    v_mfma_f32_16x16x32_bf16 v[36:39], v[28:31], v[52:55], v[36:39]
    s_waitcnt lgkmcnt(4)
    ds_read_b128 a[180:183], v20 offset:21504
    v_cvt_pk_bf16_f32 v59, v118, v119
    v_mfma_f32_16x16x32_bf16 v[128:131], a[160:163], v[48:51], v[128:131]
    v_exp_f32 v120, v120
    v_mfma_f32_16x16x32_bf16 v[160:163], a[160:163], v[52:55], v[160:163]
    s_waitcnt lgkmcnt(4)
    v_mfma_f32_16x16x32_bf16 v[132:135], a[164:167], v[48:51], v[132:135]
    v_exp_f32 v121, v121
    v_mfma_f32_16x16x32_bf16 v[164:167], a[164:167], v[52:55], v[164:167]
    s_waitcnt lgkmcnt(3)
    ds_read_b128 a[184:187], v20 offset:22528
    v_cvt_pk_bf16_f32 v60, v120, v121
    v_mfma_f32_16x16x32_bf16 v[136:139], a[168:171], v[48:51], v[136:139]
    v_exp_f32 v122, v122
    v_mfma_f32_16x16x32_bf16 v[168:171], a[168:171], v[52:55], v[168:171]
    s_waitcnt lgkmcnt(3)
    v_mfma_f32_16x16x32_bf16 v[140:143], a[172:175], v[48:51], v[140:143]
    v_exp_f32 v123, v123
    v_mfma_f32_16x16x32_bf16 v[172:175], a[172:175], v[52:55], v[172:175]
    s_waitcnt lgkmcnt(2)
    ds_read_b128 a[188:191], v20 offset:23552
    v_cvt_pk_bf16_f32 v61, v122, v123
    v_mfma_f32_16x16x32_bf16 v[144:147], a[176:179], v[48:51], v[144:147]
    v_exp_f32 v124, v124
    v_mfma_f32_16x16x32_bf16 v[176:179], a[176:179], v[52:55], v[176:179]
    s_waitcnt lgkmcnt(2)
    v_mfma_f32_16x16x32_bf16 v[148:151], a[180:183], v[48:51], v[148:151]
    v_exp_f32 v125, v125
    v_mfma_f32_16x16x32_bf16 v[180:183], a[180:183], v[52:55], v[180:183]
    s_waitcnt lgkmcnt(1)
    v_cvt_pk_bf16_f32 v62, v124, v125
    v_xor_b32 v19, 98304, v19
    v_mfma_f32_16x16x32_bf16 v[152:155], a[184:187], v[48:51], v[152:155]
    v_exp_f32 v126, v126
    v_mfma_f32_16x16x32_bf16 v[184:187], a[184:187], v[52:55], v[184:187]
    s_waitcnt lgkmcnt(0)
    v_xor_b32 v20, 98304, v20
    v_mfma_f32_16x16x32_bf16 v[156:159], a[188:191], v[48:51], v[156:159]
    v_exp_f32 v127, v127
    v_mfma_f32_16x16x32_bf16 v[188:191], a[188:191], v[52:55], v[188:191]
    v_cvt_pk_bf16_f32 v63, v126, v127
    v_mfma_f32_16x16x32_bf16 v[112:115], a[128:131], a[224:227], v[72:75]
    v_exp_f32 v96, v96
    v_mfma_f32_16x16x32_bf16 v[112:115], a[132:135], a[228:231], v[112:115]
    v_mfma_f32_16x16x32_bf16 v[112:115], a[136:139], a[232:235], v[112:115]
    v_exp_f32 v97, v97
    v_mfma_f32_16x16x32_bf16 v[112:115], a[140:143], a[236:239], v[112:115]
    v_cvt_pk_bf16_f32 v48, v96, v97
    v_mfma_f32_16x16x32_bf16 v[120:123], a[128:131], a[240:243], v[76:79]
    v_exp_f32 v98, v98
    v_mfma_f32_16x16x32_bf16 v[120:123], a[132:135], a[244:247], v[120:123]
    v_mfma_f32_16x16x32_bf16 v[120:123], a[136:139], a[248:251], v[120:123]
    v_exp_f32 v99, v99
    v_mfma_f32_16x16x32_bf16 v[120:123], a[140:143], a[252:255], v[120:123]
    v_mfma_f32_16x16x32_bf16 v[116:119], a[144:147], a[224:227], v[72:75]
    v_exp_f32 v100, v100
    v_mfma_f32_16x16x32_bf16 v[116:119], a[148:151], a[228:231], v[116:119]
    ds_read_b128 a[128:131], v18 offset:16384
    v_cvt_pk_bf16_f32 v49, v98, v99
    v_mfma_f32_16x16x32_bf16 v[116:119], a[152:155], a[232:235], v[116:119]
    s_add_u32 s19, s82, 32768
    v_exp_f32 v101, v101
    v_mfma_f32_16x16x32_bf16 v[116:119], a[156:159], a[236:239], v[116:119]
    s_sub_u32 s82, s12, s13
    ds_read_b128 a[132:135], v18 offset:17408
    v_cvt_pk_bf16_f32 v50, v100, v101
    v_mfma_f32_16x16x32_bf16 v[124:127], a[144:147], a[240:243], v[76:79]
    s_sub_u32 s82, s82, 1
    v_exp_f32 v102, v102
    v_mfma_f32_16x16x32_bf16 v[124:127], a[148:151], a[244:247], v[124:127]
    s_cmp_gt_u32 s12, s13
    s_cselect_b32 s82, s82, s12
    s_lshl_b32 s82, s82, 16
    ds_read_b128 a[136:139], v18 offset:18432
    v_mfma_f32_16x16x32_bf16 v[124:127], a[152:155], a[248:251], v[124:127]
    s_add_u32 s82, s82, s81
    v_exp_f32 v103, v103
    v_mfma_f32_16x16x32_bf16 v[124:127], a[156:159], a[252:255], v[124:127]
    s_cmp_ge_u32 s12, 17
    s_cselect_b32 s82, 2147471360, s82
    ds_read_b128 a[140:143], v18 offset:19456
    v_cvt_pk_bf16_f32 v51, v102, v103
    v_mfma_f32_16x16x32_bf16 v[40:43], v[28:31], v[56:59], v[40:43]
    s_add_u32 s12, s12, 1
    v_exp_f32 v104, v104
    v_mfma_f32_16x16x32_bf16 v[44:47], v[28:31], v[60:63], v[44:47]
    ds_read_b128 a[144:147], v18 offset:20480
    v_mfma_f32_16x16x32_bf16 v[192:195], a[160:163], v[56:59], v[192:195]
    v_exp_f32 v105, v105
    v_mfma_f32_16x16x32_bf16 v[224:227], a[160:163], v[60:63], v[224:227]
    ds_read_b128 a[148:151], v18 offset:21504
    v_cvt_pk_bf16_f32 v52, v104, v105
    v_mfma_f32_16x16x32_bf16 v[196:199], a[164:167], v[56:59], v[196:199]
    v_exp_f32 v106, v106
    v_mfma_f32_16x16x32_bf16 v[228:231], a[164:167], v[60:63], v[228:231]
    ds_read_b128 a[152:155], v18 offset:22528
    v_mfma_f32_16x16x32_bf16 v[200:203], a[168:171], v[56:59], v[200:203]
    v_exp_f32 v107, v107
    v_mfma_f32_16x16x32_bf16 v[232:235], a[168:171], v[60:63], v[232:235]
    ds_read_b128 a[156:159], v18 offset:23552
    v_cvt_pk_bf16_f32 v53, v106, v107
    v_mfma_f32_16x16x32_bf16 v[204:207], a[172:175], v[56:59], v[204:207]
    v_exp_f32 v108, v108
    v_mfma_f32_16x16x32_bf16 v[236:239], a[172:175], v[60:63], v[236:239]
    v_mfma_f32_16x16x32_bf16 v[208:211], a[176:179], v[56:59], v[208:211]
    v_exp_f32 v109, v109
    v_mfma_f32_16x16x32_bf16 v[240:243], a[176:179], v[60:63], v[240:243]
    v_cvt_pk_bf16_f32 v54, v108, v109
    v_xor_b32 v18, 196608, v18
    v_mfma_f32_16x16x32_bf16 v[212:215], a[180:183], v[56:59], v[212:215]
    v_exp_f32 v110, v110
    v_mfma_f32_16x16x32_bf16 v[244:247], a[180:183], v[60:63], v[244:247]
    v_mfma_f32_16x16x32_bf16 v[216:219], a[184:187], v[56:59], v[216:219]
    v_exp_f32 v111, v111
    v_mfma_f32_16x16x32_bf16 v[248:251], a[184:187], v[60:63], v[248:251]
    v_cvt_pk_bf16_f32 v55, v110, v111
    v_mfma_f32_16x16x32_bf16 v[220:223], a[188:191], v[56:59], v[220:223]
    v_mfma_f32_16x16x32_bf16 v[252:255], a[188:191], v[60:63], v[252:255]
    s_waitcnt vmcnt(0) lgkmcnt(0)
    s_barrier
    v_mfma_f32_16x16x32_bf16 v[96:99], a[128:131], a[192:195], v[64:67]
    s_add_u32 m0, s15, 0
    ds_read_b128 a[160:163], v19 offset:0
    v_mfma_f32_16x16x32_bf16 v[96:99], a[132:135], a[196:199], v[96:99]
    ds_read_b128 a[164:167], v19 offset:1024
    v_mfma_f32_16x16x32_bf16 v[96:99], a[136:139], a[200:203], v[96:99]
    v_exp_f32 v112, v112
    v_mfma_f32_16x16x32_bf16 v[96:99], a[140:143], a[204:207], v[96:99]
    buffer_load_dwordx4 v1, s[8:11], s82 offen offset:0 lds
    v_mfma_f32_16x16x32_bf16 v[104:107], a[128:131], a[208:211], v[68:71]
    v_exp_f32 v113, v113
    v_mfma_f32_16x16x32_bf16 v[104:107], a[132:135], a[212:215], v[104:107]
    ds_read_b128 a[168:171], v19 offset:2048
    v_cvt_pk_bf16_f32 v56, v112, v113
    v_mfma_f32_16x16x32_bf16 v[104:107], a[136:139], a[216:219], v[104:107]
    v_exp_f32 v114, v114
    v_mfma_f32_16x16x32_bf16 v[104:107], a[140:143], a[220:223], v[104:107]
    buffer_load_dwordx4 v1, s[8:11], s82 offen offset:1024 lds
    v_mfma_f32_16x16x32_bf16 v[100:103], a[144:147], a[192:195], v[64:67]
    v_exp_f32 v115, v115
    v_mfma_f32_16x16x32_bf16 v[100:103], a[148:151], a[196:199], v[100:103]
    ds_read_b128 a[172:175], v19 offset:3072
    v_cvt_pk_bf16_f32 v57, v114, v115
    v_mfma_f32_16x16x32_bf16 v[100:103], a[152:155], a[200:203], v[100:103]
    v_exp_f32 v116, v116
    v_mfma_f32_16x16x32_bf16 v[100:103], a[156:159], a[204:207], v[100:103]
    buffer_load_dwordx4 v1, s[8:11], s82 offen offset:2048 lds
    v_mfma_f32_16x16x32_bf16 v[108:111], a[144:147], a[208:211], v[68:71]
    v_exp_f32 v117, v117
    v_mfma_f32_16x16x32_bf16 v[108:111], a[148:151], a[212:215], v[108:111]
    ds_read_b128 a[176:179], v20 offset:4096
    v_cvt_pk_bf16_f32 v58, v116, v117
    v_mfma_f32_16x16x32_bf16 v[108:111], a[152:155], a[216:219], v[108:111]
    v_exp_f32 v118, v118
    v_mfma_f32_16x16x32_bf16 v[108:111], a[156:159], a[220:223], v[108:111]
    buffer_load_dwordx4 v1, s[8:11], s82 offen offset:3072 lds
    v_mfma_f32_16x16x32_bf16 v[32:35], v[28:31], v[48:51], v[32:35]
    s_add_u32 m0, s15, 4096
    v_exp_f32 v119, v119
    v_mfma_f32_16x16x32_bf16 v[36:39], v[28:31], v[52:55], v[36:39]
    s_waitcnt lgkmcnt(4)
    ds_read_b128 a[180:183], v20 offset:5120
    v_cvt_pk_bf16_f32 v59, v118, v119
    v_mfma_f32_16x16x32_bf16 v[128:131], a[160:163], v[48:51], v[128:131]
    v_exp_f32 v120, v120
    v_mfma_f32_16x16x32_bf16 v[160:163], a[160:163], v[52:55], v[160:163]
    s_waitcnt lgkmcnt(4)
    v_mfma_f32_16x16x32_bf16 v[132:135], a[164:167], v[48:51], v[132:135]
    v_exp_f32 v121, v121
    v_mfma_f32_16x16x32_bf16 v[164:167], a[164:167], v[52:55], v[164:167]
    s_waitcnt lgkmcnt(3)
    ds_read_b128 a[184:187], v20 offset:6144
    v_cvt_pk_bf16_f32 v60, v120, v121
    v_mfma_f32_16x16x32_bf16 v[136:139], a[168:171], v[48:51], v[136:139]
    s_waitcnt lgkmcnt(3)
    v_exp_f32 v122, v122
    v_mfma_f32_16x16x32_bf16 v[168:171], a[168:171], v[52:55], v[168:171]
    buffer_load_dwordx4 v15, s[8:11], s82 offen offset:0 lds
    v_mfma_f32_16x16x32_bf16 v[140:143], a[172:175], v[48:51], v[140:143]
    v_exp_f32 v123, v123
    v_mfma_f32_16x16x32_bf16 v[172:175], a[172:175], v[52:55], v[172:175]
    s_waitcnt lgkmcnt(2)
    ds_read_b128 a[188:191], v20 offset:7168
    v_cvt_pk_bf16_f32 v61, v122, v123
    v_mfma_f32_16x16x32_bf16 v[144:147], a[176:179], v[48:51], v[144:147]
    s_waitcnt lgkmcnt(2)
    v_exp_f32 v124, v124
    v_mfma_f32_16x16x32_bf16 v[176:179], a[176:179], v[52:55], v[176:179]
    buffer_load_dwordx4 v15, s[8:11], s82 offen offset:1024 lds
    v_mfma_f32_16x16x32_bf16 v[148:151], a[180:183], v[48:51], v[148:151]
    v_exp_f32 v125, v125
    v_mfma_f32_16x16x32_bf16 v[180:183], a[180:183], v[52:55], v[180:183]
    s_waitcnt lgkmcnt(1)
    v_cvt_pk_bf16_f32 v62, v124, v125
    v_mfma_f32_16x16x32_bf16 v[152:155], a[184:187], v[48:51], v[152:155]
    s_waitcnt lgkmcnt(0)
    v_exp_f32 v126, v126
    v_mfma_f32_16x16x32_bf16 v[184:187], a[184:187], v[52:55], v[184:187]
    buffer_load_dwordx4 v15, s[8:11], s82 offen offset:2048 lds
    v_mfma_f32_16x16x32_bf16 v[156:159], a[188:191], v[48:51], v[156:159]
    v_exp_f32 v127, v127
    v_mfma_f32_16x16x32_bf16 v[188:191], a[188:191], v[52:55], v[188:191]
    v_cvt_pk_bf16_f32 v63, v126, v127
    v_mfma_f32_16x16x32_bf16 v[112:115], a[128:131], a[224:227], v[72:75]
    v_mfma_f32_16x16x32_bf16 v[112:115], a[132:135], a[228:231], v[112:115]
    v_mfma_f32_16x16x32_bf16 v[112:115], a[136:139], a[232:235], v[112:115]
    v_exp_f32 v96, v96
    v_mfma_f32_16x16x32_bf16 v[112:115], a[140:143], a[236:239], v[112:115]
    buffer_load_dwordx4 v15, s[8:11], s82 offen offset:3072 lds
    v_mfma_f32_16x16x32_bf16 v[120:123], a[128:131], a[240:243], v[76:79]
    s_xor_b32 s15, s15, 196608
    v_exp_f32 v97, v97
    v_mfma_f32_16x16x32_bf16 v[120:123], a[132:135], a[244:247], v[120:123]
    s_add_u32 m0, s16, 0
    ds_read_b128 a[128:131], v18 offset:0
    v_cvt_pk_bf16_f32 v48, v96, v97
    v_mfma_f32_16x16x32_bf16 v[120:123], a[136:139], a[248:251], v[120:123]
    v_exp_f32 v98, v98
    v_mfma_f32_16x16x32_bf16 v[120:123], a[140:143], a[252:255], v[120:123]
    buffer_load_dwordx4 v1, s[8:11], s19 offen offset:0 lds
    v_mfma_f32_16x16x32_bf16 v[116:119], a[144:147], a[224:227], v[72:75]
    v_exp_f32 v99, v99
    v_mfma_f32_16x16x32_bf16 v[116:119], a[148:151], a[228:231], v[116:119]
    ds_read_b128 a[132:135], v18 offset:1024
    v_cvt_pk_bf16_f32 v49, v98, v99
    v_mfma_f32_16x16x32_bf16 v[116:119], a[152:155], a[232:235], v[116:119]
    v_exp_f32 v100, v100
    v_mfma_f32_16x16x32_bf16 v[116:119], a[156:159], a[236:239], v[116:119]
    buffer_load_dwordx4 v1, s[8:11], s19 offen offset:1024 lds
    v_mfma_f32_16x16x32_bf16 v[124:127], a[144:147], a[240:243], v[76:79]
    v_exp_f32 v101, v101
    v_mfma_f32_16x16x32_bf16 v[124:127], a[148:151], a[244:247], v[124:127]
    ds_read_b128 a[136:139], v18 offset:2048
    v_cvt_pk_bf16_f32 v50, v100, v101
    v_mfma_f32_16x16x32_bf16 v[124:127], a[152:155], a[248:251], v[124:127]
    v_exp_f32 v102, v102
    v_mfma_f32_16x16x32_bf16 v[124:127], a[156:159], a[252:255], v[124:127]
    buffer_load_dwordx4 v1, s[8:11], s19 offen offset:2048 lds
    v_mfma_f32_16x16x32_bf16 v[40:43], v[28:31], v[56:59], v[40:43]
    v_exp_f32 v103, v103
    v_mfma_f32_16x16x32_bf16 v[44:47], v[28:31], v[60:63], v[44:47]
    ds_read_b128 a[140:143], v18 offset:3072
    v_cvt_pk_bf16_f32 v51, v102, v103
    v_mfma_f32_16x16x32_bf16 v[192:195], a[160:163], v[56:59], v[192:195]
    v_exp_f32 v104, v104
    v_mfma_f32_16x16x32_bf16 v[224:227], a[160:163], v[60:63], v[224:227]
    v_mfma_f32_16x16x32_bf16 v[196:199], a[164:167], v[56:59], v[196:199]
    v_exp_f32 v105, v105
    v_mfma_f32_16x16x32_bf16 v[228:231], a[164:167], v[60:63], v[228:231]
    ds_read_b128 a[144:147], v18 offset:4096
    v_cvt_pk_bf16_f32 v52, v104, v105
    v_mfma_f32_16x16x32_bf16 v[200:203], a[168:171], v[56:59], v[200:203]
    v_exp_f32 v106, v106
    v_mfma_f32_16x16x32_bf16 v[232:235], a[168:171], v[60:63], v[232:235]
    buffer_load_dwordx4 v1, s[8:11], s19 offen offset:3072 lds
    v_mfma_f32_16x16x32_bf16 v[204:207], a[172:175], v[56:59], v[204:207]
    s_add_u32 m0, s16, 4096
    v_exp_f32 v107, v107
    v_mfma_f32_16x16x32_bf16 v[236:239], a[172:175], v[60:63], v[236:239]
    ds_read_b128 a[148:151], v18 offset:5120
    v_cvt_pk_bf16_f32 v53, v106, v107
    v_mfma_f32_16x16x32_bf16 v[208:211], a[176:179], v[56:59], v[208:211]
    s_sub_u32 s14, s14, 1
    v_exp_f32 v108, v108
    v_mfma_f32_16x16x32_bf16 v[240:243], a[176:179], v[60:63], v[240:243]
    buffer_load_dwordx4 v15, s[8:11], s19 offen offset:0 lds
    v_mfma_f32_16x16x32_bf16 v[212:215], a[180:183], v[56:59], v[212:215]
    v_exp_f32 v109, v109
    v_mfma_f32_16x16x32_bf16 v[244:247], a[180:183], v[60:63], v[244:247]
    ds_read_b128 a[152:155], v18 offset:6144
    v_cvt_pk_bf16_f32 v54, v108, v109
    v_mfma_f32_16x16x32_bf16 v[216:219], a[184:187], v[56:59], v[216:219]
    v_exp_f32 v110, v110
    v_mfma_f32_16x16x32_bf16 v[248:251], a[184:187], v[60:63], v[248:251]
    buffer_load_dwordx4 v15, s[8:11], s19 offen offset:1024 lds
    v_mfma_f32_16x16x32_bf16 v[220:223], a[188:191], v[56:59], v[220:223]
    v_exp_f32 v111, v111
    v_mfma_f32_16x16x32_bf16 v[252:255], a[188:191], v[60:63], v[252:255]
    ds_read_b128 a[156:159], v18 offset:7168
    v_cvt_pk_bf16_f32 v55, v110, v111
    s_cmp_lg_u32 s14, 0
    s_cbranch_scc1 L_t2_loop
L_t2_diag:
    s_waitcnt lgkmcnt(7)
    v_mfma_f32_16x16x32_bf16 v[96:99], a[128:131], a[192:195], v[80:83]
    s_waitcnt lgkmcnt(6)
    ds_read_b128 a[160:163], v19 offset:16384
    v_mov_b32 v24, v8
    v_mov_b32 v25, v9
    v_mfma_f32_16x16x32_bf16 v[96:99], a[132:135], a[196:199], v[96:99]
    s_waitcnt lgkmcnt(6)
    ds_read_b128 a[164:167], v19 offset:17408
    v_mov_b32 v26, v10
    v_mov_b32 v27, v11
    v_mfma_f32_16x16x32_bf16 v[96:99], a[136:139], a[200:203], v[96:99]
    s_waitcnt lgkmcnt(6)
    v_exp_f32 v112, v112
    v_add_u32 v11, 131072, v16
    v_mfma_f32_16x16x32_bf16 v[96:99], a[140:143], a[204:207], v[96:99]
    buffer_load_dwordx4 v15, s[8:11], s19 offen offset:2048 lds
    v_lshlrev_b32 v12, 6, v0
    v_mfma_f32_16x16x32_bf16 v[104:107], a[128:131], a[208:211], v[88:91]
    s_mov_b32 s71, 1327104
    v_exp_f32 v113, v113
    v_mfma_f32_16x16x32_bf16 v[104:107], a[132:135], a[212:215], v[104:107]
    ds_read_b128 a[168:171], v19 offset:18432
    v_cvt_pk_bf16_f32 v56, v112, v113
    v_mfma_f32_16x16x32_bf16 v[104:107], a[136:139], a[216:219], v[104:107]
    s_waitcnt lgkmcnt(6)
    v_exp_f32 v114, v114
    v_mfma_f32_16x16x32_bf16 v[104:107], a[140:143], a[220:223], v[104:107]
    buffer_load_dwordx4 v15, s[8:11], s19 offen offset:3072 lds
    v_mfma_f32_16x16x32_bf16 v[100:103], a[144:147], a[192:195], v[84:87]
    s_waitcnt lgkmcnt(5)
    s_xor_b32 s16, s16, 98304
    v_exp_f32 v115, v115
    v_mfma_f32_16x16x32_bf16 v[100:103], a[148:151], a[196:199], v[100:103]
    s_waitcnt lgkmcnt(4)
    ds_read_b128 a[172:175], v19 offset:19456
    v_cvt_pk_bf16_f32 v57, v114, v115
    v_mfma_f32_16x16x32_bf16 v[100:103], a[152:155], a[200:203], v[100:103]
    s_waitcnt lgkmcnt(4)
    v_exp_f32 v116, v116
    v_mfma_f32_16x16x32_bf16 v[100:103], a[156:159], a[204:207], v[100:103]
    buffer_load_dword v3, v12, s[8:11], s71 offen sc0 sc1
    v_bfe_u32 v13, v2, 1, 4
    v_mfma_f32_16x16x32_bf16 v[108:111], a[144:147], a[208:211], v[92:95]
    v_exp_f32 v117, v117
    v_lshlrev_b32 v13, 10, v13
    v_mfma_f32_16x16x32_bf16 v[108:111], a[148:151], a[212:215], v[108:111]
    ds_read_b128 a[176:179], v20 offset:20480
    v_cvt_pk_bf16_f32 v58, v116, v117
    v_and_b32 v14, 1, v2
    v_mfma_f32_16x16x32_bf16 v[108:111], a[152:155], a[216:219], v[108:111]
    v_exp_f32 v118, v118
    v_lshl_add_u32 v13, v14, 7, v13
    v_mfma_f32_16x16x32_bf16 v[108:111], a[156:159], a[220:223], v[108:111]
    s_lshl_b32 s74, s6, 2
    s_add_u32 s74, s74, s3
    s_lshl_b32 s74, s74, 14
    v_mfma_f32_16x16x32_bf16 v[32:35], v[28:31], v[48:51], v[32:35]
    v_exp_f32 v119, v119
    v_mfma_f32_16x16x32_bf16 v[36:39], v[28:31], v[52:55], v[36:39]
    s_waitcnt lgkmcnt(4)
    ds_read_b128 a[180:183], v20 offset:21504
    v_cvt_pk_bf16_f32 v59, v118, v119
    v_mfma_f32_16x16x32_bf16 v[128:131], a[160:163], v[48:51], v[128:131]
    s_waitcnt lgkmcnt(4)
    v_exp_f32 v120, v120
    v_mfma_f32_16x16x32_bf16 v[160:163], a[160:163], v[52:55], v[160:163]
    buffer_load_dword v14, v13, s[28:31], s74 offen
    v_mfma_f32_16x16x32_bf16 v[132:135], a[164:167], v[48:51], v[132:135]
    v_exp_f32 v121, v121
    v_mfma_f32_16x16x32_bf16 v[164:167], a[164:167], v[52:55], v[164:167]
    s_waitcnt lgkmcnt(3)
    ds_read_b128 a[184:187], v20 offset:22528
    v_cvt_pk_bf16_f32 v60, v120, v121
    v_mfma_f32_16x16x32_bf16 v[136:139], a[168:171], v[48:51], v[136:139]
    v_exp_f32 v122, v122
    v_mfma_f32_16x16x32_bf16 v[168:171], a[168:171], v[52:55], v[168:171]
    s_waitcnt lgkmcnt(3)
    v_add_f32 v80, 0, v22
    v_min_f32 v80, v80, v72
    v_mfma_f32_16x16x32_bf16 v[140:143], a[172:175], v[48:51], v[140:143]
    v_exp_f32 v123, v123
    v_mfma_f32_16x16x32_bf16 v[172:175], a[172:175], v[52:55], v[172:175]
    s_waitcnt lgkmcnt(2)
    ds_read_b128 a[188:191], v20 offset:23552
    v_cvt_pk_bf16_f32 v61, v122, v123
    v_mfma_f32_16x16x32_bf16 v[144:147], a[176:179], v[48:51], v[144:147]
    v_exp_f32 v124, v124
    v_mfma_f32_16x16x32_bf16 v[176:179], a[176:179], v[52:55], v[176:179]
    s_waitcnt lgkmcnt(2)
    v_add_f32 v81, 0xf1800000, v22
    v_min_f32 v81, v81, v73
    v_mfma_f32_16x16x32_bf16 v[148:151], a[180:183], v[48:51], v[148:151]
    v_exp_f32 v125, v125
    v_mfma_f32_16x16x32_bf16 v[180:183], a[180:183], v[52:55], v[180:183]
    s_waitcnt lgkmcnt(1)
    v_cvt_pk_bf16_f32 v62, v124, v125
    v_xor_b32 v19, 98304, v19
    v_mfma_f32_16x16x32_bf16 v[152:155], a[184:187], v[48:51], v[152:155]
    v_exp_f32 v126, v126
    v_mfma_f32_16x16x32_bf16 v[184:187], a[184:187], v[52:55], v[184:187]
    s_waitcnt lgkmcnt(0)
    v_xor_b32 v20, 98304, v20
    v_add_f32 v82, 0xf2000000, v22
    v_mfma_f32_16x16x32_bf16 v[156:159], a[188:191], v[48:51], v[156:159]
    v_exp_f32 v127, v127
    v_mfma_f32_16x16x32_bf16 v[188:191], a[188:191], v[52:55], v[188:191]
    v_cvt_pk_bf16_f32 v63, v126, v127
    v_min_f32 v82, v82, v74
    v_add_f32 v83, 0xf2400000, v22
    v_min_f32 v83, v83, v75
    v_add_f32 v84, 0xf3800000, v22
    v_min_f32 v84, v84, v72
    v_mfma_f32_16x16x32_bf16 v[112:115], a[128:131], a[224:227], v[72:75]
    v_exp_f32 v96, v96
    v_mfma_f32_16x16x32_bf16 v[112:115], a[132:135], a[228:231], v[112:115]
    v_add_f32 v85, 0xf3880000, v22
    v_min_f32 v85, v85, v73
    s_getpc_b64 s[100:101]
L_ct3:
    s_lshr_b32 s99, s2, 3
    s_lshl_b32 s99, s99, 2
    s_add_u32 s99, s99, s3
    s_mul_i32 s99, s99, 2
    v_min_u32 v13, 1, v2
    v_add_u32 v13, s99, v13
    v_lshlrev_b32 v13, 7, v13
    v_add_u32 v13, L_ct3-L_ct3, v13
    v_min_u32 v13, L_end-L_ct3, v13
    global_load_dword v13, v13, s[100:101]
    v_mfma_f32_16x16x32_bf16 v[112:115], a[136:139], a[232:235], v[112:115]
    v_exp_f32 v97, v97
    v_mfma_f32_16x16x32_bf16 v[112:115], a[140:143], a[236:239], v[112:115]
    v_cvt_pk_bf16_f32 v48, v96, v97
    v_add_f32 v86, 0xf3900000, v22
    v_mfma_f32_16x16x32_bf16 v[120:123], a[128:131], a[240:243], v[76:79]
    v_exp_f32 v98, v98
    v_mfma_f32_16x16x32_bf16 v[120:123], a[132:135], a[244:247], v[120:123]
    v_min_f32 v86, v86, v74
    v_add_f32 v87, 0xf3980000, v22
    v_mfma_f32_16x16x32_bf16 v[120:123], a[136:139], a[248:251], v[120:123]
    v_exp_f32 v99, v99
    v_mfma_f32_16x16x32_bf16 v[120:123], a[140:143], a[252:255], v[120:123]
    v_min_f32 v87, v87, v75
    v_add_f32 v88, 0x73800000, v22
    v_mfma_f32_16x16x32_bf16 v[116:119], a[144:147], a[224:227], v[72:75]
    v_exp_f32 v100, v100
    v_mfma_f32_16x16x32_bf16 v[116:119], a[148:151], a[228:231], v[116:119]
    ds_read_b128 a[128:131], v18 offset:16384
    v_cvt_pk_bf16_f32 v49, v98, v99
    v_mfma_f32_16x16x32_bf16 v[116:119], a[152:155], a[232:235], v[116:119]
    v_exp_f32 v101, v101
    v_mfma_f32_16x16x32_bf16 v[116:119], a[156:159], a[236:239], v[116:119]
    ds_read_b128 a[132:135], v18 offset:17408
    v_cvt_pk_bf16_f32 v50, v100, v101
    v_mfma_f32_16x16x32_bf16 v[124:127], a[144:147], a[240:243], v[76:79]
    v_exp_f32 v102, v102
    v_mfma_f32_16x16x32_bf16 v[124:127], a[148:151], a[244:247], v[124:127]
    ds_read_b128 a[136:139], v18 offset:18432
    v_min_f32 v88, v88, v76
    v_mfma_f32_16x16x32_bf16 v[124:127], a[152:155], a[248:251], v[124:127]
    v_exp_f32 v103, v103
    v_mfma_f32_16x16x32_bf16 v[124:127], a[156:159], a[252:255], v[124:127]
    ds_read_b128 a[140:143], v18 offset:19456
    v_cvt_pk_bf16_f32 v51, v102, v103
    v_mfma_f32_16x16x32_bf16 v[40:43], v[28:31], v[56:59], v[40:43]
    v_exp_f32 v104, v104
    v_mfma_f32_16x16x32_bf16 v[44:47], v[28:31], v[60:63], v[44:47]
    ds_read_b128 a[144:147], v18 offset:20480
    v_add_f32 v89, 0x73700000, v22
    v_mfma_f32_16x16x32_bf16 v[192:195], a[160:163], v[56:59], v[192:195]
    v_exp_f32 v105, v105
    v_mfma_f32_16x16x32_bf16 v[224:227], a[160:163], v[60:63], v[224:227]
    ds_read_b128 a[148:151], v18 offset:21504
    v_cvt_pk_bf16_f32 v52, v104, v105
    v_mfma_f32_16x16x32_bf16 v[196:199], a[164:167], v[56:59], v[196:199]
    v_exp_f32 v106, v106
    v_mfma_f32_16x16x32_bf16 v[228:231], a[164:167], v[60:63], v[228:231]
    ds_read_b128 a[152:155], v18 offset:22528
    v_min_f32 v89, v89, v77
    v_mfma_f32_16x16x32_bf16 v[200:203], a[168:171], v[56:59], v[200:203]
    v_exp_f32 v107, v107
    v_mfma_f32_16x16x32_bf16 v[232:235], a[168:171], v[60:63], v[232:235]
    ds_read_b128 a[156:159], v18 offset:23552
    v_cvt_pk_bf16_f32 v53, v106, v107
    v_mfma_f32_16x16x32_bf16 v[204:207], a[172:175], v[56:59], v[204:207]
    v_exp_f32 v108, v108
    v_mfma_f32_16x16x32_bf16 v[236:239], a[172:175], v[60:63], v[236:239]
    v_add_f32 v90, 0x73600000, v22
    v_min_f32 v90, v90, v78
    v_mfma_f32_16x16x32_bf16 v[208:211], a[176:179], v[56:59], v[208:211]
    v_exp_f32 v109, v109
    v_mfma_f32_16x16x32_bf16 v[240:243], a[176:179], v[60:63], v[240:243]
    v_cvt_pk_bf16_f32 v54, v108, v109
    v_xor_b32 v18, 196608, v18
    v_mfma_f32_16x16x32_bf16 v[212:215], a[180:183], v[56:59], v[212:215]
    v_exp_f32 v110, v110
    v_mfma_f32_16x16x32_bf16 v[244:247], a[180:183], v[60:63], v[244:247]
    v_add_f32 v91, 0x73500000, v22
    v_min_f32 v91, v91, v79
    v_mfma_f32_16x16x32_bf16 v[216:219], a[184:187], v[56:59], v[216:219]
    v_exp_f32 v111, v111
    v_mfma_f32_16x16x32_bf16 v[248:251], a[184:187], v[60:63], v[248:251]
    v_cvt_pk_bf16_f32 v55, v110, v111
    v_add_f32 v92, 0, v22
    s_waitcnt vmcnt(2)
    v_cmp_ne_u32 vcc, 0, v3
    s_cmp_eq_u64 vcc, -1
    s_cbranch_scc0 L_F_slow_11
L_F_ok_12:
    v_mfma_f32_16x16x32_bf16 v[220:223], a[188:191], v[56:59], v[220:223]
    v_min_f32 v92, v92, v76
    v_add_f32 v93, 0xf1800000, v22
    v_mfma_f32_16x16x32_bf16 v[252:255], a[188:191], v[60:63], v[252:255]
    v_min_f32 v93, v93, v77
    v_add_f32 v94, 0xf2000000, v22
    v_min_f32 v94, v94, v78
    v_add_f32 v95, 0xf2400000, v22
    v_min_f32 v95, v95, v79
    s_waitcnt lgkmcnt(0)
    s_barrier
    v_mfma_f32_16x16x32_bf16 v[96:99], a[128:131], a[224:227], v[80:83]
    s_xor_b32 s100, s62, 8192
    s_xor_b32 s98, s65, 262144
    ds_read_b128 a[176:179], v20 offset:4096
    s_waitcnt vmcnt(0)
    v_lshrrev_b32 v13, 1, v1
    v_mfma_f32_16x16x32_bf16 v[96:99], a[132:135], a[228:231], v[96:99]
    s_add_u32 m0, s62, 65536
    ds_read_b128 a[180:183], v20 offset:5120
    v_add_u32 v12, s100, v13
    v_mfma_f32_16x16x32_bf16 v[96:99], a[136:139], a[232:235], v[96:99]
    buffer_load_dwordx4 v24, s[28:31], s98 offen offset:0  lds
    v_exp_f32 v112, v112
    v_mfma_f32_16x16x32_bf16 v[96:99], a[140:143], a[236:239], v[96:99]
    v_exp_f32 v113, v113
    v_mfma_f32_16x16x32_bf16 v[100:103], a[144:147], a[224:227], v[84:87]
    ds_read_b128 a[184:187], v20 offset:6144
    v_cvt_pk_bf16_f32 v56, v112, v113
    v_mfma_f32_16x16x32_bf16 v[100:103], a[148:151], a[228:231], v[100:103]
    v_exp_f32 v114, v114
    v_mfma_f32_16x16x32_bf16 v[100:103], a[152:155], a[232:235], v[100:103]
    buffer_load_dwordx4 v25, s[28:31], s98 offen offset:1024  lds
    v_exp_f32 v115, v115
    v_mfma_f32_16x16x32_bf16 v[100:103], a[156:159], a[236:239], v[100:103]
    ds_read_b128 a[188:191], v20 offset:7168
    v_cvt_pk_bf16_f32 v57, v114, v115
    v_mfma_f32_16x16x32_bf16 v[104:107], a[128:131], a[240:243], v[88:91]
    v_exp_f32 v116, v116
    v_mfma_f32_16x16x32_bf16 v[104:107], a[132:135], a[244:247], v[104:107]
    v_exp_f32 v117, v117
    v_mfma_f32_16x16x32_bf16 v[104:107], a[136:139], a[248:251], v[104:107]
    ds_read_b128 a[160:163], v19 offset:0
    v_cvt_pk_bf16_f32 v58, v116, v117
    v_mfma_f32_16x16x32_bf16 v[104:107], a[140:143], a[252:255], v[104:107]
    buffer_load_dwordx4 v26, s[28:31], s98 offen offset:2048  lds
    v_exp_f32 v118, v118
    v_mfma_f32_16x16x32_bf16 v[108:111], a[144:147], a[240:243], v[92:95]
    v_exp_f32 v119, v119
    v_mfma_f32_16x16x32_bf16 v[108:111], a[148:151], a[244:247], v[108:111]
    ds_read_b128 a[164:167], v19 offset:1024
    v_cvt_pk_bf16_f32 v59, v118, v119
    v_mfma_f32_16x16x32_bf16 v[108:111], a[152:155], a[248:251], v[108:111]
    v_exp_f32 v120, v120
    v_mfma_f32_16x16x32_bf16 v[108:111], a[156:159], a[252:255], v[108:111]
    buffer_load_dwordx4 v27, s[28:31], s98 offen offset:3072  lds
    v_exp_f32 v121, v121
    v_mfma_f32_16x16x32_bf16 v[32:35], v[28:31], v[48:51], v[32:35]
    s_add_u32 m0, s62, 69632
    ds_read_b128 a[168:171], v19 offset:2048
    v_cvt_pk_bf16_f32 v60, v120, v121
    v_mfma_f32_16x16x32_bf16 v[36:39], v[28:31], v[52:55], v[36:39]
    s_waitcnt lgkmcnt(6)
    s_xor_b32 s98, s65, 294912
    v_exp_f32 v122, v122
    v_mfma_f32_16x16x32_bf16 v[144:147], a[176:179], v[48:51], v[144:147]
    v_exp_f32 v123, v123
    v_mfma_f32_16x16x32_bf16 v[176:179], a[176:179], v[52:55], v[176:179]
    s_waitcnt lgkmcnt(5)
    ds_read_b128 a[172:175], v19 offset:3072
    v_cvt_pk_bf16_f32 v61, v122, v123
    v_mfma_f32_16x16x32_bf16 v[148:151], a[180:183], v[48:51], v[148:151]
    buffer_load_dwordx4 v24, s[28:31], s98 offen offset:0  lds
    v_exp_f32 v124, v124
    v_mfma_f32_16x16x32_bf16 v[180:183], a[180:183], v[52:55], v[180:183]
    s_waitcnt lgkmcnt(5)
    v_exp_f32 v125, v125
    v_mfma_f32_16x16x32_bf16 v[152:155], a[184:187], v[48:51], v[152:155]
    s_waitcnt lgkmcnt(4)
    v_exp_f32 v126, v126
    v_mfma_f32_16x16x32_bf16 v[184:187], a[184:187], v[52:55], v[184:187]
    buffer_load_dwordx4 v25, s[28:31], s98 offen offset:1024  lds
    v_exp_f32 v127, v127
    v_mfma_f32_16x16x32_bf16 v[156:159], a[188:191], v[48:51], v[156:159]
    ds_write_b128 v11, v[144:147] offset:0
    v_cvt_pk_bf16_f32 v62, v124, v125
    v_mfma_f32_16x16x32_bf16 v[188:191], a[188:191], v[52:55], v[188:191]
    s_waitcnt lgkmcnt(4)
    v_exp_f32 v96, v96
    v_mfma_f32_16x16x32_bf16 v[128:131], a[160:163], v[48:51], v[128:131]
    v_exp_f32 v97, v97
    v_mfma_f32_16x16x32_bf16 v[160:163], a[160:163], v[52:55], v[160:163]
    s_waitcnt lgkmcnt(3)
    ds_write_b128 v11, v[176:179] offset:1024
    v_cvt_pk_bf16_f32 v63, v126, v127
    v_mfma_f32_16x16x32_bf16 v[132:135], a[164:167], v[48:51], v[132:135]
    s_waitcnt lgkmcnt(3)
    v_exp_f32 v98, v98
    v_mfma_f32_16x16x32_bf16 v[164:167], a[164:167], v[52:55], v[164:167]
    buffer_load_dwordx4 v26, s[28:31], s98 offen offset:2048  lds
    v_exp_f32 v99, v99
    v_mfma_f32_16x16x32_bf16 v[136:139], a[168:171], v[48:51], v[136:139]
    ds_write_b128 v11, v[148:151] offset:2048
    v_mfma_f32_16x16x32_bf16 v[168:171], a[168:171], v[52:55], v[168:171]
    s_waitcnt lgkmcnt(3)
    v_exp_f32 v100, v100
    v_mfma_f32_16x16x32_bf16 v[140:143], a[172:175], v[48:51], v[140:143]
    v_exp_f32 v101, v101
    v_mfma_f32_16x16x32_bf16 v[172:175], a[172:175], v[52:55], v[172:175]
    ds_write_b128 v11, v[180:183] offset:3072
    v_mov_b32 v33, v36
    v_mfma_f32_16x16x32_bf16 v[40:43], v[28:31], v[56:59], v[40:43]
    buffer_load_dwordx4 v27, s[28:31], s98 offen offset:3072  lds
    v_exp_f32 v102, v102
    v_mfma_f32_16x16x32_bf16 v[44:47], v[28:31], v[60:63], v[44:47]
    v_exp_f32 v103, v103
    v_mfma_f32_16x16x32_bf16 v[208:211], a[176:179], v[56:59], v[208:211]
    ds_write_b128 v11, v[152:155] offset:4096
    v_cvt_pk_bf16_f32 v48, v96, v97
    v_mfma_f32_16x16x32_bf16 v[240:243], a[176:179], v[60:63], v[240:243]
    ds_read_b128 a[176:179], v20 offset:20480
    v_exp_f32 v104, v104
    v_mfma_f32_16x16x32_bf16 v[212:215], a[180:183], v[56:59], v[212:215]
    v_exp_f32 v105, v105
    v_mfma_f32_16x16x32_bf16 v[244:247], a[180:183], v[60:63], v[244:247]
    ds_read_b128 a[180:183], v20 offset:21504
    v_exp_f32 v106, v106
    v_mfma_f32_16x16x32_bf16 v[216:219], a[184:187], v[56:59], v[216:219]
    ds_write_b128 v11, v[184:187] offset:5120
    v_cvt_pk_bf16_f32 v49, v98, v99
    v_mfma_f32_16x16x32_bf16 v[248:251], a[184:187], v[60:63], v[248:251]
    ds_read_b128 a[184:187], v20 offset:22528
    v_exp_f32 v107, v107
    v_mfma_f32_16x16x32_bf16 v[220:223], a[188:191], v[56:59], v[220:223]
    v_exp_f32 v108, v108
    v_mfma_f32_16x16x32_bf16 v[252:255], a[188:191], v[60:63], v[252:255]
    ds_read_b128 a[188:191], v20 offset:23552
    v_exp_f32 v109, v109
    v_mfma_f32_16x16x32_bf16 v[192:195], a[160:163], v[56:59], v[192:195]
    ds_write_b128 v11, v[156:159] offset:6144
    v_cvt_pk_bf16_f32 v50, v100, v101
    v_mfma_f32_16x16x32_bf16 v[224:227], a[160:163], v[60:63], v[224:227]
    ds_read_b128 a[160:163], v19 offset:16384
    v_exp_f32 v110, v110
    v_mfma_f32_16x16x32_bf16 v[196:199], a[164:167], v[56:59], v[196:199]
    v_exp_f32 v111, v111
    v_mfma_f32_16x16x32_bf16 v[228:231], a[164:167], v[60:63], v[228:231]
    ds_read_b128 a[164:167], v19 offset:17408
    v_cvt_pk_bf16_f32 v51, v102, v103
    v_mfma_f32_16x16x32_bf16 v[200:203], a[168:171], v[56:59], v[200:203]
    ds_write_b128 v11, v[188:191] offset:7168
    v_cvt_pk_bf16_f32 v52, v104, v105
    v_mfma_f32_16x16x32_bf16 v[232:235], a[168:171], v[60:63], v[232:235]
    ds_read_b128 a[168:171], v19 offset:18432
    v_cvt_pk_bf16_f32 v53, v106, v107
    v_mfma_f32_16x16x32_bf16 v[204:207], a[172:175], v[56:59], v[204:207]
    v_cvt_pk_bf16_f32 v54, v108, v109
    v_cvt_pk_bf16_f32 v55, v110, v111
    v_mfma_f32_16x16x32_bf16 v[236:239], a[172:175], v[60:63], v[236:239]
    ds_read_b128 a[172:175], v19 offset:19456
    ds_write_b64 v12, v[32:33]
    s_add_u32 s101, s62, 98304
    v_xor_b32 v12, 8192, v12
    v_add_u32 v9, s101, v1
    v_xor_b32 v8, 8192, v11
    v_xor_b32 v10, 8192, v9
L_t2_join:
    v_xor_b32 v19, 98304, v19
    v_xor_b32 v20, 98304, v20
    s_waitcnt lgkmcnt(0)
    s_barrier
    v_mfma_f32_16x16x32_bf16 v[40:43], v[28:31], v[48:51], v[40:43]
    s_lshl_b32 s100, s61, 20
    s_add_u32 s101, s100, s21
    ds_read_b64 v[120:121], v12
    v_mfma_f32_16x16x32_bf16 v[44:47], v[28:31], v[52:55], v[44:47]
    s_add_u32 s100, s100, s20
    ds_read_b128 v[144:147], v8 offset:0
    v_lshrrev_b32 v11, 4, v2
    v_mfma_f32_16x16x32_bf16 v[208:211], a[176:179], v[48:51], v[208:211]
    ds_read_b128 v[176:179], v8 offset:1024
    v_lshrrev_b32 v13, 2, v1
    v_mfma_f32_16x16x32_bf16 v[240:243], a[176:179], v[52:55], v[240:243]
    ds_read_b128 v[148:151], v8 offset:2048
    v_add_u32 v13, 131072, v13
    v_mfma_f32_16x16x32_bf16 v[212:215], a[180:183], v[48:51], v[212:215]
    s_xor_b32 s99, s62, 8192
    ds_read_b128 v[180:183], v8 offset:3072
    v_add_u32 v14, s99, v13
    v_mfma_f32_16x16x32_bf16 v[244:247], a[180:183], v[52:55], v[244:247]
    ds_read_b128 v[152:155], v8 offset:4096
    v_cmp_eq_u32 vcc, 1, v11
    v_mfma_f32_16x16x32_bf16 v[216:219], a[184:187], v[48:51], v[216:219]
    ds_read_b128 v[184:187], v8 offset:5120
    s_waitcnt lgkmcnt(6)
    v_add_f32 v112, v120, v32
    v_mfma_f32_16x16x32_bf16 v[248:251], a[184:187], v[52:55], v[248:251]
    ds_read_b128 v[156:159], v8 offset:6144
    v_add_f32 v114, v121, v36
    v_mfma_f32_16x16x32_bf16 v[220:223], a[188:191], v[48:51], v[220:223]
    ds_read_b128 v[188:191], v8 offset:7168
    v_cndmask_b32 v12, v32, v36, vcc
    v_mfma_f32_16x16x32_bf16 v[252:255], a[188:191], v[52:55], v[252:255]
    v_rcp_f32 v112, v112
    v_mfma_f32_16x16x32_bf16 v[192:195], a[160:163], v[48:51], v[192:195]
    v_rcp_f32 v114, v114
    v_mfma_f32_16x16x32_bf16 v[224:227], a[160:163], v[52:55], v[224:227]
    v_cmp_eq_u32 vcc, 2, v11
    v_cmp_eq_u32 s[96:97], 3, v11
    v_mfma_f32_16x16x32_bf16 v[196:199], a[164:167], v[48:51], v[196:199]
    ds_write_b128 v9, v[208:211] offset:0
    v_mfma_f32_16x16x32_bf16 v[228:231], a[164:167], v[52:55], v[228:231]
    v_mfma_f32_16x16x32_bf16 v[200:203], a[168:171], v[48:51], v[200:203]
    ds_write_b128 v9, v[240:243] offset:1024
    v_mfma_f32_16x16x32_bf16 v[232:235], a[168:171], v[52:55], v[232:235]
    v_mfma_f32_16x16x32_bf16 v[204:207], a[172:175], v[48:51], v[204:207]
    ds_write_b128 v9, v[212:215] offset:2048
    v_mfma_f32_16x16x32_bf16 v[236:239], a[172:175], v[52:55], v[236:239]
    v_cndmask_b32 v12, v12, v40, vcc
    v_cndmask_b32 v12, v12, v44, s[96:97]
    ds_write_b128 v9, v[244:247] offset:3072
    s_waitcnt lgkmcnt(11)
    v_pk_add_f32 v[128:129], v[128:129], v[144:145]
    v_pk_add_f32 v[130:131], v[130:131], v[146:147]
    s_waitcnt lgkmcnt(9)
    v_pk_add_f32 v[132:133], v[132:133], v[148:149]
    v_pk_add_f32 v[134:135], v[134:135], v[150:151]
    v_pk_mul_f32 v[128:129], v[128:129], v[112:113] op_sel_hi:[1,0]
    v_pk_mul_f32 v[130:131], v[130:131], v[112:113] op_sel_hi:[1,0]
    v_pk_mul_f32 v[132:133], v[132:133], v[112:113] op_sel_hi:[1,0]
    v_pk_mul_f32 v[134:135], v[134:135], v[112:113] op_sel_hi:[1,0]
    v_cvt_pk_bf16_f32 v128, v128, v129
    v_cvt_pk_bf16_f32 v129, v130, v131
    v_cvt_pk_bf16_f32 v130, v132, v133
    v_lshrrev_b32 v58, 2, v2
    v_and_b32 v57, 3, v2
    ds_write_b128 v9, v[216:219] offset:4096
    v_cvt_pk_bf16_f32 v131, v134, v135
    buffer_store_dwordx4 v[128:131], v1, s[8:11], s100 offen offset:0 sc0 sc1
    s_waitcnt lgkmcnt(8)
    v_pk_add_f32 v[136:137], v[136:137], v[152:153]
    v_pk_add_f32 v[138:139], v[138:139], v[154:155]
    s_waitcnt lgkmcnt(6)
    v_pk_add_f32 v[140:141], v[140:141], v[156:157]
    v_pk_add_f32 v[142:143], v[142:143], v[158:159]
    v_pk_mul_f32 v[136:137], v[136:137], v[112:113] op_sel_hi:[1,0]
    v_pk_mul_f32 v[138:139], v[138:139], v[112:113] op_sel_hi:[1,0]
    v_pk_mul_f32 v[140:141], v[140:141], v[112:113] op_sel_hi:[1,0]
    v_pk_mul_f32 v[142:143], v[142:143], v[112:113] op_sel_hi:[1,0]
    v_cvt_pk_bf16_f32 v136, v136, v137
    v_lshlrev_b32 v56, 7, v58
    v_lshl_add_u32 v56, v57, 3, v56
    v_bfe_u32 v57, v2, 3, 2
    ds_write_b128 v9, v[248:251] offset:5120
    v_cvt_pk_bf16_f32 v137, v138, v139
    v_cvt_pk_bf16_f32 v138, v140, v141
    v_cvt_pk_bf16_f32 v139, v142, v143
    buffer_store_dwordx4 v[136:139], v1, s[8:11], s100 offen offset:1024 sc0 sc1
    v_pk_add_f32 v[160:161], v[160:161], v[176:177]
    v_pk_add_f32 v[162:163], v[162:163], v[178:179]
    v_pk_add_f32 v[164:165], v[164:165], v[180:181]
    v_pk_add_f32 v[166:167], v[166:167], v[182:183]
    v_pk_mul_f32 v[160:161], v[160:161], v[114:115] op_sel_hi:[1,0]
    v_pk_mul_f32 v[162:163], v[162:163], v[114:115] op_sel_hi:[1,0]
    v_pk_mul_f32 v[164:165], v[164:165], v[114:115] op_sel_hi:[1,0]
    v_lshl_add_u32 v56, v57, 5, v56
    v_xor_b32 v57, 32, v56
    ds_write_b128 v9, v[220:223] offset:6144
    v_pk_mul_f32 v[166:167], v[166:167], v[114:115] op_sel_hi:[1,0]
    v_cvt_pk_bf16_f32 v160, v160, v161
    v_cvt_pk_bf16_f32 v161, v162, v163
    v_cvt_pk_bf16_f32 v162, v164, v165
    v_cvt_pk_bf16_f32 v163, v166, v167
    buffer_store_dwordx4 v[160:163], v15, s[8:11], s100 offen offset:0 sc0 sc1
    v_pk_add_f32 v[168:169], v[168:169], v[184:185]
    v_pk_add_f32 v[170:171], v[170:171], v[186:187]
    s_waitcnt lgkmcnt(7)
    v_pk_add_f32 v[172:173], v[172:173], v[188:189]
    v_pk_add_f32 v[174:175], v[174:175], v[190:191]
    v_pk_mul_f32 v[168:169], v[168:169], v[114:115] op_sel_hi:[1,0]
    v_xor_b32 v58, 64, v56
    v_xor_b32 v59, 96, v56
    v_add_u32 v60, 65536, v56
    ds_write_b128 v9, v[252:255] offset:7168
    v_pk_mul_f32 v[170:171], v[170:171], v[114:115] op_sel_hi:[1,0]
    v_pk_mul_f32 v[172:173], v[172:173], v[114:115] op_sel_hi:[1,0]
    v_pk_mul_f32 v[174:175], v[174:175], v[114:115] op_sel_hi:[1,0]
    v_cvt_pk_bf16_f32 v168, v168, v169
    v_cvt_pk_bf16_f32 v169, v170, v171
    v_cvt_pk_bf16_f32 v170, v172, v173
    v_cvt_pk_bf16_f32 v171, v174, v175
    buffer_store_dwordx4 v[168:171], v15, s[8:11], s100 offen offset:1024 sc0 sc1
    v_add_u32 v61, 65536, v57
    v_add_u32 v62, 65536, v58
    v_add_u32 v63, 65536, v59
    ds_write_b32 v14, v12
    v_and_b32 v14, 4294967103, v13
    v_add_u32 v14, s62, v14
    s_waitcnt lgkmcnt(0)
    s_barrier
    ds_read_b32 v116, v14 offset:128
    ds_read_b32 v118, v14 offset:192
    ds_read_b128 v[208:211], v10 offset:0
    ds_read_b128 v[212:215], v10 offset:2048
    ds_read_b128 v[216:219], v10 offset:4096
    ds_read_b128 v[220:223], v10 offset:6144
    ds_read_b128 v[240:243], v10 offset:1024
    ds_read_b128 v[244:247], v10 offset:3072
    ds_read_b128 v[248:251], v10 offset:5120
    ds_read_b128 v[252:255], v10 offset:7168
    ds_read_b32 v120, v13 offset:0
    ds_read_b32 v121, v13 offset:8192
    ds_read_b32 v122, v13 offset:16384
    ds_read_b32 v123, v13 offset:24576
    s_waitcnt lgkmcnt(13)
    v_add_f32 v116, v116, v40
    s_waitcnt lgkmcnt(12)
    v_add_f32 v118, v118, v44
    v_rcp_f32 v116, v116
    v_rcp_f32 v118, v118
    s_waitcnt lgkmcnt(11)
    v_pk_add_f32 v[192:193], v[192:193], v[208:209]
    v_pk_add_f32 v[194:195], v[194:195], v[210:211]
    s_waitcnt lgkmcnt(10)
    v_pk_add_f32 v[196:197], v[196:197], v[212:213]
    v_pk_add_f32 v[198:199], v[198:199], v[214:215]
    v_pk_mul_f32 v[192:193], v[192:193], v[116:117] op_sel_hi:[1,0]
    v_pk_mul_f32 v[194:195], v[194:195], v[116:117] op_sel_hi:[1,0]
    v_pk_mul_f32 v[196:197], v[196:197], v[116:117] op_sel_hi:[1,0]
    v_pk_mul_f32 v[198:199], v[198:199], v[116:117] op_sel_hi:[1,0]
    v_cvt_pk_bf16_f32 v192, v192, v193
    v_cvt_pk_bf16_f32 v193, v194, v195
    v_cvt_pk_bf16_f32 v194, v196, v197
    v_cvt_pk_bf16_f32 v195, v198, v199
    buffer_store_dwordx4 v[192:195], v1, s[8:11], s101 offen offset:0 sc0 sc1
    s_waitcnt lgkmcnt(9)
    v_pk_add_f32 v[200:201], v[200:201], v[216:217]
    v_pk_add_f32 v[202:203], v[202:203], v[218:219]
    s_waitcnt lgkmcnt(8)
    v_pk_add_f32 v[204:205], v[204:205], v[220:221]
    v_pk_add_f32 v[206:207], v[206:207], v[222:223]
    v_pk_mul_f32 v[200:201], v[200:201], v[116:117] op_sel_hi:[1,0]
    v_pk_mul_f32 v[202:203], v[202:203], v[116:117] op_sel_hi:[1,0]
    v_pk_mul_f32 v[204:205], v[204:205], v[116:117] op_sel_hi:[1,0]
    v_pk_mul_f32 v[206:207], v[206:207], v[116:117] op_sel_hi:[1,0]
    v_cvt_pk_bf16_f32 v200, v200, v201
    v_cvt_pk_bf16_f32 v201, v202, v203
    v_cvt_pk_bf16_f32 v202, v204, v205
    v_cvt_pk_bf16_f32 v203, v206, v207
    buffer_store_dwordx4 v[200:203], v1, s[8:11], s101 offen offset:1024 sc0 sc1
    s_waitcnt lgkmcnt(2)
    v_add_f32 v120, v120, v121
    s_waitcnt lgkmcnt(0)
    v_add_f32 v122, v122, v123
    v_min_f32 v124, v120, v122
    v_add_f32 v120, v120, v122
    v_cmp_le_f32 vcc, 0x1f800000, v124
    s_mov_b64 s[96:97], vcc
    v_cmp_ge_f32 vcc, 0x67800000, v120
    s_and_b64 s[96:97], s[96:97], vcc
    s_cmp_eq_u64 s[96:97], -1
    s_cselect_b32 s96, s25, 1
    s_cmp_lg_u32 s96, 0
    s_cbranch_scc1 L_t2_redo
L_t2_safe:
    v_pk_add_f32 v[224:225], v[224:225], v[240:241]
    v_pk_add_f32 v[226:227], v[226:227], v[242:243]
    v_pk_add_f32 v[228:229], v[228:229], v[244:245]
    v_pk_add_f32 v[230:231], v[230:231], v[246:247]
    v_pk_mul_f32 v[224:225], v[224:225], v[118:119] op_sel_hi:[1,0]
    v_pk_mul_f32 v[226:227], v[226:227], v[118:119] op_sel_hi:[1,0]
    v_pk_mul_f32 v[228:229], v[228:229], v[118:119] op_sel_hi:[1,0]
    v_pk_mul_f32 v[230:231], v[230:231], v[118:119] op_sel_hi:[1,0]
    v_cvt_pk_bf16_f32 v224, v224, v225
    v_cvt_pk_bf16_f32 v225, v226, v227
    v_cvt_pk_bf16_f32 v226, v228, v229
    v_cvt_pk_bf16_f32 v227, v230, v231
    buffer_store_dwordx4 v[224:227], v15, s[8:11], s101 offen offset:0 sc0 sc1
    ds_read_b64_tr_b16 a[192:193], v56 offset:32768
    ds_read_b64_tr_b16 a[194:195], v56 offset:34816
    ds_read_b64_tr_b16 a[196:197], v56 offset:36864
    ds_read_b64_tr_b16 a[198:199], v56 offset:38912
    ds_read_b64_tr_b16 a[200:201], v57 offset:32768
    ds_read_b64_tr_b16 a[202:203], v57 offset:34816
    ds_read_b64_tr_b16 a[204:205], v57 offset:36864
    ds_read_b64_tr_b16 a[206:207], v57 offset:38912
    v_pk_add_f32 v[232:233], v[232:233], v[248:249]
    v_pk_add_f32 v[234:235], v[234:235], v[250:251]
    v_pk_add_f32 v[236:237], v[236:237], v[252:253]
    v_pk_add_f32 v[238:239], v[238:239], v[254:255]
    v_pk_mul_f32 v[232:233], v[232:233], v[118:119] op_sel_hi:[1,0]
    v_pk_mul_f32 v[234:235], v[234:235], v[118:119] op_sel_hi:[1,0]
    v_pk_mul_f32 v[236:237], v[236:237], v[118:119] op_sel_hi:[1,0]
    v_pk_mul_f32 v[238:239], v[238:239], v[118:119] op_sel_hi:[1,0]
    v_cvt_pk_bf16_f32 v232, v232, v233
    v_cvt_pk_bf16_f32 v233, v234, v235
    v_cvt_pk_bf16_f32 v234, v236, v237
    v_cvt_pk_bf16_f32 v235, v238, v239
    buffer_store_dwordx4 v[232:235], v15, s[8:11], s101 offen offset:1024 sc0 sc1
    ds_read_b64_tr_b16 a[208:209], v56 offset:40960
    ds_read_b64_tr_b16 a[210:211], v56 offset:43008
    ds_read_b64_tr_b16 a[212:213], v56 offset:45056
    ds_read_b64_tr_b16 a[214:215], v56 offset:47104
    ds_read_b64_tr_b16 a[216:217], v57 offset:40960
    ds_read_b64_tr_b16 a[218:219], v57 offset:43008
    ds_read_b64_tr_b16 a[220:221], v57 offset:45056
    ds_read_b64_tr_b16 a[222:223], v57 offset:47104
    s_waitcnt lgkmcnt(14)
    v_mfma_f32_16x16x32_bf16 v[64:67], a[192:195], a[64:67], 0
    s_waitcnt lgkmcnt(12)
    s_add_u32 m0, s62, 0
    ds_read_b64_tr_b16 a[224:225], v56 offset:49152
    v_mfma_f32_16x16x32_bf16 v[64:67], a[196:199], a[68:71], v[64:67]
    s_xor_b32 s98, s65, 128
    ds_read_b64_tr_b16 a[226:227], v56 offset:51200
    v_mfma_f32_16x16x32_bf16 v[72:75], a[192:195], a[80:83], 0
    buffer_load_dwordx4 v24, s[28:31], s98 offen offset:0  lds
    v_mfma_f32_16x16x32_bf16 v[72:75], a[196:199], a[84:87], v[72:75]
    s_waitcnt lgkmcnt(12)
    ds_read_b64_tr_b16 a[228:229], v56 offset:53248
    v_mfma_f32_16x16x32_bf16 v[68:71], a[200:203], a[64:67], 0
    s_waitcnt lgkmcnt(11)
    s_add_u32 s22, s22, 65536
    ds_read_b64_tr_b16 a[230:231], v56 offset:55296
    v_mfma_f32_16x16x32_bf16 v[68:71], a[204:207], a[68:71], v[68:71]
    s_add_u32 s23, s23, 65536
    ds_read_b64_tr_b16 a[232:233], v57 offset:49152
    v_mfma_f32_16x16x32_bf16 v[76:79], a[200:203], a[80:83], 0
    buffer_load_dwordx4 v25, s[28:31], s98 offen offset:1024  lds
    v_mfma_f32_16x16x32_bf16 v[76:79], a[204:207], a[84:87], v[76:79]
    s_waitcnt lgkmcnt(11)
    s_lshl_b32 s24, s61, 2
    ds_read_b64_tr_b16 a[234:235], v57 offset:51200
    v_mfma_f32_16x16x32_bf16 v[64:67], a[208:211], a[72:75], v[64:67]
    s_waitcnt lgkmcnt(10)
    s_add_u32 s24, s24, s3
    ds_read_b64_tr_b16 a[236:237], v57 offset:53248
    v_mfma_f32_16x16x32_bf16 v[64:67], a[212:215], a[76:79], v[64:67]
    s_lshl_b32 s24, s24, 3
    ds_read_b64_tr_b16 a[238:239], v57 offset:55296
    v_mfma_f32_16x16x32_bf16 v[72:75], a[208:211], a[88:91], v[72:75]
    buffer_load_dwordx4 v26, s[28:31], s98 offen offset:2048  lds
    v_mfma_f32_16x16x32_bf16 v[72:75], a[212:215], a[92:95], v[72:75]
    s_waitcnt lgkmcnt(6)
    s_add_u32 s24, s24, s4
    ds_read_b64_tr_b16 a[240:241], v56 offset:57344
    v_mfma_f32_16x16x32_bf16 v[68:71], a[216:219], a[72:75], v[68:71]
    s_lshl_b32 s24, s24, 2
    ds_read_b64_tr_b16 a[242:243], v56 offset:59392
    v_mfma_f32_16x16x32_bf16 v[68:71], a[220:223], a[76:79], v[68:71]
    s_add_u32 s24, s24, s5
    ds_read_b64_tr_b16 a[244:245], v56 offset:61440
    v_mfma_f32_16x16x32_bf16 v[76:79], a[216:219], a[88:91], v[76:79]
    buffer_load_dwordx4 v27, s[28:31], s98 offen offset:3072  lds
    v_mfma_f32_16x16x32_bf16 v[76:79], a[220:223], a[92:95], v[76:79]
    s_add_u32 m0, s62, 4096
    ds_read_b64_tr_b16 a[246:247], v56 offset:63488
    v_mfma_f32_16x16x32_bf16 v[64:67], a[224:227], a[96:99], v[64:67]
    s_waitcnt lgkmcnt(7)
    s_xor_b32 s98, s65, 32896
    ds_read_b64_tr_b16 a[248:249], v57 offset:57344
    v_mfma_f32_16x16x32_bf16 v[64:67], a[228:231], a[100:103], v[64:67]
    s_lshl_b32 s24, s24, 13
    ds_read_b64_tr_b16 a[250:251], v57 offset:59392
    v_mfma_f32_16x16x32_bf16 v[72:75], a[224:227], a[112:115], v[72:75]
    buffer_load_dwordx4 v24, s[28:31], s98 offen offset:0  lds
    v_mfma_f32_16x16x32_bf16 v[72:75], a[228:231], a[116:119], v[72:75]
    s_waitcnt lgkmcnt(6)
    s_add_u32 s24, s24, 50331648
    ds_read_b64_tr_b16 a[252:253], v57 offset:61440
    v_mfma_f32_16x16x32_bf16 v[68:71], a[232:235], a[96:99], v[68:71]
    ds_read_b64_tr_b16 a[254:255], v57 offset:63488
    v_mfma_f32_16x16x32_bf16 v[68:71], a[236:239], a[100:103], v[68:71]
    ds_read_b64_tr_b16 a[192:193], v58 offset:32768
    v_mfma_f32_16x16x32_bf16 v[76:79], a[232:235], a[112:115], v[76:79]
    buffer_load_dwordx4 v25, s[28:31], s98 offen offset:1024  lds
    v_mfma_f32_16x16x32_bf16 v[76:79], a[236:239], a[116:119], v[76:79]
    s_waitcnt lgkmcnt(6)
    ds_read_b64_tr_b16 a[194:195], v58 offset:34816
    v_mfma_f32_16x16x32_bf16 v[64:67], a[240:243], a[104:107], v[64:67]
    s_waitcnt lgkmcnt(6)
    ds_read_b64_tr_b16 a[196:197], v58 offset:36864
    v_mfma_f32_16x16x32_bf16 v[64:67], a[244:247], a[108:111], v[64:67]
    ds_read_b64_tr_b16 a[198:199], v58 offset:38912
    v_mfma_f32_16x16x32_bf16 v[72:75], a[240:243], a[120:123], v[72:75]
    buffer_load_dwordx4 v26, s[28:31], s98 offen offset:2048  lds
    v_mfma_f32_16x16x32_bf16 v[72:75], a[244:247], a[124:127], v[72:75]
    s_waitcnt lgkmcnt(6)
    ds_read_b64_tr_b16 a[200:201], v59 offset:32768
    v_mfma_f32_16x16x32_bf16 v[68:71], a[248:251], a[104:107], v[68:71]
    s_waitcnt lgkmcnt(5)
    ds_read_b64_tr_b16 a[202:203], v59 offset:34816
    v_mfma_f32_16x16x32_bf16 v[68:71], a[252:255], a[108:111], v[68:71]
    ds_read_b64_tr_b16 a[204:205], v59 offset:36864
    v_mfma_f32_16x16x32_bf16 v[76:79], a[248:251], a[120:123], v[76:79]
    buffer_load_dwordx4 v27, s[28:31], s98 offen offset:3072  lds
    ds_read_b64_tr_b16 a[206:207], v59 offset:38912
    v_mfma_f32_16x16x32_bf16 v[76:79], a[252:255], a[124:127], v[76:79]
    s_waitcnt lgkmcnt(6)
    ds_read_b64_tr_b16 a[208:209], v58 offset:40960
    v_mfma_f32_16x16x32_bf16 v[80:83], a[192:195], a[64:67], 0
    s_waitcnt lgkmcnt(5)
    ds_read_b64_tr_b16 a[210:211], v58 offset:43008
    v_mfma_f32_16x16x32_bf16 v[80:83], a[196:199], a[68:71], v[80:83]
    ds_read_b64_tr_b16 a[212:213], v58 offset:45056
    v_mfma_f32_16x16x32_bf16 v[88:91], a[192:195], a[80:83], 0
    ds_read_b64_tr_b16 a[214:215], v58 offset:47104
    s_waitcnt vmcnt(16)
    s_barrier
    v_mfma_f32_16x16x32_bf16 v[88:91], a[196:199], a[84:87], v[88:91]
    s_waitcnt lgkmcnt(6)
    s_add_u32 m0, s62, 98304
    ds_read_b64_tr_b16 a[216:217], v59 offset:40960
    v_mfma_f32_16x16x32_bf16 v[84:87], a[200:203], a[64:67], 0
    s_waitcnt lgkmcnt(5)
    s_xor_b32 s98, s65, 262272
    ds_read_b64_tr_b16 a[218:219], v59 offset:43008
    v_mfma_f32_16x16x32_bf16 v[84:87], a[204:207], a[68:71], v[84:87]
    buffer_load_dwordx4 v24, s[28:31], s98 offen offset:0  lds
    ds_read_b64_tr_b16 a[220:221], v59 offset:45056
    v_mfma_f32_16x16x32_bf16 v[92:95], a[200:203], a[80:83], 0
    ds_read_b64_tr_b16 a[222:223], v59 offset:47104
    v_mfma_f32_16x16x32_bf16 v[92:95], a[204:207], a[84:87], v[92:95]
    s_waitcnt lgkmcnt(6)
    ds_read_b64_tr_b16 a[224:225], v58 offset:49152
    v_mfma_f32_16x16x32_bf16 v[80:83], a[208:211], a[72:75], v[80:83]
    s_waitcnt lgkmcnt(5)
    ds_read_b64_tr_b16 a[226:227], v58 offset:51200
    v_mfma_f32_16x16x32_bf16 v[80:83], a[212:215], a[76:79], v[80:83]
    buffer_load_dwordx4 v25, s[28:31], s98 offen offset:1024  lds
    v_mfma_f32_16x16x32_bf16 v[88:91], a[208:211], a[88:91], v[88:91]
    ds_read_b64_tr_b16 a[228:229], v58 offset:53248
    v_mfma_f32_16x16x32_bf16 v[88:91], a[212:215], a[92:95], v[88:91]
    s_waitcnt lgkmcnt(5)
    ds_read_b64_tr_b16 a[230:231], v58 offset:55296
    v_mfma_f32_16x16x32_bf16 v[84:87], a[216:219], a[72:75], v[84:87]
    s_waitcnt lgkmcnt(4)
    ds_read_b64_tr_b16 a[232:233], v59 offset:49152
    v_mfma_f32_16x16x32_bf16 v[84:87], a[220:223], a[76:79], v[84:87]
    buffer_load_dwordx4 v26, s[28:31], s98 offen offset:2048  lds
    ds_read_b64_tr_b16 a[234:235], v59 offset:51200
    v_mfma_f32_16x16x32_bf16 v[92:95], a[216:219], a[88:91], v[92:95]
    ds_read_b64_tr_b16 a[236:237], v59 offset:53248
    v_mfma_f32_16x16x32_bf16 v[92:95], a[220:223], a[92:95], v[92:95]
    s_waitcnt lgkmcnt(5)
    ds_read_b64_tr_b16 a[238:239], v59 offset:55296
    v_mfma_f32_16x16x32_bf16 v[80:83], a[224:227], a[96:99], v[80:83]
    s_waitcnt lgkmcnt(4)
    ds_read_b64_tr_b16 a[240:241], v58 offset:57344
    v_mfma_f32_16x16x32_bf16 v[80:83], a[228:231], a[100:103], v[80:83]
    buffer_load_dwordx4 v27, s[28:31], s98 offen offset:3072  lds
    v_mfma_f32_16x16x32_bf16 v[88:91], a[224:227], a[112:115], v[88:91]
    s_add_u32 m0, s62, 102400
    ds_read_b64_tr_b16 a[242:243], v58 offset:59392
    v_mfma_f32_16x16x32_bf16 v[88:91], a[228:231], a[116:119], v[88:91]
    s_waitcnt lgkmcnt(4)
    s_xor_b32 s98, s65, 295040
    ds_read_b64_tr_b16 a[244:245], v58 offset:61440
    v_mfma_f32_16x16x32_bf16 v[84:87], a[232:235], a[96:99], v[84:87]
    s_waitcnt lgkmcnt(3)
    ds_read_b64_tr_b16 a[246:247], v58 offset:63488
    v_mfma_f32_16x16x32_bf16 v[84:87], a[236:239], a[100:103], v[84:87]
    buffer_load_dwordx4 v24, s[28:31], s98 offen offset:0  lds
    ds_read_b64_tr_b16 a[248:249], v59 offset:57344
    v_mfma_f32_16x16x32_bf16 v[92:95], a[232:235], a[112:115], v[92:95]
    ds_read_b64_tr_b16 a[250:251], v59 offset:59392
    v_mfma_f32_16x16x32_bf16 v[92:95], a[236:239], a[116:119], v[92:95]
    s_waitcnt lgkmcnt(4)
    ds_read_b64_tr_b16 a[252:253], v59 offset:61440
    v_mfma_f32_16x16x32_bf16 v[80:83], a[240:243], a[104:107], v[80:83]
    s_waitcnt lgkmcnt(3)
    ds_read_b64_tr_b16 a[254:255], v59 offset:63488
    v_mfma_f32_16x16x32_bf16 v[80:83], a[244:247], a[108:111], v[80:83]
    buffer_load_dwordx4 v25, s[28:31], s98 offen offset:1024  lds
    v_mfma_f32_16x16x32_bf16 v[88:91], a[240:243], a[120:123], v[88:91]
    ds_read_b64_tr_b16 a[192:193], v60 offset:0
    v_mfma_f32_16x16x32_bf16 v[88:91], a[244:247], a[124:127], v[88:91]
    s_waitcnt lgkmcnt(3)
    ds_read_b64_tr_b16 a[194:195], v60 offset:2048
    v_mfma_f32_16x16x32_bf16 v[84:87], a[248:251], a[104:107], v[84:87]
    s_waitcnt lgkmcnt(2)
    ds_read_b64_tr_b16 a[196:197], v60 offset:4096
    v_mfma_f32_16x16x32_bf16 v[84:87], a[252:255], a[108:111], v[84:87]
    buffer_load_dwordx4 v26, s[28:31], s98 offen offset:2048  lds
    ds_read_b64_tr_b16 a[198:199], v60 offset:6144
    v_mfma_f32_16x16x32_bf16 v[92:95], a[248:251], a[120:123], v[92:95]
    ds_read_b64_tr_b16 a[200:201], v61 offset:0
    v_mfma_f32_16x16x32_bf16 v[92:95], a[252:255], a[124:127], v[92:95]
    s_waitcnt lgkmcnt(3)
    ds_read_b64_tr_b16 a[202:203], v61 offset:2048
    v_mfma_f32_16x16x32_bf16 v[64:67], a[192:195], a[0:3], v[64:67]
    s_waitcnt lgkmcnt(2)
    ds_read_b64_tr_b16 a[204:205], v61 offset:4096
    v_mfma_f32_16x16x32_bf16 v[64:67], a[196:199], a[4:7], v[64:67]
    buffer_load_dwordx4 v27, s[28:31], s98 offen offset:3072  lds
    ds_read_b64_tr_b16 a[206:207], v61 offset:6144
    v_mfma_f32_16x16x32_bf16 v[72:75], a[192:195], a[16:19], v[72:75]
    ds_read_b64_tr_b16 a[208:209], v60 offset:8192
    v_mfma_f32_16x16x32_bf16 v[72:75], a[196:199], a[20:23], v[72:75]
    s_waitcnt lgkmcnt(3)
    ds_read_b64_tr_b16 a[210:211], v60 offset:10240
    v_mfma_f32_16x16x32_bf16 v[68:71], a[200:203], a[0:3], v[68:71]
    s_waitcnt lgkmcnt(2)
    ds_read_b64_tr_b16 a[212:213], v60 offset:12288
    v_mfma_f32_16x16x32_bf16 v[68:71], a[204:207], a[4:7], v[68:71]
    ds_read_b64_tr_b16 a[214:215], v60 offset:14336
    v_mfma_f32_16x16x32_bf16 v[76:79], a[200:203], a[16:19], v[76:79]
    ds_read_b64_tr_b16 a[216:217], v61 offset:8192
    v_mfma_f32_16x16x32_bf16 v[76:79], a[204:207], a[20:23], v[76:79]
    s_waitcnt lgkmcnt(3)
    ds_read_b64_tr_b16 a[218:219], v61 offset:10240
    v_mfma_f32_16x16x32_bf16 v[64:67], a[208:211], a[8:11], v[64:67]
    s_waitcnt lgkmcnt(2)
    ds_read_b64_tr_b16 a[220:221], v61 offset:12288
    v_mfma_f32_16x16x32_bf16 v[64:67], a[212:215], a[12:15], v[64:67]
    ds_read_b64_tr_b16 a[222:223], v61 offset:14336
    v_mfma_f32_16x16x32_bf16 v[72:75], a[208:211], a[24:27], v[72:75]
    ds_read_b64_tr_b16 a[224:225], v60 offset:16384
    v_mfma_f32_16x16x32_bf16 v[72:75], a[212:215], a[28:31], v[72:75]
    s_waitcnt lgkmcnt(3)
    ds_read_b64_tr_b16 a[226:227], v60 offset:18432
    v_mfma_f32_16x16x32_bf16 v[68:71], a[216:219], a[8:11], v[68:71]
    s_waitcnt lgkmcnt(2)
    ds_read_b64_tr_b16 a[228:229], v60 offset:20480
    v_mfma_f32_16x16x32_bf16 v[68:71], a[220:223], a[12:15], v[68:71]
    ds_read_b64_tr_b16 a[230:231], v60 offset:22528
    v_mfma_f32_16x16x32_bf16 v[76:79], a[216:219], a[24:27], v[76:79]
    ds_read_b64_tr_b16 a[232:233], v61 offset:16384
    v_mfma_f32_16x16x32_bf16 v[76:79], a[220:223], a[28:31], v[76:79]
    s_waitcnt lgkmcnt(3)
    ds_read_b64_tr_b16 a[234:235], v61 offset:18432
    v_mfma_f32_16x16x32_bf16 v[64:67], a[224:227], a[32:35], v[64:67]
    s_waitcnt lgkmcnt(2)
    ds_read_b64_tr_b16 a[236:237], v61 offset:20480
    v_mfma_f32_16x16x32_bf16 v[64:67], a[228:231], a[36:39], v[64:67]
    ds_read_b64_tr_b16 a[238:239], v61 offset:22528
    v_mfma_f32_16x16x32_bf16 v[72:75], a[224:227], a[48:51], v[72:75]
    ds_read_b64_tr_b16 a[240:241], v60 offset:24576
    v_mfma_f32_16x16x32_bf16 v[72:75], a[228:231], a[52:55], v[72:75]
    s_waitcnt lgkmcnt(3)
    ds_read_b64_tr_b16 a[242:243], v60 offset:26624
    v_mfma_f32_16x16x32_bf16 v[68:71], a[232:235], a[32:35], v[68:71]
    s_waitcnt lgkmcnt(2)
    ds_read_b64_tr_b16 a[244:245], v60 offset:28672
    v_mfma_f32_16x16x32_bf16 v[68:71], a[236:239], a[36:39], v[68:71]
    ds_read_b64_tr_b16 a[246:247], v60 offset:30720
    v_mfma_f32_16x16x32_bf16 v[76:79], a[232:235], a[48:51], v[76:79]
    ds_read_b64_tr_b16 a[248:249], v61 offset:24576
    v_mfma_f32_16x16x32_bf16 v[76:79], a[236:239], a[52:55], v[76:79]
    s_waitcnt lgkmcnt(3)
    ds_read_b64_tr_b16 a[250:251], v61 offset:26624
    v_mfma_f32_16x16x32_bf16 v[64:67], a[240:243], a[40:43], v[64:67]
    s_waitcnt lgkmcnt(2)
    ds_read_b64_tr_b16 a[252:253], v61 offset:28672
    v_mfma_f32_16x16x32_bf16 v[64:67], a[244:247], a[44:47], v[64:67]
    ds_read_b64_tr_b16 a[254:255], v61 offset:30720
    v_mfma_f32_16x16x32_bf16 v[72:75], a[240:243], a[56:59], v[72:75]
    s_waitcnt lgkmcnt(2)
    ds_read_b64_tr_b16 a[192:193], v62 offset:0
    s_waitcnt vmcnt(16)
    v_mfma_f32_16x16x32_bf16 v[72:75], a[244:247], a[60:63], v[72:75]
    buffer_store_dword v6, v5, s[8:11], s22 offen sc0 sc1
    ds_read_b64_tr_b16 a[194:195], v62 offset:2048
    v_mfma_f32_16x16x32_bf16 v[68:71], a[248:251], a[40:43], v[68:71]
    s_waitcnt lgkmcnt(2)
    ds_read_b64_tr_b16 a[196:197], v62 offset:4096
    v_mfma_f32_16x16x32_bf16 v[68:71], a[252:255], a[44:47], v[68:71]
    ds_read_b64_tr_b16 a[198:199], v62 offset:6144
    v_mfma_f32_16x16x32_bf16 v[76:79], a[248:251], a[56:59], v[76:79]
    ds_read_b64_tr_b16 a[200:201], v63 offset:0
    v_mfma_f32_16x16x32_bf16 v[76:79], a[252:255], a[60:63], v[76:79]
    s_waitcnt lgkmcnt(3)
    ds_read_b64_tr_b16 a[202:203], v63 offset:2048
    v_mfma_f32_16x16x32_bf16 v[80:83], a[192:195], a[0:3], v[80:83]
    s_waitcnt lgkmcnt(2)
    ds_read_b64_tr_b16 a[204:205], v63 offset:4096
    v_mfma_f32_16x16x32_bf16 v[80:83], a[196:199], a[4:7], v[80:83]
    ds_read_b64_tr_b16 a[206:207], v63 offset:6144
    v_mfma_f32_16x16x32_bf16 v[88:91], a[192:195], a[16:19], v[88:91]
    ds_read_b64_tr_b16 a[208:209], v62 offset:8192
    v_mfma_f32_16x16x32_bf16 v[88:91], a[196:199], a[20:23], v[88:91]
    s_waitcnt lgkmcnt(3)
    ds_read_b64_tr_b16 a[210:211], v62 offset:10240
    v_mfma_f32_16x16x32_bf16 v[84:87], a[200:203], a[0:3], v[84:87]
    s_waitcnt lgkmcnt(2)
    ds_read_b64_tr_b16 a[212:213], v62 offset:12288
    v_mfma_f32_16x16x32_bf16 v[84:87], a[204:207], a[4:7], v[84:87]
    ds_read_b64_tr_b16 a[214:215], v62 offset:14336
    v_mfma_f32_16x16x32_bf16 v[92:95], a[200:203], a[16:19], v[92:95]
    ds_read_b64_tr_b16 a[216:217], v63 offset:8192
    v_cvt_pk_bf16_f32 v64, v64, v65
    s_waitcnt vmcnt(1)
    s_barrier
    v_mfma_f32_16x16x32_bf16 v[92:95], a[204:207], a[20:23], v[92:95]
    s_waitcnt lgkmcnt(1)
    s_xor_b32 s74, s24, 0
    ds_read_b64_tr_b16 a[218:219], v63 offset:10240
    v_cvt_pk_bf16_f32 v65, v66, v67
    v_mfma_f32_16x16x32_bf16 v[80:83], a[208:211], a[8:11], v[80:83]
    buffer_load_dwordx4 v[128:131], v1, s[8:11], s74 offen offset:0
    ds_read_b64_tr_b16 a[220:221], v63 offset:12288
    v_mfma_f32_16x16x32_bf16 v[80:83], a[212:215], a[12:15], v[80:83]
    s_xor_b32 s74, s24, 4096
    ds_read_b64_tr_b16 a[222:223], v63 offset:14336
    v_lshrrev_b32 v46, 2, v2
    v_mfma_f32_16x16x32_bf16 v[88:91], a[208:211], a[24:27], v[88:91]
    s_waitcnt lgkmcnt(2)
    ds_read_b64_tr_b16 a[224:225], v62 offset:16384
    v_and_b32 v45, 3, v2
    v_mfma_f32_16x16x32_bf16 v[88:91], a[212:215], a[28:31], v[88:91]
    buffer_load_dwordx4 v[144:147], v1, s[8:11], s74 offen offset:0
    ds_read_b64_tr_b16 a[226:227], v62 offset:18432
    v_mfma_f32_16x16x32_bf16 v[84:87], a[216:219], a[8:11], v[84:87]
    s_waitcnt lgkmcnt(2)
    s_xor_b32 s74, s24, 0
    ds_read_b64_tr_b16 a[228:229], v62 offset:20480
    v_lshlrev_b32 v44, 8, v46
    v_mfma_f32_16x16x32_bf16 v[84:87], a[220:223], a[12:15], v[84:87]
    ds_read_b64_tr_b16 a[230:231], v62 offset:22528
    v_lshl_add_u32 v44, v45, 4, v44
    v_mfma_f32_16x16x32_bf16 v[92:95], a[216:219], a[24:27], v[92:95]
    buffer_load_dwordx4 v[132:135], v1, s[8:11], s74 offen offset:1024
    ds_read_b64_tr_b16 a[232:233], v63 offset:16384
    v_mfma_f32_16x16x32_bf16 v[92:95], a[220:223], a[28:31], v[92:95]
    s_waitcnt lgkmcnt(3)
    s_xor_b32 s74, s24, 4096
    ds_read_b64_tr_b16 a[234:235], v63 offset:18432
    v_lshlrev_b32 v45, 3, v45
    v_mfma_f32_16x16x32_bf16 v[80:83], a[224:227], a[32:35], v[80:83]
    s_waitcnt lgkmcnt(2)
    ds_read_b64_tr_b16 a[236:237], v63 offset:20480
    v_lshl_add_u32 v45, v46, 6, v45
    v_mfma_f32_16x16x32_bf16 v[80:83], a[228:231], a[36:39], v[80:83]
    buffer_load_dwordx4 v[148:151], v1, s[8:11], s74 offen offset:1024
    ds_read_b64_tr_b16 a[238:239], v63 offset:22528
    v_mfma_f32_16x16x32_bf16 v[88:91], a[224:227], a[48:51], v[88:91]
    s_xor_b32 s74, s24, 0
    ds_read_b64_tr_b16 a[240:241], v62 offset:24576
    v_lshlrev_b32 v46, 1, v45
    v_mfma_f32_16x16x32_bf16 v[88:91], a[228:231], a[52:55], v[88:91]
    s_waitcnt lgkmcnt(1)
    s_lshl_b32 s70, s2, 15
    ds_read_b64_tr_b16 a[242:243], v62 offset:26624
    v_cvt_pk_bf16_f32 v66, v68, v69
    v_mfma_f32_16x16x32_bf16 v[84:87], a[232:235], a[32:35], v[84:87]
    buffer_load_dwordx4 v[136:139], v1, s[8:11], s74 offen offset:2048
    ds_read_b64_tr_b16 a[244:245], v62 offset:28672
    v_mfma_f32_16x16x32_bf16 v[84:87], a[236:239], a[36:39], v[84:87]
    s_xor_b32 s74, s24, 4096
    ds_read_b64_tr_b16 a[246:247], v62 offset:30720
    v_cvt_pk_bf16_f32 v67, v70, v71
    v_mfma_f32_16x16x32_bf16 v[92:95], a[232:235], a[48:51], v[92:95]
    s_waitcnt lgkmcnt(2)
    s_lshl_b32 s100, s3, 6
    ds_read_b64_tr_b16 a[248:249], v63 offset:24576
    v_min_u32 v64, -2, v64
    v_mfma_f32_16x16x32_bf16 v[92:95], a[236:239], a[52:55], v[92:95]
    buffer_load_dwordx4 v[152:155], v1, s[8:11], s74 offen offset:2048
    ds_read_b64_tr_b16 a[250:251], v63 offset:26624
    v_mfma_f32_16x16x32_bf16 v[80:83], a[240:243], a[40:43], v[80:83]
    s_waitcnt lgkmcnt(2)
    s_xor_b32 s74, s24, 0
    ds_read_b64_tr_b16 a[252:253], v63 offset:28672
    v_min_u32 v65, -2, v65
    v_mfma_f32_16x16x32_bf16 v[80:83], a[244:247], a[44:47], v[80:83]
    s_add_u32 s70, s70, s100
    ds_read_b64_tr_b16 a[254:255], v63 offset:30720
    v_min_u32 v66, -2, v66
    v_mfma_f32_16x16x32_bf16 v[88:91], a[240:243], a[56:59], v[88:91]
    buffer_load_dwordx4 v[140:143], v1, s[8:11], s74 offen offset:3072
    v_mfma_f32_16x16x32_bf16 v[88:91], a[244:247], a[60:63], v[88:91]
    s_waitcnt lgkmcnt(2)
    s_xor_b32 s74, s24, 4096
    ds_read_b64_tr_b16 a[192:193], v56 offset:0
    v_min_u32 v67, -2, v67
    v_mfma_f32_16x16x32_bf16 v[84:87], a[248:251], a[40:43], v[84:87]
    s_waitcnt lgkmcnt(1)
    s_add_u32 s70, s70, 67108864
    ds_read_b64_tr_b16 a[194:195], v56 offset:2048
    v_mfma_f32_16x16x32_bf16 v[84:87], a[252:255], a[44:47], v[84:87]
    buffer_load_dwordx4 v[156:159], v1, s[8:11], s74 offen offset:3072
    ds_read_b64_tr_b16 a[196:197], v56 offset:4096
    v_mfma_f32_16x16x32_bf16 v[92:95], a[248:251], a[56:59], v[92:95]
    s_and_b32 s68, s2, 31
    ds_read_b64_tr_b16 a[198:199], v56 offset:6144
    v_mfma_f32_16x16x32_bf16 v[92:95], a[252:255], a[60:63], v[92:95]
    s_waitcnt lgkmcnt(2)
    s_lshl_b32 s68, s68, 2
    ds_read_b64_tr_b16 a[200:201], v57 offset:0
    v_mfma_f32_16x16x32_bf16 v[96:99], a[192:195], a[64:67], 0
    s_waitcnt lgkmcnt(1)
    s_add_u32 s68, s68, s3
    ds_read_b64_tr_b16 a[202:203], v57 offset:2048
    v_mfma_f32_16x16x32_bf16 v[96:99], a[196:199], a[68:71], v[96:99]
    s_lshl_b32 s69, s61, 7
    ds_read_b64_tr_b16 a[204:205], v57 offset:4096
    v_mfma_f32_16x16x32_bf16 v[104:107], a[192:195], a[80:83], 0
    s_add_u32 s69, s69, s68
    ds_read_b64_tr_b16 a[206:207], v57 offset:6144
    v_mfma_f32_16x16x32_bf16 v[104:107], a[196:199], a[84:87], v[104:107]
    s_waitcnt lgkmcnt(2)
    s_lshl_b32 s100, s60, 7
    ds_read_b64_tr_b16 a[208:209], v56 offset:8192
    v_mfma_f32_16x16x32_bf16 v[100:103], a[200:203], a[64:67], 0
    s_waitcnt lgkmcnt(1)
    s_add_u32 s68, s68, s100
    ds_read_b64_tr_b16 a[210:211], v56 offset:10240
    v_mfma_f32_16x16x32_bf16 v[100:103], a[204:207], a[68:71], v[100:103]
    s_lshl_b32 s100, s68, 10
    ds_read_b64_tr_b16 a[212:213], v56 offset:12288
    v_mfma_f32_16x16x32_bf16 v[108:111], a[200:203], a[80:83], 0
    s_lshl_b32 s101, s69, 10
    ds_read_b64_tr_b16 a[214:215], v56 offset:14336
    v_cvt_pk_bf16_f32 v80, v80, v81
    v_mfma_f32_16x16x32_bf16 v[108:111], a[204:207], a[84:87], v[108:111]
    s_waitcnt lgkmcnt(0)
    s_add_u32 s75, s18, 0
    ds_read_b64_tr_b16 a[216:217], v57 offset:8192
    v_cvt_pk_bf16_f32 v81, v82, v83
    v_mfma_f32_16x16x32_bf16 v[96:99], a[208:211], a[72:75], v[96:99]
    buffer_store_dwordx4 v[64:67], v23, s[8:11], s75 offen offset:0 sc0 sc1
    ds_read_b64_tr_b16 a[218:219], v57 offset:10240
    v_mfma_f32_16x16x32_bf16 v[96:99], a[212:215], a[76:79], v[96:99]
    ds_read_b64_tr_b16 a[220:221], v57 offset:12288
    v_cvt_pk_bf16_f32 v72, v72, v73
    v_mfma_f32_16x16x32_bf16 v[104:107], a[208:211], a[88:91], v[104:107]
    ds_read_b64_tr_b16 a[222:223], v57 offset:14336
    v_cvt_pk_bf16_f32 v73, v74, v75
    v_mfma_f32_16x16x32_bf16 v[104:107], a[212:215], a[92:95], v[104:107]
    s_waitcnt lgkmcnt(2)
    ds_read_b64_tr_b16 a[224:225], v56 offset:16384
    v_cvt_pk_bf16_f32 v74, v76, v77
    v_mfma_f32_16x16x32_bf16 v[100:103], a[216:219], a[72:75], v[100:103]
    s_waitcnt lgkmcnt(1)
    ds_read_b64_tr_b16 a[226:227], v56 offset:18432
    v_cvt_pk_bf16_f32 v75, v78, v79
    v_mfma_f32_16x16x32_bf16 v[100:103], a[220:223], a[76:79], v[100:103]
    ds_read_b64_tr_b16 a[228:229], v56 offset:20480
    v_min_u32 v72, -2, v72
    v_mfma_f32_16x16x32_bf16 v[108:111], a[216:219], a[88:91], v[108:111]
    ds_read_b64_tr_b16 a[230:231], v56 offset:22528
    v_min_u32 v73, -2, v73
    v_mfma_f32_16x16x32_bf16 v[108:111], a[220:223], a[92:95], v[108:111]
    s_waitcnt lgkmcnt(2)
    ds_read_b64_tr_b16 a[232:233], v57 offset:16384
    v_min_u32 v74, -2, v74
    v_mfma_f32_16x16x32_bf16 v[96:99], a[224:227], a[96:99], v[96:99]
    s_waitcnt lgkmcnt(1)
    ds_read_b64_tr_b16 a[234:235], v57 offset:18432
    v_min_u32 v75, -2, v75
    v_mfma_f32_16x16x32_bf16 v[96:99], a[228:231], a[100:103], v[96:99]
    s_add_u32 s75, s18, 131072
    ds_read_b64_tr_b16 a[236:237], v57 offset:20480
    v_cvt_pk_bf16_f32 v82, v84, v85
    v_mfma_f32_16x16x32_bf16 v[104:107], a[224:227], a[112:115], v[104:107]
    buffer_store_dwordx4 v[72:75], v23, s[8:11], s75 offen offset:0 sc0 sc1
    ds_read_b64_tr_b16 a[238:239], v57 offset:22528
    v_mfma_f32_16x16x32_bf16 v[104:107], a[228:231], a[116:119], v[104:107]
    s_waitcnt lgkmcnt(2)
    ds_read_b64_tr_b16 a[240:241], v56 offset:24576
    v_cvt_pk_bf16_f32 v83, v86, v87
    v_mfma_f32_16x16x32_bf16 v[100:103], a[232:235], a[96:99], v[100:103]
    s_waitcnt lgkmcnt(1)
    ds_read_b64_tr_b16 a[242:243], v56 offset:26624
    v_min_u32 v80, -2, v80
    v_mfma_f32_16x16x32_bf16 v[100:103], a[236:239], a[100:103], v[100:103]
    ds_read_b64_tr_b16 a[244:245], v56 offset:28672
    v_min_u32 v81, -2, v81
    v_mfma_f32_16x16x32_bf16 v[108:111], a[232:235], a[112:115], v[108:111]
    ds_read_b64_tr_b16 a[246:247], v56 offset:30720
    v_min_u32 v82, -2, v82
    v_mfma_f32_16x16x32_bf16 v[108:111], a[236:239], a[116:119], v[108:111]
    s_waitcnt lgkmcnt(2)
    ds_read_b64_tr_b16 a[248:249], v57 offset:24576
    v_min_u32 v83, -2, v83
    v_mfma_f32_16x16x32_bf16 v[96:99], a[240:243], a[104:107], v[96:99]
    s_waitcnt lgkmcnt(1)
    s_add_u32 s75, s18, 0
    ds_read_b64_tr_b16 a[250:251], v57 offset:26624
    v_mfma_f32_16x16x32_bf16 v[96:99], a[244:247], a[108:111], v[96:99]
    buffer_store_dwordx4 v[80:83], v23, s[8:11], s75 offen offset:256 sc0 sc1
    ds_read_b64_tr_b16 a[252:253], v57 offset:28672
    v_mfma_f32_16x16x32_bf16 v[104:107], a[240:243], a[120:123], v[104:107]
    ds_read_b64_tr_b16 a[254:255], v57 offset:30720
    v_cvt_pk_bf16_f32 v88, v88, v89
    v_mfma_f32_16x16x32_bf16 v[104:107], a[244:247], a[124:127], v[104:107]
    s_waitcnt lgkmcnt(2)
    ds_read_b64_tr_b16 a[192:193], v60 offset:32768
    v_cvt_pk_bf16_f32 v89, v90, v91
    v_mfma_f32_16x16x32_bf16 v[100:103], a[248:251], a[104:107], v[100:103]
    s_waitcnt lgkmcnt(1)
    ds_read_b64_tr_b16 a[194:195], v60 offset:34816
    v_cvt_pk_bf16_f32 v90, v92, v93
    v_mfma_f32_16x16x32_bf16 v[100:103], a[252:255], a[108:111], v[100:103]
    ds_read_b64_tr_b16 a[196:197], v60 offset:36864
    v_cvt_pk_bf16_f32 v91, v94, v95
    v_mfma_f32_16x16x32_bf16 v[108:111], a[248:251], a[120:123], v[108:111]
    ds_read_b64_tr_b16 a[198:199], v60 offset:38912
    v_min_u32 v88, -2, v88
    v_mfma_f32_16x16x32_bf16 v[108:111], a[252:255], a[124:127], v[108:111]
    s_waitcnt lgkmcnt(2)
    ds_read_b64_tr_b16 a[200:201], v61 offset:32768
    v_min_u32 v89, -2, v89
    v_mfma_f32_16x16x32_bf16 v[96:99], a[192:195], a[0:3], v[96:99]
    s_waitcnt lgkmcnt(1)
    ds_read_b64_tr_b16 a[202:203], v61 offset:34816
    v_min_u32 v90, -2, v90
    v_mfma_f32_16x16x32_bf16 v[96:99], a[196:199], a[4:7], v[96:99]
    ds_read_b64_tr_b16 a[204:205], v61 offset:36864
    v_min_u32 v91, -2, v91
    v_mfma_f32_16x16x32_bf16 v[104:107], a[192:195], a[16:19], v[104:107]
    s_waitcnt lgkmcnt(1)
    s_add_u32 s75, s18, 131072
    ds_read_b64_tr_b16 a[206:207], v61 offset:38912
    v_mfma_f32_16x16x32_bf16 v[104:107], a[196:199], a[20:23], v[104:107]
    buffer_store_dwordx4 v[88:91], v23, s[8:11], s75 offen offset:256 sc0 sc1
    ds_read_b64_tr_b16 a[208:209], v60 offset:40960
    v_mfma_f32_16x16x32_bf16 v[100:103], a[200:203], a[0:3], v[100:103]
    s_waitcnt lgkmcnt(1)
    ds_read_b64_tr_b16 a[210:211], v60 offset:43008
    v_mfma_f32_16x16x32_bf16 v[100:103], a[204:207], a[4:7], v[100:103]
    ds_read_b64_tr_b16 a[212:213], v60 offset:45056
    v_mfma_f32_16x16x32_bf16 v[108:111], a[200:203], a[16:19], v[108:111]
    ds_read_b64_tr_b16 a[214:215], v60 offset:47104
    v_mfma_f32_16x16x32_bf16 v[108:111], a[204:207], a[20:23], v[108:111]
    s_waitcnt lgkmcnt(2)
    ds_read_b64_tr_b16 a[216:217], v61 offset:40960
    v_mfma_f32_16x16x32_bf16 v[96:99], a[208:211], a[8:11], v[96:99]
    s_waitcnt lgkmcnt(1)
    ds_read_b64_tr_b16 a[218:219], v61 offset:43008
    v_mfma_f32_16x16x32_bf16 v[96:99], a[212:215], a[12:15], v[96:99]
    ds_read_b64_tr_b16 a[220:221], v61 offset:45056
    v_mfma_f32_16x16x32_bf16 v[104:107], a[208:211], a[24:27], v[104:107]
    buffer_load_dword v3, v4, s[8:11], s23 offen sc0 sc1
    ds_read_b64_tr_b16 a[222:223], v61 offset:47104
    v_mfma_f32_16x16x32_bf16 v[104:107], a[212:215], a[28:31], v[104:107]
    s_waitcnt lgkmcnt(2)
    ds_read_b64_tr_b16 a[224:225], v60 offset:49152
    v_mfma_f32_16x16x32_bf16 v[100:103], a[216:219], a[8:11], v[100:103]
    s_waitcnt lgkmcnt(1)
    ds_read_b64_tr_b16 a[226:227], v60 offset:51200
    v_mfma_f32_16x16x32_bf16 v[100:103], a[220:223], a[12:15], v[100:103]
    ds_read_b64_tr_b16 a[228:229], v60 offset:53248
    v_mfma_f32_16x16x32_bf16 v[108:111], a[216:219], a[24:27], v[108:111]
    ds_read_b64_tr_b16 a[230:231], v60 offset:55296
    v_mfma_f32_16x16x32_bf16 v[108:111], a[220:223], a[28:31], v[108:111]
    s_waitcnt lgkmcnt(2)
    ds_read_b64_tr_b16 a[232:233], v61 offset:49152
    v_mfma_f32_16x16x32_bf16 v[96:99], a[224:227], a[32:35], v[96:99]
    s_waitcnt lgkmcnt(1)
    ds_read_b64_tr_b16 a[234:235], v61 offset:51200
    v_mfma_f32_16x16x32_bf16 v[96:99], a[228:231], a[36:39], v[96:99]
    ds_read_b64_tr_b16 a[236:237], v61 offset:53248
    v_mfma_f32_16x16x32_bf16 v[104:107], a[224:227], a[48:51], v[104:107]
    ds_read_b64_tr_b16 a[238:239], v61 offset:55296
    v_mfma_f32_16x16x32_bf16 v[104:107], a[228:231], a[52:55], v[104:107]
    s_waitcnt lgkmcnt(2)
    ds_read_b64_tr_b16 a[240:241], v60 offset:57344
    v_mfma_f32_16x16x32_bf16 v[100:103], a[232:235], a[32:35], v[100:103]
    s_waitcnt lgkmcnt(1)
    ds_read_b64_tr_b16 a[242:243], v60 offset:59392
    v_mfma_f32_16x16x32_bf16 v[100:103], a[236:239], a[36:39], v[100:103]
    ds_read_b64_tr_b16 a[244:245], v60 offset:61440
    v_mfma_f32_16x16x32_bf16 v[108:111], a[232:235], a[48:51], v[108:111]
    ds_read_b64_tr_b16 a[246:247], v60 offset:63488
    v_mfma_f32_16x16x32_bf16 v[108:111], a[236:239], a[52:55], v[108:111]
    s_waitcnt lgkmcnt(2)
    ds_read_b64_tr_b16 a[248:249], v61 offset:57344
    v_mfma_f32_16x16x32_bf16 v[96:99], a[240:243], a[40:43], v[96:99]
    s_waitcnt lgkmcnt(1)
    ds_read_b64_tr_b16 a[250:251], v61 offset:59392
    v_mfma_f32_16x16x32_bf16 v[96:99], a[244:247], a[44:47], v[96:99]
    ds_read_b64_tr_b16 a[252:253], v61 offset:61440
    v_mfma_f32_16x16x32_bf16 v[104:107], a[240:243], a[56:59], v[104:107]
    ds_read_b64_tr_b16 a[254:255], v61 offset:63488
    v_mfma_f32_16x16x32_bf16 v[104:107], a[244:247], a[60:63], v[104:107]
    s_waitcnt lgkmcnt(2)
    ds_read_b64_tr_b16 a[192:193], v58 offset:0
    v_mfma_f32_16x16x32_bf16 v[100:103], a[248:251], a[40:43], v[100:103]
    s_waitcnt lgkmcnt(1)
    ds_read_b64_tr_b16 a[194:195], v58 offset:2048
    v_mfma_f32_16x16x32_bf16 v[100:103], a[252:255], a[44:47], v[100:103]
    ds_read_b64_tr_b16 a[196:197], v58 offset:4096
    v_mfma_f32_16x16x32_bf16 v[108:111], a[248:251], a[56:59], v[108:111]
    ds_read_b64_tr_b16 a[198:199], v58 offset:6144
    v_mfma_f32_16x16x32_bf16 v[108:111], a[252:255], a[60:63], v[108:111]
    s_waitcnt lgkmcnt(2)
    ds_read_b64_tr_b16 a[200:201], v59 offset:0
    v_mfma_f32_16x16x32_bf16 v[112:115], a[192:195], a[64:67], 0
    s_waitcnt lgkmcnt(1)
    ds_read_b64_tr_b16 a[202:203], v59 offset:2048
    v_mfma_f32_16x16x32_bf16 v[112:115], a[196:199], a[68:71], v[112:115]
    ds_read_b64_tr_b16 a[204:205], v59 offset:4096
    v_mfma_f32_16x16x32_bf16 v[120:123], a[192:195], a[80:83], 0
    ds_read_b64_tr_b16 a[206:207], v59 offset:6144
    v_mfma_f32_16x16x32_bf16 v[120:123], a[196:199], a[84:87], v[120:123]
    s_waitcnt lgkmcnt(2)
    ds_read_b64_tr_b16 a[208:209], v58 offset:8192
    v_mfma_f32_16x16x32_bf16 v[116:119], a[200:203], a[64:67], 0
    s_waitcnt lgkmcnt(1)
    ds_read_b64_tr_b16 a[210:211], v58 offset:10240
    v_mfma_f32_16x16x32_bf16 v[116:119], a[204:207], a[68:71], v[116:119]
    ds_read_b64_tr_b16 a[212:213], v58 offset:12288
    v_mfma_f32_16x16x32_bf16 v[124:127], a[200:203], a[80:83], 0
    ds_read_b64_tr_b16 a[214:215], v58 offset:14336
    v_mfma_f32_16x16x32_bf16 v[124:127], a[204:207], a[84:87], v[124:127]
    s_waitcnt lgkmcnt(2)
    ds_read_b64_tr_b16 a[216:217], v59 offset:8192
    v_mfma_f32_16x16x32_bf16 v[112:115], a[208:211], a[72:75], v[112:115]
    s_waitcnt lgkmcnt(1)
    ds_read_b64_tr_b16 a[218:219], v59 offset:10240
    v_cvt_pk_bf16_f32 v96, v96, v97
    s_waitcnt vmcnt(0)
    v_cmp_ne_u32 vcc, 0, v3
    s_cmp_eq_u64 vcc, -1
    s_cbranch_scc0 L_C2_slow_13
L_C2_ok_14:
    v_mfma_f32_16x16x32_bf16 v[112:115], a[212:215], a[76:79], v[112:115]
    s_xor_b32 s74, s24, 8192
    ds_read_b64_tr_b16 a[220:221], v59 offset:12288
    v_cvt_pk_bf16_f32 v97, v98, v99
    v_mfma_f32_16x16x32_bf16 v[120:123], a[208:211], a[88:91], v[120:123]
    buffer_load_dwordx4 v[160:163], v1, s[8:11], s74 offen offset:0
    ds_read_b64_tr_b16 a[222:223], v59 offset:14336
    v_mfma_f32_16x16x32_bf16 v[120:123], a[212:215], a[92:95], v[120:123]
    s_waitcnt lgkmcnt(2)
    s_xor_b32 s74, s24, 12288
    ds_read_b64_tr_b16 a[224:225], v58 offset:16384
    v_cvt_pk_bf16_f32 v98, v100, v101
    v_mfma_f32_16x16x32_bf16 v[116:119], a[216:219], a[72:75], v[116:119]
    s_waitcnt lgkmcnt(1)
    ds_read_b64_tr_b16 a[226:227], v58 offset:18432
    v_cvt_pk_bf16_f32 v99, v102, v103
    v_mfma_f32_16x16x32_bf16 v[116:119], a[220:223], a[76:79], v[116:119]
    ds_read_b64_tr_b16 a[228:229], v58 offset:20480
    v_min_u32 v96, -2, v96
    v_mfma_f32_16x16x32_bf16 v[124:127], a[216:219], a[88:91], v[124:127]
    buffer_load_dwordx4 v[176:179], v1, s[8:11], s74 offen offset:0
    ds_read_b64_tr_b16 a[230:231], v58 offset:22528
    v_mfma_f32_16x16x32_bf16 v[124:127], a[220:223], a[92:95], v[124:127]
    s_waitcnt lgkmcnt(2)
    s_xor_b32 s74, s24, 8192
    ds_read_b64_tr_b16 a[232:233], v59 offset:16384
    v_min_u32 v97, -2, v97
    v_mfma_f32_16x16x32_bf16 v[112:115], a[224:227], a[96:99], v[112:115]
    s_waitcnt lgkmcnt(1)
    ds_read_b64_tr_b16 a[234:235], v59 offset:18432
    v_min_u32 v98, -2, v98
    v_mfma_f32_16x16x32_bf16 v[112:115], a[228:231], a[100:103], v[112:115]
    ds_read_b64_tr_b16 a[236:237], v59 offset:20480
    v_min_u32 v99, -2, v99
    v_mfma_f32_16x16x32_bf16 v[120:123], a[224:227], a[112:115], v[120:123]
    buffer_load_dwordx4 v[164:167], v1, s[8:11], s74 offen offset:1024
    ds_read_b64_tr_b16 a[238:239], v59 offset:22528
    v_mfma_f32_16x16x32_bf16 v[120:123], a[228:231], a[116:119], v[120:123]
    s_waitcnt lgkmcnt(2)
    s_xor_b32 s74, s24, 12288
    ds_read_b64_tr_b16 a[240:241], v58 offset:24576
    v_mfma_f32_16x16x32_bf16 v[116:119], a[232:235], a[96:99], v[116:119]
    s_waitcnt lgkmcnt(1)
    s_add_u32 s75, s18, 0
    ds_read_b64_tr_b16 a[242:243], v58 offset:26624
    v_mfma_f32_16x16x32_bf16 v[116:119], a[236:239], a[100:103], v[116:119]
    buffer_store_dwordx4 v[96:99], v23, s[8:11], s75 offen offset:512 sc0 sc1
    ds_read_b64_tr_b16 a[244:245], v58 offset:28672
    v_mfma_f32_16x16x32_bf16 v[124:127], a[232:235], a[112:115], v[124:127]
    buffer_load_dwordx4 v[180:183], v1, s[8:11], s74 offen offset:1024
    ds_read_b64_tr_b16 a[246:247], v58 offset:30720
    v_mfma_f32_16x16x32_bf16 v[124:127], a[236:239], a[116:119], v[124:127]
    s_waitcnt lgkmcnt(2)
    s_xor_b32 s74, s24, 8192
    ds_read_b64_tr_b16 a[248:249], v59 offset:24576
    v_cvt_pk_bf16_f32 v104, v104, v105
    v_mfma_f32_16x16x32_bf16 v[112:115], a[240:243], a[104:107], v[112:115]
    s_waitcnt lgkmcnt(1)
    ds_read_b64_tr_b16 a[250:251], v59 offset:26624
    v_cvt_pk_bf16_f32 v105, v106, v107
    v_mfma_f32_16x16x32_bf16 v[112:115], a[244:247], a[108:111], v[112:115]
    ds_read_b64_tr_b16 a[252:253], v59 offset:28672
    v_cvt_pk_bf16_f32 v106, v108, v109
    v_mfma_f32_16x16x32_bf16 v[120:123], a[240:243], a[120:123], v[120:123]
    buffer_load_dwordx4 v[168:171], v1, s[8:11], s74 offen offset:2048
    ds_read_b64_tr_b16 a[254:255], v59 offset:30720
    v_mfma_f32_16x16x32_bf16 v[120:123], a[244:247], a[124:127], v[120:123]
    s_waitcnt lgkmcnt(2)
    s_xor_b32 s74, s24, 12288
    ds_read_b64_tr_b16 a[192:193], v62 offset:32768
    v_cvt_pk_bf16_f32 v107, v110, v111
    v_mfma_f32_16x16x32_bf16 v[116:119], a[248:251], a[104:107], v[116:119]
    s_waitcnt lgkmcnt(1)
    ds_read_b64_tr_b16 a[194:195], v62 offset:34816
    v_min_u32 v104, -2, v104
    v_mfma_f32_16x16x32_bf16 v[116:119], a[252:255], a[108:111], v[116:119]
    ds_read_b64_tr_b16 a[196:197], v62 offset:36864
    v_min_u32 v105, -2, v105
    v_mfma_f32_16x16x32_bf16 v[124:127], a[248:251], a[120:123], v[124:127]
    buffer_load_dwordx4 v[184:187], v1, s[8:11], s74 offen offset:2048
    ds_read_b64_tr_b16 a[198:199], v62 offset:38912
    v_mfma_f32_16x16x32_bf16 v[124:127], a[252:255], a[124:127], v[124:127]
    s_waitcnt lgkmcnt(2)
    s_xor_b32 s74, s24, 8192
    ds_read_b64_tr_b16 a[200:201], v63 offset:32768
    v_min_u32 v106, -2, v106
    v_mfma_f32_16x16x32_bf16 v[112:115], a[192:195], a[0:3], v[112:115]
    s_waitcnt lgkmcnt(1)
    ds_read_b64_tr_b16 a[202:203], v63 offset:34816
    v_min_u32 v107, -2, v107
    v_mfma_f32_16x16x32_bf16 v[112:115], a[196:199], a[4:7], v[112:115]
    s_add_u32 s75, s18, 131072
    ds_read_b64_tr_b16 a[204:205], v63 offset:36864
    v_mfma_f32_16x16x32_bf16 v[120:123], a[192:195], a[16:19], v[120:123]
    buffer_load_dwordx4 v[172:175], v1, s[8:11], s74 offen offset:3072
    ds_read_b64_tr_b16 a[206:207], v63 offset:38912
    v_mfma_f32_16x16x32_bf16 v[120:123], a[196:199], a[20:23], v[120:123]
    s_waitcnt lgkmcnt(0)
    s_xor_b32 s74, s24, 12288
    ds_read_b64_tr_b16 a[208:209], v62 offset:40960
    v_mfma_f32_16x16x32_bf16 v[116:119], a[200:203], a[0:3], v[116:119]
    buffer_store_dwordx4 v[104:107], v23, s[8:11], s75 offen offset:512 sc0 sc1
    ds_read_b64_tr_b16 a[210:211], v62 offset:43008
    v_mfma_f32_16x16x32_bf16 v[116:119], a[204:207], a[4:7], v[116:119]
    ds_read_b64_tr_b16 a[212:213], v62 offset:45056
    v_mfma_f32_16x16x32_bf16 v[124:127], a[200:203], a[16:19], v[124:127]
    buffer_load_dwordx4 v[188:191], v1, s[8:11], s74 offen offset:3072
    ds_read_b64_tr_b16 a[214:215], v62 offset:47104
    v_mfma_f32_16x16x32_bf16 v[124:127], a[204:207], a[20:23], v[124:127]
    s_waitcnt lgkmcnt(2)
    ds_read_b64_tr_b16 a[216:217], v63 offset:40960
    v_mfma_f32_16x16x32_bf16 v[112:115], a[208:211], a[8:11], v[112:115]
    s_waitcnt lgkmcnt(1)
    ds_read_b64_tr_b16 a[218:219], v63 offset:43008
    ds_read_b64_tr_b16 a[192:193], v56 offset:32768
    v_mfma_f32_16x16x32_bf16 v[112:115], a[212:215], a[12:15], v[112:115]
    ds_read_b64_tr_b16 a[220:221], v63 offset:45056
    ds_read_b64_tr_b16 a[194:195], v56 offset:34816
    v_mfma_f32_16x16x32_bf16 v[120:123], a[208:211], a[24:27], v[120:123]
    ds_read_b64_tr_b16 a[222:223], v63 offset:47104
    ds_read_b64_tr_b16 a[196:197], v56 offset:36864
    v_mfma_f32_16x16x32_bf16 v[120:123], a[212:215], a[28:31], v[120:123]
    s_waitcnt lgkmcnt(5)
    ds_read_b64_tr_b16 a[224:225], v62 offset:49152
    ds_read_b64_tr_b16 a[198:199], v56 offset:38912
    v_mfma_f32_16x16x32_bf16 v[116:119], a[216:219], a[8:11], v[116:119]
    s_waitcnt lgkmcnt(3)
    ds_read_b64_tr_b16 a[226:227], v62 offset:51200
    ds_read_b64_tr_b16 a[200:201], v57 offset:32768
    v_mfma_f32_16x16x32_bf16 v[116:119], a[220:223], a[12:15], v[116:119]
    ds_read_b64_tr_b16 a[228:229], v62 offset:53248
    ds_read_b64_tr_b16 a[202:203], v57 offset:34816
    v_mfma_f32_16x16x32_bf16 v[124:127], a[216:219], a[24:27], v[124:127]
    ds_read_b64_tr_b16 a[230:231], v62 offset:55296
    ds_read_b64_tr_b16 a[204:205], v57 offset:36864
    v_mfma_f32_16x16x32_bf16 v[124:127], a[220:223], a[28:31], v[124:127]
    s_waitcnt lgkmcnt(5)
    ds_read_b64_tr_b16 a[232:233], v63 offset:49152
    ds_read_b64_tr_b16 a[206:207], v57 offset:38912
    v_mfma_f32_16x16x32_bf16 v[112:115], a[224:227], a[32:35], v[112:115]
    s_waitcnt lgkmcnt(3)
    ds_read_b64_tr_b16 a[234:235], v63 offset:51200
    v_mfma_f32_16x16x32_bf16 v[112:115], a[228:231], a[36:39], v[112:115]
    ds_read_b64_tr_b16 a[236:237], v63 offset:53248
    v_mfma_f32_16x16x32_bf16 v[120:123], a[224:227], a[48:51], v[120:123]
    ds_read_b64_tr_b16 a[238:239], v63 offset:55296
    v_mfma_f32_16x16x32_bf16 v[120:123], a[228:231], a[52:55], v[120:123]
    s_waitcnt lgkmcnt(2)
    ds_read_b64_tr_b16 a[240:241], v62 offset:57344
    v_mfma_f32_16x16x32_bf16 v[116:119], a[232:235], a[32:35], v[116:119]
    s_waitcnt lgkmcnt(1)
    ds_read_b64_tr_b16 a[242:243], v62 offset:59392
    v_mfma_f32_16x16x32_bf16 v[116:119], a[236:239], a[36:39], v[116:119]
    ds_read_b64_tr_b16 a[244:245], v62 offset:61440
    v_mfma_f32_16x16x32_bf16 v[124:127], a[232:235], a[48:51], v[124:127]
    ds_read_b64_tr_b16 a[246:247], v62 offset:63488
    v_mfma_f32_16x16x32_bf16 v[124:127], a[236:239], a[52:55], v[124:127]
    s_waitcnt lgkmcnt(2)
    ds_read_b64_tr_b16 a[248:249], v63 offset:57344
    v_mfma_f32_16x16x32_bf16 v[112:115], a[240:243], a[40:43], v[112:115]
    s_waitcnt lgkmcnt(1)
    ds_read_b64_tr_b16 a[250:251], v63 offset:59392
    v_mfma_f32_16x16x32_bf16 v[112:115], a[244:247], a[44:47], v[112:115]
    ds_read_b64_tr_b16 a[252:253], v63 offset:61440
    v_mfma_f32_16x16x32_bf16 v[120:123], a[240:243], a[56:59], v[120:123]
    s_waitcnt lgkmcnt(1)
    s_xor_b32 s74, s24, 16384
    ds_read_b64_tr_b16 a[254:255], v63 offset:63488
    v_mfma_f32_16x16x32_bf16 v[120:123], a[244:247], a[60:63], v[120:123]
    buffer_load_dwordx4 v[192:195], v1, s[8:11], s74 offen offset:0
    v_mfma_f32_16x16x32_bf16 v[116:119], a[248:251], a[40:43], v[116:119]
    s_waitcnt lgkmcnt(0)
    s_xor_b32 s74, s24, 20480
    ds_read_b64_tr_b16 a[208:209], v56 offset:40960
    v_mfma_f32_16x16x32_bf16 v[116:119], a[252:255], a[44:47], v[116:119]
    ds_read_b64_tr_b16 a[210:211], v56 offset:43008
    v_mfma_f32_16x16x32_bf16 v[124:127], a[248:251], a[56:59], v[124:127]
    ds_read_b64_tr_b16 a[212:213], v56 offset:45056
    v_mfma_f32_16x16x32_bf16 v[124:127], a[252:255], a[60:63], v[124:127]
    ds_read_b64_tr_b16 a[214:215], v56 offset:47104
    v_mfma_f32_16x16x32_bf16 v[64:67], a[192:195], v[128:131], 0
    buffer_load_dwordx4 v[208:211], v1, s[8:11], s74 offen offset:0
    v_mfma_f32_16x16x32_bf16 v[64:67], a[196:199], v[132:135], v[64:67]
    s_xor_b32 s74, s24, 16384
    ds_read_b64_tr_b16 a[216:217], v57 offset:40960
    v_mfma_f32_16x16x32_bf16 v[72:75], a[192:195], v[144:147], 0
    ds_read_b64_tr_b16 a[218:219], v57 offset:43008
    v_mfma_f32_16x16x32_bf16 v[72:75], a[196:199], v[148:151], v[72:75]
    ds_read_b64_tr_b16 a[220:221], v57 offset:45056
    v_mfma_f32_16x16x32_bf16 v[68:71], a[200:203], v[128:131], 0
    ds_read_b64_tr_b16 a[222:223], v57 offset:47104
    v_mfma_f32_16x16x32_bf16 v[68:71], a[204:207], v[132:135], v[68:71]
    buffer_load_dwordx4 v[196:199], v1, s[8:11], s74 offen offset:1024
    v_mfma_f32_16x16x32_bf16 v[76:79], a[200:203], v[144:147], 0
    s_xor_b32 s74, s24, 20480
    ds_read_b64_tr_b16 a[224:225], v56 offset:49152
    v_cvt_pk_bf16_f32 v112, v112, v113
    v_mfma_f32_16x16x32_bf16 v[76:79], a[204:207], v[148:151], v[76:79]
    s_waitcnt lgkmcnt(7)
    ds_read_b64_tr_b16 a[226:227], v56 offset:51200
    v_cvt_pk_bf16_f32 v113, v114, v115
    v_mfma_f32_16x16x32_bf16 v[64:67], a[208:211], v[136:139], v[64:67]
    s_waitcnt lgkmcnt(6)
    ds_read_b64_tr_b16 a[228:229], v56 offset:53248
    v_cvt_pk_bf16_f32 v114, v116, v117
    v_mfma_f32_16x16x32_bf16 v[64:67], a[212:215], v[140:143], v[64:67]
    ds_read_b64_tr_b16 a[230:231], v56 offset:55296
    v_cvt_pk_bf16_f32 v115, v118, v119
    v_mfma_f32_16x16x32_bf16 v[72:75], a[208:211], v[152:155], v[72:75]
    buffer_load_dwordx4 v[212:215], v1, s[8:11], s74 offen offset:1024
    v_mfma_f32_16x16x32_bf16 v[72:75], a[212:215], v[156:159], v[72:75]
    s_waitcnt lgkmcnt(6)
    s_xor_b32 s74, s24, 16384
    ds_read_b64_tr_b16 a[232:233], v57 offset:49152
    v_min_u32 v112, -2, v112
    v_mfma_f32_16x16x32_bf16 v[68:71], a[216:219], v[136:139], v[68:71]
    s_waitcnt lgkmcnt(5)
    ds_read_b64_tr_b16 a[234:235], v57 offset:51200
    v_min_u32 v113, -2, v113
    v_mfma_f32_16x16x32_bf16 v[68:71], a[220:223], v[140:143], v[68:71]
    ds_read_b64_tr_b16 a[236:237], v57 offset:53248
    v_min_u32 v114, -2, v114
    v_mfma_f32_16x16x32_bf16 v[76:79], a[216:219], v[152:155], v[76:79]
    s_waitcnt vmcnt(13) lgkmcnt(5)
    ds_read_b64_tr_b16 a[238:239], v57 offset:55296
    v_min_u32 v115, -2, v115
    v_mfma_f32_16x16x32_bf16 v[76:79], a[220:223], v[156:159], v[76:79]
    buffer_load_dwordx4 v[200:203], v1, s[8:11], s74 offen offset:2048
    v_mfma_f32_16x16x32_bf16 v[64:67], a[224:227], v[160:163], v[64:67]
    s_waitcnt vmcnt(12) lgkmcnt(4)
    s_xor_b32 s74, s24, 20480
    ds_read_b64_tr_b16 a[240:241], v56 offset:57344
    v_mfma_f32_16x16x32_bf16 v[64:67], a[228:231], v[164:167], v[64:67]
    s_waitcnt vmcnt(10)
    s_add_u32 s75, s18, 0
    ds_read_b64_tr_b16 a[242:243], v56 offset:59392
    v_mfma_f32_16x16x32_bf16 v[72:75], a[224:227], v[176:179], v[72:75]
    buffer_store_dwordx4 v[112:115], v23, s[8:11], s75 offen offset:768 sc0 sc1
    v_mfma_f32_16x16x32_bf16 v[72:75], a[228:231], v[180:183], v[72:75]
    s_waitcnt lgkmcnt(2)
    ds_read_b64_tr_b16 a[244:245], v56 offset:61440
    v_cvt_pk_bf16_f32 v120, v120, v121
    v_mfma_f32_16x16x32_bf16 v[68:71], a[232:235], v[160:163], v[68:71]
    buffer_load_dwordx4 v[216:219], v1, s[8:11], s74 offen offset:2048
    ds_read_b64_tr_b16 a[246:247], v56 offset:63488
    v_mfma_f32_16x16x32_bf16 v[68:71], a[236:239], v[164:167], v[68:71]
    s_xor_b32 s74, s24, 16384
    ds_read_b64_tr_b16 a[248:249], v57 offset:57344
    v_cvt_pk_bf16_f32 v121, v122, v123
    v_mfma_f32_16x16x32_bf16 v[76:79], a[232:235], v[176:179], v[76:79]
    ds_read_b64_tr_b16 a[250:251], v57 offset:59392
    v_cvt_pk_bf16_f32 v122, v124, v125
    v_mfma_f32_16x16x32_bf16 v[76:79], a[236:239], v[180:183], v[76:79]
    s_waitcnt vmcnt(11) lgkmcnt(4)
    ds_read_b64_tr_b16 a[252:253], v57 offset:61440
    v_cvt_pk_bf16_f32 v123, v126, v127
    v_mfma_f32_16x16x32_bf16 v[64:67], a[240:243], v[168:171], v[64:67]
    s_waitcnt vmcnt(9) lgkmcnt(3)
    ds_read_b64_tr_b16 a[254:255], v57 offset:63488
    v_min_u32 v120, -2, v120
    v_mfma_f32_16x16x32_bf16 v[64:67], a[244:247], v[172:175], v[64:67]
    buffer_load_dwordx4 v[204:207], v1, s[8:11], s74 offen offset:3072
    v_mfma_f32_16x16x32_bf16 v[72:75], a[240:243], v[184:187], v[72:75]
    s_waitcnt vmcnt(8)
    s_xor_b32 s74, s24, 20480
    ds_read_b64_tr_b16 a[192:193], v58 offset:32768
    v_min_u32 v121, -2, v121
    v_mfma_f32_16x16x32_bf16 v[72:75], a[244:247], v[188:191], v[72:75]
    s_waitcnt lgkmcnt(3)
    ds_read_b64_tr_b16 a[194:195], v58 offset:34816
    v_min_u32 v122, -2, v122
    v_mfma_f32_16x16x32_bf16 v[68:71], a[248:251], v[168:171], v[68:71]
    s_waitcnt lgkmcnt(2)
    ds_read_b64_tr_b16 a[196:197], v58 offset:36864
    v_min_u32 v123, -2, v123
    v_mfma_f32_16x16x32_bf16 v[68:71], a[252:255], v[172:175], v[68:71]
    s_add_u32 s75, s18, 131072
    ds_read_b64_tr_b16 a[198:199], v58 offset:38912
    v_mfma_f32_16x16x32_bf16 v[76:79], a[248:251], v[184:187], v[76:79]
    buffer_load_dwordx4 v[220:223], v1, s[8:11], s74 offen offset:3072
    ds_read_b64_tr_b16 a[200:201], v59 offset:32768
    v_mfma_f32_16x16x32_bf16 v[76:79], a[252:255], v[188:191], v[76:79]
    s_waitcnt lgkmcnt(1)
    s_xor_b32 s74, s24, 24576
    ds_read_b64_tr_b16 a[202:203], v59 offset:34816
    v_mfma_f32_16x16x32_bf16 v[80:83], a[192:195], v[128:131], 0
    buffer_store_dwordx4 v[120:123], v23, s[8:11], s75 offen offset:768 sc0 sc1
    ds_read_b64_tr_b16 a[204:205], v59 offset:36864
    v_mfma_f32_16x16x32_bf16 v[80:83], a[196:199], v[132:135], v[80:83]
    ds_read_b64_tr_b16 a[206:207], v59 offset:38912
    v_mfma_f32_16x16x32_bf16 v[88:91], a[192:195], v[144:147], 0
    s_waitcnt lgkmcnt(2)
    ds_read_b64_tr_b16 a[208:209], v58 offset:40960
    v_mfma_f32_16x16x32_bf16 v[88:91], a[196:199], v[148:151], v[88:91]
    buffer_load_dwordx4 v[224:227], v1, s[8:11], s74 offen offset:0
    ds_read_b64_tr_b16 a[210:211], v58 offset:43008
    v_mfma_f32_16x16x32_bf16 v[84:87], a[200:203], v[128:131], 0
    s_waitcnt lgkmcnt(2)
    s_xor_b32 s74, s24, 28672
    ds_read_b64_tr_b16 a[212:213], v58 offset:45056
    v_mfma_f32_16x16x32_bf16 v[84:87], a[204:207], v[132:135], v[84:87]
    ds_read_b64_tr_b16 a[214:215], v58 offset:47104
    v_mfma_f32_16x16x32_bf16 v[92:95], a[200:203], v[144:147], 0
    ds_read_b64_tr_b16 a[216:217], v59 offset:40960
    v_mfma_f32_16x16x32_bf16 v[92:95], a[204:207], v[148:151], v[92:95]
    s_waitcnt lgkmcnt(1)
    ds_read_b64_tr_b16 a[218:219], v59 offset:43008
    v_mfma_f32_16x16x32_bf16 v[80:83], a[208:211], v[136:139], v[80:83]
    buffer_load_dwordx4 v[240:243], v1, s[8:11], s74 offen offset:0
    ds_read_b64_tr_b16 a[220:221], v59 offset:45056
    v_mfma_f32_16x16x32_bf16 v[80:83], a[212:215], v[140:143], v[80:83]
    s_xor_b32 s74, s24, 24576
    ds_read_b64_tr_b16 a[222:223], v59 offset:47104
    v_mfma_f32_16x16x32_bf16 v[88:91], a[208:211], v[152:155], v[88:91]
    ds_read_b64_tr_b16 a[224:225], v58 offset:49152
    v_mfma_f32_16x16x32_bf16 v[88:91], a[212:215], v[156:159], v[88:91]
    s_waitcnt lgkmcnt(3)
    ds_read_b64_tr_b16 a[226:227], v58 offset:51200
    v_mfma_f32_16x16x32_bf16 v[84:87], a[216:219], v[136:139], v[84:87]
    s_waitcnt lgkmcnt(2)
    ds_read_b64_tr_b16 a[228:229], v58 offset:53248
    v_mfma_f32_16x16x32_bf16 v[84:87], a[220:223], v[140:143], v[84:87]
    buffer_load_dwordx4 v[228:231], v1, s[8:11], s74 offen offset:1024
    ds_read_b64_tr_b16 a[230:231], v58 offset:55296
    v_mfma_f32_16x16x32_bf16 v[92:95], a[216:219], v[152:155], v[92:95]
    s_xor_b32 s74, s24, 28672
    ds_read_b64_tr_b16 a[232:233], v59 offset:49152
    v_mfma_f32_16x16x32_bf16 v[92:95], a[220:223], v[156:159], v[92:95]
    s_waitcnt lgkmcnt(3)
    ds_read_b64_tr_b16 a[234:235], v59 offset:51200
    v_mfma_f32_16x16x32_bf16 v[80:83], a[224:227], v[160:163], v[80:83]
    s_waitcnt lgkmcnt(2)
    ds_read_b64_tr_b16 a[236:237], v59 offset:53248
    v_mfma_f32_16x16x32_bf16 v[80:83], a[228:231], v[164:167], v[80:83]
    ds_read_b64_tr_b16 a[238:239], v59 offset:55296
    v_mfma_f32_16x16x32_bf16 v[88:91], a[224:227], v[176:179], v[88:91]
    buffer_load_dwordx4 v[244:247], v1, s[8:11], s74 offen offset:1024
    v_mfma_f32_16x16x32_bf16 v[88:91], a[228:231], v[180:183], v[88:91]
    s_waitcnt lgkmcnt(2)
    s_xor_b32 s74, s24, 24576
    ds_read_b64_tr_b16 a[240:241], v58 offset:57344
    v_mfma_f32_16x16x32_bf16 v[84:87], a[232:235], v[160:163], v[84:87]
    s_waitcnt lgkmcnt(1)
    ds_read_b64_tr_b16 a[242:243], v58 offset:59392
    v_mfma_f32_16x16x32_bf16 v[84:87], a[236:239], v[164:167], v[84:87]
    ds_read_b64_tr_b16 a[244:245], v58 offset:61440
    v_mfma_f32_16x16x32_bf16 v[92:95], a[232:235], v[176:179], v[92:95]
    s_waitcnt lgkmcnt(1)
    ds_read_b64_tr_b16 a[246:247], v58 offset:63488
    v_mfma_f32_16x16x32_bf16 v[92:95], a[236:239], v[180:183], v[92:95]
    buffer_load_dwordx4 v[232:235], v1, s[8:11], s74 offen offset:2048
    ds_read_b64_tr_b16 a[248:249], v59 offset:57344
    v_mfma_f32_16x16x32_bf16 v[80:83], a[240:243], v[168:171], v[80:83]
    s_waitcnt lgkmcnt(1)
    s_xor_b32 s74, s24, 28672
    ds_read_b64_tr_b16 a[250:251], v59 offset:59392
    v_mfma_f32_16x16x32_bf16 v[80:83], a[244:247], v[172:175], v[80:83]
    ds_read_b64_tr_b16 a[252:253], v59 offset:61440
    ds_read_b64_tr_b16 a[224:225], v56 offset:16384
    v_mfma_f32_16x16x32_bf16 v[88:91], a[240:243], v[184:187], v[88:91]
    ds_read_b64_tr_b16 a[254:255], v59 offset:63488
    ds_read_b64_tr_b16 a[226:227], v56 offset:18432
    v_mfma_f32_16x16x32_bf16 v[88:91], a[244:247], v[188:191], v[88:91]
    s_waitcnt lgkmcnt(1)
    ds_read_b64_tr_b16 a[192:193], v56 offset:0
    ds_read_b64_tr_b16 a[228:229], v56 offset:20480
    v_mfma_f32_16x16x32_bf16 v[84:87], a[248:251], v[168:171], v[84:87]
    buffer_load_dwordx4 v[248:251], v1, s[8:11], s74 offen offset:2048
    ds_read_b64_tr_b16 a[194:195], v56 offset:2048
    v_mfma_f32_16x16x32_bf16 v[84:87], a[252:255], v[172:175], v[84:87]
    s_xor_b32 s74, s24, 24576
    ds_read_b64_tr_b16 a[196:197], v56 offset:4096
    v_mfma_f32_16x16x32_bf16 v[92:95], a[248:251], v[184:187], v[92:95]
    ds_read_b64_tr_b16 a[198:199], v56 offset:6144
    ds_read_b64_tr_b16 a[230:231], v56 offset:22528
    v_mfma_f32_16x16x32_bf16 v[92:95], a[252:255], v[188:191], v[92:95]
    s_waitcnt lgkmcnt(3)
    ds_read_b64_tr_b16 a[200:201], v57 offset:0
    ds_read_b64_tr_b16 a[232:233], v57 offset:16384
    v_mfma_f32_16x16x32_bf16 v[96:99], a[192:195], v[128:131], 0
    s_waitcnt lgkmcnt(3)
    ds_read_b64_tr_b16 a[202:203], v57 offset:2048
    ds_read_b64_tr_b16 a[234:235], v57 offset:18432
    v_mfma_f32_16x16x32_bf16 v[96:99], a[196:199], v[132:135], v[96:99]
    buffer_load_dwordx4 v[236:239], v1, s[8:11], s74 offen offset:3072
    ds_read_b64_tr_b16 a[204:205], v57 offset:4096
    v_mfma_f32_16x16x32_bf16 v[104:107], a[192:195], v[144:147], 0
    s_xor_b32 s74, s24, 28672
    ds_read_b64_tr_b16 a[206:207], v57 offset:6144
    v_lshlrev_b32 v48, 16, v40
    v_mfma_f32_16x16x32_bf16 v[104:107], a[196:199], v[148:151], v[104:107]
    s_waitcnt lgkmcnt(3)
    ds_read_b64_tr_b16 a[208:209], v56 offset:8192
    v_and_b32 v49, 0xffff0000, v40
    v_mfma_f32_16x16x32_bf16 v[100:103], a[200:203], v[128:131], 0
    s_waitcnt lgkmcnt(1)
    ds_read_b64_tr_b16 a[210:211], v56 offset:10240
    v_lshlrev_b32 v50, 16, v41
    v_mfma_f32_16x16x32_bf16 v[100:103], a[204:207], v[132:135], v[100:103]
    s_waitcnt lgkmcnt(0)
    ds_read_b64_tr_b16 a[212:213], v56 offset:12288
    v_and_b32 v51, 0xffff0000, v41
    v_mfma_f32_16x16x32_bf16 v[108:111], a[200:203], v[144:147], 0
    buffer_load_dwordx4 v[252:255], v1, s[8:11], s74 offen offset:3072
    ds_read_b64_tr_b16 a[214:215], v56 offset:14336
    v_mfma_f32_16x16x32_bf16 v[108:111], a[204:207], v[148:151], v[108:111]
    buffer_load_dwordx2 v[32:33], v45, s[32:35], s100 offen
    ds_read_b64_tr_b16 a[216:217], v57 offset:8192
    v_mfma_f32_16x16x32_bf16 v[96:99], a[208:211], v[136:139], v[96:99]
    s_waitcnt lgkmcnt(1)
    ds_read_b64_tr_b16 a[218:219], v57 offset:10240
    v_lshlrev_b32 v52, 16, v42
    v_mfma_f32_16x16x32_bf16 v[96:99], a[212:215], v[140:143], v[96:99]
    ds_read_b64_tr_b16 a[220:221], v57 offset:12288
    v_and_b32 v53, 0xffff0000, v42
    v_mfma_f32_16x16x32_bf16 v[104:107], a[208:211], v[152:155], v[104:107]
    s_waitcnt lgkmcnt(1)
    ds_read_b64_tr_b16 a[222:223], v57 offset:14336
    v_lshlrev_b32 v54, 16, v43
    v_mfma_f32_16x16x32_bf16 v[104:107], a[212:215], v[156:159], v[104:107]
    buffer_load_dwordx2 v[34:35], v45, s[32:35], s100 offen offset:32
    ds_read_b64_tr_b16 a[236:237], v57 offset:20480
    v_mfma_f32_16x16x32_bf16 v[100:103], a[216:219], v[136:139], v[100:103]
    s_waitcnt lgkmcnt(1)
    ds_read_b64_tr_b16 a[238:239], v57 offset:22528
    v_and_b32 v55, 0xffff0000, v43
    v_mfma_f32_16x16x32_bf16 v[100:103], a[220:223], v[140:143], v[100:103]
    ds_read_b64_tr_b16 a[240:241], v56 offset:24576
    v_mfma_f32_16x16x32_bf16 v[108:111], a[216:219], v[152:155], v[108:111]
    ds_read_b64_tr_b16 a[242:243], v56 offset:26624
    v_mfma_f32_16x16x32_bf16 v[108:111], a[220:223], v[156:159], v[108:111]
    buffer_load_dwordx2 v[36:37], v45, s[32:35], s101 offen
    v_mfma_f32_16x16x32_bf16 v[96:99], a[224:227], v[160:163], v[96:99]
    ds_read_b64_tr_b16 a[244:245], v56 offset:28672
    v_mfma_f32_16x16x32_bf16 v[96:99], a[228:231], v[164:167], v[96:99]
    ds_read_b64_tr_b16 a[246:247], v56 offset:30720
    v_mfma_f32_16x16x32_bf16 v[104:107], a[224:227], v[176:179], v[104:107]
    ds_read_b64_tr_b16 a[248:249], v57 offset:24576
    v_mfma_f32_16x16x32_bf16 v[104:107], a[228:231], v[180:183], v[104:107]
    buffer_load_dwordx2 v[38:39], v45, s[32:35], s101 offen offset:32
    ds_read_b64_tr_b16 a[250:251], v57 offset:26624
    v_mfma_f32_16x16x32_bf16 v[100:103], a[232:235], v[160:163], v[100:103]
    s_waitcnt lgkmcnt(6)
    ds_read_b64_tr_b16 a[252:253], v57 offset:28672
    v_mfma_f32_16x16x32_bf16 v[100:103], a[236:239], v[164:167], v[100:103]
    ds_read_b64_tr_b16 a[254:255], v57 offset:30720
    v_mfma_f32_16x16x32_bf16 v[108:111], a[232:235], v[176:179], v[108:111]
    s_waitcnt lgkmcnt(6)
    ds_read_b64_tr_b16 a[192:193], v58 offset:0
    v_mfma_f32_16x16x32_bf16 v[108:111], a[236:239], v[180:183], v[108:111]
    buffer_load_dwordx2 v[40:41], v45, s[56:59], 0 offen
    v_mfma_f32_16x16x32_bf16 v[96:99], a[240:243], v[168:171], v[96:99]
    s_waitcnt lgkmcnt(5)
    ds_read_b64_tr_b16 a[194:195], v58 offset:2048
    v_mfma_f32_16x16x32_bf16 v[96:99], a[244:247], v[172:175], v[96:99]
    ds_read_b64_tr_b16 a[196:197], v58 offset:4096
    v_mfma_f32_16x16x32_bf16 v[104:107], a[240:243], v[184:187], v[104:107]
    s_waitcnt lgkmcnt(5)
    ds_read_b64_tr_b16 a[198:199], v58 offset:6144
    v_mfma_f32_16x16x32_bf16 v[104:107], a[244:247], v[188:191], v[104:107]
    buffer_load_dwordx2 v[42:43], v45, s[56:59], 0 offen offset:32
    ds_read_b64_tr_b16 a[200:201], v59 offset:0
    v_mfma_f32_16x16x32_bf16 v[100:103], a[248:251], v[168:171], v[100:103]
    s_waitcnt lgkmcnt(5)
    ds_read_b64_tr_b16 a[202:203], v59 offset:2048
    v_mfma_f32_16x16x32_bf16 v[100:103], a[252:255], v[172:175], v[100:103]
    ds_read_b64_tr_b16 a[204:205], v59 offset:4096
    v_mfma_f32_16x16x32_bf16 v[108:111], a[248:251], v[184:187], v[108:111]
    ds_read_b64_tr_b16 a[206:207], v59 offset:6144
    v_mfma_f32_16x16x32_bf16 v[108:111], a[252:255], v[188:191], v[108:111]
    s_waitcnt lgkmcnt(6)
    ds_read_b64_tr_b16 a[208:209], v58 offset:8192
    v_mfma_f32_16x16x32_bf16 v[112:115], a[192:195], v[128:131], 0
    s_waitcnt lgkmcnt(5)
    ds_read_b64_tr_b16 a[210:211], v58 offset:10240
    v_mfma_f32_16x16x32_bf16 v[112:115], a[196:199], v[132:135], v[112:115]
    ds_read_b64_tr_b16 a[212:213], v58 offset:12288
    v_mfma_f32_16x16x32_bf16 v[120:123], a[192:195], v[144:147], 0
    ds_read_b64_tr_b16 a[214:215], v58 offset:14336
    v_mfma_f32_16x16x32_bf16 v[120:123], a[196:199], v[148:151], v[120:123]
    s_waitcnt lgkmcnt(6)
    ds_read_b64_tr_b16 a[216:217], v59 offset:8192
    v_mfma_f32_16x16x32_bf16 v[116:119], a[200:203], v[128:131], 0
    s_waitcnt lgkmcnt(5)
    ds_read_b64_tr_b16 a[218:219], v59 offset:10240
    v_mfma_f32_16x16x32_bf16 v[116:119], a[204:207], v[132:135], v[116:119]
    ds_read_b64_tr_b16 a[220:221], v59 offset:12288
    v_mfma_f32_16x16x32_bf16 v[124:127], a[200:203], v[144:147], 0
    ds_read_b64_tr_b16 a[222:223], v59 offset:14336
    v_mfma_f32_16x16x32_bf16 v[124:127], a[204:207], v[148:151], v[124:127]
    s_waitcnt lgkmcnt(6)
    ds_read_b64_tr_b16 a[224:225], v58 offset:16384
    v_mfma_f32_16x16x32_bf16 v[112:115], a[208:211], v[136:139], v[112:115]
    s_waitcnt lgkmcnt(5)
    ds_read_b64_tr_b16 a[226:227], v58 offset:18432
    v_mfma_f32_16x16x32_bf16 v[112:115], a[212:215], v[140:143], v[112:115]
    ds_read_b64_tr_b16 a[228:229], v58 offset:20480
    v_mfma_f32_16x16x32_bf16 v[120:123], a[208:211], v[152:155], v[120:123]
    ds_read_b64_tr_b16 a[230:231], v58 offset:22528
    v_mfma_f32_16x16x32_bf16 v[120:123], a[212:215], v[156:159], v[120:123]
    s_waitcnt lgkmcnt(6)
    ds_read_b64_tr_b16 a[232:233], v59 offset:16384
    v_mfma_f32_16x16x32_bf16 v[116:119], a[216:219], v[136:139], v[116:119]
    s_waitcnt lgkmcnt(5)
    ds_read_b64_tr_b16 a[234:235], v59 offset:18432
    v_mfma_f32_16x16x32_bf16 v[116:119], a[220:223], v[140:143], v[116:119]
    ds_read_b64_tr_b16 a[236:237], v59 offset:20480
    v_mfma_f32_16x16x32_bf16 v[124:127], a[216:219], v[152:155], v[124:127]
    ds_read_b64_tr_b16 a[238:239], v59 offset:22528
    v_mfma_f32_16x16x32_bf16 v[124:127], a[220:223], v[156:159], v[124:127]
    s_waitcnt lgkmcnt(6)
    ds_read_b64_tr_b16 a[240:241], v58 offset:24576
    v_mfma_f32_16x16x32_bf16 v[112:115], a[224:227], v[160:163], v[112:115]
    s_waitcnt lgkmcnt(5)
    ds_read_b64_tr_b16 a[242:243], v58 offset:26624
    v_mfma_f32_16x16x32_bf16 v[112:115], a[228:231], v[164:167], v[112:115]
    ds_read_b64_tr_b16 a[244:245], v58 offset:28672
    v_mfma_f32_16x16x32_bf16 v[120:123], a[224:227], v[176:179], v[120:123]
    ds_read_b64_tr_b16 a[246:247], v58 offset:30720
    v_mfma_f32_16x16x32_bf16 v[120:123], a[228:231], v[180:183], v[120:123]
    s_waitcnt lgkmcnt(6)
    ds_read_b64_tr_b16 a[248:249], v59 offset:24576
    v_mfma_f32_16x16x32_bf16 v[116:119], a[232:235], v[160:163], v[116:119]
    s_waitcnt lgkmcnt(5)
    ds_read_b64_tr_b16 a[250:251], v59 offset:26624
    v_mfma_f32_16x16x32_bf16 v[116:119], a[236:239], v[164:167], v[116:119]
    ds_read_b64_tr_b16 a[252:253], v59 offset:28672
    v_mfma_f32_16x16x32_bf16 v[124:127], a[232:235], v[176:179], v[124:127]
    ds_read_b64_tr_b16 a[254:255], v59 offset:30720
    v_mfma_f32_16x16x32_bf16 v[124:127], a[236:239], v[180:183], v[124:127]
    s_waitcnt lgkmcnt(6)
    ds_read_b64_tr_b16 a[192:193], v60 offset:0
    v_mfma_f32_16x16x32_bf16 v[112:115], a[240:243], v[168:171], v[112:115]
    s_waitcnt lgkmcnt(5)
    ds_read_b64_tr_b16 a[194:195], v60 offset:2048
    v_mfma_f32_16x16x32_bf16 v[112:115], a[244:247], v[172:175], v[112:115]
    ds_read_b64_tr_b16 a[196:197], v60 offset:4096
    v_mfma_f32_16x16x32_bf16 v[120:123], a[240:243], v[184:187], v[120:123]
    ds_read_b64_tr_b16 a[198:199], v60 offset:6144
    v_mfma_f32_16x16x32_bf16 v[120:123], a[244:247], v[188:191], v[120:123]
    s_waitcnt lgkmcnt(6)
    ds_read_b64_tr_b16 a[200:201], v61 offset:0
    v_mfma_f32_16x16x32_bf16 v[116:119], a[248:251], v[168:171], v[116:119]
    s_waitcnt lgkmcnt(5)
    ds_read_b64_tr_b16 a[202:203], v61 offset:2048
    v_mfma_f32_16x16x32_bf16 v[116:119], a[252:255], v[172:175], v[116:119]
    ds_read_b64_tr_b16 a[204:205], v61 offset:4096
    v_mfma_f32_16x16x32_bf16 v[124:127], a[248:251], v[184:187], v[124:127]
    ds_read_b64_tr_b16 a[206:207], v61 offset:6144
    v_mfma_f32_16x16x32_bf16 v[124:127], a[252:255], v[188:191], v[124:127]
    s_waitcnt vmcnt(23) lgkmcnt(6)
    ds_read_b64_tr_b16 a[208:209], v60 offset:8192
    v_mfma_f32_16x16x32_bf16 v[64:67], a[192:195], v[192:195], v[64:67]
    s_waitcnt vmcnt(21) lgkmcnt(5)
    ds_read_b64_tr_b16 a[210:211], v60 offset:10240
    v_mfma_f32_16x16x32_bf16 v[64:67], a[196:199], v[196:199], v[64:67]
    ds_read_b64_tr_b16 a[212:213], v60 offset:12288
    v_mfma_f32_16x16x32_bf16 v[72:75], a[192:195], v[208:211], v[72:75]
    s_waitcnt vmcnt(20) lgkmcnt(5)
    s_mov_b32 s74, 8192
    ds_read_b64_tr_b16 a[214:215], v60 offset:14336
    v_mfma_f32_16x16x32_bf16 v[72:75], a[196:199], v[212:215], v[72:75]
    buffer_load_dwordx4 v[168:171], v46, s[8:11], s74 offen
    ds_read_b64_tr_b16 a[216:217], v61 offset:8192
    v_mfma_f32_16x16x32_bf16 v[68:71], a[200:203], v[192:195], v[68:71]
    s_waitcnt lgkmcnt(5)
    ds_read_b64_tr_b16 a[218:219], v61 offset:10240
    v_mfma_f32_16x16x32_bf16 v[68:71], a[204:207], v[196:199], v[68:71]
    ds_read_b64_tr_b16 a[220:221], v61 offset:12288
    v_mfma_f32_16x16x32_bf16 v[76:79], a[200:203], v[208:211], v[76:79]
    buffer_load_dwordx4 v[172:175], v46, s[8:11], s74 offen offset:64
    ds_read_b64_tr_b16 a[222:223], v61 offset:14336
    v_mfma_f32_16x16x32_bf16 v[76:79], a[204:207], v[212:215], v[76:79]
    s_waitcnt vmcnt(21) lgkmcnt(6)
    s_mov_b32 s74, 6144
    ds_read_b64_tr_b16 a[224:225], v60 offset:16384
    v_mfma_f32_16x16x32_bf16 v[64:67], a[208:211], v[200:203], v[64:67]
    s_waitcnt vmcnt(18) lgkmcnt(5)
    ds_read_b64_tr_b16 a[226:227], v60 offset:18432
    v_mfma_f32_16x16x32_bf16 v[64:67], a[212:215], v[204:207], v[64:67]
    buffer_load_dwordx4 v[176:179], v46, s[8:11], s74 offen
    v_mfma_f32_16x16x32_bf16 v[72:75], a[208:211], v[216:219], v[72:75]
    s_waitcnt vmcnt(18)
    ds_read_b64_tr_b16 a[228:229], v60 offset:20480
    v_mfma_f32_16x16x32_bf16 v[72:75], a[212:215], v[220:223], v[72:75]
    s_waitcnt lgkmcnt(3)
    ds_read_b64_tr_b16 a[230:231], v60 offset:22528
    v_mfma_f32_16x16x32_bf16 v[68:71], a[216:219], v[200:203], v[68:71]
    buffer_load_dwordx4 v[180:183], v46, s[8:11], s74 offen offset:64
    ds_read_b64_tr_b16 a[232:233], v61 offset:16384
    v_mfma_f32_16x16x32_bf16 v[68:71], a[220:223], v[204:207], v[68:71]
    s_mov_b32 s74, 4096
    ds_read_b64_tr_b16 a[234:235], v61 offset:18432
    v_mfma_f32_16x16x32_bf16 v[76:79], a[216:219], v[216:219], v[76:79]
    s_waitcnt vmcnt(17) lgkmcnt(4)
    ds_read_b64_tr_b16 a[236:237], v61 offset:20480
    v_mfma_f32_16x16x32_bf16 v[76:79], a[220:223], v[220:223], v[76:79]
    buffer_load_dwordx4 v[160:163], v46, s[8:11], s74 offen
    ds_read_b64_tr_b16 a[238:239], v61 offset:22528
    v_mfma_f32_16x16x32_bf16 v[64:67], a[224:227], v[224:227], v[64:67]
    s_waitcnt vmcnt(16) lgkmcnt(4)
    ds_read_b64_tr_b16 a[240:241], v60 offset:24576
    v_mfma_f32_16x16x32_bf16 v[64:67], a[228:231], v[228:231], v[64:67]
    s_waitcnt vmcnt(15)
    ds_read_b64_tr_b16 a[242:243], v60 offset:26624
    v_mfma_f32_16x16x32_bf16 v[72:75], a[224:227], v[240:243], v[72:75]
    buffer_load_dwordx4 v[164:167], v46, s[8:11], s74 offen offset:64
    v_mfma_f32_16x16x32_bf16 v[72:75], a[228:231], v[244:247], v[72:75]
    s_waitcnt lgkmcnt(4)
    s_mov_b32 s74, 10240
    ds_read_b64_tr_b16 a[244:245], v60 offset:28672
    v_mfma_f32_16x16x32_bf16 v[68:71], a[232:235], v[224:227], v[68:71]
    s_waitcnt lgkmcnt(3)
    ds_read_b64_tr_b16 a[246:247], v60 offset:30720
    v_mfma_f32_16x16x32_bf16 v[68:71], a[236:239], v[228:231], v[68:71]
    buffer_load_dwordx4 v[184:187], v46, s[8:11], s74 offen
    ds_read_b64_tr_b16 a[248:249], v61 offset:24576
    v_mfma_f32_16x16x32_bf16 v[76:79], a[232:235], v[240:243], v[76:79]
    ds_read_b64_tr_b16 a[250:251], v61 offset:26624
    v_mfma_f32_16x16x32_bf16 v[76:79], a[236:239], v[244:247], v[76:79]
    s_waitcnt vmcnt(14) lgkmcnt(2)
    ds_read_b64_tr_b16 a[252:253], v61 offset:28672
    v_mfma_f32_16x16x32_bf16 v[64:67], a[240:243], v[232:235], v[64:67]
    buffer_load_dwordx4 v[188:191], v46, s[8:11], s74 offen offset:64
    ds_read_b64_tr_b16 a[254:255], v61 offset:30720
    v_mfma_f32_16x16x32_bf16 v[64:67], a[244:247], v[236:239], v[64:67]
    ds_read_b64_tr_b16 a[192:193], v62 offset:0
    v_mfma_f32_16x16x32_bf16 v[72:75], a[240:243], v[248:251], v[72:75]
    s_waitcnt vmcnt(14)
    ds_read_b64_tr_b16 a[194:195], v62 offset:2048
    v_mfma_f32_16x16x32_bf16 v[72:75], a[244:247], v[252:255], v[72:75]
    s_waitcnt lgkmcnt(4)
    ds_read_b64_tr_b16 a[196:197], v62 offset:4096
    v_mfma_f32_16x16x32_bf16 v[68:71], a[248:251], v[232:235], v[68:71]
    s_waitcnt lgkmcnt(3)
    ds_read_b64_tr_b16 a[198:199], v62 offset:6144
    v_mfma_f32_16x16x32_bf16 v[68:71], a[252:255], v[236:239], v[68:71]
    ds_read_b64_tr_b16 a[200:201], v63 offset:0
    v_mfma_f32_16x16x32_bf16 v[76:79], a[248:251], v[248:251], v[76:79]
    ds_read_b64_tr_b16 a[202:203], v63 offset:2048
    v_mfma_f32_16x16x32_bf16 v[76:79], a[252:255], v[252:255], v[76:79]
    s_waitcnt lgkmcnt(4)
    ds_read_b64_tr_b16 a[204:205], v63 offset:4096
    v_mfma_f32_16x16x32_bf16 v[80:83], a[192:195], v[192:195], v[80:83]
    s_waitcnt lgkmcnt(3)
    ds_read_b64_tr_b16 a[206:207], v63 offset:6144
    v_mfma_f32_16x16x32_bf16 v[80:83], a[196:199], v[196:199], v[80:83]
    ds_read_b64_tr_b16 a[208:209], v62 offset:8192
    v_mfma_f32_16x16x32_bf16 v[88:91], a[192:195], v[208:211], v[88:91]
    ds_read_b64_tr_b16 a[210:211], v62 offset:10240
    v_mfma_f32_16x16x32_bf16 v[88:91], a[196:199], v[212:215], v[88:91]
    s_waitcnt lgkmcnt(4)
    ds_read_b64_tr_b16 a[212:213], v62 offset:12288
    v_mfma_f32_16x16x32_bf16 v[84:87], a[200:203], v[192:195], v[84:87]
    s_waitcnt lgkmcnt(3)
    ds_read_b64_tr_b16 a[214:215], v62 offset:14336
    v_mfma_f32_16x16x32_bf16 v[84:87], a[204:207], v[196:199], v[84:87]
    ds_read_b64_tr_b16 a[216:217], v63 offset:8192
    v_mfma_f32_16x16x32_bf16 v[92:95], a[200:203], v[208:211], v[92:95]
    ds_read_b64_tr_b16 a[218:219], v63 offset:10240
    v_cvt_pk_bf16_f32 v64, v64, v65
    v_mfma_f32_16x16x32_bf16 v[92:95], a[204:207], v[212:215], v[92:95]
    s_waitcnt lgkmcnt(4)
    ds_read_b64_tr_b16 a[220:221], v63 offset:12288
    v_cvt_pk_bf16_f32 v65, v66, v67
    v_mfma_f32_16x16x32_bf16 v[80:83], a[208:211], v[200:203], v[80:83]
    s_waitcnt lgkmcnt(3)
    ds_read_b64_tr_b16 a[222:223], v63 offset:14336
    v_cvt_pk_bf16_f32 v66, v68, v69
    v_mfma_f32_16x16x32_bf16 v[80:83], a[212:215], v[204:207], v[80:83]
    ds_read_b64_tr_b16 a[224:225], v62 offset:16384
    v_cvt_pk_bf16_f32 v67, v70, v71
    v_mfma_f32_16x16x32_bf16 v[88:91], a[208:211], v[216:219], v[88:91]
    ds_read_b64_tr_b16 a[226:227], v62 offset:18432
    v_min_u32 v64, -2, v64
    v_mfma_f32_16x16x32_bf16 v[88:91], a[212:215], v[220:223], v[88:91]
    s_waitcnt lgkmcnt(4)
    ds_read_b64_tr_b16 a[228:229], v62 offset:20480
    v_min_u32 v65, -2, v65
    v_mfma_f32_16x16x32_bf16 v[84:87], a[216:219], v[200:203], v[84:87]
    s_waitcnt lgkmcnt(3)
    ds_read_b64_tr_b16 a[230:231], v62 offset:22528
    v_min_u32 v66, -2, v66
    v_mfma_f32_16x16x32_bf16 v[84:87], a[220:223], v[204:207], v[84:87]
    ds_read_b64_tr_b16 a[232:233], v63 offset:16384
    v_min_u32 v67, -2, v67
    v_mfma_f32_16x16x32_bf16 v[92:95], a[216:219], v[216:219], v[92:95]
    s_waitcnt lgkmcnt(3)
    s_add_u32 s75, s18, 8388608
    ds_read_b64_tr_b16 a[234:235], v63 offset:18432
    v_mfma_f32_16x16x32_bf16 v[92:95], a[220:223], v[220:223], v[92:95]
    buffer_store_dwordx4 v[64:67], v23, s[8:11], s75 offen offset:0 sc0 sc1
    ds_read_b64_tr_b16 a[236:237], v63 offset:20480
    v_mfma_f32_16x16x32_bf16 v[80:83], a[224:227], v[224:227], v[80:83]
    s_waitcnt lgkmcnt(3)
    ds_read_b64_tr_b16 a[238:239], v63 offset:22528
    v_cvt_pk_bf16_f32 v72, v72, v73
    v_mfma_f32_16x16x32_bf16 v[80:83], a[228:231], v[228:231], v[80:83]
    ds_read_b64_tr_b16 a[240:241], v62 offset:24576
    v_cvt_pk_bf16_f32 v73, v74, v75
    v_mfma_f32_16x16x32_bf16 v[88:91], a[224:227], v[240:243], v[88:91]
    ds_read_b64_tr_b16 a[242:243], v62 offset:26624
    v_cvt_pk_bf16_f32 v74, v76, v77
    v_mfma_f32_16x16x32_bf16 v[88:91], a[228:231], v[244:247], v[88:91]
    s_waitcnt lgkmcnt(4)
    ds_read_b64_tr_b16 a[244:245], v62 offset:28672
    v_cvt_pk_bf16_f32 v75, v78, v79
    v_mfma_f32_16x16x32_bf16 v[84:87], a[232:235], v[224:227], v[84:87]
    s_waitcnt lgkmcnt(3)
    ds_read_b64_tr_b16 a[246:247], v62 offset:30720
    v_min_u32 v72, -2, v72
    v_mfma_f32_16x16x32_bf16 v[84:87], a[236:239], v[228:231], v[84:87]
    ds_read_b64_tr_b16 a[248:249], v63 offset:24576
    v_min_u32 v73, -2, v73
    v_mfma_f32_16x16x32_bf16 v[92:95], a[232:235], v[240:243], v[92:95]
    ds_read_b64_tr_b16 a[250:251], v63 offset:26624
    v_min_u32 v74, -2, v74
    v_mfma_f32_16x16x32_bf16 v[92:95], a[236:239], v[244:247], v[92:95]
    s_waitcnt lgkmcnt(4)
    ds_read_b64_tr_b16 a[252:253], v63 offset:28672
    v_min_u32 v75, -2, v75
    v_mfma_f32_16x16x32_bf16 v[80:83], a[240:243], v[232:235], v[80:83]
    s_waitcnt lgkmcnt(3)
    s_add_u32 s75, s18, 8519680
    ds_read_b64_tr_b16 a[254:255], v63 offset:30720
    s_waitcnt vmcnt(8)
    v_mul_f32 v8, v48, v168
    v_mfma_f32_16x16x32_bf16 v[80:83], a[244:247], v[236:239], v[80:83]
    buffer_store_dwordx4 v[72:75], v23, s[8:11], s75 offen offset:0 sc0 sc1
    v_mfma_f32_16x16x32_bf16 v[88:91], a[240:243], v[248:251], v[88:91]
    ds_read_b64_tr_b16 a[192:193], v60 offset:32768
    v_mul_f32 v9, v49, v169
    v_mfma_f32_16x16x32_bf16 v[88:91], a[244:247], v[252:255], v[88:91]
    s_waitcnt lgkmcnt(3)
    ds_read_b64_tr_b16 a[194:195], v60 offset:34816
    v_mul_f32 v10, v50, v170
    v_mfma_f32_16x16x32_bf16 v[84:87], a[248:251], v[232:235], v[84:87]
    s_waitcnt lgkmcnt(2)
    ds_read_b64_tr_b16 a[196:197], v60 offset:36864
    v_mul_f32 v11, v51, v171
    v_mfma_f32_16x16x32_bf16 v[84:87], a[252:255], v[236:239], v[84:87]
    ds_read_b64_tr_b16 a[198:199], v60 offset:38912
    s_waitcnt vmcnt(8)
    v_mul_f32 v12, v52, v172
    v_mfma_f32_16x16x32_bf16 v[92:95], a[248:251], v[248:251], v[92:95]
    ds_read_b64_tr_b16 a[200:201], v61 offset:32768
    v_mul_f32 v13, v53, v173
    v_mfma_f32_16x16x32_bf16 v[92:95], a[252:255], v[252:255], v[92:95]
    s_waitcnt lgkmcnt(3)
    ds_read_b64_tr_b16 a[202:203], v61 offset:34816
    v_mul_f32 v14, v54, v174
    v_mfma_f32_16x16x32_bf16 v[96:99], a[192:195], v[192:195], v[96:99]
    s_waitcnt lgkmcnt(2)
    ds_read_b64_tr_b16 a[204:205], v61 offset:36864
    v_mul_f32 v15, v55, v175
    v_mfma_f32_16x16x32_bf16 v[96:99], a[196:199], v[196:199], v[96:99]
    ds_read_b64_tr_b16 a[206:207], v61 offset:38912
    s_waitcnt vmcnt(7)
    v_mul_f32 v16, v48, v176
    v_mfma_f32_16x16x32_bf16 v[104:107], a[192:195], v[208:211], v[104:107]
    ds_read_b64_tr_b16 a[208:209], v60 offset:40960
    v_fmac_f32 v16, v49, v177
    v_mfma_f32_16x16x32_bf16 v[104:107], a[196:199], v[212:215], v[104:107]
    s_waitcnt lgkmcnt(3)
    ds_read_b64_tr_b16 a[210:211], v60 offset:43008
    v_fmac_f32 v16, v50, v178
    v_mfma_f32_16x16x32_bf16 v[100:103], a[200:203], v[192:195], v[100:103]
    s_waitcnt lgkmcnt(2)
    ds_read_b64_tr_b16 a[212:213], v60 offset:45056
    v_fmac_f32 v16, v51, v179
    v_mfma_f32_16x16x32_bf16 v[100:103], a[204:207], v[196:199], v[100:103]
    ds_read_b64_tr_b16 a[214:215], v60 offset:47104
    s_waitcnt vmcnt(6)
    v_fmac_f32 v16, v52, v180
    v_mfma_f32_16x16x32_bf16 v[108:111], a[200:203], v[208:211], v[108:111]
    ds_read_b64_tr_b16 a[216:217], v61 offset:40960
    v_cvt_pk_bf16_f32 v80, v80, v81
    v_mfma_f32_16x16x32_bf16 v[108:111], a[204:207], v[212:215], v[108:111]
    s_waitcnt lgkmcnt(3)
    ds_read_b64_tr_b16 a[218:219], v61 offset:43008
    v_cvt_pk_bf16_f32 v81, v82, v83
    v_mfma_f32_16x16x32_bf16 v[96:99], a[208:211], v[200:203], v[96:99]
    s_waitcnt lgkmcnt(2)
    ds_read_b64_tr_b16 a[220:221], v61 offset:45056
    v_cvt_pk_bf16_f32 v82, v84, v85
    v_mfma_f32_16x16x32_bf16 v[96:99], a[212:215], v[204:207], v[96:99]
    ds_read_b64_tr_b16 a[222:223], v61 offset:47104
    v_cvt_pk_bf16_f32 v83, v86, v87
    v_mfma_f32_16x16x32_bf16 v[104:107], a[208:211], v[216:219], v[104:107]
    ds_read_b64_tr_b16 a[224:225], v60 offset:49152
    v_min_u32 v80, -2, v80
    v_mfma_f32_16x16x32_bf16 v[104:107], a[212:215], v[220:223], v[104:107]
    s_waitcnt lgkmcnt(3)
    ds_read_b64_tr_b16 a[226:227], v60 offset:51200
    v_min_u32 v81, -2, v81
    v_mfma_f32_16x16x32_bf16 v[100:103], a[216:219], v[200:203], v[100:103]
    s_waitcnt lgkmcnt(2)
    ds_read_b64_tr_b16 a[228:229], v60 offset:53248
    v_min_u32 v82, -2, v82
    v_mfma_f32_16x16x32_bf16 v[100:103], a[220:223], v[204:207], v[100:103]
    ds_read_b64_tr_b16 a[230:231], v60 offset:55296
    v_min_u32 v83, -2, v83
    v_mfma_f32_16x16x32_bf16 v[108:111], a[216:219], v[216:219], v[108:111]
    s_waitcnt lgkmcnt(2)
    s_add_u32 s75, s18, 8388608
    ds_read_b64_tr_b16 a[232:233], v61 offset:49152
    v_fmac_f32 v16, v53, v181
    v_mfma_f32_16x16x32_bf16 v[108:111], a[220:223], v[220:223], v[108:111]
    buffer_store_dwordx4 v[80:83], v23, s[8:11], s75 offen offset:256 sc0 sc1
    ds_read_b64_tr_b16 a[234:235], v61 offset:51200
    v_mfma_f32_16x16x32_bf16 v[96:99], a[224:227], v[224:227], v[96:99]
    s_waitcnt lgkmcnt(2)
    ds_read_b64_tr_b16 a[236:237], v61 offset:53248
    v_cvt_pk_bf16_f32 v88, v88, v89
    v_mfma_f32_16x16x32_bf16 v[96:99], a[228:231], v[228:231], v[96:99]
    ds_read_b64_tr_b16 a[238:239], v61 offset:55296
    v_cvt_pk_bf16_f32 v89, v90, v91
    v_mfma_f32_16x16x32_bf16 v[104:107], a[224:227], v[240:243], v[104:107]
    ds_read_b64_tr_b16 a[240:241], v60 offset:57344
    v_cvt_pk_bf16_f32 v90, v92, v93
    v_mfma_f32_16x16x32_bf16 v[104:107], a[228:231], v[244:247], v[104:107]
    s_waitcnt lgkmcnt(3)
    ds_read_b64_tr_b16 a[242:243], v60 offset:59392
    v_cvt_pk_bf16_f32 v91, v94, v95
    v_mfma_f32_16x16x32_bf16 v[100:103], a[232:235], v[224:227], v[100:103]
    s_waitcnt lgkmcnt(2)
    ds_read_b64_tr_b16 a[244:245], v60 offset:61440
    v_min_u32 v88, -2, v88
    v_mfma_f32_16x16x32_bf16 v[100:103], a[236:239], v[228:231], v[100:103]
    ds_read_b64_tr_b16 a[246:247], v60 offset:63488
    v_min_u32 v89, -2, v89
    v_mfma_f32_16x16x32_bf16 v[108:111], a[232:235], v[240:243], v[108:111]
    ds_read_b64_tr_b16 a[248:249], v61 offset:57344
    v_min_u32 v90, -2, v90
    v_mfma_f32_16x16x32_bf16 v[108:111], a[236:239], v[244:247], v[108:111]
    s_waitcnt lgkmcnt(3)
    ds_read_b64_tr_b16 a[250:251], v61 offset:59392
    v_fmac_f32 v16, v54, v182
    v_mfma_f32_16x16x32_bf16 v[96:99], a[240:243], v[232:235], v[96:99]
    s_waitcnt lgkmcnt(2)
    s_add_u32 s74, s70, 0
    ds_read_b64_tr_b16 a[252:253], v61 offset:61440
    v_min_u32 v91, -2, v91
    v_mfma_f32_16x16x32_bf16 v[96:99], a[244:247], v[236:239], v[96:99]
    buffer_load_dwordx4 v[128:131], v44, s[8:11], s74 offen sc0 sc1
    ds_read_b64_tr_b16 a[254:255], v61 offset:63488
    v_mfma_f32_16x16x32_bf16 v[104:107], a[240:243], v[248:251], v[104:107]
    s_add_u32 s74, s70, 4096
    ds_read_b64_tr_b16 a[192:193], v62 offset:32768
    v_fmac_f32 v16, v55, v183
    v_mfma_f32_16x16x32_bf16 v[104:107], a[244:247], v[252:255], v[104:107]
    s_waitcnt lgkmcnt(1)
    s_add_u32 s75, s18, 8519680
    ds_read_b64_tr_b16 a[194:195], v62 offset:34816
    v_add_f32_dpp v16, v16, v16 quad_perm:[1,0,3,2] row_mask:0xf bank_mask:0xf
    v_mfma_f32_16x16x32_bf16 v[100:103], a[248:251], v[232:235], v[100:103]
    buffer_store_dwordx4 v[88:91], v23, s[8:11], s75 offen offset:256 sc0 sc1
    ds_read_b64_tr_b16 a[196:197], v62 offset:36864
    v_mfma_f32_16x16x32_bf16 v[100:103], a[252:255], v[236:239], v[100:103]
    buffer_load_dwordx4 v[132:135], v44, s[8:11], s74 offen sc0 sc1
    ds_read_b64_tr_b16 a[198:199], v62 offset:38912
    v_mfma_f32_16x16x32_bf16 v[108:111], a[248:251], v[248:251], v[108:111]
    s_add_u32 s74, s70, 8192
    ds_read_b64_tr_b16 a[200:201], v63 offset:32768
    v_add_f32_dpp v16, v16, v16 quad_perm:[2,3,0,1] row_mask:0xf bank_mask:0xf
    v_mfma_f32_16x16x32_bf16 v[108:111], a[252:255], v[252:255], v[108:111]
    s_waitcnt lgkmcnt(3)
    ds_read_b64_tr_b16 a[202:203], v63 offset:34816
    v_add_f32_dpp v16, v16, v16 row_half_mirror row_mask:0xf bank_mask:0xf
    v_mfma_f32_16x16x32_bf16 v[112:115], a[192:195], v[192:195], v[112:115]
    s_waitcnt lgkmcnt(2)
    ds_read_b64_tr_b16 a[204:205], v63 offset:36864
    v_add_f32_dpp v16, v16, v16 row_mirror row_mask:0xf bank_mask:0xf
    v_mfma_f32_16x16x32_bf16 v[112:115], a[196:199], v[196:199], v[112:115]
    buffer_load_dwordx4 v[136:139], v44, s[8:11], s74 offen sc0 sc1
    ds_read_b64_tr_b16 a[206:207], v63 offset:38912
    v_mfma_f32_16x16x32_bf16 v[120:123], a[192:195], v[208:211], v[120:123]
    s_add_u32 s74, s70, 12288
    ds_read_b64_tr_b16 a[208:209], v62 offset:40960
    v_mov_b32 v19, v16
    v_mfma_f32_16x16x32_bf16 v[120:123], a[196:199], v[212:215], v[120:123]
    s_waitcnt lgkmcnt(3)
    ds_read_b64_tr_b16 a[210:211], v62 offset:43008
    v_permlane16_swap_b32 v16, v19
    v_mfma_f32_16x16x32_bf16 v[116:119], a[200:203], v[192:195], v[116:119]
    s_waitcnt lgkmcnt(2)
    ds_read_b64_tr_b16 a[212:213], v62 offset:45056
    v_add_f32 v16, v16, v19
    v_mfma_f32_16x16x32_bf16 v[116:119], a[204:207], v[196:199], v[116:119]
    buffer_load_dwordx4 v[140:143], v44, s[8:11], s74 offen sc0 sc1
    ds_read_b64_tr_b16 a[214:215], v62 offset:47104
    v_mfma_f32_16x16x32_bf16 v[124:127], a[200:203], v[208:211], v[124:127]
    s_add_u32 s74, s70, 16384
    ds_read_b64_tr_b16 a[216:217], v63 offset:40960
    v_cvt_pk_bf16_f32 v96, v96, v97
    v_mfma_f32_16x16x32_bf16 v[124:127], a[204:207], v[212:215], v[124:127]
    s_waitcnt lgkmcnt(3)
    ds_read_b64_tr_b16 a[218:219], v63 offset:43008
    v_cvt_pk_bf16_f32 v97, v98, v99
    v_mfma_f32_16x16x32_bf16 v[112:115], a[208:211], v[200:203], v[112:115]
    s_waitcnt lgkmcnt(2)
    ds_read_b64_tr_b16 a[220:221], v63 offset:45056
    v_cvt_pk_bf16_f32 v98, v100, v101
    v_mfma_f32_16x16x32_bf16 v[112:115], a[212:215], v[204:207], v[112:115]
    buffer_load_dwordx4 v[144:147], v44, s[8:11], s74 offen sc0 sc1
    ds_read_b64_tr_b16 a[222:223], v63 offset:47104
    v_mfma_f32_16x16x32_bf16 v[120:123], a[208:211], v[216:219], v[120:123]
    s_add_u32 s74, s70, 20480
    ds_read_b64_tr_b16 a[224:225], v62 offset:49152
    v_cvt_pk_bf16_f32 v99, v102, v103
    v_mfma_f32_16x16x32_bf16 v[120:123], a[212:215], v[220:223], v[120:123]
    s_waitcnt lgkmcnt(3)
    ds_read_b64_tr_b16 a[226:227], v62 offset:51200
    v_min_u32 v96, -2, v96
    v_mfma_f32_16x16x32_bf16 v[116:119], a[216:219], v[200:203], v[116:119]
    s_waitcnt lgkmcnt(2)
    ds_read_b64_tr_b16 a[228:229], v62 offset:53248
    v_min_u32 v97, -2, v97
    v_mfma_f32_16x16x32_bf16 v[116:119], a[220:223], v[204:207], v[116:119]
    buffer_load_dwordx4 v[148:151], v44, s[8:11], s74 offen sc0 sc1
    ds_read_b64_tr_b16 a[230:231], v62 offset:55296
    v_mfma_f32_16x16x32_bf16 v[124:127], a[216:219], v[216:219], v[124:127]
    s_add_u32 s74, s70, 24576
    ds_read_b64_tr_b16 a[232:233], v63 offset:49152
    v_min_u32 v98, -2, v98
    v_mfma_f32_16x16x32_bf16 v[124:127], a[220:223], v[220:223], v[124:127]
    s_waitcnt lgkmcnt(3)
    ds_read_b64_tr_b16 a[234:235], v63 offset:51200
    v_min_u32 v99, -2, v99
    v_mfma_f32_16x16x32_bf16 v[112:115], a[224:227], v[224:227], v[112:115]
    s_waitcnt lgkmcnt(2)
    s_add_u32 s75, s18, 8388608
    ds_read_b64_tr_b16 a[236:237], v63 offset:53248
    v_mov_b32 v19, v16
    v_mfma_f32_16x16x32_bf16 v[112:115], a[228:231], v[228:231], v[112:115]
    buffer_load_dwordx4 v[152:155], v44, s[8:11], s74 offen sc0 sc1
    ds_read_b64_tr_b16 a[238:239], v63 offset:55296
    v_mfma_f32_16x16x32_bf16 v[120:123], a[224:227], v[240:243], v[120:123]
    s_waitcnt lgkmcnt(2)
    s_add_u32 s74, s70, 28672
    ds_read_b64_tr_b16 a[240:241], v62 offset:57344
    v_permlane32_swap_b32 v16, v19
    v_mfma_f32_16x16x32_bf16 v[120:123], a[228:231], v[244:247], v[120:123]
    buffer_store_dwordx4 v[96:99], v23, s[8:11], s75 offen offset:512 sc0 sc1
    ds_read_b64_tr_b16 a[242:243], v62 offset:59392
    v_add_f32 v16, v16, v19
    v_mfma_f32_16x16x32_bf16 v[116:119], a[232:235], v[224:227], v[116:119]
    s_waitcnt lgkmcnt(2)
    ds_read_b64_tr_b16 a[244:245], v62 offset:61440
    v_cvt_pk_bf16_f32 v104, v104, v105
    v_mfma_f32_16x16x32_bf16 v[116:119], a[236:239], v[228:231], v[116:119]
    buffer_load_dwordx4 v[156:159], v44, s[8:11], s74 offen sc0 sc1
    ds_read_b64_tr_b16 a[246:247], v62 offset:63488
    v_mfma_f32_16x16x32_bf16 v[124:127], a[232:235], v[240:243], v[124:127]
    ds_read_b64_tr_b16 a[248:249], v63 offset:57344
    v_cvt_pk_bf16_f32 v105, v106, v107
    v_mfma_f32_16x16x32_bf16 v[124:127], a[236:239], v[244:247], v[124:127]
    s_waitcnt lgkmcnt(3)
    ds_read_b64_tr_b16 a[250:251], v63 offset:59392
    v_cvt_pk_bf16_f32 v106, v108, v109
    v_mfma_f32_16x16x32_bf16 v[112:115], a[240:243], v[232:235], v[112:115]
    s_waitcnt lgkmcnt(2)
    ds_read_b64_tr_b16 a[252:253], v63 offset:61440
    v_cvt_pk_bf16_f32 v107, v110, v111
    v_mfma_f32_16x16x32_bf16 v[112:115], a[244:247], v[236:239], v[112:115]
    ds_read_b64_tr_b16 a[254:255], v63 offset:63488
    v_min_u32 v104, -2, v104
    v_mfma_f32_16x16x32_bf16 v[120:123], a[240:243], v[248:251], v[120:123]
    v_min_u32 v105, -2, v105
    v_mfma_f32_16x16x32_bf16 v[120:123], a[244:247], v[252:255], v[120:123]
    s_waitcnt lgkmcnt(2)
    v_min_u32 v106, -2, v106
    v_mfma_f32_16x16x32_bf16 v[116:119], a[248:251], v[232:235], v[116:119]
    s_waitcnt lgkmcnt(0)
    v_min_u32 v107, -2, v107
    v_mfma_f32_16x16x32_bf16 v[116:119], a[252:255], v[236:239], v[116:119]
    s_add_u32 s75, s18, 8519680
    v_mfma_f32_16x16x32_bf16 v[124:127], a[248:251], v[248:251], v[124:127]
    buffer_store_dwordx4 v[104:107], v23, s[8:11], s75 offen offset:512 sc0 sc1
    v_mfma_f32_16x16x32_bf16 v[124:127], a[252:255], v[252:255], v[124:127]
    v_cvt_pk_bf16_f32 v112, v112, v113
    v_cvt_pk_bf16_f32 v113, v114, v115
    s_nop 1
    v_cvt_pk_bf16_f32 v114, v116, v117
    v_cvt_pk_bf16_f32 v115, v118, v119
    v_min_u32 v112, -2, v112
    v_min_u32 v113, -2, v113
    v_min_u32 v114, -2, v114
    v_min_u32 v115, -2, v115
    s_add_u32 s75, s18, 8388608
    buffer_store_dwordx4 v[112:115], v23, s[8:11], s75 offen offset:768 sc0 sc1
    v_cvt_pk_bf16_f32 v120, v120, v121
    v_cvt_pk_bf16_f32 v121, v122, v123
    v_cvt_pk_bf16_f32 v122, v124, v125
    v_cvt_pk_bf16_f32 v123, v126, v127
    v_min_u32 v120, -2, v120
    v_min_u32 v121, -2, v121
    v_min_u32 v122, -2, v122
    v_min_u32 v123, -2, v123
    s_add_u32 s75, s18, 8519680
    buffer_store_dwordx4 v[120:123], v23, s[8:11], s75 offen offset:768 sc0 sc1
    s_mov_b32 s12, 0xf000f0
    s_mov_b32 s13, 0xf000f0
    v_mov_b64 v[192:193], -1
    v_mov_b64 v[194:195], -1
    v_mov_b64 v[196:197], -1
    v_mov_b64 v[198:199], -1
    v_mov_b64 v[200:201], -1
    v_mov_b64 v[202:203], -1
    v_mov_b64 v[204:205], -1
    v_mov_b64 v[206:207], -1
    v_mov_b64 v[208:209], -1
    v_mov_b64 v[210:211], -1
    v_mov_b64 v[212:213], -1
    v_mov_b64 v[214:215], -1
    v_mov_b64 v[216:217], -1
    v_mov_b64 v[218:219], -1
    v_mov_b64 v[220:221], -1
    v_mov_b64 v[222:223], -1
    s_mov_b64 exec, s[12:13]
    s_add_u32 s74, s70, 8388608
    buffer_load_dwordx4 v[192:195], v44, s[8:11], s74 offen sc0 sc1
    s_add_u32 s74, s70, 8392704
    buffer_load_dwordx4 v[196:199], v44, s[8:11], s74 offen sc0 sc1
    s_add_u32 s74, s70, 8396800
    buffer_load_dwordx4 v[200:203], v44, s[8:11], s74 offen sc0 sc1
    s_add_u32 s74, s70, 8400896
    buffer_load_dwordx4 v[204:207], v44, s[8:11], s74 offen sc0 sc1
    s_add_u32 s74, s70, 8404992
    buffer_load_dwordx4 v[208:211], v44, s[8:11], s74 offen sc0 sc1
    s_add_u32 s74, s70, 8409088
    buffer_load_dwordx4 v[212:215], v44, s[8:11], s74 offen sc0 sc1
    s_add_u32 s74, s70, 8413184
    buffer_load_dwordx4 v[216:219], v44, s[8:11], s74 offen sc0 sc1
    s_add_u32 s74, s70, 8417280
    buffer_load_dwordx4 v[220:223], v44, s[8:11], s74 offen sc0 sc1
    s_mov_b64 exec, -1
    v_mov_b32 v100, 0x3f80
    v_mov_b32 v101, 0x3f800000
    v_lshlrev_b32 v72, 16, v32
    v_and_b32 v73, 0xffff0000, v32
    v_lshlrev_b32 v74, 16, v33
    v_and_b32 v75, 0xffff0000, v33
    v_lshlrev_b32 v76, 16, v34
    v_and_b32 v77, 0xffff0000, v34
    v_lshlrev_b32 v78, 16, v35
    v_and_b32 v79, 0xffff0000, v35
    v_lshlrev_b32 v88, 16, v36
    v_and_b32 v89, 0xffff0000, v36
    v_lshlrev_b32 v90, 16, v37
    v_and_b32 v91, 0xffff0000, v37
    v_lshlrev_b32 v92, 16, v38
    v_and_b32 v93, 0xffff0000, v38
    v_lshlrev_b32 v94, 16, v39
    v_and_b32 v95, 0xffff0000, v39
    s_waitcnt vmcnt(20)
    v_max_u32 v3, v128, v129
    v_max3_u32 v3, v3, v130, v131
    s_waitcnt vmcnt(18)
    v_max3_u32 v3, v3, v132, v133
    v_max3_u32 v3, v3, v134, v135
    s_waitcnt vmcnt(17)
    v_max3_u32 v3, v3, v136, v137
    v_max3_u32 v3, v3, v138, v139
    s_waitcnt vmcnt(16)
    v_max3_u32 v3, v3, v140, v141
    v_max3_u32 v3, v3, v142, v143
    s_waitcnt vmcnt(15)
    v_max3_u32 v3, v3, v144, v145
    v_max3_u32 v3, v3, v146, v147
    s_waitcnt vmcnt(14)
    v_max3_u32 v3, v3, v148, v149
    v_max3_u32 v3, v3, v150, v151
    s_waitcnt vmcnt(13)
    v_max3_u32 v3, v3, v152, v153
    v_max3_u32 v3, v3, v154, v155
    s_waitcnt vmcnt(11)
    v_max3_u32 v3, v3, v156, v157
    v_max3_u32 v3, v3, v158, v159
    v_cmp_eq_u32 vcc, -1, v3
    s_cbranch_vccnz L_P1_slow_15
L_P1_ok_16:
    v_lshlrev_b32 v64, 16, v128
    v_and_b32 v65, 0xffff0000, v128
    v_lshlrev_b32 v66, 16, v129
    v_and_b32 v67, 0xffff0000, v129
    v_lshlrev_b32 v68, 16, v130
    v_and_b32 v69, 0xffff0000, v130
    v_lshlrev_b32 v70, 16, v131
    v_and_b32 v71, 0xffff0000, v131
    v_dot2c_f32_bf16 v64, v132, v100
    v_dot2c_f32_bf16 v65, v132, v101
    v_dot2c_f32_bf16 v66, v133, v100
    v_dot2c_f32_bf16 v67, v133, v101
    v_dot2c_f32_bf16 v68, v134, v100
    v_dot2c_f32_bf16 v69, v134, v101
    v_dot2c_f32_bf16 v70, v135, v100
    v_dot2c_f32_bf16 v71, v135, v101
    v_dot2c_f32_bf16 v64, v136, v100
    v_dot2c_f32_bf16 v65, v136, v101
    v_dot2c_f32_bf16 v66, v137, v100
    v_dot2c_f32_bf16 v67, v137, v101
    v_dot2c_f32_bf16 v68, v138, v100
    v_dot2c_f32_bf16 v69, v138, v101
    v_dot2c_f32_bf16 v70, v139, v100
    v_dot2c_f32_bf16 v71, v139, v101
    v_dot2c_f32_bf16 v64, v140, v100
    v_dot2c_f32_bf16 v65, v140, v101
    v_dot2c_f32_bf16 v66, v141, v100
    v_dot2c_f32_bf16 v67, v141, v101
    v_dot2c_f32_bf16 v68, v142, v100
    v_dot2c_f32_bf16 v69, v142, v101
    v_dot2c_f32_bf16 v70, v143, v100
    v_dot2c_f32_bf16 v71, v143, v101
    v_dot2c_f32_bf16 v64, v144, v100
    v_dot2c_f32_bf16 v65, v144, v101
    v_dot2c_f32_bf16 v66, v145, v100
    v_dot2c_f32_bf16 v67, v145, v101
    v_dot2c_f32_bf16 v68, v146, v100
    v_dot2c_f32_bf16 v69, v146, v101
    v_dot2c_f32_bf16 v70, v147, v100
    v_dot2c_f32_bf16 v71, v147, v101
    v_dot2c_f32_bf16 v64, v148, v100
    v_dot2c_f32_bf16 v65, v148, v101
    v_dot2c_f32_bf16 v66, v149, v100
    v_dot2c_f32_bf16 v67, v149, v101
    v_dot2c_f32_bf16 v68, v150, v100
    v_dot2c_f32_bf16 v69, v150, v101
    v_dot2c_f32_bf16 v70, v151, v100
    v_dot2c_f32_bf16 v71, v151, v101
    v_dot2c_f32_bf16 v64, v152, v100
    v_dot2c_f32_bf16 v65, v152, v101
    v_dot2c_f32_bf16 v66, v153, v100
    v_dot2c_f32_bf16 v67, v153, v101
    v_dot2c_f32_bf16 v68, v154, v100
    v_dot2c_f32_bf16 v69, v154, v101
    v_dot2c_f32_bf16 v70, v155, v100
    v_dot2c_f32_bf16 v71, v155, v101
    v_dot2c_f32_bf16 v64, v156, v100
    v_dot2c_f32_bf16 v65, v156, v101
    v_dot2c_f32_bf16 v66, v157, v100
    v_dot2c_f32_bf16 v67, v157, v101
    v_dot2c_f32_bf16 v68, v158, v100
    v_dot2c_f32_bf16 v69, v158, v101
    v_dot2c_f32_bf16 v70, v159, v100
    v_dot2c_f32_bf16 v71, v159, v101
    v_pk_fma_f32 v[64:65], v[64:65], v[160:161], v[72:73]
    v_pk_fma_f32 v[66:67], v[66:67], v[162:163], v[74:75]
    v_pk_fma_f32 v[68:69], v[68:69], v[164:165], v[76:77]
    v_pk_fma_f32 v[70:71], v[70:71], v[166:167], v[78:79]
    v_cvt_pk_bf16_f32 v32, v64, v65
    v_cvt_pk_bf16_f32 v33, v66, v67
    v_cvt_pk_bf16_f32 v34, v68, v69
    v_cvt_pk_bf16_f32 v35, v70, v71
    v_lshlrev_b32 v64, 16, v32
    v_and_b32 v65, 0xffff0000, v32
    v_lshlrev_b32 v66, 16, v33
    v_and_b32 v67, 0xffff0000, v33
    v_lshlrev_b32 v68, 16, v34
    v_and_b32 v69, 0xffff0000, v34
    v_lshlrev_b32 v70, 16, v35
    v_and_b32 v71, 0xffff0000, v35
    v_pk_add_f32 v[48:49], v[64:65], v[66:67]
    v_pk_add_f32 v[50:51], v[68:69], v[70:71]
    v_pk_add_f32 v[48:49], v[48:49], v[50:51]
    v_add_f32 v48, v48, v49
    s_nop 1
    v_add_f32_dpp v48, v48, v48 quad_perm:[1,0,3,2] row_mask:0xf bank_mask:0xf
    s_nop 1
    v_add_f32_dpp v48, v48, v48 quad_perm:[2,3,0,1] row_mask:0xf bank_mask:0xf
    s_nop 1
    v_add_f32_dpp v48, v48, v48 row_half_mirror row_mask:0xf bank_mask:0xf
    s_nop 1
    v_add_f32_dpp v48, v48, v48 row_mirror row_mask:0xf bank_mask:0xf
    v_mov_b32 v49, v48
    s_nop 1
    v_permlane16_swap_b32 v48, v49
    v_add_f32 v48, v48, v49
    v_mov_b32 v49, v48
    s_nop 1
    v_permlane32_swap_b32 v48, v49
    v_add_f32 v48, v48, v49
    v_mul_f32 v48, 0xbb000000, v48
    v_pk_add_f32 v[72:73], v[64:65], v[48:49] op_sel_hi:[1,0]
    v_pk_add_f32 v[74:75], v[66:67], v[48:49] op_sel_hi:[1,0]
    v_pk_add_f32 v[76:77], v[68:69], v[48:49] op_sel_hi:[1,0]
    v_pk_add_f32 v[78:79], v[70:71], v[48:49] op_sel_hi:[1,0]
    v_pk_mul_f32 v[50:51], v[72:73], v[72:73]
    v_pk_mul_f32 v[52:53], v[72:73], v[8:9]
    v_pk_fma_f32 v[50:51], v[74:75], v[74:75], v[50:51]
    v_pk_fma_f32 v[52:53], v[74:75], v[10:11], v[52:53]
    v_pk_fma_f32 v[50:51], v[76:77], v[76:77], v[50:51]
    v_pk_fma_f32 v[52:53], v[76:77], v[12:13], v[52:53]
    v_pk_fma_f32 v[50:51], v[78:79], v[78:79], v[50:51]
    v_pk_fma_f32 v[52:53], v[78:79], v[14:15], v[52:53]
    v_add_f32 v50, v50, v51
    v_add_f32 v52, v52, v53
    s_nop 0
    v_add_f32_dpp v50, v50, v50 quad_perm:[1,0,3,2] row_mask:0xf bank_mask:0xf
    v_add_f32_dpp v52, v52, v52 quad_perm:[1,0,3,2] row_mask:0xf bank_mask:0xf
    s_nop 0
    v_add_f32_dpp v50, v50, v50 quad_perm:[2,3,0,1] row_mask:0xf bank_mask:0xf
    v_add_f32_dpp v52, v52, v52 quad_perm:[2,3,0,1] row_mask:0xf bank_mask:0xf
    s_nop 0
    v_add_f32_dpp v50, v50, v50 row_half_mirror row_mask:0xf bank_mask:0xf
    v_add_f32_dpp v52, v52, v52 row_half_mirror row_mask:0xf bank_mask:0xf
    s_nop 0
    v_add_f32_dpp v50, v50, v50 row_mirror row_mask:0xf bank_mask:0xf
    v_add_f32_dpp v52, v52, v52 row_mirror row_mask:0xf bank_mask:0xf
    v_mov_b32 v51, v50
    v_mov_b32 v53, v52
    s_nop 0
    v_permlane16_swap_b32 v50, v51
    v_permlane16_swap_b32 v52, v53
    v_add_f32 v50, v50, v51
    v_add_f32 v52, v52, v53
    v_mov_b32 v51, v50
    v_mov_b32 v53, v52
    s_nop 0
    v_permlane32_swap_b32 v50, v51
    v_permlane32_swap_b32 v52, v53
    v_add_f32 v50, v50, v51
    v_add_f32 v52, v52, v53
    v_mov_b32 v48, 0x3727c5ac
    v_fmac_f32 v48, 0x3b000000, v50
    v_rsq_f32 v48, v48
    s_nop 0
    v_fma_f32 v52, v52, v48, v16
    v_ashrrev_i32 v53, 31, v52
    v_or_b32 v53, 0x80000000, v53
    v_xor_b32 v53, v53, v52
    v_and_b32 v53, 0xfffff800, v53
    v_or_b32 v17, s68, v53
    v_pk_mul_f32 v[72:73], v[72:73], v[48:49] op_sel_hi:[1,0]
    v_pk_mul_f32 v[74:75], v[74:75], v[48:49] op_sel_hi:[1,0]
    v_pk_mul_f32 v[76:77], v[76:77], v[48:49] op_sel_hi:[1,0]
    v_pk_mul_f32 v[78:79], v[78:79], v[48:49] op_sel_hi:[1,0]
    v_pk_fma_f32 v[72:73], v[72:73], v[168:169], v[176:177]
    v_pk_fma_f32 v[74:75], v[74:75], v[170:171], v[178:179]
    v_pk_fma_f32 v[76:77], v[76:77], v[172:173], v[180:181]
    v_pk_fma_f32 v[78:79], v[78:79], v[174:175], v[182:183]
    v_cvt_pk_bf16_f32 v20, v72, v73
    v_cvt_pk_bf16_f32 v21, v74, v75
    v_cvt_pk_bf16_f32 v22, v76, v77
    v_cvt_pk_bf16_f32 v23, v78, v79
    v_lshlrev_b32 v98, 4, v0
    v_cmp_gt_u32 vcc, 224, v0
    v_mov_b32 v99, 2147479552
    s_nop 0
    v_cndmask_b32 v99, v99, v98, vcc
    s_lshl_b32 s17, s66, 13
    s_add_u32 s17, s17, 4194304
    s_cmp_lt_u32 s66, 224
    s_cselect_b32 s17, s17, 2143285248
    s_lshl_b32 s100, s3, 2
    v_mov_b32 v47, s100
    v_mov_b32 v102, 0
    s_lshl_b32 s100, s2, 6
    s_add_u32 s100, s100, 65536
    s_lshl_b32 s101, s2, 11
    s_add_u32 s101, s101, 524288
    s_mov_b32 s99, 0
L_P2_l_17:
    s_waitcnt vmcnt(0)
    v_max_u32 v48, v192, v193
    v_max3_u32 v48, v48, v194, v195
    v_max_u32 v49, v196, v197
    v_max3_u32 v49, v49, v198, v199
    v_max_u32 v50, v200, v201
    v_max3_u32 v50, v50, v202, v203
    v_max_u32 v51, v204, v205
    v_max3_u32 v51, v51, v206, v207
    v_max_u32 v52, v208, v209
    v_max3_u32 v52, v52, v210, v211
    v_max_u32 v53, v212, v213
    v_max3_u32 v53, v53, v214, v215
    v_max_u32 v54, v216, v217
    v_max3_u32 v54, v54, v218, v219
    v_max_u32 v55, v220, v221
    v_max3_u32 v55, v55, v222, v223
    v_max3_u32 v3, v48, v49, v50
    v_max3_u32 v3, v3, v51, v52
    v_max3_u32 v3, v3, v53, v54
    v_max_u32 v3, v3, v55
    v_cmp_eq_u32 vcc, -1, v3
    s_add_u32 s99, s99, 1
    s_cbranch_vccz L_P2_ok_18
    s_cmp_ge_u32 s99, 200000
    s_cbranch_scc1 L_P2_ok_18
    s_sleep 1
    v_cmp_eq_u32 vcc, -1, v48
    s_cbranch_vccz L_P2_s_19
    s_and_b64 s[96:97], vcc, s[12:13]
    s_cselect_b64 exec, s[96:97], vcc
    s_add_u32 s74, s70, 8388608
    buffer_load_dwordx4 v[192:195], v44, s[8:11], s74 offen sc0 sc1
    s_mov_b64 exec, -1
L_P2_s_19:
    v_cmp_eq_u32 vcc, -1, v49
    s_cbranch_vccz L_P2_s_20
    s_and_b64 s[96:97], vcc, s[12:13]
    s_cselect_b64 exec, s[96:97], vcc
    s_add_u32 s74, s70, 8392704
    buffer_load_dwordx4 v[196:199], v44, s[8:11], s74 offen sc0 sc1
    s_mov_b64 exec, -1
L_P2_s_20:
    v_cmp_eq_u32 vcc, -1, v50
    s_cbranch_vccz L_P2_s_21
    s_and_b64 s[96:97], vcc, s[12:13]
    s_cselect_b64 exec, s[96:97], vcc
    s_add_u32 s74, s70, 8396800
    buffer_load_dwordx4 v[200:203], v44, s[8:11], s74 offen sc0 sc1
    s_mov_b64 exec, -1
L_P2_s_21:
    v_cmp_eq_u32 vcc, -1, v51
    s_cbranch_vccz L_P2_s_22
    s_and_b64 s[96:97], vcc, s[12:13]
    s_cselect_b64 exec, s[96:97], vcc
    s_add_u32 s74, s70, 8400896
    buffer_load_dwordx4 v[204:207], v44, s[8:11], s74 offen sc0 sc1
    s_mov_b64 exec, -1
L_P2_s_22:
    v_cmp_eq_u32 vcc, -1, v52
    s_cbranch_vccz L_P2_s_23
    s_and_b64 s[96:97], vcc, s[12:13]
    s_cselect_b64 exec, s[96:97], vcc
    s_add_u32 s74, s70, 8404992
    buffer_load_dwordx4 v[208:211], v44, s[8:11], s74 offen sc0 sc1
    s_mov_b64 exec, -1
L_P2_s_23:
    v_cmp_eq_u32 vcc, -1, v53
    s_cbranch_vccz L_P2_s_24
    s_and_b64 s[96:97], vcc, s[12:13]
    s_cselect_b64 exec, s[96:97], vcc
    s_add_u32 s74, s70, 8409088
    buffer_load_dwordx4 v[212:215], v44, s[8:11], s74 offen sc0 sc1
    s_mov_b64 exec, -1
L_P2_s_24:
    v_cmp_eq_u32 vcc, -1, v54
    s_cbranch_vccz L_P2_s_25
    s_and_b64 s[96:97], vcc, s[12:13]
    s_cselect_b64 exec, s[96:97], vcc
    s_add_u32 s74, s70, 8413184
    buffer_load_dwordx4 v[216:219], v44, s[8:11], s74 offen sc0 sc1
    s_mov_b64 exec, -1
L_P2_s_25:
    v_cmp_eq_u32 vcc, -1, v55
    s_cbranch_vccz L_P2_s_26
    s_and_b64 s[96:97], vcc, s[12:13]
    s_cselect_b64 exec, s[96:97], vcc
    s_add_u32 s74, s70, 8417280
    buffer_load_dwordx4 v[220:223], v44, s[8:11], s74 offen sc0 sc1
    s_mov_b64 exec, -1
L_P2_s_26:
    s_branch L_P2_l_17
L_P2_ok_18:
    v_lshlrev_b32 v80, 16, v192
    v_and_b32 v81, 0xffff0000, v192
    v_lshlrev_b32 v82, 16, v193
    v_and_b32 v83, 0xffff0000, v193
    v_lshlrev_b32 v84, 16, v194
    v_and_b32 v85, 0xffff0000, v194
    v_lshlrev_b32 v86, 16, v195
    v_and_b32 v87, 0xffff0000, v195
    v_dot2c_f32_bf16 v80, v196, v100
    v_dot2c_f32_bf16 v81, v196, v101
    v_dot2c_f32_bf16 v82, v197, v100
    v_dot2c_f32_bf16 v83, v197, v101
    v_dot2c_f32_bf16 v84, v198, v100
    v_dot2c_f32_bf16 v85, v198, v101
    v_dot2c_f32_bf16 v86, v199, v100
    v_dot2c_f32_bf16 v87, v199, v101
    v_dot2c_f32_bf16 v80, v200, v100
    v_dot2c_f32_bf16 v81, v200, v101
    v_dot2c_f32_bf16 v82, v201, v100
    v_dot2c_f32_bf16 v83, v201, v101
    v_dot2c_f32_bf16 v84, v202, v100
    v_dot2c_f32_bf16 v85, v202, v101
    v_dot2c_f32_bf16 v86, v203, v100
    v_dot2c_f32_bf16 v87, v203, v101
    v_dot2c_f32_bf16 v80, v204, v100
    v_dot2c_f32_bf16 v81, v204, v101
    v_dot2c_f32_bf16 v82, v205, v100
    v_dot2c_f32_bf16 v83, v205, v101
    v_dot2c_f32_bf16 v84, v206, v100
    v_dot2c_f32_bf16 v85, v206, v101
    v_dot2c_f32_bf16 v86, v207, v100
    v_dot2c_f32_bf16 v87, v207, v101
    v_dot2c_f32_bf16 v80, v208, v100
    v_dot2c_f32_bf16 v81, v208, v101
    v_dot2c_f32_bf16 v82, v209, v100
    v_dot2c_f32_bf16 v83, v209, v101
    v_dot2c_f32_bf16 v84, v210, v100
    v_dot2c_f32_bf16 v85, v210, v101
    v_dot2c_f32_bf16 v86, v211, v100
    v_dot2c_f32_bf16 v87, v211, v101
    v_dot2c_f32_bf16 v80, v212, v100
    v_dot2c_f32_bf16 v81, v212, v101
    v_dot2c_f32_bf16 v82, v213, v100
    v_dot2c_f32_bf16 v83, v213, v101
    v_dot2c_f32_bf16 v84, v214, v100
    v_dot2c_f32_bf16 v85, v214, v101
    v_dot2c_f32_bf16 v86, v215, v100
    v_dot2c_f32_bf16 v87, v215, v101
    v_dot2c_f32_bf16 v80, v216, v100
    v_dot2c_f32_bf16 v81, v216, v101
    v_dot2c_f32_bf16 v82, v217, v100
    v_dot2c_f32_bf16 v83, v217, v101
    v_dot2c_f32_bf16 v84, v218, v100
    v_dot2c_f32_bf16 v85, v218, v101
    v_dot2c_f32_bf16 v86, v219, v100
    v_dot2c_f32_bf16 v87, v219, v101
    v_dot2c_f32_bf16 v80, v220, v100
    v_dot2c_f32_bf16 v81, v220, v101
    v_dot2c_f32_bf16 v82, v221, v100
    v_dot2c_f32_bf16 v83, v221, v101
    v_dot2c_f32_bf16 v84, v222, v100
    v_dot2c_f32_bf16 v85, v222, v101
    v_dot2c_f32_bf16 v86, v223, v100
    v_dot2c_f32_bf16 v87, v223, v101
    v_pk_fma_f32 v[80:81], v[80:81], v[160:161], v[88:89]
    v_pk_fma_f32 v[82:83], v[82:83], v[162:163], v[90:91]
    v_pk_fma_f32 v[84:85], v[84:85], v[164:165], v[92:93]
    v_pk_fma_f32 v[86:87], v[86:87], v[166:167], v[94:95]
    v_cvt_pk_bf16_f32 v36, v80, v81
    v_cvt_pk_bf16_f32 v37, v82, v83
    v_cvt_pk_bf16_f32 v38, v84, v85
    v_cvt_pk_bf16_f32 v39, v86, v87
    v_lshlrev_b32 v80, 16, v36
    v_and_b32 v81, 0xffff0000, v36
    v_lshlrev_b32 v82, 16, v37
    v_and_b32 v83, 0xffff0000, v37
    v_lshlrev_b32 v84, 16, v38
    v_and_b32 v85, 0xffff0000, v38
    v_lshlrev_b32 v86, 16, v39
    v_and_b32 v87, 0xffff0000, v39
    v_pk_add_f32 v[48:49], v[80:81], v[82:83]
    v_pk_add_f32 v[50:51], v[84:85], v[86:87]
    v_pk_add_f32 v[48:49], v[48:49], v[50:51]
    v_add_f32 v48, v48, v49
    s_nop 1
    v_add_f32_dpp v48, v48, v48 quad_perm:[1,0,3,2] row_mask:0xf bank_mask:0xf
    s_nop 1
    v_add_f32_dpp v48, v48, v48 quad_perm:[2,3,0,1] row_mask:0xf bank_mask:0xf
    s_nop 1
    v_add_f32_dpp v48, v48, v48 row_half_mirror row_mask:0xf bank_mask:0xf
    s_nop 1
    v_add_f32_dpp v48, v48, v48 row_mirror row_mask:0xf bank_mask:0xf
    v_mov_b32 v49, v48
    s_nop 1
    v_permlane16_swap_b32 v48, v49
    v_add_f32 v48, v48, v49
    v_mov_b32 v49, v48
    s_nop 1
    v_permlane32_swap_b32 v48, v49
    v_add_f32 v48, v48, v49
    v_mul_f32 v48, 0xbb000000, v48
    v_pk_add_f32 v[88:89], v[80:81], v[48:49] op_sel_hi:[1,0]
    v_pk_add_f32 v[90:91], v[82:83], v[48:49] op_sel_hi:[1,0]
    v_pk_add_f32 v[92:93], v[84:85], v[48:49] op_sel_hi:[1,0]
    v_pk_add_f32 v[94:95], v[86:87], v[48:49] op_sel_hi:[1,0]
    v_pk_mul_f32 v[50:51], v[88:89], v[88:89]
    v_pk_mul_f32 v[52:53], v[88:89], v[8:9]
    v_pk_fma_f32 v[50:51], v[90:91], v[90:91], v[50:51]
    v_pk_fma_f32 v[52:53], v[90:91], v[10:11], v[52:53]
    v_pk_fma_f32 v[50:51], v[92:93], v[92:93], v[50:51]
    v_pk_fma_f32 v[52:53], v[92:93], v[12:13], v[52:53]
    v_pk_fma_f32 v[50:51], v[94:95], v[94:95], v[50:51]
    v_pk_fma_f32 v[52:53], v[94:95], v[14:15], v[52:53]
    v_add_f32 v50, v50, v51
    v_add_f32 v52, v52, v53
    s_nop 0
    v_add_f32_dpp v50, v50, v50 quad_perm:[1,0,3,2] row_mask:0xf bank_mask:0xf
    v_add_f32_dpp v52, v52, v52 quad_perm:[1,0,3,2] row_mask:0xf bank_mask:0xf
    s_nop 0
    v_add_f32_dpp v50, v50, v50 quad_perm:[2,3,0,1] row_mask:0xf bank_mask:0xf
    v_add_f32_dpp v52, v52, v52 quad_perm:[2,3,0,1] row_mask:0xf bank_mask:0xf
    s_nop 0
    v_add_f32_dpp v50, v50, v50 row_half_mirror row_mask:0xf bank_mask:0xf
    v_add_f32_dpp v52, v52, v52 row_half_mirror row_mask:0xf bank_mask:0xf
    s_nop 0
    v_add_f32_dpp v50, v50, v50 row_mirror row_mask:0xf bank_mask:0xf
    v_add_f32_dpp v52, v52, v52 row_mirror row_mask:0xf bank_mask:0xf
    v_mov_b32 v51, v50
    v_mov_b32 v53, v52
    s_nop 0
    v_permlane16_swap_b32 v50, v51
    v_permlane16_swap_b32 v52, v53
    v_add_f32 v50, v50, v51
    v_add_f32 v52, v52, v53
    v_mov_b32 v51, v50
    v_mov_b32 v53, v52
    s_nop 0
    v_permlane32_swap_b32 v50, v51
    v_permlane32_swap_b32 v52, v53
    v_add_f32 v50, v50, v51
    v_add_f32 v52, v52, v53
    v_mov_b32 v48, 0x3727c5ac
    v_fmac_f32 v48, 0x3b000000, v50
    v_rsq_f32 v48, v48
    s_nop 0
    v_fma_f32 v52, v52, v48, v16
    v_ashrrev_i32 v53, 31, v52
    v_or_b32 v53, 0x80000000, v53
    v_xor_b32 v53, v53, v52
    v_and_b32 v53, 0xfffff800, v53
    v_or_b32 v18, s69, v53
    v_max3_u32 v19, v17, v18, 1
    ds_write_b32 v47, v19
    s_waitcnt lgkmcnt(0)
    s_barrier
    ds_read_b128 v[52:55], v102
    v_pk_mul_f32 v[88:89], v[88:89], v[48:49] op_sel_hi:[1,0]
    v_pk_mul_f32 v[90:91], v[90:91], v[48:49] op_sel_hi:[1,0]
    v_pk_mul_f32 v[92:93], v[92:93], v[48:49] op_sel_hi:[1,0]
    v_pk_mul_f32 v[94:95], v[94:95], v[48:49] op_sel_hi:[1,0]
    v_pk_fma_f32 v[88:89], v[88:89], v[168:169], v[176:177]
    v_pk_fma_f32 v[90:91], v[90:91], v[170:171], v[178:179]
    v_pk_fma_f32 v[92:93], v[92:93], v[172:173], v[180:181]
    v_pk_fma_f32 v[94:95], v[94:95], v[174:175], v[182:183]
    v_cvt_pk_bf16_f32 v24, v88, v89
    v_cvt_pk_bf16_f32 v25, v90, v91
    v_cvt_pk_bf16_f32 v26, v92, v93
    v_cvt_pk_bf16_f32 v27, v94, v95
    s_waitcnt lgkmcnt(0)
    v_max_u32 v52, v52, v53
    v_max3_u32 v52, v52, v54, v55
    v_cmp_eq_u32 vcc, v52, v19
    s_cbranch_vccz L_notbest
    buffer_store_dword v19, v5, s[8:11], s100 offen sc0 sc1
    v_cmp_gt_u32 vcc, v17, v18
    s_nop 1
    v_cndmask_b32 v28, v24, v20, vcc
    v_cndmask_b32 v40, v36, v32, vcc
    v_cndmask_b32 v29, v25, v21, vcc
    v_cndmask_b32 v41, v37, v33, vcc
    v_cndmask_b32 v30, v26, v22, vcc
    v_cndmask_b32 v42, v38, v34, vcc
    v_cndmask_b32 v31, v27, v23, vcc
    v_cndmask_b32 v43, v39, v35, vcc
    v_min_u32 v28, -2, v28
    v_min_u32 v40, -2, v40
    v_min_u32 v29, -2, v29
    v_min_u32 v41, -2, v41
    v_min_u32 v30, -2, v30
    v_min_u32 v42, -2, v42
    v_min_u32 v31, -2, v31
    v_min_u32 v43, -2, v43
    buffer_store_dwordx4 v[28:31], v1, s[8:11], s101 offen sc0 sc1
    buffer_store_dwordx4 v[40:43], v1, s[8:11], s101 offen offset:1024 sc0 sc1
L_notbest:
    buffer_load_dwordx4 v[112:115], v98, s[8:11], s17 offen
    s_add_u32 s17, s17, 4096
    buffer_load_dwordx4 v[116:119], v98, s[8:11], s17 offen
    s_add_u32 s17, s17, 2093056
    buffer_load_dwordx4 v[120:123], v98, s[8:11], s17 offen
    s_add_u32 s17, s17, 4096
    buffer_load_dwordx4 v[124:127], v98, s[8:11], s17 offen
    s_mul_i32 s17, s67, 28672
    s_add_u32 s17, s17, 8388608
    s_cmp_lt_u32 s67, 64
    s_cselect_b32 s17, s17, 2143285248
    buffer_load_dwordx4 v[128:131], v99, s[8:11], s17 offen offset:0
    buffer_load_dwordx4 v[132:135], v99, s[8:11], s17 offen offset:3584
    s_add_u32 s17, s17, 7168
    buffer_load_dwordx4 v[136:139], v99, s[8:11], s17 offen offset:0
    buffer_load_dwordx4 v[140:143], v99, s[8:11], s17 offen offset:3584
    s_add_u32 s17, s17, 7168
    buffer_load_dwordx4 v[144:147], v99, s[8:11], s17 offen offset:0
    buffer_load_dwordx4 v[148:151], v99, s[8:11], s17 offen offset:3584
    s_add_u32 s17, s17, 7168
    buffer_load_dwordx4 v[152:155], v99, s[8:11], s17 offen offset:0
    buffer_load_dwordx4 v[156:159], v99, s[8:11], s17 offen offset:3584
    v_lshlrev_b32 v72, 16, v20
    v_and_b32 v73, 0xffff0000, v20
    v_lshlrev_b32 v74, 16, v21
    v_and_b32 v75, 0xffff0000, v21
    v_lshlrev_b32 v76, 16, v22
    v_and_b32 v77, 0xffff0000, v22
    v_lshlrev_b32 v78, 16, v23
    v_and_b32 v79, 0xffff0000, v23
    v_pk_mul_f32 v[72:73], v[72:73], v[184:185]
    v_pk_mul_f32 v[74:75], v[74:75], v[186:187]
    v_pk_mul_f32 v[76:77], v[76:77], v[188:189]
    v_pk_mul_f32 v[78:79], v[78:79], v[190:191]
    v_cvt_pk_bf16_f32 v56, v72, v73
    v_cvt_pk_bf16_f32 v57, v74, v75
    v_cvt_pk_bf16_f32 v58, v76, v77
    v_cvt_pk_bf16_f32 v59, v78, v79
    v_lshlrev_b32 v72, 16, v56
    v_and_b32 v73, 0xffff0000, v56
    v_lshlrev_b32 v74, 16, v57
    v_and_b32 v75, 0xffff0000, v57
    v_lshlrev_b32 v76, 16, v58
    v_and_b32 v77, 0xffff0000, v58
    v_lshlrev_b32 v78, 16, v59
    v_and_b32 v79, 0xffff0000, v59
    v_pk_add_f32 v[72:73], v[72:73], v[64:65]
    v_pk_add_f32 v[74:75], v[74:75], v[66:67]
    v_pk_add_f32 v[76:77], v[76:77], v[68:69]
    v_pk_add_f32 v[78:79], v[78:79], v[70:71]
    v_cvt_pk_bf16_f32 v56, v72, v73
    v_cvt_pk_bf16_f32 v57, v74, v75
    v_cvt_pk_bf16_f32 v58, v76, v77
    v_cvt_pk_bf16_f32 v59, v78, v79
    v_lshlrev_b32 v88, 16, v24
    v_and_b32 v89, 0xffff0000, v24
    v_lshlrev_b32 v90, 16, v25
    v_and_b32 v91, 0xffff0000, v25
    v_lshlrev_b32 v92, 16, v26
    v_and_b32 v93, 0xffff0000, v26
    v_lshlrev_b32 v94, 16, v27
    v_and_b32 v95, 0xffff0000, v27
    v_pk_mul_f32 v[88:89], v[88:89], v[184:185]
    v_pk_mul_f32 v[90:91], v[90:91], v[186:187]
    v_pk_mul_f32 v[92:93], v[92:93], v[188:189]
    v_pk_mul_f32 v[94:95], v[94:95], v[190:191]
    v_cvt_pk_bf16_f32 v60, v88, v89
    v_cvt_pk_bf16_f32 v61, v90, v91
    v_cvt_pk_bf16_f32 v62, v92, v93
    v_cvt_pk_bf16_f32 v63, v94, v95
    v_lshlrev_b32 v88, 16, v60
    v_and_b32 v89, 0xffff0000, v60
    v_lshlrev_b32 v90, 16, v61
    v_and_b32 v91, 0xffff0000, v61
    v_lshlrev_b32 v92, 16, v62
    v_and_b32 v93, 0xffff0000, v62
    v_lshlrev_b32 v94, 16, v63
    v_and_b32 v95, 0xffff0000, v63
    v_pk_add_f32 v[88:89], v[88:89], v[80:81]
    v_pk_add_f32 v[90:91], v[90:91], v[82:83]
    v_pk_add_f32 v[92:93], v[92:93], v[84:85]
    v_pk_add_f32 v[94:95], v[94:95], v[86:87]
    v_cvt_pk_bf16_f32 v60, v88, v89
    v_cvt_pk_bf16_f32 v61, v90, v91
    v_cvt_pk_bf16_f32 v62, v92, v93
    v_cvt_pk_bf16_f32 v63, v94, v95
    v_lshlrev_b32 v4, 6, v0
    s_mov_b32 s71, 65536
    s_mov_b32 s99, 0
L_kl:
    buffer_load_dword v3, v4, s[8:11], s71 offen sc0 sc1
    s_add_u32 s99, s99, 1
    s_waitcnt vmcnt(0)
    v_cmp_eq_u32 vcc, 0, v3
    s_cbranch_vccz L_kd
    s_cmp_ge_u32 s99, 200000
    s_cbranch_scc1 L_kd
    s_mov_b64 exec, vcc
    s_sleep 2
    s_branch L_kl
L_kd:
    s_mov_b64 exec, -1
    v_max_u32_dpp v3, v3, v3 quad_perm:[1,0,3,2] row_mask:0xf bank_mask:0xf
    s_nop 1
    v_max_u32_dpp v3, v3, v3 quad_perm:[2,3,0,1] row_mask:0xf bank_mask:0xf
    s_nop 1
    v_max_u32_dpp v3, v3, v3 row_half_mirror row_mask:0xf bank_mask:0xf
    s_nop 1
    v_max_u32_dpp v3, v3, v3 row_mirror row_mask:0xf bank_mask:0xf
    v_mov_b32 v19, v3
    s_nop 1
    v_permlane16_swap_b32 v3, v19
    v_max_u32 v3, v3, v19
    v_mov_b32 v19, v3
    s_nop 1
    v_permlane32_swap_b32 v3, v19
    v_max_u32 v3, v3, v19
    ds_write_b32 v47, v3 offset:64
    s_waitcnt lgkmcnt(0)
    s_barrier
    ds_read_b128 v[52:55], v102 offset:64
    v_lshlrev_b32 v4, 2, v0
    s_waitcnt lgkmcnt(0)
    v_max_u32 v52, v52, v53
    v_max3_u32 v52, v52, v54, v55
    s_nop 0
    v_readfirstlane_b32 s71, v52
    s_and_b32 s72, s71, 2047
    s_lshr_b32 s100, s72, 7
    s_sub_u32 s101, 15, s100
    s_min_u32 s100, s100, s101
    s_lshl_b32 s100, s100, 16
    s_and_b32 s73, s72, 124
    s_lshl_b32 s73, s73, 9
    s_add_u32 s73, s73, s100
    s_add_u32 s73, s73, 524288
    buffer_load_dword v19, v4, s[8:11], s73 offen sc0 sc1
    s_lshl_b32 s100, s68, 10
    s_cmp_eq_u32 s68, s72
    s_cselect_b32 s100, 2147479552, s100
    buffer_store_dwordx2 v[56:57], v45, s[52:55], s100 offen
    buffer_store_dwordx2 v[58:59], v45, s[52:55], s100 offen offset:32
    s_lshl_b32 s100, s69, 10
    s_cmp_eq_u32 s69, s72
    s_cselect_b32 s100, 2147479552, s100
    buffer_store_dwordx2 v[60:61], v45, s[52:55], s100 offen
    buffer_store_dwordx2 v[62:63], v45, s[52:55], s100 offen offset:32
    s_cmp_ge_u32 s66, 224
    s_cbranch_scc1 L_nprod
    v_lshlrev_b32 v160, 16, v112
    v_and_b32 v161, 0xffff0000, v112
    v_lshlrev_b32 v162, 16, v113
    v_and_b32 v163, 0xffff0000, v113
    v_lshlrev_b32 v164, 16, v114
    v_and_b32 v165, 0xffff0000, v114
    v_lshlrev_b32 v166, 16, v115
    v_and_b32 v167, 0xffff0000, v115
    v_lshlrev_b32 v168, 16, v116
    v_and_b32 v169, 0xffff0000, v116
    v_lshlrev_b32 v170, 16, v117
    v_and_b32 v171, 0xffff0000, v117
    v_lshlrev_b32 v172, 16, v118
    v_and_b32 v173, 0xffff0000, v118
    v_lshlrev_b32 v174, 16, v119
    v_and_b32 v175, 0xffff0000, v119
    v_lshlrev_b32 v176, 16, v120
    v_and_b32 v177, 0xffff0000, v120
    v_lshlrev_b32 v178, 16, v121
    v_and_b32 v179, 0xffff0000, v121
    v_lshlrev_b32 v180, 16, v122
    v_and_b32 v181, 0xffff0000, v122
    v_lshlrev_b32 v182, 16, v123
    v_and_b32 v183, 0xffff0000, v123
    v_lshlrev_b32 v184, 16, v124
    v_and_b32 v185, 0xffff0000, v124
    v_lshlrev_b32 v186, 16, v125
    v_and_b32 v187, 0xffff0000, v125
    v_lshlrev_b32 v188, 16, v126
    v_and_b32 v189, 0xffff0000, v126
    v_lshlrev_b32 v190, 16, v127
    v_and_b32 v191, 0xffff0000, v127
    s_mov_b32 s99, 0
    s_waitcnt vmcnt(4)
L_hl:
    v_cmp_eq_u32 vcc, -1, v19
    s_add_u32 s99, s99, 1
    s_cbranch_vccz L_hok
    s_cmp_ge_u32 s99, 200000
    s_cbranch_scc1 L_hok
    buffer_load_dword v19, v4, s[8:11], s73 offen sc0 sc1
    s_waitcnt vmcnt(0)
    s_branch L_hl
L_hok:
    v_lshlrev_b32 v48, 16, v19
    v_and_b32 v50, 0xffff0000, v19
    v_pk_mul_f32 v[64:65], v[160:161], v[48:49] op_sel_hi:[1,0]
    v_pk_mul_f32 v[66:67], v[162:163], v[48:49] op_sel_hi:[1,0]
    v_pk_mul_f32 v[68:69], v[164:165], v[48:49] op_sel_hi:[1,0]
    v_pk_mul_f32 v[70:71], v[166:167], v[48:49] op_sel_hi:[1,0]
    v_pk_mul_f32 v[72:73], v[176:177], v[48:49] op_sel_hi:[1,0]
    v_pk_mul_f32 v[74:75], v[178:179], v[48:49] op_sel_hi:[1,0]
    v_pk_mul_f32 v[76:77], v[180:181], v[48:49] op_sel_hi:[1,0]
    v_pk_mul_f32 v[78:79], v[182:183], v[48:49] op_sel_hi:[1,0]
    v_pk_fma_f32 v[64:65], v[168:169], v[50:51], v[64:65] op_sel_hi:[1,0,1]
    v_pk_fma_f32 v[66:67], v[170:171], v[50:51], v[66:67] op_sel_hi:[1,0,1]
    v_pk_fma_f32 v[68:69], v[172:173], v[50:51], v[68:69] op_sel_hi:[1,0,1]
    v_pk_fma_f32 v[70:71], v[174:175], v[50:51], v[70:71] op_sel_hi:[1,0,1]
    v_pk_fma_f32 v[72:73], v[184:185], v[50:51], v[72:73] op_sel_hi:[1,0,1]
    v_pk_fma_f32 v[74:75], v[186:187], v[50:51], v[74:75] op_sel_hi:[1,0,1]
    v_pk_fma_f32 v[76:77], v[188:189], v[50:51], v[76:77] op_sel_hi:[1,0,1]
    v_pk_fma_f32 v[78:79], v[190:191], v[50:51], v[78:79] op_sel_hi:[1,0,1]
    v_permlane32_swap_b32 v64, v72
    v_permlane32_swap_b32 v65, v73
    v_permlane32_swap_b32 v66, v74
    v_permlane32_swap_b32 v67, v75
    v_permlane32_swap_b32 v68, v76
    v_permlane32_swap_b32 v69, v77
    v_permlane32_swap_b32 v70, v78
    v_permlane32_swap_b32 v71, v79
    v_add_f32 v64, v64, v72
    v_add_f32 v65, v65, v73
    v_add_f32 v66, v66, v74
    v_add_f32 v67, v67, v75
    v_add_f32 v68, v68, v76
    v_add_f32 v69, v69, v77
    v_add_f32 v70, v70, v78
    v_add_f32 v71, v71, v79
    v_permlane16_swap_b32 v64, v68
    v_permlane16_swap_b32 v65, v69
    v_permlane16_swap_b32 v66, v70
    v_permlane16_swap_b32 v67, v71
    v_add_f32 v64, v64, v68
    v_add_f32 v65, v65, v69
    v_add_f32 v66, v66, v70
    v_add_f32 v67, v67, v71
    v_add_f32_dpp v64, v64, v64 quad_perm:[1,0,3,2] row_mask:0xf bank_mask:0xf
    v_add_f32_dpp v65, v65, v65 quad_perm:[1,0,3,2] row_mask:0xf bank_mask:0xf
    v_add_f32_dpp v66, v66, v66 quad_perm:[1,0,3,2] row_mask:0xf bank_mask:0xf
    v_add_f32_dpp v67, v67, v67 quad_perm:[1,0,3,2] row_mask:0xf bank_mask:0xf
    v_add_f32_dpp v64, v64, v64 quad_perm:[2,3,0,1] row_mask:0xf bank_mask:0xf
    v_add_f32_dpp v65, v65, v65 quad_perm:[2,3,0,1] row_mask:0xf bank_mask:0xf
    v_add_f32_dpp v66, v66, v66 quad_perm:[2,3,0,1] row_mask:0xf bank_mask:0xf
    v_add_f32_dpp v67, v67, v67 quad_perm:[2,3,0,1] row_mask:0xf bank_mask:0xf
    v_add_f32_dpp v64, v64, v64 row_half_mirror row_mask:0xf bank_mask:0xf
    v_add_f32_dpp v65, v65, v65 row_half_mirror row_mask:0xf bank_mask:0xf
    v_add_f32_dpp v66, v66, v66 row_half_mirror row_mask:0xf bank_mask:0xf
    v_add_f32_dpp v67, v67, v67 row_half_mirror row_mask:0xf bank_mask:0xf
    v_add_f32_dpp v64, v64, v64 row_mirror row_mask:0xf bank_mask:0xf
    v_add_f32_dpp v65, v65, v65 row_mirror row_mask:0xf bank_mask:0xf
    v_add_f32_dpp v66, v66, v66 row_mirror row_mask:0xf bank_mask:0xf
    v_add_f32_dpp v67, v67, v67 row_mirror row_mask:0xf bank_mask:0xf
    v_and_b32 v50, 15, v2
    v_cmp_eq_u32 vcc, 0, v50
    v_mov_b32 v51, 1024
    s_nop 0
    v_cndmask_b32 v51, v51, v0, vcc
    ds_write_b128 v51, v[64:67] offset:256
    v_lshlrev_b32 v50, 2, v50
    s_waitcnt lgkmcnt(0)
    s_barrier
    s_cmp_lg_u32 s3, 0
    s_cbranch_scc1 L_nprod
    ds_read_b32 v64, v50 offset:256
    ds_read_b32 v65, v50 offset:320
    ds_read_b32 v66, v50 offset:384
    ds_read_b32 v67, v50 offset:448
    v_cmp_gt_u32 vcc, 8, v2
    v_mov_b32 v51, 2147479552
    s_nop 0
    v_cndmask_b32 v51, v51, v50, vcc
    s_lshl_b32 s100, s66, 6
    s_add_u32 s100, s100, 81920
    s_waitcnt lgkmcnt(2)
    v_add_f32 v64, v64, v65
    s_waitcnt lgkmcnt(0)
    v_add_f32 v66, v66, v67
    v_add_f32 v64, v64, v66
    v_cvt_pk_bf16_f32 v64, v64, v64
    v_and_b32 v64, 0xffff0000, v64
    s_nop 1
    v_mov_b32_dpp v65, v64 row_ror:8 row_mask:0xf bank_mask:0xf
    v_mul_f32 v66, 0xbfb8aa3b, v64
    v_exp_f32 v66, v66
    s_nop 0
    v_add_f32 v66, 1.0, v66
    v_rcp_f32 v66, v66
    s_nop 0
    v_mul_f32 v64, v64, v66
    v_cvt_pk_bf16_f32 v64, v64, v64
    v_and_b32 v64, 0xffff0000, v64
    v_mul_f32 v64, v64, v65
    v_cvt_pk_bf16_f32 v64, v64, v64
    v_and_b32 v64, 0xffff0000, v64
    buffer_store_dword v64, v51, s[8:11], s100 offen sc0 sc1
L_nprod:
    s_cmp_ge_u32 s67, 64
    s_cbranch_scc1 L_fin
    v_lshlrev_b32 v4, 6, v0
    v_cmp_gt_u32 vcc, 224, v0
    v_mov_b32 v51, 2147479552
    s_nop 0
    v_cndmask_b32 v4, v51, v4, vcc
    s_mov_b32 s100, 81920
    v_and_b32 v52, 7, v2
    s_lshl_b32 s101, s67, 3
    v_add_u32 v52, s101, v52
    v_lshrrev_b32 v53, 5, v52
    v_lshlrev_b32 v53, 6, v53
    v_and_b32 v54, 12, v52
    v_lshl_add_u32 v53, v54, 2, v53
    v_bfe_u32 v54, v52, 4, 1
    v_lshl_add_u32 v53, v54, 3, v53
    v_and_b32 v54, 2, v52
    v_lshl_add_u32 v53, v54, 1, v53
    v_lshlrev_b32 v54, 2, v52
    s_mov_b32 s101, 10240
    buffer_load_dword v55, v54, s[8:11], s101 offen
    buffer_load_dword v88, v53, s[8:11], s73 offen sc0 sc1
    buffer_load_dword v89, v53, s[8:11], s73 offen offset:1024 sc0 sc1
    v_lshlrev_b32 v192, 16, v128
    v_and_b32 v193, 0xffff0000, v128
    v_lshlrev_b32 v194, 16, v129
    v_and_b32 v195, 0xffff0000, v129
    v_lshlrev_b32 v196, 16, v130
    v_and_b32 v197, 0xffff0000, v130
    v_lshlrev_b32 v198, 16, v131
    v_and_b32 v199, 0xffff0000, v131
    v_lshlrev_b32 v200, 16, v132
    v_and_b32 v201, 0xffff0000, v132
    v_lshlrev_b32 v202, 16, v133
    v_and_b32 v203, 0xffff0000, v133
    v_lshlrev_b32 v204, 16, v134
    v_and_b32 v205, 0xffff0000, v134
    v_lshlrev_b32 v206, 16, v135
    v_and_b32 v207, 0xffff0000, v135
    v_lshlrev_b32 v208, 16, v136
    v_and_b32 v209, 0xffff0000, v136
    v_lshlrev_b32 v210, 16, v137
    v_and_b32 v211, 0xffff0000, v137
    v_lshlrev_b32 v212, 16, v138
    v_and_b32 v213, 0xffff0000, v138
    v_lshlrev_b32 v214, 16, v139
    v_and_b32 v215, 0xffff0000, v139
    v_lshlrev_b32 v216, 16, v140
    v_and_b32 v217, 0xffff0000, v140
    v_lshlrev_b32 v218, 16, v141
    v_and_b32 v219, 0xffff0000, v141
    v_lshlrev_b32 v220, 16, v142
    v_and_b32 v221, 0xffff0000, v142
    v_lshlrev_b32 v222, 16, v143
    v_and_b32 v223, 0xffff0000, v143
    v_lshlrev_b32 v224, 16, v144
    v_and_b32 v225, 0xffff0000, v144
    v_lshlrev_b32 v226, 16, v145
    v_and_b32 v227, 0xffff0000, v145
    v_lshlrev_b32 v228, 16, v146
    v_and_b32 v229, 0xffff0000, v146
    v_lshlrev_b32 v230, 16, v147
    v_and_b32 v231, 0xffff0000, v147
    v_lshlrev_b32 v232, 16, v148
    v_and_b32 v233, 0xffff0000, v148
    v_lshlrev_b32 v234, 16, v149
    v_and_b32 v235, 0xffff0000, v149
    v_lshlrev_b32 v236, 16, v150
    v_and_b32 v237, 0xffff0000, v150
    v_lshlrev_b32 v238, 16, v151
    v_and_b32 v239, 0xffff0000, v151
    v_lshlrev_b32 v240, 16, v152
    v_and_b32 v241, 0xffff0000, v152
    v_lshlrev_b32 v242, 16, v153
    v_and_b32 v243, 0xffff0000, v153
    v_lshlrev_b32 v244, 16, v154
    v_and_b32 v245, 0xffff0000, v154
    v_lshlrev_b32 v246, 16, v155
    v_and_b32 v247, 0xffff0000, v155
    v_lshlrev_b32 v248, 16, v156
    v_and_b32 v249, 0xffff0000, v156
    v_lshlrev_b32 v250, 16, v157
    v_and_b32 v251, 0xffff0000, v157
    v_lshlrev_b32 v252, 16, v158
    v_and_b32 v253, 0xffff0000, v158
    v_lshlrev_b32 v254, 16, v159
    v_and_b32 v255, 0xffff0000, v159
    s_and_b32 s101, s71, 0xfffff800
    s_or_b32 s101, s101, 0x400
    v_mov_b32 v90, s101
    v_not_b32 v91, v90
    v_ashrrev_i32 v91, 31, v91
    v_or_b32 v91, 0x80000000, v91
    v_xor_b32 v90, v90, v91
    v_cvt_pk_bf16_f32 v90, v90, v90
    v_and_b32 v90, 0xffff0000, v90
    v_mul_f32 v90, 0xbfb8aa3b, v90
    v_exp_f32 v90, v90
    s_nop 0
    v_add_f32 v90, 1.0, v90
    v_rcp_f32 v90, v90
    s_nop 0
    v_cvt_pk_bf16_f32 v90, v90, v90
    v_and_b32 v90, 0xffff0000, v90
    s_mov_b32 s99, 0
L_CND_l_27:
    s_waitcnt vmcnt(0)
    v_max_u32 v3, v88, v89
    v_cmp_eq_u32 vcc, -1, v3
    s_add_u32 s99, s99, 1
    s_cbranch_vccz L_CND_ok_28
    s_cmp_ge_u32 s99, 200000
    s_cbranch_scc1 L_CND_ok_28
    s_mov_b64 exec, vcc
    s_sleep 1
    buffer_load_dword v88, v53, s[8:11], s73 offen sc0 sc1
    buffer_load_dword v89, v53, s[8:11], s73 offen offset:1024 sc0 sc1
    s_branch L_CND_l_27
L_CND_ok_28:
    s_mov_b64 exec, -1
    v_and_b32 v51, 1, v52
    v_cmp_eq_u32 vcc, 0, v51
    v_lshlrev_b32 v91, 16, v88
    v_and_b32 v88, 0xffff0000, v88
    v_cndmask_b32 v88, v88, v91, vcc
    v_lshlrev_b32 v91, 16, v89
    v_and_b32 v89, 0xffff0000, v89
    v_cndmask_b32 v89, v89, v91, vcc
    v_and_b32 v50, 15, v2
    v_cmp_eq_u32 vcc, 0, v50
    v_lshrrev_b32 v51, 1, v0
    v_mov_b32 v50, 1024
    v_cndmask_b32 v51, v50, v51, vcc
    v_and_b32 v50, 7, v2
    v_lshlrev_b32 v50, 2, v50
    v_cmp_gt_u32 vcc, 8, v2
    v_lshlrev_b32 v52, 1, v52
    v_mov_b32 v53, 2147479552
    v_cndmask_b32 v52, v53, v52, vcc
    s_cmp_lt_u32 s66, 224
    s_cbranch_scc1 L_asl
    s_sleep 16
L_asl:
    s_sleep 7
    buffer_load_dwordx4 v[80:83], v4, s[8:11], s100 offen sc0 sc1
    buffer_load_dwordx4 v[84:87], v4, s[8:11], s100 offen offset:16 sc0 sc1
    s_mov_b32 s99, 0
L_ACT_l_29:
    s_waitcnt vmcnt(0)
    v_max_u32 v3, v80, v81
    v_max3_u32 v3, v3, v82, v83
    v_max3_u32 v3, v3, v84, v85
    v_max3_u32 v3, v3, v86, v87
    v_cmp_eq_u32 vcc, -1, v3
    s_add_u32 s99, s99, 1
    s_cbranch_vccz L_ACT_ok_30
    s_cmp_ge_u32 s99, 200000
    s_cbranch_scc1 L_ACT_ok_30
    s_mov_b64 exec, vcc
    s_sleep 2
    buffer_load_dwordx4 v[80:83], v4, s[8:11], s100 offen sc0 sc1
    buffer_load_dwordx4 v[84:87], v4, s[8:11], s100 offen offset:16 sc0 sc1
    s_branch L_ACT_l_29
L_ACT_ok_30:
    s_mov_b64 exec, -1
    v_pk_mul_f32 v[64:65], v[192:193], v[80:81] op_sel_hi:[1,0]
    v_pk_mul_f32 v[66:67], v[194:195], v[80:81] op_sel_hi:[1,0]
    v_pk_mul_f32 v[68:69], v[196:197], v[80:81] op_sel_hi:[1,0]
    v_pk_mul_f32 v[70:71], v[198:199], v[80:81] op_sel_hi:[1,0]
    v_pk_fma_f32 v[64:65], v[200:201], v[80:81], v[64:65] op_sel:[0,1,0] op_sel_hi:[1,1,1]
    v_pk_fma_f32 v[66:67], v[202:203], v[80:81], v[66:67] op_sel:[0,1,0] op_sel_hi:[1,1,1]
    v_pk_fma_f32 v[68:69], v[204:205], v[80:81], v[68:69] op_sel:[0,1,0] op_sel_hi:[1,1,1]
    v_pk_fma_f32 v[70:71], v[206:207], v[80:81], v[70:71] op_sel:[0,1,0] op_sel_hi:[1,1,1]
    v_pk_fma_f32 v[64:65], v[208:209], v[82:83], v[64:65] op_sel:[0,0,0] op_sel_hi:[1,0,1]
    v_pk_fma_f32 v[66:67], v[210:211], v[82:83], v[66:67] op_sel:[0,0,0] op_sel_hi:[1,0,1]
    v_pk_fma_f32 v[68:69], v[212:213], v[82:83], v[68:69] op_sel:[0,0,0] op_sel_hi:[1,0,1]
    v_pk_fma_f32 v[70:71], v[214:215], v[82:83], v[70:71] op_sel:[0,0,0] op_sel_hi:[1,0,1]
    v_pk_fma_f32 v[64:65], v[216:217], v[82:83], v[64:65] op_sel:[0,1,0] op_sel_hi:[1,1,1]
    v_pk_fma_f32 v[66:67], v[218:219], v[82:83], v[66:67] op_sel:[0,1,0] op_sel_hi:[1,1,1]
    v_pk_fma_f32 v[68:69], v[220:221], v[82:83], v[68:69] op_sel:[0,1,0] op_sel_hi:[1,1,1]
    v_pk_fma_f32 v[70:71], v[222:223], v[82:83], v[70:71] op_sel:[0,1,0] op_sel_hi:[1,1,1]
    v_pk_fma_f32 v[64:65], v[224:225], v[84:85], v[64:65] op_sel:[0,0,0] op_sel_hi:[1,0,1]
    v_pk_fma_f32 v[66:67], v[226:227], v[84:85], v[66:67] op_sel:[0,0,0] op_sel_hi:[1,0,1]
    v_pk_fma_f32 v[68:69], v[228:229], v[84:85], v[68:69] op_sel:[0,0,0] op_sel_hi:[1,0,1]
    v_pk_fma_f32 v[70:71], v[230:231], v[84:85], v[70:71] op_sel:[0,0,0] op_sel_hi:[1,0,1]
    v_pk_fma_f32 v[64:65], v[232:233], v[84:85], v[64:65] op_sel:[0,1,0] op_sel_hi:[1,1,1]
    v_pk_fma_f32 v[66:67], v[234:235], v[84:85], v[66:67] op_sel:[0,1,0] op_sel_hi:[1,1,1]
    v_pk_fma_f32 v[68:69], v[236:237], v[84:85], v[68:69] op_sel:[0,1,0] op_sel_hi:[1,1,1]
    v_pk_fma_f32 v[70:71], v[238:239], v[84:85], v[70:71] op_sel:[0,1,0] op_sel_hi:[1,1,1]
    v_pk_fma_f32 v[64:65], v[240:241], v[86:87], v[64:65] op_sel:[0,0,0] op_sel_hi:[1,0,1]
    v_pk_fma_f32 v[66:67], v[242:243], v[86:87], v[66:67] op_sel:[0,0,0] op_sel_hi:[1,0,1]
    v_pk_fma_f32 v[68:69], v[244:245], v[86:87], v[68:69] op_sel:[0,0,0] op_sel_hi:[1,0,1]
    v_pk_fma_f32 v[70:71], v[246:247], v[86:87], v[70:71] op_sel:[0,0,0] op_sel_hi:[1,0,1]
    v_pk_fma_f32 v[64:65], v[248:249], v[86:87], v[64:65] op_sel:[0,1,0] op_sel_hi:[1,1,1]
    v_pk_fma_f32 v[66:67], v[250:251], v[86:87], v[66:67] op_sel:[0,1,0] op_sel_hi:[1,1,1]
    v_pk_fma_f32 v[68:69], v[252:253], v[86:87], v[68:69] op_sel:[0,1,0] op_sel_hi:[1,1,1]
    v_pk_fma_f32 v[70:71], v[254:255], v[86:87], v[70:71] op_sel:[0,1,0] op_sel_hi:[1,1,1]
    s_nop 0
    v_permlane32_swap_b32 v64, v68
    v_permlane32_swap_b32 v65, v69
    v_permlane32_swap_b32 v66, v70
    v_permlane32_swap_b32 v67, v71
    v_add_f32 v64, v64, v68
    v_add_f32 v65, v65, v69
    v_add_f32 v66, v66, v70
    v_add_f32 v67, v67, v71
    s_nop 0
    v_permlane16_swap_b32 v64, v66
    v_permlane16_swap_b32 v65, v67
    v_add_f32 v64, v64, v66
    v_add_f32 v65, v65, v67
    s_nop 0
    v_add_f32_dpp v64, v64, v64 quad_perm:[1,0,3,2] row_mask:0xf bank_mask:0xf
    v_add_f32_dpp v65, v65, v65 quad_perm:[1,0,3,2] row_mask:0xf bank_mask:0xf
    s_nop 0
    v_add_f32_dpp v64, v64, v64 quad_perm:[2,3,0,1] row_mask:0xf bank_mask:0xf
    v_add_f32_dpp v65, v65, v65 quad_perm:[2,3,0,1] row_mask:0xf bank_mask:0xf
    s_nop 0
    v_add_f32_dpp v64, v64, v64 row_half_mirror row_mask:0xf bank_mask:0xf
    v_add_f32_dpp v65, v65, v65 row_half_mirror row_mask:0xf bank_mask:0xf
    s_nop 0
    v_add_f32_dpp v64, v64, v64 row_mirror row_mask:0xf bank_mask:0xf
    v_add_f32_dpp v65, v65, v65 row_mirror row_mask:0xf bank_mask:0xf
    ds_write_b64 v51, v[64:65] offset:2048
    s_waitcnt lgkmcnt(0)
    s_barrier
    s_cmp_lg_u32 s3, 0
    s_cbranch_scc1 L_fin
    ds_read_b32 v64, v50 offset:2048
    ds_read_b32 v65, v50 offset:2080
    ds_read_b32 v66, v50 offset:2112
    ds_read_b32 v67, v50 offset:2144
    s_lshl_b32 s100, s72, 10
    s_waitcnt lgkmcnt(2)
    v_add_f32 v64, v64, v65
    s_waitcnt lgkmcnt(0)
    v_add_f32 v66, v66, v67
    v_add_f32 v64, v64, v66
    v_cvt_pk_bf16_f32 v64, v64, v64
    v_and_b32 v64, 0xffff0000, v64
    v_mul_f32 v64, v64, v90
    v_cvt_pk_bf16_f32 v64, v64, v64
    v_and_b32 v64, 0xffff0000, v64
    v_add_f32 v64, v64, v88
    v_cvt_pk_bf16_f32 v64, v64, v64
    v_and_b32 v64, 0xffff0000, v64
    v_mul_f32 v64, v64, v55
    v_cvt_pk_bf16_f32 v64, v64, v64
    v_and_b32 v64, 0xffff0000, v64
    v_add_f32 v64, v64, v89
    v_cvt_pk_bf16_f32 v64, v64, v64
    buffer_store_short v64, v52, s[52:55], s100 offen
L_fin:
L_end:
    s_endpgm
L_E_slow_1:
    s_mov_b32 s99, 0
L_E_slow_1_l:
    s_sleep 4
    buffer_load_dword v3, v4, s[36:39], s67 offen sc0 sc1
    s_add_u32 s99, s99, 1
    s_waitcnt vmcnt(0)
    v_cmp_le_u32 vcc, s68, v3
    s_cmp_eq_u64 vcc, -1
    s_cbranch_scc1 L_E_ok_2
    s_cmp_lt_u32 s99, 200000
    s_cbranch_scc1 L_E_slow_1_l
    s_branch L_E_ok_2
L_H_slow_3:
    s_mov_b32 s99, 0
L_H_slow_3_l:
    s_sleep 4
    buffer_load_dword v3, v16, s[8:11], s78 offen sc0 sc1
    s_add_u32 s99, s99, 1
    s_waitcnt vmcnt(0)
    v_cmp_ne_u32 vcc, 0, v3
    s_cmp_eq_u64 vcc, -1
    s_cbranch_scc1 L_H_ok_4
    s_cmp_lt_u32 s99, 200000
    s_cbranch_scc1 L_H_slow_3_l
    s_branch L_H_ok_4
L_E2_slow_5:
    s_mov_b32 s99, 0
L_E2_slow_5_l:
    s_sleep 4
    buffer_load_dword v118, v119, s[8:11], s69 offen sc0 sc1
    s_add_u32 s99, s99, 1
    s_waitcnt vmcnt(0)
    v_cmp_ne_u32 vcc, 0, v118
    s_cmp_eq_u64 vcc, -1
    s_cbranch_scc1 L_E2_ok_6
    s_cmp_lt_u32 s99, 200000
    s_cbranch_scc1 L_E2_slow_5_l
    s_branch L_E2_ok_6
L_KV_slow_7:
    s_mov_b32 s99, 0
L_KV_slow_7_l:
    s_sleep 4
    buffer_load_dword v3, v17, s[8:11], s74 offen sc0 sc1
    s_add_u32 s99, s99, 1
    s_waitcnt vmcnt(0)
    v_cmp_ne_u32 vcc, 0, v3
    s_cmp_eq_u64 vcc, -1
    s_cbranch_scc1 L_KV_ok_8
    s_cmp_lt_u32 s99, 200000
    s_cbranch_scc1 L_KV_slow_7_l
    s_branch L_KV_ok_8
L_t1_start:
    v_mfma_f32_16x16x32_bf16 v[96:99], a[128:131], a[64:67], v[96:99]
    s_add_u32 s19, s82, 32768
    s_sub_u32 s82, s12, s13
    s_sub_u32 s82, s82, 1
    v_mfma_f32_16x16x32_bf16 v[96:99], a[132:135], a[68:71], v[96:99]
    s_cmp_gt_u32 s12, s13
    s_cselect_b32 s82, s82, s12
    s_lshl_b32 s82, s82, 16
    s_add_u32 s82, s82, s81
    v_mfma_f32_16x16x32_bf16 v[96:99], a[136:139], a[72:75], v[96:99]
    s_cmp_ge_u32 s12, 17
    s_cselect_b32 s82, 2147471360, s82
    s_add_u32 s12, s12, 1
    s_sub_u32 s14, s60, 1
    v_mfma_f32_16x16x32_bf16 v[96:99], a[140:143], a[76:79], v[96:99]
    v_mfma_f32_16x16x32_bf16 v[100:103], a[144:147], a[64:67], v[100:103]
    v_mfma_f32_16x16x32_bf16 v[100:103], a[148:151], a[68:71], v[100:103]
    v_mfma_f32_16x16x32_bf16 v[100:103], a[152:155], a[72:75], v[100:103]
    v_mfma_f32_16x16x32_bf16 v[100:103], a[156:159], a[76:79], v[100:103]
    v_mfma_f32_16x16x32_bf16 v[104:107], a[128:131], a[80:83], v[104:107]
    s_nop 2
    v_exp_f32 v96, v96
    v_mfma_f32_16x16x32_bf16 v[104:107], a[132:135], a[84:87], v[104:107]
    v_exp_f32 v97, v97
    v_mfma_f32_16x16x32_bf16 v[104:107], a[136:139], a[88:91], v[104:107]
    v_exp_f32 v98, v98
    v_mfma_f32_16x16x32_bf16 v[104:107], a[140:143], a[92:95], v[104:107]
    v_exp_f32 v99, v99
    v_mfma_f32_16x16x32_bf16 v[108:111], a[144:147], a[80:83], v[108:111]
    v_exp_f32 v100, v100
    v_mfma_f32_16x16x32_bf16 v[108:111], a[148:151], a[84:87], v[108:111]
    v_exp_f32 v101, v101
    v_mfma_f32_16x16x32_bf16 v[108:111], a[152:155], a[88:91], v[108:111]
    v_exp_f32 v102, v102
    v_mfma_f32_16x16x32_bf16 v[108:111], a[156:159], a[92:95], v[108:111]
    v_exp_f32 v103, v103
    v_mfma_f32_16x16x32_bf16 v[112:115], a[128:131], a[96:99], v[72:75]
    v_exp_f32 v104, v104
    v_mfma_f32_16x16x32_bf16 v[112:115], a[132:135], a[100:103], v[112:115]
    v_exp_f32 v105, v105
    v_mfma_f32_16x16x32_bf16 v[112:115], a[136:139], a[104:107], v[112:115]
    v_exp_f32 v106, v106
    v_mfma_f32_16x16x32_bf16 v[112:115], a[140:143], a[108:111], v[112:115]
    v_exp_f32 v107, v107
    v_mfma_f32_16x16x32_bf16 v[120:123], a[128:131], a[112:115], v[76:79]
    v_exp_f32 v108, v108
    v_mfma_f32_16x16x32_bf16 v[120:123], a[132:135], a[116:119], v[120:123]
    v_exp_f32 v109, v109
    v_mfma_f32_16x16x32_bf16 v[120:123], a[136:139], a[120:123], v[120:123]
    v_exp_f32 v110, v110
    v_mfma_f32_16x16x32_bf16 v[120:123], a[140:143], a[124:127], v[120:123]
    v_exp_f32 v111, v111
    v_mfma_f32_16x16x32_bf16 v[116:119], a[144:147], a[96:99], v[72:75]
    ds_read_b128 a[128:131], v18 offset:16384
    v_cvt_pk_bf16_f32 v48, v96, v97
    v_mfma_f32_16x16x32_bf16 v[116:119], a[148:151], a[100:103], v[116:119]
    ds_read_b128 a[132:135], v18 offset:17408
    v_cvt_pk_bf16_f32 v49, v98, v99
    v_mfma_f32_16x16x32_bf16 v[116:119], a[152:155], a[104:107], v[116:119]
    ds_read_b128 a[136:139], v18 offset:18432
    v_cvt_pk_bf16_f32 v50, v100, v101
    v_mfma_f32_16x16x32_bf16 v[116:119], a[156:159], a[108:111], v[116:119]
    ds_read_b128 a[140:143], v18 offset:19456
    v_cvt_pk_bf16_f32 v51, v102, v103
    v_mfma_f32_16x16x32_bf16 v[124:127], a[144:147], a[112:115], v[76:79]
    ds_read_b128 a[144:147], v18 offset:20480
    v_cvt_pk_bf16_f32 v52, v104, v105
    v_mfma_f32_16x16x32_bf16 v[124:127], a[148:151], a[116:119], v[124:127]
    ds_read_b128 a[148:151], v18 offset:21504
    v_cvt_pk_bf16_f32 v53, v106, v107
    v_mfma_f32_16x16x32_bf16 v[124:127], a[152:155], a[120:123], v[124:127]
    ds_read_b128 a[152:155], v18 offset:22528
    v_cvt_pk_bf16_f32 v54, v108, v109
    v_mfma_f32_16x16x32_bf16 v[124:127], a[156:159], a[124:127], v[124:127]
    ds_read_b128 a[156:159], v18 offset:23552
    v_cvt_pk_bf16_f32 v55, v110, v111
    v_xor_b32 v18, 196608, v18
    s_branch L_t1_p1
L_t1_zero:
    v_mfma_f32_16x16x32_bf16 v[96:99], a[128:131], a[96:99], v[80:83]
    s_xor_b32 s100, s16, 8192
    ds_read_b128 a[176:179], v20 offset:4096
    v_lshrrev_b32 v13, 1, v1
    v_mfma_f32_16x16x32_bf16 v[96:99], a[132:135], a[100:103], v[96:99]
    s_add_u32 m0, s15, 0
    ds_read_b128 a[180:183], v20 offset:5120
    v_add_u32 v12, s100, v13
    v_mfma_f32_16x16x32_bf16 v[96:99], a[136:139], a[104:107], v[96:99]
    buffer_load_dwordx4 v1, s[8:11], s82 offen offset:0 lds
    v_exp_f32 v112, v112
    v_mfma_f32_16x16x32_bf16 v[96:99], a[140:143], a[108:111], v[96:99]
    v_exp_f32 v113, v113
    v_mfma_f32_16x16x32_bf16 v[100:103], a[144:147], a[96:99], v[84:87]
    ds_read_b128 a[184:187], v20 offset:6144
    v_cvt_pk_bf16_f32 v56, v112, v113
    v_mfma_f32_16x16x32_bf16 v[100:103], a[148:151], a[100:103], v[100:103]
    v_exp_f32 v114, v114
    v_mfma_f32_16x16x32_bf16 v[100:103], a[152:155], a[104:107], v[100:103]
    buffer_load_dwordx4 v1, s[8:11], s82 offen offset:1024 lds
    v_exp_f32 v115, v115
    v_mfma_f32_16x16x32_bf16 v[100:103], a[156:159], a[108:111], v[100:103]
    ds_read_b128 a[188:191], v20 offset:7168
    v_cvt_pk_bf16_f32 v57, v114, v115
    v_mfma_f32_16x16x32_bf16 v[104:107], a[128:131], a[112:115], v[88:91]
    v_exp_f32 v116, v116
    v_mfma_f32_16x16x32_bf16 v[104:107], a[132:135], a[116:119], v[104:107]
    v_exp_f32 v117, v117
    v_mfma_f32_16x16x32_bf16 v[104:107], a[136:139], a[120:123], v[104:107]
    ds_read_b128 a[160:163], v19 offset:0
    v_cvt_pk_bf16_f32 v58, v116, v117
    v_mfma_f32_16x16x32_bf16 v[104:107], a[140:143], a[124:127], v[104:107]
    buffer_load_dwordx4 v1, s[8:11], s82 offen offset:2048 lds
    v_exp_f32 v118, v118
    v_mfma_f32_16x16x32_bf16 v[108:111], a[144:147], a[112:115], v[92:95]
    v_exp_f32 v119, v119
    v_mfma_f32_16x16x32_bf16 v[108:111], a[148:151], a[116:119], v[108:111]
    ds_read_b128 a[164:167], v19 offset:1024
    v_cvt_pk_bf16_f32 v59, v118, v119
    v_mfma_f32_16x16x32_bf16 v[108:111], a[152:155], a[120:123], v[108:111]
    v_exp_f32 v120, v120
    v_mfma_f32_16x16x32_bf16 v[108:111], a[156:159], a[124:127], v[108:111]
    buffer_load_dwordx4 v1, s[8:11], s82 offen offset:3072 lds
    v_exp_f32 v121, v121
    v_mfma_f32_16x16x32_bf16 v[32:35], v[28:31], v[48:51], 0
    s_add_u32 m0, s15, 4096
    ds_read_b128 a[168:171], v19 offset:2048
    v_cvt_pk_bf16_f32 v60, v120, v121
    v_mfma_f32_16x16x32_bf16 v[36:39], v[28:31], v[52:55], 0
    s_waitcnt lgkmcnt(6)
    v_exp_f32 v122, v122
    v_mfma_f32_16x16x32_bf16 v[144:147], a[176:179], v[48:51], 0
    v_exp_f32 v123, v123
    v_mfma_f32_16x16x32_bf16 v[176:179], a[176:179], v[52:55], 0
    s_waitcnt lgkmcnt(5)
    ds_read_b128 a[172:175], v19 offset:3072
    v_cvt_pk_bf16_f32 v61, v122, v123
    v_mfma_f32_16x16x32_bf16 v[148:151], a[180:183], v[48:51], 0
    buffer_load_dwordx4 v15, s[8:11], s82 offen offset:0 lds
    v_exp_f32 v124, v124
    v_mfma_f32_16x16x32_bf16 v[180:183], a[180:183], v[52:55], 0
    s_waitcnt lgkmcnt(5)
    v_exp_f32 v125, v125
    v_mfma_f32_16x16x32_bf16 v[152:155], a[184:187], v[48:51], 0
    s_waitcnt lgkmcnt(4)
    v_exp_f32 v126, v126
    v_mfma_f32_16x16x32_bf16 v[184:187], a[184:187], v[52:55], 0
    buffer_load_dwordx4 v15, s[8:11], s82 offen offset:1024 lds
    v_exp_f32 v127, v127
    v_mfma_f32_16x16x32_bf16 v[156:159], a[188:191], v[48:51], 0
    ds_write_b128 v16, v[144:147] offset:32768
    v_cvt_pk_bf16_f32 v62, v124, v125
    v_mfma_f32_16x16x32_bf16 v[188:191], a[188:191], v[52:55], 0
    s_waitcnt lgkmcnt(4)
    v_exp_f32 v96, v96
    v_mfma_f32_16x16x32_bf16 v[128:131], a[160:163], v[48:51], 0
    v_exp_f32 v97, v97
    v_mfma_f32_16x16x32_bf16 v[160:163], a[160:163], v[52:55], 0
    s_waitcnt lgkmcnt(3)
    ds_write_b128 v16, v[176:179] offset:33792
    v_cvt_pk_bf16_f32 v63, v126, v127
    v_mfma_f32_16x16x32_bf16 v[132:135], a[164:167], v[48:51], 0
    s_waitcnt lgkmcnt(3)
    v_exp_f32 v98, v98
    v_mfma_f32_16x16x32_bf16 v[164:167], a[164:167], v[52:55], 0
    buffer_load_dwordx4 v15, s[8:11], s82 offen offset:2048 lds
    v_exp_f32 v99, v99
    v_mfma_f32_16x16x32_bf16 v[136:139], a[168:171], v[48:51], 0
    ds_write_b128 v16, v[148:151] offset:34816
    v_mfma_f32_16x16x32_bf16 v[168:171], a[168:171], v[52:55], 0
    s_waitcnt lgkmcnt(3)
    v_exp_f32 v100, v100
    v_mfma_f32_16x16x32_bf16 v[140:143], a[172:175], v[48:51], 0
    v_exp_f32 v101, v101
    v_mfma_f32_16x16x32_bf16 v[172:175], a[172:175], v[52:55], 0
    ds_write_b128 v16, v[180:183] offset:35840
    v_mov_b32 v33, v36
    v_mfma_f32_16x16x32_bf16 v[40:43], v[28:31], v[56:59], 0
    buffer_load_dwordx4 v15, s[8:11], s82 offen offset:3072 lds
    v_exp_f32 v102, v102
    v_mfma_f32_16x16x32_bf16 v[44:47], v[28:31], v[60:63], 0
    s_xor_b32 s15, s15, 196608
    v_exp_f32 v103, v103
    v_mfma_f32_16x16x32_bf16 v[208:211], a[176:179], v[56:59], 0
    ds_write_b128 v16, v[152:155] offset:36864
    v_cvt_pk_bf16_f32 v48, v96, v97
    v_mfma_f32_16x16x32_bf16 v[240:243], a[176:179], v[60:63], 0
    ds_read_b128 a[176:179], v20 offset:20480
    v_exp_f32 v104, v104
    v_mfma_f32_16x16x32_bf16 v[212:215], a[180:183], v[56:59], 0
    v_exp_f32 v105, v105
    v_mfma_f32_16x16x32_bf16 v[244:247], a[180:183], v[60:63], 0
    ds_read_b128 a[180:183], v20 offset:21504
    v_exp_f32 v106, v106
    v_mfma_f32_16x16x32_bf16 v[216:219], a[184:187], v[56:59], 0
    ds_write_b128 v16, v[184:187] offset:37888
    v_cvt_pk_bf16_f32 v49, v98, v99
    v_mfma_f32_16x16x32_bf16 v[248:251], a[184:187], v[60:63], 0
    ds_read_b128 a[184:187], v20 offset:22528
    v_exp_f32 v107, v107
    v_mfma_f32_16x16x32_bf16 v[220:223], a[188:191], v[56:59], 0
    v_exp_f32 v108, v108
    v_mfma_f32_16x16x32_bf16 v[252:255], a[188:191], v[60:63], 0
    ds_read_b128 a[188:191], v20 offset:23552
    v_exp_f32 v109, v109
    v_mfma_f32_16x16x32_bf16 v[192:195], a[160:163], v[56:59], 0
    ds_write_b128 v16, v[156:159] offset:38912
    v_cvt_pk_bf16_f32 v50, v100, v101
    v_mfma_f32_16x16x32_bf16 v[224:227], a[160:163], v[60:63], 0
    ds_read_b128 a[160:163], v19 offset:16384
    v_exp_f32 v110, v110
    v_mfma_f32_16x16x32_bf16 v[196:199], a[164:167], v[56:59], 0
    v_exp_f32 v111, v111
    v_mfma_f32_16x16x32_bf16 v[228:231], a[164:167], v[60:63], 0
    ds_read_b128 a[164:167], v19 offset:17408
    v_cvt_pk_bf16_f32 v51, v102, v103
    v_mfma_f32_16x16x32_bf16 v[200:203], a[168:171], v[56:59], 0
    ds_write_b128 v16, v[188:191] offset:39936
    v_cvt_pk_bf16_f32 v52, v104, v105
    v_mfma_f32_16x16x32_bf16 v[232:235], a[168:171], v[60:63], 0
    ds_read_b128 a[168:171], v19 offset:18432
    v_cvt_pk_bf16_f32 v53, v106, v107
    v_mfma_f32_16x16x32_bf16 v[204:207], a[172:175], v[56:59], 0
    v_cvt_pk_bf16_f32 v54, v108, v109
    v_cvt_pk_bf16_f32 v55, v110, v111
    v_mfma_f32_16x16x32_bf16 v[236:239], a[172:175], v[60:63], 0
    ds_read_b128 a[172:175], v19 offset:19456
    ds_write_b64 v12, v[32:33]
    s_xor_b32 s101, s16, 98304
    v_xor_b32 v12, 8192, v12
    v_add_u32 v9, s101, v1
    v_xor_b32 v8, 8192, v16
    v_xor_b32 v10, 8192, v9
    s_branch L_t1_join
L_t1_redo:
    s_cmp_eq_u32 s25, 0
    s_cbranch_scc1 L_t1_max
    s_mov_b32 s25, 0
    v_mov_b32 v64, 0
    v_mov_b32 v65, 0
    v_mov_b32 v66, 0
    v_mov_b32 v67, 0
    v_mov_b32 v68, 0
    v_mov_b32 v69, 0
    v_mov_b32 v70, 0
    v_mov_b32 v71, 0
    v_mov_b32 v72, 0
    v_mov_b32 v73, 0
    v_mov_b32 v74, 0
    v_mov_b32 v75, 0
    v_mov_b32 v76, 0
    v_mov_b32 v77, 0
    v_mov_b32 v78, 0
    v_mov_b32 v79, 0
    s_nop 1
    s_branch L_t1_safe
L_t1_max:
    s_waitcnt vmcnt(0) lgkmcnt(0)
    s_barrier
    s_mov_b32 s25, 1
    s_and_b32 s100, s3, 1
    s_lshl_b32 s100, s100, 13
    s_sub_u32 s101, s81, s62
    s_add_u32 s101, s101, s100
    s_mov_b32 s14, s60
    v_mov_b32 v48, 0xff800000
    v_mov_b32 v49, 0xff800000
    v_mov_b32 v50, 0xff800000
    v_mov_b32 v51, 0xff800000
L_t1_maxl:
    s_cmp_eq_u32 s14, 0
    s_cbranch_scc1 L_t1_maxd
    s_add_u32 s100, s101, 0
    buffer_load_dwordx4 a[128:131], v1, s[8:11], s100 offen offset:0
    buffer_load_dwordx4 a[132:135], v1, s[8:11], s100 offen offset:1024
    buffer_load_dwordx4 a[136:139], v1, s[8:11], s100 offen offset:2048
    buffer_load_dwordx4 a[140:143], v1, s[8:11], s100 offen offset:3072
    buffer_load_dwordx4 a[144:147], v15, s[8:11], s100 offen offset:0
    buffer_load_dwordx4 a[148:151], v15, s[8:11], s100 offen offset:1024
    buffer_load_dwordx4 a[152:155], v15, s[8:11], s100 offen offset:2048
    buffer_load_dwordx4 a[156:159], v15, s[8:11], s100 offen offset:3072
    s_waitcnt vmcnt(7)
    v_mfma_f32_16x16x32_bf16 v[96:99], a[128:131], a[64:67], v[64:67]
    s_waitcnt vmcnt(6)
    v_mfma_f32_16x16x32_bf16 v[96:99], a[132:135], a[68:71], v[96:99]
    s_waitcnt vmcnt(5)
    v_mfma_f32_16x16x32_bf16 v[96:99], a[136:139], a[72:75], v[96:99]
    s_waitcnt vmcnt(4)
    v_mfma_f32_16x16x32_bf16 v[96:99], a[140:143], a[76:79], v[96:99]
    v_mfma_f32_16x16x32_bf16 v[104:107], a[128:131], a[80:83], v[68:71]
    v_mfma_f32_16x16x32_bf16 v[104:107], a[132:135], a[84:87], v[104:107]
    v_mfma_f32_16x16x32_bf16 v[104:107], a[136:139], a[88:91], v[104:107]
    v_mfma_f32_16x16x32_bf16 v[104:107], a[140:143], a[92:95], v[104:107]
    s_waitcnt vmcnt(3)
    v_mfma_f32_16x16x32_bf16 v[100:103], a[144:147], a[64:67], v[64:67]
    s_waitcnt vmcnt(2)
    v_mfma_f32_16x16x32_bf16 v[100:103], a[148:151], a[68:71], v[100:103]
    s_waitcnt vmcnt(1)
    v_mfma_f32_16x16x32_bf16 v[100:103], a[152:155], a[72:75], v[100:103]
    s_waitcnt vmcnt(0)
    v_mfma_f32_16x16x32_bf16 v[100:103], a[156:159], a[76:79], v[100:103]
    v_mfma_f32_16x16x32_bf16 v[108:111], a[144:147], a[80:83], v[68:71]
    v_mfma_f32_16x16x32_bf16 v[108:111], a[148:151], a[84:87], v[108:111]
    v_mfma_f32_16x16x32_bf16 v[108:111], a[152:155], a[88:91], v[108:111]
    v_mfma_f32_16x16x32_bf16 v[108:111], a[156:159], a[92:95], v[108:111]
    v_mfma_f32_16x16x32_bf16 v[112:115], a[128:131], a[96:99], v[72:75]
    v_mfma_f32_16x16x32_bf16 v[112:115], a[132:135], a[100:103], v[112:115]
    v_mfma_f32_16x16x32_bf16 v[112:115], a[136:139], a[104:107], v[112:115]
    v_mfma_f32_16x16x32_bf16 v[112:115], a[140:143], a[108:111], v[112:115]
    v_mfma_f32_16x16x32_bf16 v[120:123], a[128:131], a[112:115], v[76:79]
    v_mfma_f32_16x16x32_bf16 v[120:123], a[132:135], a[116:119], v[120:123]
    v_mfma_f32_16x16x32_bf16 v[120:123], a[136:139], a[120:123], v[120:123]
    v_mfma_f32_16x16x32_bf16 v[120:123], a[140:143], a[124:127], v[120:123]
    v_mfma_f32_16x16x32_bf16 v[116:119], a[144:147], a[96:99], v[72:75]
    v_mfma_f32_16x16x32_bf16 v[116:119], a[148:151], a[100:103], v[116:119]
    v_mfma_f32_16x16x32_bf16 v[116:119], a[152:155], a[104:107], v[116:119]
    v_mfma_f32_16x16x32_bf16 v[116:119], a[156:159], a[108:111], v[116:119]
    v_mfma_f32_16x16x32_bf16 v[124:127], a[144:147], a[112:115], v[76:79]
    v_mfma_f32_16x16x32_bf16 v[124:127], a[148:151], a[116:119], v[124:127]
    v_mfma_f32_16x16x32_bf16 v[124:127], a[152:155], a[120:123], v[124:127]
    v_mfma_f32_16x16x32_bf16 v[124:127], a[156:159], a[124:127], v[124:127]
    v_max3_f32 v48, v48, v96, v97
    v_max3_f32 v48, v48, v98, v99
    v_max3_f32 v48, v48, v100, v101
    v_max3_f32 v48, v48, v102, v103
    v_max3_f32 v49, v49, v104, v105
    v_max3_f32 v49, v49, v106, v107
    v_max3_f32 v49, v49, v108, v109
    v_max3_f32 v49, v49, v110, v111
    v_max3_f32 v50, v50, v112, v113
    v_max3_f32 v50, v50, v114, v115
    v_max3_f32 v50, v50, v116, v117
    v_max3_f32 v50, v50, v118, v119
    v_max3_f32 v51, v51, v120, v121
    v_max3_f32 v51, v51, v122, v123
    v_max3_f32 v51, v51, v124, v125
    v_max3_f32 v51, v51, v126, v127
    s_add_u32 s100, s101, 16384
    buffer_load_dwordx4 a[128:131], v1, s[8:11], s100 offen offset:0
    buffer_load_dwordx4 a[132:135], v1, s[8:11], s100 offen offset:1024
    buffer_load_dwordx4 a[136:139], v1, s[8:11], s100 offen offset:2048
    buffer_load_dwordx4 a[140:143], v1, s[8:11], s100 offen offset:3072
    buffer_load_dwordx4 a[144:147], v15, s[8:11], s100 offen offset:0
    buffer_load_dwordx4 a[148:151], v15, s[8:11], s100 offen offset:1024
    buffer_load_dwordx4 a[152:155], v15, s[8:11], s100 offen offset:2048
    buffer_load_dwordx4 a[156:159], v15, s[8:11], s100 offen offset:3072
    s_waitcnt vmcnt(7)
    v_mfma_f32_16x16x32_bf16 v[96:99], a[128:131], a[64:67], v[64:67]
    s_waitcnt vmcnt(6)
    v_mfma_f32_16x16x32_bf16 v[96:99], a[132:135], a[68:71], v[96:99]
    s_waitcnt vmcnt(5)
    v_mfma_f32_16x16x32_bf16 v[96:99], a[136:139], a[72:75], v[96:99]
    s_waitcnt vmcnt(4)
    v_mfma_f32_16x16x32_bf16 v[96:99], a[140:143], a[76:79], v[96:99]
    v_mfma_f32_16x16x32_bf16 v[104:107], a[128:131], a[80:83], v[68:71]
    v_mfma_f32_16x16x32_bf16 v[104:107], a[132:135], a[84:87], v[104:107]
    v_mfma_f32_16x16x32_bf16 v[104:107], a[136:139], a[88:91], v[104:107]
    v_mfma_f32_16x16x32_bf16 v[104:107], a[140:143], a[92:95], v[104:107]
    s_waitcnt vmcnt(3)
    v_mfma_f32_16x16x32_bf16 v[100:103], a[144:147], a[64:67], v[64:67]
    s_waitcnt vmcnt(2)
    v_mfma_f32_16x16x32_bf16 v[100:103], a[148:151], a[68:71], v[100:103]
    s_waitcnt vmcnt(1)
    v_mfma_f32_16x16x32_bf16 v[100:103], a[152:155], a[72:75], v[100:103]
    s_waitcnt vmcnt(0)
    v_mfma_f32_16x16x32_bf16 v[100:103], a[156:159], a[76:79], v[100:103]
    v_mfma_f32_16x16x32_bf16 v[108:111], a[144:147], a[80:83], v[68:71]
    v_mfma_f32_16x16x32_bf16 v[108:111], a[148:151], a[84:87], v[108:111]
    v_mfma_f32_16x16x32_bf16 v[108:111], a[152:155], a[88:91], v[108:111]
    v_mfma_f32_16x16x32_bf16 v[108:111], a[156:159], a[92:95], v[108:111]
    v_mfma_f32_16x16x32_bf16 v[112:115], a[128:131], a[96:99], v[72:75]
    v_mfma_f32_16x16x32_bf16 v[112:115], a[132:135], a[100:103], v[112:115]
    v_mfma_f32_16x16x32_bf16 v[112:115], a[136:139], a[104:107], v[112:115]
    v_mfma_f32_16x16x32_bf16 v[112:115], a[140:143], a[108:111], v[112:115]
    v_mfma_f32_16x16x32_bf16 v[120:123], a[128:131], a[112:115], v[76:79]
    v_mfma_f32_16x16x32_bf16 v[120:123], a[132:135], a[116:119], v[120:123]
    v_mfma_f32_16x16x32_bf16 v[120:123], a[136:139], a[120:123], v[120:123]
    v_mfma_f32_16x16x32_bf16 v[120:123], a[140:143], a[124:127], v[120:123]
    v_mfma_f32_16x16x32_bf16 v[116:119], a[144:147], a[96:99], v[72:75]
    v_mfma_f32_16x16x32_bf16 v[116:119], a[148:151], a[100:103], v[116:119]
    v_mfma_f32_16x16x32_bf16 v[116:119], a[152:155], a[104:107], v[116:119]
    v_mfma_f32_16x16x32_bf16 v[116:119], a[156:159], a[108:111], v[116:119]
    v_mfma_f32_16x16x32_bf16 v[124:127], a[144:147], a[112:115], v[76:79]
    v_mfma_f32_16x16x32_bf16 v[124:127], a[148:151], a[116:119], v[124:127]
    v_mfma_f32_16x16x32_bf16 v[124:127], a[152:155], a[120:123], v[124:127]
    v_mfma_f32_16x16x32_bf16 v[124:127], a[156:159], a[124:127], v[124:127]
    v_max3_f32 v48, v48, v96, v97
    v_max3_f32 v48, v48, v98, v99
    v_max3_f32 v48, v48, v100, v101
    v_max3_f32 v48, v48, v102, v103
    v_max3_f32 v49, v49, v104, v105
    v_max3_f32 v49, v49, v106, v107
    v_max3_f32 v49, v49, v108, v109
    v_max3_f32 v49, v49, v110, v111
    v_max3_f32 v50, v50, v112, v113
    v_max3_f32 v50, v50, v114, v115
    v_max3_f32 v50, v50, v116, v117
    v_max3_f32 v50, v50, v118, v119
    v_max3_f32 v51, v51, v120, v121
    v_max3_f32 v51, v51, v122, v123
    v_max3_f32 v51, v51, v124, v125
    v_max3_f32 v51, v51, v126, v127
    s_add_u32 s101, s101, 65536
    s_sub_u32 s14, s14, 1
    s_nop 7
    s_branch L_t1_maxl
L_t1_maxd:
    s_add_u32 s100, s101, 0
    buffer_load_dwordx4 a[128:131], v1, s[8:11], s100 offen offset:0
    buffer_load_dwordx4 a[132:135], v1, s[8:11], s100 offen offset:1024
    buffer_load_dwordx4 a[136:139], v1, s[8:11], s100 offen offset:2048
    buffer_load_dwordx4 a[140:143], v1, s[8:11], s100 offen offset:3072
    buffer_load_dwordx4 a[144:147], v15, s[8:11], s100 offen offset:0
    buffer_load_dwordx4 a[148:151], v15, s[8:11], s100 offen offset:1024
    buffer_load_dwordx4 a[152:155], v15, s[8:11], s100 offen offset:2048
    buffer_load_dwordx4 a[156:159], v15, s[8:11], s100 offen offset:3072
    v_add_f32 v80, 0, v21
    v_min_f32 v80, v80, v64
    v_add_f32 v81, 0xf1800000, v21
    v_min_f32 v81, v81, v65
    v_add_f32 v82, 0xf2000000, v21
    v_min_f32 v82, v82, v66
    v_add_f32 v83, 0xf2400000, v21
    v_min_f32 v83, v83, v67
    v_add_f32 v84, 0xf3800000, v21
    v_min_f32 v84, v84, v64
    v_add_f32 v85, 0xf3880000, v21
    v_min_f32 v85, v85, v65
    v_add_f32 v86, 0xf3900000, v21
    v_min_f32 v86, v86, v66
    v_add_f32 v87, 0xf3980000, v21
    v_min_f32 v87, v87, v67
    v_add_f32 v88, 0x73800000, v21
    v_min_f32 v88, v88, v68
    v_add_f32 v89, 0x73700000, v21
    v_min_f32 v89, v89, v69
    v_add_f32 v90, 0x73600000, v21
    v_min_f32 v90, v90, v70
    v_add_f32 v91, 0x73500000, v21
    v_min_f32 v91, v91, v71
    v_add_f32 v92, 0, v21
    v_min_f32 v92, v92, v68
    v_add_f32 v93, 0xf1800000, v21
    v_min_f32 v93, v93, v69
    v_add_f32 v94, 0xf2000000, v21
    v_min_f32 v94, v94, v70
    v_add_f32 v95, 0xf2400000, v21
    v_min_f32 v95, v95, v71
    s_waitcnt vmcnt(7)
    v_mfma_f32_16x16x32_bf16 v[96:99], a[128:131], a[64:67], v[80:83]
    s_waitcnt vmcnt(6)
    v_mfma_f32_16x16x32_bf16 v[96:99], a[132:135], a[68:71], v[96:99]
    s_waitcnt vmcnt(5)
    v_mfma_f32_16x16x32_bf16 v[96:99], a[136:139], a[72:75], v[96:99]
    s_waitcnt vmcnt(4)
    v_mfma_f32_16x16x32_bf16 v[96:99], a[140:143], a[76:79], v[96:99]
    v_mfma_f32_16x16x32_bf16 v[104:107], a[128:131], a[80:83], v[88:91]
    v_mfma_f32_16x16x32_bf16 v[104:107], a[132:135], a[84:87], v[104:107]
    v_mfma_f32_16x16x32_bf16 v[104:107], a[136:139], a[88:91], v[104:107]
    v_mfma_f32_16x16x32_bf16 v[104:107], a[140:143], a[92:95], v[104:107]
    s_waitcnt vmcnt(3)
    v_mfma_f32_16x16x32_bf16 v[100:103], a[144:147], a[64:67], v[84:87]
    s_waitcnt vmcnt(2)
    v_mfma_f32_16x16x32_bf16 v[100:103], a[148:151], a[68:71], v[100:103]
    s_waitcnt vmcnt(1)
    v_mfma_f32_16x16x32_bf16 v[100:103], a[152:155], a[72:75], v[100:103]
    s_waitcnt vmcnt(0)
    v_mfma_f32_16x16x32_bf16 v[100:103], a[156:159], a[76:79], v[100:103]
    v_mfma_f32_16x16x32_bf16 v[108:111], a[144:147], a[80:83], v[92:95]
    v_mfma_f32_16x16x32_bf16 v[108:111], a[148:151], a[84:87], v[108:111]
    v_mfma_f32_16x16x32_bf16 v[108:111], a[152:155], a[88:91], v[108:111]
    v_mfma_f32_16x16x32_bf16 v[108:111], a[156:159], a[92:95], v[108:111]
    v_mfma_f32_16x16x32_bf16 v[112:115], a[128:131], a[96:99], v[72:75]
    v_mfma_f32_16x16x32_bf16 v[112:115], a[132:135], a[100:103], v[112:115]
    v_mfma_f32_16x16x32_bf16 v[112:115], a[136:139], a[104:107], v[112:115]
    v_mfma_f32_16x16x32_bf16 v[112:115], a[140:143], a[108:111], v[112:115]
    v_mfma_f32_16x16x32_bf16 v[120:123], a[128:131], a[112:115], v[76:79]
    v_mfma_f32_16x16x32_bf16 v[120:123], a[132:135], a[116:119], v[120:123]
    v_mfma_f32_16x16x32_bf16 v[120:123], a[136:139], a[120:123], v[120:123]
    v_mfma_f32_16x16x32_bf16 v[120:123], a[140:143], a[124:127], v[120:123]
    v_mfma_f32_16x16x32_bf16 v[116:119], a[144:147], a[96:99], v[72:75]
    v_mfma_f32_16x16x32_bf16 v[116:119], a[148:151], a[100:103], v[116:119]
    v_mfma_f32_16x16x32_bf16 v[116:119], a[152:155], a[104:107], v[116:119]
    v_mfma_f32_16x16x32_bf16 v[116:119], a[156:159], a[108:111], v[116:119]
    v_mfma_f32_16x16x32_bf16 v[124:127], a[144:147], a[112:115], v[76:79]
    v_mfma_f32_16x16x32_bf16 v[124:127], a[148:151], a[116:119], v[124:127]
    v_mfma_f32_16x16x32_bf16 v[124:127], a[152:155], a[120:123], v[124:127]
    v_mfma_f32_16x16x32_bf16 v[124:127], a[156:159], a[124:127], v[124:127]
    v_max3_f32 v48, v48, v96, v97
    v_max3_f32 v48, v48, v98, v99
    v_max3_f32 v48, v48, v100, v101
    v_max3_f32 v48, v48, v102, v103
    v_max3_f32 v49, v49, v104, v105
    v_max3_f32 v49, v49, v106, v107
    v_max3_f32 v49, v49, v108, v109
    v_max3_f32 v49, v49, v110, v111
    v_max3_f32 v50, v50, v112, v113
    v_max3_f32 v50, v50, v114, v115
    v_max3_f32 v50, v50, v116, v117
    v_max3_f32 v50, v50, v118, v119
    v_max3_f32 v51, v51, v120, v121
    v_max3_f32 v51, v51, v122, v123
    v_max3_f32 v51, v51, v124, v125
    v_max3_f32 v51, v51, v126, v127
    s_add_u32 s100, s101, 16384
    buffer_load_dwordx4 a[128:131], v1, s[8:11], s100 offen offset:0
    buffer_load_dwordx4 a[132:135], v1, s[8:11], s100 offen offset:1024
    buffer_load_dwordx4 a[136:139], v1, s[8:11], s100 offen offset:2048
    buffer_load_dwordx4 a[140:143], v1, s[8:11], s100 offen offset:3072
    buffer_load_dwordx4 a[144:147], v15, s[8:11], s100 offen offset:0
    buffer_load_dwordx4 a[148:151], v15, s[8:11], s100 offen offset:1024
    buffer_load_dwordx4 a[152:155], v15, s[8:11], s100 offen offset:2048
    buffer_load_dwordx4 a[156:159], v15, s[8:11], s100 offen offset:3072
    v_add_f32 v80, 0, v22
    v_min_f32 v80, v80, v72
    v_add_f32 v81, 0xf1800000, v22
    v_min_f32 v81, v81, v73
    v_add_f32 v82, 0xf2000000, v22
    v_min_f32 v82, v82, v74
    v_add_f32 v83, 0xf2400000, v22
    v_min_f32 v83, v83, v75
    v_add_f32 v84, 0xf3800000, v22
    v_min_f32 v84, v84, v72
    v_add_f32 v85, 0xf3880000, v22
    v_min_f32 v85, v85, v73
    v_add_f32 v86, 0xf3900000, v22
    v_min_f32 v86, v86, v74
    v_add_f32 v87, 0xf3980000, v22
    v_min_f32 v87, v87, v75
    v_add_f32 v88, 0x73800000, v22
    v_min_f32 v88, v88, v76
    v_add_f32 v89, 0x73700000, v22
    v_min_f32 v89, v89, v77
    v_add_f32 v90, 0x73600000, v22
    v_min_f32 v90, v90, v78
    v_add_f32 v91, 0x73500000, v22
    v_min_f32 v91, v91, v79
    v_add_f32 v92, 0, v22
    v_min_f32 v92, v92, v76
    v_add_f32 v93, 0xf1800000, v22
    v_min_f32 v93, v93, v77
    v_add_f32 v94, 0xf2000000, v22
    v_min_f32 v94, v94, v78
    v_add_f32 v95, 0xf2400000, v22
    v_min_f32 v95, v95, v79
    s_waitcnt vmcnt(7)
    v_mfma_f32_16x16x32_bf16 v[96:99], a[128:131], a[96:99], v[80:83]
    s_waitcnt vmcnt(6)
    v_mfma_f32_16x16x32_bf16 v[96:99], a[132:135], a[100:103], v[96:99]
    s_waitcnt vmcnt(5)
    v_mfma_f32_16x16x32_bf16 v[96:99], a[136:139], a[104:107], v[96:99]
    s_waitcnt vmcnt(4)
    v_mfma_f32_16x16x32_bf16 v[96:99], a[140:143], a[108:111], v[96:99]
    v_mfma_f32_16x16x32_bf16 v[104:107], a[128:131], a[112:115], v[88:91]
    v_mfma_f32_16x16x32_bf16 v[104:107], a[132:135], a[116:119], v[104:107]
    v_mfma_f32_16x16x32_bf16 v[104:107], a[136:139], a[120:123], v[104:107]
    v_mfma_f32_16x16x32_bf16 v[104:107], a[140:143], a[124:127], v[104:107]
    s_waitcnt vmcnt(3)
    v_mfma_f32_16x16x32_bf16 v[100:103], a[144:147], a[96:99], v[84:87]
    s_waitcnt vmcnt(2)
    v_mfma_f32_16x16x32_bf16 v[100:103], a[148:151], a[100:103], v[100:103]
    s_waitcnt vmcnt(1)
    v_mfma_f32_16x16x32_bf16 v[100:103], a[152:155], a[104:107], v[100:103]
    s_waitcnt vmcnt(0)
    v_mfma_f32_16x16x32_bf16 v[100:103], a[156:159], a[108:111], v[100:103]
    v_mfma_f32_16x16x32_bf16 v[108:111], a[144:147], a[112:115], v[92:95]
    v_mfma_f32_16x16x32_bf16 v[108:111], a[148:151], a[116:119], v[108:111]
    v_mfma_f32_16x16x32_bf16 v[108:111], a[152:155], a[120:123], v[108:111]
    v_mfma_f32_16x16x32_bf16 v[108:111], a[156:159], a[124:127], v[108:111]
    v_max3_f32 v50, v50, v96, v97
    v_max3_f32 v50, v50, v98, v99
    s_nop 1
    v_max3_f32 v50, v50, v100, v101
    v_max3_f32 v50, v50, v102, v103
    v_max3_f32 v51, v51, v104, v105
    v_max3_f32 v51, v51, v106, v107
    v_max3_f32 v51, v51, v108, v109
    v_max3_f32 v51, v51, v110, v111
    v_mov_b32 v52, v48
    v_mov_b32 v53, v49
    v_mov_b32 v54, v50
    v_mov_b32 v55, v51
    v_permlane16_swap_b32 v48, v52
    v_permlane16_swap_b32 v49, v53
    v_permlane16_swap_b32 v50, v54
    v_permlane16_swap_b32 v51, v55
    v_max_f32 v48, v48, v52
    v_max_f32 v49, v49, v53
    v_max_f32 v50, v50, v54
    v_max_f32 v51, v51, v55
    v_mov_b32 v52, v48
    v_mov_b32 v53, v49
    v_mov_b32 v54, v50
    v_mov_b32 v55, v51
    v_permlane32_swap_b32 v48, v52
    v_permlane32_swap_b32 v49, v53
    v_permlane32_swap_b32 v50, v54
    v_permlane32_swap_b32 v51, v55
    v_max_f32 v48, v48, v52
    v_max_f32 v49, v49, v53
    v_max_f32 v50, v50, v54
    v_max_f32 v51, v51, v55
    ds_write_b128 v16, v[48:51] offset:32768
    v_xor_b32 v8, 8192, v16
    s_waitcnt lgkmcnt(0)
    s_barrier
    ds_read_b128 v[52:55], v8 offset:32768
    s_waitcnt lgkmcnt(0)
    v_max_f32 v48, v48, v52
    v_max_f32 v49, v49, v53
    v_max_f32 v50, v50, v54
    v_max_f32 v51, v51, v55
    v_sub_f32 v64, 0, v48
    v_sub_f32 v65, 0, v48
    v_sub_f32 v66, 0, v48
    v_sub_f32 v67, 0, v48
    v_sub_f32 v68, 0, v49
    v_sub_f32 v69, 0, v49
    v_sub_f32 v70, 0, v49
    v_sub_f32 v71, 0, v49
    v_sub_f32 v72, 0, v50
    v_sub_f32 v73, 0, v50
    v_sub_f32 v74, 0, v50
    v_sub_f32 v75, 0, v50
    v_sub_f32 v76, 0, v51
    v_sub_f32 v77, 0, v51
    v_sub_f32 v78, 0, v51
    v_sub_f32 v79, 0, v51
    s_mov_b32 s12, 0
    s_and_b32 s100, s12, 1
    s_mul_i32 s15, s100, 196608
    s_xor_b32 s15, s15, 65536
    s_mul_i32 s16, s100, 98304
    s_xor_b32 s16, s16, 98304
    v_and_b32 v18, 0x7fff, v18
    v_or_b32 v18, s15, v18
    v_and_b32 v19, 0x7fff, v19
    v_or_b32 v19, s16, v19
    v_and_b32 v20, 0x7fff, v20
    v_or_b32 v20, s16, v20
    s_add_u32 s15, s15, s62
    s_add_u32 s16, s16, s62
    s_add_u32 s12, s12, 2
    s_mov_b32 s82, s81
    s_add_u32 s19, s81, 32768
    s_add_u32 m0, s15, 0
    s_nop 0
    buffer_load_dwordx4 v1, s[8:11], s82 offen offset:0 lds
    buffer_load_dwordx4 v1, s[8:11], s82 offen offset:1024 lds
    buffer_load_dwordx4 v1, s[8:11], s82 offen offset:2048 lds
    buffer_load_dwordx4 v1, s[8:11], s82 offen offset:3072 lds
    s_add_u32 m0, s15, 4096
    s_nop 0
    buffer_load_dwordx4 v15, s[8:11], s82 offen offset:0 lds
    buffer_load_dwordx4 v15, s[8:11], s82 offen offset:1024 lds
    buffer_load_dwordx4 v15, s[8:11], s82 offen offset:2048 lds
    buffer_load_dwordx4 v15, s[8:11], s82 offen offset:3072 lds
    s_xor_b32 s15, s15, 196608
    s_add_u32 m0, s16, 0
    s_nop 0
    buffer_load_dwordx4 v1, s[8:11], s19 offen offset:0 lds
    buffer_load_dwordx4 v1, s[8:11], s19 offen offset:1024 lds
    buffer_load_dwordx4 v1, s[8:11], s19 offen offset:2048 lds
    buffer_load_dwordx4 v1, s[8:11], s19 offen offset:3072 lds
    s_add_u32 m0, s16, 4096
    s_nop 0
    buffer_load_dwordx4 v15, s[8:11], s19 offen offset:0 lds
    buffer_load_dwordx4 v15, s[8:11], s19 offen offset:1024 lds
    buffer_load_dwordx4 v15, s[8:11], s19 offen offset:2048 lds
    buffer_load_dwordx4 v15, s[8:11], s19 offen offset:3072 lds
    s_xor_b32 s16, s16, 98304
    s_min_u32 s82, s60, 1
    s_lshl_b32 s82, s82, 16
    s_add_u32 s82, s82, s81
    s_add_u32 m0, s15, 0
    s_nop 0
    buffer_load_dwordx4 v1, s[8:11], s82 offen offset:0 lds
    buffer_load_dwordx4 v1, s[8:11], s82 offen offset:1024 lds
    buffer_load_dwordx4 v1, s[8:11], s82 offen offset:2048 lds
    buffer_load_dwordx4 v1, s[8:11], s82 offen offset:3072 lds
    s_add_u32 m0, s15, 4096
    s_nop 0
    buffer_load_dwordx4 v15, s[8:11], s82 offen offset:0 lds
    buffer_load_dwordx4 v15, s[8:11], s82 offen offset:1024 lds
    buffer_load_dwordx4 v15, s[8:11], s82 offen offset:2048 lds
    buffer_load_dwordx4 v15, s[8:11], s82 offen offset:3072 lds
    s_xor_b32 s15, s15, 196608
    s_cmp_eq_u32 s60, 0
    s_cselect_b32 s19, 0, 0x76800000
    v_add_f32 v3, s19, v21
    v_add_f32 v96, 0, v3
    v_min_f32 v96, v96, v64
    v_add_f32 v97, 0xf1800000, v3
    v_min_f32 v97, v97, v65
    v_add_f32 v98, 0xf2000000, v3
    v_min_f32 v98, v98, v66
    v_add_f32 v99, 0xf2400000, v3
    v_min_f32 v99, v99, v67
    v_add_f32 v100, 0xf3800000, v3
    v_min_f32 v100, v100, v64
    v_add_f32 v101, 0xf3880000, v3
    v_min_f32 v101, v101, v65
    v_add_f32 v102, 0xf3900000, v3
    v_min_f32 v102, v102, v66
    v_add_f32 v103, 0xf3980000, v3
    v_min_f32 v103, v103, v67
    v_add_f32 v104, 0x73800000, v3
    v_min_f32 v104, v104, v68
    v_add_f32 v105, 0x73700000, v3
    v_min_f32 v105, v105, v69
    v_add_f32 v106, 0x73600000, v3
    v_min_f32 v106, v106, v70
    v_add_f32 v107, 0x73500000, v3
    v_min_f32 v107, v107, v71
    v_add_f32 v108, 0, v3
    v_min_f32 v108, v108, v68
    v_add_f32 v109, 0xf1800000, v3
    v_min_f32 v109, v109, v69
    v_add_f32 v110, 0xf2000000, v3
    v_min_f32 v110, v110, v70
    v_add_f32 v111, 0xf2400000, v3
    v_min_f32 v111, v111, v71
    v_add_f32 v80, 0, v22
    v_min_f32 v80, v80, v72
    v_add_f32 v81, 0xf1800000, v22
    v_min_f32 v81, v81, v73
    v_add_f32 v82, 0xf2000000, v22
    v_min_f32 v82, v82, v74
    v_add_f32 v83, 0xf2400000, v22
    v_min_f32 v83, v83, v75
    v_add_f32 v84, 0xf3800000, v22
    v_min_f32 v84, v84, v72
    v_add_f32 v85, 0xf3880000, v22
    v_min_f32 v85, v85, v73
    v_add_f32 v86, 0xf3900000, v22
    v_min_f32 v86, v86, v74
    v_add_f32 v87, 0xf3980000, v22
    v_min_f32 v87, v87, v75
    v_add_f32 v88, 0x73800000, v22
    v_min_f32 v88, v88, v76
    v_add_f32 v89, 0x73700000, v22
    v_min_f32 v89, v89, v77
    v_add_f32 v90, 0x73600000, v22
    v_min_f32 v90, v90, v78
    v_add_f32 v91, 0x73500000, v22
    v_min_f32 v91, v91, v79
    v_add_f32 v92, 0, v22
    v_min_f32 v92, v92, v76
    v_add_f32 v93, 0xf1800000, v22
    v_min_f32 v93, v93, v77
    v_add_f32 v94, 0xf2000000, v22
    v_min_f32 v94, v94, v78
    v_add_f32 v95, 0xf2400000, v22
    v_min_f32 v95, v95, v79
    s_cmp_eq_u32 s60, 0
    s_cbranch_scc1 L_t1_mk
    v_add_f32 v80, 0, v21
    v_min_f32 v80, v80, v64
    v_add_f32 v81, 0xf1800000, v21
    v_min_f32 v81, v81, v65
    v_add_f32 v82, 0xf2000000, v21
    v_min_f32 v82, v82, v66
    v_add_f32 v83, 0xf2400000, v21
    v_min_f32 v83, v83, v67
    v_add_f32 v84, 0xf3800000, v21
    v_min_f32 v84, v84, v64
    v_add_f32 v85, 0xf3880000, v21
    v_min_f32 v85, v85, v65
    v_add_f32 v86, 0xf3900000, v21
    v_min_f32 v86, v86, v66
    v_add_f32 v87, 0xf3980000, v21
    v_min_f32 v87, v87, v67
    v_add_f32 v88, 0x73800000, v21
    v_min_f32 v88, v88, v68
    v_add_f32 v89, 0x73700000, v21
    v_min_f32 v89, v89, v69
    v_add_f32 v90, 0x73600000, v21
    v_min_f32 v90, v90, v70
    v_add_f32 v91, 0x73500000, v21
    v_min_f32 v91, v91, v71
    v_add_f32 v92, 0, v21
    v_min_f32 v92, v92, v68
    v_add_f32 v93, 0xf1800000, v21
    v_min_f32 v93, v93, v69
    v_add_f32 v94, 0xf2000000, v21
    v_min_f32 v94, v94, v70
    v_add_f32 v95, 0xf2400000, v21
    v_min_f32 v95, v95, v71
L_t1_mk:
    s_waitcnt vmcnt(0) lgkmcnt(0)
    s_barrier
    ds_read_b128 a[128:131], v18 offset:0
    ds_read_b128 a[132:135], v18 offset:1024
    ds_read_b128 a[136:139], v18 offset:2048
    ds_read_b128 a[140:143], v18 offset:3072
    ds_read_b128 a[144:147], v18 offset:4096
    ds_read_b128 a[148:151], v18 offset:5120
    ds_read_b128 a[152:155], v18 offset:6144
    ds_read_b128 a[156:159], v18 offset:7168
    s_waitcnt lgkmcnt(0)
    s_branch L_t1_start
L_C1_slow_9:
    s_mov_b32 s99, 0
L_C1_slow_9_l:
    s_sleep 4
    buffer_load_dword v3, v4, s[8:11], s23 offen sc0 sc1
    s_add_u32 s99, s99, 1
    s_waitcnt vmcnt(0)
    v_cmp_ne_u32 vcc, 0, v3
    s_cmp_eq_u64 vcc, -1
    s_cbranch_scc1 L_C1_ok_10
    s_cmp_lt_u32 s99, 200000
    s_cbranch_scc1 L_C1_slow_9_l
    s_branch L_C1_ok_10
L_F_slow_11:
    s_mov_b32 s99, 0
L_F_slow_11_l:
    s_sleep 4
    buffer_load_dword v3, v12, s[8:11], s71 offen sc0 sc1
    s_add_u32 s99, s99, 1
    s_waitcnt vmcnt(0)
    v_cmp_ne_u32 vcc, 0, v3
    s_cmp_eq_u64 vcc, -1
    s_cbranch_scc1 L_F_ok_12
    s_cmp_lt_u32 s99, 200000
    s_cbranch_scc1 L_F_slow_11_l
    s_branch L_F_ok_12
L_t2_redo:
    s_cmp_eq_u32 s25, 0
    s_cbranch_scc1 L_t2_max
    s_mov_b32 s25, 0
    v_mov_b32 v64, 0
    v_mov_b32 v65, 0
    v_mov_b32 v66, 0
    v_mov_b32 v67, 0
    v_mov_b32 v68, 0
    v_mov_b32 v69, 0
    v_mov_b32 v70, 0
    v_mov_b32 v71, 0
    v_mov_b32 v72, 0
    v_mov_b32 v73, 0
    v_mov_b32 v74, 0
    v_mov_b32 v75, 0
    v_mov_b32 v76, 0
    v_mov_b32 v77, 0
    v_mov_b32 v78, 0
    v_mov_b32 v79, 0
    s_nop 1
    s_branch L_t2_safe
L_t2_max:
    s_waitcnt vmcnt(0) lgkmcnt(0)
    s_barrier
    s_mov_b32 s25, 1
    s_and_b32 s100, s3, 1
    s_lshl_b32 s100, s100, 13
    s_sub_u32 s101, s81, s62
    s_add_u32 s101, s101, s100
    s_mov_b32 s14, s61
    s_mov_b32 s26, 0
    v_mov_b32 v24, -1
    v_mov_b32 v25, -1
    v_mov_b32 v26, -1
    v_mov_b32 v27, -1
    v_mov_b32 v48, 0xff800000
    v_mov_b32 v49, 0xff800000
    v_mov_b32 v50, 0xff800000
    v_mov_b32 v51, 0xff800000
L_t2_maxl:
    s_cmp_eq_u32 s14, 0
    s_cbranch_scc1 L_t2_maxd
    s_add_u32 s100, s101, 0
    buffer_load_dwordx4 a[128:131], v1, s[8:11], s100 offen offset:0
    buffer_load_dwordx4 a[132:135], v1, s[8:11], s100 offen offset:1024
    buffer_load_dwordx4 a[136:139], v1, s[8:11], s100 offen offset:2048
    buffer_load_dwordx4 a[140:143], v1, s[8:11], s100 offen offset:3072
    buffer_load_dwordx4 a[144:147], v15, s[8:11], s100 offen offset:0
    buffer_load_dwordx4 a[148:151], v15, s[8:11], s100 offen offset:1024
    buffer_load_dwordx4 a[152:155], v15, s[8:11], s100 offen offset:2048
    buffer_load_dwordx4 a[156:159], v15, s[8:11], s100 offen offset:3072
    s_waitcnt vmcnt(7)
    v_mfma_f32_16x16x32_bf16 v[96:99], a[128:131], a[192:195], v[64:67]
    s_waitcnt vmcnt(6)
    v_mfma_f32_16x16x32_bf16 v[96:99], a[132:135], a[196:199], v[96:99]
    s_waitcnt vmcnt(5)
    v_mfma_f32_16x16x32_bf16 v[96:99], a[136:139], a[200:203], v[96:99]
    s_waitcnt vmcnt(4)
    v_mfma_f32_16x16x32_bf16 v[96:99], a[140:143], a[204:207], v[96:99]
    v_mfma_f32_16x16x32_bf16 v[104:107], a[128:131], a[208:211], v[68:71]
    v_mfma_f32_16x16x32_bf16 v[104:107], a[132:135], a[212:215], v[104:107]
    v_mfma_f32_16x16x32_bf16 v[104:107], a[136:139], a[216:219], v[104:107]
    v_mfma_f32_16x16x32_bf16 v[104:107], a[140:143], a[220:223], v[104:107]
    s_waitcnt vmcnt(3)
    v_mfma_f32_16x16x32_bf16 v[100:103], a[144:147], a[192:195], v[64:67]
    s_waitcnt vmcnt(2)
    v_mfma_f32_16x16x32_bf16 v[100:103], a[148:151], a[196:199], v[100:103]
    s_waitcnt vmcnt(1)
    v_mfma_f32_16x16x32_bf16 v[100:103], a[152:155], a[200:203], v[100:103]
    s_waitcnt vmcnt(0)
    v_mfma_f32_16x16x32_bf16 v[100:103], a[156:159], a[204:207], v[100:103]
    v_mfma_f32_16x16x32_bf16 v[108:111], a[144:147], a[208:211], v[68:71]
    v_mfma_f32_16x16x32_bf16 v[108:111], a[148:151], a[212:215], v[108:111]
    v_mfma_f32_16x16x32_bf16 v[108:111], a[152:155], a[216:219], v[108:111]
    v_mfma_f32_16x16x32_bf16 v[108:111], a[156:159], a[220:223], v[108:111]
    v_mfma_f32_16x16x32_bf16 v[112:115], a[128:131], a[224:227], v[72:75]
    v_mfma_f32_16x16x32_bf16 v[112:115], a[132:135], a[228:231], v[112:115]
    v_mfma_f32_16x16x32_bf16 v[112:115], a[136:139], a[232:235], v[112:115]
    v_mfma_f32_16x16x32_bf16 v[112:115], a[140:143], a[236:239], v[112:115]
    v_mfma_f32_16x16x32_bf16 v[120:123], a[128:131], a[240:243], v[76:79]
    v_mfma_f32_16x16x32_bf16 v[120:123], a[132:135], a[244:247], v[120:123]
    v_mfma_f32_16x16x32_bf16 v[120:123], a[136:139], a[248:251], v[120:123]
    v_mfma_f32_16x16x32_bf16 v[120:123], a[140:143], a[252:255], v[120:123]
    v_mfma_f32_16x16x32_bf16 v[116:119], a[144:147], a[224:227], v[72:75]
    v_mfma_f32_16x16x32_bf16 v[116:119], a[148:151], a[228:231], v[116:119]
    v_mfma_f32_16x16x32_bf16 v[116:119], a[152:155], a[232:235], v[116:119]
    v_mfma_f32_16x16x32_bf16 v[116:119], a[156:159], a[236:239], v[116:119]
    v_mfma_f32_16x16x32_bf16 v[124:127], a[144:147], a[240:243], v[76:79]
    v_mfma_f32_16x16x32_bf16 v[124:127], a[148:151], a[244:247], v[124:127]
    v_mfma_f32_16x16x32_bf16 v[124:127], a[152:155], a[248:251], v[124:127]
    v_mfma_f32_16x16x32_bf16 v[124:127], a[156:159], a[252:255], v[124:127]
    v_max3_f32 v48, v48, v96, v97
    v_max3_f32 v48, v48, v98, v99
    v_max3_f32 v48, v48, v100, v101
    v_max3_f32 v48, v48, v102, v103
    v_max3_f32 v49, v49, v104, v105
    v_max3_f32 v49, v49, v106, v107
    v_max3_f32 v49, v49, v108, v109
    v_max3_f32 v49, v49, v110, v111
    v_max3_f32 v50, v50, v112, v113
    v_max3_f32 v50, v50, v114, v115
    v_max3_f32 v50, v50, v116, v117
    v_max3_f32 v50, v50, v118, v119
    v_max3_f32 v51, v51, v120, v121
    v_max3_f32 v51, v51, v122, v123
    v_max3_f32 v51, v51, v124, v125
    v_max3_f32 v51, v51, v126, v127
    s_add_u32 s100, s101, 16384
    buffer_load_dwordx4 a[128:131], v1, s[8:11], s100 offen offset:0
    buffer_load_dwordx4 a[132:135], v1, s[8:11], s100 offen offset:1024
    buffer_load_dwordx4 a[136:139], v1, s[8:11], s100 offen offset:2048
    buffer_load_dwordx4 a[140:143], v1, s[8:11], s100 offen offset:3072
    buffer_load_dwordx4 a[144:147], v15, s[8:11], s100 offen offset:0
    buffer_load_dwordx4 a[148:151], v15, s[8:11], s100 offen offset:1024
    buffer_load_dwordx4 a[152:155], v15, s[8:11], s100 offen offset:2048
    buffer_load_dwordx4 a[156:159], v15, s[8:11], s100 offen offset:3072
    s_waitcnt vmcnt(7)
    v_mfma_f32_16x16x32_bf16 v[96:99], a[128:131], a[192:195], v[64:67]
    s_waitcnt vmcnt(6)
    v_mfma_f32_16x16x32_bf16 v[96:99], a[132:135], a[196:199], v[96:99]
    s_waitcnt vmcnt(5)
    v_mfma_f32_16x16x32_bf16 v[96:99], a[136:139], a[200:203], v[96:99]
    s_waitcnt vmcnt(4)
    v_mfma_f32_16x16x32_bf16 v[96:99], a[140:143], a[204:207], v[96:99]
    v_mfma_f32_16x16x32_bf16 v[104:107], a[128:131], a[208:211], v[68:71]
    v_mfma_f32_16x16x32_bf16 v[104:107], a[132:135], a[212:215], v[104:107]
    v_mfma_f32_16x16x32_bf16 v[104:107], a[136:139], a[216:219], v[104:107]
    v_mfma_f32_16x16x32_bf16 v[104:107], a[140:143], a[220:223], v[104:107]
    s_waitcnt vmcnt(3)
    v_mfma_f32_16x16x32_bf16 v[100:103], a[144:147], a[192:195], v[64:67]
    s_waitcnt vmcnt(2)
    v_mfma_f32_16x16x32_bf16 v[100:103], a[148:151], a[196:199], v[100:103]
    s_waitcnt vmcnt(1)
    v_mfma_f32_16x16x32_bf16 v[100:103], a[152:155], a[200:203], v[100:103]
    s_waitcnt vmcnt(0)
    v_mfma_f32_16x16x32_bf16 v[100:103], a[156:159], a[204:207], v[100:103]
    v_mfma_f32_16x16x32_bf16 v[108:111], a[144:147], a[208:211], v[68:71]
    v_mfma_f32_16x16x32_bf16 v[108:111], a[148:151], a[212:215], v[108:111]
    v_mfma_f32_16x16x32_bf16 v[108:111], a[152:155], a[216:219], v[108:111]
    v_mfma_f32_16x16x32_bf16 v[108:111], a[156:159], a[220:223], v[108:111]
    v_mfma_f32_16x16x32_bf16 v[112:115], a[128:131], a[224:227], v[72:75]
    v_mfma_f32_16x16x32_bf16 v[112:115], a[132:135], a[228:231], v[112:115]
    v_mfma_f32_16x16x32_bf16 v[112:115], a[136:139], a[232:235], v[112:115]
    v_mfma_f32_16x16x32_bf16 v[112:115], a[140:143], a[236:239], v[112:115]
    v_mfma_f32_16x16x32_bf16 v[120:123], a[128:131], a[240:243], v[76:79]
    v_mfma_f32_16x16x32_bf16 v[120:123], a[132:135], a[244:247], v[120:123]
    v_mfma_f32_16x16x32_bf16 v[120:123], a[136:139], a[248:251], v[120:123]
    v_mfma_f32_16x16x32_bf16 v[120:123], a[140:143], a[252:255], v[120:123]
    v_mfma_f32_16x16x32_bf16 v[116:119], a[144:147], a[224:227], v[72:75]
    v_mfma_f32_16x16x32_bf16 v[116:119], a[148:151], a[228:231], v[116:119]
    v_mfma_f32_16x16x32_bf16 v[116:119], a[152:155], a[232:235], v[116:119]
    v_mfma_f32_16x16x32_bf16 v[116:119], a[156:159], a[236:239], v[116:119]
    v_mfma_f32_16x16x32_bf16 v[124:127], a[144:147], a[240:243], v[76:79]
    v_mfma_f32_16x16x32_bf16 v[124:127], a[148:151], a[244:247], v[124:127]
    v_mfma_f32_16x16x32_bf16 v[124:127], a[152:155], a[248:251], v[124:127]
    v_mfma_f32_16x16x32_bf16 v[124:127], a[156:159], a[252:255], v[124:127]
    v_max3_f32 v48, v48, v96, v97
    v_max3_f32 v48, v48, v98, v99
    v_max3_f32 v48, v48, v100, v101
    v_max3_f32 v48, v48, v102, v103
    v_max3_f32 v49, v49, v104, v105
    v_max3_f32 v49, v49, v106, v107
    v_max3_f32 v49, v49, v108, v109
    v_max3_f32 v49, v49, v110, v111
    v_max3_f32 v50, v50, v112, v113
    v_max3_f32 v50, v50, v114, v115
    v_max3_f32 v50, v50, v116, v117
    v_max3_f32 v50, v50, v118, v119
    v_max3_f32 v51, v51, v120, v121
    v_max3_f32 v51, v51, v122, v123
    v_max3_f32 v51, v51, v124, v125
    v_max3_f32 v51, v51, v126, v127
    s_add_u32 s101, s101, 65536
    s_sub_u32 s14, s14, 1
    s_nop 7
    s_branch L_t2_maxl
L_t2_maxd:
    s_add_u32 s100, s101, 0
    buffer_load_dwordx4 a[128:131], v1, s[8:11], s100 offen offset:0
    buffer_load_dwordx4 a[132:135], v1, s[8:11], s100 offen offset:1024
    buffer_load_dwordx4 a[136:139], v1, s[8:11], s100 offen offset:2048
    buffer_load_dwordx4 a[140:143], v1, s[8:11], s100 offen offset:3072
    buffer_load_dwordx4 a[144:147], v15, s[8:11], s100 offen offset:0
    buffer_load_dwordx4 a[148:151], v15, s[8:11], s100 offen offset:1024
    buffer_load_dwordx4 a[152:155], v15, s[8:11], s100 offen offset:2048
    buffer_load_dwordx4 a[156:159], v15, s[8:11], s100 offen offset:3072
    v_add_f32 v80, 0, v21
    v_min_f32 v80, v80, v64
    v_add_f32 v81, 0xf1800000, v21
    v_min_f32 v81, v81, v65
    v_add_f32 v82, 0xf2000000, v21
    v_min_f32 v82, v82, v66
    v_add_f32 v83, 0xf2400000, v21
    v_min_f32 v83, v83, v67
    v_add_f32 v84, 0xf3800000, v21
    v_min_f32 v84, v84, v64
    v_add_f32 v85, 0xf3880000, v21
    v_min_f32 v85, v85, v65
    v_add_f32 v86, 0xf3900000, v21
    v_min_f32 v86, v86, v66
    v_add_f32 v87, 0xf3980000, v21
    v_min_f32 v87, v87, v67
    v_add_f32 v88, 0x73800000, v21
    v_min_f32 v88, v88, v68
    v_add_f32 v89, 0x73700000, v21
    v_min_f32 v89, v89, v69
    v_add_f32 v90, 0x73600000, v21
    v_min_f32 v90, v90, v70
    v_add_f32 v91, 0x73500000, v21
    v_min_f32 v91, v91, v71
    v_add_f32 v92, 0, v21
    v_min_f32 v92, v92, v68
    v_add_f32 v93, 0xf1800000, v21
    v_min_f32 v93, v93, v69
    v_add_f32 v94, 0xf2000000, v21
    v_min_f32 v94, v94, v70
    v_add_f32 v95, 0xf2400000, v21
    v_min_f32 v95, v95, v71
    s_waitcnt vmcnt(7)
    v_mfma_f32_16x16x32_bf16 v[96:99], a[128:131], a[192:195], v[80:83]
    s_waitcnt vmcnt(6)
    v_mfma_f32_16x16x32_bf16 v[96:99], a[132:135], a[196:199], v[96:99]
    s_waitcnt vmcnt(5)
    v_mfma_f32_16x16x32_bf16 v[96:99], a[136:139], a[200:203], v[96:99]
    s_waitcnt vmcnt(4)
    v_mfma_f32_16x16x32_bf16 v[96:99], a[140:143], a[204:207], v[96:99]
    v_mfma_f32_16x16x32_bf16 v[104:107], a[128:131], a[208:211], v[88:91]
    v_mfma_f32_16x16x32_bf16 v[104:107], a[132:135], a[212:215], v[104:107]
    v_mfma_f32_16x16x32_bf16 v[104:107], a[136:139], a[216:219], v[104:107]
    v_mfma_f32_16x16x32_bf16 v[104:107], a[140:143], a[220:223], v[104:107]
    s_waitcnt vmcnt(3)
    v_mfma_f32_16x16x32_bf16 v[100:103], a[144:147], a[192:195], v[84:87]
    s_waitcnt vmcnt(2)
    v_mfma_f32_16x16x32_bf16 v[100:103], a[148:151], a[196:199], v[100:103]
    s_waitcnt vmcnt(1)
    v_mfma_f32_16x16x32_bf16 v[100:103], a[152:155], a[200:203], v[100:103]
    s_waitcnt vmcnt(0)
    v_mfma_f32_16x16x32_bf16 v[100:103], a[156:159], a[204:207], v[100:103]
    v_mfma_f32_16x16x32_bf16 v[108:111], a[144:147], a[208:211], v[92:95]
    v_mfma_f32_16x16x32_bf16 v[108:111], a[148:151], a[212:215], v[108:111]
    v_mfma_f32_16x16x32_bf16 v[108:111], a[152:155], a[216:219], v[108:111]
    v_mfma_f32_16x16x32_bf16 v[108:111], a[156:159], a[220:223], v[108:111]
    v_mfma_f32_16x16x32_bf16 v[112:115], a[128:131], a[224:227], v[72:75]
    v_mfma_f32_16x16x32_bf16 v[112:115], a[132:135], a[228:231], v[112:115]
    v_mfma_f32_16x16x32_bf16 v[112:115], a[136:139], a[232:235], v[112:115]
    v_mfma_f32_16x16x32_bf16 v[112:115], a[140:143], a[236:239], v[112:115]
    v_mfma_f32_16x16x32_bf16 v[120:123], a[128:131], a[240:243], v[76:79]
    v_mfma_f32_16x16x32_bf16 v[120:123], a[132:135], a[244:247], v[120:123]
    v_mfma_f32_16x16x32_bf16 v[120:123], a[136:139], a[248:251], v[120:123]
    v_mfma_f32_16x16x32_bf16 v[120:123], a[140:143], a[252:255], v[120:123]
    v_mfma_f32_16x16x32_bf16 v[116:119], a[144:147], a[224:227], v[72:75]
    v_mfma_f32_16x16x32_bf16 v[116:119], a[148:151], a[228:231], v[116:119]
    v_mfma_f32_16x16x32_bf16 v[116:119], a[152:155], a[232:235], v[116:119]
    v_mfma_f32_16x16x32_bf16 v[116:119], a[156:159], a[236:239], v[116:119]
    v_mfma_f32_16x16x32_bf16 v[124:127], a[144:147], a[240:243], v[76:79]
    v_mfma_f32_16x16x32_bf16 v[124:127], a[148:151], a[244:247], v[124:127]
    v_mfma_f32_16x16x32_bf16 v[124:127], a[152:155], a[248:251], v[124:127]
    v_mfma_f32_16x16x32_bf16 v[124:127], a[156:159], a[252:255], v[124:127]
    v_max3_f32 v48, v48, v96, v97
    v_max3_f32 v48, v48, v98, v99
    v_max3_f32 v48, v48, v100, v101
    v_max3_f32 v48, v48, v102, v103
    v_max3_f32 v49, v49, v104, v105
    v_max3_f32 v49, v49, v106, v107
    v_max3_f32 v49, v49, v108, v109
    v_max3_f32 v49, v49, v110, v111
    v_max3_f32 v50, v50, v112, v113
    v_max3_f32 v50, v50, v114, v115
    v_max3_f32 v50, v50, v116, v117
    v_max3_f32 v50, v50, v118, v119
    v_max3_f32 v51, v51, v120, v121
    v_max3_f32 v51, v51, v122, v123
    v_max3_f32 v51, v51, v124, v125
    v_max3_f32 v51, v51, v126, v127
    s_add_u32 s100, s101, 16384
    buffer_load_dwordx4 a[128:131], v1, s[8:11], s100 offen offset:0
    buffer_load_dwordx4 a[132:135], v1, s[8:11], s100 offen offset:1024
    buffer_load_dwordx4 a[136:139], v1, s[8:11], s100 offen offset:2048
    buffer_load_dwordx4 a[140:143], v1, s[8:11], s100 offen offset:3072
    buffer_load_dwordx4 a[144:147], v15, s[8:11], s100 offen offset:0
    buffer_load_dwordx4 a[148:151], v15, s[8:11], s100 offen offset:1024
    buffer_load_dwordx4 a[152:155], v15, s[8:11], s100 offen offset:2048
    buffer_load_dwordx4 a[156:159], v15, s[8:11], s100 offen offset:3072
    v_add_f32 v80, 0, v22
    v_min_f32 v80, v80, v72
    v_add_f32 v81, 0xf1800000, v22
    v_min_f32 v81, v81, v73
    v_add_f32 v82, 0xf2000000, v22
    v_min_f32 v82, v82, v74
    v_add_f32 v83, 0xf2400000, v22
    v_min_f32 v83, v83, v75
    v_add_f32 v84, 0xf3800000, v22
    v_min_f32 v84, v84, v72
    v_add_f32 v85, 0xf3880000, v22
    v_min_f32 v85, v85, v73
    v_add_f32 v86, 0xf3900000, v22
    v_min_f32 v86, v86, v74
    v_add_f32 v87, 0xf3980000, v22
    v_min_f32 v87, v87, v75
    v_add_f32 v88, 0x73800000, v22
    v_min_f32 v88, v88, v76
    v_add_f32 v89, 0x73700000, v22
    v_min_f32 v89, v89, v77
    v_add_f32 v90, 0x73600000, v22
    v_min_f32 v90, v90, v78
    v_add_f32 v91, 0x73500000, v22
    v_min_f32 v91, v91, v79
    v_add_f32 v92, 0, v22
    v_min_f32 v92, v92, v76
    v_add_f32 v93, 0xf1800000, v22
    v_min_f32 v93, v93, v77
    v_add_f32 v94, 0xf2000000, v22
    v_min_f32 v94, v94, v78
    v_add_f32 v95, 0xf2400000, v22
    v_min_f32 v95, v95, v79
    s_waitcnt vmcnt(7)
    v_mfma_f32_16x16x32_bf16 v[96:99], a[128:131], a[224:227], v[80:83]
    s_waitcnt vmcnt(6)
    v_mfma_f32_16x16x32_bf16 v[96:99], a[132:135], a[228:231], v[96:99]
    s_waitcnt vmcnt(5)
    v_mfma_f32_16x16x32_bf16 v[96:99], a[136:139], a[232:235], v[96:99]
    s_waitcnt vmcnt(4)
    v_mfma_f32_16x16x32_bf16 v[96:99], a[140:143], a[236:239], v[96:99]
    v_mfma_f32_16x16x32_bf16 v[104:107], a[128:131], a[240:243], v[88:91]
    v_mfma_f32_16x16x32_bf16 v[104:107], a[132:135], a[244:247], v[104:107]
    v_mfma_f32_16x16x32_bf16 v[104:107], a[136:139], a[248:251], v[104:107]
    v_mfma_f32_16x16x32_bf16 v[104:107], a[140:143], a[252:255], v[104:107]
    s_waitcnt vmcnt(3)
    v_mfma_f32_16x16x32_bf16 v[100:103], a[144:147], a[224:227], v[84:87]
    s_waitcnt vmcnt(2)
    v_mfma_f32_16x16x32_bf16 v[100:103], a[148:151], a[228:231], v[100:103]
    s_waitcnt vmcnt(1)
    v_mfma_f32_16x16x32_bf16 v[100:103], a[152:155], a[232:235], v[100:103]
    s_waitcnt vmcnt(0)
    v_mfma_f32_16x16x32_bf16 v[100:103], a[156:159], a[236:239], v[100:103]
    v_mfma_f32_16x16x32_bf16 v[108:111], a[144:147], a[240:243], v[92:95]
    v_mfma_f32_16x16x32_bf16 v[108:111], a[148:151], a[244:247], v[108:111]
    v_mfma_f32_16x16x32_bf16 v[108:111], a[152:155], a[248:251], v[108:111]
    v_mfma_f32_16x16x32_bf16 v[108:111], a[156:159], a[252:255], v[108:111]
    v_max3_f32 v50, v50, v96, v97
    v_max3_f32 v50, v50, v98, v99
    s_nop 1
    v_max3_f32 v50, v50, v100, v101
    v_max3_f32 v50, v50, v102, v103
    v_max3_f32 v51, v51, v104, v105
    v_max3_f32 v51, v51, v106, v107
    v_max3_f32 v51, v51, v108, v109
    v_max3_f32 v51, v51, v110, v111
    v_mov_b32 v52, v48
    v_mov_b32 v53, v49
    v_mov_b32 v54, v50
    v_mov_b32 v55, v51
    v_permlane16_swap_b32 v48, v52
    v_permlane16_swap_b32 v49, v53
    v_permlane16_swap_b32 v50, v54
    v_permlane16_swap_b32 v51, v55
    v_max_f32 v48, v48, v52
    v_max_f32 v49, v49, v53
    v_max_f32 v50, v50, v54
    v_max_f32 v51, v51, v55
    v_mov_b32 v52, v48
    v_mov_b32 v53, v49
    v_mov_b32 v54, v50
    v_mov_b32 v55, v51
    v_permlane32_swap_b32 v48, v52
    v_permlane32_swap_b32 v49, v53
    v_permlane32_swap_b32 v50, v54
    v_permlane32_swap_b32 v51, v55
    v_max_f32 v48, v48, v52
    v_max_f32 v49, v49, v53
    v_max_f32 v50, v50, v54
    v_max_f32 v51, v51, v55
    ds_write_b128 v16, v[48:51] offset:32768
    v_xor_b32 v8, 8192, v16
    s_waitcnt lgkmcnt(0)
    s_barrier
    ds_read_b128 v[52:55], v8 offset:32768
    s_waitcnt lgkmcnt(0)
    v_max_f32 v48, v48, v52
    v_max_f32 v49, v49, v53
    v_max_f32 v50, v50, v54
    v_max_f32 v51, v51, v55
    v_sub_f32 v64, 0, v48
    v_sub_f32 v65, 0, v48
    v_sub_f32 v66, 0, v48
    v_sub_f32 v67, 0, v48
    v_sub_f32 v68, 0, v49
    v_sub_f32 v69, 0, v49
    v_sub_f32 v70, 0, v49
    v_sub_f32 v71, 0, v49
    v_sub_f32 v72, 0, v50
    v_sub_f32 v73, 0, v50
    v_sub_f32 v74, 0, v50
    v_sub_f32 v75, 0, v50
    v_sub_f32 v76, 0, v51
    v_sub_f32 v77, 0, v51
    v_sub_f32 v78, 0, v51
    v_sub_f32 v79, 0, v51
    s_add_u32 s12, s13, 1
    s_and_b32 s100, s12, 1
    s_mul_i32 s15, s100, 196608
    s_xor_b32 s15, s15, 65536
    s_mul_i32 s16, s100, 98304
    s_xor_b32 s16, s16, 98304
    v_and_b32 v18, 0x7fff, v18
    v_or_b32 v18, s15, v18
    v_and_b32 v19, 0x7fff, v19
    v_or_b32 v19, s16, v19
    v_and_b32 v20, 0x7fff, v20
    v_or_b32 v20, s16, v20
    s_add_u32 s15, s15, s62
    s_add_u32 s16, s16, s62
    s_add_u32 s12, s12, 2
    s_mov_b32 s82, s81
    s_add_u32 s19, s81, 32768
    s_add_u32 m0, s15, 0
    s_nop 0
    buffer_load_dwordx4 v1, s[8:11], s82 offen offset:0 lds
    buffer_load_dwordx4 v1, s[8:11], s82 offen offset:1024 lds
    buffer_load_dwordx4 v1, s[8:11], s82 offen offset:2048 lds
    buffer_load_dwordx4 v1, s[8:11], s82 offen offset:3072 lds
    s_add_u32 m0, s15, 4096
    s_nop 0
    buffer_load_dwordx4 v15, s[8:11], s82 offen offset:0 lds
    buffer_load_dwordx4 v15, s[8:11], s82 offen offset:1024 lds
    buffer_load_dwordx4 v15, s[8:11], s82 offen offset:2048 lds
    buffer_load_dwordx4 v15, s[8:11], s82 offen offset:3072 lds
    s_xor_b32 s15, s15, 196608
    s_add_u32 m0, s16, 0
    s_nop 0
    buffer_load_dwordx4 v1, s[8:11], s19 offen offset:0 lds
    buffer_load_dwordx4 v1, s[8:11], s19 offen offset:1024 lds
    buffer_load_dwordx4 v1, s[8:11], s19 offen offset:2048 lds
    buffer_load_dwordx4 v1, s[8:11], s19 offen offset:3072 lds
    s_add_u32 m0, s16, 4096
    s_nop 0
    buffer_load_dwordx4 v15, s[8:11], s19 offen offset:0 lds
    buffer_load_dwordx4 v15, s[8:11], s19 offen offset:1024 lds
    buffer_load_dwordx4 v15, s[8:11], s19 offen offset:2048 lds
    buffer_load_dwordx4 v15, s[8:11], s19 offen offset:3072 lds
    s_xor_b32 s16, s16, 98304
    s_min_u32 s82, s61, 1
    s_lshl_b32 s82, s82, 16
    s_add_u32 s82, s82, s81
    s_add_u32 m0, s15, 0
    s_nop 0
    buffer_load_dwordx4 v1, s[8:11], s82 offen offset:0 lds
    buffer_load_dwordx4 v1, s[8:11], s82 offen offset:1024 lds
    buffer_load_dwordx4 v1, s[8:11], s82 offen offset:2048 lds
    buffer_load_dwordx4 v1, s[8:11], s82 offen offset:3072 lds
    s_add_u32 m0, s15, 4096
    s_nop 0
    buffer_load_dwordx4 v15, s[8:11], s82 offen offset:0 lds
    buffer_load_dwordx4 v15, s[8:11], s82 offen offset:1024 lds
    buffer_load_dwordx4 v15, s[8:11], s82 offen offset:2048 lds
    buffer_load_dwordx4 v15, s[8:11], s82 offen offset:3072 lds
    s_xor_b32 s15, s15, 196608
    s_waitcnt vmcnt(0) lgkmcnt(0)
    s_barrier
    ds_read_b128 a[128:131], v18 offset:0
    ds_read_b128 a[132:135], v18 offset:1024
    ds_read_b128 a[136:139], v18 offset:2048
    ds_read_b128 a[140:143], v18 offset:3072
    ds_read_b128 a[144:147], v18 offset:4096
    ds_read_b128 a[148:151], v18 offset:5120
    ds_read_b128 a[152:155], v18 offset:6144
    ds_read_b128 a[156:159], v18 offset:7168
    s_waitcnt lgkmcnt(0)
    s_branch L_t2_start
L_C2_slow_13:
    s_mov_b32 s99, 0
L_C2_slow_13_l:
    s_sleep 4
    buffer_load_dword v3, v4, s[8:11], s23 offen sc0 sc1
    s_add_u32 s99, s99, 1
    s_waitcnt vmcnt(0)
    v_cmp_ne_u32 vcc, 0, v3
    s_cmp_eq_u64 vcc, -1
    s_cbranch_scc1 L_C2_ok_14
    s_cmp_lt_u32 s99, 200000
    s_cbranch_scc1 L_C2_slow_13_l
    s_branch L_C2_ok_14
L_P1_slow_15:
    s_mov_b32 s99, 0
L_P2_l_5001:
    s_waitcnt vmcnt(0)
    v_max_u32 v48, v128, v129
    v_max3_u32 v48, v48, v130, v131
    v_max_u32 v49, v132, v133
    v_max3_u32 v49, v49, v134, v135
    v_max_u32 v50, v136, v137
    v_max3_u32 v50, v50, v138, v139
    v_max_u32 v51, v140, v141
    v_max3_u32 v51, v51, v142, v143
    v_max_u32 v52, v144, v145
    v_max3_u32 v52, v52, v146, v147
    v_max_u32 v53, v148, v149
    v_max3_u32 v53, v53, v150, v151
    v_max_u32 v54, v152, v153
    v_max3_u32 v54, v54, v154, v155
    v_max_u32 v55, v156, v157
    v_max3_u32 v55, v55, v158, v159
    v_max3_u32 v3, v48, v49, v50
    v_max3_u32 v3, v3, v51, v52
    v_max3_u32 v3, v3, v53, v54
    v_max_u32 v3, v3, v55
    v_cmp_eq_u32 vcc, -1, v3
    s_add_u32 s99, s99, 1
    s_cbranch_vccz L_P2_ok_5002
    s_cmp_ge_u32 s99, 200000
    s_cbranch_scc1 L_P2_ok_5002
    s_sleep 1
    v_cmp_eq_u32 vcc, -1, v48
    s_cbranch_vccz L_P2_s_5003
    s_and_b64 s[96:97], vcc, s[12:13]
    s_cselect_b64 exec, s[96:97], vcc
    s_add_u32 s74, s70, 0
    buffer_load_dwordx4 v[128:131], v44, s[8:11], s74 offen sc0 sc1
    s_mov_b64 exec, -1
L_P2_s_5003:
    v_cmp_eq_u32 vcc, -1, v49
    s_cbranch_vccz L_P2_s_5004
    s_and_b64 s[96:97], vcc, s[12:13]
    s_cselect_b64 exec, s[96:97], vcc
    s_add_u32 s74, s70, 4096
    buffer_load_dwordx4 v[132:135], v44, s[8:11], s74 offen sc0 sc1
    s_mov_b64 exec, -1
L_P2_s_5004:
    v_cmp_eq_u32 vcc, -1, v50
    s_cbranch_vccz L_P2_s_5005
    s_and_b64 s[96:97], vcc, s[12:13]
    s_cselect_b64 exec, s[96:97], vcc
    s_add_u32 s74, s70, 8192
    buffer_load_dwordx4 v[136:139], v44, s[8:11], s74 offen sc0 sc1
    s_mov_b64 exec, -1
L_P2_s_5005:
    v_cmp_eq_u32 vcc, -1, v51
    s_cbranch_vccz L_P2_s_5006
    s_and_b64 s[96:97], vcc, s[12:13]
    s_cselect_b64 exec, s[96:97], vcc
    s_add_u32 s74, s70, 12288
    buffer_load_dwordx4 v[140:143], v44, s[8:11], s74 offen sc0 sc1
    s_mov_b64 exec, -1
L_P2_s_5006:
    v_cmp_eq_u32 vcc, -1, v52
    s_cbranch_vccz L_P2_s_5007
    s_and_b64 s[96:97], vcc, s[12:13]
    s_cselect_b64 exec, s[96:97], vcc
    s_add_u32 s74, s70, 16384
    buffer_load_dwordx4 v[144:147], v44, s[8:11], s74 offen sc0 sc1
    s_mov_b64 exec, -1
L_P2_s_5007:
    v_cmp_eq_u32 vcc, -1, v53
    s_cbranch_vccz L_P2_s_5008
    s_and_b64 s[96:97], vcc, s[12:13]
    s_cselect_b64 exec, s[96:97], vcc
    s_add_u32 s74, s70, 20480
    buffer_load_dwordx4 v[148:151], v44, s[8:11], s74 offen sc0 sc1
    s_mov_b64 exec, -1
L_P2_s_5008:
    v_cmp_eq_u32 vcc, -1, v54
    s_cbranch_vccz L_P2_s_5009
    s_and_b64 s[96:97], vcc, s[12:13]
    s_cselect_b64 exec, s[96:97], vcc
    s_add_u32 s74, s70, 24576
    buffer_load_dwordx4 v[152:155], v44, s[8:11], s74 offen sc0 sc1
    s_mov_b64 exec, -1
L_P2_s_5009:
    v_cmp_eq_u32 vcc, -1, v55
    s_cbranch_vccz L_P2_s_5010
    s_and_b64 s[96:97], vcc, s[12:13]
    s_cselect_b64 exec, s[96:97], vcc
    s_add_u32 s74, s70, 28672
    buffer_load_dwordx4 v[156:159], v44, s[8:11], s74 offen sc0 sc1
    s_mov_b64 exec, -1
L_P2_s_5010:
    s_branch L_P2_l_5001
L_P2_ok_5002:
    s_branch L_P1_ok_16
L_code_end:
    s_endpgm
.section .rodata,"a"
.p2align 6
.amdhsa_kernel adaLN_cond__compressed_kv_cla__moe_arch_mod__prompt_kernel
  .amdhsa_next_free_vgpr 512
  .amdhsa_next_free_sgpr 102
  .amdhsa_accum_offset 256
  .amdhsa_group_segment_fixed_size 0
  .amdhsa_kernarg_size 128
  .amdhsa_user_sgpr_count 2
  .amdhsa_user_sgpr_kernarg_segment_ptr 1
  .amdhsa_system_sgpr_workgroup_id_x 1
.end_amdhsa_kernel
```

```asm
; @launch grid=(256,1,1) block=(256,1,1) lds=163840
.amdgcn_target "amdgcn-amd-amdhsa--gfx950"
.text
.globl adaLN_cond__compressed_kv_cla__moe_arch_mod__prompt_kernel
.p2align 8
.type adaLN_cond__compressed_kv_cla__moe_arch_mod__prompt_kernel,@function
adaLN_cond__compressed_kv_cla__moe_arch_mod__prompt_kernel:
    s_cmp_ge_u32 s2, 256
    s_cbranch_scc1 L_end
    s_load_dwordx16 s[64:79], s[0:1], 0
    s_load_dwordx16 s[80:95], s[0:1], 64
    s_getpc_b64 s[100:101]
L_pf1:
    v_lshrrev_b32 v3, 6, v0
    v_and_b32 v2, 63, v0
    s_lshr_b32 s5, s2, 3
    s_mul_i32 s98, s5, 24
    v_min_u32 v5, 5, v2
    v_mad_u32_u24 v5, v3, 6, v5
    v_add_u32 v5, s98, v5
    v_lshlrev_b32 v5, 7, v5
    v_min_u32 v5, L_code_end-L_pf1, v5
    global_load_dword a255, v5, s[100:101]
    v_readfirstlane_b32 s3, v3
    v_lshlrev_b32 v1, 4, v2
    s_and_b32 s4, s2, 7
    s_and_b32 s5, s5, 3
    s_lshr_b32 s6, s2, 5
    s_lshl_b32 s7, s4, 2
    s_add_u32 s7, s7, s5
    s_mov_b32 s60, s6
    s_sub_u32 s61, 15, s6
    v_lshrrev_b32 v3, 3, v2
    v_lshrrev_b32 v4, 4, v2
    v_and_b32 v5, 7, v2
    v_xor_b32 v5, v5, v4
    v_lshlrev_b32 v5, 4, v5
    v_lshl_add_u32 v16, v3, 10, v5
    v_xor_b32 v17, 64, v16
    v_add_u32 v17, 7168, v17
    v_add_u32 v18, 14336, v16
    v_add_u32 v19, 14336, v17
    v_bfe_u32 v5, v2, 1, 3
    v_xor_b32 v5, v5, v4
    v_lshlrev_b32 v5, 5, v5
    v_and_b32 v6, 1, v2
    v_lshl_add_u32 v5, v6, 4, v5
    v_lshl_add_u32 v20, v4, 13, v5
    v_add_u32 v21, 31744, v20
    v_xor_b32 v22, 128, v20
    v_add_u32 v22, 63488, v22
    v_add_u32 v23, 31744, v22
    s_lshl_b32 s62, s3, 13
    s_lshl_b32 s63, s3, 12
    s_lshl_b32 s96, s6, 18
    s_lshl_b32 s98, s3, 16
    s_add_u32 s96, s96, s98
    s_lshl_b32 s97, s3, 17
    s_lshl_b32 s99, s5, 0
    s_xor_b32 s99, s99, s6
    s_lshl_b32 s99, s99, 3
    s_and_b32 s99, s99, 7
    s_lshl_b32 s98, s99, 7
    s_add_u32 s96, s96, s98
    s_lshl_b32 s98, s99, 19
    s_add_u32 s97, s97, s98
    v_and_b32 v84, 7, v2
    v_lshrrev_b32 v65, 3, v0
    v_mul_u32_u24 v64, 24576, v65
    v_lshl_add_u32 v64, v84, 4, v64
    v_lshlrev_b32 v65, 3, v65
    v_lshrrev_b32 v85, 3, v2
    v_lshlrev_b32 v86, 10, v84
    v_lshl_add_u32 v86, v85, 4, v86
    s_lshl_b32 s100, s7, 8
    s_waitcnt lgkmcnt(0)
    s_add_u32 s16, s70, s100
    s_addc_u32 s17, s71, 0
    s_sub_u32 s18, 4194304, s100
    s_mov_b32 s19, 0x00020000
    s_mov_b32 s12, s66
    s_mov_b32 s13, s67
    s_mov_b32 s14, 2097152
    s_mov_b32 s15, 0x00020000
    s_add_u32 m0, s63, 98304
    s_xor_b32 s98, s97, 0
    buffer_load_dwordx4 v20, s[16:19], s98 offen offset:0  lds
    buffer_load_dwordx4 v21, s[16:19], s98 offen offset:1024  lds
    buffer_load_dwordx4 v22, s[16:19], s98 offen offset:2048  lds
    buffer_load_dwordx4 v23, s[16:19], s98 offen offset:3072  lds
    s_add_u32 m0, s62, 0
    s_xor_b32 s98, s96, 0
    buffer_load_dwordx4 v16, s[12:15], s98 offen offset:0  lds
    buffer_load_dwordx4 v17, s[12:15], s98 offen offset:1024  lds
    buffer_load_dwordx4 v18, s[12:15], s98 offen offset:2048  lds
    buffer_load_dwordx4 v19, s[12:15], s98 offen offset:3072  lds
    s_add_u32 m0, s62, 4096
    s_xor_b32 s98, s96, 32768
    buffer_load_dwordx4 v16, s[12:15], s98 offen offset:0  lds
    buffer_load_dwordx4 v17, s[12:15], s98 offen offset:1024  lds
    buffer_load_dwordx4 v18, s[12:15], s98 offen offset:2048  lds
    buffer_load_dwordx4 v19, s[12:15], s98 offen offset:3072  lds
    s_mov_b32 s40, s88
    s_mov_b32 s41, s89
    s_mov_b32 s42, 3145728
    s_mov_b32 s43, 0x00020000
    s_mov_b32 s44, s86
    s_mov_b32 s45, s87
    s_mov_b32 s46, 1024
    s_mov_b32 s47, 0x00020000
    s_mov_b32 s32, s64
    s_mov_b32 s33, s65
    s_mov_b32 s34, 2097152
    s_mov_b32 s35, 0x00020000
    s_mov_b32 s8, s94
    s_mov_b32 s9, s95
    s_mov_b32 s10, 268435456
    s_mov_b32 s11, 0x00020000
    s_add_u32 s20, s72, s100
    s_addc_u32 s21, s73, 0
    s_sub_u32 s22, 4194304, s100
    s_mov_b32 s23, 0x00020000
    s_add_u32 s24, s68, s100
    s_addc_u32 s25, s69, 0
    s_sub_u32 s26, 4194304, s100
    s_mov_b32 s27, 0x00020000
    s_mov_b32 s36, s92
    s_mov_b32 s37, s93
    s_mov_b32 s38, 256
    s_mov_b32 s39, 0x00020000
    s_lshl_b32 s100, s4, 19
    s_lshl_b32 s99, s5, 8
    s_add_u32 s100, s100, s99
    s_add_u32 s28, s74, s100
    s_addc_u32 s29, s75, 0
    s_sub_u32 s30, 4194304, s100
    s_mov_b32 s31, 0x00020000
    s_mov_b32 s48, s84
    s_mov_b32 s49, s85
    s_mov_b32 s50, 1835008
    s_mov_b32 s51, 0x00020000
    s_mov_b32 s52, s90
    s_mov_b32 s53, s91
    s_mov_b32 s54, 2097152
    s_mov_b32 s55, 0x00020000
    s_mov_b64 s[92:93], s[80:81]
    s_mov_b64 s[94:95], s[82:83]
    s_mov_b32 s56, s78
    s_mov_b32 s57, s79
    s_mov_b32 s58, 1024
    s_mov_b32 s59, 0x00020000
    s_load_dword s90, s[36:37], 64
    s_load_dword s91, s[8:9], 0x3f00
    s_lshl_b32 s64, s3, 19
    s_and_b32 s100, s97, 3670016
    s_xor_b32 s64, s64, s100
    s_lshr_b32 s100, s6, 1
    s_and_b32 s100, s100, 0
    s_lshl_b32 s1, s100, 12
    s_lshl_b32 s100, s100, 7
    s_add_u32 s64, s64, s100
    s_lshl_b32 s100, s5, 1
    s_xor_b32 s100, s100, s6
    s_and_b32 s100, s100, 0
    s_lshl_b32 s68, s100, 11
    s_lshl_b32 s100, s100, 19
    s_lshl_b32 s0, s3, 17
    s_add_u32 s0, s0, s100
    s_lshl_b32 s81, s7, 20
    s_add_u32 s81, s81, 16777216
    s_lshl_b32 s100, s6, 17
    s_add_u32 s65, s81, s100
    s_lshr_b32 s100, s3, 1
    s_lshl_b32 s100, s100, 16
    s_add_u32 s65, s65, s100
    s_and_b32 s100, s3, 1
    s_lshl_b32 s100, s100, 14
    s_add_u32 s65, s65, s100
    s_add_u32 s81, s81, s62
    s_min_u32 s82, s60, 1
    s_lshl_b32 s82, s82, 16
    s_add_u32 s82, s82, s81
    s_sub_u32 s100, s6, 2
    s_lshl_b32 s69, s100, 7
    s_lshl_b32 s100, s100, 3
    s_add_u32 s100, s100, s4
    s_lshl_b32 s100, s100, 8
    s_mul_i32 s101, s5, 12288
    s_add_u32 s100, s100, s101
    s_add_u32 s100, s100, 16384
    s_cmp_ge_u32 s6, 2
    s_cselect_b32 s66, s100, 2147479552
    s_cselect_b32 s69, s69, 2147479552
    s_cmp_eq_u32 s3, 0
    s_cselect_b32 s66, s66, 2147479552
    s_lshl_b32 s70, s3, 9
    s_add_u32 s70, s70, 16384
    s_lshr_b32 s71, s2, 1
    s_lshl_b32 s71, s71, 14
    s_and_b32 s100, s2, 1
    s_lshl_b32 s100, s100, 7
    s_add_u32 s71, s71, s100
    s_add_u32 s71, s71, s63
    s_add_u32 s71, s71, 2097152
    s_lshl_b32 s72, s2, 2
    s_add_u32 s72, s72, s3
    s_lshl_b32 s72, s72, 6
    s_add_u32 s72, s72, 1048576
    s_lshl_b32 s74, s7, 11
    s_add_u32 s74, s74, 1114112
    s_lshl_b32 s73, s6, 2
    s_add_u32 s73, s73, s3
    s_lshl_b32 s73, s73, 6
    s_add_u32 s73, s73, s74
    s_lshr_b32 s100, s3, 1
    s_sub_u32 s101, 3, s100
    s_and_b32 s98, s3, 1
    s_cselect_b32 s100, s101, s100
    s_lshl_b32 s75, s60, 2
    s_add_u32 s75, s75, s100
    s_lshl_b32 s76, s61, 2
    s_add_u32 s76, s76, s100
    s_sub_u32 s77, s76, s75
    s_lshl_b32 s77, s77, 10
    s_lshl_b32 s78, s75, 10
    s_add_u32 s78, s78, 983040
    s_lshl_b32 s75, s75, 15
    s_add_u32 s75, s75, 2097152
    s_add_u32 s75, s75, s68
    s_lshl_b32 s76, s76, 15
    s_add_u32 s76, s76, 2097152
    s_add_u32 s76, s76, s68
    s_add_u32 s1, s1, s65
    s_cmp_eq_u32 s3, 0
    s_cselect_b32 s68, 32, 0
    s_cselect_b32 s67, 0, 2147479552
    v_and_b32 v48, 15, v2
    v_lshrrev_b32 v49, 4, v2
    v_lshrrev_b32 v50, 1, v48
    v_xor_b32 v50, v50, v49
    v_lshlrev_b32 v50, 4, v50
    v_lshl_add_u32 v28, v48, 7, v50
    v_add_u32 v28, s62, v28
    v_xor_b32 v29, 64, v28
    v_add_u32 v30, 65536, v28
    v_add_u32 v31, 65536, v29
    v_lshrrev_b32 v50, 2, v48
    v_and_b32 v51, 3, v48
    v_lshl_add_u32 v52, v49, 3, v50
    v_lshlrev_b32 v53, 8, v52
    v_lshl_add_u32 v53, v51, 3, v53
    v_add_u32 v53, 98304, v53
    v_and_b32 v54, 1, v49
    v_lshl_add_u32 v54, v54, 2, v50
    v_xor_b32 v55, 0, v54
    v_lshl_add_u32 v8, v55, 5, v53
    v_xor_b32 v55, 1, v54
    v_lshl_add_u32 v9, v55, 5, v53
    v_xor_b32 v55, 2, v54
    v_lshl_add_u32 v10, v55, 5, v53
    v_xor_b32 v55, 3, v54
    v_lshl_add_u32 v11, v55, 5, v53
    v_xor_b32 v55, 4, v54
    v_lshl_add_u32 v12, v55, 5, v53
    v_xor_b32 v55, 5, v54
    v_lshl_add_u32 v13, v55, 5, v53
    v_xor_b32 v55, 6, v54
    v_lshl_add_u32 v14, v55, 5, v53
    v_xor_b32 v55, 7, v54
    v_lshl_add_u32 v15, v55, 5, v53
    v_bfe_u32 v49, v2, 1, 2
    v_bfe_u32 v50, v2, 4, 1
    v_xor_b32 v49, v49, v50
    v_lshlrev_b32 v49, 5, v49
    v_and_b32 v50, 1, v2
    v_lshl_add_u32 v49, v50, 4, v49
    v_lshl_add_u32 v24, v85, 13, v49
    v_xor_b32 v25, 64, v24
    v_add_u32 v25, 64512, v25
    v_add_u32 v26, 129024, v24
    v_add_u32 v27, 129024, v25
    v_cmp_eq_u32 vcc, 0, v2
    v_mov_b32 v6, 2147479552
    s_nop 0
    v_cndmask_b32 v5, v6, v2, vcc
    v_cmp_eq_u32 vcc, 0, v0
    s_nop 1
    v_cndmask_b32 v7, v6, v0, vcc
    v_and_b32 v48, 8, v2
    v_cmp_eq_u32 vcc, 0, v48
    v_lshlrev_b32 v48, 5, v84
    v_lshrrev_b32 v49, 1, v2
    v_and_b32 v49, 24, v49
    v_add_u32 v48, v48, v49
    s_lshl_b32 s100, s3, 8
    s_add_u32 s100, s100, 147456
    v_add_u32 v48, s100, v48
    v_mov_b32 v49, 148480
    v_cndmask_b32 v98, v49, v48, vcc
    v_lshlrev_b32 v99, 5, v84
    v_add_u32 v99, 149504, v99
    s_lshl_b32 s100, s3, 3
    v_add_u32 v100, s100, v99
    v_lshlrev_b32 v106, 5, v85
    v_lshlrev_b32 v107, 8, v85
    v_lshl_add_u32 v107, v84, 4, v107
    s_sub_u32 s100, s2, 64
    s_lshl_b32 s80, s100, 12
    s_add_u32 s80, s80, 1048576
    s_cmp_lt_u32 s100, 64
    s_cselect_b32 s80, s80, 2147479552
    s_mul_i32 s99, s5, 786432
    s_sub_u32 s79, s6, 2
    s_lshl_b32 s79, s79, 3
    s_add_u32 s79, s79, s4
    s_lshl_b32 s79, s79, 7
    s_add_u32 s79, s79, s99
    s_cmp_ge_u32 s6, 2
    s_cselect_b32 s79, s79, 2147414016
    s_lshl_b32 s100, s5, 8
    v_add_u32 v65, s100, v65
    v_mov_b32 v6, 1
    v_and_b32 v4, 1, v2
    v_lshlrev_b32 v4, 7, v4
    buffer_load_dwordx2 v[66:67], v65, s[44:47], 0 offen
    buffer_load_dwordx4 v[68:71], v64, s[40:43], s79 offen
    s_add_u32 s79, s79, 6144
    buffer_load_dwordx4 v[72:75], v64, s[40:43], s79 offen
    s_add_u32 s79, s79, 6144
    buffer_load_dwordx4 v[76:79], v64, s[40:43], s79 offen
    s_add_u32 s79, s79, 6144
    buffer_load_dwordx4 v[80:83], v64, s[40:43], s79 offen
    s_lshl_b32 s79, s2, 5
    s_add_u32 s79, s79, s3
    s_lshl_b32 s79, s79, 8
    buffer_load_dwordx4 v[88:91], v86, s[32:35], s79 offen
    buffer_load_dwordx4 v[92:95], v86, s[32:35], s79 offen offset:128
    s_add_u32 m0, s63, 114688
    s_xor_b32 s98, s97, 524288
    buffer_load_dwordx4 v20, s[16:19], s98 offen offset:0  lds
    buffer_load_dwordx4 v21, s[16:19], s98 offen offset:1024  lds
    buffer_load_dwordx4 v22, s[16:19], s98 offen offset:2048  lds
    buffer_load_dwordx4 v23, s[16:19], s98 offen offset:3072  lds
    s_add_u32 m0, s62, 32768
    s_xor_b32 s98, s96, 128
    buffer_load_dwordx4 v16, s[12:15], s98 offen offset:0  lds
    buffer_load_dwordx4 v17, s[12:15], s98 offen offset:1024  lds
    buffer_load_dwordx4 v18, s[12:15], s98 offen offset:2048  lds
    buffer_load_dwordx4 v19, s[12:15], s98 offen offset:3072  lds
    s_add_u32 m0, s62, 36864
    s_xor_b32 s98, s96, 32896
    buffer_load_dwordx4 v16, s[12:15], s98 offen offset:0  lds
    buffer_load_dwordx4 v17, s[12:15], s98 offen offset:1024  lds
    buffer_load_dwordx4 v18, s[12:15], s98 offen offset:2048  lds
    buffer_load_dwordx4 v19, s[12:15], s98 offen offset:3072  lds
    s_waitcnt vmcnt(19) lgkmcnt(0)
    s_barrier
    ds_read_b64_tr_b16 v[32:33], v8 offset:0
    ds_read_b64_tr_b16 v[34:35], v8 offset:1024
    ds_read_b128 a[0:3], v28 offset:0
    ds_read_b128 a[4:7], v28 offset:2048
    ds_read_b128 a[8:11], v28 offset:4096
    ds_read_b128 a[12:15], v28 offset:6144
    ds_read_b64_tr_b16 v[36:37], v9 offset:0
    ds_read_b64_tr_b16 v[38:39], v9 offset:1024
    ds_read_b64_tr_b16 v[40:41], v10 offset:0
    ds_read_b64_tr_b16 v[42:43], v10 offset:1024
    ds_read_b64_tr_b16 v[44:45], v11 offset:0
    ds_read_b64_tr_b16 v[46:47], v11 offset:1024
    ds_read_b64_tr_b16 v[48:49], v12 offset:0
    ds_read_b64_tr_b16 v[50:51], v12 offset:1024
    ds_read_b64_tr_b16 v[52:53], v13 offset:0
    ds_read_b64_tr_b16 v[54:55], v13 offset:1024
    ds_read_b64_tr_b16 v[56:57], v14 offset:0
    ds_read_b64_tr_b16 v[58:59], v14 offset:1024
    ds_read_b64_tr_b16 v[60:61], v15 offset:0
    ds_read_b64_tr_b16 v[62:63], v15 offset:1024
    s_waitcnt lgkmcnt(15)
    v_mfma_f32_16x16x32_bf16 v[128:131], v[32:35], a[0:3], 0
    v_mfma_f32_16x16x32_bf16 v[160:163], v[32:35], a[4:7], 0
    v_mfma_f32_16x16x32_bf16 v[192:195], v[32:35], a[8:11], 0
    s_waitcnt lgkmcnt(14)
    s_add_u32 m0, s63, 131072
    s_xor_b32 s98, s97, 1048576
    ds_read_b128 a[16:19], v29 offset:0
    v_mfma_f32_16x16x32_bf16 v[224:227], v[32:35], a[12:15], 0
    s_waitcnt lgkmcnt(13)
    ds_read_b128 a[20:23], v29 offset:2048
    v_mfma_f32_16x16x32_bf16 v[132:135], v[36:39], a[0:3], 0
    ds_read_b64_tr_b16 v[32:33], v8 offset:8192
    v_mfma_f32_16x16x32_bf16 v[164:167], v[36:39], a[4:7], 0
    ds_read_b64_tr_b16 v[34:35], v8 offset:9216
    v_mfma_f32_16x16x32_bf16 v[196:199], v[36:39], a[8:11], 0
    ds_read_b128 a[24:27], v29 offset:4096
    v_mfma_f32_16x16x32_bf16 v[228:231], v[36:39], a[12:15], 0
    s_waitcnt lgkmcnt(15)
    ds_read_b128 a[28:31], v29 offset:6144
    v_mfma_f32_16x16x32_bf16 v[136:139], v[40:43], a[0:3], 0
    ds_read_b64_tr_b16 v[36:37], v9 offset:8192
    v_mfma_f32_16x16x32_bf16 v[168:171], v[40:43], a[4:7], 0
    s_waitcnt lgkmcnt(7)
    ds_read_b64_tr_b16 v[38:39], v9 offset:9216
    v_mfma_f32_16x16x32_bf16 v[200:203], v[40:43], a[8:11], 0
    buffer_load_dwordx4 v20, s[16:19], s98 offen offset:0  lds
    v_mfma_f32_16x16x32_bf16 v[232:235], v[40:43], a[12:15], 0
    buffer_load_dwordx4 v21, s[16:19], s98 offen offset:1024  lds
    v_mfma_f32_16x16x32_bf16 v[140:143], v[44:47], a[0:3], 0
    ds_read_b64_tr_b16 v[40:41], v10 offset:8192
    v_mfma_f32_16x16x32_bf16 v[172:175], v[44:47], a[4:7], 0
    ds_read_b64_tr_b16 v[42:43], v10 offset:9216
    v_mfma_f32_16x16x32_bf16 v[204:207], v[44:47], a[8:11], 0
    buffer_load_dwordx4 v22, s[16:19], s98 offen offset:2048  lds
    v_mfma_f32_16x16x32_bf16 v[236:239], v[44:47], a[12:15], 0
    buffer_load_dwordx4 v23, s[16:19], s98 offen offset:3072  lds
    v_mfma_f32_16x16x32_bf16 v[144:147], v[48:51], a[0:3], 0
    s_add_u32 m0, s62, 65536
    s_xor_b32 s98, s96, 256
    ds_read_b64_tr_b16 v[44:45], v11 offset:8192
    v_mfma_f32_16x16x32_bf16 v[176:179], v[48:51], a[4:7], 0
    ds_read_b64_tr_b16 v[46:47], v11 offset:9216
    v_mfma_f32_16x16x32_bf16 v[208:211], v[48:51], a[8:11], 0
    buffer_load_dwordx4 v16, s[12:15], s98 offen offset:0  lds
    v_mfma_f32_16x16x32_bf16 v[240:243], v[48:51], a[12:15], 0
    buffer_load_dwordx4 v17, s[12:15], s98 offen offset:1024  lds
    v_mfma_f32_16x16x32_bf16 v[148:151], v[52:55], a[0:3], 0
    ds_read_b64_tr_b16 v[48:49], v12 offset:8192
    v_mfma_f32_16x16x32_bf16 v[180:183], v[52:55], a[4:7], 0
    ds_read_b64_tr_b16 v[50:51], v12 offset:9216
    v_mfma_f32_16x16x32_bf16 v[212:215], v[52:55], a[8:11], 0
    buffer_load_dwordx4 v18, s[12:15], s98 offen offset:2048  lds
    v_mfma_f32_16x16x32_bf16 v[244:247], v[52:55], a[12:15], 0
    buffer_load_dwordx4 v19, s[12:15], s98 offen offset:3072  lds
    v_mfma_f32_16x16x32_bf16 v[152:155], v[56:59], a[0:3], 0
    s_add_u32 m0, s62, 69632
    s_xor_b32 s98, s96, 33024
    ds_read_b64_tr_b16 v[52:53], v13 offset:8192
    v_mfma_f32_16x16x32_bf16 v[184:187], v[56:59], a[4:7], 0
    ds_read_b64_tr_b16 v[54:55], v13 offset:9216
    v_mfma_f32_16x16x32_bf16 v[216:219], v[56:59], a[8:11], 0
    buffer_load_dwordx4 v16, s[12:15], s98 offen offset:0  lds
    v_mfma_f32_16x16x32_bf16 v[248:251], v[56:59], a[12:15], 0
    buffer_load_dwordx4 v17, s[12:15], s98 offen offset:1024  lds
    v_mfma_f32_16x16x32_bf16 v[156:159], v[60:63], a[0:3], 0
    ds_read_b64_tr_b16 v[56:57], v14 offset:8192
    v_mfma_f32_16x16x32_bf16 v[188:191], v[60:63], a[4:7], 0
    s_waitcnt lgkmcnt(5)
    ds_read_b64_tr_b16 v[58:59], v14 offset:9216
    v_mfma_f32_16x16x32_bf16 v[220:223], v[60:63], a[8:11], 0
    buffer_load_dwordx4 v18, s[12:15], s98 offen offset:2048  lds
    v_mfma_f32_16x16x32_bf16 v[252:255], v[60:63], a[12:15], 0
    buffer_load_dwordx4 v19, s[12:15], s98 offen offset:3072  lds
    v_mfma_f32_16x16x32_bf16 v[128:131], v[32:35], a[16:19], v[128:131]
    ds_read_b64_tr_b16 v[60:61], v15 offset:8192
    v_mfma_f32_16x16x32_bf16 v[160:163], v[32:35], a[20:23], v[160:163]
    ds_read_b64_tr_b16 v[62:63], v15 offset:9216
    v_mfma_f32_16x16x32_bf16 v[192:195], v[32:35], a[24:27], v[192:195]
    v_mfma_f32_16x16x32_bf16 v[224:227], v[32:35], a[28:31], v[224:227]
    v_mfma_f32_16x16x32_bf16 v[132:135], v[36:39], a[16:19], v[132:135]
    v_mfma_f32_16x16x32_bf16 v[164:167], v[36:39], a[20:23], v[164:167]
    v_mfma_f32_16x16x32_bf16 v[196:199], v[36:39], a[24:27], v[196:199]
    v_mfma_f32_16x16x32_bf16 v[228:231], v[36:39], a[28:31], v[228:231]
    v_mfma_f32_16x16x32_bf16 v[136:139], v[40:43], a[16:19], v[136:139]
    s_waitcnt vmcnt(12) lgkmcnt(0)
    s_barrier
    v_mfma_f32_16x16x32_bf16 v[168:171], v[40:43], a[20:23], v[168:171]
    s_add_u32 m0, s63, 98304
    s_xor_b32 s98, s97, 1572864
    ds_read_b64_tr_b16 v[32:33], v8 offset:16384
    v_lshlrev_b32 v102, 16, v66
    v_and_b32 v103, 0xffff0000, v66
    v_lshlrev_b32 v104, 16, v67
    v_mfma_f32_16x16x32_bf16 v[200:203], v[40:43], a[24:27], v[200:203]
    ds_read_b64_tr_b16 v[34:35], v8 offset:17408
    v_and_b32 v105, 0xffff0000, v67
    v_mul_f32 v108, 0xbfb8aa3b, v102
    v_mul_f32 v109, 0xbfb8aa3b, v103
    v_mfma_f32_16x16x32_bf16 v[232:235], v[40:43], a[28:31], v[232:235]
    ds_read_b64_tr_b16 v[36:37], v9 offset:16384
    v_mul_f32 v110, 0xbfb8aa3b, v104
    v_mul_f32 v111, 0xbfb8aa3b, v105
    v_mfma_f32_16x16x32_bf16 v[140:143], v[44:47], a[16:19], v[140:143]
    ds_read_b64_tr_b16 v[38:39], v9 offset:17408
    v_exp_f32 v108, v108
    v_mfma_f32_16x16x32_bf16 v[172:175], v[44:47], a[20:23], v[172:175]
    ds_read_b64_tr_b16 v[40:41], v10 offset:16384
    v_exp_f32 v109, v109
    v_mfma_f32_16x16x32_bf16 v[204:207], v[44:47], a[24:27], v[204:207]
    ds_read_b64_tr_b16 v[42:43], v10 offset:17408
    v_exp_f32 v110, v110
    v_mfma_f32_16x16x32_bf16 v[236:239], v[44:47], a[28:31], v[236:239]
    ds_read_b128 a[32:35], v28 offset:32768
    v_exp_f32 v111, v111
    v_add_f32 v108, 1.0, v108
    v_mfma_f32_16x16x32_bf16 v[144:147], v[48:51], a[16:19], v[144:147]
    ds_read_b64_tr_b16 v[44:45], v11 offset:16384
    v_add_f32 v109, 1.0, v109
    v_add_f32 v110, 1.0, v110
    v_add_f32 v111, 1.0, v111
    v_mfma_f32_16x16x32_bf16 v[176:179], v[48:51], a[20:23], v[176:179]
    ds_read_b64_tr_b16 v[46:47], v11 offset:17408
    v_rcp_f32 v108, v108
    v_mfma_f32_16x16x32_bf16 v[208:211], v[48:51], a[24:27], v[208:211]
    ds_read_b128 a[36:39], v28 offset:34816
    v_mov_b32 v112, 0
    v_rcp_f32 v109, v109
    v_mfma_f32_16x16x32_bf16 v[240:243], v[48:51], a[28:31], v[240:243]
    ds_read_b128 a[40:43], v28 offset:36864
    v_mov_b32 v113, 0
    v_rcp_f32 v110, v110
    v_mfma_f32_16x16x32_bf16 v[148:151], v[52:55], a[16:19], v[148:151]
    ds_read_b64_tr_b16 v[48:49], v12 offset:16384
    v_mov_b32 v114, 0
    v_rcp_f32 v111, v111
    v_mfma_f32_16x16x32_bf16 v[180:183], v[52:55], a[20:23], v[180:183]
    ds_read_b64_tr_b16 v[50:51], v12 offset:17408
    v_mov_b32 v115, 0
    v_mul_f32 v102, v102, v108
    v_mul_f32 v103, v103, v109
    v_mfma_f32_16x16x32_bf16 v[212:215], v[52:55], a[24:27], v[212:215]
    ds_read_b128 a[44:47], v28 offset:38912
    v_lshlrev_b32 v116, 4, v0
    v_mul_f32 v104, v104, v110
    v_mul_f32 v105, v105, v111
    v_mfma_f32_16x16x32_bf16 v[244:247], v[52:55], a[28:31], v[244:247]
    buffer_load_dwordx4 v20, s[16:19], s98 offen offset:0  lds
    v_cvt_pk_bf16_f32 v108, v102, v103
    v_cvt_pk_bf16_f32 v109, v104, v105
    v_mfma_f32_16x16x32_bf16 v[152:155], v[56:59], a[16:19], v[152:155]
    ds_read_b64_tr_b16 v[52:53], v13 offset:16384
    v_lshlrev_b32 v102, 16, v108
    v_and_b32 v103, 0xffff0000, v108
    v_lshlrev_b32 v104, 16, v109
    v_mfma_f32_16x16x32_bf16 v[184:187], v[56:59], a[20:23], v[184:187]
    ds_read_b64_tr_b16 v[54:55], v13 offset:17408
    v_and_b32 v105, 0xffff0000, v109
    v_lshlrev_b32 v108, 16, v68
    v_and_b32 v109, 0xffff0000, v68
    v_mfma_f32_16x16x32_bf16 v[216:219], v[56:59], a[24:27], v[216:219]
    buffer_load_dwordx4 v21, s[16:19], s98 offen offset:1024  lds
    v_mul_f32 v120, v108, v102
    v_mul_f32 v121, v109, v102
    v_mfma_f32_16x16x32_bf16 v[248:251], v[56:59], a[28:31], v[248:251]
    buffer_store_dwordx4 v[112:115], v116, s[8:11], s80 offen sc0 sc1
    v_lshlrev_b32 v110, 16, v69
    v_and_b32 v111, 0xffff0000, v69
    v_mfma_f32_16x16x32_bf16 v[156:159], v[60:63], a[16:19], v[156:159]
    ds_read_b64_tr_b16 v[56:57], v14 offset:16384
    v_lshlrev_b32 v117, 13, v2
    v_mul_f32 v122, v110, v102
    v_mul_f32 v123, v111, v102
    v_mfma_f32_16x16x32_bf16 v[188:191], v[60:63], a[20:23], v[188:191]
    s_lshl_b32 s100, s6, 19
    s_and_b32 s101, s3, 1
    ds_read_b64_tr_b16 v[58:59], v14 offset:17408
    v_lshlrev_b32 v108, 16, v70
    v_and_b32 v109, 0xffff0000, v70
    v_mul_f32 v124, v108, v102
    v_mfma_f32_16x16x32_bf16 v[220:223], v[60:63], a[24:27], v[220:223]
    buffer_load_dwordx4 v22, s[16:19], s98 offen offset:2048  lds
    v_mul_f32 v125, v109, v102
    v_lshlrev_b32 v110, 16, v71
    v_mfma_f32_16x16x32_bf16 v[252:255], v[60:63], a[28:31], v[252:255]
    s_waitcnt lgkmcnt(5)
    s_lshl_b32 s101, s101, 7
    s_add_u32 s100, s100, s101
    v_min_u32 v116, 496, v116
    v_and_b32 v111, 0xffff0000, v71
    v_mul_f32 v126, v110, v102
    v_mul_f32 v127, v111, v102
    v_mfma_f32_16x16x32_bf16 v[128:131], v[32:35], a[32:35], v[128:131]
    s_sub_u32 s80, s80, 1048576
    s_lshr_b32 s80, s80, 3
    ds_read_b64_tr_b16 v[60:61], v15 offset:16384
    v_lshlrev_b32 v108, 16, v72
    v_and_b32 v109, 0xffff0000, v72
    v_fmac_f32 v120, v108, v103
    v_mfma_f32_16x16x32_bf16 v[160:163], v[32:35], a[36:39], v[160:163]
    s_add_u32 s80, s80, 1310720
    s_cmp_lt_u32 s80, 1343488
    s_cselect_b32 s80, s80, 2147479552
    ds_read_b64_tr_b16 v[62:63], v15 offset:17408
    v_fmac_f32 v121, v109, v103
    v_lshlrev_b32 v110, 16, v73
    v_and_b32 v111, 0xffff0000, v73
    v_mfma_f32_16x16x32_bf16 v[192:195], v[32:35], a[40:43], v[192:195]
    s_waitcnt lgkmcnt(5)
    ds_read_b128 a[48:51], v29 offset:32768
    v_fmac_f32 v122, v110, v103
    v_fmac_f32 v123, v111, v103
    v_lshlrev_b32 v108, 16, v74
    v_mfma_f32_16x16x32_bf16 v[224:227], v[32:35], a[44:47], v[224:227]
    ds_read_b128 a[52:55], v29 offset:34816
    v_and_b32 v109, 0xffff0000, v74
    v_fmac_f32 v124, v108, v103
    v_fmac_f32 v125, v109, v103
    v_mfma_f32_16x16x32_bf16 v[132:135], v[36:39], a[32:35], v[132:135]
    ds_read_b64_tr_b16 v[32:33], v8 offset:24576
    v_lshlrev_b32 v110, 16, v75
    v_and_b32 v111, 0xffff0000, v75
    v_fmac_f32 v126, v110, v103
    v_mfma_f32_16x16x32_bf16 v[164:167], v[36:39], a[36:39], v[164:167]
    ds_read_b64_tr_b16 v[34:35], v8 offset:25600
    v_fmac_f32 v127, v111, v103
    v_lshlrev_b32 v108, 16, v76
    v_and_b32 v109, 0xffff0000, v76
    v_mfma_f32_16x16x32_bf16 v[196:199], v[36:39], a[40:43], v[196:199]
    ds_read_b128 a[56:59], v29 offset:36864
    v_fmac_f32 v120, v108, v104
    v_fmac_f32 v121, v109, v104
    v_lshlrev_b32 v110, 16, v77
    v_mfma_f32_16x16x32_bf16 v[228:231], v[36:39], a[44:47], v[228:231]
    ds_read_b128 a[60:63], v29 offset:38912
    v_and_b32 v111, 0xffff0000, v77
    v_fmac_f32 v122, v110, v104
    v_fmac_f32 v123, v111, v104
    v_mfma_f32_16x16x32_bf16 v[136:139], v[40:43], a[32:35], v[136:139]
    ds_read_b64_tr_b16 v[36:37], v9 offset:24576
    v_lshlrev_b32 v108, 16, v78
    v_and_b32 v109, 0xffff0000, v78
    v_fmac_f32 v124, v108, v104
    v_mfma_f32_16x16x32_bf16 v[168:171], v[40:43], a[36:39], v[168:171]
    ds_read_b64_tr_b16 v[38:39], v9 offset:25600
    v_fmac_f32 v125, v109, v104
    v_lshlrev_b32 v110, 16, v79
    v_and_b32 v111, 0xffff0000, v79
    v_mfma_f32_16x16x32_bf16 v[200:203], v[40:43], a[40:43], v[200:203]
    buffer_load_dwordx4 v23, s[16:19], s98 offen offset:3072  lds
    v_fmac_f32 v126, v110, v104
    v_fmac_f32 v127, v111, v104
    v_mfma_f32_16x16x32_bf16 v[232:235], v[40:43], a[44:47], v[232:235]
    buffer_store_dwordx4 v[112:115], v116, s[8:11], s80 offen sc0 sc1
    v_lshlrev_b32 v108, 16, v80
    v_and_b32 v109, 0xffff0000, v80
    v_mfma_f32_16x16x32_bf16 v[140:143], v[44:47], a[32:35], v[140:143]
    s_add_u32 m0, s62, 0
    s_xor_b32 s98, s96, 384
    ds_read_b64_tr_b16 v[40:41], v10 offset:24576
    v_fmac_f32 v120, v108, v105
    v_fmac_f32 v121, v109, v105
    v_lshlrev_b32 v110, 16, v81
    v_mfma_f32_16x16x32_bf16 v[172:175], v[44:47], a[36:39], v[172:175]
    ds_read_b64_tr_b16 v[42:43], v10 offset:25600
    v_and_b32 v111, 0xffff0000, v81
    v_fmac_f32 v122, v110, v105
    v_fmac_f32 v123, v111, v105
    v_mfma_f32_16x16x32_bf16 v[204:207], v[44:47], a[40:43], v[204:207]
    buffer_load_dwordx4 v16, s[12:15], s98 offen offset:0  lds
    v_lshlrev_b32 v108, 16, v82
    v_and_b32 v109, 0xffff0000, v82
    v_mfma_f32_16x16x32_bf16 v[236:239], v[44:47], a[44:47], v[236:239]
    v_fmac_f32 v124, v108, v105
    v_fmac_f32 v125, v109, v105
    v_lshlrev_b32 v110, 16, v83
    v_and_b32 v111, 0xffff0000, v83
    v_mfma_f32_16x16x32_bf16 v[144:147], v[48:51], a[32:35], v[144:147]
    ds_read_b64_tr_b16 v[44:45], v11 offset:24576
    v_fmac_f32 v126, v110, v105
    v_fmac_f32 v127, v111, v105
    v_permlane32_swap_b32 v120, v124
    v_mfma_f32_16x16x32_bf16 v[176:179], v[48:51], a[36:39], v[176:179]
    ds_read_b64_tr_b16 v[46:47], v11 offset:25600
    v_permlane32_swap_b32 v121, v125
    v_permlane32_swap_b32 v122, v126
    v_permlane32_swap_b32 v123, v127
    v_mfma_f32_16x16x32_bf16 v[208:211], v[48:51], a[40:43], v[208:211]
    buffer_load_dwordx4 v17, s[12:15], s98 offen offset:1024  lds
    v_add_f32 v120, v120, v124
    v_add_f32 v121, v121, v125
    v_mfma_f32_16x16x32_bf16 v[240:243], v[48:51], a[44:47], v[240:243]
    s_waitcnt lgkmcnt(4)
    v_add_f32 v122, v122, v126
    v_add_f32 v123, v123, v127
    s_nop 0
    v_permlane16_swap_b32 v120, v122
    v_permlane16_swap_b32 v121, v123
    v_mfma_f32_16x16x32_bf16 v[148:151], v[52:55], a[32:35], v[148:151]
    ds_read_b64_tr_b16 v[48:49], v12 offset:24576
    v_add_f32 v120, v120, v122
    v_add_f32 v121, v121, v123
    s_nop 0
    v_add_f32_dpp v120, v120, v120 row_ror:8 row_mask:0xf bank_mask:0xf
    v_mfma_f32_16x16x32_bf16 v[180:183], v[52:55], a[36:39], v[180:183]
    ds_read_b64_tr_b16 v[50:51], v12 offset:25600
    v_add_f32_dpp v121, v121, v121 row_ror:8 row_mask:0xf bank_mask:0xf
    v_mfma_f32_16x16x32_bf16 v[212:215], v[52:55], a[40:43], v[212:215]
    buffer_load_dwordx4 v18, s[12:15], s98 offen offset:2048  lds
    ds_write_b64 v98, v[120:121]
    v_mfma_f32_16x16x32_bf16 v[244:247], v[52:55], a[44:47], v[244:247]
    v_mfma_f32_16x16x32_bf16 v[152:155], v[56:59], a[32:35], v[152:155]
    ds_read_b64_tr_b16 v[52:53], v13 offset:24576
    v_lshlrev_b32 v64, 16, v88
    v_mfma_f32_16x16x32_bf16 v[184:187], v[56:59], a[36:39], v[184:187]
    ds_read_b64_tr_b16 v[54:55], v13 offset:25600
    v_and_b32 v65, 0xffff0000, v88
    v_mfma_f32_16x16x32_bf16 v[216:219], v[56:59], a[40:43], v[216:219]
    buffer_load_dwordx4 v19, s[12:15], s98 offen offset:3072  lds
    v_mfma_f32_16x16x32_bf16 v[248:251], v[56:59], a[44:47], v[248:251]
    v_lshlrev_b32 v66, 16, v89
    v_and_b32 v67, 0xffff0000, v89
    v_mfma_f32_16x16x32_bf16 v[156:159], v[60:63], a[32:35], v[156:159]
    s_add_u32 m0, s62, 4096
    s_xor_b32 s98, s96, 33152
    ds_read_b64_tr_b16 v[56:57], v14 offset:24576
    v_mfma_f32_16x16x32_bf16 v[188:191], v[60:63], a[36:39], v[188:191]
    ds_read_b64_tr_b16 v[58:59], v14 offset:25600
    v_lshlrev_b32 v68, 16, v90
    v_mfma_f32_16x16x32_bf16 v[220:223], v[60:63], a[40:43], v[220:223]
    buffer_load_dwordx4 v16, s[12:15], s98 offen offset:0  lds
    v_mfma_f32_16x16x32_bf16 v[252:255], v[60:63], a[44:47], v[252:255]
    v_and_b32 v69, 0xffff0000, v90
    v_lshlrev_b32 v70, 16, v91
    v_mfma_f32_16x16x32_bf16 v[128:131], v[32:35], a[48:51], v[128:131]
    ds_read_b64_tr_b16 v[60:61], v15 offset:24576
    v_and_b32 v71, 0xffff0000, v91
    v_mfma_f32_16x16x32_bf16 v[160:163], v[32:35], a[52:55], v[160:163]
    ds_read_b64_tr_b16 v[62:63], v15 offset:25600
    v_lshlrev_b32 v72, 16, v92
    v_mfma_f32_16x16x32_bf16 v[192:195], v[32:35], a[56:59], v[192:195]
    buffer_load_dwordx4 v17, s[12:15], s98 offen offset:1024  lds
    v_mfma_f32_16x16x32_bf16 v[224:227], v[32:35], a[60:63], v[224:227]
    v_and_b32 v73, 0xffff0000, v92
    v_lshlrev_b32 v74, 16, v93
    v_mfma_f32_16x16x32_bf16 v[132:135], v[36:39], a[48:51], v[132:135]
    buffer_load_dwordx4 v18, s[12:15], s98 offen offset:2048  lds
    v_mfma_f32_16x16x32_bf16 v[164:167], v[36:39], a[52:55], v[164:167]
    v_and_b32 v75, 0xffff0000, v93
    v_lshlrev_b32 v76, 16, v94
    v_mfma_f32_16x16x32_bf16 v[196:199], v[36:39], a[56:59], v[196:199]
    buffer_load_dwordx4 v19, s[12:15], s98 offen offset:3072  lds
    s_cmp_eq_u32 s3, 0
    s_cselect_b32 s101, s100, 2147479552
    buffer_load_dword a241, v117, s[20:23], s101 offen offset:4
    v_mfma_f32_16x16x32_bf16 v[228:231], v[36:39], a[60:63], v[228:231]
    s_waitcnt lgkmcnt(2)
    v_and_b32 v77, 0xffff0000, v94
    v_lshlrev_b32 v78, 16, v95
    s_waitcnt vmcnt(9)
    v_mfma_f32_16x16x32_bf16 v[136:139], v[40:43], a[48:51], v[136:139]
    v_and_b32 v79, 0xffff0000, v95
    v_add_f32 v108, v64, v65
    s_waitcnt lgkmcnt(0)
    s_barrier
    v_mfma_f32_16x16x32_bf16 v[168:171], v[40:43], a[52:55], v[168:171]
    s_add_u32 m0, s63, 114688
    s_xor_b32 s98, s97, 2097152
    ds_read_b64_tr_b16 v[32:33], v8 offset:32768
    v_lshrrev_b32 v87, 2, v1
    v_add_u32 v101, 147456, v87
    v_mfma_f32_16x16x32_bf16 v[200:203], v[40:43], a[56:59], v[200:203]
    ds_read_b64_tr_b16 v[34:35], v8 offset:33792
    ds_read_b32 v102, v101
    v_mfma_f32_16x16x32_bf16 v[232:235], v[40:43], a[60:63], v[232:235]
    ds_read_b64_tr_b16 v[36:37], v9 offset:32768
    ds_read_b32 v103, v101 offset:256
    v_mfma_f32_16x16x32_bf16 v[140:143], v[44:47], a[48:51], v[140:143]
    ds_read_b64_tr_b16 v[38:39], v9 offset:33792
    ds_read_b32 v104, v101 offset:512
    v_mfma_f32_16x16x32_bf16 v[172:175], v[44:47], a[52:55], v[172:175]
    ds_read_b64_tr_b16 v[40:41], v10 offset:32768
    ds_read_b32 v105, v101 offset:768
    v_mfma_f32_16x16x32_bf16 v[204:207], v[44:47], a[56:59], v[204:207]
    ds_read_b64_tr_b16 v[42:43], v10 offset:33792
    v_add_f32 v109, v66, v67
    v_mfma_f32_16x16x32_bf16 v[236:239], v[44:47], a[60:63], v[236:239]
    ds_read_b128 a[64:67], v30 offset:0
    v_add_f32 v108, v108, v68
    v_mfma_f32_16x16x32_bf16 v[144:147], v[48:51], a[48:51], v[144:147]
    ds_read_b64_tr_b16 v[44:45], v11 offset:32768
    v_add_f32 v109, v109, v69
    v_mfma_f32_16x16x32_bf16 v[176:179], v[48:51], a[52:55], v[176:179]
    ds_read_b64_tr_b16 v[46:47], v11 offset:33792
    v_add_f32 v108, v108, v70
    v_mfma_f32_16x16x32_bf16 v[208:211], v[48:51], a[56:59], v[208:211]
    ds_read_b128 a[68:71], v30 offset:2048
    v_add_f32 v109, v109, v71
    v_mfma_f32_16x16x32_bf16 v[240:243], v[48:51], a[60:63], v[240:243]
    ds_read_b128 a[72:75], v30 offset:4096
    s_waitcnt lgkmcnt(10)
    v_add_f32 v102, v102, v103
    v_mfma_f32_16x16x32_bf16 v[148:151], v[52:55], a[48:51], v[148:151]
    ds_read_b64_tr_b16 v[48:49], v12 offset:32768
    s_waitcnt lgkmcnt(7)
    v_add_f32 v104, v104, v105
    v_mfma_f32_16x16x32_bf16 v[180:183], v[52:55], a[52:55], v[180:183]
    ds_read_b64_tr_b16 v[50:51], v12 offset:33792
    v_add_f32 v102, v102, v104
    buffer_store_dword v102, v87, s[8:11], s66 offen sc0 sc1
    v_mfma_f32_16x16x32_bf16 v[212:215], v[52:55], a[56:59], v[212:215]
    ds_read_b128 a[76:79], v30 offset:6144
    v_add_f32 v108, v108, v72
    v_mfma_f32_16x16x32_bf16 v[244:247], v[52:55], a[60:63], v[244:247]
    buffer_load_dwordx4 v20, s[16:19], s98 offen offset:0  lds
    v_mfma_f32_16x16x32_bf16 v[152:155], v[56:59], a[48:51], v[152:155]
    s_mov_b32 s40, s92
    s_mov_b32 s41, s93
    ds_read_b64_tr_b16 v[52:53], v13 offset:32768
    v_mfma_f32_16x16x32_bf16 v[184:187], v[56:59], a[52:55], v[184:187]
    s_mov_b32 s42, 1835008
    s_mov_b32 s44, s94
    ds_read_b64_tr_b16 v[54:55], v13 offset:33792
    v_mfma_f32_16x16x32_bf16 v[216:219], v[56:59], a[56:59], v[216:219]
    s_mov_b32 s45, s95
    s_mov_b32 s46, 1835008
    v_add_f32 v109, v109, v73
    v_mfma_f32_16x16x32_bf16 v[248:251], v[56:59], a[60:63], v[248:251]
    buffer_load_dwordx4 v21, s[16:19], s98 offen offset:1024  lds
    v_mfma_f32_16x16x32_bf16 v[156:159], v[60:63], a[48:51], v[156:159]
    ds_read_b64_tr_b16 v[56:57], v14 offset:32768
    v_add_f32 v108, v108, v74
    v_mfma_f32_16x16x32_bf16 v[188:191], v[60:63], a[52:55], v[188:191]
    ds_read_b64_tr_b16 v[58:59], v14 offset:33792
    v_add_f32 v109, v109, v75
    v_mfma_f32_16x16x32_bf16 v[220:223], v[60:63], a[56:59], v[220:223]
    buffer_load_dwordx4 v22, s[16:19], s98 offen offset:2048  lds
    v_mfma_f32_16x16x32_bf16 v[252:255], v[60:63], a[60:63], v[252:255]
    s_waitcnt lgkmcnt(5)
    v_add_f32 v108, v108, v76
    v_add_f32 v109, v109, v77
    v_mfma_f32_16x16x32_bf16 v[128:131], v[32:35], a[64:67], v[128:131]
    ds_read_b64_tr_b16 v[60:61], v15 offset:32768
    v_add_f32 v108, v108, v78
    v_mfma_f32_16x16x32_bf16 v[160:163], v[32:35], a[68:71], v[160:163]
    ds_read_b64_tr_b16 v[62:63], v15 offset:33792
    v_add_f32 v109, v109, v79
    v_mfma_f32_16x16x32_bf16 v[192:195], v[32:35], a[72:75], v[192:195]
    s_waitcnt lgkmcnt(5)
    ds_read_b128 a[80:83], v31 offset:0
    v_add_f32 v108, v108, v109
    v_mfma_f32_16x16x32_bf16 v[224:227], v[32:35], a[76:79], v[224:227]
    ds_read_b128 a[84:87], v31 offset:2048
    v_add_f32_dpp v108, v108, v108 row_ror:8 row_mask:0xf bank_mask:0xf
    v_mfma_f32_16x16x32_bf16 v[132:135], v[36:39], a[64:67], v[132:135]
    ds_read_b64_tr_b16 v[32:33], v8 offset:40960
    v_mov_b32 v110, v108
    v_mfma_f32_16x16x32_bf16 v[164:167], v[36:39], a[68:71], v[164:167]
    ds_read_b64_tr_b16 v[34:35], v8 offset:41984
    v_permlane16_swap_b32 v108, v110
    v_mfma_f32_16x16x32_bf16 v[196:199], v[36:39], a[72:75], v[196:199]
    ds_read_b128 a[88:91], v31 offset:4096
    v_add_f32 v108, v108, v110
    v_mfma_f32_16x16x32_bf16 v[228:231], v[36:39], a[76:79], v[228:231]
    ds_read_b128 a[92:95], v31 offset:6144
    v_mov_b32 v110, v108
    v_mfma_f32_16x16x32_bf16 v[136:139], v[40:43], a[64:67], v[136:139]
    ds_read_b64_tr_b16 v[36:37], v9 offset:40960
    v_permlane32_swap_b32 v108, v110
    v_mfma_f32_16x16x32_bf16 v[168:171], v[40:43], a[68:71], v[168:171]
    ds_read_b64_tr_b16 v[38:39], v9 offset:41984
    v_add_f32 v108, v108, v110
    v_mfma_f32_16x16x32_bf16 v[200:203], v[40:43], a[72:75], v[200:203]
    buffer_load_dwordx4 v23, s[16:19], s98 offen offset:3072  lds
    v_mfma_f32_16x16x32_bf16 v[232:235], v[40:43], a[76:79], v[232:235]
    v_mul_f32 v108, 0x3c000000, v108
    v_sub_f32 v110, v64, v108
    v_mfma_f32_16x16x32_bf16 v[140:143], v[44:47], a[64:67], v[140:143]
    s_add_u32 m0, s62, 32768
    s_xor_b32 s98, s96, 512
    ds_read_b64_tr_b16 v[40:41], v10 offset:40960
    v_mfma_f32_16x16x32_bf16 v[172:175], v[44:47], a[68:71], v[172:175]
    ds_read_b64_tr_b16 v[42:43], v10 offset:41984
    v_mul_f32 v109, v110, v110
    v_mfma_f32_16x16x32_bf16 v[204:207], v[44:47], a[72:75], v[204:207]
    buffer_load_dwordx4 v16, s[12:15], s98 offen offset:0  lds
    v_mfma_f32_16x16x32_bf16 v[236:239], v[44:47], a[76:79], v[236:239]
    v_sub_f32 v111, v65, v108
    v_fmac_f32 v109, v111, v111
    v_mfma_f32_16x16x32_bf16 v[144:147], v[48:51], a[64:67], v[144:147]
    ds_read_b64_tr_b16 v[44:45], v11 offset:40960
    v_sub_f32 v110, v66, v108
    v_mfma_f32_16x16x32_bf16 v[176:179], v[48:51], a[68:71], v[176:179]
    ds_read_b64_tr_b16 v[46:47], v11 offset:41984
    v_fmac_f32 v109, v110, v110
    v_mfma_f32_16x16x32_bf16 v[208:211], v[48:51], a[72:75], v[208:211]
    buffer_load_dwordx4 v17, s[12:15], s98 offen offset:1024  lds
    v_mfma_f32_16x16x32_bf16 v[240:243], v[48:51], a[76:79], v[240:243]
    s_waitcnt lgkmcnt(4)
    v_sub_f32 v111, v67, v108
    v_fmac_f32 v109, v111, v111
    v_mfma_f32_16x16x32_bf16 v[148:151], v[52:55], a[64:67], v[148:151]
    ds_read_b64_tr_b16 v[48:49], v12 offset:40960
    v_sub_f32 v110, v68, v108
    v_mfma_f32_16x16x32_bf16 v[180:183], v[52:55], a[68:71], v[180:183]
    ds_read_b64_tr_b16 v[50:51], v12 offset:41984
    v_fmac_f32 v109, v110, v110
    v_mfma_f32_16x16x32_bf16 v[212:215], v[52:55], a[72:75], v[212:215]
    buffer_load_dwordx4 v18, s[12:15], s98 offen offset:2048  lds
    v_mfma_f32_16x16x32_bf16 v[244:247], v[52:55], a[76:79], v[244:247]
    v_sub_f32 v111, v69, v108
    v_fmac_f32 v109, v111, v111
    v_mfma_f32_16x16x32_bf16 v[152:155], v[56:59], a[64:67], v[152:155]
    ds_read_b64_tr_b16 v[52:53], v13 offset:40960
    v_sub_f32 v110, v70, v108
    v_mfma_f32_16x16x32_bf16 v[184:187], v[56:59], a[68:71], v[184:187]
    ds_read_b64_tr_b16 v[54:55], v13 offset:41984
    v_fmac_f32 v109, v110, v110
    v_mfma_f32_16x16x32_bf16 v[216:219], v[56:59], a[72:75], v[216:219]
    buffer_load_dwordx4 v19, s[12:15], s98 offen offset:3072  lds
    v_mfma_f32_16x16x32_bf16 v[248:251], v[56:59], a[76:79], v[248:251]
    v_sub_f32 v111, v71, v108
    v_fmac_f32 v109, v111, v111
    v_mfma_f32_16x16x32_bf16 v[156:159], v[60:63], a[64:67], v[156:159]
    s_add_u32 m0, s62, 36864
    s_xor_b32 s98, s96, 33280
    ds_read_b64_tr_b16 v[56:57], v14 offset:40960
    v_mfma_f32_16x16x32_bf16 v[188:191], v[60:63], a[68:71], v[188:191]
    ds_read_b64_tr_b16 v[58:59], v14 offset:41984
    v_sub_f32 v110, v72, v108
    v_mfma_f32_16x16x32_bf16 v[220:223], v[60:63], a[72:75], v[220:223]
    buffer_load_dwordx4 v16, s[12:15], s98 offen offset:0  lds
    v_mfma_f32_16x16x32_bf16 v[252:255], v[60:63], a[76:79], v[252:255]
    v_fmac_f32 v109, v110, v110
    v_sub_f32 v111, v73, v108
    v_mfma_f32_16x16x32_bf16 v[128:131], v[32:35], a[80:83], v[128:131]
    ds_read_b64_tr_b16 v[60:61], v15 offset:40960
    v_fmac_f32 v109, v111, v111
    v_mfma_f32_16x16x32_bf16 v[160:163], v[32:35], a[84:87], v[160:163]
    ds_read_b64_tr_b16 v[62:63], v15 offset:41984
    v_sub_f32 v110, v74, v108
    v_mfma_f32_16x16x32_bf16 v[192:195], v[32:35], a[88:91], v[192:195]
    buffer_load_dwordx4 v17, s[12:15], s98 offen offset:1024  lds
    v_mfma_f32_16x16x32_bf16 v[224:227], v[32:35], a[92:95], v[224:227]
    v_fmac_f32 v109, v110, v110
    v_sub_f32 v111, v75, v108
    v_mfma_f32_16x16x32_bf16 v[132:135], v[36:39], a[80:83], v[132:135]
    buffer_load_dwordx4 v18, s[12:15], s98 offen offset:2048  lds
    v_mfma_f32_16x16x32_bf16 v[164:167], v[36:39], a[84:87], v[164:167]
    v_fmac_f32 v109, v111, v111
    v_sub_f32 v110, v76, v108
    v_mfma_f32_16x16x32_bf16 v[196:199], v[36:39], a[88:91], v[196:199]
    buffer_load_dwordx4 v19, s[12:15], s98 offen offset:3072  lds
    s_cmp_eq_u32 s3, 1
    s_cselect_b32 s101, s100, 2147479552
    buffer_load_dword a243, v117, s[20:23], s101 offen offset:4
    v_mfma_f32_16x16x32_bf16 v[228:231], v[36:39], a[92:95], v[228:231]
    s_waitcnt lgkmcnt(2)
    v_fmac_f32 v109, v110, v110
    v_sub_f32 v111, v77, v108
    v_mfma_f32_16x16x32_bf16 v[136:139], v[40:43], a[80:83], v[136:139]
    v_fmac_f32 v109, v111, v111
    v_sub_f32 v110, v78, v108
    s_waitcnt vmcnt(15) lgkmcnt(0)
    s_barrier
    v_mfma_f32_16x16x32_bf16 v[168:171], v[40:43], a[84:87], v[168:171]
    s_add_u32 m0, s63, 131072
    s_xor_b32 s98, s97, 2621440
    ds_read_b64_tr_b16 v[32:33], v8 offset:0
    v_mfma_f32_16x16x32_bf16 v[200:203], v[40:43], a[88:91], v[200:203]
    ds_read_b64_tr_b16 v[34:35], v8 offset:1024
    v_fmac_f32 v109, v110, v110
    v_mfma_f32_16x16x32_bf16 v[232:235], v[40:43], a[92:95], v[232:235]
    ds_read_b64_tr_b16 v[36:37], v9 offset:0
    v_sub_f32 v111, v79, v108
    v_mfma_f32_16x16x32_bf16 v[140:143], v[44:47], a[80:83], v[140:143]
    ds_read_b64_tr_b16 v[38:39], v9 offset:1024
    v_fmac_f32 v109, v111, v111
    v_mfma_f32_16x16x32_bf16 v[172:175], v[44:47], a[84:87], v[172:175]
    ds_read_b64_tr_b16 v[40:41], v10 offset:0
    v_add_f32_dpp v109, v109, v109 row_ror:8 row_mask:0xf bank_mask:0xf
    v_mfma_f32_16x16x32_bf16 v[204:207], v[44:47], a[88:91], v[204:207]
    ds_read_b64_tr_b16 v[42:43], v10 offset:1024
    v_mov_b32 v110, v109
    v_mfma_f32_16x16x32_bf16 v[236:239], v[44:47], a[92:95], v[236:239]
    ds_read_b128 a[96:99], v28 offset:0
    v_permlane16_swap_b32 v109, v110
    v_mfma_f32_16x16x32_bf16 v[144:147], v[48:51], a[80:83], v[144:147]
    ds_read_b64_tr_b16 v[44:45], v11 offset:0
    v_add_f32 v109, v109, v110
    v_mfma_f32_16x16x32_bf16 v[176:179], v[48:51], a[84:87], v[176:179]
    ds_read_b64_tr_b16 v[46:47], v11 offset:1024
    v_mov_b32 v110, v109
    s_waitcnt vmcnt(13)
    buffer_atomic_add v6, v7, s[36:39], s69 offen sc1
    v_mfma_f32_16x16x32_bf16 v[208:211], v[48:51], a[88:91], v[208:211]
    ds_read_b128 a[100:103], v28 offset:2048
    v_permlane32_swap_b32 v109, v110
    v_mfma_f32_16x16x32_bf16 v[240:243], v[48:51], a[92:95], v[240:243]
    ds_read_b128 a[104:107], v28 offset:4096
    v_add_f32 v109, v109, v110
    v_mfma_f32_16x16x32_bf16 v[148:151], v[52:55], a[80:83], v[148:151]
    ds_read_b64_tr_b16 v[48:49], v12 offset:0
    v_mfma_f32_16x16x32_bf16 v[180:183], v[52:55], a[84:87], v[180:183]
    ds_read_b64_tr_b16 v[50:51], v12 offset:1024
    v_mfma_f32_16x16x32_bf16 v[212:215], v[52:55], a[88:91], v[212:215]
    ds_read_b128 a[108:111], v28 offset:6144
    v_mfma_f32_16x16x32_bf16 v[244:247], v[52:55], a[92:95], v[244:247]
    buffer_load_dwordx4 v20, s[16:19], s98 offen offset:0  lds
    v_mfma_f32_16x16x32_bf16 v[152:155], v[56:59], a[80:83], v[152:155]
    ds_read_b64_tr_b16 v[52:53], v13 offset:0
    v_mfma_f32_16x16x32_bf16 v[184:187], v[56:59], a[84:87], v[184:187]
    ds_read_b64_tr_b16 v[54:55], v13 offset:1024
    v_mfma_f32_16x16x32_bf16 v[216:219], v[56:59], a[88:91], v[216:219]
    buffer_load_dwordx4 v21, s[16:19], s98 offen offset:1024  lds
    v_mfma_f32_16x16x32_bf16 v[248:251], v[56:59], a[92:95], v[248:251]
    ds_write_b64 v100, v[108:109]
    v_mfma_f32_16x16x32_bf16 v[156:159], v[60:63], a[80:83], v[156:159]
    ds_read_b64_tr_b16 v[56:57], v14 offset:0
    v_mfma_f32_16x16x32_bf16 v[188:191], v[60:63], a[84:87], v[188:191]
    ds_read_b64_tr_b16 v[58:59], v14 offset:1024
    v_mfma_f32_16x16x32_bf16 v[220:223], v[60:63], a[88:91], v[220:223]
    buffer_load_dwordx4 v22, s[16:19], s98 offen offset:2048  lds
    v_mfma_f32_16x16x32_bf16 v[252:255], v[60:63], a[92:95], v[252:255]
    s_waitcnt lgkmcnt(6)
    v_mfma_f32_16x16x32_bf16 v[128:131], v[32:35], a[96:99], v[128:131]
    ds_read_b64_tr_b16 v[60:61], v15 offset:0
    v_mfma_f32_16x16x32_bf16 v[160:163], v[32:35], a[100:103], v[160:163]
    ds_read_b64_tr_b16 v[62:63], v15 offset:1024
    v_mfma_f32_16x16x32_bf16 v[192:195], v[32:35], a[104:107], v[192:195]
    s_waitcnt lgkmcnt(6)
    ds_read_b128 a[112:115], v29 offset:0
    v_mfma_f32_16x16x32_bf16 v[224:227], v[32:35], a[108:111], v[224:227]
    ds_read_b128 a[116:119], v29 offset:2048
    v_mfma_f32_16x16x32_bf16 v[132:135], v[36:39], a[96:99], v[132:135]
    ds_read_b64_tr_b16 v[32:33], v8 offset:8192
    v_mfma_f32_16x16x32_bf16 v[164:167], v[36:39], a[100:103], v[164:167]
    ds_read_b64_tr_b16 v[34:35], v8 offset:9216
    v_mfma_f32_16x16x32_bf16 v[196:199], v[36:39], a[104:107], v[196:199]
    ds_read_b128 a[120:123], v29 offset:4096
    v_mfma_f32_16x16x32_bf16 v[228:231], v[36:39], a[108:111], v[228:231]
    ds_read_b128 a[124:127], v29 offset:6144
    v_mfma_f32_16x16x32_bf16 v[136:139], v[40:43], a[96:99], v[136:139]
    ds_read_b64_tr_b16 v[36:37], v9 offset:8192
    v_mfma_f32_16x16x32_bf16 v[168:171], v[40:43], a[100:103], v[168:171]
    ds_read_b64_tr_b16 v[38:39], v9 offset:9216
    v_mfma_f32_16x16x32_bf16 v[200:203], v[40:43], a[104:107], v[200:203]
    buffer_load_dwordx4 v23, s[16:19], s98 offen offset:3072  lds
    v_mfma_f32_16x16x32_bf16 v[232:235], v[40:43], a[108:111], v[232:235]
    v_mfma_f32_16x16x32_bf16 v[140:143], v[44:47], a[96:99], v[140:143]
    s_add_u32 m0, s62, 65536
    s_xor_b32 s98, s96, 640
    ds_read_b64_tr_b16 v[40:41], v10 offset:8192
    v_mfma_f32_16x16x32_bf16 v[172:175], v[44:47], a[100:103], v[172:175]
    ds_read_b64_tr_b16 v[42:43], v10 offset:9216
    v_mfma_f32_16x16x32_bf16 v[204:207], v[44:47], a[104:107], v[204:207]
    buffer_load_dwordx4 v16, s[12:15], s98 offen offset:0  lds
    v_mfma_f32_16x16x32_bf16 v[236:239], v[44:47], a[108:111], v[236:239]
    v_mfma_f32_16x16x32_bf16 v[144:147], v[48:51], a[96:99], v[144:147]
    ds_read_b64_tr_b16 v[44:45], v11 offset:8192
    v_mfma_f32_16x16x32_bf16 v[176:179], v[48:51], a[100:103], v[176:179]
    ds_read_b64_tr_b16 v[46:47], v11 offset:9216
    v_mfma_f32_16x16x32_bf16 v[208:211], v[48:51], a[104:107], v[208:211]
    buffer_load_dwordx4 v17, s[12:15], s98 offen offset:1024  lds
    v_mfma_f32_16x16x32_bf16 v[240:243], v[48:51], a[108:111], v[240:243]
    s_waitcnt lgkmcnt(4)
    v_mfma_f32_16x16x32_bf16 v[148:151], v[52:55], a[96:99], v[148:151]
    ds_read_b64_tr_b16 v[48:49], v12 offset:8192
    v_mfma_f32_16x16x32_bf16 v[180:183], v[52:55], a[100:103], v[180:183]
    ds_read_b64_tr_b16 v[50:51], v12 offset:9216
    v_mfma_f32_16x16x32_bf16 v[212:215], v[52:55], a[104:107], v[212:215]
    buffer_load_dwordx4 v18, s[12:15], s98 offen offset:2048  lds
    v_mfma_f32_16x16x32_bf16 v[244:247], v[52:55], a[108:111], v[244:247]
    v_mfma_f32_16x16x32_bf16 v[152:155], v[56:59], a[96:99], v[152:155]
    ds_read_b64_tr_b16 v[52:53], v13 offset:8192
    v_mfma_f32_16x16x32_bf16 v[184:187], v[56:59], a[100:103], v[184:187]
    ds_read_b64_tr_b16 v[54:55], v13 offset:9216
    v_mfma_f32_16x16x32_bf16 v[216:219], v[56:59], a[104:107], v[216:219]
    buffer_load_dwordx4 v19, s[12:15], s98 offen offset:3072  lds
    v_mfma_f32_16x16x32_bf16 v[248:251], v[56:59], a[108:111], v[248:251]
    v_mfma_f32_16x16x32_bf16 v[156:159], v[60:63], a[96:99], v[156:159]
    s_add_u32 m0, s62, 69632
    s_xor_b32 s98, s96, 33408
    ds_read_b64_tr_b16 v[56:57], v14 offset:8192
    v_mfma_f32_16x16x32_bf16 v[188:191], v[60:63], a[100:103], v[188:191]
    ds_read_b64_tr_b16 v[58:59], v14 offset:9216
    v_mfma_f32_16x16x32_bf16 v[220:223], v[60:63], a[104:107], v[220:223]
    buffer_load_dwordx4 v16, s[12:15], s98 offen offset:0  lds
    v_mfma_f32_16x16x32_bf16 v[252:255], v[60:63], a[108:111], v[252:255]
    v_mfma_f32_16x16x32_bf16 v[128:131], v[32:35], a[112:115], v[128:131]
    ds_read_b64_tr_b16 v[60:61], v15 offset:8192
    v_mfma_f32_16x16x32_bf16 v[160:163], v[32:35], a[116:119], v[160:163]
    ds_read_b64_tr_b16 v[62:63], v15 offset:9216
    v_mfma_f32_16x16x32_bf16 v[192:195], v[32:35], a[120:123], v[192:195]
    buffer_load_dwordx4 v17, s[12:15], s98 offen offset:1024  lds
    v_mfma_f32_16x16x32_bf16 v[224:227], v[32:35], a[124:127], v[224:227]
    v_mfma_f32_16x16x32_bf16 v[132:135], v[36:39], a[112:115], v[132:135]
    buffer_load_dwordx4 v18, s[12:15], s98 offen offset:2048  lds
    v_mfma_f32_16x16x32_bf16 v[164:167], v[36:39], a[116:119], v[164:167]
    v_mfma_f32_16x16x32_bf16 v[196:199], v[36:39], a[120:123], v[196:199]
    buffer_load_dwordx4 v19, s[12:15], s98 offen offset:3072  lds
    s_cmp_eq_u32 s3, 2
    s_cselect_b32 s101, s100, 2147479552
    buffer_load_dword a245, v117, s[24:27], s101 offen offset:4
    v_mfma_f32_16x16x32_bf16 v[228:231], v[36:39], a[124:127], v[228:231]
    s_waitcnt lgkmcnt(2)
    v_mfma_f32_16x16x32_bf16 v[136:139], v[40:43], a[112:115], v[136:139]
    s_waitcnt vmcnt(15) lgkmcnt(0)
    s_barrier
    v_mfma_f32_16x16x32_bf16 v[168:171], v[40:43], a[116:119], v[168:171]
    s_add_u32 m0, s63, 98304
    s_xor_b32 s98, s97, 3145728
    ds_read_b64_tr_b16 v[32:33], v8 offset:16384
    v_mfma_f32_16x16x32_bf16 v[200:203], v[40:43], a[120:123], v[200:203]
    ds_read_b64_tr_b16 v[34:35], v8 offset:17408
    v_mfma_f32_16x16x32_bf16 v[232:235], v[40:43], a[124:127], v[232:235]
    ds_read_b64_tr_b16 v[36:37], v9 offset:16384
    v_mfma_f32_16x16x32_bf16 v[140:143], v[44:47], a[112:115], v[140:143]
    ds_read_b64_tr_b16 v[38:39], v9 offset:17408
    v_mfma_f32_16x16x32_bf16 v[172:175], v[44:47], a[116:119], v[172:175]
    ds_read_b64_tr_b16 v[40:41], v10 offset:16384
    v_mfma_f32_16x16x32_bf16 v[204:207], v[44:47], a[120:123], v[204:207]
    ds_read_b64_tr_b16 v[42:43], v10 offset:17408
    v_mfma_f32_16x16x32_bf16 v[236:239], v[44:47], a[124:127], v[236:239]
    ds_read_b128 a[128:131], v28 offset:32768
    v_mfma_f32_16x16x32_bf16 v[144:147], v[48:51], a[112:115], v[144:147]
    ds_read_b64_tr_b16 v[44:45], v11 offset:16384
    v_mfma_f32_16x16x32_bf16 v[176:179], v[48:51], a[116:119], v[176:179]
    ds_read_b64_tr_b16 v[46:47], v11 offset:17408
    v_mfma_f32_16x16x32_bf16 v[208:211], v[48:51], a[120:123], v[208:211]
    ds_read_b128 a[132:135], v28 offset:34816
    v_mfma_f32_16x16x32_bf16 v[240:243], v[48:51], a[124:127], v[240:243]
    ds_read_b128 a[136:139], v28 offset:36864
    v_mfma_f32_16x16x32_bf16 v[148:151], v[52:55], a[112:115], v[148:151]
    ds_read_b64_tr_b16 v[48:49], v12 offset:16384
    v_mfma_f32_16x16x32_bf16 v[180:183], v[52:55], a[116:119], v[180:183]
    ds_read_b64_tr_b16 v[50:51], v12 offset:17408
    v_mfma_f32_16x16x32_bf16 v[212:215], v[52:55], a[120:123], v[212:215]
    ds_read_b128 a[140:143], v28 offset:38912
    v_mfma_f32_16x16x32_bf16 v[244:247], v[52:55], a[124:127], v[244:247]
    buffer_load_dwordx4 v20, s[16:19], s98 offen offset:0  lds
    v_mfma_f32_16x16x32_bf16 v[152:155], v[56:59], a[112:115], v[152:155]
    ds_read_b64_tr_b16 v[52:53], v13 offset:16384
    v_mfma_f32_16x16x32_bf16 v[184:187], v[56:59], a[116:119], v[184:187]
    ds_read_b64_tr_b16 v[54:55], v13 offset:17408
    v_mfma_f32_16x16x32_bf16 v[216:219], v[56:59], a[120:123], v[216:219]
    buffer_load_dwordx4 v21, s[16:19], s98 offen offset:1024  lds
    v_mfma_f32_16x16x32_bf16 v[248:251], v[56:59], a[124:127], v[248:251]
    ds_read_b128 v[88:91], v99
    v_mfma_f32_16x16x32_bf16 v[156:159], v[60:63], a[112:115], v[156:159]
    ds_read_b64_tr_b16 v[56:57], v14 offset:16384
    v_mfma_f32_16x16x32_bf16 v[188:191], v[60:63], a[116:119], v[188:191]
    ds_read_b64_tr_b16 v[58:59], v14 offset:17408
    v_mfma_f32_16x16x32_bf16 v[220:223], v[60:63], a[120:123], v[220:223]
    buffer_load_dwordx4 v22, s[16:19], s98 offen offset:2048  lds
    v_mfma_f32_16x16x32_bf16 v[252:255], v[60:63], a[124:127], v[252:255]
    s_waitcnt lgkmcnt(6)
    ds_read_b128 v[92:95], v99 offset:16
    v_mfma_f32_16x16x32_bf16 v[128:131], v[32:35], a[128:131], v[128:131]
    ds_read_b64_tr_b16 v[60:61], v15 offset:16384
    v_mfma_f32_16x16x32_bf16 v[160:163], v[32:35], a[132:135], v[160:163]
    ds_read_b64_tr_b16 v[62:63], v15 offset:17408
    v_mfma_f32_16x16x32_bf16 v[192:195], v[32:35], a[136:139], v[192:195]
    s_waitcnt lgkmcnt(7)
    ds_read_b128 a[144:147], v29 offset:32768
    v_mfma_f32_16x16x32_bf16 v[224:227], v[32:35], a[140:143], v[224:227]
    ds_read_b128 a[148:151], v29 offset:34816
    v_mfma_f32_16x16x32_bf16 v[132:135], v[36:39], a[128:131], v[132:135]
    ds_read_b64_tr_b16 v[32:33], v8 offset:24576
    v_mfma_f32_16x16x32_bf16 v[164:167], v[36:39], a[132:135], v[164:167]
    ds_read_b64_tr_b16 v[34:35], v8 offset:25600
    v_mfma_f32_16x16x32_bf16 v[196:199], v[36:39], a[136:139], v[196:199]
    ds_read_b128 a[152:155], v29 offset:36864
    v_mfma_f32_16x16x32_bf16 v[228:231], v[36:39], a[140:143], v[228:231]
    ds_read_b128 a[156:159], v29 offset:38912
    s_waitcnt lgkmcnt(11)
    v_add_f32 v108, v88, v90
    v_mfma_f32_16x16x32_bf16 v[136:139], v[40:43], a[128:131], v[136:139]
    ds_read_b64_tr_b16 v[36:37], v9 offset:24576
    s_waitcnt lgkmcnt(9)
    v_add_f32 v109, v92, v94
    v_mfma_f32_16x16x32_bf16 v[168:171], v[40:43], a[132:135], v[168:171]
    ds_read_b64_tr_b16 v[38:39], v9 offset:25600
    v_add_f32 v108, v108, v109
    v_mfma_f32_16x16x32_bf16 v[200:203], v[40:43], a[136:139], v[200:203]
    buffer_load_dwordx4 v23, s[16:19], s98 offen offset:3072  lds
    v_mfma_f32_16x16x32_bf16 v[232:235], v[40:43], a[140:143], v[232:235]
    v_mul_f32 v108, 0x3e800000, v108
    v_add_f32 v109, v89, v91
    v_mfma_f32_16x16x32_bf16 v[140:143], v[44:47], a[128:131], v[140:143]
    s_add_u32 m0, s62, 0
    s_xor_b32 s98, s96, 768
    ds_read_b64_tr_b16 v[40:41], v10 offset:24576
    v_mfma_f32_16x16x32_bf16 v[172:175], v[44:47], a[132:135], v[172:175]
    ds_read_b64_tr_b16 v[42:43], v10 offset:25600
    v_add_f32 v110, v93, v95
    v_mfma_f32_16x16x32_bf16 v[204:207], v[44:47], a[136:139], v[204:207]
    buffer_load_dwordx4 v16, s[12:15], s98 offen offset:0  lds
    v_mfma_f32_16x16x32_bf16 v[236:239], v[44:47], a[140:143], v[236:239]
    v_add_f32 v109, v109, v110
    v_sub_f32 v88, v88, v108
    v_mfma_f32_16x16x32_bf16 v[144:147], v[48:51], a[128:131], v[144:147]
    ds_read_b64_tr_b16 v[44:45], v11 offset:24576
    v_sub_f32 v90, v90, v108
    v_mfma_f32_16x16x32_bf16 v[176:179], v[48:51], a[132:135], v[176:179]
    ds_read_b64_tr_b16 v[46:47], v11 offset:25600
    v_sub_f32 v92, v92, v108
    v_mfma_f32_16x16x32_bf16 v[208:211], v[48:51], a[136:139], v[208:211]
    buffer_load_dwordx4 v17, s[12:15], s98 offen offset:1024  lds
    v_mfma_f32_16x16x32_bf16 v[240:243], v[48:51], a[140:143], v[240:243]
    v_sub_f32 v94, v94, v108
    v_mul_f32 v110, v88, v88
    v_mfma_f32_16x16x32_bf16 v[148:151], v[52:55], a[128:131], v[148:151]
    ds_read_b64_tr_b16 v[48:49], v12 offset:24576
    v_fmac_f32 v110, v90, v90
    v_mfma_f32_16x16x32_bf16 v[180:183], v[52:55], a[132:135], v[180:183]
    ds_read_b64_tr_b16 v[50:51], v12 offset:25600
    v_fmac_f32 v110, v92, v92
    v_mfma_f32_16x16x32_bf16 v[212:215], v[52:55], a[136:139], v[212:215]
    buffer_load_dwordx4 v18, s[12:15], s98 offen offset:2048  lds
    v_mfma_f32_16x16x32_bf16 v[244:247], v[52:55], a[140:143], v[244:247]
    v_fmac_f32 v110, v94, v94
    v_fmac_f32 v109, 0x43000000, v110
    v_mfma_f32_16x16x32_bf16 v[152:155], v[56:59], a[128:131], v[152:155]
    ds_read_b64_tr_b16 v[52:53], v13 offset:24576
    v_mov_b32 v110, 0x3727c5ac
    v_mfma_f32_16x16x32_bf16 v[184:187], v[56:59], a[132:135], v[184:187]
    ds_read_b64_tr_b16 v[54:55], v13 offset:25600
    v_fmac_f32 v110, 0x3b000000, v109
    v_mfma_f32_16x16x32_bf16 v[216:219], v[56:59], a[136:139], v[216:219]
    buffer_load_dwordx4 v19, s[12:15], s98 offen offset:3072  lds
    v_mfma_f32_16x16x32_bf16 v[248:251], v[56:59], a[140:143], v[248:251]
    s_waitcnt lgkmcnt(4)
    v_rsq_f32 v110, v110
    v_mfma_f32_16x16x32_bf16 v[156:159], v[60:63], a[128:131], v[156:159]
    s_add_u32 m0, s62, 4096
    s_xor_b32 s98, s96, 33536
    ds_read_b64_tr_b16 v[56:57], v14 offset:24576
    v_mfma_f32_16x16x32_bf16 v[188:191], v[60:63], a[132:135], v[188:191]
    ds_read_b64_tr_b16 v[58:59], v14 offset:25600
    v_sub_f32 v64, v64, v108
    v_mfma_f32_16x16x32_bf16 v[220:223], v[60:63], a[136:139], v[220:223]
    buffer_load_dwordx4 v16, s[12:15], s98 offen offset:0  lds
    v_mfma_f32_16x16x32_bf16 v[252:255], v[60:63], a[140:143], v[252:255]
    v_sub_f32 v65, v65, v108
    v_sub_f32 v66, v66, v108
    v_mfma_f32_16x16x32_bf16 v[128:131], v[32:35], a[144:147], v[128:131]
    ds_read_b64_tr_b16 v[60:61], v15 offset:24576
    v_sub_f32 v67, v67, v108
    v_mfma_f32_16x16x32_bf16 v[160:163], v[32:35], a[148:151], v[160:163]
    ds_read_b64_tr_b16 v[62:63], v15 offset:25600
    v_sub_f32 v68, v68, v108
    v_mfma_f32_16x16x32_bf16 v[192:195], v[32:35], a[152:155], v[192:195]
    buffer_load_dwordx4 v17, s[12:15], s98 offen offset:1024  lds
    v_mfma_f32_16x16x32_bf16 v[224:227], v[32:35], a[156:159], v[224:227]
    v_sub_f32 v69, v69, v108
    v_sub_f32 v70, v70, v108
    v_mfma_f32_16x16x32_bf16 v[132:135], v[36:39], a[144:147], v[132:135]
    buffer_load_dwordx4 v18, s[12:15], s98 offen offset:2048  lds
    v_mfma_f32_16x16x32_bf16 v[164:167], v[36:39], a[148:151], v[164:167]
    v_sub_f32 v71, v71, v108
    v_sub_f32 v72, v72, v108
    v_mfma_f32_16x16x32_bf16 v[196:199], v[36:39], a[152:155], v[196:199]
    buffer_load_dwordx4 v19, s[12:15], s98 offen offset:3072  lds
    s_cmp_eq_u32 s3, 3
    s_cselect_b32 s101, s100, 2147479552
    buffer_load_dword a247, v117, s[24:27], s101 offen offset:4
    v_mfma_f32_16x16x32_bf16 v[228:231], v[36:39], a[156:159], v[228:231]
    v_sub_f32 v73, v73, v108
    v_sub_f32 v74, v74, v108
    v_mfma_f32_16x16x32_bf16 v[136:139], v[40:43], a[144:147], v[136:139]
    v_sub_f32 v75, v75, v108
    v_sub_f32 v76, v76, v108
    s_waitcnt vmcnt(14) lgkmcnt(0)
    s_barrier
    v_mfma_f32_16x16x32_bf16 v[168:171], v[40:43], a[148:151], v[168:171]
    s_add_u32 m0, s63, 114688
    s_xor_b32 s98, s97, 3670016
    ds_read_b64_tr_b16 v[32:33], v8 offset:32768
    v_mfma_f32_16x16x32_bf16 v[200:203], v[40:43], a[152:155], v[200:203]
    ds_read_b64_tr_b16 v[34:35], v8 offset:33792
    v_sub_f32 v77, v77, v108
    v_mfma_f32_16x16x32_bf16 v[232:235], v[40:43], a[156:159], v[232:235]
    ds_read_b64_tr_b16 v[36:37], v9 offset:32768
    v_sub_f32 v78, v78, v108
    v_mfma_f32_16x16x32_bf16 v[140:143], v[44:47], a[144:147], v[140:143]
    ds_read_b64_tr_b16 v[38:39], v9 offset:33792
    v_sub_f32 v79, v79, v108
    v_mfma_f32_16x16x32_bf16 v[172:175], v[44:47], a[148:151], v[172:175]
    ds_read_b64_tr_b16 v[40:41], v10 offset:32768
    v_mul_f32 v64, v64, v110
    v_mfma_f32_16x16x32_bf16 v[204:207], v[44:47], a[152:155], v[204:207]
    ds_read_b64_tr_b16 v[42:43], v10 offset:33792
    v_mul_f32 v65, v65, v110
    v_mfma_f32_16x16x32_bf16 v[236:239], v[44:47], a[156:159], v[236:239]
    ds_read_b128 a[160:163], v30 offset:0
    v_mul_f32 v66, v66, v110
    v_mfma_f32_16x16x32_bf16 v[144:147], v[48:51], a[144:147], v[144:147]
    ds_read_b64_tr_b16 v[44:45], v11 offset:32768
    v_mul_f32 v67, v67, v110
    v_mfma_f32_16x16x32_bf16 v[176:179], v[48:51], a[148:151], v[176:179]
    ds_read_b64_tr_b16 v[46:47], v11 offset:33792
    v_mul_f32 v68, v68, v110
    v_mfma_f32_16x16x32_bf16 v[208:211], v[48:51], a[152:155], v[208:211]
    ds_read_b128 a[164:167], v30 offset:2048
    v_mul_f32 v69, v69, v110
    v_mfma_f32_16x16x32_bf16 v[240:243], v[48:51], a[156:159], v[240:243]
    ds_read_b128 a[168:171], v30 offset:4096
    v_mul_f32 v70, v70, v110
    v_mfma_f32_16x16x32_bf16 v[148:151], v[52:55], a[144:147], v[148:151]
    ds_read_b64_tr_b16 v[48:49], v12 offset:32768
    v_mul_f32 v71, v71, v110
    v_mfma_f32_16x16x32_bf16 v[180:183], v[52:55], a[148:151], v[180:183]
    ds_read_b64_tr_b16 v[50:51], v12 offset:33792
    v_mul_f32 v72, v72, v110
    v_mfma_f32_16x16x32_bf16 v[212:215], v[52:55], a[152:155], v[212:215]
    ds_read_b128 a[172:175], v30 offset:6144
    v_mul_f32 v73, v73, v110
    buffer_load_dword v3, v4, s[36:39], s67 offen sc0 sc1
    v_mfma_f32_16x16x32_bf16 v[244:247], v[52:55], a[156:159], v[244:247]
    buffer_load_dwordx4 v20, s[16:19], s98 offen offset:0  lds
    v_mfma_f32_16x16x32_bf16 v[152:155], v[56:59], a[144:147], v[152:155]
    ds_read_b64_tr_b16 v[52:53], v13 offset:32768
    v_mul_f32 v74, v74, v110
    v_mfma_f32_16x16x32_bf16 v[184:187], v[56:59], a[148:151], v[184:187]
    ds_read_b64_tr_b16 v[54:55], v13 offset:33792
    v_mul_f32 v75, v75, v110
    v_mfma_f32_16x16x32_bf16 v[216:219], v[56:59], a[152:155], v[216:219]
    buffer_load_dwordx4 v21, s[16:19], s98 offen offset:1024  lds
    v_mfma_f32_16x16x32_bf16 v[248:251], v[56:59], a[156:159], v[248:251]
    v_mul_f32 v76, v76, v110
    v_mul_f32 v77, v77, v110
    v_mfma_f32_16x16x32_bf16 v[156:159], v[60:63], a[144:147], v[156:159]
    ds_read_b64_tr_b16 v[56:57], v14 offset:32768
    v_mul_f32 v78, v78, v110
    v_mfma_f32_16x16x32_bf16 v[188:191], v[60:63], a[148:151], v[188:191]
    ds_read_b64_tr_b16 v[58:59], v14 offset:33792
    v_mul_f32 v79, v79, v110
    v_mfma_f32_16x16x32_bf16 v[220:223], v[60:63], a[152:155], v[220:223]
    buffer_load_dwordx4 v22, s[16:19], s98 offen offset:2048  lds
    v_mfma_f32_16x16x32_bf16 v[252:255], v[60:63], a[156:159], v[252:255]
    s_waitcnt lgkmcnt(5)
    v_mfma_f32_16x16x32_bf16 v[128:131], v[32:35], a[160:163], v[128:131]
    ds_read_b64_tr_b16 v[60:61], v15 offset:32768
    v_and_b32 v96, 31, v2
    v_mfma_f32_16x16x32_bf16 v[160:163], v[32:35], a[164:167], v[160:163]
    ds_read_b64_tr_b16 v[62:63], v15 offset:33792
    v_lshlrev_b32 v96, 4, v96
    v_mfma_f32_16x16x32_bf16 v[192:195], v[32:35], a[168:171], v[192:195]
    s_waitcnt lgkmcnt(5)
    ds_read_b128 a[176:179], v31 offset:0
    v_lshrrev_b32 v97, 5, v2
    v_mfma_f32_16x16x32_bf16 v[224:227], v[32:35], a[172:175], v[224:227]
    ds_read_b128 a[180:183], v31 offset:2048
    v_lshl_add_u32 v96, v97, 11, v96
    v_mfma_f32_16x16x32_bf16 v[132:135], v[36:39], a[160:163], v[132:135]
    ds_read_b64_tr_b16 v[32:33], v8 offset:40960
    v_mfma_f32_16x16x32_bf16 v[164:167], v[36:39], a[164:167], v[164:167]
    ds_read_b64_tr_b16 v[34:35], v8 offset:41984
    v_mfma_f32_16x16x32_bf16 v[196:199], v[36:39], a[168:171], v[196:199]
    ds_read_b128 a[184:187], v31 offset:4096
    v_mfma_f32_16x16x32_bf16 v[228:231], v[36:39], a[172:175], v[228:231]
    ds_read_b128 a[188:191], v31 offset:6144
    v_mfma_f32_16x16x32_bf16 v[136:139], v[40:43], a[160:163], v[136:139]
    ds_read_b64_tr_b16 v[36:37], v9 offset:40960
    v_mfma_f32_16x16x32_bf16 v[168:171], v[40:43], a[164:167], v[168:171]
    ds_read_b64_tr_b16 v[38:39], v9 offset:41984
    v_mfma_f32_16x16x32_bf16 v[200:203], v[40:43], a[168:171], v[200:203]
    buffer_load_dwordx4 v23, s[16:19], s98 offen offset:3072  lds
    v_mfma_f32_16x16x32_bf16 v[232:235], v[40:43], a[172:175], v[232:235]
    v_mfma_f32_16x16x32_bf16 v[140:143], v[44:47], a[160:163], v[140:143]
    s_add_u32 m0, s62, 32768
    s_xor_b32 s98, s96, 896
    ds_read_b64_tr_b16 v[40:41], v10 offset:40960
    v_mfma_f32_16x16x32_bf16 v[172:175], v[44:47], a[164:167], v[172:175]
    ds_read_b64_tr_b16 v[42:43], v10 offset:41984
    v_mfma_f32_16x16x32_bf16 v[204:207], v[44:47], a[168:171], v[204:207]
    buffer_load_dwordx4 v16, s[12:15], s98 offen offset:0  lds
    v_mfma_f32_16x16x32_bf16 v[236:239], v[44:47], a[172:175], v[236:239]
    v_mfma_f32_16x16x32_bf16 v[144:147], v[48:51], a[160:163], v[144:147]
    ds_read_b64_tr_b16 v[44:45], v11 offset:40960
    v_mfma_f32_16x16x32_bf16 v[176:179], v[48:51], a[164:167], v[176:179]
    ds_read_b64_tr_b16 v[46:47], v11 offset:41984
    v_mfma_f32_16x16x32_bf16 v[208:211], v[48:51], a[168:171], v[208:211]
    buffer_load_dwordx4 v17, s[12:15], s98 offen offset:1024  lds
    v_mfma_f32_16x16x32_bf16 v[240:243], v[48:51], a[172:175], v[240:243]
    s_waitcnt lgkmcnt(4)
    v_mfma_f32_16x16x32_bf16 v[148:151], v[52:55], a[160:163], v[148:151]
    ds_read_b64_tr_b16 v[48:49], v12 offset:40960
    v_mfma_f32_16x16x32_bf16 v[180:183], v[52:55], a[164:167], v[180:183]
    ds_read_b64_tr_b16 v[50:51], v12 offset:41984
    v_mfma_f32_16x16x32_bf16 v[212:215], v[52:55], a[168:171], v[212:215]
    buffer_load_dwordx4 v18, s[12:15], s98 offen offset:2048  lds
    v_mfma_f32_16x16x32_bf16 v[244:247], v[52:55], a[172:175], v[244:247]
    v_mfma_f32_16x16x32_bf16 v[152:155], v[56:59], a[160:163], v[152:155]
    ds_read_b64_tr_b16 v[52:53], v13 offset:40960
    v_mfma_f32_16x16x32_bf16 v[184:187], v[56:59], a[164:167], v[184:187]
    ds_read_b64_tr_b16 v[54:55], v13 offset:41984
    v_mfma_f32_16x16x32_bf16 v[216:219], v[56:59], a[168:171], v[216:219]
    buffer_load_dwordx4 v19, s[12:15], s98 offen offset:3072  lds
    v_mfma_f32_16x16x32_bf16 v[248:251], v[56:59], a[172:175], v[248:251]
    v_mfma_f32_16x16x32_bf16 v[156:159], v[60:63], a[160:163], v[156:159]
    s_add_u32 m0, s62, 36864
    s_xor_b32 s98, s96, 33664
    ds_read_b64_tr_b16 v[56:57], v14 offset:40960
    v_mfma_f32_16x16x32_bf16 v[188:191], v[60:63], a[164:167], v[188:191]
    ds_read_b64_tr_b16 v[58:59], v14 offset:41984
    v_mfma_f32_16x16x32_bf16 v[220:223], v[60:63], a[168:171], v[220:223]
    buffer_load_dwordx4 v16, s[12:15], s98 offen offset:0  lds
    v_mfma_f32_16x16x32_bf16 v[252:255], v[60:63], a[172:175], v[252:255]
    v_mfma_f32_16x16x32_bf16 v[128:131], v[32:35], a[176:179], v[128:131]
    ds_read_b64_tr_b16 v[60:61], v15 offset:40960
    v_mfma_f32_16x16x32_bf16 v[160:163], v[32:35], a[180:183], v[160:163]
    ds_read_b64_tr_b16 v[62:63], v15 offset:41984
    v_mfma_f32_16x16x32_bf16 v[192:195], v[32:35], a[184:187], v[192:195]
    buffer_load_dwordx4 v17, s[12:15], s98 offen offset:1024  lds
    v_mfma_f32_16x16x32_bf16 v[224:227], v[32:35], a[188:191], v[224:227]
    v_mfma_f32_16x16x32_bf16 v[132:135], v[36:39], a[176:179], v[132:135]
    buffer_load_dwordx4 v18, s[12:15], s98 offen offset:2048  lds
    v_mfma_f32_16x16x32_bf16 v[164:167], v[36:39], a[180:183], v[164:167]
    v_mfma_f32_16x16x32_bf16 v[196:199], v[36:39], a[184:187], v[196:199]
    buffer_load_dwordx4 v19, s[12:15], s98 offen offset:3072  lds
    v_mfma_f32_16x16x32_bf16 v[228:231], v[36:39], a[188:191], v[228:231]
    s_waitcnt lgkmcnt(2)
    s_waitcnt vmcnt(12)
    v_cmp_le_u32 vcc, s68, v3
    s_cmp_eq_u64 vcc, -1
    s_cbranch_scc0 L_E_slow_1
L_E_ok_2:
    v_mfma_f32_16x16x32_bf16 v[136:139], v[40:43], a[176:179], v[136:139]
    s_waitcnt lgkmcnt(0)
    s_barrier
    v_mfma_f32_16x16x32_bf16 v[168:171], v[40:43], a[180:183], v[168:171]
    s_add_u32 m0, s62, 65536
    s_xor_b32 s98, s64, 0
    ds_read_b64_tr_b16 v[32:33], v8 offset:0
    v_mfma_f32_16x16x32_bf16 v[200:203], v[40:43], a[184:187], v[200:203]
    ds_read_b64_tr_b16 v[34:35], v8 offset:1024
    v_mov_b32 v18, v106
    v_mfma_f32_16x16x32_bf16 v[232:235], v[40:43], a[188:191], v[232:235]
    ds_read_b64_tr_b16 v[36:37], v9 offset:0
    v_mov_b32 v19, v107
    v_mfma_f32_16x16x32_bf16 v[140:143], v[44:47], a[176:179], v[140:143]
    ds_read_b64_tr_b16 v[38:39], v9 offset:1024
    v_mfma_f32_16x16x32_bf16 v[172:175], v[44:47], a[180:183], v[172:175]
    ds_read_b64_tr_b16 v[40:41], v10 offset:0
    v_mfma_f32_16x16x32_bf16 v[204:207], v[44:47], a[184:187], v[204:207]
    ds_read_b64_tr_b16 v[42:43], v10 offset:1024
    v_mfma_f32_16x16x32_bf16 v[236:239], v[44:47], a[188:191], v[236:239]
    ds_read_b128 a[192:195], v28 offset:0
    v_mfma_f32_16x16x32_bf16 v[144:147], v[48:51], a[176:179], v[144:147]
    ds_read_b64_tr_b16 v[44:45], v11 offset:0
    v_mfma_f32_16x16x32_bf16 v[176:179], v[48:51], a[180:183], v[176:179]
    ds_read_b64_tr_b16 v[46:47], v11 offset:1024
    v_mfma_f32_16x16x32_bf16 v[208:211], v[48:51], a[184:187], v[208:211]
    ds_read_b128 a[196:199], v28 offset:2048
    v_mfma_f32_16x16x32_bf16 v[240:243], v[48:51], a[188:191], v[240:243]
    ds_read_b128 a[200:203], v28 offset:4096
    v_mfma_f32_16x16x32_bf16 v[148:151], v[52:55], a[176:179], v[148:151]
    ds_read_b64_tr_b16 v[48:49], v12 offset:0
    v_mfma_f32_16x16x32_bf16 v[180:183], v[52:55], a[180:183], v[180:183]
    ds_read_b64_tr_b16 v[50:51], v12 offset:1024
    v_mfma_f32_16x16x32_bf16 v[212:215], v[52:55], a[184:187], v[212:215]
    ds_read_b128 a[204:207], v28 offset:6144
    v_mfma_f32_16x16x32_bf16 v[244:247], v[52:55], a[188:191], v[244:247]
    buffer_load_dwordx4 v24, s[20:23], s98 offen offset:0  lds
    v_mfma_f32_16x16x32_bf16 v[152:155], v[56:59], a[176:179], v[152:155]
    ds_read_b64_tr_b16 v[52:53], v13 offset:0
    v_mfma_f32_16x16x32_bf16 v[184:187], v[56:59], a[180:183], v[184:187]
    ds_read_b64_tr_b16 v[54:55], v13 offset:1024
    v_mfma_f32_16x16x32_bf16 v[216:219], v[56:59], a[184:187], v[216:219]
    buffer_load_dwordx4 v[80:83], v96, s[8:11], s70 offen
    v_mfma_f32_16x16x32_bf16 v[248:251], v[56:59], a[188:191], v[248:251]
    buffer_load_dwordx4 v25, s[20:23], s98 offen offset:1024  lds
    v_mfma_f32_16x16x32_bf16 v[156:159], v[60:63], a[176:179], v[156:159]
    s_lshl_b32 s80, s2, 6
    s_add_u32 s80, s80, 1310720
    ds_read_b64_tr_b16 v[56:57], v14 offset:0
    v_mfma_f32_16x16x32_bf16 v[188:191], v[60:63], a[180:183], v[188:191]
    s_waitcnt lgkmcnt(6)
    s_add_u32 s70, s70, 12288
    ds_read_b64_tr_b16 v[58:59], v14 offset:1024
    v_mfma_f32_16x16x32_bf16 v[220:223], v[60:63], a[184:187], v[220:223]
    buffer_store_dword v6, v7, s[8:11], s80 offen sc0 sc1
    v_mfma_f32_16x16x32_bf16 v[252:255], v[60:63], a[188:191], v[252:255]
    buffer_load_dwordx4 v26, s[20:23], s98 offen offset:2048  lds
    v_mfma_f32_16x16x32_bf16 v[128:131], v[32:35], a[192:195], v[128:131]
    ds_read_b64_tr_b16 v[60:61], v15 offset:0
    v_mfma_f32_16x16x32_bf16 v[160:163], v[32:35], a[196:199], v[160:163]
    ds_read_b64_tr_b16 v[62:63], v15 offset:1024
    v_mfma_f32_16x16x32_bf16 v[192:195], v[32:35], a[200:203], v[192:195]
    s_waitcnt lgkmcnt(5)
    ds_read_b128 a[208:211], v29 offset:0
    v_mfma_f32_16x16x32_bf16 v[224:227], v[32:35], a[204:207], v[224:227]
    ds_read_b128 a[212:215], v29 offset:2048
    v_mfma_f32_16x16x32_bf16 v[132:135], v[36:39], a[192:195], v[132:135]
    ds_read_b64_tr_b16 v[32:33], v8 offset:8192
    v_mfma_f32_16x16x32_bf16 v[164:167], v[36:39], a[196:199], v[164:167]
    ds_read_b64_tr_b16 v[34:35], v8 offset:9216
    v_mfma_f32_16x16x32_bf16 v[196:199], v[36:39], a[200:203], v[196:199]
    ds_read_b128 a[216:219], v29 offset:4096
    v_mfma_f32_16x16x32_bf16 v[228:231], v[36:39], a[204:207], v[228:231]
    ds_read_b128 a[220:223], v29 offset:6144
    v_mfma_f32_16x16x32_bf16 v[136:139], v[40:43], a[192:195], v[136:139]
    ds_read_b64_tr_b16 v[36:37], v9 offset:8192
    v_mfma_f32_16x16x32_bf16 v[168:171], v[40:43], a[196:199], v[168:171]
    ds_read_b64_tr_b16 v[38:39], v9 offset:9216
    v_mfma_f32_16x16x32_bf16 v[200:203], v[40:43], a[200:203], v[200:203]
    buffer_load_dwordx4 v27, s[20:23], s98 offen offset:3072  lds
    v_mfma_f32_16x16x32_bf16 v[232:235], v[40:43], a[204:207], v[232:235]
    buffer_load_dwordx4 v[84:87], v96, s[8:11], s70 offen
    v_mfma_f32_16x16x32_bf16 v[140:143], v[44:47], a[192:195], v[140:143]
    s_add_u32 m0, s62, 69632
    s_xor_b32 s98, s64, 262144
    ds_read_b64_tr_b16 v[40:41], v10 offset:8192
    v_mfma_f32_16x16x32_bf16 v[172:175], v[44:47], a[196:199], v[172:175]
    s_add_u32 s70, s70, 12288
    ds_read_b64_tr_b16 v[42:43], v10 offset:9216
    v_mfma_f32_16x16x32_bf16 v[204:207], v[44:47], a[200:203], v[204:207]
    buffer_load_dwordx4 v24, s[20:23], s98 offen offset:0  lds
    v_mfma_f32_16x16x32_bf16 v[236:239], v[44:47], a[204:207], v[236:239]
    buffer_load_dwordx4 v[88:91], v96, s[8:11], s70 offen
    v_mfma_f32_16x16x32_bf16 v[144:147], v[48:51], a[192:195], v[144:147]
    s_add_u32 s70, s70, 12288
    ds_read_b64_tr_b16 v[44:45], v11 offset:8192
    v_mfma_f32_16x16x32_bf16 v[176:179], v[48:51], a[196:199], v[176:179]
    s_waitcnt lgkmcnt(5)
    ds_read_b64_tr_b16 v[46:47], v11 offset:9216
    v_mfma_f32_16x16x32_bf16 v[208:211], v[48:51], a[200:203], v[208:211]
    buffer_load_dwordx4 v25, s[20:23], s98 offen offset:1024  lds
    v_mfma_f32_16x16x32_bf16 v[240:243], v[48:51], a[204:207], v[240:243]
    buffer_load_dwordx4 v[92:95], v96, s[8:11], s70 offen
    v_mfma_f32_16x16x32_bf16 v[148:151], v[52:55], a[192:195], v[148:151]
    ds_read_b64_tr_b16 v[48:49], v12 offset:8192
    v_mfma_f32_16x16x32_bf16 v[180:183], v[52:55], a[196:199], v[180:183]
    ds_read_b64_tr_b16 v[50:51], v12 offset:9216
    v_mfma_f32_16x16x32_bf16 v[212:215], v[52:55], a[200:203], v[212:215]
    buffer_load_dwordx4 v26, s[20:23], s98 offen offset:2048  lds
    v_mfma_f32_16x16x32_bf16 v[244:247], v[52:55], a[204:207], v[244:247]
    v_mfma_f32_16x16x32_bf16 v[152:155], v[56:59], a[192:195], v[152:155]
    ds_read_b64_tr_b16 v[52:53], v13 offset:8192
    v_mfma_f32_16x16x32_bf16 v[184:187], v[56:59], a[196:199], v[184:187]
    ds_read_b64_tr_b16 v[54:55], v13 offset:9216
    v_mfma_f32_16x16x32_bf16 v[216:219], v[56:59], a[200:203], v[216:219]
    buffer_load_dwordx4 v27, s[20:23], s98 offen offset:3072  lds
    v_mfma_f32_16x16x32_bf16 v[248:251], v[56:59], a[204:207], v[248:251]
    v_mfma_f32_16x16x32_bf16 v[156:159], v[60:63], a[192:195], v[156:159]
    ds_read_b64_tr_b16 v[56:57], v14 offset:8192
    v_mfma_f32_16x16x32_bf16 v[188:191], v[60:63], a[196:199], v[188:191]
    ds_read_b64_tr_b16 v[58:59], v14 offset:9216
    v_mfma_f32_16x16x32_bf16 v[220:223], v[60:63], a[200:203], v[220:223]
    v_mfma_f32_16x16x32_bf16 v[252:255], v[60:63], a[204:207], v[252:255]
    v_mfma_f32_16x16x32_bf16 v[128:131], v[32:35], a[208:211], v[128:131]
    ds_read_b64_tr_b16 v[60:61], v15 offset:8192
    v_mfma_f32_16x16x32_bf16 v[160:163], v[32:35], a[212:215], v[160:163]
    ds_read_b64_tr_b16 v[62:63], v15 offset:9216
    v_mfma_f32_16x16x32_bf16 v[192:195], v[32:35], a[216:219], v[192:195]
    s_getpc_b64 s[100:101]
L_ct1:
    s_lshr_b32 s99, s2, 3
    s_lshl_b32 s99, s99, 2
    s_add_u32 s99, s99, s3
    s_mul_i32 s99, s99, 2
    v_min_u32 v119, 1, v2
    v_add_u32 v119, s99, v119
    v_lshlrev_b32 v119, 7, v119
    v_add_u32 v119, L_ct1-L_ct1, v119
    v_min_u32 v119, L_attn-L_ct1, v119
    global_load_dword v119, v119, s[100:101]
    v_mfma_f32_16x16x32_bf16 v[224:227], v[32:35], a[220:223], v[224:227]
    s_waitcnt lgkmcnt(4)
    v_mfma_f32_16x16x32_bf16 v[132:135], v[36:39], a[208:211], v[132:135]
    v_mfma_f32_16x16x32_bf16 v[164:167], v[36:39], a[212:215], v[164:167]
    v_mfma_f32_16x16x32_bf16 v[196:199], v[36:39], a[216:219], v[196:199]
    v_mfma_f32_16x16x32_bf16 v[228:231], v[36:39], a[220:223], v[228:231]
    v_mfma_f32_16x16x32_bf16 v[136:139], v[40:43], a[208:211], v[136:139]
    s_waitcnt vmcnt(14) lgkmcnt(0)
    s_barrier
    v_mfma_f32_16x16x32_bf16 v[168:171], v[40:43], a[212:215], v[168:171]
    s_add_u32 m0, s62, 0
    s_xor_b32 s98, s64, 2097152
    ds_read_b64_tr_b16 v[32:33], v8 offset:16384
    v_mfma_f32_16x16x32_bf16 v[200:203], v[40:43], a[216:219], v[200:203]
    ds_read_b64_tr_b16 v[34:35], v8 offset:17408
    v_mfma_f32_16x16x32_bf16 v[232:235], v[40:43], a[220:223], v[232:235]
    ds_read_b64_tr_b16 v[36:37], v9 offset:16384
    v_mfma_f32_16x16x32_bf16 v[140:143], v[44:47], a[208:211], v[140:143]
    ds_read_b64_tr_b16 v[38:39], v9 offset:17408
    v_mfma_f32_16x16x32_bf16 v[172:175], v[44:47], a[212:215], v[172:175]
    ds_read_b64_tr_b16 v[40:41], v10 offset:16384
    v_mfma_f32_16x16x32_bf16 v[204:207], v[44:47], a[216:219], v[204:207]
    ds_read_b64_tr_b16 v[42:43], v10 offset:17408
    v_mfma_f32_16x16x32_bf16 v[236:239], v[44:47], a[220:223], v[236:239]
    ds_read_b128 a[224:227], v28 offset:32768
    v_mfma_f32_16x16x32_bf16 v[144:147], v[48:51], a[208:211], v[144:147]
    ds_read_b64_tr_b16 v[44:45], v11 offset:16384
    v_mfma_f32_16x16x32_bf16 v[176:179], v[48:51], a[212:215], v[176:179]
    ds_read_b64_tr_b16 v[46:47], v11 offset:17408
    v_mfma_f32_16x16x32_bf16 v[208:211], v[48:51], a[216:219], v[208:211]
    ds_read_b128 a[228:231], v28 offset:34816
    v_mfma_f32_16x16x32_bf16 v[240:243], v[48:51], a[220:223], v[240:243]
    ds_read_b128 a[232:235], v28 offset:36864
    v_mfma_f32_16x16x32_bf16 v[148:151], v[52:55], a[208:211], v[148:151]
    ds_read_b64_tr_b16 v[48:49], v12 offset:16384
    v_mfma_f32_16x16x32_bf16 v[180:183], v[52:55], a[212:215], v[180:183]
    ds_read_b64_tr_b16 v[50:51], v12 offset:17408
    v_mfma_f32_16x16x32_bf16 v[212:215], v[52:55], a[216:219], v[212:215]
    ds_read_b128 a[236:239], v28 offset:38912
    v_mfma_f32_16x16x32_bf16 v[244:247], v[52:55], a[220:223], v[244:247]
    buffer_load_dwordx4 v24, s[20:23], s98 offen offset:0  lds
    v_mfma_f32_16x16x32_bf16 v[152:155], v[56:59], a[208:211], v[152:155]
    ds_read_b64_tr_b16 v[52:53], v13 offset:16384
    v_mfma_f32_16x16x32_bf16 v[184:187], v[56:59], a[212:215], v[184:187]
    ds_read_b64_tr_b16 v[54:55], v13 offset:17408
    v_mfma_f32_16x16x32_bf16 v[216:219], v[56:59], a[216:219], v[216:219]
    v_mfma_f32_16x16x32_bf16 v[248:251], v[56:59], a[220:223], v[248:251]
    buffer_load_dwordx4 v25, s[20:23], s98 offen offset:1024  lds
    v_mfma_f32_16x16x32_bf16 v[156:159], v[60:63], a[208:211], v[156:159]
    ds_read_b64_tr_b16 v[56:57], v14 offset:16384
    v_mfma_f32_16x16x32_bf16 v[188:191], v[60:63], a[212:215], v[188:191]
    ds_read_b64_tr_b16 v[58:59], v14 offset:17408
    v_mfma_f32_16x16x32_bf16 v[220:223], v[60:63], a[216:219], v[220:223]
    s_waitcnt lgkmcnt(6)
    v_mfma_f32_16x16x32_bf16 v[252:255], v[60:63], a[220:223], v[252:255]
    buffer_load_dwordx4 v26, s[20:23], s98 offen offset:2048  lds
    v_mfma_f32_16x16x32_bf16 v[128:131], v[32:35], a[224:227], v[128:131]
    ds_read_b64_tr_b16 v[60:61], v15 offset:16384
    v_mfma_f32_16x16x32_bf16 v[160:163], v[32:35], a[228:231], v[160:163]
    ds_read_b64_tr_b16 v[62:63], v15 offset:17408
    v_mfma_f32_16x16x32_bf16 v[192:195], v[32:35], a[232:235], v[192:195]
    s_waitcnt lgkmcnt(5)
    ds_read_b128 a[240:243], v29 offset:32768
    v_mfma_f32_16x16x32_bf16 v[224:227], v[32:35], a[236:239], v[224:227]
    ds_read_b128 a[244:247], v29 offset:34816
    v_mfma_f32_16x16x32_bf16 v[132:135], v[36:39], a[224:227], v[132:135]
    ds_read_b64_tr_b16 v[32:33], v8 offset:24576
    v_mfma_f32_16x16x32_bf16 v[164:167], v[36:39], a[228:231], v[164:167]
    ds_read_b64_tr_b16 v[34:35], v8 offset:25600
    s_waitcnt vmcnt(10)
    v_add_f32 v80, v80, v84
    s_waitcnt vmcnt(6)
    v_add_f32 v88, v88, v92
    v_mfma_f32_16x16x32_bf16 v[196:199], v[36:39], a[232:235], v[196:199]
    ds_read_b128 a[248:251], v29 offset:36864
    v_add_f32 v81, v81, v85
    v_add_f32 v89, v89, v93
    v_mfma_f32_16x16x32_bf16 v[228:231], v[36:39], a[236:239], v[228:231]
    ds_read_b128 a[252:255], v29 offset:38912
    v_add_f32 v82, v82, v86
    v_add_f32 v90, v90, v94
    v_mfma_f32_16x16x32_bf16 v[136:139], v[40:43], a[224:227], v[136:139]
    ds_read_b64_tr_b16 v[36:37], v9 offset:24576
    v_and_b32 v16, 15, v2
    v_add_f32 v83, v83, v87
    v_mfma_f32_16x16x32_bf16 v[168:171], v[40:43], a[228:231], v[168:171]
    ds_read_b64_tr_b16 v[38:39], v9 offset:25600
    v_lshrrev_b32 v17, 4, v2
    v_add_f32 v91, v91, v95
    v_mfma_f32_16x16x32_bf16 v[200:203], v[40:43], a[232:235], v[200:203]
    v_lshrrev_b32 v29, 2, v16
    v_and_b32 v16, 3, v16
    v_add_f32 v80, v80, v88
    v_mfma_f32_16x16x32_bf16 v[232:235], v[40:43], a[236:239], v[232:235]
    buffer_load_dwordx4 v27, s[20:23], s98 offen offset:3072  lds
    v_add_f32 v81, v81, v89
    v_mfma_f32_16x16x32_bf16 v[140:143], v[44:47], a[224:227], v[140:143]
    s_add_u32 m0, s62, 4096
    ds_read_b64_tr_b16 v[40:41], v10 offset:24576
    v_lshl_add_u32 v28, v17, 3, v29
    v_add_f32 v82, v82, v90
    v_mfma_f32_16x16x32_bf16 v[172:175], v[44:47], a[228:231], v[172:175]
    s_xor_b32 s98, s64, 2359296
    ds_read_b64_tr_b16 v[42:43], v10 offset:25600
    v_lshlrev_b32 v28, 7, v28
    v_add_f32 v83, v83, v91
    v_mfma_f32_16x16x32_bf16 v[204:207], v[44:47], a[232:235], v[204:207]
    v_lshl_add_u32 v28, v16, 3, v28
    v_and_b32 v17, 1, v17
    v_lshrrev_b32 v88, 5, v2
    v_mfma_f32_16x16x32_bf16 v[236:239], v[44:47], a[236:239], v[236:239]
    buffer_load_dwordx4 v24, s[20:23], s98 offen offset:0  lds
    v_cvt_f32_u32 v88, v88
    v_mfma_f32_16x16x32_bf16 v[144:147], v[48:51], a[224:227], v[144:147]
    ds_read_b64_tr_b16 v[44:45], v11 offset:24576
    v_lshrrev_b32 v29, 1, v29
    v_cvt_pk_bf16_f32 v84, v80, v81
    v_mfma_f32_16x16x32_bf16 v[176:179], v[48:51], a[228:231], v[176:179]
    ds_read_b64_tr_b16 v[46:47], v11 offset:25600
    v_lshl_add_u32 v29, v17, 1, v29
    v_cvt_pk_bf16_f32 v85, v82, v83
    v_mfma_f32_16x16x32_bf16 v[208:211], v[48:51], a[232:235], v[208:211]
    s_waitcnt lgkmcnt(5)
    v_lshl_add_u32 v28, v29, 5, v28
    v_add_u32 v28, 65536, v28
    v_lshlrev_b32 v80, 16, v84
    v_mfma_f32_16x16x32_bf16 v[240:243], v[48:51], a[236:239], v[240:243]
    buffer_load_dwordx4 v25, s[20:23], s98 offen offset:1024  lds
    v_and_b32 v81, 0xffff0000, v84
    v_mfma_f32_16x16x32_bf16 v[148:151], v[52:55], a[224:227], v[148:151]
    ds_read_b64_tr_b16 v[48:49], v12 offset:24576
    v_xor_b32 v29, 32, v28
    v_lshlrev_b32 v82, 16, v85
    v_mfma_f32_16x16x32_bf16 v[180:183], v[52:55], a[228:231], v[180:183]
    ds_read_b64_tr_b16 v[50:51], v12 offset:25600
    v_xor_b32 v30, 64, v28
    v_and_b32 v83, 0xffff0000, v85
    v_mfma_f32_16x16x32_bf16 v[212:215], v[52:55], a[232:235], v[212:215]
    v_xor_b32 v31, 96, v28
    v_and_b32 v16, 15, v2
    v_add_f32 v80, v80, v88
    v_mfma_f32_16x16x32_bf16 v[244:247], v[52:55], a[236:239], v[244:247]
    buffer_load_dwordx4 v26, s[20:23], s98 offen offset:2048  lds
    v_add_f32 v81, v81, v88
    v_mfma_f32_16x16x32_bf16 v[152:155], v[56:59], a[224:227], v[152:155]
    ds_read_b64_tr_b16 v[52:53], v13 offset:24576
    v_lshlrev_b32 v16, 6, v16
    v_add_f32 v82, v82, v88
    v_mfma_f32_16x16x32_bf16 v[184:187], v[56:59], a[228:231], v[184:187]
    ds_read_b64_tr_b16 v[54:55], v13 offset:25600
    v_add_u32 v16, 65536, v16
    v_add_f32 v83, v83, v88
    v_mfma_f32_16x16x32_bf16 v[216:219], v[56:59], a[232:235], v[216:219]
    v_mad_i32_i24 v16, v17, s77, v16
    v_and_b32 v17, 31, v2
    v_cvt_pk_bf16_f32 v84, v80, v81
    v_mfma_f32_16x16x32_bf16 v[248:251], v[56:59], a[236:239], v[248:251]
    buffer_load_dwordx4 v27, s[20:23], s98 offen offset:3072  lds
    v_cvt_pk_bf16_f32 v85, v82, v83
    v_mfma_f32_16x16x32_bf16 v[156:159], v[60:63], a[224:227], v[156:159]
    ds_read_b64_tr_b16 v[56:57], v14 offset:24576
    v_lshlrev_b32 v17, 6, v17
    v_lshlrev_b32 v80, 16, v84
    v_mfma_f32_16x16x32_bf16 v[188:191], v[60:63], a[228:231], v[188:191]
    ds_read_b64_tr_b16 v[58:59], v14 offset:25600
    v_and_b32 v81, 0xffff0000, v84
    v_lshlrev_b32 v82, 16, v85
    v_mfma_f32_16x16x32_bf16 v[220:223], v[60:63], a[232:235], v[220:223]
    v_and_b32 v83, 0xffff0000, v85
    v_mul_f32 v80, 0x3e0293ee, v80
    v_mul_f32 v81, 0x3e0293ee, v81
    v_mfma_f32_16x16x32_bf16 v[252:255], v[60:63], a[236:239], v[252:255]
    v_mul_f32 v82, 0x3e0293ee, v82
    v_mul_f32 v83, 0x3e0293ee, v83
    v_mfma_f32_16x16x32_bf16 v[128:131], v[32:35], a[240:243], v[128:131]
    s_lshl_b32 s70, s3, 10
    s_add_u32 s70, s70, 151552
    ds_read_b64_tr_b16 v[60:61], v15 offset:24576
    v_add_u32 v88, s70, v1
    v_add_u32 v18, s70, v18
    v_mfma_f32_16x16x32_bf16 v[160:163], v[32:35], a[244:247], v[160:163]
    ds_read_b64_tr_b16 v[62:63], v15 offset:25600
    ds_write_b128 v88, v[80:83]
    v_mfma_f32_16x16x32_bf16 v[192:195], v[32:35], a[248:251], v[192:195]
    v_mfma_f32_16x16x32_bf16 v[224:227], v[32:35], a[252:255], v[224:227]
    s_waitcnt lgkmcnt(5)
    v_mfma_f32_16x16x32_bf16 v[132:135], v[36:39], a[240:243], v[132:135]
    v_mfma_f32_16x16x32_bf16 v[164:167], v[36:39], a[244:247], v[164:167]
    v_mfma_f32_16x16x32_bf16 v[196:199], v[36:39], a[248:251], v[196:199]
    v_mfma_f32_16x16x32_bf16 v[228:231], v[36:39], a[252:255], v[228:231]
    ds_read_b128 v[80:83], v18 offset:0
    v_mfma_f32_16x16x32_bf16 v[136:139], v[40:43], a[240:243], v[136:139]
    ds_read_b128 v[84:87], v18 offset:16
    s_waitcnt vmcnt(9) lgkmcnt(0)
    s_barrier
    v_mfma_f32_16x16x32_bf16 v[168:171], v[40:43], a[244:247], v[168:171]
    s_add_u32 m0, s62, 32768
    s_xor_b32 s98, s64, 128
    ds_read_b64_tr_b16 v[32:33], v28 offset:0
    v_mfma_f32_16x16x32_bf16 v[200:203], v[40:43], a[248:251], v[200:203]
    ds_read_b64_tr_b16 v[34:35], v28 offset:512
    v_mfma_f32_16x16x32_bf16 v[232:235], v[40:43], a[252:255], v[232:235]
    ds_read_b64_tr_b16 v[36:37], v28 offset:4096
    v_mfma_f32_16x16x32_bf16 v[140:143], v[44:47], a[240:243], v[140:143]
    ds_read_b64_tr_b16 v[38:39], v28 offset:4608
    v_mfma_f32_16x16x32_bf16 v[172:175], v[44:47], a[244:247], v[172:175]
    ds_read_b64_tr_b16 v[40:41], v29 offset:0
    v_mfma_f32_16x16x32_bf16 v[204:207], v[44:47], a[248:251], v[204:207]
    ds_read_b64_tr_b16 v[42:43], v29 offset:512
    v_mfma_f32_16x16x32_bf16 v[236:239], v[44:47], a[252:255], v[236:239]
    buffer_load_dwordx4 v24, s[20:23], s98 offen offset:0  lds
    v_mfma_f32_16x16x32_bf16 v[144:147], v[48:51], a[240:243], v[144:147]
    ds_read_b64_tr_b16 v[44:45], v29 offset:4096
    v_mfma_f32_16x16x32_bf16 v[176:179], v[48:51], a[244:247], v[176:179]
    ds_read_b64_tr_b16 v[46:47], v29 offset:4608
    v_mfma_f32_16x16x32_bf16 v[208:211], v[48:51], a[248:251], v[208:211]
    ds_read_b128 v[88:91], v18 offset:512
    v_mfma_f32_16x16x32_bf16 v[240:243], v[48:51], a[252:255], v[240:243]
    buffer_load_dwordx4 v25, s[20:23], s98 offen offset:1024  lds
    v_mfma_f32_16x16x32_bf16 v[148:151], v[52:55], a[240:243], v[148:151]
    ds_read_b64_tr_b16 v[48:49], v28 offset:8192
    v_mfma_f32_16x16x32_bf16 v[180:183], v[52:55], a[244:247], v[180:183]
    ds_read_b64_tr_b16 v[50:51], v28 offset:8704
    v_mfma_f32_16x16x32_bf16 v[212:215], v[52:55], a[248:251], v[212:215]
    ds_read_b128 v[92:95], v18 offset:528
    v_mfma_f32_16x16x32_bf16 v[244:247], v[52:55], a[252:255], v[244:247]
    buffer_load_dwordx4 v26, s[20:23], s98 offen offset:2048  lds
    v_mfma_f32_16x16x32_bf16 v[152:155], v[56:59], a[240:243], v[152:155]
    ds_read_b64_tr_b16 v[52:53], v28 offset:12288
    v_mfma_f32_16x16x32_bf16 v[184:187], v[56:59], a[244:247], v[184:187]
    ds_read_b64_tr_b16 v[54:55], v28 offset:12800
    v_mfma_f32_16x16x32_bf16 v[216:219], v[56:59], a[248:251], v[216:219]
    v_mfma_f32_16x16x32_bf16 v[248:251], v[56:59], a[252:255], v[248:251]
    buffer_load_dwordx4 v27, s[20:23], s98 offen offset:3072  lds
    v_mfma_f32_16x16x32_bf16 v[156:159], v[60:63], a[240:243], v[156:159]
    s_add_u32 m0, s62, 36864
    s_xor_b32 s98, s64, 262272
    ds_read_b64_tr_b16 v[56:57], v29 offset:8192
    v_mfma_f32_16x16x32_bf16 v[188:191], v[60:63], a[244:247], v[188:191]
    ds_read_b64_tr_b16 v[58:59], v29 offset:8704
    s_waitcnt lgkmcnt(7)
    v_fma_f32 v64, v64, v88, v80
    v_mfma_f32_16x16x32_bf16 v[220:223], v[60:63], a[248:251], v[220:223]
    v_fma_f32 v65, v65, v89, v81
    v_fma_f32 v66, v66, v90, v82
    v_mfma_f32_16x16x32_bf16 v[252:255], v[60:63], a[252:255], v[252:255]
    buffer_load_dwordx4 v24, s[20:23], s98 offen offset:0  lds
    v_mfma_f32_16x16x32_bf16 v[96:99], a[0:3], v[32:35], 0
    ds_read_b64_tr_b16 v[60:61], v29 offset:12288
    v_fma_f32 v67, v67, v91, v83
    v_mfma_f32_16x16x32_bf16 v[96:99], a[16:19], v[36:39], v[96:99]
    ds_read_b64_tr_b16 v[62:63], v29 offset:12800
    s_waitcnt lgkmcnt(6)
    v_fma_f32 v68, v68, v92, v84
    v_mfma_f32_16x16x32_bf16 v[100:103], a[4:7], v[32:35], 0
    v_fma_f32 v69, v69, v93, v85
    v_fma_f32 v70, v70, v94, v86
    v_mfma_f32_16x16x32_bf16 v[100:103], a[20:23], v[36:39], v[100:103]
    buffer_load_dwordx4 v25, s[20:23], s98 offen offset:1024  lds
    v_mfma_f32_16x16x32_bf16 v[104:107], a[8:11], v[32:35], 0
    v_fma_f32 v71, v71, v95, v87
    v_mfma_f32_16x16x32_bf16 v[104:107], a[24:27], v[36:39], v[104:107]
    v_cvt_pk_bf16_f32 v64, v64, v65
    v_cvt_pk_bf16_f32 v65, v66, v67
    v_mfma_f32_16x16x32_bf16 v[108:111], a[12:15], v[32:35], 0
    v_cvt_pk_bf16_f32 v66, v68, v69
    v_cvt_pk_bf16_f32 v67, v70, v71
    v_mfma_f32_16x16x32_bf16 v[108:111], a[28:31], v[36:39], v[108:111]
    buffer_load_dwordx4 v26, s[20:23], s98 offen offset:2048  lds
    v_mfma_f32_16x16x32_bf16 v[112:115], a[0:3], v[40:43], 0
    ds_read_b64_tr_b16 v[32:33], v28 offset:16384
    v_cvt_pk_bf16_f32 v128, v128, v129
    v_mfma_f32_16x16x32_bf16 v[112:115], a[16:19], v[44:47], v[112:115]
    s_waitcnt vmcnt(15)
    ds_read_b64_tr_b16 v[34:35], v28 offset:16896
    v_cvt_pk_bf16_f32 v129, v130, v131
    v_mfma_f32_16x16x32_bf16 v[116:119], a[4:7], v[40:43], 0
    ds_read_b64_tr_b16 v[36:37], v28 offset:20480
    v_cvt_pk_bf16_f32 v130, v132, v133
    v_mfma_f32_16x16x32_bf16 v[116:119], a[20:23], v[44:47], v[116:119]
    ds_read_b64_tr_b16 v[38:39], v28 offset:20992
    v_cvt_pk_bf16_f32 v131, v134, v135
    v_mfma_f32_16x16x32_bf16 v[120:123], a[8:11], v[40:43], 0
    buffer_load_dwordx4 v27, s[20:23], s98 offen offset:3072  lds
    v_mfma_f32_16x16x32_bf16 v[120:123], a[24:27], v[44:47], v[120:123]
    s_add_u32 m0, s63, 131072
    s_xor_b32 s98, s0, 0
    ds_read_b128 v[80:83], v18 offset:256
    v_mfma_f32_16x16x32_bf16 v[124:127], a[12:15], v[40:43], 0
    buffer_store_dwordx4 v[64:67], v19, s[8:11], s71 offen offset:0 sc0 sc1
    v_mfma_f32_16x16x32_bf16 v[124:127], a[28:31], v[44:47], v[124:127]
    s_xor_b32 s79, s65, 0
    ds_read_b128 v[84:87], v18 offset:272
    v_mfma_f32_16x16x32_bf16 v[96:99], a[32:35], v[48:51], v[96:99]
    s_waitcnt lgkmcnt(6)
    ds_read_b64_tr_b16 v[40:41], v29 offset:16384
    v_mfma_f32_16x16x32_bf16 v[96:99], a[48:51], v[52:55], v[96:99]
    ds_read_b64_tr_b16 v[42:43], v29 offset:16896
    v_mfma_f32_16x16x32_bf16 v[100:103], a[36:39], v[48:51], v[100:103]
    ds_read_b64_tr_b16 v[44:45], v29 offset:20480
    v_mfma_f32_16x16x32_bf16 v[100:103], a[52:55], v[52:55], v[100:103]
    ds_read_b64_tr_b16 v[46:47], v29 offset:20992
    v_mfma_f32_16x16x32_bf16 v[104:107], a[40:43], v[48:51], v[104:107]
    buffer_load_dwordx4 v20, s[24:27], s98 offen offset:0  lds
    v_mfma_f32_16x16x32_bf16 v[104:107], a[56:59], v[52:55], v[104:107]
    s_lshr_b32 s100, s2, 3
    s_mul_i32 s66, s4, 28
    ds_read_b128 v[88:91], v18 offset:768
    v_mfma_f32_16x16x32_bf16 v[108:111], a[44:47], v[48:51], v[108:111]
    s_add_u32 s66, s66, s100
    s_cmp_lt_u32 s100, 28
    s_cselect_b32 s66, s66, 255
    ds_read_b128 v[92:95], v18 offset:784
    v_mfma_f32_16x16x32_bf16 v[108:111], a[60:63], v[52:55], v[108:111]
    buffer_store_dwordx4 v[128:131], v1, s[8:11], s79 offen offset:0 sc0 sc1
    v_mfma_f32_16x16x32_bf16 v[112:115], a[32:35], v[56:59], v[112:115]
    s_lshl_b32 s67, s4, 3
    s_add_u32 s67, s67, s100
    ds_read_b64_tr_b16 v[48:49], v28 offset:24576
    v_mfma_f32_16x16x32_bf16 v[112:115], a[48:51], v[60:63], v[112:115]
    s_sub_u32 s67, s67, 24
    ds_read_b64_tr_b16 v[50:51], v28 offset:25088
    v_cvt_pk_bf16_f32 v136, v136, v137
    v_mfma_f32_16x16x32_bf16 v[116:119], a[36:39], v[56:59], v[116:119]
    s_cmp_ge_u32 s100, 24
    s_cselect_b32 s67, s67, 255
    ds_read_b64_tr_b16 v[52:53], v28 offset:28672
    v_cvt_pk_bf16_f32 v137, v138, v139
    v_mfma_f32_16x16x32_bf16 v[116:119], a[52:55], v[60:63], v[116:119]
    ds_read_b64_tr_b16 v[54:55], v28 offset:29184
    v_cvt_pk_bf16_f32 v138, v140, v141
    v_mfma_f32_16x16x32_bf16 v[120:123], a[40:43], v[56:59], v[120:123]
    buffer_load_dwordx4 v21, s[24:27], s98 offen offset:1024  lds
    v_mfma_f32_16x16x32_bf16 v[120:123], a[56:59], v[60:63], v[120:123]
    s_waitcnt lgkmcnt(5)
    v_fma_f32 v72, v72, v88, v80
    v_fma_f32 v73, v73, v89, v81
    v_mfma_f32_16x16x32_bf16 v[124:127], a[44:47], v[56:59], v[124:127]
    v_fma_f32 v74, v74, v90, v82
    v_fma_f32 v75, v75, v91, v83
    v_mfma_f32_16x16x32_bf16 v[124:127], a[60:63], v[60:63], v[124:127]
    v_cvt_pk_bf16_f32 v139, v142, v143
    v_mfma_f32_16x16x32_bf16 v[96:99], a[64:67], v[32:35], v[96:99]
    s_xor_b32 s79, s65, 0
    ds_read_b64_tr_b16 v[56:57], v29 offset:24576
    s_waitcnt lgkmcnt(5)
    v_fma_f32 v76, v76, v92, v84
    v_mfma_f32_16x16x32_bf16 v[96:99], a[80:83], v[36:39], v[96:99]
    ds_read_b64_tr_b16 v[58:59], v29 offset:25088
    v_fma_f32 v77, v77, v93, v85
    v_mfma_f32_16x16x32_bf16 v[100:103], a[68:71], v[32:35], v[100:103]
    ds_read_b64_tr_b16 v[60:61], v29 offset:28672
    v_fma_f32 v78, v78, v94, v86
    v_mfma_f32_16x16x32_bf16 v[100:103], a[84:87], v[36:39], v[100:103]
    ds_read_b64_tr_b16 v[62:63], v29 offset:29184
    v_fma_f32 v79, v79, v95, v87
    v_mfma_f32_16x16x32_bf16 v[104:107], a[72:75], v[32:35], v[104:107]
    buffer_load_dwordx4 v22, s[24:27], s98 offen offset:2048  lds
    v_mfma_f32_16x16x32_bf16 v[104:107], a[88:91], v[36:39], v[104:107]
    v_cvt_pk_bf16_f32 v72, v72, v73
    v_cvt_pk_bf16_f32 v73, v74, v75
    v_mfma_f32_16x16x32_bf16 v[108:111], a[76:79], v[32:35], v[108:111]
    v_cvt_pk_bf16_f32 v74, v76, v77
    v_cvt_pk_bf16_f32 v75, v78, v79
    v_mfma_f32_16x16x32_bf16 v[108:111], a[92:95], v[36:39], v[108:111]
    buffer_store_dwordx4 v[72:75], v19, s[8:11], s71 offen offset:2048 sc0 sc1
    v_mfma_f32_16x16x32_bf16 v[112:115], a[64:67], v[40:43], v[112:115]
    ds_read_b64_tr_b16 v[32:33], v30 offset:0
    v_mfma_f32_16x16x32_bf16 v[112:115], a[80:83], v[44:47], v[112:115]
    ds_read_b64_tr_b16 v[34:35], v30 offset:512
    v_mfma_f32_16x16x32_bf16 v[116:119], a[68:71], v[40:43], v[116:119]
    ds_read_b64_tr_b16 v[36:37], v30 offset:4096
    v_mfma_f32_16x16x32_bf16 v[116:119], a[84:87], v[44:47], v[116:119]
    ds_read_b64_tr_b16 v[38:39], v30 offset:4608
    v_mfma_f32_16x16x32_bf16 v[120:123], a[72:75], v[40:43], v[120:123]
    buffer_load_dwordx4 v23, s[24:27], s98 offen offset:3072  lds
    v_mfma_f32_16x16x32_bf16 v[120:123], a[88:91], v[44:47], v[120:123]
    s_add_u32 m0, s63, 98304
    s_xor_b32 s98, s0, 524288
    v_mfma_f32_16x16x32_bf16 v[124:127], a[76:79], v[40:43], v[124:127]
    buffer_store_dwordx4 v[136:139], v1, s[8:11], s79 offen offset:1024 sc0 sc1
    v_mfma_f32_16x16x32_bf16 v[124:127], a[92:95], v[44:47], v[124:127]
    s_waitcnt lgkmcnt(4)
    v_mfma_f32_16x16x32_bf16 v[96:99], a[96:99], v[48:51], v[96:99]
    ds_read_b64_tr_b16 v[40:41], v31 offset:0
    v_cvt_pk_bf16_f32 v144, v144, v145
    v_mfma_f32_16x16x32_bf16 v[96:99], a[112:115], v[52:55], v[96:99]
    ds_read_b64_tr_b16 v[42:43], v31 offset:512
    v_cvt_pk_bf16_f32 v145, v146, v147
    v_mfma_f32_16x16x32_bf16 v[100:103], a[100:103], v[48:51], v[100:103]
    ds_read_b64_tr_b16 v[44:45], v31 offset:4096
    v_cvt_pk_bf16_f32 v146, v148, v149
    v_mfma_f32_16x16x32_bf16 v[100:103], a[116:119], v[52:55], v[100:103]
    ds_read_b64_tr_b16 v[46:47], v31 offset:4608
    v_cvt_pk_bf16_f32 v147, v150, v151
    v_mfma_f32_16x16x32_bf16 v[104:107], a[104:107], v[48:51], v[104:107]
    buffer_load_dwordx4 v20, s[24:27], s98 offen offset:0  lds
    v_mfma_f32_16x16x32_bf16 v[104:107], a[120:123], v[52:55], v[104:107]
    s_xor_b32 s79, s65, 0
    v_mfma_f32_16x16x32_bf16 v[108:111], a[108:111], v[48:51], v[108:111]
    buffer_store_dwordx4 v[144:147], v1, s[8:11], s79 offen offset:2048 sc0 sc1
    v_mfma_f32_16x16x32_bf16 v[108:111], a[124:127], v[52:55], v[108:111]
    v_mfma_f32_16x16x32_bf16 v[112:115], a[96:99], v[56:59], v[112:115]
    ds_read_b64_tr_b16 v[48:49], v30 offset:8192
    v_mfma_f32_16x16x32_bf16 v[112:115], a[112:115], v[60:63], v[112:115]
    ds_read_b64_tr_b16 v[50:51], v30 offset:8704
    v_mfma_f32_16x16x32_bf16 v[116:119], a[100:103], v[56:59], v[116:119]
    ds_read_b64_tr_b16 v[52:53], v30 offset:12288
    v_mfma_f32_16x16x32_bf16 v[116:119], a[116:119], v[60:63], v[116:119]
    ds_read_b64_tr_b16 v[54:55], v30 offset:12800
    v_cvt_pk_bf16_f32 v152, v152, v153
    v_mfma_f32_16x16x32_bf16 v[120:123], a[104:107], v[56:59], v[120:123]
    buffer_load_dwordx4 v21, s[24:27], s98 offen offset:1024  lds
    v_mfma_f32_16x16x32_bf16 v[120:123], a[120:123], v[60:63], v[120:123]
    v_cvt_pk_bf16_f32 v153, v154, v155
    v_cvt_pk_bf16_f32 v154, v156, v157
    v_mfma_f32_16x16x32_bf16 v[124:127], a[108:111], v[56:59], v[124:127]
    v_cvt_pk_bf16_f32 v155, v158, v159
    v_mfma_f32_16x16x32_bf16 v[124:127], a[124:127], v[60:63], v[124:127]
    s_waitcnt lgkmcnt(4)
    v_mfma_f32_16x16x32_bf16 v[64:67], a[0:3], v[32:35], 0
    s_xor_b32 s79, s65, 0
    ds_read_b64_tr_b16 v[56:57], v31 offset:8192
    v_mfma_f32_16x16x32_bf16 v[64:67], a[16:19], v[36:39], v[64:67]
    ds_read_b64_tr_b16 v[58:59], v31 offset:8704
    v_mfma_f32_16x16x32_bf16 v[68:71], a[4:7], v[32:35], 0
    ds_read_b64_tr_b16 v[60:61], v31 offset:12288
    v_mfma_f32_16x16x32_bf16 v[68:71], a[20:23], v[36:39], v[68:71]
    ds_read_b64_tr_b16 v[62:63], v31 offset:12800
    v_mfma_f32_16x16x32_bf16 v[72:75], a[8:11], v[32:35], 0
    buffer_load_dwordx4 v22, s[24:27], s98 offen offset:2048  lds
    v_mfma_f32_16x16x32_bf16 v[72:75], a[24:27], v[36:39], v[72:75]
    buffer_store_dwordx4 v[152:155], v1, s[8:11], s79 offen offset:3072 sc0 sc1
    v_mfma_f32_16x16x32_bf16 v[76:79], a[12:15], v[32:35], 0
    v_mfma_f32_16x16x32_bf16 v[76:79], a[28:31], v[36:39], v[76:79]
    v_mfma_f32_16x16x32_bf16 v[80:83], a[0:3], v[40:43], 0
    ds_read_b64_tr_b16 v[32:33], v30 offset:16384
    v_mfma_f32_16x16x32_bf16 v[80:83], a[16:19], v[44:47], v[80:83]
    ds_read_b64_tr_b16 v[34:35], v30 offset:16896
    v_mfma_f32_16x16x32_bf16 v[84:87], a[4:7], v[40:43], 0
    ds_read_b64_tr_b16 v[36:37], v30 offset:20480
    v_mfma_f32_16x16x32_bf16 v[84:87], a[20:23], v[44:47], v[84:87]
    ds_read_b64_tr_b16 v[38:39], v30 offset:20992
    v_mfma_f32_16x16x32_bf16 v[88:91], a[8:11], v[40:43], 0
    buffer_load_dwordx4 v23, s[24:27], s98 offen offset:3072  lds
    v_mfma_f32_16x16x32_bf16 v[88:91], a[24:27], v[44:47], v[88:91]
    v_cvt_pk_bf16_f32 v160, v160, v161
    v_cvt_pk_bf16_f32 v161, v162, v163
    v_mfma_f32_16x16x32_bf16 v[92:95], a[12:15], v[40:43], 0
    v_cvt_pk_bf16_f32 v162, v164, v165
    v_cvt_pk_bf16_f32 v163, v166, v167
    v_mfma_f32_16x16x32_bf16 v[92:95], a[28:31], v[44:47], v[92:95]
    s_waitcnt lgkmcnt(4)
    v_mfma_f32_16x16x32_bf16 v[64:67], a[32:35], v[48:51], v[64:67]
    s_xor_b32 s79, s65, 4096
    ds_read_b64_tr_b16 v[40:41], v31 offset:16384
    v_mfma_f32_16x16x32_bf16 v[64:67], a[48:51], v[52:55], v[64:67]
    ds_read_b64_tr_b16 v[42:43], v31 offset:16896
    v_mfma_f32_16x16x32_bf16 v[68:71], a[36:39], v[48:51], v[68:71]
    ds_read_b64_tr_b16 v[44:45], v31 offset:20480
    v_mfma_f32_16x16x32_bf16 v[68:71], a[52:55], v[52:55], v[68:71]
    ds_read_b64_tr_b16 v[46:47], v31 offset:20992
    v_mfma_f32_16x16x32_bf16 v[72:75], a[40:43], v[48:51], v[72:75]
    buffer_store_dwordx4 v[160:163], v1, s[8:11], s79 offen offset:0 sc0 sc1
    v_mfma_f32_16x16x32_bf16 v[72:75], a[56:59], v[52:55], v[72:75]
    v_mfma_f32_16x16x32_bf16 v[76:79], a[44:47], v[48:51], v[76:79]
    v_mfma_f32_16x16x32_bf16 v[76:79], a[60:63], v[52:55], v[76:79]
    v_mfma_f32_16x16x32_bf16 v[80:83], a[32:35], v[56:59], v[80:83]
    ds_read_b64_tr_b16 v[48:49], v30 offset:24576
    v_mfma_f32_16x16x32_bf16 v[80:83], a[48:51], v[60:63], v[80:83]
    ds_read_b64_tr_b16 v[50:51], v30 offset:25088
    v_mfma_f32_16x16x32_bf16 v[84:87], a[36:39], v[56:59], v[84:87]
    ds_read_b64_tr_b16 v[52:53], v30 offset:28672
    v_mfma_f32_16x16x32_bf16 v[84:87], a[52:55], v[60:63], v[84:87]
    ds_read_b64_tr_b16 v[54:55], v30 offset:29184
    v_mfma_f32_16x16x32_bf16 v[88:91], a[40:43], v[56:59], v[88:91]
    v_mfma_f32_16x16x32_bf16 v[88:91], a[56:59], v[60:63], v[88:91]
    v_cvt_pk_bf16_f32 v168, v168, v169
    v_cvt_pk_bf16_f32 v169, v170, v171
    v_mfma_f32_16x16x32_bf16 v[92:95], a[44:47], v[56:59], v[92:95]
    v_cvt_pk_bf16_f32 v170, v172, v173
    v_cvt_pk_bf16_f32 v171, v174, v175
    v_mfma_f32_16x16x32_bf16 v[92:95], a[60:63], v[60:63], v[92:95]
    s_waitcnt lgkmcnt(4)
    v_mfma_f32_16x16x32_bf16 v[64:67], a[64:67], v[32:35], v[64:67]
    s_xor_b32 s79, s65, 4096
    ds_read_b64_tr_b16 v[56:57], v31 offset:24576
    v_mfma_f32_16x16x32_bf16 v[64:67], a[80:83], v[36:39], v[64:67]
    ds_read_b64_tr_b16 v[58:59], v31 offset:25088
    v_mfma_f32_16x16x32_bf16 v[68:71], a[68:71], v[32:35], v[68:71]
    ds_read_b64_tr_b16 v[60:61], v31 offset:28672
    v_mfma_f32_16x16x32_bf16 v[68:71], a[84:87], v[36:39], v[68:71]
    ds_read_b64_tr_b16 v[62:63], v31 offset:29184
    v_mfma_f32_16x16x32_bf16 v[72:75], a[72:75], v[32:35], v[72:75]
    buffer_store_dwordx4 v[168:171], v1, s[8:11], s79 offen offset:1024 sc0 sc1
    v_mfma_f32_16x16x32_bf16 v[72:75], a[88:91], v[36:39], v[72:75]
    v_mfma_f32_16x16x32_bf16 v[76:79], a[76:79], v[32:35], v[76:79]
    v_mfma_f32_16x16x32_bf16 v[76:79], a[92:95], v[36:39], v[76:79]
    v_mfma_f32_16x16x32_bf16 v[80:83], a[64:67], v[40:43], v[80:83]
    v_mfma_f32_16x16x32_bf16 v[80:83], a[80:83], v[44:47], v[80:83]
    v_mfma_f32_16x16x32_bf16 v[84:87], a[68:71], v[40:43], v[84:87]
    v_mfma_f32_16x16x32_bf16 v[84:87], a[84:87], v[44:47], v[84:87]
    v_mfma_f32_16x16x32_bf16 v[88:91], a[72:75], v[40:43], v[88:91]
    v_mfma_f32_16x16x32_bf16 v[88:91], a[88:91], v[44:47], v[88:91]
    s_waitcnt vmcnt(10)
    v_mfma_f32_16x16x32_bf16 v[92:95], a[76:79], v[40:43], v[92:95]
    v_xor_b32 v28, 65536, v28
    v_cvt_pk_bf16_f32 v176, v176, v177
    s_waitcnt lgkmcnt(0)
    s_barrier
    v_mfma_f32_16x16x32_bf16 v[92:95], a[92:95], v[44:47], v[92:95]
    s_add_u32 m0, s62, 65536
    ds_read_b64_tr_b16 v[32:33], v28 offset:0
    v_xor_b32 v29, 65536, v29
    v_mfma_f32_16x16x32_bf16 v[64:67], a[96:99], v[48:51], v[64:67]
    s_xor_b32 s98, s64, 2097280
    ds_read_b64_tr_b16 v[34:35], v28 offset:512
    v_cvt_pk_bf16_f32 v177, v178, v179
    v_mfma_f32_16x16x32_bf16 v[64:67], a[112:115], v[52:55], v[64:67]
    ds_read_b64_tr_b16 v[36:37], v28 offset:4096
    v_cvt_pk_bf16_f32 v178, v180, v181
    v_mfma_f32_16x16x32_bf16 v[68:71], a[100:103], v[48:51], v[68:71]
    ds_read_b64_tr_b16 v[38:39], v28 offset:4608
    v_cvt_pk_bf16_f32 v179, v182, v183
    v_mfma_f32_16x16x32_bf16 v[68:71], a[116:119], v[52:55], v[68:71]
    s_xor_b32 s79, s65, 4096
    ds_read_b64_tr_b16 v[40:41], v29 offset:0
    v_mfma_f32_16x16x32_bf16 v[72:75], a[104:107], v[48:51], v[72:75]
    ds_read_b64_tr_b16 v[42:43], v29 offset:512
    v_mfma_f32_16x16x32_bf16 v[72:75], a[120:123], v[52:55], v[72:75]
    ds_read_b64_tr_b16 v[44:45], v29 offset:4096
    v_mfma_f32_16x16x32_bf16 v[76:79], a[108:111], v[48:51], v[76:79]
    ds_read_b64_tr_b16 v[46:47], v29 offset:4608
    v_mfma_f32_16x16x32_bf16 v[76:79], a[124:127], v[52:55], v[76:79]
    buffer_load_dwordx4 v24, s[20:23], s98 offen offset:0  lds
    v_mfma_f32_16x16x32_bf16 v[80:83], a[96:99], v[56:59], v[80:83]
    ds_read_b64_tr_b16 v[48:49], v28 offset:8192
    v_mfma_f32_16x16x32_bf16 v[80:83], a[112:115], v[60:63], v[80:83]
    ds_read_b64_tr_b16 v[50:51], v28 offset:8704
    v_mfma_f32_16x16x32_bf16 v[84:87], a[100:103], v[56:59], v[84:87]
    ds_read_b64_tr_b16 v[52:53], v28 offset:12288
    v_mfma_f32_16x16x32_bf16 v[84:87], a[116:119], v[60:63], v[84:87]
    ds_read_b64_tr_b16 v[54:55], v28 offset:12800
    v_mfma_f32_16x16x32_bf16 v[88:91], a[104:107], v[56:59], v[88:91]
    buffer_load_dwordx4 v25, s[20:23], s98 offen offset:1024  lds
    v_mfma_f32_16x16x32_bf16 v[88:91], a[120:123], v[60:63], v[88:91]
    buffer_store_dword v6, v5, s[8:11], s72 offen sc0 sc1
    v_mfma_f32_16x16x32_bf16 v[92:95], a[108:111], v[56:59], v[92:95]
    buffer_store_dwordx4 v[176:179], v1, s[8:11], s79 offen offset:2048 sc0 sc1
    v_mfma_f32_16x16x32_bf16 v[92:95], a[124:127], v[60:63], v[92:95]
    s_waitcnt lgkmcnt(5)
    v_mfma_f32_16x16x32_bf16 v[96:99], a[128:131], v[32:35], v[96:99]
    ds_read_b64_tr_b16 v[56:57], v29 offset:8192
    v_cvt_pk_bf16_f32 v184, v184, v185
    v_mfma_f32_16x16x32_bf16 v[96:99], a[144:147], v[36:39], v[96:99]
    ds_read_b64_tr_b16 v[58:59], v29 offset:8704
    v_cvt_pk_bf16_f32 v185, v186, v187
    v_mfma_f32_16x16x32_bf16 v[100:103], a[132:135], v[32:35], v[100:103]
    ds_read_b64_tr_b16 v[60:61], v29 offset:12288
    v_cvt_pk_bf16_f32 v186, v188, v189
    v_mfma_f32_16x16x32_bf16 v[100:103], a[148:151], v[36:39], v[100:103]
    ds_read_b64_tr_b16 v[62:63], v29 offset:12800
    v_cvt_pk_bf16_f32 v187, v190, v191
    v_mfma_f32_16x16x32_bf16 v[104:107], a[136:139], v[32:35], v[104:107]
    buffer_load_dwordx4 v26, s[20:23], s98 offen offset:2048  lds
    v_mfma_f32_16x16x32_bf16 v[104:107], a[152:155], v[36:39], v[104:107]
    s_xor_b32 s79, s65, 4096
    v_mfma_f32_16x16x32_bf16 v[108:111], a[140:143], v[32:35], v[108:111]
    buffer_store_dwordx4 v[184:187], v1, s[8:11], s79 offen offset:3072 sc0 sc1
    v_mfma_f32_16x16x32_bf16 v[108:111], a[156:159], v[36:39], v[108:111]
    v_mfma_f32_16x16x32_bf16 v[112:115], a[128:131], v[40:43], v[112:115]
    s_waitcnt lgkmcnt(4)
    ds_read_b64_tr_b16 v[32:33], v28 offset:16384
    v_mfma_f32_16x16x32_bf16 v[112:115], a[144:147], v[44:47], v[112:115]
    ds_read_b64_tr_b16 v[34:35], v28 offset:16896
    v_mfma_f32_16x16x32_bf16 v[116:119], a[132:135], v[40:43], v[116:119]
    ds_read_b64_tr_b16 v[36:37], v28 offset:20480
    v_mfma_f32_16x16x32_bf16 v[116:119], a[148:151], v[44:47], v[116:119]
    ds_read_b64_tr_b16 v[38:39], v28 offset:20992
    v_mfma_f32_16x16x32_bf16 v[120:123], a[136:139], v[40:43], v[120:123]
    buffer_load_dwordx4 v27, s[20:23], s98 offen offset:3072  lds
    v_mfma_f32_16x16x32_bf16 v[120:123], a[152:155], v[44:47], v[120:123]
    s_add_u32 m0, s62, 69632
    s_xor_b32 s98, s64, 2359424
    v_mfma_f32_16x16x32_bf16 v[124:127], a[140:143], v[40:43], v[124:127]
    v_mfma_f32_16x16x32_bf16 v[124:127], a[156:159], v[44:47], v[124:127]
    v_mfma_f32_16x16x32_bf16 v[96:99], a[160:163], v[48:51], v[96:99]
    ds_read_b64_tr_b16 v[40:41], v29 offset:16384
    v_cvt_pk_bf16_f32 v192, v192, v193
    v_mfma_f32_16x16x32_bf16 v[96:99], a[176:179], v[52:55], v[96:99]
    ds_read_b64_tr_b16 v[42:43], v29 offset:16896
    v_cvt_pk_bf16_f32 v193, v194, v195
    v_mfma_f32_16x16x32_bf16 v[100:103], a[164:167], v[48:51], v[100:103]
    ds_read_b64_tr_b16 v[44:45], v29 offset:20480
    v_cvt_pk_bf16_f32 v194, v196, v197
    v_mfma_f32_16x16x32_bf16 v[100:103], a[180:183], v[52:55], v[100:103]
    ds_read_b64_tr_b16 v[46:47], v29 offset:20992
    v_cvt_pk_bf16_f32 v195, v198, v199
    v_mfma_f32_16x16x32_bf16 v[104:107], a[168:171], v[48:51], v[104:107]
    buffer_load_dwordx4 v24, s[20:23], s98 offen offset:0  lds
    v_mfma_f32_16x16x32_bf16 v[104:107], a[184:187], v[52:55], v[104:107]
    s_xor_b32 s79, s65, 8192
    v_mfma_f32_16x16x32_bf16 v[108:111], a[172:175], v[48:51], v[108:111]
    buffer_store_dwordx4 v[192:195], v1, s[8:11], s79 offen offset:0 sc0 sc1
    v_mfma_f32_16x16x32_bf16 v[108:111], a[188:191], v[52:55], v[108:111]
    s_waitcnt lgkmcnt(4)
    v_mfma_f32_16x16x32_bf16 v[112:115], a[160:163], v[56:59], v[112:115]
    ds_read_b64_tr_b16 v[48:49], v28 offset:24576
    v_mfma_f32_16x16x32_bf16 v[112:115], a[176:179], v[60:63], v[112:115]
    ds_read_b64_tr_b16 v[50:51], v28 offset:25088
    v_mfma_f32_16x16x32_bf16 v[116:119], a[164:167], v[56:59], v[116:119]
    ds_read_b64_tr_b16 v[52:53], v28 offset:28672
    v_mfma_f32_16x16x32_bf16 v[116:119], a[180:183], v[60:63], v[116:119]
    ds_read_b64_tr_b16 v[54:55], v28 offset:29184
    v_mfma_f32_16x16x32_bf16 v[120:123], a[168:171], v[56:59], v[120:123]
    buffer_load_dwordx4 v25, s[20:23], s98 offen offset:1024  lds
    v_mfma_f32_16x16x32_bf16 v[120:123], a[184:187], v[60:63], v[120:123]
    v_mfma_f32_16x16x32_bf16 v[124:127], a[172:175], v[56:59], v[124:127]
    v_mfma_f32_16x16x32_bf16 v[124:127], a[188:191], v[60:63], v[124:127]
    v_mfma_f32_16x16x32_bf16 v[96:99], a[192:195], v[32:35], v[96:99]
    ds_read_b64_tr_b16 v[56:57], v29 offset:24576
    v_mfma_f32_16x16x32_bf16 v[96:99], a[208:211], v[36:39], v[96:99]
    ds_read_b64_tr_b16 v[58:59], v29 offset:25088
    v_cvt_pk_bf16_f32 v200, v200, v201
    v_mfma_f32_16x16x32_bf16 v[100:103], a[196:199], v[32:35], v[100:103]
    ds_read_b64_tr_b16 v[60:61], v29 offset:28672
    v_cvt_pk_bf16_f32 v201, v202, v203
    v_mfma_f32_16x16x32_bf16 v[100:103], a[212:215], v[36:39], v[100:103]
    ds_read_b64_tr_b16 v[62:63], v29 offset:29184
    v_cvt_pk_bf16_f32 v202, v204, v205
    v_mfma_f32_16x16x32_bf16 v[104:107], a[200:203], v[32:35], v[104:107]
    buffer_load_dwordx4 v26, s[20:23], s98 offen offset:2048  lds
    v_mfma_f32_16x16x32_bf16 v[104:107], a[216:219], v[36:39], v[104:107]
    v_cvt_pk_bf16_f32 v203, v206, v207
    v_mfma_f32_16x16x32_bf16 v[108:111], a[204:207], v[32:35], v[108:111]
    v_mfma_f32_16x16x32_bf16 v[108:111], a[220:223], v[36:39], v[108:111]
    s_waitcnt lgkmcnt(4)
    s_xor_b32 s79, s65, 8192
    v_xor_b32 v30, 65536, v30
    v_mfma_f32_16x16x32_bf16 v[112:115], a[192:195], v[40:43], v[112:115]
    ds_read_b64_tr_b16 v[32:33], v30 offset:0
    v_mfma_f32_16x16x32_bf16 v[112:115], a[208:211], v[44:47], v[112:115]
    ds_read_b64_tr_b16 v[34:35], v30 offset:512
    v_mfma_f32_16x16x32_bf16 v[116:119], a[196:199], v[40:43], v[116:119]
    ds_read_b64_tr_b16 v[36:37], v30 offset:4096
    v_mfma_f32_16x16x32_bf16 v[116:119], a[212:215], v[44:47], v[116:119]
    ds_read_b64_tr_b16 v[38:39], v30 offset:4608
    v_mfma_f32_16x16x32_bf16 v[120:123], a[200:203], v[40:43], v[120:123]
    buffer_load_dwordx4 v27, s[20:23], s98 offen offset:3072  lds
    v_mfma_f32_16x16x32_bf16 v[120:123], a[216:219], v[44:47], v[120:123]
    buffer_store_dwordx4 v[200:203], v1, s[8:11], s79 offen offset:1024 sc0 sc1
    v_mfma_f32_16x16x32_bf16 v[124:127], a[204:207], v[40:43], v[124:127]
    v_mfma_f32_16x16x32_bf16 v[124:127], a[220:223], v[44:47], v[124:127]
    s_add_u32 m0, s63, 114688
    s_xor_b32 s98, s0, 1048576
    v_xor_b32 v31, 65536, v31
    v_mfma_f32_16x16x32_bf16 v[96:99], a[224:227], v[48:51], v[96:99]
    ds_read_b64_tr_b16 v[40:41], v31 offset:0
    v_mfma_f32_16x16x32_bf16 v[96:99], a[240:243], v[52:55], v[96:99]
    ds_read_b64_tr_b16 v[42:43], v31 offset:512
    v_mfma_f32_16x16x32_bf16 v[100:103], a[228:231], v[48:51], v[100:103]
    ds_read_b64_tr_b16 v[44:45], v31 offset:4096
    v_cvt_pk_bf16_f32 v208, v208, v209
    v_mfma_f32_16x16x32_bf16 v[100:103], a[244:247], v[52:55], v[100:103]
    ds_read_b64_tr_b16 v[46:47], v31 offset:4608
    v_cvt_pk_bf16_f32 v209, v210, v211
    v_mfma_f32_16x16x32_bf16 v[104:107], a[232:235], v[48:51], v[104:107]
    buffer_load_dwordx4 v20, s[24:27], s98 offen offset:0  lds
    v_mfma_f32_16x16x32_bf16 v[104:107], a[248:251], v[52:55], v[104:107]
    v_cvt_pk_bf16_f32 v210, v212, v213
    v_cvt_pk_bf16_f32 v211, v214, v215
    v_mfma_f32_16x16x32_bf16 v[108:111], a[236:239], v[48:51], v[108:111]
    v_mfma_f32_16x16x32_bf16 v[108:111], a[252:255], v[52:55], v[108:111]
    s_waitcnt lgkmcnt(4)
    v_mfma_f32_16x16x32_bf16 v[112:115], a[224:227], v[56:59], v[112:115]
    s_xor_b32 s79, s65, 8192
    ds_read_b64_tr_b16 v[48:49], v30 offset:8192
    v_mfma_f32_16x16x32_bf16 v[112:115], a[240:243], v[60:63], v[112:115]
    ds_read_b64_tr_b16 v[50:51], v30 offset:8704
    v_mfma_f32_16x16x32_bf16 v[116:119], a[228:231], v[56:59], v[116:119]
    ds_read_b64_tr_b16 v[52:53], v30 offset:12288
    v_mfma_f32_16x16x32_bf16 v[116:119], a[244:247], v[60:63], v[116:119]
    ds_read_b64_tr_b16 v[54:55], v30 offset:12800
    v_mfma_f32_16x16x32_bf16 v[120:123], a[232:235], v[56:59], v[120:123]
    buffer_load_dwordx4 v21, s[24:27], s98 offen offset:1024  lds
    v_mfma_f32_16x16x32_bf16 v[120:123], a[248:251], v[60:63], v[120:123]
    buffer_store_dwordx4 v[208:211], v1, s[8:11], s79 offen offset:2048 sc0 sc1
    v_mfma_f32_16x16x32_bf16 v[124:127], a[236:239], v[56:59], v[124:127]
    v_mfma_f32_16x16x32_bf16 v[124:127], a[252:255], v[60:63], v[124:127]
    v_mfma_f32_16x16x32_bf16 v[64:67], a[128:131], v[32:35], v[64:67]
    ds_read_b64_tr_b16 v[56:57], v31 offset:8192
    v_mfma_f32_16x16x32_bf16 v[64:67], a[144:147], v[36:39], v[64:67]
    ds_read_b64_tr_b16 v[58:59], v31 offset:8704
    v_mfma_f32_16x16x32_bf16 v[68:71], a[132:135], v[32:35], v[68:71]
    ds_read_b64_tr_b16 v[60:61], v31 offset:12288
    v_mfma_f32_16x16x32_bf16 v[68:71], a[148:151], v[36:39], v[68:71]
    ds_read_b64_tr_b16 v[62:63], v31 offset:12800
    v_mfma_f32_16x16x32_bf16 v[72:75], a[136:139], v[32:35], v[72:75]
    buffer_load_dwordx4 v22, s[24:27], s98 offen offset:2048  lds
    v_mfma_f32_16x16x32_bf16 v[72:75], a[152:155], v[36:39], v[72:75]
    v_mfma_f32_16x16x32_bf16 v[76:79], a[140:143], v[32:35], v[76:79]
    v_mfma_f32_16x16x32_bf16 v[76:79], a[156:159], v[36:39], v[76:79]
    s_waitcnt lgkmcnt(4)
    v_mfma_f32_16x16x32_bf16 v[80:83], a[128:131], v[40:43], v[80:83]
    ds_read_b64_tr_b16 v[32:33], v30 offset:16384
    v_cvt_pk_bf16_f32 v96, v96, v97
    v_mfma_f32_16x16x32_bf16 v[80:83], a[144:147], v[44:47], v[80:83]
    ds_read_b64_tr_b16 v[34:35], v30 offset:16896
    v_cvt_pk_bf16_f32 v97, v98, v99
    v_mfma_f32_16x16x32_bf16 v[84:87], a[132:135], v[40:43], v[84:87]
    ds_read_b64_tr_b16 v[36:37], v30 offset:20480
    v_cvt_pk_bf16_f32 v98, v100, v101
    v_mfma_f32_16x16x32_bf16 v[84:87], a[148:151], v[44:47], v[84:87]
    ds_read_b64_tr_b16 v[38:39], v30 offset:20992
    v_cvt_pk_bf16_f32 v99, v102, v103
    v_mfma_f32_16x16x32_bf16 v[88:91], a[136:139], v[40:43], v[88:91]
    buffer_load_dwordx4 v23, s[24:27], s98 offen offset:3072  lds
    v_mfma_f32_16x16x32_bf16 v[88:91], a[152:155], v[44:47], v[88:91]
    s_add_u32 m0, s63, 147456
    s_xor_b32 s98, s0, 1572864
    s_xor_b32 s79, s1, 32768
    v_mfma_f32_16x16x32_bf16 v[92:95], a[140:143], v[40:43], v[92:95]
    buffer_store_dwordx4 v[96:99], v1, s[8:11], s79 offen offset:0 sc0 sc1
    v_mfma_f32_16x16x32_bf16 v[92:95], a[156:159], v[44:47], v[92:95]
    v_mfma_f32_16x16x32_bf16 v[64:67], a[160:163], v[48:51], v[64:67]
    ds_read_b64_tr_b16 v[40:41], v31 offset:16384
    v_mfma_f32_16x16x32_bf16 v[64:67], a[176:179], v[52:55], v[64:67]
    ds_read_b64_tr_b16 v[42:43], v31 offset:16896
    v_mfma_f32_16x16x32_bf16 v[68:71], a[164:167], v[48:51], v[68:71]
    ds_read_b64_tr_b16 v[44:45], v31 offset:20480
    v_mfma_f32_16x16x32_bf16 v[68:71], a[180:183], v[52:55], v[68:71]
    ds_read_b64_tr_b16 v[46:47], v31 offset:20992
    v_mfma_f32_16x16x32_bf16 v[72:75], a[168:171], v[48:51], v[72:75]
    buffer_load_dwordx4 v20, s[24:27], s98 offen offset:0  lds
    v_mfma_f32_16x16x32_bf16 v[72:75], a[184:187], v[52:55], v[72:75]
    v_cvt_pk_bf16_f32 v104, v104, v105
    v_cvt_pk_bf16_f32 v105, v106, v107
    v_mfma_f32_16x16x32_bf16 v[76:79], a[172:175], v[48:51], v[76:79]
    v_cvt_pk_bf16_f32 v106, v108, v109
    v_cvt_pk_bf16_f32 v107, v110, v111
    v_mfma_f32_16x16x32_bf16 v[76:79], a[188:191], v[52:55], v[76:79]
    s_waitcnt lgkmcnt(4)
    v_mfma_f32_16x16x32_bf16 v[80:83], a[160:163], v[56:59], v[80:83]
    s_xor_b32 s79, s1, 40960
    ds_read_b64_tr_b16 v[48:49], v30 offset:24576
    v_mfma_f32_16x16x32_bf16 v[80:83], a[176:179], v[60:63], v[80:83]
    ds_read_b64_tr_b16 v[50:51], v30 offset:25088
    v_mfma_f32_16x16x32_bf16 v[84:87], a[164:167], v[56:59], v[84:87]
    ds_read_b64_tr_b16 v[52:53], v30 offset:28672
    v_mfma_f32_16x16x32_bf16 v[84:87], a[180:183], v[60:63], v[84:87]
    ds_read_b64_tr_b16 v[54:55], v30 offset:29184
    v_mfma_f32_16x16x32_bf16 v[88:91], a[168:171], v[56:59], v[88:91]
    buffer_load_dwordx4 v21, s[24:27], s98 offen offset:1024  lds
    v_mfma_f32_16x16x32_bf16 v[88:91], a[184:187], v[60:63], v[88:91]
    buffer_store_dwordx4 v[104:107], v1, s[8:11], s79 offen offset:0 sc0 sc1
    v_mfma_f32_16x16x32_bf16 v[92:95], a[172:175], v[56:59], v[92:95]
    v_mfma_f32_16x16x32_bf16 v[92:95], a[188:191], v[60:63], v[92:95]
    v_mfma_f32_16x16x32_bf16 v[64:67], a[192:195], v[32:35], v[64:67]
    ds_read_b64_tr_b16 v[56:57], v31 offset:24576
    v_mfma_f32_16x16x32_bf16 v[64:67], a[208:211], v[36:39], v[64:67]
    ds_read_b64_tr_b16 v[58:59], v31 offset:25088
    v_mfma_f32_16x16x32_bf16 v[68:71], a[196:199], v[32:35], v[68:71]
    ds_read_b64_tr_b16 v[60:61], v31 offset:28672
    v_cvt_pk_bf16_f32 v112, v112, v113
    v_mfma_f32_16x16x32_bf16 v[68:71], a[212:215], v[36:39], v[68:71]
    ds_read_b64_tr_b16 v[62:63], v31 offset:29184
    v_cvt_pk_bf16_f32 v113, v114, v115
    v_mfma_f32_16x16x32_bf16 v[72:75], a[200:203], v[32:35], v[72:75]
    buffer_load_dwordx4 v22, s[24:27], s98 offen offset:2048  lds
    v_mfma_f32_16x16x32_bf16 v[72:75], a[216:219], v[36:39], v[72:75]
    v_cvt_pk_bf16_f32 v114, v116, v117
    v_cvt_pk_bf16_f32 v115, v118, v119
    v_mfma_f32_16x16x32_bf16 v[76:79], a[204:207], v[32:35], v[76:79]
    s_waitcnt lgkmcnt(4)
    s_xor_b32 s79, s1, 32768
    v_mfma_f32_16x16x32_bf16 v[76:79], a[220:223], v[36:39], v[76:79]
    buffer_store_dwordx4 v[112:115], v1, s[8:11], s79 offen offset:1024 sc0 sc1
    v_mfma_f32_16x16x32_bf16 v[80:83], a[192:195], v[40:43], v[80:83]
    v_mfma_f32_16x16x32_bf16 v[80:83], a[208:211], v[44:47], v[80:83]
    buffer_load_dwordx4 v23, s[24:27], s98 offen offset:3072  lds
    v_mfma_f32_16x16x32_bf16 v[84:87], a[196:199], v[40:43], v[84:87]
    v_mfma_f32_16x16x32_bf16 v[84:87], a[212:215], v[44:47], v[84:87]
    v_mfma_f32_16x16x32_bf16 v[88:91], a[200:203], v[40:43], v[88:91]
    v_mfma_f32_16x16x32_bf16 v[88:91], a[216:219], v[44:47], v[88:91]
    v_mfma_f32_16x16x32_bf16 v[92:95], a[204:207], v[40:43], v[92:95]
    s_waitcnt lgkmcnt(0)
    s_barrier
    v_mfma_f32_16x16x32_bf16 v[92:95], a[220:223], v[44:47], v[92:95]
    s_add_u32 m0, s63, 0
    s_xor_b32 s98, s0, 2097152
    ds_read_b64_tr_b16 v[32:33], v28 offset:32768
    v_mfma_f32_16x16x32_bf16 v[64:67], a[224:227], v[48:51], v[64:67]
    ds_read_b64_tr_b16 v[34:35], v28 offset:33280
    v_cvt_pk_bf16_f32 v120, v120, v121
    v_mfma_f32_16x16x32_bf16 v[64:67], a[240:243], v[52:55], v[64:67]
    ds_read_b64_tr_b16 v[36:37], v28 offset:36864
    v_cvt_pk_bf16_f32 v121, v122, v123
    v_mfma_f32_16x16x32_bf16 v[68:71], a[228:231], v[48:51], v[68:71]
    ds_read_b64_tr_b16 v[38:39], v28 offset:37376
    v_cvt_pk_bf16_f32 v122, v124, v125
    v_mfma_f32_16x16x32_bf16 v[68:71], a[244:247], v[52:55], v[68:71]
    ds_read_b64_tr_b16 v[40:41], v29 offset:32768
    v_cvt_pk_bf16_f32 v123, v126, v127
    v_mfma_f32_16x16x32_bf16 v[72:75], a[232:235], v[48:51], v[72:75]
    s_xor_b32 s79, s1, 40960
    ds_read_b64_tr_b16 v[42:43], v29 offset:33280
    v_mfma_f32_16x16x32_bf16 v[72:75], a[248:251], v[52:55], v[72:75]
    ds_read_b64_tr_b16 v[44:45], v29 offset:36864
    v_mfma_f32_16x16x32_bf16 v[76:79], a[236:239], v[48:51], v[76:79]
    ds_read_b64_tr_b16 v[46:47], v29 offset:37376
    v_mfma_f32_16x16x32_bf16 v[76:79], a[252:255], v[52:55], v[76:79]
    buffer_load_dwordx4 v20, s[24:27], s98 offen offset:0  lds
    v_mfma_f32_16x16x32_bf16 v[80:83], a[224:227], v[56:59], v[80:83]
    ds_read_b64_tr_b16 v[48:49], v28 offset:40960
    v_mfma_f32_16x16x32_bf16 v[80:83], a[240:243], v[60:63], v[80:83]
    ds_read_b64_tr_b16 v[50:51], v28 offset:41472
    v_mfma_f32_16x16x32_bf16 v[84:87], a[228:231], v[56:59], v[84:87]
    ds_read_b64_tr_b16 v[52:53], v28 offset:45056
    v_mfma_f32_16x16x32_bf16 v[84:87], a[244:247], v[60:63], v[84:87]
    ds_read_b64_tr_b16 v[54:55], v28 offset:45568
    v_mfma_f32_16x16x32_bf16 v[88:91], a[232:235], v[56:59], v[88:91]
    buffer_store_dwordx4 v[120:123], v1, s[8:11], s79 offen offset:1024 sc0 sc1
    v_mfma_f32_16x16x32_bf16 v[88:91], a[248:251], v[60:63], v[88:91]
    buffer_load_dwordx4 v21, s[24:27], s98 offen offset:1024  lds
    v_mfma_f32_16x16x32_bf16 v[92:95], a[236:239], v[56:59], v[92:95]
    v_mfma_f32_16x16x32_bf16 v[92:95], a[252:255], v[60:63], v[92:95]
    s_waitcnt lgkmcnt(5)
    v_mfma_f32_16x16x32_bf16 v[96:99], a[0:3], v[32:35], 0
    ds_read_b64_tr_b16 v[56:57], v29 offset:40960
    v_mfma_f32_16x16x32_bf16 v[96:99], a[16:19], v[36:39], v[96:99]
    ds_read_b64_tr_b16 v[58:59], v29 offset:41472
    v_mfma_f32_16x16x32_bf16 v[100:103], a[4:7], v[32:35], 0
    ds_read_b64_tr_b16 v[60:61], v29 offset:45056
    v_mfma_f32_16x16x32_bf16 v[100:103], a[20:23], v[36:39], v[100:103]
    ds_read_b64_tr_b16 v[62:63], v29 offset:45568
    v_mfma_f32_16x16x32_bf16 v[104:107], a[8:11], v[32:35], 0
    buffer_load_dwordx4 v22, s[24:27], s98 offen offset:2048  lds
    v_mfma_f32_16x16x32_bf16 v[104:107], a[24:27], v[36:39], v[104:107]
    v_mfma_f32_16x16x32_bf16 v[108:111], a[12:15], v[32:35], 0
    v_mfma_f32_16x16x32_bf16 v[108:111], a[28:31], v[36:39], v[108:111]
    v_mfma_f32_16x16x32_bf16 v[112:115], a[0:3], v[40:43], 0
    s_waitcnt lgkmcnt(4)
    ds_read_b64_tr_b16 v[32:33], v28 offset:49152
    v_cvt_pk_bf16_f32 v64, v64, v65
    v_mfma_f32_16x16x32_bf16 v[112:115], a[16:19], v[44:47], v[112:115]
    ds_read_b64_tr_b16 v[34:35], v28 offset:49664
    v_cvt_pk_bf16_f32 v65, v66, v67
    v_mfma_f32_16x16x32_bf16 v[116:119], a[4:7], v[40:43], 0
    ds_read_b64_tr_b16 v[36:37], v28 offset:53248
    v_cvt_pk_bf16_f32 v66, v68, v69
    v_mfma_f32_16x16x32_bf16 v[116:119], a[20:23], v[44:47], v[116:119]
    ds_read_b64_tr_b16 v[38:39], v28 offset:53760
    v_cvt_pk_bf16_f32 v67, v70, v71
    v_mfma_f32_16x16x32_bf16 v[120:123], a[8:11], v[40:43], 0
    buffer_load_dwordx4 v23, s[24:27], s98 offen offset:3072  lds
    v_mfma_f32_16x16x32_bf16 v[120:123], a[24:27], v[44:47], v[120:123]
    s_add_u32 m0, s63, 16384
    s_xor_b32 s98, s0, 2621440
    s_xor_b32 s79, s1, 32768
    v_mfma_f32_16x16x32_bf16 v[124:127], a[12:15], v[40:43], 0
    buffer_store_dwordx4 v[64:67], v1, s[8:11], s79 offen offset:2048 sc0 sc1
    v_mfma_f32_16x16x32_bf16 v[124:127], a[28:31], v[44:47], v[124:127]
    v_mfma_f32_16x16x32_bf16 v[96:99], a[32:35], v[48:51], v[96:99]
    ds_read_b64_tr_b16 v[40:41], v29 offset:49152
    v_mfma_f32_16x16x32_bf16 v[96:99], a[48:51], v[52:55], v[96:99]
    ds_read_b64_tr_b16 v[42:43], v29 offset:49664
    v_mfma_f32_16x16x32_bf16 v[100:103], a[36:39], v[48:51], v[100:103]
    ds_read_b64_tr_b16 v[44:45], v29 offset:53248
    v_mfma_f32_16x16x32_bf16 v[100:103], a[52:55], v[52:55], v[100:103]
    ds_read_b64_tr_b16 v[46:47], v29 offset:53760
    v_mfma_f32_16x16x32_bf16 v[104:107], a[40:43], v[48:51], v[104:107]
    buffer_load_dwordx4 v20, s[24:27], s98 offen offset:0  lds
    v_mfma_f32_16x16x32_bf16 v[104:107], a[56:59], v[52:55], v[104:107]
    v_cvt_pk_bf16_f32 v72, v72, v73
    v_cvt_pk_bf16_f32 v73, v74, v75
    v_mfma_f32_16x16x32_bf16 v[108:111], a[44:47], v[48:51], v[108:111]
    v_cvt_pk_bf16_f32 v74, v76, v77
    v_cvt_pk_bf16_f32 v75, v78, v79
    v_mfma_f32_16x16x32_bf16 v[108:111], a[60:63], v[52:55], v[108:111]
    s_waitcnt lgkmcnt(4)
    v_mfma_f32_16x16x32_bf16 v[112:115], a[32:35], v[56:59], v[112:115]
    s_xor_b32 s79, s1, 40960
    ds_read_b64_tr_b16 v[48:49], v28 offset:57344
    v_mfma_f32_16x16x32_bf16 v[112:115], a[48:51], v[60:63], v[112:115]
    ds_read_b64_tr_b16 v[50:51], v28 offset:57856
    v_mfma_f32_16x16x32_bf16 v[116:119], a[36:39], v[56:59], v[116:119]
    ds_read_b64_tr_b16 v[52:53], v28 offset:61440
    v_mfma_f32_16x16x32_bf16 v[116:119], a[52:55], v[60:63], v[116:119]
    ds_read_b64_tr_b16 v[54:55], v28 offset:61952
    v_mfma_f32_16x16x32_bf16 v[120:123], a[40:43], v[56:59], v[120:123]
    buffer_load_dwordx4 v21, s[24:27], s98 offen offset:1024  lds
    v_mfma_f32_16x16x32_bf16 v[120:123], a[56:59], v[60:63], v[120:123]
    buffer_store_dwordx4 v[72:75], v1, s[8:11], s79 offen offset:2048 sc0 sc1
    v_mfma_f32_16x16x32_bf16 v[124:127], a[44:47], v[56:59], v[124:127]
    v_mfma_f32_16x16x32_bf16 v[124:127], a[60:63], v[60:63], v[124:127]
    v_mfma_f32_16x16x32_bf16 v[96:99], a[64:67], v[32:35], v[96:99]
    ds_read_b64_tr_b16 v[56:57], v29 offset:57344
    v_mfma_f32_16x16x32_bf16 v[96:99], a[80:83], v[36:39], v[96:99]
    ds_read_b64_tr_b16 v[58:59], v29 offset:57856
    v_mfma_f32_16x16x32_bf16 v[100:103], a[68:71], v[32:35], v[100:103]
    ds_read_b64_tr_b16 v[60:61], v29 offset:61440
    v_cvt_pk_bf16_f32 v80, v80, v81
    v_mfma_f32_16x16x32_bf16 v[100:103], a[84:87], v[36:39], v[100:103]
    ds_read_b64_tr_b16 v[62:63], v29 offset:61952
    v_cvt_pk_bf16_f32 v81, v82, v83
    v_mfma_f32_16x16x32_bf16 v[104:107], a[72:75], v[32:35], v[104:107]
    buffer_load_dwordx4 v22, s[24:27], s98 offen offset:2048  lds
    v_mfma_f32_16x16x32_bf16 v[104:107], a[88:91], v[36:39], v[104:107]
    v_cvt_pk_bf16_f32 v82, v84, v85
    v_cvt_pk_bf16_f32 v83, v86, v87
    v_mfma_f32_16x16x32_bf16 v[108:111], a[76:79], v[32:35], v[108:111]
    v_mfma_f32_16x16x32_bf16 v[108:111], a[92:95], v[36:39], v[108:111]
    s_waitcnt lgkmcnt(4)
    v_mfma_f32_16x16x32_bf16 v[112:115], a[64:67], v[40:43], v[112:115]
    s_xor_b32 s79, s1, 32768
    ds_read_b64_tr_b16 v[32:33], v30 offset:32768
    v_mfma_f32_16x16x32_bf16 v[112:115], a[80:83], v[44:47], v[112:115]
    ds_read_b64_tr_b16 v[34:35], v30 offset:33280
    v_mfma_f32_16x16x32_bf16 v[116:119], a[68:71], v[40:43], v[116:119]
    ds_read_b64_tr_b16 v[36:37], v30 offset:36864
    v_mfma_f32_16x16x32_bf16 v[116:119], a[84:87], v[44:47], v[116:119]
    ds_read_b64_tr_b16 v[38:39], v30 offset:37376
    v_mfma_f32_16x16x32_bf16 v[120:123], a[72:75], v[40:43], v[120:123]
    buffer_load_dwordx4 v23, s[24:27], s98 offen offset:3072  lds
    v_mfma_f32_16x16x32_bf16 v[120:123], a[88:91], v[44:47], v[120:123]
    buffer_store_dwordx4 v[80:83], v1, s[8:11], s79 offen offset:3072 sc0 sc1
    v_mfma_f32_16x16x32_bf16 v[124:127], a[76:79], v[40:43], v[124:127]
    v_mfma_f32_16x16x32_bf16 v[124:127], a[92:95], v[44:47], v[124:127]
    v_mfma_f32_16x16x32_bf16 v[96:99], a[96:99], v[48:51], v[96:99]
    ds_read_b64_tr_b16 v[40:41], v31 offset:32768
    v_cvt_pk_bf16_f32 v88, v88, v89
    v_mfma_f32_16x16x32_bf16 v[96:99], a[112:115], v[52:55], v[96:99]
    ds_read_b64_tr_b16 v[42:43], v31 offset:33280
    v_cvt_pk_bf16_f32 v89, v90, v91
    v_mfma_f32_16x16x32_bf16 v[100:103], a[100:103], v[48:51], v[100:103]
    ds_read_b64_tr_b16 v[44:45], v31 offset:36864
    v_cvt_pk_bf16_f32 v90, v92, v93
    v_mfma_f32_16x16x32_bf16 v[100:103], a[116:119], v[52:55], v[100:103]
    ds_read_b64_tr_b16 v[46:47], v31 offset:37376
    v_cvt_pk_bf16_f32 v91, v94, v95
    v_mfma_f32_16x16x32_bf16 v[104:107], a[104:107], v[48:51], v[104:107]
    s_xor_b32 s79, s1, 40960
    v_mfma_f32_16x16x32_bf16 v[104:107], a[120:123], v[52:55], v[104:107]
    buffer_store_dwordx4 v[88:91], v1, s[8:11], s79 offen offset:3072 sc0 sc1
    v_mfma_f32_16x16x32_bf16 v[108:111], a[108:111], v[48:51], v[108:111]
    v_mfma_f32_16x16x32_bf16 v[108:111], a[124:127], v[52:55], v[108:111]
    s_waitcnt lgkmcnt(4)
    v_mfma_f32_16x16x32_bf16 v[112:115], a[96:99], v[56:59], v[112:115]
    ds_read_b64_tr_b16 v[48:49], v30 offset:40960
    v_mfma_f32_16x16x32_bf16 v[112:115], a[112:115], v[60:63], v[112:115]
    ds_read_b64_tr_b16 v[50:51], v30 offset:41472
    v_mfma_f32_16x16x32_bf16 v[116:119], a[100:103], v[56:59], v[116:119]
    ds_read_b64_tr_b16 v[52:53], v30 offset:45056
    v_mfma_f32_16x16x32_bf16 v[116:119], a[116:119], v[60:63], v[116:119]
    ds_read_b64_tr_b16 v[54:55], v30 offset:45568
    v_mfma_f32_16x16x32_bf16 v[120:123], a[104:107], v[56:59], v[120:123]
    v_mfma_f32_16x16x32_bf16 v[120:123], a[120:123], v[60:63], v[120:123]
    v_mfma_f32_16x16x32_bf16 v[124:127], a[108:111], v[56:59], v[124:127]
    v_mfma_f32_16x16x32_bf16 v[124:127], a[124:127], v[60:63], v[124:127]
    v_mfma_f32_16x16x32_bf16 v[64:67], a[0:3], v[32:35], 0
    ds_read_b64_tr_b16 v[56:57], v31 offset:40960
    v_mfma_f32_16x16x32_bf16 v[64:67], a[16:19], v[36:39], v[64:67]
    ds_read_b64_tr_b16 v[58:59], v31 offset:41472
    v_mfma_f32_16x16x32_bf16 v[68:71], a[4:7], v[32:35], 0
    ds_read_b64_tr_b16 v[60:61], v31 offset:45056
    v_cvt_pk_bf16_f32 v216, v216, v217
    v_mfma_f32_16x16x32_bf16 v[68:71], a[20:23], v[36:39], v[68:71]
    ds_read_b64_tr_b16 v[62:63], v31 offset:45568
    v_cvt_pk_bf16_f32 v217, v218, v219
    v_mfma_f32_16x16x32_bf16 v[72:75], a[8:11], v[32:35], 0
    v_cvt_pk_bf16_f32 v218, v220, v221
    v_cvt_pk_bf16_f32 v219, v222, v223
    v_mfma_f32_16x16x32_bf16 v[72:75], a[24:27], v[36:39], v[72:75]
    s_xor_b32 s79, s65, 8192
    v_mfma_f32_16x16x32_bf16 v[76:79], a[12:15], v[32:35], 0
    buffer_store_dwordx4 v[216:219], v1, s[8:11], s79 offen offset:3072 sc0 sc1
    v_mfma_f32_16x16x32_bf16 v[76:79], a[28:31], v[36:39], v[76:79]
    s_waitcnt lgkmcnt(4)
    v_mfma_f32_16x16x32_bf16 v[80:83], a[0:3], v[40:43], 0
    ds_read_b64_tr_b16 v[32:33], v30 offset:49152
    v_mfma_f32_16x16x32_bf16 v[80:83], a[16:19], v[44:47], v[80:83]
    ds_read_b64_tr_b16 v[34:35], v30 offset:49664
    v_mfma_f32_16x16x32_bf16 v[84:87], a[4:7], v[40:43], 0
    ds_read_b64_tr_b16 v[36:37], v30 offset:53248
    v_mfma_f32_16x16x32_bf16 v[84:87], a[20:23], v[44:47], v[84:87]
    ds_read_b64_tr_b16 v[38:39], v30 offset:53760
    v_mfma_f32_16x16x32_bf16 v[88:91], a[8:11], v[40:43], 0
    v_mfma_f32_16x16x32_bf16 v[88:91], a[24:27], v[44:47], v[88:91]
    v_mfma_f32_16x16x32_bf16 v[92:95], a[12:15], v[40:43], 0
    v_mfma_f32_16x16x32_bf16 v[92:95], a[28:31], v[44:47], v[92:95]
    v_mfma_f32_16x16x32_bf16 v[64:67], a[32:35], v[48:51], v[64:67]
    ds_read_b64_tr_b16 v[40:41], v31 offset:49152
    v_mfma_f32_16x16x32_bf16 v[64:67], a[48:51], v[52:55], v[64:67]
    ds_read_b64_tr_b16 v[42:43], v31 offset:49664
    v_mfma_f32_16x16x32_bf16 v[68:71], a[36:39], v[48:51], v[68:71]
    ds_read_b64_tr_b16 v[44:45], v31 offset:53248
    v_mfma_f32_16x16x32_bf16 v[68:71], a[52:55], v[52:55], v[68:71]
    ds_read_b64_tr_b16 v[46:47], v31 offset:53760
    v_mfma_f32_16x16x32_bf16 v[72:75], a[40:43], v[48:51], v[72:75]
    buffer_load_dword v3, v16, s[8:11], s78 offen sc0 sc1
    v_mfma_f32_16x16x32_bf16 v[72:75], a[56:59], v[52:55], v[72:75]
    v_mfma_f32_16x16x32_bf16 v[76:79], a[44:47], v[48:51], v[76:79]
    v_mfma_f32_16x16x32_bf16 v[76:79], a[60:63], v[52:55], v[76:79]
    s_waitcnt lgkmcnt(4)
    v_mfma_f32_16x16x32_bf16 v[80:83], a[32:35], v[56:59], v[80:83]
    ds_read_b64_tr_b16 v[48:49], v30 offset:57344
    v_cvt_pk_bf16_f32 v224, v224, v225
    v_mfma_f32_16x16x32_bf16 v[80:83], a[48:51], v[60:63], v[80:83]
    ds_read_b64_tr_b16 v[50:51], v30 offset:57856
    v_cvt_pk_bf16_f32 v225, v226, v227
    v_mfma_f32_16x16x32_bf16 v[84:87], a[36:39], v[56:59], v[84:87]
    ds_read_b64_tr_b16 v[52:53], v30 offset:61440
    v_cvt_pk_bf16_f32 v226, v228, v229
    v_mfma_f32_16x16x32_bf16 v[84:87], a[52:55], v[60:63], v[84:87]
    ds_read_b64_tr_b16 v[54:55], v30 offset:61952
    v_cvt_pk_bf16_f32 v227, v230, v231
    v_mfma_f32_16x16x32_bf16 v[88:91], a[40:43], v[56:59], v[88:91]
    s_xor_b32 s79, s65, 12288
    v_mfma_f32_16x16x32_bf16 v[88:91], a[56:59], v[60:63], v[88:91]
    buffer_store_dwordx4 v[224:227], v1, s[8:11], s79 offen offset:0 sc0 sc1
    v_mfma_f32_16x16x32_bf16 v[92:95], a[44:47], v[56:59], v[92:95]
    v_mfma_f32_16x16x32_bf16 v[92:95], a[60:63], v[60:63], v[92:95]
    v_mfma_f32_16x16x32_bf16 v[64:67], a[64:67], v[32:35], v[64:67]
    ds_read_b64_tr_b16 v[56:57], v31 offset:57344
    v_mfma_f32_16x16x32_bf16 v[64:67], a[80:83], v[36:39], v[64:67]
    ds_read_b64_tr_b16 v[58:59], v31 offset:57856
    v_mfma_f32_16x16x32_bf16 v[68:71], a[68:71], v[32:35], v[68:71]
    ds_read_b64_tr_b16 v[60:61], v31 offset:61440
    v_mfma_f32_16x16x32_bf16 v[68:71], a[84:87], v[36:39], v[68:71]
    ds_read_b64_tr_b16 v[62:63], v31 offset:61952
    v_mfma_f32_16x16x32_bf16 v[72:75], a[72:75], v[32:35], v[72:75]
    v_mfma_f32_16x16x32_bf16 v[72:75], a[88:91], v[36:39], v[72:75]
    v_mfma_f32_16x16x32_bf16 v[76:79], a[76:79], v[32:35], v[76:79]
    v_mfma_f32_16x16x32_bf16 v[76:79], a[92:95], v[36:39], v[76:79]
    s_waitcnt lgkmcnt(4)
    v_mfma_f32_16x16x32_bf16 v[80:83], a[64:67], v[40:43], v[80:83]
    v_mfma_f32_16x16x32_bf16 v[80:83], a[80:83], v[44:47], v[80:83]
    v_mfma_f32_16x16x32_bf16 v[84:87], a[68:71], v[40:43], v[84:87]
    v_mfma_f32_16x16x32_bf16 v[84:87], a[84:87], v[44:47], v[84:87]
    v_mfma_f32_16x16x32_bf16 v[88:91], a[72:75], v[40:43], v[88:91]
    v_mfma_f32_16x16x32_bf16 v[88:91], a[88:91], v[44:47], v[88:91]
    v_mfma_f32_16x16x32_bf16 v[92:95], a[76:79], v[40:43], v[92:95]
    v_xor_b32 v28, 65536, v28
    v_cvt_pk_bf16_f32 v232, v232, v233
    s_waitcnt vmcnt(29) lgkmcnt(0)
    s_barrier
    v_mfma_f32_16x16x32_bf16 v[92:95], a[92:95], v[44:47], v[92:95]
    s_add_u32 m0, s63, 32768
    ds_read_b64_tr_b16 v[32:33], v28 offset:0
    v_xor_b32 v29, 65536, v29
    v_mfma_f32_16x16x32_bf16 v[64:67], a[96:99], v[48:51], v[64:67]
    s_xor_b32 s98, s0, 3145728
    ds_read_b64_tr_b16 v[34:35], v28 offset:512
    v_cvt_pk_bf16_f32 v233, v234, v235
    v_mfma_f32_16x16x32_bf16 v[64:67], a[112:115], v[52:55], v[64:67]
    ds_read_b64_tr_b16 v[36:37], v28 offset:4096
    v_cvt_pk_bf16_f32 v234, v236, v237
    v_mfma_f32_16x16x32_bf16 v[68:71], a[100:103], v[48:51], v[68:71]
    ds_read_b64_tr_b16 v[38:39], v28 offset:4608
    v_cvt_pk_bf16_f32 v235, v238, v239
    v_mfma_f32_16x16x32_bf16 v[68:71], a[116:119], v[52:55], v[68:71]
    s_xor_b32 s79, s65, 12288
    ds_read_b64_tr_b16 v[40:41], v29 offset:0
    v_mfma_f32_16x16x32_bf16 v[72:75], a[104:107], v[48:51], v[72:75]
    ds_read_b64_tr_b16 v[42:43], v29 offset:512
    v_mfma_f32_16x16x32_bf16 v[72:75], a[120:123], v[52:55], v[72:75]
    ds_read_b64_tr_b16 v[44:45], v29 offset:4096
    v_mfma_f32_16x16x32_bf16 v[76:79], a[108:111], v[48:51], v[76:79]
    ds_read_b64_tr_b16 v[46:47], v29 offset:4608
    v_mfma_f32_16x16x32_bf16 v[76:79], a[124:127], v[52:55], v[76:79]
    buffer_load_dwordx4 v20, s[24:27], s98 offen offset:0  lds
    v_mfma_f32_16x16x32_bf16 v[80:83], a[96:99], v[56:59], v[80:83]
    ds_read_b64_tr_b16 v[48:49], v28 offset:8192
    v_mfma_f32_16x16x32_bf16 v[80:83], a[112:115], v[60:63], v[80:83]
    ds_read_b64_tr_b16 v[50:51], v28 offset:8704
    v_mfma_f32_16x16x32_bf16 v[84:87], a[100:103], v[56:59], v[84:87]
    ds_read_b64_tr_b16 v[52:53], v28 offset:12288
    v_mfma_f32_16x16x32_bf16 v[84:87], a[116:119], v[60:63], v[84:87]
    ds_read_b64_tr_b16 v[54:55], v28 offset:12800
    v_mfma_f32_16x16x32_bf16 v[88:91], a[104:107], v[56:59], v[88:91]
    buffer_store_dwordx4 v[232:235], v1, s[8:11], s79 offen offset:1024 sc0 sc1
    v_mfma_f32_16x16x32_bf16 v[88:91], a[120:123], v[60:63], v[88:91]
    buffer_load_dwordx4 v21, s[24:27], s98 offen offset:1024  lds
    v_mfma_f32_16x16x32_bf16 v[92:95], a[108:111], v[56:59], v[92:95]
    v_mfma_f32_16x16x32_bf16 v[92:95], a[124:127], v[60:63], v[92:95]
    s_waitcnt lgkmcnt(5)
    v_mfma_f32_16x16x32_bf16 v[96:99], a[128:131], v[32:35], v[96:99]
    ds_read_b64_tr_b16 v[56:57], v29 offset:8192
    s_waitcnt vmcnt(4)
    v_cmp_ne_u32 vcc, 0, v3
    s_cmp_eq_u64 vcc, -1
    s_cbranch_scc0 L_H_slow_3
L_H_ok_4:
    v_mfma_f32_16x16x32_bf16 v[96:99], a[144:147], v[36:39], v[96:99]
    ds_read_b64_tr_b16 v[58:59], v29 offset:8704
    v_mfma_f32_16x16x32_bf16 v[100:103], a[132:135], v[32:35], v[100:103]
    s_xor_b32 s80, s75, 0
    ds_read_b64_tr_b16 v[60:61], v29 offset:12288
    v_mfma_f32_16x16x32_bf16 v[100:103], a[148:151], v[36:39], v[100:103]
    ds_read_b64_tr_b16 v[62:63], v29 offset:12800
    v_mfma_f32_16x16x32_bf16 v[104:107], a[136:139], v[32:35], v[104:107]
    buffer_load_dwordx4 v22, s[24:27], s98 offen offset:2048  lds
    v_mfma_f32_16x16x32_bf16 v[104:107], a[152:155], v[36:39], v[104:107]
    v_cvt_pk_bf16_f32 v240, v240, v241
    v_cvt_pk_bf16_f32 v241, v242, v243
    v_mfma_f32_16x16x32_bf16 v[108:111], a[140:143], v[32:35], v[108:111]
    v_cvt_pk_bf16_f32 v242, v244, v245
    v_cvt_pk_bf16_f32 v243, v246, v247
    v_mfma_f32_16x16x32_bf16 v[108:111], a[156:159], v[36:39], v[108:111]
    buffer_load_dwordx4 a[0:3], v1, s[8:11], s80 offen offset:0
    v_mfma_f32_16x16x32_bf16 v[112:115], a[128:131], v[40:43], v[112:115]
    s_waitcnt lgkmcnt(4)
    s_xor_b32 s79, s65, 12288
    s_xor_b32 s80, s75, 16384
    ds_read_b64_tr_b16 v[32:33], v28 offset:16384
    v_mfma_f32_16x16x32_bf16 v[112:115], a[144:147], v[44:47], v[112:115]
    ds_read_b64_tr_b16 v[34:35], v28 offset:16896
    v_mfma_f32_16x16x32_bf16 v[116:119], a[132:135], v[40:43], v[116:119]
    ds_read_b64_tr_b16 v[36:37], v28 offset:20480
    v_mfma_f32_16x16x32_bf16 v[116:119], a[148:151], v[44:47], v[116:119]
    ds_read_b64_tr_b16 v[38:39], v28 offset:20992
    v_mfma_f32_16x16x32_bf16 v[120:123], a[136:139], v[40:43], v[120:123]
    buffer_load_dwordx4 v23, s[24:27], s98 offen offset:3072  lds
    v_mfma_f32_16x16x32_bf16 v[120:123], a[152:155], v[44:47], v[120:123]
    s_add_u32 m0, s63, 49152
    s_xor_b32 s98, s0, 3670016
    v_mfma_f32_16x16x32_bf16 v[124:127], a[140:143], v[40:43], v[124:127]
    buffer_store_dwordx4 v[240:243], v1, s[8:11], s79 offen offset:2048 sc0 sc1
    v_mfma_f32_16x16x32_bf16 v[124:127], a[156:159], v[44:47], v[124:127]
    buffer_load_dwordx4 a[4:7], v1, s[8:11], s80 offen offset:0
    v_mfma_f32_16x16x32_bf16 v[96:99], a[160:163], v[48:51], v[96:99]
    s_xor_b32 s80, s76, 0
    ds_read_b64_tr_b16 v[40:41], v29 offset:16384
    v_mfma_f32_16x16x32_bf16 v[96:99], a[176:179], v[52:55], v[96:99]
    ds_read_b64_tr_b16 v[42:43], v29 offset:16896
    v_mfma_f32_16x16x32_bf16 v[100:103], a[164:167], v[48:51], v[100:103]
    ds_read_b64_tr_b16 v[44:45], v29 offset:20480
    v_mfma_f32_16x16x32_bf16 v[100:103], a[180:183], v[52:55], v[100:103]
    ds_read_b64_tr_b16 v[46:47], v29 offset:20992
    v_mfma_f32_16x16x32_bf16 v[104:107], a[168:171], v[48:51], v[104:107]
    buffer_load_dwordx4 v20, s[24:27], s98 offen offset:0  lds
    v_mfma_f32_16x16x32_bf16 v[104:107], a[184:187], v[52:55], v[104:107]
    buffer_load_dwordx4 a[8:11], v1, s[8:11], s80 offen offset:0
    v_mfma_f32_16x16x32_bf16 v[108:111], a[172:175], v[48:51], v[108:111]
    v_mfma_f32_16x16x32_bf16 v[108:111], a[188:191], v[52:55], v[108:111]
    s_waitcnt lgkmcnt(4)
    v_mfma_f32_16x16x32_bf16 v[112:115], a[160:163], v[56:59], v[112:115]
    s_xor_b32 s80, s76, 16384
    ds_read_b64_tr_b16 v[48:49], v28 offset:24576
    v_mfma_f32_16x16x32_bf16 v[112:115], a[176:179], v[60:63], v[112:115]
    ds_read_b64_tr_b16 v[50:51], v28 offset:25088
    v_mfma_f32_16x16x32_bf16 v[116:119], a[164:167], v[56:59], v[116:119]
    ds_read_b64_tr_b16 v[52:53], v28 offset:28672
    v_cvt_pk_bf16_f32 v248, v248, v249
    v_mfma_f32_16x16x32_bf16 v[116:119], a[180:183], v[60:63], v[116:119]
    ds_read_b64_tr_b16 v[54:55], v28 offset:29184
    v_cvt_pk_bf16_f32 v249, v250, v251
    v_mfma_f32_16x16x32_bf16 v[120:123], a[168:171], v[56:59], v[120:123]
    buffer_load_dwordx4 v21, s[24:27], s98 offen offset:1024  lds
    v_mfma_f32_16x16x32_bf16 v[120:123], a[184:187], v[60:63], v[120:123]
    v_cvt_pk_bf16_f32 v250, v252, v253
    v_cvt_pk_bf16_f32 v251, v254, v255
    v_mfma_f32_16x16x32_bf16 v[124:127], a[172:175], v[56:59], v[124:127]
    buffer_load_dwordx4 a[12:15], v1, s[8:11], s80 offen offset:0
    v_mfma_f32_16x16x32_bf16 v[124:127], a[188:191], v[60:63], v[124:127]
    v_mfma_f32_16x16x32_bf16 v[96:99], a[192:195], v[32:35], v[96:99]
    s_xor_b32 s79, s65, 12288
    s_xor_b32 s80, s75, 0
    ds_read_b64_tr_b16 v[56:57], v29 offset:24576
    v_mfma_f32_16x16x32_bf16 v[96:99], a[208:211], v[36:39], v[96:99]
    ds_read_b64_tr_b16 v[58:59], v29 offset:25088
    v_mfma_f32_16x16x32_bf16 v[100:103], a[196:199], v[32:35], v[100:103]
    ds_read_b64_tr_b16 v[60:61], v29 offset:28672
    v_mfma_f32_16x16x32_bf16 v[100:103], a[212:215], v[36:39], v[100:103]
    ds_read_b64_tr_b16 v[62:63], v29 offset:29184
    v_mfma_f32_16x16x32_bf16 v[104:107], a[200:203], v[32:35], v[104:107]
    buffer_load_dwordx4 v22, s[24:27], s98 offen offset:2048  lds
    v_mfma_f32_16x16x32_bf16 v[104:107], a[216:219], v[36:39], v[104:107]
    buffer_store_dwordx4 v[248:251], v1, s[8:11], s79 offen offset:3072 sc0 sc1
    v_mfma_f32_16x16x32_bf16 v[108:111], a[204:207], v[32:35], v[108:111]
    buffer_load_dwordx4 a[16:19], v1, s[8:11], s80 offen offset:1024
    v_mfma_f32_16x16x32_bf16 v[108:111], a[220:223], v[36:39], v[108:111]
    s_waitcnt lgkmcnt(4)
    s_xor_b32 s80, s75, 16384
    v_xor_b32 v30, 65536, v30
    v_mfma_f32_16x16x32_bf16 v[112:115], a[192:195], v[40:43], v[112:115]
    ds_read_b64_tr_b16 v[32:33], v30 offset:0
    v_mfma_f32_16x16x32_bf16 v[112:115], a[208:211], v[44:47], v[112:115]
    ds_read_b64_tr_b16 v[34:35], v30 offset:512
    v_mfma_f32_16x16x32_bf16 v[116:119], a[196:199], v[40:43], v[116:119]
    ds_read_b64_tr_b16 v[36:37], v30 offset:4096
    v_mfma_f32_16x16x32_bf16 v[116:119], a[212:215], v[44:47], v[116:119]
    ds_read_b64_tr_b16 v[38:39], v30 offset:4608
    v_mfma_f32_16x16x32_bf16 v[120:123], a[200:203], v[40:43], v[120:123]
    buffer_load_dwordx4 v23, s[24:27], s98 offen offset:3072  lds
    v_mfma_f32_16x16x32_bf16 v[120:123], a[216:219], v[44:47], v[120:123]
    buffer_load_dwordx4 a[20:23], v1, s[8:11], s80 offen offset:1024
    v_mfma_f32_16x16x32_bf16 v[124:127], a[204:207], v[40:43], v[124:127]
    v_mfma_f32_16x16x32_bf16 v[124:127], a[220:223], v[44:47], v[124:127]
    s_xor_b32 s80, s76, 0
    v_xor_b32 v31, 65536, v31
    v_mfma_f32_16x16x32_bf16 v[96:99], a[224:227], v[48:51], v[96:99]
    ds_read_b64_tr_b16 v[40:41], v31 offset:0
    v_mfma_f32_16x16x32_bf16 v[96:99], a[240:243], v[52:55], v[96:99]
    ds_read_b64_tr_b16 v[42:43], v31 offset:512
    v_mfma_f32_16x16x32_bf16 v[100:103], a[228:231], v[48:51], v[100:103]
    ds_read_b64_tr_b16 v[44:45], v31 offset:4096
    v_mfma_f32_16x16x32_bf16 v[100:103], a[244:247], v[52:55], v[100:103]
    ds_read_b64_tr_b16 v[46:47], v31 offset:4608
    v_mfma_f32_16x16x32_bf16 v[104:107], a[232:235], v[48:51], v[104:107]
    buffer_load_dwordx4 a[24:27], v1, s[8:11], s80 offen offset:1024
    v_mfma_f32_16x16x32_bf16 v[104:107], a[248:251], v[52:55], v[104:107]
    s_xor_b32 s80, s76, 16384
    v_mfma_f32_16x16x32_bf16 v[108:111], a[236:239], v[48:51], v[108:111]
    buffer_load_dwordx4 a[28:31], v1, s[8:11], s80 offen offset:1024
    v_mfma_f32_16x16x32_bf16 v[108:111], a[252:255], v[52:55], v[108:111]
    s_waitcnt lgkmcnt(4)
    v_mfma_f32_16x16x32_bf16 v[112:115], a[224:227], v[56:59], v[112:115]
    ds_read_b64_tr_b16 v[48:49], v30 offset:8192
    v_mfma_f32_16x16x32_bf16 v[112:115], a[240:243], v[60:63], v[112:115]
    s_xor_b32 s80, s75, 2048
    ds_read_b64_tr_b16 v[50:51], v30 offset:8704
    v_mfma_f32_16x16x32_bf16 v[116:119], a[228:231], v[56:59], v[116:119]
    ds_read_b64_tr_b16 v[52:53], v30 offset:12288
    v_mfma_f32_16x16x32_bf16 v[116:119], a[244:247], v[60:63], v[116:119]
    ds_read_b64_tr_b16 v[54:55], v30 offset:12800
    v_mfma_f32_16x16x32_bf16 v[120:123], a[232:235], v[56:59], v[120:123]
    buffer_load_dwordx4 a[32:35], v1, s[8:11], s80 offen offset:0
    v_mfma_f32_16x16x32_bf16 v[120:123], a[248:251], v[60:63], v[120:123]
    v_mfma_f32_16x16x32_bf16 v[124:127], a[236:239], v[56:59], v[124:127]
    v_mfma_f32_16x16x32_bf16 v[124:127], a[252:255], v[60:63], v[124:127]
    v_mfma_f32_16x16x32_bf16 v[64:67], a[128:131], v[32:35], v[64:67]
    s_xor_b32 s80, s75, 18432
    ds_read_b64_tr_b16 v[56:57], v31 offset:8192
    v_mfma_f32_16x16x32_bf16 v[64:67], a[144:147], v[36:39], v[64:67]
    ds_read_b64_tr_b16 v[58:59], v31 offset:8704
    v_mfma_f32_16x16x32_bf16 v[68:71], a[132:135], v[32:35], v[68:71]
    ds_read_b64_tr_b16 v[60:61], v31 offset:12288
    v_mfma_f32_16x16x32_bf16 v[68:71], a[148:151], v[36:39], v[68:71]
    ds_read_b64_tr_b16 v[62:63], v31 offset:12800
    v_mfma_f32_16x16x32_bf16 v[72:75], a[136:139], v[32:35], v[72:75]
    buffer_load_dwordx4 a[36:39], v1, s[8:11], s80 offen offset:0
    v_mfma_f32_16x16x32_bf16 v[72:75], a[152:155], v[36:39], v[72:75]
    v_mfma_f32_16x16x32_bf16 v[76:79], a[140:143], v[32:35], v[76:79]
    v_mfma_f32_16x16x32_bf16 v[76:79], a[156:159], v[36:39], v[76:79]
    s_waitcnt lgkmcnt(4)
    v_mfma_f32_16x16x32_bf16 v[80:83], a[128:131], v[40:43], v[80:83]
    s_xor_b32 s80, s76, 2048
    ds_read_b64_tr_b16 v[32:33], v30 offset:16384
    v_cvt_pk_bf16_f32 v96, v96, v97
    v_mfma_f32_16x16x32_bf16 v[80:83], a[144:147], v[44:47], v[80:83]
    ds_read_b64_tr_b16 v[34:35], v30 offset:16896
    v_cvt_pk_bf16_f32 v97, v98, v99
    v_mfma_f32_16x16x32_bf16 v[84:87], a[132:135], v[40:43], v[84:87]
    ds_read_b64_tr_b16 v[36:37], v30 offset:20480
    v_cvt_pk_bf16_f32 v98, v100, v101
    v_mfma_f32_16x16x32_bf16 v[84:87], a[148:151], v[44:47], v[84:87]
    ds_read_b64_tr_b16 v[38:39], v30 offset:20992
    v_cvt_pk_bf16_f32 v99, v102, v103
    v_mfma_f32_16x16x32_bf16 v[88:91], a[136:139], v[40:43], v[88:91]
    s_xor_b32 s79, s1, 36864
    v_mfma_f32_16x16x32_bf16 v[88:91], a[152:155], v[44:47], v[88:91]
    buffer_store_dwordx4 v[96:99], v1, s[8:11], s79 offen offset:0 sc0 sc1
    v_mfma_f32_16x16x32_bf16 v[92:95], a[140:143], v[40:43], v[92:95]
    buffer_load_dwordx4 a[40:43], v1, s[8:11], s80 offen offset:0
    v_mfma_f32_16x16x32_bf16 v[92:95], a[156:159], v[44:47], v[92:95]
    v_mfma_f32_16x16x32_bf16 v[64:67], a[160:163], v[48:51], v[64:67]
    s_xor_b32 s80, s76, 18432
    ds_read_b64_tr_b16 v[40:41], v31 offset:16384
    v_mfma_f32_16x16x32_bf16 v[64:67], a[176:179], v[52:55], v[64:67]
    ds_read_b64_tr_b16 v[42:43], v31 offset:16896
    v_mfma_f32_16x16x32_bf16 v[68:71], a[164:167], v[48:51], v[68:71]
    ds_read_b64_tr_b16 v[44:45], v31 offset:20480
    v_mfma_f32_16x16x32_bf16 v[68:71], a[180:183], v[52:55], v[68:71]
    ds_read_b64_tr_b16 v[46:47], v31 offset:20992
    v_mfma_f32_16x16x32_bf16 v[72:75], a[168:171], v[48:51], v[72:75]
    buffer_load_dwordx4 a[44:47], v1, s[8:11], s80 offen offset:0
    v_mfma_f32_16x16x32_bf16 v[72:75], a[184:187], v[52:55], v[72:75]
    s_xor_b32 s80, s75, 2048
    v_mfma_f32_16x16x32_bf16 v[76:79], a[172:175], v[48:51], v[76:79]
    buffer_load_dwordx4 a[48:51], v1, s[8:11], s80 offen offset:1024
    v_mfma_f32_16x16x32_bf16 v[76:79], a[188:191], v[52:55], v[76:79]
    s_waitcnt lgkmcnt(4)
    v_mfma_f32_16x16x32_bf16 v[80:83], a[160:163], v[56:59], v[80:83]
    ds_read_b64_tr_b16 v[48:49], v30 offset:24576
    v_cvt_pk_bf16_f32 v104, v104, v105
    v_mfma_f32_16x16x32_bf16 v[80:83], a[176:179], v[60:63], v[80:83]
    ds_read_b64_tr_b16 v[50:51], v30 offset:25088
    v_cvt_pk_bf16_f32 v105, v106, v107
    v_mfma_f32_16x16x32_bf16 v[84:87], a[164:167], v[56:59], v[84:87]
    ds_read_b64_tr_b16 v[52:53], v30 offset:28672
    v_cvt_pk_bf16_f32 v106, v108, v109
    v_mfma_f32_16x16x32_bf16 v[84:87], a[180:183], v[60:63], v[84:87]
    ds_read_b64_tr_b16 v[54:55], v30 offset:29184
    v_cvt_pk_bf16_f32 v107, v110, v111
    v_mfma_f32_16x16x32_bf16 v[88:91], a[168:171], v[56:59], v[88:91]
    s_xor_b32 s79, s1, 45056
    s_xor_b32 s80, s75, 18432
    v_mfma_f32_16x16x32_bf16 v[88:91], a[184:187], v[60:63], v[88:91]
    buffer_store_dwordx4 v[104:107], v1, s[8:11], s79 offen offset:0 sc0 sc1
    v_mfma_f32_16x16x32_bf16 v[92:95], a[172:175], v[56:59], v[92:95]
    buffer_load_dwordx4 a[52:55], v1, s[8:11], s80 offen offset:1024
    v_mfma_f32_16x16x32_bf16 v[92:95], a[188:191], v[60:63], v[92:95]
    v_mfma_f32_16x16x32_bf16 v[64:67], a[192:195], v[32:35], v[64:67]
    ds_read_b64_tr_b16 v[56:57], v31 offset:24576
    v_mfma_f32_16x16x32_bf16 v[64:67], a[208:211], v[36:39], v[64:67]
    ds_read_b64_tr_b16 v[58:59], v31 offset:25088
    v_mfma_f32_16x16x32_bf16 v[68:71], a[196:199], v[32:35], v[68:71]
    ds_read_b64_tr_b16 v[60:61], v31 offset:28672
    v_mfma_f32_16x16x32_bf16 v[68:71], a[212:215], v[36:39], v[68:71]
    s_xor_b32 s80, s76, 2048
    ds_read_b64_tr_b16 v[62:63], v31 offset:29184
    v_mfma_f32_16x16x32_bf16 v[72:75], a[200:203], v[32:35], v[72:75]
    buffer_load_dwordx4 a[56:59], v1, s[8:11], s80 offen offset:1024
    v_mfma_f32_16x16x32_bf16 v[72:75], a[216:219], v[36:39], v[72:75]
    v_mfma_f32_16x16x32_bf16 v[76:79], a[204:207], v[32:35], v[76:79]
    v_cvt_pk_bf16_f32 v112, v112, v113
    v_cvt_pk_bf16_f32 v113, v114, v115
    v_mfma_f32_16x16x32_bf16 v[76:79], a[220:223], v[36:39], v[76:79]
    s_waitcnt lgkmcnt(4)
    v_cvt_pk_bf16_f32 v114, v116, v117
    v_cvt_pk_bf16_f32 v115, v118, v119
    v_mfma_f32_16x16x32_bf16 v[80:83], a[192:195], v[40:43], v[80:83]
    s_xor_b32 s79, s1, 36864
    v_mfma_f32_16x16x32_bf16 v[80:83], a[208:211], v[44:47], v[80:83]
    buffer_store_dwordx4 v[112:115], v1, s[8:11], s79 offen offset:1024 sc0 sc1
    v_mfma_f32_16x16x32_bf16 v[84:87], a[196:199], v[40:43], v[84:87]
    s_xor_b32 s80, s76, 18432
    v_mfma_f32_16x16x32_bf16 v[84:87], a[212:215], v[44:47], v[84:87]
    buffer_load_dwordx4 a[60:63], v1, s[8:11], s80 offen offset:1024
    v_mfma_f32_16x16x32_bf16 v[88:91], a[200:203], v[40:43], v[88:91]
    v_mfma_f32_16x16x32_bf16 v[88:91], a[216:219], v[44:47], v[88:91]
    v_mfma_f32_16x16x32_bf16 v[92:95], a[204:207], v[40:43], v[92:95]
    s_waitcnt lgkmcnt(0)
    s_barrier
    v_mfma_f32_16x16x32_bf16 v[92:95], a[220:223], v[44:47], v[92:95]
    ds_read_b64_tr_b16 v[32:33], v8 offset:32768
    v_mfma_f32_16x16x32_bf16 v[64:67], a[224:227], v[48:51], v[64:67]
    ds_read_b64_tr_b16 v[34:35], v8 offset:33792
    v_mfma_f32_16x16x32_bf16 v[64:67], a[240:243], v[52:55], v[64:67]
    s_xor_b32 s80, s75, 4096
    ds_read_b64_tr_b16 v[36:37], v9 offset:32768
    v_mfma_f32_16x16x32_bf16 v[68:71], a[228:231], v[48:51], v[68:71]
    ds_read_b64_tr_b16 v[38:39], v9 offset:33792
    v_mfma_f32_16x16x32_bf16 v[68:71], a[244:247], v[52:55], v[68:71]
    ds_read_b64_tr_b16 v[40:41], v10 offset:32768
    v_mfma_f32_16x16x32_bf16 v[72:75], a[232:235], v[48:51], v[72:75]
    ds_read_b64_tr_b16 v[42:43], v10 offset:33792
    v_mfma_f32_16x16x32_bf16 v[72:75], a[248:251], v[52:55], v[72:75]
    ds_read_b64_tr_b16 v[44:45], v11 offset:32768
    v_mfma_f32_16x16x32_bf16 v[76:79], a[236:239], v[48:51], v[76:79]
    ds_read_b64_tr_b16 v[46:47], v11 offset:33792
    v_cvt_pk_bf16_f32 v120, v120, v121
    v_mfma_f32_16x16x32_bf16 v[76:79], a[252:255], v[52:55], v[76:79]
    buffer_load_dwordx4 a[64:67], v1, s[8:11], s80 offen offset:0
    v_mfma_f32_16x16x32_bf16 v[80:83], a[224:227], v[56:59], v[80:83]
    s_xor_b32 s80, s75, 20480
    ds_read_b64_tr_b16 v[48:49], v12 offset:32768
    v_cvt_pk_bf16_f32 v121, v122, v123
    v_mfma_f32_16x16x32_bf16 v[80:83], a[240:243], v[60:63], v[80:83]
    ds_read_b64_tr_b16 v[50:51], v12 offset:33792
    v_cvt_pk_bf16_f32 v122, v124, v125
    v_mfma_f32_16x16x32_bf16 v[84:87], a[228:231], v[56:59], v[84:87]
    ds_read_b64_tr_b16 v[52:53], v13 offset:32768
    v_cvt_pk_bf16_f32 v123, v126, v127
    v_mfma_f32_16x16x32_bf16 v[84:87], a[244:247], v[60:63], v[84:87]
    s_xor_b32 s79, s1, 45056
    ds_read_b64_tr_b16 v[54:55], v13 offset:33792
    v_mfma_f32_16x16x32_bf16 v[88:91], a[232:235], v[56:59], v[88:91]
    buffer_store_dwordx4 v[120:123], v1, s[8:11], s79 offen offset:1024 sc0 sc1
    v_mfma_f32_16x16x32_bf16 v[88:91], a[248:251], v[60:63], v[88:91]
    buffer_load_dwordx4 a[68:71], v1, s[8:11], s80 offen offset:0
    v_mfma_f32_16x16x32_bf16 v[92:95], a[236:239], v[56:59], v[92:95]
    v_mfma_f32_16x16x32_bf16 v[92:95], a[252:255], v[60:63], v[92:95]
    s_waitcnt vmcnt(28) lgkmcnt(5)
    v_mfma_f32_16x16x32_bf16 v[128:131], v[32:35], a[0:3], 0
    s_waitcnt vmcnt(25)
    s_xor_b32 s80, s76, 4096
    ds_read_b64_tr_b16 v[56:57], v14 offset:32768
    v_mfma_f32_16x16x32_bf16 v[160:163], v[32:35], a[4:7], 0
    s_waitcnt vmcnt(23)
    ds_read_b64_tr_b16 v[58:59], v14 offset:33792
    v_mfma_f32_16x16x32_bf16 v[192:195], v[32:35], a[8:11], 0
    s_waitcnt vmcnt(21)
    ds_read_b64_tr_b16 v[60:61], v15 offset:32768
    v_mfma_f32_16x16x32_bf16 v[224:227], v[32:35], a[12:15], 0
    ds_read_b64_tr_b16 v[62:63], v15 offset:33792
    v_mfma_f32_16x16x32_bf16 v[132:135], v[36:39], a[0:3], 0
    ds_read_b64_tr_b16 v[32:33], v8 offset:40960
    v_mfma_f32_16x16x32_bf16 v[164:167], v[36:39], a[4:7], 0
    ds_read_b64_tr_b16 v[34:35], v8 offset:41984
    v_mfma_f32_16x16x32_bf16 v[196:199], v[36:39], a[8:11], 0
    buffer_load_dwordx4 a[72:75], v1, s[8:11], s80 offen offset:0
    v_mfma_f32_16x16x32_bf16 v[228:231], v[36:39], a[12:15], 0
    v_mfma_f32_16x16x32_bf16 v[136:139], v[40:43], a[0:3], 0
    s_xor_b32 s80, s76, 20480
    ds_read_b64_tr_b16 v[36:37], v9 offset:40960
    v_cvt_pk_bf16_f32 v64, v64, v65
    v_mfma_f32_16x16x32_bf16 v[168:171], v[40:43], a[4:7], 0
    ds_read_b64_tr_b16 v[38:39], v9 offset:41984
    v_cvt_pk_bf16_f32 v65, v66, v67
    v_mfma_f32_16x16x32_bf16 v[200:203], v[40:43], a[8:11], 0
    s_waitcnt lgkmcnt(7)
    v_cvt_pk_bf16_f32 v66, v68, v69
    v_cvt_pk_bf16_f32 v67, v70, v71
    v_mfma_f32_16x16x32_bf16 v[232:235], v[40:43], a[12:15], 0
    buffer_load_dwordx4 a[76:79], v1, s[8:11], s80 offen offset:0
    v_mfma_f32_16x16x32_bf16 v[140:143], v[44:47], a[0:3], 0
    s_xor_b32 s79, s1, 36864
    ds_read_b64_tr_b16 v[40:41], v10 offset:40960
    v_mfma_f32_16x16x32_bf16 v[172:175], v[44:47], a[4:7], 0
    s_xor_b32 s80, s75, 4096
    ds_read_b64_tr_b16 v[42:43], v10 offset:41984
    v_mfma_f32_16x16x32_bf16 v[204:207], v[44:47], a[8:11], 0
    buffer_store_dwordx4 v[64:67], v1, s[8:11], s79 offen offset:2048 sc0 sc1
    v_mfma_f32_16x16x32_bf16 v[236:239], v[44:47], a[12:15], 0
    buffer_load_dwordx4 a[80:83], v1, s[8:11], s80 offen offset:1024
    v_mfma_f32_16x16x32_bf16 v[144:147], v[48:51], a[0:3], 0
    ds_read_b64_tr_b16 v[44:45], v11 offset:40960
    v_mfma_f32_16x16x32_bf16 v[176:179], v[48:51], a[4:7], 0
    ds_read_b64_tr_b16 v[46:47], v11 offset:41984
    v_mfma_f32_16x16x32_bf16 v[208:211], v[48:51], a[8:11], 0
    v_mfma_f32_16x16x32_bf16 v[240:243], v[48:51], a[12:15], 0
    v_mfma_f32_16x16x32_bf16 v[148:151], v[52:55], a[0:3], 0
    s_xor_b32 s80, s75, 20480
    ds_read_b64_tr_b16 v[48:49], v12 offset:40960
    v_mfma_f32_16x16x32_bf16 v[180:183], v[52:55], a[4:7], 0
    ds_read_b64_tr_b16 v[50:51], v12 offset:41984
    v_mfma_f32_16x16x32_bf16 v[212:215], v[52:55], a[8:11], 0
    buffer_load_dwordx4 a[84:87], v1, s[8:11], s80 offen offset:1024
    v_mfma_f32_16x16x32_bf16 v[244:247], v[52:55], a[12:15], 0
    s_waitcnt lgkmcnt(4)
    v_mfma_f32_16x16x32_bf16 v[152:155], v[56:59], a[0:3], 0
    ds_read_b64_tr_b16 v[52:53], v13 offset:40960
    v_cvt_pk_bf16_f32 v72, v72, v73
    v_mfma_f32_16x16x32_bf16 v[184:187], v[56:59], a[4:7], 0
    ds_read_b64_tr_b16 v[54:55], v13 offset:41984
    v_cvt_pk_bf16_f32 v73, v74, v75
    v_mfma_f32_16x16x32_bf16 v[216:219], v[56:59], a[8:11], 0
    v_cvt_pk_bf16_f32 v74, v76, v77
    v_cvt_pk_bf16_f32 v75, v78, v79
    v_mfma_f32_16x16x32_bf16 v[248:251], v[56:59], a[12:15], 0
    v_mfma_f32_16x16x32_bf16 v[156:159], v[60:63], a[0:3], 0
    s_xor_b32 s79, s1, 45056
    s_xor_b32 s80, s76, 4096
    ds_read_b64_tr_b16 v[56:57], v14 offset:40960
    v_mfma_f32_16x16x32_bf16 v[188:191], v[60:63], a[4:7], 0
    s_waitcnt vmcnt(23)
    ds_read_b64_tr_b16 v[58:59], v14 offset:41984
    v_mfma_f32_16x16x32_bf16 v[220:223], v[60:63], a[8:11], 0
    buffer_store_dwordx4 v[72:75], v1, s[8:11], s79 offen offset:2048 sc0 sc1
    v_mfma_f32_16x16x32_bf16 v[252:255], v[60:63], a[12:15], 0
    buffer_load_dwordx4 a[88:91], v1, s[8:11], s80 offen offset:1024
    v_mfma_f32_16x16x32_bf16 v[128:131], v[32:35], a[16:19], v[128:131]
    s_waitcnt vmcnt(23)
    ds_read_b64_tr_b16 v[60:61], v15 offset:40960
    v_mfma_f32_16x16x32_bf16 v[160:163], v[32:35], a[20:23], v[160:163]
    s_waitcnt vmcnt(22)
    ds_read_b64_tr_b16 v[62:63], v15 offset:41984
    v_mfma_f32_16x16x32_bf16 v[192:195], v[32:35], a[24:27], v[192:195]
    s_waitcnt vmcnt(21)
    v_mfma_f32_16x16x32_bf16 v[224:227], v[32:35], a[28:31], v[224:227]
    v_mfma_f32_16x16x32_bf16 v[132:135], v[36:39], a[16:19], v[132:135]
    s_xor_b32 s80, s76, 20480
    ds_read_b64_tr_b16 v[32:33], v8 offset:0
    v_mfma_f32_16x16x32_bf16 v[164:167], v[36:39], a[20:23], v[164:167]
    ds_read_b64_tr_b16 v[34:35], v8 offset:1024
    v_mfma_f32_16x16x32_bf16 v[196:199], v[36:39], a[24:27], v[196:199]
    buffer_load_dwordx4 a[92:95], v1, s[8:11], s80 offen offset:1024
    v_mfma_f32_16x16x32_bf16 v[228:231], v[36:39], a[28:31], v[228:231]
    v_mfma_f32_16x16x32_bf16 v[136:139], v[40:43], a[16:19], v[136:139]
    ds_read_b64_tr_b16 v[36:37], v9 offset:0
    v_cvt_pk_bf16_f32 v80, v80, v81
    v_mfma_f32_16x16x32_bf16 v[168:171], v[40:43], a[20:23], v[168:171]
    s_xor_b32 s80, s75, 6144
    ds_read_b64_tr_b16 v[38:39], v9 offset:1024
    v_cvt_pk_bf16_f32 v81, v82, v83
    v_mfma_f32_16x16x32_bf16 v[200:203], v[40:43], a[24:27], v[200:203]
    s_waitcnt lgkmcnt(5)
    v_cvt_pk_bf16_f32 v82, v84, v85
    v_cvt_pk_bf16_f32 v83, v86, v87
    v_mfma_f32_16x16x32_bf16 v[232:235], v[40:43], a[28:31], v[232:235]
    buffer_load_dwordx4 a[96:99], v1, s[8:11], s80 offen offset:0
    v_mfma_f32_16x16x32_bf16 v[140:143], v[44:47], a[16:19], v[140:143]
    s_xor_b32 s79, s1, 36864
    ds_read_b64_tr_b16 v[40:41], v10 offset:0
    v_mfma_f32_16x16x32_bf16 v[172:175], v[44:47], a[20:23], v[172:175]
    ds_read_b64_tr_b16 v[42:43], v10 offset:1024
    v_mfma_f32_16x16x32_bf16 v[204:207], v[44:47], a[24:27], v[204:207]
    buffer_store_dwordx4 v[80:83], v1, s[8:11], s79 offen offset:3072 sc0 sc1
    v_mfma_f32_16x16x32_bf16 v[236:239], v[44:47], a[28:31], v[236:239]
    v_mfma_f32_16x16x32_bf16 v[144:147], v[48:51], a[16:19], v[144:147]
    s_xor_b32 s80, s75, 22528
    ds_read_b64_tr_b16 v[44:45], v11 offset:0
    v_mfma_f32_16x16x32_bf16 v[176:179], v[48:51], a[20:23], v[176:179]
    ds_read_b64_tr_b16 v[46:47], v11 offset:1024
    v_mfma_f32_16x16x32_bf16 v[208:211], v[48:51], a[24:27], v[208:211]
    buffer_load_dwordx4 a[100:103], v1, s[8:11], s80 offen offset:0
    v_mfma_f32_16x16x32_bf16 v[240:243], v[48:51], a[28:31], v[240:243]
    v_mfma_f32_16x16x32_bf16 v[148:151], v[52:55], a[16:19], v[148:151]
    ds_read_b64_tr_b16 v[48:49], v12 offset:0
    v_mfma_f32_16x16x32_bf16 v[180:183], v[52:55], a[20:23], v[180:183]
    ds_read_b64_tr_b16 v[50:51], v12 offset:1024
    v_mfma_f32_16x16x32_bf16 v[212:215], v[52:55], a[24:27], v[212:215]
    v_mfma_f32_16x16x32_bf16 v[244:247], v[52:55], a[28:31], v[244:247]
    v_mfma_f32_16x16x32_bf16 v[152:155], v[56:59], a[16:19], v[152:155]
    s_xor_b32 s80, s76, 6144
    ds_read_b64_tr_b16 v[52:53], v13 offset:0
    v_cvt_pk_bf16_f32 v88, v88, v89
    v_mfma_f32_16x16x32_bf16 v[184:187], v[56:59], a[20:23], v[184:187]
    ds_read_b64_tr_b16 v[54:55], v13 offset:1024
    v_cvt_pk_bf16_f32 v89, v90, v91
    v_mfma_f32_16x16x32_bf16 v[216:219], v[56:59], a[24:27], v[216:219]
    s_waitcnt lgkmcnt(5)
    v_cvt_pk_bf16_f32 v90, v92, v93
    v_cvt_pk_bf16_f32 v91, v94, v95
    v_mfma_f32_16x16x32_bf16 v[248:251], v[56:59], a[28:31], v[248:251]
    buffer_load_dwordx4 a[104:107], v1, s[8:11], s80 offen offset:0
    v_mfma_f32_16x16x32_bf16 v[156:159], v[60:63], a[16:19], v[156:159]
    s_xor_b32 s79, s1, 45056
    ds_read_b64_tr_b16 v[56:57], v14 offset:0
    v_mfma_f32_16x16x32_bf16 v[188:191], v[60:63], a[20:23], v[188:191]
    ds_read_b64_tr_b16 v[58:59], v14 offset:1024
    v_mfma_f32_16x16x32_bf16 v[220:223], v[60:63], a[24:27], v[220:223]
    buffer_store_dwordx4 v[88:91], v1, s[8:11], s79 offen offset:3072 sc0 sc1
    v_mfma_f32_16x16x32_bf16 v[252:255], v[60:63], a[28:31], v[252:255]
    s_waitcnt vmcnt(26)
    v_mfma_f32_16x16x32_bf16 v[128:131], v[32:35], a[32:35], v[128:131]
    s_waitcnt vmcnt(25)
    s_xor_b32 s80, s76, 22528
    ds_read_b64_tr_b16 v[60:61], v15 offset:0
    v_mfma_f32_16x16x32_bf16 v[160:163], v[32:35], a[36:39], v[160:163]
    s_waitcnt vmcnt(22)
    ds_read_b64_tr_b16 v[62:63], v15 offset:1024
    v_mfma_f32_16x16x32_bf16 v[192:195], v[32:35], a[40:43], v[192:195]
    buffer_load_dwordx4 a[108:111], v1, s[8:11], s80 offen offset:0
    v_mfma_f32_16x16x32_bf16 v[224:227], v[32:35], a[44:47], v[224:227]
    v_mfma_f32_16x16x32_bf16 v[132:135], v[36:39], a[32:35], v[132:135]
    ds_read_b64_tr_b16 v[32:33], v8 offset:8192
    v_mfma_f32_16x16x32_bf16 v[164:167], v[36:39], a[36:39], v[164:167]
    s_xor_b32 s80, s75, 6144
    ds_read_b64_tr_b16 v[34:35], v8 offset:9216
    v_mfma_f32_16x16x32_bf16 v[196:199], v[36:39], a[40:43], v[196:199]
    buffer_load_dwordx4 a[112:115], v1, s[8:11], s80 offen offset:1024
    v_mfma_f32_16x16x32_bf16 v[228:231], v[36:39], a[44:47], v[228:231]
    v_mfma_f32_16x16x32_bf16 v[136:139], v[40:43], a[32:35], v[136:139]
    ds_read_b64_tr_b16 v[36:37], v9 offset:8192
    v_mfma_f32_16x16x32_bf16 v[168:171], v[40:43], a[36:39], v[168:171]
    ds_read_b64_tr_b16 v[38:39], v9 offset:9216
    v_mfma_f32_16x16x32_bf16 v[200:203], v[40:43], a[40:43], v[200:203]
    v_mfma_f32_16x16x32_bf16 v[232:235], v[40:43], a[44:47], v[232:235]
    s_waitcnt lgkmcnt(4)
    v_mfma_f32_16x16x32_bf16 v[140:143], v[44:47], a[32:35], v[140:143]
    s_xor_b32 s80, s75, 22528
    ds_read_b64_tr_b16 v[40:41], v10 offset:8192
    v_mfma_f32_16x16x32_bf16 v[172:175], v[44:47], a[36:39], v[172:175]
    ds_read_b64_tr_b16 v[42:43], v10 offset:9216
    v_mfma_f32_16x16x32_bf16 v[204:207], v[44:47], a[40:43], v[204:207]
    buffer_load_dwordx4 a[116:119], v1, s[8:11], s80 offen offset:1024
    v_mfma_f32_16x16x32_bf16 v[236:239], v[44:47], a[44:47], v[236:239]
    v_mfma_f32_16x16x32_bf16 v[144:147], v[48:51], a[32:35], v[144:147]
    ds_read_b64_tr_b16 v[44:45], v11 offset:8192
    v_mfma_f32_16x16x32_bf16 v[176:179], v[48:51], a[36:39], v[176:179]
    ds_read_b64_tr_b16 v[46:47], v11 offset:9216
    v_mfma_f32_16x16x32_bf16 v[208:211], v[48:51], a[40:43], v[208:211]
    v_mfma_f32_16x16x32_bf16 v[240:243], v[48:51], a[44:47], v[240:243]
    v_mfma_f32_16x16x32_bf16 v[148:151], v[52:55], a[32:35], v[148:151]
    s_xor_b32 s80, s76, 6144
    ds_read_b64_tr_b16 v[48:49], v12 offset:8192
    v_mfma_f32_16x16x32_bf16 v[180:183], v[52:55], a[36:39], v[180:183]
    ds_read_b64_tr_b16 v[50:51], v12 offset:9216
    v_mfma_f32_16x16x32_bf16 v[212:215], v[52:55], a[40:43], v[212:215]
    buffer_load_dwordx4 a[120:123], v1, s[8:11], s80 offen offset:1024
    v_mfma_f32_16x16x32_bf16 v[244:247], v[52:55], a[44:47], v[244:247]
    v_mfma_f32_16x16x32_bf16 v[152:155], v[56:59], a[32:35], v[152:155]
    ds_read_b64_tr_b16 v[52:53], v13 offset:8192
    v_mfma_f32_16x16x32_bf16 v[184:187], v[56:59], a[36:39], v[184:187]
    ds_read_b64_tr_b16 v[54:55], v13 offset:9216
    v_mfma_f32_16x16x32_bf16 v[216:219], v[56:59], a[40:43], v[216:219]
    v_mfma_f32_16x16x32_bf16 v[248:251], v[56:59], a[44:47], v[248:251]
    v_mfma_f32_16x16x32_bf16 v[156:159], v[60:63], a[32:35], v[156:159]
    s_xor_b32 s80, s76, 22528
    ds_read_b64_tr_b16 v[56:57], v14 offset:8192
    v_mfma_f32_16x16x32_bf16 v[188:191], v[60:63], a[36:39], v[188:191]
    ds_read_b64_tr_b16 v[58:59], v14 offset:9216
    v_mfma_f32_16x16x32_bf16 v[220:223], v[60:63], a[40:43], v[220:223]
    buffer_load_dwordx4 a[124:127], v1, s[8:11], s80 offen offset:1024
    v_mfma_f32_16x16x32_bf16 v[252:255], v[60:63], a[44:47], v[252:255]
    s_waitcnt vmcnt(26) lgkmcnt(4)
    v_mfma_f32_16x16x32_bf16 v[128:131], v[32:35], a[48:51], v[128:131]
    s_waitcnt vmcnt(24)
    ds_read_b64_tr_b16 v[60:61], v15 offset:8192
    v_mfma_f32_16x16x32_bf16 v[160:163], v[32:35], a[52:55], v[160:163]
    s_waitcnt vmcnt(21)
    s_xor_b32 s80, s75, 8192
    ds_read_b64_tr_b16 v[62:63], v15 offset:9216
    v_mfma_f32_16x16x32_bf16 v[192:195], v[32:35], a[56:59], v[192:195]
    buffer_load_dwordx4 a[128:131], v1, s[8:11], s80 offen offset:0
    v_mfma_f32_16x16x32_bf16 v[224:227], v[32:35], a[60:63], v[224:227]
    v_mfma_f32_16x16x32_bf16 v[132:135], v[36:39], a[48:51], v[132:135]
    ds_read_b64_tr_b16 v[32:33], v8 offset:16384
    v_mfma_f32_16x16x32_bf16 v[164:167], v[36:39], a[52:55], v[164:167]
    ds_read_b64_tr_b16 v[34:35], v8 offset:17408
    v_mfma_f32_16x16x32_bf16 v[196:199], v[36:39], a[56:59], v[196:199]
    v_mfma_f32_16x16x32_bf16 v[228:231], v[36:39], a[60:63], v[228:231]
    v_mfma_f32_16x16x32_bf16 v[136:139], v[40:43], a[48:51], v[136:139]
    s_xor_b32 s80, s75, 24576
    ds_read_b64_tr_b16 v[36:37], v9 offset:16384
    v_mfma_f32_16x16x32_bf16 v[168:171], v[40:43], a[52:55], v[168:171]
    ds_read_b64_tr_b16 v[38:39], v9 offset:17408
    v_mfma_f32_16x16x32_bf16 v[200:203], v[40:43], a[56:59], v[200:203]
    buffer_load_dwordx4 a[132:135], v1, s[8:11], s80 offen offset:0
    v_mfma_f32_16x16x32_bf16 v[232:235], v[40:43], a[60:63], v[232:235]
    v_mfma_f32_16x16x32_bf16 v[140:143], v[44:47], a[48:51], v[140:143]
    ds_read_b64_tr_b16 v[40:41], v10 offset:16384
    v_mfma_f32_16x16x32_bf16 v[172:175], v[44:47], a[52:55], v[172:175]
    ds_read_b64_tr_b16 v[42:43], v10 offset:17408
    v_mfma_f32_16x16x32_bf16 v[204:207], v[44:47], a[56:59], v[204:207]
    v_mfma_f32_16x16x32_bf16 v[236:239], v[44:47], a[60:63], v[236:239]
    v_mfma_f32_16x16x32_bf16 v[144:147], v[48:51], a[48:51], v[144:147]
    s_xor_b32 s80, s76, 8192
    ds_read_b64_tr_b16 v[44:45], v11 offset:16384
    v_mfma_f32_16x16x32_bf16 v[176:179], v[48:51], a[52:55], v[176:179]
    ds_read_b64_tr_b16 v[46:47], v11 offset:17408
    v_mfma_f32_16x16x32_bf16 v[208:211], v[48:51], a[56:59], v[208:211]
    buffer_load_dwordx4 a[136:139], v1, s[8:11], s80 offen offset:0
    v_mfma_f32_16x16x32_bf16 v[240:243], v[48:51], a[60:63], v[240:243]
    s_waitcnt lgkmcnt(4)
    v_mfma_f32_16x16x32_bf16 v[148:151], v[52:55], a[48:51], v[148:151]
    ds_read_b64_tr_b16 v[48:49], v12 offset:16384
    v_mfma_f32_16x16x32_bf16 v[180:183], v[52:55], a[52:55], v[180:183]
    ds_read_b64_tr_b16 v[50:51], v12 offset:17408
    v_mfma_f32_16x16x32_bf16 v[212:215], v[52:55], a[56:59], v[212:215]
    v_mfma_f32_16x16x32_bf16 v[244:247], v[52:55], a[60:63], v[244:247]
    v_mfma_f32_16x16x32_bf16 v[152:155], v[56:59], a[48:51], v[152:155]
    s_xor_b32 s80, s76, 24576
    ds_read_b64_tr_b16 v[52:53], v13 offset:16384
    v_mfma_f32_16x16x32_bf16 v[184:187], v[56:59], a[52:55], v[184:187]
    ds_read_b64_tr_b16 v[54:55], v13 offset:17408
    v_mfma_f32_16x16x32_bf16 v[216:219], v[56:59], a[56:59], v[216:219]
    buffer_load_dwordx4 a[140:143], v1, s[8:11], s80 offen offset:0
    s_waitcnt vmcnt(9)
    v_mfma_f32_16x16x32_bf16 v[248:251], v[56:59], a[60:63], v[248:251]
    buffer_store_dword v6, v5, s[8:11], s73 offen sc0 sc1
    v_mfma_f32_16x16x32_bf16 v[156:159], v[60:63], a[48:51], v[156:159]
    ds_read_b64_tr_b16 v[56:57], v14 offset:16384
    v_mfma_f32_16x16x32_bf16 v[188:191], v[60:63], a[52:55], v[188:191]
    s_xor_b32 s80, s75, 8192
    ds_read_b64_tr_b16 v[58:59], v14 offset:17408
    v_mfma_f32_16x16x32_bf16 v[220:223], v[60:63], a[56:59], v[220:223]
    buffer_load_dwordx4 a[144:147], v1, s[8:11], s80 offen offset:1024
    v_mfma_f32_16x16x32_bf16 v[252:255], v[60:63], a[60:63], v[252:255]
    v_mfma_f32_16x16x32_bf16 v[128:131], v[32:35], a[64:67], v[128:131]
    ds_read_b64_tr_b16 v[60:61], v15 offset:16384
    v_mfma_f32_16x16x32_bf16 v[160:163], v[32:35], a[68:71], v[160:163]
    ds_read_b64_tr_b16 v[62:63], v15 offset:17408
    v_mfma_f32_16x16x32_bf16 v[192:195], v[32:35], a[72:75], v[192:195]
    v_mfma_f32_16x16x32_bf16 v[224:227], v[32:35], a[76:79], v[224:227]
    v_mfma_f32_16x16x32_bf16 v[132:135], v[36:39], a[64:67], v[132:135]
    s_xor_b32 s80, s75, 24576
    ds_read_b64_tr_b16 v[32:33], v8 offset:24576
    v_mfma_f32_16x16x32_bf16 v[164:167], v[36:39], a[68:71], v[164:167]
    ds_read_b64_tr_b16 v[34:35], v8 offset:25600
    v_mfma_f32_16x16x32_bf16 v[196:199], v[36:39], a[72:75], v[196:199]
    buffer_load_dwordx4 a[148:151], v1, s[8:11], s80 offen offset:1024
    v_mfma_f32_16x16x32_bf16 v[228:231], v[36:39], a[76:79], v[228:231]
    s_waitcnt lgkmcnt(4)
    v_mfma_f32_16x16x32_bf16 v[136:139], v[40:43], a[64:67], v[136:139]
    ds_read_b64_tr_b16 v[36:37], v9 offset:24576
    v_mfma_f32_16x16x32_bf16 v[168:171], v[40:43], a[68:71], v[168:171]
    ds_read_b64_tr_b16 v[38:39], v9 offset:25600
    v_mfma_f32_16x16x32_bf16 v[200:203], v[40:43], a[72:75], v[200:203]
    v_mfma_f32_16x16x32_bf16 v[232:235], v[40:43], a[76:79], v[232:235]
    v_mfma_f32_16x16x32_bf16 v[140:143], v[44:47], a[64:67], v[140:143]
    s_xor_b32 s80, s76, 8192
    ds_read_b64_tr_b16 v[40:41], v10 offset:24576
    v_mfma_f32_16x16x32_bf16 v[172:175], v[44:47], a[68:71], v[172:175]
    ds_read_b64_tr_b16 v[42:43], v10 offset:25600
    v_mfma_f32_16x16x32_bf16 v[204:207], v[44:47], a[72:75], v[204:207]
    buffer_load_dwordx4 a[152:155], v1, s[8:11], s80 offen offset:1024
    v_mfma_f32_16x16x32_bf16 v[236:239], v[44:47], a[76:79], v[236:239]
    v_mfma_f32_16x16x32_bf16 v[144:147], v[48:51], a[64:67], v[144:147]
    ds_read_b64_tr_b16 v[44:45], v11 offset:24576
    v_mfma_f32_16x16x32_bf16 v[176:179], v[48:51], a[68:71], v[176:179]
    ds_read_b64_tr_b16 v[46:47], v11 offset:25600
    v_mfma_f32_16x16x32_bf16 v[208:211], v[48:51], a[72:75], v[208:211]
    v_mfma_f32_16x16x32_bf16 v[240:243], v[48:51], a[76:79], v[240:243]
    v_mfma_f32_16x16x32_bf16 v[148:151], v[52:55], a[64:67], v[148:151]
    s_xor_b32 s80, s76, 24576
    ds_read_b64_tr_b16 v[48:49], v12 offset:24576
    v_mfma_f32_16x16x32_bf16 v[180:183], v[52:55], a[68:71], v[180:183]
    ds_read_b64_tr_b16 v[50:51], v12 offset:25600
    v_mfma_f32_16x16x32_bf16 v[212:215], v[52:55], a[72:75], v[212:215]
    buffer_load_dwordx4 a[156:159], v1, s[8:11], s80 offen offset:1024
    v_mfma_f32_16x16x32_bf16 v[244:247], v[52:55], a[76:79], v[244:247]
    v_mfma_f32_16x16x32_bf16 v[152:155], v[56:59], a[64:67], v[152:155]
    ds_read_b64_tr_b16 v[52:53], v13 offset:24576
    v_lshlrev_b32 v116, 2, v0
    v_mfma_f32_16x16x32_bf16 v[184:187], v[56:59], a[68:71], v[184:187]
    s_xor_b32 s80, s75, 10240
    ds_read_b64_tr_b16 v[54:55], v13 offset:25600
    v_cmp_gt_u32 vcc, 8, v0
    v_mfma_f32_16x16x32_bf16 v[216:219], v[56:59], a[72:75], v[216:219]
    buffer_load_dwordx4 a[160:163], v1, s[8:11], s80 offen offset:0
    v_mfma_f32_16x16x32_bf16 v[248:251], v[56:59], a[76:79], v[248:251]
    s_waitcnt lgkmcnt(4)
    v_mov_b32 v117, 2147479552
    v_cndmask_b32 v116, v117, v116, vcc
    v_mfma_f32_16x16x32_bf16 v[156:159], v[60:63], a[64:67], v[156:159]
    s_lshl_b32 s70, s2, 5
    s_add_u32 s70, s70, 20480
    ds_read_b64_tr_b16 v[56:57], v14 offset:24576
    v_mfma_f32_16x16x32_bf16 v[188:191], v[60:63], a[68:71], v[188:191]
    ds_read_b64_tr_b16 v[58:59], v14 offset:25600
    v_and_b32 v119, 3, v2
    v_mfma_f32_16x16x32_bf16 v[220:223], v[60:63], a[72:75], v[220:223]
    v_lshlrev_b32 v119, 9, v119
    v_mfma_f32_16x16x32_bf16 v[252:255], v[60:63], a[76:79], v[252:255]
    v_mfma_f32_16x16x32_bf16 v[128:131], v[32:35], a[80:83], v[128:131]
    s_xor_b32 s80, s75, 26624
    s_lshr_b32 s69, s2, 6
    ds_read_b64_tr_b16 v[60:61], v15 offset:24576
    v_mfma_f32_16x16x32_bf16 v[160:163], v[32:35], a[84:87], v[160:163]
    s_add_u32 s69, s69, 4
    s_lshl_b32 s69, s69, 5
    ds_read_b64_tr_b16 v[62:63], v15 offset:25600
    v_mfma_f32_16x16x32_bf16 v[192:195], v[32:35], a[88:91], v[192:195]
    buffer_load_dwordx4 a[164:167], v1, s[8:11], s80 offen offset:0
    v_mfma_f32_16x16x32_bf16 v[224:227], v[32:35], a[92:95], v[224:227]
    s_bfe_u32 s68, s2, 196611
    s_add_u32 s69, s69, s68
    s_lshl_b32 s69, s69, 6
    v_mfma_f32_16x16x32_bf16 v[132:135], v[36:39], a[80:83], v[132:135]
    s_add_u32 s69, s69, 1310720
    s_and_b32 s100, s3, 1
    ds_read_b64_tr_b16 v[32:33], v8 offset:49152
    v_mfma_f32_16x16x32_bf16 v[164:167], v[36:39], a[84:87], v[164:167]
    s_lshr_b32 s101, s3, 1
    s_lshl_b32 s19, s100, 13
    ds_read_b64_tr_b16 v[34:35], v8 offset:50176
    v_mfma_f32_16x16x32_bf16 v[196:199], v[36:39], a[88:91], v[196:199]
    buffer_load_dword v118, v119, s[8:11], s69 offen sc0 sc1
    v_mfma_f32_16x16x32_bf16 v[228:231], v[36:39], a[92:95], v[228:231]
    s_add_u32 s19, s19, 65536
    v_add_u32 v18, s19, v1
    v_mfma_f32_16x16x32_bf16 v[136:139], v[40:43], a[80:83], v[136:139]
    s_xor_b32 s80, s76, 10240
    s_mul_i32 s19, s100, 12288
    ds_read_b64_tr_b16 v[36:37], v9 offset:49152
    v_mfma_f32_16x16x32_bf16 v[168:171], v[40:43], a[84:87], v[168:171]
    s_add_u32 s19, s19, 98304
    ds_read_b64_tr_b16 v[38:39], v9 offset:50176
    v_add_u32 v19, s19, v1
    v_mfma_f32_16x16x32_bf16 v[200:203], v[40:43], a[88:91], v[200:203]
    buffer_load_dwordx4 a[168:171], v1, s[8:11], s80 offen offset:0
    v_mfma_f32_16x16x32_bf16 v[232:235], v[40:43], a[92:95], v[232:235]
    v_mfma_f32_16x16x32_bf16 v[140:143], v[44:47], a[80:83], v[140:143]
    s_lshl_b32 s19, s100, 12
    s_add_u32 s19, s19, 98304
    ds_read_b64_tr_b16 v[40:41], v10 offset:49152
    v_mfma_f32_16x16x32_bf16 v[172:175], v[44:47], a[84:87], v[172:175]
    ds_read_b64_tr_b16 v[42:43], v10 offset:50176
    v_add_u32 v20, s19, v1
    v_mfma_f32_16x16x32_bf16 v[204:207], v[44:47], a[88:91], v[204:207]
    v_and_b32 v23, 15, v2
    v_lshrrev_b32 v24, 4, v2
    v_mfma_f32_16x16x32_bf16 v[236:239], v[44:47], a[92:95], v[236:239]
    s_waitcnt lgkmcnt(4)
    v_mfma_f32_16x16x32_bf16 v[144:147], v[48:51], a[80:83], v[144:147]
    s_xor_b32 s80, s76, 26624
    ds_read_b64_tr_b16 v[44:45], v11 offset:49152
    v_lshlrev_b32 v25, 2, v24
    v_mfma_f32_16x16x32_bf16 v[176:179], v[48:51], a[84:87], v[176:179]
    ds_read_b64_tr_b16 v[46:47], v11 offset:50176
    v_sub_u32 v25, v23, v25
    v_mfma_f32_16x16x32_bf16 v[208:211], v[48:51], a[88:91], v[208:211]
    buffer_load_dwordx4 a[172:175], v1, s[8:11], s80 offen offset:0
    v_mfma_f32_16x16x32_bf16 v[240:243], v[48:51], a[92:95], v[240:243]
    v_mfma_f32_16x16x32_bf16 v[148:151], v[52:55], a[80:83], v[148:151]
    s_sub_i32 s19, s101, s100
    s_lshl_b32 s19, s19, 5
    ds_read_b64_tr_b16 v[48:49], v12 offset:49152
    v_mfma_f32_16x16x32_bf16 v[180:183], v[52:55], a[84:87], v[180:183]
    s_xor_b32 s80, s75, 10240
    ds_read_b64_tr_b16 v[50:51], v12 offset:50176
    v_add_u32 v21, s19, v25
    v_mfma_f32_16x16x32_bf16 v[212:215], v[52:55], a[88:91], v[212:215]
    buffer_load_dwordx4 a[176:179], v1, s[8:11], s80 offen offset:1024
    v_mfma_f32_16x16x32_bf16 v[244:247], v[52:55], a[92:95], v[244:247]
    v_mfma_f32_16x16x32_bf16 v[152:155], v[56:59], a[80:83], v[152:155]
    s_add_u32 s19, s101, s100
    s_sub_i32 s19, 1, s19
    ds_read_b64_tr_b16 v[52:53], v13 offset:49152
    v_mfma_f32_16x16x32_bf16 v[184:187], v[56:59], a[84:87], v[184:187]
    s_lshl_b32 s19, s19, 5
    ds_read_b64_tr_b16 v[54:55], v13 offset:50176
    v_add_u32 v22, s19, v25
    v_mfma_f32_16x16x32_bf16 v[216:219], v[56:59], a[88:91], v[216:219]
    v_cvt_f32_i32 v21, v21
    v_cvt_f32_i32 v22, v22
    v_mfma_f32_16x16x32_bf16 v[248:251], v[56:59], a[92:95], v[248:251]
    v_mfma_f32_16x16x32_bf16 v[156:159], v[60:63], a[80:83], v[156:159]
    s_xor_b32 s80, s75, 26624
    ds_read_b64_tr_b16 v[56:57], v14 offset:49152
    v_add_f32 v21, 0.5, v21
    v_mfma_f32_16x16x32_bf16 v[188:191], v[60:63], a[84:87], v[188:191]
    ds_read_b64_tr_b16 v[58:59], v14 offset:50176
    v_add_f32 v22, 0.5, v22
    v_mfma_f32_16x16x32_bf16 v[220:223], v[60:63], a[88:91], v[220:223]
    buffer_load_dwordx4 a[180:183], v1, s[8:11], s80 offen offset:1024
    v_mfma_f32_16x16x32_bf16 v[252:255], v[60:63], a[92:95], v[252:255]
    v_mul_f32 v21, 0x71800000, v21
    v_mul_f32 v22, 0x71800000, v22
    v_mfma_f32_16x16x32_bf16 v[128:131], v[32:35], a[96:99], v[128:131]
    ds_read_b64_tr_b16 v[60:61], v15 offset:49152
    v_lshrrev_b32 v25, 2, v23
    v_mfma_f32_16x16x32_bf16 v[160:163], v[32:35], a[100:103], v[160:163]
    ds_read_b64_tr_b16 v[62:63], v15 offset:50176
    v_and_b32 v23, 3, v23
    v_mfma_f32_16x16x32_bf16 v[192:195], v[32:35], a[104:107], v[192:195]
    s_waitcnt vmcnt(20)
    v_lshlrev_b32 v23, 6, v23
    v_lshl_add_u32 v23, v25, 15, v23
    v_mfma_f32_16x16x32_bf16 v[224:227], v[32:35], a[108:111], v[224:227]
    s_waitcnt lgkmcnt(4)
    v_mfma_f32_16x16x32_bf16 v[132:135], v[36:39], a[96:99], v[132:135]
    s_xor_b32 s80, s76, 10240
    ds_read_b64_tr_b16 v[32:33], v8 offset:57344
    v_lshl_add_u32 v23, v24, 4, v23
    v_mfma_f32_16x16x32_bf16 v[164:167], v[36:39], a[100:103], v[164:167]
    s_lshl_b32 s18, s6, 20
    s_lshl_b32 s19, s3, 18
    ds_read_b64_tr_b16 v[34:35], v8 offset:58368
    v_mfma_f32_16x16x32_bf16 v[196:199], v[36:39], a[104:107], v[196:199]
    buffer_load_dwordx4 a[184:187], v1, s[8:11], s80 offen offset:1024
    v_mfma_f32_16x16x32_bf16 v[228:231], v[36:39], a[108:111], v[228:231]
    s_add_u32 s18, s18, s19
    s_lshl_b32 s19, s7, 10
    s_add_u32 s18, s18, s19
    v_mfma_f32_16x16x32_bf16 v[136:139], v[40:43], a[96:99], v[136:139]
    s_add_u32 s18, s18, 67108864
    s_mov_b32 s13, s60
    ds_read_b64_tr_b16 v[36:37], v9 offset:57344
    v_mfma_f32_16x16x32_bf16 v[168:171], v[40:43], a[100:103], v[168:171]
    s_mov_b32 s12, 2
    s_mov_b32 s25, 0
    ds_read_b64_tr_b16 v[38:39], v9 offset:58368
    v_mfma_f32_16x16x32_bf16 v[200:203], v[40:43], a[104:107], v[200:203]
    s_mov_b32 s26, 28
    s_mov_b32 s64, 128
    s_lshl_b32 s65, s5, 1
    v_mfma_f32_16x16x32_bf16 v[232:235], v[40:43], a[108:111], v[232:235]
    v_mfma_f32_16x16x32_bf16 v[140:143], v[44:47], a[96:99], v[140:143]
    s_xor_b32 s80, s76, 26624
    s_and_b32 s65, s65, 7
    ds_read_b64_tr_b16 v[40:41], v10 offset:57344
    v_mfma_f32_16x16x32_bf16 v[172:175], v[44:47], a[100:103], v[172:175]
    s_xor_b32 s65, s65, s3
    s_lshl_b32 s65, s65, 16
    ds_read_b64_tr_b16 v[42:43], v10 offset:58368
    v_mfma_f32_16x16x32_bf16 v[204:207], v[44:47], a[104:107], v[204:207]
    buffer_load_dwordx4 a[188:191], v1, s[8:11], s80 offen offset:1024
    v_mfma_f32_16x16x32_bf16 v[236:239], v[44:47], a[108:111], v[236:239]
    s_add_u32 s15, s62, 65536
    s_add_u32 s16, s62, 0
    s_lshl_b32 s20, s7, 13
    v_mfma_f32_16x16x32_bf16 v[144:147], v[48:51], a[96:99], v[144:147]
    s_lshl_b32 s19, s100, 11
    s_add_u32 s20, s20, s19
    ds_read_b64_tr_b16 v[44:45], v11 offset:57344
    v_mfma_f32_16x16x32_bf16 v[176:179], v[48:51], a[100:103], v[176:179]
    s_xor_b32 s80, s75, 12288
    s_add_u32 s20, s20, 50331648
    ds_read_b64_tr_b16 v[46:47], v11 offset:58368
    v_mfma_f32_16x16x32_bf16 v[208:211], v[48:51], a[104:107], v[208:211]
    buffer_load_dwordx4 a[192:195], v1, s[8:11], s80 offen offset:0
    v_mfma_f32_16x16x32_bf16 v[240:243], v[48:51], a[108:111], v[240:243]
    s_sub_u32 s19, 3, s101
    s_lshl_b32 s19, s19, 18
    s_add_u32 s21, s20, s19
    v_mfma_f32_16x16x32_bf16 v[148:151], v[52:55], a[96:99], v[148:151]
    s_lshl_b32 s19, s101, 18
    s_add_u32 s20, s20, s19
    ds_read_b64_tr_b16 v[48:49], v12 offset:57344
    v_mfma_f32_16x16x32_bf16 v[180:183], v[52:55], a[100:103], v[180:183]
    s_add_u32 s22, s72, 131072
    s_and_b32 s23, s2, 231
    ds_read_b64_tr_b16 v[50:51], v12 offset:58368
    v_mfma_f32_16x16x32_bf16 v[212:215], v[52:55], a[104:107], v[212:215]
    s_lshl_b32 s23, s23, 8
    s_sub_u32 s19, 3, s3
    s_min_u32 s19, s19, s3
    v_mfma_f32_16x16x32_bf16 v[244:247], v[52:55], a[108:111], v[244:247]
    s_waitcnt lgkmcnt(4)
    v_mfma_f32_16x16x32_bf16 v[152:155], v[56:59], a[96:99], v[152:155]
    s_xor_b32 s80, s75, 28672
    s_lshl_b32 s19, s19, 7
    ds_read_b64_tr_b16 v[52:53], v13 offset:57344
    s_waitcnt vmcnt(7)
    v_cmp_ne_u32 vcc, 0, v118
    s_cmp_eq_u64 vcc, -1
    s_cbranch_scc0 L_E2_slow_5
L_E2_ok_6:
    v_mfma_f32_16x16x32_bf16 v[184:187], v[56:59], a[100:103], v[184:187]
    s_add_u32 s23, s23, s19
    s_add_u32 s23, s23, 1179648
    ds_read_b64_tr_b16 v[54:55], v13 offset:58368
    v_mfma_f32_16x16x32_bf16 v[216:219], v[56:59], a[104:107], v[216:219]
    buffer_load_dwordx4 a[196:199], v1, s[8:11], s80 offen offset:0
    v_mfma_f32_16x16x32_bf16 v[248:251], v[56:59], a[108:111], v[248:251]
    buffer_load_dword v112, v116, s[8:11], s70 offen
    v_mfma_f32_16x16x32_bf16 v[156:159], v[60:63], a[96:99], v[156:159]
    s_add_u32 s70, s70, 12288
    s_lshl_b32 s71, s2, 2
    ds_read_b64_tr_b16 v[56:57], v14 offset:57344
    v_mfma_f32_16x16x32_bf16 v[188:191], v[60:63], a[100:103], v[188:191]
    s_add_u32 s71, s71, s3
    s_and_b32 s100, s71, 31
    ds_read_b64_tr_b16 v[58:59], v14 offset:58368
    v_mfma_f32_16x16x32_bf16 v[220:223], v[60:63], a[104:107], v[220:223]
    buffer_load_dword v113, v116, s[8:11], s70 offen
    v_mfma_f32_16x16x32_bf16 v[252:255], v[60:63], a[108:111], v[252:255]
    s_lshr_b32 s101, s71, 5
    s_sub_u32 s101, s101, 4
    s_and_b32 s101, s101, 31
    v_mfma_f32_16x16x32_bf16 v[128:131], v[32:35], a[112:115], v[128:131]
    s_xor_b32 s80, s76, 12288
    s_add_u32 s70, s70, 12288
    ds_read_b64_tr_b16 v[60:61], v15 offset:57344
    v_mfma_f32_16x16x32_bf16 v[160:163], v[32:35], a[116:119], v[160:163]
    ds_read_b64_tr_b16 v[62:63], v15 offset:58368
    v_and_b32 v121, 7, v2
    v_mfma_f32_16x16x32_bf16 v[192:195], v[32:35], a[120:123], v[192:195]
    buffer_load_dwordx4 a[200:203], v1, s[8:11], s80 offen offset:0
    v_mfma_f32_16x16x32_bf16 v[224:227], v[32:35], a[124:127], v[224:227]
    buffer_load_dword v114, v116, s[8:11], s70 offen
    v_mfma_f32_16x16x32_bf16 v[132:135], v[36:39], a[112:115], v[132:135]
    s_add_u32 s70, s70, 12288
    v_and_b32 v120, 4, v121
    v_and_b32 v122, 2, v121
    v_mfma_f32_16x16x32_bf16 v[164:167], v[36:39], a[116:119], v[164:167]
    buffer_load_dword v115, v116, s[8:11], s70 offen
    v_mfma_f32_16x16x32_bf16 v[196:199], v[36:39], a[120:123], v[196:199]
    s_add_u32 s70, s70, 12288
    v_lshl_add_u32 v120, v122, 3, v120
    v_and_b32 v122, 1, v121
    v_mfma_f32_16x16x32_bf16 v[228:231], v[36:39], a[124:127], v[228:231]
    v_lshl_add_u32 v120, v122, 1, v120
    v_mul_u32_u24 v120, 3584, v120
    v_mfma_f32_16x16x32_bf16 v[136:139], v[40:43], a[112:115], v[136:139]
    s_xor_b32 s80, s76, 28672
    v_subrev_u32 v8, 98304, v8
    v_subrev_u32 v9, 98304, v9
    s_waitcnt lgkmcnt(0)
    s_barrier
    v_mfma_f32_16x16x32_bf16 v[168:171], v[40:43], a[116:119], v[168:171]
    ds_read_b64_tr_b16 v[32:33], v8 offset:0
    v_lshrrev_b32 v122, 3, v2
    v_mfma_f32_16x16x32_bf16 v[200:203], v[40:43], a[120:123], v[200:203]
    ds_read_b64_tr_b16 v[34:35], v8 offset:1024
    v_lshl_add_u32 v120, v122, 4, v120
    v_mfma_f32_16x16x32_bf16 v[232:235], v[40:43], a[124:127], v[232:235]
    ds_read_b64_tr_b16 v[36:37], v9 offset:0
    v_subrev_u32 v10, 98304, v10
    v_mfma_f32_16x16x32_bf16 v[140:143], v[44:47], a[112:115], v[140:143]
    ds_read_b64_tr_b16 v[38:39], v9 offset:1024
    v_lshlrev_b32 v121, 13, v121
    v_mfma_f32_16x16x32_bf16 v[172:175], v[44:47], a[116:119], v[172:175]
    ds_read_b64_tr_b16 v[40:41], v10 offset:0
    v_lshl_add_u32 v121, v122, 4, v121
    v_mfma_f32_16x16x32_bf16 v[204:207], v[44:47], a[120:123], v[204:207]
    s_lshr_b32 s71, s100, 1
    s_lshl_b32 s71, s71, 2
    ds_read_b64_tr_b16 v[42:43], v10 offset:1024
    v_mfma_f32_16x16x32_bf16 v[236:239], v[44:47], a[124:127], v[236:239]
    s_and_b32 s100, s100, 1
    s_add_u32 s71, s71, s100
    v_subrev_u32 v11, 98304, v11
    v_mfma_f32_16x16x32_bf16 v[144:147], v[48:51], a[112:115], v[144:147]
    s_mul_i32 s71, s71, 28672
    s_lshl_b32 s100, s101, 7
    ds_read_b64_tr_b16 v[44:45], v11 offset:0
    v_mfma_f32_16x16x32_bf16 v[176:179], v[48:51], a[116:119], v[176:179]
    s_add_u32 s71, s71, s100
    s_cmp_lt_u32 s101, 28
    s_cselect_b32 s71, s71, 2147479552
    ds_read_b64_tr_b16 v[46:47], v11 offset:1024
    v_mfma_f32_16x16x32_bf16 v[208:211], v[48:51], a[120:123], v[208:211]
    buffer_load_dwordx4 a[204:207], v1, s[8:11], s80 offen offset:0
    v_mfma_f32_16x16x32_bf16 v[240:243], v[48:51], a[124:127], v[240:243]
    s_xor_b32 s80, s75, 12288
    v_subrev_u32 v12, 98304, v12
    v_mfma_f32_16x16x32_bf16 v[148:151], v[52:55], a[112:115], v[148:151]
    ds_read_b64_tr_b16 v[48:49], v12 offset:0
    v_mfma_f32_16x16x32_bf16 v[180:183], v[52:55], a[116:119], v[180:183]
    ds_read_b64_tr_b16 v[50:51], v12 offset:1024
    v_mfma_f32_16x16x32_bf16 v[212:215], v[52:55], a[120:123], v[212:215]
    buffer_load_dwordx4 a[208:211], v1, s[8:11], s80 offen offset:1024
    v_mfma_f32_16x16x32_bf16 v[244:247], v[52:55], a[124:127], v[244:247]
    s_xor_b32 s80, s75, 28672
    v_subrev_u32 v13, 98304, v13
    v_mfma_f32_16x16x32_bf16 v[152:155], v[56:59], a[112:115], v[152:155]
    ds_read_b64_tr_b16 v[52:53], v13 offset:0
    v_mfma_f32_16x16x32_bf16 v[184:187], v[56:59], a[116:119], v[184:187]
    ds_read_b64_tr_b16 v[54:55], v13 offset:1024
    v_mfma_f32_16x16x32_bf16 v[216:219], v[56:59], a[120:123], v[216:219]
    buffer_load_dwordx4 a[212:215], v1, s[8:11], s80 offen offset:1024
    v_mfma_f32_16x16x32_bf16 v[248:251], v[56:59], a[124:127], v[248:251]
    s_xor_b32 s80, s76, 12288
    v_subrev_u32 v14, 98304, v14
    v_mfma_f32_16x16x32_bf16 v[156:159], v[60:63], a[112:115], v[156:159]
    ds_read_b64_tr_b16 v[56:57], v14 offset:0
    v_mfma_f32_16x16x32_bf16 v[188:191], v[60:63], a[116:119], v[188:191]
    ds_read_b64_tr_b16 v[58:59], v14 offset:1024
    v_mfma_f32_16x16x32_bf16 v[220:223], v[60:63], a[120:123], v[220:223]
    buffer_load_dwordx4 a[216:219], v1, s[8:11], s80 offen offset:1024
    v_mfma_f32_16x16x32_bf16 v[252:255], v[60:63], a[124:127], v[252:255]
    s_waitcnt lgkmcnt(4)
    v_subrev_u32 v15, 98304, v15
    v_mfma_f32_16x16x32_bf16 v[128:131], v[32:35], a[128:131], v[128:131]
    ds_read_b64_tr_b16 v[60:61], v15 offset:0
    v_mfma_f32_16x16x32_bf16 v[160:163], v[32:35], a[132:135], v[160:163]
    ds_read_b64_tr_b16 v[62:63], v15 offset:1024
    v_mfma_f32_16x16x32_bf16 v[192:195], v[32:35], a[136:139], v[192:195]
    buffer_load_dword v3, v17, s[8:11], s74 offen sc0 sc1
    v_mfma_f32_16x16x32_bf16 v[224:227], v[32:35], a[140:143], v[224:227]
    v_mfma_f32_16x16x32_bf16 v[132:135], v[36:39], a[128:131], v[132:135]
    s_xor_b32 s80, s76, 28672
    ds_read_b64_tr_b16 v[32:33], v8 offset:8192
    v_mfma_f32_16x16x32_bf16 v[164:167], v[36:39], a[132:135], v[164:167]
    ds_read_b64_tr_b16 v[34:35], v8 offset:9216
    v_mfma_f32_16x16x32_bf16 v[196:199], v[36:39], a[136:139], v[196:199]
    buffer_load_dwordx4 a[220:223], v1, s[8:11], s80 offen offset:1024
    v_mfma_f32_16x16x32_bf16 v[228:231], v[36:39], a[140:143], v[228:231]
    v_mfma_f32_16x16x32_bf16 v[136:139], v[40:43], a[128:131], v[136:139]
    ds_read_b64_tr_b16 v[36:37], v9 offset:8192
    v_mfma_f32_16x16x32_bf16 v[168:171], v[40:43], a[132:135], v[168:171]
    s_xor_b32 s80, s75, 14336
    ds_read_b64_tr_b16 v[38:39], v9 offset:9216
    v_mfma_f32_16x16x32_bf16 v[200:203], v[40:43], a[136:139], v[200:203]
    buffer_load_dwordx4 a[224:227], v1, s[8:11], s80 offen offset:0
    v_mfma_f32_16x16x32_bf16 v[232:235], v[40:43], a[140:143], v[232:235]
    v_mfma_f32_16x16x32_bf16 v[140:143], v[44:47], a[128:131], v[140:143]
    ds_read_b64_tr_b16 v[40:41], v10 offset:8192
    v_mfma_f32_16x16x32_bf16 v[172:175], v[44:47], a[132:135], v[172:175]
    ds_read_b64_tr_b16 v[42:43], v10 offset:9216
    v_mfma_f32_16x16x32_bf16 v[204:207], v[44:47], a[136:139], v[204:207]
    v_mfma_f32_16x16x32_bf16 v[236:239], v[44:47], a[140:143], v[236:239]
    v_mfma_f32_16x16x32_bf16 v[144:147], v[48:51], a[128:131], v[144:147]
    s_xor_b32 s80, s75, 30720
    ds_read_b64_tr_b16 v[44:45], v11 offset:8192
    v_mfma_f32_16x16x32_bf16 v[176:179], v[48:51], a[132:135], v[176:179]
    ds_read_b64_tr_b16 v[46:47], v11 offset:9216
    v_mfma_f32_16x16x32_bf16 v[208:211], v[48:51], a[136:139], v[208:211]
    buffer_load_dwordx4 a[228:231], v1, s[8:11], s80 offen offset:0
    v_mfma_f32_16x16x32_bf16 v[240:243], v[48:51], a[140:143], v[240:243]
    s_waitcnt lgkmcnt(4)
    v_mfma_f32_16x16x32_bf16 v[148:151], v[52:55], a[128:131], v[148:151]
    ds_read_b64_tr_b16 v[48:49], v12 offset:8192
    v_mfma_f32_16x16x32_bf16 v[180:183], v[52:55], a[132:135], v[180:183]
    ds_read_b64_tr_b16 v[50:51], v12 offset:9216
    v_mfma_f32_16x16x32_bf16 v[212:215], v[52:55], a[136:139], v[212:215]
    v_mfma_f32_16x16x32_bf16 v[244:247], v[52:55], a[140:143], v[244:247]
    v_mfma_f32_16x16x32_bf16 v[152:155], v[56:59], a[128:131], v[152:155]
    s_xor_b32 s80, s76, 14336
    ds_read_b64_tr_b16 v[52:53], v13 offset:8192
    v_mfma_f32_16x16x32_bf16 v[184:187], v[56:59], a[132:135], v[184:187]
    ds_read_b64_tr_b16 v[54:55], v13 offset:9216
    v_mfma_f32_16x16x32_bf16 v[216:219], v[56:59], a[136:139], v[216:219]
    buffer_load_dwordx4 a[232:235], v1, s[8:11], s80 offen offset:0
    s_waitcnt vmcnt(4)
    v_cmp_ne_u32 vcc, 0, v3
    s_cmp_eq_u64 vcc, -1
    s_cbranch_scc0 L_KV_slow_7
L_KV_ok_8:
    v_mfma_f32_16x16x32_bf16 v[248:251], v[56:59], a[140:143], v[248:251]
    v_mfma_f32_16x16x32_bf16 v[156:159], v[60:63], a[128:131], v[156:159]
    s_add_u32 m0, s62, 65536
    s_add_u32 s98, s81, 0
    ds_read_b64_tr_b16 v[56:57], v14 offset:8192
    v_mfma_f32_16x16x32_bf16 v[188:191], v[60:63], a[132:135], v[188:191]
    ds_read_b64_tr_b16 v[58:59], v14 offset:9216
    v_add_u32 v16, s62, v1
    v_mfma_f32_16x16x32_bf16 v[220:223], v[60:63], a[136:139], v[220:223]
    buffer_load_dwordx4 v1, s[8:11], s98 offen offset:0  lds
    v_mfma_f32_16x16x32_bf16 v[252:255], v[60:63], a[140:143], v[252:255]
    v_and_b32 v17, 4294959103, v16
    v_mov_b32 v24, -1
    v_mfma_f32_16x16x32_bf16 v[128:131], v[32:35], a[144:147], v[128:131]
    s_xor_b32 s80, s76, 30720
    ds_read_b64_tr_b16 v[60:61], v15 offset:8192
    v_mov_b32 v28, 0x3f803f80
    v_mfma_f32_16x16x32_bf16 v[160:163], v[32:35], a[148:151], v[160:163]
    ds_read_b64_tr_b16 v[62:63], v15 offset:9216
    v_mov_b32 v25, -1
    v_mfma_f32_16x16x32_bf16 v[192:195], v[32:35], a[152:155], v[192:195]
    buffer_load_dwordx4 a[236:239], v1, s[8:11], s80 offen offset:0
    v_mfma_f32_16x16x32_bf16 v[224:227], v[32:35], a[156:159], v[224:227]
    buffer_load_dwordx4 v1, s[8:11], s98 offen offset:1024  lds
    v_mfma_f32_16x16x32_bf16 v[132:135], v[36:39], a[144:147], v[132:135]
    ds_read_b64_tr_b16 v[32:33], v8 offset:16384
    v_add_f32 v112, v112, v113
    v_mfma_f32_16x16x32_bf16 v[164:167], v[36:39], a[148:151], v[164:167]
    s_xor_b32 s80, s75, 14336
    ds_read_b64_tr_b16 v[34:35], v8 offset:17408
    v_add_f32 v114, v114, v115
    v_mfma_f32_16x16x32_bf16 v[196:199], v[36:39], a[152:155], v[196:199]
    buffer_load_dwordx4 a[240:243], v1, s[8:11], s80 offen offset:1024
    v_mfma_f32_16x16x32_bf16 v[228:231], v[36:39], a[156:159], v[228:231]
    s_waitcnt lgkmcnt(4)
    ds_read_b64_tr_b16 a[24:25], v8 offset:49152
    v_add_f32 v112, v112, v114
    v_mfma_f32_16x16x32_bf16 v[136:139], v[40:43], a[144:147], v[136:139]
    ds_read_b64_tr_b16 v[36:37], v9 offset:16384
    v_cvt_pk_bf16_f32 v112, v112, v112
    v_mfma_f32_16x16x32_bf16 v[168:171], v[40:43], a[148:151], v[168:171]
    ds_read_b64_tr_b16 v[38:39], v9 offset:17408
    v_and_b32 v112, 0xffff0000, v112
    v_mfma_f32_16x16x32_bf16 v[200:203], v[40:43], a[152:155], v[200:203]
    s_lshr_b32 s70, s2, 6
    s_cmp_eq_u32 s70, 2
    s_cselect_b32 s70, 1.0, 0
    ds_read_b64_tr_b16 a[26:27], v8 offset:50176
    v_mfma_f32_16x16x32_bf16 v[232:235], v[40:43], a[156:159], v[232:235]
    buffer_load_dwordx4 v1, s[8:11], s98 offen offset:2048  lds
    v_mfma_f32_16x16x32_bf16 v[140:143], v[44:47], a[144:147], v[140:143]
    s_xor_b32 s80, s75, 30720
    ds_read_b64_tr_b16 v[40:41], v10 offset:16384
    v_add_f32 v112, s70, v112
    v_mfma_f32_16x16x32_bf16 v[172:175], v[44:47], a[148:151], v[172:175]
    ds_read_b64_tr_b16 v[42:43], v10 offset:17408
    v_cvt_pk_bf16_f32 v112, v112, v112
    v_mfma_f32_16x16x32_bf16 v[204:207], v[44:47], a[152:155], v[204:207]
    ds_read_b64_tr_b16 a[28:29], v9 offset:49152
    v_and_b32 v112, 0xffff0000, v112
    v_mfma_f32_16x16x32_bf16 v[236:239], v[44:47], a[156:159], v[236:239]
    buffer_load_dwordx4 a[244:247], v1, s[8:11], s80 offen offset:1024
    v_mfma_f32_16x16x32_bf16 v[144:147], v[48:51], a[144:147], v[144:147]
    s_lshl_b32 s70, s2, 5
    s_add_u32 s70, s70, 4096
    ds_read_b64_tr_b16 v[44:45], v11 offset:16384
    v_mfma_f32_16x16x32_bf16 v[176:179], v[48:51], a[148:151], v[176:179]
    ds_read_b64_tr_b16 v[46:47], v11 offset:17408
    v_mov_b32 v29, 0x3f803f80
    v_mfma_f32_16x16x32_bf16 v[208:211], v[48:51], a[152:155], v[208:211]
    ds_read_b64_tr_b16 a[30:31], v9 offset:50176
    v_mov_b32 v26, -1
    v_mfma_f32_16x16x32_bf16 v[240:243], v[48:51], a[156:159], v[240:243]
    buffer_store_dword v112, v116, s[8:11], s70 offen sc0 sc1
    v_mfma_f32_16x16x32_bf16 v[148:151], v[52:55], a[144:147], v[148:151]
    s_xor_b32 s80, s76, 14336
    ds_read_b64_tr_b16 v[48:49], v12 offset:16384
    v_mov_b32 v30, 0x3f803f80
    v_mfma_f32_16x16x32_bf16 v[180:183], v[52:55], a[148:151], v[180:183]
    ds_read_b64_tr_b16 v[50:51], v12 offset:17408
    v_mov_b32 v27, -1
    v_mfma_f32_16x16x32_bf16 v[212:215], v[52:55], a[152:155], v[212:215]
    ds_read_b64_tr_b16 a[32:33], v10 offset:49152
    v_mov_b32 v31, 0x3f803f80
    v_mfma_f32_16x16x32_bf16 v[244:247], v[52:55], a[156:159], v[244:247]
    buffer_load_dwordx4 a[248:251], v1, s[8:11], s80 offen offset:1024
    v_mfma_f32_16x16x32_bf16 v[152:155], v[56:59], a[144:147], v[152:155]
    ds_read_b64_tr_b16 v[52:53], v13 offset:16384
    v_mov_b32 v64, 0
    v_mfma_f32_16x16x32_bf16 v[184:187], v[56:59], a[148:151], v[184:187]
    ds_read_b64_tr_b16 v[54:55], v13 offset:17408
    v_mov_b32 v65, 0
    v_mfma_f32_16x16x32_bf16 v[216:219], v[56:59], a[152:155], v[216:219]
    s_waitcnt lgkmcnt(7)
    s_xor_b32 s80, s76, 30720
    ds_read_b64_tr_b16 a[34:35], v10 offset:50176
    v_mov_b32 v66, 0
    v_mfma_f32_16x16x32_bf16 v[248:251], v[56:59], a[156:159], v[248:251]
    buffer_load_dwordx4 a[252:255], v1, s[8:11], s80 offen offset:1024
    v_mfma_f32_16x16x32_bf16 v[156:159], v[60:63], a[144:147], v[156:159]
    ds_read_b64_tr_b16 v[56:57], v14 offset:16384
    v_mov_b32 v67, 0
    v_mfma_f32_16x16x32_bf16 v[188:191], v[60:63], a[148:151], v[188:191]
    ds_read_b64_tr_b16 v[58:59], v14 offset:17408
    v_mov_b32 v68, 0
    v_mfma_f32_16x16x32_bf16 v[220:223], v[60:63], a[152:155], v[220:223]
    ds_read_b64_tr_b16 a[36:37], v11 offset:49152
    v_mov_b32 v69, 0
    v_mfma_f32_16x16x32_bf16 v[252:255], v[60:63], a[156:159], v[252:255]
    buffer_load_dwordx4 v1, s[8:11], s98 offen offset:3072  lds
    v_mfma_f32_16x16x32_bf16 v[128:131], v[32:35], a[160:163], v[128:131]
    s_add_u32 m0, s62, 69632
    s_add_u32 s98, s81, 4096
    ds_read_b64_tr_b16 v[60:61], v15 offset:16384
    v_mfma_f32_16x16x32_bf16 v[160:163], v[32:35], a[164:167], v[160:163]
    ds_read_b64_tr_b16 v[62:63], v15 offset:17408
    v_mov_b32 v70, 0
    v_mfma_f32_16x16x32_bf16 v[192:195], v[32:35], a[168:171], v[192:195]
    ds_read_b64_tr_b16 a[38:39], v11 offset:50176
    v_mov_b32 v71, 0
    v_mfma_f32_16x16x32_bf16 v[224:227], v[32:35], a[172:175], v[224:227]
    buffer_load_dwordx4 v1, s[8:11], s98 offen offset:0  lds
    v_mfma_f32_16x16x32_bf16 v[132:135], v[36:39], a[160:163], v[132:135]
    ds_read_b64_tr_b16 v[32:33], v8 offset:24576
    v_mov_b32 v72, 0
    v_mfma_f32_16x16x32_bf16 v[164:167], v[36:39], a[164:167], v[164:167]
    ds_read_b64_tr_b16 v[34:35], v8 offset:25600
    v_mov_b32 v73, 0
    v_mfma_f32_16x16x32_bf16 v[196:199], v[36:39], a[168:171], v[196:199]
    ds_read_b64_tr_b16 a[40:41], v12 offset:49152
    v_mov_b32 v74, 0
    v_mfma_f32_16x16x32_bf16 v[228:231], v[36:39], a[172:175], v[228:231]
    buffer_load_dwordx4 v1, s[8:11], s98 offen offset:1024  lds
    v_mfma_f32_16x16x32_bf16 v[136:139], v[40:43], a[160:163], v[136:139]
    ds_read_b64_tr_b16 v[36:37], v9 offset:24576
    v_mov_b32 v75, 0
    v_mfma_f32_16x16x32_bf16 v[168:171], v[40:43], a[164:167], v[168:171]
    ds_read_b64_tr_b16 v[38:39], v9 offset:25600
    v_mov_b32 v76, 0
    v_mfma_f32_16x16x32_bf16 v[200:203], v[40:43], a[168:171], v[200:203]
    s_waitcnt lgkmcnt(7)
    ds_read_b64_tr_b16 a[42:43], v12 offset:50176
    v_mov_b32 v77, 0
    v_mfma_f32_16x16x32_bf16 v[232:235], v[40:43], a[172:175], v[232:235]
    buffer_load_dwordx4 v1, s[8:11], s98 offen offset:2048  lds
    v_mfma_f32_16x16x32_bf16 v[140:143], v[44:47], a[160:163], v[140:143]
    ds_read_b64_tr_b16 v[40:41], v10 offset:24576
    v_mov_b32 v78, 0
    v_mfma_f32_16x16x32_bf16 v[172:175], v[44:47], a[164:167], v[172:175]
    ds_read_b64_tr_b16 v[42:43], v10 offset:25600
    v_mov_b32 v79, 0
    v_mfma_f32_16x16x32_bf16 v[204:207], v[44:47], a[168:171], v[204:207]
    s_cmp_eq_u32 s60, 0
    s_cselect_b32 s19, 0, 0x76800000
    ds_read_b64_tr_b16 a[44:45], v13 offset:49152
    v_add_f32 v3, s19, v21
    v_mfma_f32_16x16x32_bf16 v[236:239], v[44:47], a[172:175], v[236:239]
    buffer_load_dwordx4 v1, s[8:11], s98 offen offset:3072  lds
    v_mfma_f32_16x16x32_bf16 v[144:147], v[48:51], a[160:163], v[144:147]
    s_add_u32 m0, s62, 98304
    s_add_u32 s98, s81, 32768
    ds_read_b64_tr_b16 v[44:45], v11 offset:24576
    v_mfma_f32_16x16x32_bf16 v[176:179], v[48:51], a[164:167], v[176:179]
    ds_read_b64_tr_b16 v[46:47], v11 offset:25600
    v_add_f32 v96, 0, v3
    v_mfma_f32_16x16x32_bf16 v[208:211], v[48:51], a[168:171], v[208:211]
    ds_read_b64_tr_b16 a[46:47], v13 offset:50176
    v_min_f32 v96, v96, v64
    v_mfma_f32_16x16x32_bf16 v[240:243], v[48:51], a[172:175], v[240:243]
    buffer_load_dwordx4 v1, s[8:11], s98 offen offset:0  lds
    v_mfma_f32_16x16x32_bf16 v[148:151], v[52:55], a[160:163], v[148:151]
    ds_read_b64_tr_b16 v[48:49], v12 offset:24576
    v_add_f32 v97, 0xf1800000, v3
    v_mfma_f32_16x16x32_bf16 v[180:183], v[52:55], a[164:167], v[180:183]
    ds_read_b64_tr_b16 v[50:51], v12 offset:25600
    v_min_f32 v97, v97, v65
    v_mfma_f32_16x16x32_bf16 v[212:215], v[52:55], a[168:171], v[212:215]
    ds_read_b64_tr_b16 a[48:49], v14 offset:49152
    v_add_f32 v98, 0xf2000000, v3
    v_mfma_f32_16x16x32_bf16 v[244:247], v[52:55], a[172:175], v[244:247]
    buffer_load_dwordx4 v1, s[8:11], s98 offen offset:1024  lds
    v_mfma_f32_16x16x32_bf16 v[152:155], v[56:59], a[160:163], v[152:155]
    ds_read_b64_tr_b16 v[52:53], v13 offset:24576
    v_min_f32 v98, v98, v66
    v_mfma_f32_16x16x32_bf16 v[184:187], v[56:59], a[164:167], v[184:187]
    ds_read_b64_tr_b16 v[54:55], v13 offset:25600
    v_add_f32 v99, 0xf2400000, v3
    v_mfma_f32_16x16x32_bf16 v[216:219], v[56:59], a[168:171], v[216:219]
    s_waitcnt lgkmcnt(7)
    ds_read_b64_tr_b16 a[50:51], v14 offset:50176
    v_min_f32 v99, v99, v67
    v_mfma_f32_16x16x32_bf16 v[248:251], v[56:59], a[172:175], v[248:251]
    buffer_load_dwordx4 v1, s[8:11], s98 offen offset:2048  lds
    v_mfma_f32_16x16x32_bf16 v[156:159], v[60:63], a[160:163], v[156:159]
    ds_read_b64_tr_b16 v[56:57], v14 offset:24576
    v_add_f32 v100, 0xf3800000, v3
    v_mfma_f32_16x16x32_bf16 v[188:191], v[60:63], a[164:167], v[188:191]
    ds_read_b64_tr_b16 v[58:59], v14 offset:25600
    v_min_f32 v100, v100, v64
    v_mfma_f32_16x16x32_bf16 v[220:223], v[60:63], a[168:171], v[220:223]
    ds_read_b64_tr_b16 a[52:53], v15 offset:49152
    v_add_f32 v101, 0xf3880000, v3
    v_mfma_f32_16x16x32_bf16 v[252:255], v[60:63], a[172:175], v[252:255]
    buffer_load_dwordx4 v1, s[8:11], s98 offen offset:3072  lds
    v_mfma_f32_16x16x32_bf16 v[128:131], v[32:35], a[176:179], v[128:131]
    s_add_u32 m0, s62, 102400
    s_add_u32 s98, s81, 36864
    ds_read_b64_tr_b16 v[60:61], v15 offset:24576
    v_mfma_f32_16x16x32_bf16 v[160:163], v[32:35], a[180:183], v[160:163]
    ds_read_b64_tr_b16 v[62:63], v15 offset:25600
    v_min_f32 v101, v101, v65
    v_mfma_f32_16x16x32_bf16 v[192:195], v[32:35], a[184:187], v[192:195]
    ds_read_b64_tr_b16 a[54:55], v15 offset:50176
    v_add_f32 v102, 0xf3900000, v3
    v_mfma_f32_16x16x32_bf16 v[224:227], v[32:35], a[188:191], v[224:227]
    buffer_load_dwordx4 v1, s[8:11], s98 offen offset:0  lds
    v_mfma_f32_16x16x32_bf16 v[132:135], v[36:39], a[176:179], v[132:135]
    ds_read_b64_tr_b16 v[32:33], v8 offset:32768
    v_min_f32 v102, v102, v66
    v_mfma_f32_16x16x32_bf16 v[164:167], v[36:39], a[180:183], v[164:167]
    ds_read_b64_tr_b16 v[34:35], v8 offset:33792
    v_add_f32 v103, 0xf3980000, v3
    v_mfma_f32_16x16x32_bf16 v[196:199], v[36:39], a[184:187], v[196:199]
    ds_read_b64_tr_b16 a[64:65], v8 offset:57344
    v_min_f32 v103, v103, v67
    v_mfma_f32_16x16x32_bf16 v[228:231], v[36:39], a[188:191], v[228:231]
    buffer_load_dwordx4 v1, s[8:11], s98 offen offset:1024  lds
    v_mfma_f32_16x16x32_bf16 v[136:139], v[40:43], a[176:179], v[136:139]
    ds_read_b64_tr_b16 v[36:37], v9 offset:32768
    v_add_f32 v104, 0x73800000, v3
    v_mfma_f32_16x16x32_bf16 v[168:171], v[40:43], a[180:183], v[168:171]
    ds_read_b64_tr_b16 v[38:39], v9 offset:33792
    v_min_f32 v104, v104, v68
    v_mfma_f32_16x16x32_bf16 v[200:203], v[40:43], a[184:187], v[200:203]
    s_waitcnt lgkmcnt(7)
    ds_read_b64_tr_b16 a[66:67], v8 offset:58368
    v_add_f32 v105, 0x73700000, v3
    v_mfma_f32_16x16x32_bf16 v[232:235], v[40:43], a[188:191], v[232:235]
    buffer_load_dwordx4 v1, s[8:11], s98 offen offset:2048  lds
    v_mfma_f32_16x16x32_bf16 v[140:143], v[44:47], a[176:179], v[140:143]
    ds_read_b64_tr_b16 v[40:41], v10 offset:32768
    v_min_f32 v105, v105, v69
    v_mfma_f32_16x16x32_bf16 v[172:175], v[44:47], a[180:183], v[172:175]
    ds_read_b64_tr_b16 v[42:43], v10 offset:33792
    v_add_f32 v106, 0x73600000, v3
    v_mfma_f32_16x16x32_bf16 v[204:207], v[44:47], a[184:187], v[204:207]
    ds_read_b64_tr_b16 a[68:69], v9 offset:57344
    v_min_f32 v106, v106, v70
    v_mfma_f32_16x16x32_bf16 v[236:239], v[44:47], a[188:191], v[236:239]
    buffer_load_dwordx4 v1, s[8:11], s98 offen offset:3072  lds
    v_mfma_f32_16x16x32_bf16 v[144:147], v[48:51], a[176:179], v[144:147]
    s_add_u32 m0, s62, 131072
    s_add_u32 s98, s82, 0
    ds_read_b64_tr_b16 v[44:45], v11 offset:32768
    v_mfma_f32_16x16x32_bf16 v[176:179], v[48:51], a[180:183], v[176:179]
    ds_read_b64_tr_b16 v[46:47], v11 offset:33792
    v_add_f32 v107, 0x73500000, v3
    v_mfma_f32_16x16x32_bf16 v[208:211], v[48:51], a[184:187], v[208:211]
    ds_read_b64_tr_b16 a[70:71], v9 offset:58368
    v_min_f32 v107, v107, v71
    v_mfma_f32_16x16x32_bf16 v[240:243], v[48:51], a[188:191], v[240:243]
    buffer_load_dwordx4 v1, s[8:11], s98 offen offset:0  lds
    v_mfma_f32_16x16x32_bf16 v[148:151], v[52:55], a[176:179], v[148:151]
    ds_read_b64_tr_b16 v[48:49], v12 offset:32768
    v_add_f32 v108, 0, v3
    v_mfma_f32_16x16x32_bf16 v[180:183], v[52:55], a[180:183], v[180:183]
    ds_read_b64_tr_b16 v[50:51], v12 offset:33792
    v_min_f32 v108, v108, v68
    v_mfma_f32_16x16x32_bf16 v[212:215], v[52:55], a[184:187], v[212:215]
    ds_read_b64_tr_b16 a[72:73], v10 offset:57344
    v_add_f32 v109, 0xf1800000, v3
    v_mfma_f32_16x16x32_bf16 v[244:247], v[52:55], a[188:191], v[244:247]
    buffer_load_dwordx4 v1, s[8:11], s98 offen offset:1024  lds
    v_mfma_f32_16x16x32_bf16 v[152:155], v[56:59], a[176:179], v[152:155]
    ds_read_b64_tr_b16 v[52:53], v13 offset:32768
    v_min_f32 v109, v109, v69
    v_mfma_f32_16x16x32_bf16 v[184:187], v[56:59], a[180:183], v[184:187]
    ds_read_b64_tr_b16 v[54:55], v13 offset:33792
    v_add_f32 v110, 0xf2000000, v3
    v_mfma_f32_16x16x32_bf16 v[216:219], v[56:59], a[184:187], v[216:219]
    s_waitcnt lgkmcnt(7)
    ds_read_b64_tr_b16 a[74:75], v10 offset:58368
    v_min_f32 v110, v110, v70
    v_mfma_f32_16x16x32_bf16 v[248:251], v[56:59], a[188:191], v[248:251]
    buffer_load_dwordx4 v1, s[8:11], s98 offen offset:2048  lds
    v_mfma_f32_16x16x32_bf16 v[156:159], v[60:63], a[176:179], v[156:159]
    ds_read_b64_tr_b16 v[56:57], v14 offset:32768
    v_add_f32 v111, 0xf2400000, v3
    v_mfma_f32_16x16x32_bf16 v[188:191], v[60:63], a[180:183], v[188:191]
    ds_read_b64_tr_b16 v[58:59], v14 offset:33792
    v_min_f32 v111, v111, v71
    v_mfma_f32_16x16x32_bf16 v[220:223], v[60:63], a[184:187], v[220:223]
    s_cmp_eq_u32 s60, 0
    s_cselect_b32 s19, 1.0, 0
    ds_read_b64_tr_b16 a[76:77], v11 offset:57344
    v_sub_f32 v3, v22, v21
    v_mfma_f32_16x16x32_bf16 v[252:255], v[60:63], a[188:191], v[252:255]
    buffer_load_dwordx4 v1, s[8:11], s98 offen offset:3072  lds
    v_mfma_f32_16x16x32_bf16 v[128:131], v[32:35], a[192:195], v[128:131]
    s_add_u32 m0, s62, 135168
    s_add_u32 s98, s82, 4096
    ds_read_b64_tr_b16 v[60:61], v15 offset:32768
    v_mfma_f32_16x16x32_bf16 v[160:163], v[32:35], a[196:199], v[160:163]
    ds_read_b64_tr_b16 v[62:63], v15 offset:33792
    v_fma_f32 v3, s19, v3, v21
    v_mfma_f32_16x16x32_bf16 v[192:195], v[32:35], a[200:203], v[192:195]
    ds_read_b64_tr_b16 a[78:79], v11 offset:58368
    v_add_f32 v80, 0, v3
    v_mfma_f32_16x16x32_bf16 v[224:227], v[32:35], a[204:207], v[224:227]
    buffer_load_dwordx4 v1, s[8:11], s98 offen offset:0  lds
    v_mfma_f32_16x16x32_bf16 v[132:135], v[36:39], a[192:195], v[132:135]
    ds_read_b64_tr_b16 v[32:33], v8 offset:40960
    v_min_f32 v80, v80, v64
    v_mfma_f32_16x16x32_bf16 v[164:167], v[36:39], a[196:199], v[164:167]
    ds_read_b64_tr_b16 v[34:35], v8 offset:41984
    v_add_f32 v81, 0xf1800000, v3
    v_mfma_f32_16x16x32_bf16 v[196:199], v[36:39], a[200:203], v[196:199]
    ds_read_b64_tr_b16 a[80:81], v12 offset:57344
    v_min_f32 v81, v81, v65
    v_mfma_f32_16x16x32_bf16 v[228:231], v[36:39], a[204:207], v[228:231]
    buffer_load_dwordx4 v1, s[8:11], s98 offen offset:1024  lds
    v_mfma_f32_16x16x32_bf16 v[136:139], v[40:43], a[192:195], v[136:139]
    ds_read_b64_tr_b16 v[36:37], v9 offset:40960
    v_add_f32 v82, 0xf2000000, v3
    v_mfma_f32_16x16x32_bf16 v[168:171], v[40:43], a[196:199], v[168:171]
    ds_read_b64_tr_b16 v[38:39], v9 offset:41984
    v_min_f32 v82, v82, v66
    v_mfma_f32_16x16x32_bf16 v[200:203], v[40:43], a[200:203], v[200:203]
    s_waitcnt lgkmcnt(7)
    ds_read_b64_tr_b16 a[82:83], v12 offset:58368
    v_add_f32 v83, 0xf2400000, v3
    v_mfma_f32_16x16x32_bf16 v[232:235], v[40:43], a[204:207], v[232:235]
    buffer_load_dwordx4 v1, s[8:11], s98 offen offset:2048  lds
    v_mfma_f32_16x16x32_bf16 v[140:143], v[44:47], a[192:195], v[140:143]
    ds_read_b64_tr_b16 v[40:41], v10 offset:40960
    v_min_f32 v83, v83, v67
    v_mfma_f32_16x16x32_bf16 v[172:175], v[44:47], a[196:199], v[172:175]
    ds_read_b64_tr_b16 v[42:43], v10 offset:41984
    v_add_f32 v84, 0xf3800000, v3
    v_mfma_f32_16x16x32_bf16 v[204:207], v[44:47], a[200:203], v[204:207]
    ds_read_b64_tr_b16 a[84:85], v13 offset:57344
    v_min_f32 v84, v84, v64
    v_mfma_f32_16x16x32_bf16 v[236:239], v[44:47], a[204:207], v[236:239]
    buffer_load_dwordx4 v1, s[8:11], s98 offen offset:3072  lds
    v_mfma_f32_16x16x32_bf16 v[144:147], v[48:51], a[192:195], v[144:147]
    ds_read_b64_tr_b16 v[44:45], v11 offset:40960
    v_add_f32 v85, 0xf3880000, v3
    v_mfma_f32_16x16x32_bf16 v[176:179], v[48:51], a[196:199], v[176:179]
    ds_read_b64_tr_b16 v[46:47], v11 offset:41984
    v_min_f32 v85, v85, v65
    v_mfma_f32_16x16x32_bf16 v[208:211], v[48:51], a[200:203], v[208:211]
    ds_read_b64_tr_b16 a[86:87], v13 offset:58368
    v_add_f32 v86, 0xf3900000, v3
    v_mfma_f32_16x16x32_bf16 v[240:243], v[48:51], a[204:207], v[240:243]
    buffer_load_dwordx4 a[0:3], v120, s[40:43], s71 offen
    v_mfma_f32_16x16x32_bf16 v[148:151], v[52:55], a[192:195], v[148:151]
    ds_read_b64_tr_b16 v[48:49], v12 offset:40960
    v_min_f32 v86, v86, v66
    v_mfma_f32_16x16x32_bf16 v[180:183], v[52:55], a[196:199], v[180:183]
    ds_read_b64_tr_b16 v[50:51], v12 offset:41984
    v_add_f32 v87, 0xf3980000, v3
    v_mfma_f32_16x16x32_bf16 v[212:215], v[52:55], a[200:203], v[212:215]
    ds_read_b64_tr_b16 a[88:89], v14 offset:57344
    v_min_f32 v87, v87, v67
    v_mfma_f32_16x16x32_bf16 v[244:247], v[52:55], a[204:207], v[244:247]
    buffer_load_dwordx4 a[4:7], v120, s[40:43], s71 offen offset:3584
    v_mfma_f32_16x16x32_bf16 v[152:155], v[56:59], a[192:195], v[152:155]
    ds_read_b64_tr_b16 v[52:53], v13 offset:40960
    v_add_f32 v88, 0x73800000, v3
    v_mfma_f32_16x16x32_bf16 v[184:187], v[56:59], a[196:199], v[184:187]
    ds_read_b64_tr_b16 v[54:55], v13 offset:41984
    v_min_f32 v88, v88, v68
    v_mfma_f32_16x16x32_bf16 v[216:219], v[56:59], a[200:203], v[216:219]
    s_waitcnt lgkmcnt(7)
    ds_read_b64_tr_b16 a[90:91], v14 offset:58368
    v_add_f32 v89, 0x73700000, v3
    v_mfma_f32_16x16x32_bf16 v[248:251], v[56:59], a[204:207], v[248:251]
    buffer_load_dwordx4 a[8:11], v120, s[44:47], s71 offen
    v_mfma_f32_16x16x32_bf16 v[156:159], v[60:63], a[192:195], v[156:159]
    ds_read_b64_tr_b16 v[56:57], v14 offset:40960
    v_min_f32 v89, v89, v69
    v_mfma_f32_16x16x32_bf16 v[188:191], v[60:63], a[196:199], v[188:191]
    ds_read_b64_tr_b16 v[58:59], v14 offset:41984
    v_add_f32 v90, 0x73600000, v3
    v_mfma_f32_16x16x32_bf16 v[220:223], v[60:63], a[200:203], v[220:223]
    ds_read_b64_tr_b16 a[92:93], v15 offset:57344
    v_min_f32 v90, v90, v70
    v_mfma_f32_16x16x32_bf16 v[252:255], v[60:63], a[204:207], v[252:255]
    buffer_load_dwordx4 a[12:15], v120, s[44:47], s71 offen offset:3584
    v_mfma_f32_16x16x32_bf16 v[192:195], v[32:35], a[216:219], v[192:195]
    s_waitcnt vmcnt(34)
    s_lshl_b32 s71, s101, 16
    ds_read_b64_tr_b16 v[60:61], v15 offset:40960
    v_add_f32 v91, 0x73500000, v3
    v_mfma_f32_16x16x32_bf16 v[192:195], a[24:27], a[232:235], v[192:195]
    s_waitcnt vmcnt(26)
    s_lshl_b32 s100, s3, 11
    ds_read_b64_tr_b16 v[62:63], v15 offset:41984
    v_min_f32 v91, v91, v71
    v_mfma_f32_16x16x32_bf16 v[192:195], a[64:67], a[248:251], v[192:195]
    s_add_u32 s71, s71, s100
    ds_read_b64_tr_b16 a[94:95], v15 offset:58368
    v_add_f32 v92, 0, v3
    v_mfma_f32_16x16x32_bf16 v[196:199], v[36:39], a[216:219], v[196:199]
    s_lshl_b32 s100, s4, 7
    v_min_f32 v92, v92, v68
    v_add_f32 v93, 0xf1800000, v3
    v_mfma_f32_16x16x32_bf16 v[196:199], a[28:31], a[232:235], v[196:199]
    s_add_u32 s71, s71, s100
    v_min_f32 v93, v93, v69
    v_add_f32 v94, 0xf2000000, v3
    v_mfma_f32_16x16x32_bf16 v[196:199], a[68:71], a[248:251], v[196:199]
    v_min_f32 v94, v94, v70
    v_add_f32 v95, 0xf2400000, v3
    v_mfma_f32_16x16x32_bf16 v[224:227], v[32:35], a[220:223], v[224:227]
    buffer_load_dwordx4 a[16:19], v121, s[48:51], s71 offen
    v_mfma_f32_16x16x32_bf16 v[224:227], a[24:27], a[236:239], v[224:227]
    s_waitcnt vmcnt(26)
    v_min_f32 v95, v95, v71
    s_waitcnt lgkmcnt(0)
    s_barrier
    v_mfma_f32_16x16x32_bf16 v[224:227], a[64:67], a[252:255], v[224:227]
    buffer_load_dwordx4 a[20:23], v121, s[48:51], s71 offen offset:1024
    v_mfma_f32_16x16x32_bf16 v[228:231], v[36:39], a[220:223], v[228:231]
    v_cvt_pk_bf16_f32 v192, v192, v193
    v_cvt_pk_bf16_f32 v193, v194, v195
    v_mfma_f32_16x16x32_bf16 v[228:231], a[28:31], a[236:239], v[228:231]
    v_cvt_pk_bf16_f32 v194, v196, v197
    v_cvt_pk_bf16_f32 v195, v198, v199
    v_mfma_f32_16x16x32_bf16 v[228:231], a[68:71], a[252:255], v[228:231]
    ds_write_b128 v16, v[192:195] offset:32768
    v_lshrrev_b32 v121, 1, v2
    v_mfma_f32_16x16x32_bf16 v[128:131], v[32:35], a[208:211], v[128:131]
    v_and_b32 v121, 15, v121
    v_lshlrev_b32 v121, 10, v121
    v_mfma_f32_16x16x32_bf16 v[128:131], a[24:27], a[224:227], v[128:131]
    v_and_b32 v122, 1, v2
    v_lshl_add_u32 v121, v122, 7, v121
    v_mfma_f32_16x16x32_bf16 v[128:131], a[64:67], a[240:243], v[128:131]
    v_mfma_f32_16x16x32_bf16 v[132:135], v[36:39], a[208:211], v[132:135]
    s_lshl_b32 s71, s6, 2
    v_cvt_pk_bf16_f32 v224, v224, v225
    v_cvt_pk_bf16_f32 v225, v226, v227
    v_mfma_f32_16x16x32_bf16 v[132:135], a[28:31], a[224:227], v[132:135]
    s_add_u32 s71, s71, s3
    v_cvt_pk_bf16_f32 v226, v228, v229
    v_cvt_pk_bf16_f32 v227, v230, v231
    v_mfma_f32_16x16x32_bf16 v[132:135], a[68:71], a[240:243], v[132:135]
    s_lshl_b32 s71, s71, 14
    ds_write_b128 v16, v[224:227] offset:36864
    v_mfma_f32_16x16x32_bf16 v[160:163], v[32:35], a[212:215], v[160:163]
    buffer_load_dword a60, v121, s[28:31], s71 offen
    v_mfma_f32_16x16x32_bf16 v[160:163], a[24:27], a[228:231], v[160:163]
    v_mfma_f32_16x16x32_bf16 v[160:163], a[64:67], a[244:247], v[160:163]
    s_getpc_b64 s[100:101]
L_ct2:
    s_lshr_b32 s99, s2, 3
    s_lshl_b32 s99, s99, 2
    s_add_u32 s99, s99, s3
    s_mul_i32 s99, s99, 4
    v_min_u32 v123, 3, v2
    v_add_u32 v123, s99, v123
    v_lshlrev_b32 v123, 7, v123
    v_add_u32 v123, L_attn-L_ct2, v123
    v_min_u32 v123, L_code_end-L_ct2, v123
    global_load_dword a61, v123, s[100:101]
    v_mfma_f32_16x16x32_bf16 v[164:167], v[36:39], a[212:215], v[164:167]
    v_cvt_pk_bf16_f32 v128, v128, v129
    v_cvt_pk_bf16_f32 v129, v130, v131
    v_mfma_f32_16x16x32_bf16 v[164:167], a[28:31], a[228:231], v[164:167]
    v_cvt_pk_bf16_f32 v130, v132, v133
    v_cvt_pk_bf16_f32 v131, v134, v135
    v_mfma_f32_16x16x32_bf16 v[164:167], a[68:71], a[244:247], v[164:167]
    ds_write_b128 v16, v[128:131] offset:0
    v_mfma_f32_16x16x32_bf16 v[200:203], v[40:43], a[216:219], v[200:203]
    v_mfma_f32_16x16x32_bf16 v[200:203], a[32:35], a[232:235], v[200:203]
    v_mfma_f32_16x16x32_bf16 v[200:203], a[72:75], a[248:251], v[200:203]
    v_mfma_f32_16x16x32_bf16 v[204:207], v[44:47], a[216:219], v[204:207]
    v_cvt_pk_bf16_f32 v160, v160, v161
    v_cvt_pk_bf16_f32 v161, v162, v163
    v_mfma_f32_16x16x32_bf16 v[204:207], a[36:39], a[232:235], v[204:207]
    v_cvt_pk_bf16_f32 v162, v164, v165
    v_cvt_pk_bf16_f32 v163, v166, v167
    v_mfma_f32_16x16x32_bf16 v[204:207], a[76:79], a[248:251], v[204:207]
    ds_write_b128 v16, v[160:163] offset:4096
    v_mfma_f32_16x16x32_bf16 v[232:235], v[40:43], a[220:223], v[232:235]
    v_mfma_f32_16x16x32_bf16 v[232:235], a[32:35], a[236:239], v[232:235]
    v_mfma_f32_16x16x32_bf16 v[232:235], a[72:75], a[252:255], v[232:235]
    v_mfma_f32_16x16x32_bf16 v[236:239], v[44:47], a[220:223], v[236:239]
    v_cvt_pk_bf16_f32 v200, v200, v201
    v_cvt_pk_bf16_f32 v201, v202, v203
    v_mfma_f32_16x16x32_bf16 v[236:239], a[36:39], a[236:239], v[236:239]
    v_cvt_pk_bf16_f32 v202, v204, v205
    v_cvt_pk_bf16_f32 v203, v206, v207
    v_mfma_f32_16x16x32_bf16 v[236:239], a[76:79], a[252:255], v[236:239]
    ds_write_b128 v16, v[200:203] offset:33792
    v_mfma_f32_16x16x32_bf16 v[136:139], v[40:43], a[208:211], v[136:139]
    v_mfma_f32_16x16x32_bf16 v[136:139], a[32:35], a[224:227], v[136:139]
    v_mfma_f32_16x16x32_bf16 v[136:139], a[72:75], a[240:243], v[136:139]
    v_mfma_f32_16x16x32_bf16 v[140:143], v[44:47], a[208:211], v[140:143]
    v_cvt_pk_bf16_f32 v232, v232, v233
    v_cvt_pk_bf16_f32 v233, v234, v235
    v_mfma_f32_16x16x32_bf16 v[140:143], a[36:39], a[224:227], v[140:143]
    v_cvt_pk_bf16_f32 v234, v236, v237
    v_cvt_pk_bf16_f32 v235, v238, v239
    v_mfma_f32_16x16x32_bf16 v[140:143], a[76:79], a[240:243], v[140:143]
    ds_write_b128 v16, v[232:235] offset:37888
    v_mfma_f32_16x16x32_bf16 v[168:171], v[40:43], a[212:215], v[168:171]
    v_mfma_f32_16x16x32_bf16 v[168:171], a[32:35], a[228:231], v[168:171]
    v_mfma_f32_16x16x32_bf16 v[168:171], a[72:75], a[244:247], v[168:171]
    v_mfma_f32_16x16x32_bf16 v[172:175], v[44:47], a[212:215], v[172:175]
    v_cvt_pk_bf16_f32 v136, v136, v137
    v_cvt_pk_bf16_f32 v137, v138, v139
    v_mfma_f32_16x16x32_bf16 v[172:175], a[36:39], a[228:231], v[172:175]
    v_cvt_pk_bf16_f32 v138, v140, v141
    v_cvt_pk_bf16_f32 v139, v142, v143
    v_mfma_f32_16x16x32_bf16 v[172:175], a[76:79], a[244:247], v[172:175]
    ds_write_b128 v16, v[136:139] offset:1024
    v_mfma_f32_16x16x32_bf16 v[208:211], v[48:51], a[216:219], v[208:211]
    v_mfma_f32_16x16x32_bf16 v[208:211], a[40:43], a[232:235], v[208:211]
    v_mfma_f32_16x16x32_bf16 v[208:211], a[80:83], a[248:251], v[208:211]
    v_mfma_f32_16x16x32_bf16 v[212:215], v[52:55], a[216:219], v[212:215]
    v_cvt_pk_bf16_f32 v168, v168, v169
    v_cvt_pk_bf16_f32 v169, v170, v171
    v_mfma_f32_16x16x32_bf16 v[212:215], a[44:47], a[232:235], v[212:215]
    v_cvt_pk_bf16_f32 v170, v172, v173
    v_cvt_pk_bf16_f32 v171, v174, v175
    v_mfma_f32_16x16x32_bf16 v[212:215], a[84:87], a[248:251], v[212:215]
    ds_write_b128 v16, v[168:171] offset:5120
    v_mfma_f32_16x16x32_bf16 v[240:243], v[48:51], a[220:223], v[240:243]
    v_mfma_f32_16x16x32_bf16 v[240:243], a[40:43], a[236:239], v[240:243]
    v_mfma_f32_16x16x32_bf16 v[240:243], a[80:83], a[252:255], v[240:243]
    v_mfma_f32_16x16x32_bf16 v[244:247], v[52:55], a[220:223], v[244:247]
    v_cvt_pk_bf16_f32 v208, v208, v209
    v_cvt_pk_bf16_f32 v209, v210, v211
    v_mfma_f32_16x16x32_bf16 v[244:247], a[44:47], a[236:239], v[244:247]
    v_cvt_pk_bf16_f32 v210, v212, v213
    v_cvt_pk_bf16_f32 v211, v214, v215
    v_mfma_f32_16x16x32_bf16 v[244:247], a[84:87], a[252:255], v[244:247]
    ds_write_b128 v16, v[208:211] offset:34816
    v_mfma_f32_16x16x32_bf16 v[144:147], v[48:51], a[208:211], v[144:147]
    v_mfma_f32_16x16x32_bf16 v[144:147], a[40:43], a[224:227], v[144:147]
    v_mfma_f32_16x16x32_bf16 v[144:147], a[80:83], a[240:243], v[144:147]
    v_mfma_f32_16x16x32_bf16 v[148:151], v[52:55], a[208:211], v[148:151]
    v_cvt_pk_bf16_f32 v240, v240, v241
    v_cvt_pk_bf16_f32 v241, v242, v243
    v_mfma_f32_16x16x32_bf16 v[148:151], a[44:47], a[224:227], v[148:151]
    v_cvt_pk_bf16_f32 v242, v244, v245
    v_cvt_pk_bf16_f32 v243, v246, v247
    v_mfma_f32_16x16x32_bf16 v[148:151], a[84:87], a[240:243], v[148:151]
    ds_write_b128 v16, v[240:243] offset:38912
    v_mfma_f32_16x16x32_bf16 v[176:179], v[48:51], a[212:215], v[176:179]
    v_mfma_f32_16x16x32_bf16 v[176:179], a[40:43], a[228:231], v[176:179]
    v_mfma_f32_16x16x32_bf16 v[176:179], a[80:83], a[244:247], v[176:179]
    v_mfma_f32_16x16x32_bf16 v[180:183], v[52:55], a[212:215], v[180:183]
    v_cvt_pk_bf16_f32 v144, v144, v145
    v_cvt_pk_bf16_f32 v145, v146, v147
    v_mfma_f32_16x16x32_bf16 v[180:183], a[44:47], a[228:231], v[180:183]
    v_cvt_pk_bf16_f32 v146, v148, v149
    v_cvt_pk_bf16_f32 v147, v150, v151
    v_mfma_f32_16x16x32_bf16 v[180:183], a[84:87], a[244:247], v[180:183]
    ds_write_b128 v16, v[144:147] offset:2048
    v_mfma_f32_16x16x32_bf16 v[216:219], v[56:59], a[216:219], v[216:219]
    v_mfma_f32_16x16x32_bf16 v[216:219], a[48:51], a[232:235], v[216:219]
    v_mfma_f32_16x16x32_bf16 v[216:219], a[88:91], a[248:251], v[216:219]
    v_mfma_f32_16x16x32_bf16 v[220:223], v[60:63], a[216:219], v[220:223]
    v_cvt_pk_bf16_f32 v176, v176, v177
    v_cvt_pk_bf16_f32 v177, v178, v179
    v_mfma_f32_16x16x32_bf16 v[220:223], a[52:55], a[232:235], v[220:223]
    v_cvt_pk_bf16_f32 v178, v180, v181
    v_cvt_pk_bf16_f32 v179, v182, v183
    v_mfma_f32_16x16x32_bf16 v[220:223], a[92:95], a[248:251], v[220:223]
    ds_write_b128 v16, v[176:179] offset:6144
    v_mfma_f32_16x16x32_bf16 v[248:251], v[56:59], a[220:223], v[248:251]
    v_mfma_f32_16x16x32_bf16 v[248:251], a[48:51], a[236:239], v[248:251]
    v_mfma_f32_16x16x32_bf16 v[248:251], a[88:91], a[252:255], v[248:251]
    v_mfma_f32_16x16x32_bf16 v[252:255], v[60:63], a[220:223], v[252:255]
    v_cvt_pk_bf16_f32 v216, v216, v217
    v_cvt_pk_bf16_f32 v217, v218, v219
    v_mfma_f32_16x16x32_bf16 v[252:255], a[52:55], a[236:239], v[252:255]
    v_cvt_pk_bf16_f32 v218, v220, v221
    v_cvt_pk_bf16_f32 v219, v222, v223
    v_mfma_f32_16x16x32_bf16 v[252:255], a[92:95], a[252:255], v[252:255]
    ds_write_b128 v16, v[216:219] offset:35840
    v_mfma_f32_16x16x32_bf16 v[152:155], v[56:59], a[208:211], v[152:155]
    v_mfma_f32_16x16x32_bf16 v[152:155], a[48:51], a[224:227], v[152:155]
    v_mfma_f32_16x16x32_bf16 v[152:155], a[88:91], a[240:243], v[152:155]
    v_mfma_f32_16x16x32_bf16 v[156:159], v[60:63], a[208:211], v[156:159]
    v_cvt_pk_bf16_f32 v248, v248, v249
    v_cvt_pk_bf16_f32 v249, v250, v251
    v_mfma_f32_16x16x32_bf16 v[156:159], a[52:55], a[224:227], v[156:159]
    v_cvt_pk_bf16_f32 v250, v252, v253
    v_cvt_pk_bf16_f32 v251, v254, v255
    v_mfma_f32_16x16x32_bf16 v[156:159], a[92:95], a[240:243], v[156:159]
    ds_write_b128 v16, v[248:251] offset:39936
    v_mfma_f32_16x16x32_bf16 v[184:187], v[56:59], a[212:215], v[184:187]
    v_mfma_f32_16x16x32_bf16 v[184:187], a[48:51], a[228:231], v[184:187]
    v_mfma_f32_16x16x32_bf16 v[184:187], a[88:91], a[244:247], v[184:187]
    v_mfma_f32_16x16x32_bf16 v[188:191], v[60:63], a[212:215], v[188:191]
    v_cvt_pk_bf16_f32 v152, v152, v153
    v_cvt_pk_bf16_f32 v153, v154, v155
    v_mfma_f32_16x16x32_bf16 v[188:191], a[52:55], a[228:231], v[188:191]
    v_cvt_pk_bf16_f32 v154, v156, v157
    v_cvt_pk_bf16_f32 v155, v158, v159
    v_mfma_f32_16x16x32_bf16 v[188:191], a[92:95], a[244:247], v[188:191]
    ds_write_b128 v16, v[152:155] offset:3072
L_attn:
    v_add_u32 v15, 4096, v1
    v_cvt_pk_bf16_f32 v184, v184, v185
    v_cvt_pk_bf16_f32 v185, v186, v187
    s_nop 3
    v_cvt_pk_bf16_f32 v186, v188, v189
    v_cvt_pk_bf16_f32 v187, v190, v191
    ds_write_b128 v16, v[184:187] offset:7168
    s_waitcnt vmcnt(24) lgkmcnt(0)
    s_barrier
    ds_read_b128 a[64:67], v17 offset:0
    ds_read_b128 a[128:131], v18 offset:0
    ds_read_b128 a[68:71], v17 offset:1024
    ds_read_b128 a[132:135], v18 offset:1024
    ds_read_b128 a[72:75], v17 offset:2048
    ds_read_b128 a[136:139], v18 offset:2048
    ds_read_b128 a[76:79], v17 offset:3072
    ds_read_b128 a[140:143], v18 offset:3072
    ds_read_b128 a[144:147], v18 offset:4096
    ds_read_b128 a[148:151], v18 offset:5120
    ds_read_b128 a[152:155], v18 offset:6144
    ds_read_b128 a[156:159], v18 offset:7168
    ds_read_b128 a[80:83], v17 offset:4096
    ds_read_b128 a[84:87], v17 offset:5120
    ds_read_b128 a[88:91], v17 offset:6144
    ds_read_b128 a[92:95], v17 offset:7168
    s_waitcnt lgkmcnt(14)
    v_mfma_f32_16x16x32_bf16 v[96:99], a[128:131], a[64:67], v[96:99]
    s_waitcnt lgkmcnt(12)
    s_add_u32 s19, s82, 32768
    s_sub_u32 s82, s12, s13
    ds_read_b128 a[96:99], v17 offset:8192
    v_mfma_f32_16x16x32_bf16 v[96:99], a[132:135], a[68:71], v[96:99]
    s_waitcnt lgkmcnt(11)
    s_sub_u32 s82, s82, 1
    s_cmp_gt_u32 s12, s13
    s_cselect_b32 s82, s82, s12
    ds_read_b128 a[100:103], v17 offset:9216
    v_mfma_f32_16x16x32_bf16 v[96:99], a[136:139], a[72:75], v[96:99]
    s_waitcnt lgkmcnt(10)
    s_lshl_b32 s82, s82, 16
    s_add_u32 s82, s82, s81
    ds_read_b128 a[104:107], v17 offset:10240
    v_mfma_f32_16x16x32_bf16 v[96:99], a[140:143], a[76:79], v[96:99]
    s_waitcnt lgkmcnt(10)
    s_cmp_ge_u32 s12, 17
    s_cselect_b32 s82, 2147471360, s82
    s_add_u32 s12, s12, 1
    ds_read_b128 a[108:111], v17 offset:11264
    v_mfma_f32_16x16x32_bf16 v[100:103], a[144:147], a[64:67], v[100:103]
    s_waitcnt lgkmcnt(10)
    s_sub_u32 s14, s60, 1
    ds_read_b128 a[112:115], v17 offset:12288
    v_mfma_f32_16x16x32_bf16 v[100:103], a[148:151], a[68:71], v[100:103]
    s_waitcnt lgkmcnt(10)
    ds_read_b128 a[116:119], v17 offset:13312
    v_mfma_f32_16x16x32_bf16 v[100:103], a[152:155], a[72:75], v[100:103]
    s_waitcnt lgkmcnt(10)
    ds_read_b128 a[120:123], v17 offset:14336
    v_mfma_f32_16x16x32_bf16 v[100:103], a[156:159], a[76:79], v[100:103]
    s_waitcnt lgkmcnt(10)
    ds_read_b128 a[124:127], v17 offset:15360
    v_mfma_f32_16x16x32_bf16 v[104:107], a[128:131], a[80:83], v[104:107]
    s_waitcnt lgkmcnt(10)
    ds_read_b128 a[192:195], v17 offset:32768
    v_exp_f32 v96, v96
    v_mfma_f32_16x16x32_bf16 v[104:107], a[132:135], a[84:87], v[104:107]
    s_waitcnt lgkmcnt(10)
    ds_read_b128 a[196:199], v17 offset:33792
    v_exp_f32 v97, v97
    v_mfma_f32_16x16x32_bf16 v[104:107], a[136:139], a[88:91], v[104:107]
    s_waitcnt lgkmcnt(10)
    ds_read_b128 a[200:203], v17 offset:34816
    v_exp_f32 v98, v98
    v_mfma_f32_16x16x32_bf16 v[104:107], a[140:143], a[92:95], v[104:107]
    ds_read_b128 a[204:207], v17 offset:35840
    v_exp_f32 v99, v99
    v_mfma_f32_16x16x32_bf16 v[108:111], a[144:147], a[80:83], v[108:111]
    ds_read_b128 a[208:211], v17 offset:36864
    v_exp_f32 v100, v100
    v_mfma_f32_16x16x32_bf16 v[108:111], a[148:151], a[84:87], v[108:111]
    ds_read_b128 a[212:215], v17 offset:37888
    v_exp_f32 v101, v101
    v_mfma_f32_16x16x32_bf16 v[108:111], a[152:155], a[88:91], v[108:111]
    ds_read_b128 a[216:219], v17 offset:38912
    v_exp_f32 v102, v102
    v_mfma_f32_16x16x32_bf16 v[108:111], a[156:159], a[92:95], v[108:111]
    s_waitcnt lgkmcnt(14)
    ds_read_b128 a[220:223], v17 offset:39936
    v_exp_f32 v103, v103
    v_mfma_f32_16x16x32_bf16 v[112:115], a[128:131], a[96:99], v[72:75]
    s_waitcnt lgkmcnt(14)
    ds_read_b128 a[224:227], v17 offset:40960
    v_exp_f32 v104, v104
    v_mfma_f32_16x16x32_bf16 v[112:115], a[132:135], a[100:103], v[112:115]
    s_waitcnt lgkmcnt(14)
    ds_read_b128 a[228:231], v17 offset:41984
    v_exp_f32 v105, v105
    v_mfma_f32_16x16x32_bf16 v[112:115], a[136:139], a[104:107], v[112:115]
    s_waitcnt lgkmcnt(14)
    ds_read_b128 a[232:235], v17 offset:43008
    v_exp_f32 v106, v106
    v_mfma_f32_16x16x32_bf16 v[112:115], a[140:143], a[108:111], v[112:115]
    s_waitcnt lgkmcnt(14)
    ds_read_b128 a[236:239], v17 offset:44032
    v_exp_f32 v107, v107
    v_mfma_f32_16x16x32_bf16 v[120:123], a[128:131], a[112:115], v[76:79]
    s_waitcnt lgkmcnt(14)
    ds_read_b128 a[240:243], v17 offset:45056
    v_exp_f32 v108, v108
    v_mfma_f32_16x16x32_bf16 v[120:123], a[132:135], a[116:119], v[120:123]
    s_waitcnt lgkmcnt(14)
    ds_read_b128 a[244:247], v17 offset:46080
    v_exp_f32 v109, v109
    v_mfma_f32_16x16x32_bf16 v[120:123], a[136:139], a[120:123], v[120:123]
    s_waitcnt lgkmcnt(14)
    ds_read_b128 a[248:251], v17 offset:47104
    v_exp_f32 v110, v110
    v_mfma_f32_16x16x32_bf16 v[120:123], a[140:143], a[124:127], v[120:123]
    ds_read_b128 a[252:255], v17 offset:48128
    v_exp_f32 v111, v111
    v_mfma_f32_16x16x32_bf16 v[116:119], a[144:147], a[96:99], v[72:75]
    ds_read_b128 a[128:131], v18 offset:16384
    v_cvt_pk_bf16_f32 v48, v96, v97
    v_mfma_f32_16x16x32_bf16 v[116:119], a[148:151], a[100:103], v[116:119]
    ds_read_b128 a[132:135], v18 offset:17408
    v_cvt_pk_bf16_f32 v49, v98, v99
    v_mfma_f32_16x16x32_bf16 v[116:119], a[152:155], a[104:107], v[116:119]
    ds_read_b128 a[136:139], v18 offset:18432
    v_cvt_pk_bf16_f32 v50, v100, v101
    v_mfma_f32_16x16x32_bf16 v[116:119], a[156:159], a[108:111], v[116:119]
    ds_read_b128 a[140:143], v18 offset:19456
    v_cvt_pk_bf16_f32 v51, v102, v103
    v_mfma_f32_16x16x32_bf16 v[124:127], a[144:147], a[112:115], v[76:79]
    ds_read_b128 a[144:147], v18 offset:20480
    v_cvt_pk_bf16_f32 v52, v104, v105
    v_mfma_f32_16x16x32_bf16 v[124:127], a[148:151], a[116:119], v[124:127]
    ds_read_b128 a[148:151], v18 offset:21504
    v_cvt_pk_bf16_f32 v53, v106, v107
    v_mfma_f32_16x16x32_bf16 v[124:127], a[152:155], a[120:123], v[124:127]
    ds_read_b128 a[152:155], v18 offset:22528
    v_cvt_pk_bf16_f32 v54, v108, v109
    v_mfma_f32_16x16x32_bf16 v[124:127], a[156:159], a[124:127], v[124:127]
    ds_read_b128 a[156:159], v18 offset:23552
    v_cvt_pk_bf16_f32 v55, v110, v111
    v_xor_b32 v18, 196608, v18
    v_lshrrev_b32 v17, 4, v2
    v_lshlrev_b32 v17, 15, v17
    v_and_b32 v14, 255, v1
    v_add_u32 v17, v17, v14
L_t1_p1:
    s_waitcnt vmcnt(8) lgkmcnt(0)
    s_barrier
    s_cmp_eq_u32 s60, 0
    s_cbranch_scc1 L_t1_zero
    v_mfma_f32_16x16x32_bf16 v[96:99], a[128:131], a[64:67], v[64:67]
    s_add_u32 m0, s15, 0
    ds_read_b128 a[160:163], v19 offset:0
    v_mfma_f32_16x16x32_bf16 v[96:99], a[132:135], a[68:71], v[96:99]
    ds_read_b128 a[164:167], v19 offset:1024
    v_mfma_f32_16x16x32_bf16 v[96:99], a[136:139], a[72:75], v[96:99]
    v_exp_f32 v112, v112
    v_mfma_f32_16x16x32_bf16 v[96:99], a[140:143], a[76:79], v[96:99]
    buffer_load_dwordx4 v1, s[8:11], s82 offen offset:0 lds
    v_mfma_f32_16x16x32_bf16 v[104:107], a[128:131], a[80:83], v[68:71]
    v_exp_f32 v113, v113
    v_mfma_f32_16x16x32_bf16 v[104:107], a[132:135], a[84:87], v[104:107]
    ds_read_b128 a[168:171], v19 offset:2048
    v_cvt_pk_bf16_f32 v56, v112, v113
    v_mfma_f32_16x16x32_bf16 v[104:107], a[136:139], a[88:91], v[104:107]
    v_exp_f32 v114, v114
    v_mfma_f32_16x16x32_bf16 v[104:107], a[140:143], a[92:95], v[104:107]
    buffer_load_dwordx4 v1, s[8:11], s82 offen offset:1024 lds
    v_mfma_f32_16x16x32_bf16 v[100:103], a[144:147], a[64:67], v[64:67]
    v_exp_f32 v115, v115
    v_mfma_f32_16x16x32_bf16 v[100:103], a[148:151], a[68:71], v[100:103]
    ds_read_b128 a[172:175], v19 offset:3072
    v_cvt_pk_bf16_f32 v57, v114, v115
    v_mfma_f32_16x16x32_bf16 v[100:103], a[152:155], a[72:75], v[100:103]
    v_exp_f32 v116, v116
    v_mfma_f32_16x16x32_bf16 v[100:103], a[156:159], a[76:79], v[100:103]
    buffer_load_dwordx4 v1, s[8:11], s82 offen offset:2048 lds
    v_mfma_f32_16x16x32_bf16 v[108:111], a[144:147], a[80:83], v[68:71]
    v_exp_f32 v117, v117
    v_mfma_f32_16x16x32_bf16 v[108:111], a[148:151], a[84:87], v[108:111]
    ds_read_b128 a[176:179], v20 offset:4096
    v_cvt_pk_bf16_f32 v58, v116, v117
    v_mfma_f32_16x16x32_bf16 v[108:111], a[152:155], a[88:91], v[108:111]
    v_exp_f32 v118, v118
    v_mfma_f32_16x16x32_bf16 v[108:111], a[156:159], a[92:95], v[108:111]
    buffer_load_dwordx4 v1, s[8:11], s82 offen offset:3072 lds
    v_mfma_f32_16x16x32_bf16 v[32:35], v[28:31], v[48:51], 0
    s_add_u32 m0, s15, 4096
    v_exp_f32 v119, v119
    v_mfma_f32_16x16x32_bf16 v[36:39], v[28:31], v[52:55], 0
    s_waitcnt lgkmcnt(4)
    ds_read_b128 a[180:183], v20 offset:5120
    v_cvt_pk_bf16_f32 v59, v118, v119
    v_mfma_f32_16x16x32_bf16 v[128:131], a[160:163], v[48:51], 0
    v_exp_f32 v120, v120
    v_mfma_f32_16x16x32_bf16 v[160:163], a[160:163], v[52:55], 0
    s_waitcnt lgkmcnt(4)
    v_mfma_f32_16x16x32_bf16 v[132:135], a[164:167], v[48:51], 0
    v_exp_f32 v121, v121
    v_mfma_f32_16x16x32_bf16 v[164:167], a[164:167], v[52:55], 0
    s_waitcnt lgkmcnt(3)
    ds_read_b128 a[184:187], v20 offset:6144
    v_cvt_pk_bf16_f32 v60, v120, v121
    v_mfma_f32_16x16x32_bf16 v[136:139], a[168:171], v[48:51], 0
    s_waitcnt lgkmcnt(3)
    v_exp_f32 v122, v122
    v_mfma_f32_16x16x32_bf16 v[168:171], a[168:171], v[52:55], 0
    buffer_load_dwordx4 v15, s[8:11], s82 offen offset:0 lds
    v_mfma_f32_16x16x32_bf16 v[140:143], a[172:175], v[48:51], 0
    v_exp_f32 v123, v123
    v_mfma_f32_16x16x32_bf16 v[172:175], a[172:175], v[52:55], 0
    s_waitcnt lgkmcnt(2)
    ds_read_b128 a[188:191], v20 offset:7168
    v_cvt_pk_bf16_f32 v61, v122, v123
    v_mfma_f32_16x16x32_bf16 v[144:147], a[176:179], v[48:51], 0
    s_waitcnt lgkmcnt(2)
    v_exp_f32 v124, v124
    v_mfma_f32_16x16x32_bf16 v[176:179], a[176:179], v[52:55], 0
    buffer_load_dwordx4 v15, s[8:11], s82 offen offset:1024 lds
    v_mfma_f32_16x16x32_bf16 v[148:151], a[180:183], v[48:51], 0
    v_exp_f32 v125, v125
    v_mfma_f32_16x16x32_bf16 v[180:183], a[180:183], v[52:55], 0
    s_waitcnt lgkmcnt(1)
    v_cvt_pk_bf16_f32 v62, v124, v125
    v_mfma_f32_16x16x32_bf16 v[152:155], a[184:187], v[48:51], 0
    s_waitcnt lgkmcnt(0)
    v_exp_f32 v126, v126
    v_mfma_f32_16x16x32_bf16 v[184:187], a[184:187], v[52:55], 0
    buffer_load_dwordx4 v15, s[8:11], s82 offen offset:2048 lds
    v_mfma_f32_16x16x32_bf16 v[156:159], a[188:191], v[48:51], 0
    v_exp_f32 v127, v127
    v_mfma_f32_16x16x32_bf16 v[188:191], a[188:191], v[52:55], 0
    v_cvt_pk_bf16_f32 v63, v126, v127
    v_mfma_f32_16x16x32_bf16 v[112:115], a[128:131], a[96:99], v[72:75]
    v_mfma_f32_16x16x32_bf16 v[112:115], a[132:135], a[100:103], v[112:115]
    v_mfma_f32_16x16x32_bf16 v[112:115], a[136:139], a[104:107], v[112:115]
    v_exp_f32 v96, v96
    v_mfma_f32_16x16x32_bf16 v[112:115], a[140:143], a[108:111], v[112:115]
    buffer_load_dwordx4 v15, s[8:11], s82 offen offset:3072 lds
    v_mfma_f32_16x16x32_bf16 v[120:123], a[128:131], a[112:115], v[76:79]
    s_xor_b32 s15, s15, 196608
    v_exp_f32 v97, v97
    v_mfma_f32_16x16x32_bf16 v[120:123], a[132:135], a[116:119], v[120:123]
    s_add_u32 m0, s16, 0
    ds_read_b128 a[128:131], v18 offset:0
    v_cvt_pk_bf16_f32 v48, v96, v97
    v_mfma_f32_16x16x32_bf16 v[120:123], a[136:139], a[120:123], v[120:123]
    v_exp_f32 v98, v98
    v_mfma_f32_16x16x32_bf16 v[120:123], a[140:143], a[124:127], v[120:123]
    buffer_load_dwordx4 v1, s[8:11], s19 offen offset:0 lds
    v_mfma_f32_16x16x32_bf16 v[116:119], a[144:147], a[96:99], v[72:75]
    v_exp_f32 v99, v99
    v_mfma_f32_16x16x32_bf16 v[116:119], a[148:151], a[100:103], v[116:119]
    ds_read_b128 a[132:135], v18 offset:1024
    v_cvt_pk_bf16_f32 v49, v98, v99
    v_mfma_f32_16x16x32_bf16 v[116:119], a[152:155], a[104:107], v[116:119]
    v_exp_f32 v100, v100
    v_mfma_f32_16x16x32_bf16 v[116:119], a[156:159], a[108:111], v[116:119]
    buffer_load_dwordx4 v1, s[8:11], s19 offen offset:1024 lds
    v_mfma_f32_16x16x32_bf16 v[124:127], a[144:147], a[112:115], v[76:79]
    v_exp_f32 v101, v101
    v_mfma_f32_16x16x32_bf16 v[124:127], a[148:151], a[116:119], v[124:127]
    ds_read_b128 a[136:139], v18 offset:2048
    v_cvt_pk_bf16_f32 v50, v100, v101
    v_mfma_f32_16x16x32_bf16 v[124:127], a[152:155], a[120:123], v[124:127]
    v_exp_f32 v102, v102
    v_mfma_f32_16x16x32_bf16 v[124:127], a[156:159], a[124:127], v[124:127]
    buffer_load_dwordx4 v1, s[8:11], s19 offen offset:2048 lds
    v_mfma_f32_16x16x32_bf16 v[40:43], v[28:31], v[56:59], 0
    v_exp_f32 v103, v103
    v_mfma_f32_16x16x32_bf16 v[44:47], v[28:31], v[60:63], 0
    ds_read_b128 a[140:143], v18 offset:3072
    v_cvt_pk_bf16_f32 v51, v102, v103
    v_mfma_f32_16x16x32_bf16 v[192:195], a[160:163], v[56:59], 0
    v_exp_f32 v104, v104
    v_mfma_f32_16x16x32_bf16 v[224:227], a[160:163], v[60:63], 0
    v_mfma_f32_16x16x32_bf16 v[196:199], a[164:167], v[56:59], 0
    v_exp_f32 v105, v105
    v_mfma_f32_16x16x32_bf16 v[228:231], a[164:167], v[60:63], 0
    ds_read_b128 a[144:147], v18 offset:4096
    v_cvt_pk_bf16_f32 v52, v104, v105
    v_mfma_f32_16x16x32_bf16 v[200:203], a[168:171], v[56:59], 0
    v_exp_f32 v106, v106
    v_mfma_f32_16x16x32_bf16 v[232:235], a[168:171], v[60:63], 0
    buffer_load_dwordx4 v1, s[8:11], s19 offen offset:3072 lds
    v_mfma_f32_16x16x32_bf16 v[204:207], a[172:175], v[56:59], 0
    s_add_u32 m0, s16, 4096
    v_exp_f32 v107, v107
    v_mfma_f32_16x16x32_bf16 v[236:239], a[172:175], v[60:63], 0
    ds_read_b128 a[148:151], v18 offset:5120
    v_cvt_pk_bf16_f32 v53, v106, v107
    v_mfma_f32_16x16x32_bf16 v[208:211], a[176:179], v[56:59], 0
    v_exp_f32 v108, v108
    v_mfma_f32_16x16x32_bf16 v[240:243], a[176:179], v[60:63], 0
    buffer_load_dwordx4 v15, s[8:11], s19 offen offset:0 lds
    v_mfma_f32_16x16x32_bf16 v[212:215], a[180:183], v[56:59], 0
    v_exp_f32 v109, v109
    v_mfma_f32_16x16x32_bf16 v[244:247], a[180:183], v[60:63], 0
    ds_read_b128 a[152:155], v18 offset:6144
    v_cvt_pk_bf16_f32 v54, v108, v109
    v_mfma_f32_16x16x32_bf16 v[216:219], a[184:187], v[56:59], 0
    v_exp_f32 v110, v110
    v_mfma_f32_16x16x32_bf16 v[248:251], a[184:187], v[60:63], 0
    buffer_load_dwordx4 v15, s[8:11], s19 offen offset:1024 lds
    v_mfma_f32_16x16x32_bf16 v[220:223], a[188:191], v[56:59], 0
    v_exp_f32 v111, v111
    v_mfma_f32_16x16x32_bf16 v[252:255], a[188:191], v[60:63], 0
    ds_read_b128 a[156:159], v18 offset:7168
    v_cvt_pk_bf16_f32 v55, v110, v111
    s_cmp_eq_u32 s14, 0
    s_cbranch_scc1 L_t1_diag
.p2align 3
L_t1_loop:
    s_waitcnt lgkmcnt(7)
    v_mfma_f32_16x16x32_bf16 v[96:99], a[128:131], a[64:67], v[64:67]
    s_waitcnt lgkmcnt(6)
    ds_read_b128 a[160:163], v19 offset:16384
    v_mfma_f32_16x16x32_bf16 v[96:99], a[132:135], a[68:71], v[96:99]
    s_waitcnt lgkmcnt(6)
    ds_read_b128 a[164:167], v19 offset:17408
    v_mfma_f32_16x16x32_bf16 v[96:99], a[136:139], a[72:75], v[96:99]
    s_waitcnt lgkmcnt(6)
    v_exp_f32 v112, v112
    v_mfma_f32_16x16x32_bf16 v[96:99], a[140:143], a[76:79], v[96:99]
    buffer_load_dwordx4 v15, s[8:11], s19 offen offset:2048 lds
    v_mfma_f32_16x16x32_bf16 v[104:107], a[128:131], a[80:83], v[68:71]
    v_exp_f32 v113, v113
    v_mfma_f32_16x16x32_bf16 v[104:107], a[132:135], a[84:87], v[104:107]
    ds_read_b128 a[168:171], v19 offset:18432
    v_cvt_pk_bf16_f32 v56, v112, v113
    v_mfma_f32_16x16x32_bf16 v[104:107], a[136:139], a[88:91], v[104:107]
    s_waitcnt lgkmcnt(6)
    v_exp_f32 v114, v114
    v_mfma_f32_16x16x32_bf16 v[104:107], a[140:143], a[92:95], v[104:107]
    buffer_load_dwordx4 v15, s[8:11], s19 offen offset:3072 lds
    v_mfma_f32_16x16x32_bf16 v[100:103], a[144:147], a[64:67], v[64:67]
    s_waitcnt lgkmcnt(5)
    s_xor_b32 s16, s16, 98304
    v_exp_f32 v115, v115
    v_mfma_f32_16x16x32_bf16 v[100:103], a[148:151], a[68:71], v[100:103]
    s_waitcnt lgkmcnt(4)
    ds_read_b128 a[172:175], v19 offset:19456
    v_cvt_pk_bf16_f32 v57, v114, v115
    v_mfma_f32_16x16x32_bf16 v[100:103], a[152:155], a[72:75], v[100:103]
    s_waitcnt lgkmcnt(4)
    v_exp_f32 v116, v116
    v_mfma_f32_16x16x32_bf16 v[100:103], a[156:159], a[76:79], v[100:103]
    v_mfma_f32_16x16x32_bf16 v[108:111], a[144:147], a[80:83], v[68:71]
    v_exp_f32 v117, v117
    v_mfma_f32_16x16x32_bf16 v[108:111], a[148:151], a[84:87], v[108:111]
    ds_read_b128 a[176:179], v20 offset:20480
    v_cvt_pk_bf16_f32 v58, v116, v117
    v_mfma_f32_16x16x32_bf16 v[108:111], a[152:155], a[88:91], v[108:111]
    v_exp_f32 v118, v118
    v_mfma_f32_16x16x32_bf16 v[108:111], a[156:159], a[92:95], v[108:111]
    v_mfma_f32_16x16x32_bf16 v[32:35], v[28:31], v[48:51], v[32:35]
    v_exp_f32 v119, v119
    v_mfma_f32_16x16x32_bf16 v[36:39], v[28:31], v[52:55], v[36:39]
    s_waitcnt lgkmcnt(4)
    ds_read_b128 a[180:183], v20 offset:21504
    v_cvt_pk_bf16_f32 v59, v118, v119
    v_mfma_f32_16x16x32_bf16 v[128:131], a[160:163], v[48:51], v[128:131]
    v_exp_f32 v120, v120
    v_mfma_f32_16x16x32_bf16 v[160:163], a[160:163], v[52:55], v[160:163]
    s_waitcnt lgkmcnt(4)
    v_mfma_f32_16x16x32_bf16 v[132:135], a[164:167], v[48:51], v[132:135]
    v_exp_f32 v121, v121
    v_mfma_f32_16x16x32_bf16 v[164:167], a[164:167], v[52:55], v[164:167]
    s_waitcnt lgkmcnt(3)
    ds_read_b128 a[184:187], v20 offset:22528
    v_cvt_pk_bf16_f32 v60, v120, v121
    v_mfma_f32_16x16x32_bf16 v[136:139], a[168:171], v[48:51], v[136:139]
    v_exp_f32 v122, v122
    v_mfma_f32_16x16x32_bf16 v[168:171], a[168:171], v[52:55], v[168:171]
    s_waitcnt lgkmcnt(3)
    v_mfma_f32_16x16x32_bf16 v[140:143], a[172:175], v[48:51], v[140:143]
    v_exp_f32 v123, v123
    v_mfma_f32_16x16x32_bf16 v[172:175], a[172:175], v[52:55], v[172:175]
    s_waitcnt lgkmcnt(2)
    ds_read_b128 a[188:191], v20 offset:23552
    v_cvt_pk_bf16_f32 v61, v122, v123
    v_mfma_f32_16x16x32_bf16 v[144:147], a[176:179], v[48:51], v[144:147]
    v_exp_f32 v124, v124
    v_mfma_f32_16x16x32_bf16 v[176:179], a[176:179], v[52:55], v[176:179]
    s_waitcnt lgkmcnt(2)
    v_mfma_f32_16x16x32_bf16 v[148:151], a[180:183], v[48:51], v[148:151]
    v_exp_f32 v125, v125
    v_mfma_f32_16x16x32_bf16 v[180:183], a[180:183], v[52:55], v[180:183]
    s_waitcnt lgkmcnt(1)
    v_cvt_pk_bf16_f32 v62, v124, v125
    v_xor_b32 v19, 98304, v19
    v_mfma_f32_16x16x32_bf16 v[152:155], a[184:187], v[48:51], v[152:155]
    v_exp_f32 v126, v126
    v_mfma_f32_16x16x32_bf16 v[184:187], a[184:187], v[52:55], v[184:187]
    s_waitcnt lgkmcnt(0)
    v_xor_b32 v20, 98304, v20
    v_mfma_f32_16x16x32_bf16 v[156:159], a[188:191], v[48:51], v[156:159]
    v_exp_f32 v127, v127
    v_mfma_f32_16x16x32_bf16 v[188:191], a[188:191], v[52:55], v[188:191]
    v_cvt_pk_bf16_f32 v63, v126, v127
    v_mfma_f32_16x16x32_bf16 v[112:115], a[128:131], a[96:99], v[72:75]
    v_exp_f32 v96, v96
    v_mfma_f32_16x16x32_bf16 v[112:115], a[132:135], a[100:103], v[112:115]
    v_mfma_f32_16x16x32_bf16 v[112:115], a[136:139], a[104:107], v[112:115]
    v_exp_f32 v97, v97
    v_mfma_f32_16x16x32_bf16 v[112:115], a[140:143], a[108:111], v[112:115]
    v_cvt_pk_bf16_f32 v48, v96, v97
    v_mfma_f32_16x16x32_bf16 v[120:123], a[128:131], a[112:115], v[76:79]
    v_exp_f32 v98, v98
    v_mfma_f32_16x16x32_bf16 v[120:123], a[132:135], a[116:119], v[120:123]
    v_mfma_f32_16x16x32_bf16 v[120:123], a[136:139], a[120:123], v[120:123]
    v_exp_f32 v99, v99
    v_mfma_f32_16x16x32_bf16 v[120:123], a[140:143], a[124:127], v[120:123]
    v_mfma_f32_16x16x32_bf16 v[116:119], a[144:147], a[96:99], v[72:75]
    v_exp_f32 v100, v100
    v_mfma_f32_16x16x32_bf16 v[116:119], a[148:151], a[100:103], v[116:119]
    ds_read_b128 a[128:131], v18 offset:16384
    v_cvt_pk_bf16_f32 v49, v98, v99
    v_mfma_f32_16x16x32_bf16 v[116:119], a[152:155], a[104:107], v[116:119]
    s_add_u32 s19, s82, 32768
    v_exp_f32 v101, v101
    v_mfma_f32_16x16x32_bf16 v[116:119], a[156:159], a[108:111], v[116:119]
    s_sub_u32 s82, s12, s13
    ds_read_b128 a[132:135], v18 offset:17408
    v_cvt_pk_bf16_f32 v50, v100, v101
    v_mfma_f32_16x16x32_bf16 v[124:127], a[144:147], a[112:115], v[76:79]
    s_sub_u32 s82, s82, 1
    v_exp_f32 v102, v102
    v_mfma_f32_16x16x32_bf16 v[124:127], a[148:151], a[116:119], v[124:127]
    s_cmp_gt_u32 s12, s13
    s_cselect_b32 s82, s82, s12
    s_lshl_b32 s82, s82, 16
    ds_read_b128 a[136:139], v18 offset:18432
    v_mfma_f32_16x16x32_bf16 v[124:127], a[152:155], a[120:123], v[124:127]
    s_add_u32 s82, s82, s81
    v_exp_f32 v103, v103
    v_mfma_f32_16x16x32_bf16 v[124:127], a[156:159], a[124:127], v[124:127]
    s_cmp_ge_u32 s12, 17
    s_cselect_b32 s82, 2147471360, s82
    ds_read_b128 a[140:143], v18 offset:19456
    v_cvt_pk_bf16_f32 v51, v102, v103
    v_mfma_f32_16x16x32_bf16 v[40:43], v[28:31], v[56:59], v[40:43]
    s_add_u32 s12, s12, 1
    v_exp_f32 v104, v104
    v_mfma_f32_16x16x32_bf16 v[44:47], v[28:31], v[60:63], v[44:47]
    ds_read_b128 a[144:147], v18 offset:20480
    v_mfma_f32_16x16x32_bf16 v[192:195], a[160:163], v[56:59], v[192:195]
    v_exp_f32 v105, v105
    v_mfma_f32_16x16x32_bf16 v[224:227], a[160:163], v[60:63], v[224:227]
    ds_read_b128 a[148:151], v18 offset:21504
    v_cvt_pk_bf16_f32 v52, v104, v105
    v_mfma_f32_16x16x32_bf16 v[196:199], a[164:167], v[56:59], v[196:199]
    v_exp_f32 v106, v106
    v_mfma_f32_16x16x32_bf16 v[228:231], a[164:167], v[60:63], v[228:231]
    ds_read_b128 a[152:155], v18 offset:22528
    v_mfma_f32_16x16x32_bf16 v[200:203], a[168:171], v[56:59], v[200:203]
    v_exp_f32 v107, v107
    v_mfma_f32_16x16x32_bf16 v[232:235], a[168:171], v[60:63], v[232:235]
    ds_read_b128 a[156:159], v18 offset:23552
    v_cvt_pk_bf16_f32 v53, v106, v107
    v_mfma_f32_16x16x32_bf16 v[204:207], a[172:175], v[56:59], v[204:207]
    v_exp_f32 v108, v108
    v_mfma_f32_16x16x32_bf16 v[236:239], a[172:175], v[60:63], v[236:239]
    v_mfma_f32_16x16x32_bf16 v[208:211], a[176:179], v[56:59], v[208:211]
    v_exp_f32 v109, v109
    v_mfma_f32_16x16x32_bf16 v[240:243], a[176:179], v[60:63], v[240:243]
    v_cvt_pk_bf16_f32 v54, v108, v109
    v_xor_b32 v18, 196608, v18
    v_mfma_f32_16x16x32_bf16 v[212:215], a[180:183], v[56:59], v[212:215]
    v_exp_f32 v110, v110
    v_mfma_f32_16x16x32_bf16 v[244:247], a[180:183], v[60:63], v[244:247]
    v_mfma_f32_16x16x32_bf16 v[216:219], a[184:187], v[56:59], v[216:219]
    v_exp_f32 v111, v111
    v_mfma_f32_16x16x32_bf16 v[248:251], a[184:187], v[60:63], v[248:251]
    v_cvt_pk_bf16_f32 v55, v110, v111
    v_mfma_f32_16x16x32_bf16 v[220:223], a[188:191], v[56:59], v[220:223]
    v_mfma_f32_16x16x32_bf16 v[252:255], a[188:191], v[60:63], v[252:255]
    s_waitcnt vmcnt(0) lgkmcnt(0)
    s_barrier
    v_mfma_f32_16x16x32_bf16 v[96:99], a[128:131], a[64:67], v[64:67]
    s_add_u32 m0, s15, 0
    ds_read_b128 a[160:163], v19 offset:0
    v_mfma_f32_16x16x32_bf16 v[96:99], a[132:135], a[68:71], v[96:99]
    ds_read_b128 a[164:167], v19 offset:1024
    v_mfma_f32_16x16x32_bf16 v[96:99], a[136:139], a[72:75], v[96:99]
    v_exp_f32 v112, v112
    v_mfma_f32_16x16x32_bf16 v[96:99], a[140:143], a[76:79], v[96:99]
    buffer_load_dwordx4 v1, s[8:11], s82 offen offset:0 lds
    v_mfma_f32_16x16x32_bf16 v[104:107], a[128:131], a[80:83], v[68:71]
    v_exp_f32 v113, v113
    v_mfma_f32_16x16x32_bf16 v[104:107], a[132:135], a[84:87], v[104:107]
    ds_read_b128 a[168:171], v19 offset:2048
    v_cvt_pk_bf16_f32 v56, v112, v113
    v_mfma_f32_16x16x32_bf16 v[104:107], a[136:139], a[88:91], v[104:107]
    v_exp_f32 v114, v114
    v_mfma_f32_16x16x32_bf16 v[104:107], a[140:143], a[92:95], v[104:107]
    buffer_load_dwordx4 v1, s[8:11], s82 offen offset:1024 lds
    v_mfma_f32_16x16x32_bf16 v[100:103], a[144:147], a[64:67], v[64:67]
    v_exp_f32 v115, v115
    v_mfma_f32_16x16x32_bf16 v[100:103], a[148:151], a[68:71], v[100:103]
    ds_read_b128 a[172:175], v19 offset:3072
    v_cvt_pk_bf16_f32 v57, v114, v115
    v_mfma_f32_16x16x32_bf16 v[100:103], a[152:155], a[72:75], v[100:103]
    v_exp_f32 v116, v116
    v_mfma_f32_16x16x32_bf16 v[100:103], a[156:159], a[76:79], v[100:103]
    buffer_load_dwordx4 v1, s[8:11], s82 offen offset:2048 lds
    v_mfma_f32_16x16x32_bf16 v[108:111], a[144:147], a[80:83], v[68:71]
    v_exp_f32 v117, v117
    v_mfma_f32_16x16x32_bf16 v[108:111], a[148:151], a[84:87], v[108:111]
    ds_read_b128 a[176:179], v20 offset:4096
    v_cvt_pk_bf16_f32 v58, v116, v117
    v_mfma_f32_16x16x32_bf16 v[108:111], a[152:155], a[88:91], v[108:111]
    v_exp_f32 v118, v118
    v_mfma_f32_16x16x32_bf16 v[108:111], a[156:159], a[92:95], v[108:111]
    buffer_load_dwordx4 v1, s[8:11], s82 offen offset:3072 lds
    v_mfma_f32_16x16x32_bf16 v[32:35], v[28:31], v[48:51], v[32:35]
    s_add_u32 m0, s15, 4096
    v_exp_f32 v119, v119
    v_mfma_f32_16x16x32_bf16 v[36:39], v[28:31], v[52:55], v[36:39]
    s_waitcnt lgkmcnt(4)
    ds_read_b128 a[180:183], v20 offset:5120
    v_cvt_pk_bf16_f32 v59, v118, v119
    v_mfma_f32_16x16x32_bf16 v[128:131], a[160:163], v[48:51], v[128:131]
    v_exp_f32 v120, v120
    v_mfma_f32_16x16x32_bf16 v[160:163], a[160:163], v[52:55], v[160:163]
    s_waitcnt lgkmcnt(4)
    v_mfma_f32_16x16x32_bf16 v[132:135], a[164:167], v[48:51], v[132:135]
    v_exp_f32 v121, v121
    v_mfma_f32_16x16x32_bf16 v[164:167], a[164:167], v[52:55], v[164:167]
    s_waitcnt lgkmcnt(3)
    ds_read_b128 a[184:187], v20 offset:6144
    v_cvt_pk_bf16_f32 v60, v120, v121
    v_mfma_f32_16x16x32_bf16 v[136:139], a[168:171], v[48:51], v[136:139]
    s_waitcnt lgkmcnt(3)
    v_exp_f32 v122, v122
    v_mfma_f32_16x16x32_bf16 v[168:171], a[168:171], v[52:55], v[168:171]
    buffer_load_dwordx4 v15, s[8:11], s82 offen offset:0 lds
    v_mfma_f32_16x16x32_bf16 v[140:143], a[172:175], v[48:51], v[140:143]
    v_exp_f32 v123, v123
    v_mfma_f32_16x16x32_bf16 v[172:175], a[172:175], v[52:55], v[172:175]
    s_waitcnt lgkmcnt(2)
    ds_read_b128 a[188:191], v20 offset:7168
    v_cvt_pk_bf16_f32 v61, v122, v123
    v_mfma_f32_16x16x32_bf16 v[144:147], a[176:179], v[48:51], v[144:147]
    s_waitcnt lgkmcnt(2)
    v_exp_f32 v124, v124
    v_mfma_f32_16x16x32_bf16 v[176:179], a[176:179], v[52:55], v[176:179]
    buffer_load_dwordx4 v15, s[8:11], s82 offen offset:1024 lds
    v_mfma_f32_16x16x32_bf16 v[148:151], a[180:183], v[48:51], v[148:151]
    v_exp_f32 v125, v125
    v_mfma_f32_16x16x32_bf16 v[180:183], a[180:183], v[52:55], v[180:183]
    s_waitcnt lgkmcnt(1)
    v_cvt_pk_bf16_f32 v62, v124, v125
    v_mfma_f32_16x16x32_bf16 v[152:155], a[184:187], v[48:51], v[152:155]
    s_waitcnt lgkmcnt(0)
    v_exp_f32 v126, v126
    v_mfma_f32_16x16x32_bf16 v[184:187], a[184:187], v[52:55], v[184:187]
    buffer_load_dwordx4 v15, s[8:11], s82 offen offset:2048 lds
    v_mfma_f32_16x16x32_bf16 v[156:159], a[188:191], v[48:51], v[156:159]
    v_exp_f32 v127, v127
    v_mfma_f32_16x16x32_bf16 v[188:191], a[188:191], v[52:55], v[188:191]
    v_cvt_pk_bf16_f32 v63, v126, v127
    v_mfma_f32_16x16x32_bf16 v[112:115], a[128:131], a[96:99], v[72:75]
    v_mfma_f32_16x16x32_bf16 v[112:115], a[132:135], a[100:103], v[112:115]
    v_mfma_f32_16x16x32_bf16 v[112:115], a[136:139], a[104:107], v[112:115]
    v_exp_f32 v96, v96
    v_mfma_f32_16x16x32_bf16 v[112:115], a[140:143], a[108:111], v[112:115]
    buffer_load_dwordx4 v15, s[8:11], s82 offen offset:3072 lds
    v_mfma_f32_16x16x32_bf16 v[120:123], a[128:131], a[112:115], v[76:79]
    s_xor_b32 s15, s15, 196608
    v_exp_f32 v97, v97
    v_mfma_f32_16x16x32_bf16 v[120:123], a[132:135], a[116:119], v[120:123]
    s_add_u32 m0, s16, 0
    ds_read_b128 a[128:131], v18 offset:0
    v_cvt_pk_bf16_f32 v48, v96, v97
    v_mfma_f32_16x16x32_bf16 v[120:123], a[136:139], a[120:123], v[120:123]
    v_exp_f32 v98, v98
    v_mfma_f32_16x16x32_bf16 v[120:123], a[140:143], a[124:127], v[120:123]
    buffer_load_dwordx4 v1, s[8:11], s19 offen offset:0 lds
    v_mfma_f32_16x16x32_bf16 v[116:119], a[144:147], a[96:99], v[72:75]
    v_exp_f32 v99, v99
    v_mfma_f32_16x16x32_bf16 v[116:119], a[148:151], a[100:103], v[116:119]
    ds_read_b128 a[132:135], v18 offset:1024
    v_cvt_pk_bf16_f32 v49, v98, v99
    v_mfma_f32_16x16x32_bf16 v[116:119], a[152:155], a[104:107], v[116:119]
    v_exp_f32 v100, v100
    v_mfma_f32_16x16x32_bf16 v[116:119], a[156:159], a[108:111], v[116:119]
    buffer_load_dwordx4 v1, s[8:11], s19 offen offset:1024 lds
    v_mfma_f32_16x16x32_bf16 v[124:127], a[144:147], a[112:115], v[76:79]
    v_exp_f32 v101, v101
    v_mfma_f32_16x16x32_bf16 v[124:127], a[148:151], a[116:119], v[124:127]
    ds_read_b128 a[136:139], v18 offset:2048
    v_cvt_pk_bf16_f32 v50, v100, v101
    v_mfma_f32_16x16x32_bf16 v[124:127], a[152:155], a[120:123], v[124:127]
    v_exp_f32 v102, v102
    v_mfma_f32_16x16x32_bf16 v[124:127], a[156:159], a[124:127], v[124:127]
    buffer_load_dwordx4 v1, s[8:11], s19 offen offset:2048 lds
    v_mfma_f32_16x16x32_bf16 v[40:43], v[28:31], v[56:59], v[40:43]
    v_exp_f32 v103, v103
    v_mfma_f32_16x16x32_bf16 v[44:47], v[28:31], v[60:63], v[44:47]
    ds_read_b128 a[140:143], v18 offset:3072
    v_cvt_pk_bf16_f32 v51, v102, v103
    v_mfma_f32_16x16x32_bf16 v[192:195], a[160:163], v[56:59], v[192:195]
    v_exp_f32 v104, v104
    v_mfma_f32_16x16x32_bf16 v[224:227], a[160:163], v[60:63], v[224:227]
    v_mfma_f32_16x16x32_bf16 v[196:199], a[164:167], v[56:59], v[196:199]
    v_exp_f32 v105, v105
    v_mfma_f32_16x16x32_bf16 v[228:231], a[164:167], v[60:63], v[228:231]
    ds_read_b128 a[144:147], v18 offset:4096
    v_cvt_pk_bf16_f32 v52, v104, v105
    v_mfma_f32_16x16x32_bf16 v[200:203], a[168:171], v[56:59], v[200:203]
    v_exp_f32 v106, v106
    v_mfma_f32_16x16x32_bf16 v[232:235], a[168:171], v[60:63], v[232:235]
    buffer_load_dwordx4 v1, s[8:11], s19 offen offset:3072 lds
    v_mfma_f32_16x16x32_bf16 v[204:207], a[172:175], v[56:59], v[204:207]
    s_add_u32 m0, s16, 4096
    v_exp_f32 v107, v107
    v_mfma_f32_16x16x32_bf16 v[236:239], a[172:175], v[60:63], v[236:239]
    ds_read_b128 a[148:151], v18 offset:5120
    v_cvt_pk_bf16_f32 v53, v106, v107
    v_mfma_f32_16x16x32_bf16 v[208:211], a[176:179], v[56:59], v[208:211]
    s_sub_u32 s14, s14, 1
    v_exp_f32 v108, v108
    v_mfma_f32_16x16x32_bf16 v[240:243], a[176:179], v[60:63], v[240:243]
    buffer_load_dwordx4 v15, s[8:11], s19 offen offset:0 lds
    v_mfma_f32_16x16x32_bf16 v[212:215], a[180:183], v[56:59], v[212:215]
    v_exp_f32 v109, v109
    v_mfma_f32_16x16x32_bf16 v[244:247], a[180:183], v[60:63], v[244:247]
    ds_read_b128 a[152:155], v18 offset:6144
    v_cvt_pk_bf16_f32 v54, v108, v109
    v_mfma_f32_16x16x32_bf16 v[216:219], a[184:187], v[56:59], v[216:219]
    v_exp_f32 v110, v110
    v_mfma_f32_16x16x32_bf16 v[248:251], a[184:187], v[60:63], v[248:251]
    buffer_load_dwordx4 v15, s[8:11], s19 offen offset:1024 lds
    v_mfma_f32_16x16x32_bf16 v[220:223], a[188:191], v[56:59], v[220:223]
    v_exp_f32 v111, v111
    v_mfma_f32_16x16x32_bf16 v[252:255], a[188:191], v[60:63], v[252:255]
    ds_read_b128 a[156:159], v18 offset:7168
    v_cvt_pk_bf16_f32 v55, v110, v111
    s_cmp_lg_u32 s14, 0
    s_cbranch_scc1 L_t1_loop
L_t1_diag:
    s_waitcnt lgkmcnt(7)
    v_mfma_f32_16x16x32_bf16 v[96:99], a[128:131], a[64:67], v[80:83]
    s_waitcnt lgkmcnt(6)
    ds_read_b128 a[160:163], v19 offset:16384
    v_mfma_f32_16x16x32_bf16 v[96:99], a[132:135], a[68:71], v[96:99]
    s_waitcnt lgkmcnt(6)
    ds_read_b128 a[164:167], v19 offset:17408
    v_mfma_f32_16x16x32_bf16 v[96:99], a[136:139], a[72:75], v[96:99]
    s_waitcnt lgkmcnt(6)
    v_exp_f32 v112, v112
    v_mfma_f32_16x16x32_bf16 v[96:99], a[140:143], a[76:79], v[96:99]
    buffer_load_dwordx4 v15, s[8:11], s19 offen offset:2048 lds
    v_mfma_f32_16x16x32_bf16 v[104:107], a[128:131], a[80:83], v[88:91]
    v_exp_f32 v113, v113
    v_mfma_f32_16x16x32_bf16 v[104:107], a[132:135], a[84:87], v[104:107]
    ds_read_b128 a[168:171], v19 offset:18432
    v_cvt_pk_bf16_f32 v56, v112, v113
    v_mfma_f32_16x16x32_bf16 v[104:107], a[136:139], a[88:91], v[104:107]
    s_waitcnt lgkmcnt(6)
    v_exp_f32 v114, v114
    v_mfma_f32_16x16x32_bf16 v[104:107], a[140:143], a[92:95], v[104:107]
    buffer_load_dwordx4 v15, s[8:11], s19 offen offset:3072 lds
    v_mfma_f32_16x16x32_bf16 v[100:103], a[144:147], a[64:67], v[84:87]
    s_waitcnt lgkmcnt(5)
    s_xor_b32 s16, s16, 98304
    v_exp_f32 v115, v115
    v_mfma_f32_16x16x32_bf16 v[100:103], a[148:151], a[68:71], v[100:103]
    s_waitcnt lgkmcnt(4)
    ds_read_b128 a[172:175], v19 offset:19456
    v_cvt_pk_bf16_f32 v57, v114, v115
    v_mfma_f32_16x16x32_bf16 v[100:103], a[152:155], a[72:75], v[100:103]
    s_waitcnt lgkmcnt(4)
    v_exp_f32 v116, v116
    v_mfma_f32_16x16x32_bf16 v[100:103], a[156:159], a[76:79], v[100:103]
    v_mfma_f32_16x16x32_bf16 v[108:111], a[144:147], a[80:83], v[92:95]
    v_exp_f32 v117, v117
    v_mfma_f32_16x16x32_bf16 v[108:111], a[148:151], a[84:87], v[108:111]
    ds_read_b128 a[176:179], v20 offset:20480
    v_cvt_pk_bf16_f32 v58, v116, v117
    v_mfma_f32_16x16x32_bf16 v[108:111], a[152:155], a[88:91], v[108:111]
    v_exp_f32 v118, v118
    v_mfma_f32_16x16x32_bf16 v[108:111], a[156:159], a[92:95], v[108:111]
    v_mfma_f32_16x16x32_bf16 v[32:35], v[28:31], v[48:51], v[32:35]
    v_exp_f32 v119, v119
    v_mfma_f32_16x16x32_bf16 v[36:39], v[28:31], v[52:55], v[36:39]
    s_waitcnt lgkmcnt(4)
    ds_read_b128 a[180:183], v20 offset:21504
    v_cvt_pk_bf16_f32 v59, v118, v119
    v_mfma_f32_16x16x32_bf16 v[128:131], a[160:163], v[48:51], v[128:131]
    v_exp_f32 v120, v120
    v_mfma_f32_16x16x32_bf16 v[160:163], a[160:163], v[52:55], v[160:163]
    s_waitcnt lgkmcnt(4)
    v_add_f32 v80, 0, v22
    v_min_f32 v80, v80, v72
    v_mfma_f32_16x16x32_bf16 v[132:135], a[164:167], v[48:51], v[132:135]
    v_exp_f32 v121, v121
    v_mfma_f32_16x16x32_bf16 v[164:167], a[164:167], v[52:55], v[164:167]
    s_waitcnt lgkmcnt(3)
    ds_read_b128 a[184:187], v20 offset:22528
    v_cvt_pk_bf16_f32 v60, v120, v121
    v_mfma_f32_16x16x32_bf16 v[136:139], a[168:171], v[48:51], v[136:139]
    v_exp_f32 v122, v122
    v_mfma_f32_16x16x32_bf16 v[168:171], a[168:171], v[52:55], v[168:171]
    s_waitcnt lgkmcnt(3)
    v_add_f32 v81, 0xf1800000, v22
    v_min_f32 v81, v81, v73
    v_mfma_f32_16x16x32_bf16 v[140:143], a[172:175], v[48:51], v[140:143]
    v_exp_f32 v123, v123
    v_mfma_f32_16x16x32_bf16 v[172:175], a[172:175], v[52:55], v[172:175]
    s_waitcnt lgkmcnt(2)
    ds_read_b128 a[188:191], v20 offset:23552
    v_cvt_pk_bf16_f32 v61, v122, v123
    v_mfma_f32_16x16x32_bf16 v[144:147], a[176:179], v[48:51], v[144:147]
    v_exp_f32 v124, v124
    v_mfma_f32_16x16x32_bf16 v[176:179], a[176:179], v[52:55], v[176:179]
    s_waitcnt lgkmcnt(2)
    v_add_f32 v82, 0xf2000000, v22
    v_min_f32 v82, v82, v74
    v_mfma_f32_16x16x32_bf16 v[148:151], a[180:183], v[48:51], v[148:151]
    v_exp_f32 v125, v125
    v_mfma_f32_16x16x32_bf16 v[180:183], a[180:183], v[52:55], v[180:183]
    s_waitcnt lgkmcnt(1)
    v_cvt_pk_bf16_f32 v62, v124, v125
    v_xor_b32 v19, 98304, v19
    v_mfma_f32_16x16x32_bf16 v[152:155], a[184:187], v[48:51], v[152:155]
    v_exp_f32 v126, v126
    v_mfma_f32_16x16x32_bf16 v[184:187], a[184:187], v[52:55], v[184:187]
    s_waitcnt lgkmcnt(0)
    v_xor_b32 v20, 98304, v20
    v_add_f32 v83, 0xf2400000, v22
    v_mfma_f32_16x16x32_bf16 v[156:159], a[188:191], v[48:51], v[156:159]
    v_exp_f32 v127, v127
    v_mfma_f32_16x16x32_bf16 v[188:191], a[188:191], v[52:55], v[188:191]
    v_cvt_pk_bf16_f32 v63, v126, v127
    v_min_f32 v83, v83, v75
    v_add_f32 v84, 0xf3800000, v22
    v_min_f32 v84, v84, v72
    v_mfma_f32_16x16x32_bf16 v[112:115], a[128:131], a[96:99], v[72:75]
    v_exp_f32 v96, v96
    v_mfma_f32_16x16x32_bf16 v[112:115], a[132:135], a[100:103], v[112:115]
    v_mfma_f32_16x16x32_bf16 v[112:115], a[136:139], a[104:107], v[112:115]
    v_exp_f32 v97, v97
    v_mfma_f32_16x16x32_bf16 v[112:115], a[140:143], a[108:111], v[112:115]
    v_cvt_pk_bf16_f32 v48, v96, v97
    v_add_f32 v85, 0xf3880000, v22
    v_mfma_f32_16x16x32_bf16 v[120:123], a[128:131], a[112:115], v[76:79]
    v_exp_f32 v98, v98
    v_mfma_f32_16x16x32_bf16 v[120:123], a[132:135], a[116:119], v[120:123]
    v_min_f32 v85, v85, v73
    v_add_f32 v86, 0xf3900000, v22
    v_mfma_f32_16x16x32_bf16 v[120:123], a[136:139], a[120:123], v[120:123]
    v_exp_f32 v99, v99
    v_mfma_f32_16x16x32_bf16 v[120:123], a[140:143], a[124:127], v[120:123]
    v_min_f32 v86, v86, v74
    v_add_f32 v87, 0xf3980000, v22
    v_mfma_f32_16x16x32_bf16 v[116:119], a[144:147], a[96:99], v[72:75]
    v_exp_f32 v100, v100
    v_mfma_f32_16x16x32_bf16 v[116:119], a[148:151], a[100:103], v[116:119]
    ds_read_b128 a[128:131], v18 offset:16384
    v_cvt_pk_bf16_f32 v49, v98, v99
    v_mfma_f32_16x16x32_bf16 v[116:119], a[152:155], a[104:107], v[116:119]
    s_add_u32 s19, s82, 32768
    v_exp_f32 v101, v101
    v_mfma_f32_16x16x32_bf16 v[116:119], a[156:159], a[108:111], v[116:119]
    s_sub_u32 s82, s12, s13
    ds_read_b128 a[132:135], v18 offset:17408
    v_cvt_pk_bf16_f32 v50, v100, v101
    v_mfma_f32_16x16x32_bf16 v[124:127], a[144:147], a[112:115], v[76:79]
    s_sub_u32 s82, s82, 1
    v_exp_f32 v102, v102
    v_mfma_f32_16x16x32_bf16 v[124:127], a[148:151], a[116:119], v[124:127]
    s_cmp_gt_u32 s12, s13
    s_cselect_b32 s82, s82, s12
    s_lshl_b32 s82, s82, 16
    ds_read_b128 a[136:139], v18 offset:18432
    v_mfma_f32_16x16x32_bf16 v[124:127], a[152:155], a[120:123], v[124:127]
    s_add_u32 s82, s82, s81
    v_exp_f32 v103, v103
    v_mfma_f32_16x16x32_bf16 v[124:127], a[156:159], a[124:127], v[124:127]
    s_cmp_ge_u32 s12, 17
    s_cselect_b32 s82, 2147471360, s82
    ds_read_b128 a[140:143], v18 offset:19456
    v_cvt_pk_bf16_f32 v51, v102, v103
    v_mfma_f32_16x16x32_bf16 v[40:43], v[28:31], v[56:59], v[40:43]
    s_add_u32 s12, s12, 1
    v_exp_f32 v104, v104
    v_mfma_f32_16x16x32_bf16 v[44:47], v[28:31], v[60:63], v[44:47]
    ds_read_b128 a[144:147], v18 offset:20480
    v_min_f32 v87, v87, v75
    v_mfma_f32_16x16x32_bf16 v[192:195], a[160:163], v[56:59], v[192:195]
    v_exp_f32 v105, v105
    v_mfma_f32_16x16x32_bf16 v[224:227], a[160:163], v[60:63], v[224:227]
    ds_read_b128 a[148:151], v18 offset:21504
    v_cvt_pk_bf16_f32 v52, v104, v105
    v_mfma_f32_16x16x32_bf16 v[196:199], a[164:167], v[56:59], v[196:199]
    v_exp_f32 v106, v106
    v_mfma_f32_16x16x32_bf16 v[228:231], a[164:167], v[60:63], v[228:231]
    ds_read_b128 a[152:155], v18 offset:22528
    v_add_f32 v88, 0x73800000, v22
    v_mfma_f32_16x16x32_bf16 v[200:203], a[168:171], v[56:59], v[200:203]
    v_exp_f32 v107, v107
    v_mfma_f32_16x16x32_bf16 v[232:235], a[168:171], v[60:63], v[232:235]
    ds_read_b128 a[156:159], v18 offset:23552
    v_cvt_pk_bf16_f32 v53, v106, v107
    v_mfma_f32_16x16x32_bf16 v[204:207], a[172:175], v[56:59], v[204:207]
    v_exp_f32 v108, v108
    v_mfma_f32_16x16x32_bf16 v[236:239], a[172:175], v[60:63], v[236:239]
    v_min_f32 v88, v88, v76
    v_add_f32 v89, 0x73700000, v22
    v_mfma_f32_16x16x32_bf16 v[208:211], a[176:179], v[56:59], v[208:211]
    v_exp_f32 v109, v109
    v_mfma_f32_16x16x32_bf16 v[240:243], a[176:179], v[60:63], v[240:243]
    v_cvt_pk_bf16_f32 v54, v108, v109
    v_xor_b32 v18, 196608, v18
    v_mfma_f32_16x16x32_bf16 v[212:215], a[180:183], v[56:59], v[212:215]
    v_exp_f32 v110, v110
    v_mfma_f32_16x16x32_bf16 v[244:247], a[180:183], v[60:63], v[244:247]
    v_min_f32 v89, v89, v77
    v_add_f32 v90, 0x73600000, v22
    v_mfma_f32_16x16x32_bf16 v[216:219], a[184:187], v[56:59], v[216:219]
    v_exp_f32 v111, v111
    v_mfma_f32_16x16x32_bf16 v[248:251], a[184:187], v[60:63], v[248:251]
    v_cvt_pk_bf16_f32 v55, v110, v111
    v_min_f32 v90, v90, v78
    v_mfma_f32_16x16x32_bf16 v[220:223], a[188:191], v[56:59], v[220:223]
    v_add_f32 v91, 0x73500000, v22
    v_min_f32 v91, v91, v79
    v_mfma_f32_16x16x32_bf16 v[252:255], a[188:191], v[60:63], v[252:255]
    v_add_f32 v92, 0, v22
    v_min_f32 v92, v92, v76
    v_add_f32 v93, 0xf1800000, v22
    v_min_f32 v93, v93, v77
    v_add_f32 v94, 0xf2000000, v22
    v_min_f32 v94, v94, v78
    v_add_f32 v95, 0xf2400000, v22
    v_min_f32 v95, v95, v79
    s_waitcnt vmcnt(0) lgkmcnt(0)
    s_barrier
    v_mfma_f32_16x16x32_bf16 v[96:99], a[128:131], a[96:99], v[80:83]
    s_xor_b32 s100, s16, 8192
    ds_read_b128 a[176:179], v20 offset:4096
    v_lshrrev_b32 v13, 1, v1
    v_mfma_f32_16x16x32_bf16 v[96:99], a[132:135], a[100:103], v[96:99]
    s_add_u32 m0, s15, 0
    ds_read_b128 a[180:183], v20 offset:5120
    v_add_u32 v12, s100, v13
    v_mfma_f32_16x16x32_bf16 v[96:99], a[136:139], a[104:107], v[96:99]
    buffer_load_dwordx4 v1, s[8:11], s82 offen offset:0 lds
    v_exp_f32 v112, v112
    v_mfma_f32_16x16x32_bf16 v[96:99], a[140:143], a[108:111], v[96:99]
    v_exp_f32 v113, v113
    v_mfma_f32_16x16x32_bf16 v[100:103], a[144:147], a[96:99], v[84:87]
    ds_read_b128 a[184:187], v20 offset:6144
    v_cvt_pk_bf16_f32 v56, v112, v113
    v_mfma_f32_16x16x32_bf16 v[100:103], a[148:151], a[100:103], v[100:103]
    v_exp_f32 v114, v114
    v_mfma_f32_16x16x32_bf16 v[100:103], a[152:155], a[104:107], v[100:103]
    buffer_load_dwordx4 v1, s[8:11], s82 offen offset:1024 lds
    v_exp_f32 v115, v115
    v_mfma_f32_16x16x32_bf16 v[100:103], a[156:159], a[108:111], v[100:103]
    ds_read_b128 a[188:191], v20 offset:7168
    v_cvt_pk_bf16_f32 v57, v114, v115
    v_mfma_f32_16x16x32_bf16 v[104:107], a[128:131], a[112:115], v[88:91]
    v_exp_f32 v116, v116
    v_mfma_f32_16x16x32_bf16 v[104:107], a[132:135], a[116:119], v[104:107]
    v_exp_f32 v117, v117
    v_mfma_f32_16x16x32_bf16 v[104:107], a[136:139], a[120:123], v[104:107]
    ds_read_b128 a[160:163], v19 offset:0
    v_cvt_pk_bf16_f32 v58, v116, v117
    v_mfma_f32_16x16x32_bf16 v[104:107], a[140:143], a[124:127], v[104:107]
    buffer_load_dwordx4 v1, s[8:11], s82 offen offset:2048 lds
    v_exp_f32 v118, v118
    v_mfma_f32_16x16x32_bf16 v[108:111], a[144:147], a[112:115], v[92:95]
    v_exp_f32 v119, v119
    v_mfma_f32_16x16x32_bf16 v[108:111], a[148:151], a[116:119], v[108:111]
    ds_read_b128 a[164:167], v19 offset:1024
    v_cvt_pk_bf16_f32 v59, v118, v119
    v_mfma_f32_16x16x32_bf16 v[108:111], a[152:155], a[120:123], v[108:111]
    v_exp_f32 v120, v120
    v_mfma_f32_16x16x32_bf16 v[108:111], a[156:159], a[124:127], v[108:111]
    buffer_load_dwordx4 v1, s[8:11], s82 offen offset:3072 lds
    v_exp_f32 v121, v121
    v_mfma_f32_16x16x32_bf16 v[32:35], v[28:31], v[48:51], v[32:35]
    s_add_u32 m0, s15, 4096
    ds_read_b128 a[168:171], v19 offset:2048
    v_cvt_pk_bf16_f32 v60, v120, v121
    v_mfma_f32_16x16x32_bf16 v[36:39], v[28:31], v[52:55], v[36:39]
    s_waitcnt lgkmcnt(6)
    v_exp_f32 v122, v122
    v_mfma_f32_16x16x32_bf16 v[144:147], a[176:179], v[48:51], v[144:147]
    v_exp_f32 v123, v123
    v_mfma_f32_16x16x32_bf16 v[176:179], a[176:179], v[52:55], v[176:179]
    s_waitcnt lgkmcnt(5)
    ds_read_b128 a[172:175], v19 offset:3072
    v_cvt_pk_bf16_f32 v61, v122, v123
    v_mfma_f32_16x16x32_bf16 v[148:151], a[180:183], v[48:51], v[148:151]
    buffer_load_dwordx4 v15, s[8:11], s82 offen offset:0 lds
    v_exp_f32 v124, v124
    v_mfma_f32_16x16x32_bf16 v[180:183], a[180:183], v[52:55], v[180:183]
    s_waitcnt lgkmcnt(5)
    v_exp_f32 v125, v125
    v_mfma_f32_16x16x32_bf16 v[152:155], a[184:187], v[48:51], v[152:155]
    s_waitcnt lgkmcnt(4)
    v_exp_f32 v126, v126
    v_mfma_f32_16x16x32_bf16 v[184:187], a[184:187], v[52:55], v[184:187]
    buffer_load_dwordx4 v15, s[8:11], s82 offen offset:1024 lds
    v_exp_f32 v127, v127
    v_mfma_f32_16x16x32_bf16 v[156:159], a[188:191], v[48:51], v[156:159]
    ds_write_b128 v16, v[144:147] offset:32768
    v_cvt_pk_bf16_f32 v62, v124, v125
    v_mfma_f32_16x16x32_bf16 v[188:191], a[188:191], v[52:55], v[188:191]
    s_waitcnt lgkmcnt(4)
    v_exp_f32 v96, v96
    v_mfma_f32_16x16x32_bf16 v[128:131], a[160:163], v[48:51], v[128:131]
    v_exp_f32 v97, v97
    v_mfma_f32_16x16x32_bf16 v[160:163], a[160:163], v[52:55], v[160:163]
    s_waitcnt lgkmcnt(3)
    ds_write_b128 v16, v[176:179] offset:33792
    v_cvt_pk_bf16_f32 v63, v126, v127
    v_mfma_f32_16x16x32_bf16 v[132:135], a[164:167], v[48:51], v[132:135]
    s_waitcnt lgkmcnt(3)
    v_exp_f32 v98, v98
    v_mfma_f32_16x16x32_bf16 v[164:167], a[164:167], v[52:55], v[164:167]
    buffer_load_dwordx4 v15, s[8:11], s82 offen offset:2048 lds
    v_exp_f32 v99, v99
    v_mfma_f32_16x16x32_bf16 v[136:139], a[168:171], v[48:51], v[136:139]
    ds_write_b128 v16, v[148:151] offset:34816
    v_mfma_f32_16x16x32_bf16 v[168:171], a[168:171], v[52:55], v[168:171]
    s_waitcnt lgkmcnt(3)
    v_exp_f32 v100, v100
    v_mfma_f32_16x16x32_bf16 v[140:143], a[172:175], v[48:51], v[140:143]
    v_exp_f32 v101, v101
    v_mfma_f32_16x16x32_bf16 v[172:175], a[172:175], v[52:55], v[172:175]
    ds_write_b128 v16, v[180:183] offset:35840
    v_mov_b32 v33, v36
    v_mfma_f32_16x16x32_bf16 v[40:43], v[28:31], v[56:59], v[40:43]
    buffer_load_dwordx4 v15, s[8:11], s82 offen offset:3072 lds
    v_exp_f32 v102, v102
    v_mfma_f32_16x16x32_bf16 v[44:47], v[28:31], v[60:63], v[44:47]
    s_xor_b32 s15, s15, 196608
    v_exp_f32 v103, v103
    v_mfma_f32_16x16x32_bf16 v[208:211], a[176:179], v[56:59], v[208:211]
    ds_write_b128 v16, v[152:155] offset:36864
    v_cvt_pk_bf16_f32 v48, v96, v97
    v_mfma_f32_16x16x32_bf16 v[240:243], a[176:179], v[60:63], v[240:243]
    ds_read_b128 a[176:179], v20 offset:20480
    v_exp_f32 v104, v104
    v_mfma_f32_16x16x32_bf16 v[212:215], a[180:183], v[56:59], v[212:215]
    v_exp_f32 v105, v105
    v_mfma_f32_16x16x32_bf16 v[244:247], a[180:183], v[60:63], v[244:247]
    ds_read_b128 a[180:183], v20 offset:21504
    v_exp_f32 v106, v106
    v_mfma_f32_16x16x32_bf16 v[216:219], a[184:187], v[56:59], v[216:219]
    ds_write_b128 v16, v[184:187] offset:37888
    v_cvt_pk_bf16_f32 v49, v98, v99
    v_mfma_f32_16x16x32_bf16 v[248:251], a[184:187], v[60:63], v[248:251]
    ds_read_b128 a[184:187], v20 offset:22528
    v_exp_f32 v107, v107
    v_mfma_f32_16x16x32_bf16 v[220:223], a[188:191], v[56:59], v[220:223]
    v_exp_f32 v108, v108
    v_mfma_f32_16x16x32_bf16 v[252:255], a[188:191], v[60:63], v[252:255]
    ds_read_b128 a[188:191], v20 offset:23552
    v_exp_f32 v109, v109
    v_mfma_f32_16x16x32_bf16 v[192:195], a[160:163], v[56:59], v[192:195]
    ds_write_b128 v16, v[156:159] offset:38912
    v_cvt_pk_bf16_f32 v50, v100, v101
    v_mfma_f32_16x16x32_bf16 v[224:227], a[160:163], v[60:63], v[224:227]
    ds_read_b128 a[160:163], v19 offset:16384
    v_exp_f32 v110, v110
    v_mfma_f32_16x16x32_bf16 v[196:199], a[164:167], v[56:59], v[196:199]
    v_exp_f32 v111, v111
    v_mfma_f32_16x16x32_bf16 v[228:231], a[164:167], v[60:63], v[228:231]
    ds_read_b128 a[164:167], v19 offset:17408
    v_cvt_pk_bf16_f32 v51, v102, v103
    v_mfma_f32_16x16x32_bf16 v[200:203], a[168:171], v[56:59], v[200:203]
    ds_write_b128 v16, v[188:191] offset:39936
    v_cvt_pk_bf16_f32 v52, v104, v105
    v_mfma_f32_16x16x32_bf16 v[232:235], a[168:171], v[60:63], v[232:235]
    ds_read_b128 a[168:171], v19 offset:18432
    v_cvt_pk_bf16_f32 v53, v106, v107
    v_mfma_f32_16x16x32_bf16 v[204:207], a[172:175], v[56:59], v[204:207]
    v_cvt_pk_bf16_f32 v54, v108, v109
    v_cvt_pk_bf16_f32 v55, v110, v111
    v_mfma_f32_16x16x32_bf16 v[236:239], a[172:175], v[60:63], v[236:239]
    ds_read_b128 a[172:175], v19 offset:19456
    ds_write_b64 v12, v[32:33]
    s_xor_b32 s101, s16, 98304
    v_xor_b32 v12, 8192, v12
    v_add_u32 v9, s101, v1
    v_xor_b32 v8, 8192, v16
    v_xor_b32 v10, 8192, v9
L_t1_join:
    v_xor_b32 v19, 98304, v19
    v_xor_b32 v20, 98304, v20
    s_waitcnt lgkmcnt(0)
    s_barrier
    v_mfma_f32_16x16x32_bf16 v[40:43], v[28:31], v[48:51], v[40:43]
    s_lshl_b32 s100, s60, 20
    s_add_u32 s101, s100, s21
    ds_read_b64 v[120:121], v12
    v_mfma_f32_16x16x32_bf16 v[44:47], v[28:31], v[52:55], v[44:47]
    s_add_u32 s100, s100, s20
    ds_read_b128 v[144:147], v8 offset:32768
    v_lshrrev_b32 v11, 4, v2
    v_mfma_f32_16x16x32_bf16 v[208:211], a[176:179], v[48:51], v[208:211]
    ds_read_b128 v[176:179], v8 offset:33792
    v_lshrrev_b32 v13, 2, v1
    v_mfma_f32_16x16x32_bf16 v[240:243], a[176:179], v[52:55], v[240:243]
    ds_read_b128 v[148:151], v8 offset:34816
    v_add_u32 v13, 32768, v13
    v_mfma_f32_16x16x32_bf16 v[212:215], a[180:183], v[48:51], v[212:215]
    s_xor_b32 s99, s62, 8192
    ds_read_b128 v[180:183], v8 offset:35840
    v_add_u32 v14, s99, v13
    v_mfma_f32_16x16x32_bf16 v[244:247], a[180:183], v[52:55], v[244:247]
    ds_read_b128 v[152:155], v8 offset:36864
    v_cmp_eq_u32 vcc, 1, v11
    v_mfma_f32_16x16x32_bf16 v[216:219], a[184:187], v[48:51], v[216:219]
    ds_read_b128 v[184:187], v8 offset:37888
    s_waitcnt lgkmcnt(6)
    v_add_f32 v112, v120, v32
    v_mfma_f32_16x16x32_bf16 v[248:251], a[184:187], v[52:55], v[248:251]
    ds_read_b128 v[156:159], v8 offset:38912
    v_add_f32 v114, v121, v36
    v_mfma_f32_16x16x32_bf16 v[220:223], a[188:191], v[48:51], v[220:223]
    ds_read_b128 v[188:191], v8 offset:39936
    v_cndmask_b32 v12, v32, v36, vcc
    v_mfma_f32_16x16x32_bf16 v[252:255], a[188:191], v[52:55], v[252:255]
    v_rcp_f32 v112, v112
    v_mfma_f32_16x16x32_bf16 v[192:195], a[160:163], v[48:51], v[192:195]
    v_rcp_f32 v114, v114
    v_mfma_f32_16x16x32_bf16 v[224:227], a[160:163], v[52:55], v[224:227]
    v_cmp_eq_u32 vcc, 2, v11
    v_cmp_eq_u32 s[96:97], 3, v11
    v_mfma_f32_16x16x32_bf16 v[196:199], a[164:167], v[48:51], v[196:199]
    ds_write_b128 v9, v[208:211] offset:0
    v_mfma_f32_16x16x32_bf16 v[228:231], a[164:167], v[52:55], v[228:231]
    v_mfma_f32_16x16x32_bf16 v[200:203], a[168:171], v[48:51], v[200:203]
    ds_write_b128 v9, v[240:243] offset:1024
    v_mfma_f32_16x16x32_bf16 v[232:235], a[168:171], v[52:55], v[232:235]
    v_mfma_f32_16x16x32_bf16 v[204:207], a[172:175], v[48:51], v[204:207]
    ds_write_b128 v9, v[212:215] offset:2048
    v_mfma_f32_16x16x32_bf16 v[236:239], a[172:175], v[52:55], v[236:239]
    v_cndmask_b32 v12, v12, v40, vcc
    v_cndmask_b32 v12, v12, v44, s[96:97]
    ds_write_b128 v9, v[244:247] offset:3072
    s_waitcnt lgkmcnt(11)
    v_pk_add_f32 v[128:129], v[128:129], v[144:145]
    v_pk_add_f32 v[130:131], v[130:131], v[146:147]
    s_waitcnt lgkmcnt(9)
    v_pk_add_f32 v[132:133], v[132:133], v[148:149]
    v_pk_add_f32 v[134:135], v[134:135], v[150:151]
    v_pk_mul_f32 v[128:129], v[128:129], v[112:113] op_sel_hi:[1,0]
    v_pk_mul_f32 v[130:131], v[130:131], v[112:113] op_sel_hi:[1,0]
    v_pk_mul_f32 v[132:133], v[132:133], v[112:113] op_sel_hi:[1,0]
    v_pk_mul_f32 v[134:135], v[134:135], v[112:113] op_sel_hi:[1,0]
    v_cvt_pk_bf16_f32 v128, v128, v129
    v_cvt_pk_bf16_f32 v129, v130, v131
    v_cvt_pk_bf16_f32 v130, v132, v133
    s_add_u32 m0, s16, 0
    ds_write_b128 v9, v[216:219] offset:4096
    v_cvt_pk_bf16_f32 v131, v134, v135
    buffer_store_dwordx4 v[128:131], v1, s[8:11], s100 offen offset:0 sc0 sc1
    s_waitcnt lgkmcnt(8)
    v_pk_add_f32 v[136:137], v[136:137], v[152:153]
    v_pk_add_f32 v[138:139], v[138:139], v[154:155]
    s_waitcnt lgkmcnt(6)
    v_pk_add_f32 v[140:141], v[140:141], v[156:157]
    v_pk_add_f32 v[142:143], v[142:143], v[158:159]
    v_pk_mul_f32 v[136:137], v[136:137], v[112:113] op_sel_hi:[1,0]
    v_pk_mul_f32 v[138:139], v[138:139], v[112:113] op_sel_hi:[1,0]
    v_pk_mul_f32 v[140:141], v[140:141], v[112:113] op_sel_hi:[1,0]
    v_pk_mul_f32 v[142:143], v[142:143], v[112:113] op_sel_hi:[1,0]
    v_cvt_pk_bf16_f32 v136, v136, v137
    buffer_load_dwordx4 v1, s[8:11], s19 offen offset:0 lds
    ds_write_b128 v9, v[248:251] offset:5120
    v_cvt_pk_bf16_f32 v137, v138, v139
    v_cvt_pk_bf16_f32 v138, v140, v141
    v_cvt_pk_bf16_f32 v139, v142, v143
    buffer_store_dwordx4 v[136:139], v1, s[8:11], s100 offen offset:1024 sc0 sc1
    v_pk_add_f32 v[160:161], v[160:161], v[176:177]
    v_pk_add_f32 v[162:163], v[162:163], v[178:179]
    v_pk_add_f32 v[164:165], v[164:165], v[180:181]
    v_pk_add_f32 v[166:167], v[166:167], v[182:183]
    v_pk_mul_f32 v[160:161], v[160:161], v[114:115] op_sel_hi:[1,0]
    v_pk_mul_f32 v[162:163], v[162:163], v[114:115] op_sel_hi:[1,0]
    v_pk_mul_f32 v[164:165], v[164:165], v[114:115] op_sel_hi:[1,0]
    buffer_load_dwordx4 v1, s[8:11], s19 offen offset:1024 lds
    ds_write_b128 v9, v[220:223] offset:6144
    v_pk_mul_f32 v[166:167], v[166:167], v[114:115] op_sel_hi:[1,0]
    v_cvt_pk_bf16_f32 v160, v160, v161
    v_cvt_pk_bf16_f32 v161, v162, v163
    v_cvt_pk_bf16_f32 v162, v164, v165
    v_cvt_pk_bf16_f32 v163, v166, v167
    buffer_store_dwordx4 v[160:163], v15, s[8:11], s100 offen offset:0 sc0 sc1
    v_pk_add_f32 v[168:169], v[168:169], v[184:185]
    v_pk_add_f32 v[170:171], v[170:171], v[186:187]
    s_waitcnt lgkmcnt(7)
    v_pk_add_f32 v[172:173], v[172:173], v[188:189]
    v_pk_add_f32 v[174:175], v[174:175], v[190:191]
    v_pk_mul_f32 v[168:169], v[168:169], v[114:115] op_sel_hi:[1,0]
    buffer_load_dwordx4 v1, s[8:11], s19 offen offset:2048 lds
    ds_write_b128 v9, v[252:255] offset:7168
    v_pk_mul_f32 v[170:171], v[170:171], v[114:115] op_sel_hi:[1,0]
    v_pk_mul_f32 v[172:173], v[172:173], v[114:115] op_sel_hi:[1,0]
    v_pk_mul_f32 v[174:175], v[174:175], v[114:115] op_sel_hi:[1,0]
    v_cvt_pk_bf16_f32 v168, v168, v169
    v_cvt_pk_bf16_f32 v169, v170, v171
    v_cvt_pk_bf16_f32 v170, v172, v173
    v_cvt_pk_bf16_f32 v171, v174, v175
    buffer_store_dwordx4 v[168:171], v15, s[8:11], s100 offen offset:1024 sc0 sc1
    buffer_load_dwordx4 v1, s[8:11], s19 offen offset:3072 lds
    ds_write_b32 v14, v12
    v_and_b32 v14, 4294967103, v13
    v_add_u32 v14, s62, v14
    s_waitcnt lgkmcnt(0)
    s_barrier
    ds_read_b32 v116, v14 offset:128
    ds_read_b32 v118, v14 offset:192
    ds_read_b128 v[208:211], v10 offset:0
    ds_read_b128 v[212:215], v10 offset:2048
    ds_read_b128 v[216:219], v10 offset:4096
    ds_read_b128 v[220:223], v10 offset:6144
    ds_read_b128 v[240:243], v10 offset:1024
    ds_read_b128 v[244:247], v10 offset:3072
    ds_read_b128 v[248:251], v10 offset:5120
    ds_read_b128 v[252:255], v10 offset:7168
    ds_read_b32 v120, v13 offset:0
    ds_read_b32 v121, v13 offset:8192
    ds_read_b32 v122, v13 offset:16384
    ds_read_b32 v123, v13 offset:24576
    s_waitcnt lgkmcnt(13)
    v_add_f32 v116, v116, v40
    s_waitcnt lgkmcnt(12)
    v_add_f32 v118, v118, v44
    v_rcp_f32 v116, v116
    v_rcp_f32 v118, v118
    s_waitcnt lgkmcnt(11)
    v_pk_add_f32 v[192:193], v[192:193], v[208:209]
    v_pk_add_f32 v[194:195], v[194:195], v[210:211]
    s_waitcnt lgkmcnt(10)
    v_pk_add_f32 v[196:197], v[196:197], v[212:213]
    v_pk_add_f32 v[198:199], v[198:199], v[214:215]
    v_pk_mul_f32 v[192:193], v[192:193], v[116:117] op_sel_hi:[1,0]
    v_pk_mul_f32 v[194:195], v[194:195], v[116:117] op_sel_hi:[1,0]
    v_pk_mul_f32 v[196:197], v[196:197], v[116:117] op_sel_hi:[1,0]
    v_pk_mul_f32 v[198:199], v[198:199], v[116:117] op_sel_hi:[1,0]
    v_cvt_pk_bf16_f32 v192, v192, v193
    v_cvt_pk_bf16_f32 v193, v194, v195
    v_cvt_pk_bf16_f32 v194, v196, v197
    v_cvt_pk_bf16_f32 v195, v198, v199
    buffer_store_dwordx4 v[192:195], v1, s[8:11], s101 offen offset:0 sc0 sc1
    s_add_u32 m0, s16, 4096
    s_waitcnt lgkmcnt(9)
    v_pk_add_f32 v[200:201], v[200:201], v[216:217]
    v_pk_add_f32 v[202:203], v[202:203], v[218:219]
    s_waitcnt lgkmcnt(8)
    v_pk_add_f32 v[204:205], v[204:205], v[220:221]
    v_pk_add_f32 v[206:207], v[206:207], v[222:223]
    v_pk_mul_f32 v[200:201], v[200:201], v[116:117] op_sel_hi:[1,0]
    v_pk_mul_f32 v[202:203], v[202:203], v[116:117] op_sel_hi:[1,0]
    v_pk_mul_f32 v[204:205], v[204:205], v[116:117] op_sel_hi:[1,0]
    v_pk_mul_f32 v[206:207], v[206:207], v[116:117] op_sel_hi:[1,0]
    v_cvt_pk_bf16_f32 v200, v200, v201
    v_cvt_pk_bf16_f32 v201, v202, v203
    v_cvt_pk_bf16_f32 v202, v204, v205
    v_cvt_pk_bf16_f32 v203, v206, v207
    buffer_store_dwordx4 v[200:203], v1, s[8:11], s101 offen offset:1024 sc0 sc1
    buffer_load_dwordx4 v15, s[8:11], s19 offen offset:0 lds
    buffer_load_dwordx4 v15, s[8:11], s19 offen offset:1024 lds
    s_waitcnt lgkmcnt(2)
    v_add_f32 v120, v120, v121
    s_waitcnt lgkmcnt(0)
    v_add_f32 v122, v122, v123
    v_min_f32 v124, v120, v122
    v_add_f32 v120, v120, v122
    v_cmp_le_f32 vcc, 0x1f800000, v124
    s_mov_b64 s[96:97], vcc
    v_cmp_ge_f32 vcc, 0x67800000, v120
    s_and_b64 s[96:97], s[96:97], vcc
    s_cmp_eq_u64 s[96:97], -1
    s_cselect_b32 s96, s25, 1
    s_cmp_lg_u32 s96, 0
    s_cbranch_scc1 L_t1_redo
L_t1_safe:
    v_pk_add_f32 v[224:225], v[224:225], v[240:241]
    v_pk_add_f32 v[226:227], v[226:227], v[242:243]
    v_pk_add_f32 v[228:229], v[228:229], v[244:245]
    v_pk_add_f32 v[230:231], v[230:231], v[246:247]
    v_pk_mul_f32 v[224:225], v[224:225], v[118:119] op_sel_hi:[1,0]
    v_pk_mul_f32 v[226:227], v[226:227], v[118:119] op_sel_hi:[1,0]
    v_pk_mul_f32 v[228:229], v[228:229], v[118:119] op_sel_hi:[1,0]
    v_pk_mul_f32 v[230:231], v[230:231], v[118:119] op_sel_hi:[1,0]
    v_cvt_pk_bf16_f32 v224, v224, v225
    v_cvt_pk_bf16_f32 v225, v226, v227
    v_cvt_pk_bf16_f32 v226, v228, v229
    v_cvt_pk_bf16_f32 v227, v230, v231
    buffer_store_dwordx4 v[224:227], v15, s[8:11], s101 offen offset:0 sc0 sc1
    buffer_load_dwordx4 v15, s[8:11], s19 offen offset:2048 lds
    ds_read_b128 a[128:131], v18 offset:0
    ds_read_b128 a[132:135], v18 offset:1024
    ds_read_b128 a[136:139], v18 offset:2048
    ds_read_b128 a[140:143], v18 offset:3072
    v_pk_add_f32 v[232:233], v[232:233], v[248:249]
    v_pk_add_f32 v[234:235], v[234:235], v[250:251]
    v_pk_add_f32 v[236:237], v[236:237], v[252:253]
    v_pk_add_f32 v[238:239], v[238:239], v[254:255]
    v_pk_mul_f32 v[232:233], v[232:233], v[118:119] op_sel_hi:[1,0]
    v_pk_mul_f32 v[234:235], v[234:235], v[118:119] op_sel_hi:[1,0]
    v_pk_mul_f32 v[236:237], v[236:237], v[118:119] op_sel_hi:[1,0]
    v_pk_mul_f32 v[238:239], v[238:239], v[118:119] op_sel_hi:[1,0]
    v_cvt_pk_bf16_f32 v232, v232, v233
    v_cvt_pk_bf16_f32 v233, v234, v235
    v_cvt_pk_bf16_f32 v234, v236, v237
    v_cvt_pk_bf16_f32 v235, v238, v239
    buffer_store_dwordx4 v[232:235], v15, s[8:11], s101 offen offset:1024 sc0 sc1
    buffer_load_dwordx4 v15, s[8:11], s19 offen offset:3072 lds
    s_xor_b32 s16, s16, 98304
    ds_read_b128 a[144:147], v18 offset:4096
    ds_read_b128 a[148:151], v18 offset:5120
    ds_read_b128 a[152:155], v18 offset:6144
    ds_read_b128 a[156:159], v18 offset:7168
L_t2_start:
    s_waitcnt lgkmcnt(7)
    v_mfma_f32_16x16x32_bf16 v[96:99], a[128:131], a[192:195], v[64:67]
    s_waitcnt lgkmcnt(6)
    s_add_u32 s19, s82, 32768
    s_sub_u32 s82, s12, s13
    s_sub_u32 s82, s82, 1
    v_mfma_f32_16x16x32_bf16 v[96:99], a[132:135], a[196:199], v[96:99]
    s_waitcnt lgkmcnt(5)
    s_cmp_gt_u32 s12, s13
    s_cselect_b32 s82, s82, s12
    s_lshl_b32 s82, s82, 16
    s_add_u32 s82, s82, s81
    v_mfma_f32_16x16x32_bf16 v[96:99], a[136:139], a[200:203], v[96:99]
    s_waitcnt lgkmcnt(4)
    s_cmp_ge_u32 s12, 17
    s_cselect_b32 s82, 2147471360, s82
    s_add_u32 s12, s12, 1
    s_sub_u32 s14, s61, 8
    v_mfma_f32_16x16x32_bf16 v[96:99], a[140:143], a[204:207], v[96:99]
    s_waitcnt lgkmcnt(3)
    v_mfma_f32_16x16x32_bf16 v[100:103], a[144:147], a[192:195], v[64:67]
    s_waitcnt lgkmcnt(2)
    v_mfma_f32_16x16x32_bf16 v[100:103], a[148:151], a[196:199], v[100:103]
    s_waitcnt lgkmcnt(1)
    v_mfma_f32_16x16x32_bf16 v[100:103], a[152:155], a[200:203], v[100:103]
    s_waitcnt lgkmcnt(0)
    v_mfma_f32_16x16x32_bf16 v[100:103], a[156:159], a[204:207], v[100:103]
    v_mfma_f32_16x16x32_bf16 v[104:107], a[128:131], a[208:211], v[68:71]
    v_exp_f32 v96, v96
    v_mfma_f32_16x16x32_bf16 v[104:107], a[132:135], a[212:215], v[104:107]
    v_exp_f32 v97, v97
    v_mfma_f32_16x16x32_bf16 v[104:107], a[136:139], a[216:219], v[104:107]
    v_exp_f32 v98, v98
    v_mfma_f32_16x16x32_bf16 v[104:107], a[140:143], a[220:223], v[104:107]
    v_exp_f32 v99, v99
    v_mfma_f32_16x16x32_bf16 v[108:111], a[144:147], a[208:211], v[68:71]
    v_exp_f32 v100, v100
    v_mfma_f32_16x16x32_bf16 v[108:111], a[148:151], a[212:215], v[108:111]
    v_exp_f32 v101, v101
    v_mfma_f32_16x16x32_bf16 v[108:111], a[152:155], a[216:219], v[108:111]
    v_exp_f32 v102, v102
    v_mfma_f32_16x16x32_bf16 v[108:111], a[156:159], a[220:223], v[108:111]
    v_exp_f32 v103, v103
    v_mfma_f32_16x16x32_bf16 v[112:115], a[128:131], a[224:227], v[72:75]
    v_exp_f32 v104, v104
    v_mfma_f32_16x16x32_bf16 v[112:115], a[132:135], a[228:231], v[112:115]
    v_exp_f32 v105, v105
    v_mfma_f32_16x16x32_bf16 v[112:115], a[136:139], a[232:235], v[112:115]
    v_exp_f32 v106, v106
    v_mfma_f32_16x16x32_bf16 v[112:115], a[140:143], a[236:239], v[112:115]
    v_exp_f32 v107, v107
    v_mfma_f32_16x16x32_bf16 v[120:123], a[128:131], a[240:243], v[76:79]
    v_exp_f32 v108, v108
    v_mfma_f32_16x16x32_bf16 v[120:123], a[132:135], a[244:247], v[120:123]
    v_exp_f32 v109, v109
    v_mfma_f32_16x16x32_bf16 v[120:123], a[136:139], a[248:251], v[120:123]
    v_exp_f32 v110, v110
    v_mfma_f32_16x16x32_bf16 v[120:123], a[140:143], a[252:255], v[120:123]
    v_exp_f32 v111, v111
    v_mfma_f32_16x16x32_bf16 v[116:119], a[144:147], a[224:227], v[72:75]
    ds_read_b128 a[128:131], v18 offset:16384
    v_cvt_pk_bf16_f32 v48, v96, v97
    v_mfma_f32_16x16x32_bf16 v[116:119], a[148:151], a[228:231], v[116:119]
    ds_read_b128 a[132:135], v18 offset:17408
    v_cvt_pk_bf16_f32 v49, v98, v99
    v_mfma_f32_16x16x32_bf16 v[116:119], a[152:155], a[232:235], v[116:119]
    ds_read_b128 a[136:139], v18 offset:18432
    v_cvt_pk_bf16_f32 v50, v100, v101
    v_mfma_f32_16x16x32_bf16 v[116:119], a[156:159], a[236:239], v[116:119]
    ds_read_b128 a[140:143], v18 offset:19456
    v_cvt_pk_bf16_f32 v51, v102, v103
    v_mfma_f32_16x16x32_bf16 v[124:127], a[144:147], a[240:243], v[76:79]
    ds_read_b128 a[144:147], v18 offset:20480
    v_cvt_pk_bf16_f32 v52, v104, v105
    v_mfma_f32_16x16x32_bf16 v[124:127], a[148:151], a[244:247], v[124:127]
    ds_read_b128 a[148:151], v18 offset:21504
    v_cvt_pk_bf16_f32 v53, v106, v107
    v_mfma_f32_16x16x32_bf16 v[124:127], a[152:155], a[248:251], v[124:127]
    ds_read_b128 a[152:155], v18 offset:22528
    v_cvt_pk_bf16_f32 v54, v108, v109
    v_mfma_f32_16x16x32_bf16 v[124:127], a[156:159], a[252:255], v[124:127]
    ds_read_b128 a[156:159], v18 offset:23552
    v_cvt_pk_bf16_f32 v55, v110, v111
    v_xor_b32 v18, 196608, v18
    s_waitcnt vmcnt(0) lgkmcnt(0)
    s_barrier
    v_mfma_f32_16x16x32_bf16 v[96:99], a[128:131], a[192:195], v[64:67]
    s_add_u32 m0, s15, 0
    ds_read_b128 a[160:163], v19 offset:0
    v_mfma_f32_16x16x32_bf16 v[96:99], a[132:135], a[196:199], v[96:99]
    ds_read_b128 a[164:167], v19 offset:1024
    v_mfma_f32_16x16x32_bf16 v[96:99], a[136:139], a[200:203], v[96:99]
    v_exp_f32 v112, v112
    v_mfma_f32_16x16x32_bf16 v[96:99], a[140:143], a[204:207], v[96:99]
    buffer_load_dwordx4 v1, s[8:11], s82 offen offset:0 lds
    v_mfma_f32_16x16x32_bf16 v[104:107], a[128:131], a[208:211], v[68:71]
    v_exp_f32 v113, v113
    v_mfma_f32_16x16x32_bf16 v[104:107], a[132:135], a[212:215], v[104:107]
    ds_read_b128 a[168:171], v19 offset:2048
    v_cvt_pk_bf16_f32 v56, v112, v113
    v_mfma_f32_16x16x32_bf16 v[104:107], a[136:139], a[216:219], v[104:107]
    v_exp_f32 v114, v114
    v_mfma_f32_16x16x32_bf16 v[104:107], a[140:143], a[220:223], v[104:107]
    buffer_load_dwordx4 v1, s[8:11], s82 offen offset:1024 lds
    v_mfma_f32_16x16x32_bf16 v[100:103], a[144:147], a[192:195], v[64:67]
    v_exp_f32 v115, v115
    v_mfma_f32_16x16x32_bf16 v[100:103], a[148:151], a[196:199], v[100:103]
    ds_read_b128 a[172:175], v19 offset:3072
    v_cvt_pk_bf16_f32 v57, v114, v115
    v_mfma_f32_16x16x32_bf16 v[100:103], a[152:155], a[200:203], v[100:103]
    v_exp_f32 v116, v116
    v_mfma_f32_16x16x32_bf16 v[100:103], a[156:159], a[204:207], v[100:103]
    buffer_load_dwordx4 v1, s[8:11], s82 offen offset:2048 lds
    v_mfma_f32_16x16x32_bf16 v[108:111], a[144:147], a[208:211], v[68:71]
    v_exp_f32 v117, v117
    v_mfma_f32_16x16x32_bf16 v[108:111], a[148:151], a[212:215], v[108:111]
    ds_read_b128 a[176:179], v20 offset:4096
    v_cvt_pk_bf16_f32 v58, v116, v117
    v_mfma_f32_16x16x32_bf16 v[108:111], a[152:155], a[216:219], v[108:111]
    v_exp_f32 v118, v118
    v_mfma_f32_16x16x32_bf16 v[108:111], a[156:159], a[220:223], v[108:111]
    buffer_load_dwordx4 v1, s[8:11], s82 offen offset:3072 lds
    v_mfma_f32_16x16x32_bf16 v[32:35], v[28:31], v[48:51], 0
    s_add_u32 m0, s15, 4096
    v_exp_f32 v119, v119
    v_mfma_f32_16x16x32_bf16 v[36:39], v[28:31], v[52:55], 0
    s_waitcnt lgkmcnt(4)
    ds_read_b128 a[180:183], v20 offset:5120
    v_cvt_pk_bf16_f32 v59, v118, v119
    v_mfma_f32_16x16x32_bf16 v[128:131], a[160:163], v[48:51], 0
    v_exp_f32 v120, v120
    v_mfma_f32_16x16x32_bf16 v[160:163], a[160:163], v[52:55], 0
    s_waitcnt lgkmcnt(4)
    v_mfma_f32_16x16x32_bf16 v[132:135], a[164:167], v[48:51], 0
    v_exp_f32 v121, v121
    v_mfma_f32_16x16x32_bf16 v[164:167], a[164:167], v[52:55], 0
    s_waitcnt lgkmcnt(3)
    ds_read_b128 a[184:187], v20 offset:6144
    v_cvt_pk_bf16_f32 v60, v120, v121
    v_mfma_f32_16x16x32_bf16 v[136:139], a[168:171], v[48:51], 0
    s_waitcnt lgkmcnt(3)
    v_exp_f32 v122, v122
    v_mfma_f32_16x16x32_bf16 v[168:171], a[168:171], v[52:55], 0
    buffer_load_dwordx4 v15, s[8:11], s82 offen offset:0 lds
    v_mfma_f32_16x16x32_bf16 v[140:143], a[172:175], v[48:51], 0
    v_exp_f32 v123, v123
    v_mfma_f32_16x16x32_bf16 v[172:175], a[172:175], v[52:55], 0
    s_waitcnt lgkmcnt(2)
    ds_read_b128 a[188:191], v20 offset:7168
    v_cvt_pk_bf16_f32 v61, v122, v123
    v_mfma_f32_16x16x32_bf16 v[144:147], a[176:179], v[48:51], 0
    s_waitcnt lgkmcnt(2)
    v_exp_f32 v124, v124
    v_mfma_f32_16x16x32_bf16 v[176:179], a[176:179], v[52:55], 0
    buffer_load_dwordx4 v15, s[8:11], s82 offen offset:1024 lds
    v_mfma_f32_16x16x32_bf16 v[148:151], a[180:183], v[48:51], 0
    v_exp_f32 v125, v125
    v_mfma_f32_16x16x32_bf16 v[180:183], a[180:183], v[52:55], 0
    s_waitcnt lgkmcnt(1)
    v_cvt_pk_bf16_f32 v62, v124, v125
    v_mfma_f32_16x16x32_bf16 v[152:155], a[184:187], v[48:51], 0
    s_waitcnt lgkmcnt(0)
    v_exp_f32 v126, v126
    v_mfma_f32_16x16x32_bf16 v[184:187], a[184:187], v[52:55], 0
    buffer_load_dwordx4 v15, s[8:11], s82 offen offset:2048 lds
    v_mfma_f32_16x16x32_bf16 v[156:159], a[188:191], v[48:51], 0
    v_exp_f32 v127, v127
    v_mfma_f32_16x16x32_bf16 v[188:191], a[188:191], v[52:55], 0
    v_cvt_pk_bf16_f32 v63, v126, v127
    v_mfma_f32_16x16x32_bf16 v[112:115], a[128:131], a[224:227], v[72:75]
    v_mfma_f32_16x16x32_bf16 v[112:115], a[132:135], a[228:231], v[112:115]
    v_mfma_f32_16x16x32_bf16 v[112:115], a[136:139], a[232:235], v[112:115]
    v_exp_f32 v96, v96
    v_mfma_f32_16x16x32_bf16 v[112:115], a[140:143], a[236:239], v[112:115]
    buffer_load_dwordx4 v15, s[8:11], s82 offen offset:3072 lds
    v_mfma_f32_16x16x32_bf16 v[120:123], a[128:131], a[240:243], v[76:79]
    s_xor_b32 s15, s15, 196608
    v_exp_f32 v97, v97
    v_mfma_f32_16x16x32_bf16 v[120:123], a[132:135], a[244:247], v[120:123]
    s_add_u32 m0, s16, 0
    ds_read_b128 a[128:131], v18 offset:0
    v_cvt_pk_bf16_f32 v48, v96, v97
    v_mfma_f32_16x16x32_bf16 v[120:123], a[136:139], a[248:251], v[120:123]
    v_exp_f32 v98, v98
    v_mfma_f32_16x16x32_bf16 v[120:123], a[140:143], a[252:255], v[120:123]
    buffer_load_dwordx4 v1, s[8:11], s19 offen offset:0 lds
    v_mfma_f32_16x16x32_bf16 v[116:119], a[144:147], a[224:227], v[72:75]
    v_exp_f32 v99, v99
    v_mfma_f32_16x16x32_bf16 v[116:119], a[148:151], a[228:231], v[116:119]
    ds_read_b128 a[132:135], v18 offset:1024
    v_cvt_pk_bf16_f32 v49, v98, v99
    v_mfma_f32_16x16x32_bf16 v[116:119], a[152:155], a[232:235], v[116:119]
    v_exp_f32 v100, v100
    v_mfma_f32_16x16x32_bf16 v[116:119], a[156:159], a[236:239], v[116:119]
    buffer_load_dwordx4 v1, s[8:11], s19 offen offset:1024 lds
    v_mfma_f32_16x16x32_bf16 v[124:127], a[144:147], a[240:243], v[76:79]
    v_exp_f32 v101, v101
    v_mfma_f32_16x16x32_bf16 v[124:127], a[148:151], a[244:247], v[124:127]
    ds_read_b128 a[136:139], v18 offset:2048
    v_cvt_pk_bf16_f32 v50, v100, v101
    v_mfma_f32_16x16x32_bf16 v[124:127], a[152:155], a[248:251], v[124:127]
    v_exp_f32 v102, v102
    v_mfma_f32_16x16x32_bf16 v[124:127], a[156:159], a[252:255], v[124:127]
    buffer_load_dwordx4 v1, s[8:11], s19 offen offset:2048 lds
    v_mfma_f32_16x16x32_bf16 v[40:43], v[28:31], v[56:59], 0
    v_exp_f32 v103, v103
    v_mfma_f32_16x16x32_bf16 v[44:47], v[28:31], v[60:63], 0
    ds_read_b128 a[140:143], v18 offset:3072
    v_cvt_pk_bf16_f32 v51, v102, v103
    v_mfma_f32_16x16x32_bf16 v[192:195], a[160:163], v[56:59], 0
    v_exp_f32 v104, v104
    v_mfma_f32_16x16x32_bf16 v[224:227], a[160:163], v[60:63], 0
    v_mfma_f32_16x16x32_bf16 v[196:199], a[164:167], v[56:59], 0
    v_exp_f32 v105, v105
    v_mfma_f32_16x16x32_bf16 v[228:231], a[164:167], v[60:63], 0
    ds_read_b128 a[144:147], v18 offset:4096
    v_cvt_pk_bf16_f32 v52, v104, v105
    v_mfma_f32_16x16x32_bf16 v[200:203], a[168:171], v[56:59], 0
    v_exp_f32 v106, v106
    v_mfma_f32_16x16x32_bf16 v[232:235], a[168:171], v[60:63], 0
    buffer_load_dwordx4 v1, s[8:11], s19 offen offset:3072 lds
    v_mfma_f32_16x16x32_bf16 v[204:207], a[172:175], v[56:59], 0
    s_add_u32 m0, s16, 4096
    v_exp_f32 v107, v107
    v_mfma_f32_16x16x32_bf16 v[236:239], a[172:175], v[60:63], 0
    ds_read_b128 a[148:151], v18 offset:5120
    v_cvt_pk_bf16_f32 v53, v106, v107
    v_mfma_f32_16x16x32_bf16 v[208:211], a[176:179], v[56:59], 0
    v_exp_f32 v108, v108
    v_mfma_f32_16x16x32_bf16 v[240:243], a[176:179], v[60:63], 0
    buffer_load_dwordx4 v15, s[8:11], s19 offen offset:0 lds
    v_mfma_f32_16x16x32_bf16 v[212:215], a[180:183], v[56:59], 0
    v_exp_f32 v109, v109
    v_mfma_f32_16x16x32_bf16 v[244:247], a[180:183], v[60:63], 0
    ds_read_b128 a[152:155], v18 offset:6144
    v_cvt_pk_bf16_f32 v54, v108, v109
    v_mfma_f32_16x16x32_bf16 v[216:219], a[184:187], v[56:59], 0
    v_exp_f32 v110, v110
    v_mfma_f32_16x16x32_bf16 v[248:251], a[184:187], v[60:63], 0
    buffer_load_dwordx4 v15, s[8:11], s19 offen offset:1024 lds
    v_mfma_f32_16x16x32_bf16 v[220:223], a[188:191], v[56:59], 0
    v_exp_f32 v111, v111
    v_mfma_f32_16x16x32_bf16 v[252:255], a[188:191], v[60:63], 0
    ds_read_b128 a[156:159], v18 offset:7168
    v_cvt_pk_bf16_f32 v55, v110, v111
    s_waitcnt lgkmcnt(7)
    v_mfma_f32_16x16x32_bf16 v[96:99], a[128:131], a[192:195], v[64:67]
    s_waitcnt lgkmcnt(6)
    s_lshr_b32 s101, s2, 3
    s_sub_u32 s101, s101, 4
    ds_read_b128 a[160:163], v19 offset:16384
    v_mfma_f32_16x16x32_bf16 v[96:99], a[132:135], a[196:199], v[96:99]
    s_waitcnt lgkmcnt(6)
    s_and_b32 s101, s101, 31
    ds_read_b128 a[164:167], v19 offset:17408
    v_and_b32 v14, 7, v2
    v_mfma_f32_16x16x32_bf16 v[96:99], a[136:139], a[200:203], v[96:99]
    s_waitcnt lgkmcnt(6)
    v_exp_f32 v112, v112
    v_mfma_f32_16x16x32_bf16 v[96:99], a[140:143], a[204:207], v[96:99]
    buffer_load_dwordx4 v15, s[8:11], s19 offen offset:2048 lds
    v_mfma_f32_16x16x32_bf16 v[104:107], a[128:131], a[208:211], v[68:71]
    v_exp_f32 v113, v113
    v_mfma_f32_16x16x32_bf16 v[104:107], a[132:135], a[212:215], v[104:107]
    ds_read_b128 a[168:171], v19 offset:18432
    v_cvt_pk_bf16_f32 v56, v112, v113
    v_mfma_f32_16x16x32_bf16 v[104:107], a[136:139], a[216:219], v[104:107]
    s_waitcnt lgkmcnt(6)
    v_exp_f32 v114, v114
    v_mfma_f32_16x16x32_bf16 v[104:107], a[140:143], a[220:223], v[104:107]
    buffer_load_dwordx4 v15, s[8:11], s19 offen offset:3072 lds
    v_mfma_f32_16x16x32_bf16 v[100:103], a[144:147], a[192:195], v[64:67]
    s_waitcnt lgkmcnt(5)
    s_xor_b32 s16, s16, 98304
    v_exp_f32 v115, v115
    v_mfma_f32_16x16x32_bf16 v[100:103], a[148:151], a[196:199], v[100:103]
    s_waitcnt lgkmcnt(4)
    s_add_u32 s27, s18, 0
    ds_read_b128 a[172:175], v19 offset:19456
    v_cvt_pk_bf16_f32 v57, v114, v115
    v_mfma_f32_16x16x32_bf16 v[100:103], a[152:155], a[200:203], v[100:103]
    s_waitcnt lgkmcnt(4)
    v_exp_f32 v116, v116
    v_mfma_f32_16x16x32_bf16 v[100:103], a[156:159], a[204:207], v[100:103]
    buffer_store_dwordx4 v[24:27], v17, s[8:11], s27 offen offset:0 sc0 sc1
    v_mfma_f32_16x16x32_bf16 v[108:111], a[144:147], a[208:211], v[68:71]
    s_add_u32 s27, s18, 131072
    v_exp_f32 v117, v117
    v_mfma_f32_16x16x32_bf16 v[108:111], a[148:151], a[212:215], v[108:111]
    ds_read_b128 a[176:179], v20 offset:20480
    v_cvt_pk_bf16_f32 v58, v116, v117
    v_mfma_f32_16x16x32_bf16 v[108:111], a[152:155], a[216:219], v[108:111]
    v_exp_f32 v118, v118
    v_mfma_f32_16x16x32_bf16 v[108:111], a[156:159], a[220:223], v[108:111]
    buffer_store_dwordx4 v[24:27], v17, s[8:11], s27 offen offset:0 sc0 sc1
    v_mfma_f32_16x16x32_bf16 v[32:35], v[28:31], v[48:51], v[32:35]
    v_exp_f32 v119, v119
    v_mfma_f32_16x16x32_bf16 v[36:39], v[28:31], v[52:55], v[36:39]
    s_waitcnt lgkmcnt(4)
    ds_read_b128 a[180:183], v20 offset:21504
    v_cvt_pk_bf16_f32 v59, v118, v119
    v_mfma_f32_16x16x32_bf16 v[128:131], a[160:163], v[48:51], v[128:131]
    v_exp_f32 v120, v120
    v_mfma_f32_16x16x32_bf16 v[160:163], a[160:163], v[52:55], v[160:163]
    s_waitcnt lgkmcnt(4)
    v_lshlrev_b32 v14, 4, v14
    v_lshrrev_b32 v13, 3, v2
    v_mfma_f32_16x16x32_bf16 v[132:135], a[164:167], v[48:51], v[132:135]
    v_exp_f32 v121, v121
    v_mfma_f32_16x16x32_bf16 v[164:167], a[164:167], v[52:55], v[164:167]
    s_waitcnt lgkmcnt(3)
    ds_read_b128 a[184:187], v20 offset:22528
    v_cvt_pk_bf16_f32 v60, v120, v121
    v_mfma_f32_16x16x32_bf16 v[136:139], a[168:171], v[48:51], v[136:139]
    v_exp_f32 v122, v122
    v_mfma_f32_16x16x32_bf16 v[168:171], a[168:171], v[52:55], v[168:171]
    s_waitcnt lgkmcnt(3)
    v_lshl_add_u32 v12, v13, 13, v14
    v_mul_u32_u24 v13, 28672, v13
    v_mfma_f32_16x16x32_bf16 v[140:143], a[172:175], v[48:51], v[140:143]
    v_exp_f32 v123, v123
    v_mfma_f32_16x16x32_bf16 v[172:175], a[172:175], v[52:55], v[172:175]
    s_waitcnt lgkmcnt(2)
    ds_read_b128 a[188:191], v20 offset:23552
    v_cvt_pk_bf16_f32 v61, v122, v123
    v_mfma_f32_16x16x32_bf16 v[144:147], a[176:179], v[48:51], v[144:147]
    v_exp_f32 v124, v124
    v_mfma_f32_16x16x32_bf16 v[176:179], a[176:179], v[52:55], v[176:179]
    s_waitcnt lgkmcnt(2)
    v_add_u32 v13, v13, v14
    v_mfma_f32_16x16x32_bf16 v[148:151], a[180:183], v[48:51], v[148:151]
    s_lshl_b32 s17, s4, 2
    v_exp_f32 v125, v125
    v_mfma_f32_16x16x32_bf16 v[180:183], a[180:183], v[52:55], v[180:183]
    s_waitcnt lgkmcnt(1)
    s_add_u32 s17, s17, s3
    v_cvt_pk_bf16_f32 v62, v124, v125
    v_xor_b32 v19, 98304, v19
    v_mfma_f32_16x16x32_bf16 v[152:155], a[184:187], v[48:51], v[152:155]
    s_lshl_b32 s17, s17, 7
    v_exp_f32 v126, v126
    v_mfma_f32_16x16x32_bf16 v[184:187], a[184:187], v[52:55], v[184:187]
    s_waitcnt lgkmcnt(0)
    s_lshl_b32 s100, s101, 16
    s_add_u32 s17, s17, s100
    v_xor_b32 v20, 98304, v20
    v_mfma_f32_16x16x32_bf16 v[156:159], a[188:191], v[48:51], v[156:159]
    s_add_u32 s17, s17, 4194304
    v_exp_f32 v127, v127
    v_mfma_f32_16x16x32_bf16 v[188:191], a[188:191], v[52:55], v[188:191]
    s_cmp_lt_u32 s101, s26
    s_cselect_b32 s17, s17, 2143285248
    v_cvt_pk_bf16_f32 v63, v126, v127
    buffer_store_dwordx4 a[0:3], v12, s[8:11], s17 offen sc0 sc1
    v_mfma_f32_16x16x32_bf16 v[112:115], a[128:131], a[224:227], v[72:75]
    s_add_u32 s17, s17, 4096
    v_exp_f32 v96, v96
    v_mfma_f32_16x16x32_bf16 v[112:115], a[132:135], a[228:231], v[112:115]
    buffer_store_dwordx4 a[4:7], v12, s[8:11], s17 offen sc0 sc1
    v_mfma_f32_16x16x32_bf16 v[112:115], a[136:139], a[232:235], v[112:115]
    s_add_u32 s27, s18, 0
    v_exp_f32 v97, v97
    v_mfma_f32_16x16x32_bf16 v[112:115], a[140:143], a[236:239], v[112:115]
    v_cvt_pk_bf16_f32 v48, v96, v97
    v_lshrrev_b32 v9, 1, v2
    v_mfma_f32_16x16x32_bf16 v[120:123], a[128:131], a[240:243], v[76:79]
    v_exp_f32 v98, v98
    v_mfma_f32_16x16x32_bf16 v[120:123], a[132:135], a[244:247], v[120:123]
    buffer_store_dwordx4 v[24:27], v17, s[8:11], s27 offen offset:256 sc0 sc1
    v_mfma_f32_16x16x32_bf16 v[120:123], a[136:139], a[248:251], v[120:123]
    s_add_u32 s27, s18, 131072
    v_exp_f32 v99, v99
    v_mfma_f32_16x16x32_bf16 v[120:123], a[140:143], a[252:255], v[120:123]
    buffer_store_dwordx4 v[24:27], v17, s[8:11], s27 offen offset:256 sc0 sc1
    v_mfma_f32_16x16x32_bf16 v[116:119], a[144:147], a[224:227], v[72:75]
    s_add_u32 s27, s18, 0
    v_exp_f32 v100, v100
    v_mfma_f32_16x16x32_bf16 v[116:119], a[148:151], a[228:231], v[116:119]
    ds_read_b128 a[128:131], v18 offset:16384
    v_cvt_pk_bf16_f32 v49, v98, v99
    v_mfma_f32_16x16x32_bf16 v[116:119], a[152:155], a[232:235], v[116:119]
    s_add_u32 s19, s82, 32768
    v_exp_f32 v101, v101
    v_mfma_f32_16x16x32_bf16 v[116:119], a[156:159], a[236:239], v[116:119]
    s_sub_u32 s82, s12, s13
    ds_read_b128 a[132:135], v18 offset:17408
    v_cvt_pk_bf16_f32 v50, v100, v101
    v_mfma_f32_16x16x32_bf16 v[124:127], a[144:147], a[240:243], v[76:79]
    s_sub_u32 s82, s82, 1
    v_exp_f32 v102, v102
    v_mfma_f32_16x16x32_bf16 v[124:127], a[148:151], a[244:247], v[124:127]
    s_cmp_gt_u32 s12, s13
    s_cselect_b32 s82, s82, s12
    s_lshl_b32 s82, s82, 16
    ds_read_b128 a[136:139], v18 offset:18432
    v_mfma_f32_16x16x32_bf16 v[124:127], a[152:155], a[248:251], v[124:127]
    s_add_u32 s82, s82, s81
    v_exp_f32 v103, v103
    v_mfma_f32_16x16x32_bf16 v[124:127], a[156:159], a[252:255], v[124:127]
    s_cmp_ge_u32 s12, 17
    s_cselect_b32 s82, 2147471360, s82
    ds_read_b128 a[140:143], v18 offset:19456
    v_cvt_pk_bf16_f32 v51, v102, v103
    v_mfma_f32_16x16x32_bf16 v[40:43], v[28:31], v[56:59], v[40:43]
    s_add_u32 s12, s12, 1
    v_exp_f32 v104, v104
    v_mfma_f32_16x16x32_bf16 v[44:47], v[28:31], v[60:63], v[44:47]
    ds_read_b128 a[144:147], v18 offset:20480
    v_lshrrev_b32 v10, 4, v2
    v_mfma_f32_16x16x32_bf16 v[192:195], a[160:163], v[56:59], v[192:195]
    v_exp_f32 v105, v105
    v_mfma_f32_16x16x32_bf16 v[224:227], a[160:163], v[60:63], v[224:227]
    ds_read_b128 a[148:151], v18 offset:21504
    v_cvt_pk_bf16_f32 v52, v104, v105
    v_mfma_f32_16x16x32_bf16 v[196:199], a[164:167], v[56:59], v[196:199]
    v_exp_f32 v106, v106
    v_mfma_f32_16x16x32_bf16 v[228:231], a[164:167], v[60:63], v[228:231]
    ds_read_b128 a[152:155], v18 offset:22528
    v_xor_b32 v9, v9, v10
    v_mfma_f32_16x16x32_bf16 v[200:203], a[168:171], v[56:59], v[200:203]
    v_exp_f32 v107, v107
    v_mfma_f32_16x16x32_bf16 v[232:235], a[168:171], v[60:63], v[232:235]
    ds_read_b128 a[156:159], v18 offset:23552
    v_cvt_pk_bf16_f32 v53, v106, v107
    v_mfma_f32_16x16x32_bf16 v[204:207], a[172:175], v[56:59], v[204:207]
    v_exp_f32 v108, v108
    v_mfma_f32_16x16x32_bf16 v[236:239], a[172:175], v[60:63], v[236:239]
    buffer_store_dwordx4 v[24:27], v17, s[8:11], s27 offen offset:512 sc0 sc1
    v_mfma_f32_16x16x32_bf16 v[208:211], a[176:179], v[56:59], v[208:211]
    s_add_u32 s27, s18, 131072
    v_exp_f32 v109, v109
    v_mfma_f32_16x16x32_bf16 v[240:243], a[176:179], v[60:63], v[240:243]
    v_cvt_pk_bf16_f32 v54, v108, v109
    v_xor_b32 v18, 196608, v18
    v_mfma_f32_16x16x32_bf16 v[212:215], a[180:183], v[56:59], v[212:215]
    v_exp_f32 v110, v110
    v_mfma_f32_16x16x32_bf16 v[244:247], a[180:183], v[60:63], v[244:247]
    buffer_store_dwordx4 v[24:27], v17, s[8:11], s27 offen offset:512 sc0 sc1
    v_mfma_f32_16x16x32_bf16 v[216:219], a[184:187], v[56:59], v[216:219]
    s_add_u32 s27, s18, 0
    v_exp_f32 v111, v111
    v_mfma_f32_16x16x32_bf16 v[248:251], a[184:187], v[60:63], v[248:251]
    v_cvt_pk_bf16_f32 v55, v110, v111
    v_and_b32 v9, 3, v9
    v_mfma_f32_16x16x32_bf16 v[220:223], a[188:191], v[56:59], v[220:223]
    buffer_store_dwordx4 v[24:27], v17, s[8:11], s27 offen offset:768 sc0 sc1
    v_mfma_f32_16x16x32_bf16 v[252:255], a[188:191], v[60:63], v[252:255]
    v_lshlrev_b32 v9, 5, v9
    v_and_b32 v10, 1, v2
    v_lshl_add_u32 v9, v10, 4, v9
    v_lshrrev_b32 v8, 3, v2
    s_waitcnt vmcnt(9) lgkmcnt(0)
    s_barrier
    buffer_store_dword v6, v5, s[8:11], s22 offen sc0 sc1
    v_mfma_f32_16x16x32_bf16 v[96:99], a[128:131], a[192:195], v[64:67]
    s_add_u32 m0, s15, 0
    ds_read_b128 a[160:163], v19 offset:0
    v_mfma_f32_16x16x32_bf16 v[96:99], a[132:135], a[196:199], v[96:99]
    ds_read_b128 a[164:167], v19 offset:1024
    v_mfma_f32_16x16x32_bf16 v[96:99], a[136:139], a[200:203], v[96:99]
    v_exp_f32 v112, v112
    v_mfma_f32_16x16x32_bf16 v[96:99], a[140:143], a[204:207], v[96:99]
    buffer_load_dwordx4 v1, s[8:11], s82 offen offset:0 lds
    v_mfma_f32_16x16x32_bf16 v[104:107], a[128:131], a[208:211], v[68:71]
    v_exp_f32 v113, v113
    v_mfma_f32_16x16x32_bf16 v[104:107], a[132:135], a[212:215], v[104:107]
    ds_read_b128 a[168:171], v19 offset:2048
    v_cvt_pk_bf16_f32 v56, v112, v113
    v_mfma_f32_16x16x32_bf16 v[104:107], a[136:139], a[216:219], v[104:107]
    v_exp_f32 v114, v114
    v_mfma_f32_16x16x32_bf16 v[104:107], a[140:143], a[220:223], v[104:107]
    buffer_load_dwordx4 v1, s[8:11], s82 offen offset:1024 lds
    v_mfma_f32_16x16x32_bf16 v[100:103], a[144:147], a[192:195], v[64:67]
    v_exp_f32 v115, v115
    v_mfma_f32_16x16x32_bf16 v[100:103], a[148:151], a[196:199], v[100:103]
    ds_read_b128 a[172:175], v19 offset:3072
    v_cvt_pk_bf16_f32 v57, v114, v115
    v_mfma_f32_16x16x32_bf16 v[100:103], a[152:155], a[200:203], v[100:103]
    v_exp_f32 v116, v116
    v_mfma_f32_16x16x32_bf16 v[100:103], a[156:159], a[204:207], v[100:103]
    buffer_load_dwordx4 v1, s[8:11], s82 offen offset:2048 lds
    v_mfma_f32_16x16x32_bf16 v[108:111], a[144:147], a[208:211], v[68:71]
    v_exp_f32 v117, v117
    v_mfma_f32_16x16x32_bf16 v[108:111], a[148:151], a[212:215], v[108:111]
    ds_read_b128 a[176:179], v20 offset:4096
    v_cvt_pk_bf16_f32 v58, v116, v117
    v_mfma_f32_16x16x32_bf16 v[108:111], a[152:155], a[216:219], v[108:111]
    v_exp_f32 v118, v118
    v_mfma_f32_16x16x32_bf16 v[108:111], a[156:159], a[220:223], v[108:111]
    buffer_load_dwordx4 v1, s[8:11], s82 offen offset:3072 lds
    v_mfma_f32_16x16x32_bf16 v[32:35], v[28:31], v[48:51], v[32:35]
    s_add_u32 m0, s15, 4096
    v_exp_f32 v119, v119
    v_mfma_f32_16x16x32_bf16 v[36:39], v[28:31], v[52:55], v[36:39]
    s_waitcnt lgkmcnt(4)
    ds_read_b128 a[180:183], v20 offset:5120
    v_cvt_pk_bf16_f32 v59, v118, v119
    v_mfma_f32_16x16x32_bf16 v[128:131], a[160:163], v[48:51], v[128:131]
    v_exp_f32 v120, v120
    v_mfma_f32_16x16x32_bf16 v[160:163], a[160:163], v[52:55], v[160:163]
    s_waitcnt lgkmcnt(4)
    v_mfma_f32_16x16x32_bf16 v[132:135], a[164:167], v[48:51], v[132:135]
    v_exp_f32 v121, v121
    v_mfma_f32_16x16x32_bf16 v[164:167], a[164:167], v[52:55], v[164:167]
    s_waitcnt lgkmcnt(3)
    ds_read_b128 a[184:187], v20 offset:6144
    v_cvt_pk_bf16_f32 v60, v120, v121
    v_mfma_f32_16x16x32_bf16 v[136:139], a[168:171], v[48:51], v[136:139]
    s_waitcnt lgkmcnt(3)
    v_exp_f32 v122, v122
    v_mfma_f32_16x16x32_bf16 v[168:171], a[168:171], v[52:55], v[168:171]
    buffer_load_dwordx4 v15, s[8:11], s82 offen offset:0 lds
    v_mfma_f32_16x16x32_bf16 v[140:143], a[172:175], v[48:51], v[140:143]
    v_exp_f32 v123, v123
    v_mfma_f32_16x16x32_bf16 v[172:175], a[172:175], v[52:55], v[172:175]
    s_waitcnt lgkmcnt(2)
    ds_read_b128 a[188:191], v20 offset:7168
    v_cvt_pk_bf16_f32 v61, v122, v123
    v_mfma_f32_16x16x32_bf16 v[144:147], a[176:179], v[48:51], v[144:147]
    s_waitcnt lgkmcnt(2)
    v_exp_f32 v124, v124
    v_mfma_f32_16x16x32_bf16 v[176:179], a[176:179], v[52:55], v[176:179]
    buffer_load_dwordx4 v15, s[8:11], s82 offen offset:1024 lds
    v_mfma_f32_16x16x32_bf16 v[148:151], a[180:183], v[48:51], v[148:151]
    v_exp_f32 v125, v125
    v_mfma_f32_16x16x32_bf16 v[180:183], a[180:183], v[52:55], v[180:183]
    s_waitcnt lgkmcnt(1)
    v_cvt_pk_bf16_f32 v62, v124, v125
    v_mfma_f32_16x16x32_bf16 v[152:155], a[184:187], v[48:51], v[152:155]
    s_waitcnt lgkmcnt(0)
    v_exp_f32 v126, v126
    v_mfma_f32_16x16x32_bf16 v[184:187], a[184:187], v[52:55], v[184:187]
    buffer_load_dwordx4 v15, s[8:11], s82 offen offset:2048 lds
    v_mfma_f32_16x16x32_bf16 v[156:159], a[188:191], v[48:51], v[156:159]
    v_exp_f32 v127, v127
    v_mfma_f32_16x16x32_bf16 v[188:191], a[188:191], v[52:55], v[188:191]
    v_cvt_pk_bf16_f32 v63, v126, v127
    v_mfma_f32_16x16x32_bf16 v[112:115], a[128:131], a[224:227], v[72:75]
    v_mfma_f32_16x16x32_bf16 v[112:115], a[132:135], a[228:231], v[112:115]
    v_mfma_f32_16x16x32_bf16 v[112:115], a[136:139], a[232:235], v[112:115]
    v_exp_f32 v96, v96
    v_mfma_f32_16x16x32_bf16 v[112:115], a[140:143], a[236:239], v[112:115]
    buffer_load_dwordx4 v15, s[8:11], s82 offen offset:3072 lds
    v_mfma_f32_16x16x32_bf16 v[120:123], a[128:131], a[240:243], v[76:79]
    s_xor_b32 s15, s15, 196608
    v_exp_f32 v97, v97
    v_mfma_f32_16x16x32_bf16 v[120:123], a[132:135], a[244:247], v[120:123]
    s_add_u32 m0, s16, 0
    ds_read_b128 a[128:131], v18 offset:0
    v_cvt_pk_bf16_f32 v48, v96, v97
    v_mfma_f32_16x16x32_bf16 v[120:123], a[136:139], a[248:251], v[120:123]
    v_exp_f32 v98, v98
    v_mfma_f32_16x16x32_bf16 v[120:123], a[140:143], a[252:255], v[120:123]
    buffer_load_dwordx4 v1, s[8:11], s19 offen offset:0 lds
    v_mfma_f32_16x16x32_bf16 v[116:119], a[144:147], a[224:227], v[72:75]
    v_exp_f32 v99, v99
    v_mfma_f32_16x16x32_bf16 v[116:119], a[148:151], a[228:231], v[116:119]
    ds_read_b128 a[132:135], v18 offset:1024
    v_cvt_pk_bf16_f32 v49, v98, v99
    v_mfma_f32_16x16x32_bf16 v[116:119], a[152:155], a[232:235], v[116:119]
    v_exp_f32 v100, v100
    v_mfma_f32_16x16x32_bf16 v[116:119], a[156:159], a[236:239], v[116:119]
    buffer_load_dwordx4 v1, s[8:11], s19 offen offset:1024 lds
    v_mfma_f32_16x16x32_bf16 v[124:127], a[144:147], a[240:243], v[76:79]
    v_exp_f32 v101, v101
    v_mfma_f32_16x16x32_bf16 v[124:127], a[148:151], a[244:247], v[124:127]
    ds_read_b128 a[136:139], v18 offset:2048
    v_cvt_pk_bf16_f32 v50, v100, v101
    v_mfma_f32_16x16x32_bf16 v[124:127], a[152:155], a[248:251], v[124:127]
    v_exp_f32 v102, v102
    v_mfma_f32_16x16x32_bf16 v[124:127], a[156:159], a[252:255], v[124:127]
    buffer_load_dwordx4 v1, s[8:11], s19 offen offset:2048 lds
    v_mfma_f32_16x16x32_bf16 v[40:43], v[28:31], v[56:59], v[40:43]
    v_exp_f32 v103, v103
    v_mfma_f32_16x16x32_bf16 v[44:47], v[28:31], v[60:63], v[44:47]
    ds_read_b128 a[140:143], v18 offset:3072
    v_cvt_pk_bf16_f32 v51, v102, v103
    v_mfma_f32_16x16x32_bf16 v[192:195], a[160:163], v[56:59], v[192:195]
    v_exp_f32 v104, v104
    v_mfma_f32_16x16x32_bf16 v[224:227], a[160:163], v[60:63], v[224:227]
    v_mfma_f32_16x16x32_bf16 v[196:199], a[164:167], v[56:59], v[196:199]
    v_exp_f32 v105, v105
    v_mfma_f32_16x16x32_bf16 v[228:231], a[164:167], v[60:63], v[228:231]
    ds_read_b128 a[144:147], v18 offset:4096
    v_cvt_pk_bf16_f32 v52, v104, v105
    v_mfma_f32_16x16x32_bf16 v[200:203], a[168:171], v[56:59], v[200:203]
    v_exp_f32 v106, v106
    v_mfma_f32_16x16x32_bf16 v[232:235], a[168:171], v[60:63], v[232:235]
    buffer_load_dwordx4 v1, s[8:11], s19 offen offset:3072 lds
    v_mfma_f32_16x16x32_bf16 v[204:207], a[172:175], v[56:59], v[204:207]
    s_add_u32 m0, s16, 4096
    v_exp_f32 v107, v107
    v_mfma_f32_16x16x32_bf16 v[236:239], a[172:175], v[60:63], v[236:239]
    ds_read_b128 a[148:151], v18 offset:5120
    v_cvt_pk_bf16_f32 v53, v106, v107
    v_mfma_f32_16x16x32_bf16 v[208:211], a[176:179], v[56:59], v[208:211]
    v_exp_f32 v108, v108
    v_mfma_f32_16x16x32_bf16 v[240:243], a[176:179], v[60:63], v[240:243]
    buffer_load_dwordx4 v15, s[8:11], s19 offen offset:0 lds
    v_mfma_f32_16x16x32_bf16 v[212:215], a[180:183], v[56:59], v[212:215]
    v_exp_f32 v109, v109
    v_mfma_f32_16x16x32_bf16 v[244:247], a[180:183], v[60:63], v[244:247]
    ds_read_b128 a[152:155], v18 offset:6144
    v_cvt_pk_bf16_f32 v54, v108, v109
    v_mfma_f32_16x16x32_bf16 v[216:219], a[184:187], v[56:59], v[216:219]
    v_exp_f32 v110, v110
    v_mfma_f32_16x16x32_bf16 v[248:251], a[184:187], v[60:63], v[248:251]
    buffer_load_dwordx4 v15, s[8:11], s19 offen offset:1024 lds
    v_mfma_f32_16x16x32_bf16 v[220:223], a[188:191], v[56:59], v[220:223]
    v_exp_f32 v111, v111
    v_mfma_f32_16x16x32_bf16 v[252:255], a[188:191], v[60:63], v[252:255]
    ds_read_b128 a[156:159], v18 offset:7168
    v_cvt_pk_bf16_f32 v55, v110, v111
    s_waitcnt lgkmcnt(7)
    v_mfma_f32_16x16x32_bf16 v[96:99], a[128:131], a[192:195], v[64:67]
    s_waitcnt lgkmcnt(6)
    ds_read_b128 a[160:163], v19 offset:16384
    v_mfma_f32_16x16x32_bf16 v[96:99], a[132:135], a[196:199], v[96:99]
    s_waitcnt lgkmcnt(6)
    ds_read_b128 a[164:167], v19 offset:17408
    v_mfma_f32_16x16x32_bf16 v[96:99], a[136:139], a[200:203], v[96:99]
    s_waitcnt lgkmcnt(6)
    v_exp_f32 v112, v112
    v_mfma_f32_16x16x32_bf16 v[96:99], a[140:143], a[204:207], v[96:99]
    buffer_load_dwordx4 v15, s[8:11], s19 offen offset:2048 lds
    v_mfma_f32_16x16x32_bf16 v[104:107], a[128:131], a[208:211], v[68:71]
    v_exp_f32 v113, v113
    v_mfma_f32_16x16x32_bf16 v[104:107], a[132:135], a[212:215], v[104:107]
    ds_read_b128 a[168:171], v19 offset:18432
    v_cvt_pk_bf16_f32 v56, v112, v113
    v_mfma_f32_16x16x32_bf16 v[104:107], a[136:139], a[216:219], v[104:107]
    s_waitcnt lgkmcnt(6)
    v_exp_f32 v114, v114
    v_mfma_f32_16x16x32_bf16 v[104:107], a[140:143], a[220:223], v[104:107]
    buffer_load_dwordx4 v15, s[8:11], s19 offen offset:3072 lds
    v_mfma_f32_16x16x32_bf16 v[100:103], a[144:147], a[192:195], v[64:67]
    s_waitcnt lgkmcnt(5)
    s_xor_b32 s16, s16, 98304
    v_exp_f32 v115, v115
    v_mfma_f32_16x16x32_bf16 v[100:103], a[148:151], a[196:199], v[100:103]
    s_waitcnt lgkmcnt(4)
    s_add_u32 s17, s17, 2093056
    ds_read_b128 a[172:175], v19 offset:19456
    v_cvt_pk_bf16_f32 v57, v114, v115
    v_mfma_f32_16x16x32_bf16 v[100:103], a[152:155], a[200:203], v[100:103]
    s_waitcnt lgkmcnt(4)
    v_exp_f32 v116, v116
    v_mfma_f32_16x16x32_bf16 v[100:103], a[156:159], a[204:207], v[100:103]
    buffer_store_dwordx4 a[8:11], v12, s[8:11], s17 offen sc0 sc1
    v_mfma_f32_16x16x32_bf16 v[108:111], a[144:147], a[208:211], v[68:71]
    s_add_u32 s27, s18, 131072
    v_exp_f32 v117, v117
    v_mfma_f32_16x16x32_bf16 v[108:111], a[148:151], a[212:215], v[108:111]
    ds_read_b128 a[176:179], v20 offset:20480
    v_cvt_pk_bf16_f32 v58, v116, v117
    v_mfma_f32_16x16x32_bf16 v[108:111], a[152:155], a[216:219], v[108:111]
    v_exp_f32 v118, v118
    v_mfma_f32_16x16x32_bf16 v[108:111], a[156:159], a[220:223], v[108:111]
    buffer_store_dwordx4 v[24:27], v17, s[8:11], s27 offen offset:768 sc0 sc1
    v_mfma_f32_16x16x32_bf16 v[32:35], v[28:31], v[48:51], v[32:35]
    s_add_u32 s27, s18, 8388608
    v_exp_f32 v119, v119
    v_mfma_f32_16x16x32_bf16 v[36:39], v[28:31], v[52:55], v[36:39]
    s_waitcnt lgkmcnt(4)
    ds_read_b128 a[180:183], v20 offset:21504
    v_cvt_pk_bf16_f32 v59, v118, v119
    v_mfma_f32_16x16x32_bf16 v[128:131], a[160:163], v[48:51], v[128:131]
    s_waitcnt lgkmcnt(4)
    v_exp_f32 v120, v120
    v_mfma_f32_16x16x32_bf16 v[160:163], a[160:163], v[52:55], v[160:163]
    buffer_store_dwordx4 v[24:27], v17, s[8:11], s27 offen offset:0 sc0 sc1
    v_mfma_f32_16x16x32_bf16 v[132:135], a[164:167], v[48:51], v[132:135]
    s_add_u32 s27, s18, 8519680
    v_exp_f32 v121, v121
    v_mfma_f32_16x16x32_bf16 v[164:167], a[164:167], v[52:55], v[164:167]
    s_waitcnt lgkmcnt(3)
    ds_read_b128 a[184:187], v20 offset:22528
    v_cvt_pk_bf16_f32 v60, v120, v121
    v_mfma_f32_16x16x32_bf16 v[136:139], a[168:171], v[48:51], v[136:139]
    s_waitcnt lgkmcnt(3)
    v_exp_f32 v122, v122
    v_mfma_f32_16x16x32_bf16 v[168:171], a[168:171], v[52:55], v[168:171]
    buffer_store_dwordx4 v[24:27], v17, s[8:11], s27 offen offset:0 sc0 sc1
    v_mfma_f32_16x16x32_bf16 v[140:143], a[172:175], v[48:51], v[140:143]
    v_exp_f32 v123, v123
    v_mfma_f32_16x16x32_bf16 v[172:175], a[172:175], v[52:55], v[172:175]
    s_waitcnt lgkmcnt(2)
    ds_read_b128 a[188:191], v20 offset:23552
    v_cvt_pk_bf16_f32 v61, v122, v123
    v_mfma_f32_16x16x32_bf16 v[144:147], a[176:179], v[48:51], v[144:147]
    v_exp_f32 v124, v124
    v_mfma_f32_16x16x32_bf16 v[176:179], a[176:179], v[52:55], v[176:179]
    s_waitcnt lgkmcnt(2)
    v_mfma_f32_16x16x32_bf16 v[148:151], a[180:183], v[48:51], v[148:151]
    v_exp_f32 v125, v125
    v_mfma_f32_16x16x32_bf16 v[180:183], a[180:183], v[52:55], v[180:183]
    s_waitcnt lgkmcnt(1)
    v_cvt_pk_bf16_f32 v62, v124, v125
    v_xor_b32 v19, 98304, v19
    v_mfma_f32_16x16x32_bf16 v[152:155], a[184:187], v[48:51], v[152:155]
    v_exp_f32 v126, v126
    v_mfma_f32_16x16x32_bf16 v[184:187], a[184:187], v[52:55], v[184:187]
    s_waitcnt lgkmcnt(0)
    v_xor_b32 v20, 98304, v20
    v_mfma_f32_16x16x32_bf16 v[156:159], a[188:191], v[48:51], v[156:159]
    v_exp_f32 v127, v127
    v_mfma_f32_16x16x32_bf16 v[188:191], a[188:191], v[52:55], v[188:191]
    v_cvt_pk_bf16_f32 v63, v126, v127
    v_mfma_f32_16x16x32_bf16 v[112:115], a[128:131], a[224:227], v[72:75]
    s_add_u32 s17, s17, 4096
    v_exp_f32 v96, v96
    v_mfma_f32_16x16x32_bf16 v[112:115], a[132:135], a[228:231], v[112:115]
    buffer_store_dwordx4 a[12:15], v12, s[8:11], s17 offen sc0 sc1
    v_mfma_f32_16x16x32_bf16 v[112:115], a[136:139], a[232:235], v[112:115]
    s_add_u32 s27, s18, 8388608
    v_exp_f32 v97, v97
    v_mfma_f32_16x16x32_bf16 v[112:115], a[140:143], a[236:239], v[112:115]
    v_cvt_pk_bf16_f32 v48, v96, v97
    v_lshl_add_u32 v8, v8, 10, v9
    v_mfma_f32_16x16x32_bf16 v[120:123], a[128:131], a[240:243], v[76:79]
    v_exp_f32 v98, v98
    v_mfma_f32_16x16x32_bf16 v[120:123], a[132:135], a[244:247], v[120:123]
    buffer_store_dwordx4 v[24:27], v17, s[8:11], s27 offen offset:256 sc0 sc1
    v_mfma_f32_16x16x32_bf16 v[120:123], a[136:139], a[248:251], v[120:123]
    s_add_u32 s27, s18, 8519680
    v_exp_f32 v99, v99
    v_mfma_f32_16x16x32_bf16 v[120:123], a[140:143], a[252:255], v[120:123]
    buffer_store_dwordx4 v[24:27], v17, s[8:11], s27 offen offset:256 sc0 sc1
    v_mfma_f32_16x16x32_bf16 v[116:119], a[144:147], a[224:227], v[72:75]
    s_add_u32 s27, s18, 8388608
    v_exp_f32 v100, v100
    v_mfma_f32_16x16x32_bf16 v[116:119], a[148:151], a[228:231], v[116:119]
    ds_read_b128 a[128:131], v18 offset:16384
    v_cvt_pk_bf16_f32 v49, v98, v99
    v_mfma_f32_16x16x32_bf16 v[116:119], a[152:155], a[232:235], v[116:119]
    s_add_u32 s19, s82, 32768
    v_exp_f32 v101, v101
    v_mfma_f32_16x16x32_bf16 v[116:119], a[156:159], a[236:239], v[116:119]
    s_sub_u32 s82, s12, s13
    ds_read_b128 a[132:135], v18 offset:17408
    v_cvt_pk_bf16_f32 v50, v100, v101
    v_mfma_f32_16x16x32_bf16 v[124:127], a[144:147], a[240:243], v[76:79]
    s_sub_u32 s82, s82, 1
    v_exp_f32 v102, v102
    v_mfma_f32_16x16x32_bf16 v[124:127], a[148:151], a[244:247], v[124:127]
    s_cmp_gt_u32 s12, s13
    s_cselect_b32 s82, s82, s12
    s_lshl_b32 s82, s82, 16
    ds_read_b128 a[136:139], v18 offset:18432
    v_mfma_f32_16x16x32_bf16 v[124:127], a[152:155], a[248:251], v[124:127]
    s_add_u32 s82, s82, s81
    v_exp_f32 v103, v103
    v_mfma_f32_16x16x32_bf16 v[124:127], a[156:159], a[252:255], v[124:127]
    s_cmp_ge_u32 s12, 17
    s_cselect_b32 s82, 2147471360, s82
    ds_read_b128 a[140:143], v18 offset:19456
    v_cvt_pk_bf16_f32 v51, v102, v103
    v_mfma_f32_16x16x32_bf16 v[40:43], v[28:31], v[56:59], v[40:43]
    s_add_u32 s12, s12, 1
    v_exp_f32 v104, v104
    v_mfma_f32_16x16x32_bf16 v[44:47], v[28:31], v[60:63], v[44:47]
    ds_read_b128 a[144:147], v18 offset:20480
    v_bfe_u32 v4, v2, 1, 2
    v_mfma_f32_16x16x32_bf16 v[192:195], a[160:163], v[56:59], v[192:195]
    v_exp_f32 v105, v105
    v_mfma_f32_16x16x32_bf16 v[224:227], a[160:163], v[60:63], v[224:227]
    ds_read_b128 a[148:151], v18 offset:21504
    v_cvt_pk_bf16_f32 v52, v104, v105
    v_mfma_f32_16x16x32_bf16 v[196:199], a[164:167], v[56:59], v[196:199]
    v_exp_f32 v106, v106
    v_mfma_f32_16x16x32_bf16 v[228:231], a[164:167], v[60:63], v[228:231]
    ds_read_b128 a[152:155], v18 offset:22528
    v_lshlrev_b32 v4, 11, v4
    v_mfma_f32_16x16x32_bf16 v[200:203], a[168:171], v[56:59], v[200:203]
    v_exp_f32 v107, v107
    v_mfma_f32_16x16x32_bf16 v[232:235], a[168:171], v[60:63], v[232:235]
    ds_read_b128 a[156:159], v18 offset:23552
    v_cvt_pk_bf16_f32 v53, v106, v107
    v_mfma_f32_16x16x32_bf16 v[204:207], a[172:175], v[56:59], v[204:207]
    v_exp_f32 v108, v108
    v_mfma_f32_16x16x32_bf16 v[236:239], a[172:175], v[60:63], v[236:239]
    buffer_store_dwordx4 v[24:27], v17, s[8:11], s27 offen offset:512 sc0 sc1
    v_mfma_f32_16x16x32_bf16 v[208:211], a[176:179], v[56:59], v[208:211]
    s_add_u32 s27, s18, 8519680
    v_exp_f32 v109, v109
    v_mfma_f32_16x16x32_bf16 v[240:243], a[176:179], v[60:63], v[240:243]
    v_cvt_pk_bf16_f32 v54, v108, v109
    v_xor_b32 v18, 196608, v18
    v_mfma_f32_16x16x32_bf16 v[212:215], a[180:183], v[56:59], v[212:215]
    v_exp_f32 v110, v110
    v_mfma_f32_16x16x32_bf16 v[244:247], a[180:183], v[60:63], v[244:247]
    buffer_store_dwordx4 v[24:27], v17, s[8:11], s27 offen offset:512 sc0 sc1
    v_mfma_f32_16x16x32_bf16 v[216:219], a[184:187], v[56:59], v[216:219]
    v_exp_f32 v111, v111
    v_mfma_f32_16x16x32_bf16 v[248:251], a[184:187], v[60:63], v[248:251]
    v_cvt_pk_bf16_f32 v55, v110, v111
    v_lshl_add_u32 v4, v10, 6, v4
    v_mfma_f32_16x16x32_bf16 v[220:223], a[188:191], v[56:59], v[220:223]
    v_add_u32 v9, 7168, v8
    v_add_u32 v10, 14336, v8
    v_mfma_f32_16x16x32_bf16 v[252:255], a[188:191], v[60:63], v[252:255]
    v_add_u32 v11, 21504, v8
    s_waitcnt vmcnt(9) lgkmcnt(0)
    s_barrier
    v_mfma_f32_16x16x32_bf16 v[96:99], a[128:131], a[192:195], v[64:67]
    s_add_u32 m0, s15, 0
    ds_read_b128 a[160:163], v19 offset:0
    v_mfma_f32_16x16x32_bf16 v[96:99], a[132:135], a[196:199], v[96:99]
    ds_read_b128 a[164:167], v19 offset:1024
    v_mfma_f32_16x16x32_bf16 v[96:99], a[136:139], a[200:203], v[96:99]
    v_exp_f32 v112, v112
    v_mfma_f32_16x16x32_bf16 v[96:99], a[140:143], a[204:207], v[96:99]
    buffer_load_dwordx4 v1, s[8:11], s82 offen offset:0 lds
    v_mfma_f32_16x16x32_bf16 v[104:107], a[128:131], a[208:211], v[68:71]
    v_exp_f32 v113, v113
    v_mfma_f32_16x16x32_bf16 v[104:107], a[132:135], a[212:215], v[104:107]
    ds_read_b128 a[168:171], v19 offset:2048
    v_cvt_pk_bf16_f32 v56, v112, v113
    v_mfma_f32_16x16x32_bf16 v[104:107], a[136:139], a[216:219], v[104:107]
    v_exp_f32 v114, v114
    v_mfma_f32_16x16x32_bf16 v[104:107], a[140:143], a[220:223], v[104:107]
    buffer_load_dwordx4 v1, s[8:11], s82 offen offset:1024 lds
    v_mfma_f32_16x16x32_bf16 v[100:103], a[144:147], a[192:195], v[64:67]
    v_exp_f32 v115, v115
    v_mfma_f32_16x16x32_bf16 v[100:103], a[148:151], a[196:199], v[100:103]
    ds_read_b128 a[172:175], v19 offset:3072
    v_cvt_pk_bf16_f32 v57, v114, v115
    v_mfma_f32_16x16x32_bf16 v[100:103], a[152:155], a[200:203], v[100:103]
    v_exp_f32 v116, v116
    v_mfma_f32_16x16x32_bf16 v[100:103], a[156:159], a[204:207], v[100:103]
    buffer_load_dwordx4 v1, s[8:11], s82 offen offset:2048 lds
    v_mfma_f32_16x16x32_bf16 v[108:111], a[144:147], a[208:211], v[68:71]
    v_exp_f32 v117, v117
    v_mfma_f32_16x16x32_bf16 v[108:111], a[148:151], a[212:215], v[108:111]
    ds_read_b128 a[176:179], v20 offset:4096
    v_cvt_pk_bf16_f32 v58, v116, v117
    v_mfma_f32_16x16x32_bf16 v[108:111], a[152:155], a[216:219], v[108:111]
    v_exp_f32 v118, v118
    v_mfma_f32_16x16x32_bf16 v[108:111], a[156:159], a[220:223], v[108:111]
    buffer_load_dwordx4 v1, s[8:11], s82 offen offset:3072 lds
    v_mfma_f32_16x16x32_bf16 v[32:35], v[28:31], v[48:51], v[32:35]
    s_add_u32 m0, s15, 4096
    v_exp_f32 v119, v119
    v_mfma_f32_16x16x32_bf16 v[36:39], v[28:31], v[52:55], v[36:39]
    s_waitcnt lgkmcnt(4)
    ds_read_b128 a[180:183], v20 offset:5120
    v_cvt_pk_bf16_f32 v59, v118, v119
    v_mfma_f32_16x16x32_bf16 v[128:131], a[160:163], v[48:51], v[128:131]
    v_exp_f32 v120, v120
    v_mfma_f32_16x16x32_bf16 v[160:163], a[160:163], v[52:55], v[160:163]
    s_waitcnt lgkmcnt(4)
    v_mfma_f32_16x16x32_bf16 v[132:135], a[164:167], v[48:51], v[132:135]
    v_exp_f32 v121, v121
    v_mfma_f32_16x16x32_bf16 v[164:167], a[164:167], v[52:55], v[164:167]
    s_waitcnt lgkmcnt(3)
    ds_read_b128 a[184:187], v20 offset:6144
    v_cvt_pk_bf16_f32 v60, v120, v121
    v_mfma_f32_16x16x32_bf16 v[136:139], a[168:171], v[48:51], v[136:139]
    s_waitcnt lgkmcnt(3)
    v_exp_f32 v122, v122
    v_mfma_f32_16x16x32_bf16 v[168:171], a[168:171], v[52:55], v[168:171]
    buffer_load_dwordx4 v15, s[8:11], s82 offen offset:0 lds
    v_mfma_f32_16x16x32_bf16 v[140:143], a[172:175], v[48:51], v[140:143]
    v_exp_f32 v123, v123
    v_mfma_f32_16x16x32_bf16 v[172:175], a[172:175], v[52:55], v[172:175]
    s_waitcnt lgkmcnt(2)
    ds_read_b128 a[188:191], v20 offset:7168
    v_cvt_pk_bf16_f32 v61, v122, v123
    v_mfma_f32_16x16x32_bf16 v[144:147], a[176:179], v[48:51], v[144:147]
    s_waitcnt lgkmcnt(2)
    v_exp_f32 v124, v124
    v_mfma_f32_16x16x32_bf16 v[176:179], a[176:179], v[52:55], v[176:179]
    buffer_load_dwordx4 v15, s[8:11], s82 offen offset:1024 lds
    v_mfma_f32_16x16x32_bf16 v[148:151], a[180:183], v[48:51], v[148:151]
    v_exp_f32 v125, v125
    v_mfma_f32_16x16x32_bf16 v[180:183], a[180:183], v[52:55], v[180:183]
    s_waitcnt lgkmcnt(1)
    v_cvt_pk_bf16_f32 v62, v124, v125
    v_mfma_f32_16x16x32_bf16 v[152:155], a[184:187], v[48:51], v[152:155]
    s_waitcnt lgkmcnt(0)
    v_exp_f32 v126, v126
    v_mfma_f32_16x16x32_bf16 v[184:187], a[184:187], v[52:55], v[184:187]
    buffer_load_dwordx4 v15, s[8:11], s82 offen offset:2048 lds
    v_mfma_f32_16x16x32_bf16 v[156:159], a[188:191], v[48:51], v[156:159]
    v_exp_f32 v127, v127
    v_mfma_f32_16x16x32_bf16 v[188:191], a[188:191], v[52:55], v[188:191]
    v_cvt_pk_bf16_f32 v63, v126, v127
    v_mfma_f32_16x16x32_bf16 v[112:115], a[128:131], a[224:227], v[72:75]
    v_mfma_f32_16x16x32_bf16 v[112:115], a[132:135], a[228:231], v[112:115]
    v_mfma_f32_16x16x32_bf16 v[112:115], a[136:139], a[232:235], v[112:115]
    v_exp_f32 v96, v96
    v_mfma_f32_16x16x32_bf16 v[112:115], a[140:143], a[236:239], v[112:115]
    buffer_load_dwordx4 v15, s[8:11], s82 offen offset:3072 lds
    v_mfma_f32_16x16x32_bf16 v[120:123], a[128:131], a[240:243], v[76:79]
    s_xor_b32 s15, s15, 196608
    v_exp_f32 v97, v97
    v_mfma_f32_16x16x32_bf16 v[120:123], a[132:135], a[244:247], v[120:123]
    s_add_u32 m0, s16, 0
    ds_read_b128 a[128:131], v18 offset:0
    v_cvt_pk_bf16_f32 v48, v96, v97
    v_mfma_f32_16x16x32_bf16 v[120:123], a[136:139], a[248:251], v[120:123]
    v_exp_f32 v98, v98
    v_mfma_f32_16x16x32_bf16 v[120:123], a[140:143], a[252:255], v[120:123]
    buffer_load_dwordx4 v1, s[8:11], s19 offen offset:0 lds
    v_mfma_f32_16x16x32_bf16 v[116:119], a[144:147], a[224:227], v[72:75]
    v_exp_f32 v99, v99
    v_mfma_f32_16x16x32_bf16 v[116:119], a[148:151], a[228:231], v[116:119]
    ds_read_b128 a[132:135], v18 offset:1024
    v_cvt_pk_bf16_f32 v49, v98, v99
    v_mfma_f32_16x16x32_bf16 v[116:119], a[152:155], a[232:235], v[116:119]
    v_exp_f32 v100, v100
    v_mfma_f32_16x16x32_bf16 v[116:119], a[156:159], a[236:239], v[116:119]
    buffer_load_dwordx4 v1, s[8:11], s19 offen offset:1024 lds
    v_mfma_f32_16x16x32_bf16 v[124:127], a[144:147], a[240:243], v[76:79]
    v_exp_f32 v101, v101
    v_mfma_f32_16x16x32_bf16 v[124:127], a[148:151], a[244:247], v[124:127]
    ds_read_b128 a[136:139], v18 offset:2048
    v_cvt_pk_bf16_f32 v50, v100, v101
    v_mfma_f32_16x16x32_bf16 v[124:127], a[152:155], a[248:251], v[124:127]
    v_exp_f32 v102, v102
    v_mfma_f32_16x16x32_bf16 v[124:127], a[156:159], a[252:255], v[124:127]
    buffer_load_dwordx4 v1, s[8:11], s19 offen offset:2048 lds
    v_mfma_f32_16x16x32_bf16 v[40:43], v[28:31], v[56:59], v[40:43]
    v_exp_f32 v103, v103
    v_mfma_f32_16x16x32_bf16 v[44:47], v[28:31], v[60:63], v[44:47]
    ds_read_b128 a[140:143], v18 offset:3072
    v_cvt_pk_bf16_f32 v51, v102, v103
    v_mfma_f32_16x16x32_bf16 v[192:195], a[160:163], v[56:59], v[192:195]
    v_exp_f32 v104, v104
    v_mfma_f32_16x16x32_bf16 v[224:227], a[160:163], v[60:63], v[224:227]
    v_mfma_f32_16x16x32_bf16 v[196:199], a[164:167], v[56:59], v[196:199]
    v_exp_f32 v105, v105
    v_mfma_f32_16x16x32_bf16 v[228:231], a[164:167], v[60:63], v[228:231]
    ds_read_b128 a[144:147], v18 offset:4096
    v_cvt_pk_bf16_f32 v52, v104, v105
    v_mfma_f32_16x16x32_bf16 v[200:203], a[168:171], v[56:59], v[200:203]
    v_exp_f32 v106, v106
    v_mfma_f32_16x16x32_bf16 v[232:235], a[168:171], v[60:63], v[232:235]
    buffer_load_dwordx4 v1, s[8:11], s19 offen offset:3072 lds
    v_mfma_f32_16x16x32_bf16 v[204:207], a[172:175], v[56:59], v[204:207]
    s_add_u32 m0, s16, 4096
    v_exp_f32 v107, v107
    v_mfma_f32_16x16x32_bf16 v[236:239], a[172:175], v[60:63], v[236:239]
    ds_read_b128 a[148:151], v18 offset:5120
    v_cvt_pk_bf16_f32 v53, v106, v107
    v_mfma_f32_16x16x32_bf16 v[208:211], a[176:179], v[56:59], v[208:211]
    v_exp_f32 v108, v108
    v_mfma_f32_16x16x32_bf16 v[240:243], a[176:179], v[60:63], v[240:243]
    buffer_load_dwordx4 v15, s[8:11], s19 offen offset:0 lds
    v_mfma_f32_16x16x32_bf16 v[212:215], a[180:183], v[56:59], v[212:215]
    v_exp_f32 v109, v109
    v_mfma_f32_16x16x32_bf16 v[244:247], a[180:183], v[60:63], v[244:247]
    ds_read_b128 a[152:155], v18 offset:6144
    v_cvt_pk_bf16_f32 v54, v108, v109
    v_mfma_f32_16x16x32_bf16 v[216:219], a[184:187], v[56:59], v[216:219]
    v_exp_f32 v110, v110
    v_mfma_f32_16x16x32_bf16 v[248:251], a[184:187], v[60:63], v[248:251]
    buffer_load_dwordx4 v15, s[8:11], s19 offen offset:1024 lds
    v_mfma_f32_16x16x32_bf16 v[220:223], a[188:191], v[56:59], v[220:223]
    v_exp_f32 v111, v111
    v_mfma_f32_16x16x32_bf16 v[252:255], a[188:191], v[60:63], v[252:255]
    ds_read_b128 a[156:159], v18 offset:7168
    v_cvt_pk_bf16_f32 v55, v110, v111
    s_waitcnt lgkmcnt(7)
    v_mfma_f32_16x16x32_bf16 v[96:99], a[128:131], a[192:195], v[64:67]
    s_waitcnt lgkmcnt(6)
    s_mul_i32 s17, s4, 229376
    s_mul_i32 s100, s3, 7168
    ds_read_b128 a[160:163], v19 offset:16384
    v_mfma_f32_16x16x32_bf16 v[96:99], a[132:135], a[196:199], v[96:99]
    s_waitcnt lgkmcnt(6)
    s_add_u32 s17, s17, s100
    s_lshl_b32 s100, s101, 7
    ds_read_b128 a[164:167], v19 offset:17408
    v_mfma_f32_16x16x32_bf16 v[96:99], a[136:139], a[200:203], v[96:99]
    s_waitcnt lgkmcnt(6)
    s_add_u32 s17, s17, s100
    v_exp_f32 v112, v112
    v_mfma_f32_16x16x32_bf16 v[96:99], a[140:143], a[204:207], v[96:99]
    buffer_load_dwordx4 v15, s[8:11], s19 offen offset:2048 lds
    v_mfma_f32_16x16x32_bf16 v[104:107], a[128:131], a[208:211], v[68:71]
    s_add_u32 s17, s17, 8388608
    v_exp_f32 v113, v113
    v_mfma_f32_16x16x32_bf16 v[104:107], a[132:135], a[212:215], v[104:107]
    s_cmp_lt_u32 s101, s26
    s_cselect_b32 s17, s17, 2147479552
    ds_read_b128 a[168:171], v19 offset:18432
    v_cvt_pk_bf16_f32 v56, v112, v113
    v_mfma_f32_16x16x32_bf16 v[104:107], a[136:139], a[216:219], v[104:107]
    s_waitcnt lgkmcnt(6)
    v_exp_f32 v114, v114
    v_mfma_f32_16x16x32_bf16 v[104:107], a[140:143], a[220:223], v[104:107]
    buffer_load_dwordx4 v15, s[8:11], s19 offen offset:3072 lds
    v_mfma_f32_16x16x32_bf16 v[100:103], a[144:147], a[192:195], v[64:67]
    s_waitcnt lgkmcnt(5)
    s_xor_b32 s16, s16, 98304
    v_exp_f32 v115, v115
    v_mfma_f32_16x16x32_bf16 v[100:103], a[148:151], a[196:199], v[100:103]
    s_waitcnt lgkmcnt(4)
    ds_read_b128 a[172:175], v19 offset:19456
    v_cvt_pk_bf16_f32 v57, v114, v115
    v_mfma_f32_16x16x32_bf16 v[100:103], a[152:155], a[200:203], v[100:103]
    s_waitcnt lgkmcnt(4)
    v_exp_f32 v116, v116
    v_mfma_f32_16x16x32_bf16 v[100:103], a[156:159], a[204:207], v[100:103]
    buffer_store_dwordx4 a[16:19], v13, s[8:11], s17 offen sc0 sc1
    v_mfma_f32_16x16x32_bf16 v[108:111], a[144:147], a[208:211], v[68:71]
    s_add_u32 s27, s18, 8388608
    v_exp_f32 v117, v117
    v_mfma_f32_16x16x32_bf16 v[108:111], a[148:151], a[212:215], v[108:111]
    ds_read_b128 a[176:179], v20 offset:20480
    v_cvt_pk_bf16_f32 v58, v116, v117
    v_mfma_f32_16x16x32_bf16 v[108:111], a[152:155], a[216:219], v[108:111]
    v_exp_f32 v118, v118
    v_mfma_f32_16x16x32_bf16 v[108:111], a[156:159], a[220:223], v[108:111]
    buffer_store_dwordx4 v[24:27], v17, s[8:11], s27 offen offset:768 sc0 sc1
    v_mfma_f32_16x16x32_bf16 v[32:35], v[28:31], v[48:51], v[32:35]
    s_add_u32 s27, s18, 8519680
    v_exp_f32 v119, v119
    v_mfma_f32_16x16x32_bf16 v[36:39], v[28:31], v[52:55], v[36:39]
    s_waitcnt lgkmcnt(4)
    ds_read_b128 a[180:183], v20 offset:21504
    v_cvt_pk_bf16_f32 v59, v118, v119
    v_mfma_f32_16x16x32_bf16 v[128:131], a[160:163], v[48:51], v[128:131]
    s_waitcnt lgkmcnt(4)
    v_exp_f32 v120, v120
    v_mfma_f32_16x16x32_bf16 v[160:163], a[160:163], v[52:55], v[160:163]
    buffer_store_dwordx4 v[24:27], v17, s[8:11], s27 offen offset:768 sc0 sc1
    v_mfma_f32_16x16x32_bf16 v[132:135], a[164:167], v[48:51], v[132:135]
    v_exp_f32 v121, v121
    v_mfma_f32_16x16x32_bf16 v[164:167], a[164:167], v[52:55], v[164:167]
    s_waitcnt lgkmcnt(3)
    ds_read_b128 a[184:187], v20 offset:22528
    v_cvt_pk_bf16_f32 v60, v120, v121
    v_mfma_f32_16x16x32_bf16 v[136:139], a[168:171], v[48:51], v[136:139]
    s_waitcnt lgkmcnt(3)
    v_exp_f32 v122, v122
    v_mfma_f32_16x16x32_bf16 v[168:171], a[168:171], v[52:55], v[168:171]
    buffer_load_dword v3, v4, s[8:11], s23 offen sc0 sc1
    v_mfma_f32_16x16x32_bf16 v[140:143], a[172:175], v[48:51], v[140:143]
    v_exp_f32 v123, v123
    v_mfma_f32_16x16x32_bf16 v[172:175], a[172:175], v[52:55], v[172:175]
    s_waitcnt lgkmcnt(2)
    ds_read_b128 a[188:191], v20 offset:23552
    v_cvt_pk_bf16_f32 v61, v122, v123
    v_mfma_f32_16x16x32_bf16 v[144:147], a[176:179], v[48:51], v[144:147]
    v_exp_f32 v124, v124
    v_mfma_f32_16x16x32_bf16 v[176:179], a[176:179], v[52:55], v[176:179]
    s_waitcnt lgkmcnt(2)
    v_mfma_f32_16x16x32_bf16 v[148:151], a[180:183], v[48:51], v[148:151]
    v_exp_f32 v125, v125
    v_mfma_f32_16x16x32_bf16 v[180:183], a[180:183], v[52:55], v[180:183]
    s_waitcnt lgkmcnt(1)
    v_cvt_pk_bf16_f32 v62, v124, v125
    v_xor_b32 v19, 98304, v19
    v_mfma_f32_16x16x32_bf16 v[152:155], a[184:187], v[48:51], v[152:155]
    v_exp_f32 v126, v126
    v_mfma_f32_16x16x32_bf16 v[184:187], a[184:187], v[52:55], v[184:187]
    s_waitcnt lgkmcnt(0)
    v_xor_b32 v20, 98304, v20
    v_mfma_f32_16x16x32_bf16 v[156:159], a[188:191], v[48:51], v[156:159]
    v_exp_f32 v127, v127
    v_mfma_f32_16x16x32_bf16 v[188:191], a[188:191], v[52:55], v[188:191]
    v_cvt_pk_bf16_f32 v63, v126, v127
    v_mfma_f32_16x16x32_bf16 v[112:115], a[128:131], a[224:227], v[72:75]
    v_exp_f32 v96, v96
    v_mfma_f32_16x16x32_bf16 v[112:115], a[132:135], a[228:231], v[112:115]
    buffer_store_dwordx4 a[20:23], v13, s[8:11], s17 offen offset:3584 sc0 sc1
    v_mfma_f32_16x16x32_bf16 v[112:115], a[136:139], a[232:235], v[112:115]
    v_exp_f32 v97, v97
    v_mfma_f32_16x16x32_bf16 v[112:115], a[140:143], a[236:239], v[112:115]
    v_cvt_pk_bf16_f32 v48, v96, v97
    v_lshlrev_b32 v12, 3, v0
    v_mfma_f32_16x16x32_bf16 v[120:123], a[128:131], a[240:243], v[76:79]
    s_lshl_b32 s101, s2, 11
    v_exp_f32 v98, v98
    v_mfma_f32_16x16x32_bf16 v[120:123], a[132:135], a[244:247], v[120:123]
    v_add_f32 v80, 0, v21
    v_min_f32 v80, v80, v64
    v_mfma_f32_16x16x32_bf16 v[120:123], a[136:139], a[248:251], v[120:123]
    s_add_u32 s101, s101, 524288
    v_exp_f32 v99, v99
    v_mfma_f32_16x16x32_bf16 v[120:123], a[140:143], a[252:255], v[120:123]
    buffer_store_dwordx2 v[24:25], v12, s[8:11], s101 offen sc0 sc1
    v_mfma_f32_16x16x32_bf16 v[116:119], a[144:147], a[224:227], v[72:75]
    s_lshl_b32 s101, s2, 6
    v_exp_f32 v100, v100
    v_mfma_f32_16x16x32_bf16 v[116:119], a[148:151], a[228:231], v[116:119]
    s_add_u32 s101, s101, 65536
    ds_read_b128 a[128:131], v18 offset:16384
    v_cvt_pk_bf16_f32 v49, v98, v99
    v_mfma_f32_16x16x32_bf16 v[116:119], a[152:155], a[232:235], v[116:119]
    s_add_u32 s19, s82, 32768
    v_exp_f32 v101, v101
    v_mfma_f32_16x16x32_bf16 v[116:119], a[156:159], a[236:239], v[116:119]
    s_sub_u32 s82, s12, s13
    ds_read_b128 a[132:135], v18 offset:17408
    v_cvt_pk_bf16_f32 v50, v100, v101
    v_mfma_f32_16x16x32_bf16 v[124:127], a[144:147], a[240:243], v[76:79]
    s_sub_u32 s82, s82, 1
    v_exp_f32 v102, v102
    v_mfma_f32_16x16x32_bf16 v[124:127], a[148:151], a[244:247], v[124:127]
    s_cmp_gt_u32 s12, s13
    s_cselect_b32 s82, s82, s12
    s_lshl_b32 s82, s82, 16
    ds_read_b128 a[136:139], v18 offset:18432
    v_mfma_f32_16x16x32_bf16 v[124:127], a[152:155], a[248:251], v[124:127]
    s_add_u32 s82, s82, s81
    v_exp_f32 v103, v103
    v_mfma_f32_16x16x32_bf16 v[124:127], a[156:159], a[252:255], v[124:127]
    s_cmp_ge_u32 s12, 17
    s_cselect_b32 s82, 2147471360, s82
    ds_read_b128 a[140:143], v18 offset:19456
    v_cvt_pk_bf16_f32 v51, v102, v103
    v_mfma_f32_16x16x32_bf16 v[40:43], v[28:31], v[56:59], v[40:43]
    s_add_u32 s12, s12, 1
    v_exp_f32 v104, v104
    v_mfma_f32_16x16x32_bf16 v[44:47], v[28:31], v[60:63], v[44:47]
    ds_read_b128 a[144:147], v18 offset:20480
    v_mov_b32 v13, 0
    v_mfma_f32_16x16x32_bf16 v[192:195], a[160:163], v[56:59], v[192:195]
    v_exp_f32 v105, v105
    v_mfma_f32_16x16x32_bf16 v[224:227], a[160:163], v[60:63], v[224:227]
    ds_read_b128 a[148:151], v18 offset:21504
    v_cvt_pk_bf16_f32 v52, v104, v105
    v_mfma_f32_16x16x32_bf16 v[196:199], a[164:167], v[56:59], v[196:199]
    v_exp_f32 v106, v106
    v_mfma_f32_16x16x32_bf16 v[228:231], a[164:167], v[60:63], v[228:231]
    ds_read_b128 a[152:155], v18 offset:22528
    v_add_f32 v81, 0xf1800000, v21
    v_mfma_f32_16x16x32_bf16 v[200:203], a[168:171], v[56:59], v[200:203]
    v_exp_f32 v107, v107
    v_mfma_f32_16x16x32_bf16 v[232:235], a[168:171], v[60:63], v[232:235]
    ds_read_b128 a[156:159], v18 offset:23552
    v_cvt_pk_bf16_f32 v53, v106, v107
    v_mfma_f32_16x16x32_bf16 v[204:207], a[172:175], v[56:59], v[204:207]
    v_exp_f32 v108, v108
    v_mfma_f32_16x16x32_bf16 v[236:239], a[172:175], v[60:63], v[236:239]
    buffer_store_dword v13, v7, s[8:11], s101 offen sc0 sc1
    v_mfma_f32_16x16x32_bf16 v[208:211], a[176:179], v[56:59], v[208:211]
    s_lshl_b32 s101, s66, 6
    v_exp_f32 v109, v109
    v_mfma_f32_16x16x32_bf16 v[240:243], a[176:179], v[60:63], v[240:243]
    s_add_u32 s101, s101, 81920
    v_cvt_pk_bf16_f32 v54, v108, v109
    v_xor_b32 v18, 196608, v18
    v_mfma_f32_16x16x32_bf16 v[212:215], a[180:183], v[56:59], v[212:215]
    v_exp_f32 v110, v110
    v_mfma_f32_16x16x32_bf16 v[244:247], a[180:183], v[60:63], v[244:247]
    buffer_store_dwordx4 v[24:27], v7, s[8:11], s101 offen sc0 sc1
    v_mfma_f32_16x16x32_bf16 v[216:219], a[184:187], v[56:59], v[216:219]
    v_exp_f32 v111, v111
    v_mfma_f32_16x16x32_bf16 v[248:251], a[184:187], v[60:63], v[248:251]
    v_cvt_pk_bf16_f32 v55, v110, v111
    v_min_f32 v81, v81, v65
    v_mfma_f32_16x16x32_bf16 v[220:223], a[188:191], v[56:59], v[220:223]
    buffer_store_dwordx4 v[24:27], v7, s[8:11], s101 offen offset:16 sc0 sc1
    v_mfma_f32_16x16x32_bf16 v[252:255], a[188:191], v[60:63], v[252:255]
    v_add_f32 v82, 0xf2000000, v21
    v_min_f32 v82, v82, v66
    s_waitcnt vmcnt(9) lgkmcnt(0)
    s_barrier
    v_mfma_f32_16x16x32_bf16 v[96:99], a[128:131], a[192:195], v[64:67]
    s_add_u32 m0, s15, 0
    ds_read_b128 a[160:163], v19 offset:0
    v_mfma_f32_16x16x32_bf16 v[96:99], a[132:135], a[196:199], v[96:99]
    ds_read_b128 a[164:167], v19 offset:1024
    v_mfma_f32_16x16x32_bf16 v[96:99], a[136:139], a[200:203], v[96:99]
    v_exp_f32 v112, v112
    v_mfma_f32_16x16x32_bf16 v[96:99], a[140:143], a[204:207], v[96:99]
    buffer_load_dwordx4 v1, s[8:11], s82 offen offset:0 lds
    v_mfma_f32_16x16x32_bf16 v[104:107], a[128:131], a[208:211], v[68:71]
    v_exp_f32 v113, v113
    v_mfma_f32_16x16x32_bf16 v[104:107], a[132:135], a[212:215], v[104:107]
    ds_read_b128 a[168:171], v19 offset:2048
    v_cvt_pk_bf16_f32 v56, v112, v113
    v_mfma_f32_16x16x32_bf16 v[104:107], a[136:139], a[216:219], v[104:107]
    v_exp_f32 v114, v114
    v_mfma_f32_16x16x32_bf16 v[104:107], a[140:143], a[220:223], v[104:107]
    buffer_load_dwordx4 v1, s[8:11], s82 offen offset:1024 lds
    v_mfma_f32_16x16x32_bf16 v[100:103], a[144:147], a[192:195], v[64:67]
    v_exp_f32 v115, v115
    v_mfma_f32_16x16x32_bf16 v[100:103], a[148:151], a[196:199], v[100:103]
    ds_read_b128 a[172:175], v19 offset:3072
    v_cvt_pk_bf16_f32 v57, v114, v115
    v_mfma_f32_16x16x32_bf16 v[100:103], a[152:155], a[200:203], v[100:103]
    v_exp_f32 v116, v116
    v_mfma_f32_16x16x32_bf16 v[100:103], a[156:159], a[204:207], v[100:103]
    buffer_load_dwordx4 v1, s[8:11], s82 offen offset:2048 lds
    v_mfma_f32_16x16x32_bf16 v[108:111], a[144:147], a[208:211], v[68:71]
    v_exp_f32 v117, v117
    v_mfma_f32_16x16x32_bf16 v[108:111], a[148:151], a[212:215], v[108:111]
    ds_read_b128 a[176:179], v20 offset:4096
    v_cvt_pk_bf16_f32 v58, v116, v117
    v_mfma_f32_16x16x32_bf16 v[108:111], a[152:155], a[216:219], v[108:111]
    v_exp_f32 v118, v118
    v_mfma_f32_16x16x32_bf16 v[108:111], a[156:159], a[220:223], v[108:111]
    buffer_load_dwordx4 v1, s[8:11], s82 offen offset:3072 lds
    v_mfma_f32_16x16x32_bf16 v[32:35], v[28:31], v[48:51], v[32:35]
    s_add_u32 m0, s15, 4096
    v_exp_f32 v119, v119
    v_mfma_f32_16x16x32_bf16 v[36:39], v[28:31], v[52:55], v[36:39]
    s_waitcnt lgkmcnt(4)
    ds_read_b128 a[180:183], v20 offset:5120
    v_cvt_pk_bf16_f32 v59, v118, v119
    v_mfma_f32_16x16x32_bf16 v[128:131], a[160:163], v[48:51], v[128:131]
    v_exp_f32 v120, v120
    v_mfma_f32_16x16x32_bf16 v[160:163], a[160:163], v[52:55], v[160:163]
    s_waitcnt lgkmcnt(4)
    v_mfma_f32_16x16x32_bf16 v[132:135], a[164:167], v[48:51], v[132:135]
    v_exp_f32 v121, v121
    v_mfma_f32_16x16x32_bf16 v[164:167], a[164:167], v[52:55], v[164:167]
    s_waitcnt lgkmcnt(3)
    ds_read_b128 a[184:187], v20 offset:6144
    v_cvt_pk_bf16_f32 v60, v120, v121
    v_mfma_f32_16x16x32_bf16 v[136:139], a[168:171], v[48:51], v[136:139]
    s_waitcnt lgkmcnt(3)
    v_exp_f32 v122, v122
    v_mfma_f32_16x16x32_bf16 v[168:171], a[168:171], v[52:55], v[168:171]
    buffer_load_dwordx4 v15, s[8:11], s82 offen offset:0 lds
    v_mfma_f32_16x16x32_bf16 v[140:143], a[172:175], v[48:51], v[140:143]
    v_exp_f32 v123, v123
    v_mfma_f32_16x16x32_bf16 v[172:175], a[172:175], v[52:55], v[172:175]
    s_waitcnt lgkmcnt(2)
    ds_read_b128 a[188:191], v20 offset:7168
    v_cvt_pk_bf16_f32 v61, v122, v123
    v_mfma_f32_16x16x32_bf16 v[144:147], a[176:179], v[48:51], v[144:147]
    s_waitcnt lgkmcnt(2)
    v_exp_f32 v124, v124
    v_mfma_f32_16x16x32_bf16 v[176:179], a[176:179], v[52:55], v[176:179]
    buffer_load_dwordx4 v15, s[8:11], s82 offen offset:1024 lds
    v_mfma_f32_16x16x32_bf16 v[148:151], a[180:183], v[48:51], v[148:151]
    v_exp_f32 v125, v125
    v_mfma_f32_16x16x32_bf16 v[180:183], a[180:183], v[52:55], v[180:183]
    s_waitcnt lgkmcnt(1)
    v_cvt_pk_bf16_f32 v62, v124, v125
    v_mfma_f32_16x16x32_bf16 v[152:155], a[184:187], v[48:51], v[152:155]
    s_waitcnt lgkmcnt(0)
    v_exp_f32 v126, v126
    v_mfma_f32_16x16x32_bf16 v[184:187], a[184:187], v[52:55], v[184:187]
    buffer_load_dwordx4 v15, s[8:11], s82 offen offset:2048 lds
    v_mfma_f32_16x16x32_bf16 v[156:159], a[188:191], v[48:51], v[156:159]
    v_exp_f32 v127, v127
    v_mfma_f32_16x16x32_bf16 v[188:191], a[188:191], v[52:55], v[188:191]
    v_cvt_pk_bf16_f32 v63, v126, v127
    v_mfma_f32_16x16x32_bf16 v[112:115], a[128:131], a[224:227], v[72:75]
    v_mfma_f32_16x16x32_bf16 v[112:115], a[132:135], a[228:231], v[112:115]
    v_mfma_f32_16x16x32_bf16 v[112:115], a[136:139], a[232:235], v[112:115]
    v_exp_f32 v96, v96
    v_mfma_f32_16x16x32_bf16 v[112:115], a[140:143], a[236:239], v[112:115]
    buffer_load_dwordx4 v15, s[8:11], s82 offen offset:3072 lds
    v_mfma_f32_16x16x32_bf16 v[120:123], a[128:131], a[240:243], v[76:79]
    s_xor_b32 s15, s15, 196608
    v_exp_f32 v97, v97
    v_mfma_f32_16x16x32_bf16 v[120:123], a[132:135], a[244:247], v[120:123]
    s_add_u32 m0, s16, 0
    ds_read_b128 a[128:131], v18 offset:0
    v_cvt_pk_bf16_f32 v48, v96, v97
    v_mfma_f32_16x16x32_bf16 v[120:123], a[136:139], a[248:251], v[120:123]
    v_exp_f32 v98, v98
    v_mfma_f32_16x16x32_bf16 v[120:123], a[140:143], a[252:255], v[120:123]
    buffer_load_dwordx4 v1, s[8:11], s19 offen offset:0 lds
    v_mfma_f32_16x16x32_bf16 v[116:119], a[144:147], a[224:227], v[72:75]
    v_exp_f32 v99, v99
    v_mfma_f32_16x16x32_bf16 v[116:119], a[148:151], a[228:231], v[116:119]
    ds_read_b128 a[132:135], v18 offset:1024
    v_cvt_pk_bf16_f32 v49, v98, v99
    v_mfma_f32_16x16x32_bf16 v[116:119], a[152:155], a[232:235], v[116:119]
    v_exp_f32 v100, v100
    v_mfma_f32_16x16x32_bf16 v[116:119], a[156:159], a[236:239], v[116:119]
    buffer_load_dwordx4 v1, s[8:11], s19 offen offset:1024 lds
    v_mfma_f32_16x16x32_bf16 v[124:127], a[144:147], a[240:243], v[76:79]
    v_exp_f32 v101, v101
    v_mfma_f32_16x16x32_bf16 v[124:127], a[148:151], a[244:247], v[124:127]
    ds_read_b128 a[136:139], v18 offset:2048
    v_cvt_pk_bf16_f32 v50, v100, v101
    v_mfma_f32_16x16x32_bf16 v[124:127], a[152:155], a[248:251], v[124:127]
    v_exp_f32 v102, v102
    v_mfma_f32_16x16x32_bf16 v[124:127], a[156:159], a[252:255], v[124:127]
    buffer_load_dwordx4 v1, s[8:11], s19 offen offset:2048 lds
    v_mfma_f32_16x16x32_bf16 v[40:43], v[28:31], v[56:59], v[40:43]
    v_exp_f32 v103, v103
    v_mfma_f32_16x16x32_bf16 v[44:47], v[28:31], v[60:63], v[44:47]
    ds_read_b128 a[140:143], v18 offset:3072
    v_cvt_pk_bf16_f32 v51, v102, v103
    v_mfma_f32_16x16x32_bf16 v[192:195], a[160:163], v[56:59], v[192:195]
    v_exp_f32 v104, v104
    v_mfma_f32_16x16x32_bf16 v[224:227], a[160:163], v[60:63], v[224:227]
    v_mfma_f32_16x16x32_bf16 v[196:199], a[164:167], v[56:59], v[196:199]
    v_exp_f32 v105, v105
    v_mfma_f32_16x16x32_bf16 v[228:231], a[164:167], v[60:63], v[228:231]
    ds_read_b128 a[144:147], v18 offset:4096
    v_cvt_pk_bf16_f32 v52, v104, v105
    v_mfma_f32_16x16x32_bf16 v[200:203], a[168:171], v[56:59], v[200:203]
    v_exp_f32 v106, v106
    v_mfma_f32_16x16x32_bf16 v[232:235], a[168:171], v[60:63], v[232:235]
    buffer_load_dwordx4 v1, s[8:11], s19 offen offset:3072 lds
    v_mfma_f32_16x16x32_bf16 v[204:207], a[172:175], v[56:59], v[204:207]
    s_add_u32 m0, s16, 4096
    v_exp_f32 v107, v107
    v_mfma_f32_16x16x32_bf16 v[236:239], a[172:175], v[60:63], v[236:239]
    ds_read_b128 a[148:151], v18 offset:5120
    v_cvt_pk_bf16_f32 v53, v106, v107
    v_mfma_f32_16x16x32_bf16 v[208:211], a[176:179], v[56:59], v[208:211]
    v_exp_f32 v108, v108
    v_mfma_f32_16x16x32_bf16 v[240:243], a[176:179], v[60:63], v[240:243]
    buffer_load_dwordx4 v15, s[8:11], s19 offen offset:0 lds
    v_mfma_f32_16x16x32_bf16 v[212:215], a[180:183], v[56:59], v[212:215]
    v_exp_f32 v109, v109
    v_mfma_f32_16x16x32_bf16 v[244:247], a[180:183], v[60:63], v[244:247]
    ds_read_b128 a[152:155], v18 offset:6144
    v_cvt_pk_bf16_f32 v54, v108, v109
    v_mfma_f32_16x16x32_bf16 v[216:219], a[184:187], v[56:59], v[216:219]
    v_exp_f32 v110, v110
    v_mfma_f32_16x16x32_bf16 v[248:251], a[184:187], v[60:63], v[248:251]
    buffer_load_dwordx4 v15, s[8:11], s19 offen offset:1024 lds
    v_mfma_f32_16x16x32_bf16 v[220:223], a[188:191], v[56:59], v[220:223]
    v_exp_f32 v111, v111
    v_mfma_f32_16x16x32_bf16 v[252:255], a[188:191], v[60:63], v[252:255]
    ds_read_b128 a[156:159], v18 offset:7168
    v_cvt_pk_bf16_f32 v55, v110, v111
    s_waitcnt lgkmcnt(7)
    v_mfma_f32_16x16x32_bf16 v[96:99], a[128:131], a[192:195], v[64:67]
    s_waitcnt lgkmcnt(6)
    s_lshl_b32 s24, s60, 2
    s_add_u32 s24, s24, s3
    ds_read_b128 a[160:163], v19 offset:16384
    v_mfma_f32_16x16x32_bf16 v[96:99], a[132:135], a[196:199], v[96:99]
    s_waitcnt lgkmcnt(6)
    s_lshl_b32 s24, s24, 3
    s_add_u32 s24, s24, s4
    ds_read_b128 a[164:167], v19 offset:17408
    v_mfma_f32_16x16x32_bf16 v[96:99], a[136:139], a[200:203], v[96:99]
    s_waitcnt lgkmcnt(6)
    s_lshl_b32 s24, s24, 2
    v_exp_f32 v112, v112
    v_mfma_f32_16x16x32_bf16 v[96:99], a[140:143], a[204:207], v[96:99]
    buffer_load_dwordx4 v15, s[8:11], s19 offen offset:2048 lds
    v_mfma_f32_16x16x32_bf16 v[104:107], a[128:131], a[208:211], v[68:71]
    s_add_u32 s24, s24, s5
    v_exp_f32 v113, v113
    v_mfma_f32_16x16x32_bf16 v[104:107], a[132:135], a[212:215], v[104:107]
    s_lshl_b32 s24, s24, 13
    ds_read_b128 a[168:171], v19 offset:18432
    v_cvt_pk_bf16_f32 v56, v112, v113
    v_mfma_f32_16x16x32_bf16 v[104:107], a[136:139], a[216:219], v[104:107]
    s_waitcnt lgkmcnt(6)
    s_add_u32 s24, s24, 50331648
    v_exp_f32 v114, v114
    s_waitcnt vmcnt(20)
    v_cmp_ne_u32 vcc, 0, v3
    s_cmp_eq_u64 vcc, -1
    s_cbranch_scc0 L_C1_slow_9
L_C1_ok_10:
    v_mfma_f32_16x16x32_bf16 v[104:107], a[140:143], a[220:223], v[104:107]
    buffer_load_dwordx4 v15, s[8:11], s19 offen offset:3072 lds
    v_mfma_f32_16x16x32_bf16 v[100:103], a[144:147], a[192:195], v[64:67]
    s_waitcnt lgkmcnt(5)
    s_xor_b32 s16, s16, 98304
    v_exp_f32 v115, v115
    v_mfma_f32_16x16x32_bf16 v[100:103], a[148:151], a[196:199], v[100:103]
    s_waitcnt lgkmcnt(4)
    s_xor_b32 s74, s24, 0
    ds_read_b128 a[172:175], v19 offset:19456
    v_cvt_pk_bf16_f32 v57, v114, v115
    v_mfma_f32_16x16x32_bf16 v[100:103], a[152:155], a[200:203], v[100:103]
    s_waitcnt lgkmcnt(4)
    v_exp_f32 v116, v116
    v_mfma_f32_16x16x32_bf16 v[100:103], a[156:159], a[204:207], v[100:103]
    buffer_load_dwordx4 a[64:67], v1, s[8:11], s74 offen offset:0
    v_mfma_f32_16x16x32_bf16 v[108:111], a[144:147], a[208:211], v[68:71]
    s_xor_b32 s74, s24, 0
    v_exp_f32 v117, v117
    v_mfma_f32_16x16x32_bf16 v[108:111], a[148:151], a[212:215], v[108:111]
    ds_read_b128 a[176:179], v20 offset:20480
    v_cvt_pk_bf16_f32 v58, v116, v117
    v_mfma_f32_16x16x32_bf16 v[108:111], a[152:155], a[216:219], v[108:111]
    v_exp_f32 v118, v118
    v_mfma_f32_16x16x32_bf16 v[108:111], a[156:159], a[220:223], v[108:111]
    buffer_load_dwordx4 a[68:71], v1, s[8:11], s74 offen offset:1024
    v_mfma_f32_16x16x32_bf16 v[32:35], v[28:31], v[48:51], v[32:35]
    s_xor_b32 s74, s24, 0
    v_exp_f32 v119, v119
    v_mfma_f32_16x16x32_bf16 v[36:39], v[28:31], v[52:55], v[36:39]
    s_waitcnt lgkmcnt(4)
    ds_read_b128 a[180:183], v20 offset:21504
    v_cvt_pk_bf16_f32 v59, v118, v119
    v_mfma_f32_16x16x32_bf16 v[128:131], a[160:163], v[48:51], v[128:131]
    s_waitcnt lgkmcnt(4)
    v_exp_f32 v120, v120
    v_mfma_f32_16x16x32_bf16 v[160:163], a[160:163], v[52:55], v[160:163]
    buffer_load_dwordx4 a[72:75], v1, s[8:11], s74 offen offset:2048
    v_mfma_f32_16x16x32_bf16 v[132:135], a[164:167], v[48:51], v[132:135]
    s_xor_b32 s74, s24, 0
    v_exp_f32 v121, v121
    v_mfma_f32_16x16x32_bf16 v[164:167], a[164:167], v[52:55], v[164:167]
    s_waitcnt lgkmcnt(3)
    ds_read_b128 a[184:187], v20 offset:22528
    v_cvt_pk_bf16_f32 v60, v120, v121
    v_mfma_f32_16x16x32_bf16 v[136:139], a[168:171], v[48:51], v[136:139]
    s_waitcnt lgkmcnt(3)
    v_exp_f32 v122, v122
    v_mfma_f32_16x16x32_bf16 v[168:171], a[168:171], v[52:55], v[168:171]
    buffer_load_dwordx4 a[76:79], v1, s[8:11], s74 offen offset:3072
    v_mfma_f32_16x16x32_bf16 v[140:143], a[172:175], v[48:51], v[140:143]
    s_xor_b32 s74, s24, 4096
    v_exp_f32 v123, v123
    v_mfma_f32_16x16x32_bf16 v[172:175], a[172:175], v[52:55], v[172:175]
    s_waitcnt lgkmcnt(2)
    ds_read_b128 a[188:191], v20 offset:23552
    v_cvt_pk_bf16_f32 v61, v122, v123
    v_mfma_f32_16x16x32_bf16 v[144:147], a[176:179], v[48:51], v[144:147]
    s_waitcnt lgkmcnt(2)
    v_exp_f32 v124, v124
    v_mfma_f32_16x16x32_bf16 v[176:179], a[176:179], v[52:55], v[176:179]
    buffer_load_dwordx4 a[80:83], v1, s[8:11], s74 offen offset:0
    v_mfma_f32_16x16x32_bf16 v[148:151], a[180:183], v[48:51], v[148:151]
    v_exp_f32 v125, v125
    v_mfma_f32_16x16x32_bf16 v[180:183], a[180:183], v[52:55], v[180:183]
    s_waitcnt lgkmcnt(1)
    v_cvt_pk_bf16_f32 v62, v124, v125
    v_xor_b32 v19, 98304, v19
    v_mfma_f32_16x16x32_bf16 v[152:155], a[184:187], v[48:51], v[152:155]
    v_exp_f32 v126, v126
    v_mfma_f32_16x16x32_bf16 v[184:187], a[184:187], v[52:55], v[184:187]
    s_waitcnt lgkmcnt(0)
    v_xor_b32 v20, 98304, v20
    v_mfma_f32_16x16x32_bf16 v[156:159], a[188:191], v[48:51], v[156:159]
    v_exp_f32 v127, v127
    v_mfma_f32_16x16x32_bf16 v[188:191], a[188:191], v[52:55], v[188:191]
    v_cvt_pk_bf16_f32 v63, v126, v127
    v_mfma_f32_16x16x32_bf16 v[112:115], a[128:131], a[224:227], v[72:75]
    s_add_u32 m0, s62, 32768
    v_exp_f32 v96, v96
    v_mfma_f32_16x16x32_bf16 v[112:115], a[132:135], a[228:231], v[112:115]
    v_add_f32 v83, 0xf2400000, v21
    v_min_f32 v83, v83, v67
    v_mfma_f32_16x16x32_bf16 v[112:115], a[136:139], a[232:235], v[112:115]
    s_xor_b32 s98, s65, 0
    v_exp_f32 v97, v97
    v_mfma_f32_16x16x32_bf16 v[112:115], a[140:143], a[236:239], v[112:115]
    v_cvt_pk_bf16_f32 v48, v96, v97
    v_add_f32 v84, 0xf3800000, v21
    v_mfma_f32_16x16x32_bf16 v[120:123], a[128:131], a[240:243], v[76:79]
    v_exp_f32 v98, v98
    v_mfma_f32_16x16x32_bf16 v[120:123], a[132:135], a[244:247], v[120:123]
    buffer_load_dwordx4 v8, s[28:31], s98 offen offset:0  lds
    v_mfma_f32_16x16x32_bf16 v[120:123], a[136:139], a[248:251], v[120:123]
    v_exp_f32 v99, v99
    v_mfma_f32_16x16x32_bf16 v[120:123], a[140:143], a[252:255], v[120:123]
    buffer_load_dwordx4 v9, s[28:31], s98 offen offset:1024  lds
    v_mfma_f32_16x16x32_bf16 v[116:119], a[144:147], a[224:227], v[72:75]
    v_exp_f32 v100, v100
    v_mfma_f32_16x16x32_bf16 v[116:119], a[148:151], a[228:231], v[116:119]
    ds_read_b128 a[128:131], v18 offset:16384
    v_cvt_pk_bf16_f32 v49, v98, v99
    v_mfma_f32_16x16x32_bf16 v[116:119], a[152:155], a[232:235], v[116:119]
    s_add_u32 s19, s82, 32768
    v_exp_f32 v101, v101
    v_mfma_f32_16x16x32_bf16 v[116:119], a[156:159], a[236:239], v[116:119]
    s_sub_u32 s82, s12, s13
    ds_read_b128 a[132:135], v18 offset:17408
    v_cvt_pk_bf16_f32 v50, v100, v101
    v_mfma_f32_16x16x32_bf16 v[124:127], a[144:147], a[240:243], v[76:79]
    s_sub_u32 s82, s82, 1
    v_exp_f32 v102, v102
    v_mfma_f32_16x16x32_bf16 v[124:127], a[148:151], a[244:247], v[124:127]
    s_cmp_gt_u32 s12, s13
    s_cselect_b32 s82, s82, s12
    s_lshl_b32 s82, s82, 16
    ds_read_b128 a[136:139], v18 offset:18432
    v_mfma_f32_16x16x32_bf16 v[124:127], a[152:155], a[248:251], v[124:127]
    s_add_u32 s82, s82, s81
    v_exp_f32 v103, v103
    v_mfma_f32_16x16x32_bf16 v[124:127], a[156:159], a[252:255], v[124:127]
    s_cmp_ge_u32 s12, 17
    s_cselect_b32 s82, 2147471360, s82
    ds_read_b128 a[140:143], v18 offset:19456
    v_cvt_pk_bf16_f32 v51, v102, v103
    v_mfma_f32_16x16x32_bf16 v[40:43], v[28:31], v[56:59], v[40:43]
    s_add_u32 s12, s12, 1
    v_exp_f32 v104, v104
    v_mfma_f32_16x16x32_bf16 v[44:47], v[28:31], v[60:63], v[44:47]
    ds_read_b128 a[144:147], v18 offset:20480
    v_min_f32 v84, v84, v64
    v_mfma_f32_16x16x32_bf16 v[192:195], a[160:163], v[56:59], v[192:195]
    v_exp_f32 v105, v105
    v_mfma_f32_16x16x32_bf16 v[224:227], a[160:163], v[60:63], v[224:227]
    ds_read_b128 a[148:151], v18 offset:21504
    v_cvt_pk_bf16_f32 v52, v104, v105
    v_mfma_f32_16x16x32_bf16 v[196:199], a[164:167], v[56:59], v[196:199]
    v_exp_f32 v106, v106
    v_mfma_f32_16x16x32_bf16 v[228:231], a[164:167], v[60:63], v[228:231]
    ds_read_b128 a[152:155], v18 offset:22528
    v_add_f32 v85, 0xf3880000, v21
    v_mfma_f32_16x16x32_bf16 v[200:203], a[168:171], v[56:59], v[200:203]
    v_exp_f32 v107, v107
    v_mfma_f32_16x16x32_bf16 v[232:235], a[168:171], v[60:63], v[232:235]
    ds_read_b128 a[156:159], v18 offset:23552
    v_cvt_pk_bf16_f32 v53, v106, v107
    v_mfma_f32_16x16x32_bf16 v[204:207], a[172:175], v[56:59], v[204:207]
    v_exp_f32 v108, v108
    v_mfma_f32_16x16x32_bf16 v[236:239], a[172:175], v[60:63], v[236:239]
    buffer_load_dwordx4 v10, s[28:31], s98 offen offset:2048  lds
    v_mfma_f32_16x16x32_bf16 v[208:211], a[176:179], v[56:59], v[208:211]
    v_exp_f32 v109, v109
    v_mfma_f32_16x16x32_bf16 v[240:243], a[176:179], v[60:63], v[240:243]
    v_cvt_pk_bf16_f32 v54, v108, v109
    v_xor_b32 v18, 196608, v18
    v_mfma_f32_16x16x32_bf16 v[212:215], a[180:183], v[56:59], v[212:215]
    v_exp_f32 v110, v110
    v_mfma_f32_16x16x32_bf16 v[244:247], a[180:183], v[60:63], v[244:247]
    buffer_load_dwordx4 v11, s[28:31], s98 offen offset:3072  lds
    v_mfma_f32_16x16x32_bf16 v[216:219], a[184:187], v[56:59], v[216:219]
    s_xor_b32 s74, s24, 4096
    v_exp_f32 v111, v111
    v_mfma_f32_16x16x32_bf16 v[248:251], a[184:187], v[60:63], v[248:251]
    v_cvt_pk_bf16_f32 v55, v110, v111
    v_min_f32 v85, v85, v65
    v_mfma_f32_16x16x32_bf16 v[220:223], a[188:191], v[56:59], v[220:223]
    buffer_load_dwordx4 a[84:87], v1, s[8:11], s74 offen offset:1024
    v_mfma_f32_16x16x32_bf16 v[252:255], a[188:191], v[60:63], v[252:255]
    s_xor_b32 s74, s24, 4096
    buffer_load_dwordx4 a[88:91], v1, s[8:11], s74 offen offset:2048
    s_xor_b32 s74, s24, 4096
    buffer_load_dwordx4 a[92:95], v1, s[8:11], s74 offen offset:3072
    s_waitcnt vmcnt(12) lgkmcnt(0)
    s_barrier
    v_mfma_f32_16x16x32_bf16 v[96:99], a[128:131], a[192:195], v[64:67]
    s_add_u32 m0, s15, 0
    ds_read_b128 a[160:163], v19 offset:0
    v_mfma_f32_16x16x32_bf16 v[96:99], a[132:135], a[196:199], v[96:99]
    ds_read_b128 a[164:167], v19 offset:1024
    v_mfma_f32_16x16x32_bf16 v[96:99], a[136:139], a[200:203], v[96:99]
    v_exp_f32 v112, v112
    v_mfma_f32_16x16x32_bf16 v[96:99], a[140:143], a[204:207], v[96:99]
    buffer_load_dwordx4 v1, s[8:11], s82 offen offset:0 lds
    v_mfma_f32_16x16x32_bf16 v[104:107], a[128:131], a[208:211], v[68:71]
    v_exp_f32 v113, v113
    v_mfma_f32_16x16x32_bf16 v[104:107], a[132:135], a[212:215], v[104:107]
    ds_read_b128 a[168:171], v19 offset:2048
    v_cvt_pk_bf16_f32 v56, v112, v113
    v_mfma_f32_16x16x32_bf16 v[104:107], a[136:139], a[216:219], v[104:107]
    v_exp_f32 v114, v114
    v_mfma_f32_16x16x32_bf16 v[104:107], a[140:143], a[220:223], v[104:107]
    buffer_load_dwordx4 v1, s[8:11], s82 offen offset:1024 lds
    v_mfma_f32_16x16x32_bf16 v[100:103], a[144:147], a[192:195], v[64:67]
    v_exp_f32 v115, v115
    v_mfma_f32_16x16x32_bf16 v[100:103], a[148:151], a[196:199], v[100:103]
    ds_read_b128 a[172:175], v19 offset:3072
    v_cvt_pk_bf16_f32 v57, v114, v115
    v_mfma_f32_16x16x32_bf16 v[100:103], a[152:155], a[200:203], v[100:103]
    v_exp_f32 v116, v116
    v_mfma_f32_16x16x32_bf16 v[100:103], a[156:159], a[204:207], v[100:103]
    buffer_load_dwordx4 v1, s[8:11], s82 offen offset:2048 lds
    v_mfma_f32_16x16x32_bf16 v[108:111], a[144:147], a[208:211], v[68:71]
    v_exp_f32 v117, v117
    v_mfma_f32_16x16x32_bf16 v[108:111], a[148:151], a[212:215], v[108:111]
    ds_read_b128 a[176:179], v20 offset:4096
    v_cvt_pk_bf16_f32 v58, v116, v117
    v_mfma_f32_16x16x32_bf16 v[108:111], a[152:155], a[216:219], v[108:111]
    v_exp_f32 v118, v118
    v_mfma_f32_16x16x32_bf16 v[108:111], a[156:159], a[220:223], v[108:111]
    buffer_load_dwordx4 v1, s[8:11], s82 offen offset:3072 lds
    v_mfma_f32_16x16x32_bf16 v[32:35], v[28:31], v[48:51], v[32:35]
    s_add_u32 m0, s15, 4096
    v_exp_f32 v119, v119
    v_mfma_f32_16x16x32_bf16 v[36:39], v[28:31], v[52:55], v[36:39]
    s_waitcnt lgkmcnt(4)
    ds_read_b128 a[180:183], v20 offset:5120
    v_cvt_pk_bf16_f32 v59, v118, v119
    v_mfma_f32_16x16x32_bf16 v[128:131], a[160:163], v[48:51], v[128:131]
    v_exp_f32 v120, v120
    v_mfma_f32_16x16x32_bf16 v[160:163], a[160:163], v[52:55], v[160:163]
    s_waitcnt lgkmcnt(4)
    v_mfma_f32_16x16x32_bf16 v[132:135], a[164:167], v[48:51], v[132:135]
    v_exp_f32 v121, v121
    v_mfma_f32_16x16x32_bf16 v[164:167], a[164:167], v[52:55], v[164:167]
    s_waitcnt lgkmcnt(3)
    ds_read_b128 a[184:187], v20 offset:6144
    v_cvt_pk_bf16_f32 v60, v120, v121
    v_mfma_f32_16x16x32_bf16 v[136:139], a[168:171], v[48:51], v[136:139]
    s_waitcnt lgkmcnt(3)
    v_exp_f32 v122, v122
    v_mfma_f32_16x16x32_bf16 v[168:171], a[168:171], v[52:55], v[168:171]
    buffer_load_dwordx4 v15, s[8:11], s82 offen offset:0 lds
    v_mfma_f32_16x16x32_bf16 v[140:143], a[172:175], v[48:51], v[140:143]
    v_exp_f32 v123, v123
    v_mfma_f32_16x16x32_bf16 v[172:175], a[172:175], v[52:55], v[172:175]
    s_waitcnt lgkmcnt(2)
    ds_read_b128 a[188:191], v20 offset:7168
    v_cvt_pk_bf16_f32 v61, v122, v123
    v_mfma_f32_16x16x32_bf16 v[144:147], a[176:179], v[48:51], v[144:147]
    s_waitcnt lgkmcnt(2)
    v_exp_f32 v124, v124
    v_mfma_f32_16x16x32_bf16 v[176:179], a[176:179], v[52:55], v[176:179]
    buffer_load_dwordx4 v15, s[8:11], s82 offen offset:1024 lds
    v_mfma_f32_16x16x32_bf16 v[148:151], a[180:183], v[48:51], v[148:151]
    v_exp_f32 v125, v125
    v_mfma_f32_16x16x32_bf16 v[180:183], a[180:183], v[52:55], v[180:183]
    s_waitcnt lgkmcnt(1)
    v_cvt_pk_bf16_f32 v62, v124, v125
    v_mfma_f32_16x16x32_bf16 v[152:155], a[184:187], v[48:51], v[152:155]
    s_waitcnt lgkmcnt(0)
    v_exp_f32 v126, v126
    v_mfma_f32_16x16x32_bf16 v[184:187], a[184:187], v[52:55], v[184:187]
    buffer_load_dwordx4 v15, s[8:11], s82 offen offset:2048 lds
    v_mfma_f32_16x16x32_bf16 v[156:159], a[188:191], v[48:51], v[156:159]
    v_exp_f32 v127, v127
    v_mfma_f32_16x16x32_bf16 v[188:191], a[188:191], v[52:55], v[188:191]
    v_cvt_pk_bf16_f32 v63, v126, v127
    v_mfma_f32_16x16x32_bf16 v[112:115], a[128:131], a[224:227], v[72:75]
    v_mfma_f32_16x16x32_bf16 v[112:115], a[132:135], a[228:231], v[112:115]
    v_mfma_f32_16x16x32_bf16 v[112:115], a[136:139], a[232:235], v[112:115]
    v_exp_f32 v96, v96
    v_mfma_f32_16x16x32_bf16 v[112:115], a[140:143], a[236:239], v[112:115]
    buffer_load_dwordx4 v15, s[8:11], s82 offen offset:3072 lds
    v_mfma_f32_16x16x32_bf16 v[120:123], a[128:131], a[240:243], v[76:79]
    s_xor_b32 s15, s15, 196608
    v_exp_f32 v97, v97
    v_mfma_f32_16x16x32_bf16 v[120:123], a[132:135], a[244:247], v[120:123]
    s_add_u32 m0, s16, 0
    ds_read_b128 a[128:131], v18 offset:0
    v_cvt_pk_bf16_f32 v48, v96, v97
    v_mfma_f32_16x16x32_bf16 v[120:123], a[136:139], a[248:251], v[120:123]
    v_exp_f32 v98, v98
    v_mfma_f32_16x16x32_bf16 v[120:123], a[140:143], a[252:255], v[120:123]
    buffer_load_dwordx4 v1, s[8:11], s19 offen offset:0 lds
    v_mfma_f32_16x16x32_bf16 v[116:119], a[144:147], a[224:227], v[72:75]
    v_exp_f32 v99, v99
    v_mfma_f32_16x16x32_bf16 v[116:119], a[148:151], a[228:231], v[116:119]
    ds_read_b128 a[132:135], v18 offset:1024
    v_cvt_pk_bf16_f32 v49, v98, v99
    v_mfma_f32_16x16x32_bf16 v[116:119], a[152:155], a[232:235], v[116:119]
    v_exp_f32 v100, v100
    v_mfma_f32_16x16x32_bf16 v[116:119], a[156:159], a[236:239], v[116:119]
    buffer_load_dwordx4 v1, s[8:11], s19 offen offset:1024 lds
    v_mfma_f32_16x16x32_bf16 v[124:127], a[144:147], a[240:243], v[76:79]
    v_exp_f32 v101, v101
    v_mfma_f32_16x16x32_bf16 v[124:127], a[148:151], a[244:247], v[124:127]
    ds_read_b128 a[136:139], v18 offset:2048
    v_cvt_pk_bf16_f32 v50, v100, v101
    v_mfma_f32_16x16x32_bf16 v[124:127], a[152:155], a[248:251], v[124:127]
    v_exp_f32 v102, v102
    v_mfma_f32_16x16x32_bf16 v[124:127], a[156:159], a[252:255], v[124:127]
    buffer_load_dwordx4 v1, s[8:11], s19 offen offset:2048 lds
    v_mfma_f32_16x16x32_bf16 v[40:43], v[28:31], v[56:59], v[40:43]
    v_exp_f32 v103, v103
    v_mfma_f32_16x16x32_bf16 v[44:47], v[28:31], v[60:63], v[44:47]
    ds_read_b128 a[140:143], v18 offset:3072
    v_cvt_pk_bf16_f32 v51, v102, v103
    v_mfma_f32_16x16x32_bf16 v[192:195], a[160:163], v[56:59], v[192:195]
    v_exp_f32 v104, v104
    v_mfma_f32_16x16x32_bf16 v[224:227], a[160:163], v[60:63], v[224:227]
    v_mfma_f32_16x16x32_bf16 v[196:199], a[164:167], v[56:59], v[196:199]
    v_exp_f32 v105, v105
    v_mfma_f32_16x16x32_bf16 v[228:231], a[164:167], v[60:63], v[228:231]
    ds_read_b128 a[144:147], v18 offset:4096
    v_cvt_pk_bf16_f32 v52, v104, v105
    v_mfma_f32_16x16x32_bf16 v[200:203], a[168:171], v[56:59], v[200:203]
    v_exp_f32 v106, v106
    v_mfma_f32_16x16x32_bf16 v[232:235], a[168:171], v[60:63], v[232:235]
    buffer_load_dwordx4 v1, s[8:11], s19 offen offset:3072 lds
    v_mfma_f32_16x16x32_bf16 v[204:207], a[172:175], v[56:59], v[204:207]
    s_add_u32 m0, s16, 4096
    v_exp_f32 v107, v107
    v_mfma_f32_16x16x32_bf16 v[236:239], a[172:175], v[60:63], v[236:239]
    ds_read_b128 a[148:151], v18 offset:5120
    v_cvt_pk_bf16_f32 v53, v106, v107
    v_mfma_f32_16x16x32_bf16 v[208:211], a[176:179], v[56:59], v[208:211]
    v_exp_f32 v108, v108
    v_mfma_f32_16x16x32_bf16 v[240:243], a[176:179], v[60:63], v[240:243]
    buffer_load_dwordx4 v15, s[8:11], s19 offen offset:0 lds
    v_mfma_f32_16x16x32_bf16 v[212:215], a[180:183], v[56:59], v[212:215]
    v_exp_f32 v109, v109
    v_mfma_f32_16x16x32_bf16 v[244:247], a[180:183], v[60:63], v[244:247]
    ds_read_b128 a[152:155], v18 offset:6144
    v_cvt_pk_bf16_f32 v54, v108, v109
    v_mfma_f32_16x16x32_bf16 v[216:219], a[184:187], v[56:59], v[216:219]
    v_exp_f32 v110, v110
    v_mfma_f32_16x16x32_bf16 v[248:251], a[184:187], v[60:63], v[248:251]
    buffer_load_dwordx4 v15, s[8:11], s19 offen offset:1024 lds
    v_mfma_f32_16x16x32_bf16 v[220:223], a[188:191], v[56:59], v[220:223]
    v_exp_f32 v111, v111
    v_mfma_f32_16x16x32_bf16 v[252:255], a[188:191], v[60:63], v[252:255]
    ds_read_b128 a[156:159], v18 offset:7168
    v_cvt_pk_bf16_f32 v55, v110, v111
    s_waitcnt lgkmcnt(7)
    v_mfma_f32_16x16x32_bf16 v[96:99], a[128:131], a[192:195], v[64:67]
    s_waitcnt lgkmcnt(6)
    ds_read_b128 a[160:163], v19 offset:16384
    v_mfma_f32_16x16x32_bf16 v[96:99], a[132:135], a[196:199], v[96:99]
    s_waitcnt lgkmcnt(6)
    ds_read_b128 a[164:167], v19 offset:17408
    v_mfma_f32_16x16x32_bf16 v[96:99], a[136:139], a[200:203], v[96:99]
    s_waitcnt lgkmcnt(6)
    v_exp_f32 v112, v112
    v_mfma_f32_16x16x32_bf16 v[96:99], a[140:143], a[204:207], v[96:99]
    buffer_load_dwordx4 v15, s[8:11], s19 offen offset:2048 lds
    v_mfma_f32_16x16x32_bf16 v[104:107], a[128:131], a[208:211], v[68:71]
    v_exp_f32 v113, v113
    v_mfma_f32_16x16x32_bf16 v[104:107], a[132:135], a[212:215], v[104:107]
    ds_read_b128 a[168:171], v19 offset:18432
    v_cvt_pk_bf16_f32 v56, v112, v113
    v_mfma_f32_16x16x32_bf16 v[104:107], a[136:139], a[216:219], v[104:107]
    s_waitcnt lgkmcnt(6)
    v_exp_f32 v114, v114
    v_mfma_f32_16x16x32_bf16 v[104:107], a[140:143], a[220:223], v[104:107]
    buffer_load_dwordx4 v15, s[8:11], s19 offen offset:3072 lds
    v_mfma_f32_16x16x32_bf16 v[100:103], a[144:147], a[192:195], v[64:67]
    s_waitcnt lgkmcnt(5)
    s_xor_b32 s16, s16, 98304
    v_exp_f32 v115, v115
    v_mfma_f32_16x16x32_bf16 v[100:103], a[148:151], a[196:199], v[100:103]
    s_waitcnt lgkmcnt(4)
    s_lshl_b32 s64, s2, 6
    ds_read_b128 a[172:175], v19 offset:19456
    v_cvt_pk_bf16_f32 v57, v114, v115
    v_mfma_f32_16x16x32_bf16 v[100:103], a[152:155], a[200:203], v[100:103]
    s_waitcnt lgkmcnt(4)
    s_add_u32 s64, s64, 1327104
    v_exp_f32 v116, v116
    v_mfma_f32_16x16x32_bf16 v[100:103], a[156:159], a[204:207], v[100:103]
    buffer_store_dword v6, v7, s[8:11], s64 offen sc0 sc1
    v_mfma_f32_16x16x32_bf16 v[108:111], a[144:147], a[208:211], v[68:71]
    s_xor_b32 s74, s24, 8192
    v_exp_f32 v117, v117
    v_mfma_f32_16x16x32_bf16 v[108:111], a[148:151], a[212:215], v[108:111]
    ds_read_b128 a[176:179], v20 offset:20480
    v_cvt_pk_bf16_f32 v58, v116, v117
    v_mfma_f32_16x16x32_bf16 v[108:111], a[152:155], a[216:219], v[108:111]
    v_exp_f32 v118, v118
    v_mfma_f32_16x16x32_bf16 v[108:111], a[156:159], a[220:223], v[108:111]
    buffer_load_dwordx4 a[96:99], v1, s[8:11], s74 offen offset:0
    v_mfma_f32_16x16x32_bf16 v[32:35], v[28:31], v[48:51], v[32:35]
    s_xor_b32 s74, s24, 8192
    v_exp_f32 v119, v119
    v_mfma_f32_16x16x32_bf16 v[36:39], v[28:31], v[52:55], v[36:39]
    s_waitcnt lgkmcnt(4)
    ds_read_b128 a[180:183], v20 offset:21504
    v_cvt_pk_bf16_f32 v59, v118, v119
    v_mfma_f32_16x16x32_bf16 v[128:131], a[160:163], v[48:51], v[128:131]
    s_waitcnt lgkmcnt(4)
    v_exp_f32 v120, v120
    v_mfma_f32_16x16x32_bf16 v[160:163], a[160:163], v[52:55], v[160:163]
    buffer_load_dwordx4 a[100:103], v1, s[8:11], s74 offen offset:1024
    v_mfma_f32_16x16x32_bf16 v[132:135], a[164:167], v[48:51], v[132:135]
    s_xor_b32 s74, s24, 8192
    v_exp_f32 v121, v121
    v_mfma_f32_16x16x32_bf16 v[164:167], a[164:167], v[52:55], v[164:167]
    s_waitcnt lgkmcnt(3)
    ds_read_b128 a[184:187], v20 offset:22528
    v_cvt_pk_bf16_f32 v60, v120, v121
    v_mfma_f32_16x16x32_bf16 v[136:139], a[168:171], v[48:51], v[136:139]
    s_waitcnt lgkmcnt(3)
    v_exp_f32 v122, v122
    v_mfma_f32_16x16x32_bf16 v[168:171], a[168:171], v[52:55], v[168:171]
    buffer_load_dwordx4 a[104:107], v1, s[8:11], s74 offen offset:2048
    v_mfma_f32_16x16x32_bf16 v[140:143], a[172:175], v[48:51], v[140:143]
    s_xor_b32 s74, s24, 8192
    v_exp_f32 v123, v123
    v_mfma_f32_16x16x32_bf16 v[172:175], a[172:175], v[52:55], v[172:175]
    s_waitcnt lgkmcnt(2)
    ds_read_b128 a[188:191], v20 offset:23552
    v_cvt_pk_bf16_f32 v61, v122, v123
    v_mfma_f32_16x16x32_bf16 v[144:147], a[176:179], v[48:51], v[144:147]
    s_waitcnt lgkmcnt(2)
    v_exp_f32 v124, v124
    v_mfma_f32_16x16x32_bf16 v[176:179], a[176:179], v[52:55], v[176:179]
    buffer_load_dwordx4 a[108:111], v1, s[8:11], s74 offen offset:3072
    v_mfma_f32_16x16x32_bf16 v[148:151], a[180:183], v[48:51], v[148:151]
    s_xor_b32 s74, s24, 12288
    v_exp_f32 v125, v125
    v_mfma_f32_16x16x32_bf16 v[180:183], a[180:183], v[52:55], v[180:183]
    s_waitcnt lgkmcnt(1)
    v_cvt_pk_bf16_f32 v62, v124, v125
    v_xor_b32 v19, 98304, v19
    v_mfma_f32_16x16x32_bf16 v[152:155], a[184:187], v[48:51], v[152:155]
    buffer_load_dwordx4 a[112:115], v1, s[8:11], s74 offen offset:0
    v_exp_f32 v126, v126
    v_mfma_f32_16x16x32_bf16 v[184:187], a[184:187], v[52:55], v[184:187]
    s_waitcnt lgkmcnt(0)
    v_xor_b32 v20, 98304, v20
    v_mfma_f32_16x16x32_bf16 v[156:159], a[188:191], v[48:51], v[156:159]
    v_exp_f32 v127, v127
    v_mfma_f32_16x16x32_bf16 v[188:191], a[188:191], v[52:55], v[188:191]
    v_cvt_pk_bf16_f32 v63, v126, v127
    v_mfma_f32_16x16x32_bf16 v[112:115], a[128:131], a[224:227], v[72:75]
    s_add_u32 m0, s62, 36864
    v_exp_f32 v96, v96
    v_mfma_f32_16x16x32_bf16 v[112:115], a[132:135], a[228:231], v[112:115]
    v_add_f32 v86, 0xf3900000, v21
    v_min_f32 v86, v86, v66
    v_mfma_f32_16x16x32_bf16 v[112:115], a[136:139], a[232:235], v[112:115]
    s_xor_b32 s98, s65, 32768
    v_exp_f32 v97, v97
    v_mfma_f32_16x16x32_bf16 v[112:115], a[140:143], a[236:239], v[112:115]
    v_cvt_pk_bf16_f32 v48, v96, v97
    v_add_f32 v87, 0xf3980000, v21
    v_mfma_f32_16x16x32_bf16 v[120:123], a[128:131], a[240:243], v[76:79]
    v_exp_f32 v98, v98
    v_mfma_f32_16x16x32_bf16 v[120:123], a[132:135], a[244:247], v[120:123]
    buffer_load_dwordx4 v8, s[28:31], s98 offen offset:0  lds
    v_mfma_f32_16x16x32_bf16 v[120:123], a[136:139], a[248:251], v[120:123]
    v_exp_f32 v99, v99
    v_mfma_f32_16x16x32_bf16 v[120:123], a[140:143], a[252:255], v[120:123]
    buffer_load_dwordx4 v9, s[28:31], s98 offen offset:1024  lds
    v_mfma_f32_16x16x32_bf16 v[116:119], a[144:147], a[224:227], v[72:75]
    v_exp_f32 v100, v100
    v_mfma_f32_16x16x32_bf16 v[116:119], a[148:151], a[228:231], v[116:119]
    ds_read_b128 a[128:131], v18 offset:16384
    v_cvt_pk_bf16_f32 v49, v98, v99
    v_mfma_f32_16x16x32_bf16 v[116:119], a[152:155], a[232:235], v[116:119]
    s_add_u32 s19, s82, 32768
    v_exp_f32 v101, v101
    v_mfma_f32_16x16x32_bf16 v[116:119], a[156:159], a[236:239], v[116:119]
    s_sub_u32 s82, s12, s13
    ds_read_b128 a[132:135], v18 offset:17408
    v_cvt_pk_bf16_f32 v50, v100, v101
    v_mfma_f32_16x16x32_bf16 v[124:127], a[144:147], a[240:243], v[76:79]
    s_sub_u32 s82, s82, 1
    v_exp_f32 v102, v102
    v_mfma_f32_16x16x32_bf16 v[124:127], a[148:151], a[244:247], v[124:127]
    s_cmp_gt_u32 s12, s13
    s_cselect_b32 s82, s82, s12
    s_lshl_b32 s82, s82, 16
    ds_read_b128 a[136:139], v18 offset:18432
    v_mfma_f32_16x16x32_bf16 v[124:127], a[152:155], a[248:251], v[124:127]
    s_add_u32 s82, s82, s81
    v_exp_f32 v103, v103
    v_mfma_f32_16x16x32_bf16 v[124:127], a[156:159], a[252:255], v[124:127]
    s_cmp_ge_u32 s12, 17
    s_cselect_b32 s82, 2147471360, s82
    ds_read_b128 a[140:143], v18 offset:19456
    v_cvt_pk_bf16_f32 v51, v102, v103
    v_mfma_f32_16x16x32_bf16 v[40:43], v[28:31], v[56:59], v[40:43]
    s_add_u32 s12, s12, 1
    v_exp_f32 v104, v104
    v_mfma_f32_16x16x32_bf16 v[44:47], v[28:31], v[60:63], v[44:47]
    ds_read_b128 a[144:147], v18 offset:20480
    v_min_f32 v87, v87, v67
    v_mfma_f32_16x16x32_bf16 v[192:195], a[160:163], v[56:59], v[192:195]
    v_exp_f32 v105, v105
    v_mfma_f32_16x16x32_bf16 v[224:227], a[160:163], v[60:63], v[224:227]
    ds_read_b128 a[148:151], v18 offset:21504
    v_cvt_pk_bf16_f32 v52, v104, v105
    v_mfma_f32_16x16x32_bf16 v[196:199], a[164:167], v[56:59], v[196:199]
    v_exp_f32 v106, v106
    v_mfma_f32_16x16x32_bf16 v[228:231], a[164:167], v[60:63], v[228:231]
    ds_read_b128 a[152:155], v18 offset:22528
    v_add_f32 v88, 0x73800000, v21
    v_mfma_f32_16x16x32_bf16 v[200:203], a[168:171], v[56:59], v[200:203]
    v_exp_f32 v107, v107
    v_mfma_f32_16x16x32_bf16 v[232:235], a[168:171], v[60:63], v[232:235]
    ds_read_b128 a[156:159], v18 offset:23552
    v_cvt_pk_bf16_f32 v53, v106, v107
    v_mfma_f32_16x16x32_bf16 v[204:207], a[172:175], v[56:59], v[204:207]
    v_exp_f32 v108, v108
    v_mfma_f32_16x16x32_bf16 v[236:239], a[172:175], v[60:63], v[236:239]
    buffer_load_dwordx4 v10, s[28:31], s98 offen offset:2048  lds
    v_mfma_f32_16x16x32_bf16 v[208:211], a[176:179], v[56:59], v[208:211]
    v_exp_f32 v109, v109
    v_mfma_f32_16x16x32_bf16 v[240:243], a[176:179], v[60:63], v[240:243]
    v_cvt_pk_bf16_f32 v54, v108, v109
    v_xor_b32 v18, 196608, v18
    v_mfma_f32_16x16x32_bf16 v[212:215], a[180:183], v[56:59], v[212:215]
    v_exp_f32 v110, v110
    v_mfma_f32_16x16x32_bf16 v[244:247], a[180:183], v[60:63], v[244:247]
    buffer_load_dwordx4 v11, s[28:31], s98 offen offset:3072  lds
    v_mfma_f32_16x16x32_bf16 v[216:219], a[184:187], v[56:59], v[216:219]
    s_xor_b32 s74, s24, 12288
    v_exp_f32 v111, v111
    v_mfma_f32_16x16x32_bf16 v[248:251], a[184:187], v[60:63], v[248:251]
    v_cvt_pk_bf16_f32 v55, v110, v111
    v_min_f32 v88, v88, v68
    v_mfma_f32_16x16x32_bf16 v[220:223], a[188:191], v[56:59], v[220:223]
    buffer_load_dwordx4 a[116:119], v1, s[8:11], s74 offen offset:1024
    v_mfma_f32_16x16x32_bf16 v[252:255], a[188:191], v[60:63], v[252:255]
    s_xor_b32 s74, s24, 12288
    buffer_load_dwordx4 a[120:123], v1, s[8:11], s74 offen offset:2048
    s_xor_b32 s74, s24, 12288
    buffer_load_dwordx4 a[124:127], v1, s[8:11], s74 offen offset:3072
    s_waitcnt vmcnt(13) lgkmcnt(0)
    s_barrier
    v_mfma_f32_16x16x32_bf16 v[96:99], a[128:131], a[192:195], v[64:67]
    s_add_u32 m0, s15, 0
    ds_read_b128 a[160:163], v19 offset:0
    v_mfma_f32_16x16x32_bf16 v[96:99], a[132:135], a[196:199], v[96:99]
    ds_read_b128 a[164:167], v19 offset:1024
    v_mfma_f32_16x16x32_bf16 v[96:99], a[136:139], a[200:203], v[96:99]
    v_exp_f32 v112, v112
    v_mfma_f32_16x16x32_bf16 v[96:99], a[140:143], a[204:207], v[96:99]
    buffer_load_dwordx4 v1, s[8:11], s82 offen offset:0 lds
    v_mfma_f32_16x16x32_bf16 v[104:107], a[128:131], a[208:211], v[68:71]
    v_exp_f32 v113, v113
    v_mfma_f32_16x16x32_bf16 v[104:107], a[132:135], a[212:215], v[104:107]
    ds_read_b128 a[168:171], v19 offset:2048
    v_cvt_pk_bf16_f32 v56, v112, v113
    v_mfma_f32_16x16x32_bf16 v[104:107], a[136:139], a[216:219], v[104:107]
    v_exp_f32 v114, v114
    v_mfma_f32_16x16x32_bf16 v[104:107], a[140:143], a[220:223], v[104:107]
    buffer_load_dwordx4 v1, s[8:11], s82 offen offset:1024 lds
    v_mfma_f32_16x16x32_bf16 v[100:103], a[144:147], a[192:195], v[64:67]
    v_exp_f32 v115, v115
    v_mfma_f32_16x16x32_bf16 v[100:103], a[148:151], a[196:199], v[100:103]
    ds_read_b128 a[172:175], v19 offset:3072
    v_cvt_pk_bf16_f32 v57, v114, v115
    v_mfma_f32_16x16x32_bf16 v[100:103], a[152:155], a[200:203], v[100:103]
    v_exp_f32 v116, v116
    v_mfma_f32_16x16x32_bf16 v[100:103], a[156:159], a[204:207], v[100:103]
    buffer_load_dwordx4 v1, s[8:11], s82 offen offset:2048 lds
    v_mfma_f32_16x16x32_bf16 v[108:111], a[144:147], a[208:211], v[68:71]
    v_exp_f32 v117, v117
    v_mfma_f32_16x16x32_bf16 v[108:111], a[148:151], a[212:215], v[108:111]
    ds_read_b128 a[176:179], v20 offset:4096
    v_cvt_pk_bf16_f32 v58, v116, v117
    v_mfma_f32_16x16x32_bf16 v[108:111], a[152:155], a[216:219], v[108:111]
    v_exp_f32 v118, v118
    v_mfma_f32_16x16x32_bf16 v[108:111], a[156:159], a[220:223], v[108:111]
    buffer_load_dwordx4 v1, s[8:11], s82 offen offset:3072 lds
    v_mfma_f32_16x16x32_bf16 v[32:35], v[28:31], v[48:51], v[32:35]
    s_add_u32 m0, s15, 4096
    v_exp_f32 v119, v119
    v_mfma_f32_16x16x32_bf16 v[36:39], v[28:31], v[52:55], v[36:39]
    s_waitcnt lgkmcnt(4)
    ds_read_b128 a[180:183], v20 offset:5120
    v_cvt_pk_bf16_f32 v59, v118, v119
    v_mfma_f32_16x16x32_bf16 v[128:131], a[160:163], v[48:51], v[128:131]
    v_exp_f32 v120, v120
    v_mfma_f32_16x16x32_bf16 v[160:163], a[160:163], v[52:55], v[160:163]
    s_waitcnt lgkmcnt(4)
    v_mfma_f32_16x16x32_bf16 v[132:135], a[164:167], v[48:51], v[132:135]
    v_exp_f32 v121, v121
    v_mfma_f32_16x16x32_bf16 v[164:167], a[164:167], v[52:55], v[164:167]
    s_waitcnt lgkmcnt(3)
    ds_read_b128 a[184:187], v20 offset:6144
    v_cvt_pk_bf16_f32 v60, v120, v121
    v_mfma_f32_16x16x32_bf16 v[136:139], a[168:171], v[48:51], v[136:139]
    s_waitcnt lgkmcnt(3)
    v_exp_f32 v122, v122
    v_mfma_f32_16x16x32_bf16 v[168:171], a[168:171], v[52:55], v[168:171]
    buffer_load_dwordx4 v15, s[8:11], s82 offen offset:0 lds
    v_mfma_f32_16x16x32_bf16 v[140:143], a[172:175], v[48:51], v[140:143]
    v_exp_f32 v123, v123
    v_mfma_f32_16x16x32_bf16 v[172:175], a[172:175], v[52:55], v[172:175]
    s_waitcnt lgkmcnt(2)
    ds_read_b128 a[188:191], v20 offset:7168
    v_cvt_pk_bf16_f32 v61, v122, v123
    v_mfma_f32_16x16x32_bf16 v[144:147], a[176:179], v[48:51], v[144:147]
    s_waitcnt lgkmcnt(2)
    v_exp_f32 v124, v124
    v_mfma_f32_16x16x32_bf16 v[176:179], a[176:179], v[52:55], v[176:179]
    buffer_load_dwordx4 v15, s[8:11], s82 offen offset:1024 lds
    v_mfma_f32_16x16x32_bf16 v[148:151], a[180:183], v[48:51], v[148:151]
    v_exp_f32 v125, v125
    v_mfma_f32_16x16x32_bf16 v[180:183], a[180:183], v[52:55], v[180:183]
    s_waitcnt lgkmcnt(1)
    v_cvt_pk_bf16_f32 v62, v124, v125
    v_mfma_f32_16x16x32_bf16 v[152:155], a[184:187], v[48:51], v[152:155]
    s_waitcnt lgkmcnt(0)
    v_exp_f32 v126, v126
    v_mfma_f32_16x16x32_bf16 v[184:187], a[184:187], v[52:55], v[184:187]
    buffer_load_dwordx4 v15, s[8:11], s82 offen offset:2048 lds
    v_mfma_f32_16x16x32_bf16 v[156:159], a[188:191], v[48:51], v[156:159]
    v_exp_f32 v127, v127
    v_mfma_f32_16x16x32_bf16 v[188:191], a[188:191], v[52:55], v[188:191]
    v_cvt_pk_bf16_f32 v63, v126, v127
    v_mfma_f32_16x16x32_bf16 v[112:115], a[128:131], a[224:227], v[72:75]
    v_mfma_f32_16x16x32_bf16 v[112:115], a[132:135], a[228:231], v[112:115]
    v_mfma_f32_16x16x32_bf16 v[112:115], a[136:139], a[232:235], v[112:115]
    v_exp_f32 v96, v96
    v_mfma_f32_16x16x32_bf16 v[112:115], a[140:143], a[236:239], v[112:115]
    buffer_load_dwordx4 v15, s[8:11], s82 offen offset:3072 lds
    v_mfma_f32_16x16x32_bf16 v[120:123], a[128:131], a[240:243], v[76:79]
    s_xor_b32 s15, s15, 196608
    v_exp_f32 v97, v97
    v_mfma_f32_16x16x32_bf16 v[120:123], a[132:135], a[244:247], v[120:123]
    s_add_u32 m0, s16, 0
    ds_read_b128 a[128:131], v18 offset:0
    v_cvt_pk_bf16_f32 v48, v96, v97
    v_mfma_f32_16x16x32_bf16 v[120:123], a[136:139], a[248:251], v[120:123]
    v_exp_f32 v98, v98
    v_mfma_f32_16x16x32_bf16 v[120:123], a[140:143], a[252:255], v[120:123]
    buffer_load_dwordx4 v1, s[8:11], s19 offen offset:0 lds
    v_mfma_f32_16x16x32_bf16 v[116:119], a[144:147], a[224:227], v[72:75]
    v_exp_f32 v99, v99
    v_mfma_f32_16x16x32_bf16 v[116:119], a[148:151], a[228:231], v[116:119]
    ds_read_b128 a[132:135], v18 offset:1024
    v_cvt_pk_bf16_f32 v49, v98, v99
    v_mfma_f32_16x16x32_bf16 v[116:119], a[152:155], a[232:235], v[116:119]
    v_exp_f32 v100, v100
    v_mfma_f32_16x16x32_bf16 v[116:119], a[156:159], a[236:239], v[116:119]
    buffer_load_dwordx4 v1, s[8:11], s19 offen offset:1024 lds
    v_mfma_f32_16x16x32_bf16 v[124:127], a[144:147], a[240:243], v[76:79]
    v_exp_f32 v101, v101
    v_mfma_f32_16x16x32_bf16 v[124:127], a[148:151], a[244:247], v[124:127]
    ds_read_b128 a[136:139], v18 offset:2048
    v_cvt_pk_bf16_f32 v50, v100, v101
    v_mfma_f32_16x16x32_bf16 v[124:127], a[152:155], a[248:251], v[124:127]
    v_exp_f32 v102, v102
    v_mfma_f32_16x16x32_bf16 v[124:127], a[156:159], a[252:255], v[124:127]
    buffer_load_dwordx4 v1, s[8:11], s19 offen offset:2048 lds
    v_mfma_f32_16x16x32_bf16 v[40:43], v[28:31], v[56:59], v[40:43]
    v_exp_f32 v103, v103
    v_mfma_f32_16x16x32_bf16 v[44:47], v[28:31], v[60:63], v[44:47]
    ds_read_b128 a[140:143], v18 offset:3072
    v_cvt_pk_bf16_f32 v51, v102, v103
    v_mfma_f32_16x16x32_bf16 v[192:195], a[160:163], v[56:59], v[192:195]
    v_exp_f32 v104, v104
    v_mfma_f32_16x16x32_bf16 v[224:227], a[160:163], v[60:63], v[224:227]
    v_mfma_f32_16x16x32_bf16 v[196:199], a[164:167], v[56:59], v[196:199]
    v_exp_f32 v105, v105
    v_mfma_f32_16x16x32_bf16 v[228:231], a[164:167], v[60:63], v[228:231]
    ds_read_b128 a[144:147], v18 offset:4096
    v_cvt_pk_bf16_f32 v52, v104, v105
    v_mfma_f32_16x16x32_bf16 v[200:203], a[168:171], v[56:59], v[200:203]
    v_exp_f32 v106, v106
    v_mfma_f32_16x16x32_bf16 v[232:235], a[168:171], v[60:63], v[232:235]
    buffer_load_dwordx4 v1, s[8:11], s19 offen offset:3072 lds
    v_mfma_f32_16x16x32_bf16 v[204:207], a[172:175], v[56:59], v[204:207]
    s_add_u32 m0, s16, 4096
    v_exp_f32 v107, v107
    v_mfma_f32_16x16x32_bf16 v[236:239], a[172:175], v[60:63], v[236:239]
    ds_read_b128 a[148:151], v18 offset:5120
    v_cvt_pk_bf16_f32 v53, v106, v107
    v_mfma_f32_16x16x32_bf16 v[208:211], a[176:179], v[56:59], v[208:211]
    v_exp_f32 v108, v108
    v_mfma_f32_16x16x32_bf16 v[240:243], a[176:179], v[60:63], v[240:243]
    buffer_load_dwordx4 v15, s[8:11], s19 offen offset:0 lds
    v_mfma_f32_16x16x32_bf16 v[212:215], a[180:183], v[56:59], v[212:215]
    v_exp_f32 v109, v109
    v_mfma_f32_16x16x32_bf16 v[244:247], a[180:183], v[60:63], v[244:247]
    ds_read_b128 a[152:155], v18 offset:6144
    v_cvt_pk_bf16_f32 v54, v108, v109
    v_mfma_f32_16x16x32_bf16 v[216:219], a[184:187], v[56:59], v[216:219]
    v_exp_f32 v110, v110
    v_mfma_f32_16x16x32_bf16 v[248:251], a[184:187], v[60:63], v[248:251]
    buffer_load_dwordx4 v15, s[8:11], s19 offen offset:1024 lds
    v_mfma_f32_16x16x32_bf16 v[220:223], a[188:191], v[56:59], v[220:223]
    v_exp_f32 v111, v111
    v_mfma_f32_16x16x32_bf16 v[252:255], a[188:191], v[60:63], v[252:255]
    ds_read_b128 a[156:159], v18 offset:7168
    v_cvt_pk_bf16_f32 v55, v110, v111
    s_waitcnt lgkmcnt(7)
    v_mfma_f32_16x16x32_bf16 v[96:99], a[128:131], a[192:195], v[64:67]
    s_waitcnt lgkmcnt(6)
    ds_read_b128 a[160:163], v19 offset:16384
    v_mfma_f32_16x16x32_bf16 v[96:99], a[132:135], a[196:199], v[96:99]
    s_waitcnt lgkmcnt(6)
    ds_read_b128 a[164:167], v19 offset:17408
    v_mfma_f32_16x16x32_bf16 v[96:99], a[136:139], a[200:203], v[96:99]
    s_waitcnt lgkmcnt(6)
    v_exp_f32 v112, v112
    v_mfma_f32_16x16x32_bf16 v[96:99], a[140:143], a[204:207], v[96:99]
    buffer_load_dwordx4 v15, s[8:11], s19 offen offset:2048 lds
    v_mfma_f32_16x16x32_bf16 v[104:107], a[128:131], a[208:211], v[68:71]
    v_exp_f32 v113, v113
    v_mfma_f32_16x16x32_bf16 v[104:107], a[132:135], a[212:215], v[104:107]
    ds_read_b128 a[168:171], v19 offset:18432
    v_cvt_pk_bf16_f32 v56, v112, v113
    v_mfma_f32_16x16x32_bf16 v[104:107], a[136:139], a[216:219], v[104:107]
    s_waitcnt lgkmcnt(6)
    v_exp_f32 v114, v114
    v_mfma_f32_16x16x32_bf16 v[104:107], a[140:143], a[220:223], v[104:107]
    buffer_load_dwordx4 v15, s[8:11], s19 offen offset:3072 lds
    v_mfma_f32_16x16x32_bf16 v[100:103], a[144:147], a[192:195], v[64:67]
    s_waitcnt lgkmcnt(5)
    s_xor_b32 s16, s16, 98304
    v_exp_f32 v115, v115
    v_mfma_f32_16x16x32_bf16 v[100:103], a[148:151], a[196:199], v[100:103]
    s_waitcnt lgkmcnt(4)
    s_xor_b32 s74, s24, 16384
    ds_read_b128 a[172:175], v19 offset:19456
    v_cvt_pk_bf16_f32 v57, v114, v115
    v_mfma_f32_16x16x32_bf16 v[100:103], a[152:155], a[200:203], v[100:103]
    s_waitcnt lgkmcnt(4)
    v_exp_f32 v116, v116
    v_mfma_f32_16x16x32_bf16 v[100:103], a[156:159], a[204:207], v[100:103]
    buffer_load_dwordx4 a[0:3], v1, s[8:11], s74 offen offset:0
    v_mfma_f32_16x16x32_bf16 v[108:111], a[144:147], a[208:211], v[68:71]
    s_xor_b32 s74, s24, 16384
    v_exp_f32 v117, v117
    v_mfma_f32_16x16x32_bf16 v[108:111], a[148:151], a[212:215], v[108:111]
    ds_read_b128 a[176:179], v20 offset:20480
    v_cvt_pk_bf16_f32 v58, v116, v117
    v_mfma_f32_16x16x32_bf16 v[108:111], a[152:155], a[216:219], v[108:111]
    v_exp_f32 v118, v118
    v_mfma_f32_16x16x32_bf16 v[108:111], a[156:159], a[220:223], v[108:111]
    buffer_load_dwordx4 a[4:7], v1, s[8:11], s74 offen offset:1024
    v_mfma_f32_16x16x32_bf16 v[32:35], v[28:31], v[48:51], v[32:35]
    s_xor_b32 s74, s24, 16384
    v_exp_f32 v119, v119
    v_mfma_f32_16x16x32_bf16 v[36:39], v[28:31], v[52:55], v[36:39]
    s_waitcnt lgkmcnt(4)
    ds_read_b128 a[180:183], v20 offset:21504
    v_cvt_pk_bf16_f32 v59, v118, v119
    v_mfma_f32_16x16x32_bf16 v[128:131], a[160:163], v[48:51], v[128:131]
    s_waitcnt lgkmcnt(4)
    v_exp_f32 v120, v120
    v_mfma_f32_16x16x32_bf16 v[160:163], a[160:163], v[52:55], v[160:163]
    buffer_load_dwordx4 a[8:11], v1, s[8:11], s74 offen offset:2048
    v_mfma_f32_16x16x32_bf16 v[132:135], a[164:167], v[48:51], v[132:135]
    s_xor_b32 s74, s24, 16384
    v_exp_f32 v121, v121
    v_mfma_f32_16x16x32_bf16 v[164:167], a[164:167], v[52:55], v[164:167]
    s_waitcnt lgkmcnt(3)
    ds_read_b128 a[184:187], v20 offset:22528
    v_cvt_pk_bf16_f32 v60, v120, v121
    v_mfma_f32_16x16x32_bf16 v[136:139], a[168:171], v[48:51], v[136:139]
    s_waitcnt lgkmcnt(3)
    v_exp_f32 v122, v122
    v_mfma_f32_16x16x32_bf16 v[168:171], a[168:171], v[52:55], v[168:171]
    buffer_load_dwordx4 a[12:15], v1, s[8:11], s74 offen offset:3072
    v_mfma_f32_16x16x32_bf16 v[140:143], a[172:175], v[48:51], v[140:143]
    s_xor_b32 s74, s24, 20480
    v_exp_f32 v123, v123
    v_mfma_f32_16x16x32_bf16 v[172:175], a[172:175], v[52:55], v[172:175]
    s_waitcnt lgkmcnt(2)
    ds_read_b128 a[188:191], v20 offset:23552
    v_cvt_pk_bf16_f32 v61, v122, v123
    v_mfma_f32_16x16x32_bf16 v[144:147], a[176:179], v[48:51], v[144:147]
    s_waitcnt lgkmcnt(2)
    v_exp_f32 v124, v124
    v_mfma_f32_16x16x32_bf16 v[176:179], a[176:179], v[52:55], v[176:179]
    buffer_load_dwordx4 a[16:19], v1, s[8:11], s74 offen offset:0
    v_mfma_f32_16x16x32_bf16 v[148:151], a[180:183], v[48:51], v[148:151]
    s_xor_b32 s74, s24, 20480
    v_exp_f32 v125, v125
    v_mfma_f32_16x16x32_bf16 v[180:183], a[180:183], v[52:55], v[180:183]
    s_waitcnt lgkmcnt(1)
    v_cvt_pk_bf16_f32 v62, v124, v125
    v_xor_b32 v19, 98304, v19
    v_mfma_f32_16x16x32_bf16 v[152:155], a[184:187], v[48:51], v[152:155]
    buffer_load_dwordx4 a[20:23], v1, s[8:11], s74 offen offset:1024
    v_exp_f32 v126, v126
    v_mfma_f32_16x16x32_bf16 v[184:187], a[184:187], v[52:55], v[184:187]
    s_waitcnt lgkmcnt(0)
    v_xor_b32 v20, 98304, v20
    v_mfma_f32_16x16x32_bf16 v[156:159], a[188:191], v[48:51], v[156:159]
    v_exp_f32 v127, v127
    v_mfma_f32_16x16x32_bf16 v[188:191], a[188:191], v[52:55], v[188:191]
    v_cvt_pk_bf16_f32 v63, v126, v127
    v_mfma_f32_16x16x32_bf16 v[112:115], a[128:131], a[224:227], v[72:75]
    s_xor_b32 s74, s24, 20480
    v_exp_f32 v96, v96
    v_mfma_f32_16x16x32_bf16 v[112:115], a[132:135], a[228:231], v[112:115]
    buffer_load_dwordx4 a[24:27], v1, s[8:11], s74 offen offset:2048
    v_mfma_f32_16x16x32_bf16 v[112:115], a[136:139], a[232:235], v[112:115]
    s_xor_b32 s74, s24, 20480
    v_exp_f32 v97, v97
    v_mfma_f32_16x16x32_bf16 v[112:115], a[140:143], a[236:239], v[112:115]
    v_cvt_pk_bf16_f32 v48, v96, v97
    v_add_f32 v89, 0x73700000, v21
    v_mfma_f32_16x16x32_bf16 v[120:123], a[128:131], a[240:243], v[76:79]
    v_exp_f32 v98, v98
    v_mfma_f32_16x16x32_bf16 v[120:123], a[132:135], a[244:247], v[120:123]
    buffer_load_dwordx4 a[28:31], v1, s[8:11], s74 offen offset:3072
    v_mfma_f32_16x16x32_bf16 v[120:123], a[136:139], a[248:251], v[120:123]
    s_xor_b32 s74, s24, 24576
    v_exp_f32 v99, v99
    v_mfma_f32_16x16x32_bf16 v[120:123], a[140:143], a[252:255], v[120:123]
    buffer_load_dwordx4 a[32:35], v1, s[8:11], s74 offen offset:0
    v_mfma_f32_16x16x32_bf16 v[116:119], a[144:147], a[224:227], v[72:75]
    s_xor_b32 s74, s24, 24576
    v_exp_f32 v100, v100
    v_mfma_f32_16x16x32_bf16 v[116:119], a[148:151], a[228:231], v[116:119]
    ds_read_b128 a[128:131], v18 offset:16384
    v_cvt_pk_bf16_f32 v49, v98, v99
    v_mfma_f32_16x16x32_bf16 v[116:119], a[152:155], a[232:235], v[116:119]
    s_add_u32 s19, s82, 32768
    v_exp_f32 v101, v101
    v_mfma_f32_16x16x32_bf16 v[116:119], a[156:159], a[236:239], v[116:119]
    s_sub_u32 s82, s12, s13
    ds_read_b128 a[132:135], v18 offset:17408
    v_cvt_pk_bf16_f32 v50, v100, v101
    v_mfma_f32_16x16x32_bf16 v[124:127], a[144:147], a[240:243], v[76:79]
    s_sub_u32 s82, s82, 1
    v_exp_f32 v102, v102
    v_mfma_f32_16x16x32_bf16 v[124:127], a[148:151], a[244:247], v[124:127]
    s_cmp_gt_u32 s12, s13
    s_cselect_b32 s82, s82, s12
    s_lshl_b32 s82, s82, 16
    ds_read_b128 a[136:139], v18 offset:18432
    v_mfma_f32_16x16x32_bf16 v[124:127], a[152:155], a[248:251], v[124:127]
    s_add_u32 s82, s82, s81
    v_exp_f32 v103, v103
    v_mfma_f32_16x16x32_bf16 v[124:127], a[156:159], a[252:255], v[124:127]
    s_cmp_ge_u32 s12, 17
    s_cselect_b32 s82, 2147471360, s82
    ds_read_b128 a[140:143], v18 offset:19456
    v_cvt_pk_bf16_f32 v51, v102, v103
    v_mfma_f32_16x16x32_bf16 v[40:43], v[28:31], v[56:59], v[40:43]
    s_add_u32 s12, s12, 1
    v_exp_f32 v104, v104
    v_mfma_f32_16x16x32_bf16 v[44:47], v[28:31], v[60:63], v[44:47]
    ds_read_b128 a[144:147], v18 offset:20480
    v_min_f32 v89, v89, v69
    v_mfma_f32_16x16x32_bf16 v[192:195], a[160:163], v[56:59], v[192:195]
    v_exp_f32 v105, v105
    v_mfma_f32_16x16x32_bf16 v[224:227], a[160:163], v[60:63], v[224:227]
    ds_read_b128 a[148:151], v18 offset:21504
    v_cvt_pk_bf16_f32 v52, v104, v105
    v_mfma_f32_16x16x32_bf16 v[196:199], a[164:167], v[56:59], v[196:199]
    v_exp_f32 v106, v106
    v_mfma_f32_16x16x32_bf16 v[228:231], a[164:167], v[60:63], v[228:231]
    ds_read_b128 a[152:155], v18 offset:22528
    v_add_f32 v90, 0x73600000, v21
    v_mfma_f32_16x16x32_bf16 v[200:203], a[168:171], v[56:59], v[200:203]
    v_exp_f32 v107, v107
    v_mfma_f32_16x16x32_bf16 v[232:235], a[168:171], v[60:63], v[232:235]
    ds_read_b128 a[156:159], v18 offset:23552
    v_cvt_pk_bf16_f32 v53, v106, v107
    v_mfma_f32_16x16x32_bf16 v[204:207], a[172:175], v[56:59], v[204:207]
    v_exp_f32 v108, v108
    v_mfma_f32_16x16x32_bf16 v[236:239], a[172:175], v[60:63], v[236:239]
    buffer_load_dwordx4 a[36:39], v1, s[8:11], s74 offen offset:1024
    v_mfma_f32_16x16x32_bf16 v[208:211], a[176:179], v[56:59], v[208:211]
    s_xor_b32 s74, s24, 24576
    v_exp_f32 v109, v109
    v_mfma_f32_16x16x32_bf16 v[240:243], a[176:179], v[60:63], v[240:243]
    v_cvt_pk_bf16_f32 v54, v108, v109
    v_xor_b32 v18, 196608, v18
    v_mfma_f32_16x16x32_bf16 v[212:215], a[180:183], v[56:59], v[212:215]
    v_exp_f32 v110, v110
    v_mfma_f32_16x16x32_bf16 v[244:247], a[180:183], v[60:63], v[244:247]
    buffer_load_dwordx4 a[40:43], v1, s[8:11], s74 offen offset:2048
    v_mfma_f32_16x16x32_bf16 v[216:219], a[184:187], v[56:59], v[216:219]
    s_xor_b32 s74, s24, 24576
    v_exp_f32 v111, v111
    v_mfma_f32_16x16x32_bf16 v[248:251], a[184:187], v[60:63], v[248:251]
    v_cvt_pk_bf16_f32 v55, v110, v111
    v_min_f32 v90, v90, v70
    v_mfma_f32_16x16x32_bf16 v[220:223], a[188:191], v[56:59], v[220:223]
    buffer_load_dwordx4 a[44:47], v1, s[8:11], s74 offen offset:3072
    v_mfma_f32_16x16x32_bf16 v[252:255], a[188:191], v[60:63], v[252:255]
    v_add_f32 v91, 0x73500000, v21
    v_min_f32 v91, v91, v71
    v_add_f32 v92, 0, v21
    v_min_f32 v92, v92, v68
    s_waitcnt vmcnt(12) lgkmcnt(0)
    s_barrier
    v_mfma_f32_16x16x32_bf16 v[96:99], a[128:131], a[192:195], v[64:67]
    s_add_u32 m0, s15, 0
    ds_read_b128 a[160:163], v19 offset:0
    v_mfma_f32_16x16x32_bf16 v[96:99], a[132:135], a[196:199], v[96:99]
    ds_read_b128 a[164:167], v19 offset:1024
    v_mfma_f32_16x16x32_bf16 v[96:99], a[136:139], a[200:203], v[96:99]
    v_exp_f32 v112, v112
    v_mfma_f32_16x16x32_bf16 v[96:99], a[140:143], a[204:207], v[96:99]
    buffer_load_dwordx4 v1, s[8:11], s82 offen offset:0 lds
    v_mfma_f32_16x16x32_bf16 v[104:107], a[128:131], a[208:211], v[68:71]
    v_exp_f32 v113, v113
    v_mfma_f32_16x16x32_bf16 v[104:107], a[132:135], a[212:215], v[104:107]
    ds_read_b128 a[168:171], v19 offset:2048
    v_cvt_pk_bf16_f32 v56, v112, v113
    v_mfma_f32_16x16x32_bf16 v[104:107], a[136:139], a[216:219], v[104:107]
    v_exp_f32 v114, v114
    v_mfma_f32_16x16x32_bf16 v[104:107], a[140:143], a[220:223], v[104:107]
    buffer_load_dwordx4 v1, s[8:11], s82 offen offset:1024 lds
    v_mfma_f32_16x16x32_bf16 v[100:103], a[144:147], a[192:195], v[64:67]
    v_exp_f32 v115, v115
    v_mfma_f32_16x16x32_bf16 v[100:103], a[148:151], a[196:199], v[100:103]
    ds_read_b128 a[172:175], v19 offset:3072
    v_cvt_pk_bf16_f32 v57, v114, v115
    v_mfma_f32_16x16x32_bf16 v[100:103], a[152:155], a[200:203], v[100:103]
    v_exp_f32 v116, v116
    v_mfma_f32_16x16x32_bf16 v[100:103], a[156:159], a[204:207], v[100:103]
    buffer_load_dwordx4 v1, s[8:11], s82 offen offset:2048 lds
    v_mfma_f32_16x16x32_bf16 v[108:111], a[144:147], a[208:211], v[68:71]
    v_exp_f32 v117, v117
    v_mfma_f32_16x16x32_bf16 v[108:111], a[148:151], a[212:215], v[108:111]
    ds_read_b128 a[176:179], v20 offset:4096
    v_cvt_pk_bf16_f32 v58, v116, v117
    v_mfma_f32_16x16x32_bf16 v[108:111], a[152:155], a[216:219], v[108:111]
    v_exp_f32 v118, v118
    v_mfma_f32_16x16x32_bf16 v[108:111], a[156:159], a[220:223], v[108:111]
    buffer_load_dwordx4 v1, s[8:11], s82 offen offset:3072 lds
    v_mfma_f32_16x16x32_bf16 v[32:35], v[28:31], v[48:51], v[32:35]
    s_add_u32 m0, s15, 4096
    v_exp_f32 v119, v119
    v_mfma_f32_16x16x32_bf16 v[36:39], v[28:31], v[52:55], v[36:39]
    s_waitcnt lgkmcnt(4)
    ds_read_b128 a[180:183], v20 offset:5120
    v_cvt_pk_bf16_f32 v59, v118, v119
    v_mfma_f32_16x16x32_bf16 v[128:131], a[160:163], v[48:51], v[128:131]
    v_exp_f32 v120, v120
    v_mfma_f32_16x16x32_bf16 v[160:163], a[160:163], v[52:55], v[160:163]
    s_waitcnt lgkmcnt(4)
    v_mfma_f32_16x16x32_bf16 v[132:135], a[164:167], v[48:51], v[132:135]
    v_exp_f32 v121, v121
    v_mfma_f32_16x16x32_bf16 v[164:167], a[164:167], v[52:55], v[164:167]
    s_waitcnt lgkmcnt(3)
    ds_read_b128 a[184:187], v20 offset:6144
    v_cvt_pk_bf16_f32 v60, v120, v121
    v_mfma_f32_16x16x32_bf16 v[136:139], a[168:171], v[48:51], v[136:139]
    s_waitcnt lgkmcnt(3)
    v_exp_f32 v122, v122
    v_mfma_f32_16x16x32_bf16 v[168:171], a[168:171], v[52:55], v[168:171]
    buffer_load_dwordx4 v15, s[8:11], s82 offen offset:0 lds
    v_mfma_f32_16x16x32_bf16 v[140:143], a[172:175], v[48:51], v[140:143]
    v_exp_f32 v123, v123
    v_mfma_f32_16x16x32_bf16 v[172:175], a[172:175], v[52:55], v[172:175]
    s_waitcnt lgkmcnt(2)
    ds_read_b128 a[188:191], v20 offset:7168
    v_cvt_pk_bf16_f32 v61, v122, v123
    v_mfma_f32_16x16x32_bf16 v[144:147], a[176:179], v[48:51], v[144:147]
    s_waitcnt lgkmcnt(2)
    v_exp_f32 v124, v124
    v_mfma_f32_16x16x32_bf16 v[176:179], a[176:179], v[52:55], v[176:179]
    buffer_load_dwordx4 v15, s[8:11], s82 offen offset:1024 lds
    v_mfma_f32_16x16x32_bf16 v[148:151], a[180:183], v[48:51], v[148:151]
    v_exp_f32 v125, v125
    v_mfma_f32_16x16x32_bf16 v[180:183], a[180:183], v[52:55], v[180:183]
    s_waitcnt lgkmcnt(1)
    v_cvt_pk_bf16_f32 v62, v124, v125
    v_mfma_f32_16x16x32_bf16 v[152:155], a[184:187], v[48:51], v[152:155]
    s_waitcnt lgkmcnt(0)
    v_exp_f32 v126, v126
    v_mfma_f32_16x16x32_bf16 v[184:187], a[184:187], v[52:55], v[184:187]
    buffer_load_dwordx4 v15, s[8:11], s82 offen offset:2048 lds
    v_mfma_f32_16x16x32_bf16 v[156:159], a[188:191], v[48:51], v[156:159]
    v_exp_f32 v127, v127
    v_mfma_f32_16x16x32_bf16 v[188:191], a[188:191], v[52:55], v[188:191]
    v_cvt_pk_bf16_f32 v63, v126, v127
    v_mfma_f32_16x16x32_bf16 v[112:115], a[128:131], a[224:227], v[72:75]
    v_mfma_f32_16x16x32_bf16 v[112:115], a[132:135], a[228:231], v[112:115]
    v_mfma_f32_16x16x32_bf16 v[112:115], a[136:139], a[232:235], v[112:115]
    v_exp_f32 v96, v96
    v_mfma_f32_16x16x32_bf16 v[112:115], a[140:143], a[236:239], v[112:115]
    buffer_load_dwordx4 v15, s[8:11], s82 offen offset:3072 lds
    v_mfma_f32_16x16x32_bf16 v[120:123], a[128:131], a[240:243], v[76:79]
    s_xor_b32 s15, s15, 196608
    v_exp_f32 v97, v97
    v_mfma_f32_16x16x32_bf16 v[120:123], a[132:135], a[244:247], v[120:123]
    s_add_u32 m0, s16, 0
    ds_read_b128 a[128:131], v18 offset:0
    v_cvt_pk_bf16_f32 v48, v96, v97
    v_mfma_f32_16x16x32_bf16 v[120:123], a[136:139], a[248:251], v[120:123]
    v_exp_f32 v98, v98
    v_mfma_f32_16x16x32_bf16 v[120:123], a[140:143], a[252:255], v[120:123]
    buffer_load_dwordx4 v1, s[8:11], s19 offen offset:0 lds
    v_mfma_f32_16x16x32_bf16 v[116:119], a[144:147], a[224:227], v[72:75]
    v_exp_f32 v99, v99
    v_mfma_f32_16x16x32_bf16 v[116:119], a[148:151], a[228:231], v[116:119]
    ds_read_b128 a[132:135], v18 offset:1024
    v_cvt_pk_bf16_f32 v49, v98, v99
    v_mfma_f32_16x16x32_bf16 v[116:119], a[152:155], a[232:235], v[116:119]
    v_exp_f32 v100, v100
    v_mfma_f32_16x16x32_bf16 v[116:119], a[156:159], a[236:239], v[116:119]
    buffer_load_dwordx4 v1, s[8:11], s19 offen offset:1024 lds
    v_mfma_f32_16x16x32_bf16 v[124:127], a[144:147], a[240:243], v[76:79]
    v_exp_f32 v101, v101
    v_mfma_f32_16x16x32_bf16 v[124:127], a[148:151], a[244:247], v[124:127]
    ds_read_b128 a[136:139], v18 offset:2048
    v_cvt_pk_bf16_f32 v50, v100, v101
    v_mfma_f32_16x16x32_bf16 v[124:127], a[152:155], a[248:251], v[124:127]
    v_exp_f32 v102, v102
    v_mfma_f32_16x16x32_bf16 v[124:127], a[156:159], a[252:255], v[124:127]
    buffer_load_dwordx4 v1, s[8:11], s19 offen offset:2048 lds
    v_mfma_f32_16x16x32_bf16 v[40:43], v[28:31], v[56:59], v[40:43]
    v_exp_f32 v103, v103
    v_mfma_f32_16x16x32_bf16 v[44:47], v[28:31], v[60:63], v[44:47]
    ds_read_b128 a[140:143], v18 offset:3072
    v_cvt_pk_bf16_f32 v51, v102, v103
    v_mfma_f32_16x16x32_bf16 v[192:195], a[160:163], v[56:59], v[192:195]
    v_exp_f32 v104, v104
    v_mfma_f32_16x16x32_bf16 v[224:227], a[160:163], v[60:63], v[224:227]
    v_mfma_f32_16x16x32_bf16 v[196:199], a[164:167], v[56:59], v[196:199]
    v_exp_f32 v105, v105
    v_mfma_f32_16x16x32_bf16 v[228:231], a[164:167], v[60:63], v[228:231]
    ds_read_b128 a[144:147], v18 offset:4096
    v_cvt_pk_bf16_f32 v52, v104, v105
    v_mfma_f32_16x16x32_bf16 v[200:203], a[168:171], v[56:59], v[200:203]
    v_exp_f32 v106, v106
    v_mfma_f32_16x16x32_bf16 v[232:235], a[168:171], v[60:63], v[232:235]
    buffer_load_dwordx4 v1, s[8:11], s19 offen offset:3072 lds
    v_mfma_f32_16x16x32_bf16 v[204:207], a[172:175], v[56:59], v[204:207]
    s_add_u32 m0, s16, 4096
    v_exp_f32 v107, v107
    v_mfma_f32_16x16x32_bf16 v[236:239], a[172:175], v[60:63], v[236:239]
    ds_read_b128 a[148:151], v18 offset:5120
    v_cvt_pk_bf16_f32 v53, v106, v107
    v_mfma_f32_16x16x32_bf16 v[208:211], a[176:179], v[56:59], v[208:211]
    v_exp_f32 v108, v108
    v_mfma_f32_16x16x32_bf16 v[240:243], a[176:179], v[60:63], v[240:243]
    buffer_load_dwordx4 v15, s[8:11], s19 offen offset:0 lds
    v_mfma_f32_16x16x32_bf16 v[212:215], a[180:183], v[56:59], v[212:215]
    v_exp_f32 v109, v109
    v_mfma_f32_16x16x32_bf16 v[244:247], a[180:183], v[60:63], v[244:247]
    ds_read_b128 a[152:155], v18 offset:6144
    v_cvt_pk_bf16_f32 v54, v108, v109
    v_mfma_f32_16x16x32_bf16 v[216:219], a[184:187], v[56:59], v[216:219]
    v_exp_f32 v110, v110
    v_mfma_f32_16x16x32_bf16 v[248:251], a[184:187], v[60:63], v[248:251]
    buffer_load_dwordx4 v15, s[8:11], s19 offen offset:1024 lds
    v_mfma_f32_16x16x32_bf16 v[220:223], a[188:191], v[56:59], v[220:223]
    v_exp_f32 v111, v111
    v_mfma_f32_16x16x32_bf16 v[252:255], a[188:191], v[60:63], v[252:255]
    ds_read_b128 a[156:159], v18 offset:7168
    v_cvt_pk_bf16_f32 v55, v110, v111
    s_waitcnt lgkmcnt(7)
    v_mfma_f32_16x16x32_bf16 v[96:99], a[128:131], a[192:195], v[64:67]
    s_waitcnt lgkmcnt(6)
    ds_read_b128 a[160:163], v19 offset:16384
    v_add_f32 v93, 0xf1800000, v21
    v_mfma_f32_16x16x32_bf16 v[96:99], a[132:135], a[196:199], v[96:99]
    s_waitcnt lgkmcnt(6)
    ds_read_b128 a[164:167], v19 offset:17408
    v_min_f32 v93, v93, v69
    v_mfma_f32_16x16x32_bf16 v[96:99], a[136:139], a[200:203], v[96:99]
    s_waitcnt lgkmcnt(6)
    v_exp_f32 v112, v112
    v_mfma_f32_16x16x32_bf16 v[96:99], a[140:143], a[204:207], v[96:99]
    buffer_load_dwordx4 v15, s[8:11], s19 offen offset:2048 lds
    v_mfma_f32_16x16x32_bf16 v[104:107], a[128:131], a[208:211], v[68:71]
    v_exp_f32 v113, v113
    v_mfma_f32_16x16x32_bf16 v[104:107], a[132:135], a[212:215], v[104:107]
    ds_read_b128 a[168:171], v19 offset:18432
    v_cvt_pk_bf16_f32 v56, v112, v113
    v_mfma_f32_16x16x32_bf16 v[104:107], a[136:139], a[216:219], v[104:107]
    s_waitcnt lgkmcnt(6)
    v_exp_f32 v114, v114
    v_mfma_f32_16x16x32_bf16 v[104:107], a[140:143], a[220:223], v[104:107]
    buffer_load_dwordx4 v15, s[8:11], s19 offen offset:3072 lds
    v_mfma_f32_16x16x32_bf16 v[100:103], a[144:147], a[192:195], v[64:67]
    s_waitcnt lgkmcnt(5)
    s_xor_b32 s16, s16, 98304
    v_exp_f32 v115, v115
    v_mfma_f32_16x16x32_bf16 v[100:103], a[148:151], a[196:199], v[100:103]
    s_waitcnt lgkmcnt(4)
    s_xor_b32 s74, s24, 28672
    ds_read_b128 a[172:175], v19 offset:19456
    v_cvt_pk_bf16_f32 v57, v114, v115
    v_mfma_f32_16x16x32_bf16 v[100:103], a[152:155], a[200:203], v[100:103]
    s_waitcnt lgkmcnt(4)
    v_exp_f32 v116, v116
    v_mfma_f32_16x16x32_bf16 v[100:103], a[156:159], a[204:207], v[100:103]
    buffer_load_dwordx4 a[48:51], v1, s[8:11], s74 offen offset:0
    v_mfma_f32_16x16x32_bf16 v[108:111], a[144:147], a[208:211], v[68:71]
    s_xor_b32 s74, s24, 28672
    v_exp_f32 v117, v117
    v_mfma_f32_16x16x32_bf16 v[108:111], a[148:151], a[212:215], v[108:111]
    ds_read_b128 a[176:179], v20 offset:20480
    v_cvt_pk_bf16_f32 v58, v116, v117
    v_mfma_f32_16x16x32_bf16 v[108:111], a[152:155], a[216:219], v[108:111]
    v_exp_f32 v118, v118
    v_mfma_f32_16x16x32_bf16 v[108:111], a[156:159], a[220:223], v[108:111]
    buffer_load_dwordx4 a[52:55], v1, s[8:11], s74 offen offset:1024
    v_mfma_f32_16x16x32_bf16 v[32:35], v[28:31], v[48:51], v[32:35]
    s_xor_b32 s74, s24, 28672
    v_exp_f32 v119, v119
    v_mfma_f32_16x16x32_bf16 v[36:39], v[28:31], v[52:55], v[36:39]
    s_waitcnt lgkmcnt(4)
    ds_read_b128 a[180:183], v20 offset:21504
    v_cvt_pk_bf16_f32 v59, v118, v119
    v_mfma_f32_16x16x32_bf16 v[128:131], a[160:163], v[48:51], v[128:131]
    s_waitcnt lgkmcnt(4)
    v_exp_f32 v120, v120
    v_mfma_f32_16x16x32_bf16 v[160:163], a[160:163], v[52:55], v[160:163]
    buffer_load_dwordx4 a[56:59], v1, s[8:11], s74 offen offset:2048
    v_mfma_f32_16x16x32_bf16 v[132:135], a[164:167], v[48:51], v[132:135]
    s_xor_b32 s74, s24, 28672
    v_exp_f32 v121, v121
    v_mfma_f32_16x16x32_bf16 v[164:167], a[164:167], v[52:55], v[164:167]
    s_waitcnt lgkmcnt(3)
    ds_read_b128 a[184:187], v20 offset:22528
    v_cvt_pk_bf16_f32 v60, v120, v121
    v_mfma_f32_16x16x32_bf16 v[136:139], a[168:171], v[48:51], v[136:139]
    s_waitcnt lgkmcnt(3)
    v_exp_f32 v122, v122
    v_mfma_f32_16x16x32_bf16 v[168:171], a[168:171], v[52:55], v[168:171]
    buffer_load_dwordx4 a[60:63], v1, s[8:11], s74 offen offset:3072
    v_mfma_f32_16x16x32_bf16 v[140:143], a[172:175], v[48:51], v[140:143]
    v_exp_f32 v123, v123
    v_mfma_f32_16x16x32_bf16 v[172:175], a[172:175], v[52:55], v[172:175]
    s_waitcnt lgkmcnt(2)
    ds_read_b128 a[188:191], v20 offset:23552
    v_cvt_pk_bf16_f32 v61, v122, v123
    v_mfma_f32_16x16x32_bf16 v[144:147], a[176:179], v[48:51], v[144:147]
    v_exp_f32 v124, v124
    v_mfma_f32_16x16x32_bf16 v[176:179], a[176:179], v[52:55], v[176:179]
    s_waitcnt lgkmcnt(2)
    v_add_f32 v94, 0xf2000000, v21
    v_min_f32 v94, v94, v70
    v_mfma_f32_16x16x32_bf16 v[148:151], a[180:183], v[48:51], v[148:151]
    v_exp_f32 v125, v125
    v_mfma_f32_16x16x32_bf16 v[180:183], a[180:183], v[52:55], v[180:183]
    s_waitcnt lgkmcnt(1)
    v_cvt_pk_bf16_f32 v62, v124, v125
    v_xor_b32 v19, 98304, v19
    v_mfma_f32_16x16x32_bf16 v[152:155], a[184:187], v[48:51], v[152:155]
    v_exp_f32 v126, v126
    v_mfma_f32_16x16x32_bf16 v[184:187], a[184:187], v[52:55], v[184:187]
    s_waitcnt lgkmcnt(0)
    v_xor_b32 v20, 98304, v20
    v_add_f32 v95, 0xf2400000, v21
    v_mfma_f32_16x16x32_bf16 v[156:159], a[188:191], v[48:51], v[156:159]
    v_exp_f32 v127, v127
    v_mfma_f32_16x16x32_bf16 v[188:191], a[188:191], v[52:55], v[188:191]
    v_cvt_pk_bf16_f32 v63, v126, v127
    v_min_f32 v95, v95, v71
    v_mfma_f32_16x16x32_bf16 v[112:115], a[128:131], a[224:227], v[72:75]
    v_exp_f32 v96, v96
    v_mfma_f32_16x16x32_bf16 v[112:115], a[132:135], a[228:231], v[112:115]
    v_mfma_f32_16x16x32_bf16 v[112:115], a[136:139], a[232:235], v[112:115]
    v_exp_f32 v97, v97
    v_mfma_f32_16x16x32_bf16 v[112:115], a[140:143], a[236:239], v[112:115]
    v_cvt_pk_bf16_f32 v48, v96, v97
    v_mfma_f32_16x16x32_bf16 v[120:123], a[128:131], a[240:243], v[76:79]
    v_exp_f32 v98, v98
    v_mfma_f32_16x16x32_bf16 v[120:123], a[132:135], a[244:247], v[120:123]
    v_mfma_f32_16x16x32_bf16 v[120:123], a[136:139], a[248:251], v[120:123]
    v_exp_f32 v99, v99
    v_mfma_f32_16x16x32_bf16 v[120:123], a[140:143], a[252:255], v[120:123]
    v_mfma_f32_16x16x32_bf16 v[116:119], a[144:147], a[224:227], v[72:75]
    v_exp_f32 v100, v100
    v_mfma_f32_16x16x32_bf16 v[116:119], a[148:151], a[228:231], v[116:119]
    ds_read_b128 a[128:131], v18 offset:16384
    v_cvt_pk_bf16_f32 v49, v98, v99
    v_mfma_f32_16x16x32_bf16 v[116:119], a[152:155], a[232:235], v[116:119]
    s_add_u32 s19, s82, 32768
    v_exp_f32 v101, v101
    v_mfma_f32_16x16x32_bf16 v[116:119], a[156:159], a[236:239], v[116:119]
    s_sub_u32 s82, s12, s13
    ds_read_b128 a[132:135], v18 offset:17408
    v_cvt_pk_bf16_f32 v50, v100, v101
    v_mfma_f32_16x16x32_bf16 v[124:127], a[144:147], a[240:243], v[76:79]
    s_sub_u32 s82, s82, 1
    v_exp_f32 v102, v102
    v_mfma_f32_16x16x32_bf16 v[124:127], a[148:151], a[244:247], v[124:127]
    s_cmp_gt_u32 s12, s13
    s_cselect_b32 s82, s82, s12
    s_lshl_b32 s82, s82, 16
    ds_read_b128 a[136:139], v18 offset:18432
    v_mfma_f32_16x16x32_bf16 v[124:127], a[152:155], a[248:251], v[124:127]
    s_add_u32 s82, s82, s81
    v_exp_f32 v103, v103
    v_mfma_f32_16x16x32_bf16 v[124:127], a[156:159], a[252:255], v[124:127]
    s_cmp_ge_u32 s12, 17
    s_cselect_b32 s82, 2147471360, s82
    ds_read_b128 a[140:143], v18 offset:19456
    v_cvt_pk_bf16_f32 v51, v102, v103
    v_mfma_f32_16x16x32_bf16 v[40:43], v[28:31], v[56:59], v[40:43]
    s_add_u32 s12, s12, 1
    v_exp_f32 v104, v104
    v_mfma_f32_16x16x32_bf16 v[44:47], v[28:31], v[60:63], v[44:47]
    ds_read_b128 a[144:147], v18 offset:20480
    v_mfma_f32_16x16x32_bf16 v[192:195], a[160:163], v[56:59], v[192:195]
    v_exp_f32 v105, v105
    v_mfma_f32_16x16x32_bf16 v[224:227], a[160:163], v[60:63], v[224:227]
    ds_read_b128 a[148:151], v18 offset:21504
    v_cvt_pk_bf16_f32 v52, v104, v105
    v_mfma_f32_16x16x32_bf16 v[196:199], a[164:167], v[56:59], v[196:199]
    v_exp_f32 v106, v106
    v_mfma_f32_16x16x32_bf16 v[228:231], a[164:167], v[60:63], v[228:231]
    ds_read_b128 a[152:155], v18 offset:22528
    v_mfma_f32_16x16x32_bf16 v[200:203], a[168:171], v[56:59], v[200:203]
    v_exp_f32 v107, v107
    v_mfma_f32_16x16x32_bf16 v[232:235], a[168:171], v[60:63], v[232:235]
    ds_read_b128 a[156:159], v18 offset:23552
    v_cvt_pk_bf16_f32 v53, v106, v107
    v_mfma_f32_16x16x32_bf16 v[204:207], a[172:175], v[56:59], v[204:207]
    v_exp_f32 v108, v108
    v_mfma_f32_16x16x32_bf16 v[236:239], a[172:175], v[60:63], v[236:239]
    v_mfma_f32_16x16x32_bf16 v[208:211], a[176:179], v[56:59], v[208:211]
    v_exp_f32 v109, v109
    v_mfma_f32_16x16x32_bf16 v[240:243], a[176:179], v[60:63], v[240:243]
    v_cvt_pk_bf16_f32 v54, v108, v109
    v_xor_b32 v18, 196608, v18
    v_mfma_f32_16x16x32_bf16 v[212:215], a[180:183], v[56:59], v[212:215]
    v_exp_f32 v110, v110
    v_mfma_f32_16x16x32_bf16 v[244:247], a[180:183], v[60:63], v[244:247]
    v_mfma_f32_16x16x32_bf16 v[216:219], a[184:187], v[56:59], v[216:219]
    v_exp_f32 v111, v111
    v_mfma_f32_16x16x32_bf16 v[248:251], a[184:187], v[60:63], v[248:251]
    v_cvt_pk_bf16_f32 v55, v110, v111
    v_mfma_f32_16x16x32_bf16 v[220:223], a[188:191], v[56:59], v[220:223]
    v_mfma_f32_16x16x32_bf16 v[252:255], a[188:191], v[60:63], v[252:255]
    s_waitcnt vmcnt(4) lgkmcnt(0)
    s_barrier
    v_mfma_f32_16x16x32_bf16 v[96:99], a[128:131], a[192:195], v[64:67]
    s_add_u32 m0, s15, 0
    ds_read_b128 a[160:163], v19 offset:0
    v_mfma_f32_16x16x32_bf16 v[96:99], a[132:135], a[196:199], v[96:99]
    ds_read_b128 a[164:167], v19 offset:1024
    v_mfma_f32_16x16x32_bf16 v[96:99], a[136:139], a[200:203], v[96:99]
    v_exp_f32 v112, v112
    v_mfma_f32_16x16x32_bf16 v[96:99], a[140:143], a[204:207], v[96:99]
    buffer_load_dwordx4 v1, s[8:11], s82 offen offset:0 lds
    v_mfma_f32_16x16x32_bf16 v[104:107], a[128:131], a[208:211], v[68:71]
    v_exp_f32 v113, v113
    v_mfma_f32_16x16x32_bf16 v[104:107], a[132:135], a[212:215], v[104:107]
    ds_read_b128 a[168:171], v19 offset:2048
    v_cvt_pk_bf16_f32 v56, v112, v113
    v_mfma_f32_16x16x32_bf16 v[104:107], a[136:139], a[216:219], v[104:107]
    v_exp_f32 v114, v114
    v_mfma_f32_16x16x32_bf16 v[104:107], a[140:143], a[220:223], v[104:107]
    buffer_load_dwordx4 v1, s[8:11], s82 offen offset:1024 lds
    v_mfma_f32_16x16x32_bf16 v[100:103], a[144:147], a[192:195], v[64:67]
    v_exp_f32 v115, v115
    v_mfma_f32_16x16x32_bf16 v[100:103], a[148:151], a[196:199], v[100:103]
    ds_read_b128 a[172:175], v19 offset:3072
    v_cvt_pk_bf16_f32 v57, v114, v115
    v_mfma_f32_16x16x32_bf16 v[100:103], a[152:155], a[200:203], v[100:103]
    v_exp_f32 v116, v116
    v_mfma_f32_16x16x32_bf16 v[100:103], a[156:159], a[204:207], v[100:103]
    buffer_load_dwordx4 v1, s[8:11], s82 offen offset:2048 lds
    v_mfma_f32_16x16x32_bf16 v[108:111], a[144:147], a[208:211], v[68:71]
    v_exp_f32 v117, v117
    v_mfma_f32_16x16x32_bf16 v[108:111], a[148:151], a[212:215], v[108:111]
    ds_read_b128 a[176:179], v20 offset:4096
    v_cvt_pk_bf16_f32 v58, v116, v117
    v_mfma_f32_16x16x32_bf16 v[108:111], a[152:155], a[216:219], v[108:111]
    v_exp_f32 v118, v118
    v_mfma_f32_16x16x32_bf16 v[108:111], a[156:159], a[220:223], v[108:111]
    buffer_load_dwordx4 v1, s[8:11], s82 offen offset:3072 lds
    v_mfma_f32_16x16x32_bf16 v[32:35], v[28:31], v[48:51], v[32:35]
    s_add_u32 m0, s15, 4096
    v_exp_f32 v119, v119
    v_mfma_f32_16x16x32_bf16 v[36:39], v[28:31], v[52:55], v[36:39]
    s_waitcnt lgkmcnt(4)
    ds_read_b128 a[180:183], v20 offset:5120
    v_cvt_pk_bf16_f32 v59, v118, v119
    v_mfma_f32_16x16x32_bf16 v[128:131], a[160:163], v[48:51], v[128:131]
    v_exp_f32 v120, v120
    v_mfma_f32_16x16x32_bf16 v[160:163], a[160:163], v[52:55], v[160:163]
    s_waitcnt lgkmcnt(4)
    v_mfma_f32_16x16x32_bf16 v[132:135], a[164:167], v[48:51], v[132:135]
    v_exp_f32 v121, v121
    v_mfma_f32_16x16x32_bf16 v[164:167], a[164:167], v[52:55], v[164:167]
    s_waitcnt lgkmcnt(3)
    ds_read_b128 a[184:187], v20 offset:6144
    v_cvt_pk_bf16_f32 v60, v120, v121
    v_mfma_f32_16x16x32_bf16 v[136:139], a[168:171], v[48:51], v[136:139]
    s_waitcnt lgkmcnt(3)
    v_exp_f32 v122, v122
    v_mfma_f32_16x16x32_bf16 v[168:171], a[168:171], v[52:55], v[168:171]
    buffer_load_dwordx4 v15, s[8:11], s82 offen offset:0 lds
    v_mfma_f32_16x16x32_bf16 v[140:143], a[172:175], v[48:51], v[140:143]
    v_exp_f32 v123, v123
    v_mfma_f32_16x16x32_bf16 v[172:175], a[172:175], v[52:55], v[172:175]
    s_waitcnt lgkmcnt(2)
    ds_read_b128 a[188:191], v20 offset:7168
    v_cvt_pk_bf16_f32 v61, v122, v123
    v_mfma_f32_16x16x32_bf16 v[144:147], a[176:179], v[48:51], v[144:147]
    s_waitcnt lgkmcnt(2)
    v_exp_f32 v124, v124
    v_mfma_f32_16x16x32_bf16 v[176:179], a[176:179], v[52:55], v[176:179]
    buffer_load_dwordx4 v15, s[8:11], s82 offen offset:1024 lds
    v_mfma_f32_16x16x32_bf16 v[148:151], a[180:183], v[48:51], v[148:151]
    v_exp_f32 v125, v125
    v_mfma_f32_16x16x32_bf16 v[180:183], a[180:183], v[52:55], v[180:183]
    s_waitcnt lgkmcnt(1)
    v_cvt_pk_bf16_f32 v62, v124, v125
    v_mfma_f32_16x16x32_bf16 v[152:155], a[184:187], v[48:51], v[152:155]
    s_waitcnt lgkmcnt(0)
    v_exp_f32 v126, v126
    v_mfma_f32_16x16x32_bf16 v[184:187], a[184:187], v[52:55], v[184:187]
    buffer_load_dwordx4 v15, s[8:11], s82 offen offset:2048 lds
    v_mfma_f32_16x16x32_bf16 v[156:159], a[188:191], v[48:51], v[156:159]
    v_exp_f32 v127, v127
    v_mfma_f32_16x16x32_bf16 v[188:191], a[188:191], v[52:55], v[188:191]
    v_cvt_pk_bf16_f32 v63, v126, v127
    v_mfma_f32_16x16x32_bf16 v[112:115], a[128:131], a[224:227], v[72:75]
    v_mfma_f32_16x16x32_bf16 v[112:115], a[132:135], a[228:231], v[112:115]
    v_mfma_f32_16x16x32_bf16 v[112:115], a[136:139], a[232:235], v[112:115]
    v_exp_f32 v96, v96
    v_mfma_f32_16x16x32_bf16 v[112:115], a[140:143], a[236:239], v[112:115]
    buffer_load_dwordx4 v15, s[8:11], s82 offen offset:3072 lds
    v_mfma_f32_16x16x32_bf16 v[120:123], a[128:131], a[240:243], v[76:79]
    s_xor_b32 s15, s15, 196608
    v_exp_f32 v97, v97
    v_mfma_f32_16x16x32_bf16 v[120:123], a[132:135], a[244:247], v[120:123]
    s_add_u32 m0, s16, 0
    ds_read_b128 a[128:131], v18 offset:0
    v_cvt_pk_bf16_f32 v48, v96, v97
    v_mfma_f32_16x16x32_bf16 v[120:123], a[136:139], a[248:251], v[120:123]
    v_exp_f32 v98, v98
    v_mfma_f32_16x16x32_bf16 v[120:123], a[140:143], a[252:255], v[120:123]
    buffer_load_dwordx4 v1, s[8:11], s19 offen offset:0 lds
    v_mfma_f32_16x16x32_bf16 v[116:119], a[144:147], a[224:227], v[72:75]
    v_exp_f32 v99, v99
    v_mfma_f32_16x16x32_bf16 v[116:119], a[148:151], a[228:231], v[116:119]
    ds_read_b128 a[132:135], v18 offset:1024
    v_cvt_pk_bf16_f32 v49, v98, v99
    v_mfma_f32_16x16x32_bf16 v[116:119], a[152:155], a[232:235], v[116:119]
    v_exp_f32 v100, v100
    v_mfma_f32_16x16x32_bf16 v[116:119], a[156:159], a[236:239], v[116:119]
    buffer_load_dwordx4 v1, s[8:11], s19 offen offset:1024 lds
    v_mfma_f32_16x16x32_bf16 v[124:127], a[144:147], a[240:243], v[76:79]
    v_exp_f32 v101, v101
    v_mfma_f32_16x16x32_bf16 v[124:127], a[148:151], a[244:247], v[124:127]
    ds_read_b128 a[136:139], v18 offset:2048
    v_cvt_pk_bf16_f32 v50, v100, v101
    v_mfma_f32_16x16x32_bf16 v[124:127], a[152:155], a[248:251], v[124:127]
    v_exp_f32 v102, v102
    v_mfma_f32_16x16x32_bf16 v[124:127], a[156:159], a[252:255], v[124:127]
    buffer_load_dwordx4 v1, s[8:11], s19 offen offset:2048 lds
    v_mfma_f32_16x16x32_bf16 v[40:43], v[28:31], v[56:59], v[40:43]
    v_exp_f32 v103, v103
    v_mfma_f32_16x16x32_bf16 v[44:47], v[28:31], v[60:63], v[44:47]
    ds_read_b128 a[140:143], v18 offset:3072
    v_cvt_pk_bf16_f32 v51, v102, v103
    v_mfma_f32_16x16x32_bf16 v[192:195], a[160:163], v[56:59], v[192:195]
    v_exp_f32 v104, v104
    v_mfma_f32_16x16x32_bf16 v[224:227], a[160:163], v[60:63], v[224:227]
    v_mfma_f32_16x16x32_bf16 v[196:199], a[164:167], v[56:59], v[196:199]
    v_exp_f32 v105, v105
    v_mfma_f32_16x16x32_bf16 v[228:231], a[164:167], v[60:63], v[228:231]
    ds_read_b128 a[144:147], v18 offset:4096
    v_cvt_pk_bf16_f32 v52, v104, v105
    v_mfma_f32_16x16x32_bf16 v[200:203], a[168:171], v[56:59], v[200:203]
    v_exp_f32 v106, v106
    v_mfma_f32_16x16x32_bf16 v[232:235], a[168:171], v[60:63], v[232:235]
    buffer_load_dwordx4 v1, s[8:11], s19 offen offset:3072 lds
    v_mfma_f32_16x16x32_bf16 v[204:207], a[172:175], v[56:59], v[204:207]
    s_add_u32 m0, s16, 4096
    v_exp_f32 v107, v107
    v_mfma_f32_16x16x32_bf16 v[236:239], a[172:175], v[60:63], v[236:239]
    ds_read_b128 a[148:151], v18 offset:5120
    v_cvt_pk_bf16_f32 v53, v106, v107
    v_mfma_f32_16x16x32_bf16 v[208:211], a[176:179], v[56:59], v[208:211]
    v_exp_f32 v108, v108
    v_mfma_f32_16x16x32_bf16 v[240:243], a[176:179], v[60:63], v[240:243]
    buffer_load_dwordx4 v15, s[8:11], s19 offen offset:0 lds
    v_mfma_f32_16x16x32_bf16 v[212:215], a[180:183], v[56:59], v[212:215]
    v_exp_f32 v109, v109
    v_mfma_f32_16x16x32_bf16 v[244:247], a[180:183], v[60:63], v[244:247]
    ds_read_b128 a[152:155], v18 offset:6144
    v_cvt_pk_bf16_f32 v54, v108, v109
    v_mfma_f32_16x16x32_bf16 v[216:219], a[184:187], v[56:59], v[216:219]
    v_exp_f32 v110, v110
    v_mfma_f32_16x16x32_bf16 v[248:251], a[184:187], v[60:63], v[248:251]
    buffer_load_dwordx4 v15, s[8:11], s19 offen offset:1024 lds
    v_mfma_f32_16x16x32_bf16 v[220:223], a[188:191], v[56:59], v[220:223]
    v_exp_f32 v111, v111
    v_mfma_f32_16x16x32_bf16 v[252:255], a[188:191], v[60:63], v[252:255]
    ds_read_b128 a[156:159], v18 offset:7168
    v_cvt_pk_bf16_f32 v55, v110, v111
    s_cmp_eq_u32 s14, 0
    s_cbranch_scc1 L_t2_diag
.p2align 3
L_t2_loop:
    s_waitcnt lgkmcnt(7)
    v_mfma_f32_16x16x32_bf16 v[96:99], a[128:131], a[192:195], v[64:67]
    s_waitcnt lgkmcnt(6)
    ds_read_b128 a[160:163], v19 offset:16384
    v_mfma_f32_16x16x32_bf16 v[96:99], a[132:135], a[196:199], v[96:99]
    s_waitcnt lgkmcnt(6)
    ds_read_b128 a[164:167], v19 offset:17408
    v_mfma_f32_16x16x32_bf16 v[96:99], a[136:139], a[200:203], v[96:99]
    s_waitcnt lgkmcnt(6)
    v_exp_f32 v112, v112
    v_mfma_f32_16x16x32_bf16 v[96:99], a[140:143], a[204:207], v[96:99]
    buffer_load_dwordx4 v15, s[8:11], s19 offen offset:2048 lds
    v_mfma_f32_16x16x32_bf16 v[104:107], a[128:131], a[208:211], v[68:71]
    v_exp_f32 v113, v113
    v_mfma_f32_16x16x32_bf16 v[104:107], a[132:135], a[212:215], v[104:107]
    ds_read_b128 a[168:171], v19 offset:18432
    v_cvt_pk_bf16_f32 v56, v112, v113
    v_mfma_f32_16x16x32_bf16 v[104:107], a[136:139], a[216:219], v[104:107]
    s_waitcnt lgkmcnt(6)
    v_exp_f32 v114, v114
    v_mfma_f32_16x16x32_bf16 v[104:107], a[140:143], a[220:223], v[104:107]
    buffer_load_dwordx4 v15, s[8:11], s19 offen offset:3072 lds
    v_mfma_f32_16x16x32_bf16 v[100:103], a[144:147], a[192:195], v[64:67]
    s_waitcnt lgkmcnt(5)
    s_xor_b32 s16, s16, 98304
    v_exp_f32 v115, v115
    v_mfma_f32_16x16x32_bf16 v[100:103], a[148:151], a[196:199], v[100:103]
    s_waitcnt lgkmcnt(4)
    ds_read_b128 a[172:175], v19 offset:19456
    v_cvt_pk_bf16_f32 v57, v114, v115
    v_mfma_f32_16x16x32_bf16 v[100:103], a[152:155], a[200:203], v[100:103]
    s_waitcnt lgkmcnt(4)
    v_exp_f32 v116, v116
    v_mfma_f32_16x16x32_bf16 v[100:103], a[156:159], a[204:207], v[100:103]
    v_mfma_f32_16x16x32_bf16 v[108:111], a[144:147], a[208:211], v[68:71]
    v_exp_f32 v117, v117
    v_mfma_f32_16x16x32_bf16 v[108:111], a[148:151], a[212:215], v[108:111]
    ds_read_b128 a[176:179], v20 offset:20480
    v_cvt_pk_bf16_f32 v58, v116, v117
    v_mfma_f32_16x16x32_bf16 v[108:111], a[152:155], a[216:219], v[108:111]
    v_exp_f32 v118, v118
    v_mfma_f32_16x16x32_bf16 v[108:111], a[156:159], a[220:223], v[108:111]
    v_mfma_f32_16x16x32_bf16 v[32:35], v[28:31], v[48:51], v[32:35]
    v_exp_f32 v119, v119
    v_mfma_f32_16x16x32_bf16 v[36:39], v[28:31], v[52:55], v[36:39]
    s_waitcnt lgkmcnt(4)
    ds_read_b128 a[180:183], v20 offset:21504
    v_cvt_pk_bf16_f32 v59, v118, v119
    v_mfma_f32_16x16x32_bf16 v[128:131], a[160:163], v[48:51], v[128:131]
    v_exp_f32 v120, v120
    v_mfma_f32_16x16x32_bf16 v[160:163], a[160:163], v[52:55], v[160:163]
    s_waitcnt lgkmcnt(4)
    v_mfma_f32_16x16x32_bf16 v[132:135], a[164:167], v[48:51], v[132:135]
    v_exp_f32 v121, v121
    v_mfma_f32_16x16x32_bf16 v[164:167], a[164:167], v[52:55], v[164:167]
    s_waitcnt lgkmcnt(3)
    ds_read_b128 a[184:187], v20 offset:22528
    v_cvt_pk_bf16_f32 v60, v120, v121
    v_mfma_f32_16x16x32_bf16 v[136:139], a[168:171], v[48:51], v[136:139]
    v_exp_f32 v122, v122
    v_mfma_f32_16x16x32_bf16 v[168:171], a[168:171], v[52:55], v[168:171]
    s_waitcnt lgkmcnt(3)
    v_mfma_f32_16x16x32_bf16 v[140:143], a[172:175], v[48:51], v[140:143]
    v_exp_f32 v123, v123
    v_mfma_f32_16x16x32_bf16 v[172:175], a[172:175], v[52:55], v[172:175]
    s_waitcnt lgkmcnt(2)
    ds_read_b128 a[188:191], v20 offset:23552
    v_cvt_pk_bf16_f32 v61, v122, v123
    v_mfma_f32_16x16x32_bf16 v[144:147], a[176:179], v[48:51], v[144:147]
    v_exp_f32 v124, v124
    v_mfma_f32_16x16x32_bf16 v[176:179], a[176:179], v[52:55], v[176:179]
    s_waitcnt lgkmcnt(2)
    v_mfma_f32_16x16x32_bf16 v[148:151], a[180:183], v[48:51], v[148:151]
    v_exp_f32 v125, v125
    v_mfma_f32_16x16x32_bf16 v[180:183], a[180:183], v[52:55], v[180:183]
    s_waitcnt lgkmcnt(1)
    v_cvt_pk_bf16_f32 v62, v124, v125
    v_xor_b32 v19, 98304, v19
    v_mfma_f32_16x16x32_bf16 v[152:155], a[184:187], v[48:51], v[152:155]
    v_exp_f32 v126, v126
    v_mfma_f32_16x16x32_bf16 v[184:187], a[184:187], v[52:55], v[184:187]
    s_waitcnt lgkmcnt(0)
    v_xor_b32 v20, 98304, v20
    v_mfma_f32_16x16x32_bf16 v[156:159], a[188:191], v[48:51], v[156:159]
    v_exp_f32 v127, v127
    v_mfma_f32_16x16x32_bf16 v[188:191], a[188:191], v[52:55], v[188:191]
    v_cvt_pk_bf16_f32 v63, v126, v127
    v_mfma_f32_16x16x32_bf16 v[112:115], a[128:131], a[224:227], v[72:75]
    v_exp_f32 v96, v96
    v_mfma_f32_16x16x32_bf16 v[112:115], a[132:135], a[228:231], v[112:115]
    v_mfma_f32_16x16x32_bf16 v[112:115], a[136:139], a[232:235], v[112:115]
    v_exp_f32 v97, v97
    v_mfma_f32_16x16x32_bf16 v[112:115], a[140:143], a[236:239], v[112:115]
    v_cvt_pk_bf16_f32 v48, v96, v97
    v_mfma_f32_16x16x32_bf16 v[120:123], a[128:131], a[240:243], v[76:79]
    v_exp_f32 v98, v98
    v_mfma_f32_16x16x32_bf16 v[120:123], a[132:135], a[244:247], v[120:123]
    v_mfma_f32_16x16x32_bf16 v[120:123], a[136:139], a[248:251], v[120:123]
    v_exp_f32 v99, v99
    v_mfma_f32_16x16x32_bf16 v[120:123], a[140:143], a[252:255], v[120:123]
    v_mfma_f32_16x16x32_bf16 v[116:119], a[144:147], a[224:227], v[72:75]
    v_exp_f32 v100, v100
    v_mfma_f32_16x16x32_bf16 v[116:119], a[148:151], a[228:231], v[116:119]
    ds_read_b128 a[128:131], v18 offset:16384
    v_cvt_pk_bf16_f32 v49, v98, v99
    v_mfma_f32_16x16x32_bf16 v[116:119], a[152:155], a[232:235], v[116:119]
    s_add_u32 s19, s82, 32768
    v_exp_f32 v101, v101
    v_mfma_f32_16x16x32_bf16 v[116:119], a[156:159], a[236:239], v[116:119]
    s_sub_u32 s82, s12, s13
    ds_read_b128 a[132:135], v18 offset:17408
    v_cvt_pk_bf16_f32 v50, v100, v101
    v_mfma_f32_16x16x32_bf16 v[124:127], a[144:147], a[240:243], v[76:79]
    s_sub_u32 s82, s82, 1
    v_exp_f32 v102, v102
    v_mfma_f32_16x16x32_bf16 v[124:127], a[148:151], a[244:247], v[124:127]
    s_cmp_gt_u32 s12, s13
    s_cselect_b32 s82, s82, s12
    s_lshl_b32 s82, s82, 16
    ds_read_b128 a[136:139], v18 offset:18432
    v_mfma_f32_16x16x32_bf16 v[124:127], a[152:155], a[248:251], v[124:127]
    s_add_u32 s82, s82, s81
    v_exp_f32 v103, v103
    v_mfma_f32_16x16x32_bf16 v[124:127], a[156:159], a[252:255], v[124:127]
    s_cmp_ge_u32 s12, 17
    s_cselect_b32 s82, 2147471360, s82
    ds_read_b128 a[140:143], v18 offset:19456
    v_cvt_pk_bf16_f32 v51, v102, v103
    v_mfma_f32_16x16x32_bf16 v[40:43], v[28:31], v[56:59], v[40:43]
    s_add_u32 s12, s12, 1
    v_exp_f32 v104, v104
    v_mfma_f32_16x16x32_bf16 v[44:47], v[28:31], v[60:63], v[44:47]
    ds_read_b128 a[144:147], v18 offset:20480
    v_mfma_f32_16x16x32_bf16 v[192:195], a[160:163], v[56:59], v[192:195]
    v_exp_f32 v105, v105
    v_mfma_f32_16x16x32_bf16 v[224:227], a[160:163], v[60:63], v[224:227]
    ds_read_b128 a[148:151], v18 offset:21504
    v_cvt_pk_bf16_f32 v52, v104, v105
    v_mfma_f32_16x16x32_bf16 v[196:199], a[164:167], v[56:59], v[196:199]
    v_exp_f32 v106, v106
    v_mfma_f32_16x16x32_bf16 v[228:231], a[164:167], v[60:63], v[228:231]
    ds_read_b128 a[152:155], v18 offset:22528
    v_mfma_f32_16x16x32_bf16 v[200:203], a[168:171], v[56:59], v[200:203]
    v_exp_f32 v107, v107
    v_mfma_f32_16x16x32_bf16 v[232:235], a[168:171], v[60:63], v[232:235]
    ds_read_b128 a[156:159], v18 offset:23552
    v_cvt_pk_bf16_f32 v53, v106, v107
    v_mfma_f32_16x16x32_bf16 v[204:207], a[172:175], v[56:59], v[204:207]
    v_exp_f32 v108, v108
    v_mfma_f32_16x16x32_bf16 v[236:239], a[172:175], v[60:63], v[236:239]
    v_mfma_f32_16x16x32_bf16 v[208:211], a[176:179], v[56:59], v[208:211]
    v_exp_f32 v109, v109
    v_mfma_f32_16x16x32_bf16 v[240:243], a[176:179], v[60:63], v[240:243]
    v_cvt_pk_bf16_f32 v54, v108, v109
    v_xor_b32 v18, 196608, v18
    v_mfma_f32_16x16x32_bf16 v[212:215], a[180:183], v[56:59], v[212:215]
    v_exp_f32 v110, v110
    v_mfma_f32_16x16x32_bf16 v[244:247], a[180:183], v[60:63], v[244:247]
    v_mfma_f32_16x16x32_bf16 v[216:219], a[184:187], v[56:59], v[216:219]
    v_exp_f32 v111, v111
    v_mfma_f32_16x16x32_bf16 v[248:251], a[184:187], v[60:63], v[248:251]
    v_cvt_pk_bf16_f32 v55, v110, v111
    v_mfma_f32_16x16x32_bf16 v[220:223], a[188:191], v[56:59], v[220:223]
    v_mfma_f32_16x16x32_bf16 v[252:255], a[188:191], v[60:63], v[252:255]
    s_waitcnt vmcnt(0) lgkmcnt(0)
    s_barrier
    v_mfma_f32_16x16x32_bf16 v[96:99], a[128:131], a[192:195], v[64:67]
    s_add_u32 m0, s15, 0
    ds_read_b128 a[160:163], v19 offset:0
    v_mfma_f32_16x16x32_bf16 v[96:99], a[132:135], a[196:199], v[96:99]
    ds_read_b128 a[164:167], v19 offset:1024
    v_mfma_f32_16x16x32_bf16 v[96:99], a[136:139], a[200:203], v[96:99]
    v_exp_f32 v112, v112
    v_mfma_f32_16x16x32_bf16 v[96:99], a[140:143], a[204:207], v[96:99]
    buffer_load_dwordx4 v1, s[8:11], s82 offen offset:0 lds
    v_mfma_f32_16x16x32_bf16 v[104:107], a[128:131], a[208:211], v[68:71]
    v_exp_f32 v113, v113
    v_mfma_f32_16x16x32_bf16 v[104:107], a[132:135], a[212:215], v[104:107]
    ds_read_b128 a[168:171], v19 offset:2048
    v_cvt_pk_bf16_f32 v56, v112, v113
    v_mfma_f32_16x16x32_bf16 v[104:107], a[136:139], a[216:219], v[104:107]
    v_exp_f32 v114, v114
    v_mfma_f32_16x16x32_bf16 v[104:107], a[140:143], a[220:223], v[104:107]
    buffer_load_dwordx4 v1, s[8:11], s82 offen offset:1024 lds
    v_mfma_f32_16x16x32_bf16 v[100:103], a[144:147], a[192:195], v[64:67]
    v_exp_f32 v115, v115
    v_mfma_f32_16x16x32_bf16 v[100:103], a[148:151], a[196:199], v[100:103]
    ds_read_b128 a[172:175], v19 offset:3072
    v_cvt_pk_bf16_f32 v57, v114, v115
    v_mfma_f32_16x16x32_bf16 v[100:103], a[152:155], a[200:203], v[100:103]
    v_exp_f32 v116, v116
    v_mfma_f32_16x16x32_bf16 v[100:103], a[156:159], a[204:207], v[100:103]
    buffer_load_dwordx4 v1, s[8:11], s82 offen offset:2048 lds
    v_mfma_f32_16x16x32_bf16 v[108:111], a[144:147], a[208:211], v[68:71]
    v_exp_f32 v117, v117
    v_mfma_f32_16x16x32_bf16 v[108:111], a[148:151], a[212:215], v[108:111]
    ds_read_b128 a[176:179], v20 offset:4096
    v_cvt_pk_bf16_f32 v58, v116, v117
    v_mfma_f32_16x16x32_bf16 v[108:111], a[152:155], a[216:219], v[108:111]
    v_exp_f32 v118, v118
    v_mfma_f32_16x16x32_bf16 v[108:111], a[156:159], a[220:223], v[108:111]
    buffer_load_dwordx4 v1, s[8:11], s82 offen offset:3072 lds
    v_mfma_f32_16x16x32_bf16 v[32:35], v[28:31], v[48:51], v[32:35]
    s_add_u32 m0, s15, 4096
    v_exp_f32 v119, v119
    v_mfma_f32_16x16x32_bf16 v[36:39], v[28:31], v[52:55], v[36:39]
    s_waitcnt lgkmcnt(4)
    ds_read_b128 a[180:183], v20 offset:5120
    v_cvt_pk_bf16_f32 v59, v118, v119
    v_mfma_f32_16x16x32_bf16 v[128:131], a[160:163], v[48:51], v[128:131]
    v_exp_f32 v120, v120
    v_mfma_f32_16x16x32_bf16 v[160:163], a[160:163], v[52:55], v[160:163]
    s_waitcnt lgkmcnt(4)
    v_mfma_f32_16x16x32_bf16 v[132:135], a[164:167], v[48:51], v[132:135]
    v_exp_f32 v121, v121
    v_mfma_f32_16x16x32_bf16 v[164:167], a[164:167], v[52:55], v[164:167]
    s_waitcnt lgkmcnt(3)
    ds_read_b128 a[184:187], v20 offset:6144
    v_cvt_pk_bf16_f32 v60, v120, v121
    v_mfma_f32_16x16x32_bf16 v[136:139], a[168:171], v[48:51], v[136:139]
    s_waitcnt lgkmcnt(3)
    v_exp_f32 v122, v122
    v_mfma_f32_16x16x32_bf16 v[168:171], a[168:171], v[52:55], v[168:171]
    buffer_load_dwordx4 v15, s[8:11], s82 offen offset:0 lds
    v_mfma_f32_16x16x32_bf16 v[140:143], a[172:175], v[48:51], v[140:143]
    v_exp_f32 v123, v123
    v_mfma_f32_16x16x32_bf16 v[172:175], a[172:175], v[52:55], v[172:175]
    s_waitcnt lgkmcnt(2)
    ds_read_b128 a[188:191], v20 offset:7168
    v_cvt_pk_bf16_f32 v61, v122, v123
    v_mfma_f32_16x16x32_bf16 v[144:147], a[176:179], v[48:51], v[144:147]
    s_waitcnt lgkmcnt(2)
    v_exp_f32 v124, v124
    v_mfma_f32_16x16x32_bf16 v[176:179], a[176:179], v[52:55], v[176:179]
    buffer_load_dwordx4 v15, s[8:11], s82 offen offset:1024 lds
    v_mfma_f32_16x16x32_bf16 v[148:151], a[180:183], v[48:51], v[148:151]
    v_exp_f32 v125, v125
    v_mfma_f32_16x16x32_bf16 v[180:183], a[180:183], v[52:55], v[180:183]
    s_waitcnt lgkmcnt(1)
    v_cvt_pk_bf16_f32 v62, v124, v125
    v_mfma_f32_16x16x32_bf16 v[152:155], a[184:187], v[48:51], v[152:155]
    s_waitcnt lgkmcnt(0)
    v_exp_f32 v126, v126
    v_mfma_f32_16x16x32_bf16 v[184:187], a[184:187], v[52:55], v[184:187]
    buffer_load_dwordx4 v15, s[8:11], s82 offen offset:2048 lds
    v_mfma_f32_16x16x32_bf16 v[156:159], a[188:191], v[48:51], v[156:159]
    v_exp_f32 v127, v127
    v_mfma_f32_16x16x32_bf16 v[188:191], a[188:191], v[52:55], v[188:191]
    v_cvt_pk_bf16_f32 v63, v126, v127
    v_mfma_f32_16x16x32_bf16 v[112:115], a[128:131], a[224:227], v[72:75]
    v_mfma_f32_16x16x32_bf16 v[112:115], a[132:135], a[228:231], v[112:115]
    v_mfma_f32_16x16x32_bf16 v[112:115], a[136:139], a[232:235], v[112:115]
    v_exp_f32 v96, v96
    v_mfma_f32_16x16x32_bf16 v[112:115], a[140:143], a[236:239], v[112:115]
    buffer_load_dwordx4 v15, s[8:11], s82 offen offset:3072 lds
    v_mfma_f32_16x16x32_bf16 v[120:123], a[128:131], a[240:243], v[76:79]
    s_xor_b32 s15, s15, 196608
    v_exp_f32 v97, v97
    v_mfma_f32_16x16x32_bf16 v[120:123], a[132:135], a[244:247], v[120:123]
    s_add_u32 m0, s16, 0
    ds_read_b128 a[128:131], v18 offset:0
    v_cvt_pk_bf16_f32 v48, v96, v97
    v_mfma_f32_16x16x32_bf16 v[120:123], a[136:139], a[248:251], v[120:123]
    v_exp_f32 v98, v98
    v_mfma_f32_16x16x32_bf16 v[120:123], a[140:143], a[252:255], v[120:123]
    buffer_load_dwordx4 v1, s[8:11], s19 offen offset:0 lds
    v_mfma_f32_16x16x32_bf16 v[116:119], a[144:147], a[224:227], v[72:75]
    v_exp_f32 v99, v99
    v_mfma_f32_16x16x32_bf16 v[116:119], a[148:151], a[228:231], v[116:119]
    ds_read_b128 a[132:135], v18 offset:1024
    v_cvt_pk_bf16_f32 v49, v98, v99
    v_mfma_f32_16x16x32_bf16 v[116:119], a[152:155], a[232:235], v[116:119]
    v_exp_f32 v100, v100
    v_mfma_f32_16x16x32_bf16 v[116:119], a[156:159], a[236:239], v[116:119]
    buffer_load_dwordx4 v1, s[8:11], s19 offen offset:1024 lds
    v_mfma_f32_16x16x32_bf16 v[124:127], a[144:147], a[240:243], v[76:79]
    v_exp_f32 v101, v101
    v_mfma_f32_16x16x32_bf16 v[124:127], a[148:151], a[244:247], v[124:127]
    ds_read_b128 a[136:139], v18 offset:2048
    v_cvt_pk_bf16_f32 v50, v100, v101
    v_mfma_f32_16x16x32_bf16 v[124:127], a[152:155], a[248:251], v[124:127]
    v_exp_f32 v102, v102
    v_mfma_f32_16x16x32_bf16 v[124:127], a[156:159], a[252:255], v[124:127]
    buffer_load_dwordx4 v1, s[8:11], s19 offen offset:2048 lds
    v_mfma_f32_16x16x32_bf16 v[40:43], v[28:31], v[56:59], v[40:43]
    v_exp_f32 v103, v103
    v_mfma_f32_16x16x32_bf16 v[44:47], v[28:31], v[60:63], v[44:47]
    ds_read_b128 a[140:143], v18 offset:3072
    v_cvt_pk_bf16_f32 v51, v102, v103
    v_mfma_f32_16x16x32_bf16 v[192:195], a[160:163], v[56:59], v[192:195]
    v_exp_f32 v104, v104
    v_mfma_f32_16x16x32_bf16 v[224:227], a[160:163], v[60:63], v[224:227]
    v_mfma_f32_16x16x32_bf16 v[196:199], a[164:167], v[56:59], v[196:199]
    v_exp_f32 v105, v105
    v_mfma_f32_16x16x32_bf16 v[228:231], a[164:167], v[60:63], v[228:231]
    ds_read_b128 a[144:147], v18 offset:4096
    v_cvt_pk_bf16_f32 v52, v104, v105
    v_mfma_f32_16x16x32_bf16 v[200:203], a[168:171], v[56:59], v[200:203]
    v_exp_f32 v106, v106
    v_mfma_f32_16x16x32_bf16 v[232:235], a[168:171], v[60:63], v[232:235]
    buffer_load_dwordx4 v1, s[8:11], s19 offen offset:3072 lds
    v_mfma_f32_16x16x32_bf16 v[204:207], a[172:175], v[56:59], v[204:207]
    s_add_u32 m0, s16, 4096
    v_exp_f32 v107, v107
    v_mfma_f32_16x16x32_bf16 v[236:239], a[172:175], v[60:63], v[236:239]
    ds_read_b128 a[148:151], v18 offset:5120
    v_cvt_pk_bf16_f32 v53, v106, v107
    v_mfma_f32_16x16x32_bf16 v[208:211], a[176:179], v[56:59], v[208:211]
    s_sub_u32 s14, s14, 1
    v_exp_f32 v108, v108
    v_mfma_f32_16x16x32_bf16 v[240:243], a[176:179], v[60:63], v[240:243]
    buffer_load_dwordx4 v15, s[8:11], s19 offen offset:0 lds
    v_mfma_f32_16x16x32_bf16 v[212:215], a[180:183], v[56:59], v[212:215]
    v_exp_f32 v109, v109
    v_mfma_f32_16x16x32_bf16 v[244:247], a[180:183], v[60:63], v[244:247]
    ds_read_b128 a[152:155], v18 offset:6144
    v_cvt_pk_bf16_f32 v54, v108, v109
    v_mfma_f32_16x16x32_bf16 v[216:219], a[184:187], v[56:59], v[216:219]
    v_exp_f32 v110, v110
    v_mfma_f32_16x16x32_bf16 v[248:251], a[184:187], v[60:63], v[248:251]
    buffer_load_dwordx4 v15, s[8:11], s19 offen offset:1024 lds
    v_mfma_f32_16x16x32_bf16 v[220:223], a[188:191], v[56:59], v[220:223]
    v_exp_f32 v111, v111
    v_mfma_f32_16x16x32_bf16 v[252:255], a[188:191], v[60:63], v[252:255]
    ds_read_b128 a[156:159], v18 offset:7168
    v_cvt_pk_bf16_f32 v55, v110, v111
    s_cmp_lg_u32 s14, 0
    s_cbranch_scc1 L_t2_loop
L_t2_diag:
    s_waitcnt lgkmcnt(7)
    v_mfma_f32_16x16x32_bf16 v[96:99], a[128:131], a[192:195], v[80:83]
    s_waitcnt lgkmcnt(6)
    ds_read_b128 a[160:163], v19 offset:16384
    v_mov_b32 v24, v8
    v_mov_b32 v25, v9
    v_mfma_f32_16x16x32_bf16 v[96:99], a[132:135], a[196:199], v[96:99]
    s_waitcnt lgkmcnt(6)
    ds_read_b128 a[164:167], v19 offset:17408
    v_mov_b32 v26, v10
    v_mov_b32 v27, v11
    v_mfma_f32_16x16x32_bf16 v[96:99], a[136:139], a[200:203], v[96:99]
    s_waitcnt lgkmcnt(6)
    v_exp_f32 v112, v112
    v_add_u32 v11, 131072, v16
    v_mfma_f32_16x16x32_bf16 v[96:99], a[140:143], a[204:207], v[96:99]
    buffer_load_dwordx4 v15, s[8:11], s19 offen offset:2048 lds
    v_lshlrev_b32 v12, 6, v0
    v_mfma_f32_16x16x32_bf16 v[104:107], a[128:131], a[208:211], v[88:91]
    s_mov_b32 s71, 1327104
    v_exp_f32 v113, v113
    v_mfma_f32_16x16x32_bf16 v[104:107], a[132:135], a[212:215], v[104:107]
    ds_read_b128 a[168:171], v19 offset:18432
    v_cvt_pk_bf16_f32 v56, v112, v113
    v_mfma_f32_16x16x32_bf16 v[104:107], a[136:139], a[216:219], v[104:107]
    s_waitcnt lgkmcnt(6)
    v_exp_f32 v114, v114
    v_mfma_f32_16x16x32_bf16 v[104:107], a[140:143], a[220:223], v[104:107]
    buffer_load_dwordx4 v15, s[8:11], s19 offen offset:3072 lds
    v_mfma_f32_16x16x32_bf16 v[100:103], a[144:147], a[192:195], v[84:87]
    s_waitcnt lgkmcnt(5)
    s_xor_b32 s16, s16, 98304
    v_exp_f32 v115, v115
    v_mfma_f32_16x16x32_bf16 v[100:103], a[148:151], a[196:199], v[100:103]
    s_waitcnt lgkmcnt(4)
    ds_read_b128 a[172:175], v19 offset:19456
    v_cvt_pk_bf16_f32 v57, v114, v115
    v_mfma_f32_16x16x32_bf16 v[100:103], a[152:155], a[200:203], v[100:103]
    s_waitcnt lgkmcnt(4)
    v_exp_f32 v116, v116
    v_mfma_f32_16x16x32_bf16 v[100:103], a[156:159], a[204:207], v[100:103]
    buffer_load_dword v3, v12, s[8:11], s71 offen sc0 sc1
    v_bfe_u32 v13, v2, 1, 4
    v_mfma_f32_16x16x32_bf16 v[108:111], a[144:147], a[208:211], v[92:95]
    v_exp_f32 v117, v117
    v_lshlrev_b32 v13, 10, v13
    v_mfma_f32_16x16x32_bf16 v[108:111], a[148:151], a[212:215], v[108:111]
    ds_read_b128 a[176:179], v20 offset:20480
    v_cvt_pk_bf16_f32 v58, v116, v117
    v_and_b32 v14, 1, v2
    v_mfma_f32_16x16x32_bf16 v[108:111], a[152:155], a[216:219], v[108:111]
    v_exp_f32 v118, v118
    v_lshl_add_u32 v13, v14, 7, v13
    v_mfma_f32_16x16x32_bf16 v[108:111], a[156:159], a[220:223], v[108:111]
    s_lshl_b32 s74, s6, 2
    s_add_u32 s74, s74, s3
    s_lshl_b32 s74, s74, 14
    v_mfma_f32_16x16x32_bf16 v[32:35], v[28:31], v[48:51], v[32:35]
    v_exp_f32 v119, v119
    v_mfma_f32_16x16x32_bf16 v[36:39], v[28:31], v[52:55], v[36:39]
    s_waitcnt lgkmcnt(4)
    ds_read_b128 a[180:183], v20 offset:21504
    v_cvt_pk_bf16_f32 v59, v118, v119
    v_mfma_f32_16x16x32_bf16 v[128:131], a[160:163], v[48:51], v[128:131]
    s_waitcnt lgkmcnt(4)
    v_exp_f32 v120, v120
    v_mfma_f32_16x16x32_bf16 v[160:163], a[160:163], v[52:55], v[160:163]
    buffer_load_dword v14, v13, s[28:31], s74 offen
    v_mfma_f32_16x16x32_bf16 v[132:135], a[164:167], v[48:51], v[132:135]
    v_exp_f32 v121, v121
    v_mfma_f32_16x16x32_bf16 v[164:167], a[164:167], v[52:55], v[164:167]
    s_waitcnt lgkmcnt(3)
    ds_read_b128 a[184:187], v20 offset:22528
    v_cvt_pk_bf16_f32 v60, v120, v121
    v_mfma_f32_16x16x32_bf16 v[136:139], a[168:171], v[48:51], v[136:139]
    v_exp_f32 v122, v122
    v_mfma_f32_16x16x32_bf16 v[168:171], a[168:171], v[52:55], v[168:171]
    s_waitcnt lgkmcnt(3)
    v_add_f32 v80, 0, v22
    v_min_f32 v80, v80, v72
    v_mfma_f32_16x16x32_bf16 v[140:143], a[172:175], v[48:51], v[140:143]
    v_exp_f32 v123, v123
    v_mfma_f32_16x16x32_bf16 v[172:175], a[172:175], v[52:55], v[172:175]
    s_waitcnt lgkmcnt(2)
    ds_read_b128 a[188:191], v20 offset:23552
    v_cvt_pk_bf16_f32 v61, v122, v123
    v_mfma_f32_16x16x32_bf16 v[144:147], a[176:179], v[48:51], v[144:147]
    v_exp_f32 v124, v124
    v_mfma_f32_16x16x32_bf16 v[176:179], a[176:179], v[52:55], v[176:179]
    s_waitcnt lgkmcnt(2)
    v_add_f32 v81, 0xf1800000, v22
    v_min_f32 v81, v81, v73
    v_mfma_f32_16x16x32_bf16 v[148:151], a[180:183], v[48:51], v[148:151]
    v_exp_f32 v125, v125
    v_mfma_f32_16x16x32_bf16 v[180:183], a[180:183], v[52:55], v[180:183]
    s_waitcnt lgkmcnt(1)
    v_cvt_pk_bf16_f32 v62, v124, v125
    v_xor_b32 v19, 98304, v19
    v_mfma_f32_16x16x32_bf16 v[152:155], a[184:187], v[48:51], v[152:155]
    v_exp_f32 v126, v126
    v_mfma_f32_16x16x32_bf16 v[184:187], a[184:187], v[52:55], v[184:187]
    s_waitcnt lgkmcnt(0)
    v_xor_b32 v20, 98304, v20
    v_add_f32 v82, 0xf2000000, v22
    v_mfma_f32_16x16x32_bf16 v[156:159], a[188:191], v[48:51], v[156:159]
    v_exp_f32 v127, v127
    v_mfma_f32_16x16x32_bf16 v[188:191], a[188:191], v[52:55], v[188:191]
    v_cvt_pk_bf16_f32 v63, v126, v127
    v_min_f32 v82, v82, v74
    v_add_f32 v83, 0xf2400000, v22
    v_min_f32 v83, v83, v75
    v_add_f32 v84, 0xf3800000, v22
    v_min_f32 v84, v84, v72
    v_mfma_f32_16x16x32_bf16 v[112:115], a[128:131], a[224:227], v[72:75]
    v_exp_f32 v96, v96
    v_mfma_f32_16x16x32_bf16 v[112:115], a[132:135], a[228:231], v[112:115]
    v_add_f32 v85, 0xf3880000, v22
    v_min_f32 v85, v85, v73
    s_getpc_b64 s[100:101]
L_ct3:
    s_lshr_b32 s99, s2, 3
    s_lshl_b32 s99, s99, 2
    s_add_u32 s99, s99, s3
    s_mul_i32 s99, s99, 2
    v_min_u32 v13, 1, v2
    v_add_u32 v13, s99, v13
    v_lshlrev_b32 v13, 7, v13
    v_add_u32 v13, L_ct3-L_ct3, v13
    v_min_u32 v13, L_end-L_ct3, v13
    global_load_dword v13, v13, s[100:101]
    v_mfma_f32_16x16x32_bf16 v[112:115], a[136:139], a[232:235], v[112:115]
    v_exp_f32 v97, v97
    v_mfma_f32_16x16x32_bf16 v[112:115], a[140:143], a[236:239], v[112:115]
    v_cvt_pk_bf16_f32 v48, v96, v97
    v_add_f32 v86, 0xf3900000, v22
    v_mfma_f32_16x16x32_bf16 v[120:123], a[128:131], a[240:243], v[76:79]
    v_exp_f32 v98, v98
    v_mfma_f32_16x16x32_bf16 v[120:123], a[132:135], a[244:247], v[120:123]
    v_min_f32 v86, v86, v74
    v_add_f32 v87, 0xf3980000, v22
    v_mfma_f32_16x16x32_bf16 v[120:123], a[136:139], a[248:251], v[120:123]
    v_exp_f32 v99, v99
    v_mfma_f32_16x16x32_bf16 v[120:123], a[140:143], a[252:255], v[120:123]
    v_min_f32 v87, v87, v75
    v_add_f32 v88, 0x73800000, v22
    v_mfma_f32_16x16x32_bf16 v[116:119], a[144:147], a[224:227], v[72:75]
    v_exp_f32 v100, v100
    v_mfma_f32_16x16x32_bf16 v[116:119], a[148:151], a[228:231], v[116:119]
    ds_read_b128 a[128:131], v18 offset:16384
    v_cvt_pk_bf16_f32 v49, v98, v99
    v_mfma_f32_16x16x32_bf16 v[116:119], a[152:155], a[232:235], v[116:119]
    v_exp_f32 v101, v101
    v_mfma_f32_16x16x32_bf16 v[116:119], a[156:159], a[236:239], v[116:119]
    ds_read_b128 a[132:135], v18 offset:17408
    v_cvt_pk_bf16_f32 v50, v100, v101
    v_mfma_f32_16x16x32_bf16 v[124:127], a[144:147], a[240:243], v[76:79]
    v_exp_f32 v102, v102
    v_mfma_f32_16x16x32_bf16 v[124:127], a[148:151], a[244:247], v[124:127]
    ds_read_b128 a[136:139], v18 offset:18432
    v_min_f32 v88, v88, v76
    v_mfma_f32_16x16x32_bf16 v[124:127], a[152:155], a[248:251], v[124:127]
    v_exp_f32 v103, v103
    v_mfma_f32_16x16x32_bf16 v[124:127], a[156:159], a[252:255], v[124:127]
    ds_read_b128 a[140:143], v18 offset:19456
    v_cvt_pk_bf16_f32 v51, v102, v103
    v_mfma_f32_16x16x32_bf16 v[40:43], v[28:31], v[56:59], v[40:43]
    v_exp_f32 v104, v104
    v_mfma_f32_16x16x32_bf16 v[44:47], v[28:31], v[60:63], v[44:47]
    ds_read_b128 a[144:147], v18 offset:20480
    v_add_f32 v89, 0x73700000, v22
    v_mfma_f32_16x16x32_bf16 v[192:195], a[160:163], v[56:59], v[192:195]
    v_exp_f32 v105, v105
    v_mfma_f32_16x16x32_bf16 v[224:227], a[160:163], v[60:63], v[224:227]
    ds_read_b128 a[148:151], v18 offset:21504
    v_cvt_pk_bf16_f32 v52, v104, v105
    v_mfma_f32_16x16x32_bf16 v[196:199], a[164:167], v[56:59], v[196:199]
    v_exp_f32 v106, v106
    v_mfma_f32_16x16x32_bf16 v[228:231], a[164:167], v[60:63], v[228:231]
    ds_read_b128 a[152:155], v18 offset:22528
    v_min_f32 v89, v89, v77
    v_mfma_f32_16x16x32_bf16 v[200:203], a[168:171], v[56:59], v[200:203]
    v_exp_f32 v107, v107
    v_mfma_f32_16x16x32_bf16 v[232:235], a[168:171], v[60:63], v[232:235]
    ds_read_b128 a[156:159], v18 offset:23552
    v_cvt_pk_bf16_f32 v53, v106, v107
    v_mfma_f32_16x16x32_bf16 v[204:207], a[172:175], v[56:59], v[204:207]
    v_exp_f32 v108, v108
    v_mfma_f32_16x16x32_bf16 v[236:239], a[172:175], v[60:63], v[236:239]
    v_add_f32 v90, 0x73600000, v22
    v_min_f32 v90, v90, v78
    v_mfma_f32_16x16x32_bf16 v[208:211], a[176:179], v[56:59], v[208:211]
    v_exp_f32 v109, v109
    v_mfma_f32_16x16x32_bf16 v[240:243], a[176:179], v[60:63], v[240:243]
    v_cvt_pk_bf16_f32 v54, v108, v109
    v_xor_b32 v18, 196608, v18
    v_mfma_f32_16x16x32_bf16 v[212:215], a[180:183], v[56:59], v[212:215]
    v_exp_f32 v110, v110
    v_mfma_f32_16x16x32_bf16 v[244:247], a[180:183], v[60:63], v[244:247]
    v_add_f32 v91, 0x73500000, v22
    v_min_f32 v91, v91, v79
    v_mfma_f32_16x16x32_bf16 v[216:219], a[184:187], v[56:59], v[216:219]
    v_exp_f32 v111, v111
    v_mfma_f32_16x16x32_bf16 v[248:251], a[184:187], v[60:63], v[248:251]
    v_cvt_pk_bf16_f32 v55, v110, v111
    v_add_f32 v92, 0, v22
    s_waitcnt vmcnt(2)
    v_cmp_ne_u32 vcc, 0, v3
    s_cmp_eq_u64 vcc, -1
    s_cbranch_scc0 L_F_slow_11
L_F_ok_12:
    v_mfma_f32_16x16x32_bf16 v[220:223], a[188:191], v[56:59], v[220:223]
    v_min_f32 v92, v92, v76
    v_add_f32 v93, 0xf1800000, v22
    v_mfma_f32_16x16x32_bf16 v[252:255], a[188:191], v[60:63], v[252:255]
    v_min_f32 v93, v93, v77
    v_add_f32 v94, 0xf2000000, v22
    v_min_f32 v94, v94, v78
    v_add_f32 v95, 0xf2400000, v22
    v_min_f32 v95, v95, v79
    s_waitcnt lgkmcnt(0)
    s_barrier
    v_mfma_f32_16x16x32_bf16 v[96:99], a[128:131], a[224:227], v[80:83]
    s_xor_b32 s100, s62, 8192
    s_xor_b32 s98, s65, 262144
    ds_read_b128 a[176:179], v20 offset:4096
    s_waitcnt vmcnt(0)
    v_lshrrev_b32 v13, 1, v1
    v_mfma_f32_16x16x32_bf16 v[96:99], a[132:135], a[228:231], v[96:99]
    s_add_u32 m0, s62, 65536
    ds_read_b128 a[180:183], v20 offset:5120
    v_add_u32 v12, s100, v13
    v_mfma_f32_16x16x32_bf16 v[96:99], a[136:139], a[232:235], v[96:99]
    buffer_load_dwordx4 v24, s[28:31], s98 offen offset:0  lds
    v_exp_f32 v112, v112
    v_mfma_f32_16x16x32_bf16 v[96:99], a[140:143], a[236:239], v[96:99]
    v_exp_f32 v113, v113
    v_mfma_f32_16x16x32_bf16 v[100:103], a[144:147], a[224:227], v[84:87]
    ds_read_b128 a[184:187], v20 offset:6144
    v_cvt_pk_bf16_f32 v56, v112, v113
    v_mfma_f32_16x16x32_bf16 v[100:103], a[148:151], a[228:231], v[100:103]
    v_exp_f32 v114, v114
    v_mfma_f32_16x16x32_bf16 v[100:103], a[152:155], a[232:235], v[100:103]
    buffer_load_dwordx4 v25, s[28:31], s98 offen offset:1024  lds
    v_exp_f32 v115, v115
    v_mfma_f32_16x16x32_bf16 v[100:103], a[156:159], a[236:239], v[100:103]
    ds_read_b128 a[188:191], v20 offset:7168
    v_cvt_pk_bf16_f32 v57, v114, v115
    v_mfma_f32_16x16x32_bf16 v[104:107], a[128:131], a[240:243], v[88:91]
    v_exp_f32 v116, v116
    v_mfma_f32_16x16x32_bf16 v[104:107], a[132:135], a[244:247], v[104:107]
    v_exp_f32 v117, v117
    v_mfma_f32_16x16x32_bf16 v[104:107], a[136:139], a[248:251], v[104:107]
    ds_read_b128 a[160:163], v19 offset:0
    v_cvt_pk_bf16_f32 v58, v116, v117
    v_mfma_f32_16x16x32_bf16 v[104:107], a[140:143], a[252:255], v[104:107]
    buffer_load_dwordx4 v26, s[28:31], s98 offen offset:2048  lds
    v_exp_f32 v118, v118
    v_mfma_f32_16x16x32_bf16 v[108:111], a[144:147], a[240:243], v[92:95]
    v_exp_f32 v119, v119
    v_mfma_f32_16x16x32_bf16 v[108:111], a[148:151], a[244:247], v[108:111]
    ds_read_b128 a[164:167], v19 offset:1024
    v_cvt_pk_bf16_f32 v59, v118, v119
    v_mfma_f32_16x16x32_bf16 v[108:111], a[152:155], a[248:251], v[108:111]
    v_exp_f32 v120, v120
    v_mfma_f32_16x16x32_bf16 v[108:111], a[156:159], a[252:255], v[108:111]
    buffer_load_dwordx4 v27, s[28:31], s98 offen offset:3072  lds
    v_exp_f32 v121, v121
    v_mfma_f32_16x16x32_bf16 v[32:35], v[28:31], v[48:51], v[32:35]
    s_add_u32 m0, s62, 69632
    ds_read_b128 a[168:171], v19 offset:2048
    v_cvt_pk_bf16_f32 v60, v120, v121
    v_mfma_f32_16x16x32_bf16 v[36:39], v[28:31], v[52:55], v[36:39]
    s_waitcnt lgkmcnt(6)
    s_xor_b32 s98, s65, 294912
    v_exp_f32 v122, v122
    v_mfma_f32_16x16x32_bf16 v[144:147], a[176:179], v[48:51], v[144:147]
    v_exp_f32 v123, v123
    v_mfma_f32_16x16x32_bf16 v[176:179], a[176:179], v[52:55], v[176:179]
    s_waitcnt lgkmcnt(5)
    ds_read_b128 a[172:175], v19 offset:3072
    v_cvt_pk_bf16_f32 v61, v122, v123
    v_mfma_f32_16x16x32_bf16 v[148:151], a[180:183], v[48:51], v[148:151]
    buffer_load_dwordx4 v24, s[28:31], s98 offen offset:0  lds
    v_exp_f32 v124, v124
    v_mfma_f32_16x16x32_bf16 v[180:183], a[180:183], v[52:55], v[180:183]
    s_waitcnt lgkmcnt(5)
    v_exp_f32 v125, v125
    v_mfma_f32_16x16x32_bf16 v[152:155], a[184:187], v[48:51], v[152:155]
    s_waitcnt lgkmcnt(4)
    v_exp_f32 v126, v126
    v_mfma_f32_16x16x32_bf16 v[184:187], a[184:187], v[52:55], v[184:187]
    buffer_load_dwordx4 v25, s[28:31], s98 offen offset:1024  lds
    v_exp_f32 v127, v127
    v_mfma_f32_16x16x32_bf16 v[156:159], a[188:191], v[48:51], v[156:159]
    ds_write_b128 v11, v[144:147] offset:0
    v_cvt_pk_bf16_f32 v62, v124, v125
    v_mfma_f32_16x16x32_bf16 v[188:191], a[188:191], v[52:55], v[188:191]
    s_waitcnt lgkmcnt(4)
    v_exp_f32 v96, v96
    v_mfma_f32_16x16x32_bf16 v[128:131], a[160:163], v[48:51], v[128:131]
    v_exp_f32 v97, v97
    v_mfma_f32_16x16x32_bf16 v[160:163], a[160:163], v[52:55], v[160:163]
    s_waitcnt lgkmcnt(3)
    ds_write_b128 v11, v[176:179] offset:1024
    v_cvt_pk_bf16_f32 v63, v126, v127
    v_mfma_f32_16x16x32_bf16 v[132:135], a[164:167], v[48:51], v[132:135]
    s_waitcnt lgkmcnt(3)
    v_exp_f32 v98, v98
    v_mfma_f32_16x16x32_bf16 v[164:167], a[164:167], v[52:55], v[164:167]
    buffer_load_dwordx4 v26, s[28:31], s98 offen offset:2048  lds
    v_exp_f32 v99, v99
    v_mfma_f32_16x16x32_bf16 v[136:139], a[168:171], v[48:51], v[136:139]
    ds_write_b128 v11, v[148:151] offset:2048
    v_mfma_f32_16x16x32_bf16 v[168:171], a[168:171], v[52:55], v[168:171]
    s_waitcnt lgkmcnt(3)
    v_exp_f32 v100, v100
    v_mfma_f32_16x16x32_bf16 v[140:143], a[172:175], v[48:51], v[140:143]
    v_exp_f32 v101, v101
    v_mfma_f32_16x16x32_bf16 v[172:175], a[172:175], v[52:55], v[172:175]
    ds_write_b128 v11, v[180:183] offset:3072
    v_mov_b32 v33, v36
    v_mfma_f32_16x16x32_bf16 v[40:43], v[28:31], v[56:59], v[40:43]
    buffer_load_dwordx4 v27, s[28:31], s98 offen offset:3072  lds
    v_exp_f32 v102, v102
    v_mfma_f32_16x16x32_bf16 v[44:47], v[28:31], v[60:63], v[44:47]
    v_exp_f32 v103, v103
    v_mfma_f32_16x16x32_bf16 v[208:211], a[176:179], v[56:59], v[208:211]
    ds_write_b128 v11, v[152:155] offset:4096
    v_cvt_pk_bf16_f32 v48, v96, v97
    v_mfma_f32_16x16x32_bf16 v[240:243], a[176:179], v[60:63], v[240:243]
    ds_read_b128 a[176:179], v20 offset:20480
    v_exp_f32 v104, v104
    v_mfma_f32_16x16x32_bf16 v[212:215], a[180:183], v[56:59], v[212:215]
    v_exp_f32 v105, v105
    v_mfma_f32_16x16x32_bf16 v[244:247], a[180:183], v[60:63], v[244:247]
    ds_read_b128 a[180:183], v20 offset:21504
    v_exp_f32 v106, v106
    v_mfma_f32_16x16x32_bf16 v[216:219], a[184:187], v[56:59], v[216:219]
    ds_write_b128 v11, v[184:187] offset:5120
    v_cvt_pk_bf16_f32 v49, v98, v99
    v_mfma_f32_16x16x32_bf16 v[248:251], a[184:187], v[60:63], v[248:251]
    ds_read_b128 a[184:187], v20 offset:22528
    v_exp_f32 v107, v107
    v_mfma_f32_16x16x32_bf16 v[220:223], a[188:191], v[56:59], v[220:223]
    v_exp_f32 v108, v108
    v_mfma_f32_16x16x32_bf16 v[252:255], a[188:191], v[60:63], v[252:255]
    ds_read_b128 a[188:191], v20 offset:23552
    v_exp_f32 v109, v109
    v_mfma_f32_16x16x32_bf16 v[192:195], a[160:163], v[56:59], v[192:195]
    ds_write_b128 v11, v[156:159] offset:6144
    v_cvt_pk_bf16_f32 v50, v100, v101
    v_mfma_f32_16x16x32_bf16 v[224:227], a[160:163], v[60:63], v[224:227]
    ds_read_b128 a[160:163], v19 offset:16384
    v_exp_f32 v110, v110
    v_mfma_f32_16x16x32_bf16 v[196:199], a[164:167], v[56:59], v[196:199]
    v_exp_f32 v111, v111
    v_mfma_f32_16x16x32_bf16 v[228:231], a[164:167], v[60:63], v[228:231]
    ds_read_b128 a[164:167], v19 offset:17408
    v_cvt_pk_bf16_f32 v51, v102, v103
    v_mfma_f32_16x16x32_bf16 v[200:203], a[168:171], v[56:59], v[200:203]
    ds_write_b128 v11, v[188:191] offset:7168
    v_cvt_pk_bf16_f32 v52, v104, v105
    v_mfma_f32_16x16x32_bf16 v[232:235], a[168:171], v[60:63], v[232:235]
    ds_read_b128 a[168:171], v19 offset:18432
    v_cvt_pk_bf16_f32 v53, v106, v107
    v_mfma_f32_16x16x32_bf16 v[204:207], a[172:175], v[56:59], v[204:207]
    v_cvt_pk_bf16_f32 v54, v108, v109
    v_cvt_pk_bf16_f32 v55, v110, v111
    v_mfma_f32_16x16x32_bf16 v[236:239], a[172:175], v[60:63], v[236:239]
    ds_read_b128 a[172:175], v19 offset:19456
    ds_write_b64 v12, v[32:33]
    s_add_u32 s101, s62, 98304
    v_xor_b32 v12, 8192, v12
    v_add_u32 v9, s101, v1
    v_xor_b32 v8, 8192, v11
    v_xor_b32 v10, 8192, v9
L_t2_join:
    v_xor_b32 v19, 98304, v19
    v_xor_b32 v20, 98304, v20
    s_waitcnt lgkmcnt(0)
    s_barrier
    v_mfma_f32_16x16x32_bf16 v[40:43], v[28:31], v[48:51], v[40:43]
    s_lshl_b32 s100, s61, 20
    s_add_u32 s101, s100, s21
    ds_read_b64 v[120:121], v12
    v_mfma_f32_16x16x32_bf16 v[44:47], v[28:31], v[52:55], v[44:47]
    s_add_u32 s100, s100, s20
    ds_read_b128 v[144:147], v8 offset:0
    v_lshrrev_b32 v11, 4, v2
    v_mfma_f32_16x16x32_bf16 v[208:211], a[176:179], v[48:51], v[208:211]
    ds_read_b128 v[176:179], v8 offset:1024
    v_lshrrev_b32 v13, 2, v1
    v_mfma_f32_16x16x32_bf16 v[240:243], a[176:179], v[52:55], v[240:243]
    ds_read_b128 v[148:151], v8 offset:2048
    v_add_u32 v13, 131072, v13
    v_mfma_f32_16x16x32_bf16 v[212:215], a[180:183], v[48:51], v[212:215]
    s_xor_b32 s99, s62, 8192
    ds_read_b128 v[180:183], v8 offset:3072
    v_add_u32 v14, s99, v13
    v_mfma_f32_16x16x32_bf16 v[244:247], a[180:183], v[52:55], v[244:247]
    ds_read_b128 v[152:155], v8 offset:4096
    v_cmp_eq_u32 vcc, 1, v11
    v_mfma_f32_16x16x32_bf16 v[216:219], a[184:187], v[48:51], v[216:219]
    ds_read_b128 v[184:187], v8 offset:5120
    s_waitcnt lgkmcnt(6)
    v_add_f32 v112, v120, v32
    v_mfma_f32_16x16x32_bf16 v[248:251], a[184:187], v[52:55], v[248:251]
    ds_read_b128 v[156:159], v8 offset:6144
    v_add_f32 v114, v121, v36
    v_mfma_f32_16x16x32_bf16 v[220:223], a[188:191], v[48:51], v[220:223]
    ds_read_b128 v[188:191], v8 offset:7168
    v_cndmask_b32 v12, v32, v36, vcc
    v_mfma_f32_16x16x32_bf16 v[252:255], a[188:191], v[52:55], v[252:255]
    v_rcp_f32 v112, v112
    v_mfma_f32_16x16x32_bf16 v[192:195], a[160:163], v[48:51], v[192:195]
    v_rcp_f32 v114, v114
    v_mfma_f32_16x16x32_bf16 v[224:227], a[160:163], v[52:55], v[224:227]
    v_cmp_eq_u32 vcc, 2, v11
    v_cmp_eq_u32 s[96:97], 3, v11
    v_mfma_f32_16x16x32_bf16 v[196:199], a[164:167], v[48:51], v[196:199]
    ds_write_b128 v9, v[208:211] offset:0
    v_mfma_f32_16x16x32_bf16 v[228:231], a[164:167], v[52:55], v[228:231]
    v_mfma_f32_16x16x32_bf16 v[200:203], a[168:171], v[48:51], v[200:203]
    ds_write_b128 v9, v[240:243] offset:1024
    v_mfma_f32_16x16x32_bf16 v[232:235], a[168:171], v[52:55], v[232:235]
    v_mfma_f32_16x16x32_bf16 v[204:207], a[172:175], v[48:51], v[204:207]
    ds_write_b128 v9, v[212:215] offset:2048
    v_mfma_f32_16x16x32_bf16 v[236:239], a[172:175], v[52:55], v[236:239]
    v_cndmask_b32 v12, v12, v40, vcc
    v_cndmask_b32 v12, v12, v44, s[96:97]
    ds_write_b128 v9, v[244:247] offset:3072
    s_waitcnt lgkmcnt(11)
    v_pk_add_f32 v[128:129], v[128:129], v[144:145]
    v_pk_add_f32 v[130:131], v[130:131], v[146:147]
    s_waitcnt lgkmcnt(9)
    v_pk_add_f32 v[132:133], v[132:133], v[148:149]
    v_pk_add_f32 v[134:135], v[134:135], v[150:151]
    v_pk_mul_f32 v[128:129], v[128:129], v[112:113] op_sel_hi:[1,0]
    v_pk_mul_f32 v[130:131], v[130:131], v[112:113] op_sel_hi:[1,0]
    v_pk_mul_f32 v[132:133], v[132:133], v[112:113] op_sel_hi:[1,0]
    v_pk_mul_f32 v[134:135], v[134:135], v[112:113] op_sel_hi:[1,0]
    v_cvt_pk_bf16_f32 v128, v128, v129
    v_cvt_pk_bf16_f32 v129, v130, v131
    v_cvt_pk_bf16_f32 v130, v132, v133
    v_lshrrev_b32 v58, 2, v2
    v_and_b32 v57, 3, v2
    ds_write_b128 v9, v[216:219] offset:4096
    v_cvt_pk_bf16_f32 v131, v134, v135
    buffer_store_dwordx4 v[128:131], v1, s[8:11], s100 offen offset:0 sc0 sc1
    s_waitcnt lgkmcnt(8)
    v_pk_add_f32 v[136:137], v[136:137], v[152:153]
    v_pk_add_f32 v[138:139], v[138:139], v[154:155]
    s_waitcnt lgkmcnt(6)
    v_pk_add_f32 v[140:141], v[140:141], v[156:157]
    v_pk_add_f32 v[142:143], v[142:143], v[158:159]
    v_pk_mul_f32 v[136:137], v[136:137], v[112:113] op_sel_hi:[1,0]
    v_pk_mul_f32 v[138:139], v[138:139], v[112:113] op_sel_hi:[1,0]
    v_pk_mul_f32 v[140:141], v[140:141], v[112:113] op_sel_hi:[1,0]
    v_pk_mul_f32 v[142:143], v[142:143], v[112:113] op_sel_hi:[1,0]
    v_cvt_pk_bf16_f32 v136, v136, v137
    v_lshlrev_b32 v56, 7, v58
    v_lshl_add_u32 v56, v57, 3, v56
    v_bfe_u32 v57, v2, 3, 2
    ds_write_b128 v9, v[248:251] offset:5120
    v_cvt_pk_bf16_f32 v137, v138, v139
    v_cvt_pk_bf16_f32 v138, v140, v141
    v_cvt_pk_bf16_f32 v139, v142, v143
    buffer_store_dwordx4 v[136:139], v1, s[8:11], s100 offen offset:1024 sc0 sc1
    v_pk_add_f32 v[160:161], v[160:161], v[176:177]
    v_pk_add_f32 v[162:163], v[162:163], v[178:179]
    v_pk_add_f32 v[164:165], v[164:165], v[180:181]
    v_pk_add_f32 v[166:167], v[166:167], v[182:183]
    v_pk_mul_f32 v[160:161], v[160:161], v[114:115] op_sel_hi:[1,0]
    v_pk_mul_f32 v[162:163], v[162:163], v[114:115] op_sel_hi:[1,0]
    v_pk_mul_f32 v[164:165], v[164:165], v[114:115] op_sel_hi:[1,0]
    v_lshl_add_u32 v56, v57, 5, v56
    v_xor_b32 v57, 32, v56
    ds_write_b128 v9, v[220:223] offset:6144
    v_pk_mul_f32 v[166:167], v[166:167], v[114:115] op_sel_hi:[1,0]
    v_cvt_pk_bf16_f32 v160, v160, v161
    v_cvt_pk_bf16_f32 v161, v162, v163
    v_cvt_pk_bf16_f32 v162, v164, v165
    v_cvt_pk_bf16_f32 v163, v166, v167
    buffer_store_dwordx4 v[160:163], v15, s[8:11], s100 offen offset:0 sc0 sc1
    v_pk_add_f32 v[168:169], v[168:169], v[184:185]
    v_pk_add_f32 v[170:171], v[170:171], v[186:187]
    s_waitcnt lgkmcnt(7)
    v_pk_add_f32 v[172:173], v[172:173], v[188:189]
    v_pk_add_f32 v[174:175], v[174:175], v[190:191]
    v_pk_mul_f32 v[168:169], v[168:169], v[114:115] op_sel_hi:[1,0]
    v_xor_b32 v58, 64, v56
    v_xor_b32 v59, 96, v56
    v_add_u32 v60, 65536, v56
    ds_write_b128 v9, v[252:255] offset:7168
    v_pk_mul_f32 v[170:171], v[170:171], v[114:115] op_sel_hi:[1,0]
    v_pk_mul_f32 v[172:173], v[172:173], v[114:115] op_sel_hi:[1,0]
    v_pk_mul_f32 v[174:175], v[174:175], v[114:115] op_sel_hi:[1,0]
    v_cvt_pk_bf16_f32 v168, v168, v169
    v_cvt_pk_bf16_f32 v169, v170, v171
    v_cvt_pk_bf16_f32 v170, v172, v173
    v_cvt_pk_bf16_f32 v171, v174, v175
    buffer_store_dwordx4 v[168:171], v15, s[8:11], s100 offen offset:1024 sc0 sc1
    v_add_u32 v61, 65536, v57
    v_add_u32 v62, 65536, v58
    v_add_u32 v63, 65536, v59
    ds_write_b32 v14, v12
    v_and_b32 v14, 4294967103, v13
    v_add_u32 v14, s62, v14
    s_waitcnt lgkmcnt(0)
    s_barrier
    ds_read_b32 v116, v14 offset:128
    ds_read_b32 v118, v14 offset:192
    ds_read_b128 v[208:211], v10 offset:0
    ds_read_b128 v[212:215], v10 offset:2048
    ds_read_b128 v[216:219], v10 offset:4096
    ds_read_b128 v[220:223], v10 offset:6144
    ds_read_b128 v[240:243], v10 offset:1024
    ds_read_b128 v[244:247], v10 offset:3072
    ds_read_b128 v[248:251], v10 offset:5120
    ds_read_b128 v[252:255], v10 offset:7168
    ds_read_b32 v120, v13 offset:0
    ds_read_b32 v121, v13 offset:8192
    ds_read_b32 v122, v13 offset:16384
    ds_read_b32 v123, v13 offset:24576
    s_waitcnt lgkmcnt(13)
    v_add_f32 v116, v116, v40
    s_waitcnt lgkmcnt(12)
    v_add_f32 v118, v118, v44
    v_rcp_f32 v116, v116
    v_rcp_f32 v118, v118
    s_waitcnt lgkmcnt(11)
    v_pk_add_f32 v[192:193], v[192:193], v[208:209]
    v_pk_add_f32 v[194:195], v[194:195], v[210:211]
    s_waitcnt lgkmcnt(10)
    v_pk_add_f32 v[196:197], v[196:197], v[212:213]
    v_pk_add_f32 v[198:199], v[198:199], v[214:215]
    v_pk_mul_f32 v[192:193], v[192:193], v[116:117] op_sel_hi:[1,0]
    v_pk_mul_f32 v[194:195], v[194:195], v[116:117] op_sel_hi:[1,0]
    v_pk_mul_f32 v[196:197], v[196:197], v[116:117] op_sel_hi:[1,0]
    v_pk_mul_f32 v[198:199], v[198:199], v[116:117] op_sel_hi:[1,0]
    v_cvt_pk_bf16_f32 v192, v192, v193
    v_cvt_pk_bf16_f32 v193, v194, v195
    v_cvt_pk_bf16_f32 v194, v196, v197
    v_cvt_pk_bf16_f32 v195, v198, v199
    buffer_store_dwordx4 v[192:195], v1, s[8:11], s101 offen offset:0 sc0 sc1
    s_waitcnt lgkmcnt(9)
    v_pk_add_f32 v[200:201], v[200:201], v[216:217]
    v_pk_add_f32 v[202:203], v[202:203], v[218:219]
    s_waitcnt lgkmcnt(8)
    v_pk_add_f32 v[204:205], v[204:205], v[220:221]
    v_pk_add_f32 v[206:207], v[206:207], v[222:223]
    v_pk_mul_f32 v[200:201], v[200:201], v[116:117] op_sel_hi:[1,0]
    v_pk_mul_f32 v[202:203], v[202:203], v[116:117] op_sel_hi:[1,0]
    v_pk_mul_f32 v[204:205], v[204:205], v[116:117] op_sel_hi:[1,0]
    v_pk_mul_f32 v[206:207], v[206:207], v[116:117] op_sel_hi:[1,0]
    v_cvt_pk_bf16_f32 v200, v200, v201
    v_cvt_pk_bf16_f32 v201, v202, v203
    v_cvt_pk_bf16_f32 v202, v204, v205
    v_cvt_pk_bf16_f32 v203, v206, v207
    buffer_store_dwordx4 v[200:203], v1, s[8:11], s101 offen offset:1024 sc0 sc1
    s_waitcnt lgkmcnt(2)
    v_add_f32 v120, v120, v121
    s_waitcnt lgkmcnt(0)
    v_add_f32 v122, v122, v123
    v_min_f32 v124, v120, v122
    v_add_f32 v120, v120, v122
    v_cmp_le_f32 vcc, 0x1f800000, v124
    s_mov_b64 s[96:97], vcc
    v_cmp_ge_f32 vcc, 0x67800000, v120
    s_and_b64 s[96:97], s[96:97], vcc
    s_cmp_eq_u64 s[96:97], -1
    s_cselect_b32 s96, s25, 1
    s_cmp_lg_u32 s96, 0
    s_cbranch_scc1 L_t2_redo
L_t2_safe:
    v_pk_add_f32 v[224:225], v[224:225], v[240:241]
    v_pk_add_f32 v[226:227], v[226:227], v[242:243]
    v_pk_add_f32 v[228:229], v[228:229], v[244:245]
    v_pk_add_f32 v[230:231], v[230:231], v[246:247]
    v_pk_mul_f32 v[224:225], v[224:225], v[118:119] op_sel_hi:[1,0]
    v_pk_mul_f32 v[226:227], v[226:227], v[118:119] op_sel_hi:[1,0]
    v_pk_mul_f32 v[228:229], v[228:229], v[118:119] op_sel_hi:[1,0]
    v_pk_mul_f32 v[230:231], v[230:231], v[118:119] op_sel_hi:[1,0]
    v_cvt_pk_bf16_f32 v224, v224, v225
    v_cvt_pk_bf16_f32 v225, v226, v227
    v_cvt_pk_bf16_f32 v226, v228, v229
    v_cvt_pk_bf16_f32 v227, v230, v231
    buffer_store_dwordx4 v[224:227], v15, s[8:11], s101 offen offset:0 sc0 sc1
    ds_read_b64_tr_b16 a[192:193], v56 offset:32768
    ds_read_b64_tr_b16 a[194:195], v56 offset:34816
    ds_read_b64_tr_b16 a[196:197], v56 offset:36864
    ds_read_b64_tr_b16 a[198:199], v56 offset:38912
    ds_read_b64_tr_b16 a[200:201], v57 offset:32768
    ds_read_b64_tr_b16 a[202:203], v57 offset:34816
    ds_read_b64_tr_b16 a[204:205], v57 offset:36864
    ds_read_b64_tr_b16 a[206:207], v57 offset:38912
    v_pk_add_f32 v[232:233], v[232:233], v[248:249]
    v_pk_add_f32 v[234:235], v[234:235], v[250:251]
    v_pk_add_f32 v[236:237], v[236:237], v[252:253]
    v_pk_add_f32 v[238:239], v[238:239], v[254:255]
    v_pk_mul_f32 v[232:233], v[232:233], v[118:119] op_sel_hi:[1,0]
    v_pk_mul_f32 v[234:235], v[234:235], v[118:119] op_sel_hi:[1,0]
    v_pk_mul_f32 v[236:237], v[236:237], v[118:119] op_sel_hi:[1,0]
    v_pk_mul_f32 v[238:239], v[238:239], v[118:119] op_sel_hi:[1,0]
    v_cvt_pk_bf16_f32 v232, v232, v233
    v_cvt_pk_bf16_f32 v233, v234, v235
    v_cvt_pk_bf16_f32 v234, v236, v237
    v_cvt_pk_bf16_f32 v235, v238, v239
    buffer_store_dwordx4 v[232:235], v15, s[8:11], s101 offen offset:1024 sc0 sc1
    ds_read_b64_tr_b16 a[208:209], v56 offset:40960
    ds_read_b64_tr_b16 a[210:211], v56 offset:43008
    ds_read_b64_tr_b16 a[212:213], v56 offset:45056
    ds_read_b64_tr_b16 a[214:215], v56 offset:47104
    ds_read_b64_tr_b16 a[216:217], v57 offset:40960
    ds_read_b64_tr_b16 a[218:219], v57 offset:43008
    ds_read_b64_tr_b16 a[220:221], v57 offset:45056
    ds_read_b64_tr_b16 a[222:223], v57 offset:47104
    s_waitcnt lgkmcnt(14)
    v_mfma_f32_16x16x32_bf16 v[64:67], a[192:195], a[64:67], 0
    s_waitcnt lgkmcnt(12)
    s_add_u32 m0, s62, 0
    ds_read_b64_tr_b16 a[224:225], v56 offset:49152
    v_mfma_f32_16x16x32_bf16 v[64:67], a[196:199], a[68:71], v[64:67]
    s_xor_b32 s98, s65, 128
    ds_read_b64_tr_b16 a[226:227], v56 offset:51200
    v_mfma_f32_16x16x32_bf16 v[72:75], a[192:195], a[80:83], 0
    buffer_load_dwordx4 v24, s[28:31], s98 offen offset:0  lds
    v_mfma_f32_16x16x32_bf16 v[72:75], a[196:199], a[84:87], v[72:75]
    s_waitcnt lgkmcnt(12)
    ds_read_b64_tr_b16 a[228:229], v56 offset:53248
    v_mfma_f32_16x16x32_bf16 v[68:71], a[200:203], a[64:67], 0
    s_waitcnt lgkmcnt(11)
    s_add_u32 s22, s22, 65536
    ds_read_b64_tr_b16 a[230:231], v56 offset:55296
    v_mfma_f32_16x16x32_bf16 v[68:71], a[204:207], a[68:71], v[68:71]
    s_add_u32 s23, s23, 65536
    ds_read_b64_tr_b16 a[232:233], v57 offset:49152
    v_mfma_f32_16x16x32_bf16 v[76:79], a[200:203], a[80:83], 0
    buffer_load_dwordx4 v25, s[28:31], s98 offen offset:1024  lds
    v_mfma_f32_16x16x32_bf16 v[76:79], a[204:207], a[84:87], v[76:79]
    s_waitcnt lgkmcnt(11)
    s_lshl_b32 s24, s61, 2
    ds_read_b64_tr_b16 a[234:235], v57 offset:51200
    v_mfma_f32_16x16x32_bf16 v[64:67], a[208:211], a[72:75], v[64:67]
    s_waitcnt lgkmcnt(10)
    s_add_u32 s24, s24, s3
    ds_read_b64_tr_b16 a[236:237], v57 offset:53248
    v_mfma_f32_16x16x32_bf16 v[64:67], a[212:215], a[76:79], v[64:67]
    s_lshl_b32 s24, s24, 3
    ds_read_b64_tr_b16 a[238:239], v57 offset:55296
    v_mfma_f32_16x16x32_bf16 v[72:75], a[208:211], a[88:91], v[72:75]
    buffer_load_dwordx4 v26, s[28:31], s98 offen offset:2048  lds
    v_mfma_f32_16x16x32_bf16 v[72:75], a[212:215], a[92:95], v[72:75]
    s_waitcnt lgkmcnt(6)
    s_add_u32 s24, s24, s4
    ds_read_b64_tr_b16 a[240:241], v56 offset:57344
    v_mfma_f32_16x16x32_bf16 v[68:71], a[216:219], a[72:75], v[68:71]
    s_lshl_b32 s24, s24, 2
    ds_read_b64_tr_b16 a[242:243], v56 offset:59392
    v_mfma_f32_16x16x32_bf16 v[68:71], a[220:223], a[76:79], v[68:71]
    s_add_u32 s24, s24, s5
    ds_read_b64_tr_b16 a[244:245], v56 offset:61440
    v_mfma_f32_16x16x32_bf16 v[76:79], a[216:219], a[88:91], v[76:79]
    buffer_load_dwordx4 v27, s[28:31], s98 offen offset:3072  lds
    v_mfma_f32_16x16x32_bf16 v[76:79], a[220:223], a[92:95], v[76:79]
    s_add_u32 m0, s62, 4096
    ds_read_b64_tr_b16 a[246:247], v56 offset:63488
    v_mfma_f32_16x16x32_bf16 v[64:67], a[224:227], a[96:99], v[64:67]
    s_waitcnt lgkmcnt(7)
    s_xor_b32 s98, s65, 32896
    ds_read_b64_tr_b16 a[248:249], v57 offset:57344
    v_mfma_f32_16x16x32_bf16 v[64:67], a[228:231], a[100:103], v[64:67]
    s_lshl_b32 s24, s24, 13
    ds_read_b64_tr_b16 a[250:251], v57 offset:59392
    v_mfma_f32_16x16x32_bf16 v[72:75], a[224:227], a[112:115], v[72:75]
    buffer_load_dwordx4 v24, s[28:31], s98 offen offset:0  lds
    v_mfma_f32_16x16x32_bf16 v[72:75], a[228:231], a[116:119], v[72:75]
    s_waitcnt lgkmcnt(6)
    s_add_u32 s24, s24, 50331648
    ds_read_b64_tr_b16 a[252:253], v57 offset:61440
    v_mfma_f32_16x16x32_bf16 v[68:71], a[232:235], a[96:99], v[68:71]
    ds_read_b64_tr_b16 a[254:255], v57 offset:63488
    v_mfma_f32_16x16x32_bf16 v[68:71], a[236:239], a[100:103], v[68:71]
    ds_read_b64_tr_b16 a[192:193], v58 offset:32768
    v_mfma_f32_16x16x32_bf16 v[76:79], a[232:235], a[112:115], v[76:79]
    buffer_load_dwordx4 v25, s[28:31], s98 offen offset:1024  lds
    v_mfma_f32_16x16x32_bf16 v[76:79], a[236:239], a[116:119], v[76:79]
    s_waitcnt lgkmcnt(6)
    ds_read_b64_tr_b16 a[194:195], v58 offset:34816
    v_mfma_f32_16x16x32_bf16 v[64:67], a[240:243], a[104:107], v[64:67]
    s_waitcnt lgkmcnt(6)
    ds_read_b64_tr_b16 a[196:197], v58 offset:36864
    v_mfma_f32_16x16x32_bf16 v[64:67], a[244:247], a[108:111], v[64:67]
    ds_read_b64_tr_b16 a[198:199], v58 offset:38912
    v_mfma_f32_16x16x32_bf16 v[72:75], a[240:243], a[120:123], v[72:75]
    buffer_load_dwordx4 v26, s[28:31], s98 offen offset:2048  lds
    v_mfma_f32_16x16x32_bf16 v[72:75], a[244:247], a[124:127], v[72:75]
    s_waitcnt lgkmcnt(6)
    ds_read_b64_tr_b16 a[200:201], v59 offset:32768
    v_mfma_f32_16x16x32_bf16 v[68:71], a[248:251], a[104:107], v[68:71]
    s_waitcnt lgkmcnt(5)
    ds_read_b64_tr_b16 a[202:203], v59 offset:34816
    v_mfma_f32_16x16x32_bf16 v[68:71], a[252:255], a[108:111], v[68:71]
    ds_read_b64_tr_b16 a[204:205], v59 offset:36864
    v_mfma_f32_16x16x32_bf16 v[76:79], a[248:251], a[120:123], v[76:79]
    buffer_load_dwordx4 v27, s[28:31], s98 offen offset:3072  lds
    ds_read_b64_tr_b16 a[206:207], v59 offset:38912
    v_mfma_f32_16x16x32_bf16 v[76:79], a[252:255], a[124:127], v[76:79]
    s_waitcnt lgkmcnt(6)
    ds_read_b64_tr_b16 a[208:209], v58 offset:40960
    v_mfma_f32_16x16x32_bf16 v[80:83], a[192:195], a[64:67], 0
    s_waitcnt lgkmcnt(5)
    ds_read_b64_tr_b16 a[210:211], v58 offset:43008
    v_mfma_f32_16x16x32_bf16 v[80:83], a[196:199], a[68:71], v[80:83]
    ds_read_b64_tr_b16 a[212:213], v58 offset:45056
    v_mfma_f32_16x16x32_bf16 v[88:91], a[192:195], a[80:83], 0
    ds_read_b64_tr_b16 a[214:215], v58 offset:47104
    s_waitcnt vmcnt(16)
    s_barrier
    v_mfma_f32_16x16x32_bf16 v[88:91], a[196:199], a[84:87], v[88:91]
    s_waitcnt lgkmcnt(6)
    s_add_u32 m0, s62, 98304
    ds_read_b64_tr_b16 a[216:217], v59 offset:40960
    v_mfma_f32_16x16x32_bf16 v[84:87], a[200:203], a[64:67], 0
    s_waitcnt lgkmcnt(5)
    s_xor_b32 s98, s65, 262272
    ds_read_b64_tr_b16 a[218:219], v59 offset:43008
    v_mfma_f32_16x16x32_bf16 v[84:87], a[204:207], a[68:71], v[84:87]
    buffer_load_dwordx4 v24, s[28:31], s98 offen offset:0  lds
    ds_read_b64_tr_b16 a[220:221], v59 offset:45056
    v_mfma_f32_16x16x32_bf16 v[92:95], a[200:203], a[80:83], 0
    ds_read_b64_tr_b16 a[222:223], v59 offset:47104
    v_mfma_f32_16x16x32_bf16 v[92:95], a[204:207], a[84:87], v[92:95]
    s_waitcnt lgkmcnt(6)
    ds_read_b64_tr_b16 a[224:225], v58 offset:49152
    v_mfma_f32_16x16x32_bf16 v[80:83], a[208:211], a[72:75], v[80:83]
    s_waitcnt lgkmcnt(5)
    ds_read_b64_tr_b16 a[226:227], v58 offset:51200
    v_mfma_f32_16x16x32_bf16 v[80:83], a[212:215], a[76:79], v[80:83]
    buffer_load_dwordx4 v25, s[28:31], s98 offen offset:1024  lds
    v_mfma_f32_16x16x32_bf16 v[88:91], a[208:211], a[88:91], v[88:91]
    ds_read_b64_tr_b16 a[228:229], v58 offset:53248
    v_mfma_f32_16x16x32_bf16 v[88:91], a[212:215], a[92:95], v[88:91]
    s_waitcnt lgkmcnt(5)
    ds_read_b64_tr_b16 a[230:231], v58 offset:55296
    v_mfma_f32_16x16x32_bf16 v[84:87], a[216:219], a[72:75], v[84:87]
    s_waitcnt lgkmcnt(4)
    ds_read_b64_tr_b16 a[232:233], v59 offset:49152
    v_mfma_f32_16x16x32_bf16 v[84:87], a[220:223], a[76:79], v[84:87]
    buffer_load_dwordx4 v26, s[28:31], s98 offen offset:2048  lds
    ds_read_b64_tr_b16 a[234:235], v59 offset:51200
    v_mfma_f32_16x16x32_bf16 v[92:95], a[216:219], a[88:91], v[92:95]
    ds_read_b64_tr_b16 a[236:237], v59 offset:53248
    v_mfma_f32_16x16x32_bf16 v[92:95], a[220:223], a[92:95], v[92:95]
    s_waitcnt lgkmcnt(5)
    ds_read_b64_tr_b16 a[238:239], v59 offset:55296
    v_mfma_f32_16x16x32_bf16 v[80:83], a[224:227], a[96:99], v[80:83]
    s_waitcnt lgkmcnt(4)
    ds_read_b64_tr_b16 a[240:241], v58 offset:57344
    v_mfma_f32_16x16x32_bf16 v[80:83], a[228:231], a[100:103], v[80:83]
    buffer_load_dwordx4 v27, s[28:31], s98 offen offset:3072  lds
    v_mfma_f32_16x16x32_bf16 v[88:91], a[224:227], a[112:115], v[88:91]
    s_add_u32 m0, s62, 102400
    ds_read_b64_tr_b16 a[242:243], v58 offset:59392
    v_mfma_f32_16x16x32_bf16 v[88:91], a[228:231], a[116:119], v[88:91]
    s_waitcnt lgkmcnt(4)
    s_xor_b32 s98, s65, 295040
    ds_read_b64_tr_b16 a[244:245], v58 offset:61440
    v_mfma_f32_16x16x32_bf16 v[84:87], a[232:235], a[96:99], v[84:87]
    s_waitcnt lgkmcnt(3)
    ds_read_b64_tr_b16 a[246:247], v58 offset:63488
    v_mfma_f32_16x16x32_bf16 v[84:87], a[236:239], a[100:103], v[84:87]
    buffer_load_dwordx4 v24, s[28:31], s98 offen offset:0  lds
    ds_read_b64_tr_b16 a[248:249], v59 offset:57344
    v_mfma_f32_16x16x32_bf16 v[92:95], a[232:235], a[112:115], v[92:95]
    ds_read_b64_tr_b16 a[250:251], v59 offset:59392
    v_mfma_f32_16x16x32_bf16 v[92:95], a[236:239], a[116:119], v[92:95]
    s_waitcnt lgkmcnt(4)
    ds_read_b64_tr_b16 a[252:253], v59 offset:61440
    v_mfma_f32_16x16x32_bf16 v[80:83], a[240:243], a[104:107], v[80:83]
    s_waitcnt lgkmcnt(3)
    ds_read_b64_tr_b16 a[254:255], v59 offset:63488
    v_mfma_f32_16x16x32_bf16 v[80:83], a[244:247], a[108:111], v[80:83]
    buffer_load_dwordx4 v25, s[28:31], s98 offen offset:1024  lds
    v_mfma_f32_16x16x32_bf16 v[88:91], a[240:243], a[120:123], v[88:91]
    ds_read_b64_tr_b16 a[192:193], v60 offset:0
    v_mfma_f32_16x16x32_bf16 v[88:91], a[244:247], a[124:127], v[88:91]
    s_waitcnt lgkmcnt(3)
    ds_read_b64_tr_b16 a[194:195], v60 offset:2048
    v_mfma_f32_16x16x32_bf16 v[84:87], a[248:251], a[104:107], v[84:87]
    s_waitcnt lgkmcnt(2)
    ds_read_b64_tr_b16 a[196:197], v60 offset:4096
    v_mfma_f32_16x16x32_bf16 v[84:87], a[252:255], a[108:111], v[84:87]
    buffer_load_dwordx4 v26, s[28:31], s98 offen offset:2048  lds
    ds_read_b64_tr_b16 a[198:199], v60 offset:6144
    v_mfma_f32_16x16x32_bf16 v[92:95], a[248:251], a[120:123], v[92:95]
    ds_read_b64_tr_b16 a[200:201], v61 offset:0
    v_mfma_f32_16x16x32_bf16 v[92:95], a[252:255], a[124:127], v[92:95]
    s_waitcnt lgkmcnt(3)
    ds_read_b64_tr_b16 a[202:203], v61 offset:2048
    v_mfma_f32_16x16x32_bf16 v[64:67], a[192:195], a[0:3], v[64:67]
    s_waitcnt lgkmcnt(2)
    ds_read_b64_tr_b16 a[204:205], v61 offset:4096
    v_mfma_f32_16x16x32_bf16 v[64:67], a[196:199], a[4:7], v[64:67]
    buffer_load_dwordx4 v27, s[28:31], s98 offen offset:3072  lds
    ds_read_b64_tr_b16 a[206:207], v61 offset:6144
    v_mfma_f32_16x16x32_bf16 v[72:75], a[192:195], a[16:19], v[72:75]
    ds_read_b64_tr_b16 a[208:209], v60 offset:8192
    v_mfma_f32_16x16x32_bf16 v[72:75], a[196:199], a[20:23], v[72:75]
    s_waitcnt lgkmcnt(3)
    ds_read_b64_tr_b16 a[210:211], v60 offset:10240
    v_mfma_f32_16x16x32_bf16 v[68:71], a[200:203], a[0:3], v[68:71]
    s_waitcnt lgkmcnt(2)
    ds_read_b64_tr_b16 a[212:213], v60 offset:12288
    v_mfma_f32_16x16x32_bf16 v[68:71], a[204:207], a[4:7], v[68:71]
    ds_read_b64_tr_b16 a[214:215], v60 offset:14336
    v_mfma_f32_16x16x32_bf16 v[76:79], a[200:203], a[16:19], v[76:79]
    ds_read_b64_tr_b16 a[216:217], v61 offset:8192
    v_mfma_f32_16x16x32_bf16 v[76:79], a[204:207], a[20:23], v[76:79]
    s_waitcnt lgkmcnt(3)
    ds_read_b64_tr_b16 a[218:219], v61 offset:10240
    v_mfma_f32_16x16x32_bf16 v[64:67], a[208:211], a[8:11], v[64:67]
    s_waitcnt lgkmcnt(2)
    ds_read_b64_tr_b16 a[220:221], v61 offset:12288
    v_mfma_f32_16x16x32_bf16 v[64:67], a[212:215], a[12:15], v[64:67]
    ds_read_b64_tr_b16 a[222:223], v61 offset:14336
    v_mfma_f32_16x16x32_bf16 v[72:75], a[208:211], a[24:27], v[72:75]
    ds_read_b64_tr_b16 a[224:225], v60 offset:16384
    v_mfma_f32_16x16x32_bf16 v[72:75], a[212:215], a[28:31], v[72:75]
    s_waitcnt lgkmcnt(3)
    ds_read_b64_tr_b16 a[226:227], v60 offset:18432
    v_mfma_f32_16x16x32_bf16 v[68:71], a[216:219], a[8:11], v[68:71]
    s_waitcnt lgkmcnt(2)
    ds_read_b64_tr_b16 a[228:229], v60 offset:20480
    v_mfma_f32_16x16x32_bf16 v[68:71], a[220:223], a[12:15], v[68:71]
    ds_read_b64_tr_b16 a[230:231], v60 offset:22528
    v_mfma_f32_16x16x32_bf16 v[76:79], a[216:219], a[24:27], v[76:79]
    ds_read_b64_tr_b16 a[232:233], v61 offset:16384
    v_mfma_f32_16x16x32_bf16 v[76:79], a[220:223], a[28:31], v[76:79]
    s_waitcnt lgkmcnt(3)
    ds_read_b64_tr_b16 a[234:235], v61 offset:18432
    v_mfma_f32_16x16x32_bf16 v[64:67], a[224:227], a[32:35], v[64:67]
    s_waitcnt lgkmcnt(2)
    ds_read_b64_tr_b16 a[236:237], v61 offset:20480
    v_mfma_f32_16x16x32_bf16 v[64:67], a[228:231], a[36:39], v[64:67]
    ds_read_b64_tr_b16 a[238:239], v61 offset:22528
    v_mfma_f32_16x16x32_bf16 v[72:75], a[224:227], a[48:51], v[72:75]
    ds_read_b64_tr_b16 a[240:241], v60 offset:24576
    v_mfma_f32_16x16x32_bf16 v[72:75], a[228:231], a[52:55], v[72:75]
    s_waitcnt lgkmcnt(3)
    ds_read_b64_tr_b16 a[242:243], v60 offset:26624
    v_mfma_f32_16x16x32_bf16 v[68:71], a[232:235], a[32:35], v[68:71]
    s_waitcnt lgkmcnt(2)
    ds_read_b64_tr_b16 a[244:245], v60 offset:28672
    v_mfma_f32_16x16x32_bf16 v[68:71], a[236:239], a[36:39], v[68:71]
    ds_read_b64_tr_b16 a[246:247], v60 offset:30720
    v_mfma_f32_16x16x32_bf16 v[76:79], a[232:235], a[48:51], v[76:79]
    ds_read_b64_tr_b16 a[248:249], v61 offset:24576
    v_mfma_f32_16x16x32_bf16 v[76:79], a[236:239], a[52:55], v[76:79]
    s_waitcnt lgkmcnt(3)
    ds_read_b64_tr_b16 a[250:251], v61 offset:26624
    v_mfma_f32_16x16x32_bf16 v[64:67], a[240:243], a[40:43], v[64:67]
    s_waitcnt lgkmcnt(2)
    ds_read_b64_tr_b16 a[252:253], v61 offset:28672
    v_mfma_f32_16x16x32_bf16 v[64:67], a[244:247], a[44:47], v[64:67]
    ds_read_b64_tr_b16 a[254:255], v61 offset:30720
    v_mfma_f32_16x16x32_bf16 v[72:75], a[240:243], a[56:59], v[72:75]
    s_waitcnt lgkmcnt(2)
    ds_read_b64_tr_b16 a[192:193], v62 offset:0
    s_waitcnt vmcnt(16)
    v_mfma_f32_16x16x32_bf16 v[72:75], a[244:247], a[60:63], v[72:75]
    buffer_store_dword v6, v5, s[8:11], s22 offen sc0 sc1
    ds_read_b64_tr_b16 a[194:195], v62 offset:2048
    v_mfma_f32_16x16x32_bf16 v[68:71], a[248:251], a[40:43], v[68:71]
    s_waitcnt lgkmcnt(2)
    ds_read_b64_tr_b16 a[196:197], v62 offset:4096
    v_mfma_f32_16x16x32_bf16 v[68:71], a[252:255], a[44:47], v[68:71]
    ds_read_b64_tr_b16 a[198:199], v62 offset:6144
    v_mfma_f32_16x16x32_bf16 v[76:79], a[248:251], a[56:59], v[76:79]
    ds_read_b64_tr_b16 a[200:201], v63 offset:0
    v_mfma_f32_16x16x32_bf16 v[76:79], a[252:255], a[60:63], v[76:79]
    s_waitcnt lgkmcnt(3)
    ds_read_b64_tr_b16 a[202:203], v63 offset:2048
    v_mfma_f32_16x16x32_bf16 v[80:83], a[192:195], a[0:3], v[80:83]
    s_waitcnt lgkmcnt(2)
    ds_read_b64_tr_b16 a[204:205], v63 offset:4096
    v_mfma_f32_16x16x32_bf16 v[80:83], a[196:199], a[4:7], v[80:83]
    ds_read_b64_tr_b16 a[206:207], v63 offset:6144
    v_mfma_f32_16x16x32_bf16 v[88:91], a[192:195], a[16:19], v[88:91]
    ds_read_b64_tr_b16 a[208:209], v62 offset:8192
    v_mfma_f32_16x16x32_bf16 v[88:91], a[196:199], a[20:23], v[88:91]
    s_waitcnt lgkmcnt(3)
    ds_read_b64_tr_b16 a[210:211], v62 offset:10240
    v_mfma_f32_16x16x32_bf16 v[84:87], a[200:203], a[0:3], v[84:87]
    s_waitcnt lgkmcnt(2)
    ds_read_b64_tr_b16 a[212:213], v62 offset:12288
    v_mfma_f32_16x16x32_bf16 v[84:87], a[204:207], a[4:7], v[84:87]
    ds_read_b64_tr_b16 a[214:215], v62 offset:14336
    v_mfma_f32_16x16x32_bf16 v[92:95], a[200:203], a[16:19], v[92:95]
    ds_read_b64_tr_b16 a[216:217], v63 offset:8192
    v_cvt_pk_bf16_f32 v64, v64, v65
    s_waitcnt vmcnt(1)
    s_barrier
    v_mfma_f32_16x16x32_bf16 v[92:95], a[204:207], a[20:23], v[92:95]
    s_waitcnt lgkmcnt(1)
    s_xor_b32 s74, s24, 0
    ds_read_b64_tr_b16 a[218:219], v63 offset:10240
    v_cvt_pk_bf16_f32 v65, v66, v67
    v_mfma_f32_16x16x32_bf16 v[80:83], a[208:211], a[8:11], v[80:83]
    buffer_load_dwordx4 v[128:131], v1, s[8:11], s74 offen offset:0
    ds_read_b64_tr_b16 a[220:221], v63 offset:12288
    v_mfma_f32_16x16x32_bf16 v[80:83], a[212:215], a[12:15], v[80:83]
    s_xor_b32 s74, s24, 4096
    ds_read_b64_tr_b16 a[222:223], v63 offset:14336
    v_lshrrev_b32 v46, 2, v2
    v_mfma_f32_16x16x32_bf16 v[88:91], a[208:211], a[24:27], v[88:91]
    s_waitcnt lgkmcnt(2)
    ds_read_b64_tr_b16 a[224:225], v62 offset:16384
    v_and_b32 v45, 3, v2
    v_mfma_f32_16x16x32_bf16 v[88:91], a[212:215], a[28:31], v[88:91]
    buffer_load_dwordx4 v[144:147], v1, s[8:11], s74 offen offset:0
    ds_read_b64_tr_b16 a[226:227], v62 offset:18432
    v_mfma_f32_16x16x32_bf16 v[84:87], a[216:219], a[8:11], v[84:87]
    s_waitcnt lgkmcnt(2)
    s_xor_b32 s74, s24, 0
    ds_read_b64_tr_b16 a[228:229], v62 offset:20480
    v_lshlrev_b32 v44, 8, v46
    v_mfma_f32_16x16x32_bf16 v[84:87], a[220:223], a[12:15], v[84:87]
    ds_read_b64_tr_b16 a[230:231], v62 offset:22528
    v_lshl_add_u32 v44, v45, 4, v44
    v_mfma_f32_16x16x32_bf16 v[92:95], a[216:219], a[24:27], v[92:95]
    buffer_load_dwordx4 v[132:135], v1, s[8:11], s74 offen offset:1024
    ds_read_b64_tr_b16 a[232:233], v63 offset:16384
    v_mfma_f32_16x16x32_bf16 v[92:95], a[220:223], a[28:31], v[92:95]
    s_waitcnt lgkmcnt(3)
    s_xor_b32 s74, s24, 4096
    ds_read_b64_tr_b16 a[234:235], v63 offset:18432
    v_lshlrev_b32 v45, 3, v45
    v_mfma_f32_16x16x32_bf16 v[80:83], a[224:227], a[32:35], v[80:83]
    s_waitcnt lgkmcnt(2)
    ds_read_b64_tr_b16 a[236:237], v63 offset:20480
    v_lshl_add_u32 v45, v46, 6, v45
    v_mfma_f32_16x16x32_bf16 v[80:83], a[228:231], a[36:39], v[80:83]
    buffer_load_dwordx4 v[148:151], v1, s[8:11], s74 offen offset:1024
    ds_read_b64_tr_b16 a[238:239], v63 offset:22528
    v_mfma_f32_16x16x32_bf16 v[88:91], a[224:227], a[48:51], v[88:91]
    s_xor_b32 s74, s24, 0
    ds_read_b64_tr_b16 a[240:241], v62 offset:24576
    v_lshlrev_b32 v46, 1, v45
    v_mfma_f32_16x16x32_bf16 v[88:91], a[228:231], a[52:55], v[88:91]
    s_waitcnt lgkmcnt(1)
    s_lshl_b32 s70, s2, 15
    ds_read_b64_tr_b16 a[242:243], v62 offset:26624
    v_cvt_pk_bf16_f32 v66, v68, v69
    v_mfma_f32_16x16x32_bf16 v[84:87], a[232:235], a[32:35], v[84:87]
    buffer_load_dwordx4 v[136:139], v1, s[8:11], s74 offen offset:2048
    ds_read_b64_tr_b16 a[244:245], v62 offset:28672
    v_mfma_f32_16x16x32_bf16 v[84:87], a[236:239], a[36:39], v[84:87]
    s_xor_b32 s74, s24, 4096
    ds_read_b64_tr_b16 a[246:247], v62 offset:30720
    v_cvt_pk_bf16_f32 v67, v70, v71
    v_mfma_f32_16x16x32_bf16 v[92:95], a[232:235], a[48:51], v[92:95]
    s_waitcnt lgkmcnt(2)
    s_lshl_b32 s100, s3, 6
    ds_read_b64_tr_b16 a[248:249], v63 offset:24576
    v_min_u32 v64, -2, v64
    v_mfma_f32_16x16x32_bf16 v[92:95], a[236:239], a[52:55], v[92:95]
    buffer_load_dwordx4 v[152:155], v1, s[8:11], s74 offen offset:2048
    ds_read_b64_tr_b16 a[250:251], v63 offset:26624
    v_mfma_f32_16x16x32_bf16 v[80:83], a[240:243], a[40:43], v[80:83]
    s_waitcnt lgkmcnt(2)
    s_xor_b32 s74, s24, 0
    ds_read_b64_tr_b16 a[252:253], v63 offset:28672
    v_min_u32 v65, -2, v65
    v_mfma_f32_16x16x32_bf16 v[80:83], a[244:247], a[44:47], v[80:83]
    s_add_u32 s70, s70, s100
    ds_read_b64_tr_b16 a[254:255], v63 offset:30720
    v_min_u32 v66, -2, v66
    v_mfma_f32_16x16x32_bf16 v[88:91], a[240:243], a[56:59], v[88:91]
    buffer_load_dwordx4 v[140:143], v1, s[8:11], s74 offen offset:3072
    v_mfma_f32_16x16x32_bf16 v[88:91], a[244:247], a[60:63], v[88:91]
    s_waitcnt lgkmcnt(2)
    s_xor_b32 s74, s24, 4096
    ds_read_b64_tr_b16 a[192:193], v56 offset:0
    v_min_u32 v67, -2, v67
    v_mfma_f32_16x16x32_bf16 v[84:87], a[248:251], a[40:43], v[84:87]
    s_waitcnt lgkmcnt(1)
    s_add_u32 s70, s70, 67108864
    ds_read_b64_tr_b16 a[194:195], v56 offset:2048
    v_mfma_f32_16x16x32_bf16 v[84:87], a[252:255], a[44:47], v[84:87]
    buffer_load_dwordx4 v[156:159], v1, s[8:11], s74 offen offset:3072
    ds_read_b64_tr_b16 a[196:197], v56 offset:4096
    v_mfma_f32_16x16x32_bf16 v[92:95], a[248:251], a[56:59], v[92:95]
    s_and_b32 s68, s2, 31
    ds_read_b64_tr_b16 a[198:199], v56 offset:6144
    v_mfma_f32_16x16x32_bf16 v[92:95], a[252:255], a[60:63], v[92:95]
    s_waitcnt lgkmcnt(2)
    s_lshl_b32 s68, s68, 2
    ds_read_b64_tr_b16 a[200:201], v57 offset:0
    v_mfma_f32_16x16x32_bf16 v[96:99], a[192:195], a[64:67], 0
    s_waitcnt lgkmcnt(1)
    s_add_u32 s68, s68, s3
    ds_read_b64_tr_b16 a[202:203], v57 offset:2048
    v_mfma_f32_16x16x32_bf16 v[96:99], a[196:199], a[68:71], v[96:99]
    s_lshl_b32 s69, s61, 7
    ds_read_b64_tr_b16 a[204:205], v57 offset:4096
    v_mfma_f32_16x16x32_bf16 v[104:107], a[192:195], a[80:83], 0
    s_add_u32 s69, s69, s68
    ds_read_b64_tr_b16 a[206:207], v57 offset:6144
    v_mfma_f32_16x16x32_bf16 v[104:107], a[196:199], a[84:87], v[104:107]
    s_waitcnt lgkmcnt(2)
    s_lshl_b32 s100, s60, 7
    ds_read_b64_tr_b16 a[208:209], v56 offset:8192
    v_mfma_f32_16x16x32_bf16 v[100:103], a[200:203], a[64:67], 0
    s_waitcnt lgkmcnt(1)
    s_add_u32 s68, s68, s100
    ds_read_b64_tr_b16 a[210:211], v56 offset:10240
    v_mfma_f32_16x16x32_bf16 v[100:103], a[204:207], a[68:71], v[100:103]
    s_lshl_b32 s100, s68, 10
    ds_read_b64_tr_b16 a[212:213], v56 offset:12288
    v_mfma_f32_16x16x32_bf16 v[108:111], a[200:203], a[80:83], 0
    s_lshl_b32 s101, s69, 10
    ds_read_b64_tr_b16 a[214:215], v56 offset:14336
    v_cvt_pk_bf16_f32 v80, v80, v81
    v_mfma_f32_16x16x32_bf16 v[108:111], a[204:207], a[84:87], v[108:111]
    s_waitcnt lgkmcnt(0)
    s_add_u32 s75, s18, 0
    ds_read_b64_tr_b16 a[216:217], v57 offset:8192
    v_cvt_pk_bf16_f32 v81, v82, v83
    v_mfma_f32_16x16x32_bf16 v[96:99], a[208:211], a[72:75], v[96:99]
    buffer_store_dwordx4 v[64:67], v23, s[8:11], s75 offen offset:0 sc0 sc1
    ds_read_b64_tr_b16 a[218:219], v57 offset:10240
    v_mfma_f32_16x16x32_bf16 v[96:99], a[212:215], a[76:79], v[96:99]
    ds_read_b64_tr_b16 a[220:221], v57 offset:12288
    v_cvt_pk_bf16_f32 v72, v72, v73
    v_mfma_f32_16x16x32_bf16 v[104:107], a[208:211], a[88:91], v[104:107]
    ds_read_b64_tr_b16 a[222:223], v57 offset:14336
    v_cvt_pk_bf16_f32 v73, v74, v75
    v_mfma_f32_16x16x32_bf16 v[104:107], a[212:215], a[92:95], v[104:107]
    s_waitcnt lgkmcnt(2)
    ds_read_b64_tr_b16 a[224:225], v56 offset:16384
    v_cvt_pk_bf16_f32 v74, v76, v77
    v_mfma_f32_16x16x32_bf16 v[100:103], a[216:219], a[72:75], v[100:103]
    s_waitcnt lgkmcnt(1)
    ds_read_b64_tr_b16 a[226:227], v56 offset:18432
    v_cvt_pk_bf16_f32 v75, v78, v79
    v_mfma_f32_16x16x32_bf16 v[100:103], a[220:223], a[76:79], v[100:103]
    ds_read_b64_tr_b16 a[228:229], v56 offset:20480
    v_min_u32 v72, -2, v72
    v_mfma_f32_16x16x32_bf16 v[108:111], a[216:219], a[88:91], v[108:111]
    ds_read_b64_tr_b16 a[230:231], v56 offset:22528
    v_min_u32 v73, -2, v73
    v_mfma_f32_16x16x32_bf16 v[108:111], a[220:223], a[92:95], v[108:111]
    s_waitcnt lgkmcnt(2)
    ds_read_b64_tr_b16 a[232:233], v57 offset:16384
    v_min_u32 v74, -2, v74
    v_mfma_f32_16x16x32_bf16 v[96:99], a[224:227], a[96:99], v[96:99]
    s_waitcnt lgkmcnt(1)
    ds_read_b64_tr_b16 a[234:235], v57 offset:18432
    v_min_u32 v75, -2, v75
    v_mfma_f32_16x16x32_bf16 v[96:99], a[228:231], a[100:103], v[96:99]
    s_add_u32 s75, s18, 131072
    ds_read_b64_tr_b16 a[236:237], v57 offset:20480
    v_cvt_pk_bf16_f32 v82, v84, v85
    v_mfma_f32_16x16x32_bf16 v[104:107], a[224:227], a[112:115], v[104:107]
    buffer_store_dwordx4 v[72:75], v23, s[8:11], s75 offen offset:0 sc0 sc1
    ds_read_b64_tr_b16 a[238:239], v57 offset:22528
    v_mfma_f32_16x16x32_bf16 v[104:107], a[228:231], a[116:119], v[104:107]
    s_waitcnt lgkmcnt(2)
    ds_read_b64_tr_b16 a[240:241], v56 offset:24576
    v_cvt_pk_bf16_f32 v83, v86, v87
    v_mfma_f32_16x16x32_bf16 v[100:103], a[232:235], a[96:99], v[100:103]
    s_waitcnt lgkmcnt(1)
    ds_read_b64_tr_b16 a[242:243], v56 offset:26624
    v_min_u32 v80, -2, v80
    v_mfma_f32_16x16x32_bf16 v[100:103], a[236:239], a[100:103], v[100:103]
    ds_read_b64_tr_b16 a[244:245], v56 offset:28672
    v_min_u32 v81, -2, v81
    v_mfma_f32_16x16x32_bf16 v[108:111], a[232:235], a[112:115], v[108:111]
    ds_read_b64_tr_b16 a[246:247], v56 offset:30720
    v_min_u32 v82, -2, v82
    v_mfma_f32_16x16x32_bf16 v[108:111], a[236:239], a[116:119], v[108:111]
    s_waitcnt lgkmcnt(2)
    ds_read_b64_tr_b16 a[248:249], v57 offset:24576
    v_min_u32 v83, -2, v83
    v_mfma_f32_16x16x32_bf16 v[96:99], a[240:243], a[104:107], v[96:99]
    s_waitcnt lgkmcnt(1)
    s_add_u32 s75, s18, 0
    ds_read_b64_tr_b16 a[250:251], v57 offset:26624
    v_mfma_f32_16x16x32_bf16 v[96:99], a[244:247], a[108:111], v[96:99]
    buffer_store_dwordx4 v[80:83], v23, s[8:11], s75 offen offset:256 sc0 sc1
    ds_read_b64_tr_b16 a[252:253], v57 offset:28672
    v_mfma_f32_16x16x32_bf16 v[104:107], a[240:243], a[120:123], v[104:107]
    ds_read_b64_tr_b16 a[254:255], v57 offset:30720
    v_cvt_pk_bf16_f32 v88, v88, v89
    v_mfma_f32_16x16x32_bf16 v[104:107], a[244:247], a[124:127], v[104:107]
    s_waitcnt lgkmcnt(2)
    ds_read_b64_tr_b16 a[192:193], v60 offset:32768
    v_cvt_pk_bf16_f32 v89, v90, v91
    v_mfma_f32_16x16x32_bf16 v[100:103], a[248:251], a[104:107], v[100:103]
    s_waitcnt lgkmcnt(1)
    ds_read_b64_tr_b16 a[194:195], v60 offset:34816
    v_cvt_pk_bf16_f32 v90, v92, v93
    v_mfma_f32_16x16x32_bf16 v[100:103], a[252:255], a[108:111], v[100:103]
    ds_read_b64_tr_b16 a[196:197], v60 offset:36864
    v_cvt_pk_bf16_f32 v91, v94, v95
    v_mfma_f32_16x16x32_bf16 v[108:111], a[248:251], a[120:123], v[108:111]
    ds_read_b64_tr_b16 a[198:199], v60 offset:38912
    v_min_u32 v88, -2, v88
    v_mfma_f32_16x16x32_bf16 v[108:111], a[252:255], a[124:127], v[108:111]
    s_waitcnt lgkmcnt(2)
    ds_read_b64_tr_b16 a[200:201], v61 offset:32768
    v_min_u32 v89, -2, v89
    v_mfma_f32_16x16x32_bf16 v[96:99], a[192:195], a[0:3], v[96:99]
    s_waitcnt lgkmcnt(1)
    ds_read_b64_tr_b16 a[202:203], v61 offset:34816
    v_min_u32 v90, -2, v90
    v_mfma_f32_16x16x32_bf16 v[96:99], a[196:199], a[4:7], v[96:99]
    ds_read_b64_tr_b16 a[204:205], v61 offset:36864
    v_min_u32 v91, -2, v91
    v_mfma_f32_16x16x32_bf16 v[104:107], a[192:195], a[16:19], v[104:107]
    s_waitcnt lgkmcnt(1)
    s_add_u32 s75, s18, 131072
    ds_read_b64_tr_b16 a[206:207], v61 offset:38912
    v_mfma_f32_16x16x32_bf16 v[104:107], a[196:199], a[20:23], v[104:107]
    buffer_store_dwordx4 v[88:91], v23, s[8:11], s75 offen offset:256 sc0 sc1
    ds_read_b64_tr_b16 a[208:209], v60 offset:40960
    v_mfma_f32_16x16x32_bf16 v[100:103], a[200:203], a[0:3], v[100:103]
    s_waitcnt lgkmcnt(1)
    ds_read_b64_tr_b16 a[210:211], v60 offset:43008
    v_mfma_f32_16x16x32_bf16 v[100:103], a[204:207], a[4:7], v[100:103]
    ds_read_b64_tr_b16 a[212:213], v60 offset:45056
    v_mfma_f32_16x16x32_bf16 v[108:111], a[200:203], a[16:19], v[108:111]
    ds_read_b64_tr_b16 a[214:215], v60 offset:47104
    v_mfma_f32_16x16x32_bf16 v[108:111], a[204:207], a[20:23], v[108:111]
    s_waitcnt lgkmcnt(2)
    ds_read_b64_tr_b16 a[216:217], v61 offset:40960
    v_mfma_f32_16x16x32_bf16 v[96:99], a[208:211], a[8:11], v[96:99]
    s_waitcnt lgkmcnt(1)
    ds_read_b64_tr_b16 a[218:219], v61 offset:43008
    v_mfma_f32_16x16x32_bf16 v[96:99], a[212:215], a[12:15], v[96:99]
    ds_read_b64_tr_b16 a[220:221], v61 offset:45056
    v_mfma_f32_16x16x32_bf16 v[104:107], a[208:211], a[24:27], v[104:107]
    buffer_load_dword v3, v4, s[8:11], s23 offen sc0 sc1
    ds_read_b64_tr_b16 a[222:223], v61 offset:47104
    v_mfma_f32_16x16x32_bf16 v[104:107], a[212:215], a[28:31], v[104:107]
    s_waitcnt lgkmcnt(2)
    ds_read_b64_tr_b16 a[224:225], v60 offset:49152
    v_mfma_f32_16x16x32_bf16 v[100:103], a[216:219], a[8:11], v[100:103]
    s_waitcnt lgkmcnt(1)
    ds_read_b64_tr_b16 a[226:227], v60 offset:51200
    v_mfma_f32_16x16x32_bf16 v[100:103], a[220:223], a[12:15], v[100:103]
    ds_read_b64_tr_b16 a[228:229], v60 offset:53248
    v_mfma_f32_16x16x32_bf16 v[108:111], a[216:219], a[24:27], v[108:111]
    ds_read_b64_tr_b16 a[230:231], v60 offset:55296
    v_mfma_f32_16x16x32_bf16 v[108:111], a[220:223], a[28:31], v[108:111]
    s_waitcnt lgkmcnt(2)
    ds_read_b64_tr_b16 a[232:233], v61 offset:49152
    v_mfma_f32_16x16x32_bf16 v[96:99], a[224:227], a[32:35], v[96:99]
    s_waitcnt lgkmcnt(1)
    ds_read_b64_tr_b16 a[234:235], v61 offset:51200
    v_mfma_f32_16x16x32_bf16 v[96:99], a[228:231], a[36:39], v[96:99]
    ds_read_b64_tr_b16 a[236:237], v61 offset:53248
    v_mfma_f32_16x16x32_bf16 v[104:107], a[224:227], a[48:51], v[104:107]
    ds_read_b64_tr_b16 a[238:239], v61 offset:55296
    v_mfma_f32_16x16x32_bf16 v[104:107], a[228:231], a[52:55], v[104:107]
    s_waitcnt lgkmcnt(2)
    ds_read_b64_tr_b16 a[240:241], v60 offset:57344
    v_mfma_f32_16x16x32_bf16 v[100:103], a[232:235], a[32:35], v[100:103]
    s_waitcnt lgkmcnt(1)
    ds_read_b64_tr_b16 a[242:243], v60 offset:59392
    v_mfma_f32_16x16x32_bf16 v[100:103], a[236:239], a[36:39], v[100:103]
    ds_read_b64_tr_b16 a[244:245], v60 offset:61440
    v_mfma_f32_16x16x32_bf16 v[108:111], a[232:235], a[48:51], v[108:111]
    ds_read_b64_tr_b16 a[246:247], v60 offset:63488
    v_mfma_f32_16x16x32_bf16 v[108:111], a[236:239], a[52:55], v[108:111]
    s_waitcnt lgkmcnt(2)
    ds_read_b64_tr_b16 a[248:249], v61 offset:57344
    v_mfma_f32_16x16x32_bf16 v[96:99], a[240:243], a[40:43], v[96:99]
    s_waitcnt lgkmcnt(1)
    ds_read_b64_tr_b16 a[250:251], v61 offset:59392
    v_mfma_f32_16x16x32_bf16 v[96:99], a[244:247], a[44:47], v[96:99]
    ds_read_b64_tr_b16 a[252:253], v61 offset:61440
    v_mfma_f32_16x16x32_bf16 v[104:107], a[240:243], a[56:59], v[104:107]
    ds_read_b64_tr_b16 a[254:255], v61 offset:63488
    v_mfma_f32_16x16x32_bf16 v[104:107], a[244:247], a[60:63], v[104:107]
    s_waitcnt lgkmcnt(2)
    ds_read_b64_tr_b16 a[192:193], v58 offset:0
    v_mfma_f32_16x16x32_bf16 v[100:103], a[248:251], a[40:43], v[100:103]
    s_waitcnt lgkmcnt(1)
    ds_read_b64_tr_b16 a[194:195], v58 offset:2048
    v_mfma_f32_16x16x32_bf16 v[100:103], a[252:255], a[44:47], v[100:103]
    ds_read_b64_tr_b16 a[196:197], v58 offset:4096
    v_mfma_f32_16x16x32_bf16 v[108:111], a[248:251], a[56:59], v[108:111]
    ds_read_b64_tr_b16 a[198:199], v58 offset:6144
    v_mfma_f32_16x16x32_bf16 v[108:111], a[252:255], a[60:63], v[108:111]
    s_waitcnt lgkmcnt(2)
    ds_read_b64_tr_b16 a[200:201], v59 offset:0
    v_mfma_f32_16x16x32_bf16 v[112:115], a[192:195], a[64:67], 0
    s_waitcnt lgkmcnt(1)
    ds_read_b64_tr_b16 a[202:203], v59 offset:2048
    v_mfma_f32_16x16x32_bf16 v[112:115], a[196:199], a[68:71], v[112:115]
    ds_read_b64_tr_b16 a[204:205], v59 offset:4096
    v_mfma_f32_16x16x32_bf16 v[120:123], a[192:195], a[80:83], 0
    ds_read_b64_tr_b16 a[206:207], v59 offset:6144
    v_mfma_f32_16x16x32_bf16 v[120:123], a[196:199], a[84:87], v[120:123]
    s_waitcnt lgkmcnt(2)
    ds_read_b64_tr_b16 a[208:209], v58 offset:8192
    v_mfma_f32_16x16x32_bf16 v[116:119], a[200:203], a[64:67], 0
    s_waitcnt lgkmcnt(1)
    ds_read_b64_tr_b16 a[210:211], v58 offset:10240
    v_mfma_f32_16x16x32_bf16 v[116:119], a[204:207], a[68:71], v[116:119]
    ds_read_b64_tr_b16 a[212:213], v58 offset:12288
    v_mfma_f32_16x16x32_bf16 v[124:127], a[200:203], a[80:83], 0
    ds_read_b64_tr_b16 a[214:215], v58 offset:14336
    v_mfma_f32_16x16x32_bf16 v[124:127], a[204:207], a[84:87], v[124:127]
    s_waitcnt lgkmcnt(2)
    ds_read_b64_tr_b16 a[216:217], v59 offset:8192
    v_mfma_f32_16x16x32_bf16 v[112:115], a[208:211], a[72:75], v[112:115]
    s_waitcnt lgkmcnt(1)
    ds_read_b64_tr_b16 a[218:219], v59 offset:10240
    v_cvt_pk_bf16_f32 v96, v96, v97
    s_waitcnt vmcnt(0)
    v_cmp_ne_u32 vcc, 0, v3
    s_cmp_eq_u64 vcc, -1
    s_cbranch_scc0 L_C2_slow_13
L_C2_ok_14:
    v_mfma_f32_16x16x32_bf16 v[112:115], a[212:215], a[76:79], v[112:115]
    s_xor_b32 s74, s24, 8192
    ds_read_b64_tr_b16 a[220:221], v59 offset:12288
    v_cvt_pk_bf16_f32 v97, v98, v99
    v_mfma_f32_16x16x32_bf16 v[120:123], a[208:211], a[88:91], v[120:123]
    buffer_load_dwordx4 v[160:163], v1, s[8:11], s74 offen offset:0
    ds_read_b64_tr_b16 a[222:223], v59 offset:14336
    v_mfma_f32_16x16x32_bf16 v[120:123], a[212:215], a[92:95], v[120:123]
    s_waitcnt lgkmcnt(2)
    s_xor_b32 s74, s24, 12288
    ds_read_b64_tr_b16 a[224:225], v58 offset:16384
    v_cvt_pk_bf16_f32 v98, v100, v101
    v_mfma_f32_16x16x32_bf16 v[116:119], a[216:219], a[72:75], v[116:119]
    s_waitcnt lgkmcnt(1)
    ds_read_b64_tr_b16 a[226:227], v58 offset:18432
    v_cvt_pk_bf16_f32 v99, v102, v103
    v_mfma_f32_16x16x32_bf16 v[116:119], a[220:223], a[76:79], v[116:119]
    ds_read_b64_tr_b16 a[228:229], v58 offset:20480
    v_min_u32 v96, -2, v96
    v_mfma_f32_16x16x32_bf16 v[124:127], a[216:219], a[88:91], v[124:127]
    buffer_load_dwordx4 v[176:179], v1, s[8:11], s74 offen offset:0
    ds_read_b64_tr_b16 a[230:231], v58 offset:22528
    v_mfma_f32_16x16x32_bf16 v[124:127], a[220:223], a[92:95], v[124:127]
    s_waitcnt lgkmcnt(2)
    s_xor_b32 s74, s24, 8192
    ds_read_b64_tr_b16 a[232:233], v59 offset:16384
    v_min_u32 v97, -2, v97
    v_mfma_f32_16x16x32_bf16 v[112:115], a[224:227], a[96:99], v[112:115]
    s_waitcnt lgkmcnt(1)
    ds_read_b64_tr_b16 a[234:235], v59 offset:18432
    v_min_u32 v98, -2, v98
    v_mfma_f32_16x16x32_bf16 v[112:115], a[228:231], a[100:103], v[112:115]
    ds_read_b64_tr_b16 a[236:237], v59 offset:20480
    v_min_u32 v99, -2, v99
    v_mfma_f32_16x16x32_bf16 v[120:123], a[224:227], a[112:115], v[120:123]
    buffer_load_dwordx4 v[164:167], v1, s[8:11], s74 offen offset:1024
    ds_read_b64_tr_b16 a[238:239], v59 offset:22528
    v_mfma_f32_16x16x32_bf16 v[120:123], a[228:231], a[116:119], v[120:123]
    s_waitcnt lgkmcnt(2)
    s_xor_b32 s74, s24, 12288
    ds_read_b64_tr_b16 a[240:241], v58 offset:24576
    v_mfma_f32_16x16x32_bf16 v[116:119], a[232:235], a[96:99], v[116:119]
    s_waitcnt lgkmcnt(1)
    s_add_u32 s75, s18, 0
    ds_read_b64_tr_b16 a[242:243], v58 offset:26624
    v_mfma_f32_16x16x32_bf16 v[116:119], a[236:239], a[100:103], v[116:119]
    buffer_store_dwordx4 v[96:99], v23, s[8:11], s75 offen offset:512 sc0 sc1
    ds_read_b64_tr_b16 a[244:245], v58 offset:28672
    v_mfma_f32_16x16x32_bf16 v[124:127], a[232:235], a[112:115], v[124:127]
    buffer_load_dwordx4 v[180:183], v1, s[8:11], s74 offen offset:1024
    ds_read_b64_tr_b16 a[246:247], v58 offset:30720
    v_mfma_f32_16x16x32_bf16 v[124:127], a[236:239], a[116:119], v[124:127]
    s_waitcnt lgkmcnt(2)
    s_xor_b32 s74, s24, 8192
    ds_read_b64_tr_b16 a[248:249], v59 offset:24576
    v_cvt_pk_bf16_f32 v104, v104, v105
    v_mfma_f32_16x16x32_bf16 v[112:115], a[240:243], a[104:107], v[112:115]
    s_waitcnt lgkmcnt(1)
    ds_read_b64_tr_b16 a[250:251], v59 offset:26624
    v_cvt_pk_bf16_f32 v105, v106, v107
    v_mfma_f32_16x16x32_bf16 v[112:115], a[244:247], a[108:111], v[112:115]
    ds_read_b64_tr_b16 a[252:253], v59 offset:28672
    v_cvt_pk_bf16_f32 v106, v108, v109
    v_mfma_f32_16x16x32_bf16 v[120:123], a[240:243], a[120:123], v[120:123]
    buffer_load_dwordx4 v[168:171], v1, s[8:11], s74 offen offset:2048
    ds_read_b64_tr_b16 a[254:255], v59 offset:30720
    v_mfma_f32_16x16x32_bf16 v[120:123], a[244:247], a[124:127], v[120:123]
    s_waitcnt lgkmcnt(2)
    s_xor_b32 s74, s24, 12288
    ds_read_b64_tr_b16 a[192:193], v62 offset:32768
    v_cvt_pk_bf16_f32 v107, v110, v111
    v_mfma_f32_16x16x32_bf16 v[116:119], a[248:251], a[104:107], v[116:119]
    s_waitcnt lgkmcnt(1)
    ds_read_b64_tr_b16 a[194:195], v62 offset:34816
    v_min_u32 v104, -2, v104
    v_mfma_f32_16x16x32_bf16 v[116:119], a[252:255], a[108:111], v[116:119]
    ds_read_b64_tr_b16 a[196:197], v62 offset:36864
    v_min_u32 v105, -2, v105
    v_mfma_f32_16x16x32_bf16 v[124:127], a[248:251], a[120:123], v[124:127]
    buffer_load_dwordx4 v[184:187], v1, s[8:11], s74 offen offset:2048
    ds_read_b64_tr_b16 a[198:199], v62 offset:38912
    v_mfma_f32_16x16x32_bf16 v[124:127], a[252:255], a[124:127], v[124:127]
    s_waitcnt lgkmcnt(2)
    s_xor_b32 s74, s24, 8192
    ds_read_b64_tr_b16 a[200:201], v63 offset:32768
    v_min_u32 v106, -2, v106
    v_mfma_f32_16x16x32_bf16 v[112:115], a[192:195], a[0:3], v[112:115]
    s_waitcnt lgkmcnt(1)
    ds_read_b64_tr_b16 a[202:203], v63 offset:34816
    v_min_u32 v107, -2, v107
    v_mfma_f32_16x16x32_bf16 v[112:115], a[196:199], a[4:7], v[112:115]
    s_add_u32 s75, s18, 131072
    ds_read_b64_tr_b16 a[204:205], v63 offset:36864
    v_mfma_f32_16x16x32_bf16 v[120:123], a[192:195], a[16:19], v[120:123]
    buffer_load_dwordx4 v[172:175], v1, s[8:11], s74 offen offset:3072
    ds_read_b64_tr_b16 a[206:207], v63 offset:38912
    v_mfma_f32_16x16x32_bf16 v[120:123], a[196:199], a[20:23], v[120:123]
    s_waitcnt lgkmcnt(0)
    s_xor_b32 s74, s24, 12288
    ds_read_b64_tr_b16 a[208:209], v62 offset:40960
    v_mfma_f32_16x16x32_bf16 v[116:119], a[200:203], a[0:3], v[116:119]
    buffer_store_dwordx4 v[104:107], v23, s[8:11], s75 offen offset:512 sc0 sc1
    ds_read_b64_tr_b16 a[210:211], v62 offset:43008
    v_mfma_f32_16x16x32_bf16 v[116:119], a[204:207], a[4:7], v[116:119]
    ds_read_b64_tr_b16 a[212:213], v62 offset:45056
    v_mfma_f32_16x16x32_bf16 v[124:127], a[200:203], a[16:19], v[124:127]
    buffer_load_dwordx4 v[188:191], v1, s[8:11], s74 offen offset:3072
    ds_read_b64_tr_b16 a[214:215], v62 offset:47104
    v_mfma_f32_16x16x32_bf16 v[124:127], a[204:207], a[20:23], v[124:127]
    s_waitcnt lgkmcnt(2)
    ds_read_b64_tr_b16 a[216:217], v63 offset:40960
    v_mfma_f32_16x16x32_bf16 v[112:115], a[208:211], a[8:11], v[112:115]
    s_waitcnt lgkmcnt(1)
    ds_read_b64_tr_b16 a[218:219], v63 offset:43008
    ds_read_b64_tr_b16 a[192:193], v56 offset:32768
    v_mfma_f32_16x16x32_bf16 v[112:115], a[212:215], a[12:15], v[112:115]
    ds_read_b64_tr_b16 a[220:221], v63 offset:45056
    ds_read_b64_tr_b16 a[194:195], v56 offset:34816
    v_mfma_f32_16x16x32_bf16 v[120:123], a[208:211], a[24:27], v[120:123]
    ds_read_b64_tr_b16 a[222:223], v63 offset:47104
    ds_read_b64_tr_b16 a[196:197], v56 offset:36864
    v_mfma_f32_16x16x32_bf16 v[120:123], a[212:215], a[28:31], v[120:123]
    s_waitcnt lgkmcnt(5)
    ds_read_b64_tr_b16 a[224:225], v62 offset:49152
    ds_read_b64_tr_b16 a[198:199], v56 offset:38912
    v_mfma_f32_16x16x32_bf16 v[116:119], a[216:219], a[8:11], v[116:119]
    s_waitcnt lgkmcnt(3)
    ds_read_b64_tr_b16 a[226:227], v62 offset:51200
    ds_read_b64_tr_b16 a[200:201], v57 offset:32768
    v_mfma_f32_16x16x32_bf16 v[116:119], a[220:223], a[12:15], v[116:119]
    ds_read_b64_tr_b16 a[228:229], v62 offset:53248
    ds_read_b64_tr_b16 a[202:203], v57 offset:34816
    v_mfma_f32_16x16x32_bf16 v[124:127], a[216:219], a[24:27], v[124:127]
    ds_read_b64_tr_b16 a[230:231], v62 offset:55296
    ds_read_b64_tr_b16 a[204:205], v57 offset:36864
    v_mfma_f32_16x16x32_bf16 v[124:127], a[220:223], a[28:31], v[124:127]
    s_waitcnt lgkmcnt(5)
    ds_read_b64_tr_b16 a[232:233], v63 offset:49152
    ds_read_b64_tr_b16 a[206:207], v57 offset:38912
    v_mfma_f32_16x16x32_bf16 v[112:115], a[224:227], a[32:35], v[112:115]
    s_waitcnt lgkmcnt(3)
    ds_read_b64_tr_b16 a[234:235], v63 offset:51200
    v_mfma_f32_16x16x32_bf16 v[112:115], a[228:231], a[36:39], v[112:115]
    ds_read_b64_tr_b16 a[236:237], v63 offset:53248
    v_mfma_f32_16x16x32_bf16 v[120:123], a[224:227], a[48:51], v[120:123]
    ds_read_b64_tr_b16 a[238:239], v63 offset:55296
    v_mfma_f32_16x16x32_bf16 v[120:123], a[228:231], a[52:55], v[120:123]
    s_waitcnt lgkmcnt(2)
    ds_read_b64_tr_b16 a[240:241], v62 offset:57344
    v_mfma_f32_16x16x32_bf16 v[116:119], a[232:235], a[32:35], v[116:119]
    s_waitcnt lgkmcnt(1)
    ds_read_b64_tr_b16 a[242:243], v62 offset:59392
    v_mfma_f32_16x16x32_bf16 v[116:119], a[236:239], a[36:39], v[116:119]
    ds_read_b64_tr_b16 a[244:245], v62 offset:61440
    v_mfma_f32_16x16x32_bf16 v[124:127], a[232:235], a[48:51], v[124:127]
    ds_read_b64_tr_b16 a[246:247], v62 offset:63488
    v_mfma_f32_16x16x32_bf16 v[124:127], a[236:239], a[52:55], v[124:127]
    s_waitcnt lgkmcnt(2)
    ds_read_b64_tr_b16 a[248:249], v63 offset:57344
    v_mfma_f32_16x16x32_bf16 v[112:115], a[240:243], a[40:43], v[112:115]
    s_waitcnt lgkmcnt(1)
    ds_read_b64_tr_b16 a[250:251], v63 offset:59392
    v_mfma_f32_16x16x32_bf16 v[112:115], a[244:247], a[44:47], v[112:115]
    ds_read_b64_tr_b16 a[252:253], v63 offset:61440
    v_mfma_f32_16x16x32_bf16 v[120:123], a[240:243], a[56:59], v[120:123]
    s_waitcnt lgkmcnt(1)
    s_xor_b32 s74, s24, 16384
    ds_read_b64_tr_b16 a[254:255], v63 offset:63488
    v_mfma_f32_16x16x32_bf16 v[120:123], a[244:247], a[60:63], v[120:123]
    buffer_load_dwordx4 v[192:195], v1, s[8:11], s74 offen offset:0
    v_mfma_f32_16x16x32_bf16 v[116:119], a[248:251], a[40:43], v[116:119]
    s_waitcnt lgkmcnt(0)
    s_xor_b32 s74, s24, 20480
    ds_read_b64_tr_b16 a[208:209], v56 offset:40960
    v_mfma_f32_16x16x32_bf16 v[116:119], a[252:255], a[44:47], v[116:119]
    ds_read_b64_tr_b16 a[210:211], v56 offset:43008
    v_mfma_f32_16x16x32_bf16 v[124:127], a[248:251], a[56:59], v[124:127]
    ds_read_b64_tr_b16 a[212:213], v56 offset:45056
    v_mfma_f32_16x16x32_bf16 v[124:127], a[252:255], a[60:63], v[124:127]
    ds_read_b64_tr_b16 a[214:215], v56 offset:47104
    v_mfma_f32_16x16x32_bf16 v[64:67], a[192:195], v[128:131], 0
    buffer_load_dwordx4 v[208:211], v1, s[8:11], s74 offen offset:0
    v_mfma_f32_16x16x32_bf16 v[64:67], a[196:199], v[132:135], v[64:67]
    s_xor_b32 s74, s24, 16384
    ds_read_b64_tr_b16 a[216:217], v57 offset:40960
    v_mfma_f32_16x16x32_bf16 v[72:75], a[192:195], v[144:147], 0
    ds_read_b64_tr_b16 a[218:219], v57 offset:43008
    v_mfma_f32_16x16x32_bf16 v[72:75], a[196:199], v[148:151], v[72:75]
    ds_read_b64_tr_b16 a[220:221], v57 offset:45056
    v_mfma_f32_16x16x32_bf16 v[68:71], a[200:203], v[128:131], 0
    ds_read_b64_tr_b16 a[222:223], v57 offset:47104
    v_mfma_f32_16x16x32_bf16 v[68:71], a[204:207], v[132:135], v[68:71]
    buffer_load_dwordx4 v[196:199], v1, s[8:11], s74 offen offset:1024
    v_mfma_f32_16x16x32_bf16 v[76:79], a[200:203], v[144:147], 0
    s_xor_b32 s74, s24, 20480
    ds_read_b64_tr_b16 a[224:225], v56 offset:49152
    v_cvt_pk_bf16_f32 v112, v112, v113
    v_mfma_f32_16x16x32_bf16 v[76:79], a[204:207], v[148:151], v[76:79]
    s_waitcnt lgkmcnt(7)
    ds_read_b64_tr_b16 a[226:227], v56 offset:51200
    v_cvt_pk_bf16_f32 v113, v114, v115
    v_mfma_f32_16x16x32_bf16 v[64:67], a[208:211], v[136:139], v[64:67]
    s_waitcnt lgkmcnt(6)
    ds_read_b64_tr_b16 a[228:229], v56 offset:53248
    v_cvt_pk_bf16_f32 v114, v116, v117
    v_mfma_f32_16x16x32_bf16 v[64:67], a[212:215], v[140:143], v[64:67]
    ds_read_b64_tr_b16 a[230:231], v56 offset:55296
    v_cvt_pk_bf16_f32 v115, v118, v119
    v_mfma_f32_16x16x32_bf16 v[72:75], a[208:211], v[152:155], v[72:75]
    buffer_load_dwordx4 v[212:215], v1, s[8:11], s74 offen offset:1024
    v_mfma_f32_16x16x32_bf16 v[72:75], a[212:215], v[156:159], v[72:75]
    s_waitcnt lgkmcnt(6)
    s_xor_b32 s74, s24, 16384
    ds_read_b64_tr_b16 a[232:233], v57 offset:49152
    v_min_u32 v112, -2, v112
    v_mfma_f32_16x16x32_bf16 v[68:71], a[216:219], v[136:139], v[68:71]
    s_waitcnt lgkmcnt(5)
    ds_read_b64_tr_b16 a[234:235], v57 offset:51200
    v_min_u32 v113, -2, v113
    v_mfma_f32_16x16x32_bf16 v[68:71], a[220:223], v[140:143], v[68:71]
    ds_read_b64_tr_b16 a[236:237], v57 offset:53248
    v_min_u32 v114, -2, v114
    v_mfma_f32_16x16x32_bf16 v[76:79], a[216:219], v[152:155], v[76:79]
    s_waitcnt vmcnt(13) lgkmcnt(5)
    ds_read_b64_tr_b16 a[238:239], v57 offset:55296
    v_min_u32 v115, -2, v115
    v_mfma_f32_16x16x32_bf16 v[76:79], a[220:223], v[156:159], v[76:79]
    buffer_load_dwordx4 v[200:203], v1, s[8:11], s74 offen offset:2048
    v_mfma_f32_16x16x32_bf16 v[64:67], a[224:227], v[160:163], v[64:67]
    s_waitcnt vmcnt(12) lgkmcnt(4)
    s_xor_b32 s74, s24, 20480
    ds_read_b64_tr_b16 a[240:241], v56 offset:57344
    v_mfma_f32_16x16x32_bf16 v[64:67], a[228:231], v[164:167], v[64:67]
    s_waitcnt vmcnt(10)
    s_add_u32 s75, s18, 0
    ds_read_b64_tr_b16 a[242:243], v56 offset:59392
    v_mfma_f32_16x16x32_bf16 v[72:75], a[224:227], v[176:179], v[72:75]
    buffer_store_dwordx4 v[112:115], v23, s[8:11], s75 offen offset:768 sc0 sc1
    v_mfma_f32_16x16x32_bf16 v[72:75], a[228:231], v[180:183], v[72:75]
    s_waitcnt lgkmcnt(2)
    ds_read_b64_tr_b16 a[244:245], v56 offset:61440
    v_cvt_pk_bf16_f32 v120, v120, v121
    v_mfma_f32_16x16x32_bf16 v[68:71], a[232:235], v[160:163], v[68:71]
    buffer_load_dwordx4 v[216:219], v1, s[8:11], s74 offen offset:2048
    ds_read_b64_tr_b16 a[246:247], v56 offset:63488
    v_mfma_f32_16x16x32_bf16 v[68:71], a[236:239], v[164:167], v[68:71]
    s_xor_b32 s74, s24, 16384
    ds_read_b64_tr_b16 a[248:249], v57 offset:57344
    v_cvt_pk_bf16_f32 v121, v122, v123
    v_mfma_f32_16x16x32_bf16 v[76:79], a[232:235], v[176:179], v[76:79]
    ds_read_b64_tr_b16 a[250:251], v57 offset:59392
    v_cvt_pk_bf16_f32 v122, v124, v125
    v_mfma_f32_16x16x32_bf16 v[76:79], a[236:239], v[180:183], v[76:79]
    s_waitcnt vmcnt(11) lgkmcnt(4)
    ds_read_b64_tr_b16 a[252:253], v57 offset:61440
    v_cvt_pk_bf16_f32 v123, v126, v127
    v_mfma_f32_16x16x32_bf16 v[64:67], a[240:243], v[168:171], v[64:67]
    s_waitcnt vmcnt(9) lgkmcnt(3)
    ds_read_b64_tr_b16 a[254:255], v57 offset:63488
    v_min_u32 v120, -2, v120
    v_mfma_f32_16x16x32_bf16 v[64:67], a[244:247], v[172:175], v[64:67]
    buffer_load_dwordx4 v[204:207], v1, s[8:11], s74 offen offset:3072
    v_mfma_f32_16x16x32_bf16 v[72:75], a[240:243], v[184:187], v[72:75]
    s_waitcnt vmcnt(8)
    s_xor_b32 s74, s24, 20480
    ds_read_b64_tr_b16 a[192:193], v58 offset:32768
    v_min_u32 v121, -2, v121
    v_mfma_f32_16x16x32_bf16 v[72:75], a[244:247], v[188:191], v[72:75]
    s_waitcnt lgkmcnt(3)
    ds_read_b64_tr_b16 a[194:195], v58 offset:34816
    v_min_u32 v122, -2, v122
    v_mfma_f32_16x16x32_bf16 v[68:71], a[248:251], v[168:171], v[68:71]
    s_waitcnt lgkmcnt(2)
    ds_read_b64_tr_b16 a[196:197], v58 offset:36864
    v_min_u32 v123, -2, v123
    v_mfma_f32_16x16x32_bf16 v[68:71], a[252:255], v[172:175], v[68:71]
    s_add_u32 s75, s18, 131072
    ds_read_b64_tr_b16 a[198:199], v58 offset:38912
    v_mfma_f32_16x16x32_bf16 v[76:79], a[248:251], v[184:187], v[76:79]
    buffer_load_dwordx4 v[220:223], v1, s[8:11], s74 offen offset:3072
    ds_read_b64_tr_b16 a[200:201], v59 offset:32768
    v_mfma_f32_16x16x32_bf16 v[76:79], a[252:255], v[188:191], v[76:79]
    s_waitcnt lgkmcnt(1)
    s_xor_b32 s74, s24, 24576
    ds_read_b64_tr_b16 a[202:203], v59 offset:34816
    v_mfma_f32_16x16x32_bf16 v[80:83], a[192:195], v[128:131], 0
    buffer_store_dwordx4 v[120:123], v23, s[8:11], s75 offen offset:768 sc0 sc1
    ds_read_b64_tr_b16 a[204:205], v59 offset:36864
    v_mfma_f32_16x16x32_bf16 v[80:83], a[196:199], v[132:135], v[80:83]
    ds_read_b64_tr_b16 a[206:207], v59 offset:38912
    v_mfma_f32_16x16x32_bf16 v[88:91], a[192:195], v[144:147], 0
    s_waitcnt lgkmcnt(2)
    ds_read_b64_tr_b16 a[208:209], v58 offset:40960
    v_mfma_f32_16x16x32_bf16 v[88:91], a[196:199], v[148:151], v[88:91]
    buffer_load_dwordx4 v[224:227], v1, s[8:11], s74 offen offset:0
    ds_read_b64_tr_b16 a[210:211], v58 offset:43008
    v_mfma_f32_16x16x32_bf16 v[84:87], a[200:203], v[128:131], 0
    s_waitcnt lgkmcnt(2)
    s_xor_b32 s74, s24, 28672
    ds_read_b64_tr_b16 a[212:213], v58 offset:45056
    v_mfma_f32_16x16x32_bf16 v[84:87], a[204:207], v[132:135], v[84:87]
    ds_read_b64_tr_b16 a[214:215], v58 offset:47104
    v_mfma_f32_16x16x32_bf16 v[92:95], a[200:203], v[144:147], 0
    ds_read_b64_tr_b16 a[216:217], v59 offset:40960
    v_mfma_f32_16x16x32_bf16 v[92:95], a[204:207], v[148:151], v[92:95]
    s_waitcnt lgkmcnt(1)
    ds_read_b64_tr_b16 a[218:219], v59 offset:43008
    v_mfma_f32_16x16x32_bf16 v[80:83], a[208:211], v[136:139], v[80:83]
    buffer_load_dwordx4 v[240:243], v1, s[8:11], s74 offen offset:0
    ds_read_b64_tr_b16 a[220:221], v59 offset:45056
    v_mfma_f32_16x16x32_bf16 v[80:83], a[212:215], v[140:143], v[80:83]
    s_xor_b32 s74, s24, 24576
    ds_read_b64_tr_b16 a[222:223], v59 offset:47104
    v_mfma_f32_16x16x32_bf16 v[88:91], a[208:211], v[152:155], v[88:91]
    ds_read_b64_tr_b16 a[224:225], v58 offset:49152
    v_mfma_f32_16x16x32_bf16 v[88:91], a[212:215], v[156:159], v[88:91]
    s_waitcnt lgkmcnt(3)
    ds_read_b64_tr_b16 a[226:227], v58 offset:51200
    v_mfma_f32_16x16x32_bf16 v[84:87], a[216:219], v[136:139], v[84:87]
    s_waitcnt lgkmcnt(2)
    ds_read_b64_tr_b16 a[228:229], v58 offset:53248
    v_mfma_f32_16x16x32_bf16 v[84:87], a[220:223], v[140:143], v[84:87]
    buffer_load_dwordx4 v[228:231], v1, s[8:11], s74 offen offset:1024
    ds_read_b64_tr_b16 a[230:231], v58 offset:55296
    v_mfma_f32_16x16x32_bf16 v[92:95], a[216:219], v[152:155], v[92:95]
    s_xor_b32 s74, s24, 28672
    ds_read_b64_tr_b16 a[232:233], v59 offset:49152
    v_mfma_f32_16x16x32_bf16 v[92:95], a[220:223], v[156:159], v[92:95]
    s_waitcnt lgkmcnt(3)
    ds_read_b64_tr_b16 a[234:235], v59 offset:51200
    v_mfma_f32_16x16x32_bf16 v[80:83], a[224:227], v[160:163], v[80:83]
    s_waitcnt lgkmcnt(2)
    ds_read_b64_tr_b16 a[236:237], v59 offset:53248
    v_mfma_f32_16x16x32_bf16 v[80:83], a[228:231], v[164:167], v[80:83]
    ds_read_b64_tr_b16 a[238:239], v59 offset:55296
    v_mfma_f32_16x16x32_bf16 v[88:91], a[224:227], v[176:179], v[88:91]
    buffer_load_dwordx4 v[244:247], v1, s[8:11], s74 offen offset:1024
    v_mfma_f32_16x16x32_bf16 v[88:91], a[228:231], v[180:183], v[88:91]
    s_waitcnt lgkmcnt(2)
    s_xor_b32 s74, s24, 24576
    ds_read_b64_tr_b16 a[240:241], v58 offset:57344
    v_mfma_f32_16x16x32_bf16 v[84:87], a[232:235], v[160:163], v[84:87]
    s_waitcnt lgkmcnt(1)
    ds_read_b64_tr_b16 a[242:243], v58 offset:59392
    v_mfma_f32_16x16x32_bf16 v[84:87], a[236:239], v[164:167], v[84:87]
    ds_read_b64_tr_b16 a[244:245], v58 offset:61440
    v_mfma_f32_16x16x32_bf16 v[92:95], a[232:235], v[176:179], v[92:95]
    s_waitcnt lgkmcnt(1)
    ds_read_b64_tr_b16 a[246:247], v58 offset:63488
    v_mfma_f32_16x16x32_bf16 v[92:95], a[236:239], v[180:183], v[92:95]
    buffer_load_dwordx4 v[232:235], v1, s[8:11], s74 offen offset:2048
    ds_read_b64_tr_b16 a[248:249], v59 offset:57344
    v_mfma_f32_16x16x32_bf16 v[80:83], a[240:243], v[168:171], v[80:83]
    s_waitcnt lgkmcnt(1)
    s_xor_b32 s74, s24, 28672
    ds_read_b64_tr_b16 a[250:251], v59 offset:59392
    v_mfma_f32_16x16x32_bf16 v[80:83], a[244:247], v[172:175], v[80:83]
    ds_read_b64_tr_b16 a[252:253], v59 offset:61440
    ds_read_b64_tr_b16 a[224:225], v56 offset:16384
    v_mfma_f32_16x16x32_bf16 v[88:91], a[240:243], v[184:187], v[88:91]
    ds_read_b64_tr_b16 a[254:255], v59 offset:63488
    ds_read_b64_tr_b16 a[226:227], v56 offset:18432
    v_mfma_f32_16x16x32_bf16 v[88:91], a[244:247], v[188:191], v[88:91]
    s_waitcnt lgkmcnt(1)
    ds_read_b64_tr_b16 a[192:193], v56 offset:0
    ds_read_b64_tr_b16 a[228:229], v56 offset:20480
    v_mfma_f32_16x16x32_bf16 v[84:87], a[248:251], v[168:171], v[84:87]
    buffer_load_dwordx4 v[248:251], v1, s[8:11], s74 offen offset:2048
    ds_read_b64_tr_b16 a[194:195], v56 offset:2048
    v_mfma_f32_16x16x32_bf16 v[84:87], a[252:255], v[172:175], v[84:87]
    s_xor_b32 s74, s24, 24576
    ds_read_b64_tr_b16 a[196:197], v56 offset:4096
    v_mfma_f32_16x16x32_bf16 v[92:95], a[248:251], v[184:187], v[92:95]
    ds_read_b64_tr_b16 a[198:199], v56 offset:6144
    ds_read_b64_tr_b16 a[230:231], v56 offset:22528
    v_mfma_f32_16x16x32_bf16 v[92:95], a[252:255], v[188:191], v[92:95]
    s_waitcnt lgkmcnt(3)
    ds_read_b64_tr_b16 a[200:201], v57 offset:0
    ds_read_b64_tr_b16 a[232:233], v57 offset:16384
    v_mfma_f32_16x16x32_bf16 v[96:99], a[192:195], v[128:131], 0
    s_waitcnt lgkmcnt(3)
    ds_read_b64_tr_b16 a[202:203], v57 offset:2048
    ds_read_b64_tr_b16 a[234:235], v57 offset:18432
    v_mfma_f32_16x16x32_bf16 v[96:99], a[196:199], v[132:135], v[96:99]
    buffer_load_dwordx4 v[236:239], v1, s[8:11], s74 offen offset:3072
    ds_read_b64_tr_b16 a[204:205], v57 offset:4096
    v_mfma_f32_16x16x32_bf16 v[104:107], a[192:195], v[144:147], 0
    s_xor_b32 s74, s24, 28672
    ds_read_b64_tr_b16 a[206:207], v57 offset:6144
    v_mfma_f32_16x16x32_bf16 v[104:107], a[196:199], v[148:151], v[104:107]
    s_waitcnt lgkmcnt(3)
    ds_read_b64_tr_b16 a[208:209], v56 offset:8192
    ds_read_b64_tr_b16 a[236:237], v57 offset:20480
    v_mfma_f32_16x16x32_bf16 v[100:103], a[200:203], v[128:131], 0
    s_waitcnt lgkmcnt(2)
    ds_read_b64_tr_b16 a[210:211], v56 offset:10240
    ds_read_b64_tr_b16 a[238:239], v57 offset:22528
    v_mfma_f32_16x16x32_bf16 v[100:103], a[204:207], v[132:135], v[100:103]
    s_waitcnt lgkmcnt(1)
    ds_read_b64_tr_b16 a[212:213], v56 offset:12288
    v_mfma_f32_16x16x32_bf16 v[108:111], a[200:203], v[144:147], 0
    buffer_load_dwordx4 v[252:255], v1, s[8:11], s74 offen offset:3072
    ds_read_b64_tr_b16 a[214:215], v56 offset:14336
    v_mfma_f32_16x16x32_bf16 v[108:111], a[204:207], v[148:151], v[108:111]
    buffer_load_dwordx2 v[32:33], v45, s[32:35], s100 offen
    ds_read_b64_tr_b16 a[216:217], v57 offset:8192
    v_mfma_f32_16x16x32_bf16 v[96:99], a[208:211], v[136:139], v[96:99]
    s_waitcnt lgkmcnt(1)
    ds_read_b64_tr_b16 a[218:219], v57 offset:10240
    v_mfma_f32_16x16x32_bf16 v[96:99], a[212:215], v[140:143], v[96:99]
    ds_read_b64_tr_b16 a[220:221], v57 offset:12288
    v_mfma_f32_16x16x32_bf16 v[104:107], a[208:211], v[152:155], v[104:107]
    s_waitcnt lgkmcnt(1)
    ds_read_b64_tr_b16 a[222:223], v57 offset:14336
    v_mfma_f32_16x16x32_bf16 v[104:107], a[212:215], v[156:159], v[104:107]
    buffer_load_dwordx2 v[34:35], v45, s[32:35], s100 offen offset:32
    v_mfma_f32_16x16x32_bf16 v[100:103], a[216:219], v[136:139], v[100:103]
    s_waitcnt lgkmcnt(0)
    ds_read_b64_tr_b16 a[240:241], v56 offset:24576
    v_mfma_f32_16x16x32_bf16 v[100:103], a[220:223], v[140:143], v[100:103]
    ds_read_b64_tr_b16 a[242:243], v56 offset:26624
    v_mfma_f32_16x16x32_bf16 v[108:111], a[216:219], v[152:155], v[108:111]
    ds_read_b64_tr_b16 a[244:245], v56 offset:28672
    v_mfma_f32_16x16x32_bf16 v[108:111], a[220:223], v[156:159], v[108:111]
    buffer_load_dwordx2 v[36:37], v45, s[32:35], s101 offen
    v_mfma_f32_16x16x32_bf16 v[96:99], a[224:227], v[160:163], v[96:99]
    ds_read_b64_tr_b16 a[246:247], v56 offset:30720
    v_mfma_f32_16x16x32_bf16 v[96:99], a[228:231], v[164:167], v[96:99]
    ds_read_b64_tr_b16 a[248:249], v57 offset:24576
    v_mfma_f32_16x16x32_bf16 v[104:107], a[224:227], v[176:179], v[104:107]
    ds_read_b64_tr_b16 a[250:251], v57 offset:26624
    v_mfma_f32_16x16x32_bf16 v[104:107], a[228:231], v[180:183], v[104:107]
    buffer_load_dwordx2 v[38:39], v45, s[32:35], s101 offen offset:32
    ds_read_b64_tr_b16 a[252:253], v57 offset:28672
    v_mfma_f32_16x16x32_bf16 v[100:103], a[232:235], v[160:163], v[100:103]
    ds_read_b64_tr_b16 a[254:255], v57 offset:30720
    v_mfma_f32_16x16x32_bf16 v[100:103], a[236:239], v[164:167], v[100:103]
    ds_read_b64_tr_b16 a[192:193], v58 offset:0
    v_mfma_f32_16x16x32_bf16 v[108:111], a[232:235], v[176:179], v[108:111]
    s_waitcnt lgkmcnt(7)
    ds_read_b64_tr_b16 a[194:195], v58 offset:2048
    v_mfma_f32_16x16x32_bf16 v[108:111], a[236:239], v[180:183], v[108:111]
    buffer_load_dwordx2 v[40:41], v45, s[56:59], 0 offen
    v_mfma_f32_16x16x32_bf16 v[96:99], a[240:243], v[168:171], v[96:99]
    s_waitcnt lgkmcnt(6)
    ds_read_b64_tr_b16 a[196:197], v58 offset:4096
    v_mfma_f32_16x16x32_bf16 v[96:99], a[244:247], v[172:175], v[96:99]
    ds_read_b64_tr_b16 a[198:199], v58 offset:6144
    v_mfma_f32_16x16x32_bf16 v[104:107], a[240:243], v[184:187], v[104:107]
    s_waitcnt lgkmcnt(6)
    ds_read_b64_tr_b16 a[200:201], v59 offset:0
    v_mfma_f32_16x16x32_bf16 v[104:107], a[244:247], v[188:191], v[104:107]
    buffer_load_dwordx2 v[42:43], v45, s[56:59], 0 offen offset:32
    ds_read_b64_tr_b16 a[202:203], v59 offset:2048
    v_mfma_f32_16x16x32_bf16 v[100:103], a[248:251], v[168:171], v[100:103]
    s_waitcnt lgkmcnt(6)
    ds_read_b64_tr_b16 a[204:205], v59 offset:4096
    v_mfma_f32_16x16x32_bf16 v[100:103], a[252:255], v[172:175], v[100:103]
    ds_read_b64_tr_b16 a[206:207], v59 offset:6144
    v_mfma_f32_16x16x32_bf16 v[108:111], a[248:251], v[184:187], v[108:111]
    ds_read_b64_tr_b16 a[208:209], v58 offset:8192
    v_mfma_f32_16x16x32_bf16 v[108:111], a[252:255], v[188:191], v[108:111]
    s_waitcnt lgkmcnt(7)
    ds_read_b64_tr_b16 a[210:211], v58 offset:10240
    v_mfma_f32_16x16x32_bf16 v[112:115], a[192:195], v[128:131], 0
    s_waitcnt lgkmcnt(6)
    ds_read_b64_tr_b16 a[212:213], v58 offset:12288
    v_mfma_f32_16x16x32_bf16 v[112:115], a[196:199], v[132:135], v[112:115]
    ds_read_b64_tr_b16 a[214:215], v58 offset:14336
    v_mfma_f32_16x16x32_bf16 v[120:123], a[192:195], v[144:147], 0
    ds_read_b64_tr_b16 a[216:217], v59 offset:8192
    v_mfma_f32_16x16x32_bf16 v[120:123], a[196:199], v[148:151], v[120:123]
    s_waitcnt lgkmcnt(7)
    ds_read_b64_tr_b16 a[218:219], v59 offset:10240
    v_mfma_f32_16x16x32_bf16 v[116:119], a[200:203], v[128:131], 0
    s_waitcnt lgkmcnt(6)
    ds_read_b64_tr_b16 a[220:221], v59 offset:12288
    v_mfma_f32_16x16x32_bf16 v[116:119], a[204:207], v[132:135], v[116:119]
    ds_read_b64_tr_b16 a[222:223], v59 offset:14336
    v_mfma_f32_16x16x32_bf16 v[124:127], a[200:203], v[144:147], 0
    ds_read_b64_tr_b16 a[224:225], v58 offset:16384
    v_mfma_f32_16x16x32_bf16 v[124:127], a[204:207], v[148:151], v[124:127]
    s_waitcnt lgkmcnt(7)
    ds_read_b64_tr_b16 a[226:227], v58 offset:18432
    v_mfma_f32_16x16x32_bf16 v[112:115], a[208:211], v[136:139], v[112:115]
    s_waitcnt lgkmcnt(6)
    ds_read_b64_tr_b16 a[228:229], v58 offset:20480
    v_mfma_f32_16x16x32_bf16 v[112:115], a[212:215], v[140:143], v[112:115]
    ds_read_b64_tr_b16 a[230:231], v58 offset:22528
    v_mfma_f32_16x16x32_bf16 v[120:123], a[208:211], v[152:155], v[120:123]
    ds_read_b64_tr_b16 a[232:233], v59 offset:16384
    v_mfma_f32_16x16x32_bf16 v[120:123], a[212:215], v[156:159], v[120:123]
    s_waitcnt lgkmcnt(7)
    ds_read_b64_tr_b16 a[234:235], v59 offset:18432
    v_mfma_f32_16x16x32_bf16 v[116:119], a[216:219], v[136:139], v[116:119]
    s_waitcnt lgkmcnt(6)
    ds_read_b64_tr_b16 a[236:237], v59 offset:20480
    v_mfma_f32_16x16x32_bf16 v[116:119], a[220:223], v[140:143], v[116:119]
    ds_read_b64_tr_b16 a[238:239], v59 offset:22528
    v_mfma_f32_16x16x32_bf16 v[124:127], a[216:219], v[152:155], v[124:127]
    ds_read_b64_tr_b16 a[240:241], v58 offset:24576
    v_mfma_f32_16x16x32_bf16 v[124:127], a[220:223], v[156:159], v[124:127]
    s_waitcnt lgkmcnt(7)
    ds_read_b64_tr_b16 a[242:243], v58 offset:26624
    v_mfma_f32_16x16x32_bf16 v[112:115], a[224:227], v[160:163], v[112:115]
    s_waitcnt lgkmcnt(6)
    ds_read_b64_tr_b16 a[244:245], v58 offset:28672
    v_mfma_f32_16x16x32_bf16 v[112:115], a[228:231], v[164:167], v[112:115]
    ds_read_b64_tr_b16 a[246:247], v58 offset:30720
    v_mfma_f32_16x16x32_bf16 v[120:123], a[224:227], v[176:179], v[120:123]
    ds_read_b64_tr_b16 a[248:249], v59 offset:24576
    v_mfma_f32_16x16x32_bf16 v[120:123], a[228:231], v[180:183], v[120:123]
    s_waitcnt lgkmcnt(7)
    ds_read_b64_tr_b16 a[250:251], v59 offset:26624
    v_mfma_f32_16x16x32_bf16 v[116:119], a[232:235], v[160:163], v[116:119]
    s_waitcnt lgkmcnt(6)
    ds_read_b64_tr_b16 a[252:253], v59 offset:28672
    v_mfma_f32_16x16x32_bf16 v[116:119], a[236:239], v[164:167], v[116:119]
    ds_read_b64_tr_b16 a[254:255], v59 offset:30720
    v_mfma_f32_16x16x32_bf16 v[124:127], a[232:235], v[176:179], v[124:127]
    ds_read_b64_tr_b16 a[192:193], v60 offset:0
    v_mfma_f32_16x16x32_bf16 v[124:127], a[236:239], v[180:183], v[124:127]
    s_waitcnt lgkmcnt(7)
    ds_read_b64_tr_b16 a[194:195], v60 offset:2048
    v_mfma_f32_16x16x32_bf16 v[112:115], a[240:243], v[168:171], v[112:115]
    s_waitcnt lgkmcnt(6)
    ds_read_b64_tr_b16 a[196:197], v60 offset:4096
    v_mfma_f32_16x16x32_bf16 v[112:115], a[244:247], v[172:175], v[112:115]
    ds_read_b64_tr_b16 a[198:199], v60 offset:6144
    v_mfma_f32_16x16x32_bf16 v[120:123], a[240:243], v[184:187], v[120:123]
    ds_read_b64_tr_b16 a[200:201], v61 offset:0
    v_mfma_f32_16x16x32_bf16 v[120:123], a[244:247], v[188:191], v[120:123]
    s_waitcnt lgkmcnt(7)
    ds_read_b64_tr_b16 a[202:203], v61 offset:2048
    v_mfma_f32_16x16x32_bf16 v[116:119], a[248:251], v[168:171], v[116:119]
    s_waitcnt lgkmcnt(6)
    ds_read_b64_tr_b16 a[204:205], v61 offset:4096
    v_mfma_f32_16x16x32_bf16 v[116:119], a[252:255], v[172:175], v[116:119]
    ds_read_b64_tr_b16 a[206:207], v61 offset:6144
    v_mfma_f32_16x16x32_bf16 v[124:127], a[248:251], v[184:187], v[124:127]
    ds_read_b64_tr_b16 a[208:209], v60 offset:8192
    v_mfma_f32_16x16x32_bf16 v[124:127], a[252:255], v[188:191], v[124:127]
    s_waitcnt vmcnt(23) lgkmcnt(7)
    ds_read_b64_tr_b16 a[210:211], v60 offset:10240
    v_mfma_f32_16x16x32_bf16 v[64:67], a[192:195], v[192:195], v[64:67]
    s_waitcnt vmcnt(21) lgkmcnt(6)
    ds_read_b64_tr_b16 a[212:213], v60 offset:12288
    v_mfma_f32_16x16x32_bf16 v[64:67], a[196:199], v[196:199], v[64:67]
    ds_read_b64_tr_b16 a[214:215], v60 offset:14336
    v_mfma_f32_16x16x32_bf16 v[72:75], a[192:195], v[208:211], v[72:75]
    s_waitcnt vmcnt(20) lgkmcnt(6)
    s_mov_b32 s74, 8192
    ds_read_b64_tr_b16 a[216:217], v61 offset:8192
    v_mfma_f32_16x16x32_bf16 v[72:75], a[196:199], v[212:215], v[72:75]
    buffer_load_dwordx4 v[168:171], v46, s[8:11], s74 offen
    ds_read_b64_tr_b16 a[218:219], v61 offset:10240
    v_mfma_f32_16x16x32_bf16 v[68:71], a[200:203], v[192:195], v[68:71]
    s_waitcnt lgkmcnt(6)
    ds_read_b64_tr_b16 a[220:221], v61 offset:12288
    s_waitcnt vmcnt(2)
    v_lshlrev_b32 v48, 16, v40
    v_mfma_f32_16x16x32_bf16 v[68:71], a[204:207], v[196:199], v[68:71]
    ds_read_b64_tr_b16 a[222:223], v61 offset:14336
    v_and_b32 v49, 0xffff0000, v40
    v_mfma_f32_16x16x32_bf16 v[76:79], a[200:203], v[208:211], v[76:79]
    buffer_load_dwordx4 v[172:175], v46, s[8:11], s74 offen offset:64
    v_mfma_f32_16x16x32_bf16 v[76:79], a[204:207], v[212:215], v[76:79]
    s_waitcnt lgkmcnt(6)
    s_mov_b32 s74, 6144
    ds_read_b64_tr_b16 a[224:225], v60 offset:16384
    v_lshlrev_b32 v50, 16, v41
    v_mfma_f32_16x16x32_bf16 v[64:67], a[208:211], v[200:203], v[64:67]
    s_waitcnt lgkmcnt(5)
    ds_read_b64_tr_b16 a[226:227], v60 offset:18432
    v_and_b32 v51, 0xffff0000, v41
    v_mfma_f32_16x16x32_bf16 v[64:67], a[212:215], v[204:207], v[64:67]
    buffer_load_dwordx4 v[176:179], v46, s[8:11], s74 offen
    v_mfma_f32_16x16x32_bf16 v[72:75], a[208:211], v[216:219], v[72:75]
    ds_read_b64_tr_b16 a[228:229], v60 offset:20480
    s_waitcnt vmcnt(3)
    v_lshlrev_b32 v52, 16, v42
    v_mfma_f32_16x16x32_bf16 v[72:75], a[212:215], v[220:223], v[72:75]
    s_waitcnt lgkmcnt(3)
    ds_read_b64_tr_b16 a[230:231], v60 offset:22528
    v_and_b32 v53, 0xffff0000, v42
    v_mfma_f32_16x16x32_bf16 v[68:71], a[216:219], v[200:203], v[68:71]
    buffer_load_dwordx4 v[180:183], v46, s[8:11], s74 offen offset:64
    ds_read_b64_tr_b16 a[232:233], v61 offset:16384
    v_mfma_f32_16x16x32_bf16 v[68:71], a[220:223], v[204:207], v[68:71]
    s_mov_b32 s74, 4096
    ds_read_b64_tr_b16 a[234:235], v61 offset:18432
    v_lshlrev_b32 v54, 16, v43
    v_mfma_f32_16x16x32_bf16 v[76:79], a[216:219], v[216:219], v[76:79]
    s_waitcnt lgkmcnt(4)
    ds_read_b64_tr_b16 a[236:237], v61 offset:20480
    v_and_b32 v55, 0xffff0000, v43
    v_mfma_f32_16x16x32_bf16 v[76:79], a[220:223], v[220:223], v[76:79]
    buffer_load_dwordx4 v[160:163], v46, s[8:11], s74 offen
    ds_read_b64_tr_b16 a[238:239], v61 offset:22528
    v_mfma_f32_16x16x32_bf16 v[64:67], a[224:227], v[224:227], v[64:67]
    s_waitcnt lgkmcnt(4)
    ds_read_b64_tr_b16 a[240:241], v60 offset:24576
    v_mfma_f32_16x16x32_bf16 v[64:67], a[228:231], v[228:231], v[64:67]
    ds_read_b64_tr_b16 a[242:243], v60 offset:26624
    v_mfma_f32_16x16x32_bf16 v[72:75], a[224:227], v[240:243], v[72:75]
    buffer_load_dwordx4 v[164:167], v46, s[8:11], s74 offen offset:64
    v_mfma_f32_16x16x32_bf16 v[72:75], a[228:231], v[244:247], v[72:75]
    s_waitcnt lgkmcnt(4)
    s_mov_b32 s74, 10240
    ds_read_b64_tr_b16 a[244:245], v60 offset:28672
    v_mfma_f32_16x16x32_bf16 v[68:71], a[232:235], v[224:227], v[68:71]
    s_waitcnt lgkmcnt(3)
    ds_read_b64_tr_b16 a[246:247], v60 offset:30720
    v_mfma_f32_16x16x32_bf16 v[68:71], a[236:239], v[228:231], v[68:71]
    buffer_load_dwordx4 v[184:187], v46, s[8:11], s74 offen
    ds_read_b64_tr_b16 a[248:249], v61 offset:24576
    v_mfma_f32_16x16x32_bf16 v[76:79], a[232:235], v[240:243], v[76:79]
    ds_read_b64_tr_b16 a[250:251], v61 offset:26624
    v_mfma_f32_16x16x32_bf16 v[76:79], a[236:239], v[244:247], v[76:79]
    s_waitcnt lgkmcnt(2)
    ds_read_b64_tr_b16 a[252:253], v61 offset:28672
    v_mfma_f32_16x16x32_bf16 v[64:67], a[240:243], v[232:235], v[64:67]
    buffer_load_dwordx4 v[188:191], v46, s[8:11], s74 offen offset:64
    ds_read_b64_tr_b16 a[254:255], v61 offset:30720
    v_mfma_f32_16x16x32_bf16 v[64:67], a[244:247], v[236:239], v[64:67]
    ds_read_b64_tr_b16 a[192:193], v62 offset:0
    v_mfma_f32_16x16x32_bf16 v[72:75], a[240:243], v[248:251], v[72:75]
    ds_read_b64_tr_b16 a[194:195], v62 offset:2048
    v_mfma_f32_16x16x32_bf16 v[72:75], a[244:247], v[252:255], v[72:75]
    s_waitcnt lgkmcnt(4)
    ds_read_b64_tr_b16 a[196:197], v62 offset:4096
    v_mfma_f32_16x16x32_bf16 v[68:71], a[248:251], v[232:235], v[68:71]
    s_waitcnt lgkmcnt(3)
    ds_read_b64_tr_b16 a[198:199], v62 offset:6144
    v_mfma_f32_16x16x32_bf16 v[68:71], a[252:255], v[236:239], v[68:71]
    ds_read_b64_tr_b16 a[200:201], v63 offset:0
    v_mfma_f32_16x16x32_bf16 v[76:79], a[248:251], v[248:251], v[76:79]
    ds_read_b64_tr_b16 a[202:203], v63 offset:2048
    v_mfma_f32_16x16x32_bf16 v[76:79], a[252:255], v[252:255], v[76:79]
    s_waitcnt lgkmcnt(4)
    ds_read_b64_tr_b16 a[204:205], v63 offset:4096
    v_mfma_f32_16x16x32_bf16 v[80:83], a[192:195], v[192:195], v[80:83]
    s_waitcnt lgkmcnt(3)
    ds_read_b64_tr_b16 a[206:207], v63 offset:6144
    v_mfma_f32_16x16x32_bf16 v[80:83], a[196:199], v[196:199], v[80:83]
    ds_read_b64_tr_b16 a[208:209], v62 offset:8192
    v_mfma_f32_16x16x32_bf16 v[88:91], a[192:195], v[208:211], v[88:91]
    ds_read_b64_tr_b16 a[210:211], v62 offset:10240
    v_mfma_f32_16x16x32_bf16 v[88:91], a[196:199], v[212:215], v[88:91]
    s_waitcnt lgkmcnt(4)
    ds_read_b64_tr_b16 a[212:213], v62 offset:12288
    v_mfma_f32_16x16x32_bf16 v[84:87], a[200:203], v[192:195], v[84:87]
    s_waitcnt lgkmcnt(3)
    ds_read_b64_tr_b16 a[214:215], v62 offset:14336
    v_mfma_f32_16x16x32_bf16 v[84:87], a[204:207], v[196:199], v[84:87]
    ds_read_b64_tr_b16 a[216:217], v63 offset:8192
    v_mfma_f32_16x16x32_bf16 v[92:95], a[200:203], v[208:211], v[92:95]
    ds_read_b64_tr_b16 a[218:219], v63 offset:10240
    v_cvt_pk_bf16_f32 v64, v64, v65
    v_mfma_f32_16x16x32_bf16 v[92:95], a[204:207], v[212:215], v[92:95]
    s_waitcnt lgkmcnt(4)
    ds_read_b64_tr_b16 a[220:221], v63 offset:12288
    v_cvt_pk_bf16_f32 v65, v66, v67
    v_mfma_f32_16x16x32_bf16 v[80:83], a[208:211], v[200:203], v[80:83]
    s_waitcnt lgkmcnt(3)
    ds_read_b64_tr_b16 a[222:223], v63 offset:14336
    v_cvt_pk_bf16_f32 v66, v68, v69
    v_mfma_f32_16x16x32_bf16 v[80:83], a[212:215], v[204:207], v[80:83]
    ds_read_b64_tr_b16 a[224:225], v62 offset:16384
    v_cvt_pk_bf16_f32 v67, v70, v71
    v_mfma_f32_16x16x32_bf16 v[88:91], a[208:211], v[216:219], v[88:91]
    ds_read_b64_tr_b16 a[226:227], v62 offset:18432
    v_min_u32 v64, -2, v64
    v_mfma_f32_16x16x32_bf16 v[88:91], a[212:215], v[220:223], v[88:91]
    s_waitcnt lgkmcnt(4)
    ds_read_b64_tr_b16 a[228:229], v62 offset:20480
    v_min_u32 v65, -2, v65
    v_mfma_f32_16x16x32_bf16 v[84:87], a[216:219], v[200:203], v[84:87]
    s_waitcnt lgkmcnt(3)
    ds_read_b64_tr_b16 a[230:231], v62 offset:22528
    v_min_u32 v66, -2, v66
    v_mfma_f32_16x16x32_bf16 v[84:87], a[220:223], v[204:207], v[84:87]
    ds_read_b64_tr_b16 a[232:233], v63 offset:16384
    v_min_u32 v67, -2, v67
    v_mfma_f32_16x16x32_bf16 v[92:95], a[216:219], v[216:219], v[92:95]
    s_waitcnt lgkmcnt(3)
    s_add_u32 s75, s18, 8388608
    ds_read_b64_tr_b16 a[234:235], v63 offset:18432
    v_mfma_f32_16x16x32_bf16 v[92:95], a[220:223], v[220:223], v[92:95]
    buffer_store_dwordx4 v[64:67], v23, s[8:11], s75 offen offset:0 sc0 sc1
    ds_read_b64_tr_b16 a[236:237], v63 offset:20480
    v_mfma_f32_16x16x32_bf16 v[80:83], a[224:227], v[224:227], v[80:83]
    s_waitcnt lgkmcnt(3)
    ds_read_b64_tr_b16 a[238:239], v63 offset:22528
    v_cvt_pk_bf16_f32 v72, v72, v73
    v_mfma_f32_16x16x32_bf16 v[80:83], a[228:231], v[228:231], v[80:83]
    ds_read_b64_tr_b16 a[240:241], v62 offset:24576
    v_cvt_pk_bf16_f32 v73, v74, v75
    v_mfma_f32_16x16x32_bf16 v[88:91], a[224:227], v[240:243], v[88:91]
    ds_read_b64_tr_b16 a[242:243], v62 offset:26624
    v_cvt_pk_bf16_f32 v74, v76, v77
    v_mfma_f32_16x16x32_bf16 v[88:91], a[228:231], v[244:247], v[88:91]
    s_waitcnt lgkmcnt(4)
    ds_read_b64_tr_b16 a[244:245], v62 offset:28672
    v_cvt_pk_bf16_f32 v75, v78, v79
    v_mfma_f32_16x16x32_bf16 v[84:87], a[232:235], v[224:227], v[84:87]
    s_waitcnt lgkmcnt(3)
    ds_read_b64_tr_b16 a[246:247], v62 offset:30720
    v_min_u32 v72, -2, v72
    v_mfma_f32_16x16x32_bf16 v[84:87], a[236:239], v[228:231], v[84:87]
    ds_read_b64_tr_b16 a[248:249], v63 offset:24576
    v_min_u32 v73, -2, v73
    v_mfma_f32_16x16x32_bf16 v[92:95], a[232:235], v[240:243], v[92:95]
    ds_read_b64_tr_b16 a[250:251], v63 offset:26624
    v_min_u32 v74, -2, v74
    v_mfma_f32_16x16x32_bf16 v[92:95], a[236:239], v[244:247], v[92:95]
    s_waitcnt lgkmcnt(4)
    ds_read_b64_tr_b16 a[252:253], v63 offset:28672
    v_min_u32 v75, -2, v75
    v_mfma_f32_16x16x32_bf16 v[80:83], a[240:243], v[232:235], v[80:83]
    s_waitcnt lgkmcnt(3)
    s_add_u32 s75, s18, 8519680
    ds_read_b64_tr_b16 a[254:255], v63 offset:30720
    s_waitcnt vmcnt(8)
    v_mul_f32 v8, v48, v168
    v_mfma_f32_16x16x32_bf16 v[80:83], a[244:247], v[236:239], v[80:83]
    buffer_store_dwordx4 v[72:75], v23, s[8:11], s75 offen offset:0 sc0 sc1
    v_mfma_f32_16x16x32_bf16 v[88:91], a[240:243], v[248:251], v[88:91]
    ds_read_b64_tr_b16 a[192:193], v60 offset:32768
    v_mul_f32 v9, v49, v169
    v_mfma_f32_16x16x32_bf16 v[88:91], a[244:247], v[252:255], v[88:91]
    s_waitcnt lgkmcnt(3)
    ds_read_b64_tr_b16 a[194:195], v60 offset:34816
    v_mul_f32 v10, v50, v170
    v_mfma_f32_16x16x32_bf16 v[84:87], a[248:251], v[232:235], v[84:87]
    s_waitcnt lgkmcnt(2)
    ds_read_b64_tr_b16 a[196:197], v60 offset:36864
    v_mul_f32 v11, v51, v171
    v_mfma_f32_16x16x32_bf16 v[84:87], a[252:255], v[236:239], v[84:87]
    ds_read_b64_tr_b16 a[198:199], v60 offset:38912
    s_waitcnt vmcnt(8)
    v_mul_f32 v12, v52, v172
    v_mfma_f32_16x16x32_bf16 v[92:95], a[248:251], v[248:251], v[92:95]
    ds_read_b64_tr_b16 a[200:201], v61 offset:32768
    v_mul_f32 v13, v53, v173
    v_mfma_f32_16x16x32_bf16 v[92:95], a[252:255], v[252:255], v[92:95]
    s_waitcnt lgkmcnt(3)
    ds_read_b64_tr_b16 a[202:203], v61 offset:34816
    v_mul_f32 v14, v54, v174
    v_mfma_f32_16x16x32_bf16 v[96:99], a[192:195], v[192:195], v[96:99]
    s_waitcnt lgkmcnt(2)
    ds_read_b64_tr_b16 a[204:205], v61 offset:36864
    v_mul_f32 v15, v55, v175
    v_mfma_f32_16x16x32_bf16 v[96:99], a[196:199], v[196:199], v[96:99]
    ds_read_b64_tr_b16 a[206:207], v61 offset:38912
    s_waitcnt vmcnt(7)
    v_mul_f32 v16, v48, v176
    v_mfma_f32_16x16x32_bf16 v[104:107], a[192:195], v[208:211], v[104:107]
    ds_read_b64_tr_b16 a[208:209], v60 offset:40960
    v_fmac_f32 v16, v49, v177
    v_mfma_f32_16x16x32_bf16 v[104:107], a[196:199], v[212:215], v[104:107]
    s_waitcnt lgkmcnt(3)
    ds_read_b64_tr_b16 a[210:211], v60 offset:43008
    v_fmac_f32 v16, v50, v178
    v_mfma_f32_16x16x32_bf16 v[100:103], a[200:203], v[192:195], v[100:103]
    s_waitcnt lgkmcnt(2)
    ds_read_b64_tr_b16 a[212:213], v60 offset:45056
    v_fmac_f32 v16, v51, v179
    v_mfma_f32_16x16x32_bf16 v[100:103], a[204:207], v[196:199], v[100:103]
    ds_read_b64_tr_b16 a[214:215], v60 offset:47104
    s_waitcnt vmcnt(6)
    v_fmac_f32 v16, v52, v180
    v_mfma_f32_16x16x32_bf16 v[108:111], a[200:203], v[208:211], v[108:111]
    ds_read_b64_tr_b16 a[216:217], v61 offset:40960
    v_cvt_pk_bf16_f32 v80, v80, v81
    v_mfma_f32_16x16x32_bf16 v[108:111], a[204:207], v[212:215], v[108:111]
    s_waitcnt lgkmcnt(3)
    ds_read_b64_tr_b16 a[218:219], v61 offset:43008
    v_cvt_pk_bf16_f32 v81, v82, v83
    v_mfma_f32_16x16x32_bf16 v[96:99], a[208:211], v[200:203], v[96:99]
    s_waitcnt lgkmcnt(2)
    ds_read_b64_tr_b16 a[220:221], v61 offset:45056
    v_cvt_pk_bf16_f32 v82, v84, v85
    v_mfma_f32_16x16x32_bf16 v[96:99], a[212:215], v[204:207], v[96:99]
    ds_read_b64_tr_b16 a[222:223], v61 offset:47104
    v_cvt_pk_bf16_f32 v83, v86, v87
    v_mfma_f32_16x16x32_bf16 v[104:107], a[208:211], v[216:219], v[104:107]
    ds_read_b64_tr_b16 a[224:225], v60 offset:49152
    v_min_u32 v80, -2, v80
    v_mfma_f32_16x16x32_bf16 v[104:107], a[212:215], v[220:223], v[104:107]
    s_waitcnt lgkmcnt(3)
    ds_read_b64_tr_b16 a[226:227], v60 offset:51200
    v_min_u32 v81, -2, v81
    v_mfma_f32_16x16x32_bf16 v[100:103], a[216:219], v[200:203], v[100:103]
    s_waitcnt lgkmcnt(2)
    ds_read_b64_tr_b16 a[228:229], v60 offset:53248
    v_min_u32 v82, -2, v82
    v_mfma_f32_16x16x32_bf16 v[100:103], a[220:223], v[204:207], v[100:103]
    ds_read_b64_tr_b16 a[230:231], v60 offset:55296
    v_min_u32 v83, -2, v83
    v_mfma_f32_16x16x32_bf16 v[108:111], a[216:219], v[216:219], v[108:111]
    s_waitcnt lgkmcnt(2)
    s_add_u32 s75, s18, 8388608
    ds_read_b64_tr_b16 a[232:233], v61 offset:49152
    v_fmac_f32 v16, v53, v181
    v_mfma_f32_16x16x32_bf16 v[108:111], a[220:223], v[220:223], v[108:111]
    buffer_store_dwordx4 v[80:83], v23, s[8:11], s75 offen offset:256 sc0 sc1
    ds_read_b64_tr_b16 a[234:235], v61 offset:51200
    v_mfma_f32_16x16x32_bf16 v[96:99], a[224:227], v[224:227], v[96:99]
    s_waitcnt lgkmcnt(2)
    ds_read_b64_tr_b16 a[236:237], v61 offset:53248
    v_cvt_pk_bf16_f32 v88, v88, v89
    v_mfma_f32_16x16x32_bf16 v[96:99], a[228:231], v[228:231], v[96:99]
    ds_read_b64_tr_b16 a[238:239], v61 offset:55296
    v_cvt_pk_bf16_f32 v89, v90, v91
    v_mfma_f32_16x16x32_bf16 v[104:107], a[224:227], v[240:243], v[104:107]
    ds_read_b64_tr_b16 a[240:241], v60 offset:57344
    v_cvt_pk_bf16_f32 v90, v92, v93
    v_mfma_f32_16x16x32_bf16 v[104:107], a[228:231], v[244:247], v[104:107]
    s_waitcnt lgkmcnt(3)
    ds_read_b64_tr_b16 a[242:243], v60 offset:59392
    v_cvt_pk_bf16_f32 v91, v94, v95
    v_mfma_f32_16x16x32_bf16 v[100:103], a[232:235], v[224:227], v[100:103]
    s_waitcnt lgkmcnt(2)
    ds_read_b64_tr_b16 a[244:245], v60 offset:61440
    v_min_u32 v88, -2, v88
    v_mfma_f32_16x16x32_bf16 v[100:103], a[236:239], v[228:231], v[100:103]
    ds_read_b64_tr_b16 a[246:247], v60 offset:63488
    v_min_u32 v89, -2, v89
    v_mfma_f32_16x16x32_bf16 v[108:111], a[232:235], v[240:243], v[108:111]
    ds_read_b64_tr_b16 a[248:249], v61 offset:57344
    v_min_u32 v90, -2, v90
    v_mfma_f32_16x16x32_bf16 v[108:111], a[236:239], v[244:247], v[108:111]
    s_waitcnt lgkmcnt(3)
    ds_read_b64_tr_b16 a[250:251], v61 offset:59392
    v_fmac_f32 v16, v54, v182
    v_mfma_f32_16x16x32_bf16 v[96:99], a[240:243], v[232:235], v[96:99]
    s_waitcnt lgkmcnt(2)
    s_add_u32 s74, s70, 0
    ds_read_b64_tr_b16 a[252:253], v61 offset:61440
    v_min_u32 v91, -2, v91
    v_mfma_f32_16x16x32_bf16 v[96:99], a[244:247], v[236:239], v[96:99]
    buffer_load_dwordx4 v[128:131], v44, s[8:11], s74 offen sc0 sc1
    ds_read_b64_tr_b16 a[254:255], v61 offset:63488
    v_mfma_f32_16x16x32_bf16 v[104:107], a[240:243], v[248:251], v[104:107]
    s_add_u32 s74, s70, 4096
    ds_read_b64_tr_b16 a[192:193], v62 offset:32768
    v_fmac_f32 v16, v55, v183
    v_mfma_f32_16x16x32_bf16 v[104:107], a[244:247], v[252:255], v[104:107]
    s_waitcnt lgkmcnt(1)
    s_add_u32 s75, s18, 8519680
    ds_read_b64_tr_b16 a[194:195], v62 offset:34816
    v_add_f32_dpp v16, v16, v16 quad_perm:[1,0,3,2] row_mask:0xf bank_mask:0xf
    v_mfma_f32_16x16x32_bf16 v[100:103], a[248:251], v[232:235], v[100:103]
    buffer_store_dwordx4 v[88:91], v23, s[8:11], s75 offen offset:256 sc0 sc1
    ds_read_b64_tr_b16 a[196:197], v62 offset:36864
    v_mfma_f32_16x16x32_bf16 v[100:103], a[252:255], v[236:239], v[100:103]
    buffer_load_dwordx4 v[132:135], v44, s[8:11], s74 offen sc0 sc1
    ds_read_b64_tr_b16 a[198:199], v62 offset:38912
    v_mfma_f32_16x16x32_bf16 v[108:111], a[248:251], v[248:251], v[108:111]
    s_add_u32 s74, s70, 8192
    ds_read_b64_tr_b16 a[200:201], v63 offset:32768
    v_add_f32_dpp v16, v16, v16 quad_perm:[2,3,0,1] row_mask:0xf bank_mask:0xf
    v_mfma_f32_16x16x32_bf16 v[108:111], a[252:255], v[252:255], v[108:111]
    s_waitcnt lgkmcnt(3)
    ds_read_b64_tr_b16 a[202:203], v63 offset:34816
    v_add_f32_dpp v16, v16, v16 row_half_mirror row_mask:0xf bank_mask:0xf
    v_mfma_f32_16x16x32_bf16 v[112:115], a[192:195], v[192:195], v[112:115]
    s_waitcnt lgkmcnt(2)
    ds_read_b64_tr_b16 a[204:205], v63 offset:36864
    v_add_f32_dpp v16, v16, v16 row_mirror row_mask:0xf bank_mask:0xf
    v_mfma_f32_16x16x32_bf16 v[112:115], a[196:199], v[196:199], v[112:115]
    buffer_load_dwordx4 v[136:139], v44, s[8:11], s74 offen sc0 sc1
    ds_read_b64_tr_b16 a[206:207], v63 offset:38912
    v_mfma_f32_16x16x32_bf16 v[120:123], a[192:195], v[208:211], v[120:123]
    s_add_u32 s74, s70, 12288
    ds_read_b64_tr_b16 a[208:209], v62 offset:40960
    v_mov_b32 v19, v16
    v_mfma_f32_16x16x32_bf16 v[120:123], a[196:199], v[212:215], v[120:123]
    s_waitcnt lgkmcnt(3)
    ds_read_b64_tr_b16 a[210:211], v62 offset:43008
    v_permlane16_swap_b32 v16, v19
    v_mfma_f32_16x16x32_bf16 v[116:119], a[200:203], v[192:195], v[116:119]
    s_waitcnt lgkmcnt(2)
    ds_read_b64_tr_b16 a[212:213], v62 offset:45056
    v_add_f32 v16, v16, v19
    v_mfma_f32_16x16x32_bf16 v[116:119], a[204:207], v[196:199], v[116:119]
    buffer_load_dwordx4 v[140:143], v44, s[8:11], s74 offen sc0 sc1
    ds_read_b64_tr_b16 a[214:215], v62 offset:47104
    v_mfma_f32_16x16x32_bf16 v[124:127], a[200:203], v[208:211], v[124:127]
    s_add_u32 s74, s70, 16384
    ds_read_b64_tr_b16 a[216:217], v63 offset:40960
    v_cvt_pk_bf16_f32 v96, v96, v97
    v_mfma_f32_16x16x32_bf16 v[124:127], a[204:207], v[212:215], v[124:127]
    s_waitcnt lgkmcnt(3)
    ds_read_b64_tr_b16 a[218:219], v63 offset:43008
    v_cvt_pk_bf16_f32 v97, v98, v99
    v_mfma_f32_16x16x32_bf16 v[112:115], a[208:211], v[200:203], v[112:115]
    s_waitcnt lgkmcnt(2)
    ds_read_b64_tr_b16 a[220:221], v63 offset:45056
    v_cvt_pk_bf16_f32 v98, v100, v101
    v_mfma_f32_16x16x32_bf16 v[112:115], a[212:215], v[204:207], v[112:115]
    buffer_load_dwordx4 v[144:147], v44, s[8:11], s74 offen sc0 sc1
    ds_read_b64_tr_b16 a[222:223], v63 offset:47104
    v_mfma_f32_16x16x32_bf16 v[120:123], a[208:211], v[216:219], v[120:123]
    s_add_u32 s74, s70, 20480
    ds_read_b64_tr_b16 a[224:225], v62 offset:49152
    v_cvt_pk_bf16_f32 v99, v102, v103
    v_mfma_f32_16x16x32_bf16 v[120:123], a[212:215], v[220:223], v[120:123]
    s_waitcnt lgkmcnt(3)
    ds_read_b64_tr_b16 a[226:227], v62 offset:51200
    v_min_u32 v96, -2, v96
    v_mfma_f32_16x16x32_bf16 v[116:119], a[216:219], v[200:203], v[116:119]
    s_waitcnt lgkmcnt(2)
    ds_read_b64_tr_b16 a[228:229], v62 offset:53248
    v_min_u32 v97, -2, v97
    v_mfma_f32_16x16x32_bf16 v[116:119], a[220:223], v[204:207], v[116:119]
    buffer_load_dwordx4 v[148:151], v44, s[8:11], s74 offen sc0 sc1
    ds_read_b64_tr_b16 a[230:231], v62 offset:55296
    v_mfma_f32_16x16x32_bf16 v[124:127], a[216:219], v[216:219], v[124:127]
    s_add_u32 s74, s70, 24576
    ds_read_b64_tr_b16 a[232:233], v63 offset:49152
    v_min_u32 v98, -2, v98
    v_mfma_f32_16x16x32_bf16 v[124:127], a[220:223], v[220:223], v[124:127]
    s_waitcnt lgkmcnt(3)
    ds_read_b64_tr_b16 a[234:235], v63 offset:51200
    v_min_u32 v99, -2, v99
    v_mfma_f32_16x16x32_bf16 v[112:115], a[224:227], v[224:227], v[112:115]
    s_waitcnt lgkmcnt(2)
    s_add_u32 s75, s18, 8388608
    ds_read_b64_tr_b16 a[236:237], v63 offset:53248
    v_mov_b32 v19, v16
    v_mfma_f32_16x16x32_bf16 v[112:115], a[228:231], v[228:231], v[112:115]
    buffer_load_dwordx4 v[152:155], v44, s[8:11], s74 offen sc0 sc1
    ds_read_b64_tr_b16 a[238:239], v63 offset:55296
    v_mfma_f32_16x16x32_bf16 v[120:123], a[224:227], v[240:243], v[120:123]
    s_waitcnt lgkmcnt(2)
    s_add_u32 s74, s70, 28672
    ds_read_b64_tr_b16 a[240:241], v62 offset:57344
    v_permlane32_swap_b32 v16, v19
    v_mfma_f32_16x16x32_bf16 v[120:123], a[228:231], v[244:247], v[120:123]
    buffer_store_dwordx4 v[96:99], v23, s[8:11], s75 offen offset:512 sc0 sc1
    ds_read_b64_tr_b16 a[242:243], v62 offset:59392
    v_add_f32 v16, v16, v19
    v_mfma_f32_16x16x32_bf16 v[116:119], a[232:235], v[224:227], v[116:119]
    s_waitcnt lgkmcnt(2)
    ds_read_b64_tr_b16 a[244:245], v62 offset:61440
    v_cvt_pk_bf16_f32 v104, v104, v105
    v_mfma_f32_16x16x32_bf16 v[116:119], a[236:239], v[228:231], v[116:119]
    buffer_load_dwordx4 v[156:159], v44, s[8:11], s74 offen sc0 sc1
    ds_read_b64_tr_b16 a[246:247], v62 offset:63488
    v_mfma_f32_16x16x32_bf16 v[124:127], a[232:235], v[240:243], v[124:127]
    ds_read_b64_tr_b16 a[248:249], v63 offset:57344
    v_cvt_pk_bf16_f32 v105, v106, v107
    v_mfma_f32_16x16x32_bf16 v[124:127], a[236:239], v[244:247], v[124:127]
    s_waitcnt lgkmcnt(3)
    ds_read_b64_tr_b16 a[250:251], v63 offset:59392
    v_cvt_pk_bf16_f32 v106, v108, v109
    v_mfma_f32_16x16x32_bf16 v[112:115], a[240:243], v[232:235], v[112:115]
    s_waitcnt lgkmcnt(2)
    ds_read_b64_tr_b16 a[252:253], v63 offset:61440
    v_cvt_pk_bf16_f32 v107, v110, v111
    v_mfma_f32_16x16x32_bf16 v[112:115], a[244:247], v[236:239], v[112:115]
    ds_read_b64_tr_b16 a[254:255], v63 offset:63488
    v_min_u32 v104, -2, v104
    v_mfma_f32_16x16x32_bf16 v[120:123], a[240:243], v[248:251], v[120:123]
    v_min_u32 v105, -2, v105
    v_mfma_f32_16x16x32_bf16 v[120:123], a[244:247], v[252:255], v[120:123]
    s_waitcnt lgkmcnt(2)
    v_min_u32 v106, -2, v106
    v_mfma_f32_16x16x32_bf16 v[116:119], a[248:251], v[232:235], v[116:119]
    s_waitcnt lgkmcnt(0)
    v_min_u32 v107, -2, v107
    v_mfma_f32_16x16x32_bf16 v[116:119], a[252:255], v[236:239], v[116:119]
    s_add_u32 s75, s18, 8519680
    v_mfma_f32_16x16x32_bf16 v[124:127], a[248:251], v[248:251], v[124:127]
    buffer_store_dwordx4 v[104:107], v23, s[8:11], s75 offen offset:512 sc0 sc1
    v_mfma_f32_16x16x32_bf16 v[124:127], a[252:255], v[252:255], v[124:127]
    v_cvt_pk_bf16_f32 v112, v112, v113
    v_cvt_pk_bf16_f32 v113, v114, v115
    s_nop 1
    v_cvt_pk_bf16_f32 v114, v116, v117
    v_cvt_pk_bf16_f32 v115, v118, v119
    v_min_u32 v112, -2, v112
    v_min_u32 v113, -2, v113
    v_min_u32 v114, -2, v114
    v_min_u32 v115, -2, v115
    s_add_u32 s75, s18, 8388608
    buffer_store_dwordx4 v[112:115], v23, s[8:11], s75 offen offset:768 sc0 sc1
    v_cvt_pk_bf16_f32 v120, v120, v121
    v_cvt_pk_bf16_f32 v121, v122, v123
    v_cvt_pk_bf16_f32 v122, v124, v125
    v_cvt_pk_bf16_f32 v123, v126, v127
    v_min_u32 v120, -2, v120
    v_min_u32 v121, -2, v121
    v_min_u32 v122, -2, v122
    v_min_u32 v123, -2, v123
    s_add_u32 s75, s18, 8519680
    buffer_store_dwordx4 v[120:123], v23, s[8:11], s75 offen offset:768 sc0 sc1
    s_mov_b32 s12, 0xf000f0
    s_mov_b32 s13, 0xf000f0
    v_mov_b64 v[192:193], -1
    v_mov_b64 v[194:195], -1
    v_mov_b64 v[196:197], -1
    v_mov_b64 v[198:199], -1
    v_mov_b64 v[200:201], -1
    v_mov_b64 v[202:203], -1
    v_mov_b64 v[204:205], -1
    v_mov_b64 v[206:207], -1
    v_mov_b64 v[208:209], -1
    v_mov_b64 v[210:211], -1
    v_mov_b64 v[212:213], -1
    v_mov_b64 v[214:215], -1
    v_mov_b64 v[216:217], -1
    v_mov_b64 v[218:219], -1
    v_mov_b64 v[220:221], -1
    v_mov_b64 v[222:223], -1
    s_mov_b64 exec, s[12:13]
    s_add_u32 s74, s70, 8388608
    buffer_load_dwordx4 v[192:195], v44, s[8:11], s74 offen sc0 sc1
    s_add_u32 s74, s70, 8392704
    buffer_load_dwordx4 v[196:199], v44, s[8:11], s74 offen sc0 sc1
    s_add_u32 s74, s70, 8396800
    buffer_load_dwordx4 v[200:203], v44, s[8:11], s74 offen sc0 sc1
    s_add_u32 s74, s70, 8400896
    buffer_load_dwordx4 v[204:207], v44, s[8:11], s74 offen sc0 sc1
    s_add_u32 s74, s70, 8404992
    buffer_load_dwordx4 v[208:211], v44, s[8:11], s74 offen sc0 sc1
    s_add_u32 s74, s70, 8409088
    buffer_load_dwordx4 v[212:215], v44, s[8:11], s74 offen sc0 sc1
    s_add_u32 s74, s70, 8413184
    buffer_load_dwordx4 v[216:219], v44, s[8:11], s74 offen sc0 sc1
    s_add_u32 s74, s70, 8417280
    buffer_load_dwordx4 v[220:223], v44, s[8:11], s74 offen sc0 sc1
    s_mov_b64 exec, -1
    v_mov_b32 v100, 0x3f80
    v_mov_b32 v101, 0x3f800000
    v_lshlrev_b32 v72, 16, v32
    v_and_b32 v73, 0xffff0000, v32
    v_lshlrev_b32 v74, 16, v33
    v_and_b32 v75, 0xffff0000, v33
    v_lshlrev_b32 v76, 16, v34
    v_and_b32 v77, 0xffff0000, v34
    v_lshlrev_b32 v78, 16, v35
    v_and_b32 v79, 0xffff0000, v35
    v_lshlrev_b32 v88, 16, v36
    v_and_b32 v89, 0xffff0000, v36
    v_lshlrev_b32 v90, 16, v37
    v_and_b32 v91, 0xffff0000, v37
    v_lshlrev_b32 v92, 16, v38
    v_and_b32 v93, 0xffff0000, v38
    v_lshlrev_b32 v94, 16, v39
    v_and_b32 v95, 0xffff0000, v39
    s_waitcnt vmcnt(20)
    v_max_u32 v3, v128, v129
    v_max3_u32 v3, v3, v130, v131
    s_waitcnt vmcnt(18)
    v_max3_u32 v3, v3, v132, v133
    v_max3_u32 v3, v3, v134, v135
    s_waitcnt vmcnt(17)
    v_max3_u32 v3, v3, v136, v137
    v_max3_u32 v3, v3, v138, v139
    s_waitcnt vmcnt(16)
    v_max3_u32 v3, v3, v140, v141
    v_max3_u32 v3, v3, v142, v143
    s_waitcnt vmcnt(15)
    v_max3_u32 v3, v3, v144, v145
    v_max3_u32 v3, v3, v146, v147
    s_waitcnt vmcnt(14)
    v_max3_u32 v3, v3, v148, v149
    v_max3_u32 v3, v3, v150, v151
    s_waitcnt vmcnt(13)
    v_max3_u32 v3, v3, v152, v153
    v_max3_u32 v3, v3, v154, v155
    s_waitcnt vmcnt(11)
    v_max3_u32 v3, v3, v156, v157
    v_max3_u32 v3, v3, v158, v159
    v_cmp_eq_u32 vcc, -1, v3
    s_cbranch_vccnz L_P1_slow_15
L_P1_ok_16:
    v_lshlrev_b32 v64, 16, v128
    v_and_b32 v65, 0xffff0000, v128
    v_lshlrev_b32 v66, 16, v129
    v_and_b32 v67, 0xffff0000, v129
    v_lshlrev_b32 v68, 16, v130
    v_and_b32 v69, 0xffff0000, v130
    v_lshlrev_b32 v70, 16, v131
    v_and_b32 v71, 0xffff0000, v131
    v_dot2c_f32_bf16 v64, v132, v100
    v_dot2c_f32_bf16 v65, v132, v101
    v_dot2c_f32_bf16 v66, v133, v100
    v_dot2c_f32_bf16 v67, v133, v101
    v_dot2c_f32_bf16 v68, v134, v100
    v_dot2c_f32_bf16 v69, v134, v101
    v_dot2c_f32_bf16 v70, v135, v100
    v_dot2c_f32_bf16 v71, v135, v101
    v_dot2c_f32_bf16 v64, v136, v100
    v_dot2c_f32_bf16 v65, v136, v101
    v_dot2c_f32_bf16 v66, v137, v100
    v_dot2c_f32_bf16 v67, v137, v101
    v_dot2c_f32_bf16 v68, v138, v100
    v_dot2c_f32_bf16 v69, v138, v101
    v_dot2c_f32_bf16 v70, v139, v100
    v_dot2c_f32_bf16 v71, v139, v101
    v_dot2c_f32_bf16 v64, v140, v100
    v_dot2c_f32_bf16 v65, v140, v101
    v_dot2c_f32_bf16 v66, v141, v100
    v_dot2c_f32_bf16 v67, v141, v101
    v_dot2c_f32_bf16 v68, v142, v100
    v_dot2c_f32_bf16 v69, v142, v101
    v_dot2c_f32_bf16 v70, v143, v100
    v_dot2c_f32_bf16 v71, v143, v101
    v_dot2c_f32_bf16 v64, v144, v100
    v_dot2c_f32_bf16 v65, v144, v101
    v_dot2c_f32_bf16 v66, v145, v100
    v_dot2c_f32_bf16 v67, v145, v101
    v_dot2c_f32_bf16 v68, v146, v100
    v_dot2c_f32_bf16 v69, v146, v101
    v_dot2c_f32_bf16 v70, v147, v100
    v_dot2c_f32_bf16 v71, v147, v101
    v_dot2c_f32_bf16 v64, v148, v100
    v_dot2c_f32_bf16 v65, v148, v101
    v_dot2c_f32_bf16 v66, v149, v100
    v_dot2c_f32_bf16 v67, v149, v101
    v_dot2c_f32_bf16 v68, v150, v100
    v_dot2c_f32_bf16 v69, v150, v101
    v_dot2c_f32_bf16 v70, v151, v100
    v_dot2c_f32_bf16 v71, v151, v101
    v_dot2c_f32_bf16 v64, v152, v100
    v_dot2c_f32_bf16 v65, v152, v101
    v_dot2c_f32_bf16 v66, v153, v100
    v_dot2c_f32_bf16 v67, v153, v101
    v_dot2c_f32_bf16 v68, v154, v100
    v_dot2c_f32_bf16 v69, v154, v101
    v_dot2c_f32_bf16 v70, v155, v100
    v_dot2c_f32_bf16 v71, v155, v101
    v_dot2c_f32_bf16 v64, v156, v100
    v_dot2c_f32_bf16 v65, v156, v101
    v_dot2c_f32_bf16 v66, v157, v100
    v_dot2c_f32_bf16 v67, v157, v101
    v_dot2c_f32_bf16 v68, v158, v100
    v_dot2c_f32_bf16 v69, v158, v101
    v_dot2c_f32_bf16 v70, v159, v100
    v_dot2c_f32_bf16 v71, v159, v101
    v_pk_fma_f32 v[64:65], v[64:65], v[160:161], v[72:73]
    v_pk_fma_f32 v[66:67], v[66:67], v[162:163], v[74:75]
    v_pk_fma_f32 v[68:69], v[68:69], v[164:165], v[76:77]
    v_pk_fma_f32 v[70:71], v[70:71], v[166:167], v[78:79]
    v_cvt_pk_bf16_f32 v32, v64, v65
    v_cvt_pk_bf16_f32 v33, v66, v67
    v_cvt_pk_bf16_f32 v34, v68, v69
    v_cvt_pk_bf16_f32 v35, v70, v71
    v_lshlrev_b32 v64, 16, v32
    v_and_b32 v65, 0xffff0000, v32
    v_lshlrev_b32 v66, 16, v33
    v_and_b32 v67, 0xffff0000, v33
    v_lshlrev_b32 v68, 16, v34
    v_and_b32 v69, 0xffff0000, v34
    v_lshlrev_b32 v70, 16, v35
    v_and_b32 v71, 0xffff0000, v35
    v_pk_add_f32 v[48:49], v[64:65], v[66:67]
    v_pk_add_f32 v[50:51], v[68:69], v[70:71]
    v_pk_add_f32 v[48:49], v[48:49], v[50:51]
    v_add_f32 v48, v48, v49
    s_nop 1
    v_add_f32_dpp v48, v48, v48 quad_perm:[1,0,3,2] row_mask:0xf bank_mask:0xf
    s_nop 1
    v_add_f32_dpp v48, v48, v48 quad_perm:[2,3,0,1] row_mask:0xf bank_mask:0xf
    s_nop 1
    v_add_f32_dpp v48, v48, v48 row_half_mirror row_mask:0xf bank_mask:0xf
    s_nop 1
    v_add_f32_dpp v48, v48, v48 row_mirror row_mask:0xf bank_mask:0xf
    v_mov_b32 v49, v48
    s_nop 1
    v_permlane16_swap_b32 v48, v49
    v_add_f32 v48, v48, v49
    v_mov_b32 v49, v48
    s_nop 1
    v_permlane32_swap_b32 v48, v49
    v_add_f32 v48, v48, v49
    v_mul_f32 v48, 0xbb000000, v48
    v_pk_add_f32 v[72:73], v[64:65], v[48:49] op_sel_hi:[1,0]
    v_pk_add_f32 v[74:75], v[66:67], v[48:49] op_sel_hi:[1,0]
    v_pk_add_f32 v[76:77], v[68:69], v[48:49] op_sel_hi:[1,0]
    v_pk_add_f32 v[78:79], v[70:71], v[48:49] op_sel_hi:[1,0]
    v_pk_mul_f32 v[50:51], v[72:73], v[72:73]
    v_pk_mul_f32 v[52:53], v[72:73], v[8:9]
    v_pk_fma_f32 v[50:51], v[74:75], v[74:75], v[50:51]
    v_pk_fma_f32 v[52:53], v[74:75], v[10:11], v[52:53]
    v_pk_fma_f32 v[50:51], v[76:77], v[76:77], v[50:51]
    v_pk_fma_f32 v[52:53], v[76:77], v[12:13], v[52:53]
    v_pk_fma_f32 v[50:51], v[78:79], v[78:79], v[50:51]
    v_pk_fma_f32 v[52:53], v[78:79], v[14:15], v[52:53]
    v_add_f32 v50, v50, v51
    v_add_f32 v52, v52, v53
    s_nop 0
    v_add_f32_dpp v50, v50, v50 quad_perm:[1,0,3,2] row_mask:0xf bank_mask:0xf
    v_add_f32_dpp v52, v52, v52 quad_perm:[1,0,3,2] row_mask:0xf bank_mask:0xf
    s_nop 0
    v_add_f32_dpp v50, v50, v50 quad_perm:[2,3,0,1] row_mask:0xf bank_mask:0xf
    v_add_f32_dpp v52, v52, v52 quad_perm:[2,3,0,1] row_mask:0xf bank_mask:0xf
    s_nop 0
    v_add_f32_dpp v50, v50, v50 row_half_mirror row_mask:0xf bank_mask:0xf
    v_add_f32_dpp v52, v52, v52 row_half_mirror row_mask:0xf bank_mask:0xf
    s_nop 0
    v_add_f32_dpp v50, v50, v50 row_mirror row_mask:0xf bank_mask:0xf
    v_add_f32_dpp v52, v52, v52 row_mirror row_mask:0xf bank_mask:0xf
    v_mov_b32 v51, v50
    v_mov_b32 v53, v52
    s_nop 0
    v_permlane16_swap_b32 v50, v51
    v_permlane16_swap_b32 v52, v53
    v_add_f32 v50, v50, v51
    v_add_f32 v52, v52, v53
    v_mov_b32 v51, v50
    v_mov_b32 v53, v52
    s_nop 0
    v_permlane32_swap_b32 v50, v51
    v_permlane32_swap_b32 v52, v53
    v_add_f32 v50, v50, v51
    v_add_f32 v52, v52, v53
    v_mov_b32 v48, 0x3727c5ac
    v_fmac_f32 v48, 0x3b000000, v50
    v_rsq_f32 v48, v48
    s_nop 0
    v_fma_f32 v52, v52, v48, v16
    v_ashrrev_i32 v53, 31, v52
    v_or_b32 v53, 0x80000000, v53
    v_xor_b32 v53, v53, v52
    v_and_b32 v53, 0xfffff800, v53
    v_or_b32 v17, s68, v53
    v_pk_mul_f32 v[72:73], v[72:73], v[48:49] op_sel_hi:[1,0]
    v_pk_mul_f32 v[74:75], v[74:75], v[48:49] op_sel_hi:[1,0]
    v_pk_mul_f32 v[76:77], v[76:77], v[48:49] op_sel_hi:[1,0]
    v_pk_mul_f32 v[78:79], v[78:79], v[48:49] op_sel_hi:[1,0]
    v_pk_fma_f32 v[72:73], v[72:73], v[168:169], v[176:177]
    v_pk_fma_f32 v[74:75], v[74:75], v[170:171], v[178:179]
    v_pk_fma_f32 v[76:77], v[76:77], v[172:173], v[180:181]
    v_pk_fma_f32 v[78:79], v[78:79], v[174:175], v[182:183]
    v_cvt_pk_bf16_f32 v20, v72, v73
    v_cvt_pk_bf16_f32 v21, v74, v75
    v_cvt_pk_bf16_f32 v22, v76, v77
    v_cvt_pk_bf16_f32 v23, v78, v79
    v_lshlrev_b32 v98, 4, v0
    v_cmp_gt_u32 vcc, 224, v0
    v_mov_b32 v99, 2147479552
    s_nop 0
    v_cndmask_b32 v99, v99, v98, vcc
    s_lshl_b32 s17, s66, 13
    s_add_u32 s17, s17, 4194304
    s_cmp_lt_u32 s66, 224
    s_cselect_b32 s17, s17, 2143285248
    s_lshl_b32 s100, s3, 2
    v_mov_b32 v47, s100
    v_mov_b32 v102, 0
    s_lshl_b32 s100, s2, 6
    s_add_u32 s100, s100, 65536
    s_lshl_b32 s101, s2, 11
    s_add_u32 s101, s101, 524288
    s_mov_b32 s99, 0
L_P2_l_17:
    s_waitcnt vmcnt(0)
    v_max_u32 v48, v192, v193
    v_max3_u32 v48, v48, v194, v195
    v_max_u32 v49, v196, v197
    v_max3_u32 v49, v49, v198, v199
    v_max_u32 v50, v200, v201
    v_max3_u32 v50, v50, v202, v203
    v_max_u32 v51, v204, v205
    v_max3_u32 v51, v51, v206, v207
    v_max_u32 v52, v208, v209
    v_max3_u32 v52, v52, v210, v211
    v_max_u32 v53, v212, v213
    v_max3_u32 v53, v53, v214, v215
    v_max_u32 v54, v216, v217
    v_max3_u32 v54, v54, v218, v219
    v_max_u32 v55, v220, v221
    v_max3_u32 v55, v55, v222, v223
    v_max3_u32 v3, v48, v49, v50
    v_max3_u32 v3, v3, v51, v52
    v_max3_u32 v3, v3, v53, v54
    v_max_u32 v3, v3, v55
    v_cmp_eq_u32 vcc, -1, v3
    s_add_u32 s99, s99, 1
    s_cbranch_vccz L_P2_ok_18
    s_cmp_ge_u32 s99, 200000
    s_cbranch_scc1 L_P2_ok_18
    s_sleep 1
    v_cmp_eq_u32 vcc, -1, v48
    s_cbranch_vccz L_P2_s_19
    s_and_b64 s[96:97], vcc, s[12:13]
    s_cselect_b64 exec, s[96:97], vcc
    s_add_u32 s74, s70, 8388608
    buffer_load_dwordx4 v[192:195], v44, s[8:11], s74 offen sc0 sc1
    s_mov_b64 exec, -1
L_P2_s_19:
    v_cmp_eq_u32 vcc, -1, v49
    s_cbranch_vccz L_P2_s_20
    s_and_b64 s[96:97], vcc, s[12:13]
    s_cselect_b64 exec, s[96:97], vcc
    s_add_u32 s74, s70, 8392704
    buffer_load_dwordx4 v[196:199], v44, s[8:11], s74 offen sc0 sc1
    s_mov_b64 exec, -1
L_P2_s_20:
    v_cmp_eq_u32 vcc, -1, v50
    s_cbranch_vccz L_P2_s_21
    s_and_b64 s[96:97], vcc, s[12:13]
    s_cselect_b64 exec, s[96:97], vcc
    s_add_u32 s74, s70, 8396800
    buffer_load_dwordx4 v[200:203], v44, s[8:11], s74 offen sc0 sc1
    s_mov_b64 exec, -1
L_P2_s_21:
    v_cmp_eq_u32 vcc, -1, v51
    s_cbranch_vccz L_P2_s_22
    s_and_b64 s[96:97], vcc, s[12:13]
    s_cselect_b64 exec, s[96:97], vcc
    s_add_u32 s74, s70, 8400896
    buffer_load_dwordx4 v[204:207], v44, s[8:11], s74 offen sc0 sc1
    s_mov_b64 exec, -1
L_P2_s_22:
    v_cmp_eq_u32 vcc, -1, v52
    s_cbranch_vccz L_P2_s_23
    s_and_b64 s[96:97], vcc, s[12:13]
    s_cselect_b64 exec, s[96:97], vcc
    s_add_u32 s74, s70, 8404992
    buffer_load_dwordx4 v[208:211], v44, s[8:11], s74 offen sc0 sc1
    s_mov_b64 exec, -1
L_P2_s_23:
    v_cmp_eq_u32 vcc, -1, v53
    s_cbranch_vccz L_P2_s_24
    s_and_b64 s[96:97], vcc, s[12:13]
    s_cselect_b64 exec, s[96:97], vcc
    s_add_u32 s74, s70, 8409088
    buffer_load_dwordx4 v[212:215], v44, s[8:11], s74 offen sc0 sc1
    s_mov_b64 exec, -1
L_P2_s_24:
    v_cmp_eq_u32 vcc, -1, v54
    s_cbranch_vccz L_P2_s_25
    s_and_b64 s[96:97], vcc, s[12:13]
    s_cselect_b64 exec, s[96:97], vcc
    s_add_u32 s74, s70, 8413184
    buffer_load_dwordx4 v[216:219], v44, s[8:11], s74 offen sc0 sc1
    s_mov_b64 exec, -1
L_P2_s_25:
    v_cmp_eq_u32 vcc, -1, v55
    s_cbranch_vccz L_P2_s_26
    s_and_b64 s[96:97], vcc, s[12:13]
    s_cselect_b64 exec, s[96:97], vcc
    s_add_u32 s74, s70, 8417280
    buffer_load_dwordx4 v[220:223], v44, s[8:11], s74 offen sc0 sc1
    s_mov_b64 exec, -1
L_P2_s_26:
    s_branch L_P2_l_17
L_P2_ok_18:
    v_lshlrev_b32 v80, 16, v192
    v_and_b32 v81, 0xffff0000, v192
    v_lshlrev_b32 v82, 16, v193
    v_and_b32 v83, 0xffff0000, v193
    v_lshlrev_b32 v84, 16, v194
    v_and_b32 v85, 0xffff0000, v194
    v_lshlrev_b32 v86, 16, v195
    v_and_b32 v87, 0xffff0000, v195
    v_dot2c_f32_bf16 v80, v196, v100
    v_dot2c_f32_bf16 v81, v196, v101
    v_dot2c_f32_bf16 v82, v197, v100
    v_dot2c_f32_bf16 v83, v197, v101
    v_dot2c_f32_bf16 v84, v198, v100
    v_dot2c_f32_bf16 v85, v198, v101
    v_dot2c_f32_bf16 v86, v199, v100
    v_dot2c_f32_bf16 v87, v199, v101
    v_dot2c_f32_bf16 v80, v200, v100
    v_dot2c_f32_bf16 v81, v200, v101
    v_dot2c_f32_bf16 v82, v201, v100
    v_dot2c_f32_bf16 v83, v201, v101
    v_dot2c_f32_bf16 v84, v202, v100
    v_dot2c_f32_bf16 v85, v202, v101
    v_dot2c_f32_bf16 v86, v203, v100
    v_dot2c_f32_bf16 v87, v203, v101
    v_dot2c_f32_bf16 v80, v204, v100
    v_dot2c_f32_bf16 v81, v204, v101
    v_dot2c_f32_bf16 v82, v205, v100
    v_dot2c_f32_bf16 v83, v205, v101
    v_dot2c_f32_bf16 v84, v206, v100
    v_dot2c_f32_bf16 v85, v206, v101
    v_dot2c_f32_bf16 v86, v207, v100
    v_dot2c_f32_bf16 v87, v207, v101
    v_dot2c_f32_bf16 v80, v208, v100
    v_dot2c_f32_bf16 v81, v208, v101
    v_dot2c_f32_bf16 v82, v209, v100
    v_dot2c_f32_bf16 v83, v209, v101
    v_dot2c_f32_bf16 v84, v210, v100
    v_dot2c_f32_bf16 v85, v210, v101
    v_dot2c_f32_bf16 v86, v211, v100
    v_dot2c_f32_bf16 v87, v211, v101
    v_dot2c_f32_bf16 v80, v212, v100
    v_dot2c_f32_bf16 v81, v212, v101
    v_dot2c_f32_bf16 v82, v213, v100
    v_dot2c_f32_bf16 v83, v213, v101
    v_dot2c_f32_bf16 v84, v214, v100
    v_dot2c_f32_bf16 v85, v214, v101
    v_dot2c_f32_bf16 v86, v215, v100
    v_dot2c_f32_bf16 v87, v215, v101
    v_dot2c_f32_bf16 v80, v216, v100
    v_dot2c_f32_bf16 v81, v216, v101
    v_dot2c_f32_bf16 v82, v217, v100
    v_dot2c_f32_bf16 v83, v217, v101
    v_dot2c_f32_bf16 v84, v218, v100
    v_dot2c_f32_bf16 v85, v218, v101
    v_dot2c_f32_bf16 v86, v219, v100
    v_dot2c_f32_bf16 v87, v219, v101
    v_dot2c_f32_bf16 v80, v220, v100
    v_dot2c_f32_bf16 v81, v220, v101
    v_dot2c_f32_bf16 v82, v221, v100
    v_dot2c_f32_bf16 v83, v221, v101
    v_dot2c_f32_bf16 v84, v222, v100
    v_dot2c_f32_bf16 v85, v222, v101
    v_dot2c_f32_bf16 v86, v223, v100
    v_dot2c_f32_bf16 v87, v223, v101
    v_pk_fma_f32 v[80:81], v[80:81], v[160:161], v[88:89]
    v_pk_fma_f32 v[82:83], v[82:83], v[162:163], v[90:91]
    v_pk_fma_f32 v[84:85], v[84:85], v[164:165], v[92:93]
    v_pk_fma_f32 v[86:87], v[86:87], v[166:167], v[94:95]
    v_cvt_pk_bf16_f32 v36, v80, v81
    v_cvt_pk_bf16_f32 v37, v82, v83
    v_cvt_pk_bf16_f32 v38, v84, v85
    v_cvt_pk_bf16_f32 v39, v86, v87
    v_lshlrev_b32 v80, 16, v36
    v_and_b32 v81, 0xffff0000, v36
    v_lshlrev_b32 v82, 16, v37
    v_and_b32 v83, 0xffff0000, v37
    v_lshlrev_b32 v84, 16, v38
    v_and_b32 v85, 0xffff0000, v38
    v_lshlrev_b32 v86, 16, v39
    v_and_b32 v87, 0xffff0000, v39
    v_pk_add_f32 v[48:49], v[80:81], v[82:83]
    v_pk_add_f32 v[50:51], v[84:85], v[86:87]
    v_pk_add_f32 v[48:49], v[48:49], v[50:51]
    v_add_f32 v48, v48, v49
    s_nop 1
    v_add_f32_dpp v48, v48, v48 quad_perm:[1,0,3,2] row_mask:0xf bank_mask:0xf
    s_nop 1
    v_add_f32_dpp v48, v48, v48 quad_perm:[2,3,0,1] row_mask:0xf bank_mask:0xf
    s_nop 1
    v_add_f32_dpp v48, v48, v48 row_half_mirror row_mask:0xf bank_mask:0xf
    s_nop 1
    v_add_f32_dpp v48, v48, v48 row_mirror row_mask:0xf bank_mask:0xf
    v_mov_b32 v49, v48
    s_nop 1
    v_permlane16_swap_b32 v48, v49
    v_add_f32 v48, v48, v49
    v_mov_b32 v49, v48
    s_nop 1
    v_permlane32_swap_b32 v48, v49
    v_add_f32 v48, v48, v49
    v_mul_f32 v48, 0xbb000000, v48
    v_pk_add_f32 v[88:89], v[80:81], v[48:49] op_sel_hi:[1,0]
    v_pk_add_f32 v[90:91], v[82:83], v[48:49] op_sel_hi:[1,0]
    v_pk_add_f32 v[92:93], v[84:85], v[48:49] op_sel_hi:[1,0]
    v_pk_add_f32 v[94:95], v[86:87], v[48:49] op_sel_hi:[1,0]
    v_pk_mul_f32 v[50:51], v[88:89], v[88:89]
    v_pk_mul_f32 v[52:53], v[88:89], v[8:9]
    v_pk_fma_f32 v[50:51], v[90:91], v[90:91], v[50:51]
    v_pk_fma_f32 v[52:53], v[90:91], v[10:11], v[52:53]
    v_pk_fma_f32 v[50:51], v[92:93], v[92:93], v[50:51]
    v_pk_fma_f32 v[52:53], v[92:93], v[12:13], v[52:53]
    v_pk_fma_f32 v[50:51], v[94:95], v[94:95], v[50:51]
    v_pk_fma_f32 v[52:53], v[94:95], v[14:15], v[52:53]
    v_add_f32 v50, v50, v51
    v_add_f32 v52, v52, v53
    s_nop 0
    v_add_f32_dpp v50, v50, v50 quad_perm:[1,0,3,2] row_mask:0xf bank_mask:0xf
    v_add_f32_dpp v52, v52, v52 quad_perm:[1,0,3,2] row_mask:0xf bank_mask:0xf
    s_nop 0
    v_add_f32_dpp v50, v50, v50 quad_perm:[2,3,0,1] row_mask:0xf bank_mask:0xf
    v_add_f32_dpp v52, v52, v52 quad_perm:[2,3,0,1] row_mask:0xf bank_mask:0xf
    s_nop 0
    v_add_f32_dpp v50, v50, v50 row_half_mirror row_mask:0xf bank_mask:0xf
    v_add_f32_dpp v52, v52, v52 row_half_mirror row_mask:0xf bank_mask:0xf
    s_nop 0
    v_add_f32_dpp v50, v50, v50 row_mirror row_mask:0xf bank_mask:0xf
    v_add_f32_dpp v52, v52, v52 row_mirror row_mask:0xf bank_mask:0xf
    v_mov_b32 v51, v50
    v_mov_b32 v53, v52
    s_nop 0
    v_permlane16_swap_b32 v50, v51
    v_permlane16_swap_b32 v52, v53
    v_add_f32 v50, v50, v51
    v_add_f32 v52, v52, v53
    v_mov_b32 v51, v50
    v_mov_b32 v53, v52
    s_nop 0
    v_permlane32_swap_b32 v50, v51
    v_permlane32_swap_b32 v52, v53
    v_add_f32 v50, v50, v51
    v_add_f32 v52, v52, v53
    v_mov_b32 v48, 0x3727c5ac
    v_fmac_f32 v48, 0x3b000000, v50
    v_rsq_f32 v48, v48
    s_nop 0
    v_fma_f32 v52, v52, v48, v16
    v_ashrrev_i32 v53, 31, v52
    v_or_b32 v53, 0x80000000, v53
    v_xor_b32 v53, v53, v52
    v_and_b32 v53, 0xfffff800, v53
    v_or_b32 v18, s69, v53
    v_max3_u32 v19, v17, v18, 1
    ds_write_b32 v47, v19
    s_waitcnt lgkmcnt(0)
    s_barrier
    ds_read_b128 v[52:55], v102
    v_pk_mul_f32 v[88:89], v[88:89], v[48:49] op_sel_hi:[1,0]
    v_pk_mul_f32 v[90:91], v[90:91], v[48:49] op_sel_hi:[1,0]
    v_pk_mul_f32 v[92:93], v[92:93], v[48:49] op_sel_hi:[1,0]
    v_pk_mul_f32 v[94:95], v[94:95], v[48:49] op_sel_hi:[1,0]
    v_pk_fma_f32 v[88:89], v[88:89], v[168:169], v[176:177]
    v_pk_fma_f32 v[90:91], v[90:91], v[170:171], v[178:179]
    v_pk_fma_f32 v[92:93], v[92:93], v[172:173], v[180:181]
    v_pk_fma_f32 v[94:95], v[94:95], v[174:175], v[182:183]
    v_cvt_pk_bf16_f32 v24, v88, v89
    v_cvt_pk_bf16_f32 v25, v90, v91
    v_cvt_pk_bf16_f32 v26, v92, v93
    v_cvt_pk_bf16_f32 v27, v94, v95
    s_waitcnt lgkmcnt(0)
    v_max_u32 v52, v52, v53
    v_max3_u32 v52, v52, v54, v55
    v_cmp_eq_u32 vcc, v52, v19
    s_cbranch_vccz L_notbest
    buffer_store_dword v19, v5, s[8:11], s100 offen sc0 sc1
    v_cmp_gt_u32 vcc, v17, v18
    s_nop 1
    v_cndmask_b32 v28, v24, v20, vcc
    v_cndmask_b32 v40, v36, v32, vcc
    v_cndmask_b32 v29, v25, v21, vcc
    v_cndmask_b32 v41, v37, v33, vcc
    v_cndmask_b32 v30, v26, v22, vcc
    v_cndmask_b32 v42, v38, v34, vcc
    v_cndmask_b32 v31, v27, v23, vcc
    v_cndmask_b32 v43, v39, v35, vcc
    v_min_u32 v28, -2, v28
    v_min_u32 v40, -2, v40
    v_min_u32 v29, -2, v29
    v_min_u32 v41, -2, v41
    v_min_u32 v30, -2, v30
    v_min_u32 v42, -2, v42
    v_min_u32 v31, -2, v31
    v_min_u32 v43, -2, v43
    buffer_store_dwordx4 v[28:31], v1, s[8:11], s101 offen sc0 sc1
    buffer_store_dwordx4 v[40:43], v1, s[8:11], s101 offen offset:1024 sc0 sc1
L_notbest:
    buffer_load_dwordx4 v[112:115], v98, s[8:11], s17 offen
    s_add_u32 s17, s17, 4096
    buffer_load_dwordx4 v[116:119], v98, s[8:11], s17 offen
    s_add_u32 s17, s17, 2093056
    buffer_load_dwordx4 v[120:123], v98, s[8:11], s17 offen
    s_add_u32 s17, s17, 4096
    buffer_load_dwordx4 v[124:127], v98, s[8:11], s17 offen
    s_mul_i32 s17, s67, 28672
    s_add_u32 s17, s17, 8388608
    s_cmp_lt_u32 s67, 64
    s_cselect_b32 s17, s17, 2143285248
    buffer_load_dwordx4 v[128:131], v99, s[8:11], s17 offen offset:0
    buffer_load_dwordx4 v[132:135], v99, s[8:11], s17 offen offset:3584
    s_add_u32 s17, s17, 7168
    buffer_load_dwordx4 v[136:139], v99, s[8:11], s17 offen offset:0
    buffer_load_dwordx4 v[140:143], v99, s[8:11], s17 offen offset:3584
    s_add_u32 s17, s17, 7168
    buffer_load_dwordx4 v[144:147], v99, s[8:11], s17 offen offset:0
    buffer_load_dwordx4 v[148:151], v99, s[8:11], s17 offen offset:3584
    s_add_u32 s17, s17, 7168
    buffer_load_dwordx4 v[152:155], v99, s[8:11], s17 offen offset:0
    buffer_load_dwordx4 v[156:159], v99, s[8:11], s17 offen offset:3584
    v_lshlrev_b32 v72, 16, v20
    v_and_b32 v73, 0xffff0000, v20
    v_lshlrev_b32 v74, 16, v21
    v_and_b32 v75, 0xffff0000, v21
    v_lshlrev_b32 v76, 16, v22
    v_and_b32 v77, 0xffff0000, v22
    v_lshlrev_b32 v78, 16, v23
    v_and_b32 v79, 0xffff0000, v23
    v_pk_mul_f32 v[72:73], v[72:73], v[184:185]
    v_pk_mul_f32 v[74:75], v[74:75], v[186:187]
    v_pk_mul_f32 v[76:77], v[76:77], v[188:189]
    v_pk_mul_f32 v[78:79], v[78:79], v[190:191]
    v_cvt_pk_bf16_f32 v56, v72, v73
    v_cvt_pk_bf16_f32 v57, v74, v75
    v_cvt_pk_bf16_f32 v58, v76, v77
    v_cvt_pk_bf16_f32 v59, v78, v79
    v_lshlrev_b32 v72, 16, v56
    v_and_b32 v73, 0xffff0000, v56
    v_lshlrev_b32 v74, 16, v57
    v_and_b32 v75, 0xffff0000, v57
    v_lshlrev_b32 v76, 16, v58
    v_and_b32 v77, 0xffff0000, v58
    v_lshlrev_b32 v78, 16, v59
    v_and_b32 v79, 0xffff0000, v59
    v_pk_add_f32 v[72:73], v[72:73], v[64:65]
    v_pk_add_f32 v[74:75], v[74:75], v[66:67]
    v_pk_add_f32 v[76:77], v[76:77], v[68:69]
    v_pk_add_f32 v[78:79], v[78:79], v[70:71]
    v_cvt_pk_bf16_f32 v56, v72, v73
    v_cvt_pk_bf16_f32 v57, v74, v75
    v_cvt_pk_bf16_f32 v58, v76, v77
    v_cvt_pk_bf16_f32 v59, v78, v79
    v_lshlrev_b32 v88, 16, v24
    v_and_b32 v89, 0xffff0000, v24
    v_lshlrev_b32 v90, 16, v25
    v_and_b32 v91, 0xffff0000, v25
    v_lshlrev_b32 v92, 16, v26
    v_and_b32 v93, 0xffff0000, v26
    v_lshlrev_b32 v94, 16, v27
    v_and_b32 v95, 0xffff0000, v27
    v_pk_mul_f32 v[88:89], v[88:89], v[184:185]
    v_pk_mul_f32 v[90:91], v[90:91], v[186:187]
    v_pk_mul_f32 v[92:93], v[92:93], v[188:189]
    v_pk_mul_f32 v[94:95], v[94:95], v[190:191]
    v_cvt_pk_bf16_f32 v60, v88, v89
    v_cvt_pk_bf16_f32 v61, v90, v91
    v_cvt_pk_bf16_f32 v62, v92, v93
    v_cvt_pk_bf16_f32 v63, v94, v95
    v_lshlrev_b32 v88, 16, v60
    v_and_b32 v89, 0xffff0000, v60
    v_lshlrev_b32 v90, 16, v61
    v_and_b32 v91, 0xffff0000, v61
    v_lshlrev_b32 v92, 16, v62
    v_and_b32 v93, 0xffff0000, v62
    v_lshlrev_b32 v94, 16, v63
    v_and_b32 v95, 0xffff0000, v63
    v_pk_add_f32 v[88:89], v[88:89], v[80:81]
    v_pk_add_f32 v[90:91], v[90:91], v[82:83]
    v_pk_add_f32 v[92:93], v[92:93], v[84:85]
    v_pk_add_f32 v[94:95], v[94:95], v[86:87]
    v_cvt_pk_bf16_f32 v60, v88, v89
    v_cvt_pk_bf16_f32 v61, v90, v91
    v_cvt_pk_bf16_f32 v62, v92, v93
    v_cvt_pk_bf16_f32 v63, v94, v95
    v_lshlrev_b32 v4, 6, v0
    s_mov_b32 s71, 65536
    s_mov_b32 s99, 0
L_kl:
    buffer_load_dword v3, v4, s[8:11], s71 offen sc0 sc1
    s_add_u32 s99, s99, 1
    s_waitcnt vmcnt(0)
    v_cmp_eq_u32 vcc, 0, v3
    s_cbranch_vccz L_kd
    s_cmp_ge_u32 s99, 200000
    s_cbranch_scc1 L_kd
    s_mov_b64 exec, vcc
    s_sleep 2
    s_branch L_kl
L_kd:
    s_mov_b64 exec, -1
    v_max_u32_dpp v3, v3, v3 quad_perm:[1,0,3,2] row_mask:0xf bank_mask:0xf
    s_nop 1
    v_max_u32_dpp v3, v3, v3 quad_perm:[2,3,0,1] row_mask:0xf bank_mask:0xf
    s_nop 1
    v_max_u32_dpp v3, v3, v3 row_half_mirror row_mask:0xf bank_mask:0xf
    s_nop 1
    v_max_u32_dpp v3, v3, v3 row_mirror row_mask:0xf bank_mask:0xf
    v_mov_b32 v19, v3
    s_nop 1
    v_permlane16_swap_b32 v3, v19
    v_max_u32 v3, v3, v19
    v_mov_b32 v19, v3
    s_nop 1
    v_permlane32_swap_b32 v3, v19
    v_max_u32 v3, v3, v19
    ds_write_b32 v47, v3 offset:64
    s_waitcnt lgkmcnt(0)
    s_barrier
    ds_read_b128 v[52:55], v102 offset:64
    v_lshlrev_b32 v4, 2, v0
    s_waitcnt lgkmcnt(0)
    v_max_u32 v52, v52, v53
    v_max3_u32 v52, v52, v54, v55
    s_nop 0
    v_readfirstlane_b32 s71, v52
    s_and_b32 s72, s71, 2047
    s_lshr_b32 s100, s72, 7
    s_sub_u32 s101, 15, s100
    s_min_u32 s100, s100, s101
    s_lshl_b32 s100, s100, 16
    s_and_b32 s73, s72, 124
    s_lshl_b32 s73, s73, 9
    s_add_u32 s73, s73, s100
    s_add_u32 s73, s73, 524288
    buffer_load_dword v19, v4, s[8:11], s73 offen sc0 sc1
    s_lshl_b32 s100, s68, 10
    s_cmp_eq_u32 s68, s72
    s_cselect_b32 s100, 2147479552, s100
    buffer_store_dwordx2 v[56:57], v45, s[52:55], s100 offen
    buffer_store_dwordx2 v[58:59], v45, s[52:55], s100 offen offset:32
    s_lshl_b32 s100, s69, 10
    s_cmp_eq_u32 s69, s72
    s_cselect_b32 s100, 2147479552, s100
    buffer_store_dwordx2 v[60:61], v45, s[52:55], s100 offen
    buffer_store_dwordx2 v[62:63], v45, s[52:55], s100 offen offset:32
    s_cmp_ge_u32 s66, 224
    s_cbranch_scc1 L_nprod
    v_lshlrev_b32 v160, 16, v112
    v_and_b32 v161, 0xffff0000, v112
    v_lshlrev_b32 v162, 16, v113
    v_and_b32 v163, 0xffff0000, v113
    v_lshlrev_b32 v164, 16, v114
    v_and_b32 v165, 0xffff0000, v114
    v_lshlrev_b32 v166, 16, v115
    v_and_b32 v167, 0xffff0000, v115
    v_lshlrev_b32 v168, 16, v116
    v_and_b32 v169, 0xffff0000, v116
    v_lshlrev_b32 v170, 16, v117
    v_and_b32 v171, 0xffff0000, v117
    v_lshlrev_b32 v172, 16, v118
    v_and_b32 v173, 0xffff0000, v118
    v_lshlrev_b32 v174, 16, v119
    v_and_b32 v175, 0xffff0000, v119
    v_lshlrev_b32 v176, 16, v120
    v_and_b32 v177, 0xffff0000, v120
    v_lshlrev_b32 v178, 16, v121
    v_and_b32 v179, 0xffff0000, v121
    v_lshlrev_b32 v180, 16, v122
    v_and_b32 v181, 0xffff0000, v122
    v_lshlrev_b32 v182, 16, v123
    v_and_b32 v183, 0xffff0000, v123
    v_lshlrev_b32 v184, 16, v124
    v_and_b32 v185, 0xffff0000, v124
    v_lshlrev_b32 v186, 16, v125
    v_and_b32 v187, 0xffff0000, v125
    v_lshlrev_b32 v188, 16, v126
    v_and_b32 v189, 0xffff0000, v126
    v_lshlrev_b32 v190, 16, v127
    v_and_b32 v191, 0xffff0000, v127
    s_mov_b32 s99, 0
    s_waitcnt vmcnt(4)
L_hl:
    v_cmp_eq_u32 vcc, -1, v19
    s_add_u32 s99, s99, 1
    s_cbranch_vccz L_hok
    s_cmp_ge_u32 s99, 200000
    s_cbranch_scc1 L_hok
    buffer_load_dword v19, v4, s[8:11], s73 offen sc0 sc1
    s_waitcnt vmcnt(0)
    s_branch L_hl
L_hok:
    v_lshlrev_b32 v48, 16, v19
    v_and_b32 v50, 0xffff0000, v19
    v_pk_mul_f32 v[64:65], v[160:161], v[48:49] op_sel_hi:[1,0]
    v_pk_mul_f32 v[66:67], v[162:163], v[48:49] op_sel_hi:[1,0]
    v_pk_mul_f32 v[68:69], v[164:165], v[48:49] op_sel_hi:[1,0]
    v_pk_mul_f32 v[70:71], v[166:167], v[48:49] op_sel_hi:[1,0]
    v_pk_mul_f32 v[72:73], v[176:177], v[48:49] op_sel_hi:[1,0]
    v_pk_mul_f32 v[74:75], v[178:179], v[48:49] op_sel_hi:[1,0]
    v_pk_mul_f32 v[76:77], v[180:181], v[48:49] op_sel_hi:[1,0]
    v_pk_mul_f32 v[78:79], v[182:183], v[48:49] op_sel_hi:[1,0]
    v_pk_fma_f32 v[64:65], v[168:169], v[50:51], v[64:65] op_sel_hi:[1,0,1]
    v_pk_fma_f32 v[66:67], v[170:171], v[50:51], v[66:67] op_sel_hi:[1,0,1]
    v_pk_fma_f32 v[68:69], v[172:173], v[50:51], v[68:69] op_sel_hi:[1,0,1]
    v_pk_fma_f32 v[70:71], v[174:175], v[50:51], v[70:71] op_sel_hi:[1,0,1]
    v_pk_fma_f32 v[72:73], v[184:185], v[50:51], v[72:73] op_sel_hi:[1,0,1]
    v_pk_fma_f32 v[74:75], v[186:187], v[50:51], v[74:75] op_sel_hi:[1,0,1]
    v_pk_fma_f32 v[76:77], v[188:189], v[50:51], v[76:77] op_sel_hi:[1,0,1]
    v_pk_fma_f32 v[78:79], v[190:191], v[50:51], v[78:79] op_sel_hi:[1,0,1]
    v_permlane32_swap_b32 v64, v72
    v_permlane32_swap_b32 v65, v73
    v_permlane32_swap_b32 v66, v74
    v_permlane32_swap_b32 v67, v75
    v_permlane32_swap_b32 v68, v76
    v_permlane32_swap_b32 v69, v77
    v_permlane32_swap_b32 v70, v78
    v_permlane32_swap_b32 v71, v79
    v_add_f32 v64, v64, v72
    v_add_f32 v65, v65, v73
    v_add_f32 v66, v66, v74
    v_add_f32 v67, v67, v75
    v_add_f32 v68, v68, v76
    v_add_f32 v69, v69, v77
    v_add_f32 v70, v70, v78
    v_add_f32 v71, v71, v79
    v_permlane16_swap_b32 v64, v68
    v_permlane16_swap_b32 v65, v69
    v_permlane16_swap_b32 v66, v70
    v_permlane16_swap_b32 v67, v71
    v_add_f32 v64, v64, v68
    v_add_f32 v65, v65, v69
    v_add_f32 v66, v66, v70
    v_add_f32 v67, v67, v71
    v_add_f32_dpp v64, v64, v64 quad_perm:[1,0,3,2] row_mask:0xf bank_mask:0xf
    v_add_f32_dpp v65, v65, v65 quad_perm:[1,0,3,2] row_mask:0xf bank_mask:0xf
    v_add_f32_dpp v66, v66, v66 quad_perm:[1,0,3,2] row_mask:0xf bank_mask:0xf
    v_add_f32_dpp v67, v67, v67 quad_perm:[1,0,3,2] row_mask:0xf bank_mask:0xf
    v_add_f32_dpp v64, v64, v64 quad_perm:[2,3,0,1] row_mask:0xf bank_mask:0xf
    v_add_f32_dpp v65, v65, v65 quad_perm:[2,3,0,1] row_mask:0xf bank_mask:0xf
    v_add_f32_dpp v66, v66, v66 quad_perm:[2,3,0,1] row_mask:0xf bank_mask:0xf
    v_add_f32_dpp v67, v67, v67 quad_perm:[2,3,0,1] row_mask:0xf bank_mask:0xf
    v_add_f32_dpp v64, v64, v64 row_half_mirror row_mask:0xf bank_mask:0xf
    v_add_f32_dpp v65, v65, v65 row_half_mirror row_mask:0xf bank_mask:0xf
    v_add_f32_dpp v66, v66, v66 row_half_mirror row_mask:0xf bank_mask:0xf
    v_add_f32_dpp v67, v67, v67 row_half_mirror row_mask:0xf bank_mask:0xf
    v_add_f32_dpp v64, v64, v64 row_mirror row_mask:0xf bank_mask:0xf
    v_add_f32_dpp v65, v65, v65 row_mirror row_mask:0xf bank_mask:0xf
    v_add_f32_dpp v66, v66, v66 row_mirror row_mask:0xf bank_mask:0xf
    v_add_f32_dpp v67, v67, v67 row_mirror row_mask:0xf bank_mask:0xf
    v_and_b32 v50, 15, v2
    v_cmp_eq_u32 vcc, 0, v50
    v_mov_b32 v51, 1024
    s_nop 0
    v_cndmask_b32 v51, v51, v0, vcc
    ds_write_b128 v51, v[64:67] offset:256
    v_lshlrev_b32 v50, 2, v50
    s_waitcnt lgkmcnt(0)
    s_barrier
    s_cmp_lg_u32 s3, 0
    s_cbranch_scc1 L_nprod
    ds_read_b32 v64, v50 offset:256
    ds_read_b32 v65, v50 offset:320
    ds_read_b32 v66, v50 offset:384
    ds_read_b32 v67, v50 offset:448
    v_cmp_gt_u32 vcc, 8, v2
    v_mov_b32 v51, 2147479552
    s_nop 0
    v_cndmask_b32 v51, v51, v50, vcc
    s_lshl_b32 s100, s66, 6
    s_add_u32 s100, s100, 81920
    s_waitcnt lgkmcnt(2)
    v_add_f32 v64, v64, v65
    s_waitcnt lgkmcnt(0)
    v_add_f32 v66, v66, v67
    v_add_f32 v64, v64, v66
    v_cvt_pk_bf16_f32 v64, v64, v64
    v_and_b32 v64, 0xffff0000, v64
    s_nop 1
    v_mov_b32_dpp v65, v64 row_ror:8 row_mask:0xf bank_mask:0xf
    v_mul_f32 v66, 0xbfb8aa3b, v64
    v_exp_f32 v66, v66
    s_nop 0
    v_add_f32 v66, 1.0, v66
    v_rcp_f32 v66, v66
    s_nop 0
    v_mul_f32 v64, v64, v66
    v_cvt_pk_bf16_f32 v64, v64, v64
    v_and_b32 v64, 0xffff0000, v64
    v_mul_f32 v64, v64, v65
    v_cvt_pk_bf16_f32 v64, v64, v64
    v_and_b32 v64, 0xffff0000, v64
    buffer_store_dword v64, v51, s[8:11], s100 offen sc0 sc1
L_nprod:
    s_cmp_ge_u32 s67, 64
    s_cbranch_scc1 L_fin
    v_lshlrev_b32 v4, 6, v0
    v_cmp_gt_u32 vcc, 224, v0
    v_mov_b32 v51, 2147479552
    s_nop 0
    v_cndmask_b32 v4, v51, v4, vcc
    s_mov_b32 s100, 81920
    v_and_b32 v52, 7, v2
    s_lshl_b32 s101, s67, 3
    v_add_u32 v52, s101, v52
    v_lshrrev_b32 v53, 5, v52
    v_lshlrev_b32 v53, 6, v53
    v_and_b32 v54, 12, v52
    v_lshl_add_u32 v53, v54, 2, v53
    v_bfe_u32 v54, v52, 4, 1
    v_lshl_add_u32 v53, v54, 3, v53
    v_and_b32 v54, 2, v52
    v_lshl_add_u32 v53, v54, 1, v53
    v_lshlrev_b32 v54, 2, v52
    s_mov_b32 s101, 10240
    buffer_load_dword v55, v54, s[8:11], s101 offen
    buffer_load_dword v88, v53, s[8:11], s73 offen sc0 sc1
    buffer_load_dword v89, v53, s[8:11], s73 offen offset:1024 sc0 sc1
    v_lshlrev_b32 v192, 16, v128
    v_and_b32 v193, 0xffff0000, v128
    v_lshlrev_b32 v194, 16, v129
    v_and_b32 v195, 0xffff0000, v129
    v_lshlrev_b32 v196, 16, v130
    v_and_b32 v197, 0xffff0000, v130
    v_lshlrev_b32 v198, 16, v131
    v_and_b32 v199, 0xffff0000, v131
    v_lshlrev_b32 v200, 16, v132
    v_and_b32 v201, 0xffff0000, v132
    v_lshlrev_b32 v202, 16, v133
    v_and_b32 v203, 0xffff0000, v133
    v_lshlrev_b32 v204, 16, v134
    v_and_b32 v205, 0xffff0000, v134
    v_lshlrev_b32 v206, 16, v135
    v_and_b32 v207, 0xffff0000, v135
    v_lshlrev_b32 v208, 16, v136
    v_and_b32 v209, 0xffff0000, v136
    v_lshlrev_b32 v210, 16, v137
    v_and_b32 v211, 0xffff0000, v137
    v_lshlrev_b32 v212, 16, v138
    v_and_b32 v213, 0xffff0000, v138
    v_lshlrev_b32 v214, 16, v139
    v_and_b32 v215, 0xffff0000, v139
    v_lshlrev_b32 v216, 16, v140
    v_and_b32 v217, 0xffff0000, v140
    v_lshlrev_b32 v218, 16, v141
    v_and_b32 v219, 0xffff0000, v141
    v_lshlrev_b32 v220, 16, v142
    v_and_b32 v221, 0xffff0000, v142
    v_lshlrev_b32 v222, 16, v143
    v_and_b32 v223, 0xffff0000, v143
    v_lshlrev_b32 v224, 16, v144
    v_and_b32 v225, 0xffff0000, v144
    v_lshlrev_b32 v226, 16, v145
    v_and_b32 v227, 0xffff0000, v145
    v_lshlrev_b32 v228, 16, v146
    v_and_b32 v229, 0xffff0000, v146
    v_lshlrev_b32 v230, 16, v147
    v_and_b32 v231, 0xffff0000, v147
    v_lshlrev_b32 v232, 16, v148
    v_and_b32 v233, 0xffff0000, v148
    v_lshlrev_b32 v234, 16, v149
    v_and_b32 v235, 0xffff0000, v149
    v_lshlrev_b32 v236, 16, v150
    v_and_b32 v237, 0xffff0000, v150
    v_lshlrev_b32 v238, 16, v151
    v_and_b32 v239, 0xffff0000, v151
    v_lshlrev_b32 v240, 16, v152
    v_and_b32 v241, 0xffff0000, v152
    v_lshlrev_b32 v242, 16, v153
    v_and_b32 v243, 0xffff0000, v153
    v_lshlrev_b32 v244, 16, v154
    v_and_b32 v245, 0xffff0000, v154
    v_lshlrev_b32 v246, 16, v155
    v_and_b32 v247, 0xffff0000, v155
    v_lshlrev_b32 v248, 16, v156
    v_and_b32 v249, 0xffff0000, v156
    v_lshlrev_b32 v250, 16, v157
    v_and_b32 v251, 0xffff0000, v157
    v_lshlrev_b32 v252, 16, v158
    v_and_b32 v253, 0xffff0000, v158
    v_lshlrev_b32 v254, 16, v159
    v_and_b32 v255, 0xffff0000, v159
    s_and_b32 s101, s71, 0xfffff800
    s_or_b32 s101, s101, 0x400
    v_mov_b32 v90, s101
    v_not_b32 v91, v90
    v_ashrrev_i32 v91, 31, v91
    v_or_b32 v91, 0x80000000, v91
    v_xor_b32 v90, v90, v91
    v_cvt_pk_bf16_f32 v90, v90, v90
    v_and_b32 v90, 0xffff0000, v90
    v_mul_f32 v90, 0xbfb8aa3b, v90
    v_exp_f32 v90, v90
    s_nop 0
    v_add_f32 v90, 1.0, v90
    v_rcp_f32 v90, v90
    s_nop 0
    v_cvt_pk_bf16_f32 v90, v90, v90
    v_and_b32 v90, 0xffff0000, v90
    s_mov_b32 s99, 0
L_CND_l_27:
    s_waitcnt vmcnt(0)
    v_max_u32 v3, v88, v89
    v_cmp_eq_u32 vcc, -1, v3
    s_add_u32 s99, s99, 1
    s_cbranch_vccz L_CND_ok_28
    s_cmp_ge_u32 s99, 200000
    s_cbranch_scc1 L_CND_ok_28
    s_mov_b64 exec, vcc
    s_sleep 1
    buffer_load_dword v88, v53, s[8:11], s73 offen sc0 sc1
    buffer_load_dword v89, v53, s[8:11], s73 offen offset:1024 sc0 sc1
    s_branch L_CND_l_27
L_CND_ok_28:
    s_mov_b64 exec, -1
    v_and_b32 v51, 1, v52
    v_cmp_eq_u32 vcc, 0, v51
    v_lshlrev_b32 v91, 16, v88
    v_and_b32 v88, 0xffff0000, v88
    v_cndmask_b32 v88, v88, v91, vcc
    v_lshlrev_b32 v91, 16, v89
    v_and_b32 v89, 0xffff0000, v89
    v_cndmask_b32 v89, v89, v91, vcc
    v_and_b32 v50, 15, v2
    v_cmp_eq_u32 vcc, 0, v50
    v_lshrrev_b32 v51, 1, v0
    v_mov_b32 v50, 1024
    v_cndmask_b32 v51, v50, v51, vcc
    v_and_b32 v50, 7, v2
    v_lshlrev_b32 v50, 2, v50
    v_cmp_gt_u32 vcc, 8, v2
    v_lshlrev_b32 v52, 1, v52
    v_mov_b32 v53, 2147479552
    v_cndmask_b32 v52, v53, v52, vcc
    s_cmp_lt_u32 s66, 224
    s_cbranch_scc1 L_asl
    s_sleep 16
L_asl:
    s_sleep 7
    buffer_load_dwordx4 v[80:83], v4, s[8:11], s100 offen sc0 sc1
    buffer_load_dwordx4 v[84:87], v4, s[8:11], s100 offen offset:16 sc0 sc1
    s_mov_b32 s99, 0
L_ACT_l_29:
    s_waitcnt vmcnt(0)
    v_max_u32 v3, v80, v81
    v_max3_u32 v3, v3, v82, v83
    v_max3_u32 v3, v3, v84, v85
    v_max3_u32 v3, v3, v86, v87
    v_cmp_eq_u32 vcc, -1, v3
    s_add_u32 s99, s99, 1
    s_cbranch_vccz L_ACT_ok_30
    s_cmp_ge_u32 s99, 200000
    s_cbranch_scc1 L_ACT_ok_30
    s_mov_b64 exec, vcc
    s_sleep 2
    buffer_load_dwordx4 v[80:83], v4, s[8:11], s100 offen sc0 sc1
    buffer_load_dwordx4 v[84:87], v4, s[8:11], s100 offen offset:16 sc0 sc1
    s_branch L_ACT_l_29
L_ACT_ok_30:
    s_mov_b64 exec, -1
    v_pk_mul_f32 v[64:65], v[192:193], v[80:81] op_sel_hi:[1,0]
    v_pk_mul_f32 v[66:67], v[194:195], v[80:81] op_sel_hi:[1,0]
    v_pk_mul_f32 v[68:69], v[196:197], v[80:81] op_sel_hi:[1,0]
    v_pk_mul_f32 v[70:71], v[198:199], v[80:81] op_sel_hi:[1,0]
    v_pk_fma_f32 v[64:65], v[200:201], v[80:81], v[64:65] op_sel:[0,1,0] op_sel_hi:[1,1,1]
    v_pk_fma_f32 v[66:67], v[202:203], v[80:81], v[66:67] op_sel:[0,1,0] op_sel_hi:[1,1,1]
    v_pk_fma_f32 v[68:69], v[204:205], v[80:81], v[68:69] op_sel:[0,1,0] op_sel_hi:[1,1,1]
    v_pk_fma_f32 v[70:71], v[206:207], v[80:81], v[70:71] op_sel:[0,1,0] op_sel_hi:[1,1,1]
    v_pk_fma_f32 v[64:65], v[208:209], v[82:83], v[64:65] op_sel:[0,0,0] op_sel_hi:[1,0,1]
    v_pk_fma_f32 v[66:67], v[210:211], v[82:83], v[66:67] op_sel:[0,0,0] op_sel_hi:[1,0,1]
    v_pk_fma_f32 v[68:69], v[212:213], v[82:83], v[68:69] op_sel:[0,0,0] op_sel_hi:[1,0,1]
    v_pk_fma_f32 v[70:71], v[214:215], v[82:83], v[70:71] op_sel:[0,0,0] op_sel_hi:[1,0,1]
    v_pk_fma_f32 v[64:65], v[216:217], v[82:83], v[64:65] op_sel:[0,1,0] op_sel_hi:[1,1,1]
    v_pk_fma_f32 v[66:67], v[218:219], v[82:83], v[66:67] op_sel:[0,1,0] op_sel_hi:[1,1,1]
    v_pk_fma_f32 v[68:69], v[220:221], v[82:83], v[68:69] op_sel:[0,1,0] op_sel_hi:[1,1,1]
    v_pk_fma_f32 v[70:71], v[222:223], v[82:83], v[70:71] op_sel:[0,1,0] op_sel_hi:[1,1,1]
    v_pk_fma_f32 v[64:65], v[224:225], v[84:85], v[64:65] op_sel:[0,0,0] op_sel_hi:[1,0,1]
    v_pk_fma_f32 v[66:67], v[226:227], v[84:85], v[66:67] op_sel:[0,0,0] op_sel_hi:[1,0,1]
    v_pk_fma_f32 v[68:69], v[228:229], v[84:85], v[68:69] op_sel:[0,0,0] op_sel_hi:[1,0,1]
    v_pk_fma_f32 v[70:71], v[230:231], v[84:85], v[70:71] op_sel:[0,0,0] op_sel_hi:[1,0,1]
    v_pk_fma_f32 v[64:65], v[232:233], v[84:85], v[64:65] op_sel:[0,1,0] op_sel_hi:[1,1,1]
    v_pk_fma_f32 v[66:67], v[234:235], v[84:85], v[66:67] op_sel:[0,1,0] op_sel_hi:[1,1,1]
    v_pk_fma_f32 v[68:69], v[236:237], v[84:85], v[68:69] op_sel:[0,1,0] op_sel_hi:[1,1,1]
    v_pk_fma_f32 v[70:71], v[238:239], v[84:85], v[70:71] op_sel:[0,1,0] op_sel_hi:[1,1,1]
    v_pk_fma_f32 v[64:65], v[240:241], v[86:87], v[64:65] op_sel:[0,0,0] op_sel_hi:[1,0,1]
    v_pk_fma_f32 v[66:67], v[242:243], v[86:87], v[66:67] op_sel:[0,0,0] op_sel_hi:[1,0,1]
    v_pk_fma_f32 v[68:69], v[244:245], v[86:87], v[68:69] op_sel:[0,0,0] op_sel_hi:[1,0,1]
    v_pk_fma_f32 v[70:71], v[246:247], v[86:87], v[70:71] op_sel:[0,0,0] op_sel_hi:[1,0,1]
    v_pk_fma_f32 v[64:65], v[248:249], v[86:87], v[64:65] op_sel:[0,1,0] op_sel_hi:[1,1,1]
    v_pk_fma_f32 v[66:67], v[250:251], v[86:87], v[66:67] op_sel:[0,1,0] op_sel_hi:[1,1,1]
    v_pk_fma_f32 v[68:69], v[252:253], v[86:87], v[68:69] op_sel:[0,1,0] op_sel_hi:[1,1,1]
    v_pk_fma_f32 v[70:71], v[254:255], v[86:87], v[70:71] op_sel:[0,1,0] op_sel_hi:[1,1,1]
    s_nop 0
    v_permlane32_swap_b32 v64, v68
    v_permlane32_swap_b32 v65, v69
    v_permlane32_swap_b32 v66, v70
    v_permlane32_swap_b32 v67, v71
    v_add_f32 v64, v64, v68
    v_add_f32 v65, v65, v69
    v_add_f32 v66, v66, v70
    v_add_f32 v67, v67, v71
    s_nop 0
    v_permlane16_swap_b32 v64, v66
    v_permlane16_swap_b32 v65, v67
    v_add_f32 v64, v64, v66
    v_add_f32 v65, v65, v67
    s_nop 0
    v_add_f32_dpp v64, v64, v64 quad_perm:[1,0,3,2] row_mask:0xf bank_mask:0xf
    v_add_f32_dpp v65, v65, v65 quad_perm:[1,0,3,2] row_mask:0xf bank_mask:0xf
    s_nop 0
    v_add_f32_dpp v64, v64, v64 quad_perm:[2,3,0,1] row_mask:0xf bank_mask:0xf
    v_add_f32_dpp v65, v65, v65 quad_perm:[2,3,0,1] row_mask:0xf bank_mask:0xf
    s_nop 0
    v_add_f32_dpp v64, v64, v64 row_half_mirror row_mask:0xf bank_mask:0xf
    v_add_f32_dpp v65, v65, v65 row_half_mirror row_mask:0xf bank_mask:0xf
    s_nop 0
    v_add_f32_dpp v64, v64, v64 row_mirror row_mask:0xf bank_mask:0xf
    v_add_f32_dpp v65, v65, v65 row_mirror row_mask:0xf bank_mask:0xf
    ds_write_b64 v51, v[64:65] offset:2048
    s_waitcnt lgkmcnt(0)
    s_barrier
    s_cmp_lg_u32 s3, 0
    s_cbranch_scc1 L_fin
    ds_read_b32 v64, v50 offset:2048
    ds_read_b32 v65, v50 offset:2080
    ds_read_b32 v66, v50 offset:2112
    ds_read_b32 v67, v50 offset:2144
    s_lshl_b32 s100, s72, 10
    s_waitcnt lgkmcnt(2)
    v_add_f32 v64, v64, v65
    s_waitcnt lgkmcnt(0)
    v_add_f32 v66, v66, v67
    v_add_f32 v64, v64, v66
    v_cvt_pk_bf16_f32 v64, v64, v64
    v_and_b32 v64, 0xffff0000, v64
    v_mul_f32 v64, v64, v90
    v_cvt_pk_bf16_f32 v64, v64, v64
    v_and_b32 v64, 0xffff0000, v64
    v_add_f32 v64, v64, v88
    v_cvt_pk_bf16_f32 v64, v64, v64
    v_and_b32 v64, 0xffff0000, v64
    v_mul_f32 v64, v64, v55
    v_cvt_pk_bf16_f32 v64, v64, v64
    v_and_b32 v64, 0xffff0000, v64
    v_add_f32 v64, v64, v89
    v_cvt_pk_bf16_f32 v64, v64, v64
    buffer_store_short v64, v52, s[52:55], s100 offen
L_fin:
L_end:
    s_endpgm
L_E_slow_1:
    s_mov_b32 s99, 0
L_E_slow_1_l:
    s_sleep 4
    buffer_load_dword v3, v4, s[36:39], s67 offen sc0 sc1
    s_add_u32 s99, s99, 1
    s_waitcnt vmcnt(0)
    v_cmp_le_u32 vcc, s68, v3
    s_cmp_eq_u64 vcc, -1
    s_cbranch_scc1 L_E_ok_2
    s_cmp_lt_u32 s99, 200000
    s_cbranch_scc1 L_E_slow_1_l
    s_branch L_E_ok_2
L_H_slow_3:
    s_mov_b32 s99, 0
L_H_slow_3_l:
    s_sleep 4
    buffer_load_dword v3, v16, s[8:11], s78 offen sc0 sc1
    s_add_u32 s99, s99, 1
    s_waitcnt vmcnt(0)
    v_cmp_ne_u32 vcc, 0, v3
    s_cmp_eq_u64 vcc, -1
    s_cbranch_scc1 L_H_ok_4
    s_cmp_lt_u32 s99, 200000
    s_cbranch_scc1 L_H_slow_3_l
    s_branch L_H_ok_4
L_E2_slow_5:
    s_mov_b32 s99, 0
L_E2_slow_5_l:
    s_sleep 4
    buffer_load_dword v118, v119, s[8:11], s69 offen sc0 sc1
    s_add_u32 s99, s99, 1
    s_waitcnt vmcnt(0)
    v_cmp_ne_u32 vcc, 0, v118
    s_cmp_eq_u64 vcc, -1
    s_cbranch_scc1 L_E2_ok_6
    s_cmp_lt_u32 s99, 200000
    s_cbranch_scc1 L_E2_slow_5_l
    s_branch L_E2_ok_6
L_KV_slow_7:
    s_mov_b32 s99, 0
L_KV_slow_7_l:
    s_sleep 4
    buffer_load_dword v3, v17, s[8:11], s74 offen sc0 sc1
    s_add_u32 s99, s99, 1
    s_waitcnt vmcnt(0)
    v_cmp_ne_u32 vcc, 0, v3
    s_cmp_eq_u64 vcc, -1
    s_cbranch_scc1 L_KV_ok_8
    s_cmp_lt_u32 s99, 200000
    s_cbranch_scc1 L_KV_slow_7_l
    s_branch L_KV_ok_8
L_t1_start:
    v_mfma_f32_16x16x32_bf16 v[96:99], a[128:131], a[64:67], v[96:99]
    s_add_u32 s19, s82, 32768
    s_sub_u32 s82, s12, s13
    s_sub_u32 s82, s82, 1
    v_mfma_f32_16x16x32_bf16 v[96:99], a[132:135], a[68:71], v[96:99]
    s_cmp_gt_u32 s12, s13
    s_cselect_b32 s82, s82, s12
    s_lshl_b32 s82, s82, 16
    s_add_u32 s82, s82, s81
    v_mfma_f32_16x16x32_bf16 v[96:99], a[136:139], a[72:75], v[96:99]
    s_cmp_ge_u32 s12, 17
    s_cselect_b32 s82, 2147471360, s82
    s_add_u32 s12, s12, 1
    s_sub_u32 s14, s60, 1
    v_mfma_f32_16x16x32_bf16 v[96:99], a[140:143], a[76:79], v[96:99]
    v_mfma_f32_16x16x32_bf16 v[100:103], a[144:147], a[64:67], v[100:103]
    v_mfma_f32_16x16x32_bf16 v[100:103], a[148:151], a[68:71], v[100:103]
    v_mfma_f32_16x16x32_bf16 v[100:103], a[152:155], a[72:75], v[100:103]
    v_mfma_f32_16x16x32_bf16 v[100:103], a[156:159], a[76:79], v[100:103]
    v_mfma_f32_16x16x32_bf16 v[104:107], a[128:131], a[80:83], v[104:107]
    s_nop 2
    v_exp_f32 v96, v96
    v_mfma_f32_16x16x32_bf16 v[104:107], a[132:135], a[84:87], v[104:107]
    v_exp_f32 v97, v97
    v_mfma_f32_16x16x32_bf16 v[104:107], a[136:139], a[88:91], v[104:107]
    v_exp_f32 v98, v98
    v_mfma_f32_16x16x32_bf16 v[104:107], a[140:143], a[92:95], v[104:107]
    v_exp_f32 v99, v99
    v_mfma_f32_16x16x32_bf16 v[108:111], a[144:147], a[80:83], v[108:111]
    v_exp_f32 v100, v100
    v_mfma_f32_16x16x32_bf16 v[108:111], a[148:151], a[84:87], v[108:111]
    v_exp_f32 v101, v101
    v_mfma_f32_16x16x32_bf16 v[108:111], a[152:155], a[88:91], v[108:111]
    v_exp_f32 v102, v102
    v_mfma_f32_16x16x32_bf16 v[108:111], a[156:159], a[92:95], v[108:111]
    v_exp_f32 v103, v103
    v_mfma_f32_16x16x32_bf16 v[112:115], a[128:131], a[96:99], v[72:75]
    v_exp_f32 v104, v104
    v_mfma_f32_16x16x32_bf16 v[112:115], a[132:135], a[100:103], v[112:115]
    v_exp_f32 v105, v105
    v_mfma_f32_16x16x32_bf16 v[112:115], a[136:139], a[104:107], v[112:115]
    v_exp_f32 v106, v106
    v_mfma_f32_16x16x32_bf16 v[112:115], a[140:143], a[108:111], v[112:115]
    v_exp_f32 v107, v107
    v_mfma_f32_16x16x32_bf16 v[120:123], a[128:131], a[112:115], v[76:79]
    v_exp_f32 v108, v108
    v_mfma_f32_16x16x32_bf16 v[120:123], a[132:135], a[116:119], v[120:123]
    v_exp_f32 v109, v109
    v_mfma_f32_16x16x32_bf16 v[120:123], a[136:139], a[120:123], v[120:123]
    v_exp_f32 v110, v110
    v_mfma_f32_16x16x32_bf16 v[120:123], a[140:143], a[124:127], v[120:123]
    v_exp_f32 v111, v111
    v_mfma_f32_16x16x32_bf16 v[116:119], a[144:147], a[96:99], v[72:75]
    ds_read_b128 a[128:131], v18 offset:16384
    v_cvt_pk_bf16_f32 v48, v96, v97
    v_mfma_f32_16x16x32_bf16 v[116:119], a[148:151], a[100:103], v[116:119]
    ds_read_b128 a[132:135], v18 offset:17408
    v_cvt_pk_bf16_f32 v49, v98, v99
    v_mfma_f32_16x16x32_bf16 v[116:119], a[152:155], a[104:107], v[116:119]
    ds_read_b128 a[136:139], v18 offset:18432
    v_cvt_pk_bf16_f32 v50, v100, v101
    v_mfma_f32_16x16x32_bf16 v[116:119], a[156:159], a[108:111], v[116:119]
    ds_read_b128 a[140:143], v18 offset:19456
    v_cvt_pk_bf16_f32 v51, v102, v103
    v_mfma_f32_16x16x32_bf16 v[124:127], a[144:147], a[112:115], v[76:79]
    ds_read_b128 a[144:147], v18 offset:20480
    v_cvt_pk_bf16_f32 v52, v104, v105
    v_mfma_f32_16x16x32_bf16 v[124:127], a[148:151], a[116:119], v[124:127]
    ds_read_b128 a[148:151], v18 offset:21504
    v_cvt_pk_bf16_f32 v53, v106, v107
    v_mfma_f32_16x16x32_bf16 v[124:127], a[152:155], a[120:123], v[124:127]
    ds_read_b128 a[152:155], v18 offset:22528
    v_cvt_pk_bf16_f32 v54, v108, v109
    v_mfma_f32_16x16x32_bf16 v[124:127], a[156:159], a[124:127], v[124:127]
    ds_read_b128 a[156:159], v18 offset:23552
    v_cvt_pk_bf16_f32 v55, v110, v111
    v_xor_b32 v18, 196608, v18
    s_branch L_t1_p1
L_t1_zero:
    v_mfma_f32_16x16x32_bf16 v[96:99], a[128:131], a[96:99], v[80:83]
    s_xor_b32 s100, s16, 8192
    ds_read_b128 a[176:179], v20 offset:4096
    v_lshrrev_b32 v13, 1, v1
    v_mfma_f32_16x16x32_bf16 v[96:99], a[132:135], a[100:103], v[96:99]
    s_add_u32 m0, s15, 0
    ds_read_b128 a[180:183], v20 offset:5120
    v_add_u32 v12, s100, v13
    v_mfma_f32_16x16x32_bf16 v[96:99], a[136:139], a[104:107], v[96:99]
    buffer_load_dwordx4 v1, s[8:11], s82 offen offset:0 lds
    v_exp_f32 v112, v112
    v_mfma_f32_16x16x32_bf16 v[96:99], a[140:143], a[108:111], v[96:99]
    v_exp_f32 v113, v113
    v_mfma_f32_16x16x32_bf16 v[100:103], a[144:147], a[96:99], v[84:87]
    ds_read_b128 a[184:187], v20 offset:6144
    v_cvt_pk_bf16_f32 v56, v112, v113
    v_mfma_f32_16x16x32_bf16 v[100:103], a[148:151], a[100:103], v[100:103]
    v_exp_f32 v114, v114
    v_mfma_f32_16x16x32_bf16 v[100:103], a[152:155], a[104:107], v[100:103]
    buffer_load_dwordx4 v1, s[8:11], s82 offen offset:1024 lds
    v_exp_f32 v115, v115
    v_mfma_f32_16x16x32_bf16 v[100:103], a[156:159], a[108:111], v[100:103]
    ds_read_b128 a[188:191], v20 offset:7168
    v_cvt_pk_bf16_f32 v57, v114, v115
    v_mfma_f32_16x16x32_bf16 v[104:107], a[128:131], a[112:115], v[88:91]
    v_exp_f32 v116, v116
    v_mfma_f32_16x16x32_bf16 v[104:107], a[132:135], a[116:119], v[104:107]
    v_exp_f32 v117, v117
    v_mfma_f32_16x16x32_bf16 v[104:107], a[136:139], a[120:123], v[104:107]
    ds_read_b128 a[160:163], v19 offset:0
    v_cvt_pk_bf16_f32 v58, v116, v117
    v_mfma_f32_16x16x32_bf16 v[104:107], a[140:143], a[124:127], v[104:107]
    buffer_load_dwordx4 v1, s[8:11], s82 offen offset:2048 lds
    v_exp_f32 v118, v118
    v_mfma_f32_16x16x32_bf16 v[108:111], a[144:147], a[112:115], v[92:95]
    v_exp_f32 v119, v119
    v_mfma_f32_16x16x32_bf16 v[108:111], a[148:151], a[116:119], v[108:111]
    ds_read_b128 a[164:167], v19 offset:1024
    v_cvt_pk_bf16_f32 v59, v118, v119
    v_mfma_f32_16x16x32_bf16 v[108:111], a[152:155], a[120:123], v[108:111]
    v_exp_f32 v120, v120
    v_mfma_f32_16x16x32_bf16 v[108:111], a[156:159], a[124:127], v[108:111]
    buffer_load_dwordx4 v1, s[8:11], s82 offen offset:3072 lds
    v_exp_f32 v121, v121
    v_mfma_f32_16x16x32_bf16 v[32:35], v[28:31], v[48:51], 0
    s_add_u32 m0, s15, 4096
    ds_read_b128 a[168:171], v19 offset:2048
    v_cvt_pk_bf16_f32 v60, v120, v121
    v_mfma_f32_16x16x32_bf16 v[36:39], v[28:31], v[52:55], 0
    s_waitcnt lgkmcnt(6)
    v_exp_f32 v122, v122
    v_mfma_f32_16x16x32_bf16 v[144:147], a[176:179], v[48:51], 0
    v_exp_f32 v123, v123
    v_mfma_f32_16x16x32_bf16 v[176:179], a[176:179], v[52:55], 0
    s_waitcnt lgkmcnt(5)
    ds_read_b128 a[172:175], v19 offset:3072
    v_cvt_pk_bf16_f32 v61, v122, v123
    v_mfma_f32_16x16x32_bf16 v[148:151], a[180:183], v[48:51], 0
    buffer_load_dwordx4 v15, s[8:11], s82 offen offset:0 lds
    v_exp_f32 v124, v124
    v_mfma_f32_16x16x32_bf16 v[180:183], a[180:183], v[52:55], 0
    s_waitcnt lgkmcnt(5)
    v_exp_f32 v125, v125
    v_mfma_f32_16x16x32_bf16 v[152:155], a[184:187], v[48:51], 0
    s_waitcnt lgkmcnt(4)
    v_exp_f32 v126, v126
    v_mfma_f32_16x16x32_bf16 v[184:187], a[184:187], v[52:55], 0
    buffer_load_dwordx4 v15, s[8:11], s82 offen offset:1024 lds
    v_exp_f32 v127, v127
    v_mfma_f32_16x16x32_bf16 v[156:159], a[188:191], v[48:51], 0
    ds_write_b128 v16, v[144:147] offset:32768
    v_cvt_pk_bf16_f32 v62, v124, v125
    v_mfma_f32_16x16x32_bf16 v[188:191], a[188:191], v[52:55], 0
    s_waitcnt lgkmcnt(4)
    v_exp_f32 v96, v96
    v_mfma_f32_16x16x32_bf16 v[128:131], a[160:163], v[48:51], 0
    v_exp_f32 v97, v97
    v_mfma_f32_16x16x32_bf16 v[160:163], a[160:163], v[52:55], 0
    s_waitcnt lgkmcnt(3)
    ds_write_b128 v16, v[176:179] offset:33792
    v_cvt_pk_bf16_f32 v63, v126, v127
    v_mfma_f32_16x16x32_bf16 v[132:135], a[164:167], v[48:51], 0
    s_waitcnt lgkmcnt(3)
    v_exp_f32 v98, v98
    v_mfma_f32_16x16x32_bf16 v[164:167], a[164:167], v[52:55], 0
    buffer_load_dwordx4 v15, s[8:11], s82 offen offset:2048 lds
    v_exp_f32 v99, v99
    v_mfma_f32_16x16x32_bf16 v[136:139], a[168:171], v[48:51], 0
    ds_write_b128 v16, v[148:151] offset:34816
    v_mfma_f32_16x16x32_bf16 v[168:171], a[168:171], v[52:55], 0
    s_waitcnt lgkmcnt(3)
    v_exp_f32 v100, v100
    v_mfma_f32_16x16x32_bf16 v[140:143], a[172:175], v[48:51], 0
    v_exp_f32 v101, v101
    v_mfma_f32_16x16x32_bf16 v[172:175], a[172:175], v[52:55], 0
    ds_write_b128 v16, v[180:183] offset:35840
    v_mov_b32 v33, v36
    v_mfma_f32_16x16x32_bf16 v[40:43], v[28:31], v[56:59], 0
    buffer_load_dwordx4 v15, s[8:11], s82 offen offset:3072 lds
    v_exp_f32 v102, v102
    v_mfma_f32_16x16x32_bf16 v[44:47], v[28:31], v[60:63], 0
    s_xor_b32 s15, s15, 196608
    v_exp_f32 v103, v103
    v_mfma_f32_16x16x32_bf16 v[208:211], a[176:179], v[56:59], 0
    ds_write_b128 v16, v[152:155] offset:36864
    v_cvt_pk_bf16_f32 v48, v96, v97
    v_mfma_f32_16x16x32_bf16 v[240:243], a[176:179], v[60:63], 0
    ds_read_b128 a[176:179], v20 offset:20480
    v_exp_f32 v104, v104
    v_mfma_f32_16x16x32_bf16 v[212:215], a[180:183], v[56:59], 0
    v_exp_f32 v105, v105
    v_mfma_f32_16x16x32_bf16 v[244:247], a[180:183], v[60:63], 0
    ds_read_b128 a[180:183], v20 offset:21504
    v_exp_f32 v106, v106
    v_mfma_f32_16x16x32_bf16 v[216:219], a[184:187], v[56:59], 0
    ds_write_b128 v16, v[184:187] offset:37888
    v_cvt_pk_bf16_f32 v49, v98, v99
    v_mfma_f32_16x16x32_bf16 v[248:251], a[184:187], v[60:63], 0
    ds_read_b128 a[184:187], v20 offset:22528
    v_exp_f32 v107, v107
    v_mfma_f32_16x16x32_bf16 v[220:223], a[188:191], v[56:59], 0
    v_exp_f32 v108, v108
    v_mfma_f32_16x16x32_bf16 v[252:255], a[188:191], v[60:63], 0
    ds_read_b128 a[188:191], v20 offset:23552
    v_exp_f32 v109, v109
    v_mfma_f32_16x16x32_bf16 v[192:195], a[160:163], v[56:59], 0
    ds_write_b128 v16, v[156:159] offset:38912
    v_cvt_pk_bf16_f32 v50, v100, v101
    v_mfma_f32_16x16x32_bf16 v[224:227], a[160:163], v[60:63], 0
    ds_read_b128 a[160:163], v19 offset:16384
    v_exp_f32 v110, v110
    v_mfma_f32_16x16x32_bf16 v[196:199], a[164:167], v[56:59], 0
    v_exp_f32 v111, v111
    v_mfma_f32_16x16x32_bf16 v[228:231], a[164:167], v[60:63], 0
    ds_read_b128 a[164:167], v19 offset:17408
    v_cvt_pk_bf16_f32 v51, v102, v103
    v_mfma_f32_16x16x32_bf16 v[200:203], a[168:171], v[56:59], 0
    ds_write_b128 v16, v[188:191] offset:39936
    v_cvt_pk_bf16_f32 v52, v104, v105
    v_mfma_f32_16x16x32_bf16 v[232:235], a[168:171], v[60:63], 0
    ds_read_b128 a[168:171], v19 offset:18432
    v_cvt_pk_bf16_f32 v53, v106, v107
    v_mfma_f32_16x16x32_bf16 v[204:207], a[172:175], v[56:59], 0
    v_cvt_pk_bf16_f32 v54, v108, v109
    v_cvt_pk_bf16_f32 v55, v110, v111
    v_mfma_f32_16x16x32_bf16 v[236:239], a[172:175], v[60:63], 0
    ds_read_b128 a[172:175], v19 offset:19456
    ds_write_b64 v12, v[32:33]
    s_xor_b32 s101, s16, 98304
    v_xor_b32 v12, 8192, v12
    v_add_u32 v9, s101, v1
    v_xor_b32 v8, 8192, v16
    v_xor_b32 v10, 8192, v9
    s_branch L_t1_join
L_t1_redo:
    s_cmp_eq_u32 s25, 0
    s_cbranch_scc1 L_t1_max
    s_mov_b32 s25, 0
    v_mov_b32 v64, 0
    v_mov_b32 v65, 0
    v_mov_b32 v66, 0
    v_mov_b32 v67, 0
    v_mov_b32 v68, 0
    v_mov_b32 v69, 0
    v_mov_b32 v70, 0
    v_mov_b32 v71, 0
    v_mov_b32 v72, 0
    v_mov_b32 v73, 0
    v_mov_b32 v74, 0
    v_mov_b32 v75, 0
    v_mov_b32 v76, 0
    v_mov_b32 v77, 0
    v_mov_b32 v78, 0
    v_mov_b32 v79, 0
    s_nop 1
    s_branch L_t1_safe
L_t1_max:
    s_waitcnt vmcnt(0) lgkmcnt(0)
    s_barrier
    s_mov_b32 s25, 1
    s_and_b32 s100, s3, 1
    s_lshl_b32 s100, s100, 13
    s_sub_u32 s101, s81, s62
    s_add_u32 s101, s101, s100
    s_mov_b32 s14, s60
    v_mov_b32 v48, 0xff800000
    v_mov_b32 v49, 0xff800000
    v_mov_b32 v50, 0xff800000
    v_mov_b32 v51, 0xff800000
L_t1_maxl:
    s_cmp_eq_u32 s14, 0
    s_cbranch_scc1 L_t1_maxd
    s_add_u32 s100, s101, 0
    buffer_load_dwordx4 a[128:131], v1, s[8:11], s100 offen offset:0
    buffer_load_dwordx4 a[132:135], v1, s[8:11], s100 offen offset:1024
    buffer_load_dwordx4 a[136:139], v1, s[8:11], s100 offen offset:2048
    buffer_load_dwordx4 a[140:143], v1, s[8:11], s100 offen offset:3072
    buffer_load_dwordx4 a[144:147], v15, s[8:11], s100 offen offset:0
    buffer_load_dwordx4 a[148:151], v15, s[8:11], s100 offen offset:1024
    buffer_load_dwordx4 a[152:155], v15, s[8:11], s100 offen offset:2048
    buffer_load_dwordx4 a[156:159], v15, s[8:11], s100 offen offset:3072
    s_waitcnt vmcnt(7)
    v_mfma_f32_16x16x32_bf16 v[96:99], a[128:131], a[64:67], v[64:67]
    s_waitcnt vmcnt(6)
    v_mfma_f32_16x16x32_bf16 v[96:99], a[132:135], a[68:71], v[96:99]
    s_waitcnt vmcnt(5)
    v_mfma_f32_16x16x32_bf16 v[96:99], a[136:139], a[72:75], v[96:99]
    s_waitcnt vmcnt(4)
    v_mfma_f32_16x16x32_bf16 v[96:99], a[140:143], a[76:79], v[96:99]
    v_mfma_f32_16x16x32_bf16 v[104:107], a[128:131], a[80:83], v[68:71]
    v_mfma_f32_16x16x32_bf16 v[104:107], a[132:135], a[84:87], v[104:107]
    v_mfma_f32_16x16x32_bf16 v[104:107], a[136:139], a[88:91], v[104:107]
    v_mfma_f32_16x16x32_bf16 v[104:107], a[140:143], a[92:95], v[104:107]
    s_waitcnt vmcnt(3)
    v_mfma_f32_16x16x32_bf16 v[100:103], a[144:147], a[64:67], v[64:67]
    s_waitcnt vmcnt(2)
    v_mfma_f32_16x16x32_bf16 v[100:103], a[148:151], a[68:71], v[100:103]
    s_waitcnt vmcnt(1)
    v_mfma_f32_16x16x32_bf16 v[100:103], a[152:155], a[72:75], v[100:103]
    s_waitcnt vmcnt(0)
    v_mfma_f32_16x16x32_bf16 v[100:103], a[156:159], a[76:79], v[100:103]
    v_mfma_f32_16x16x32_bf16 v[108:111], a[144:147], a[80:83], v[68:71]
    v_mfma_f32_16x16x32_bf16 v[108:111], a[148:151], a[84:87], v[108:111]
    v_mfma_f32_16x16x32_bf16 v[108:111], a[152:155], a[88:91], v[108:111]
    v_mfma_f32_16x16x32_bf16 v[108:111], a[156:159], a[92:95], v[108:111]
    v_mfma_f32_16x16x32_bf16 v[112:115], a[128:131], a[96:99], v[72:75]
    v_mfma_f32_16x16x32_bf16 v[112:115], a[132:135], a[100:103], v[112:115]
    v_mfma_f32_16x16x32_bf16 v[112:115], a[136:139], a[104:107], v[112:115]
    v_mfma_f32_16x16x32_bf16 v[112:115], a[140:143], a[108:111], v[112:115]
    v_mfma_f32_16x16x32_bf16 v[120:123], a[128:131], a[112:115], v[76:79]
    v_mfma_f32_16x16x32_bf16 v[120:123], a[132:135], a[116:119], v[120:123]
    v_mfma_f32_16x16x32_bf16 v[120:123], a[136:139], a[120:123], v[120:123]
    v_mfma_f32_16x16x32_bf16 v[120:123], a[140:143], a[124:127], v[120:123]
    v_mfma_f32_16x16x32_bf16 v[116:119], a[144:147], a[96:99], v[72:75]
    v_mfma_f32_16x16x32_bf16 v[116:119], a[148:151], a[100:103], v[116:119]
    v_mfma_f32_16x16x32_bf16 v[116:119], a[152:155], a[104:107], v[116:119]
    v_mfma_f32_16x16x32_bf16 v[116:119], a[156:159], a[108:111], v[116:119]
    v_mfma_f32_16x16x32_bf16 v[124:127], a[144:147], a[112:115], v[76:79]
    v_mfma_f32_16x16x32_bf16 v[124:127], a[148:151], a[116:119], v[124:127]
    v_mfma_f32_16x16x32_bf16 v[124:127], a[152:155], a[120:123], v[124:127]
    v_mfma_f32_16x16x32_bf16 v[124:127], a[156:159], a[124:127], v[124:127]
    v_max3_f32 v48, v48, v96, v97
    v_max3_f32 v48, v48, v98, v99
    v_max3_f32 v48, v48, v100, v101
    v_max3_f32 v48, v48, v102, v103
    v_max3_f32 v49, v49, v104, v105
    v_max3_f32 v49, v49, v106, v107
    v_max3_f32 v49, v49, v108, v109
    v_max3_f32 v49, v49, v110, v111
    v_max3_f32 v50, v50, v112, v113
    v_max3_f32 v50, v50, v114, v115
    v_max3_f32 v50, v50, v116, v117
    v_max3_f32 v50, v50, v118, v119
    v_max3_f32 v51, v51, v120, v121
    v_max3_f32 v51, v51, v122, v123
    v_max3_f32 v51, v51, v124, v125
    v_max3_f32 v51, v51, v126, v127
    s_add_u32 s100, s101, 16384
    buffer_load_dwordx4 a[128:131], v1, s[8:11], s100 offen offset:0
    buffer_load_dwordx4 a[132:135], v1, s[8:11], s100 offen offset:1024
    buffer_load_dwordx4 a[136:139], v1, s[8:11], s100 offen offset:2048
    buffer_load_dwordx4 a[140:143], v1, s[8:11], s100 offen offset:3072
    buffer_load_dwordx4 a[144:147], v15, s[8:11], s100 offen offset:0
    buffer_load_dwordx4 a[148:151], v15, s[8:11], s100 offen offset:1024
    buffer_load_dwordx4 a[152:155], v15, s[8:11], s100 offen offset:2048
    buffer_load_dwordx4 a[156:159], v15, s[8:11], s100 offen offset:3072
    s_waitcnt vmcnt(7)
    v_mfma_f32_16x16x32_bf16 v[96:99], a[128:131], a[64:67], v[64:67]
    s_waitcnt vmcnt(6)
    v_mfma_f32_16x16x32_bf16 v[96:99], a[132:135], a[68:71], v[96:99]
    s_waitcnt vmcnt(5)
    v_mfma_f32_16x16x32_bf16 v[96:99], a[136:139], a[72:75], v[96:99]
    s_waitcnt vmcnt(4)
    v_mfma_f32_16x16x32_bf16 v[96:99], a[140:143], a[76:79], v[96:99]
    v_mfma_f32_16x16x32_bf16 v[104:107], a[128:131], a[80:83], v[68:71]
    v_mfma_f32_16x16x32_bf16 v[104:107], a[132:135], a[84:87], v[104:107]
    v_mfma_f32_16x16x32_bf16 v[104:107], a[136:139], a[88:91], v[104:107]
    v_mfma_f32_16x16x32_bf16 v[104:107], a[140:143], a[92:95], v[104:107]
    s_waitcnt vmcnt(3)
    v_mfma_f32_16x16x32_bf16 v[100:103], a[144:147], a[64:67], v[64:67]
    s_waitcnt vmcnt(2)
    v_mfma_f32_16x16x32_bf16 v[100:103], a[148:151], a[68:71], v[100:103]
    s_waitcnt vmcnt(1)
    v_mfma_f32_16x16x32_bf16 v[100:103], a[152:155], a[72:75], v[100:103]
    s_waitcnt vmcnt(0)
    v_mfma_f32_16x16x32_bf16 v[100:103], a[156:159], a[76:79], v[100:103]
    v_mfma_f32_16x16x32_bf16 v[108:111], a[144:147], a[80:83], v[68:71]
    v_mfma_f32_16x16x32_bf16 v[108:111], a[148:151], a[84:87], v[108:111]
    v_mfma_f32_16x16x32_bf16 v[108:111], a[152:155], a[88:91], v[108:111]
    v_mfma_f32_16x16x32_bf16 v[108:111], a[156:159], a[92:95], v[108:111]
    v_mfma_f32_16x16x32_bf16 v[112:115], a[128:131], a[96:99], v[72:75]
    v_mfma_f32_16x16x32_bf16 v[112:115], a[132:135], a[100:103], v[112:115]
    v_mfma_f32_16x16x32_bf16 v[112:115], a[136:139], a[104:107], v[112:115]
    v_mfma_f32_16x16x32_bf16 v[112:115], a[140:143], a[108:111], v[112:115]
    v_mfma_f32_16x16x32_bf16 v[120:123], a[128:131], a[112:115], v[76:79]
    v_mfma_f32_16x16x32_bf16 v[120:123], a[132:135], a[116:119], v[120:123]
    v_mfma_f32_16x16x32_bf16 v[120:123], a[136:139], a[120:123], v[120:123]
    v_mfma_f32_16x16x32_bf16 v[120:123], a[140:143], a[124:127], v[120:123]
    v_mfma_f32_16x16x32_bf16 v[116:119], a[144:147], a[96:99], v[72:75]
    v_mfma_f32_16x16x32_bf16 v[116:119], a[148:151], a[100:103], v[116:119]
    v_mfma_f32_16x16x32_bf16 v[116:119], a[152:155], a[104:107], v[116:119]
    v_mfma_f32_16x16x32_bf16 v[116:119], a[156:159], a[108:111], v[116:119]
    v_mfma_f32_16x16x32_bf16 v[124:127], a[144:147], a[112:115], v[76:79]
    v_mfma_f32_16x16x32_bf16 v[124:127], a[148:151], a[116:119], v[124:127]
    v_mfma_f32_16x16x32_bf16 v[124:127], a[152:155], a[120:123], v[124:127]
    v_mfma_f32_16x16x32_bf16 v[124:127], a[156:159], a[124:127], v[124:127]
    v_max3_f32 v48, v48, v96, v97
    v_max3_f32 v48, v48, v98, v99
    v_max3_f32 v48, v48, v100, v101
    v_max3_f32 v48, v48, v102, v103
    v_max3_f32 v49, v49, v104, v105
    v_max3_f32 v49, v49, v106, v107
    v_max3_f32 v49, v49, v108, v109
    v_max3_f32 v49, v49, v110, v111
    v_max3_f32 v50, v50, v112, v113
    v_max3_f32 v50, v50, v114, v115
    v_max3_f32 v50, v50, v116, v117
    v_max3_f32 v50, v50, v118, v119
    v_max3_f32 v51, v51, v120, v121
    v_max3_f32 v51, v51, v122, v123
    v_max3_f32 v51, v51, v124, v125
    v_max3_f32 v51, v51, v126, v127
    s_add_u32 s101, s101, 65536
    s_sub_u32 s14, s14, 1
    s_nop 7
    s_branch L_t1_maxl
L_t1_maxd:
    s_add_u32 s100, s101, 0
    buffer_load_dwordx4 a[128:131], v1, s[8:11], s100 offen offset:0
    buffer_load_dwordx4 a[132:135], v1, s[8:11], s100 offen offset:1024
    buffer_load_dwordx4 a[136:139], v1, s[8:11], s100 offen offset:2048
    buffer_load_dwordx4 a[140:143], v1, s[8:11], s100 offen offset:3072
    buffer_load_dwordx4 a[144:147], v15, s[8:11], s100 offen offset:0
    buffer_load_dwordx4 a[148:151], v15, s[8:11], s100 offen offset:1024
    buffer_load_dwordx4 a[152:155], v15, s[8:11], s100 offen offset:2048
    buffer_load_dwordx4 a[156:159], v15, s[8:11], s100 offen offset:3072
    v_add_f32 v80, 0, v21
    v_min_f32 v80, v80, v64
    v_add_f32 v81, 0xf1800000, v21
    v_min_f32 v81, v81, v65
    v_add_f32 v82, 0xf2000000, v21
    v_min_f32 v82, v82, v66
    v_add_f32 v83, 0xf2400000, v21
    v_min_f32 v83, v83, v67
    v_add_f32 v84, 0xf3800000, v21
    v_min_f32 v84, v84, v64
    v_add_f32 v85, 0xf3880000, v21
    v_min_f32 v85, v85, v65
    v_add_f32 v86, 0xf3900000, v21
    v_min_f32 v86, v86, v66
    v_add_f32 v87, 0xf3980000, v21
    v_min_f32 v87, v87, v67
    v_add_f32 v88, 0x73800000, v21
    v_min_f32 v88, v88, v68
    v_add_f32 v89, 0x73700000, v21
    v_min_f32 v89, v89, v69
    v_add_f32 v90, 0x73600000, v21
    v_min_f32 v90, v90, v70
    v_add_f32 v91, 0x73500000, v21
    v_min_f32 v91, v91, v71
    v_add_f32 v92, 0, v21
    v_min_f32 v92, v92, v68
    v_add_f32 v93, 0xf1800000, v21
    v_min_f32 v93, v93, v69
    v_add_f32 v94, 0xf2000000, v21
    v_min_f32 v94, v94, v70
    v_add_f32 v95, 0xf2400000, v21
    v_min_f32 v95, v95, v71
    s_waitcnt vmcnt(7)
    v_mfma_f32_16x16x32_bf16 v[96:99], a[128:131], a[64:67], v[80:83]
    s_waitcnt vmcnt(6)
    v_mfma_f32_16x16x32_bf16 v[96:99], a[132:135], a[68:71], v[96:99]
    s_waitcnt vmcnt(5)
    v_mfma_f32_16x16x32_bf16 v[96:99], a[136:139], a[72:75], v[96:99]
    s_waitcnt vmcnt(4)
    v_mfma_f32_16x16x32_bf16 v[96:99], a[140:143], a[76:79], v[96:99]
    v_mfma_f32_16x16x32_bf16 v[104:107], a[128:131], a[80:83], v[88:91]
    v_mfma_f32_16x16x32_bf16 v[104:107], a[132:135], a[84:87], v[104:107]
    v_mfma_f32_16x16x32_bf16 v[104:107], a[136:139], a[88:91], v[104:107]
    v_mfma_f32_16x16x32_bf16 v[104:107], a[140:143], a[92:95], v[104:107]
    s_waitcnt vmcnt(3)
    v_mfma_f32_16x16x32_bf16 v[100:103], a[144:147], a[64:67], v[84:87]
    s_waitcnt vmcnt(2)
    v_mfma_f32_16x16x32_bf16 v[100:103], a[148:151], a[68:71], v[100:103]
    s_waitcnt vmcnt(1)
    v_mfma_f32_16x16x32_bf16 v[100:103], a[152:155], a[72:75], v[100:103]
    s_waitcnt vmcnt(0)
    v_mfma_f32_16x16x32_bf16 v[100:103], a[156:159], a[76:79], v[100:103]
    v_mfma_f32_16x16x32_bf16 v[108:111], a[144:147], a[80:83], v[92:95]
    v_mfma_f32_16x16x32_bf16 v[108:111], a[148:151], a[84:87], v[108:111]
    v_mfma_f32_16x16x32_bf16 v[108:111], a[152:155], a[88:91], v[108:111]
    v_mfma_f32_16x16x32_bf16 v[108:111], a[156:159], a[92:95], v[108:111]
    v_mfma_f32_16x16x32_bf16 v[112:115], a[128:131], a[96:99], v[72:75]
    v_mfma_f32_16x16x32_bf16 v[112:115], a[132:135], a[100:103], v[112:115]
    v_mfma_f32_16x16x32_bf16 v[112:115], a[136:139], a[104:107], v[112:115]
    v_mfma_f32_16x16x32_bf16 v[112:115], a[140:143], a[108:111], v[112:115]
    v_mfma_f32_16x16x32_bf16 v[120:123], a[128:131], a[112:115], v[76:79]
    v_mfma_f32_16x16x32_bf16 v[120:123], a[132:135], a[116:119], v[120:123]
    v_mfma_f32_16x16x32_bf16 v[120:123], a[136:139], a[120:123], v[120:123]
    v_mfma_f32_16x16x32_bf16 v[120:123], a[140:143], a[124:127], v[120:123]
    v_mfma_f32_16x16x32_bf16 v[116:119], a[144:147], a[96:99], v[72:75]
    v_mfma_f32_16x16x32_bf16 v[116:119], a[148:151], a[100:103], v[116:119]
    v_mfma_f32_16x16x32_bf16 v[116:119], a[152:155], a[104:107], v[116:119]
    v_mfma_f32_16x16x32_bf16 v[116:119], a[156:159], a[108:111], v[116:119]
    v_mfma_f32_16x16x32_bf16 v[124:127], a[144:147], a[112:115], v[76:79]
    v_mfma_f32_16x16x32_bf16 v[124:127], a[148:151], a[116:119], v[124:127]
    v_mfma_f32_16x16x32_bf16 v[124:127], a[152:155], a[120:123], v[124:127]
    v_mfma_f32_16x16x32_bf16 v[124:127], a[156:159], a[124:127], v[124:127]
    v_max3_f32 v48, v48, v96, v97
    v_max3_f32 v48, v48, v98, v99
    v_max3_f32 v48, v48, v100, v101
    v_max3_f32 v48, v48, v102, v103
    v_max3_f32 v49, v49, v104, v105
    v_max3_f32 v49, v49, v106, v107
    v_max3_f32 v49, v49, v108, v109
    v_max3_f32 v49, v49, v110, v111
    v_max3_f32 v50, v50, v112, v113
    v_max3_f32 v50, v50, v114, v115
    v_max3_f32 v50, v50, v116, v117
    v_max3_f32 v50, v50, v118, v119
    v_max3_f32 v51, v51, v120, v121
    v_max3_f32 v51, v51, v122, v123
    v_max3_f32 v51, v51, v124, v125
    v_max3_f32 v51, v51, v126, v127
    s_add_u32 s100, s101, 16384
    buffer_load_dwordx4 a[128:131], v1, s[8:11], s100 offen offset:0
    buffer_load_dwordx4 a[132:135], v1, s[8:11], s100 offen offset:1024
    buffer_load_dwordx4 a[136:139], v1, s[8:11], s100 offen offset:2048
    buffer_load_dwordx4 a[140:143], v1, s[8:11], s100 offen offset:3072
    buffer_load_dwordx4 a[144:147], v15, s[8:11], s100 offen offset:0
    buffer_load_dwordx4 a[148:151], v15, s[8:11], s100 offen offset:1024
    buffer_load_dwordx4 a[152:155], v15, s[8:11], s100 offen offset:2048
    buffer_load_dwordx4 a[156:159], v15, s[8:11], s100 offen offset:3072
    v_add_f32 v80, 0, v22
    v_min_f32 v80, v80, v72
    v_add_f32 v81, 0xf1800000, v22
    v_min_f32 v81, v81, v73
    v_add_f32 v82, 0xf2000000, v22
    v_min_f32 v82, v82, v74
    v_add_f32 v83, 0xf2400000, v22
    v_min_f32 v83, v83, v75
    v_add_f32 v84, 0xf3800000, v22
    v_min_f32 v84, v84, v72
    v_add_f32 v85, 0xf3880000, v22
    v_min_f32 v85, v85, v73
    v_add_f32 v86, 0xf3900000, v22
    v_min_f32 v86, v86, v74
    v_add_f32 v87, 0xf3980000, v22
    v_min_f32 v87, v87, v75
    v_add_f32 v88, 0x73800000, v22
    v_min_f32 v88, v88, v76
    v_add_f32 v89, 0x73700000, v22
    v_min_f32 v89, v89, v77
    v_add_f32 v90, 0x73600000, v22
    v_min_f32 v90, v90, v78
    v_add_f32 v91, 0x73500000, v22
    v_min_f32 v91, v91, v79
    v_add_f32 v92, 0, v22
    v_min_f32 v92, v92, v76
    v_add_f32 v93, 0xf1800000, v22
    v_min_f32 v93, v93, v77
    v_add_f32 v94, 0xf2000000, v22
    v_min_f32 v94, v94, v78
    v_add_f32 v95, 0xf2400000, v22
    v_min_f32 v95, v95, v79
    s_waitcnt vmcnt(7)
    v_mfma_f32_16x16x32_bf16 v[96:99], a[128:131], a[96:99], v[80:83]
    s_waitcnt vmcnt(6)
    v_mfma_f32_16x16x32_bf16 v[96:99], a[132:135], a[100:103], v[96:99]
    s_waitcnt vmcnt(5)
    v_mfma_f32_16x16x32_bf16 v[96:99], a[136:139], a[104:107], v[96:99]
    s_waitcnt vmcnt(4)
    v_mfma_f32_16x16x32_bf16 v[96:99], a[140:143], a[108:111], v[96:99]
    v_mfma_f32_16x16x32_bf16 v[104:107], a[128:131], a[112:115], v[88:91]
    v_mfma_f32_16x16x32_bf16 v[104:107], a[132:135], a[116:119], v[104:107]
    v_mfma_f32_16x16x32_bf16 v[104:107], a[136:139], a[120:123], v[104:107]
    v_mfma_f32_16x16x32_bf16 v[104:107], a[140:143], a[124:127], v[104:107]
    s_waitcnt vmcnt(3)
    v_mfma_f32_16x16x32_bf16 v[100:103], a[144:147], a[96:99], v[84:87]
    s_waitcnt vmcnt(2)
    v_mfma_f32_16x16x32_bf16 v[100:103], a[148:151], a[100:103], v[100:103]
    s_waitcnt vmcnt(1)
    v_mfma_f32_16x16x32_bf16 v[100:103], a[152:155], a[104:107], v[100:103]
    s_waitcnt vmcnt(0)
    v_mfma_f32_16x16x32_bf16 v[100:103], a[156:159], a[108:111], v[100:103]
    v_mfma_f32_16x16x32_bf16 v[108:111], a[144:147], a[112:115], v[92:95]
    v_mfma_f32_16x16x32_bf16 v[108:111], a[148:151], a[116:119], v[108:111]
    v_mfma_f32_16x16x32_bf16 v[108:111], a[152:155], a[120:123], v[108:111]
    v_mfma_f32_16x16x32_bf16 v[108:111], a[156:159], a[124:127], v[108:111]
    v_max3_f32 v50, v50, v96, v97
    v_max3_f32 v50, v50, v98, v99
    s_nop 1
    v_max3_f32 v50, v50, v100, v101
    v_max3_f32 v50, v50, v102, v103
    v_max3_f32 v51, v51, v104, v105
    v_max3_f32 v51, v51, v106, v107
    v_max3_f32 v51, v51, v108, v109
    v_max3_f32 v51, v51, v110, v111
    v_mov_b32 v52, v48
    v_mov_b32 v53, v49
    v_mov_b32 v54, v50
    v_mov_b32 v55, v51
    v_permlane16_swap_b32 v48, v52
    v_permlane16_swap_b32 v49, v53
    v_permlane16_swap_b32 v50, v54
    v_permlane16_swap_b32 v51, v55
    v_max_f32 v48, v48, v52
    v_max_f32 v49, v49, v53
    v_max_f32 v50, v50, v54
    v_max_f32 v51, v51, v55
    v_mov_b32 v52, v48
    v_mov_b32 v53, v49
    v_mov_b32 v54, v50
    v_mov_b32 v55, v51
    v_permlane32_swap_b32 v48, v52
    v_permlane32_swap_b32 v49, v53
    v_permlane32_swap_b32 v50, v54
    v_permlane32_swap_b32 v51, v55
    v_max_f32 v48, v48, v52
    v_max_f32 v49, v49, v53
    v_max_f32 v50, v50, v54
    v_max_f32 v51, v51, v55
    ds_write_b128 v16, v[48:51] offset:32768
    v_xor_b32 v8, 8192, v16
    s_waitcnt lgkmcnt(0)
    s_barrier
    ds_read_b128 v[52:55], v8 offset:32768
    s_waitcnt lgkmcnt(0)
    v_max_f32 v48, v48, v52
    v_max_f32 v49, v49, v53
    v_max_f32 v50, v50, v54
    v_max_f32 v51, v51, v55
    v_sub_f32 v64, 0, v48
    v_sub_f32 v65, 0, v48
    v_sub_f32 v66, 0, v48
    v_sub_f32 v67, 0, v48
    v_sub_f32 v68, 0, v49
    v_sub_f32 v69, 0, v49
    v_sub_f32 v70, 0, v49
    v_sub_f32 v71, 0, v49
    v_sub_f32 v72, 0, v50
    v_sub_f32 v73, 0, v50
    v_sub_f32 v74, 0, v50
    v_sub_f32 v75, 0, v50
    v_sub_f32 v76, 0, v51
    v_sub_f32 v77, 0, v51
    v_sub_f32 v78, 0, v51
    v_sub_f32 v79, 0, v51
    s_mov_b32 s12, 0
    s_and_b32 s100, s12, 1
    s_mul_i32 s15, s100, 196608
    s_xor_b32 s15, s15, 65536
    s_mul_i32 s16, s100, 98304
    s_xor_b32 s16, s16, 98304
    v_and_b32 v18, 0x7fff, v18
    v_or_b32 v18, s15, v18
    v_and_b32 v19, 0x7fff, v19
    v_or_b32 v19, s16, v19
    v_and_b32 v20, 0x7fff, v20
    v_or_b32 v20, s16, v20
    s_add_u32 s15, s15, s62
    s_add_u32 s16, s16, s62
    s_add_u32 s12, s12, 2
    s_mov_b32 s82, s81
    s_add_u32 s19, s81, 32768
    s_add_u32 m0, s15, 0
    s_nop 0
    buffer_load_dwordx4 v1, s[8:11], s82 offen offset:0 lds
    buffer_load_dwordx4 v1, s[8:11], s82 offen offset:1024 lds
    buffer_load_dwordx4 v1, s[8:11], s82 offen offset:2048 lds
    buffer_load_dwordx4 v1, s[8:11], s82 offen offset:3072 lds
    s_add_u32 m0, s15, 4096
    s_nop 0
    buffer_load_dwordx4 v15, s[8:11], s82 offen offset:0 lds
    buffer_load_dwordx4 v15, s[8:11], s82 offen offset:1024 lds
    buffer_load_dwordx4 v15, s[8:11], s82 offen offset:2048 lds
    buffer_load_dwordx4 v15, s[8:11], s82 offen offset:3072 lds
    s_xor_b32 s15, s15, 196608
    s_add_u32 m0, s16, 0
    s_nop 0
    buffer_load_dwordx4 v1, s[8:11], s19 offen offset:0 lds
    buffer_load_dwordx4 v1, s[8:11], s19 offen offset:1024 lds
    buffer_load_dwordx4 v1, s[8:11], s19 offen offset:2048 lds
    buffer_load_dwordx4 v1, s[8:11], s19 offen offset:3072 lds
    s_add_u32 m0, s16, 4096
    s_nop 0
    buffer_load_dwordx4 v15, s[8:11], s19 offen offset:0 lds
    buffer_load_dwordx4 v15, s[8:11], s19 offen offset:1024 lds
    buffer_load_dwordx4 v15, s[8:11], s19 offen offset:2048 lds
    buffer_load_dwordx4 v15, s[8:11], s19 offen offset:3072 lds
    s_xor_b32 s16, s16, 98304
    s_min_u32 s82, s60, 1
    s_lshl_b32 s82, s82, 16
    s_add_u32 s82, s82, s81
    s_add_u32 m0, s15, 0
    s_nop 0
    buffer_load_dwordx4 v1, s[8:11], s82 offen offset:0 lds
    buffer_load_dwordx4 v1, s[8:11], s82 offen offset:1024 lds
    buffer_load_dwordx4 v1, s[8:11], s82 offen offset:2048 lds
    buffer_load_dwordx4 v1, s[8:11], s82 offen offset:3072 lds
    s_add_u32 m0, s15, 4096
    s_nop 0
    buffer_load_dwordx4 v15, s[8:11], s82 offen offset:0 lds
    buffer_load_dwordx4 v15, s[8:11], s82 offen offset:1024 lds
    buffer_load_dwordx4 v15, s[8:11], s82 offen offset:2048 lds
    buffer_load_dwordx4 v15, s[8:11], s82 offen offset:3072 lds
    s_xor_b32 s15, s15, 196608
    s_cmp_eq_u32 s60, 0
    s_cselect_b32 s19, 0, 0x76800000
    v_add_f32 v3, s19, v21
    v_add_f32 v96, 0, v3
    v_min_f32 v96, v96, v64
    v_add_f32 v97, 0xf1800000, v3
    v_min_f32 v97, v97, v65
    v_add_f32 v98, 0xf2000000, v3
    v_min_f32 v98, v98, v66
    v_add_f32 v99, 0xf2400000, v3
    v_min_f32 v99, v99, v67
    v_add_f32 v100, 0xf3800000, v3
    v_min_f32 v100, v100, v64
    v_add_f32 v101, 0xf3880000, v3
    v_min_f32 v101, v101, v65
    v_add_f32 v102, 0xf3900000, v3
    v_min_f32 v102, v102, v66
    v_add_f32 v103, 0xf3980000, v3
    v_min_f32 v103, v103, v67
    v_add_f32 v104, 0x73800000, v3
    v_min_f32 v104, v104, v68
    v_add_f32 v105, 0x73700000, v3
    v_min_f32 v105, v105, v69
    v_add_f32 v106, 0x73600000, v3
    v_min_f32 v106, v106, v70
    v_add_f32 v107, 0x73500000, v3
    v_min_f32 v107, v107, v71
    v_add_f32 v108, 0, v3
    v_min_f32 v108, v108, v68
    v_add_f32 v109, 0xf1800000, v3
    v_min_f32 v109, v109, v69
    v_add_f32 v110, 0xf2000000, v3
    v_min_f32 v110, v110, v70
    v_add_f32 v111, 0xf2400000, v3
    v_min_f32 v111, v111, v71
    v_add_f32 v80, 0, v22
    v_min_f32 v80, v80, v72
    v_add_f32 v81, 0xf1800000, v22
    v_min_f32 v81, v81, v73
    v_add_f32 v82, 0xf2000000, v22
    v_min_f32 v82, v82, v74
    v_add_f32 v83, 0xf2400000, v22
    v_min_f32 v83, v83, v75
    v_add_f32 v84, 0xf3800000, v22
    v_min_f32 v84, v84, v72
    v_add_f32 v85, 0xf3880000, v22
    v_min_f32 v85, v85, v73
    v_add_f32 v86, 0xf3900000, v22
    v_min_f32 v86, v86, v74
    v_add_f32 v87, 0xf3980000, v22
    v_min_f32 v87, v87, v75
    v_add_f32 v88, 0x73800000, v22
    v_min_f32 v88, v88, v76
    v_add_f32 v89, 0x73700000, v22
    v_min_f32 v89, v89, v77
    v_add_f32 v90, 0x73600000, v22
    v_min_f32 v90, v90, v78
    v_add_f32 v91, 0x73500000, v22
    v_min_f32 v91, v91, v79
    v_add_f32 v92, 0, v22
    v_min_f32 v92, v92, v76
    v_add_f32 v93, 0xf1800000, v22
    v_min_f32 v93, v93, v77
    v_add_f32 v94, 0xf2000000, v22
    v_min_f32 v94, v94, v78
    v_add_f32 v95, 0xf2400000, v22
    v_min_f32 v95, v95, v79
    s_cmp_eq_u32 s60, 0
    s_cbranch_scc1 L_t1_mk
    v_add_f32 v80, 0, v21
    v_min_f32 v80, v80, v64
    v_add_f32 v81, 0xf1800000, v21
    v_min_f32 v81, v81, v65
    v_add_f32 v82, 0xf2000000, v21
    v_min_f32 v82, v82, v66
    v_add_f32 v83, 0xf2400000, v21
    v_min_f32 v83, v83, v67
    v_add_f32 v84, 0xf3800000, v21
    v_min_f32 v84, v84, v64
    v_add_f32 v85, 0xf3880000, v21
    v_min_f32 v85, v85, v65
    v_add_f32 v86, 0xf3900000, v21
    v_min_f32 v86, v86, v66
    v_add_f32 v87, 0xf3980000, v21
    v_min_f32 v87, v87, v67
    v_add_f32 v88, 0x73800000, v21
    v_min_f32 v88, v88, v68
    v_add_f32 v89, 0x73700000, v21
    v_min_f32 v89, v89, v69
    v_add_f32 v90, 0x73600000, v21
    v_min_f32 v90, v90, v70
    v_add_f32 v91, 0x73500000, v21
    v_min_f32 v91, v91, v71
    v_add_f32 v92, 0, v21
    v_min_f32 v92, v92, v68
    v_add_f32 v93, 0xf1800000, v21
    v_min_f32 v93, v93, v69
    v_add_f32 v94, 0xf2000000, v21
    v_min_f32 v94, v94, v70
    v_add_f32 v95, 0xf2400000, v21
    v_min_f32 v95, v95, v71
L_t1_mk:
    s_waitcnt vmcnt(0) lgkmcnt(0)
    s_barrier
    ds_read_b128 a[128:131], v18 offset:0
    ds_read_b128 a[132:135], v18 offset:1024
    ds_read_b128 a[136:139], v18 offset:2048
    ds_read_b128 a[140:143], v18 offset:3072
    ds_read_b128 a[144:147], v18 offset:4096
    ds_read_b128 a[148:151], v18 offset:5120
    ds_read_b128 a[152:155], v18 offset:6144
    ds_read_b128 a[156:159], v18 offset:7168
    s_waitcnt lgkmcnt(0)
    s_branch L_t1_start
L_C1_slow_9:
    s_mov_b32 s99, 0
L_C1_slow_9_l:
    s_sleep 4
    buffer_load_dword v3, v4, s[8:11], s23 offen sc0 sc1
    s_add_u32 s99, s99, 1
    s_waitcnt vmcnt(0)
    v_cmp_ne_u32 vcc, 0, v3
    s_cmp_eq_u64 vcc, -1
    s_cbranch_scc1 L_C1_ok_10
    s_cmp_lt_u32 s99, 200000
    s_cbranch_scc1 L_C1_slow_9_l
    s_branch L_C1_ok_10
L_F_slow_11:
    s_mov_b32 s99, 0
L_F_slow_11_l:
    s_sleep 4
    buffer_load_dword v3, v12, s[8:11], s71 offen sc0 sc1
    s_add_u32 s99, s99, 1
    s_waitcnt vmcnt(0)
    v_cmp_ne_u32 vcc, 0, v3
    s_cmp_eq_u64 vcc, -1
    s_cbranch_scc1 L_F_ok_12
    s_cmp_lt_u32 s99, 200000
    s_cbranch_scc1 L_F_slow_11_l
    s_branch L_F_ok_12
L_t2_redo:
    s_cmp_eq_u32 s25, 0
    s_cbranch_scc1 L_t2_max
    s_mov_b32 s25, 0
    v_mov_b32 v64, 0
    v_mov_b32 v65, 0
    v_mov_b32 v66, 0
    v_mov_b32 v67, 0
    v_mov_b32 v68, 0
    v_mov_b32 v69, 0
    v_mov_b32 v70, 0
    v_mov_b32 v71, 0
    v_mov_b32 v72, 0
    v_mov_b32 v73, 0
    v_mov_b32 v74, 0
    v_mov_b32 v75, 0
    v_mov_b32 v76, 0
    v_mov_b32 v77, 0
    v_mov_b32 v78, 0
    v_mov_b32 v79, 0
    s_nop 1
    s_branch L_t2_safe
L_t2_max:
    s_waitcnt vmcnt(0) lgkmcnt(0)
    s_barrier
    s_mov_b32 s25, 1
    s_and_b32 s100, s3, 1
    s_lshl_b32 s100, s100, 13
    s_sub_u32 s101, s81, s62
    s_add_u32 s101, s101, s100
    s_mov_b32 s14, s61
    s_mov_b32 s26, 0
    v_mov_b32 v24, -1
    v_mov_b32 v25, -1
    v_mov_b32 v26, -1
    v_mov_b32 v27, -1
    v_mov_b32 v48, 0xff800000
    v_mov_b32 v49, 0xff800000
    v_mov_b32 v50, 0xff800000
    v_mov_b32 v51, 0xff800000
L_t2_maxl:
    s_cmp_eq_u32 s14, 0
    s_cbranch_scc1 L_t2_maxd
    s_add_u32 s100, s101, 0
    buffer_load_dwordx4 a[128:131], v1, s[8:11], s100 offen offset:0
    buffer_load_dwordx4 a[132:135], v1, s[8:11], s100 offen offset:1024
    buffer_load_dwordx4 a[136:139], v1, s[8:11], s100 offen offset:2048
    buffer_load_dwordx4 a[140:143], v1, s[8:11], s100 offen offset:3072
    buffer_load_dwordx4 a[144:147], v15, s[8:11], s100 offen offset:0
    buffer_load_dwordx4 a[148:151], v15, s[8:11], s100 offen offset:1024
    buffer_load_dwordx4 a[152:155], v15, s[8:11], s100 offen offset:2048
    buffer_load_dwordx4 a[156:159], v15, s[8:11], s100 offen offset:3072
    s_waitcnt vmcnt(7)
    v_mfma_f32_16x16x32_bf16 v[96:99], a[128:131], a[192:195], v[64:67]
    s_waitcnt vmcnt(6)
    v_mfma_f32_16x16x32_bf16 v[96:99], a[132:135], a[196:199], v[96:99]
    s_waitcnt vmcnt(5)
    v_mfma_f32_16x16x32_bf16 v[96:99], a[136:139], a[200:203], v[96:99]
    s_waitcnt vmcnt(4)
    v_mfma_f32_16x16x32_bf16 v[96:99], a[140:143], a[204:207], v[96:99]
    v_mfma_f32_16x16x32_bf16 v[104:107], a[128:131], a[208:211], v[68:71]
    v_mfma_f32_16x16x32_bf16 v[104:107], a[132:135], a[212:215], v[104:107]
    v_mfma_f32_16x16x32_bf16 v[104:107], a[136:139], a[216:219], v[104:107]
    v_mfma_f32_16x16x32_bf16 v[104:107], a[140:143], a[220:223], v[104:107]
    s_waitcnt vmcnt(3)
    v_mfma_f32_16x16x32_bf16 v[100:103], a[144:147], a[192:195], v[64:67]
    s_waitcnt vmcnt(2)
    v_mfma_f32_16x16x32_bf16 v[100:103], a[148:151], a[196:199], v[100:103]
    s_waitcnt vmcnt(1)
    v_mfma_f32_16x16x32_bf16 v[100:103], a[152:155], a[200:203], v[100:103]
    s_waitcnt vmcnt(0)
    v_mfma_f32_16x16x32_bf16 v[100:103], a[156:159], a[204:207], v[100:103]
    v_mfma_f32_16x16x32_bf16 v[108:111], a[144:147], a[208:211], v[68:71]
    v_mfma_f32_16x16x32_bf16 v[108:111], a[148:151], a[212:215], v[108:111]
    v_mfma_f32_16x16x32_bf16 v[108:111], a[152:155], a[216:219], v[108:111]
    v_mfma_f32_16x16x32_bf16 v[108:111], a[156:159], a[220:223], v[108:111]
    v_mfma_f32_16x16x32_bf16 v[112:115], a[128:131], a[224:227], v[72:75]
    v_mfma_f32_16x16x32_bf16 v[112:115], a[132:135], a[228:231], v[112:115]
    v_mfma_f32_16x16x32_bf16 v[112:115], a[136:139], a[232:235], v[112:115]
    v_mfma_f32_16x16x32_bf16 v[112:115], a[140:143], a[236:239], v[112:115]
    v_mfma_f32_16x16x32_bf16 v[120:123], a[128:131], a[240:243], v[76:79]
    v_mfma_f32_16x16x32_bf16 v[120:123], a[132:135], a[244:247], v[120:123]
    v_mfma_f32_16x16x32_bf16 v[120:123], a[136:139], a[248:251], v[120:123]
    v_mfma_f32_16x16x32_bf16 v[120:123], a[140:143], a[252:255], v[120:123]
    v_mfma_f32_16x16x32_bf16 v[116:119], a[144:147], a[224:227], v[72:75]
    v_mfma_f32_16x16x32_bf16 v[116:119], a[148:151], a[228:231], v[116:119]
    v_mfma_f32_16x16x32_bf16 v[116:119], a[152:155], a[232:235], v[116:119]
    v_mfma_f32_16x16x32_bf16 v[116:119], a[156:159], a[236:239], v[116:119]
    v_mfma_f32_16x16x32_bf16 v[124:127], a[144:147], a[240:243], v[76:79]
    v_mfma_f32_16x16x32_bf16 v[124:127], a[148:151], a[244:247], v[124:127]
    v_mfma_f32_16x16x32_bf16 v[124:127], a[152:155], a[248:251], v[124:127]
    v_mfma_f32_16x16x32_bf16 v[124:127], a[156:159], a[252:255], v[124:127]
    v_max3_f32 v48, v48, v96, v97
    v_max3_f32 v48, v48, v98, v99
    v_max3_f32 v48, v48, v100, v101
    v_max3_f32 v48, v48, v102, v103
    v_max3_f32 v49, v49, v104, v105
    v_max3_f32 v49, v49, v106, v107
    v_max3_f32 v49, v49, v108, v109
    v_max3_f32 v49, v49, v110, v111
    v_max3_f32 v50, v50, v112, v113
    v_max3_f32 v50, v50, v114, v115
    v_max3_f32 v50, v50, v116, v117
    v_max3_f32 v50, v50, v118, v119
    v_max3_f32 v51, v51, v120, v121
    v_max3_f32 v51, v51, v122, v123
    v_max3_f32 v51, v51, v124, v125
    v_max3_f32 v51, v51, v126, v127
    s_add_u32 s100, s101, 16384
    buffer_load_dwordx4 a[128:131], v1, s[8:11], s100 offen offset:0
    buffer_load_dwordx4 a[132:135], v1, s[8:11], s100 offen offset:1024
    buffer_load_dwordx4 a[136:139], v1, s[8:11], s100 offen offset:2048
    buffer_load_dwordx4 a[140:143], v1, s[8:11], s100 offen offset:3072
    buffer_load_dwordx4 a[144:147], v15, s[8:11], s100 offen offset:0
    buffer_load_dwordx4 a[148:151], v15, s[8:11], s100 offen offset:1024
    buffer_load_dwordx4 a[152:155], v15, s[8:11], s100 offen offset:2048
    buffer_load_dwordx4 a[156:159], v15, s[8:11], s100 offen offset:3072
    s_waitcnt vmcnt(7)
    v_mfma_f32_16x16x32_bf16 v[96:99], a[128:131], a[192:195], v[64:67]
    s_waitcnt vmcnt(6)
    v_mfma_f32_16x16x32_bf16 v[96:99], a[132:135], a[196:199], v[96:99]
    s_waitcnt vmcnt(5)
    v_mfma_f32_16x16x32_bf16 v[96:99], a[136:139], a[200:203], v[96:99]
    s_waitcnt vmcnt(4)
    v_mfma_f32_16x16x32_bf16 v[96:99], a[140:143], a[204:207], v[96:99]
    v_mfma_f32_16x16x32_bf16 v[104:107], a[128:131], a[208:211], v[68:71]
    v_mfma_f32_16x16x32_bf16 v[104:107], a[132:135], a[212:215], v[104:107]
    v_mfma_f32_16x16x32_bf16 v[104:107], a[136:139], a[216:219], v[104:107]
    v_mfma_f32_16x16x32_bf16 v[104:107], a[140:143], a[220:223], v[104:107]
    s_waitcnt vmcnt(3)
    v_mfma_f32_16x16x32_bf16 v[100:103], a[144:147], a[192:195], v[64:67]
    s_waitcnt vmcnt(2)
    v_mfma_f32_16x16x32_bf16 v[100:103], a[148:151], a[196:199], v[100:103]
    s_waitcnt vmcnt(1)
    v_mfma_f32_16x16x32_bf16 v[100:103], a[152:155], a[200:203], v[100:103]
    s_waitcnt vmcnt(0)
    v_mfma_f32_16x16x32_bf16 v[100:103], a[156:159], a[204:207], v[100:103]
    v_mfma_f32_16x16x32_bf16 v[108:111], a[144:147], a[208:211], v[68:71]
    v_mfma_f32_16x16x32_bf16 v[108:111], a[148:151], a[212:215], v[108:111]
    v_mfma_f32_16x16x32_bf16 v[108:111], a[152:155], a[216:219], v[108:111]
    v_mfma_f32_16x16x32_bf16 v[108:111], a[156:159], a[220:223], v[108:111]
    v_mfma_f32_16x16x32_bf16 v[112:115], a[128:131], a[224:227], v[72:75]
    v_mfma_f32_16x16x32_bf16 v[112:115], a[132:135], a[228:231], v[112:115]
    v_mfma_f32_16x16x32_bf16 v[112:115], a[136:139], a[232:235], v[112:115]
    v_mfma_f32_16x16x32_bf16 v[112:115], a[140:143], a[236:239], v[112:115]
    v_mfma_f32_16x16x32_bf16 v[120:123], a[128:131], a[240:243], v[76:79]
    v_mfma_f32_16x16x32_bf16 v[120:123], a[132:135], a[244:247], v[120:123]
    v_mfma_f32_16x16x32_bf16 v[120:123], a[136:139], a[248:251], v[120:123]
    v_mfma_f32_16x16x32_bf16 v[120:123], a[140:143], a[252:255], v[120:123]
    v_mfma_f32_16x16x32_bf16 v[116:119], a[144:147], a[224:227], v[72:75]
    v_mfma_f32_16x16x32_bf16 v[116:119], a[148:151], a[228:231], v[116:119]
    v_mfma_f32_16x16x32_bf16 v[116:119], a[152:155], a[232:235], v[116:119]
    v_mfma_f32_16x16x32_bf16 v[116:119], a[156:159], a[236:239], v[116:119]
    v_mfma_f32_16x16x32_bf16 v[124:127], a[144:147], a[240:243], v[76:79]
    v_mfma_f32_16x16x32_bf16 v[124:127], a[148:151], a[244:247], v[124:127]
    v_mfma_f32_16x16x32_bf16 v[124:127], a[152:155], a[248:251], v[124:127]
    v_mfma_f32_16x16x32_bf16 v[124:127], a[156:159], a[252:255], v[124:127]
    v_max3_f32 v48, v48, v96, v97
    v_max3_f32 v48, v48, v98, v99
    v_max3_f32 v48, v48, v100, v101
    v_max3_f32 v48, v48, v102, v103
    v_max3_f32 v49, v49, v104, v105
    v_max3_f32 v49, v49, v106, v107
    v_max3_f32 v49, v49, v108, v109
    v_max3_f32 v49, v49, v110, v111
    v_max3_f32 v50, v50, v112, v113
    v_max3_f32 v50, v50, v114, v115
    v_max3_f32 v50, v50, v116, v117
    v_max3_f32 v50, v50, v118, v119
    v_max3_f32 v51, v51, v120, v121
    v_max3_f32 v51, v51, v122, v123
    v_max3_f32 v51, v51, v124, v125
    v_max3_f32 v51, v51, v126, v127
    s_add_u32 s101, s101, 65536
    s_sub_u32 s14, s14, 1
    s_nop 7
    s_branch L_t2_maxl
L_t2_maxd:
    s_add_u32 s100, s101, 0
    buffer_load_dwordx4 a[128:131], v1, s[8:11], s100 offen offset:0
    buffer_load_dwordx4 a[132:135], v1, s[8:11], s100 offen offset:1024
    buffer_load_dwordx4 a[136:139], v1, s[8:11], s100 offen offset:2048
    buffer_load_dwordx4 a[140:143], v1, s[8:11], s100 offen offset:3072
    buffer_load_dwordx4 a[144:147], v15, s[8:11], s100 offen offset:0
    buffer_load_dwordx4 a[148:151], v15, s[8:11], s100 offen offset:1024
    buffer_load_dwordx4 a[152:155], v15, s[8:11], s100 offen offset:2048
    buffer_load_dwordx4 a[156:159], v15, s[8:11], s100 offen offset:3072
    v_add_f32 v80, 0, v21
    v_min_f32 v80, v80, v64
    v_add_f32 v81, 0xf1800000, v21
    v_min_f32 v81, v81, v65
    v_add_f32 v82, 0xf2000000, v21
    v_min_f32 v82, v82, v66
    v_add_f32 v83, 0xf2400000, v21
    v_min_f32 v83, v83, v67
    v_add_f32 v84, 0xf3800000, v21
    v_min_f32 v84, v84, v64
    v_add_f32 v85, 0xf3880000, v21
    v_min_f32 v85, v85, v65
    v_add_f32 v86, 0xf3900000, v21
    v_min_f32 v86, v86, v66
    v_add_f32 v87, 0xf3980000, v21
    v_min_f32 v87, v87, v67
    v_add_f32 v88, 0x73800000, v21
    v_min_f32 v88, v88, v68
    v_add_f32 v89, 0x73700000, v21
    v_min_f32 v89, v89, v69
    v_add_f32 v90, 0x73600000, v21
    v_min_f32 v90, v90, v70
    v_add_f32 v91, 0x73500000, v21
    v_min_f32 v91, v91, v71
    v_add_f32 v92, 0, v21
    v_min_f32 v92, v92, v68
    v_add_f32 v93, 0xf1800000, v21
    v_min_f32 v93, v93, v69
    v_add_f32 v94, 0xf2000000, v21
    v_min_f32 v94, v94, v70
    v_add_f32 v95, 0xf2400000, v21
    v_min_f32 v95, v95, v71
    s_waitcnt vmcnt(7)
    v_mfma_f32_16x16x32_bf16 v[96:99], a[128:131], a[192:195], v[80:83]
    s_waitcnt vmcnt(6)
    v_mfma_f32_16x16x32_bf16 v[96:99], a[132:135], a[196:199], v[96:99]
    s_waitcnt vmcnt(5)
    v_mfma_f32_16x16x32_bf16 v[96:99], a[136:139], a[200:203], v[96:99]
    s_waitcnt vmcnt(4)
    v_mfma_f32_16x16x32_bf16 v[96:99], a[140:143], a[204:207], v[96:99]
    v_mfma_f32_16x16x32_bf16 v[104:107], a[128:131], a[208:211], v[88:91]
    v_mfma_f32_16x16x32_bf16 v[104:107], a[132:135], a[212:215], v[104:107]
    v_mfma_f32_16x16x32_bf16 v[104:107], a[136:139], a[216:219], v[104:107]
    v_mfma_f32_16x16x32_bf16 v[104:107], a[140:143], a[220:223], v[104:107]
    s_waitcnt vmcnt(3)
    v_mfma_f32_16x16x32_bf16 v[100:103], a[144:147], a[192:195], v[84:87]
    s_waitcnt vmcnt(2)
    v_mfma_f32_16x16x32_bf16 v[100:103], a[148:151], a[196:199], v[100:103]
    s_waitcnt vmcnt(1)
    v_mfma_f32_16x16x32_bf16 v[100:103], a[152:155], a[200:203], v[100:103]
    s_waitcnt vmcnt(0)
    v_mfma_f32_16x16x32_bf16 v[100:103], a[156:159], a[204:207], v[100:103]
    v_mfma_f32_16x16x32_bf16 v[108:111], a[144:147], a[208:211], v[92:95]
    v_mfma_f32_16x16x32_bf16 v[108:111], a[148:151], a[212:215], v[108:111]
    v_mfma_f32_16x16x32_bf16 v[108:111], a[152:155], a[216:219], v[108:111]
    v_mfma_f32_16x16x32_bf16 v[108:111], a[156:159], a[220:223], v[108:111]
    v_mfma_f32_16x16x32_bf16 v[112:115], a[128:131], a[224:227], v[72:75]
    v_mfma_f32_16x16x32_bf16 v[112:115], a[132:135], a[228:231], v[112:115]
    v_mfma_f32_16x16x32_bf16 v[112:115], a[136:139], a[232:235], v[112:115]
    v_mfma_f32_16x16x32_bf16 v[112:115], a[140:143], a[236:239], v[112:115]
    v_mfma_f32_16x16x32_bf16 v[120:123], a[128:131], a[240:243], v[76:79]
    v_mfma_f32_16x16x32_bf16 v[120:123], a[132:135], a[244:247], v[120:123]
    v_mfma_f32_16x16x32_bf16 v[120:123], a[136:139], a[248:251], v[120:123]
    v_mfma_f32_16x16x32_bf16 v[120:123], a[140:143], a[252:255], v[120:123]
    v_mfma_f32_16x16x32_bf16 v[116:119], a[144:147], a[224:227], v[72:75]
    v_mfma_f32_16x16x32_bf16 v[116:119], a[148:151], a[228:231], v[116:119]
    v_mfma_f32_16x16x32_bf16 v[116:119], a[152:155], a[232:235], v[116:119]
    v_mfma_f32_16x16x32_bf16 v[116:119], a[156:159], a[236:239], v[116:119]
    v_mfma_f32_16x16x32_bf16 v[124:127], a[144:147], a[240:243], v[76:79]
    v_mfma_f32_16x16x32_bf16 v[124:127], a[148:151], a[244:247], v[124:127]
    v_mfma_f32_16x16x32_bf16 v[124:127], a[152:155], a[248:251], v[124:127]
    v_mfma_f32_16x16x32_bf16 v[124:127], a[156:159], a[252:255], v[124:127]
    v_max3_f32 v48, v48, v96, v97
    v_max3_f32 v48, v48, v98, v99
    v_max3_f32 v48, v48, v100, v101
    v_max3_f32 v48, v48, v102, v103
    v_max3_f32 v49, v49, v104, v105
    v_max3_f32 v49, v49, v106, v107
    v_max3_f32 v49, v49, v108, v109
    v_max3_f32 v49, v49, v110, v111
    v_max3_f32 v50, v50, v112, v113
    v_max3_f32 v50, v50, v114, v115
    v_max3_f32 v50, v50, v116, v117
    v_max3_f32 v50, v50, v118, v119
    v_max3_f32 v51, v51, v120, v121
    v_max3_f32 v51, v51, v122, v123
    v_max3_f32 v51, v51, v124, v125
    v_max3_f32 v51, v51, v126, v127
    s_add_u32 s100, s101, 16384
    buffer_load_dwordx4 a[128:131], v1, s[8:11], s100 offen offset:0
    buffer_load_dwordx4 a[132:135], v1, s[8:11], s100 offen offset:1024
    buffer_load_dwordx4 a[136:139], v1, s[8:11], s100 offen offset:2048
    buffer_load_dwordx4 a[140:143], v1, s[8:11], s100 offen offset:3072
    buffer_load_dwordx4 a[144:147], v15, s[8:11], s100 offen offset:0
    buffer_load_dwordx4 a[148:151], v15, s[8:11], s100 offen offset:1024
    buffer_load_dwordx4 a[152:155], v15, s[8:11], s100 offen offset:2048
    buffer_load_dwordx4 a[156:159], v15, s[8:11], s100 offen offset:3072
    v_add_f32 v80, 0, v22
    v_min_f32 v80, v80, v72
    v_add_f32 v81, 0xf1800000, v22
    v_min_f32 v81, v81, v73
    v_add_f32 v82, 0xf2000000, v22
    v_min_f32 v82, v82, v74
    v_add_f32 v83, 0xf2400000, v22
    v_min_f32 v83, v83, v75
    v_add_f32 v84, 0xf3800000, v22
    v_min_f32 v84, v84, v72
    v_add_f32 v85, 0xf3880000, v22
    v_min_f32 v85, v85, v73
    v_add_f32 v86, 0xf3900000, v22
    v_min_f32 v86, v86, v74
    v_add_f32 v87, 0xf3980000, v22
    v_min_f32 v87, v87, v75
    v_add_f32 v88, 0x73800000, v22
    v_min_f32 v88, v88, v76
    v_add_f32 v89, 0x73700000, v22
    v_min_f32 v89, v89, v77
    v_add_f32 v90, 0x73600000, v22
    v_min_f32 v90, v90, v78
    v_add_f32 v91, 0x73500000, v22
    v_min_f32 v91, v91, v79
    v_add_f32 v92, 0, v22
    v_min_f32 v92, v92, v76
    v_add_f32 v93, 0xf1800000, v22
    v_min_f32 v93, v93, v77
    v_add_f32 v94, 0xf2000000, v22
    v_min_f32 v94, v94, v78
    v_add_f32 v95, 0xf2400000, v22
    v_min_f32 v95, v95, v79
    s_waitcnt vmcnt(7)
    v_mfma_f32_16x16x32_bf16 v[96:99], a[128:131], a[224:227], v[80:83]
    s_waitcnt vmcnt(6)
    v_mfma_f32_16x16x32_bf16 v[96:99], a[132:135], a[228:231], v[96:99]
    s_waitcnt vmcnt(5)
    v_mfma_f32_16x16x32_bf16 v[96:99], a[136:139], a[232:235], v[96:99]
    s_waitcnt vmcnt(4)
    v_mfma_f32_16x16x32_bf16 v[96:99], a[140:143], a[236:239], v[96:99]
    v_mfma_f32_16x16x32_bf16 v[104:107], a[128:131], a[240:243], v[88:91]
    v_mfma_f32_16x16x32_bf16 v[104:107], a[132:135], a[244:247], v[104:107]
    v_mfma_f32_16x16x32_bf16 v[104:107], a[136:139], a[248:251], v[104:107]
    v_mfma_f32_16x16x32_bf16 v[104:107], a[140:143], a[252:255], v[104:107]
    s_waitcnt vmcnt(3)
    v_mfma_f32_16x16x32_bf16 v[100:103], a[144:147], a[224:227], v[84:87]
    s_waitcnt vmcnt(2)
    v_mfma_f32_16x16x32_bf16 v[100:103], a[148:151], a[228:231], v[100:103]
    s_waitcnt vmcnt(1)
    v_mfma_f32_16x16x32_bf16 v[100:103], a[152:155], a[232:235], v[100:103]
    s_waitcnt vmcnt(0)
    v_mfma_f32_16x16x32_bf16 v[100:103], a[156:159], a[236:239], v[100:103]
    v_mfma_f32_16x16x32_bf16 v[108:111], a[144:147], a[240:243], v[92:95]
    v_mfma_f32_16x16x32_bf16 v[108:111], a[148:151], a[244:247], v[108:111]
    v_mfma_f32_16x16x32_bf16 v[108:111], a[152:155], a[248:251], v[108:111]
    v_mfma_f32_16x16x32_bf16 v[108:111], a[156:159], a[252:255], v[108:111]
    v_max3_f32 v50, v50, v96, v97
    v_max3_f32 v50, v50, v98, v99
    s_nop 1
    v_max3_f32 v50, v50, v100, v101
    v_max3_f32 v50, v50, v102, v103
    v_max3_f32 v51, v51, v104, v105
    v_max3_f32 v51, v51, v106, v107
    v_max3_f32 v51, v51, v108, v109
    v_max3_f32 v51, v51, v110, v111
    v_mov_b32 v52, v48
    v_mov_b32 v53, v49
    v_mov_b32 v54, v50
    v_mov_b32 v55, v51
    v_permlane16_swap_b32 v48, v52
    v_permlane16_swap_b32 v49, v53
    v_permlane16_swap_b32 v50, v54
    v_permlane16_swap_b32 v51, v55
    v_max_f32 v48, v48, v52
    v_max_f32 v49, v49, v53
    v_max_f32 v50, v50, v54
    v_max_f32 v51, v51, v55
    v_mov_b32 v52, v48
    v_mov_b32 v53, v49
    v_mov_b32 v54, v50
    v_mov_b32 v55, v51
    v_permlane32_swap_b32 v48, v52
    v_permlane32_swap_b32 v49, v53
    v_permlane32_swap_b32 v50, v54
    v_permlane32_swap_b32 v51, v55
    v_max_f32 v48, v48, v52
    v_max_f32 v49, v49, v53
    v_max_f32 v50, v50, v54
    v_max_f32 v51, v51, v55
    ds_write_b128 v16, v[48:51] offset:32768
    v_xor_b32 v8, 8192, v16
    s_waitcnt lgkmcnt(0)
    s_barrier
    ds_read_b128 v[52:55], v8 offset:32768
    s_waitcnt lgkmcnt(0)
    v_max_f32 v48, v48, v52
    v_max_f32 v49, v49, v53
    v_max_f32 v50, v50, v54
    v_max_f32 v51, v51, v55
    v_sub_f32 v64, 0, v48
    v_sub_f32 v65, 0, v48
    v_sub_f32 v66, 0, v48
    v_sub_f32 v67, 0, v48
    v_sub_f32 v68, 0, v49
    v_sub_f32 v69, 0, v49
    v_sub_f32 v70, 0, v49
    v_sub_f32 v71, 0, v49
    v_sub_f32 v72, 0, v50
    v_sub_f32 v73, 0, v50
    v_sub_f32 v74, 0, v50
    v_sub_f32 v75, 0, v50
    v_sub_f32 v76, 0, v51
    v_sub_f32 v77, 0, v51
    v_sub_f32 v78, 0, v51
    v_sub_f32 v79, 0, v51
    s_add_u32 s12, s13, 1
    s_and_b32 s100, s12, 1
    s_mul_i32 s15, s100, 196608
    s_xor_b32 s15, s15, 65536
    s_mul_i32 s16, s100, 98304
    s_xor_b32 s16, s16, 98304
    v_and_b32 v18, 0x7fff, v18
    v_or_b32 v18, s15, v18
    v_and_b32 v19, 0x7fff, v19
    v_or_b32 v19, s16, v19
    v_and_b32 v20, 0x7fff, v20
    v_or_b32 v20, s16, v20
    s_add_u32 s15, s15, s62
    s_add_u32 s16, s16, s62
    s_add_u32 s12, s12, 2
    s_mov_b32 s82, s81
    s_add_u32 s19, s81, 32768
    s_add_u32 m0, s15, 0
    s_nop 0
    buffer_load_dwordx4 v1, s[8:11], s82 offen offset:0 lds
    buffer_load_dwordx4 v1, s[8:11], s82 offen offset:1024 lds
    buffer_load_dwordx4 v1, s[8:11], s82 offen offset:2048 lds
    buffer_load_dwordx4 v1, s[8:11], s82 offen offset:3072 lds
    s_add_u32 m0, s15, 4096
    s_nop 0
    buffer_load_dwordx4 v15, s[8:11], s82 offen offset:0 lds
    buffer_load_dwordx4 v15, s[8:11], s82 offen offset:1024 lds
    buffer_load_dwordx4 v15, s[8:11], s82 offen offset:2048 lds
    buffer_load_dwordx4 v15, s[8:11], s82 offen offset:3072 lds
    s_xor_b32 s15, s15, 196608
    s_add_u32 m0, s16, 0
    s_nop 0
    buffer_load_dwordx4 v1, s[8:11], s19 offen offset:0 lds
    buffer_load_dwordx4 v1, s[8:11], s19 offen offset:1024 lds
    buffer_load_dwordx4 v1, s[8:11], s19 offen offset:2048 lds
    buffer_load_dwordx4 v1, s[8:11], s19 offen offset:3072 lds
    s_add_u32 m0, s16, 4096
    s_nop 0
    buffer_load_dwordx4 v15, s[8:11], s19 offen offset:0 lds
    buffer_load_dwordx4 v15, s[8:11], s19 offen offset:1024 lds
    buffer_load_dwordx4 v15, s[8:11], s19 offen offset:2048 lds
    buffer_load_dwordx4 v15, s[8:11], s19 offen offset:3072 lds
    s_xor_b32 s16, s16, 98304
    s_min_u32 s82, s61, 1
    s_lshl_b32 s82, s82, 16
    s_add_u32 s82, s82, s81
    s_add_u32 m0, s15, 0
    s_nop 0
    buffer_load_dwordx4 v1, s[8:11], s82 offen offset:0 lds
    buffer_load_dwordx4 v1, s[8:11], s82 offen offset:1024 lds
    buffer_load_dwordx4 v1, s[8:11], s82 offen offset:2048 lds
    buffer_load_dwordx4 v1, s[8:11], s82 offen offset:3072 lds
    s_add_u32 m0, s15, 4096
    s_nop 0
    buffer_load_dwordx4 v15, s[8:11], s82 offen offset:0 lds
    buffer_load_dwordx4 v15, s[8:11], s82 offen offset:1024 lds
    buffer_load_dwordx4 v15, s[8:11], s82 offen offset:2048 lds
    buffer_load_dwordx4 v15, s[8:11], s82 offen offset:3072 lds
    s_xor_b32 s15, s15, 196608
    s_waitcnt vmcnt(0) lgkmcnt(0)
    s_barrier
    ds_read_b128 a[128:131], v18 offset:0
    ds_read_b128 a[132:135], v18 offset:1024
    ds_read_b128 a[136:139], v18 offset:2048
    ds_read_b128 a[140:143], v18 offset:3072
    ds_read_b128 a[144:147], v18 offset:4096
    ds_read_b128 a[148:151], v18 offset:5120
    ds_read_b128 a[152:155], v18 offset:6144
    ds_read_b128 a[156:159], v18 offset:7168
    s_waitcnt lgkmcnt(0)
    s_branch L_t2_start
L_C2_slow_13:
    s_mov_b32 s99, 0
L_C2_slow_13_l:
    s_sleep 4
    buffer_load_dword v3, v4, s[8:11], s23 offen sc0 sc1
    s_add_u32 s99, s99, 1
    s_waitcnt vmcnt(0)
    v_cmp_ne_u32 vcc, 0, v3
    s_cmp_eq_u64 vcc, -1
    s_cbranch_scc1 L_C2_ok_14
    s_cmp_lt_u32 s99, 200000
    s_cbranch_scc1 L_C2_slow_13_l
    s_branch L_C2_ok_14
L_P1_slow_15:
    s_mov_b32 s99, 0
L_P2_l_5001:
    s_waitcnt vmcnt(0)
    v_max_u32 v48, v128, v129
    v_max3_u32 v48, v48, v130, v131
    v_max_u32 v49, v132, v133
    v_max3_u32 v49, v49, v134, v135
    v_max_u32 v50, v136, v137
    v_max3_u32 v50, v50, v138, v139
    v_max_u32 v51, v140, v141
    v_max3_u32 v51, v51, v142, v143
    v_max_u32 v52, v144, v145
    v_max3_u32 v52, v52, v146, v147
    v_max_u32 v53, v148, v149
    v_max3_u32 v53, v53, v150, v151
    v_max_u32 v54, v152, v153
    v_max3_u32 v54, v54, v154, v155
    v_max_u32 v55, v156, v157
    v_max3_u32 v55, v55, v158, v159
    v_max3_u32 v3, v48, v49, v50
    v_max3_u32 v3, v3, v51, v52
    v_max3_u32 v3, v3, v53, v54
    v_max_u32 v3, v3, v55
    v_cmp_eq_u32 vcc, -1, v3
    s_add_u32 s99, s99, 1
    s_cbranch_vccz L_P2_ok_5002
    s_cmp_ge_u32 s99, 200000
    s_cbranch_scc1 L_P2_ok_5002
    s_sleep 1
    v_cmp_eq_u32 vcc, -1, v48
    s_cbranch_vccz L_P2_s_5003
    s_and_b64 s[96:97], vcc, s[12:13]
    s_cselect_b64 exec, s[96:97], vcc
    s_add_u32 s74, s70, 0
    buffer_load_dwordx4 v[128:131], v44, s[8:11], s74 offen sc0 sc1
    s_mov_b64 exec, -1
L_P2_s_5003:
    v_cmp_eq_u32 vcc, -1, v49
    s_cbranch_vccz L_P2_s_5004
    s_and_b64 s[96:97], vcc, s[12:13]
    s_cselect_b64 exec, s[96:97], vcc
    s_add_u32 s74, s70, 4096
    buffer_load_dwordx4 v[132:135], v44, s[8:11], s74 offen sc0 sc1
    s_mov_b64 exec, -1
L_P2_s_5004:
    v_cmp_eq_u32 vcc, -1, v50
    s_cbranch_vccz L_P2_s_5005
    s_and_b64 s[96:97], vcc, s[12:13]
    s_cselect_b64 exec, s[96:97], vcc
    s_add_u32 s74, s70, 8192
    buffer_load_dwordx4 v[136:139], v44, s[8:11], s74 offen sc0 sc1
    s_mov_b64 exec, -1
L_P2_s_5005:
    v_cmp_eq_u32 vcc, -1, v51
    s_cbranch_vccz L_P2_s_5006
    s_and_b64 s[96:97], vcc, s[12:13]
    s_cselect_b64 exec, s[96:97], vcc
    s_add_u32 s74, s70, 12288
    buffer_load_dwordx4 v[140:143], v44, s[8:11], s74 offen sc0 sc1
    s_mov_b64 exec, -1
L_P2_s_5006:
    v_cmp_eq_u32 vcc, -1, v52
    s_cbranch_vccz L_P2_s_5007
    s_and_b64 s[96:97], vcc, s[12:13]
    s_cselect_b64 exec, s[96:97], vcc
    s_add_u32 s74, s70, 16384
    buffer_load_dwordx4 v[144:147], v44, s[8:11], s74 offen sc0 sc1
    s_mov_b64 exec, -1
L_P2_s_5007:
    v_cmp_eq_u32 vcc, -1, v53
    s_cbranch_vccz L_P2_s_5008
    s_and_b64 s[96:97], vcc, s[12:13]
    s_cselect_b64 exec, s[96:97], vcc
    s_add_u32 s74, s70, 20480
    buffer_load_dwordx4 v[148:151], v44, s[8:11], s74 offen sc0 sc1
    s_mov_b64 exec, -1
L_P2_s_5008:
    v_cmp_eq_u32 vcc, -1, v54
    s_cbranch_vccz L_P2_s_5009
    s_and_b64 s[96:97], vcc, s[12:13]
    s_cselect_b64 exec, s[96:97], vcc
    s_add_u32 s74, s70, 24576
    buffer_load_dwordx4 v[152:155], v44, s[8:11], s74 offen sc0 sc1
    s_mov_b64 exec, -1
L_P2_s_5009:
    v_cmp_eq_u32 vcc, -1, v55
    s_cbranch_vccz L_P2_s_5010
    s_and_b64 s[96:97], vcc, s[12:13]
    s_cselect_b64 exec, s[96:97], vcc
    s_add_u32 s74, s70, 28672
    buffer_load_dwordx4 v[156:159], v44, s[8:11], s74 offen sc0 sc1
    s_mov_b64 exec, -1
L_P2_s_5010:
    s_branch L_P2_l_5001
L_P2_ok_5002:
    s_branch L_P1_ok_16
L_code_end:
    s_endpgm
.section .rodata,"a"
.p2align 6
.amdhsa_kernel adaLN_cond__compressed_kv_cla__moe_arch_mod__prompt_kernel
  .amdhsa_next_free_vgpr 512
  .amdhsa_next_free_sgpr 102
  .amdhsa_accum_offset 256
  .amdhsa_group_segment_fixed_size 0
  .amdhsa_kernarg_size 128
  .amdhsa_user_sgpr_count 2
  .amdhsa_user_sgpr_kernarg_segment_ptr 1
  .amdhsa_system_sgpr_workgroup_id_x 1
.end_amdhsa_kernel
```

```asm
; @launch grid=(256,1,1) block=(256,1,1) lds=163840
.amdgcn_target "amdgcn-amd-amdhsa--gfx950"
.text
.globl adaLN_cond__compressed_kv_cla__moe_arch_mod__prompt_kernel
.p2align 8
.type adaLN_cond__compressed_kv_cla__moe_arch_mod__prompt_kernel,@function
adaLN_cond__compressed_kv_cla__moe_arch_mod__prompt_kernel:
    s_cmp_ge_u32 s2, 256
    s_cbranch_scc1 L_end
    s_load_dwordx16 s[64:79], s[0:1], 0
    s_load_dwordx16 s[80:95], s[0:1], 64
    s_getpc_b64 s[100:101]
L_pf1:
    v_lshrrev_b32 v3, 6, v0
    v_and_b32 v2, 63, v0
    s_lshr_b32 s5, s2, 3
    s_mul_i32 s98, s5, 24
    v_min_u32 v5, 5, v2
    v_mad_u32_u24 v5, v3, 6, v5
    v_add_u32 v5, s98, v5
    v_lshlrev_b32 v5, 7, v5
    v_min_u32 v5, L_code_end-L_pf1, v5
    global_load_dword a255, v5, s[100:101]
    v_readfirstlane_b32 s3, v3
    v_lshlrev_b32 v1, 4, v2
    s_and_b32 s4, s2, 7
    s_and_b32 s5, s5, 3
    s_lshr_b32 s6, s2, 5
    s_lshl_b32 s7, s4, 2
    s_add_u32 s7, s7, s5
    s_mov_b32 s60, s6
    s_sub_u32 s61, 15, s6
    v_lshrrev_b32 v3, 3, v2
    v_lshrrev_b32 v4, 4, v2
    v_and_b32 v5, 7, v2
    v_xor_b32 v5, v5, v4
    v_lshlrev_b32 v5, 4, v5
    v_lshl_add_u32 v16, v3, 10, v5
    v_xor_b32 v17, 64, v16
    v_add_u32 v17, 7168, v17
    v_add_u32 v18, 14336, v16
    v_add_u32 v19, 14336, v17
    v_bfe_u32 v5, v2, 1, 3
    v_xor_b32 v5, v5, v4
    v_lshlrev_b32 v5, 5, v5
    v_and_b32 v6, 1, v2
    v_lshl_add_u32 v5, v6, 4, v5
    v_lshl_add_u32 v20, v4, 13, v5
    v_add_u32 v21, 31744, v20
    v_xor_b32 v22, 128, v20
    v_add_u32 v22, 63488, v22
    v_add_u32 v23, 31744, v22
    s_lshl_b32 s62, s3, 13
    s_lshl_b32 s63, s3, 12
    s_lshl_b32 s96, s6, 18
    s_lshl_b32 s98, s3, 16
    s_add_u32 s96, s96, s98
    s_lshl_b32 s97, s3, 17
    s_lshl_b32 s99, s5, 0
    s_xor_b32 s99, s99, s6
    s_lshl_b32 s99, s99, 3
    s_and_b32 s99, s99, 7
    s_lshl_b32 s98, s99, 7
    s_add_u32 s96, s96, s98
    s_lshl_b32 s98, s99, 19
    s_add_u32 s97, s97, s98
    v_and_b32 v84, 7, v2
    v_lshrrev_b32 v65, 3, v0
    v_mul_u32_u24 v64, 24576, v65
    v_lshl_add_u32 v64, v84, 4, v64
    v_lshlrev_b32 v65, 3, v65
    v_lshrrev_b32 v85, 3, v2
    v_lshlrev_b32 v86, 10, v84
    v_lshl_add_u32 v86, v85, 4, v86
    s_lshl_b32 s100, s7, 8
    s_waitcnt lgkmcnt(0)
    s_add_u32 s16, s70, s100
    s_addc_u32 s17, s71, 0
    s_sub_u32 s18, 4194304, s100
    s_mov_b32 s19, 0x00020000
    s_mov_b32 s12, s66
    s_mov_b32 s13, s67
    s_mov_b32 s14, 2097152
    s_mov_b32 s15, 0x00020000
    s_add_u32 m0, s63, 98304
    s_xor_b32 s98, s97, 0
    buffer_load_dwordx4 v20, s[16:19], s98 offen offset:0   lds
    buffer_load_dwordx4 v21, s[16:19], s98 offen offset:1024   lds
    buffer_load_dwordx4 v22, s[16:19], s98 offen offset:2048   lds
    buffer_load_dwordx4 v23, s[16:19], s98 offen offset:3072   lds
    s_add_u32 m0, s62, 0
    s_xor_b32 s98, s96, 0
    buffer_load_dwordx4 v16, s[12:15], s98 offen offset:0   lds
    buffer_load_dwordx4 v17, s[12:15], s98 offen offset:1024   lds
    buffer_load_dwordx4 v18, s[12:15], s98 offen offset:2048   lds
    buffer_load_dwordx4 v19, s[12:15], s98 offen offset:3072   lds
    s_add_u32 m0, s62, 4096
    s_xor_b32 s98, s96, 32768
    buffer_load_dwordx4 v16, s[12:15], s98 offen offset:0   lds
    buffer_load_dwordx4 v17, s[12:15], s98 offen offset:1024   lds
    buffer_load_dwordx4 v18, s[12:15], s98 offen offset:2048   lds
    buffer_load_dwordx4 v19, s[12:15], s98 offen offset:3072   lds
    s_mov_b32 s40, s88
    s_mov_b32 s41, s89
    s_mov_b32 s42, 3145728
    s_mov_b32 s43, 0x00020000
    s_mov_b32 s44, s86
    s_mov_b32 s45, s87
    s_mov_b32 s46, 1024
    s_mov_b32 s47, 0x00020000
    s_mov_b32 s32, s64
    s_mov_b32 s33, s65
    s_mov_b32 s34, 2097152
    s_mov_b32 s35, 0x00020000
    s_mov_b32 s8, s94
    s_mov_b32 s9, s95
    s_mov_b32 s10, 268435456
    s_mov_b32 s11, 0x00020000
    s_add_u32 s20, s72, s100
    s_addc_u32 s21, s73, 0
    s_sub_u32 s22, 4194304, s100
    s_mov_b32 s23, 0x00020000
    s_add_u32 s24, s68, s100
    s_addc_u32 s25, s69, 0
    s_sub_u32 s26, 4194304, s100
    s_mov_b32 s27, 0x00020000
    s_mov_b32 s36, s92
    s_mov_b32 s37, s93
    s_mov_b32 s38, 256
    s_mov_b32 s39, 0x00020000
    s_lshl_b32 s100, s4, 19
    s_lshl_b32 s99, s5, 8
    s_add_u32 s100, s100, s99
    s_add_u32 s28, s74, s100
    s_addc_u32 s29, s75, 0
    s_sub_u32 s30, 4194304, s100
    s_mov_b32 s31, 0x00020000
    s_mov_b32 s48, s84
    s_mov_b32 s49, s85
    s_mov_b32 s50, 1835008
    s_mov_b32 s51, 0x00020000
    s_mov_b32 s52, s90
    s_mov_b32 s53, s91
    s_mov_b32 s54, 2097152
    s_mov_b32 s55, 0x00020000
    s_mov_b64 s[92:93], s[80:81]
    s_mov_b64 s[94:95], s[82:83]
    s_mov_b32 s56, s78
    s_mov_b32 s57, s79
    s_mov_b32 s58, 1024
    s_mov_b32 s59, 0x00020000
    s_load_dword s90, s[36:37], 64
    s_load_dword s91, s[8:9], 0x3f00
    s_lshl_b32 s64, s3, 19
    s_and_b32 s100, s97, 3670016
    s_xor_b32 s64, s64, s100
    s_lshr_b32 s100, s6, 1
    s_and_b32 s100, s100, 0
    s_lshl_b32 s1, s100, 12
    s_lshl_b32 s100, s100, 7
    s_add_u32 s64, s64, s100
    s_lshl_b32 s100, s5, 1
    s_xor_b32 s100, s100, s6
    s_and_b32 s100, s100, 0
    s_lshl_b32 s68, s100, 11
    s_lshl_b32 s100, s100, 19
    s_lshl_b32 s0, s3, 17
    s_add_u32 s0, s0, s100
    s_lshl_b32 s81, s7, 20
    s_add_u32 s81, s81, 16777216
    s_lshl_b32 s100, s6, 17
    s_add_u32 s65, s81, s100
    s_lshr_b32 s100, s3, 1
    s_lshl_b32 s100, s100, 16
    s_add_u32 s65, s65, s100
    s_and_b32 s100, s3, 1
    s_lshl_b32 s100, s100, 14
    s_add_u32 s65, s65, s100
    s_add_u32 s81, s81, s62
    s_min_u32 s82, s60, 1
    s_lshl_b32 s82, s82, 16
    s_add_u32 s82, s82, s81
    s_sub_u32 s100, s6, 2
    s_lshl_b32 s69, s100, 7
    s_lshl_b32 s100, s100, 3
    s_add_u32 s100, s100, s4
    s_lshl_b32 s100, s100, 8
    s_mul_i32 s101, s5, 12288
    s_add_u32 s100, s100, s101
    s_add_u32 s100, s100, 16384
    s_cmp_ge_u32 s6, 2
    s_cselect_b32 s66, s100, 2147479552
    s_cselect_b32 s69, s69, 2147479552
    s_cmp_eq_u32 s3, 0
    s_cselect_b32 s66, s66, 2147479552
    s_lshl_b32 s70, s3, 9
    s_add_u32 s70, s70, 16384
    s_lshr_b32 s71, s2, 1
    s_lshl_b32 s71, s71, 14
    s_and_b32 s100, s2, 1
    s_lshl_b32 s100, s100, 7
    s_add_u32 s71, s71, s100
    s_add_u32 s71, s71, s63
    s_add_u32 s71, s71, 2097152
    s_lshl_b32 s72, s2, 2
    s_add_u32 s72, s72, s3
    s_lshl_b32 s72, s72, 6
    s_add_u32 s72, s72, 1048576
    s_lshl_b32 s74, s7, 11
    s_add_u32 s74, s74, 1114112
    s_lshl_b32 s73, s6, 2
    s_add_u32 s73, s73, s3
    s_lshl_b32 s73, s73, 6
    s_add_u32 s73, s73, s74
    s_lshr_b32 s100, s3, 1
    s_sub_u32 s101, 3, s100
    s_and_b32 s98, s3, 1
    s_cselect_b32 s100, s101, s100
    s_lshl_b32 s75, s60, 2
    s_add_u32 s75, s75, s100
    s_lshl_b32 s76, s61, 2
    s_add_u32 s76, s76, s100
    s_sub_u32 s77, s76, s75
    s_lshl_b32 s77, s77, 10
    s_lshl_b32 s78, s75, 10
    s_add_u32 s78, s78, 983040
    s_lshl_b32 s75, s75, 15
    s_add_u32 s75, s75, 2097152
    s_add_u32 s75, s75, s68
    s_lshl_b32 s76, s76, 15
    s_add_u32 s76, s76, 2097152
    s_add_u32 s76, s76, s68
    s_add_u32 s1, s1, s65
    s_cmp_eq_u32 s3, 0
    s_cselect_b32 s68, 32, 0
    s_cselect_b32 s67, 0, 2147479552
    v_and_b32 v48, 15, v2
    v_lshrrev_b32 v49, 4, v2
    v_lshrrev_b32 v50, 1, v48
    v_xor_b32 v50, v50, v49
    v_lshlrev_b32 v50, 4, v50
    v_lshl_add_u32 v28, v48, 7, v50
    v_add_u32 v28, s62, v28
    v_xor_b32 v29, 64, v28
    v_add_u32 v30, 65536, v28
    v_add_u32 v31, 65536, v29
    v_lshrrev_b32 v50, 2, v48
    v_and_b32 v51, 3, v48
    v_lshl_add_u32 v52, v49, 3, v50
    v_lshlrev_b32 v53, 8, v52
    v_lshl_add_u32 v53, v51, 3, v53
    v_add_u32 v53, 98304, v53
    v_and_b32 v54, 1, v49
    v_lshl_add_u32 v54, v54, 2, v50
    v_xor_b32 v55, 0, v54
    v_lshl_add_u32 v8, v55, 5, v53
    v_xor_b32 v55, 1, v54
    v_lshl_add_u32 v9, v55, 5, v53
    v_xor_b32 v55, 2, v54
    v_lshl_add_u32 v10, v55, 5, v53
    v_xor_b32 v55, 3, v54
    v_lshl_add_u32 v11, v55, 5, v53
    v_xor_b32 v55, 4, v54
    v_lshl_add_u32 v12, v55, 5, v53
    v_xor_b32 v55, 5, v54
    v_lshl_add_u32 v13, v55, 5, v53
    v_xor_b32 v55, 6, v54
    v_lshl_add_u32 v14, v55, 5, v53
    v_xor_b32 v55, 7, v54
    v_lshl_add_u32 v15, v55, 5, v53
    v_bfe_u32 v49, v2, 1, 2
    v_bfe_u32 v50, v2, 4, 1
    v_xor_b32 v49, v49, v50
    v_lshlrev_b32 v49, 5, v49
    v_and_b32 v50, 1, v2
    v_lshl_add_u32 v49, v50, 4, v49
    v_lshl_add_u32 v24, v85, 13, v49
    v_xor_b32 v25, 64, v24
    v_add_u32 v25, 64512, v25
    v_add_u32 v26, 129024, v24
    v_add_u32 v27, 129024, v25
    v_cmp_eq_u32 vcc, 0, v2
    v_mov_b32 v6, 2147479552
    s_nop 0
    v_cndmask_b32 v5, v6, v2, vcc
    v_cmp_eq_u32 vcc, 0, v0
    s_nop 1
    v_cndmask_b32 v7, v6, v0, vcc
    v_and_b32 v48, 8, v2
    v_cmp_eq_u32 vcc, 0, v48
    v_lshlrev_b32 v48, 5, v84
    v_lshrrev_b32 v49, 1, v2
    v_and_b32 v49, 24, v49
    v_add_u32 v48, v48, v49
    s_lshl_b32 s100, s3, 8
    s_add_u32 s100, s100, 147456
    v_add_u32 v48, s100, v48
    v_mov_b32 v49, 148480
    v_cndmask_b32 v98, v49, v48, vcc
    v_lshlrev_b32 v99, 5, v84
    v_add_u32 v99, 149504, v99
    s_lshl_b32 s100, s3, 3
    v_add_u32 v100, s100, v99
    v_lshlrev_b32 v106, 5, v85
    v_lshlrev_b32 v107, 8, v85
    v_lshl_add_u32 v107, v84, 4, v107
    s_sub_u32 s100, s2, 64
    s_lshl_b32 s80, s100, 12
    s_add_u32 s80, s80, 1048576
    s_cmp_lt_u32 s100, 64
    s_cselect_b32 s80, s80, 2147479552
    s_mul_i32 s99, s5, 786432
    s_sub_u32 s79, s6, 2
    s_lshl_b32 s79, s79, 3
    s_add_u32 s79, s79, s4
    s_lshl_b32 s79, s79, 7
    s_add_u32 s79, s79, s99
    s_cmp_ge_u32 s6, 2
    s_cselect_b32 s79, s79, 2147414016
    s_lshl_b32 s100, s5, 8
    v_add_u32 v65, s100, v65
    v_mov_b32 v6, 1
    v_and_b32 v4, 1, v2
    v_lshlrev_b32 v4, 7, v4
    buffer_load_dwordx2 v[66:67], v65, s[44:47], 0 offen
    buffer_load_dwordx4 v[68:71], v64, s[40:43], s79 offen
    s_add_u32 s79, s79, 6144
    buffer_load_dwordx4 v[72:75], v64, s[40:43], s79 offen
    s_add_u32 s79, s79, 6144
    buffer_load_dwordx4 v[76:79], v64, s[40:43], s79 offen
    s_add_u32 s79, s79, 6144
    buffer_load_dwordx4 v[80:83], v64, s[40:43], s79 offen
    s_lshl_b32 s79, s2, 5
    s_add_u32 s79, s79, s3
    s_lshl_b32 s79, s79, 8
    buffer_load_dwordx4 v[88:91], v86, s[32:35], s79 offen
    buffer_load_dwordx4 v[92:95], v86, s[32:35], s79 offen offset:128
    s_add_u32 m0, s63, 114688
    s_xor_b32 s98, s97, 524288
    buffer_load_dwordx4 v20, s[16:19], s98 offen offset:0   lds
    buffer_load_dwordx4 v21, s[16:19], s98 offen offset:1024   lds
    buffer_load_dwordx4 v22, s[16:19], s98 offen offset:2048   lds
    buffer_load_dwordx4 v23, s[16:19], s98 offen offset:3072   lds
    s_add_u32 m0, s62, 32768
    s_xor_b32 s98, s96, 128
    buffer_load_dwordx4 v16, s[12:15], s98 offen offset:0   lds
    buffer_load_dwordx4 v17, s[12:15], s98 offen offset:1024   lds
    buffer_load_dwordx4 v18, s[12:15], s98 offen offset:2048   lds
    buffer_load_dwordx4 v19, s[12:15], s98 offen offset:3072   lds
    s_add_u32 m0, s62, 36864
    s_xor_b32 s98, s96, 32896
    buffer_load_dwordx4 v16, s[12:15], s98 offen offset:0   lds
    buffer_load_dwordx4 v17, s[12:15], s98 offen offset:1024   lds
    buffer_load_dwordx4 v18, s[12:15], s98 offen offset:2048   lds
    buffer_load_dwordx4 v19, s[12:15], s98 offen offset:3072   lds
    s_waitcnt vmcnt(19) lgkmcnt(0)
    s_barrier
    ds_read_b64_tr_b16 v[32:33], v8 offset:0
    ds_read_b64_tr_b16 v[34:35], v8 offset:1024
    ds_read_b128 a[0:3], v28 offset:0
    ds_read_b128 a[4:7], v28 offset:2048
    ds_read_b128 a[8:11], v28 offset:4096
    ds_read_b128 a[12:15], v28 offset:6144
    ds_read_b64_tr_b16 v[36:37], v9 offset:0
    ds_read_b64_tr_b16 v[38:39], v9 offset:1024
    ds_read_b64_tr_b16 v[40:41], v10 offset:0
    ds_read_b64_tr_b16 v[42:43], v10 offset:1024
    ds_read_b64_tr_b16 v[44:45], v11 offset:0
    ds_read_b64_tr_b16 v[46:47], v11 offset:1024
    ds_read_b64_tr_b16 v[48:49], v12 offset:0
    ds_read_b64_tr_b16 v[50:51], v12 offset:1024
    ds_read_b64_tr_b16 v[52:53], v13 offset:0
    ds_read_b64_tr_b16 v[54:55], v13 offset:1024
    ds_read_b64_tr_b16 v[56:57], v14 offset:0
    ds_read_b64_tr_b16 v[58:59], v14 offset:1024
    ds_read_b64_tr_b16 v[60:61], v15 offset:0
    ds_read_b64_tr_b16 v[62:63], v15 offset:1024
    s_waitcnt lgkmcnt(15)
    v_mfma_f32_16x16x32_bf16 v[128:131], v[32:35], a[0:3], 0
    v_mfma_f32_16x16x32_bf16 v[160:163], v[32:35], a[4:7], 0
    v_mfma_f32_16x16x32_bf16 v[192:195], v[32:35], a[8:11], 0
    s_waitcnt lgkmcnt(14)
    s_add_u32 m0, s63, 131072
    s_xor_b32 s98, s97, 1048576
    ds_read_b128 a[16:19], v29 offset:0
    v_mfma_f32_16x16x32_bf16 v[224:227], v[32:35], a[12:15], 0
    s_waitcnt lgkmcnt(13)
    ds_read_b128 a[20:23], v29 offset:2048
    v_mfma_f32_16x16x32_bf16 v[132:135], v[36:39], a[0:3], 0
    ds_read_b64_tr_b16 v[32:33], v8 offset:8192
    v_mfma_f32_16x16x32_bf16 v[164:167], v[36:39], a[4:7], 0
    ds_read_b64_tr_b16 v[34:35], v8 offset:9216
    v_mfma_f32_16x16x32_bf16 v[196:199], v[36:39], a[8:11], 0
    ds_read_b128 a[24:27], v29 offset:4096
    v_mfma_f32_16x16x32_bf16 v[228:231], v[36:39], a[12:15], 0
    s_waitcnt lgkmcnt(15)
    ds_read_b128 a[28:31], v29 offset:6144
    v_mfma_f32_16x16x32_bf16 v[136:139], v[40:43], a[0:3], 0
    ds_read_b64_tr_b16 v[36:37], v9 offset:8192
    v_mfma_f32_16x16x32_bf16 v[168:171], v[40:43], a[4:7], 0
    s_waitcnt lgkmcnt(7)
    ds_read_b64_tr_b16 v[38:39], v9 offset:9216
    v_mfma_f32_16x16x32_bf16 v[200:203], v[40:43], a[8:11], 0
    buffer_load_dwordx4 v20, s[16:19], s98 offen offset:0   lds
    v_mfma_f32_16x16x32_bf16 v[232:235], v[40:43], a[12:15], 0
    buffer_load_dwordx4 v21, s[16:19], s98 offen offset:1024   lds
    v_mfma_f32_16x16x32_bf16 v[140:143], v[44:47], a[0:3], 0
    ds_read_b64_tr_b16 v[40:41], v10 offset:8192
    v_mfma_f32_16x16x32_bf16 v[172:175], v[44:47], a[4:7], 0
    ds_read_b64_tr_b16 v[42:43], v10 offset:9216
    v_mfma_f32_16x16x32_bf16 v[204:207], v[44:47], a[8:11], 0
    buffer_load_dwordx4 v22, s[16:19], s98 offen offset:2048   lds
    v_mfma_f32_16x16x32_bf16 v[236:239], v[44:47], a[12:15], 0
    buffer_load_dwordx4 v23, s[16:19], s98 offen offset:3072   lds
    v_mfma_f32_16x16x32_bf16 v[144:147], v[48:51], a[0:3], 0
    s_add_u32 m0, s62, 65536
    s_xor_b32 s98, s96, 256
    ds_read_b64_tr_b16 v[44:45], v11 offset:8192
    v_mfma_f32_16x16x32_bf16 v[176:179], v[48:51], a[4:7], 0
    ds_read_b64_tr_b16 v[46:47], v11 offset:9216
    v_mfma_f32_16x16x32_bf16 v[208:211], v[48:51], a[8:11], 0
    buffer_load_dwordx4 v16, s[12:15], s98 offen offset:0   lds
    v_mfma_f32_16x16x32_bf16 v[240:243], v[48:51], a[12:15], 0
    buffer_load_dwordx4 v17, s[12:15], s98 offen offset:1024   lds
    v_mfma_f32_16x16x32_bf16 v[148:151], v[52:55], a[0:3], 0
    ds_read_b64_tr_b16 v[48:49], v12 offset:8192
    v_mfma_f32_16x16x32_bf16 v[180:183], v[52:55], a[4:7], 0
    ds_read_b64_tr_b16 v[50:51], v12 offset:9216
    v_mfma_f32_16x16x32_bf16 v[212:215], v[52:55], a[8:11], 0
    buffer_load_dwordx4 v18, s[12:15], s98 offen offset:2048   lds
    v_mfma_f32_16x16x32_bf16 v[244:247], v[52:55], a[12:15], 0
    buffer_load_dwordx4 v19, s[12:15], s98 offen offset:3072   lds
    v_mfma_f32_16x16x32_bf16 v[152:155], v[56:59], a[0:3], 0
    s_add_u32 m0, s62, 69632
    s_xor_b32 s98, s96, 33024
    ds_read_b64_tr_b16 v[52:53], v13 offset:8192
    v_mfma_f32_16x16x32_bf16 v[184:187], v[56:59], a[4:7], 0
    ds_read_b64_tr_b16 v[54:55], v13 offset:9216
    v_mfma_f32_16x16x32_bf16 v[216:219], v[56:59], a[8:11], 0
    buffer_load_dwordx4 v16, s[12:15], s98 offen offset:0   lds
    v_mfma_f32_16x16x32_bf16 v[248:251], v[56:59], a[12:15], 0
    buffer_load_dwordx4 v17, s[12:15], s98 offen offset:1024   lds
    v_mfma_f32_16x16x32_bf16 v[156:159], v[60:63], a[0:3], 0
    ds_read_b64_tr_b16 v[56:57], v14 offset:8192
    v_mfma_f32_16x16x32_bf16 v[188:191], v[60:63], a[4:7], 0
    s_waitcnt lgkmcnt(5)
    ds_read_b64_tr_b16 v[58:59], v14 offset:9216
    v_mfma_f32_16x16x32_bf16 v[220:223], v[60:63], a[8:11], 0
    buffer_load_dwordx4 v18, s[12:15], s98 offen offset:2048   lds
    v_mfma_f32_16x16x32_bf16 v[252:255], v[60:63], a[12:15], 0
    buffer_load_dwordx4 v19, s[12:15], s98 offen offset:3072   lds
    v_mfma_f32_16x16x32_bf16 v[128:131], v[32:35], a[16:19], v[128:131]
    ds_read_b64_tr_b16 v[60:61], v15 offset:8192
    v_mfma_f32_16x16x32_bf16 v[160:163], v[32:35], a[20:23], v[160:163]
    ds_read_b64_tr_b16 v[62:63], v15 offset:9216
    v_mfma_f32_16x16x32_bf16 v[192:195], v[32:35], a[24:27], v[192:195]
    v_mfma_f32_16x16x32_bf16 v[224:227], v[32:35], a[28:31], v[224:227]
    v_mfma_f32_16x16x32_bf16 v[132:135], v[36:39], a[16:19], v[132:135]
    v_mfma_f32_16x16x32_bf16 v[164:167], v[36:39], a[20:23], v[164:167]
    v_mfma_f32_16x16x32_bf16 v[196:199], v[36:39], a[24:27], v[196:199]
    v_mfma_f32_16x16x32_bf16 v[228:231], v[36:39], a[28:31], v[228:231]
    v_mfma_f32_16x16x32_bf16 v[136:139], v[40:43], a[16:19], v[136:139]
    s_waitcnt vmcnt(12) lgkmcnt(0)
    s_barrier
    v_mfma_f32_16x16x32_bf16 v[168:171], v[40:43], a[20:23], v[168:171]
    s_add_u32 m0, s63, 98304
    s_xor_b32 s98, s97, 1572864
    ds_read_b64_tr_b16 v[32:33], v8 offset:16384
    v_lshlrev_b32 v102, 16, v66
    v_and_b32 v103, 0xffff0000, v66
    v_lshlrev_b32 v104, 16, v67
    v_mfma_f32_16x16x32_bf16 v[200:203], v[40:43], a[24:27], v[200:203]
    ds_read_b64_tr_b16 v[34:35], v8 offset:17408
    v_and_b32 v105, 0xffff0000, v67
    v_mul_f32 v108, 0xbfb8aa3b, v102
    v_mul_f32 v109, 0xbfb8aa3b, v103
    v_mfma_f32_16x16x32_bf16 v[232:235], v[40:43], a[28:31], v[232:235]
    ds_read_b64_tr_b16 v[36:37], v9 offset:16384
    v_mul_f32 v110, 0xbfb8aa3b, v104
    v_mul_f32 v111, 0xbfb8aa3b, v105
    v_mfma_f32_16x16x32_bf16 v[140:143], v[44:47], a[16:19], v[140:143]
    ds_read_b64_tr_b16 v[38:39], v9 offset:17408
    v_exp_f32 v108, v108
    v_mfma_f32_16x16x32_bf16 v[172:175], v[44:47], a[20:23], v[172:175]
    ds_read_b64_tr_b16 v[40:41], v10 offset:16384
    v_exp_f32 v109, v109
    v_mfma_f32_16x16x32_bf16 v[204:207], v[44:47], a[24:27], v[204:207]
    ds_read_b64_tr_b16 v[42:43], v10 offset:17408
    v_exp_f32 v110, v110
    v_mfma_f32_16x16x32_bf16 v[236:239], v[44:47], a[28:31], v[236:239]
    ds_read_b128 a[32:35], v28 offset:32768
    v_exp_f32 v111, v111
    v_add_f32 v108, 1.0, v108
    v_mfma_f32_16x16x32_bf16 v[144:147], v[48:51], a[16:19], v[144:147]
    ds_read_b64_tr_b16 v[44:45], v11 offset:16384
    v_add_f32 v109, 1.0, v109
    v_add_f32 v110, 1.0, v110
    v_add_f32 v111, 1.0, v111
    v_mfma_f32_16x16x32_bf16 v[176:179], v[48:51], a[20:23], v[176:179]
    ds_read_b64_tr_b16 v[46:47], v11 offset:17408
    v_rcp_f32 v108, v108
    v_mfma_f32_16x16x32_bf16 v[208:211], v[48:51], a[24:27], v[208:211]
    ds_read_b128 a[36:39], v28 offset:34816
    v_mov_b32 v112, 0
    v_rcp_f32 v109, v109
    v_mfma_f32_16x16x32_bf16 v[240:243], v[48:51], a[28:31], v[240:243]
    ds_read_b128 a[40:43], v28 offset:36864
    v_mov_b32 v113, 0
    v_rcp_f32 v110, v110
    v_mfma_f32_16x16x32_bf16 v[148:151], v[52:55], a[16:19], v[148:151]
    ds_read_b64_tr_b16 v[48:49], v12 offset:16384
    v_mov_b32 v114, 0
    v_rcp_f32 v111, v111
    v_mfma_f32_16x16x32_bf16 v[180:183], v[52:55], a[20:23], v[180:183]
    ds_read_b64_tr_b16 v[50:51], v12 offset:17408
    v_mov_b32 v115, 0
    v_mul_f32 v102, v102, v108
    v_mul_f32 v103, v103, v109
    v_mfma_f32_16x16x32_bf16 v[212:215], v[52:55], a[24:27], v[212:215]
    ds_read_b128 a[44:47], v28 offset:38912
    v_lshlrev_b32 v116, 4, v0
    v_mul_f32 v104, v104, v110
    v_mul_f32 v105, v105, v111
    v_mfma_f32_16x16x32_bf16 v[244:247], v[52:55], a[28:31], v[244:247]
    buffer_load_dwordx4 v20, s[16:19], s98 offen offset:0   lds
    v_cvt_pk_bf16_f32 v108, v102, v103
    v_cvt_pk_bf16_f32 v109, v104, v105
    v_mfma_f32_16x16x32_bf16 v[152:155], v[56:59], a[16:19], v[152:155]
    ds_read_b64_tr_b16 v[52:53], v13 offset:16384
    v_lshlrev_b32 v102, 16, v108
    v_and_b32 v103, 0xffff0000, v108
    v_lshlrev_b32 v104, 16, v109
    v_mfma_f32_16x16x32_bf16 v[184:187], v[56:59], a[20:23], v[184:187]
    ds_read_b64_tr_b16 v[54:55], v13 offset:17408
    v_and_b32 v105, 0xffff0000, v109
    v_lshlrev_b32 v108, 16, v68
    v_and_b32 v109, 0xffff0000, v68
    v_mfma_f32_16x16x32_bf16 v[216:219], v[56:59], a[24:27], v[216:219]
    buffer_load_dwordx4 v21, s[16:19], s98 offen offset:1024   lds
    v_mul_f32 v120, v108, v102
    v_mul_f32 v121, v109, v102
    v_mfma_f32_16x16x32_bf16 v[248:251], v[56:59], a[28:31], v[248:251]
    buffer_store_dwordx4 v[112:115], v116, s[8:11], s80 offen sc0 sc1
    v_lshlrev_b32 v110, 16, v69
    v_and_b32 v111, 0xffff0000, v69
    v_mfma_f32_16x16x32_bf16 v[156:159], v[60:63], a[16:19], v[156:159]
    ds_read_b64_tr_b16 v[56:57], v14 offset:16384
    v_lshlrev_b32 v117, 13, v2
    v_mul_f32 v122, v110, v102
    v_mul_f32 v123, v111, v102
    v_mfma_f32_16x16x32_bf16 v[188:191], v[60:63], a[20:23], v[188:191]
    s_lshl_b32 s100, s6, 19
    s_and_b32 s101, s3, 1
    ds_read_b64_tr_b16 v[58:59], v14 offset:17408
    v_lshlrev_b32 v108, 16, v70
    v_and_b32 v109, 0xffff0000, v70
    v_mul_f32 v124, v108, v102
    v_mfma_f32_16x16x32_bf16 v[220:223], v[60:63], a[24:27], v[220:223]
    buffer_load_dwordx4 v22, s[16:19], s98 offen offset:2048   lds
    v_mul_f32 v125, v109, v102
    v_lshlrev_b32 v110, 16, v71
    v_mfma_f32_16x16x32_bf16 v[252:255], v[60:63], a[28:31], v[252:255]
    s_waitcnt lgkmcnt(5)
    s_lshl_b32 s101, s101, 7
    s_add_u32 s100, s100, s101
    v_min_u32 v116, 496, v116
    v_and_b32 v111, 0xffff0000, v71
    v_mul_f32 v126, v110, v102
    v_mul_f32 v127, v111, v102
    v_mfma_f32_16x16x32_bf16 v[128:131], v[32:35], a[32:35], v[128:131]
    s_sub_u32 s80, s80, 1048576
    s_lshr_b32 s80, s80, 3
    ds_read_b64_tr_b16 v[60:61], v15 offset:16384
    v_lshlrev_b32 v108, 16, v72
    v_and_b32 v109, 0xffff0000, v72
    v_fmac_f32 v120, v108, v103
    v_mfma_f32_16x16x32_bf16 v[160:163], v[32:35], a[36:39], v[160:163]
    s_add_u32 s80, s80, 1310720
    s_cmp_lt_u32 s80, 1343488
    s_cselect_b32 s80, s80, 2147479552
    ds_read_b64_tr_b16 v[62:63], v15 offset:17408
    v_fmac_f32 v121, v109, v103
    v_lshlrev_b32 v110, 16, v73
    v_and_b32 v111, 0xffff0000, v73
    v_mfma_f32_16x16x32_bf16 v[192:195], v[32:35], a[40:43], v[192:195]
    s_waitcnt lgkmcnt(5)
    ds_read_b128 a[48:51], v29 offset:32768
    v_fmac_f32 v122, v110, v103
    v_fmac_f32 v123, v111, v103
    v_lshlrev_b32 v108, 16, v74
    v_mfma_f32_16x16x32_bf16 v[224:227], v[32:35], a[44:47], v[224:227]
    ds_read_b128 a[52:55], v29 offset:34816
    v_and_b32 v109, 0xffff0000, v74
    v_fmac_f32 v124, v108, v103
    v_fmac_f32 v125, v109, v103
    v_mfma_f32_16x16x32_bf16 v[132:135], v[36:39], a[32:35], v[132:135]
    ds_read_b64_tr_b16 v[32:33], v8 offset:24576
    v_lshlrev_b32 v110, 16, v75
    v_and_b32 v111, 0xffff0000, v75
    v_fmac_f32 v126, v110, v103
    v_mfma_f32_16x16x32_bf16 v[164:167], v[36:39], a[36:39], v[164:167]
    ds_read_b64_tr_b16 v[34:35], v8 offset:25600
    v_fmac_f32 v127, v111, v103
    v_lshlrev_b32 v108, 16, v76
    v_and_b32 v109, 0xffff0000, v76
    v_mfma_f32_16x16x32_bf16 v[196:199], v[36:39], a[40:43], v[196:199]
    ds_read_b128 a[56:59], v29 offset:36864
    v_fmac_f32 v120, v108, v104
    v_fmac_f32 v121, v109, v104
    v_lshlrev_b32 v110, 16, v77
    v_mfma_f32_16x16x32_bf16 v[228:231], v[36:39], a[44:47], v[228:231]
    ds_read_b128 a[60:63], v29 offset:38912
    v_and_b32 v111, 0xffff0000, v77
    v_fmac_f32 v122, v110, v104
    v_fmac_f32 v123, v111, v104
    v_mfma_f32_16x16x32_bf16 v[136:139], v[40:43], a[32:35], v[136:139]
    ds_read_b64_tr_b16 v[36:37], v9 offset:24576
    v_lshlrev_b32 v108, 16, v78
    v_and_b32 v109, 0xffff0000, v78
    v_fmac_f32 v124, v108, v104
    v_mfma_f32_16x16x32_bf16 v[168:171], v[40:43], a[36:39], v[168:171]
    ds_read_b64_tr_b16 v[38:39], v9 offset:25600
    v_fmac_f32 v125, v109, v104
    v_lshlrev_b32 v110, 16, v79
    v_and_b32 v111, 0xffff0000, v79
    v_mfma_f32_16x16x32_bf16 v[200:203], v[40:43], a[40:43], v[200:203]
    buffer_load_dwordx4 v23, s[16:19], s98 offen offset:3072   lds
    v_fmac_f32 v126, v110, v104
    v_fmac_f32 v127, v111, v104
    v_mfma_f32_16x16x32_bf16 v[232:235], v[40:43], a[44:47], v[232:235]
    buffer_store_dwordx4 v[112:115], v116, s[8:11], s80 offen sc0 sc1
    v_lshlrev_b32 v108, 16, v80
    v_and_b32 v109, 0xffff0000, v80
    v_mfma_f32_16x16x32_bf16 v[140:143], v[44:47], a[32:35], v[140:143]
    s_add_u32 m0, s62, 0
    s_xor_b32 s98, s96, 384
    ds_read_b64_tr_b16 v[40:41], v10 offset:24576
    v_fmac_f32 v120, v108, v105
    v_fmac_f32 v121, v109, v105
    v_lshlrev_b32 v110, 16, v81
    v_mfma_f32_16x16x32_bf16 v[172:175], v[44:47], a[36:39], v[172:175]
    ds_read_b64_tr_b16 v[42:43], v10 offset:25600
    v_and_b32 v111, 0xffff0000, v81
    v_fmac_f32 v122, v110, v105
    v_fmac_f32 v123, v111, v105
    v_mfma_f32_16x16x32_bf16 v[204:207], v[44:47], a[40:43], v[204:207]
    buffer_load_dwordx4 v16, s[12:15], s98 offen offset:0   lds
    v_lshlrev_b32 v108, 16, v82
    v_and_b32 v109, 0xffff0000, v82
    v_mfma_f32_16x16x32_bf16 v[236:239], v[44:47], a[44:47], v[236:239]
    v_fmac_f32 v124, v108, v105
    v_fmac_f32 v125, v109, v105
    v_lshlrev_b32 v110, 16, v83
    v_and_b32 v111, 0xffff0000, v83
    v_mfma_f32_16x16x32_bf16 v[144:147], v[48:51], a[32:35], v[144:147]
    ds_read_b64_tr_b16 v[44:45], v11 offset:24576
    v_fmac_f32 v126, v110, v105
    v_fmac_f32 v127, v111, v105
    v_permlane32_swap_b32 v120, v124
    v_mfma_f32_16x16x32_bf16 v[176:179], v[48:51], a[36:39], v[176:179]
    ds_read_b64_tr_b16 v[46:47], v11 offset:25600
    v_permlane32_swap_b32 v121, v125
    v_permlane32_swap_b32 v122, v126
    v_permlane32_swap_b32 v123, v127
    v_mfma_f32_16x16x32_bf16 v[208:211], v[48:51], a[40:43], v[208:211]
    buffer_load_dwordx4 v17, s[12:15], s98 offen offset:1024   lds
    v_add_f32 v120, v120, v124
    v_add_f32 v121, v121, v125
    v_mfma_f32_16x16x32_bf16 v[240:243], v[48:51], a[44:47], v[240:243]
    s_waitcnt lgkmcnt(4)
    v_add_f32 v122, v122, v126
    v_add_f32 v123, v123, v127
    s_nop 0
    v_permlane16_swap_b32 v120, v122
    v_permlane16_swap_b32 v121, v123
    v_mfma_f32_16x16x32_bf16 v[148:151], v[52:55], a[32:35], v[148:151]
    ds_read_b64_tr_b16 v[48:49], v12 offset:24576
    v_add_f32 v120, v120, v122
    v_add_f32 v121, v121, v123
    s_nop 0
    v_add_f32_dpp v120, v120, v120 row_ror:8 row_mask:0xf bank_mask:0xf
    v_mfma_f32_16x16x32_bf16 v[180:183], v[52:55], a[36:39], v[180:183]
    ds_read_b64_tr_b16 v[50:51], v12 offset:25600
    v_add_f32_dpp v121, v121, v121 row_ror:8 row_mask:0xf bank_mask:0xf
    v_mfma_f32_16x16x32_bf16 v[212:215], v[52:55], a[40:43], v[212:215]
    buffer_load_dwordx4 v18, s[12:15], s98 offen offset:2048   lds
    ds_write_b64 v98, v[120:121]
    v_mfma_f32_16x16x32_bf16 v[244:247], v[52:55], a[44:47], v[244:247]
    v_mfma_f32_16x16x32_bf16 v[152:155], v[56:59], a[32:35], v[152:155]
    ds_read_b64_tr_b16 v[52:53], v13 offset:24576
    v_lshlrev_b32 v64, 16, v88
    v_mfma_f32_16x16x32_bf16 v[184:187], v[56:59], a[36:39], v[184:187]
    ds_read_b64_tr_b16 v[54:55], v13 offset:25600
    v_and_b32 v65, 0xffff0000, v88
    v_mfma_f32_16x16x32_bf16 v[216:219], v[56:59], a[40:43], v[216:219]
    buffer_load_dwordx4 v19, s[12:15], s98 offen offset:3072   lds
    v_mfma_f32_16x16x32_bf16 v[248:251], v[56:59], a[44:47], v[248:251]
    v_lshlrev_b32 v66, 16, v89
    v_and_b32 v67, 0xffff0000, v89
    v_mfma_f32_16x16x32_bf16 v[156:159], v[60:63], a[32:35], v[156:159]
    s_add_u32 m0, s62, 4096
    s_xor_b32 s98, s96, 33152
    ds_read_b64_tr_b16 v[56:57], v14 offset:24576
    v_mfma_f32_16x16x32_bf16 v[188:191], v[60:63], a[36:39], v[188:191]
    ds_read_b64_tr_b16 v[58:59], v14 offset:25600
    v_lshlrev_b32 v68, 16, v90
    v_mfma_f32_16x16x32_bf16 v[220:223], v[60:63], a[40:43], v[220:223]
    buffer_load_dwordx4 v16, s[12:15], s98 offen offset:0   lds
    v_mfma_f32_16x16x32_bf16 v[252:255], v[60:63], a[44:47], v[252:255]
    v_and_b32 v69, 0xffff0000, v90
    v_lshlrev_b32 v70, 16, v91
    v_mfma_f32_16x16x32_bf16 v[128:131], v[32:35], a[48:51], v[128:131]
    ds_read_b64_tr_b16 v[60:61], v15 offset:24576
    v_and_b32 v71, 0xffff0000, v91
    v_mfma_f32_16x16x32_bf16 v[160:163], v[32:35], a[52:55], v[160:163]
    ds_read_b64_tr_b16 v[62:63], v15 offset:25600
    v_lshlrev_b32 v72, 16, v92
    v_mfma_f32_16x16x32_bf16 v[192:195], v[32:35], a[56:59], v[192:195]
    buffer_load_dwordx4 v17, s[12:15], s98 offen offset:1024   lds
    v_mfma_f32_16x16x32_bf16 v[224:227], v[32:35], a[60:63], v[224:227]
    v_and_b32 v73, 0xffff0000, v92
    v_lshlrev_b32 v74, 16, v93
    v_mfma_f32_16x16x32_bf16 v[132:135], v[36:39], a[48:51], v[132:135]
    buffer_load_dwordx4 v18, s[12:15], s98 offen offset:2048   lds
    v_mfma_f32_16x16x32_bf16 v[164:167], v[36:39], a[52:55], v[164:167]
    v_and_b32 v75, 0xffff0000, v93
    v_lshlrev_b32 v76, 16, v94
    v_mfma_f32_16x16x32_bf16 v[196:199], v[36:39], a[56:59], v[196:199]
    buffer_load_dwordx4 v19, s[12:15], s98 offen offset:3072   lds
    s_cmp_eq_u32 s3, 0
    s_cselect_b32 s101, s100, 2147479552
    buffer_load_dword a241, v117, s[20:23], s101 offen offset:4
    v_mfma_f32_16x16x32_bf16 v[228:231], v[36:39], a[60:63], v[228:231]
    s_waitcnt lgkmcnt(2)
    v_and_b32 v77, 0xffff0000, v94
    v_lshlrev_b32 v78, 16, v95
    s_waitcnt vmcnt(9)
    v_mfma_f32_16x16x32_bf16 v[136:139], v[40:43], a[48:51], v[136:139]
    v_and_b32 v79, 0xffff0000, v95
    v_add_f32 v108, v64, v65
    s_waitcnt lgkmcnt(0)
    s_barrier
    v_mfma_f32_16x16x32_bf16 v[168:171], v[40:43], a[52:55], v[168:171]
    s_add_u32 m0, s63, 114688
    s_xor_b32 s98, s97, 2097152
    ds_read_b64_tr_b16 v[32:33], v8 offset:32768
    v_lshrrev_b32 v87, 2, v1
    v_add_u32 v101, 147456, v87
    v_mfma_f32_16x16x32_bf16 v[200:203], v[40:43], a[56:59], v[200:203]
    ds_read_b64_tr_b16 v[34:35], v8 offset:33792
    ds_read_b32 v102, v101
    v_mfma_f32_16x16x32_bf16 v[232:235], v[40:43], a[60:63], v[232:235]
    ds_read_b64_tr_b16 v[36:37], v9 offset:32768
    ds_read_b32 v103, v101 offset:256
    v_mfma_f32_16x16x32_bf16 v[140:143], v[44:47], a[48:51], v[140:143]
    ds_read_b64_tr_b16 v[38:39], v9 offset:33792
    ds_read_b32 v104, v101 offset:512
    v_mfma_f32_16x16x32_bf16 v[172:175], v[44:47], a[52:55], v[172:175]
    ds_read_b64_tr_b16 v[40:41], v10 offset:32768
    ds_read_b32 v105, v101 offset:768
    v_mfma_f32_16x16x32_bf16 v[204:207], v[44:47], a[56:59], v[204:207]
    ds_read_b64_tr_b16 v[42:43], v10 offset:33792
    v_add_f32 v109, v66, v67
    v_mfma_f32_16x16x32_bf16 v[236:239], v[44:47], a[60:63], v[236:239]
    ds_read_b128 a[64:67], v30 offset:0
    v_add_f32 v108, v108, v68
    v_mfma_f32_16x16x32_bf16 v[144:147], v[48:51], a[48:51], v[144:147]
    ds_read_b64_tr_b16 v[44:45], v11 offset:32768
    v_add_f32 v109, v109, v69
    v_mfma_f32_16x16x32_bf16 v[176:179], v[48:51], a[52:55], v[176:179]
    ds_read_b64_tr_b16 v[46:47], v11 offset:33792
    v_add_f32 v108, v108, v70
    v_mfma_f32_16x16x32_bf16 v[208:211], v[48:51], a[56:59], v[208:211]
    ds_read_b128 a[68:71], v30 offset:2048
    v_add_f32 v109, v109, v71
    v_mfma_f32_16x16x32_bf16 v[240:243], v[48:51], a[60:63], v[240:243]
    ds_read_b128 a[72:75], v30 offset:4096
    s_waitcnt lgkmcnt(10)
    v_add_f32 v102, v102, v103
    v_mfma_f32_16x16x32_bf16 v[148:151], v[52:55], a[48:51], v[148:151]
    ds_read_b64_tr_b16 v[48:49], v12 offset:32768
    s_waitcnt lgkmcnt(7)
    v_add_f32 v104, v104, v105
    v_mfma_f32_16x16x32_bf16 v[180:183], v[52:55], a[52:55], v[180:183]
    ds_read_b64_tr_b16 v[50:51], v12 offset:33792
    v_add_f32 v102, v102, v104
    buffer_store_dword v102, v87, s[8:11], s66 offen sc0 sc1
    v_mfma_f32_16x16x32_bf16 v[212:215], v[52:55], a[56:59], v[212:215]
    ds_read_b128 a[76:79], v30 offset:6144
    v_add_f32 v108, v108, v72
    v_mfma_f32_16x16x32_bf16 v[244:247], v[52:55], a[60:63], v[244:247]
    buffer_load_dwordx4 v20, s[16:19], s98 offen offset:0   lds
    v_mfma_f32_16x16x32_bf16 v[152:155], v[56:59], a[48:51], v[152:155]
    s_mov_b32 s40, s92
    s_mov_b32 s41, s93
    ds_read_b64_tr_b16 v[52:53], v13 offset:32768
    v_mfma_f32_16x16x32_bf16 v[184:187], v[56:59], a[52:55], v[184:187]
    s_mov_b32 s42, 1835008
    s_mov_b32 s44, s94
    ds_read_b64_tr_b16 v[54:55], v13 offset:33792
    v_mfma_f32_16x16x32_bf16 v[216:219], v[56:59], a[56:59], v[216:219]
    s_mov_b32 s45, s95
    s_mov_b32 s46, 1835008
    v_add_f32 v109, v109, v73
    v_mfma_f32_16x16x32_bf16 v[248:251], v[56:59], a[60:63], v[248:251]
    buffer_load_dwordx4 v21, s[16:19], s98 offen offset:1024   lds
    v_mfma_f32_16x16x32_bf16 v[156:159], v[60:63], a[48:51], v[156:159]
    ds_read_b64_tr_b16 v[56:57], v14 offset:32768
    v_add_f32 v108, v108, v74
    v_mfma_f32_16x16x32_bf16 v[188:191], v[60:63], a[52:55], v[188:191]
    ds_read_b64_tr_b16 v[58:59], v14 offset:33792
    v_add_f32 v109, v109, v75
    v_mfma_f32_16x16x32_bf16 v[220:223], v[60:63], a[56:59], v[220:223]
    buffer_load_dwordx4 v22, s[16:19], s98 offen offset:2048   lds
    v_mfma_f32_16x16x32_bf16 v[252:255], v[60:63], a[60:63], v[252:255]
    s_waitcnt lgkmcnt(5)
    v_add_f32 v108, v108, v76
    v_add_f32 v109, v109, v77
    v_mfma_f32_16x16x32_bf16 v[128:131], v[32:35], a[64:67], v[128:131]
    ds_read_b64_tr_b16 v[60:61], v15 offset:32768
    v_add_f32 v108, v108, v78
    v_mfma_f32_16x16x32_bf16 v[160:163], v[32:35], a[68:71], v[160:163]
    ds_read_b64_tr_b16 v[62:63], v15 offset:33792
    v_add_f32 v109, v109, v79
    v_mfma_f32_16x16x32_bf16 v[192:195], v[32:35], a[72:75], v[192:195]
    s_waitcnt lgkmcnt(5)
    ds_read_b128 a[80:83], v31 offset:0
    v_add_f32 v108, v108, v109
    v_mfma_f32_16x16x32_bf16 v[224:227], v[32:35], a[76:79], v[224:227]
    ds_read_b128 a[84:87], v31 offset:2048
    v_add_f32_dpp v108, v108, v108 row_ror:8 row_mask:0xf bank_mask:0xf
    v_mfma_f32_16x16x32_bf16 v[132:135], v[36:39], a[64:67], v[132:135]
    ds_read_b64_tr_b16 v[32:33], v8 offset:40960
    v_mov_b32 v110, v108
    v_mfma_f32_16x16x32_bf16 v[164:167], v[36:39], a[68:71], v[164:167]
    ds_read_b64_tr_b16 v[34:35], v8 offset:41984
    v_permlane16_swap_b32 v108, v110
    v_mfma_f32_16x16x32_bf16 v[196:199], v[36:39], a[72:75], v[196:199]
    ds_read_b128 a[88:91], v31 offset:4096
    v_add_f32 v108, v108, v110
    v_mfma_f32_16x16x32_bf16 v[228:231], v[36:39], a[76:79], v[228:231]
    ds_read_b128 a[92:95], v31 offset:6144
    v_mov_b32 v110, v108
    v_mfma_f32_16x16x32_bf16 v[136:139], v[40:43], a[64:67], v[136:139]
    ds_read_b64_tr_b16 v[36:37], v9 offset:40960
    v_permlane32_swap_b32 v108, v110
    v_mfma_f32_16x16x32_bf16 v[168:171], v[40:43], a[68:71], v[168:171]
    ds_read_b64_tr_b16 v[38:39], v9 offset:41984
    v_add_f32 v108, v108, v110
    v_mfma_f32_16x16x32_bf16 v[200:203], v[40:43], a[72:75], v[200:203]
    buffer_load_dwordx4 v23, s[16:19], s98 offen offset:3072   lds
    v_mfma_f32_16x16x32_bf16 v[232:235], v[40:43], a[76:79], v[232:235]
    v_mul_f32 v108, 0x3c000000, v108
    v_sub_f32 v110, v64, v108
    v_mfma_f32_16x16x32_bf16 v[140:143], v[44:47], a[64:67], v[140:143]
    s_add_u32 m0, s62, 32768
    s_xor_b32 s98, s96, 512
    ds_read_b64_tr_b16 v[40:41], v10 offset:40960
    v_mfma_f32_16x16x32_bf16 v[172:175], v[44:47], a[68:71], v[172:175]
    ds_read_b64_tr_b16 v[42:43], v10 offset:41984
    v_mul_f32 v109, v110, v110
    v_mfma_f32_16x16x32_bf16 v[204:207], v[44:47], a[72:75], v[204:207]
    buffer_load_dwordx4 v16, s[12:15], s98 offen offset:0   lds
    v_mfma_f32_16x16x32_bf16 v[236:239], v[44:47], a[76:79], v[236:239]
    v_sub_f32 v111, v65, v108
    v_fmac_f32 v109, v111, v111
    v_mfma_f32_16x16x32_bf16 v[144:147], v[48:51], a[64:67], v[144:147]
    ds_read_b64_tr_b16 v[44:45], v11 offset:40960
    v_sub_f32 v110, v66, v108
    v_mfma_f32_16x16x32_bf16 v[176:179], v[48:51], a[68:71], v[176:179]
    ds_read_b64_tr_b16 v[46:47], v11 offset:41984
    v_fmac_f32 v109, v110, v110
    v_mfma_f32_16x16x32_bf16 v[208:211], v[48:51], a[72:75], v[208:211]
    buffer_load_dwordx4 v17, s[12:15], s98 offen offset:1024   lds
    v_mfma_f32_16x16x32_bf16 v[240:243], v[48:51], a[76:79], v[240:243]
    s_waitcnt lgkmcnt(4)
    v_sub_f32 v111, v67, v108
    v_fmac_f32 v109, v111, v111
    v_mfma_f32_16x16x32_bf16 v[148:151], v[52:55], a[64:67], v[148:151]
    ds_read_b64_tr_b16 v[48:49], v12 offset:40960
    v_sub_f32 v110, v68, v108
    v_mfma_f32_16x16x32_bf16 v[180:183], v[52:55], a[68:71], v[180:183]
    ds_read_b64_tr_b16 v[50:51], v12 offset:41984
    v_fmac_f32 v109, v110, v110
    v_mfma_f32_16x16x32_bf16 v[212:215], v[52:55], a[72:75], v[212:215]
    buffer_load_dwordx4 v18, s[12:15], s98 offen offset:2048   lds
    v_mfma_f32_16x16x32_bf16 v[244:247], v[52:55], a[76:79], v[244:247]
    v_sub_f32 v111, v69, v108
    v_fmac_f32 v109, v111, v111
    v_mfma_f32_16x16x32_bf16 v[152:155], v[56:59], a[64:67], v[152:155]
    ds_read_b64_tr_b16 v[52:53], v13 offset:40960
    v_sub_f32 v110, v70, v108
    v_mfma_f32_16x16x32_bf16 v[184:187], v[56:59], a[68:71], v[184:187]
    ds_read_b64_tr_b16 v[54:55], v13 offset:41984
    v_fmac_f32 v109, v110, v110
    v_mfma_f32_16x16x32_bf16 v[216:219], v[56:59], a[72:75], v[216:219]
    buffer_load_dwordx4 v19, s[12:15], s98 offen offset:3072   lds
    v_mfma_f32_16x16x32_bf16 v[248:251], v[56:59], a[76:79], v[248:251]
    v_sub_f32 v111, v71, v108
    v_fmac_f32 v109, v111, v111
    v_mfma_f32_16x16x32_bf16 v[156:159], v[60:63], a[64:67], v[156:159]
    s_add_u32 m0, s62, 36864
    s_xor_b32 s98, s96, 33280
    ds_read_b64_tr_b16 v[56:57], v14 offset:40960
    v_mfma_f32_16x16x32_bf16 v[188:191], v[60:63], a[68:71], v[188:191]
    ds_read_b64_tr_b16 v[58:59], v14 offset:41984
    v_sub_f32 v110, v72, v108
    v_mfma_f32_16x16x32_bf16 v[220:223], v[60:63], a[72:75], v[220:223]
    buffer_load_dwordx4 v16, s[12:15], s98 offen offset:0   lds
    v_mfma_f32_16x16x32_bf16 v[252:255], v[60:63], a[76:79], v[252:255]
    v_fmac_f32 v109, v110, v110
    v_sub_f32 v111, v73, v108
    v_mfma_f32_16x16x32_bf16 v[128:131], v[32:35], a[80:83], v[128:131]
    ds_read_b64_tr_b16 v[60:61], v15 offset:40960
    v_fmac_f32 v109, v111, v111
    v_mfma_f32_16x16x32_bf16 v[160:163], v[32:35], a[84:87], v[160:163]
    ds_read_b64_tr_b16 v[62:63], v15 offset:41984
    v_sub_f32 v110, v74, v108
    v_mfma_f32_16x16x32_bf16 v[192:195], v[32:35], a[88:91], v[192:195]
    buffer_load_dwordx4 v17, s[12:15], s98 offen offset:1024   lds
    v_mfma_f32_16x16x32_bf16 v[224:227], v[32:35], a[92:95], v[224:227]
    v_fmac_f32 v109, v110, v110
    v_sub_f32 v111, v75, v108
    v_mfma_f32_16x16x32_bf16 v[132:135], v[36:39], a[80:83], v[132:135]
    buffer_load_dwordx4 v18, s[12:15], s98 offen offset:2048   lds
    v_mfma_f32_16x16x32_bf16 v[164:167], v[36:39], a[84:87], v[164:167]
    v_fmac_f32 v109, v111, v111
    v_sub_f32 v110, v76, v108
    v_mfma_f32_16x16x32_bf16 v[196:199], v[36:39], a[88:91], v[196:199]
    buffer_load_dwordx4 v19, s[12:15], s98 offen offset:3072   lds
    s_cmp_eq_u32 s3, 1
    s_cselect_b32 s101, s100, 2147479552
    buffer_load_dword a243, v117, s[20:23], s101 offen offset:4
    v_mfma_f32_16x16x32_bf16 v[228:231], v[36:39], a[92:95], v[228:231]
    s_waitcnt lgkmcnt(2)
    v_fmac_f32 v109, v110, v110
    v_sub_f32 v111, v77, v108
    v_mfma_f32_16x16x32_bf16 v[136:139], v[40:43], a[80:83], v[136:139]
    v_fmac_f32 v109, v111, v111
    v_sub_f32 v110, v78, v108
    s_waitcnt vmcnt(15) lgkmcnt(0)
    s_barrier
    v_mfma_f32_16x16x32_bf16 v[168:171], v[40:43], a[84:87], v[168:171]
    s_add_u32 m0, s63, 131072
    s_xor_b32 s98, s97, 2621440
    ds_read_b64_tr_b16 v[32:33], v8 offset:0
    v_mfma_f32_16x16x32_bf16 v[200:203], v[40:43], a[88:91], v[200:203]
    ds_read_b64_tr_b16 v[34:35], v8 offset:1024
    v_fmac_f32 v109, v110, v110
    v_mfma_f32_16x16x32_bf16 v[232:235], v[40:43], a[92:95], v[232:235]
    ds_read_b64_tr_b16 v[36:37], v9 offset:0
    v_sub_f32 v111, v79, v108
    v_mfma_f32_16x16x32_bf16 v[140:143], v[44:47], a[80:83], v[140:143]
    ds_read_b64_tr_b16 v[38:39], v9 offset:1024
    v_fmac_f32 v109, v111, v111
    v_mfma_f32_16x16x32_bf16 v[172:175], v[44:47], a[84:87], v[172:175]
    ds_read_b64_tr_b16 v[40:41], v10 offset:0
    v_add_f32_dpp v109, v109, v109 row_ror:8 row_mask:0xf bank_mask:0xf
    v_mfma_f32_16x16x32_bf16 v[204:207], v[44:47], a[88:91], v[204:207]
    ds_read_b64_tr_b16 v[42:43], v10 offset:1024
    v_mov_b32 v110, v109
    v_mfma_f32_16x16x32_bf16 v[236:239], v[44:47], a[92:95], v[236:239]
    ds_read_b128 a[96:99], v28 offset:0
    v_permlane16_swap_b32 v109, v110
    v_mfma_f32_16x16x32_bf16 v[144:147], v[48:51], a[80:83], v[144:147]
    ds_read_b64_tr_b16 v[44:45], v11 offset:0
    v_add_f32 v109, v109, v110
    v_mfma_f32_16x16x32_bf16 v[176:179], v[48:51], a[84:87], v[176:179]
    ds_read_b64_tr_b16 v[46:47], v11 offset:1024
    v_mov_b32 v110, v109
    s_waitcnt vmcnt(13)
    buffer_atomic_add v6, v7, s[36:39], s69 offen sc1
    v_mfma_f32_16x16x32_bf16 v[208:211], v[48:51], a[88:91], v[208:211]
    ds_read_b128 a[100:103], v28 offset:2048
    v_permlane32_swap_b32 v109, v110
    v_mfma_f32_16x16x32_bf16 v[240:243], v[48:51], a[92:95], v[240:243]
    ds_read_b128 a[104:107], v28 offset:4096
    v_add_f32 v109, v109, v110
    v_mfma_f32_16x16x32_bf16 v[148:151], v[52:55], a[80:83], v[148:151]
    ds_read_b64_tr_b16 v[48:49], v12 offset:0
    v_mfma_f32_16x16x32_bf16 v[180:183], v[52:55], a[84:87], v[180:183]
    ds_read_b64_tr_b16 v[50:51], v12 offset:1024
    v_mfma_f32_16x16x32_bf16 v[212:215], v[52:55], a[88:91], v[212:215]
    ds_read_b128 a[108:111], v28 offset:6144
    v_mfma_f32_16x16x32_bf16 v[244:247], v[52:55], a[92:95], v[244:247]
    buffer_load_dwordx4 v20, s[16:19], s98 offen offset:0   lds
    v_mfma_f32_16x16x32_bf16 v[152:155], v[56:59], a[80:83], v[152:155]
    ds_read_b64_tr_b16 v[52:53], v13 offset:0
    v_mfma_f32_16x16x32_bf16 v[184:187], v[56:59], a[84:87], v[184:187]
    ds_read_b64_tr_b16 v[54:55], v13 offset:1024
    v_mfma_f32_16x16x32_bf16 v[216:219], v[56:59], a[88:91], v[216:219]
    buffer_load_dwordx4 v21, s[16:19], s98 offen offset:1024   lds
    v_mfma_f32_16x16x32_bf16 v[248:251], v[56:59], a[92:95], v[248:251]
    ds_write_b64 v100, v[108:109]
    v_mfma_f32_16x16x32_bf16 v[156:159], v[60:63], a[80:83], v[156:159]
    ds_read_b64_tr_b16 v[56:57], v14 offset:0
    v_mfma_f32_16x16x32_bf16 v[188:191], v[60:63], a[84:87], v[188:191]
    ds_read_b64_tr_b16 v[58:59], v14 offset:1024
    v_mfma_f32_16x16x32_bf16 v[220:223], v[60:63], a[88:91], v[220:223]
    buffer_load_dwordx4 v22, s[16:19], s98 offen offset:2048   lds
    v_mfma_f32_16x16x32_bf16 v[252:255], v[60:63], a[92:95], v[252:255]
    s_waitcnt lgkmcnt(6)
    v_mfma_f32_16x16x32_bf16 v[128:131], v[32:35], a[96:99], v[128:131]
    ds_read_b64_tr_b16 v[60:61], v15 offset:0
    v_mfma_f32_16x16x32_bf16 v[160:163], v[32:35], a[100:103], v[160:163]
    ds_read_b64_tr_b16 v[62:63], v15 offset:1024
    v_mfma_f32_16x16x32_bf16 v[192:195], v[32:35], a[104:107], v[192:195]
    s_waitcnt lgkmcnt(6)
    ds_read_b128 a[112:115], v29 offset:0
    v_mfma_f32_16x16x32_bf16 v[224:227], v[32:35], a[108:111], v[224:227]
    ds_read_b128 a[116:119], v29 offset:2048
    v_mfma_f32_16x16x32_bf16 v[132:135], v[36:39], a[96:99], v[132:135]
    ds_read_b64_tr_b16 v[32:33], v8 offset:8192
    v_mfma_f32_16x16x32_bf16 v[164:167], v[36:39], a[100:103], v[164:167]
    ds_read_b64_tr_b16 v[34:35], v8 offset:9216
    v_mfma_f32_16x16x32_bf16 v[196:199], v[36:39], a[104:107], v[196:199]
    ds_read_b128 a[120:123], v29 offset:4096
    v_mfma_f32_16x16x32_bf16 v[228:231], v[36:39], a[108:111], v[228:231]
    ds_read_b128 a[124:127], v29 offset:6144
    v_mfma_f32_16x16x32_bf16 v[136:139], v[40:43], a[96:99], v[136:139]
    ds_read_b64_tr_b16 v[36:37], v9 offset:8192
    v_mfma_f32_16x16x32_bf16 v[168:171], v[40:43], a[100:103], v[168:171]
    ds_read_b64_tr_b16 v[38:39], v9 offset:9216
    v_mfma_f32_16x16x32_bf16 v[200:203], v[40:43], a[104:107], v[200:203]
    buffer_load_dwordx4 v23, s[16:19], s98 offen offset:3072   lds
    v_mfma_f32_16x16x32_bf16 v[232:235], v[40:43], a[108:111], v[232:235]
    v_mfma_f32_16x16x32_bf16 v[140:143], v[44:47], a[96:99], v[140:143]
    s_add_u32 m0, s62, 65536
    s_xor_b32 s98, s96, 640
    ds_read_b64_tr_b16 v[40:41], v10 offset:8192
    v_mfma_f32_16x16x32_bf16 v[172:175], v[44:47], a[100:103], v[172:175]
    ds_read_b64_tr_b16 v[42:43], v10 offset:9216
    v_mfma_f32_16x16x32_bf16 v[204:207], v[44:47], a[104:107], v[204:207]
    buffer_load_dwordx4 v16, s[12:15], s98 offen offset:0   lds
    v_mfma_f32_16x16x32_bf16 v[236:239], v[44:47], a[108:111], v[236:239]
    v_mfma_f32_16x16x32_bf16 v[144:147], v[48:51], a[96:99], v[144:147]
    ds_read_b64_tr_b16 v[44:45], v11 offset:8192
    v_mfma_f32_16x16x32_bf16 v[176:179], v[48:51], a[100:103], v[176:179]
    ds_read_b64_tr_b16 v[46:47], v11 offset:9216
    v_mfma_f32_16x16x32_bf16 v[208:211], v[48:51], a[104:107], v[208:211]
    buffer_load_dwordx4 v17, s[12:15], s98 offen offset:1024   lds
    v_mfma_f32_16x16x32_bf16 v[240:243], v[48:51], a[108:111], v[240:243]
    s_waitcnt lgkmcnt(4)
    v_mfma_f32_16x16x32_bf16 v[148:151], v[52:55], a[96:99], v[148:151]
    ds_read_b64_tr_b16 v[48:49], v12 offset:8192
    v_mfma_f32_16x16x32_bf16 v[180:183], v[52:55], a[100:103], v[180:183]
    ds_read_b64_tr_b16 v[50:51], v12 offset:9216
    v_mfma_f32_16x16x32_bf16 v[212:215], v[52:55], a[104:107], v[212:215]
    buffer_load_dwordx4 v18, s[12:15], s98 offen offset:2048   lds
    v_mfma_f32_16x16x32_bf16 v[244:247], v[52:55], a[108:111], v[244:247]
    v_mfma_f32_16x16x32_bf16 v[152:155], v[56:59], a[96:99], v[152:155]
    ds_read_b64_tr_b16 v[52:53], v13 offset:8192
    v_mfma_f32_16x16x32_bf16 v[184:187], v[56:59], a[100:103], v[184:187]
    ds_read_b64_tr_b16 v[54:55], v13 offset:9216
    v_mfma_f32_16x16x32_bf16 v[216:219], v[56:59], a[104:107], v[216:219]
    buffer_load_dwordx4 v19, s[12:15], s98 offen offset:3072   lds
    v_mfma_f32_16x16x32_bf16 v[248:251], v[56:59], a[108:111], v[248:251]
    v_mfma_f32_16x16x32_bf16 v[156:159], v[60:63], a[96:99], v[156:159]
    s_add_u32 m0, s62, 69632
    s_xor_b32 s98, s96, 33408
    ds_read_b64_tr_b16 v[56:57], v14 offset:8192
    v_mfma_f32_16x16x32_bf16 v[188:191], v[60:63], a[100:103], v[188:191]
    ds_read_b64_tr_b16 v[58:59], v14 offset:9216
    v_mfma_f32_16x16x32_bf16 v[220:223], v[60:63], a[104:107], v[220:223]
    buffer_load_dwordx4 v16, s[12:15], s98 offen offset:0   lds
    v_mfma_f32_16x16x32_bf16 v[252:255], v[60:63], a[108:111], v[252:255]
    v_mfma_f32_16x16x32_bf16 v[128:131], v[32:35], a[112:115], v[128:131]
    ds_read_b64_tr_b16 v[60:61], v15 offset:8192
    v_mfma_f32_16x16x32_bf16 v[160:163], v[32:35], a[116:119], v[160:163]
    ds_read_b64_tr_b16 v[62:63], v15 offset:9216
    v_mfma_f32_16x16x32_bf16 v[192:195], v[32:35], a[120:123], v[192:195]
    buffer_load_dwordx4 v17, s[12:15], s98 offen offset:1024   lds
    v_mfma_f32_16x16x32_bf16 v[224:227], v[32:35], a[124:127], v[224:227]
    v_mfma_f32_16x16x32_bf16 v[132:135], v[36:39], a[112:115], v[132:135]
    buffer_load_dwordx4 v18, s[12:15], s98 offen offset:2048   lds
    v_mfma_f32_16x16x32_bf16 v[164:167], v[36:39], a[116:119], v[164:167]
    v_mfma_f32_16x16x32_bf16 v[196:199], v[36:39], a[120:123], v[196:199]
    buffer_load_dwordx4 v19, s[12:15], s98 offen offset:3072   lds
    s_cmp_eq_u32 s3, 2
    s_cselect_b32 s101, s100, 2147479552
    buffer_load_dword a245, v117, s[24:27], s101 offen offset:4
    v_mfma_f32_16x16x32_bf16 v[228:231], v[36:39], a[124:127], v[228:231]
    s_waitcnt lgkmcnt(2)
    v_mfma_f32_16x16x32_bf16 v[136:139], v[40:43], a[112:115], v[136:139]
    s_waitcnt vmcnt(15) lgkmcnt(0)
    s_barrier
    v_mfma_f32_16x16x32_bf16 v[168:171], v[40:43], a[116:119], v[168:171]
    s_add_u32 m0, s63, 98304
    s_xor_b32 s98, s97, 3145728
    ds_read_b64_tr_b16 v[32:33], v8 offset:16384
    v_mfma_f32_16x16x32_bf16 v[200:203], v[40:43], a[120:123], v[200:203]
    ds_read_b64_tr_b16 v[34:35], v8 offset:17408
    v_mfma_f32_16x16x32_bf16 v[232:235], v[40:43], a[124:127], v[232:235]
    ds_read_b64_tr_b16 v[36:37], v9 offset:16384
    v_mfma_f32_16x16x32_bf16 v[140:143], v[44:47], a[112:115], v[140:143]
    ds_read_b64_tr_b16 v[38:39], v9 offset:17408
    v_mfma_f32_16x16x32_bf16 v[172:175], v[44:47], a[116:119], v[172:175]
    ds_read_b64_tr_b16 v[40:41], v10 offset:16384
    v_mfma_f32_16x16x32_bf16 v[204:207], v[44:47], a[120:123], v[204:207]
    ds_read_b64_tr_b16 v[42:43], v10 offset:17408
    v_mfma_f32_16x16x32_bf16 v[236:239], v[44:47], a[124:127], v[236:239]
    ds_read_b128 a[128:131], v28 offset:32768
    v_mfma_f32_16x16x32_bf16 v[144:147], v[48:51], a[112:115], v[144:147]
    ds_read_b64_tr_b16 v[44:45], v11 offset:16384
    v_mfma_f32_16x16x32_bf16 v[176:179], v[48:51], a[116:119], v[176:179]
    ds_read_b64_tr_b16 v[46:47], v11 offset:17408
    v_mfma_f32_16x16x32_bf16 v[208:211], v[48:51], a[120:123], v[208:211]
    ds_read_b128 a[132:135], v28 offset:34816
    v_mfma_f32_16x16x32_bf16 v[240:243], v[48:51], a[124:127], v[240:243]
    ds_read_b128 a[136:139], v28 offset:36864
    v_mfma_f32_16x16x32_bf16 v[148:151], v[52:55], a[112:115], v[148:151]
    ds_read_b64_tr_b16 v[48:49], v12 offset:16384
    v_mfma_f32_16x16x32_bf16 v[180:183], v[52:55], a[116:119], v[180:183]
    ds_read_b64_tr_b16 v[50:51], v12 offset:17408
    v_mfma_f32_16x16x32_bf16 v[212:215], v[52:55], a[120:123], v[212:215]
    ds_read_b128 a[140:143], v28 offset:38912
    v_mfma_f32_16x16x32_bf16 v[244:247], v[52:55], a[124:127], v[244:247]
    buffer_load_dwordx4 v20, s[16:19], s98 offen offset:0   lds
    v_mfma_f32_16x16x32_bf16 v[152:155], v[56:59], a[112:115], v[152:155]
    ds_read_b64_tr_b16 v[52:53], v13 offset:16384
    v_mfma_f32_16x16x32_bf16 v[184:187], v[56:59], a[116:119], v[184:187]
    ds_read_b64_tr_b16 v[54:55], v13 offset:17408
    v_mfma_f32_16x16x32_bf16 v[216:219], v[56:59], a[120:123], v[216:219]
    buffer_load_dwordx4 v21, s[16:19], s98 offen offset:1024   lds
    v_mfma_f32_16x16x32_bf16 v[248:251], v[56:59], a[124:127], v[248:251]
    ds_read_b128 v[88:91], v99
    v_mfma_f32_16x16x32_bf16 v[156:159], v[60:63], a[112:115], v[156:159]
    ds_read_b64_tr_b16 v[56:57], v14 offset:16384
    v_mfma_f32_16x16x32_bf16 v[188:191], v[60:63], a[116:119], v[188:191]
    ds_read_b64_tr_b16 v[58:59], v14 offset:17408
    v_mfma_f32_16x16x32_bf16 v[220:223], v[60:63], a[120:123], v[220:223]
    buffer_load_dwordx4 v22, s[16:19], s98 offen offset:2048   lds
    v_mfma_f32_16x16x32_bf16 v[252:255], v[60:63], a[124:127], v[252:255]
    s_waitcnt lgkmcnt(6)
    ds_read_b128 v[92:95], v99 offset:16
    v_mfma_f32_16x16x32_bf16 v[128:131], v[32:35], a[128:131], v[128:131]
    ds_read_b64_tr_b16 v[60:61], v15 offset:16384
    v_mfma_f32_16x16x32_bf16 v[160:163], v[32:35], a[132:135], v[160:163]
    ds_read_b64_tr_b16 v[62:63], v15 offset:17408
    v_mfma_f32_16x16x32_bf16 v[192:195], v[32:35], a[136:139], v[192:195]
    s_waitcnt lgkmcnt(7)
    ds_read_b128 a[144:147], v29 offset:32768
    v_mfma_f32_16x16x32_bf16 v[224:227], v[32:35], a[140:143], v[224:227]
    ds_read_b128 a[148:151], v29 offset:34816
    v_mfma_f32_16x16x32_bf16 v[132:135], v[36:39], a[128:131], v[132:135]
    ds_read_b64_tr_b16 v[32:33], v8 offset:24576
    v_mfma_f32_16x16x32_bf16 v[164:167], v[36:39], a[132:135], v[164:167]
    ds_read_b64_tr_b16 v[34:35], v8 offset:25600
    v_mfma_f32_16x16x32_bf16 v[196:199], v[36:39], a[136:139], v[196:199]
    ds_read_b128 a[152:155], v29 offset:36864
    v_mfma_f32_16x16x32_bf16 v[228:231], v[36:39], a[140:143], v[228:231]
    ds_read_b128 a[156:159], v29 offset:38912
    s_waitcnt lgkmcnt(11)
    v_add_f32 v108, v88, v90
    v_mfma_f32_16x16x32_bf16 v[136:139], v[40:43], a[128:131], v[136:139]
    ds_read_b64_tr_b16 v[36:37], v9 offset:24576
    s_waitcnt lgkmcnt(9)
    v_add_f32 v109, v92, v94
    v_mfma_f32_16x16x32_bf16 v[168:171], v[40:43], a[132:135], v[168:171]
    ds_read_b64_tr_b16 v[38:39], v9 offset:25600
    v_add_f32 v108, v108, v109
    v_mfma_f32_16x16x32_bf16 v[200:203], v[40:43], a[136:139], v[200:203]
    buffer_load_dwordx4 v23, s[16:19], s98 offen offset:3072   lds
    v_mfma_f32_16x16x32_bf16 v[232:235], v[40:43], a[140:143], v[232:235]
    v_mul_f32 v108, 0x3e800000, v108
    v_add_f32 v109, v89, v91
    v_mfma_f32_16x16x32_bf16 v[140:143], v[44:47], a[128:131], v[140:143]
    s_add_u32 m0, s62, 0
    s_xor_b32 s98, s96, 768
    ds_read_b64_tr_b16 v[40:41], v10 offset:24576
    v_mfma_f32_16x16x32_bf16 v[172:175], v[44:47], a[132:135], v[172:175]
    ds_read_b64_tr_b16 v[42:43], v10 offset:25600
    v_add_f32 v110, v93, v95
    v_mfma_f32_16x16x32_bf16 v[204:207], v[44:47], a[136:139], v[204:207]
    buffer_load_dwordx4 v16, s[12:15], s98 offen offset:0   lds
    v_mfma_f32_16x16x32_bf16 v[236:239], v[44:47], a[140:143], v[236:239]
    v_add_f32 v109, v109, v110
    v_sub_f32 v88, v88, v108
    v_mfma_f32_16x16x32_bf16 v[144:147], v[48:51], a[128:131], v[144:147]
    ds_read_b64_tr_b16 v[44:45], v11 offset:24576
    v_sub_f32 v90, v90, v108
    v_mfma_f32_16x16x32_bf16 v[176:179], v[48:51], a[132:135], v[176:179]
    ds_read_b64_tr_b16 v[46:47], v11 offset:25600
    v_sub_f32 v92, v92, v108
    v_mfma_f32_16x16x32_bf16 v[208:211], v[48:51], a[136:139], v[208:211]
    buffer_load_dwordx4 v17, s[12:15], s98 offen offset:1024   lds
    v_mfma_f32_16x16x32_bf16 v[240:243], v[48:51], a[140:143], v[240:243]
    v_sub_f32 v94, v94, v108
    v_mul_f32 v110, v88, v88
    v_mfma_f32_16x16x32_bf16 v[148:151], v[52:55], a[128:131], v[148:151]
    ds_read_b64_tr_b16 v[48:49], v12 offset:24576
    v_fmac_f32 v110, v90, v90
    v_mfma_f32_16x16x32_bf16 v[180:183], v[52:55], a[132:135], v[180:183]
    ds_read_b64_tr_b16 v[50:51], v12 offset:25600
    v_fmac_f32 v110, v92, v92
    v_mfma_f32_16x16x32_bf16 v[212:215], v[52:55], a[136:139], v[212:215]
    buffer_load_dwordx4 v18, s[12:15], s98 offen offset:2048   lds
    v_mfma_f32_16x16x32_bf16 v[244:247], v[52:55], a[140:143], v[244:247]
    v_fmac_f32 v110, v94, v94
    v_fmac_f32 v109, 0x43000000, v110
    v_mfma_f32_16x16x32_bf16 v[152:155], v[56:59], a[128:131], v[152:155]
    ds_read_b64_tr_b16 v[52:53], v13 offset:24576
    v_mov_b32 v110, 0x3727c5ac
    v_mfma_f32_16x16x32_bf16 v[184:187], v[56:59], a[132:135], v[184:187]
    ds_read_b64_tr_b16 v[54:55], v13 offset:25600
    v_fmac_f32 v110, 0x3b000000, v109
    v_mfma_f32_16x16x32_bf16 v[216:219], v[56:59], a[136:139], v[216:219]
    buffer_load_dwordx4 v19, s[12:15], s98 offen offset:3072   lds
    v_mfma_f32_16x16x32_bf16 v[248:251], v[56:59], a[140:143], v[248:251]
    s_waitcnt lgkmcnt(4)
    v_rsq_f32 v110, v110
    v_mfma_f32_16x16x32_bf16 v[156:159], v[60:63], a[128:131], v[156:159]
    s_add_u32 m0, s62, 4096
    s_xor_b32 s98, s96, 33536
    ds_read_b64_tr_b16 v[56:57], v14 offset:24576
    v_mfma_f32_16x16x32_bf16 v[188:191], v[60:63], a[132:135], v[188:191]
    ds_read_b64_tr_b16 v[58:59], v14 offset:25600
    v_sub_f32 v64, v64, v108
    v_mfma_f32_16x16x32_bf16 v[220:223], v[60:63], a[136:139], v[220:223]
    buffer_load_dwordx4 v16, s[12:15], s98 offen offset:0   lds
    v_mfma_f32_16x16x32_bf16 v[252:255], v[60:63], a[140:143], v[252:255]
    v_sub_f32 v65, v65, v108
    v_sub_f32 v66, v66, v108
    v_mfma_f32_16x16x32_bf16 v[128:131], v[32:35], a[144:147], v[128:131]
    ds_read_b64_tr_b16 v[60:61], v15 offset:24576
    v_sub_f32 v67, v67, v108
    v_mfma_f32_16x16x32_bf16 v[160:163], v[32:35], a[148:151], v[160:163]
    ds_read_b64_tr_b16 v[62:63], v15 offset:25600
    v_sub_f32 v68, v68, v108
    v_mfma_f32_16x16x32_bf16 v[192:195], v[32:35], a[152:155], v[192:195]
    buffer_load_dwordx4 v17, s[12:15], s98 offen offset:1024   lds
    v_mfma_f32_16x16x32_bf16 v[224:227], v[32:35], a[156:159], v[224:227]
    v_sub_f32 v69, v69, v108
    v_sub_f32 v70, v70, v108
    v_mfma_f32_16x16x32_bf16 v[132:135], v[36:39], a[144:147], v[132:135]
    buffer_load_dwordx4 v18, s[12:15], s98 offen offset:2048   lds
    v_mfma_f32_16x16x32_bf16 v[164:167], v[36:39], a[148:151], v[164:167]
    v_sub_f32 v71, v71, v108
    v_sub_f32 v72, v72, v108
    v_mfma_f32_16x16x32_bf16 v[196:199], v[36:39], a[152:155], v[196:199]
    buffer_load_dwordx4 v19, s[12:15], s98 offen offset:3072   lds
    s_cmp_eq_u32 s3, 3
    s_cselect_b32 s101, s100, 2147479552
    buffer_load_dword a247, v117, s[24:27], s101 offen offset:4
    v_mfma_f32_16x16x32_bf16 v[228:231], v[36:39], a[156:159], v[228:231]
    v_sub_f32 v73, v73, v108
    v_sub_f32 v74, v74, v108
    v_mfma_f32_16x16x32_bf16 v[136:139], v[40:43], a[144:147], v[136:139]
    v_sub_f32 v75, v75, v108
    v_sub_f32 v76, v76, v108
    s_waitcnt vmcnt(14) lgkmcnt(0)
    s_barrier
    v_mfma_f32_16x16x32_bf16 v[168:171], v[40:43], a[148:151], v[168:171]
    s_add_u32 m0, s63, 114688
    s_xor_b32 s98, s97, 3670016
    ds_read_b64_tr_b16 v[32:33], v8 offset:32768
    v_mfma_f32_16x16x32_bf16 v[200:203], v[40:43], a[152:155], v[200:203]
    ds_read_b64_tr_b16 v[34:35], v8 offset:33792
    v_sub_f32 v77, v77, v108
    v_mfma_f32_16x16x32_bf16 v[232:235], v[40:43], a[156:159], v[232:235]
    ds_read_b64_tr_b16 v[36:37], v9 offset:32768
    v_sub_f32 v78, v78, v108
    v_mfma_f32_16x16x32_bf16 v[140:143], v[44:47], a[144:147], v[140:143]
    ds_read_b64_tr_b16 v[38:39], v9 offset:33792
    v_sub_f32 v79, v79, v108
    v_mfma_f32_16x16x32_bf16 v[172:175], v[44:47], a[148:151], v[172:175]
    ds_read_b64_tr_b16 v[40:41], v10 offset:32768
    v_mul_f32 v64, v64, v110
    v_mfma_f32_16x16x32_bf16 v[204:207], v[44:47], a[152:155], v[204:207]
    ds_read_b64_tr_b16 v[42:43], v10 offset:33792
    v_mul_f32 v65, v65, v110
    v_mfma_f32_16x16x32_bf16 v[236:239], v[44:47], a[156:159], v[236:239]
    ds_read_b128 a[160:163], v30 offset:0
    v_mul_f32 v66, v66, v110
    v_mfma_f32_16x16x32_bf16 v[144:147], v[48:51], a[144:147], v[144:147]
    ds_read_b64_tr_b16 v[44:45], v11 offset:32768
    v_mul_f32 v67, v67, v110
    v_mfma_f32_16x16x32_bf16 v[176:179], v[48:51], a[148:151], v[176:179]
    ds_read_b64_tr_b16 v[46:47], v11 offset:33792
    v_mul_f32 v68, v68, v110
    v_mfma_f32_16x16x32_bf16 v[208:211], v[48:51], a[152:155], v[208:211]
    ds_read_b128 a[164:167], v30 offset:2048
    v_mul_f32 v69, v69, v110
    v_mfma_f32_16x16x32_bf16 v[240:243], v[48:51], a[156:159], v[240:243]
    ds_read_b128 a[168:171], v30 offset:4096
    v_mul_f32 v70, v70, v110
    v_mfma_f32_16x16x32_bf16 v[148:151], v[52:55], a[144:147], v[148:151]
    ds_read_b64_tr_b16 v[48:49], v12 offset:32768
    v_mul_f32 v71, v71, v110
    v_mfma_f32_16x16x32_bf16 v[180:183], v[52:55], a[148:151], v[180:183]
    ds_read_b64_tr_b16 v[50:51], v12 offset:33792
    v_mul_f32 v72, v72, v110
    v_mfma_f32_16x16x32_bf16 v[212:215], v[52:55], a[152:155], v[212:215]
    ds_read_b128 a[172:175], v30 offset:6144
    v_mul_f32 v73, v73, v110
    buffer_load_dword v3, v4, s[36:39], s67 offen sc0 sc1
    v_mfma_f32_16x16x32_bf16 v[244:247], v[52:55], a[156:159], v[244:247]
    buffer_load_dwordx4 v20, s[16:19], s98 offen offset:0   lds
    v_mfma_f32_16x16x32_bf16 v[152:155], v[56:59], a[144:147], v[152:155]
    ds_read_b64_tr_b16 v[52:53], v13 offset:32768
    v_mul_f32 v74, v74, v110
    v_mfma_f32_16x16x32_bf16 v[184:187], v[56:59], a[148:151], v[184:187]
    ds_read_b64_tr_b16 v[54:55], v13 offset:33792
    v_mul_f32 v75, v75, v110
    v_mfma_f32_16x16x32_bf16 v[216:219], v[56:59], a[152:155], v[216:219]
    buffer_load_dwordx4 v21, s[16:19], s98 offen offset:1024   lds
    v_mfma_f32_16x16x32_bf16 v[248:251], v[56:59], a[156:159], v[248:251]
    v_mul_f32 v76, v76, v110
    v_mul_f32 v77, v77, v110
    v_mfma_f32_16x16x32_bf16 v[156:159], v[60:63], a[144:147], v[156:159]
    ds_read_b64_tr_b16 v[56:57], v14 offset:32768
    v_mul_f32 v78, v78, v110
    v_mfma_f32_16x16x32_bf16 v[188:191], v[60:63], a[148:151], v[188:191]
    ds_read_b64_tr_b16 v[58:59], v14 offset:33792
    v_mul_f32 v79, v79, v110
    v_mfma_f32_16x16x32_bf16 v[220:223], v[60:63], a[152:155], v[220:223]
    buffer_load_dwordx4 v22, s[16:19], s98 offen offset:2048   lds
    v_mfma_f32_16x16x32_bf16 v[252:255], v[60:63], a[156:159], v[252:255]
    s_waitcnt lgkmcnt(5)
    v_mfma_f32_16x16x32_bf16 v[128:131], v[32:35], a[160:163], v[128:131]
    ds_read_b64_tr_b16 v[60:61], v15 offset:32768
    v_and_b32 v96, 31, v2
    v_mfma_f32_16x16x32_bf16 v[160:163], v[32:35], a[164:167], v[160:163]
    ds_read_b64_tr_b16 v[62:63], v15 offset:33792
    v_lshlrev_b32 v96, 4, v96
    v_mfma_f32_16x16x32_bf16 v[192:195], v[32:35], a[168:171], v[192:195]
    s_waitcnt lgkmcnt(5)
    ds_read_b128 a[176:179], v31 offset:0
    v_lshrrev_b32 v97, 5, v2
    v_mfma_f32_16x16x32_bf16 v[224:227], v[32:35], a[172:175], v[224:227]
    ds_read_b128 a[180:183], v31 offset:2048
    v_lshl_add_u32 v96, v97, 11, v96
    v_mfma_f32_16x16x32_bf16 v[132:135], v[36:39], a[160:163], v[132:135]
    ds_read_b64_tr_b16 v[32:33], v8 offset:40960
    v_mfma_f32_16x16x32_bf16 v[164:167], v[36:39], a[164:167], v[164:167]
    ds_read_b64_tr_b16 v[34:35], v8 offset:41984
    v_mfma_f32_16x16x32_bf16 v[196:199], v[36:39], a[168:171], v[196:199]
    ds_read_b128 a[184:187], v31 offset:4096
    v_mfma_f32_16x16x32_bf16 v[228:231], v[36:39], a[172:175], v[228:231]
    ds_read_b128 a[188:191], v31 offset:6144
    v_mfma_f32_16x16x32_bf16 v[136:139], v[40:43], a[160:163], v[136:139]
    ds_read_b64_tr_b16 v[36:37], v9 offset:40960
    v_mfma_f32_16x16x32_bf16 v[168:171], v[40:43], a[164:167], v[168:171]
    ds_read_b64_tr_b16 v[38:39], v9 offset:41984
    v_mfma_f32_16x16x32_bf16 v[200:203], v[40:43], a[168:171], v[200:203]
    buffer_load_dwordx4 v23, s[16:19], s98 offen offset:3072   lds
    v_mfma_f32_16x16x32_bf16 v[232:235], v[40:43], a[172:175], v[232:235]
    v_mfma_f32_16x16x32_bf16 v[140:143], v[44:47], a[160:163], v[140:143]
    s_add_u32 m0, s62, 32768
    s_xor_b32 s98, s96, 896
    ds_read_b64_tr_b16 v[40:41], v10 offset:40960
    v_mfma_f32_16x16x32_bf16 v[172:175], v[44:47], a[164:167], v[172:175]
    ds_read_b64_tr_b16 v[42:43], v10 offset:41984
    v_mfma_f32_16x16x32_bf16 v[204:207], v[44:47], a[168:171], v[204:207]
    buffer_load_dwordx4 v16, s[12:15], s98 offen offset:0   lds
    v_mfma_f32_16x16x32_bf16 v[236:239], v[44:47], a[172:175], v[236:239]
    v_mfma_f32_16x16x32_bf16 v[144:147], v[48:51], a[160:163], v[144:147]
    ds_read_b64_tr_b16 v[44:45], v11 offset:40960
    v_mfma_f32_16x16x32_bf16 v[176:179], v[48:51], a[164:167], v[176:179]
    ds_read_b64_tr_b16 v[46:47], v11 offset:41984
    v_mfma_f32_16x16x32_bf16 v[208:211], v[48:51], a[168:171], v[208:211]
    buffer_load_dwordx4 v17, s[12:15], s98 offen offset:1024   lds
    v_mfma_f32_16x16x32_bf16 v[240:243], v[48:51], a[172:175], v[240:243]
    s_waitcnt lgkmcnt(4)
    v_mfma_f32_16x16x32_bf16 v[148:151], v[52:55], a[160:163], v[148:151]
    ds_read_b64_tr_b16 v[48:49], v12 offset:40960
    v_mfma_f32_16x16x32_bf16 v[180:183], v[52:55], a[164:167], v[180:183]
    ds_read_b64_tr_b16 v[50:51], v12 offset:41984
    v_mfma_f32_16x16x32_bf16 v[212:215], v[52:55], a[168:171], v[212:215]
    buffer_load_dwordx4 v18, s[12:15], s98 offen offset:2048   lds
    v_mfma_f32_16x16x32_bf16 v[244:247], v[52:55], a[172:175], v[244:247]
    v_mfma_f32_16x16x32_bf16 v[152:155], v[56:59], a[160:163], v[152:155]
    ds_read_b64_tr_b16 v[52:53], v13 offset:40960
    v_mfma_f32_16x16x32_bf16 v[184:187], v[56:59], a[164:167], v[184:187]
    ds_read_b64_tr_b16 v[54:55], v13 offset:41984
    v_mfma_f32_16x16x32_bf16 v[216:219], v[56:59], a[168:171], v[216:219]
    buffer_load_dwordx4 v19, s[12:15], s98 offen offset:3072   lds
    v_mfma_f32_16x16x32_bf16 v[248:251], v[56:59], a[172:175], v[248:251]
    v_mfma_f32_16x16x32_bf16 v[156:159], v[60:63], a[160:163], v[156:159]
    s_add_u32 m0, s62, 36864
    s_xor_b32 s98, s96, 33664
    ds_read_b64_tr_b16 v[56:57], v14 offset:40960
    v_mfma_f32_16x16x32_bf16 v[188:191], v[60:63], a[164:167], v[188:191]
    ds_read_b64_tr_b16 v[58:59], v14 offset:41984
    v_mfma_f32_16x16x32_bf16 v[220:223], v[60:63], a[168:171], v[220:223]
    buffer_load_dwordx4 v16, s[12:15], s98 offen offset:0   lds
    v_mfma_f32_16x16x32_bf16 v[252:255], v[60:63], a[172:175], v[252:255]
    v_mfma_f32_16x16x32_bf16 v[128:131], v[32:35], a[176:179], v[128:131]
    ds_read_b64_tr_b16 v[60:61], v15 offset:40960
    v_mfma_f32_16x16x32_bf16 v[160:163], v[32:35], a[180:183], v[160:163]
    ds_read_b64_tr_b16 v[62:63], v15 offset:41984
    v_mfma_f32_16x16x32_bf16 v[192:195], v[32:35], a[184:187], v[192:195]
    buffer_load_dwordx4 v17, s[12:15], s98 offen offset:1024   lds
    v_mfma_f32_16x16x32_bf16 v[224:227], v[32:35], a[188:191], v[224:227]
    v_mfma_f32_16x16x32_bf16 v[132:135], v[36:39], a[176:179], v[132:135]
    buffer_load_dwordx4 v18, s[12:15], s98 offen offset:2048   lds
    v_mfma_f32_16x16x32_bf16 v[164:167], v[36:39], a[180:183], v[164:167]
    v_mfma_f32_16x16x32_bf16 v[196:199], v[36:39], a[184:187], v[196:199]
    buffer_load_dwordx4 v19, s[12:15], s98 offen offset:3072   lds
    v_mfma_f32_16x16x32_bf16 v[228:231], v[36:39], a[188:191], v[228:231]
    s_waitcnt lgkmcnt(2)
    s_waitcnt vmcnt(12)
    v_cmp_le_u32 vcc, s68, v3
    s_cmp_eq_u64 vcc, -1
    s_cbranch_scc0 L_E_slow_1
L_E_ok_2:
    v_mfma_f32_16x16x32_bf16 v[136:139], v[40:43], a[176:179], v[136:139]
    s_waitcnt lgkmcnt(0)
    s_barrier
    v_mfma_f32_16x16x32_bf16 v[168:171], v[40:43], a[180:183], v[168:171]
    s_add_u32 m0, s62, 65536
    s_xor_b32 s98, s64, 0
    ds_read_b64_tr_b16 v[32:33], v8 offset:0
    v_mfma_f32_16x16x32_bf16 v[200:203], v[40:43], a[184:187], v[200:203]
    ds_read_b64_tr_b16 v[34:35], v8 offset:1024
    v_mov_b32 v18, v106
    v_mfma_f32_16x16x32_bf16 v[232:235], v[40:43], a[188:191], v[232:235]
    ds_read_b64_tr_b16 v[36:37], v9 offset:0
    v_mov_b32 v19, v107
    v_mfma_f32_16x16x32_bf16 v[140:143], v[44:47], a[176:179], v[140:143]
    ds_read_b64_tr_b16 v[38:39], v9 offset:1024
    v_mfma_f32_16x16x32_bf16 v[172:175], v[44:47], a[180:183], v[172:175]
    ds_read_b64_tr_b16 v[40:41], v10 offset:0
    v_mfma_f32_16x16x32_bf16 v[204:207], v[44:47], a[184:187], v[204:207]
    ds_read_b64_tr_b16 v[42:43], v10 offset:1024
    v_mfma_f32_16x16x32_bf16 v[236:239], v[44:47], a[188:191], v[236:239]
    ds_read_b128 a[192:195], v28 offset:0
    v_mfma_f32_16x16x32_bf16 v[144:147], v[48:51], a[176:179], v[144:147]
    ds_read_b64_tr_b16 v[44:45], v11 offset:0
    v_mfma_f32_16x16x32_bf16 v[176:179], v[48:51], a[180:183], v[176:179]
    ds_read_b64_tr_b16 v[46:47], v11 offset:1024
    v_mfma_f32_16x16x32_bf16 v[208:211], v[48:51], a[184:187], v[208:211]
    ds_read_b128 a[196:199], v28 offset:2048
    v_mfma_f32_16x16x32_bf16 v[240:243], v[48:51], a[188:191], v[240:243]
    ds_read_b128 a[200:203], v28 offset:4096
    v_mfma_f32_16x16x32_bf16 v[148:151], v[52:55], a[176:179], v[148:151]
    ds_read_b64_tr_b16 v[48:49], v12 offset:0
    v_mfma_f32_16x16x32_bf16 v[180:183], v[52:55], a[180:183], v[180:183]
    ds_read_b64_tr_b16 v[50:51], v12 offset:1024
    v_mfma_f32_16x16x32_bf16 v[212:215], v[52:55], a[184:187], v[212:215]
    ds_read_b128 a[204:207], v28 offset:6144
    v_mfma_f32_16x16x32_bf16 v[244:247], v[52:55], a[188:191], v[244:247]
    buffer_load_dwordx4 v24, s[20:23], s98 offen offset:0   lds
    v_mfma_f32_16x16x32_bf16 v[152:155], v[56:59], a[176:179], v[152:155]
    ds_read_b64_tr_b16 v[52:53], v13 offset:0
    v_mfma_f32_16x16x32_bf16 v[184:187], v[56:59], a[180:183], v[184:187]
    ds_read_b64_tr_b16 v[54:55], v13 offset:1024
    v_mfma_f32_16x16x32_bf16 v[216:219], v[56:59], a[184:187], v[216:219]
    buffer_load_dwordx4 v[80:83], v96, s[8:11], s70 offen
    v_mfma_f32_16x16x32_bf16 v[248:251], v[56:59], a[188:191], v[248:251]
    buffer_load_dwordx4 v25, s[20:23], s98 offen offset:1024   lds
    v_mfma_f32_16x16x32_bf16 v[156:159], v[60:63], a[176:179], v[156:159]
    s_lshl_b32 s80, s2, 6
    s_add_u32 s80, s80, 1310720
    ds_read_b64_tr_b16 v[56:57], v14 offset:0
    v_mfma_f32_16x16x32_bf16 v[188:191], v[60:63], a[180:183], v[188:191]
    s_waitcnt lgkmcnt(6)
    s_add_u32 s70, s70, 12288
    ds_read_b64_tr_b16 v[58:59], v14 offset:1024
    v_mfma_f32_16x16x32_bf16 v[220:223], v[60:63], a[184:187], v[220:223]
    buffer_store_dword v6, v7, s[8:11], s80 offen sc0 sc1
    v_mfma_f32_16x16x32_bf16 v[252:255], v[60:63], a[188:191], v[252:255]
    buffer_load_dwordx4 v26, s[20:23], s98 offen offset:2048   lds
    v_mfma_f32_16x16x32_bf16 v[128:131], v[32:35], a[192:195], v[128:131]
    ds_read_b64_tr_b16 v[60:61], v15 offset:0
    v_mfma_f32_16x16x32_bf16 v[160:163], v[32:35], a[196:199], v[160:163]
    ds_read_b64_tr_b16 v[62:63], v15 offset:1024
    v_mfma_f32_16x16x32_bf16 v[192:195], v[32:35], a[200:203], v[192:195]
    s_waitcnt lgkmcnt(5)
    ds_read_b128 a[208:211], v29 offset:0
    v_mfma_f32_16x16x32_bf16 v[224:227], v[32:35], a[204:207], v[224:227]
    ds_read_b128 a[212:215], v29 offset:2048
    v_mfma_f32_16x16x32_bf16 v[132:135], v[36:39], a[192:195], v[132:135]
    ds_read_b64_tr_b16 v[32:33], v8 offset:8192
    v_mfma_f32_16x16x32_bf16 v[164:167], v[36:39], a[196:199], v[164:167]
    ds_read_b64_tr_b16 v[34:35], v8 offset:9216
    v_mfma_f32_16x16x32_bf16 v[196:199], v[36:39], a[200:203], v[196:199]
    ds_read_b128 a[216:219], v29 offset:4096
    v_mfma_f32_16x16x32_bf16 v[228:231], v[36:39], a[204:207], v[228:231]
    ds_read_b128 a[220:223], v29 offset:6144
    v_mfma_f32_16x16x32_bf16 v[136:139], v[40:43], a[192:195], v[136:139]
    ds_read_b64_tr_b16 v[36:37], v9 offset:8192
    v_mfma_f32_16x16x32_bf16 v[168:171], v[40:43], a[196:199], v[168:171]
    ds_read_b64_tr_b16 v[38:39], v9 offset:9216
    v_mfma_f32_16x16x32_bf16 v[200:203], v[40:43], a[200:203], v[200:203]
    buffer_load_dwordx4 v27, s[20:23], s98 offen offset:3072   lds
    v_mfma_f32_16x16x32_bf16 v[232:235], v[40:43], a[204:207], v[232:235]
    buffer_load_dwordx4 v[84:87], v96, s[8:11], s70 offen
    v_mfma_f32_16x16x32_bf16 v[140:143], v[44:47], a[192:195], v[140:143]
    s_add_u32 m0, s62, 69632
    s_xor_b32 s98, s64, 262144
    ds_read_b64_tr_b16 v[40:41], v10 offset:8192
    v_mfma_f32_16x16x32_bf16 v[172:175], v[44:47], a[196:199], v[172:175]
    s_add_u32 s70, s70, 12288
    ds_read_b64_tr_b16 v[42:43], v10 offset:9216
    v_mfma_f32_16x16x32_bf16 v[204:207], v[44:47], a[200:203], v[204:207]
    buffer_load_dwordx4 v24, s[20:23], s98 offen offset:0   lds
    v_mfma_f32_16x16x32_bf16 v[236:239], v[44:47], a[204:207], v[236:239]
    buffer_load_dwordx4 v[88:91], v96, s[8:11], s70 offen
    v_mfma_f32_16x16x32_bf16 v[144:147], v[48:51], a[192:195], v[144:147]
    s_add_u32 s70, s70, 12288
    ds_read_b64_tr_b16 v[44:45], v11 offset:8192
    v_mfma_f32_16x16x32_bf16 v[176:179], v[48:51], a[196:199], v[176:179]
    s_waitcnt lgkmcnt(5)
    ds_read_b64_tr_b16 v[46:47], v11 offset:9216
    v_mfma_f32_16x16x32_bf16 v[208:211], v[48:51], a[200:203], v[208:211]
    buffer_load_dwordx4 v25, s[20:23], s98 offen offset:1024   lds
    v_mfma_f32_16x16x32_bf16 v[240:243], v[48:51], a[204:207], v[240:243]
    buffer_load_dwordx4 v[92:95], v96, s[8:11], s70 offen
    v_mfma_f32_16x16x32_bf16 v[148:151], v[52:55], a[192:195], v[148:151]
    ds_read_b64_tr_b16 v[48:49], v12 offset:8192
    v_mfma_f32_16x16x32_bf16 v[180:183], v[52:55], a[196:199], v[180:183]
    ds_read_b64_tr_b16 v[50:51], v12 offset:9216
    v_mfma_f32_16x16x32_bf16 v[212:215], v[52:55], a[200:203], v[212:215]
    buffer_load_dwordx4 v26, s[20:23], s98 offen offset:2048   lds
    v_mfma_f32_16x16x32_bf16 v[244:247], v[52:55], a[204:207], v[244:247]
    v_mfma_f32_16x16x32_bf16 v[152:155], v[56:59], a[192:195], v[152:155]
    ds_read_b64_tr_b16 v[52:53], v13 offset:8192
    v_mfma_f32_16x16x32_bf16 v[184:187], v[56:59], a[196:199], v[184:187]
    ds_read_b64_tr_b16 v[54:55], v13 offset:9216
    v_mfma_f32_16x16x32_bf16 v[216:219], v[56:59], a[200:203], v[216:219]
    buffer_load_dwordx4 v27, s[20:23], s98 offen offset:3072   lds
    v_mfma_f32_16x16x32_bf16 v[248:251], v[56:59], a[204:207], v[248:251]
    v_mfma_f32_16x16x32_bf16 v[156:159], v[60:63], a[192:195], v[156:159]
    ds_read_b64_tr_b16 v[56:57], v14 offset:8192
    v_mfma_f32_16x16x32_bf16 v[188:191], v[60:63], a[196:199], v[188:191]
    ds_read_b64_tr_b16 v[58:59], v14 offset:9216
    v_mfma_f32_16x16x32_bf16 v[220:223], v[60:63], a[200:203], v[220:223]
    v_mfma_f32_16x16x32_bf16 v[252:255], v[60:63], a[204:207], v[252:255]
    v_mfma_f32_16x16x32_bf16 v[128:131], v[32:35], a[208:211], v[128:131]
    ds_read_b64_tr_b16 v[60:61], v15 offset:8192
    v_mfma_f32_16x16x32_bf16 v[160:163], v[32:35], a[212:215], v[160:163]
    ds_read_b64_tr_b16 v[62:63], v15 offset:9216
    v_mfma_f32_16x16x32_bf16 v[192:195], v[32:35], a[216:219], v[192:195]
    s_getpc_b64 s[100:101]
L_ct1:
    s_lshr_b32 s99, s2, 3
    s_lshl_b32 s99, s99, 2
    s_add_u32 s99, s99, s3
    s_mul_i32 s99, s99, 2
    v_min_u32 v119, 1, v2
    v_add_u32 v119, s99, v119
    v_lshlrev_b32 v119, 7, v119
    v_add_u32 v119, L_ct1-L_ct1, v119
    v_min_u32 v119, L_attn-L_ct1, v119
    global_load_dword v119, v119, s[100:101]
    v_mfma_f32_16x16x32_bf16 v[224:227], v[32:35], a[220:223], v[224:227]
    s_waitcnt lgkmcnt(4)
    v_mfma_f32_16x16x32_bf16 v[132:135], v[36:39], a[208:211], v[132:135]
    v_mfma_f32_16x16x32_bf16 v[164:167], v[36:39], a[212:215], v[164:167]
    v_mfma_f32_16x16x32_bf16 v[196:199], v[36:39], a[216:219], v[196:199]
    v_mfma_f32_16x16x32_bf16 v[228:231], v[36:39], a[220:223], v[228:231]
    v_mfma_f32_16x16x32_bf16 v[136:139], v[40:43], a[208:211], v[136:139]
    s_waitcnt vmcnt(14) lgkmcnt(0)
    s_barrier
    v_mfma_f32_16x16x32_bf16 v[168:171], v[40:43], a[212:215], v[168:171]
    s_add_u32 m0, s62, 0
    s_xor_b32 s98, s64, 2097152
    ds_read_b64_tr_b16 v[32:33], v8 offset:16384
    v_mfma_f32_16x16x32_bf16 v[200:203], v[40:43], a[216:219], v[200:203]
    ds_read_b64_tr_b16 v[34:35], v8 offset:17408
    v_mfma_f32_16x16x32_bf16 v[232:235], v[40:43], a[220:223], v[232:235]
    ds_read_b64_tr_b16 v[36:37], v9 offset:16384
    v_mfma_f32_16x16x32_bf16 v[140:143], v[44:47], a[208:211], v[140:143]
    ds_read_b64_tr_b16 v[38:39], v9 offset:17408
    v_mfma_f32_16x16x32_bf16 v[172:175], v[44:47], a[212:215], v[172:175]
    ds_read_b64_tr_b16 v[40:41], v10 offset:16384
    v_mfma_f32_16x16x32_bf16 v[204:207], v[44:47], a[216:219], v[204:207]
    ds_read_b64_tr_b16 v[42:43], v10 offset:17408
    v_mfma_f32_16x16x32_bf16 v[236:239], v[44:47], a[220:223], v[236:239]
    ds_read_b128 a[224:227], v28 offset:32768
    v_mfma_f32_16x16x32_bf16 v[144:147], v[48:51], a[208:211], v[144:147]
    ds_read_b64_tr_b16 v[44:45], v11 offset:16384
    v_mfma_f32_16x16x32_bf16 v[176:179], v[48:51], a[212:215], v[176:179]
    ds_read_b64_tr_b16 v[46:47], v11 offset:17408
    v_mfma_f32_16x16x32_bf16 v[208:211], v[48:51], a[216:219], v[208:211]
    ds_read_b128 a[228:231], v28 offset:34816
    v_mfma_f32_16x16x32_bf16 v[240:243], v[48:51], a[220:223], v[240:243]
    ds_read_b128 a[232:235], v28 offset:36864
    v_mfma_f32_16x16x32_bf16 v[148:151], v[52:55], a[208:211], v[148:151]
    ds_read_b64_tr_b16 v[48:49], v12 offset:16384
    v_mfma_f32_16x16x32_bf16 v[180:183], v[52:55], a[212:215], v[180:183]
    ds_read_b64_tr_b16 v[50:51], v12 offset:17408
    v_mfma_f32_16x16x32_bf16 v[212:215], v[52:55], a[216:219], v[212:215]
    ds_read_b128 a[236:239], v28 offset:38912
    v_mfma_f32_16x16x32_bf16 v[244:247], v[52:55], a[220:223], v[244:247]
    buffer_load_dwordx4 v24, s[20:23], s98 offen offset:0   lds
    v_mfma_f32_16x16x32_bf16 v[152:155], v[56:59], a[208:211], v[152:155]
    ds_read_b64_tr_b16 v[52:53], v13 offset:16384
    v_mfma_f32_16x16x32_bf16 v[184:187], v[56:59], a[212:215], v[184:187]
    ds_read_b64_tr_b16 v[54:55], v13 offset:17408
    v_mfma_f32_16x16x32_bf16 v[216:219], v[56:59], a[216:219], v[216:219]
    v_mfma_f32_16x16x32_bf16 v[248:251], v[56:59], a[220:223], v[248:251]
    buffer_load_dwordx4 v25, s[20:23], s98 offen offset:1024   lds
    v_mfma_f32_16x16x32_bf16 v[156:159], v[60:63], a[208:211], v[156:159]
    ds_read_b64_tr_b16 v[56:57], v14 offset:16384
    v_mfma_f32_16x16x32_bf16 v[188:191], v[60:63], a[212:215], v[188:191]
    ds_read_b64_tr_b16 v[58:59], v14 offset:17408
    v_mfma_f32_16x16x32_bf16 v[220:223], v[60:63], a[216:219], v[220:223]
    s_waitcnt lgkmcnt(6)
    v_mfma_f32_16x16x32_bf16 v[252:255], v[60:63], a[220:223], v[252:255]
    buffer_load_dwordx4 v26, s[20:23], s98 offen offset:2048   lds
    v_mfma_f32_16x16x32_bf16 v[128:131], v[32:35], a[224:227], v[128:131]
    ds_read_b64_tr_b16 v[60:61], v15 offset:16384
    v_mfma_f32_16x16x32_bf16 v[160:163], v[32:35], a[228:231], v[160:163]
    ds_read_b64_tr_b16 v[62:63], v15 offset:17408
    v_mfma_f32_16x16x32_bf16 v[192:195], v[32:35], a[232:235], v[192:195]
    s_waitcnt lgkmcnt(5)
    ds_read_b128 a[240:243], v29 offset:32768
    v_mfma_f32_16x16x32_bf16 v[224:227], v[32:35], a[236:239], v[224:227]
    ds_read_b128 a[244:247], v29 offset:34816
    v_mfma_f32_16x16x32_bf16 v[132:135], v[36:39], a[224:227], v[132:135]
    ds_read_b64_tr_b16 v[32:33], v8 offset:24576
    v_mfma_f32_16x16x32_bf16 v[164:167], v[36:39], a[228:231], v[164:167]
    ds_read_b64_tr_b16 v[34:35], v8 offset:25600
    s_waitcnt vmcnt(10)
    v_add_f32 v80, v80, v84
    s_waitcnt vmcnt(6)
    v_add_f32 v88, v88, v92
    v_mfma_f32_16x16x32_bf16 v[196:199], v[36:39], a[232:235], v[196:199]
    ds_read_b128 a[248:251], v29 offset:36864
    v_add_f32 v81, v81, v85
    v_add_f32 v89, v89, v93
    v_mfma_f32_16x16x32_bf16 v[228:231], v[36:39], a[236:239], v[228:231]
    ds_read_b128 a[252:255], v29 offset:38912
    v_add_f32 v82, v82, v86
    v_add_f32 v90, v90, v94
    v_mfma_f32_16x16x32_bf16 v[136:139], v[40:43], a[224:227], v[136:139]
    ds_read_b64_tr_b16 v[36:37], v9 offset:24576
    v_and_b32 v16, 15, v2
    v_add_f32 v83, v83, v87
    v_mfma_f32_16x16x32_bf16 v[168:171], v[40:43], a[228:231], v[168:171]
    ds_read_b64_tr_b16 v[38:39], v9 offset:25600
    v_lshrrev_b32 v17, 4, v2
    v_add_f32 v91, v91, v95
    v_mfma_f32_16x16x32_bf16 v[200:203], v[40:43], a[232:235], v[200:203]
    v_lshrrev_b32 v29, 2, v16
    v_and_b32 v16, 3, v16
    v_add_f32 v80, v80, v88
    v_mfma_f32_16x16x32_bf16 v[232:235], v[40:43], a[236:239], v[232:235]
    buffer_load_dwordx4 v27, s[20:23], s98 offen offset:3072   lds
    v_add_f32 v81, v81, v89
    v_mfma_f32_16x16x32_bf16 v[140:143], v[44:47], a[224:227], v[140:143]
    s_add_u32 m0, s62, 4096
    ds_read_b64_tr_b16 v[40:41], v10 offset:24576
    v_lshl_add_u32 v28, v17, 3, v29
    v_add_f32 v82, v82, v90
    v_mfma_f32_16x16x32_bf16 v[172:175], v[44:47], a[228:231], v[172:175]
    s_xor_b32 s98, s64, 2359296
    ds_read_b64_tr_b16 v[42:43], v10 offset:25600
    v_lshlrev_b32 v28, 7, v28
    v_add_f32 v83, v83, v91
    v_mfma_f32_16x16x32_bf16 v[204:207], v[44:47], a[232:235], v[204:207]
    v_lshl_add_u32 v28, v16, 3, v28
    v_and_b32 v17, 1, v17
    v_lshrrev_b32 v88, 5, v2
    v_mfma_f32_16x16x32_bf16 v[236:239], v[44:47], a[236:239], v[236:239]
    buffer_load_dwordx4 v24, s[20:23], s98 offen offset:0   lds
    v_cvt_f32_u32 v88, v88
    v_mfma_f32_16x16x32_bf16 v[144:147], v[48:51], a[224:227], v[144:147]
    ds_read_b64_tr_b16 v[44:45], v11 offset:24576
    v_lshrrev_b32 v29, 1, v29
    v_cvt_pk_bf16_f32 v84, v80, v81
    v_mfma_f32_16x16x32_bf16 v[176:179], v[48:51], a[228:231], v[176:179]
    ds_read_b64_tr_b16 v[46:47], v11 offset:25600
    v_lshl_add_u32 v29, v17, 1, v29
    v_cvt_pk_bf16_f32 v85, v82, v83
    v_mfma_f32_16x16x32_bf16 v[208:211], v[48:51], a[232:235], v[208:211]
    s_waitcnt lgkmcnt(5)
    v_lshl_add_u32 v28, v29, 5, v28
    v_add_u32 v28, 65536, v28
    v_lshlrev_b32 v80, 16, v84
    v_mfma_f32_16x16x32_bf16 v[240:243], v[48:51], a[236:239], v[240:243]
    buffer_load_dwordx4 v25, s[20:23], s98 offen offset:1024   lds
    v_and_b32 v81, 0xffff0000, v84
    v_mfma_f32_16x16x32_bf16 v[148:151], v[52:55], a[224:227], v[148:151]
    ds_read_b64_tr_b16 v[48:49], v12 offset:24576
    v_xor_b32 v29, 32, v28
    v_lshlrev_b32 v82, 16, v85
    v_mfma_f32_16x16x32_bf16 v[180:183], v[52:55], a[228:231], v[180:183]
    ds_read_b64_tr_b16 v[50:51], v12 offset:25600
    v_xor_b32 v30, 64, v28
    v_and_b32 v83, 0xffff0000, v85
    v_mfma_f32_16x16x32_bf16 v[212:215], v[52:55], a[232:235], v[212:215]
    v_xor_b32 v31, 96, v28
    v_and_b32 v16, 15, v2
    v_add_f32 v80, v80, v88
    v_mfma_f32_16x16x32_bf16 v[244:247], v[52:55], a[236:239], v[244:247]
    buffer_load_dwordx4 v26, s[20:23], s98 offen offset:2048   lds
    v_add_f32 v81, v81, v88
    v_mfma_f32_16x16x32_bf16 v[152:155], v[56:59], a[224:227], v[152:155]
    ds_read_b64_tr_b16 v[52:53], v13 offset:24576
    v_lshlrev_b32 v16, 6, v16
    v_add_f32 v82, v82, v88
    v_mfma_f32_16x16x32_bf16 v[184:187], v[56:59], a[228:231], v[184:187]
    ds_read_b64_tr_b16 v[54:55], v13 offset:25600
    v_add_u32 v16, 65536, v16
    v_add_f32 v83, v83, v88
    v_mfma_f32_16x16x32_bf16 v[216:219], v[56:59], a[232:235], v[216:219]
    v_mad_i32_i24 v16, v17, s77, v16
    v_and_b32 v17, 31, v2
    v_cvt_pk_bf16_f32 v84, v80, v81
    v_mfma_f32_16x16x32_bf16 v[248:251], v[56:59], a[236:239], v[248:251]
    buffer_load_dwordx4 v27, s[20:23], s98 offen offset:3072   lds
    v_cvt_pk_bf16_f32 v85, v82, v83
    v_mfma_f32_16x16x32_bf16 v[156:159], v[60:63], a[224:227], v[156:159]
    ds_read_b64_tr_b16 v[56:57], v14 offset:24576
    v_lshlrev_b32 v17, 6, v17
    v_lshlrev_b32 v80, 16, v84
    v_mfma_f32_16x16x32_bf16 v[188:191], v[60:63], a[228:231], v[188:191]
    ds_read_b64_tr_b16 v[58:59], v14 offset:25600
    v_and_b32 v81, 0xffff0000, v84
    v_lshlrev_b32 v82, 16, v85
    v_mfma_f32_16x16x32_bf16 v[220:223], v[60:63], a[232:235], v[220:223]
    v_and_b32 v83, 0xffff0000, v85
    v_mul_f32 v80, 0x3e0293ee, v80
    v_mul_f32 v81, 0x3e0293ee, v81
    v_mfma_f32_16x16x32_bf16 v[252:255], v[60:63], a[236:239], v[252:255]
    v_mul_f32 v82, 0x3e0293ee, v82
    v_mul_f32 v83, 0x3e0293ee, v83
    v_mfma_f32_16x16x32_bf16 v[128:131], v[32:35], a[240:243], v[128:131]
    s_lshl_b32 s70, s3, 10
    s_add_u32 s70, s70, 151552
    ds_read_b64_tr_b16 v[60:61], v15 offset:24576
    v_add_u32 v88, s70, v1
    v_add_u32 v18, s70, v18
    v_mfma_f32_16x16x32_bf16 v[160:163], v[32:35], a[244:247], v[160:163]
    ds_read_b64_tr_b16 v[62:63], v15 offset:25600
    ds_write_b128 v88, v[80:83]
    v_mfma_f32_16x16x32_bf16 v[192:195], v[32:35], a[248:251], v[192:195]
    v_mfma_f32_16x16x32_bf16 v[224:227], v[32:35], a[252:255], v[224:227]
    s_waitcnt lgkmcnt(5)
    v_mfma_f32_16x16x32_bf16 v[132:135], v[36:39], a[240:243], v[132:135]
    v_mfma_f32_16x16x32_bf16 v[164:167], v[36:39], a[244:247], v[164:167]
    v_mfma_f32_16x16x32_bf16 v[196:199], v[36:39], a[248:251], v[196:199]
    v_mfma_f32_16x16x32_bf16 v[228:231], v[36:39], a[252:255], v[228:231]
    ds_read_b128 v[80:83], v18 offset:0
    v_mfma_f32_16x16x32_bf16 v[136:139], v[40:43], a[240:243], v[136:139]
    ds_read_b128 v[84:87], v18 offset:16
    s_waitcnt vmcnt(9) lgkmcnt(0)
    s_barrier
    v_mfma_f32_16x16x32_bf16 v[168:171], v[40:43], a[244:247], v[168:171]
    s_add_u32 m0, s62, 32768
    s_xor_b32 s98, s64, 128
    ds_read_b64_tr_b16 v[32:33], v28 offset:0
    v_mfma_f32_16x16x32_bf16 v[200:203], v[40:43], a[248:251], v[200:203]
    ds_read_b64_tr_b16 v[34:35], v28 offset:512
    v_mfma_f32_16x16x32_bf16 v[232:235], v[40:43], a[252:255], v[232:235]
    ds_read_b64_tr_b16 v[36:37], v28 offset:4096
    v_mfma_f32_16x16x32_bf16 v[140:143], v[44:47], a[240:243], v[140:143]
    ds_read_b64_tr_b16 v[38:39], v28 offset:4608
    v_mfma_f32_16x16x32_bf16 v[172:175], v[44:47], a[244:247], v[172:175]
    ds_read_b64_tr_b16 v[40:41], v29 offset:0
    v_mfma_f32_16x16x32_bf16 v[204:207], v[44:47], a[248:251], v[204:207]
    ds_read_b64_tr_b16 v[42:43], v29 offset:512
    v_mfma_f32_16x16x32_bf16 v[236:239], v[44:47], a[252:255], v[236:239]
    buffer_load_dwordx4 v24, s[20:23], s98 offen offset:0   lds
    v_mfma_f32_16x16x32_bf16 v[144:147], v[48:51], a[240:243], v[144:147]
    ds_read_b64_tr_b16 v[44:45], v29 offset:4096
    v_mfma_f32_16x16x32_bf16 v[176:179], v[48:51], a[244:247], v[176:179]
    ds_read_b64_tr_b16 v[46:47], v29 offset:4608
    v_mfma_f32_16x16x32_bf16 v[208:211], v[48:51], a[248:251], v[208:211]
    ds_read_b128 v[88:91], v18 offset:512
    v_mfma_f32_16x16x32_bf16 v[240:243], v[48:51], a[252:255], v[240:243]
    buffer_load_dwordx4 v25, s[20:23], s98 offen offset:1024   lds
    v_mfma_f32_16x16x32_bf16 v[148:151], v[52:55], a[240:243], v[148:151]
    ds_read_b64_tr_b16 v[48:49], v28 offset:8192
    v_mfma_f32_16x16x32_bf16 v[180:183], v[52:55], a[244:247], v[180:183]
    ds_read_b64_tr_b16 v[50:51], v28 offset:8704
    v_mfma_f32_16x16x32_bf16 v[212:215], v[52:55], a[248:251], v[212:215]
    ds_read_b128 v[92:95], v18 offset:528
    v_mfma_f32_16x16x32_bf16 v[244:247], v[52:55], a[252:255], v[244:247]
    buffer_load_dwordx4 v26, s[20:23], s98 offen offset:2048   lds
    v_mfma_f32_16x16x32_bf16 v[152:155], v[56:59], a[240:243], v[152:155]
    ds_read_b64_tr_b16 v[52:53], v28 offset:12288
    v_mfma_f32_16x16x32_bf16 v[184:187], v[56:59], a[244:247], v[184:187]
    ds_read_b64_tr_b16 v[54:55], v28 offset:12800
    v_mfma_f32_16x16x32_bf16 v[216:219], v[56:59], a[248:251], v[216:219]
    v_mfma_f32_16x16x32_bf16 v[248:251], v[56:59], a[252:255], v[248:251]
    buffer_load_dwordx4 v27, s[20:23], s98 offen offset:3072   lds
    v_mfma_f32_16x16x32_bf16 v[156:159], v[60:63], a[240:243], v[156:159]
    s_add_u32 m0, s62, 36864
    s_xor_b32 s98, s64, 262272
    ds_read_b64_tr_b16 v[56:57], v29 offset:8192
    v_mfma_f32_16x16x32_bf16 v[188:191], v[60:63], a[244:247], v[188:191]
    ds_read_b64_tr_b16 v[58:59], v29 offset:8704
    s_waitcnt lgkmcnt(7)
    v_fma_f32 v64, v64, v88, v80
    v_mfma_f32_16x16x32_bf16 v[220:223], v[60:63], a[248:251], v[220:223]
    v_fma_f32 v65, v65, v89, v81
    v_fma_f32 v66, v66, v90, v82
    v_mfma_f32_16x16x32_bf16 v[252:255], v[60:63], a[252:255], v[252:255]
    buffer_load_dwordx4 v24, s[20:23], s98 offen offset:0   lds
    v_mfma_f32_16x16x32_bf16 v[96:99], a[0:3], v[32:35], 0
    ds_read_b64_tr_b16 v[60:61], v29 offset:12288
    v_fma_f32 v67, v67, v91, v83
    v_mfma_f32_16x16x32_bf16 v[96:99], a[16:19], v[36:39], v[96:99]
    ds_read_b64_tr_b16 v[62:63], v29 offset:12800
    s_waitcnt lgkmcnt(6)
    v_fma_f32 v68, v68, v92, v84
    v_mfma_f32_16x16x32_bf16 v[100:103], a[4:7], v[32:35], 0
    v_fma_f32 v69, v69, v93, v85
    v_fma_f32 v70, v70, v94, v86
    v_mfma_f32_16x16x32_bf16 v[100:103], a[20:23], v[36:39], v[100:103]
    buffer_load_dwordx4 v25, s[20:23], s98 offen offset:1024   lds
    v_mfma_f32_16x16x32_bf16 v[104:107], a[8:11], v[32:35], 0
    v_fma_f32 v71, v71, v95, v87
    v_mfma_f32_16x16x32_bf16 v[104:107], a[24:27], v[36:39], v[104:107]
    v_cvt_pk_bf16_f32 v64, v64, v65
    v_cvt_pk_bf16_f32 v65, v66, v67
    v_mfma_f32_16x16x32_bf16 v[108:111], a[12:15], v[32:35], 0
    v_cvt_pk_bf16_f32 v66, v68, v69
    v_cvt_pk_bf16_f32 v67, v70, v71
    v_mfma_f32_16x16x32_bf16 v[108:111], a[28:31], v[36:39], v[108:111]
    buffer_load_dwordx4 v26, s[20:23], s98 offen offset:2048   lds
    v_mfma_f32_16x16x32_bf16 v[112:115], a[0:3], v[40:43], 0
    ds_read_b64_tr_b16 v[32:33], v28 offset:16384
    v_cvt_pk_bf16_f32 v128, v128, v129
    v_mfma_f32_16x16x32_bf16 v[112:115], a[16:19], v[44:47], v[112:115]
    s_waitcnt vmcnt(15)
    ds_read_b64_tr_b16 v[34:35], v28 offset:16896
    v_cvt_pk_bf16_f32 v129, v130, v131
    v_mfma_f32_16x16x32_bf16 v[116:119], a[4:7], v[40:43], 0
    ds_read_b64_tr_b16 v[36:37], v28 offset:20480
    v_cvt_pk_bf16_f32 v130, v132, v133
    v_mfma_f32_16x16x32_bf16 v[116:119], a[20:23], v[44:47], v[116:119]
    ds_read_b64_tr_b16 v[38:39], v28 offset:20992
    v_cvt_pk_bf16_f32 v131, v134, v135
    v_mfma_f32_16x16x32_bf16 v[120:123], a[8:11], v[40:43], 0
    buffer_load_dwordx4 v27, s[20:23], s98 offen offset:3072   lds
    v_mfma_f32_16x16x32_bf16 v[120:123], a[24:27], v[44:47], v[120:123]
    s_add_u32 m0, s63, 131072
    s_xor_b32 s98, s0, 0
    ds_read_b128 v[80:83], v18 offset:256
    v_mfma_f32_16x16x32_bf16 v[124:127], a[12:15], v[40:43], 0
    buffer_store_dwordx4 v[64:67], v19, s[8:11], s71 offen offset:0 sc0 sc1
    v_mfma_f32_16x16x32_bf16 v[124:127], a[28:31], v[44:47], v[124:127]
    s_xor_b32 s79, s65, 0
    ds_read_b128 v[84:87], v18 offset:272
    v_mfma_f32_16x16x32_bf16 v[96:99], a[32:35], v[48:51], v[96:99]
    s_waitcnt lgkmcnt(6)
    ds_read_b64_tr_b16 v[40:41], v29 offset:16384
    v_mfma_f32_16x16x32_bf16 v[96:99], a[48:51], v[52:55], v[96:99]
    ds_read_b64_tr_b16 v[42:43], v29 offset:16896
    v_mfma_f32_16x16x32_bf16 v[100:103], a[36:39], v[48:51], v[100:103]
    ds_read_b64_tr_b16 v[44:45], v29 offset:20480
    v_mfma_f32_16x16x32_bf16 v[100:103], a[52:55], v[52:55], v[100:103]
    ds_read_b64_tr_b16 v[46:47], v29 offset:20992
    v_mfma_f32_16x16x32_bf16 v[104:107], a[40:43], v[48:51], v[104:107]
    buffer_load_dwordx4 v20, s[24:27], s98 offen offset:0   lds
    v_mfma_f32_16x16x32_bf16 v[104:107], a[56:59], v[52:55], v[104:107]
    s_lshr_b32 s100, s2, 3
    s_mul_i32 s66, s4, 28
    ds_read_b128 v[88:91], v18 offset:768
    v_mfma_f32_16x16x32_bf16 v[108:111], a[44:47], v[48:51], v[108:111]
    s_add_u32 s66, s66, s100
    s_cmp_lt_u32 s100, 28
    s_cselect_b32 s66, s66, 255
    ds_read_b128 v[92:95], v18 offset:784
    v_mfma_f32_16x16x32_bf16 v[108:111], a[60:63], v[52:55], v[108:111]
    buffer_store_dwordx4 v[128:131], v1, s[8:11], s79 offen offset:0 sc0 sc1
    v_mfma_f32_16x16x32_bf16 v[112:115], a[32:35], v[56:59], v[112:115]
    s_lshl_b32 s67, s4, 3
    s_add_u32 s67, s67, s100
    ds_read_b64_tr_b16 v[48:49], v28 offset:24576
    v_mfma_f32_16x16x32_bf16 v[112:115], a[48:51], v[60:63], v[112:115]
    s_sub_u32 s67, s67, 24
    ds_read_b64_tr_b16 v[50:51], v28 offset:25088
    v_cvt_pk_bf16_f32 v136, v136, v137
    v_mfma_f32_16x16x32_bf16 v[116:119], a[36:39], v[56:59], v[116:119]
    s_cmp_ge_u32 s100, 24
    s_cselect_b32 s67, s67, 255
    ds_read_b64_tr_b16 v[52:53], v28 offset:28672
    v_cvt_pk_bf16_f32 v137, v138, v139
    v_mfma_f32_16x16x32_bf16 v[116:119], a[52:55], v[60:63], v[116:119]
    ds_read_b64_tr_b16 v[54:55], v28 offset:29184
    v_cvt_pk_bf16_f32 v138, v140, v141
    v_mfma_f32_16x16x32_bf16 v[120:123], a[40:43], v[56:59], v[120:123]
    buffer_load_dwordx4 v21, s[24:27], s98 offen offset:1024   lds
    v_mfma_f32_16x16x32_bf16 v[120:123], a[56:59], v[60:63], v[120:123]
    s_waitcnt lgkmcnt(5)
    v_fma_f32 v72, v72, v88, v80
    v_fma_f32 v73, v73, v89, v81
    v_mfma_f32_16x16x32_bf16 v[124:127], a[44:47], v[56:59], v[124:127]
    v_fma_f32 v74, v74, v90, v82
    v_fma_f32 v75, v75, v91, v83
    v_mfma_f32_16x16x32_bf16 v[124:127], a[60:63], v[60:63], v[124:127]
    v_cvt_pk_bf16_f32 v139, v142, v143
    v_mfma_f32_16x16x32_bf16 v[96:99], a[64:67], v[32:35], v[96:99]
    s_xor_b32 s79, s65, 0
    ds_read_b64_tr_b16 v[56:57], v29 offset:24576
    s_waitcnt lgkmcnt(5)
    v_fma_f32 v76, v76, v92, v84
    v_mfma_f32_16x16x32_bf16 v[96:99], a[80:83], v[36:39], v[96:99]
    ds_read_b64_tr_b16 v[58:59], v29 offset:25088
    v_fma_f32 v77, v77, v93, v85
    v_mfma_f32_16x16x32_bf16 v[100:103], a[68:71], v[32:35], v[100:103]
    ds_read_b64_tr_b16 v[60:61], v29 offset:28672
    v_fma_f32 v78, v78, v94, v86
    v_mfma_f32_16x16x32_bf16 v[100:103], a[84:87], v[36:39], v[100:103]
    ds_read_b64_tr_b16 v[62:63], v29 offset:29184
    v_fma_f32 v79, v79, v95, v87
    v_mfma_f32_16x16x32_bf16 v[104:107], a[72:75], v[32:35], v[104:107]
    buffer_load_dwordx4 v22, s[24:27], s98 offen offset:2048   lds
    v_mfma_f32_16x16x32_bf16 v[104:107], a[88:91], v[36:39], v[104:107]
    v_cvt_pk_bf16_f32 v72, v72, v73
    v_cvt_pk_bf16_f32 v73, v74, v75
    v_mfma_f32_16x16x32_bf16 v[108:111], a[76:79], v[32:35], v[108:111]
    v_cvt_pk_bf16_f32 v74, v76, v77
    v_cvt_pk_bf16_f32 v75, v78, v79
    v_mfma_f32_16x16x32_bf16 v[108:111], a[92:95], v[36:39], v[108:111]
    buffer_store_dwordx4 v[72:75], v19, s[8:11], s71 offen offset:2048 sc0 sc1
    v_mfma_f32_16x16x32_bf16 v[112:115], a[64:67], v[40:43], v[112:115]
    ds_read_b64_tr_b16 v[32:33], v30 offset:0
    v_mfma_f32_16x16x32_bf16 v[112:115], a[80:83], v[44:47], v[112:115]
    ds_read_b64_tr_b16 v[34:35], v30 offset:512
    v_mfma_f32_16x16x32_bf16 v[116:119], a[68:71], v[40:43], v[116:119]
    ds_read_b64_tr_b16 v[36:37], v30 offset:4096
    v_mfma_f32_16x16x32_bf16 v[116:119], a[84:87], v[44:47], v[116:119]
    ds_read_b64_tr_b16 v[38:39], v30 offset:4608
    v_mfma_f32_16x16x32_bf16 v[120:123], a[72:75], v[40:43], v[120:123]
    buffer_load_dwordx4 v23, s[24:27], s98 offen offset:3072   lds
    v_mfma_f32_16x16x32_bf16 v[120:123], a[88:91], v[44:47], v[120:123]
    s_add_u32 m0, s63, 98304
    s_xor_b32 s98, s0, 524288
    v_mfma_f32_16x16x32_bf16 v[124:127], a[76:79], v[40:43], v[124:127]
    buffer_store_dwordx4 v[136:139], v1, s[8:11], s79 offen offset:1024 sc0 sc1
    v_mfma_f32_16x16x32_bf16 v[124:127], a[92:95], v[44:47], v[124:127]
    s_waitcnt lgkmcnt(4)
    v_mfma_f32_16x16x32_bf16 v[96:99], a[96:99], v[48:51], v[96:99]
    ds_read_b64_tr_b16 v[40:41], v31 offset:0
    v_cvt_pk_bf16_f32 v144, v144, v145
    v_mfma_f32_16x16x32_bf16 v[96:99], a[112:115], v[52:55], v[96:99]
    ds_read_b64_tr_b16 v[42:43], v31 offset:512
    v_cvt_pk_bf16_f32 v145, v146, v147
    v_mfma_f32_16x16x32_bf16 v[100:103], a[100:103], v[48:51], v[100:103]
    ds_read_b64_tr_b16 v[44:45], v31 offset:4096
    v_cvt_pk_bf16_f32 v146, v148, v149
    v_mfma_f32_16x16x32_bf16 v[100:103], a[116:119], v[52:55], v[100:103]
    ds_read_b64_tr_b16 v[46:47], v31 offset:4608
    v_cvt_pk_bf16_f32 v147, v150, v151
    v_mfma_f32_16x16x32_bf16 v[104:107], a[104:107], v[48:51], v[104:107]
    buffer_load_dwordx4 v20, s[24:27], s98 offen offset:0   lds
    v_mfma_f32_16x16x32_bf16 v[104:107], a[120:123], v[52:55], v[104:107]
    s_xor_b32 s79, s65, 0
    v_mfma_f32_16x16x32_bf16 v[108:111], a[108:111], v[48:51], v[108:111]
    buffer_store_dwordx4 v[144:147], v1, s[8:11], s79 offen offset:2048 sc0 sc1
    v_mfma_f32_16x16x32_bf16 v[108:111], a[124:127], v[52:55], v[108:111]
    v_mfma_f32_16x16x32_bf16 v[112:115], a[96:99], v[56:59], v[112:115]
    ds_read_b64_tr_b16 v[48:49], v30 offset:8192
    v_mfma_f32_16x16x32_bf16 v[112:115], a[112:115], v[60:63], v[112:115]
    ds_read_b64_tr_b16 v[50:51], v30 offset:8704
    v_mfma_f32_16x16x32_bf16 v[116:119], a[100:103], v[56:59], v[116:119]
    ds_read_b64_tr_b16 v[52:53], v30 offset:12288
    v_mfma_f32_16x16x32_bf16 v[116:119], a[116:119], v[60:63], v[116:119]
    ds_read_b64_tr_b16 v[54:55], v30 offset:12800
    v_cvt_pk_bf16_f32 v152, v152, v153
    v_mfma_f32_16x16x32_bf16 v[120:123], a[104:107], v[56:59], v[120:123]
    buffer_load_dwordx4 v21, s[24:27], s98 offen offset:1024   lds
    v_mfma_f32_16x16x32_bf16 v[120:123], a[120:123], v[60:63], v[120:123]
    v_cvt_pk_bf16_f32 v153, v154, v155
    v_cvt_pk_bf16_f32 v154, v156, v157
    v_mfma_f32_16x16x32_bf16 v[124:127], a[108:111], v[56:59], v[124:127]
    v_cvt_pk_bf16_f32 v155, v158, v159
    v_mfma_f32_16x16x32_bf16 v[124:127], a[124:127], v[60:63], v[124:127]
    s_waitcnt lgkmcnt(4)
    v_mfma_f32_16x16x32_bf16 v[64:67], a[0:3], v[32:35], 0
    s_xor_b32 s79, s65, 0
    ds_read_b64_tr_b16 v[56:57], v31 offset:8192
    v_mfma_f32_16x16x32_bf16 v[64:67], a[16:19], v[36:39], v[64:67]
    ds_read_b64_tr_b16 v[58:59], v31 offset:8704
    v_mfma_f32_16x16x32_bf16 v[68:71], a[4:7], v[32:35], 0
    ds_read_b64_tr_b16 v[60:61], v31 offset:12288
    v_mfma_f32_16x16x32_bf16 v[68:71], a[20:23], v[36:39], v[68:71]
    ds_read_b64_tr_b16 v[62:63], v31 offset:12800
    v_mfma_f32_16x16x32_bf16 v[72:75], a[8:11], v[32:35], 0
    buffer_load_dwordx4 v22, s[24:27], s98 offen offset:2048   lds
    v_mfma_f32_16x16x32_bf16 v[72:75], a[24:27], v[36:39], v[72:75]
    buffer_store_dwordx4 v[152:155], v1, s[8:11], s79 offen offset:3072 sc0 sc1
    v_mfma_f32_16x16x32_bf16 v[76:79], a[12:15], v[32:35], 0
    v_mfma_f32_16x16x32_bf16 v[76:79], a[28:31], v[36:39], v[76:79]
    v_mfma_f32_16x16x32_bf16 v[80:83], a[0:3], v[40:43], 0
    ds_read_b64_tr_b16 v[32:33], v30 offset:16384
    v_mfma_f32_16x16x32_bf16 v[80:83], a[16:19], v[44:47], v[80:83]
    ds_read_b64_tr_b16 v[34:35], v30 offset:16896
    v_mfma_f32_16x16x32_bf16 v[84:87], a[4:7], v[40:43], 0
    ds_read_b64_tr_b16 v[36:37], v30 offset:20480
    v_mfma_f32_16x16x32_bf16 v[84:87], a[20:23], v[44:47], v[84:87]
    ds_read_b64_tr_b16 v[38:39], v30 offset:20992
    v_mfma_f32_16x16x32_bf16 v[88:91], a[8:11], v[40:43], 0
    buffer_load_dwordx4 v23, s[24:27], s98 offen offset:3072   lds
    v_mfma_f32_16x16x32_bf16 v[88:91], a[24:27], v[44:47], v[88:91]
    v_cvt_pk_bf16_f32 v160, v160, v161
    v_cvt_pk_bf16_f32 v161, v162, v163
    v_mfma_f32_16x16x32_bf16 v[92:95], a[12:15], v[40:43], 0
    v_cvt_pk_bf16_f32 v162, v164, v165
    v_cvt_pk_bf16_f32 v163, v166, v167
    v_mfma_f32_16x16x32_bf16 v[92:95], a[28:31], v[44:47], v[92:95]
    s_waitcnt lgkmcnt(4)
    v_mfma_f32_16x16x32_bf16 v[64:67], a[32:35], v[48:51], v[64:67]
    s_xor_b32 s79, s65, 4096
    ds_read_b64_tr_b16 v[40:41], v31 offset:16384
    v_mfma_f32_16x16x32_bf16 v[64:67], a[48:51], v[52:55], v[64:67]
    ds_read_b64_tr_b16 v[42:43], v31 offset:16896
    v_mfma_f32_16x16x32_bf16 v[68:71], a[36:39], v[48:51], v[68:71]
    ds_read_b64_tr_b16 v[44:45], v31 offset:20480
    v_mfma_f32_16x16x32_bf16 v[68:71], a[52:55], v[52:55], v[68:71]
    ds_read_b64_tr_b16 v[46:47], v31 offset:20992
    v_mfma_f32_16x16x32_bf16 v[72:75], a[40:43], v[48:51], v[72:75]
    buffer_store_dwordx4 v[160:163], v1, s[8:11], s79 offen offset:0 sc0 sc1
    v_mfma_f32_16x16x32_bf16 v[72:75], a[56:59], v[52:55], v[72:75]
    v_mfma_f32_16x16x32_bf16 v[76:79], a[44:47], v[48:51], v[76:79]
    v_mfma_f32_16x16x32_bf16 v[76:79], a[60:63], v[52:55], v[76:79]
    v_mfma_f32_16x16x32_bf16 v[80:83], a[32:35], v[56:59], v[80:83]
    ds_read_b64_tr_b16 v[48:49], v30 offset:24576
    v_mfma_f32_16x16x32_bf16 v[80:83], a[48:51], v[60:63], v[80:83]
    ds_read_b64_tr_b16 v[50:51], v30 offset:25088
    v_mfma_f32_16x16x32_bf16 v[84:87], a[36:39], v[56:59], v[84:87]
    ds_read_b64_tr_b16 v[52:53], v30 offset:28672
    v_mfma_f32_16x16x32_bf16 v[84:87], a[52:55], v[60:63], v[84:87]
    ds_read_b64_tr_b16 v[54:55], v30 offset:29184
    v_mfma_f32_16x16x32_bf16 v[88:91], a[40:43], v[56:59], v[88:91]
    v_mfma_f32_16x16x32_bf16 v[88:91], a[56:59], v[60:63], v[88:91]
    v_cvt_pk_bf16_f32 v168, v168, v169
    v_cvt_pk_bf16_f32 v169, v170, v171
    v_mfma_f32_16x16x32_bf16 v[92:95], a[44:47], v[56:59], v[92:95]
    v_cvt_pk_bf16_f32 v170, v172, v173
    v_cvt_pk_bf16_f32 v171, v174, v175
    v_mfma_f32_16x16x32_bf16 v[92:95], a[60:63], v[60:63], v[92:95]
    s_waitcnt lgkmcnt(4)
    v_mfma_f32_16x16x32_bf16 v[64:67], a[64:67], v[32:35], v[64:67]
    s_xor_b32 s79, s65, 4096
    ds_read_b64_tr_b16 v[56:57], v31 offset:24576
    v_mfma_f32_16x16x32_bf16 v[64:67], a[80:83], v[36:39], v[64:67]
    ds_read_b64_tr_b16 v[58:59], v31 offset:25088
    v_mfma_f32_16x16x32_bf16 v[68:71], a[68:71], v[32:35], v[68:71]
    ds_read_b64_tr_b16 v[60:61], v31 offset:28672
    v_mfma_f32_16x16x32_bf16 v[68:71], a[84:87], v[36:39], v[68:71]
    ds_read_b64_tr_b16 v[62:63], v31 offset:29184
    v_mfma_f32_16x16x32_bf16 v[72:75], a[72:75], v[32:35], v[72:75]
    buffer_store_dwordx4 v[168:171], v1, s[8:11], s79 offen offset:1024 sc0 sc1
    v_mfma_f32_16x16x32_bf16 v[72:75], a[88:91], v[36:39], v[72:75]
    v_mfma_f32_16x16x32_bf16 v[76:79], a[76:79], v[32:35], v[76:79]
    v_mfma_f32_16x16x32_bf16 v[76:79], a[92:95], v[36:39], v[76:79]
    v_mfma_f32_16x16x32_bf16 v[80:83], a[64:67], v[40:43], v[80:83]
    v_mfma_f32_16x16x32_bf16 v[80:83], a[80:83], v[44:47], v[80:83]
    v_mfma_f32_16x16x32_bf16 v[84:87], a[68:71], v[40:43], v[84:87]
    v_mfma_f32_16x16x32_bf16 v[84:87], a[84:87], v[44:47], v[84:87]
    v_mfma_f32_16x16x32_bf16 v[88:91], a[72:75], v[40:43], v[88:91]
    v_mfma_f32_16x16x32_bf16 v[88:91], a[88:91], v[44:47], v[88:91]
    s_waitcnt vmcnt(10)
    v_mfma_f32_16x16x32_bf16 v[92:95], a[76:79], v[40:43], v[92:95]
    v_xor_b32 v28, 65536, v28
    v_cvt_pk_bf16_f32 v176, v176, v177
    s_waitcnt lgkmcnt(0)
    s_barrier
    v_mfma_f32_16x16x32_bf16 v[92:95], a[92:95], v[44:47], v[92:95]
    s_add_u32 m0, s62, 65536
    ds_read_b64_tr_b16 v[32:33], v28 offset:0
    v_xor_b32 v29, 65536, v29
    v_mfma_f32_16x16x32_bf16 v[64:67], a[96:99], v[48:51], v[64:67]
    s_xor_b32 s98, s64, 2097280
    ds_read_b64_tr_b16 v[34:35], v28 offset:512
    v_cvt_pk_bf16_f32 v177, v178, v179
    v_mfma_f32_16x16x32_bf16 v[64:67], a[112:115], v[52:55], v[64:67]
    ds_read_b64_tr_b16 v[36:37], v28 offset:4096
    v_cvt_pk_bf16_f32 v178, v180, v181
    v_mfma_f32_16x16x32_bf16 v[68:71], a[100:103], v[48:51], v[68:71]
    ds_read_b64_tr_b16 v[38:39], v28 offset:4608
    v_cvt_pk_bf16_f32 v179, v182, v183
    v_mfma_f32_16x16x32_bf16 v[68:71], a[116:119], v[52:55], v[68:71]
    s_xor_b32 s79, s65, 4096
    ds_read_b64_tr_b16 v[40:41], v29 offset:0
    v_mfma_f32_16x16x32_bf16 v[72:75], a[104:107], v[48:51], v[72:75]
    ds_read_b64_tr_b16 v[42:43], v29 offset:512
    v_mfma_f32_16x16x32_bf16 v[72:75], a[120:123], v[52:55], v[72:75]
    ds_read_b64_tr_b16 v[44:45], v29 offset:4096
    v_mfma_f32_16x16x32_bf16 v[76:79], a[108:111], v[48:51], v[76:79]
    ds_read_b64_tr_b16 v[46:47], v29 offset:4608
    v_mfma_f32_16x16x32_bf16 v[76:79], a[124:127], v[52:55], v[76:79]
    buffer_load_dwordx4 v24, s[20:23], s98 offen offset:0   lds
    v_mfma_f32_16x16x32_bf16 v[80:83], a[96:99], v[56:59], v[80:83]
    ds_read_b64_tr_b16 v[48:49], v28 offset:8192
    v_mfma_f32_16x16x32_bf16 v[80:83], a[112:115], v[60:63], v[80:83]
    ds_read_b64_tr_b16 v[50:51], v28 offset:8704
    v_mfma_f32_16x16x32_bf16 v[84:87], a[100:103], v[56:59], v[84:87]
    ds_read_b64_tr_b16 v[52:53], v28 offset:12288
    v_mfma_f32_16x16x32_bf16 v[84:87], a[116:119], v[60:63], v[84:87]
    ds_read_b64_tr_b16 v[54:55], v28 offset:12800
    v_mfma_f32_16x16x32_bf16 v[88:91], a[104:107], v[56:59], v[88:91]
    buffer_load_dwordx4 v25, s[20:23], s98 offen offset:1024   lds
    v_mfma_f32_16x16x32_bf16 v[88:91], a[120:123], v[60:63], v[88:91]
    buffer_store_dword v6, v5, s[8:11], s72 offen sc0 sc1
    v_mfma_f32_16x16x32_bf16 v[92:95], a[108:111], v[56:59], v[92:95]
    buffer_store_dwordx4 v[176:179], v1, s[8:11], s79 offen offset:2048 sc0 sc1
    v_mfma_f32_16x16x32_bf16 v[92:95], a[124:127], v[60:63], v[92:95]
    s_waitcnt lgkmcnt(5)
    v_mfma_f32_16x16x32_bf16 v[96:99], a[128:131], v[32:35], v[96:99]
    ds_read_b64_tr_b16 v[56:57], v29 offset:8192
    v_cvt_pk_bf16_f32 v184, v184, v185
    v_mfma_f32_16x16x32_bf16 v[96:99], a[144:147], v[36:39], v[96:99]
    ds_read_b64_tr_b16 v[58:59], v29 offset:8704
    v_cvt_pk_bf16_f32 v185, v186, v187
    v_mfma_f32_16x16x32_bf16 v[100:103], a[132:135], v[32:35], v[100:103]
    ds_read_b64_tr_b16 v[60:61], v29 offset:12288
    v_cvt_pk_bf16_f32 v186, v188, v189
    v_mfma_f32_16x16x32_bf16 v[100:103], a[148:151], v[36:39], v[100:103]
    ds_read_b64_tr_b16 v[62:63], v29 offset:12800
    v_cvt_pk_bf16_f32 v187, v190, v191
    v_mfma_f32_16x16x32_bf16 v[104:107], a[136:139], v[32:35], v[104:107]
    buffer_load_dwordx4 v26, s[20:23], s98 offen offset:2048   lds
    v_mfma_f32_16x16x32_bf16 v[104:107], a[152:155], v[36:39], v[104:107]
    s_xor_b32 s79, s65, 4096
    v_mfma_f32_16x16x32_bf16 v[108:111], a[140:143], v[32:35], v[108:111]
    buffer_store_dwordx4 v[184:187], v1, s[8:11], s79 offen offset:3072 sc0 sc1
    v_mfma_f32_16x16x32_bf16 v[108:111], a[156:159], v[36:39], v[108:111]
    v_mfma_f32_16x16x32_bf16 v[112:115], a[128:131], v[40:43], v[112:115]
    s_waitcnt lgkmcnt(4)
    ds_read_b64_tr_b16 v[32:33], v28 offset:16384
    v_mfma_f32_16x16x32_bf16 v[112:115], a[144:147], v[44:47], v[112:115]
    ds_read_b64_tr_b16 v[34:35], v28 offset:16896
    v_mfma_f32_16x16x32_bf16 v[116:119], a[132:135], v[40:43], v[116:119]
    ds_read_b64_tr_b16 v[36:37], v28 offset:20480
    v_mfma_f32_16x16x32_bf16 v[116:119], a[148:151], v[44:47], v[116:119]
    ds_read_b64_tr_b16 v[38:39], v28 offset:20992
    v_mfma_f32_16x16x32_bf16 v[120:123], a[136:139], v[40:43], v[120:123]
    buffer_load_dwordx4 v27, s[20:23], s98 offen offset:3072   lds
    v_mfma_f32_16x16x32_bf16 v[120:123], a[152:155], v[44:47], v[120:123]
    s_add_u32 m0, s62, 69632
    s_xor_b32 s98, s64, 2359424
    v_mfma_f32_16x16x32_bf16 v[124:127], a[140:143], v[40:43], v[124:127]
    v_mfma_f32_16x16x32_bf16 v[124:127], a[156:159], v[44:47], v[124:127]
    v_mfma_f32_16x16x32_bf16 v[96:99], a[160:163], v[48:51], v[96:99]
    ds_read_b64_tr_b16 v[40:41], v29 offset:16384
    v_cvt_pk_bf16_f32 v192, v192, v193
    v_mfma_f32_16x16x32_bf16 v[96:99], a[176:179], v[52:55], v[96:99]
    ds_read_b64_tr_b16 v[42:43], v29 offset:16896
    v_cvt_pk_bf16_f32 v193, v194, v195
    v_mfma_f32_16x16x32_bf16 v[100:103], a[164:167], v[48:51], v[100:103]
    ds_read_b64_tr_b16 v[44:45], v29 offset:20480
    v_cvt_pk_bf16_f32 v194, v196, v197
    v_mfma_f32_16x16x32_bf16 v[100:103], a[180:183], v[52:55], v[100:103]
    ds_read_b64_tr_b16 v[46:47], v29 offset:20992
    v_cvt_pk_bf16_f32 v195, v198, v199
    v_mfma_f32_16x16x32_bf16 v[104:107], a[168:171], v[48:51], v[104:107]
    buffer_load_dwordx4 v24, s[20:23], s98 offen offset:0   lds
    v_mfma_f32_16x16x32_bf16 v[104:107], a[184:187], v[52:55], v[104:107]
    s_xor_b32 s79, s65, 8192
    v_mfma_f32_16x16x32_bf16 v[108:111], a[172:175], v[48:51], v[108:111]
    buffer_store_dwordx4 v[192:195], v1, s[8:11], s79 offen offset:0 sc0 sc1
    v_mfma_f32_16x16x32_bf16 v[108:111], a[188:191], v[52:55], v[108:111]
    s_waitcnt lgkmcnt(4)
    v_mfma_f32_16x16x32_bf16 v[112:115], a[160:163], v[56:59], v[112:115]
    ds_read_b64_tr_b16 v[48:49], v28 offset:24576
    v_mfma_f32_16x16x32_bf16 v[112:115], a[176:179], v[60:63], v[112:115]
    ds_read_b64_tr_b16 v[50:51], v28 offset:25088
    v_mfma_f32_16x16x32_bf16 v[116:119], a[164:167], v[56:59], v[116:119]
    ds_read_b64_tr_b16 v[52:53], v28 offset:28672
    v_mfma_f32_16x16x32_bf16 v[116:119], a[180:183], v[60:63], v[116:119]
    ds_read_b64_tr_b16 v[54:55], v28 offset:29184
    v_mfma_f32_16x16x32_bf16 v[120:123], a[168:171], v[56:59], v[120:123]
    buffer_load_dwordx4 v25, s[20:23], s98 offen offset:1024   lds
    v_mfma_f32_16x16x32_bf16 v[120:123], a[184:187], v[60:63], v[120:123]
    v_mfma_f32_16x16x32_bf16 v[124:127], a[172:175], v[56:59], v[124:127]
    v_mfma_f32_16x16x32_bf16 v[124:127], a[188:191], v[60:63], v[124:127]
    v_mfma_f32_16x16x32_bf16 v[96:99], a[192:195], v[32:35], v[96:99]
    ds_read_b64_tr_b16 v[56:57], v29 offset:24576
    v_mfma_f32_16x16x32_bf16 v[96:99], a[208:211], v[36:39], v[96:99]
    ds_read_b64_tr_b16 v[58:59], v29 offset:25088
    v_cvt_pk_bf16_f32 v200, v200, v201
    v_mfma_f32_16x16x32_bf16 v[100:103], a[196:199], v[32:35], v[100:103]
    ds_read_b64_tr_b16 v[60:61], v29 offset:28672
    v_cvt_pk_bf16_f32 v201, v202, v203
    v_mfma_f32_16x16x32_bf16 v[100:103], a[212:215], v[36:39], v[100:103]
    ds_read_b64_tr_b16 v[62:63], v29 offset:29184
    v_cvt_pk_bf16_f32 v202, v204, v205
    v_mfma_f32_16x16x32_bf16 v[104:107], a[200:203], v[32:35], v[104:107]
    buffer_load_dwordx4 v26, s[20:23], s98 offen offset:2048   lds
    v_mfma_f32_16x16x32_bf16 v[104:107], a[216:219], v[36:39], v[104:107]
    v_cvt_pk_bf16_f32 v203, v206, v207
    v_mfma_f32_16x16x32_bf16 v[108:111], a[204:207], v[32:35], v[108:111]
    v_mfma_f32_16x16x32_bf16 v[108:111], a[220:223], v[36:39], v[108:111]
    s_waitcnt lgkmcnt(4)
    s_xor_b32 s79, s65, 8192
    v_xor_b32 v30, 65536, v30
    v_mfma_f32_16x16x32_bf16 v[112:115], a[192:195], v[40:43], v[112:115]
    ds_read_b64_tr_b16 v[32:33], v30 offset:0
    v_mfma_f32_16x16x32_bf16 v[112:115], a[208:211], v[44:47], v[112:115]
    ds_read_b64_tr_b16 v[34:35], v30 offset:512
    v_mfma_f32_16x16x32_bf16 v[116:119], a[196:199], v[40:43], v[116:119]
    ds_read_b64_tr_b16 v[36:37], v30 offset:4096
    v_mfma_f32_16x16x32_bf16 v[116:119], a[212:215], v[44:47], v[116:119]
    ds_read_b64_tr_b16 v[38:39], v30 offset:4608
    v_mfma_f32_16x16x32_bf16 v[120:123], a[200:203], v[40:43], v[120:123]
    buffer_load_dwordx4 v27, s[20:23], s98 offen offset:3072   lds
    v_mfma_f32_16x16x32_bf16 v[120:123], a[216:219], v[44:47], v[120:123]
    buffer_store_dwordx4 v[200:203], v1, s[8:11], s79 offen offset:1024 sc0 sc1
    v_mfma_f32_16x16x32_bf16 v[124:127], a[204:207], v[40:43], v[124:127]
    v_mfma_f32_16x16x32_bf16 v[124:127], a[220:223], v[44:47], v[124:127]
    s_add_u32 m0, s63, 114688
    s_xor_b32 s98, s0, 1048576
    v_xor_b32 v31, 65536, v31
    v_mfma_f32_16x16x32_bf16 v[96:99], a[224:227], v[48:51], v[96:99]
    ds_read_b64_tr_b16 v[40:41], v31 offset:0
    v_mfma_f32_16x16x32_bf16 v[96:99], a[240:243], v[52:55], v[96:99]
    ds_read_b64_tr_b16 v[42:43], v31 offset:512
    v_mfma_f32_16x16x32_bf16 v[100:103], a[228:231], v[48:51], v[100:103]
    ds_read_b64_tr_b16 v[44:45], v31 offset:4096
    v_cvt_pk_bf16_f32 v208, v208, v209
    v_mfma_f32_16x16x32_bf16 v[100:103], a[244:247], v[52:55], v[100:103]
    ds_read_b64_tr_b16 v[46:47], v31 offset:4608
    v_cvt_pk_bf16_f32 v209, v210, v211
    v_mfma_f32_16x16x32_bf16 v[104:107], a[232:235], v[48:51], v[104:107]
    buffer_load_dwordx4 v20, s[24:27], s98 offen offset:0   lds
    v_mfma_f32_16x16x32_bf16 v[104:107], a[248:251], v[52:55], v[104:107]
    v_cvt_pk_bf16_f32 v210, v212, v213
    v_cvt_pk_bf16_f32 v211, v214, v215
    v_mfma_f32_16x16x32_bf16 v[108:111], a[236:239], v[48:51], v[108:111]
    v_mfma_f32_16x16x32_bf16 v[108:111], a[252:255], v[52:55], v[108:111]
    s_waitcnt lgkmcnt(4)
    v_mfma_f32_16x16x32_bf16 v[112:115], a[224:227], v[56:59], v[112:115]
    s_xor_b32 s79, s65, 8192
    ds_read_b64_tr_b16 v[48:49], v30 offset:8192
    v_mfma_f32_16x16x32_bf16 v[112:115], a[240:243], v[60:63], v[112:115]
    ds_read_b64_tr_b16 v[50:51], v30 offset:8704
    v_mfma_f32_16x16x32_bf16 v[116:119], a[228:231], v[56:59], v[116:119]
    ds_read_b64_tr_b16 v[52:53], v30 offset:12288
    v_mfma_f32_16x16x32_bf16 v[116:119], a[244:247], v[60:63], v[116:119]
    ds_read_b64_tr_b16 v[54:55], v30 offset:12800
    v_mfma_f32_16x16x32_bf16 v[120:123], a[232:235], v[56:59], v[120:123]
    buffer_load_dwordx4 v21, s[24:27], s98 offen offset:1024   lds
    v_mfma_f32_16x16x32_bf16 v[120:123], a[248:251], v[60:63], v[120:123]
    buffer_store_dwordx4 v[208:211], v1, s[8:11], s79 offen offset:2048 sc0 sc1
    v_mfma_f32_16x16x32_bf16 v[124:127], a[236:239], v[56:59], v[124:127]
    v_mfma_f32_16x16x32_bf16 v[124:127], a[252:255], v[60:63], v[124:127]
    v_mfma_f32_16x16x32_bf16 v[64:67], a[128:131], v[32:35], v[64:67]
    ds_read_b64_tr_b16 v[56:57], v31 offset:8192
    v_mfma_f32_16x16x32_bf16 v[64:67], a[144:147], v[36:39], v[64:67]
    ds_read_b64_tr_b16 v[58:59], v31 offset:8704
    v_mfma_f32_16x16x32_bf16 v[68:71], a[132:135], v[32:35], v[68:71]
    ds_read_b64_tr_b16 v[60:61], v31 offset:12288
    v_mfma_f32_16x16x32_bf16 v[68:71], a[148:151], v[36:39], v[68:71]
    ds_read_b64_tr_b16 v[62:63], v31 offset:12800
    v_mfma_f32_16x16x32_bf16 v[72:75], a[136:139], v[32:35], v[72:75]
    buffer_load_dwordx4 v22, s[24:27], s98 offen offset:2048   lds
    v_mfma_f32_16x16x32_bf16 v[72:75], a[152:155], v[36:39], v[72:75]
    v_mfma_f32_16x16x32_bf16 v[76:79], a[140:143], v[32:35], v[76:79]
    v_mfma_f32_16x16x32_bf16 v[76:79], a[156:159], v[36:39], v[76:79]
    s_waitcnt lgkmcnt(4)
    v_mfma_f32_16x16x32_bf16 v[80:83], a[128:131], v[40:43], v[80:83]
    ds_read_b64_tr_b16 v[32:33], v30 offset:16384
    v_cvt_pk_bf16_f32 v96, v96, v97
    v_mfma_f32_16x16x32_bf16 v[80:83], a[144:147], v[44:47], v[80:83]
    ds_read_b64_tr_b16 v[34:35], v30 offset:16896
    v_cvt_pk_bf16_f32 v97, v98, v99
    v_mfma_f32_16x16x32_bf16 v[84:87], a[132:135], v[40:43], v[84:87]
    ds_read_b64_tr_b16 v[36:37], v30 offset:20480
    v_cvt_pk_bf16_f32 v98, v100, v101
    v_mfma_f32_16x16x32_bf16 v[84:87], a[148:151], v[44:47], v[84:87]
    ds_read_b64_tr_b16 v[38:39], v30 offset:20992
    v_cvt_pk_bf16_f32 v99, v102, v103
    v_mfma_f32_16x16x32_bf16 v[88:91], a[136:139], v[40:43], v[88:91]
    buffer_load_dwordx4 v23, s[24:27], s98 offen offset:3072   lds
    v_mfma_f32_16x16x32_bf16 v[88:91], a[152:155], v[44:47], v[88:91]
    s_add_u32 m0, s63, 147456
    s_xor_b32 s98, s0, 1572864
    s_xor_b32 s79, s1, 32768
    v_mfma_f32_16x16x32_bf16 v[92:95], a[140:143], v[40:43], v[92:95]
    buffer_store_dwordx4 v[96:99], v1, s[8:11], s79 offen offset:0 sc0 sc1
    v_mfma_f32_16x16x32_bf16 v[92:95], a[156:159], v[44:47], v[92:95]
    v_mfma_f32_16x16x32_bf16 v[64:67], a[160:163], v[48:51], v[64:67]
    ds_read_b64_tr_b16 v[40:41], v31 offset:16384
    v_mfma_f32_16x16x32_bf16 v[64:67], a[176:179], v[52:55], v[64:67]
    ds_read_b64_tr_b16 v[42:43], v31 offset:16896
    v_mfma_f32_16x16x32_bf16 v[68:71], a[164:167], v[48:51], v[68:71]
    ds_read_b64_tr_b16 v[44:45], v31 offset:20480
    v_mfma_f32_16x16x32_bf16 v[68:71], a[180:183], v[52:55], v[68:71]
    ds_read_b64_tr_b16 v[46:47], v31 offset:20992
    v_mfma_f32_16x16x32_bf16 v[72:75], a[168:171], v[48:51], v[72:75]
    buffer_load_dwordx4 v20, s[24:27], s98 offen offset:0   lds
    v_mfma_f32_16x16x32_bf16 v[72:75], a[184:187], v[52:55], v[72:75]
    v_cvt_pk_bf16_f32 v104, v104, v105
    v_cvt_pk_bf16_f32 v105, v106, v107
    v_mfma_f32_16x16x32_bf16 v[76:79], a[172:175], v[48:51], v[76:79]
    v_cvt_pk_bf16_f32 v106, v108, v109
    v_cvt_pk_bf16_f32 v107, v110, v111
    v_mfma_f32_16x16x32_bf16 v[76:79], a[188:191], v[52:55], v[76:79]
    s_waitcnt lgkmcnt(4)
    v_mfma_f32_16x16x32_bf16 v[80:83], a[160:163], v[56:59], v[80:83]
    s_xor_b32 s79, s1, 40960
    ds_read_b64_tr_b16 v[48:49], v30 offset:24576
    v_mfma_f32_16x16x32_bf16 v[80:83], a[176:179], v[60:63], v[80:83]
    ds_read_b64_tr_b16 v[50:51], v30 offset:25088
    v_mfma_f32_16x16x32_bf16 v[84:87], a[164:167], v[56:59], v[84:87]
    ds_read_b64_tr_b16 v[52:53], v30 offset:28672
    v_mfma_f32_16x16x32_bf16 v[84:87], a[180:183], v[60:63], v[84:87]
    ds_read_b64_tr_b16 v[54:55], v30 offset:29184
    v_mfma_f32_16x16x32_bf16 v[88:91], a[168:171], v[56:59], v[88:91]
    buffer_load_dwordx4 v21, s[24:27], s98 offen offset:1024   lds
    v_mfma_f32_16x16x32_bf16 v[88:91], a[184:187], v[60:63], v[88:91]
    buffer_store_dwordx4 v[104:107], v1, s[8:11], s79 offen offset:0 sc0 sc1
    v_mfma_f32_16x16x32_bf16 v[92:95], a[172:175], v[56:59], v[92:95]
    v_mfma_f32_16x16x32_bf16 v[92:95], a[188:191], v[60:63], v[92:95]
    v_mfma_f32_16x16x32_bf16 v[64:67], a[192:195], v[32:35], v[64:67]
    ds_read_b64_tr_b16 v[56:57], v31 offset:24576
    v_mfma_f32_16x16x32_bf16 v[64:67], a[208:211], v[36:39], v[64:67]
    ds_read_b64_tr_b16 v[58:59], v31 offset:25088
    v_mfma_f32_16x16x32_bf16 v[68:71], a[196:199], v[32:35], v[68:71]
    ds_read_b64_tr_b16 v[60:61], v31 offset:28672
    v_cvt_pk_bf16_f32 v112, v112, v113
    v_mfma_f32_16x16x32_bf16 v[68:71], a[212:215], v[36:39], v[68:71]
    ds_read_b64_tr_b16 v[62:63], v31 offset:29184
    v_cvt_pk_bf16_f32 v113, v114, v115
    v_mfma_f32_16x16x32_bf16 v[72:75], a[200:203], v[32:35], v[72:75]
    buffer_load_dwordx4 v22, s[24:27], s98 offen offset:2048   lds
    v_mfma_f32_16x16x32_bf16 v[72:75], a[216:219], v[36:39], v[72:75]
    v_cvt_pk_bf16_f32 v114, v116, v117
    v_cvt_pk_bf16_f32 v115, v118, v119
    v_mfma_f32_16x16x32_bf16 v[76:79], a[204:207], v[32:35], v[76:79]
    s_waitcnt lgkmcnt(4)
    s_xor_b32 s79, s1, 32768
    v_mfma_f32_16x16x32_bf16 v[76:79], a[220:223], v[36:39], v[76:79]
    buffer_store_dwordx4 v[112:115], v1, s[8:11], s79 offen offset:1024 sc0 sc1
    v_mfma_f32_16x16x32_bf16 v[80:83], a[192:195], v[40:43], v[80:83]
    v_mfma_f32_16x16x32_bf16 v[80:83], a[208:211], v[44:47], v[80:83]
    buffer_load_dwordx4 v23, s[24:27], s98 offen offset:3072   lds
    v_mfma_f32_16x16x32_bf16 v[84:87], a[196:199], v[40:43], v[84:87]
    v_mfma_f32_16x16x32_bf16 v[84:87], a[212:215], v[44:47], v[84:87]
    v_mfma_f32_16x16x32_bf16 v[88:91], a[200:203], v[40:43], v[88:91]
    v_mfma_f32_16x16x32_bf16 v[88:91], a[216:219], v[44:47], v[88:91]
    v_mfma_f32_16x16x32_bf16 v[92:95], a[204:207], v[40:43], v[92:95]
    s_waitcnt lgkmcnt(0)
    s_barrier
    v_mfma_f32_16x16x32_bf16 v[92:95], a[220:223], v[44:47], v[92:95]
    s_add_u32 m0, s63, 0
    s_xor_b32 s98, s0, 2097152
    ds_read_b64_tr_b16 v[32:33], v28 offset:32768
    v_mfma_f32_16x16x32_bf16 v[64:67], a[224:227], v[48:51], v[64:67]
    ds_read_b64_tr_b16 v[34:35], v28 offset:33280
    v_cvt_pk_bf16_f32 v120, v120, v121
    v_mfma_f32_16x16x32_bf16 v[64:67], a[240:243], v[52:55], v[64:67]
    ds_read_b64_tr_b16 v[36:37], v28 offset:36864
    v_cvt_pk_bf16_f32 v121, v122, v123
    v_mfma_f32_16x16x32_bf16 v[68:71], a[228:231], v[48:51], v[68:71]
    ds_read_b64_tr_b16 v[38:39], v28 offset:37376
    v_cvt_pk_bf16_f32 v122, v124, v125
    v_mfma_f32_16x16x32_bf16 v[68:71], a[244:247], v[52:55], v[68:71]
    ds_read_b64_tr_b16 v[40:41], v29 offset:32768
    v_cvt_pk_bf16_f32 v123, v126, v127
    v_mfma_f32_16x16x32_bf16 v[72:75], a[232:235], v[48:51], v[72:75]
    s_xor_b32 s79, s1, 40960
    ds_read_b64_tr_b16 v[42:43], v29 offset:33280
    v_mfma_f32_16x16x32_bf16 v[72:75], a[248:251], v[52:55], v[72:75]
    ds_read_b64_tr_b16 v[44:45], v29 offset:36864
    v_mfma_f32_16x16x32_bf16 v[76:79], a[236:239], v[48:51], v[76:79]
    ds_read_b64_tr_b16 v[46:47], v29 offset:37376
    v_mfma_f32_16x16x32_bf16 v[76:79], a[252:255], v[52:55], v[76:79]
    buffer_load_dwordx4 v20, s[24:27], s98 offen offset:0   lds
    v_mfma_f32_16x16x32_bf16 v[80:83], a[224:227], v[56:59], v[80:83]
    ds_read_b64_tr_b16 v[48:49], v28 offset:40960
    v_mfma_f32_16x16x32_bf16 v[80:83], a[240:243], v[60:63], v[80:83]
    ds_read_b64_tr_b16 v[50:51], v28 offset:41472
    v_mfma_f32_16x16x32_bf16 v[84:87], a[228:231], v[56:59], v[84:87]
    ds_read_b64_tr_b16 v[52:53], v28 offset:45056
    v_mfma_f32_16x16x32_bf16 v[84:87], a[244:247], v[60:63], v[84:87]
    ds_read_b64_tr_b16 v[54:55], v28 offset:45568
    v_mfma_f32_16x16x32_bf16 v[88:91], a[232:235], v[56:59], v[88:91]
    buffer_store_dwordx4 v[120:123], v1, s[8:11], s79 offen offset:1024 sc0 sc1
    v_mfma_f32_16x16x32_bf16 v[88:91], a[248:251], v[60:63], v[88:91]
    buffer_load_dwordx4 v21, s[24:27], s98 offen offset:1024   lds
    v_mfma_f32_16x16x32_bf16 v[92:95], a[236:239], v[56:59], v[92:95]
    v_mfma_f32_16x16x32_bf16 v[92:95], a[252:255], v[60:63], v[92:95]
    s_waitcnt lgkmcnt(5)
    v_mfma_f32_16x16x32_bf16 v[96:99], a[0:3], v[32:35], 0
    ds_read_b64_tr_b16 v[56:57], v29 offset:40960
    v_mfma_f32_16x16x32_bf16 v[96:99], a[16:19], v[36:39], v[96:99]
    ds_read_b64_tr_b16 v[58:59], v29 offset:41472
    v_mfma_f32_16x16x32_bf16 v[100:103], a[4:7], v[32:35], 0
    ds_read_b64_tr_b16 v[60:61], v29 offset:45056
    v_mfma_f32_16x16x32_bf16 v[100:103], a[20:23], v[36:39], v[100:103]
    ds_read_b64_tr_b16 v[62:63], v29 offset:45568
    v_mfma_f32_16x16x32_bf16 v[104:107], a[8:11], v[32:35], 0
    buffer_load_dwordx4 v22, s[24:27], s98 offen offset:2048   lds
    v_mfma_f32_16x16x32_bf16 v[104:107], a[24:27], v[36:39], v[104:107]
    v_mfma_f32_16x16x32_bf16 v[108:111], a[12:15], v[32:35], 0
    v_mfma_f32_16x16x32_bf16 v[108:111], a[28:31], v[36:39], v[108:111]
    v_mfma_f32_16x16x32_bf16 v[112:115], a[0:3], v[40:43], 0
    s_waitcnt lgkmcnt(4)
    ds_read_b64_tr_b16 v[32:33], v28 offset:49152
    v_cvt_pk_bf16_f32 v64, v64, v65
    v_mfma_f32_16x16x32_bf16 v[112:115], a[16:19], v[44:47], v[112:115]
    ds_read_b64_tr_b16 v[34:35], v28 offset:49664
    v_cvt_pk_bf16_f32 v65, v66, v67
    v_mfma_f32_16x16x32_bf16 v[116:119], a[4:7], v[40:43], 0
    ds_read_b64_tr_b16 v[36:37], v28 offset:53248
    v_cvt_pk_bf16_f32 v66, v68, v69
    v_mfma_f32_16x16x32_bf16 v[116:119], a[20:23], v[44:47], v[116:119]
    ds_read_b64_tr_b16 v[38:39], v28 offset:53760
    v_cvt_pk_bf16_f32 v67, v70, v71
    v_mfma_f32_16x16x32_bf16 v[120:123], a[8:11], v[40:43], 0
    buffer_load_dwordx4 v23, s[24:27], s98 offen offset:3072   lds
    v_mfma_f32_16x16x32_bf16 v[120:123], a[24:27], v[44:47], v[120:123]
    s_add_u32 m0, s63, 16384
    s_xor_b32 s98, s0, 2621440
    s_xor_b32 s79, s1, 32768
    v_mfma_f32_16x16x32_bf16 v[124:127], a[12:15], v[40:43], 0
    buffer_store_dwordx4 v[64:67], v1, s[8:11], s79 offen offset:2048 sc0 sc1
    v_mfma_f32_16x16x32_bf16 v[124:127], a[28:31], v[44:47], v[124:127]
    v_mfma_f32_16x16x32_bf16 v[96:99], a[32:35], v[48:51], v[96:99]
    ds_read_b64_tr_b16 v[40:41], v29 offset:49152
    v_mfma_f32_16x16x32_bf16 v[96:99], a[48:51], v[52:55], v[96:99]
    ds_read_b64_tr_b16 v[42:43], v29 offset:49664
    v_mfma_f32_16x16x32_bf16 v[100:103], a[36:39], v[48:51], v[100:103]
    ds_read_b64_tr_b16 v[44:45], v29 offset:53248
    v_mfma_f32_16x16x32_bf16 v[100:103], a[52:55], v[52:55], v[100:103]
    ds_read_b64_tr_b16 v[46:47], v29 offset:53760
    v_mfma_f32_16x16x32_bf16 v[104:107], a[40:43], v[48:51], v[104:107]
    buffer_load_dwordx4 v20, s[24:27], s98 offen offset:0   lds
    v_mfma_f32_16x16x32_bf16 v[104:107], a[56:59], v[52:55], v[104:107]
    v_cvt_pk_bf16_f32 v72, v72, v73
    v_cvt_pk_bf16_f32 v73, v74, v75
    v_mfma_f32_16x16x32_bf16 v[108:111], a[44:47], v[48:51], v[108:111]
    v_cvt_pk_bf16_f32 v74, v76, v77
    v_cvt_pk_bf16_f32 v75, v78, v79
    v_mfma_f32_16x16x32_bf16 v[108:111], a[60:63], v[52:55], v[108:111]
    s_waitcnt lgkmcnt(4)
    v_mfma_f32_16x16x32_bf16 v[112:115], a[32:35], v[56:59], v[112:115]
    s_xor_b32 s79, s1, 40960
    ds_read_b64_tr_b16 v[48:49], v28 offset:57344
    v_mfma_f32_16x16x32_bf16 v[112:115], a[48:51], v[60:63], v[112:115]
    ds_read_b64_tr_b16 v[50:51], v28 offset:57856
    v_mfma_f32_16x16x32_bf16 v[116:119], a[36:39], v[56:59], v[116:119]
    ds_read_b64_tr_b16 v[52:53], v28 offset:61440
    v_mfma_f32_16x16x32_bf16 v[116:119], a[52:55], v[60:63], v[116:119]
    ds_read_b64_tr_b16 v[54:55], v28 offset:61952
    v_mfma_f32_16x16x32_bf16 v[120:123], a[40:43], v[56:59], v[120:123]
    buffer_load_dwordx4 v21, s[24:27], s98 offen offset:1024   lds
    v_mfma_f32_16x16x32_bf16 v[120:123], a[56:59], v[60:63], v[120:123]
    buffer_store_dwordx4 v[72:75], v1, s[8:11], s79 offen offset:2048 sc0 sc1
    v_mfma_f32_16x16x32_bf16 v[124:127], a[44:47], v[56:59], v[124:127]
    v_mfma_f32_16x16x32_bf16 v[124:127], a[60:63], v[60:63], v[124:127]
    v_mfma_f32_16x16x32_bf16 v[96:99], a[64:67], v[32:35], v[96:99]
    ds_read_b64_tr_b16 v[56:57], v29 offset:57344
    v_mfma_f32_16x16x32_bf16 v[96:99], a[80:83], v[36:39], v[96:99]
    ds_read_b64_tr_b16 v[58:59], v29 offset:57856
    v_mfma_f32_16x16x32_bf16 v[100:103], a[68:71], v[32:35], v[100:103]
    ds_read_b64_tr_b16 v[60:61], v29 offset:61440
    v_cvt_pk_bf16_f32 v80, v80, v81
    v_mfma_f32_16x16x32_bf16 v[100:103], a[84:87], v[36:39], v[100:103]
    ds_read_b64_tr_b16 v[62:63], v29 offset:61952
    v_cvt_pk_bf16_f32 v81, v82, v83
    v_mfma_f32_16x16x32_bf16 v[104:107], a[72:75], v[32:35], v[104:107]
    buffer_load_dwordx4 v22, s[24:27], s98 offen offset:2048   lds
    v_mfma_f32_16x16x32_bf16 v[104:107], a[88:91], v[36:39], v[104:107]
    v_cvt_pk_bf16_f32 v82, v84, v85
    v_cvt_pk_bf16_f32 v83, v86, v87
    v_mfma_f32_16x16x32_bf16 v[108:111], a[76:79], v[32:35], v[108:111]
    v_mfma_f32_16x16x32_bf16 v[108:111], a[92:95], v[36:39], v[108:111]
    s_waitcnt lgkmcnt(4)
    v_mfma_f32_16x16x32_bf16 v[112:115], a[64:67], v[40:43], v[112:115]
    s_xor_b32 s79, s1, 32768
    ds_read_b64_tr_b16 v[32:33], v30 offset:32768
    v_mfma_f32_16x16x32_bf16 v[112:115], a[80:83], v[44:47], v[112:115]
    ds_read_b64_tr_b16 v[34:35], v30 offset:33280
    v_mfma_f32_16x16x32_bf16 v[116:119], a[68:71], v[40:43], v[116:119]
    ds_read_b64_tr_b16 v[36:37], v30 offset:36864
    v_mfma_f32_16x16x32_bf16 v[116:119], a[84:87], v[44:47], v[116:119]
    ds_read_b64_tr_b16 v[38:39], v30 offset:37376
    v_mfma_f32_16x16x32_bf16 v[120:123], a[72:75], v[40:43], v[120:123]
    buffer_load_dwordx4 v23, s[24:27], s98 offen offset:3072   lds
    v_mfma_f32_16x16x32_bf16 v[120:123], a[88:91], v[44:47], v[120:123]
    buffer_store_dwordx4 v[80:83], v1, s[8:11], s79 offen offset:3072 sc0 sc1
    v_mfma_f32_16x16x32_bf16 v[124:127], a[76:79], v[40:43], v[124:127]
    v_mfma_f32_16x16x32_bf16 v[124:127], a[92:95], v[44:47], v[124:127]
    v_mfma_f32_16x16x32_bf16 v[96:99], a[96:99], v[48:51], v[96:99]
    ds_read_b64_tr_b16 v[40:41], v31 offset:32768
    v_cvt_pk_bf16_f32 v88, v88, v89
    v_mfma_f32_16x16x32_bf16 v[96:99], a[112:115], v[52:55], v[96:99]
    ds_read_b64_tr_b16 v[42:43], v31 offset:33280
    v_cvt_pk_bf16_f32 v89, v90, v91
    v_mfma_f32_16x16x32_bf16 v[100:103], a[100:103], v[48:51], v[100:103]
    ds_read_b64_tr_b16 v[44:45], v31 offset:36864
    v_cvt_pk_bf16_f32 v90, v92, v93
    v_mfma_f32_16x16x32_bf16 v[100:103], a[116:119], v[52:55], v[100:103]
    ds_read_b64_tr_b16 v[46:47], v31 offset:37376
    v_cvt_pk_bf16_f32 v91, v94, v95
    v_mfma_f32_16x16x32_bf16 v[104:107], a[104:107], v[48:51], v[104:107]
    s_xor_b32 s79, s1, 40960
    v_mfma_f32_16x16x32_bf16 v[104:107], a[120:123], v[52:55], v[104:107]
    buffer_store_dwordx4 v[88:91], v1, s[8:11], s79 offen offset:3072 sc0 sc1
    v_mfma_f32_16x16x32_bf16 v[108:111], a[108:111], v[48:51], v[108:111]
    v_mfma_f32_16x16x32_bf16 v[108:111], a[124:127], v[52:55], v[108:111]
    s_waitcnt lgkmcnt(4)
    v_mfma_f32_16x16x32_bf16 v[112:115], a[96:99], v[56:59], v[112:115]
    ds_read_b64_tr_b16 v[48:49], v30 offset:40960
    v_mfma_f32_16x16x32_bf16 v[112:115], a[112:115], v[60:63], v[112:115]
    ds_read_b64_tr_b16 v[50:51], v30 offset:41472
    v_mfma_f32_16x16x32_bf16 v[116:119], a[100:103], v[56:59], v[116:119]
    ds_read_b64_tr_b16 v[52:53], v30 offset:45056
    v_mfma_f32_16x16x32_bf16 v[116:119], a[116:119], v[60:63], v[116:119]
    ds_read_b64_tr_b16 v[54:55], v30 offset:45568
    v_mfma_f32_16x16x32_bf16 v[120:123], a[104:107], v[56:59], v[120:123]
    v_mfma_f32_16x16x32_bf16 v[120:123], a[120:123], v[60:63], v[120:123]
    v_mfma_f32_16x16x32_bf16 v[124:127], a[108:111], v[56:59], v[124:127]
    v_mfma_f32_16x16x32_bf16 v[124:127], a[124:127], v[60:63], v[124:127]
    v_mfma_f32_16x16x32_bf16 v[64:67], a[0:3], v[32:35], 0
    ds_read_b64_tr_b16 v[56:57], v31 offset:40960
    v_mfma_f32_16x16x32_bf16 v[64:67], a[16:19], v[36:39], v[64:67]
    ds_read_b64_tr_b16 v[58:59], v31 offset:41472
    v_mfma_f32_16x16x32_bf16 v[68:71], a[4:7], v[32:35], 0
    ds_read_b64_tr_b16 v[60:61], v31 offset:45056
    v_cvt_pk_bf16_f32 v216, v216, v217
    v_mfma_f32_16x16x32_bf16 v[68:71], a[20:23], v[36:39], v[68:71]
    ds_read_b64_tr_b16 v[62:63], v31 offset:45568
    v_cvt_pk_bf16_f32 v217, v218, v219
    v_mfma_f32_16x16x32_bf16 v[72:75], a[8:11], v[32:35], 0
    v_cvt_pk_bf16_f32 v218, v220, v221
    v_cvt_pk_bf16_f32 v219, v222, v223
    v_mfma_f32_16x16x32_bf16 v[72:75], a[24:27], v[36:39], v[72:75]
    s_xor_b32 s79, s65, 8192
    v_mfma_f32_16x16x32_bf16 v[76:79], a[12:15], v[32:35], 0
    buffer_store_dwordx4 v[216:219], v1, s[8:11], s79 offen offset:3072 sc0 sc1
    v_mfma_f32_16x16x32_bf16 v[76:79], a[28:31], v[36:39], v[76:79]
    s_waitcnt lgkmcnt(4)
    v_mfma_f32_16x16x32_bf16 v[80:83], a[0:3], v[40:43], 0
    ds_read_b64_tr_b16 v[32:33], v30 offset:49152
    v_mfma_f32_16x16x32_bf16 v[80:83], a[16:19], v[44:47], v[80:83]
    ds_read_b64_tr_b16 v[34:35], v30 offset:49664
    v_mfma_f32_16x16x32_bf16 v[84:87], a[4:7], v[40:43], 0
    ds_read_b64_tr_b16 v[36:37], v30 offset:53248
    v_mfma_f32_16x16x32_bf16 v[84:87], a[20:23], v[44:47], v[84:87]
    ds_read_b64_tr_b16 v[38:39], v30 offset:53760
    v_mfma_f32_16x16x32_bf16 v[88:91], a[8:11], v[40:43], 0
    v_mfma_f32_16x16x32_bf16 v[88:91], a[24:27], v[44:47], v[88:91]
    v_mfma_f32_16x16x32_bf16 v[92:95], a[12:15], v[40:43], 0
    v_mfma_f32_16x16x32_bf16 v[92:95], a[28:31], v[44:47], v[92:95]
    v_mfma_f32_16x16x32_bf16 v[64:67], a[32:35], v[48:51], v[64:67]
    ds_read_b64_tr_b16 v[40:41], v31 offset:49152
    v_mfma_f32_16x16x32_bf16 v[64:67], a[48:51], v[52:55], v[64:67]
    ds_read_b64_tr_b16 v[42:43], v31 offset:49664
    v_mfma_f32_16x16x32_bf16 v[68:71], a[36:39], v[48:51], v[68:71]
    ds_read_b64_tr_b16 v[44:45], v31 offset:53248
    v_mfma_f32_16x16x32_bf16 v[68:71], a[52:55], v[52:55], v[68:71]
    ds_read_b64_tr_b16 v[46:47], v31 offset:53760
    v_mfma_f32_16x16x32_bf16 v[72:75], a[40:43], v[48:51], v[72:75]
    buffer_load_dword v3, v16, s[8:11], s78 offen sc0 sc1
    v_mfma_f32_16x16x32_bf16 v[72:75], a[56:59], v[52:55], v[72:75]
    v_mfma_f32_16x16x32_bf16 v[76:79], a[44:47], v[48:51], v[76:79]
    v_mfma_f32_16x16x32_bf16 v[76:79], a[60:63], v[52:55], v[76:79]
    s_waitcnt lgkmcnt(4)
    v_mfma_f32_16x16x32_bf16 v[80:83], a[32:35], v[56:59], v[80:83]
    ds_read_b64_tr_b16 v[48:49], v30 offset:57344
    v_cvt_pk_bf16_f32 v224, v224, v225
    v_mfma_f32_16x16x32_bf16 v[80:83], a[48:51], v[60:63], v[80:83]
    ds_read_b64_tr_b16 v[50:51], v30 offset:57856
    v_cvt_pk_bf16_f32 v225, v226, v227
    v_mfma_f32_16x16x32_bf16 v[84:87], a[36:39], v[56:59], v[84:87]
    ds_read_b64_tr_b16 v[52:53], v30 offset:61440
    v_cvt_pk_bf16_f32 v226, v228, v229
    v_mfma_f32_16x16x32_bf16 v[84:87], a[52:55], v[60:63], v[84:87]
    ds_read_b64_tr_b16 v[54:55], v30 offset:61952
    v_cvt_pk_bf16_f32 v227, v230, v231
    v_mfma_f32_16x16x32_bf16 v[88:91], a[40:43], v[56:59], v[88:91]
    s_xor_b32 s79, s65, 12288
    v_mfma_f32_16x16x32_bf16 v[88:91], a[56:59], v[60:63], v[88:91]
    buffer_store_dwordx4 v[224:227], v1, s[8:11], s79 offen offset:0 sc0 sc1
    v_mfma_f32_16x16x32_bf16 v[92:95], a[44:47], v[56:59], v[92:95]
    v_mfma_f32_16x16x32_bf16 v[92:95], a[60:63], v[60:63], v[92:95]
    v_mfma_f32_16x16x32_bf16 v[64:67], a[64:67], v[32:35], v[64:67]
    ds_read_b64_tr_b16 v[56:57], v31 offset:57344
    v_mfma_f32_16x16x32_bf16 v[64:67], a[80:83], v[36:39], v[64:67]
    ds_read_b64_tr_b16 v[58:59], v31 offset:57856
    v_mfma_f32_16x16x32_bf16 v[68:71], a[68:71], v[32:35], v[68:71]
    ds_read_b64_tr_b16 v[60:61], v31 offset:61440
    v_mfma_f32_16x16x32_bf16 v[68:71], a[84:87], v[36:39], v[68:71]
    ds_read_b64_tr_b16 v[62:63], v31 offset:61952
    v_mfma_f32_16x16x32_bf16 v[72:75], a[72:75], v[32:35], v[72:75]
    v_mfma_f32_16x16x32_bf16 v[72:75], a[88:91], v[36:39], v[72:75]
    v_mfma_f32_16x16x32_bf16 v[76:79], a[76:79], v[32:35], v[76:79]
    v_mfma_f32_16x16x32_bf16 v[76:79], a[92:95], v[36:39], v[76:79]
    s_waitcnt lgkmcnt(4)
    v_mfma_f32_16x16x32_bf16 v[80:83], a[64:67], v[40:43], v[80:83]
    v_mfma_f32_16x16x32_bf16 v[80:83], a[80:83], v[44:47], v[80:83]
    v_mfma_f32_16x16x32_bf16 v[84:87], a[68:71], v[40:43], v[84:87]
    v_mfma_f32_16x16x32_bf16 v[84:87], a[84:87], v[44:47], v[84:87]
    v_mfma_f32_16x16x32_bf16 v[88:91], a[72:75], v[40:43], v[88:91]
    v_mfma_f32_16x16x32_bf16 v[88:91], a[88:91], v[44:47], v[88:91]
    v_mfma_f32_16x16x32_bf16 v[92:95], a[76:79], v[40:43], v[92:95]
    v_xor_b32 v28, 65536, v28
    v_cvt_pk_bf16_f32 v232, v232, v233
    s_waitcnt vmcnt(29) lgkmcnt(0)
    s_barrier
    v_mfma_f32_16x16x32_bf16 v[92:95], a[92:95], v[44:47], v[92:95]
    s_add_u32 m0, s63, 32768
    ds_read_b64_tr_b16 v[32:33], v28 offset:0
    v_xor_b32 v29, 65536, v29
    v_mfma_f32_16x16x32_bf16 v[64:67], a[96:99], v[48:51], v[64:67]
    s_xor_b32 s98, s0, 3145728
    ds_read_b64_tr_b16 v[34:35], v28 offset:512
    v_cvt_pk_bf16_f32 v233, v234, v235
    v_mfma_f32_16x16x32_bf16 v[64:67], a[112:115], v[52:55], v[64:67]
    ds_read_b64_tr_b16 v[36:37], v28 offset:4096
    v_cvt_pk_bf16_f32 v234, v236, v237
    v_mfma_f32_16x16x32_bf16 v[68:71], a[100:103], v[48:51], v[68:71]
    ds_read_b64_tr_b16 v[38:39], v28 offset:4608
    v_cvt_pk_bf16_f32 v235, v238, v239
    v_mfma_f32_16x16x32_bf16 v[68:71], a[116:119], v[52:55], v[68:71]
    s_xor_b32 s79, s65, 12288
    ds_read_b64_tr_b16 v[40:41], v29 offset:0
    v_mfma_f32_16x16x32_bf16 v[72:75], a[104:107], v[48:51], v[72:75]
    ds_read_b64_tr_b16 v[42:43], v29 offset:512
    v_mfma_f32_16x16x32_bf16 v[72:75], a[120:123], v[52:55], v[72:75]
    ds_read_b64_tr_b16 v[44:45], v29 offset:4096
    v_mfma_f32_16x16x32_bf16 v[76:79], a[108:111], v[48:51], v[76:79]
    ds_read_b64_tr_b16 v[46:47], v29 offset:4608
    v_mfma_f32_16x16x32_bf16 v[76:79], a[124:127], v[52:55], v[76:79]
    buffer_load_dwordx4 v20, s[24:27], s98 offen offset:0   lds
    v_mfma_f32_16x16x32_bf16 v[80:83], a[96:99], v[56:59], v[80:83]
    ds_read_b64_tr_b16 v[48:49], v28 offset:8192
    v_mfma_f32_16x16x32_bf16 v[80:83], a[112:115], v[60:63], v[80:83]
    ds_read_b64_tr_b16 v[50:51], v28 offset:8704
    v_mfma_f32_16x16x32_bf16 v[84:87], a[100:103], v[56:59], v[84:87]
    ds_read_b64_tr_b16 v[52:53], v28 offset:12288
    v_mfma_f32_16x16x32_bf16 v[84:87], a[116:119], v[60:63], v[84:87]
    ds_read_b64_tr_b16 v[54:55], v28 offset:12800
    v_mfma_f32_16x16x32_bf16 v[88:91], a[104:107], v[56:59], v[88:91]
    buffer_store_dwordx4 v[232:235], v1, s[8:11], s79 offen offset:1024 sc0 sc1
    v_mfma_f32_16x16x32_bf16 v[88:91], a[120:123], v[60:63], v[88:91]
    buffer_load_dwordx4 v21, s[24:27], s98 offen offset:1024   lds
    v_mfma_f32_16x16x32_bf16 v[92:95], a[108:111], v[56:59], v[92:95]
    v_mfma_f32_16x16x32_bf16 v[92:95], a[124:127], v[60:63], v[92:95]
    s_waitcnt lgkmcnt(5)
    v_mfma_f32_16x16x32_bf16 v[96:99], a[128:131], v[32:35], v[96:99]
    ds_read_b64_tr_b16 v[56:57], v29 offset:8192
    s_waitcnt vmcnt(4)
    v_cmp_ne_u32 vcc, 0, v3
    s_cmp_eq_u64 vcc, -1
    s_cbranch_scc0 L_H_slow_3
L_H_ok_4:
    v_mfma_f32_16x16x32_bf16 v[96:99], a[144:147], v[36:39], v[96:99]
    ds_read_b64_tr_b16 v[58:59], v29 offset:8704
    v_mfma_f32_16x16x32_bf16 v[100:103], a[132:135], v[32:35], v[100:103]
    s_xor_b32 s80, s75, 0
    ds_read_b64_tr_b16 v[60:61], v29 offset:12288
    v_mfma_f32_16x16x32_bf16 v[100:103], a[148:151], v[36:39], v[100:103]
    ds_read_b64_tr_b16 v[62:63], v29 offset:12800
    v_mfma_f32_16x16x32_bf16 v[104:107], a[136:139], v[32:35], v[104:107]
    buffer_load_dwordx4 v22, s[24:27], s98 offen offset:2048   lds
    v_mfma_f32_16x16x32_bf16 v[104:107], a[152:155], v[36:39], v[104:107]
    v_cvt_pk_bf16_f32 v240, v240, v241
    v_cvt_pk_bf16_f32 v241, v242, v243
    v_mfma_f32_16x16x32_bf16 v[108:111], a[140:143], v[32:35], v[108:111]
    v_cvt_pk_bf16_f32 v242, v244, v245
    v_cvt_pk_bf16_f32 v243, v246, v247
    v_mfma_f32_16x16x32_bf16 v[108:111], a[156:159], v[36:39], v[108:111]
    buffer_load_dwordx4 a[0:3], v1, s[8:11], s80 offen offset:0
    v_mfma_f32_16x16x32_bf16 v[112:115], a[128:131], v[40:43], v[112:115]
    s_waitcnt lgkmcnt(4)
    s_xor_b32 s79, s65, 12288
    s_xor_b32 s80, s75, 16384
    ds_read_b64_tr_b16 v[32:33], v28 offset:16384
    v_mfma_f32_16x16x32_bf16 v[112:115], a[144:147], v[44:47], v[112:115]
    ds_read_b64_tr_b16 v[34:35], v28 offset:16896
    v_mfma_f32_16x16x32_bf16 v[116:119], a[132:135], v[40:43], v[116:119]
    ds_read_b64_tr_b16 v[36:37], v28 offset:20480
    v_mfma_f32_16x16x32_bf16 v[116:119], a[148:151], v[44:47], v[116:119]
    ds_read_b64_tr_b16 v[38:39], v28 offset:20992
    v_mfma_f32_16x16x32_bf16 v[120:123], a[136:139], v[40:43], v[120:123]
    buffer_load_dwordx4 v23, s[24:27], s98 offen offset:3072   lds
    v_mfma_f32_16x16x32_bf16 v[120:123], a[152:155], v[44:47], v[120:123]
    s_add_u32 m0, s63, 49152
    s_xor_b32 s98, s0, 3670016
    v_mfma_f32_16x16x32_bf16 v[124:127], a[140:143], v[40:43], v[124:127]
    buffer_store_dwordx4 v[240:243], v1, s[8:11], s79 offen offset:2048 sc0 sc1
    v_mfma_f32_16x16x32_bf16 v[124:127], a[156:159], v[44:47], v[124:127]
    buffer_load_dwordx4 a[4:7], v1, s[8:11], s80 offen offset:0
    v_mfma_f32_16x16x32_bf16 v[96:99], a[160:163], v[48:51], v[96:99]
    s_xor_b32 s80, s76, 0
    ds_read_b64_tr_b16 v[40:41], v29 offset:16384
    v_mfma_f32_16x16x32_bf16 v[96:99], a[176:179], v[52:55], v[96:99]
    ds_read_b64_tr_b16 v[42:43], v29 offset:16896
    v_mfma_f32_16x16x32_bf16 v[100:103], a[164:167], v[48:51], v[100:103]
    ds_read_b64_tr_b16 v[44:45], v29 offset:20480
    v_mfma_f32_16x16x32_bf16 v[100:103], a[180:183], v[52:55], v[100:103]
    ds_read_b64_tr_b16 v[46:47], v29 offset:20992
    v_mfma_f32_16x16x32_bf16 v[104:107], a[168:171], v[48:51], v[104:107]
    buffer_load_dwordx4 v20, s[24:27], s98 offen offset:0   lds
    v_mfma_f32_16x16x32_bf16 v[104:107], a[184:187], v[52:55], v[104:107]
    buffer_load_dwordx4 a[8:11], v1, s[8:11], s80 offen offset:0
    v_mfma_f32_16x16x32_bf16 v[108:111], a[172:175], v[48:51], v[108:111]
    v_mfma_f32_16x16x32_bf16 v[108:111], a[188:191], v[52:55], v[108:111]
    s_waitcnt lgkmcnt(4)
    v_mfma_f32_16x16x32_bf16 v[112:115], a[160:163], v[56:59], v[112:115]
    s_xor_b32 s80, s76, 16384
    ds_read_b64_tr_b16 v[48:49], v28 offset:24576
    v_mfma_f32_16x16x32_bf16 v[112:115], a[176:179], v[60:63], v[112:115]
    ds_read_b64_tr_b16 v[50:51], v28 offset:25088
    v_mfma_f32_16x16x32_bf16 v[116:119], a[164:167], v[56:59], v[116:119]
    ds_read_b64_tr_b16 v[52:53], v28 offset:28672
    v_cvt_pk_bf16_f32 v248, v248, v249
    v_mfma_f32_16x16x32_bf16 v[116:119], a[180:183], v[60:63], v[116:119]
    ds_read_b64_tr_b16 v[54:55], v28 offset:29184
    v_cvt_pk_bf16_f32 v249, v250, v251
    v_mfma_f32_16x16x32_bf16 v[120:123], a[168:171], v[56:59], v[120:123]
    buffer_load_dwordx4 v21, s[24:27], s98 offen offset:1024   lds
    v_mfma_f32_16x16x32_bf16 v[120:123], a[184:187], v[60:63], v[120:123]
    v_cvt_pk_bf16_f32 v250, v252, v253
    v_cvt_pk_bf16_f32 v251, v254, v255
    v_mfma_f32_16x16x32_bf16 v[124:127], a[172:175], v[56:59], v[124:127]
    buffer_load_dwordx4 a[12:15], v1, s[8:11], s80 offen offset:0
    v_mfma_f32_16x16x32_bf16 v[124:127], a[188:191], v[60:63], v[124:127]
    v_mfma_f32_16x16x32_bf16 v[96:99], a[192:195], v[32:35], v[96:99]
    s_xor_b32 s79, s65, 12288
    s_xor_b32 s80, s75, 0
    ds_read_b64_tr_b16 v[56:57], v29 offset:24576
    v_mfma_f32_16x16x32_bf16 v[96:99], a[208:211], v[36:39], v[96:99]
    ds_read_b64_tr_b16 v[58:59], v29 offset:25088
    v_mfma_f32_16x16x32_bf16 v[100:103], a[196:199], v[32:35], v[100:103]
    ds_read_b64_tr_b16 v[60:61], v29 offset:28672
    v_mfma_f32_16x16x32_bf16 v[100:103], a[212:215], v[36:39], v[100:103]
    ds_read_b64_tr_b16 v[62:63], v29 offset:29184
    v_mfma_f32_16x16x32_bf16 v[104:107], a[200:203], v[32:35], v[104:107]
    buffer_load_dwordx4 v22, s[24:27], s98 offen offset:2048   lds
    v_mfma_f32_16x16x32_bf16 v[104:107], a[216:219], v[36:39], v[104:107]
    buffer_store_dwordx4 v[248:251], v1, s[8:11], s79 offen offset:3072 sc0 sc1
    v_mfma_f32_16x16x32_bf16 v[108:111], a[204:207], v[32:35], v[108:111]
    buffer_load_dwordx4 a[16:19], v1, s[8:11], s80 offen offset:1024
    v_mfma_f32_16x16x32_bf16 v[108:111], a[220:223], v[36:39], v[108:111]
    s_waitcnt lgkmcnt(4)
    s_xor_b32 s80, s75, 16384
    v_xor_b32 v30, 65536, v30
    v_mfma_f32_16x16x32_bf16 v[112:115], a[192:195], v[40:43], v[112:115]
    ds_read_b64_tr_b16 v[32:33], v30 offset:0
    v_mfma_f32_16x16x32_bf16 v[112:115], a[208:211], v[44:47], v[112:115]
    ds_read_b64_tr_b16 v[34:35], v30 offset:512
    v_mfma_f32_16x16x32_bf16 v[116:119], a[196:199], v[40:43], v[116:119]
    ds_read_b64_tr_b16 v[36:37], v30 offset:4096
    v_mfma_f32_16x16x32_bf16 v[116:119], a[212:215], v[44:47], v[116:119]
    ds_read_b64_tr_b16 v[38:39], v30 offset:4608
    v_mfma_f32_16x16x32_bf16 v[120:123], a[200:203], v[40:43], v[120:123]
    buffer_load_dwordx4 v23, s[24:27], s98 offen offset:3072   lds
    v_mfma_f32_16x16x32_bf16 v[120:123], a[216:219], v[44:47], v[120:123]
    buffer_load_dwordx4 a[20:23], v1, s[8:11], s80 offen offset:1024
    v_mfma_f32_16x16x32_bf16 v[124:127], a[204:207], v[40:43], v[124:127]
    v_mfma_f32_16x16x32_bf16 v[124:127], a[220:223], v[44:47], v[124:127]
    s_xor_b32 s80, s76, 0
    v_xor_b32 v31, 65536, v31
    v_mfma_f32_16x16x32_bf16 v[96:99], a[224:227], v[48:51], v[96:99]
    ds_read_b64_tr_b16 v[40:41], v31 offset:0
    v_mfma_f32_16x16x32_bf16 v[96:99], a[240:243], v[52:55], v[96:99]
    ds_read_b64_tr_b16 v[42:43], v31 offset:512
    v_mfma_f32_16x16x32_bf16 v[100:103], a[228:231], v[48:51], v[100:103]
    ds_read_b64_tr_b16 v[44:45], v31 offset:4096
    v_mfma_f32_16x16x32_bf16 v[100:103], a[244:247], v[52:55], v[100:103]
    ds_read_b64_tr_b16 v[46:47], v31 offset:4608
    v_mfma_f32_16x16x32_bf16 v[104:107], a[232:235], v[48:51], v[104:107]
    buffer_load_dwordx4 a[24:27], v1, s[8:11], s80 offen offset:1024
    v_mfma_f32_16x16x32_bf16 v[104:107], a[248:251], v[52:55], v[104:107]
    s_xor_b32 s80, s76, 16384
    v_mfma_f32_16x16x32_bf16 v[108:111], a[236:239], v[48:51], v[108:111]
    buffer_load_dwordx4 a[28:31], v1, s[8:11], s80 offen offset:1024
    v_mfma_f32_16x16x32_bf16 v[108:111], a[252:255], v[52:55], v[108:111]
    s_waitcnt lgkmcnt(4)
    v_mfma_f32_16x16x32_bf16 v[112:115], a[224:227], v[56:59], v[112:115]
    ds_read_b64_tr_b16 v[48:49], v30 offset:8192
    v_mfma_f32_16x16x32_bf16 v[112:115], a[240:243], v[60:63], v[112:115]
    s_xor_b32 s80, s75, 2048
    ds_read_b64_tr_b16 v[50:51], v30 offset:8704
    v_mfma_f32_16x16x32_bf16 v[116:119], a[228:231], v[56:59], v[116:119]
    ds_read_b64_tr_b16 v[52:53], v30 offset:12288
    v_mfma_f32_16x16x32_bf16 v[116:119], a[244:247], v[60:63], v[116:119]
    ds_read_b64_tr_b16 v[54:55], v30 offset:12800
    v_mfma_f32_16x16x32_bf16 v[120:123], a[232:235], v[56:59], v[120:123]
    buffer_load_dwordx4 a[32:35], v1, s[8:11], s80 offen offset:0
    v_mfma_f32_16x16x32_bf16 v[120:123], a[248:251], v[60:63], v[120:123]
    v_mfma_f32_16x16x32_bf16 v[124:127], a[236:239], v[56:59], v[124:127]
    v_mfma_f32_16x16x32_bf16 v[124:127], a[252:255], v[60:63], v[124:127]
    v_mfma_f32_16x16x32_bf16 v[64:67], a[128:131], v[32:35], v[64:67]
    s_xor_b32 s80, s75, 18432
    ds_read_b64_tr_b16 v[56:57], v31 offset:8192
    v_mfma_f32_16x16x32_bf16 v[64:67], a[144:147], v[36:39], v[64:67]
    ds_read_b64_tr_b16 v[58:59], v31 offset:8704
    v_mfma_f32_16x16x32_bf16 v[68:71], a[132:135], v[32:35], v[68:71]
    ds_read_b64_tr_b16 v[60:61], v31 offset:12288
    v_mfma_f32_16x16x32_bf16 v[68:71], a[148:151], v[36:39], v[68:71]
    ds_read_b64_tr_b16 v[62:63], v31 offset:12800
    v_mfma_f32_16x16x32_bf16 v[72:75], a[136:139], v[32:35], v[72:75]
    buffer_load_dwordx4 a[36:39], v1, s[8:11], s80 offen offset:0
    v_mfma_f32_16x16x32_bf16 v[72:75], a[152:155], v[36:39], v[72:75]
    v_mfma_f32_16x16x32_bf16 v[76:79], a[140:143], v[32:35], v[76:79]
    v_mfma_f32_16x16x32_bf16 v[76:79], a[156:159], v[36:39], v[76:79]
    s_waitcnt lgkmcnt(4)
    v_mfma_f32_16x16x32_bf16 v[80:83], a[128:131], v[40:43], v[80:83]
    s_xor_b32 s80, s76, 2048
    ds_read_b64_tr_b16 v[32:33], v30 offset:16384
    v_cvt_pk_bf16_f32 v96, v96, v97
    v_mfma_f32_16x16x32_bf16 v[80:83], a[144:147], v[44:47], v[80:83]
    ds_read_b64_tr_b16 v[34:35], v30 offset:16896
    v_cvt_pk_bf16_f32 v97, v98, v99
    v_mfma_f32_16x16x32_bf16 v[84:87], a[132:135], v[40:43], v[84:87]
    ds_read_b64_tr_b16 v[36:37], v30 offset:20480
    v_cvt_pk_bf16_f32 v98, v100, v101
    v_mfma_f32_16x16x32_bf16 v[84:87], a[148:151], v[44:47], v[84:87]
    ds_read_b64_tr_b16 v[38:39], v30 offset:20992
    v_cvt_pk_bf16_f32 v99, v102, v103
    v_mfma_f32_16x16x32_bf16 v[88:91], a[136:139], v[40:43], v[88:91]
    s_xor_b32 s79, s1, 36864
    v_mfma_f32_16x16x32_bf16 v[88:91], a[152:155], v[44:47], v[88:91]
    buffer_store_dwordx4 v[96:99], v1, s[8:11], s79 offen offset:0 sc0 sc1
    v_mfma_f32_16x16x32_bf16 v[92:95], a[140:143], v[40:43], v[92:95]
    buffer_load_dwordx4 a[40:43], v1, s[8:11], s80 offen offset:0
    v_mfma_f32_16x16x32_bf16 v[92:95], a[156:159], v[44:47], v[92:95]
    v_mfma_f32_16x16x32_bf16 v[64:67], a[160:163], v[48:51], v[64:67]
    s_xor_b32 s80, s76, 18432
    ds_read_b64_tr_b16 v[40:41], v31 offset:16384
    v_mfma_f32_16x16x32_bf16 v[64:67], a[176:179], v[52:55], v[64:67]
    ds_read_b64_tr_b16 v[42:43], v31 offset:16896
    v_mfma_f32_16x16x32_bf16 v[68:71], a[164:167], v[48:51], v[68:71]
    ds_read_b64_tr_b16 v[44:45], v31 offset:20480
    v_mfma_f32_16x16x32_bf16 v[68:71], a[180:183], v[52:55], v[68:71]
    ds_read_b64_tr_b16 v[46:47], v31 offset:20992
    v_mfma_f32_16x16x32_bf16 v[72:75], a[168:171], v[48:51], v[72:75]
    buffer_load_dwordx4 a[44:47], v1, s[8:11], s80 offen offset:0
    v_mfma_f32_16x16x32_bf16 v[72:75], a[184:187], v[52:55], v[72:75]
    s_xor_b32 s80, s75, 2048
    v_mfma_f32_16x16x32_bf16 v[76:79], a[172:175], v[48:51], v[76:79]
    buffer_load_dwordx4 a[48:51], v1, s[8:11], s80 offen offset:1024
    v_mfma_f32_16x16x32_bf16 v[76:79], a[188:191], v[52:55], v[76:79]
    s_waitcnt lgkmcnt(4)
    v_mfma_f32_16x16x32_bf16 v[80:83], a[160:163], v[56:59], v[80:83]
    ds_read_b64_tr_b16 v[48:49], v30 offset:24576
    v_cvt_pk_bf16_f32 v104, v104, v105
    v_mfma_f32_16x16x32_bf16 v[80:83], a[176:179], v[60:63], v[80:83]
    ds_read_b64_tr_b16 v[50:51], v30 offset:25088
    v_cvt_pk_bf16_f32 v105, v106, v107
    v_mfma_f32_16x16x32_bf16 v[84:87], a[164:167], v[56:59], v[84:87]
    ds_read_b64_tr_b16 v[52:53], v30 offset:28672
    v_cvt_pk_bf16_f32 v106, v108, v109
    v_mfma_f32_16x16x32_bf16 v[84:87], a[180:183], v[60:63], v[84:87]
    ds_read_b64_tr_b16 v[54:55], v30 offset:29184
    v_cvt_pk_bf16_f32 v107, v110, v111
    v_mfma_f32_16x16x32_bf16 v[88:91], a[168:171], v[56:59], v[88:91]
    s_xor_b32 s79, s1, 45056
    s_xor_b32 s80, s75, 18432
    v_mfma_f32_16x16x32_bf16 v[88:91], a[184:187], v[60:63], v[88:91]
    buffer_store_dwordx4 v[104:107], v1, s[8:11], s79 offen offset:0 sc0 sc1
    v_mfma_f32_16x16x32_bf16 v[92:95], a[172:175], v[56:59], v[92:95]
    buffer_load_dwordx4 a[52:55], v1, s[8:11], s80 offen offset:1024
    v_mfma_f32_16x16x32_bf16 v[92:95], a[188:191], v[60:63], v[92:95]
    v_mfma_f32_16x16x32_bf16 v[64:67], a[192:195], v[32:35], v[64:67]
    ds_read_b64_tr_b16 v[56:57], v31 offset:24576
    v_mfma_f32_16x16x32_bf16 v[64:67], a[208:211], v[36:39], v[64:67]
    ds_read_b64_tr_b16 v[58:59], v31 offset:25088
    v_mfma_f32_16x16x32_bf16 v[68:71], a[196:199], v[32:35], v[68:71]
    ds_read_b64_tr_b16 v[60:61], v31 offset:28672
    v_mfma_f32_16x16x32_bf16 v[68:71], a[212:215], v[36:39], v[68:71]
    s_xor_b32 s80, s76, 2048
    ds_read_b64_tr_b16 v[62:63], v31 offset:29184
    v_mfma_f32_16x16x32_bf16 v[72:75], a[200:203], v[32:35], v[72:75]
    buffer_load_dwordx4 a[56:59], v1, s[8:11], s80 offen offset:1024
    v_mfma_f32_16x16x32_bf16 v[72:75], a[216:219], v[36:39], v[72:75]
    v_mfma_f32_16x16x32_bf16 v[76:79], a[204:207], v[32:35], v[76:79]
    v_cvt_pk_bf16_f32 v112, v112, v113
    v_cvt_pk_bf16_f32 v113, v114, v115
    v_mfma_f32_16x16x32_bf16 v[76:79], a[220:223], v[36:39], v[76:79]
    s_waitcnt lgkmcnt(4)
    v_cvt_pk_bf16_f32 v114, v116, v117
    v_cvt_pk_bf16_f32 v115, v118, v119
    v_mfma_f32_16x16x32_bf16 v[80:83], a[192:195], v[40:43], v[80:83]
    s_xor_b32 s79, s1, 36864
    v_mfma_f32_16x16x32_bf16 v[80:83], a[208:211], v[44:47], v[80:83]
    buffer_store_dwordx4 v[112:115], v1, s[8:11], s79 offen offset:1024 sc0 sc1
    v_mfma_f32_16x16x32_bf16 v[84:87], a[196:199], v[40:43], v[84:87]
    s_xor_b32 s80, s76, 18432
    v_mfma_f32_16x16x32_bf16 v[84:87], a[212:215], v[44:47], v[84:87]
    buffer_load_dwordx4 a[60:63], v1, s[8:11], s80 offen offset:1024
    v_mfma_f32_16x16x32_bf16 v[88:91], a[200:203], v[40:43], v[88:91]
    v_mfma_f32_16x16x32_bf16 v[88:91], a[216:219], v[44:47], v[88:91]
    v_mfma_f32_16x16x32_bf16 v[92:95], a[204:207], v[40:43], v[92:95]
    s_waitcnt lgkmcnt(0)
    s_barrier
    v_mfma_f32_16x16x32_bf16 v[92:95], a[220:223], v[44:47], v[92:95]
    ds_read_b64_tr_b16 v[32:33], v8 offset:32768
    v_mfma_f32_16x16x32_bf16 v[64:67], a[224:227], v[48:51], v[64:67]
    ds_read_b64_tr_b16 v[34:35], v8 offset:33792
    v_mfma_f32_16x16x32_bf16 v[64:67], a[240:243], v[52:55], v[64:67]
    s_xor_b32 s80, s75, 4096
    ds_read_b64_tr_b16 v[36:37], v9 offset:32768
    v_mfma_f32_16x16x32_bf16 v[68:71], a[228:231], v[48:51], v[68:71]
    ds_read_b64_tr_b16 v[38:39], v9 offset:33792
    v_mfma_f32_16x16x32_bf16 v[68:71], a[244:247], v[52:55], v[68:71]
    ds_read_b64_tr_b16 v[40:41], v10 offset:32768
    v_mfma_f32_16x16x32_bf16 v[72:75], a[232:235], v[48:51], v[72:75]
    ds_read_b64_tr_b16 v[42:43], v10 offset:33792
    v_mfma_f32_16x16x32_bf16 v[72:75], a[248:251], v[52:55], v[72:75]
    ds_read_b64_tr_b16 v[44:45], v11 offset:32768
    v_mfma_f32_16x16x32_bf16 v[76:79], a[236:239], v[48:51], v[76:79]
    ds_read_b64_tr_b16 v[46:47], v11 offset:33792
    v_cvt_pk_bf16_f32 v120, v120, v121
    v_mfma_f32_16x16x32_bf16 v[76:79], a[252:255], v[52:55], v[76:79]
    buffer_load_dwordx4 a[64:67], v1, s[8:11], s80 offen offset:0
    v_mfma_f32_16x16x32_bf16 v[80:83], a[224:227], v[56:59], v[80:83]
    s_xor_b32 s80, s75, 20480
    ds_read_b64_tr_b16 v[48:49], v12 offset:32768
    v_cvt_pk_bf16_f32 v121, v122, v123
    v_mfma_f32_16x16x32_bf16 v[80:83], a[240:243], v[60:63], v[80:83]
    ds_read_b64_tr_b16 v[50:51], v12 offset:33792
    v_cvt_pk_bf16_f32 v122, v124, v125
    v_mfma_f32_16x16x32_bf16 v[84:87], a[228:231], v[56:59], v[84:87]
    ds_read_b64_tr_b16 v[52:53], v13 offset:32768
    v_cvt_pk_bf16_f32 v123, v126, v127
    v_mfma_f32_16x16x32_bf16 v[84:87], a[244:247], v[60:63], v[84:87]
    s_xor_b32 s79, s1, 45056
    ds_read_b64_tr_b16 v[54:55], v13 offset:33792
    v_mfma_f32_16x16x32_bf16 v[88:91], a[232:235], v[56:59], v[88:91]
    buffer_store_dwordx4 v[120:123], v1, s[8:11], s79 offen offset:1024 sc0 sc1
    v_mfma_f32_16x16x32_bf16 v[88:91], a[248:251], v[60:63], v[88:91]
    buffer_load_dwordx4 a[68:71], v1, s[8:11], s80 offen offset:0
    v_mfma_f32_16x16x32_bf16 v[92:95], a[236:239], v[56:59], v[92:95]
    v_mfma_f32_16x16x32_bf16 v[92:95], a[252:255], v[60:63], v[92:95]
    s_waitcnt vmcnt(28) lgkmcnt(5)
    v_mfma_f32_16x16x32_bf16 v[128:131], v[32:35], a[0:3], 0
    s_waitcnt vmcnt(25)
    s_xor_b32 s80, s76, 4096
    ds_read_b64_tr_b16 v[56:57], v14 offset:32768
    v_mfma_f32_16x16x32_bf16 v[160:163], v[32:35], a[4:7], 0
    s_waitcnt vmcnt(23)
    ds_read_b64_tr_b16 v[58:59], v14 offset:33792
    v_mfma_f32_16x16x32_bf16 v[192:195], v[32:35], a[8:11], 0
    s_waitcnt vmcnt(21)
    ds_read_b64_tr_b16 v[60:61], v15 offset:32768
    v_mfma_f32_16x16x32_bf16 v[224:227], v[32:35], a[12:15], 0
    ds_read_b64_tr_b16 v[62:63], v15 offset:33792
    v_mfma_f32_16x16x32_bf16 v[132:135], v[36:39], a[0:3], 0
    ds_read_b64_tr_b16 v[32:33], v8 offset:40960
    v_mfma_f32_16x16x32_bf16 v[164:167], v[36:39], a[4:7], 0
    ds_read_b64_tr_b16 v[34:35], v8 offset:41984
    v_mfma_f32_16x16x32_bf16 v[196:199], v[36:39], a[8:11], 0
    buffer_load_dwordx4 a[72:75], v1, s[8:11], s80 offen offset:0
    v_mfma_f32_16x16x32_bf16 v[228:231], v[36:39], a[12:15], 0
    v_mfma_f32_16x16x32_bf16 v[136:139], v[40:43], a[0:3], 0
    s_xor_b32 s80, s76, 20480
    ds_read_b64_tr_b16 v[36:37], v9 offset:40960
    v_cvt_pk_bf16_f32 v64, v64, v65
    v_mfma_f32_16x16x32_bf16 v[168:171], v[40:43], a[4:7], 0
    ds_read_b64_tr_b16 v[38:39], v9 offset:41984
    v_cvt_pk_bf16_f32 v65, v66, v67
    v_mfma_f32_16x16x32_bf16 v[200:203], v[40:43], a[8:11], 0
    s_waitcnt lgkmcnt(7)
    v_cvt_pk_bf16_f32 v66, v68, v69
    v_cvt_pk_bf16_f32 v67, v70, v71
    v_mfma_f32_16x16x32_bf16 v[232:235], v[40:43], a[12:15], 0
    buffer_load_dwordx4 a[76:79], v1, s[8:11], s80 offen offset:0
    v_mfma_f32_16x16x32_bf16 v[140:143], v[44:47], a[0:3], 0
    s_xor_b32 s79, s1, 36864
    ds_read_b64_tr_b16 v[40:41], v10 offset:40960
    v_mfma_f32_16x16x32_bf16 v[172:175], v[44:47], a[4:7], 0
    s_xor_b32 s80, s75, 4096
    ds_read_b64_tr_b16 v[42:43], v10 offset:41984
    v_mfma_f32_16x16x32_bf16 v[204:207], v[44:47], a[8:11], 0
    buffer_store_dwordx4 v[64:67], v1, s[8:11], s79 offen offset:2048 sc0 sc1
    v_mfma_f32_16x16x32_bf16 v[236:239], v[44:47], a[12:15], 0
    buffer_load_dwordx4 a[80:83], v1, s[8:11], s80 offen offset:1024
    v_mfma_f32_16x16x32_bf16 v[144:147], v[48:51], a[0:3], 0
    ds_read_b64_tr_b16 v[44:45], v11 offset:40960
    v_mfma_f32_16x16x32_bf16 v[176:179], v[48:51], a[4:7], 0
    ds_read_b64_tr_b16 v[46:47], v11 offset:41984
    v_mfma_f32_16x16x32_bf16 v[208:211], v[48:51], a[8:11], 0
    v_mfma_f32_16x16x32_bf16 v[240:243], v[48:51], a[12:15], 0
    v_mfma_f32_16x16x32_bf16 v[148:151], v[52:55], a[0:3], 0
    s_xor_b32 s80, s75, 20480
    ds_read_b64_tr_b16 v[48:49], v12 offset:40960
    v_mfma_f32_16x16x32_bf16 v[180:183], v[52:55], a[4:7], 0
    ds_read_b64_tr_b16 v[50:51], v12 offset:41984
    v_mfma_f32_16x16x32_bf16 v[212:215], v[52:55], a[8:11], 0
    buffer_load_dwordx4 a[84:87], v1, s[8:11], s80 offen offset:1024
    v_mfma_f32_16x16x32_bf16 v[244:247], v[52:55], a[12:15], 0
    s_waitcnt lgkmcnt(4)
    v_mfma_f32_16x16x32_bf16 v[152:155], v[56:59], a[0:3], 0
    ds_read_b64_tr_b16 v[52:53], v13 offset:40960
    v_cvt_pk_bf16_f32 v72, v72, v73
    v_mfma_f32_16x16x32_bf16 v[184:187], v[56:59], a[4:7], 0
    ds_read_b64_tr_b16 v[54:55], v13 offset:41984
    v_cvt_pk_bf16_f32 v73, v74, v75
    v_mfma_f32_16x16x32_bf16 v[216:219], v[56:59], a[8:11], 0
    v_cvt_pk_bf16_f32 v74, v76, v77
    v_cvt_pk_bf16_f32 v75, v78, v79
    v_mfma_f32_16x16x32_bf16 v[248:251], v[56:59], a[12:15], 0
    v_mfma_f32_16x16x32_bf16 v[156:159], v[60:63], a[0:3], 0
    s_xor_b32 s79, s1, 45056
    s_xor_b32 s80, s76, 4096
    ds_read_b64_tr_b16 v[56:57], v14 offset:40960
    v_mfma_f32_16x16x32_bf16 v[188:191], v[60:63], a[4:7], 0
    s_waitcnt vmcnt(23)
    ds_read_b64_tr_b16 v[58:59], v14 offset:41984
    v_mfma_f32_16x16x32_bf16 v[220:223], v[60:63], a[8:11], 0
    buffer_store_dwordx4 v[72:75], v1, s[8:11], s79 offen offset:2048 sc0 sc1
    v_mfma_f32_16x16x32_bf16 v[252:255], v[60:63], a[12:15], 0
    buffer_load_dwordx4 a[88:91], v1, s[8:11], s80 offen offset:1024
    v_mfma_f32_16x16x32_bf16 v[128:131], v[32:35], a[16:19], v[128:131]
    s_waitcnt vmcnt(23)
    ds_read_b64_tr_b16 v[60:61], v15 offset:40960
    v_mfma_f32_16x16x32_bf16 v[160:163], v[32:35], a[20:23], v[160:163]
    s_waitcnt vmcnt(22)
    ds_read_b64_tr_b16 v[62:63], v15 offset:41984
    v_mfma_f32_16x16x32_bf16 v[192:195], v[32:35], a[24:27], v[192:195]
    s_waitcnt vmcnt(21)
    v_mfma_f32_16x16x32_bf16 v[224:227], v[32:35], a[28:31], v[224:227]
    v_mfma_f32_16x16x32_bf16 v[132:135], v[36:39], a[16:19], v[132:135]
    s_xor_b32 s80, s76, 20480
    ds_read_b64_tr_b16 v[32:33], v8 offset:0
    v_mfma_f32_16x16x32_bf16 v[164:167], v[36:39], a[20:23], v[164:167]
    ds_read_b64_tr_b16 v[34:35], v8 offset:1024
    v_mfma_f32_16x16x32_bf16 v[196:199], v[36:39], a[24:27], v[196:199]
    buffer_load_dwordx4 a[92:95], v1, s[8:11], s80 offen offset:1024
    v_mfma_f32_16x16x32_bf16 v[228:231], v[36:39], a[28:31], v[228:231]
    v_mfma_f32_16x16x32_bf16 v[136:139], v[40:43], a[16:19], v[136:139]
    ds_read_b64_tr_b16 v[36:37], v9 offset:0
    v_cvt_pk_bf16_f32 v80, v80, v81
    v_mfma_f32_16x16x32_bf16 v[168:171], v[40:43], a[20:23], v[168:171]
    s_xor_b32 s80, s75, 6144
    ds_read_b64_tr_b16 v[38:39], v9 offset:1024
    v_cvt_pk_bf16_f32 v81, v82, v83
    v_mfma_f32_16x16x32_bf16 v[200:203], v[40:43], a[24:27], v[200:203]
    s_waitcnt lgkmcnt(5)
    v_cvt_pk_bf16_f32 v82, v84, v85
    v_cvt_pk_bf16_f32 v83, v86, v87
    v_mfma_f32_16x16x32_bf16 v[232:235], v[40:43], a[28:31], v[232:235]
    buffer_load_dwordx4 a[96:99], v1, s[8:11], s80 offen offset:0
    v_mfma_f32_16x16x32_bf16 v[140:143], v[44:47], a[16:19], v[140:143]
    s_xor_b32 s79, s1, 36864
    ds_read_b64_tr_b16 v[40:41], v10 offset:0
    v_mfma_f32_16x16x32_bf16 v[172:175], v[44:47], a[20:23], v[172:175]
    ds_read_b64_tr_b16 v[42:43], v10 offset:1024
    v_mfma_f32_16x16x32_bf16 v[204:207], v[44:47], a[24:27], v[204:207]
    buffer_store_dwordx4 v[80:83], v1, s[8:11], s79 offen offset:3072 sc0 sc1
    v_mfma_f32_16x16x32_bf16 v[236:239], v[44:47], a[28:31], v[236:239]
    v_mfma_f32_16x16x32_bf16 v[144:147], v[48:51], a[16:19], v[144:147]
    s_xor_b32 s80, s75, 22528
    ds_read_b64_tr_b16 v[44:45], v11 offset:0
    v_mfma_f32_16x16x32_bf16 v[176:179], v[48:51], a[20:23], v[176:179]
    ds_read_b64_tr_b16 v[46:47], v11 offset:1024
    v_mfma_f32_16x16x32_bf16 v[208:211], v[48:51], a[24:27], v[208:211]
    buffer_load_dwordx4 a[100:103], v1, s[8:11], s80 offen offset:0
    v_mfma_f32_16x16x32_bf16 v[240:243], v[48:51], a[28:31], v[240:243]
    v_mfma_f32_16x16x32_bf16 v[148:151], v[52:55], a[16:19], v[148:151]
    ds_read_b64_tr_b16 v[48:49], v12 offset:0
    v_mfma_f32_16x16x32_bf16 v[180:183], v[52:55], a[20:23], v[180:183]
    ds_read_b64_tr_b16 v[50:51], v12 offset:1024
    v_mfma_f32_16x16x32_bf16 v[212:215], v[52:55], a[24:27], v[212:215]
    v_mfma_f32_16x16x32_bf16 v[244:247], v[52:55], a[28:31], v[244:247]
    v_mfma_f32_16x16x32_bf16 v[152:155], v[56:59], a[16:19], v[152:155]
    s_xor_b32 s80, s76, 6144
    ds_read_b64_tr_b16 v[52:53], v13 offset:0
    v_cvt_pk_bf16_f32 v88, v88, v89
    v_mfma_f32_16x16x32_bf16 v[184:187], v[56:59], a[20:23], v[184:187]
    ds_read_b64_tr_b16 v[54:55], v13 offset:1024
    v_cvt_pk_bf16_f32 v89, v90, v91
    v_mfma_f32_16x16x32_bf16 v[216:219], v[56:59], a[24:27], v[216:219]
    s_waitcnt lgkmcnt(5)
    v_cvt_pk_bf16_f32 v90, v92, v93
    v_cvt_pk_bf16_f32 v91, v94, v95
    v_mfma_f32_16x16x32_bf16 v[248:251], v[56:59], a[28:31], v[248:251]
    buffer_load_dwordx4 a[104:107], v1, s[8:11], s80 offen offset:0
    v_mfma_f32_16x16x32_bf16 v[156:159], v[60:63], a[16:19], v[156:159]
    s_xor_b32 s79, s1, 45056
    ds_read_b64_tr_b16 v[56:57], v14 offset:0
    v_mfma_f32_16x16x32_bf16 v[188:191], v[60:63], a[20:23], v[188:191]
    ds_read_b64_tr_b16 v[58:59], v14 offset:1024
    v_mfma_f32_16x16x32_bf16 v[220:223], v[60:63], a[24:27], v[220:223]
    buffer_store_dwordx4 v[88:91], v1, s[8:11], s79 offen offset:3072 sc0 sc1
    v_mfma_f32_16x16x32_bf16 v[252:255], v[60:63], a[28:31], v[252:255]
    s_waitcnt vmcnt(26)
    v_mfma_f32_16x16x32_bf16 v[128:131], v[32:35], a[32:35], v[128:131]
    s_waitcnt vmcnt(25)
    s_xor_b32 s80, s76, 22528
    ds_read_b64_tr_b16 v[60:61], v15 offset:0
    v_mfma_f32_16x16x32_bf16 v[160:163], v[32:35], a[36:39], v[160:163]
    s_waitcnt vmcnt(22)
    ds_read_b64_tr_b16 v[62:63], v15 offset:1024
    v_mfma_f32_16x16x32_bf16 v[192:195], v[32:35], a[40:43], v[192:195]
    buffer_load_dwordx4 a[108:111], v1, s[8:11], s80 offen offset:0
    v_mfma_f32_16x16x32_bf16 v[224:227], v[32:35], a[44:47], v[224:227]
    v_mfma_f32_16x16x32_bf16 v[132:135], v[36:39], a[32:35], v[132:135]
    ds_read_b64_tr_b16 v[32:33], v8 offset:8192
    v_mfma_f32_16x16x32_bf16 v[164:167], v[36:39], a[36:39], v[164:167]
    s_xor_b32 s80, s75, 6144
    ds_read_b64_tr_b16 v[34:35], v8 offset:9216
    v_mfma_f32_16x16x32_bf16 v[196:199], v[36:39], a[40:43], v[196:199]
    buffer_load_dwordx4 a[112:115], v1, s[8:11], s80 offen offset:1024
    v_mfma_f32_16x16x32_bf16 v[228:231], v[36:39], a[44:47], v[228:231]
    v_mfma_f32_16x16x32_bf16 v[136:139], v[40:43], a[32:35], v[136:139]
    ds_read_b64_tr_b16 v[36:37], v9 offset:8192
    v_mfma_f32_16x16x32_bf16 v[168:171], v[40:43], a[36:39], v[168:171]
    ds_read_b64_tr_b16 v[38:39], v9 offset:9216
    v_mfma_f32_16x16x32_bf16 v[200:203], v[40:43], a[40:43], v[200:203]
    v_mfma_f32_16x16x32_bf16 v[232:235], v[40:43], a[44:47], v[232:235]
    s_waitcnt lgkmcnt(4)
    v_mfma_f32_16x16x32_bf16 v[140:143], v[44:47], a[32:35], v[140:143]
    s_xor_b32 s80, s75, 22528
    ds_read_b64_tr_b16 v[40:41], v10 offset:8192
    v_mfma_f32_16x16x32_bf16 v[172:175], v[44:47], a[36:39], v[172:175]
    ds_read_b64_tr_b16 v[42:43], v10 offset:9216
    v_mfma_f32_16x16x32_bf16 v[204:207], v[44:47], a[40:43], v[204:207]
    buffer_load_dwordx4 a[116:119], v1, s[8:11], s80 offen offset:1024
    v_mfma_f32_16x16x32_bf16 v[236:239], v[44:47], a[44:47], v[236:239]
    v_mfma_f32_16x16x32_bf16 v[144:147], v[48:51], a[32:35], v[144:147]
    ds_read_b64_tr_b16 v[44:45], v11 offset:8192
    v_mfma_f32_16x16x32_bf16 v[176:179], v[48:51], a[36:39], v[176:179]
    ds_read_b64_tr_b16 v[46:47], v11 offset:9216
    v_mfma_f32_16x16x32_bf16 v[208:211], v[48:51], a[40:43], v[208:211]
    v_mfma_f32_16x16x32_bf16 v[240:243], v[48:51], a[44:47], v[240:243]
    v_mfma_f32_16x16x32_bf16 v[148:151], v[52:55], a[32:35], v[148:151]
    s_xor_b32 s80, s76, 6144
    ds_read_b64_tr_b16 v[48:49], v12 offset:8192
    v_mfma_f32_16x16x32_bf16 v[180:183], v[52:55], a[36:39], v[180:183]
    ds_read_b64_tr_b16 v[50:51], v12 offset:9216
    v_mfma_f32_16x16x32_bf16 v[212:215], v[52:55], a[40:43], v[212:215]
    buffer_load_dwordx4 a[120:123], v1, s[8:11], s80 offen offset:1024
    v_mfma_f32_16x16x32_bf16 v[244:247], v[52:55], a[44:47], v[244:247]
    v_mfma_f32_16x16x32_bf16 v[152:155], v[56:59], a[32:35], v[152:155]
    ds_read_b64_tr_b16 v[52:53], v13 offset:8192
    v_mfma_f32_16x16x32_bf16 v[184:187], v[56:59], a[36:39], v[184:187]
    ds_read_b64_tr_b16 v[54:55], v13 offset:9216
    v_mfma_f32_16x16x32_bf16 v[216:219], v[56:59], a[40:43], v[216:219]
    v_mfma_f32_16x16x32_bf16 v[248:251], v[56:59], a[44:47], v[248:251]
    v_mfma_f32_16x16x32_bf16 v[156:159], v[60:63], a[32:35], v[156:159]
    s_xor_b32 s80, s76, 22528
    ds_read_b64_tr_b16 v[56:57], v14 offset:8192
    v_mfma_f32_16x16x32_bf16 v[188:191], v[60:63], a[36:39], v[188:191]
    ds_read_b64_tr_b16 v[58:59], v14 offset:9216
    v_mfma_f32_16x16x32_bf16 v[220:223], v[60:63], a[40:43], v[220:223]
    buffer_load_dwordx4 a[124:127], v1, s[8:11], s80 offen offset:1024
    v_mfma_f32_16x16x32_bf16 v[252:255], v[60:63], a[44:47], v[252:255]
    s_waitcnt vmcnt(26) lgkmcnt(4)
    v_mfma_f32_16x16x32_bf16 v[128:131], v[32:35], a[48:51], v[128:131]
    s_waitcnt vmcnt(24)
    ds_read_b64_tr_b16 v[60:61], v15 offset:8192
    v_mfma_f32_16x16x32_bf16 v[160:163], v[32:35], a[52:55], v[160:163]
    s_waitcnt vmcnt(21)
    s_xor_b32 s80, s75, 8192
    ds_read_b64_tr_b16 v[62:63], v15 offset:9216
    v_mfma_f32_16x16x32_bf16 v[192:195], v[32:35], a[56:59], v[192:195]
    buffer_load_dwordx4 a[128:131], v1, s[8:11], s80 offen offset:0
    v_mfma_f32_16x16x32_bf16 v[224:227], v[32:35], a[60:63], v[224:227]
    v_mfma_f32_16x16x32_bf16 v[132:135], v[36:39], a[48:51], v[132:135]
    ds_read_b64_tr_b16 v[32:33], v8 offset:16384
    v_mfma_f32_16x16x32_bf16 v[164:167], v[36:39], a[52:55], v[164:167]
    ds_read_b64_tr_b16 v[34:35], v8 offset:17408
    v_mfma_f32_16x16x32_bf16 v[196:199], v[36:39], a[56:59], v[196:199]
    v_mfma_f32_16x16x32_bf16 v[228:231], v[36:39], a[60:63], v[228:231]
    v_mfma_f32_16x16x32_bf16 v[136:139], v[40:43], a[48:51], v[136:139]
    s_xor_b32 s80, s75, 24576
    ds_read_b64_tr_b16 v[36:37], v9 offset:16384
    v_mfma_f32_16x16x32_bf16 v[168:171], v[40:43], a[52:55], v[168:171]
    ds_read_b64_tr_b16 v[38:39], v9 offset:17408
    v_mfma_f32_16x16x32_bf16 v[200:203], v[40:43], a[56:59], v[200:203]
    buffer_load_dwordx4 a[132:135], v1, s[8:11], s80 offen offset:0
    v_mfma_f32_16x16x32_bf16 v[232:235], v[40:43], a[60:63], v[232:235]
    v_mfma_f32_16x16x32_bf16 v[140:143], v[44:47], a[48:51], v[140:143]
    ds_read_b64_tr_b16 v[40:41], v10 offset:16384
    v_mfma_f32_16x16x32_bf16 v[172:175], v[44:47], a[52:55], v[172:175]
    ds_read_b64_tr_b16 v[42:43], v10 offset:17408
    v_mfma_f32_16x16x32_bf16 v[204:207], v[44:47], a[56:59], v[204:207]
    v_mfma_f32_16x16x32_bf16 v[236:239], v[44:47], a[60:63], v[236:239]
    v_mfma_f32_16x16x32_bf16 v[144:147], v[48:51], a[48:51], v[144:147]
    s_xor_b32 s80, s76, 8192
    ds_read_b64_tr_b16 v[44:45], v11 offset:16384
    v_mfma_f32_16x16x32_bf16 v[176:179], v[48:51], a[52:55], v[176:179]
    ds_read_b64_tr_b16 v[46:47], v11 offset:17408
    v_mfma_f32_16x16x32_bf16 v[208:211], v[48:51], a[56:59], v[208:211]
    buffer_load_dwordx4 a[136:139], v1, s[8:11], s80 offen offset:0
    v_mfma_f32_16x16x32_bf16 v[240:243], v[48:51], a[60:63], v[240:243]
    s_waitcnt lgkmcnt(4)
    v_mfma_f32_16x16x32_bf16 v[148:151], v[52:55], a[48:51], v[148:151]
    ds_read_b64_tr_b16 v[48:49], v12 offset:16384
    v_mfma_f32_16x16x32_bf16 v[180:183], v[52:55], a[52:55], v[180:183]
    ds_read_b64_tr_b16 v[50:51], v12 offset:17408
    v_mfma_f32_16x16x32_bf16 v[212:215], v[52:55], a[56:59], v[212:215]
    v_mfma_f32_16x16x32_bf16 v[244:247], v[52:55], a[60:63], v[244:247]
    v_mfma_f32_16x16x32_bf16 v[152:155], v[56:59], a[48:51], v[152:155]
    s_xor_b32 s80, s76, 24576
    ds_read_b64_tr_b16 v[52:53], v13 offset:16384
    v_mfma_f32_16x16x32_bf16 v[184:187], v[56:59], a[52:55], v[184:187]
    ds_read_b64_tr_b16 v[54:55], v13 offset:17408
    v_mfma_f32_16x16x32_bf16 v[216:219], v[56:59], a[56:59], v[216:219]
    buffer_load_dwordx4 a[140:143], v1, s[8:11], s80 offen offset:0
    s_waitcnt vmcnt(9)
    v_mfma_f32_16x16x32_bf16 v[248:251], v[56:59], a[60:63], v[248:251]
    buffer_store_dword v6, v5, s[8:11], s73 offen sc0 sc1
    v_mfma_f32_16x16x32_bf16 v[156:159], v[60:63], a[48:51], v[156:159]
    ds_read_b64_tr_b16 v[56:57], v14 offset:16384
    v_mfma_f32_16x16x32_bf16 v[188:191], v[60:63], a[52:55], v[188:191]
    s_xor_b32 s80, s75, 8192
    ds_read_b64_tr_b16 v[58:59], v14 offset:17408
    v_mfma_f32_16x16x32_bf16 v[220:223], v[60:63], a[56:59], v[220:223]
    buffer_load_dwordx4 a[144:147], v1, s[8:11], s80 offen offset:1024
    v_mfma_f32_16x16x32_bf16 v[252:255], v[60:63], a[60:63], v[252:255]
    v_mfma_f32_16x16x32_bf16 v[128:131], v[32:35], a[64:67], v[128:131]
    ds_read_b64_tr_b16 v[60:61], v15 offset:16384
    v_mfma_f32_16x16x32_bf16 v[160:163], v[32:35], a[68:71], v[160:163]
    ds_read_b64_tr_b16 v[62:63], v15 offset:17408
    v_mfma_f32_16x16x32_bf16 v[192:195], v[32:35], a[72:75], v[192:195]
    v_mfma_f32_16x16x32_bf16 v[224:227], v[32:35], a[76:79], v[224:227]
    v_mfma_f32_16x16x32_bf16 v[132:135], v[36:39], a[64:67], v[132:135]
    s_xor_b32 s80, s75, 24576
    ds_read_b64_tr_b16 v[32:33], v8 offset:24576
    v_mfma_f32_16x16x32_bf16 v[164:167], v[36:39], a[68:71], v[164:167]
    ds_read_b64_tr_b16 v[34:35], v8 offset:25600
    v_mfma_f32_16x16x32_bf16 v[196:199], v[36:39], a[72:75], v[196:199]
    buffer_load_dwordx4 a[148:151], v1, s[8:11], s80 offen offset:1024
    v_mfma_f32_16x16x32_bf16 v[228:231], v[36:39], a[76:79], v[228:231]
    s_waitcnt lgkmcnt(4)
    v_mfma_f32_16x16x32_bf16 v[136:139], v[40:43], a[64:67], v[136:139]
    ds_read_b64_tr_b16 v[36:37], v9 offset:24576
    v_mfma_f32_16x16x32_bf16 v[168:171], v[40:43], a[68:71], v[168:171]
    ds_read_b64_tr_b16 v[38:39], v9 offset:25600
    v_mfma_f32_16x16x32_bf16 v[200:203], v[40:43], a[72:75], v[200:203]
    v_mfma_f32_16x16x32_bf16 v[232:235], v[40:43], a[76:79], v[232:235]
    v_mfma_f32_16x16x32_bf16 v[140:143], v[44:47], a[64:67], v[140:143]
    s_xor_b32 s80, s76, 8192
    ds_read_b64_tr_b16 v[40:41], v10 offset:24576
    v_mfma_f32_16x16x32_bf16 v[172:175], v[44:47], a[68:71], v[172:175]
    ds_read_b64_tr_b16 v[42:43], v10 offset:25600
    v_mfma_f32_16x16x32_bf16 v[204:207], v[44:47], a[72:75], v[204:207]
    buffer_load_dwordx4 a[152:155], v1, s[8:11], s80 offen offset:1024
    v_mfma_f32_16x16x32_bf16 v[236:239], v[44:47], a[76:79], v[236:239]
    v_mfma_f32_16x16x32_bf16 v[144:147], v[48:51], a[64:67], v[144:147]
    ds_read_b64_tr_b16 v[44:45], v11 offset:24576
    v_mfma_f32_16x16x32_bf16 v[176:179], v[48:51], a[68:71], v[176:179]
    ds_read_b64_tr_b16 v[46:47], v11 offset:25600
    v_mfma_f32_16x16x32_bf16 v[208:211], v[48:51], a[72:75], v[208:211]
    v_mfma_f32_16x16x32_bf16 v[240:243], v[48:51], a[76:79], v[240:243]
    v_mfma_f32_16x16x32_bf16 v[148:151], v[52:55], a[64:67], v[148:151]
    s_xor_b32 s80, s76, 24576
    ds_read_b64_tr_b16 v[48:49], v12 offset:24576
    v_mfma_f32_16x16x32_bf16 v[180:183], v[52:55], a[68:71], v[180:183]
    ds_read_b64_tr_b16 v[50:51], v12 offset:25600
    v_mfma_f32_16x16x32_bf16 v[212:215], v[52:55], a[72:75], v[212:215]
    buffer_load_dwordx4 a[156:159], v1, s[8:11], s80 offen offset:1024
    v_mfma_f32_16x16x32_bf16 v[244:247], v[52:55], a[76:79], v[244:247]
    v_mfma_f32_16x16x32_bf16 v[152:155], v[56:59], a[64:67], v[152:155]
    ds_read_b64_tr_b16 v[52:53], v13 offset:24576
    v_lshlrev_b32 v116, 2, v0
    v_mfma_f32_16x16x32_bf16 v[184:187], v[56:59], a[68:71], v[184:187]
    s_xor_b32 s80, s75, 10240
    ds_read_b64_tr_b16 v[54:55], v13 offset:25600
    v_cmp_gt_u32 vcc, 8, v0
    v_mfma_f32_16x16x32_bf16 v[216:219], v[56:59], a[72:75], v[216:219]
    buffer_load_dwordx4 a[160:163], v1, s[8:11], s80 offen offset:0
    v_mfma_f32_16x16x32_bf16 v[248:251], v[56:59], a[76:79], v[248:251]
    s_waitcnt lgkmcnt(4)
    v_mov_b32 v117, 2147479552
    v_cndmask_b32 v116, v117, v116, vcc
    v_mfma_f32_16x16x32_bf16 v[156:159], v[60:63], a[64:67], v[156:159]
    s_lshl_b32 s70, s2, 5
    s_add_u32 s70, s70, 20480
    ds_read_b64_tr_b16 v[56:57], v14 offset:24576
    v_mfma_f32_16x16x32_bf16 v[188:191], v[60:63], a[68:71], v[188:191]
    ds_read_b64_tr_b16 v[58:59], v14 offset:25600
    v_and_b32 v119, 3, v2
    v_mfma_f32_16x16x32_bf16 v[220:223], v[60:63], a[72:75], v[220:223]
    v_lshlrev_b32 v119, 9, v119
    v_mfma_f32_16x16x32_bf16 v[252:255], v[60:63], a[76:79], v[252:255]
    v_mfma_f32_16x16x32_bf16 v[128:131], v[32:35], a[80:83], v[128:131]
    s_xor_b32 s80, s75, 26624
    s_lshr_b32 s69, s2, 6
    ds_read_b64_tr_b16 v[60:61], v15 offset:24576
    v_mfma_f32_16x16x32_bf16 v[160:163], v[32:35], a[84:87], v[160:163]
    s_add_u32 s69, s69, 4
    s_lshl_b32 s69, s69, 5
    ds_read_b64_tr_b16 v[62:63], v15 offset:25600
    v_mfma_f32_16x16x32_bf16 v[192:195], v[32:35], a[88:91], v[192:195]
    buffer_load_dwordx4 a[164:167], v1, s[8:11], s80 offen offset:0
    v_mfma_f32_16x16x32_bf16 v[224:227], v[32:35], a[92:95], v[224:227]
    s_bfe_u32 s68, s2, 196611
    s_add_u32 s69, s69, s68
    s_lshl_b32 s69, s69, 6
    v_mfma_f32_16x16x32_bf16 v[132:135], v[36:39], a[80:83], v[132:135]
    s_add_u32 s69, s69, 1310720
    s_and_b32 s100, s3, 1
    ds_read_b64_tr_b16 v[32:33], v8 offset:49152
    v_mfma_f32_16x16x32_bf16 v[164:167], v[36:39], a[84:87], v[164:167]
    s_lshr_b32 s101, s3, 1
    s_lshl_b32 s19, s100, 13
    ds_read_b64_tr_b16 v[34:35], v8 offset:50176
    v_mfma_f32_16x16x32_bf16 v[196:199], v[36:39], a[88:91], v[196:199]
    buffer_load_dword v118, v119, s[8:11], s69 offen sc0 sc1
    v_mfma_f32_16x16x32_bf16 v[228:231], v[36:39], a[92:95], v[228:231]
    s_add_u32 s19, s19, 65536
    v_add_u32 v18, s19, v1
    v_mfma_f32_16x16x32_bf16 v[136:139], v[40:43], a[80:83], v[136:139]
    s_xor_b32 s80, s76, 10240
    s_mul_i32 s19, s100, 12288
    ds_read_b64_tr_b16 v[36:37], v9 offset:49152
    v_mfma_f32_16x16x32_bf16 v[168:171], v[40:43], a[84:87], v[168:171]
    s_add_u32 s19, s19, 98304
    ds_read_b64_tr_b16 v[38:39], v9 offset:50176
    v_add_u32 v19, s19, v1
    v_mfma_f32_16x16x32_bf16 v[200:203], v[40:43], a[88:91], v[200:203]
    buffer_load_dwordx4 a[168:171], v1, s[8:11], s80 offen offset:0
    v_mfma_f32_16x16x32_bf16 v[232:235], v[40:43], a[92:95], v[232:235]
    v_mfma_f32_16x16x32_bf16 v[140:143], v[44:47], a[80:83], v[140:143]
    s_lshl_b32 s19, s100, 12
    s_add_u32 s19, s19, 98304
    ds_read_b64_tr_b16 v[40:41], v10 offset:49152
    v_mfma_f32_16x16x32_bf16 v[172:175], v[44:47], a[84:87], v[172:175]
    ds_read_b64_tr_b16 v[42:43], v10 offset:50176
    v_add_u32 v20, s19, v1
    v_mfma_f32_16x16x32_bf16 v[204:207], v[44:47], a[88:91], v[204:207]
    v_and_b32 v23, 15, v2
    v_lshrrev_b32 v24, 4, v2
    v_mfma_f32_16x16x32_bf16 v[236:239], v[44:47], a[92:95], v[236:239]
    s_waitcnt lgkmcnt(4)
    v_mfma_f32_16x16x32_bf16 v[144:147], v[48:51], a[80:83], v[144:147]
    s_xor_b32 s80, s76, 26624
    ds_read_b64_tr_b16 v[44:45], v11 offset:49152
    v_lshlrev_b32 v25, 2, v24
    v_mfma_f32_16x16x32_bf16 v[176:179], v[48:51], a[84:87], v[176:179]
    ds_read_b64_tr_b16 v[46:47], v11 offset:50176
    v_sub_u32 v25, v23, v25
    v_mfma_f32_16x16x32_bf16 v[208:211], v[48:51], a[88:91], v[208:211]
    buffer_load_dwordx4 a[172:175], v1, s[8:11], s80 offen offset:0
    v_mfma_f32_16x16x32_bf16 v[240:243], v[48:51], a[92:95], v[240:243]
    v_mfma_f32_16x16x32_bf16 v[148:151], v[52:55], a[80:83], v[148:151]
    s_sub_i32 s19, s101, s100
    s_lshl_b32 s19, s19, 5
    ds_read_b64_tr_b16 v[48:49], v12 offset:49152
    v_mfma_f32_16x16x32_bf16 v[180:183], v[52:55], a[84:87], v[180:183]
    s_xor_b32 s80, s75, 10240
    ds_read_b64_tr_b16 v[50:51], v12 offset:50176
    v_add_u32 v21, s19, v25
    v_mfma_f32_16x16x32_bf16 v[212:215], v[52:55], a[88:91], v[212:215]
    buffer_load_dwordx4 a[176:179], v1, s[8:11], s80 offen offset:1024
    v_mfma_f32_16x16x32_bf16 v[244:247], v[52:55], a[92:95], v[244:247]
    v_mfma_f32_16x16x32_bf16 v[152:155], v[56:59], a[80:83], v[152:155]
    s_add_u32 s19, s101, s100
    s_sub_i32 s19, 1, s19
    ds_read_b64_tr_b16 v[52:53], v13 offset:49152
    v_mfma_f32_16x16x32_bf16 v[184:187], v[56:59], a[84:87], v[184:187]
    s_lshl_b32 s19, s19, 5
    ds_read_b64_tr_b16 v[54:55], v13 offset:50176
    v_add_u32 v22, s19, v25
    v_mfma_f32_16x16x32_bf16 v[216:219], v[56:59], a[88:91], v[216:219]
    v_cvt_f32_i32 v21, v21
    v_cvt_f32_i32 v22, v22
    v_mfma_f32_16x16x32_bf16 v[248:251], v[56:59], a[92:95], v[248:251]
    v_mfma_f32_16x16x32_bf16 v[156:159], v[60:63], a[80:83], v[156:159]
    s_xor_b32 s80, s75, 26624
    ds_read_b64_tr_b16 v[56:57], v14 offset:49152
    v_add_f32 v21, 0.5, v21
    v_mfma_f32_16x16x32_bf16 v[188:191], v[60:63], a[84:87], v[188:191]
    ds_read_b64_tr_b16 v[58:59], v14 offset:50176
    v_add_f32 v22, 0.5, v22
    v_mfma_f32_16x16x32_bf16 v[220:223], v[60:63], a[88:91], v[220:223]
    buffer_load_dwordx4 a[180:183], v1, s[8:11], s80 offen offset:1024
    v_mfma_f32_16x16x32_bf16 v[252:255], v[60:63], a[92:95], v[252:255]
    v_mul_f32 v21, 0x71800000, v21
    v_mul_f32 v22, 0x71800000, v22
    v_mfma_f32_16x16x32_bf16 v[128:131], v[32:35], a[96:99], v[128:131]
    ds_read_b64_tr_b16 v[60:61], v15 offset:49152
    v_lshrrev_b32 v25, 2, v23
    v_mfma_f32_16x16x32_bf16 v[160:163], v[32:35], a[100:103], v[160:163]
    ds_read_b64_tr_b16 v[62:63], v15 offset:50176
    v_and_b32 v23, 3, v23
    v_mfma_f32_16x16x32_bf16 v[192:195], v[32:35], a[104:107], v[192:195]
    s_waitcnt vmcnt(20)
    v_lshlrev_b32 v23, 6, v23
    v_lshl_add_u32 v23, v25, 15, v23
    v_mfma_f32_16x16x32_bf16 v[224:227], v[32:35], a[108:111], v[224:227]
    s_waitcnt lgkmcnt(4)
    v_mfma_f32_16x16x32_bf16 v[132:135], v[36:39], a[96:99], v[132:135]
    s_xor_b32 s80, s76, 10240
    ds_read_b64_tr_b16 v[32:33], v8 offset:57344
    v_lshl_add_u32 v23, v24, 4, v23
    v_mfma_f32_16x16x32_bf16 v[164:167], v[36:39], a[100:103], v[164:167]
    s_lshl_b32 s18, s6, 20
    s_lshl_b32 s19, s3, 18
    ds_read_b64_tr_b16 v[34:35], v8 offset:58368
    v_mfma_f32_16x16x32_bf16 v[196:199], v[36:39], a[104:107], v[196:199]
    buffer_load_dwordx4 a[184:187], v1, s[8:11], s80 offen offset:1024
    v_mfma_f32_16x16x32_bf16 v[228:231], v[36:39], a[108:111], v[228:231]
    s_add_u32 s18, s18, s19
    s_lshl_b32 s19, s7, 10
    s_add_u32 s18, s18, s19
    v_mfma_f32_16x16x32_bf16 v[136:139], v[40:43], a[96:99], v[136:139]
    s_add_u32 s18, s18, 67108864
    s_mov_b32 s13, s60
    ds_read_b64_tr_b16 v[36:37], v9 offset:57344
    v_mfma_f32_16x16x32_bf16 v[168:171], v[40:43], a[100:103], v[168:171]
    s_mov_b32 s12, 2
    s_mov_b32 s25, 0
    ds_read_b64_tr_b16 v[38:39], v9 offset:58368
    v_mfma_f32_16x16x32_bf16 v[200:203], v[40:43], a[104:107], v[200:203]
    s_mov_b32 s26, 28
    s_mov_b32 s64, 128
    s_lshl_b32 s65, s5, 1
    v_mfma_f32_16x16x32_bf16 v[232:235], v[40:43], a[108:111], v[232:235]
    v_mfma_f32_16x16x32_bf16 v[140:143], v[44:47], a[96:99], v[140:143]
    s_xor_b32 s80, s76, 26624
    s_and_b32 s65, s65, 7
    ds_read_b64_tr_b16 v[40:41], v10 offset:57344
    v_mfma_f32_16x16x32_bf16 v[172:175], v[44:47], a[100:103], v[172:175]
    s_xor_b32 s65, s65, s3
    s_lshl_b32 s65, s65, 16
    ds_read_b64_tr_b16 v[42:43], v10 offset:58368
    v_mfma_f32_16x16x32_bf16 v[204:207], v[44:47], a[104:107], v[204:207]
    buffer_load_dwordx4 a[188:191], v1, s[8:11], s80 offen offset:1024
    v_mfma_f32_16x16x32_bf16 v[236:239], v[44:47], a[108:111], v[236:239]
    s_add_u32 s15, s62, 65536
    s_add_u32 s16, s62, 0
    s_lshl_b32 s20, s7, 13
    v_mfma_f32_16x16x32_bf16 v[144:147], v[48:51], a[96:99], v[144:147]
    s_lshl_b32 s19, s100, 11
    s_add_u32 s20, s20, s19
    ds_read_b64_tr_b16 v[44:45], v11 offset:57344
    v_mfma_f32_16x16x32_bf16 v[176:179], v[48:51], a[100:103], v[176:179]
    s_xor_b32 s80, s75, 12288
    s_add_u32 s20, s20, 50331648
    ds_read_b64_tr_b16 v[46:47], v11 offset:58368
    v_mfma_f32_16x16x32_bf16 v[208:211], v[48:51], a[104:107], v[208:211]
    buffer_load_dwordx4 a[192:195], v1, s[8:11], s80 offen offset:0
    v_mfma_f32_16x16x32_bf16 v[240:243], v[48:51], a[108:111], v[240:243]
    s_sub_u32 s19, 3, s101
    s_lshl_b32 s19, s19, 18
    s_add_u32 s21, s20, s19
    v_mfma_f32_16x16x32_bf16 v[148:151], v[52:55], a[96:99], v[148:151]
    s_lshl_b32 s19, s101, 18
    s_add_u32 s20, s20, s19
    ds_read_b64_tr_b16 v[48:49], v12 offset:57344
    v_mfma_f32_16x16x32_bf16 v[180:183], v[52:55], a[100:103], v[180:183]
    s_add_u32 s22, s72, 131072
    s_and_b32 s23, s2, 231
    ds_read_b64_tr_b16 v[50:51], v12 offset:58368
    v_mfma_f32_16x16x32_bf16 v[212:215], v[52:55], a[104:107], v[212:215]
    s_lshl_b32 s23, s23, 8
    s_sub_u32 s19, 3, s3
    s_min_u32 s19, s19, s3
    v_mfma_f32_16x16x32_bf16 v[244:247], v[52:55], a[108:111], v[244:247]
    s_waitcnt lgkmcnt(4)
    v_mfma_f32_16x16x32_bf16 v[152:155], v[56:59], a[96:99], v[152:155]
    s_xor_b32 s80, s75, 28672
    s_lshl_b32 s19, s19, 7
    ds_read_b64_tr_b16 v[52:53], v13 offset:57344
    s_waitcnt vmcnt(7)
    v_cmp_ne_u32 vcc, 0, v118
    s_cmp_eq_u64 vcc, -1
    s_cbranch_scc0 L_E2_slow_5
L_E2_ok_6:
    v_mfma_f32_16x16x32_bf16 v[184:187], v[56:59], a[100:103], v[184:187]
    s_add_u32 s23, s23, s19
    s_add_u32 s23, s23, 1179648
    ds_read_b64_tr_b16 v[54:55], v13 offset:58368
    v_mfma_f32_16x16x32_bf16 v[216:219], v[56:59], a[104:107], v[216:219]
    buffer_load_dwordx4 a[196:199], v1, s[8:11], s80 offen offset:0
    v_mfma_f32_16x16x32_bf16 v[248:251], v[56:59], a[108:111], v[248:251]
    buffer_load_dword v112, v116, s[8:11], s70 offen
    v_mfma_f32_16x16x32_bf16 v[156:159], v[60:63], a[96:99], v[156:159]
    s_add_u32 s70, s70, 12288
    s_lshl_b32 s71, s2, 2
    ds_read_b64_tr_b16 v[56:57], v14 offset:57344
    v_mfma_f32_16x16x32_bf16 v[188:191], v[60:63], a[100:103], v[188:191]
    s_add_u32 s71, s71, s3
    s_and_b32 s100, s71, 31
    ds_read_b64_tr_b16 v[58:59], v14 offset:58368
    v_mfma_f32_16x16x32_bf16 v[220:223], v[60:63], a[104:107], v[220:223]
    buffer_load_dword v113, v116, s[8:11], s70 offen
    v_mfma_f32_16x16x32_bf16 v[252:255], v[60:63], a[108:111], v[252:255]
    s_lshr_b32 s101, s71, 5
    s_sub_u32 s101, s101, 4
    s_and_b32 s101, s101, 31
    v_mfma_f32_16x16x32_bf16 v[128:131], v[32:35], a[112:115], v[128:131]
    s_xor_b32 s80, s76, 12288
    s_add_u32 s70, s70, 12288
    ds_read_b64_tr_b16 v[60:61], v15 offset:57344
    v_mfma_f32_16x16x32_bf16 v[160:163], v[32:35], a[116:119], v[160:163]
    ds_read_b64_tr_b16 v[62:63], v15 offset:58368
    v_and_b32 v121, 7, v2
    v_mfma_f32_16x16x32_bf16 v[192:195], v[32:35], a[120:123], v[192:195]
    buffer_load_dwordx4 a[200:203], v1, s[8:11], s80 offen offset:0
    v_mfma_f32_16x16x32_bf16 v[224:227], v[32:35], a[124:127], v[224:227]
    buffer_load_dword v114, v116, s[8:11], s70 offen
    v_mfma_f32_16x16x32_bf16 v[132:135], v[36:39], a[112:115], v[132:135]
    s_add_u32 s70, s70, 12288
    v_and_b32 v120, 4, v121
    v_and_b32 v122, 2, v121
    v_mfma_f32_16x16x32_bf16 v[164:167], v[36:39], a[116:119], v[164:167]
    buffer_load_dword v115, v116, s[8:11], s70 offen
    v_mfma_f32_16x16x32_bf16 v[196:199], v[36:39], a[120:123], v[196:199]
    s_add_u32 s70, s70, 12288
    v_lshl_add_u32 v120, v122, 3, v120
    v_and_b32 v122, 1, v121
    v_mfma_f32_16x16x32_bf16 v[228:231], v[36:39], a[124:127], v[228:231]
    v_lshl_add_u32 v120, v122, 1, v120
    v_mul_u32_u24 v120, 3584, v120
    v_mfma_f32_16x16x32_bf16 v[136:139], v[40:43], a[112:115], v[136:139]
    s_xor_b32 s80, s76, 28672
    v_subrev_u32 v8, 98304, v8
    v_subrev_u32 v9, 98304, v9
    s_waitcnt lgkmcnt(0)
    s_barrier
    v_mfma_f32_16x16x32_bf16 v[168:171], v[40:43], a[116:119], v[168:171]
    ds_read_b64_tr_b16 v[32:33], v8 offset:0
    v_lshrrev_b32 v122, 3, v2
    v_mfma_f32_16x16x32_bf16 v[200:203], v[40:43], a[120:123], v[200:203]
    ds_read_b64_tr_b16 v[34:35], v8 offset:1024
    v_lshl_add_u32 v120, v122, 4, v120
    v_mfma_f32_16x16x32_bf16 v[232:235], v[40:43], a[124:127], v[232:235]
    ds_read_b64_tr_b16 v[36:37], v9 offset:0
    v_subrev_u32 v10, 98304, v10
    v_mfma_f32_16x16x32_bf16 v[140:143], v[44:47], a[112:115], v[140:143]
    ds_read_b64_tr_b16 v[38:39], v9 offset:1024
    v_lshlrev_b32 v121, 13, v121
    v_mfma_f32_16x16x32_bf16 v[172:175], v[44:47], a[116:119], v[172:175]
    ds_read_b64_tr_b16 v[40:41], v10 offset:0
    v_lshl_add_u32 v121, v122, 4, v121
    v_mfma_f32_16x16x32_bf16 v[204:207], v[44:47], a[120:123], v[204:207]
    s_lshr_b32 s71, s100, 1
    s_lshl_b32 s71, s71, 2
    ds_read_b64_tr_b16 v[42:43], v10 offset:1024
    v_mfma_f32_16x16x32_bf16 v[236:239], v[44:47], a[124:127], v[236:239]
    s_and_b32 s100, s100, 1
    s_add_u32 s71, s71, s100
    v_subrev_u32 v11, 98304, v11
    v_mfma_f32_16x16x32_bf16 v[144:147], v[48:51], a[112:115], v[144:147]
    s_mul_i32 s71, s71, 28672
    s_lshl_b32 s100, s101, 7
    ds_read_b64_tr_b16 v[44:45], v11 offset:0
    v_mfma_f32_16x16x32_bf16 v[176:179], v[48:51], a[116:119], v[176:179]
    s_add_u32 s71, s71, s100
    s_cmp_lt_u32 s101, 28
    s_cselect_b32 s71, s71, 2147479552
    ds_read_b64_tr_b16 v[46:47], v11 offset:1024
    v_mfma_f32_16x16x32_bf16 v[208:211], v[48:51], a[120:123], v[208:211]
    buffer_load_dwordx4 a[204:207], v1, s[8:11], s80 offen offset:0
    v_mfma_f32_16x16x32_bf16 v[240:243], v[48:51], a[124:127], v[240:243]
    s_xor_b32 s80, s75, 12288
    v_subrev_u32 v12, 98304, v12
    v_mfma_f32_16x16x32_bf16 v[148:151], v[52:55], a[112:115], v[148:151]
    ds_read_b64_tr_b16 v[48:49], v12 offset:0
    v_mfma_f32_16x16x32_bf16 v[180:183], v[52:55], a[116:119], v[180:183]
    ds_read_b64_tr_b16 v[50:51], v12 offset:1024
    v_mfma_f32_16x16x32_bf16 v[212:215], v[52:55], a[120:123], v[212:215]
    buffer_load_dwordx4 a[208:211], v1, s[8:11], s80 offen offset:1024
    v_mfma_f32_16x16x32_bf16 v[244:247], v[52:55], a[124:127], v[244:247]
    s_xor_b32 s80, s75, 28672
    v_subrev_u32 v13, 98304, v13
    v_mfma_f32_16x16x32_bf16 v[152:155], v[56:59], a[112:115], v[152:155]
    ds_read_b64_tr_b16 v[52:53], v13 offset:0
    v_mfma_f32_16x16x32_bf16 v[184:187], v[56:59], a[116:119], v[184:187]
    ds_read_b64_tr_b16 v[54:55], v13 offset:1024
    v_mfma_f32_16x16x32_bf16 v[216:219], v[56:59], a[120:123], v[216:219]
    buffer_load_dwordx4 a[212:215], v1, s[8:11], s80 offen offset:1024
    v_mfma_f32_16x16x32_bf16 v[248:251], v[56:59], a[124:127], v[248:251]
    s_xor_b32 s80, s76, 12288
    v_subrev_u32 v14, 98304, v14
    v_mfma_f32_16x16x32_bf16 v[156:159], v[60:63], a[112:115], v[156:159]
    ds_read_b64_tr_b16 v[56:57], v14 offset:0
    v_mfma_f32_16x16x32_bf16 v[188:191], v[60:63], a[116:119], v[188:191]
    ds_read_b64_tr_b16 v[58:59], v14 offset:1024
    v_mfma_f32_16x16x32_bf16 v[220:223], v[60:63], a[120:123], v[220:223]
    buffer_load_dwordx4 a[216:219], v1, s[8:11], s80 offen offset:1024
    v_mfma_f32_16x16x32_bf16 v[252:255], v[60:63], a[124:127], v[252:255]
    s_waitcnt lgkmcnt(4)
    v_subrev_u32 v15, 98304, v15
    v_mfma_f32_16x16x32_bf16 v[128:131], v[32:35], a[128:131], v[128:131]
    ds_read_b64_tr_b16 v[60:61], v15 offset:0
    v_mfma_f32_16x16x32_bf16 v[160:163], v[32:35], a[132:135], v[160:163]
    ds_read_b64_tr_b16 v[62:63], v15 offset:1024
    v_mfma_f32_16x16x32_bf16 v[192:195], v[32:35], a[136:139], v[192:195]
    buffer_load_dword v3, v17, s[8:11], s74 offen sc0 sc1
    v_mfma_f32_16x16x32_bf16 v[224:227], v[32:35], a[140:143], v[224:227]
    v_mfma_f32_16x16x32_bf16 v[132:135], v[36:39], a[128:131], v[132:135]
    s_xor_b32 s80, s76, 28672
    ds_read_b64_tr_b16 v[32:33], v8 offset:8192
    v_mfma_f32_16x16x32_bf16 v[164:167], v[36:39], a[132:135], v[164:167]
    ds_read_b64_tr_b16 v[34:35], v8 offset:9216
    v_mfma_f32_16x16x32_bf16 v[196:199], v[36:39], a[136:139], v[196:199]
    buffer_load_dwordx4 a[220:223], v1, s[8:11], s80 offen offset:1024
    v_mfma_f32_16x16x32_bf16 v[228:231], v[36:39], a[140:143], v[228:231]
    v_mfma_f32_16x16x32_bf16 v[136:139], v[40:43], a[128:131], v[136:139]
    ds_read_b64_tr_b16 v[36:37], v9 offset:8192
    v_mfma_f32_16x16x32_bf16 v[168:171], v[40:43], a[132:135], v[168:171]
    s_xor_b32 s80, s75, 14336
    ds_read_b64_tr_b16 v[38:39], v9 offset:9216
    v_mfma_f32_16x16x32_bf16 v[200:203], v[40:43], a[136:139], v[200:203]
    buffer_load_dwordx4 a[224:227], v1, s[8:11], s80 offen offset:0
    v_mfma_f32_16x16x32_bf16 v[232:235], v[40:43], a[140:143], v[232:235]
    v_mfma_f32_16x16x32_bf16 v[140:143], v[44:47], a[128:131], v[140:143]
    ds_read_b64_tr_b16 v[40:41], v10 offset:8192
    v_mfma_f32_16x16x32_bf16 v[172:175], v[44:47], a[132:135], v[172:175]
    ds_read_b64_tr_b16 v[42:43], v10 offset:9216
    v_mfma_f32_16x16x32_bf16 v[204:207], v[44:47], a[136:139], v[204:207]
    v_mfma_f32_16x16x32_bf16 v[236:239], v[44:47], a[140:143], v[236:239]
    v_mfma_f32_16x16x32_bf16 v[144:147], v[48:51], a[128:131], v[144:147]
    s_xor_b32 s80, s75, 30720
    ds_read_b64_tr_b16 v[44:45], v11 offset:8192
    v_mfma_f32_16x16x32_bf16 v[176:179], v[48:51], a[132:135], v[176:179]
    ds_read_b64_tr_b16 v[46:47], v11 offset:9216
    v_mfma_f32_16x16x32_bf16 v[208:211], v[48:51], a[136:139], v[208:211]
    buffer_load_dwordx4 a[228:231], v1, s[8:11], s80 offen offset:0
    v_mfma_f32_16x16x32_bf16 v[240:243], v[48:51], a[140:143], v[240:243]
    s_waitcnt lgkmcnt(4)
    v_mfma_f32_16x16x32_bf16 v[148:151], v[52:55], a[128:131], v[148:151]
    ds_read_b64_tr_b16 v[48:49], v12 offset:8192
    v_mfma_f32_16x16x32_bf16 v[180:183], v[52:55], a[132:135], v[180:183]
    ds_read_b64_tr_b16 v[50:51], v12 offset:9216
    v_mfma_f32_16x16x32_bf16 v[212:215], v[52:55], a[136:139], v[212:215]
    v_mfma_f32_16x16x32_bf16 v[244:247], v[52:55], a[140:143], v[244:247]
    v_mfma_f32_16x16x32_bf16 v[152:155], v[56:59], a[128:131], v[152:155]
    s_xor_b32 s80, s76, 14336
    ds_read_b64_tr_b16 v[52:53], v13 offset:8192
    v_mfma_f32_16x16x32_bf16 v[184:187], v[56:59], a[132:135], v[184:187]
    ds_read_b64_tr_b16 v[54:55], v13 offset:9216
    v_mfma_f32_16x16x32_bf16 v[216:219], v[56:59], a[136:139], v[216:219]
    buffer_load_dwordx4 a[232:235], v1, s[8:11], s80 offen offset:0
    s_waitcnt vmcnt(4)
    v_cmp_ne_u32 vcc, 0, v3
    s_cmp_eq_u64 vcc, -1
    s_cbranch_scc0 L_KV_slow_7
L_KV_ok_8:
    v_mfma_f32_16x16x32_bf16 v[248:251], v[56:59], a[140:143], v[248:251]
    v_mfma_f32_16x16x32_bf16 v[156:159], v[60:63], a[128:131], v[156:159]
    s_add_u32 m0, s62, 65536
    s_add_u32 s98, s81, 0
    ds_read_b64_tr_b16 v[56:57], v14 offset:8192
    v_mfma_f32_16x16x32_bf16 v[188:191], v[60:63], a[132:135], v[188:191]
    ds_read_b64_tr_b16 v[58:59], v14 offset:9216
    v_add_u32 v16, s62, v1
    v_mfma_f32_16x16x32_bf16 v[220:223], v[60:63], a[136:139], v[220:223]
    buffer_load_dwordx4 v1, s[8:11], s98 offen offset:0   lds
    v_mfma_f32_16x16x32_bf16 v[252:255], v[60:63], a[140:143], v[252:255]
    v_and_b32 v17, 4294959103, v16
    v_mov_b32 v24, -1
    v_mfma_f32_16x16x32_bf16 v[128:131], v[32:35], a[144:147], v[128:131]
    s_xor_b32 s80, s76, 30720
    ds_read_b64_tr_b16 v[60:61], v15 offset:8192
    v_mov_b32 v28, 0x3f803f80
    v_mfma_f32_16x16x32_bf16 v[160:163], v[32:35], a[148:151], v[160:163]
    ds_read_b64_tr_b16 v[62:63], v15 offset:9216
    v_mov_b32 v25, -1
    v_mfma_f32_16x16x32_bf16 v[192:195], v[32:35], a[152:155], v[192:195]
    buffer_load_dwordx4 a[236:239], v1, s[8:11], s80 offen offset:0
    v_mfma_f32_16x16x32_bf16 v[224:227], v[32:35], a[156:159], v[224:227]
    buffer_load_dwordx4 v1, s[8:11], s98 offen offset:1024   lds
    v_mfma_f32_16x16x32_bf16 v[132:135], v[36:39], a[144:147], v[132:135]
    ds_read_b64_tr_b16 v[32:33], v8 offset:16384
    v_add_f32 v112, v112, v113
    v_mfma_f32_16x16x32_bf16 v[164:167], v[36:39], a[148:151], v[164:167]
    s_xor_b32 s80, s75, 14336
    ds_read_b64_tr_b16 v[34:35], v8 offset:17408
    v_add_f32 v114, v114, v115
    v_mfma_f32_16x16x32_bf16 v[196:199], v[36:39], a[152:155], v[196:199]
    buffer_load_dwordx4 a[240:243], v1, s[8:11], s80 offen offset:1024
    v_mfma_f32_16x16x32_bf16 v[228:231], v[36:39], a[156:159], v[228:231]
    s_waitcnt lgkmcnt(4)
    ds_read_b64_tr_b16 a[24:25], v8 offset:49152
    v_add_f32 v112, v112, v114
    v_mfma_f32_16x16x32_bf16 v[136:139], v[40:43], a[144:147], v[136:139]
    ds_read_b64_tr_b16 v[36:37], v9 offset:16384
    v_cvt_pk_bf16_f32 v112, v112, v112
    v_mfma_f32_16x16x32_bf16 v[168:171], v[40:43], a[148:151], v[168:171]
    ds_read_b64_tr_b16 v[38:39], v9 offset:17408
    v_and_b32 v112, 0xffff0000, v112
    v_mfma_f32_16x16x32_bf16 v[200:203], v[40:43], a[152:155], v[200:203]
    s_lshr_b32 s70, s2, 6
    s_cmp_eq_u32 s70, 2
    s_cselect_b32 s70, 1.0, 0
    ds_read_b64_tr_b16 a[26:27], v8 offset:50176
    v_mfma_f32_16x16x32_bf16 v[232:235], v[40:43], a[156:159], v[232:235]
    buffer_load_dwordx4 v1, s[8:11], s98 offen offset:2048   lds
    v_mfma_f32_16x16x32_bf16 v[140:143], v[44:47], a[144:147], v[140:143]
    s_xor_b32 s80, s75, 30720
    ds_read_b64_tr_b16 v[40:41], v10 offset:16384
    v_add_f32 v112, s70, v112
    v_mfma_f32_16x16x32_bf16 v[172:175], v[44:47], a[148:151], v[172:175]
    ds_read_b64_tr_b16 v[42:43], v10 offset:17408
    v_cvt_pk_bf16_f32 v112, v112, v112
    v_mfma_f32_16x16x32_bf16 v[204:207], v[44:47], a[152:155], v[204:207]
    ds_read_b64_tr_b16 a[28:29], v9 offset:49152
    v_and_b32 v112, 0xffff0000, v112
    v_mfma_f32_16x16x32_bf16 v[236:239], v[44:47], a[156:159], v[236:239]
    buffer_load_dwordx4 a[244:247], v1, s[8:11], s80 offen offset:1024
    v_mfma_f32_16x16x32_bf16 v[144:147], v[48:51], a[144:147], v[144:147]
    s_lshl_b32 s70, s2, 5
    s_add_u32 s70, s70, 4096
    ds_read_b64_tr_b16 v[44:45], v11 offset:16384
    v_mfma_f32_16x16x32_bf16 v[176:179], v[48:51], a[148:151], v[176:179]
    ds_read_b64_tr_b16 v[46:47], v11 offset:17408
    v_mov_b32 v29, 0x3f803f80
    v_mfma_f32_16x16x32_bf16 v[208:211], v[48:51], a[152:155], v[208:211]
    ds_read_b64_tr_b16 a[30:31], v9 offset:50176
    v_mov_b32 v26, -1
    v_mfma_f32_16x16x32_bf16 v[240:243], v[48:51], a[156:159], v[240:243]
    buffer_store_dword v112, v116, s[8:11], s70 offen sc0 sc1
    v_mfma_f32_16x16x32_bf16 v[148:151], v[52:55], a[144:147], v[148:151]
    s_xor_b32 s80, s76, 14336
    ds_read_b64_tr_b16 v[48:49], v12 offset:16384
    v_mov_b32 v30, 0x3f803f80
    v_mfma_f32_16x16x32_bf16 v[180:183], v[52:55], a[148:151], v[180:183]
    ds_read_b64_tr_b16 v[50:51], v12 offset:17408
    v_mov_b32 v27, -1
    v_mfma_f32_16x16x32_bf16 v[212:215], v[52:55], a[152:155], v[212:215]
    ds_read_b64_tr_b16 a[32:33], v10 offset:49152
    v_mov_b32 v31, 0x3f803f80
    v_mfma_f32_16x16x32_bf16 v[244:247], v[52:55], a[156:159], v[244:247]
    buffer_load_dwordx4 a[248:251], v1, s[8:11], s80 offen offset:1024
    v_mfma_f32_16x16x32_bf16 v[152:155], v[56:59], a[144:147], v[152:155]
    ds_read_b64_tr_b16 v[52:53], v13 offset:16384
    v_mov_b32 v64, 0
    v_mfma_f32_16x16x32_bf16 v[184:187], v[56:59], a[148:151], v[184:187]
    ds_read_b64_tr_b16 v[54:55], v13 offset:17408
    v_mov_b32 v65, 0
    v_mfma_f32_16x16x32_bf16 v[216:219], v[56:59], a[152:155], v[216:219]
    s_waitcnt lgkmcnt(7)
    s_xor_b32 s80, s76, 30720
    ds_read_b64_tr_b16 a[34:35], v10 offset:50176
    v_mov_b32 v66, 0
    v_mfma_f32_16x16x32_bf16 v[248:251], v[56:59], a[156:159], v[248:251]
    buffer_load_dwordx4 a[252:255], v1, s[8:11], s80 offen offset:1024
    v_mfma_f32_16x16x32_bf16 v[156:159], v[60:63], a[144:147], v[156:159]
    ds_read_b64_tr_b16 v[56:57], v14 offset:16384
    v_mov_b32 v67, 0
    v_mfma_f32_16x16x32_bf16 v[188:191], v[60:63], a[148:151], v[188:191]
    ds_read_b64_tr_b16 v[58:59], v14 offset:17408
    v_mov_b32 v68, 0
    v_mfma_f32_16x16x32_bf16 v[220:223], v[60:63], a[152:155], v[220:223]
    ds_read_b64_tr_b16 a[36:37], v11 offset:49152
    v_mov_b32 v69, 0
    v_mfma_f32_16x16x32_bf16 v[252:255], v[60:63], a[156:159], v[252:255]
    buffer_load_dwordx4 v1, s[8:11], s98 offen offset:3072   lds
    v_mfma_f32_16x16x32_bf16 v[128:131], v[32:35], a[160:163], v[128:131]
    s_add_u32 m0, s62, 69632
    s_add_u32 s98, s81, 4096
    ds_read_b64_tr_b16 v[60:61], v15 offset:16384
    v_mfma_f32_16x16x32_bf16 v[160:163], v[32:35], a[164:167], v[160:163]
    ds_read_b64_tr_b16 v[62:63], v15 offset:17408
    v_mov_b32 v70, 0
    v_mfma_f32_16x16x32_bf16 v[192:195], v[32:35], a[168:171], v[192:195]
    ds_read_b64_tr_b16 a[38:39], v11 offset:50176
    v_mov_b32 v71, 0
    v_mfma_f32_16x16x32_bf16 v[224:227], v[32:35], a[172:175], v[224:227]
    buffer_load_dwordx4 v1, s[8:11], s98 offen offset:0   lds
    v_mfma_f32_16x16x32_bf16 v[132:135], v[36:39], a[160:163], v[132:135]
    ds_read_b64_tr_b16 v[32:33], v8 offset:24576
    v_mov_b32 v72, 0
    v_mfma_f32_16x16x32_bf16 v[164:167], v[36:39], a[164:167], v[164:167]
    ds_read_b64_tr_b16 v[34:35], v8 offset:25600
    v_mov_b32 v73, 0
    v_mfma_f32_16x16x32_bf16 v[196:199], v[36:39], a[168:171], v[196:199]
    ds_read_b64_tr_b16 a[40:41], v12 offset:49152
    v_mov_b32 v74, 0
    v_mfma_f32_16x16x32_bf16 v[228:231], v[36:39], a[172:175], v[228:231]
    buffer_load_dwordx4 v1, s[8:11], s98 offen offset:1024   lds
    v_mfma_f32_16x16x32_bf16 v[136:139], v[40:43], a[160:163], v[136:139]
    ds_read_b64_tr_b16 v[36:37], v9 offset:24576
    v_mov_b32 v75, 0
    v_mfma_f32_16x16x32_bf16 v[168:171], v[40:43], a[164:167], v[168:171]
    ds_read_b64_tr_b16 v[38:39], v9 offset:25600
    v_mov_b32 v76, 0
    v_mfma_f32_16x16x32_bf16 v[200:203], v[40:43], a[168:171], v[200:203]
    s_waitcnt lgkmcnt(7)
    ds_read_b64_tr_b16 a[42:43], v12 offset:50176
    v_mov_b32 v77, 0
    v_mfma_f32_16x16x32_bf16 v[232:235], v[40:43], a[172:175], v[232:235]
    buffer_load_dwordx4 v1, s[8:11], s98 offen offset:2048   lds
    v_mfma_f32_16x16x32_bf16 v[140:143], v[44:47], a[160:163], v[140:143]
    ds_read_b64_tr_b16 v[40:41], v10 offset:24576
    v_mov_b32 v78, 0
    v_mfma_f32_16x16x32_bf16 v[172:175], v[44:47], a[164:167], v[172:175]
    ds_read_b64_tr_b16 v[42:43], v10 offset:25600
    v_mov_b32 v79, 0
    v_mfma_f32_16x16x32_bf16 v[204:207], v[44:47], a[168:171], v[204:207]
    s_cmp_eq_u32 s60, 0
    s_cselect_b32 s19, 0, 0x76800000
    ds_read_b64_tr_b16 a[44:45], v13 offset:49152
    v_add_f32 v3, s19, v21
    v_mfma_f32_16x16x32_bf16 v[236:239], v[44:47], a[172:175], v[236:239]
    buffer_load_dwordx4 v1, s[8:11], s98 offen offset:3072   lds
    v_mfma_f32_16x16x32_bf16 v[144:147], v[48:51], a[160:163], v[144:147]
    s_add_u32 m0, s62, 98304
    s_add_u32 s98, s81, 32768
    ds_read_b64_tr_b16 v[44:45], v11 offset:24576
    v_mfma_f32_16x16x32_bf16 v[176:179], v[48:51], a[164:167], v[176:179]
    ds_read_b64_tr_b16 v[46:47], v11 offset:25600
    v_add_f32 v96, 0, v3
    v_mfma_f32_16x16x32_bf16 v[208:211], v[48:51], a[168:171], v[208:211]
    ds_read_b64_tr_b16 a[46:47], v13 offset:50176
    v_min_f32 v96, v96, v64
    v_mfma_f32_16x16x32_bf16 v[240:243], v[48:51], a[172:175], v[240:243]
    buffer_load_dwordx4 v1, s[8:11], s98 offen offset:0   lds
    v_mfma_f32_16x16x32_bf16 v[148:151], v[52:55], a[160:163], v[148:151]
    ds_read_b64_tr_b16 v[48:49], v12 offset:24576
    v_add_f32 v97, 0xf1800000, v3
    v_mfma_f32_16x16x32_bf16 v[180:183], v[52:55], a[164:167], v[180:183]
    ds_read_b64_tr_b16 v[50:51], v12 offset:25600
    v_min_f32 v97, v97, v65
    v_mfma_f32_16x16x32_bf16 v[212:215], v[52:55], a[168:171], v[212:215]
    ds_read_b64_tr_b16 a[48:49], v14 offset:49152
    v_add_f32 v98, 0xf2000000, v3
    v_mfma_f32_16x16x32_bf16 v[244:247], v[52:55], a[172:175], v[244:247]
    buffer_load_dwordx4 v1, s[8:11], s98 offen offset:1024   lds
    v_mfma_f32_16x16x32_bf16 v[152:155], v[56:59], a[160:163], v[152:155]
    ds_read_b64_tr_b16 v[52:53], v13 offset:24576
    v_min_f32 v98, v98, v66
    v_mfma_f32_16x16x32_bf16 v[184:187], v[56:59], a[164:167], v[184:187]
    ds_read_b64_tr_b16 v[54:55], v13 offset:25600
    v_add_f32 v99, 0xf2400000, v3
    v_mfma_f32_16x16x32_bf16 v[216:219], v[56:59], a[168:171], v[216:219]
    s_waitcnt lgkmcnt(7)
    ds_read_b64_tr_b16 a[50:51], v14 offset:50176
    v_min_f32 v99, v99, v67
    v_mfma_f32_16x16x32_bf16 v[248:251], v[56:59], a[172:175], v[248:251]
    buffer_load_dwordx4 v1, s[8:11], s98 offen offset:2048   lds
    v_mfma_f32_16x16x32_bf16 v[156:159], v[60:63], a[160:163], v[156:159]
    ds_read_b64_tr_b16 v[56:57], v14 offset:24576
    v_add_f32 v100, 0xf3800000, v3
    v_mfma_f32_16x16x32_bf16 v[188:191], v[60:63], a[164:167], v[188:191]
    ds_read_b64_tr_b16 v[58:59], v14 offset:25600
    v_min_f32 v100, v100, v64
    v_mfma_f32_16x16x32_bf16 v[220:223], v[60:63], a[168:171], v[220:223]
    ds_read_b64_tr_b16 a[52:53], v15 offset:49152
    v_add_f32 v101, 0xf3880000, v3
    v_mfma_f32_16x16x32_bf16 v[252:255], v[60:63], a[172:175], v[252:255]
    buffer_load_dwordx4 v1, s[8:11], s98 offen offset:3072   lds
    v_mfma_f32_16x16x32_bf16 v[128:131], v[32:35], a[176:179], v[128:131]
    s_add_u32 m0, s62, 102400
    s_add_u32 s98, s81, 36864
    ds_read_b64_tr_b16 v[60:61], v15 offset:24576
    v_mfma_f32_16x16x32_bf16 v[160:163], v[32:35], a[180:183], v[160:163]
    ds_read_b64_tr_b16 v[62:63], v15 offset:25600
    v_min_f32 v101, v101, v65
    v_mfma_f32_16x16x32_bf16 v[192:195], v[32:35], a[184:187], v[192:195]
    ds_read_b64_tr_b16 a[54:55], v15 offset:50176
    v_add_f32 v102, 0xf3900000, v3
    v_mfma_f32_16x16x32_bf16 v[224:227], v[32:35], a[188:191], v[224:227]
    buffer_load_dwordx4 v1, s[8:11], s98 offen offset:0   lds
    v_mfma_f32_16x16x32_bf16 v[132:135], v[36:39], a[176:179], v[132:135]
    ds_read_b64_tr_b16 v[32:33], v8 offset:32768
    v_min_f32 v102, v102, v66
    v_mfma_f32_16x16x32_bf16 v[164:167], v[36:39], a[180:183], v[164:167]
    ds_read_b64_tr_b16 v[34:35], v8 offset:33792
    v_add_f32 v103, 0xf3980000, v3
    v_mfma_f32_16x16x32_bf16 v[196:199], v[36:39], a[184:187], v[196:199]
    ds_read_b64_tr_b16 a[64:65], v8 offset:57344
    v_min_f32 v103, v103, v67
    v_mfma_f32_16x16x32_bf16 v[228:231], v[36:39], a[188:191], v[228:231]
    buffer_load_dwordx4 v1, s[8:11], s98 offen offset:1024   lds
    v_mfma_f32_16x16x32_bf16 v[136:139], v[40:43], a[176:179], v[136:139]
    ds_read_b64_tr_b16 v[36:37], v9 offset:32768
    v_add_f32 v104, 0x73800000, v3
    v_mfma_f32_16x16x32_bf16 v[168:171], v[40:43], a[180:183], v[168:171]
    ds_read_b64_tr_b16 v[38:39], v9 offset:33792
    v_min_f32 v104, v104, v68
    v_mfma_f32_16x16x32_bf16 v[200:203], v[40:43], a[184:187], v[200:203]
    s_waitcnt lgkmcnt(7)
    ds_read_b64_tr_b16 a[66:67], v8 offset:58368
    v_add_f32 v105, 0x73700000, v3
    v_mfma_f32_16x16x32_bf16 v[232:235], v[40:43], a[188:191], v[232:235]
    buffer_load_dwordx4 v1, s[8:11], s98 offen offset:2048   lds
    v_mfma_f32_16x16x32_bf16 v[140:143], v[44:47], a[176:179], v[140:143]
    ds_read_b64_tr_b16 v[40:41], v10 offset:32768
    v_min_f32 v105, v105, v69
    v_mfma_f32_16x16x32_bf16 v[172:175], v[44:47], a[180:183], v[172:175]
    ds_read_b64_tr_b16 v[42:43], v10 offset:33792
    v_add_f32 v106, 0x73600000, v3
    v_mfma_f32_16x16x32_bf16 v[204:207], v[44:47], a[184:187], v[204:207]
    ds_read_b64_tr_b16 a[68:69], v9 offset:57344
    v_min_f32 v106, v106, v70
    v_mfma_f32_16x16x32_bf16 v[236:239], v[44:47], a[188:191], v[236:239]
    buffer_load_dwordx4 v1, s[8:11], s98 offen offset:3072   lds
    v_mfma_f32_16x16x32_bf16 v[144:147], v[48:51], a[176:179], v[144:147]
    s_add_u32 m0, s62, 131072
    s_add_u32 s98, s82, 0
    ds_read_b64_tr_b16 v[44:45], v11 offset:32768
    v_mfma_f32_16x16x32_bf16 v[176:179], v[48:51], a[180:183], v[176:179]
    ds_read_b64_tr_b16 v[46:47], v11 offset:33792
    v_add_f32 v107, 0x73500000, v3
    v_mfma_f32_16x16x32_bf16 v[208:211], v[48:51], a[184:187], v[208:211]
    ds_read_b64_tr_b16 a[70:71], v9 offset:58368
    v_min_f32 v107, v107, v71
    v_mfma_f32_16x16x32_bf16 v[240:243], v[48:51], a[188:191], v[240:243]
    buffer_load_dwordx4 v1, s[8:11], s98 offen offset:0   lds
    v_mfma_f32_16x16x32_bf16 v[148:151], v[52:55], a[176:179], v[148:151]
    ds_read_b64_tr_b16 v[48:49], v12 offset:32768
    v_add_f32 v108, 0, v3
    v_mfma_f32_16x16x32_bf16 v[180:183], v[52:55], a[180:183], v[180:183]
    ds_read_b64_tr_b16 v[50:51], v12 offset:33792
    v_min_f32 v108, v108, v68
    v_mfma_f32_16x16x32_bf16 v[212:215], v[52:55], a[184:187], v[212:215]
    ds_read_b64_tr_b16 a[72:73], v10 offset:57344
    v_add_f32 v109, 0xf1800000, v3
    v_mfma_f32_16x16x32_bf16 v[244:247], v[52:55], a[188:191], v[244:247]
    buffer_load_dwordx4 v1, s[8:11], s98 offen offset:1024   lds
    v_mfma_f32_16x16x32_bf16 v[152:155], v[56:59], a[176:179], v[152:155]
    ds_read_b64_tr_b16 v[52:53], v13 offset:32768
    v_min_f32 v109, v109, v69
    v_mfma_f32_16x16x32_bf16 v[184:187], v[56:59], a[180:183], v[184:187]
    ds_read_b64_tr_b16 v[54:55], v13 offset:33792
    v_add_f32 v110, 0xf2000000, v3
    v_mfma_f32_16x16x32_bf16 v[216:219], v[56:59], a[184:187], v[216:219]
    s_waitcnt lgkmcnt(7)
    ds_read_b64_tr_b16 a[74:75], v10 offset:58368
    v_min_f32 v110, v110, v70
    v_mfma_f32_16x16x32_bf16 v[248:251], v[56:59], a[188:191], v[248:251]
    buffer_load_dwordx4 v1, s[8:11], s98 offen offset:2048   lds
    v_mfma_f32_16x16x32_bf16 v[156:159], v[60:63], a[176:179], v[156:159]
    ds_read_b64_tr_b16 v[56:57], v14 offset:32768
    v_add_f32 v111, 0xf2400000, v3
    v_mfma_f32_16x16x32_bf16 v[188:191], v[60:63], a[180:183], v[188:191]
    ds_read_b64_tr_b16 v[58:59], v14 offset:33792
    v_min_f32 v111, v111, v71
    v_mfma_f32_16x16x32_bf16 v[220:223], v[60:63], a[184:187], v[220:223]
    s_cmp_eq_u32 s60, 0
    s_cselect_b32 s19, 1.0, 0
    ds_read_b64_tr_b16 a[76:77], v11 offset:57344
    v_sub_f32 v3, v22, v21
    v_mfma_f32_16x16x32_bf16 v[252:255], v[60:63], a[188:191], v[252:255]
    buffer_load_dwordx4 v1, s[8:11], s98 offen offset:3072   lds
    v_mfma_f32_16x16x32_bf16 v[128:131], v[32:35], a[192:195], v[128:131]
    s_add_u32 m0, s62, 135168
    s_add_u32 s98, s82, 4096
    ds_read_b64_tr_b16 v[60:61], v15 offset:32768
    v_mfma_f32_16x16x32_bf16 v[160:163], v[32:35], a[196:199], v[160:163]
    ds_read_b64_tr_b16 v[62:63], v15 offset:33792
    v_fma_f32 v3, s19, v3, v21
    v_mfma_f32_16x16x32_bf16 v[192:195], v[32:35], a[200:203], v[192:195]
    ds_read_b64_tr_b16 a[78:79], v11 offset:58368
    v_add_f32 v80, 0, v3
    v_mfma_f32_16x16x32_bf16 v[224:227], v[32:35], a[204:207], v[224:227]
    buffer_load_dwordx4 v1, s[8:11], s98 offen offset:0   lds
    v_mfma_f32_16x16x32_bf16 v[132:135], v[36:39], a[192:195], v[132:135]
    ds_read_b64_tr_b16 v[32:33], v8 offset:40960
    v_min_f32 v80, v80, v64
    v_mfma_f32_16x16x32_bf16 v[164:167], v[36:39], a[196:199], v[164:167]
    ds_read_b64_tr_b16 v[34:35], v8 offset:41984
    v_add_f32 v81, 0xf1800000, v3
    v_mfma_f32_16x16x32_bf16 v[196:199], v[36:39], a[200:203], v[196:199]
    ds_read_b64_tr_b16 a[80:81], v12 offset:57344
    v_min_f32 v81, v81, v65
    v_mfma_f32_16x16x32_bf16 v[228:231], v[36:39], a[204:207], v[228:231]
    buffer_load_dwordx4 v1, s[8:11], s98 offen offset:1024   lds
    v_mfma_f32_16x16x32_bf16 v[136:139], v[40:43], a[192:195], v[136:139]
    ds_read_b64_tr_b16 v[36:37], v9 offset:40960
    v_add_f32 v82, 0xf2000000, v3
    v_mfma_f32_16x16x32_bf16 v[168:171], v[40:43], a[196:199], v[168:171]
    ds_read_b64_tr_b16 v[38:39], v9 offset:41984
    v_min_f32 v82, v82, v66
    v_mfma_f32_16x16x32_bf16 v[200:203], v[40:43], a[200:203], v[200:203]
    s_waitcnt lgkmcnt(7)
    ds_read_b64_tr_b16 a[82:83], v12 offset:58368
    v_add_f32 v83, 0xf2400000, v3
    v_mfma_f32_16x16x32_bf16 v[232:235], v[40:43], a[204:207], v[232:235]
    buffer_load_dwordx4 v1, s[8:11], s98 offen offset:2048   lds
    v_mfma_f32_16x16x32_bf16 v[140:143], v[44:47], a[192:195], v[140:143]
    ds_read_b64_tr_b16 v[40:41], v10 offset:40960
    v_min_f32 v83, v83, v67
    v_mfma_f32_16x16x32_bf16 v[172:175], v[44:47], a[196:199], v[172:175]
    ds_read_b64_tr_b16 v[42:43], v10 offset:41984
    v_add_f32 v84, 0xf3800000, v3
    v_mfma_f32_16x16x32_bf16 v[204:207], v[44:47], a[200:203], v[204:207]
    ds_read_b64_tr_b16 a[84:85], v13 offset:57344
    v_min_f32 v84, v84, v64
    v_mfma_f32_16x16x32_bf16 v[236:239], v[44:47], a[204:207], v[236:239]
    buffer_load_dwordx4 v1, s[8:11], s98 offen offset:3072   lds
    v_mfma_f32_16x16x32_bf16 v[144:147], v[48:51], a[192:195], v[144:147]
    ds_read_b64_tr_b16 v[44:45], v11 offset:40960
    v_add_f32 v85, 0xf3880000, v3
    v_mfma_f32_16x16x32_bf16 v[176:179], v[48:51], a[196:199], v[176:179]
    ds_read_b64_tr_b16 v[46:47], v11 offset:41984
    v_min_f32 v85, v85, v65
    v_mfma_f32_16x16x32_bf16 v[208:211], v[48:51], a[200:203], v[208:211]
    ds_read_b64_tr_b16 a[86:87], v13 offset:58368
    v_add_f32 v86, 0xf3900000, v3
    v_mfma_f32_16x16x32_bf16 v[240:243], v[48:51], a[204:207], v[240:243]
    buffer_load_dwordx4 a[0:3], v120, s[40:43], s71 offen
    v_mfma_f32_16x16x32_bf16 v[148:151], v[52:55], a[192:195], v[148:151]
    ds_read_b64_tr_b16 v[48:49], v12 offset:40960
    v_min_f32 v86, v86, v66
    v_mfma_f32_16x16x32_bf16 v[180:183], v[52:55], a[196:199], v[180:183]
    ds_read_b64_tr_b16 v[50:51], v12 offset:41984
    v_add_f32 v87, 0xf3980000, v3
    v_mfma_f32_16x16x32_bf16 v[212:215], v[52:55], a[200:203], v[212:215]
    ds_read_b64_tr_b16 a[88:89], v14 offset:57344
    v_min_f32 v87, v87, v67
    v_mfma_f32_16x16x32_bf16 v[244:247], v[52:55], a[204:207], v[244:247]
    buffer_load_dwordx4 a[4:7], v120, s[40:43], s71 offen offset:3584
    v_mfma_f32_16x16x32_bf16 v[152:155], v[56:59], a[192:195], v[152:155]
    ds_read_b64_tr_b16 v[52:53], v13 offset:40960
    v_add_f32 v88, 0x73800000, v3
    v_mfma_f32_16x16x32_bf16 v[184:187], v[56:59], a[196:199], v[184:187]
    ds_read_b64_tr_b16 v[54:55], v13 offset:41984
    v_min_f32 v88, v88, v68
    v_mfma_f32_16x16x32_bf16 v[216:219], v[56:59], a[200:203], v[216:219]
    s_waitcnt lgkmcnt(7)
    ds_read_b64_tr_b16 a[90:91], v14 offset:58368
    v_add_f32 v89, 0x73700000, v3
    v_mfma_f32_16x16x32_bf16 v[248:251], v[56:59], a[204:207], v[248:251]
    buffer_load_dwordx4 a[8:11], v120, s[44:47], s71 offen
    v_mfma_f32_16x16x32_bf16 v[156:159], v[60:63], a[192:195], v[156:159]
    ds_read_b64_tr_b16 v[56:57], v14 offset:40960
    v_min_f32 v89, v89, v69
    v_mfma_f32_16x16x32_bf16 v[188:191], v[60:63], a[196:199], v[188:191]
    ds_read_b64_tr_b16 v[58:59], v14 offset:41984
    v_add_f32 v90, 0x73600000, v3
    v_mfma_f32_16x16x32_bf16 v[220:223], v[60:63], a[200:203], v[220:223]
    ds_read_b64_tr_b16 a[92:93], v15 offset:57344
    v_min_f32 v90, v90, v70
    v_mfma_f32_16x16x32_bf16 v[252:255], v[60:63], a[204:207], v[252:255]
    buffer_load_dwordx4 a[12:15], v120, s[44:47], s71 offen offset:3584
    v_mfma_f32_16x16x32_bf16 v[192:195], v[32:35], a[216:219], v[192:195]
    s_waitcnt vmcnt(34)
    s_lshl_b32 s71, s101, 16
    ds_read_b64_tr_b16 v[60:61], v15 offset:40960
    v_add_f32 v91, 0x73500000, v3
    v_mfma_f32_16x16x32_bf16 v[192:195], a[24:27], a[232:235], v[192:195]
    s_waitcnt vmcnt(26)
    s_lshl_b32 s100, s3, 11
    ds_read_b64_tr_b16 v[62:63], v15 offset:41984
    v_min_f32 v91, v91, v71
    v_mfma_f32_16x16x32_bf16 v[192:195], a[64:67], a[248:251], v[192:195]
    s_add_u32 s71, s71, s100
    ds_read_b64_tr_b16 a[94:95], v15 offset:58368
    v_add_f32 v92, 0, v3
    v_mfma_f32_16x16x32_bf16 v[196:199], v[36:39], a[216:219], v[196:199]
    s_lshl_b32 s100, s4, 7
    v_min_f32 v92, v92, v68
    v_add_f32 v93, 0xf1800000, v3
    v_mfma_f32_16x16x32_bf16 v[196:199], a[28:31], a[232:235], v[196:199]
    s_add_u32 s71, s71, s100
    v_min_f32 v93, v93, v69
    v_add_f32 v94, 0xf2000000, v3
    v_mfma_f32_16x16x32_bf16 v[196:199], a[68:71], a[248:251], v[196:199]
    v_min_f32 v94, v94, v70
    v_add_f32 v95, 0xf2400000, v3
    v_mfma_f32_16x16x32_bf16 v[224:227], v[32:35], a[220:223], v[224:227]
    buffer_load_dwordx4 a[16:19], v121, s[48:51], s71 offen
    v_mfma_f32_16x16x32_bf16 v[224:227], a[24:27], a[236:239], v[224:227]
    s_waitcnt vmcnt(26)
    v_min_f32 v95, v95, v71
    s_waitcnt lgkmcnt(0)
    s_barrier
    v_mfma_f32_16x16x32_bf16 v[224:227], a[64:67], a[252:255], v[224:227]
    buffer_load_dwordx4 a[20:23], v121, s[48:51], s71 offen offset:1024
    v_mfma_f32_16x16x32_bf16 v[228:231], v[36:39], a[220:223], v[228:231]
    v_cvt_pk_bf16_f32 v192, v192, v193
    v_cvt_pk_bf16_f32 v193, v194, v195
    v_mfma_f32_16x16x32_bf16 v[228:231], a[28:31], a[236:239], v[228:231]
    v_cvt_pk_bf16_f32 v194, v196, v197
    v_cvt_pk_bf16_f32 v195, v198, v199
    v_mfma_f32_16x16x32_bf16 v[228:231], a[68:71], a[252:255], v[228:231]
    ds_write_b128 v16, v[192:195] offset:32768
    v_lshrrev_b32 v121, 1, v2
    v_mfma_f32_16x16x32_bf16 v[128:131], v[32:35], a[208:211], v[128:131]
    v_and_b32 v121, 15, v121
    v_lshlrev_b32 v121, 10, v121
    v_mfma_f32_16x16x32_bf16 v[128:131], a[24:27], a[224:227], v[128:131]
    v_and_b32 v122, 1, v2
    v_lshl_add_u32 v121, v122, 7, v121
    v_mfma_f32_16x16x32_bf16 v[128:131], a[64:67], a[240:243], v[128:131]
    v_mfma_f32_16x16x32_bf16 v[132:135], v[36:39], a[208:211], v[132:135]
    s_lshl_b32 s71, s6, 2
    v_cvt_pk_bf16_f32 v224, v224, v225
    v_cvt_pk_bf16_f32 v225, v226, v227
    v_mfma_f32_16x16x32_bf16 v[132:135], a[28:31], a[224:227], v[132:135]
    s_add_u32 s71, s71, s3
    v_cvt_pk_bf16_f32 v226, v228, v229
    v_cvt_pk_bf16_f32 v227, v230, v231
    v_mfma_f32_16x16x32_bf16 v[132:135], a[68:71], a[240:243], v[132:135]
    s_lshl_b32 s71, s71, 14
    ds_write_b128 v16, v[224:227] offset:36864
    v_mfma_f32_16x16x32_bf16 v[160:163], v[32:35], a[212:215], v[160:163]
    buffer_load_dword a60, v121, s[28:31], s71 offen
    v_mfma_f32_16x16x32_bf16 v[160:163], a[24:27], a[228:231], v[160:163]
    v_mfma_f32_16x16x32_bf16 v[160:163], a[64:67], a[244:247], v[160:163]
    s_getpc_b64 s[100:101]
L_ct2:
    s_lshr_b32 s99, s2, 3
    s_lshl_b32 s99, s99, 2
    s_add_u32 s99, s99, s3
    s_mul_i32 s99, s99, 6
    v_min_u32 v123, 5, v2
    v_add_u32 v123, s99, v123
    v_lshlrev_b32 v123, 7, v123
    v_add_u32 v123, L_attn-L_ct2, v123
    v_min_u32 v123, L_code_end-L_ct2, v123
    global_load_dword a61, v123, s[100:101]
    v_mfma_f32_16x16x32_bf16 v[164:167], v[36:39], a[212:215], v[164:167]
    v_cvt_pk_bf16_f32 v128, v128, v129
    v_cvt_pk_bf16_f32 v129, v130, v131
    v_mfma_f32_16x16x32_bf16 v[164:167], a[28:31], a[228:231], v[164:167]
    v_cvt_pk_bf16_f32 v130, v132, v133
    v_cvt_pk_bf16_f32 v131, v134, v135
    v_mfma_f32_16x16x32_bf16 v[164:167], a[68:71], a[244:247], v[164:167]
    ds_write_b128 v16, v[128:131] offset:0
    v_mfma_f32_16x16x32_bf16 v[200:203], v[40:43], a[216:219], v[200:203]
    v_mfma_f32_16x16x32_bf16 v[200:203], a[32:35], a[232:235], v[200:203]
    v_mfma_f32_16x16x32_bf16 v[200:203], a[72:75], a[248:251], v[200:203]
    v_mfma_f32_16x16x32_bf16 v[204:207], v[44:47], a[216:219], v[204:207]
    v_cvt_pk_bf16_f32 v160, v160, v161
    v_cvt_pk_bf16_f32 v161, v162, v163
    v_mfma_f32_16x16x32_bf16 v[204:207], a[36:39], a[232:235], v[204:207]
    v_cvt_pk_bf16_f32 v162, v164, v165
    v_cvt_pk_bf16_f32 v163, v166, v167
    v_mfma_f32_16x16x32_bf16 v[204:207], a[76:79], a[248:251], v[204:207]
    ds_write_b128 v16, v[160:163] offset:4096
    v_mfma_f32_16x16x32_bf16 v[232:235], v[40:43], a[220:223], v[232:235]
    v_mfma_f32_16x16x32_bf16 v[232:235], a[32:35], a[236:239], v[232:235]
    v_mfma_f32_16x16x32_bf16 v[232:235], a[72:75], a[252:255], v[232:235]
    v_mfma_f32_16x16x32_bf16 v[236:239], v[44:47], a[220:223], v[236:239]
    v_cvt_pk_bf16_f32 v200, v200, v201
    v_cvt_pk_bf16_f32 v201, v202, v203
    v_mfma_f32_16x16x32_bf16 v[236:239], a[36:39], a[236:239], v[236:239]
    v_cvt_pk_bf16_f32 v202, v204, v205
    v_cvt_pk_bf16_f32 v203, v206, v207
    v_mfma_f32_16x16x32_bf16 v[236:239], a[76:79], a[252:255], v[236:239]
    ds_write_b128 v16, v[200:203] offset:33792
    v_mfma_f32_16x16x32_bf16 v[136:139], v[40:43], a[208:211], v[136:139]
    v_mfma_f32_16x16x32_bf16 v[136:139], a[32:35], a[224:227], v[136:139]
    v_mfma_f32_16x16x32_bf16 v[136:139], a[72:75], a[240:243], v[136:139]
    v_mfma_f32_16x16x32_bf16 v[140:143], v[44:47], a[208:211], v[140:143]
    v_cvt_pk_bf16_f32 v232, v232, v233
    v_cvt_pk_bf16_f32 v233, v234, v235
    v_mfma_f32_16x16x32_bf16 v[140:143], a[36:39], a[224:227], v[140:143]
    v_cvt_pk_bf16_f32 v234, v236, v237
    v_cvt_pk_bf16_f32 v235, v238, v239
    v_mfma_f32_16x16x32_bf16 v[140:143], a[76:79], a[240:243], v[140:143]
    ds_write_b128 v16, v[232:235] offset:37888
    v_mfma_f32_16x16x32_bf16 v[168:171], v[40:43], a[212:215], v[168:171]
    v_mfma_f32_16x16x32_bf16 v[168:171], a[32:35], a[228:231], v[168:171]
    v_mfma_f32_16x16x32_bf16 v[168:171], a[72:75], a[244:247], v[168:171]
    v_mfma_f32_16x16x32_bf16 v[172:175], v[44:47], a[212:215], v[172:175]
    v_cvt_pk_bf16_f32 v136, v136, v137
    v_cvt_pk_bf16_f32 v137, v138, v139
    v_mfma_f32_16x16x32_bf16 v[172:175], a[36:39], a[228:231], v[172:175]
    v_cvt_pk_bf16_f32 v138, v140, v141
    v_cvt_pk_bf16_f32 v139, v142, v143
    v_mfma_f32_16x16x32_bf16 v[172:175], a[76:79], a[244:247], v[172:175]
    ds_write_b128 v16, v[136:139] offset:1024
    v_mfma_f32_16x16x32_bf16 v[208:211], v[48:51], a[216:219], v[208:211]
    v_mfma_f32_16x16x32_bf16 v[208:211], a[40:43], a[232:235], v[208:211]
    v_mfma_f32_16x16x32_bf16 v[208:211], a[80:83], a[248:251], v[208:211]
    v_mfma_f32_16x16x32_bf16 v[212:215], v[52:55], a[216:219], v[212:215]
    v_cvt_pk_bf16_f32 v168, v168, v169
    v_cvt_pk_bf16_f32 v169, v170, v171
    v_mfma_f32_16x16x32_bf16 v[212:215], a[44:47], a[232:235], v[212:215]
    v_cvt_pk_bf16_f32 v170, v172, v173
    v_cvt_pk_bf16_f32 v171, v174, v175
    v_mfma_f32_16x16x32_bf16 v[212:215], a[84:87], a[248:251], v[212:215]
    ds_write_b128 v16, v[168:171] offset:5120
    v_mfma_f32_16x16x32_bf16 v[240:243], v[48:51], a[220:223], v[240:243]
    v_mfma_f32_16x16x32_bf16 v[240:243], a[40:43], a[236:239], v[240:243]
    v_mfma_f32_16x16x32_bf16 v[240:243], a[80:83], a[252:255], v[240:243]
    v_mfma_f32_16x16x32_bf16 v[244:247], v[52:55], a[220:223], v[244:247]
    v_cvt_pk_bf16_f32 v208, v208, v209
    v_cvt_pk_bf16_f32 v209, v210, v211
    v_mfma_f32_16x16x32_bf16 v[244:247], a[44:47], a[236:239], v[244:247]
    v_cvt_pk_bf16_f32 v210, v212, v213
    v_cvt_pk_bf16_f32 v211, v214, v215
    v_mfma_f32_16x16x32_bf16 v[244:247], a[84:87], a[252:255], v[244:247]
    ds_write_b128 v16, v[208:211] offset:34816
    v_mfma_f32_16x16x32_bf16 v[144:147], v[48:51], a[208:211], v[144:147]
    v_mfma_f32_16x16x32_bf16 v[144:147], a[40:43], a[224:227], v[144:147]
    v_mfma_f32_16x16x32_bf16 v[144:147], a[80:83], a[240:243], v[144:147]
    v_mfma_f32_16x16x32_bf16 v[148:151], v[52:55], a[208:211], v[148:151]
    v_cvt_pk_bf16_f32 v240, v240, v241
    v_cvt_pk_bf16_f32 v241, v242, v243
    v_mfma_f32_16x16x32_bf16 v[148:151], a[44:47], a[224:227], v[148:151]
    v_cvt_pk_bf16_f32 v242, v244, v245
    v_cvt_pk_bf16_f32 v243, v246, v247
    v_mfma_f32_16x16x32_bf16 v[148:151], a[84:87], a[240:243], v[148:151]
    ds_write_b128 v16, v[240:243] offset:38912
    v_mfma_f32_16x16x32_bf16 v[176:179], v[48:51], a[212:215], v[176:179]
    v_mfma_f32_16x16x32_bf16 v[176:179], a[40:43], a[228:231], v[176:179]
    v_mfma_f32_16x16x32_bf16 v[176:179], a[80:83], a[244:247], v[176:179]
    v_mfma_f32_16x16x32_bf16 v[180:183], v[52:55], a[212:215], v[180:183]
    v_cvt_pk_bf16_f32 v144, v144, v145
    v_cvt_pk_bf16_f32 v145, v146, v147
    v_mfma_f32_16x16x32_bf16 v[180:183], a[44:47], a[228:231], v[180:183]
    v_cvt_pk_bf16_f32 v146, v148, v149
    v_cvt_pk_bf16_f32 v147, v150, v151
    v_mfma_f32_16x16x32_bf16 v[180:183], a[84:87], a[244:247], v[180:183]
    ds_write_b128 v16, v[144:147] offset:2048
    v_mfma_f32_16x16x32_bf16 v[216:219], v[56:59], a[216:219], v[216:219]
    v_mfma_f32_16x16x32_bf16 v[216:219], a[48:51], a[232:235], v[216:219]
    v_mfma_f32_16x16x32_bf16 v[216:219], a[88:91], a[248:251], v[216:219]
    v_mfma_f32_16x16x32_bf16 v[220:223], v[60:63], a[216:219], v[220:223]
    v_cvt_pk_bf16_f32 v176, v176, v177
    v_cvt_pk_bf16_f32 v177, v178, v179
    v_mfma_f32_16x16x32_bf16 v[220:223], a[52:55], a[232:235], v[220:223]
    v_cvt_pk_bf16_f32 v178, v180, v181
    v_cvt_pk_bf16_f32 v179, v182, v183
    v_mfma_f32_16x16x32_bf16 v[220:223], a[92:95], a[248:251], v[220:223]
    ds_write_b128 v16, v[176:179] offset:6144
    v_mfma_f32_16x16x32_bf16 v[248:251], v[56:59], a[220:223], v[248:251]
    v_mfma_f32_16x16x32_bf16 v[248:251], a[48:51], a[236:239], v[248:251]
    v_mfma_f32_16x16x32_bf16 v[248:251], a[88:91], a[252:255], v[248:251]
    v_mfma_f32_16x16x32_bf16 v[252:255], v[60:63], a[220:223], v[252:255]
    v_cvt_pk_bf16_f32 v216, v216, v217
    v_cvt_pk_bf16_f32 v217, v218, v219
    v_mfma_f32_16x16x32_bf16 v[252:255], a[52:55], a[236:239], v[252:255]
    v_cvt_pk_bf16_f32 v218, v220, v221
    v_cvt_pk_bf16_f32 v219, v222, v223
    v_mfma_f32_16x16x32_bf16 v[252:255], a[92:95], a[252:255], v[252:255]
    ds_write_b128 v16, v[216:219] offset:35840
    v_mfma_f32_16x16x32_bf16 v[152:155], v[56:59], a[208:211], v[152:155]
    v_mfma_f32_16x16x32_bf16 v[152:155], a[48:51], a[224:227], v[152:155]
    v_mfma_f32_16x16x32_bf16 v[152:155], a[88:91], a[240:243], v[152:155]
    v_mfma_f32_16x16x32_bf16 v[156:159], v[60:63], a[208:211], v[156:159]
    v_cvt_pk_bf16_f32 v248, v248, v249
    v_cvt_pk_bf16_f32 v249, v250, v251
    v_mfma_f32_16x16x32_bf16 v[156:159], a[52:55], a[224:227], v[156:159]
    v_cvt_pk_bf16_f32 v250, v252, v253
    v_cvt_pk_bf16_f32 v251, v254, v255
    v_mfma_f32_16x16x32_bf16 v[156:159], a[92:95], a[240:243], v[156:159]
    ds_write_b128 v16, v[248:251] offset:39936
    v_mfma_f32_16x16x32_bf16 v[184:187], v[56:59], a[212:215], v[184:187]
    v_mfma_f32_16x16x32_bf16 v[184:187], a[48:51], a[228:231], v[184:187]
    v_mfma_f32_16x16x32_bf16 v[184:187], a[88:91], a[244:247], v[184:187]
    v_mfma_f32_16x16x32_bf16 v[188:191], v[60:63], a[212:215], v[188:191]
    v_cvt_pk_bf16_f32 v152, v152, v153
    v_cvt_pk_bf16_f32 v153, v154, v155
    v_mfma_f32_16x16x32_bf16 v[188:191], a[52:55], a[228:231], v[188:191]
    v_cvt_pk_bf16_f32 v154, v156, v157
    v_cvt_pk_bf16_f32 v155, v158, v159
    v_mfma_f32_16x16x32_bf16 v[188:191], a[92:95], a[244:247], v[188:191]
    ds_write_b128 v16, v[152:155] offset:3072
L_attn:
    v_add_u32 v15, 4096, v1
    v_cvt_pk_bf16_f32 v184, v184, v185
    v_cvt_pk_bf16_f32 v185, v186, v187
    s_nop 3
    v_cvt_pk_bf16_f32 v186, v188, v189
    v_cvt_pk_bf16_f32 v187, v190, v191
    ds_write_b128 v16, v[184:187] offset:7168
    s_waitcnt vmcnt(24) lgkmcnt(0)
    s_barrier
    ds_read_b128 a[64:67], v17 offset:0
    ds_read_b128 a[128:131], v18 offset:0
    ds_read_b128 a[68:71], v17 offset:1024
    ds_read_b128 a[132:135], v18 offset:1024
    ds_read_b128 a[72:75], v17 offset:2048
    ds_read_b128 a[136:139], v18 offset:2048
    ds_read_b128 a[76:79], v17 offset:3072
    ds_read_b128 a[140:143], v18 offset:3072
    ds_read_b128 a[144:147], v18 offset:4096
    ds_read_b128 a[148:151], v18 offset:5120
    ds_read_b128 a[152:155], v18 offset:6144
    ds_read_b128 a[156:159], v18 offset:7168
    ds_read_b128 a[80:83], v17 offset:4096
    ds_read_b128 a[84:87], v17 offset:5120
    ds_read_b128 a[88:91], v17 offset:6144
    ds_read_b128 a[92:95], v17 offset:7168
    s_waitcnt lgkmcnt(14)
    v_mfma_f32_16x16x32_bf16 v[96:99], a[128:131], a[64:67], v[96:99]
    s_waitcnt lgkmcnt(12)
    s_add_u32 s19, s82, 32768
    s_sub_u32 s82, s12, s13
    ds_read_b128 a[96:99], v17 offset:8192
    v_mfma_f32_16x16x32_bf16 v[96:99], a[132:135], a[68:71], v[96:99]
    s_waitcnt lgkmcnt(11)
    s_sub_u32 s82, s82, 1
    s_cmp_gt_u32 s12, s13
    s_cselect_b32 s82, s82, s12
    ds_read_b128 a[100:103], v17 offset:9216
    v_mfma_f32_16x16x32_bf16 v[96:99], a[136:139], a[72:75], v[96:99]
    s_waitcnt lgkmcnt(10)
    s_lshl_b32 s82, s82, 16
    s_add_u32 s82, s82, s81
    ds_read_b128 a[104:107], v17 offset:10240
    v_mfma_f32_16x16x32_bf16 v[96:99], a[140:143], a[76:79], v[96:99]
    s_waitcnt lgkmcnt(10)
    s_cmp_ge_u32 s12, 17
    s_cselect_b32 s82, 2147471360, s82
    s_add_u32 s12, s12, 1
    ds_read_b128 a[108:111], v17 offset:11264
    v_mfma_f32_16x16x32_bf16 v[100:103], a[144:147], a[64:67], v[100:103]
    s_waitcnt lgkmcnt(10)
    s_sub_u32 s14, s60, 1
    ds_read_b128 a[112:115], v17 offset:12288
    v_mfma_f32_16x16x32_bf16 v[100:103], a[148:151], a[68:71], v[100:103]
    s_waitcnt lgkmcnt(10)
    ds_read_b128 a[116:119], v17 offset:13312
    v_mfma_f32_16x16x32_bf16 v[100:103], a[152:155], a[72:75], v[100:103]
    s_waitcnt lgkmcnt(10)
    ds_read_b128 a[120:123], v17 offset:14336
    v_mfma_f32_16x16x32_bf16 v[100:103], a[156:159], a[76:79], v[100:103]
    s_waitcnt lgkmcnt(10)
    ds_read_b128 a[124:127], v17 offset:15360
    v_mfma_f32_16x16x32_bf16 v[104:107], a[128:131], a[80:83], v[104:107]
    s_waitcnt lgkmcnt(10)
    ds_read_b128 a[192:195], v17 offset:32768
    v_exp_f32 v96, v96
    v_mfma_f32_16x16x32_bf16 v[104:107], a[132:135], a[84:87], v[104:107]
    s_waitcnt lgkmcnt(10)
    ds_read_b128 a[196:199], v17 offset:33792
    v_exp_f32 v97, v97
    v_mfma_f32_16x16x32_bf16 v[104:107], a[136:139], a[88:91], v[104:107]
    s_waitcnt lgkmcnt(10)
    ds_read_b128 a[200:203], v17 offset:34816
    v_exp_f32 v98, v98
    v_mfma_f32_16x16x32_bf16 v[104:107], a[140:143], a[92:95], v[104:107]
    ds_read_b128 a[204:207], v17 offset:35840
    v_exp_f32 v99, v99
    v_mfma_f32_16x16x32_bf16 v[108:111], a[144:147], a[80:83], v[108:111]
    ds_read_b128 a[208:211], v17 offset:36864
    v_exp_f32 v100, v100
    v_mfma_f32_16x16x32_bf16 v[108:111], a[148:151], a[84:87], v[108:111]
    ds_read_b128 a[212:215], v17 offset:37888
    v_exp_f32 v101, v101
    v_mfma_f32_16x16x32_bf16 v[108:111], a[152:155], a[88:91], v[108:111]
    ds_read_b128 a[216:219], v17 offset:38912
    v_exp_f32 v102, v102
    v_mfma_f32_16x16x32_bf16 v[108:111], a[156:159], a[92:95], v[108:111]
    s_waitcnt lgkmcnt(14)
    ds_read_b128 a[220:223], v17 offset:39936
    v_exp_f32 v103, v103
    v_mfma_f32_16x16x32_bf16 v[112:115], a[128:131], a[96:99], v[72:75]
    s_waitcnt lgkmcnt(14)
    ds_read_b128 a[224:227], v17 offset:40960
    v_exp_f32 v104, v104
    v_mfma_f32_16x16x32_bf16 v[112:115], a[132:135], a[100:103], v[112:115]
    s_waitcnt lgkmcnt(14)
    ds_read_b128 a[228:231], v17 offset:41984
    v_exp_f32 v105, v105
    v_mfma_f32_16x16x32_bf16 v[112:115], a[136:139], a[104:107], v[112:115]
    s_waitcnt lgkmcnt(14)
    ds_read_b128 a[232:235], v17 offset:43008
    v_exp_f32 v106, v106
    v_mfma_f32_16x16x32_bf16 v[112:115], a[140:143], a[108:111], v[112:115]
    s_waitcnt lgkmcnt(14)
    ds_read_b128 a[236:239], v17 offset:44032
    v_exp_f32 v107, v107
    v_mfma_f32_16x16x32_bf16 v[120:123], a[128:131], a[112:115], v[76:79]
    s_waitcnt lgkmcnt(14)
    ds_read_b128 a[240:243], v17 offset:45056
    v_exp_f32 v108, v108
    v_mfma_f32_16x16x32_bf16 v[120:123], a[132:135], a[116:119], v[120:123]
    s_waitcnt lgkmcnt(14)
    ds_read_b128 a[244:247], v17 offset:46080
    v_exp_f32 v109, v109
    v_mfma_f32_16x16x32_bf16 v[120:123], a[136:139], a[120:123], v[120:123]
    s_waitcnt lgkmcnt(14)
    ds_read_b128 a[248:251], v17 offset:47104
    v_exp_f32 v110, v110
    v_mfma_f32_16x16x32_bf16 v[120:123], a[140:143], a[124:127], v[120:123]
    ds_read_b128 a[252:255], v17 offset:48128
    v_exp_f32 v111, v111
    v_mfma_f32_16x16x32_bf16 v[116:119], a[144:147], a[96:99], v[72:75]
    ds_read_b128 a[128:131], v18 offset:16384
    v_cvt_pk_bf16_f32 v48, v96, v97
    v_mfma_f32_16x16x32_bf16 v[116:119], a[148:151], a[100:103], v[116:119]
    ds_read_b128 a[132:135], v18 offset:17408
    v_cvt_pk_bf16_f32 v49, v98, v99
    v_mfma_f32_16x16x32_bf16 v[116:119], a[152:155], a[104:107], v[116:119]
    ds_read_b128 a[136:139], v18 offset:18432
    v_cvt_pk_bf16_f32 v50, v100, v101
    v_mfma_f32_16x16x32_bf16 v[116:119], a[156:159], a[108:111], v[116:119]
    ds_read_b128 a[140:143], v18 offset:19456
    v_cvt_pk_bf16_f32 v51, v102, v103
    v_mfma_f32_16x16x32_bf16 v[124:127], a[144:147], a[112:115], v[76:79]
    ds_read_b128 a[144:147], v18 offset:20480
    v_cvt_pk_bf16_f32 v52, v104, v105
    v_mfma_f32_16x16x32_bf16 v[124:127], a[148:151], a[116:119], v[124:127]
    ds_read_b128 a[148:151], v18 offset:21504
    v_cvt_pk_bf16_f32 v53, v106, v107
    v_mfma_f32_16x16x32_bf16 v[124:127], a[152:155], a[120:123], v[124:127]
    ds_read_b128 a[152:155], v18 offset:22528
    v_cvt_pk_bf16_f32 v54, v108, v109
    v_mfma_f32_16x16x32_bf16 v[124:127], a[156:159], a[124:127], v[124:127]
    ds_read_b128 a[156:159], v18 offset:23552
    v_cvt_pk_bf16_f32 v55, v110, v111
    v_xor_b32 v18, 196608, v18
    v_lshrrev_b32 v17, 4, v2
    v_lshlrev_b32 v17, 15, v17
    v_and_b32 v14, 255, v1
    v_add_u32 v17, v17, v14
L_t1_p1:
    s_waitcnt vmcnt(8) lgkmcnt(0)
    s_barrier
    s_cmp_eq_u32 s60, 0
    s_cbranch_scc1 L_t1_zero
    v_mfma_f32_16x16x32_bf16 v[96:99], a[128:131], a[64:67], v[64:67]
    s_add_u32 m0, s15, 0
    ds_read_b128 a[160:163], v19 offset:0
    v_mfma_f32_16x16x32_bf16 v[96:99], a[132:135], a[68:71], v[96:99]
    ds_read_b128 a[164:167], v19 offset:1024
    v_mfma_f32_16x16x32_bf16 v[96:99], a[136:139], a[72:75], v[96:99]
    v_exp_f32 v112, v112
    v_mfma_f32_16x16x32_bf16 v[96:99], a[140:143], a[76:79], v[96:99]
    buffer_load_dwordx4 v1, s[8:11], s82 offen offset:0  lds
    v_mfma_f32_16x16x32_bf16 v[104:107], a[128:131], a[80:83], v[68:71]
    v_exp_f32 v113, v113
    v_mfma_f32_16x16x32_bf16 v[104:107], a[132:135], a[84:87], v[104:107]
    ds_read_b128 a[168:171], v19 offset:2048
    v_cvt_pk_bf16_f32 v56, v112, v113
    v_mfma_f32_16x16x32_bf16 v[104:107], a[136:139], a[88:91], v[104:107]
    v_exp_f32 v114, v114
    v_mfma_f32_16x16x32_bf16 v[104:107], a[140:143], a[92:95], v[104:107]
    buffer_load_dwordx4 v1, s[8:11], s82 offen offset:1024  lds
    v_mfma_f32_16x16x32_bf16 v[100:103], a[144:147], a[64:67], v[64:67]
    v_exp_f32 v115, v115
    v_mfma_f32_16x16x32_bf16 v[100:103], a[148:151], a[68:71], v[100:103]
    ds_read_b128 a[172:175], v19 offset:3072
    v_cvt_pk_bf16_f32 v57, v114, v115
    v_mfma_f32_16x16x32_bf16 v[100:103], a[152:155], a[72:75], v[100:103]
    v_exp_f32 v116, v116
    v_mfma_f32_16x16x32_bf16 v[100:103], a[156:159], a[76:79], v[100:103]
    buffer_load_dwordx4 v1, s[8:11], s82 offen offset:2048  lds
    v_mfma_f32_16x16x32_bf16 v[108:111], a[144:147], a[80:83], v[68:71]
    v_exp_f32 v117, v117
    v_mfma_f32_16x16x32_bf16 v[108:111], a[148:151], a[84:87], v[108:111]
    ds_read_b128 a[176:179], v20 offset:4096
    v_cvt_pk_bf16_f32 v58, v116, v117
    v_mfma_f32_16x16x32_bf16 v[108:111], a[152:155], a[88:91], v[108:111]
    v_exp_f32 v118, v118
    v_mfma_f32_16x16x32_bf16 v[108:111], a[156:159], a[92:95], v[108:111]
    buffer_load_dwordx4 v1, s[8:11], s82 offen offset:3072  lds
    v_mfma_f32_16x16x32_bf16 v[32:35], v[28:31], v[48:51], 0
    s_add_u32 m0, s15, 4096
    v_exp_f32 v119, v119
    v_mfma_f32_16x16x32_bf16 v[36:39], v[28:31], v[52:55], 0
    s_waitcnt lgkmcnt(4)
    ds_read_b128 a[180:183], v20 offset:5120
    v_cvt_pk_bf16_f32 v59, v118, v119
    v_mfma_f32_16x16x32_bf16 v[128:131], a[160:163], v[48:51], 0
    v_exp_f32 v120, v120
    v_mfma_f32_16x16x32_bf16 v[160:163], a[160:163], v[52:55], 0
    s_waitcnt lgkmcnt(4)
    v_mfma_f32_16x16x32_bf16 v[132:135], a[164:167], v[48:51], 0
    v_exp_f32 v121, v121
    v_mfma_f32_16x16x32_bf16 v[164:167], a[164:167], v[52:55], 0
    s_waitcnt lgkmcnt(3)
    ds_read_b128 a[184:187], v20 offset:6144
    v_cvt_pk_bf16_f32 v60, v120, v121
    v_mfma_f32_16x16x32_bf16 v[136:139], a[168:171], v[48:51], 0
    s_waitcnt lgkmcnt(3)
    v_exp_f32 v122, v122
    v_mfma_f32_16x16x32_bf16 v[168:171], a[168:171], v[52:55], 0
    buffer_load_dwordx4 v15, s[8:11], s82 offen offset:0  lds
    v_mfma_f32_16x16x32_bf16 v[140:143], a[172:175], v[48:51], 0
    v_exp_f32 v123, v123
    v_mfma_f32_16x16x32_bf16 v[172:175], a[172:175], v[52:55], 0
    s_waitcnt lgkmcnt(2)
    ds_read_b128 a[188:191], v20 offset:7168
    v_cvt_pk_bf16_f32 v61, v122, v123
    v_mfma_f32_16x16x32_bf16 v[144:147], a[176:179], v[48:51], 0
    s_waitcnt lgkmcnt(2)
    v_exp_f32 v124, v124
    v_mfma_f32_16x16x32_bf16 v[176:179], a[176:179], v[52:55], 0
    buffer_load_dwordx4 v15, s[8:11], s82 offen offset:1024  lds
    v_mfma_f32_16x16x32_bf16 v[148:151], a[180:183], v[48:51], 0
    v_exp_f32 v125, v125
    v_mfma_f32_16x16x32_bf16 v[180:183], a[180:183], v[52:55], 0
    s_waitcnt lgkmcnt(1)
    v_cvt_pk_bf16_f32 v62, v124, v125
    v_mfma_f32_16x16x32_bf16 v[152:155], a[184:187], v[48:51], 0
    s_waitcnt lgkmcnt(0)
    v_exp_f32 v126, v126
    v_mfma_f32_16x16x32_bf16 v[184:187], a[184:187], v[52:55], 0
    buffer_load_dwordx4 v15, s[8:11], s82 offen offset:2048  lds
    v_mfma_f32_16x16x32_bf16 v[156:159], a[188:191], v[48:51], 0
    v_exp_f32 v127, v127
    v_mfma_f32_16x16x32_bf16 v[188:191], a[188:191], v[52:55], 0
    v_cvt_pk_bf16_f32 v63, v126, v127
    v_mfma_f32_16x16x32_bf16 v[112:115], a[128:131], a[96:99], v[72:75]
    v_mfma_f32_16x16x32_bf16 v[112:115], a[132:135], a[100:103], v[112:115]
    v_mfma_f32_16x16x32_bf16 v[112:115], a[136:139], a[104:107], v[112:115]
    v_exp_f32 v96, v96
    v_mfma_f32_16x16x32_bf16 v[112:115], a[140:143], a[108:111], v[112:115]
    buffer_load_dwordx4 v15, s[8:11], s82 offen offset:3072  lds
    v_mfma_f32_16x16x32_bf16 v[120:123], a[128:131], a[112:115], v[76:79]
    s_xor_b32 s15, s15, 196608
    v_exp_f32 v97, v97
    v_mfma_f32_16x16x32_bf16 v[120:123], a[132:135], a[116:119], v[120:123]
    s_add_u32 m0, s16, 0
    ds_read_b128 a[128:131], v18 offset:0
    v_cvt_pk_bf16_f32 v48, v96, v97
    v_mfma_f32_16x16x32_bf16 v[120:123], a[136:139], a[120:123], v[120:123]
    v_exp_f32 v98, v98
    v_mfma_f32_16x16x32_bf16 v[120:123], a[140:143], a[124:127], v[120:123]
    buffer_load_dwordx4 v1, s[8:11], s19 offen offset:0  lds
    v_mfma_f32_16x16x32_bf16 v[116:119], a[144:147], a[96:99], v[72:75]
    v_exp_f32 v99, v99
    v_mfma_f32_16x16x32_bf16 v[116:119], a[148:151], a[100:103], v[116:119]
    ds_read_b128 a[132:135], v18 offset:1024
    v_cvt_pk_bf16_f32 v49, v98, v99
    v_mfma_f32_16x16x32_bf16 v[116:119], a[152:155], a[104:107], v[116:119]
    v_exp_f32 v100, v100
    v_mfma_f32_16x16x32_bf16 v[116:119], a[156:159], a[108:111], v[116:119]
    buffer_load_dwordx4 v1, s[8:11], s19 offen offset:1024  lds
    v_mfma_f32_16x16x32_bf16 v[124:127], a[144:147], a[112:115], v[76:79]
    v_exp_f32 v101, v101
    v_mfma_f32_16x16x32_bf16 v[124:127], a[148:151], a[116:119], v[124:127]
    ds_read_b128 a[136:139], v18 offset:2048
    v_cvt_pk_bf16_f32 v50, v100, v101
    v_mfma_f32_16x16x32_bf16 v[124:127], a[152:155], a[120:123], v[124:127]
    v_exp_f32 v102, v102
    v_mfma_f32_16x16x32_bf16 v[124:127], a[156:159], a[124:127], v[124:127]
    buffer_load_dwordx4 v1, s[8:11], s19 offen offset:2048  lds
    v_mfma_f32_16x16x32_bf16 v[40:43], v[28:31], v[56:59], 0
    v_exp_f32 v103, v103
    v_mfma_f32_16x16x32_bf16 v[44:47], v[28:31], v[60:63], 0
    ds_read_b128 a[140:143], v18 offset:3072
    v_cvt_pk_bf16_f32 v51, v102, v103
    v_mfma_f32_16x16x32_bf16 v[192:195], a[160:163], v[56:59], 0
    v_exp_f32 v104, v104
    v_mfma_f32_16x16x32_bf16 v[224:227], a[160:163], v[60:63], 0
    v_mfma_f32_16x16x32_bf16 v[196:199], a[164:167], v[56:59], 0
    v_exp_f32 v105, v105
    v_mfma_f32_16x16x32_bf16 v[228:231], a[164:167], v[60:63], 0
    ds_read_b128 a[144:147], v18 offset:4096
    v_cvt_pk_bf16_f32 v52, v104, v105
    v_mfma_f32_16x16x32_bf16 v[200:203], a[168:171], v[56:59], 0
    v_exp_f32 v106, v106
    v_mfma_f32_16x16x32_bf16 v[232:235], a[168:171], v[60:63], 0
    buffer_load_dwordx4 v1, s[8:11], s19 offen offset:3072  lds
    v_mfma_f32_16x16x32_bf16 v[204:207], a[172:175], v[56:59], 0
    s_add_u32 m0, s16, 4096
    v_exp_f32 v107, v107
    v_mfma_f32_16x16x32_bf16 v[236:239], a[172:175], v[60:63], 0
    ds_read_b128 a[148:151], v18 offset:5120
    v_cvt_pk_bf16_f32 v53, v106, v107
    v_mfma_f32_16x16x32_bf16 v[208:211], a[176:179], v[56:59], 0
    v_exp_f32 v108, v108
    v_mfma_f32_16x16x32_bf16 v[240:243], a[176:179], v[60:63], 0
    buffer_load_dwordx4 v15, s[8:11], s19 offen offset:0  lds
    v_mfma_f32_16x16x32_bf16 v[212:215], a[180:183], v[56:59], 0
    v_exp_f32 v109, v109
    v_mfma_f32_16x16x32_bf16 v[244:247], a[180:183], v[60:63], 0
    ds_read_b128 a[152:155], v18 offset:6144
    v_cvt_pk_bf16_f32 v54, v108, v109
    v_mfma_f32_16x16x32_bf16 v[216:219], a[184:187], v[56:59], 0
    v_exp_f32 v110, v110
    v_mfma_f32_16x16x32_bf16 v[248:251], a[184:187], v[60:63], 0
    buffer_load_dwordx4 v15, s[8:11], s19 offen offset:1024  lds
    v_mfma_f32_16x16x32_bf16 v[220:223], a[188:191], v[56:59], 0
    v_exp_f32 v111, v111
    v_mfma_f32_16x16x32_bf16 v[252:255], a[188:191], v[60:63], 0
    ds_read_b128 a[156:159], v18 offset:7168
    v_cvt_pk_bf16_f32 v55, v110, v111
    s_cmp_eq_u32 s14, 0
    s_cbranch_scc1 L_t1_diag
.p2align 3
L_t1_loop:
    s_waitcnt lgkmcnt(7)
    v_mfma_f32_16x16x32_bf16 v[96:99], a[128:131], a[64:67], v[64:67]
    s_waitcnt lgkmcnt(6)
    ds_read_b128 a[160:163], v19 offset:16384
    v_mfma_f32_16x16x32_bf16 v[96:99], a[132:135], a[68:71], v[96:99]
    s_waitcnt lgkmcnt(6)
    ds_read_b128 a[164:167], v19 offset:17408
    v_mfma_f32_16x16x32_bf16 v[96:99], a[136:139], a[72:75], v[96:99]
    s_waitcnt lgkmcnt(6)
    v_exp_f32 v112, v112
    v_mfma_f32_16x16x32_bf16 v[96:99], a[140:143], a[76:79], v[96:99]
    buffer_load_dwordx4 v15, s[8:11], s19 offen offset:2048  lds
    v_mfma_f32_16x16x32_bf16 v[104:107], a[128:131], a[80:83], v[68:71]
    v_exp_f32 v113, v113
    v_mfma_f32_16x16x32_bf16 v[104:107], a[132:135], a[84:87], v[104:107]
    ds_read_b128 a[168:171], v19 offset:18432
    v_cvt_pk_bf16_f32 v56, v112, v113
    v_mfma_f32_16x16x32_bf16 v[104:107], a[136:139], a[88:91], v[104:107]
    s_waitcnt lgkmcnt(6)
    v_exp_f32 v114, v114
    v_mfma_f32_16x16x32_bf16 v[104:107], a[140:143], a[92:95], v[104:107]
    buffer_load_dwordx4 v15, s[8:11], s19 offen offset:3072  lds
    v_mfma_f32_16x16x32_bf16 v[100:103], a[144:147], a[64:67], v[64:67]
    s_waitcnt lgkmcnt(5)
    s_xor_b32 s16, s16, 98304
    v_exp_f32 v115, v115
    v_mfma_f32_16x16x32_bf16 v[100:103], a[148:151], a[68:71], v[100:103]
    s_waitcnt lgkmcnt(4)
    ds_read_b128 a[172:175], v19 offset:19456
    v_cvt_pk_bf16_f32 v57, v114, v115
    v_mfma_f32_16x16x32_bf16 v[100:103], a[152:155], a[72:75], v[100:103]
    s_waitcnt lgkmcnt(4)
    v_exp_f32 v116, v116
    v_mfma_f32_16x16x32_bf16 v[100:103], a[156:159], a[76:79], v[100:103]
    v_mfma_f32_16x16x32_bf16 v[108:111], a[144:147], a[80:83], v[68:71]
    v_exp_f32 v117, v117
    v_mfma_f32_16x16x32_bf16 v[108:111], a[148:151], a[84:87], v[108:111]
    ds_read_b128 a[176:179], v20 offset:20480
    v_cvt_pk_bf16_f32 v58, v116, v117
    v_mfma_f32_16x16x32_bf16 v[108:111], a[152:155], a[88:91], v[108:111]
    v_exp_f32 v118, v118
    v_mfma_f32_16x16x32_bf16 v[108:111], a[156:159], a[92:95], v[108:111]
    v_mfma_f32_16x16x32_bf16 v[32:35], v[28:31], v[48:51], v[32:35]
    v_exp_f32 v119, v119
    v_mfma_f32_16x16x32_bf16 v[36:39], v[28:31], v[52:55], v[36:39]
    s_waitcnt lgkmcnt(4)
    ds_read_b128 a[180:183], v20 offset:21504
    v_cvt_pk_bf16_f32 v59, v118, v119
    v_mfma_f32_16x16x32_bf16 v[128:131], a[160:163], v[48:51], v[128:131]
    v_exp_f32 v120, v120
    v_mfma_f32_16x16x32_bf16 v[160:163], a[160:163], v[52:55], v[160:163]
    s_waitcnt lgkmcnt(4)
    v_mfma_f32_16x16x32_bf16 v[132:135], a[164:167], v[48:51], v[132:135]
    v_exp_f32 v121, v121
    v_mfma_f32_16x16x32_bf16 v[164:167], a[164:167], v[52:55], v[164:167]
    s_waitcnt lgkmcnt(3)
    ds_read_b128 a[184:187], v20 offset:22528
    v_cvt_pk_bf16_f32 v60, v120, v121
    v_mfma_f32_16x16x32_bf16 v[136:139], a[168:171], v[48:51], v[136:139]
    v_exp_f32 v122, v122
    v_mfma_f32_16x16x32_bf16 v[168:171], a[168:171], v[52:55], v[168:171]
    s_waitcnt lgkmcnt(3)
    v_mfma_f32_16x16x32_bf16 v[140:143], a[172:175], v[48:51], v[140:143]
    v_exp_f32 v123, v123
    v_mfma_f32_16x16x32_bf16 v[172:175], a[172:175], v[52:55], v[172:175]
    s_waitcnt lgkmcnt(2)
    ds_read_b128 a[188:191], v20 offset:23552
    v_cvt_pk_bf16_f32 v61, v122, v123
    v_mfma_f32_16x16x32_bf16 v[144:147], a[176:179], v[48:51], v[144:147]
    v_exp_f32 v124, v124
    v_mfma_f32_16x16x32_bf16 v[176:179], a[176:179], v[52:55], v[176:179]
    s_waitcnt lgkmcnt(2)
    v_mfma_f32_16x16x32_bf16 v[148:151], a[180:183], v[48:51], v[148:151]
    v_exp_f32 v125, v125
    v_mfma_f32_16x16x32_bf16 v[180:183], a[180:183], v[52:55], v[180:183]
    s_waitcnt lgkmcnt(1)
    v_cvt_pk_bf16_f32 v62, v124, v125
    v_xor_b32 v19, 98304, v19
    v_mfma_f32_16x16x32_bf16 v[152:155], a[184:187], v[48:51], v[152:155]
    v_exp_f32 v126, v126
    v_mfma_f32_16x16x32_bf16 v[184:187], a[184:187], v[52:55], v[184:187]
    s_waitcnt lgkmcnt(0)
    v_xor_b32 v20, 98304, v20
    v_mfma_f32_16x16x32_bf16 v[156:159], a[188:191], v[48:51], v[156:159]
    v_exp_f32 v127, v127
    v_mfma_f32_16x16x32_bf16 v[188:191], a[188:191], v[52:55], v[188:191]
    v_cvt_pk_bf16_f32 v63, v126, v127
    v_mfma_f32_16x16x32_bf16 v[112:115], a[128:131], a[96:99], v[72:75]
    v_exp_f32 v96, v96
    v_mfma_f32_16x16x32_bf16 v[112:115], a[132:135], a[100:103], v[112:115]
    v_mfma_f32_16x16x32_bf16 v[112:115], a[136:139], a[104:107], v[112:115]
    v_exp_f32 v97, v97
    v_mfma_f32_16x16x32_bf16 v[112:115], a[140:143], a[108:111], v[112:115]
    v_cvt_pk_bf16_f32 v48, v96, v97
    v_mfma_f32_16x16x32_bf16 v[120:123], a[128:131], a[112:115], v[76:79]
    v_exp_f32 v98, v98
    v_mfma_f32_16x16x32_bf16 v[120:123], a[132:135], a[116:119], v[120:123]
    v_mfma_f32_16x16x32_bf16 v[120:123], a[136:139], a[120:123], v[120:123]
    v_exp_f32 v99, v99
    v_mfma_f32_16x16x32_bf16 v[120:123], a[140:143], a[124:127], v[120:123]
    v_mfma_f32_16x16x32_bf16 v[116:119], a[144:147], a[96:99], v[72:75]
    v_exp_f32 v100, v100
    v_mfma_f32_16x16x32_bf16 v[116:119], a[148:151], a[100:103], v[116:119]
    ds_read_b128 a[128:131], v18 offset:16384
    v_cvt_pk_bf16_f32 v49, v98, v99
    v_mfma_f32_16x16x32_bf16 v[116:119], a[152:155], a[104:107], v[116:119]
    s_add_u32 s19, s82, 32768
    v_exp_f32 v101, v101
    v_mfma_f32_16x16x32_bf16 v[116:119], a[156:159], a[108:111], v[116:119]
    s_sub_u32 s82, s12, s13
    ds_read_b128 a[132:135], v18 offset:17408
    v_cvt_pk_bf16_f32 v50, v100, v101
    v_mfma_f32_16x16x32_bf16 v[124:127], a[144:147], a[112:115], v[76:79]
    s_sub_u32 s82, s82, 1
    v_exp_f32 v102, v102
    v_mfma_f32_16x16x32_bf16 v[124:127], a[148:151], a[116:119], v[124:127]
    s_cmp_gt_u32 s12, s13
    s_cselect_b32 s82, s82, s12
    s_lshl_b32 s82, s82, 16
    ds_read_b128 a[136:139], v18 offset:18432
    v_mfma_f32_16x16x32_bf16 v[124:127], a[152:155], a[120:123], v[124:127]
    s_add_u32 s82, s82, s81
    v_exp_f32 v103, v103
    v_mfma_f32_16x16x32_bf16 v[124:127], a[156:159], a[124:127], v[124:127]
    s_cmp_ge_u32 s12, 17
    s_cselect_b32 s82, 2147471360, s82
    ds_read_b128 a[140:143], v18 offset:19456
    v_cvt_pk_bf16_f32 v51, v102, v103
    v_mfma_f32_16x16x32_bf16 v[40:43], v[28:31], v[56:59], v[40:43]
    s_add_u32 s12, s12, 1
    v_exp_f32 v104, v104
    v_mfma_f32_16x16x32_bf16 v[44:47], v[28:31], v[60:63], v[44:47]
    ds_read_b128 a[144:147], v18 offset:20480
    v_mfma_f32_16x16x32_bf16 v[192:195], a[160:163], v[56:59], v[192:195]
    v_exp_f32 v105, v105
    v_mfma_f32_16x16x32_bf16 v[224:227], a[160:163], v[60:63], v[224:227]
    ds_read_b128 a[148:151], v18 offset:21504
    v_cvt_pk_bf16_f32 v52, v104, v105
    v_mfma_f32_16x16x32_bf16 v[196:199], a[164:167], v[56:59], v[196:199]
    v_exp_f32 v106, v106
    v_mfma_f32_16x16x32_bf16 v[228:231], a[164:167], v[60:63], v[228:231]
    ds_read_b128 a[152:155], v18 offset:22528
    v_mfma_f32_16x16x32_bf16 v[200:203], a[168:171], v[56:59], v[200:203]
    v_exp_f32 v107, v107
    v_mfma_f32_16x16x32_bf16 v[232:235], a[168:171], v[60:63], v[232:235]
    ds_read_b128 a[156:159], v18 offset:23552
    v_cvt_pk_bf16_f32 v53, v106, v107
    v_mfma_f32_16x16x32_bf16 v[204:207], a[172:175], v[56:59], v[204:207]
    v_exp_f32 v108, v108
    v_mfma_f32_16x16x32_bf16 v[236:239], a[172:175], v[60:63], v[236:239]
    v_mfma_f32_16x16x32_bf16 v[208:211], a[176:179], v[56:59], v[208:211]
    v_exp_f32 v109, v109
    v_mfma_f32_16x16x32_bf16 v[240:243], a[176:179], v[60:63], v[240:243]
    v_cvt_pk_bf16_f32 v54, v108, v109
    v_xor_b32 v18, 196608, v18
    v_mfma_f32_16x16x32_bf16 v[212:215], a[180:183], v[56:59], v[212:215]
    v_exp_f32 v110, v110
    v_mfma_f32_16x16x32_bf16 v[244:247], a[180:183], v[60:63], v[244:247]
    v_mfma_f32_16x16x32_bf16 v[216:219], a[184:187], v[56:59], v[216:219]
    v_exp_f32 v111, v111
    v_mfma_f32_16x16x32_bf16 v[248:251], a[184:187], v[60:63], v[248:251]
    v_cvt_pk_bf16_f32 v55, v110, v111
    v_mfma_f32_16x16x32_bf16 v[220:223], a[188:191], v[56:59], v[220:223]
    v_mfma_f32_16x16x32_bf16 v[252:255], a[188:191], v[60:63], v[252:255]
    s_waitcnt vmcnt(0) lgkmcnt(0)
    s_barrier
    v_mfma_f32_16x16x32_bf16 v[96:99], a[128:131], a[64:67], v[64:67]
    s_add_u32 m0, s15, 0
    ds_read_b128 a[160:163], v19 offset:0
    v_mfma_f32_16x16x32_bf16 v[96:99], a[132:135], a[68:71], v[96:99]
    ds_read_b128 a[164:167], v19 offset:1024
    v_mfma_f32_16x16x32_bf16 v[96:99], a[136:139], a[72:75], v[96:99]
    v_exp_f32 v112, v112
    v_mfma_f32_16x16x32_bf16 v[96:99], a[140:143], a[76:79], v[96:99]
    buffer_load_dwordx4 v1, s[8:11], s82 offen offset:0  lds
    v_mfma_f32_16x16x32_bf16 v[104:107], a[128:131], a[80:83], v[68:71]
    v_exp_f32 v113, v113
    v_mfma_f32_16x16x32_bf16 v[104:107], a[132:135], a[84:87], v[104:107]
    ds_read_b128 a[168:171], v19 offset:2048
    v_cvt_pk_bf16_f32 v56, v112, v113
    v_mfma_f32_16x16x32_bf16 v[104:107], a[136:139], a[88:91], v[104:107]
    v_exp_f32 v114, v114
    v_mfma_f32_16x16x32_bf16 v[104:107], a[140:143], a[92:95], v[104:107]
    buffer_load_dwordx4 v1, s[8:11], s82 offen offset:1024  lds
    v_mfma_f32_16x16x32_bf16 v[100:103], a[144:147], a[64:67], v[64:67]
    v_exp_f32 v115, v115
    v_mfma_f32_16x16x32_bf16 v[100:103], a[148:151], a[68:71], v[100:103]
    ds_read_b128 a[172:175], v19 offset:3072
    v_cvt_pk_bf16_f32 v57, v114, v115
    v_mfma_f32_16x16x32_bf16 v[100:103], a[152:155], a[72:75], v[100:103]
    v_exp_f32 v116, v116
    v_mfma_f32_16x16x32_bf16 v[100:103], a[156:159], a[76:79], v[100:103]
    buffer_load_dwordx4 v1, s[8:11], s82 offen offset:2048  lds
    v_mfma_f32_16x16x32_bf16 v[108:111], a[144:147], a[80:83], v[68:71]
    v_exp_f32 v117, v117
    v_mfma_f32_16x16x32_bf16 v[108:111], a[148:151], a[84:87], v[108:111]
    ds_read_b128 a[176:179], v20 offset:4096
    v_cvt_pk_bf16_f32 v58, v116, v117
    v_mfma_f32_16x16x32_bf16 v[108:111], a[152:155], a[88:91], v[108:111]
    v_exp_f32 v118, v118
    v_mfma_f32_16x16x32_bf16 v[108:111], a[156:159], a[92:95], v[108:111]
    buffer_load_dwordx4 v1, s[8:11], s82 offen offset:3072  lds
    v_mfma_f32_16x16x32_bf16 v[32:35], v[28:31], v[48:51], v[32:35]
    s_add_u32 m0, s15, 4096
    v_exp_f32 v119, v119
    v_mfma_f32_16x16x32_bf16 v[36:39], v[28:31], v[52:55], v[36:39]
    s_waitcnt lgkmcnt(4)
    ds_read_b128 a[180:183], v20 offset:5120
    v_cvt_pk_bf16_f32 v59, v118, v119
    v_mfma_f32_16x16x32_bf16 v[128:131], a[160:163], v[48:51], v[128:131]
    v_exp_f32 v120, v120
    v_mfma_f32_16x16x32_bf16 v[160:163], a[160:163], v[52:55], v[160:163]
    s_waitcnt lgkmcnt(4)
    v_mfma_f32_16x16x32_bf16 v[132:135], a[164:167], v[48:51], v[132:135]
    v_exp_f32 v121, v121
    v_mfma_f32_16x16x32_bf16 v[164:167], a[164:167], v[52:55], v[164:167]
    s_waitcnt lgkmcnt(3)
    ds_read_b128 a[184:187], v20 offset:6144
    v_cvt_pk_bf16_f32 v60, v120, v121
    v_mfma_f32_16x16x32_bf16 v[136:139], a[168:171], v[48:51], v[136:139]
    s_waitcnt lgkmcnt(3)
    v_exp_f32 v122, v122
    v_mfma_f32_16x16x32_bf16 v[168:171], a[168:171], v[52:55], v[168:171]
    buffer_load_dwordx4 v15, s[8:11], s82 offen offset:0  lds
    v_mfma_f32_16x16x32_bf16 v[140:143], a[172:175], v[48:51], v[140:143]
    v_exp_f32 v123, v123
    v_mfma_f32_16x16x32_bf16 v[172:175], a[172:175], v[52:55], v[172:175]
    s_waitcnt lgkmcnt(2)
    ds_read_b128 a[188:191], v20 offset:7168
    v_cvt_pk_bf16_f32 v61, v122, v123
    v_mfma_f32_16x16x32_bf16 v[144:147], a[176:179], v[48:51], v[144:147]
    s_waitcnt lgkmcnt(2)
    v_exp_f32 v124, v124
    v_mfma_f32_16x16x32_bf16 v[176:179], a[176:179], v[52:55], v[176:179]
    buffer_load_dwordx4 v15, s[8:11], s82 offen offset:1024  lds
    v_mfma_f32_16x16x32_bf16 v[148:151], a[180:183], v[48:51], v[148:151]
    v_exp_f32 v125, v125
    v_mfma_f32_16x16x32_bf16 v[180:183], a[180:183], v[52:55], v[180:183]
    s_waitcnt lgkmcnt(1)
    v_cvt_pk_bf16_f32 v62, v124, v125
    v_mfma_f32_16x16x32_bf16 v[152:155], a[184:187], v[48:51], v[152:155]
    s_waitcnt lgkmcnt(0)
    v_exp_f32 v126, v126
    v_mfma_f32_16x16x32_bf16 v[184:187], a[184:187], v[52:55], v[184:187]
    buffer_load_dwordx4 v15, s[8:11], s82 offen offset:2048  lds
    v_mfma_f32_16x16x32_bf16 v[156:159], a[188:191], v[48:51], v[156:159]
    v_exp_f32 v127, v127
    v_mfma_f32_16x16x32_bf16 v[188:191], a[188:191], v[52:55], v[188:191]
    v_cvt_pk_bf16_f32 v63, v126, v127
    v_mfma_f32_16x16x32_bf16 v[112:115], a[128:131], a[96:99], v[72:75]
    v_mfma_f32_16x16x32_bf16 v[112:115], a[132:135], a[100:103], v[112:115]
    v_mfma_f32_16x16x32_bf16 v[112:115], a[136:139], a[104:107], v[112:115]
    v_exp_f32 v96, v96
    v_mfma_f32_16x16x32_bf16 v[112:115], a[140:143], a[108:111], v[112:115]
    buffer_load_dwordx4 v15, s[8:11], s82 offen offset:3072  lds
    v_mfma_f32_16x16x32_bf16 v[120:123], a[128:131], a[112:115], v[76:79]
    s_xor_b32 s15, s15, 196608
    v_exp_f32 v97, v97
    v_mfma_f32_16x16x32_bf16 v[120:123], a[132:135], a[116:119], v[120:123]
    s_add_u32 m0, s16, 0
    ds_read_b128 a[128:131], v18 offset:0
    v_cvt_pk_bf16_f32 v48, v96, v97
    v_mfma_f32_16x16x32_bf16 v[120:123], a[136:139], a[120:123], v[120:123]
    v_exp_f32 v98, v98
    v_mfma_f32_16x16x32_bf16 v[120:123], a[140:143], a[124:127], v[120:123]
    buffer_load_dwordx4 v1, s[8:11], s19 offen offset:0  lds
    v_mfma_f32_16x16x32_bf16 v[116:119], a[144:147], a[96:99], v[72:75]
    v_exp_f32 v99, v99
    v_mfma_f32_16x16x32_bf16 v[116:119], a[148:151], a[100:103], v[116:119]
    ds_read_b128 a[132:135], v18 offset:1024
    v_cvt_pk_bf16_f32 v49, v98, v99
    v_mfma_f32_16x16x32_bf16 v[116:119], a[152:155], a[104:107], v[116:119]
    v_exp_f32 v100, v100
    v_mfma_f32_16x16x32_bf16 v[116:119], a[156:159], a[108:111], v[116:119]
    buffer_load_dwordx4 v1, s[8:11], s19 offen offset:1024  lds
    v_mfma_f32_16x16x32_bf16 v[124:127], a[144:147], a[112:115], v[76:79]
    v_exp_f32 v101, v101
    v_mfma_f32_16x16x32_bf16 v[124:127], a[148:151], a[116:119], v[124:127]
    ds_read_b128 a[136:139], v18 offset:2048
    v_cvt_pk_bf16_f32 v50, v100, v101
    v_mfma_f32_16x16x32_bf16 v[124:127], a[152:155], a[120:123], v[124:127]
    v_exp_f32 v102, v102
    v_mfma_f32_16x16x32_bf16 v[124:127], a[156:159], a[124:127], v[124:127]
    buffer_load_dwordx4 v1, s[8:11], s19 offen offset:2048  lds
    v_mfma_f32_16x16x32_bf16 v[40:43], v[28:31], v[56:59], v[40:43]
    v_exp_f32 v103, v103
    v_mfma_f32_16x16x32_bf16 v[44:47], v[28:31], v[60:63], v[44:47]
    ds_read_b128 a[140:143], v18 offset:3072
    v_cvt_pk_bf16_f32 v51, v102, v103
    v_mfma_f32_16x16x32_bf16 v[192:195], a[160:163], v[56:59], v[192:195]
    v_exp_f32 v104, v104
    v_mfma_f32_16x16x32_bf16 v[224:227], a[160:163], v[60:63], v[224:227]
    v_mfma_f32_16x16x32_bf16 v[196:199], a[164:167], v[56:59], v[196:199]
    v_exp_f32 v105, v105
    v_mfma_f32_16x16x32_bf16 v[228:231], a[164:167], v[60:63], v[228:231]
    ds_read_b128 a[144:147], v18 offset:4096
    v_cvt_pk_bf16_f32 v52, v104, v105
    v_mfma_f32_16x16x32_bf16 v[200:203], a[168:171], v[56:59], v[200:203]
    v_exp_f32 v106, v106
    v_mfma_f32_16x16x32_bf16 v[232:235], a[168:171], v[60:63], v[232:235]
    buffer_load_dwordx4 v1, s[8:11], s19 offen offset:3072  lds
    v_mfma_f32_16x16x32_bf16 v[204:207], a[172:175], v[56:59], v[204:207]
    s_add_u32 m0, s16, 4096
    v_exp_f32 v107, v107
    v_mfma_f32_16x16x32_bf16 v[236:239], a[172:175], v[60:63], v[236:239]
    ds_read_b128 a[148:151], v18 offset:5120
    v_cvt_pk_bf16_f32 v53, v106, v107
    v_mfma_f32_16x16x32_bf16 v[208:211], a[176:179], v[56:59], v[208:211]
    s_sub_u32 s14, s14, 1
    v_exp_f32 v108, v108
    v_mfma_f32_16x16x32_bf16 v[240:243], a[176:179], v[60:63], v[240:243]
    buffer_load_dwordx4 v15, s[8:11], s19 offen offset:0  lds
    v_mfma_f32_16x16x32_bf16 v[212:215], a[180:183], v[56:59], v[212:215]
    v_exp_f32 v109, v109
    v_mfma_f32_16x16x32_bf16 v[244:247], a[180:183], v[60:63], v[244:247]
    ds_read_b128 a[152:155], v18 offset:6144
    v_cvt_pk_bf16_f32 v54, v108, v109
    v_mfma_f32_16x16x32_bf16 v[216:219], a[184:187], v[56:59], v[216:219]
    v_exp_f32 v110, v110
    v_mfma_f32_16x16x32_bf16 v[248:251], a[184:187], v[60:63], v[248:251]
    buffer_load_dwordx4 v15, s[8:11], s19 offen offset:1024  lds
    v_mfma_f32_16x16x32_bf16 v[220:223], a[188:191], v[56:59], v[220:223]
    v_exp_f32 v111, v111
    v_mfma_f32_16x16x32_bf16 v[252:255], a[188:191], v[60:63], v[252:255]
    ds_read_b128 a[156:159], v18 offset:7168
    v_cvt_pk_bf16_f32 v55, v110, v111
    s_cmp_lg_u32 s14, 0
    s_cbranch_scc1 L_t1_loop
L_t1_diag:
    s_waitcnt lgkmcnt(7)
    v_mfma_f32_16x16x32_bf16 v[96:99], a[128:131], a[64:67], v[80:83]
    s_waitcnt lgkmcnt(6)
    ds_read_b128 a[160:163], v19 offset:16384
    v_mfma_f32_16x16x32_bf16 v[96:99], a[132:135], a[68:71], v[96:99]
    s_waitcnt lgkmcnt(6)
    ds_read_b128 a[164:167], v19 offset:17408
    v_mfma_f32_16x16x32_bf16 v[96:99], a[136:139], a[72:75], v[96:99]
    s_waitcnt lgkmcnt(6)
    v_exp_f32 v112, v112
    v_mfma_f32_16x16x32_bf16 v[96:99], a[140:143], a[76:79], v[96:99]
    buffer_load_dwordx4 v15, s[8:11], s19 offen offset:2048  lds
    v_mfma_f32_16x16x32_bf16 v[104:107], a[128:131], a[80:83], v[88:91]
    v_exp_f32 v113, v113
    v_mfma_f32_16x16x32_bf16 v[104:107], a[132:135], a[84:87], v[104:107]
    ds_read_b128 a[168:171], v19 offset:18432
    v_cvt_pk_bf16_f32 v56, v112, v113
    v_mfma_f32_16x16x32_bf16 v[104:107], a[136:139], a[88:91], v[104:107]
    s_waitcnt lgkmcnt(6)
    v_exp_f32 v114, v114
    v_mfma_f32_16x16x32_bf16 v[104:107], a[140:143], a[92:95], v[104:107]
    buffer_load_dwordx4 v15, s[8:11], s19 offen offset:3072  lds
    v_mfma_f32_16x16x32_bf16 v[100:103], a[144:147], a[64:67], v[84:87]
    s_waitcnt lgkmcnt(5)
    s_xor_b32 s16, s16, 98304
    v_exp_f32 v115, v115
    v_mfma_f32_16x16x32_bf16 v[100:103], a[148:151], a[68:71], v[100:103]
    s_waitcnt lgkmcnt(4)
    ds_read_b128 a[172:175], v19 offset:19456
    v_cvt_pk_bf16_f32 v57, v114, v115
    v_mfma_f32_16x16x32_bf16 v[100:103], a[152:155], a[72:75], v[100:103]
    s_waitcnt lgkmcnt(4)
    v_exp_f32 v116, v116
    v_mfma_f32_16x16x32_bf16 v[100:103], a[156:159], a[76:79], v[100:103]
    v_mfma_f32_16x16x32_bf16 v[108:111], a[144:147], a[80:83], v[92:95]
    v_exp_f32 v117, v117
    v_mfma_f32_16x16x32_bf16 v[108:111], a[148:151], a[84:87], v[108:111]
    ds_read_b128 a[176:179], v20 offset:20480
    v_cvt_pk_bf16_f32 v58, v116, v117
    v_mfma_f32_16x16x32_bf16 v[108:111], a[152:155], a[88:91], v[108:111]
    v_exp_f32 v118, v118
    v_mfma_f32_16x16x32_bf16 v[108:111], a[156:159], a[92:95], v[108:111]
    v_mfma_f32_16x16x32_bf16 v[32:35], v[28:31], v[48:51], v[32:35]
    v_exp_f32 v119, v119
    v_mfma_f32_16x16x32_bf16 v[36:39], v[28:31], v[52:55], v[36:39]
    s_waitcnt lgkmcnt(4)
    ds_read_b128 a[180:183], v20 offset:21504
    v_cvt_pk_bf16_f32 v59, v118, v119
    v_mfma_f32_16x16x32_bf16 v[128:131], a[160:163], v[48:51], v[128:131]
    v_exp_f32 v120, v120
    v_mfma_f32_16x16x32_bf16 v[160:163], a[160:163], v[52:55], v[160:163]
    s_waitcnt lgkmcnt(4)
    v_add_f32 v80, 0, v22
    v_min_f32 v80, v80, v72
    v_mfma_f32_16x16x32_bf16 v[132:135], a[164:167], v[48:51], v[132:135]
    v_exp_f32 v121, v121
    v_mfma_f32_16x16x32_bf16 v[164:167], a[164:167], v[52:55], v[164:167]
    s_waitcnt lgkmcnt(3)
    ds_read_b128 a[184:187], v20 offset:22528
    v_cvt_pk_bf16_f32 v60, v120, v121
    v_mfma_f32_16x16x32_bf16 v[136:139], a[168:171], v[48:51], v[136:139]
    v_exp_f32 v122, v122
    v_mfma_f32_16x16x32_bf16 v[168:171], a[168:171], v[52:55], v[168:171]
    s_waitcnt lgkmcnt(3)
    v_add_f32 v81, 0xf1800000, v22
    v_min_f32 v81, v81, v73
    v_mfma_f32_16x16x32_bf16 v[140:143], a[172:175], v[48:51], v[140:143]
    v_exp_f32 v123, v123
    v_mfma_f32_16x16x32_bf16 v[172:175], a[172:175], v[52:55], v[172:175]
    s_waitcnt lgkmcnt(2)
    ds_read_b128 a[188:191], v20 offset:23552
    v_cvt_pk_bf16_f32 v61, v122, v123
    v_mfma_f32_16x16x32_bf16 v[144:147], a[176:179], v[48:51], v[144:147]
    v_exp_f32 v124, v124
    v_mfma_f32_16x16x32_bf16 v[176:179], a[176:179], v[52:55], v[176:179]
    s_waitcnt lgkmcnt(2)
    v_add_f32 v82, 0xf2000000, v22
    v_min_f32 v82, v82, v74
    v_mfma_f32_16x16x32_bf16 v[148:151], a[180:183], v[48:51], v[148:151]
    v_exp_f32 v125, v125
    v_mfma_f32_16x16x32_bf16 v[180:183], a[180:183], v[52:55], v[180:183]
    s_waitcnt lgkmcnt(1)
    v_cvt_pk_bf16_f32 v62, v124, v125
    v_xor_b32 v19, 98304, v19
    v_mfma_f32_16x16x32_bf16 v[152:155], a[184:187], v[48:51], v[152:155]
    v_exp_f32 v126, v126
    v_mfma_f32_16x16x32_bf16 v[184:187], a[184:187], v[52:55], v[184:187]
    s_waitcnt lgkmcnt(0)
    v_xor_b32 v20, 98304, v20
    v_add_f32 v83, 0xf2400000, v22
    v_mfma_f32_16x16x32_bf16 v[156:159], a[188:191], v[48:51], v[156:159]
    v_exp_f32 v127, v127
    v_mfma_f32_16x16x32_bf16 v[188:191], a[188:191], v[52:55], v[188:191]
    v_cvt_pk_bf16_f32 v63, v126, v127
    v_min_f32 v83, v83, v75
    v_add_f32 v84, 0xf3800000, v22
    v_min_f32 v84, v84, v72
    v_mfma_f32_16x16x32_bf16 v[112:115], a[128:131], a[96:99], v[72:75]
    v_exp_f32 v96, v96
    v_mfma_f32_16x16x32_bf16 v[112:115], a[132:135], a[100:103], v[112:115]
    v_mfma_f32_16x16x32_bf16 v[112:115], a[136:139], a[104:107], v[112:115]
    v_exp_f32 v97, v97
    v_mfma_f32_16x16x32_bf16 v[112:115], a[140:143], a[108:111], v[112:115]
    v_cvt_pk_bf16_f32 v48, v96, v97
    v_add_f32 v85, 0xf3880000, v22
    v_mfma_f32_16x16x32_bf16 v[120:123], a[128:131], a[112:115], v[76:79]
    v_exp_f32 v98, v98
    v_mfma_f32_16x16x32_bf16 v[120:123], a[132:135], a[116:119], v[120:123]
    v_min_f32 v85, v85, v73
    v_add_f32 v86, 0xf3900000, v22
    v_mfma_f32_16x16x32_bf16 v[120:123], a[136:139], a[120:123], v[120:123]
    v_exp_f32 v99, v99
    v_mfma_f32_16x16x32_bf16 v[120:123], a[140:143], a[124:127], v[120:123]
    v_min_f32 v86, v86, v74
    v_add_f32 v87, 0xf3980000, v22
    v_mfma_f32_16x16x32_bf16 v[116:119], a[144:147], a[96:99], v[72:75]
    v_exp_f32 v100, v100
    v_mfma_f32_16x16x32_bf16 v[116:119], a[148:151], a[100:103], v[116:119]
    ds_read_b128 a[128:131], v18 offset:16384
    v_cvt_pk_bf16_f32 v49, v98, v99
    v_mfma_f32_16x16x32_bf16 v[116:119], a[152:155], a[104:107], v[116:119]
    s_add_u32 s19, s82, 32768
    v_exp_f32 v101, v101
    v_mfma_f32_16x16x32_bf16 v[116:119], a[156:159], a[108:111], v[116:119]
    s_sub_u32 s82, s12, s13
    ds_read_b128 a[132:135], v18 offset:17408
    v_cvt_pk_bf16_f32 v50, v100, v101
    v_mfma_f32_16x16x32_bf16 v[124:127], a[144:147], a[112:115], v[76:79]
    s_sub_u32 s82, s82, 1
    v_exp_f32 v102, v102
    v_mfma_f32_16x16x32_bf16 v[124:127], a[148:151], a[116:119], v[124:127]
    s_cmp_gt_u32 s12, s13
    s_cselect_b32 s82, s82, s12
    s_lshl_b32 s82, s82, 16
    ds_read_b128 a[136:139], v18 offset:18432
    v_mfma_f32_16x16x32_bf16 v[124:127], a[152:155], a[120:123], v[124:127]
    s_add_u32 s82, s82, s81
    v_exp_f32 v103, v103
    v_mfma_f32_16x16x32_bf16 v[124:127], a[156:159], a[124:127], v[124:127]
    s_cmp_ge_u32 s12, 17
    s_cselect_b32 s82, 2147471360, s82
    ds_read_b128 a[140:143], v18 offset:19456
    v_cvt_pk_bf16_f32 v51, v102, v103
    v_mfma_f32_16x16x32_bf16 v[40:43], v[28:31], v[56:59], v[40:43]
    s_add_u32 s12, s12, 1
    v_exp_f32 v104, v104
    v_mfma_f32_16x16x32_bf16 v[44:47], v[28:31], v[60:63], v[44:47]
    ds_read_b128 a[144:147], v18 offset:20480
    v_min_f32 v87, v87, v75
    v_mfma_f32_16x16x32_bf16 v[192:195], a[160:163], v[56:59], v[192:195]
    v_exp_f32 v105, v105
    v_mfma_f32_16x16x32_bf16 v[224:227], a[160:163], v[60:63], v[224:227]
    ds_read_b128 a[148:151], v18 offset:21504
    v_cvt_pk_bf16_f32 v52, v104, v105
    v_mfma_f32_16x16x32_bf16 v[196:199], a[164:167], v[56:59], v[196:199]
    v_exp_f32 v106, v106
    v_mfma_f32_16x16x32_bf16 v[228:231], a[164:167], v[60:63], v[228:231]
    ds_read_b128 a[152:155], v18 offset:22528
    v_add_f32 v88, 0x73800000, v22
    v_mfma_f32_16x16x32_bf16 v[200:203], a[168:171], v[56:59], v[200:203]
    v_exp_f32 v107, v107
    v_mfma_f32_16x16x32_bf16 v[232:235], a[168:171], v[60:63], v[232:235]
    ds_read_b128 a[156:159], v18 offset:23552
    v_cvt_pk_bf16_f32 v53, v106, v107
    v_mfma_f32_16x16x32_bf16 v[204:207], a[172:175], v[56:59], v[204:207]
    v_exp_f32 v108, v108
    v_mfma_f32_16x16x32_bf16 v[236:239], a[172:175], v[60:63], v[236:239]
    v_min_f32 v88, v88, v76
    v_add_f32 v89, 0x73700000, v22
    v_mfma_f32_16x16x32_bf16 v[208:211], a[176:179], v[56:59], v[208:211]
    v_exp_f32 v109, v109
    v_mfma_f32_16x16x32_bf16 v[240:243], a[176:179], v[60:63], v[240:243]
    v_cvt_pk_bf16_f32 v54, v108, v109
    v_xor_b32 v18, 196608, v18
    v_mfma_f32_16x16x32_bf16 v[212:215], a[180:183], v[56:59], v[212:215]
    v_exp_f32 v110, v110
    v_mfma_f32_16x16x32_bf16 v[244:247], a[180:183], v[60:63], v[244:247]
    v_min_f32 v89, v89, v77
    v_add_f32 v90, 0x73600000, v22
    v_mfma_f32_16x16x32_bf16 v[216:219], a[184:187], v[56:59], v[216:219]
    v_exp_f32 v111, v111
    v_mfma_f32_16x16x32_bf16 v[248:251], a[184:187], v[60:63], v[248:251]
    v_cvt_pk_bf16_f32 v55, v110, v111
    v_min_f32 v90, v90, v78
    v_mfma_f32_16x16x32_bf16 v[220:223], a[188:191], v[56:59], v[220:223]
    v_add_f32 v91, 0x73500000, v22
    v_min_f32 v91, v91, v79
    v_mfma_f32_16x16x32_bf16 v[252:255], a[188:191], v[60:63], v[252:255]
    v_add_f32 v92, 0, v22
    v_min_f32 v92, v92, v76
    v_add_f32 v93, 0xf1800000, v22
    v_min_f32 v93, v93, v77
    v_add_f32 v94, 0xf2000000, v22
    v_min_f32 v94, v94, v78
    v_add_f32 v95, 0xf2400000, v22
    v_min_f32 v95, v95, v79
    s_waitcnt vmcnt(0) lgkmcnt(0)
    s_barrier
    v_mfma_f32_16x16x32_bf16 v[96:99], a[128:131], a[96:99], v[80:83]
    s_xor_b32 s100, s16, 8192
    ds_read_b128 a[176:179], v20 offset:4096
    v_lshrrev_b32 v13, 1, v1
    v_mfma_f32_16x16x32_bf16 v[96:99], a[132:135], a[100:103], v[96:99]
    s_add_u32 m0, s15, 0
    ds_read_b128 a[180:183], v20 offset:5120
    v_add_u32 v12, s100, v13
    v_mfma_f32_16x16x32_bf16 v[96:99], a[136:139], a[104:107], v[96:99]
    buffer_load_dwordx4 v1, s[8:11], s82 offen offset:0  lds
    v_exp_f32 v112, v112
    v_mfma_f32_16x16x32_bf16 v[96:99], a[140:143], a[108:111], v[96:99]
    v_exp_f32 v113, v113
    v_mfma_f32_16x16x32_bf16 v[100:103], a[144:147], a[96:99], v[84:87]
    ds_read_b128 a[184:187], v20 offset:6144
    v_cvt_pk_bf16_f32 v56, v112, v113
    v_mfma_f32_16x16x32_bf16 v[100:103], a[148:151], a[100:103], v[100:103]
    v_exp_f32 v114, v114
    v_mfma_f32_16x16x32_bf16 v[100:103], a[152:155], a[104:107], v[100:103]
    buffer_load_dwordx4 v1, s[8:11], s82 offen offset:1024  lds
    v_exp_f32 v115, v115
    v_mfma_f32_16x16x32_bf16 v[100:103], a[156:159], a[108:111], v[100:103]
    ds_read_b128 a[188:191], v20 offset:7168
    v_cvt_pk_bf16_f32 v57, v114, v115
    v_mfma_f32_16x16x32_bf16 v[104:107], a[128:131], a[112:115], v[88:91]
    v_exp_f32 v116, v116
    v_mfma_f32_16x16x32_bf16 v[104:107], a[132:135], a[116:119], v[104:107]
    v_exp_f32 v117, v117
    v_mfma_f32_16x16x32_bf16 v[104:107], a[136:139], a[120:123], v[104:107]
    ds_read_b128 a[160:163], v19 offset:0
    v_cvt_pk_bf16_f32 v58, v116, v117
    v_mfma_f32_16x16x32_bf16 v[104:107], a[140:143], a[124:127], v[104:107]
    buffer_load_dwordx4 v1, s[8:11], s82 offen offset:2048  lds
    v_exp_f32 v118, v118
    v_mfma_f32_16x16x32_bf16 v[108:111], a[144:147], a[112:115], v[92:95]
    v_exp_f32 v119, v119
    v_mfma_f32_16x16x32_bf16 v[108:111], a[148:151], a[116:119], v[108:111]
    ds_read_b128 a[164:167], v19 offset:1024
    v_cvt_pk_bf16_f32 v59, v118, v119
    v_mfma_f32_16x16x32_bf16 v[108:111], a[152:155], a[120:123], v[108:111]
    v_exp_f32 v120, v120
    v_mfma_f32_16x16x32_bf16 v[108:111], a[156:159], a[124:127], v[108:111]
    buffer_load_dwordx4 v1, s[8:11], s82 offen offset:3072  lds
    v_exp_f32 v121, v121
    v_mfma_f32_16x16x32_bf16 v[32:35], v[28:31], v[48:51], v[32:35]
    s_add_u32 m0, s15, 4096
    ds_read_b128 a[168:171], v19 offset:2048
    v_cvt_pk_bf16_f32 v60, v120, v121
    v_mfma_f32_16x16x32_bf16 v[36:39], v[28:31], v[52:55], v[36:39]
    s_waitcnt lgkmcnt(6)
    v_exp_f32 v122, v122
    v_mfma_f32_16x16x32_bf16 v[144:147], a[176:179], v[48:51], v[144:147]
    v_exp_f32 v123, v123
    v_mfma_f32_16x16x32_bf16 v[176:179], a[176:179], v[52:55], v[176:179]
    s_waitcnt lgkmcnt(5)
    ds_read_b128 a[172:175], v19 offset:3072
    v_cvt_pk_bf16_f32 v61, v122, v123
    v_mfma_f32_16x16x32_bf16 v[148:151], a[180:183], v[48:51], v[148:151]
    buffer_load_dwordx4 v15, s[8:11], s82 offen offset:0  lds
    v_exp_f32 v124, v124
    v_mfma_f32_16x16x32_bf16 v[180:183], a[180:183], v[52:55], v[180:183]
    s_waitcnt lgkmcnt(5)
    v_exp_f32 v125, v125
    v_mfma_f32_16x16x32_bf16 v[152:155], a[184:187], v[48:51], v[152:155]
    s_waitcnt lgkmcnt(4)
    v_exp_f32 v126, v126
    v_mfma_f32_16x16x32_bf16 v[184:187], a[184:187], v[52:55], v[184:187]
    buffer_load_dwordx4 v15, s[8:11], s82 offen offset:1024  lds
    v_exp_f32 v127, v127
    v_mfma_f32_16x16x32_bf16 v[156:159], a[188:191], v[48:51], v[156:159]
    ds_write_b128 v16, v[144:147] offset:32768
    v_cvt_pk_bf16_f32 v62, v124, v125
    v_mfma_f32_16x16x32_bf16 v[188:191], a[188:191], v[52:55], v[188:191]
    s_waitcnt lgkmcnt(4)
    v_exp_f32 v96, v96
    v_mfma_f32_16x16x32_bf16 v[128:131], a[160:163], v[48:51], v[128:131]
    v_exp_f32 v97, v97
    v_mfma_f32_16x16x32_bf16 v[160:163], a[160:163], v[52:55], v[160:163]
    s_waitcnt lgkmcnt(3)
    ds_write_b128 v16, v[176:179] offset:33792
    v_cvt_pk_bf16_f32 v63, v126, v127
    v_mfma_f32_16x16x32_bf16 v[132:135], a[164:167], v[48:51], v[132:135]
    s_waitcnt lgkmcnt(3)
    v_exp_f32 v98, v98
    v_mfma_f32_16x16x32_bf16 v[164:167], a[164:167], v[52:55], v[164:167]
    buffer_load_dwordx4 v15, s[8:11], s82 offen offset:2048  lds
    v_exp_f32 v99, v99
    v_mfma_f32_16x16x32_bf16 v[136:139], a[168:171], v[48:51], v[136:139]
    ds_write_b128 v16, v[148:151] offset:34816
    v_mfma_f32_16x16x32_bf16 v[168:171], a[168:171], v[52:55], v[168:171]
    s_waitcnt lgkmcnt(3)
    v_exp_f32 v100, v100
    v_mfma_f32_16x16x32_bf16 v[140:143], a[172:175], v[48:51], v[140:143]
    v_exp_f32 v101, v101
    v_mfma_f32_16x16x32_bf16 v[172:175], a[172:175], v[52:55], v[172:175]
    ds_write_b128 v16, v[180:183] offset:35840
    v_mov_b32 v33, v36
    v_mfma_f32_16x16x32_bf16 v[40:43], v[28:31], v[56:59], v[40:43]
    buffer_load_dwordx4 v15, s[8:11], s82 offen offset:3072  lds
    v_exp_f32 v102, v102
    v_mfma_f32_16x16x32_bf16 v[44:47], v[28:31], v[60:63], v[44:47]
    s_xor_b32 s15, s15, 196608
    v_exp_f32 v103, v103
    v_mfma_f32_16x16x32_bf16 v[208:211], a[176:179], v[56:59], v[208:211]
    ds_write_b128 v16, v[152:155] offset:36864
    v_cvt_pk_bf16_f32 v48, v96, v97
    v_mfma_f32_16x16x32_bf16 v[240:243], a[176:179], v[60:63], v[240:243]
    ds_read_b128 a[176:179], v20 offset:20480
    v_exp_f32 v104, v104
    v_mfma_f32_16x16x32_bf16 v[212:215], a[180:183], v[56:59], v[212:215]
    v_exp_f32 v105, v105
    v_mfma_f32_16x16x32_bf16 v[244:247], a[180:183], v[60:63], v[244:247]
    ds_read_b128 a[180:183], v20 offset:21504
    v_exp_f32 v106, v106
    v_mfma_f32_16x16x32_bf16 v[216:219], a[184:187], v[56:59], v[216:219]
    ds_write_b128 v16, v[184:187] offset:37888
    v_cvt_pk_bf16_f32 v49, v98, v99
    v_mfma_f32_16x16x32_bf16 v[248:251], a[184:187], v[60:63], v[248:251]
    ds_read_b128 a[184:187], v20 offset:22528
    v_exp_f32 v107, v107
    v_mfma_f32_16x16x32_bf16 v[220:223], a[188:191], v[56:59], v[220:223]
    v_exp_f32 v108, v108
    v_mfma_f32_16x16x32_bf16 v[252:255], a[188:191], v[60:63], v[252:255]
    ds_read_b128 a[188:191], v20 offset:23552
    v_exp_f32 v109, v109
    v_mfma_f32_16x16x32_bf16 v[192:195], a[160:163], v[56:59], v[192:195]
    ds_write_b128 v16, v[156:159] offset:38912
    v_cvt_pk_bf16_f32 v50, v100, v101
    v_mfma_f32_16x16x32_bf16 v[224:227], a[160:163], v[60:63], v[224:227]
    ds_read_b128 a[160:163], v19 offset:16384
    v_exp_f32 v110, v110
    v_mfma_f32_16x16x32_bf16 v[196:199], a[164:167], v[56:59], v[196:199]
    v_exp_f32 v111, v111
    v_mfma_f32_16x16x32_bf16 v[228:231], a[164:167], v[60:63], v[228:231]
    ds_read_b128 a[164:167], v19 offset:17408
    v_cvt_pk_bf16_f32 v51, v102, v103
    v_mfma_f32_16x16x32_bf16 v[200:203], a[168:171], v[56:59], v[200:203]
    ds_write_b128 v16, v[188:191] offset:39936
    v_cvt_pk_bf16_f32 v52, v104, v105
    v_mfma_f32_16x16x32_bf16 v[232:235], a[168:171], v[60:63], v[232:235]
    ds_read_b128 a[168:171], v19 offset:18432
    v_cvt_pk_bf16_f32 v53, v106, v107
    v_mfma_f32_16x16x32_bf16 v[204:207], a[172:175], v[56:59], v[204:207]
    v_cvt_pk_bf16_f32 v54, v108, v109
    v_cvt_pk_bf16_f32 v55, v110, v111
    v_mfma_f32_16x16x32_bf16 v[236:239], a[172:175], v[60:63], v[236:239]
    ds_read_b128 a[172:175], v19 offset:19456
    ds_write_b64 v12, v[32:33]
    s_xor_b32 s101, s16, 98304
    v_xor_b32 v12, 8192, v12
    v_add_u32 v9, s101, v1
    v_xor_b32 v8, 8192, v16
    v_xor_b32 v10, 8192, v9
L_t1_join:
    v_xor_b32 v19, 98304, v19
    v_xor_b32 v20, 98304, v20
    s_waitcnt lgkmcnt(0)
    s_barrier
    v_mfma_f32_16x16x32_bf16 v[40:43], v[28:31], v[48:51], v[40:43]
    s_lshl_b32 s100, s60, 20
    s_add_u32 s101, s100, s21
    ds_read_b64 v[120:121], v12
    v_mfma_f32_16x16x32_bf16 v[44:47], v[28:31], v[52:55], v[44:47]
    s_add_u32 s100, s100, s20
    ds_read_b128 v[144:147], v8 offset:32768
    v_lshrrev_b32 v11, 4, v2
    v_mfma_f32_16x16x32_bf16 v[208:211], a[176:179], v[48:51], v[208:211]
    ds_read_b128 v[176:179], v8 offset:33792
    v_lshrrev_b32 v13, 2, v1
    v_mfma_f32_16x16x32_bf16 v[240:243], a[176:179], v[52:55], v[240:243]
    ds_read_b128 v[148:151], v8 offset:34816
    v_add_u32 v13, 32768, v13
    v_mfma_f32_16x16x32_bf16 v[212:215], a[180:183], v[48:51], v[212:215]
    s_xor_b32 s99, s62, 8192
    ds_read_b128 v[180:183], v8 offset:35840
    v_add_u32 v14, s99, v13
    v_mfma_f32_16x16x32_bf16 v[244:247], a[180:183], v[52:55], v[244:247]
    ds_read_b128 v[152:155], v8 offset:36864
    v_cmp_eq_u32 vcc, 1, v11
    v_mfma_f32_16x16x32_bf16 v[216:219], a[184:187], v[48:51], v[216:219]
    ds_read_b128 v[184:187], v8 offset:37888
    s_waitcnt lgkmcnt(6)
    v_add_f32 v112, v120, v32
    v_mfma_f32_16x16x32_bf16 v[248:251], a[184:187], v[52:55], v[248:251]
    ds_read_b128 v[156:159], v8 offset:38912
    v_add_f32 v114, v121, v36
    v_mfma_f32_16x16x32_bf16 v[220:223], a[188:191], v[48:51], v[220:223]
    ds_read_b128 v[188:191], v8 offset:39936
    v_cndmask_b32 v12, v32, v36, vcc
    v_mfma_f32_16x16x32_bf16 v[252:255], a[188:191], v[52:55], v[252:255]
    v_rcp_f32 v112, v112
    v_mfma_f32_16x16x32_bf16 v[192:195], a[160:163], v[48:51], v[192:195]
    v_rcp_f32 v114, v114
    v_mfma_f32_16x16x32_bf16 v[224:227], a[160:163], v[52:55], v[224:227]
    v_cmp_eq_u32 vcc, 2, v11
    v_cmp_eq_u32 s[96:97], 3, v11
    v_mfma_f32_16x16x32_bf16 v[196:199], a[164:167], v[48:51], v[196:199]
    ds_write_b128 v9, v[208:211] offset:0
    v_mfma_f32_16x16x32_bf16 v[228:231], a[164:167], v[52:55], v[228:231]
    v_mfma_f32_16x16x32_bf16 v[200:203], a[168:171], v[48:51], v[200:203]
    ds_write_b128 v9, v[240:243] offset:1024
    v_mfma_f32_16x16x32_bf16 v[232:235], a[168:171], v[52:55], v[232:235]
    v_mfma_f32_16x16x32_bf16 v[204:207], a[172:175], v[48:51], v[204:207]
    ds_write_b128 v9, v[212:215] offset:2048
    v_mfma_f32_16x16x32_bf16 v[236:239], a[172:175], v[52:55], v[236:239]
    v_cndmask_b32 v12, v12, v40, vcc
    v_cndmask_b32 v12, v12, v44, s[96:97]
    ds_write_b128 v9, v[244:247] offset:3072
    s_waitcnt lgkmcnt(11)
    v_pk_add_f32 v[128:129], v[128:129], v[144:145]
    v_pk_add_f32 v[130:131], v[130:131], v[146:147]
    s_waitcnt lgkmcnt(9)
    v_pk_add_f32 v[132:133], v[132:133], v[148:149]
    v_pk_add_f32 v[134:135], v[134:135], v[150:151]
    v_pk_mul_f32 v[128:129], v[128:129], v[112:113] op_sel_hi:[1,0]
    v_pk_mul_f32 v[130:131], v[130:131], v[112:113] op_sel_hi:[1,0]
    v_pk_mul_f32 v[132:133], v[132:133], v[112:113] op_sel_hi:[1,0]
    v_pk_mul_f32 v[134:135], v[134:135], v[112:113] op_sel_hi:[1,0]
    v_cvt_pk_bf16_f32 v128, v128, v129
    v_cvt_pk_bf16_f32 v129, v130, v131
    v_cvt_pk_bf16_f32 v130, v132, v133
    s_add_u32 m0, s16, 0
    ds_write_b128 v9, v[216:219] offset:4096
    v_cvt_pk_bf16_f32 v131, v134, v135
    buffer_store_dwordx4 v[128:131], v1, s[8:11], s100 offen offset:0 sc0 sc1
    s_waitcnt lgkmcnt(8)
    v_pk_add_f32 v[136:137], v[136:137], v[152:153]
    v_pk_add_f32 v[138:139], v[138:139], v[154:155]
    s_waitcnt lgkmcnt(6)
    v_pk_add_f32 v[140:141], v[140:141], v[156:157]
    v_pk_add_f32 v[142:143], v[142:143], v[158:159]
    v_pk_mul_f32 v[136:137], v[136:137], v[112:113] op_sel_hi:[1,0]
    v_pk_mul_f32 v[138:139], v[138:139], v[112:113] op_sel_hi:[1,0]
    v_pk_mul_f32 v[140:141], v[140:141], v[112:113] op_sel_hi:[1,0]
    v_pk_mul_f32 v[142:143], v[142:143], v[112:113] op_sel_hi:[1,0]
    v_cvt_pk_bf16_f32 v136, v136, v137
    buffer_load_dwordx4 v1, s[8:11], s19 offen offset:0  lds
    ds_write_b128 v9, v[248:251] offset:5120
    v_cvt_pk_bf16_f32 v137, v138, v139
    v_cvt_pk_bf16_f32 v138, v140, v141
    v_cvt_pk_bf16_f32 v139, v142, v143
    buffer_store_dwordx4 v[136:139], v1, s[8:11], s100 offen offset:1024 sc0 sc1
    v_pk_add_f32 v[160:161], v[160:161], v[176:177]
    v_pk_add_f32 v[162:163], v[162:163], v[178:179]
    v_pk_add_f32 v[164:165], v[164:165], v[180:181]
    v_pk_add_f32 v[166:167], v[166:167], v[182:183]
    v_pk_mul_f32 v[160:161], v[160:161], v[114:115] op_sel_hi:[1,0]
    v_pk_mul_f32 v[162:163], v[162:163], v[114:115] op_sel_hi:[1,0]
    v_pk_mul_f32 v[164:165], v[164:165], v[114:115] op_sel_hi:[1,0]
    buffer_load_dwordx4 v1, s[8:11], s19 offen offset:1024  lds
    ds_write_b128 v9, v[220:223] offset:6144
    v_pk_mul_f32 v[166:167], v[166:167], v[114:115] op_sel_hi:[1,0]
    v_cvt_pk_bf16_f32 v160, v160, v161
    v_cvt_pk_bf16_f32 v161, v162, v163
    v_cvt_pk_bf16_f32 v162, v164, v165
    v_cvt_pk_bf16_f32 v163, v166, v167
    buffer_store_dwordx4 v[160:163], v15, s[8:11], s100 offen offset:0 sc0 sc1
    v_pk_add_f32 v[168:169], v[168:169], v[184:185]
    v_pk_add_f32 v[170:171], v[170:171], v[186:187]
    s_waitcnt lgkmcnt(7)
    v_pk_add_f32 v[172:173], v[172:173], v[188:189]
    v_pk_add_f32 v[174:175], v[174:175], v[190:191]
    v_pk_mul_f32 v[168:169], v[168:169], v[114:115] op_sel_hi:[1,0]
    buffer_load_dwordx4 v1, s[8:11], s19 offen offset:2048  lds
    ds_write_b128 v9, v[252:255] offset:7168
    v_pk_mul_f32 v[170:171], v[170:171], v[114:115] op_sel_hi:[1,0]
    v_pk_mul_f32 v[172:173], v[172:173], v[114:115] op_sel_hi:[1,0]
    v_pk_mul_f32 v[174:175], v[174:175], v[114:115] op_sel_hi:[1,0]
    v_cvt_pk_bf16_f32 v168, v168, v169
    v_cvt_pk_bf16_f32 v169, v170, v171
    v_cvt_pk_bf16_f32 v170, v172, v173
    v_cvt_pk_bf16_f32 v171, v174, v175
    buffer_store_dwordx4 v[168:171], v15, s[8:11], s100 offen offset:1024 sc0 sc1
    buffer_load_dwordx4 v1, s[8:11], s19 offen offset:3072  lds
    ds_write_b32 v14, v12
    v_and_b32 v14, 4294967103, v13
    v_add_u32 v14, s62, v14
    s_waitcnt lgkmcnt(0)
    s_barrier
    ds_read_b32 v116, v14 offset:128
    ds_read_b32 v118, v14 offset:192
    ds_read_b128 v[208:211], v10 offset:0
    ds_read_b128 v[212:215], v10 offset:2048
    ds_read_b128 v[216:219], v10 offset:4096
    ds_read_b128 v[220:223], v10 offset:6144
    ds_read_b128 v[240:243], v10 offset:1024
    ds_read_b128 v[244:247], v10 offset:3072
    ds_read_b128 v[248:251], v10 offset:5120
    ds_read_b128 v[252:255], v10 offset:7168
    ds_read_b32 v120, v13 offset:0
    ds_read_b32 v121, v13 offset:8192
    ds_read_b32 v122, v13 offset:16384
    ds_read_b32 v123, v13 offset:24576
    s_waitcnt lgkmcnt(13)
    v_add_f32 v116, v116, v40
    s_waitcnt lgkmcnt(12)
    v_add_f32 v118, v118, v44
    v_rcp_f32 v116, v116
    v_rcp_f32 v118, v118
    s_waitcnt lgkmcnt(11)
    v_pk_add_f32 v[192:193], v[192:193], v[208:209]
    v_pk_add_f32 v[194:195], v[194:195], v[210:211]
    s_waitcnt lgkmcnt(10)
    v_pk_add_f32 v[196:197], v[196:197], v[212:213]
    v_pk_add_f32 v[198:199], v[198:199], v[214:215]
    v_pk_mul_f32 v[192:193], v[192:193], v[116:117] op_sel_hi:[1,0]
    v_pk_mul_f32 v[194:195], v[194:195], v[116:117] op_sel_hi:[1,0]
    v_pk_mul_f32 v[196:197], v[196:197], v[116:117] op_sel_hi:[1,0]
    v_pk_mul_f32 v[198:199], v[198:199], v[116:117] op_sel_hi:[1,0]
    v_cvt_pk_bf16_f32 v192, v192, v193
    v_cvt_pk_bf16_f32 v193, v194, v195
    v_cvt_pk_bf16_f32 v194, v196, v197
    v_cvt_pk_bf16_f32 v195, v198, v199
    buffer_store_dwordx4 v[192:195], v1, s[8:11], s101 offen offset:0 sc0 sc1
    s_add_u32 m0, s16, 4096
    s_waitcnt lgkmcnt(9)
    v_pk_add_f32 v[200:201], v[200:201], v[216:217]
    v_pk_add_f32 v[202:203], v[202:203], v[218:219]
    s_waitcnt lgkmcnt(8)
    v_pk_add_f32 v[204:205], v[204:205], v[220:221]
    v_pk_add_f32 v[206:207], v[206:207], v[222:223]
    v_pk_mul_f32 v[200:201], v[200:201], v[116:117] op_sel_hi:[1,0]
    v_pk_mul_f32 v[202:203], v[202:203], v[116:117] op_sel_hi:[1,0]
    v_pk_mul_f32 v[204:205], v[204:205], v[116:117] op_sel_hi:[1,0]
    v_pk_mul_f32 v[206:207], v[206:207], v[116:117] op_sel_hi:[1,0]
    v_cvt_pk_bf16_f32 v200, v200, v201
    v_cvt_pk_bf16_f32 v201, v202, v203
    v_cvt_pk_bf16_f32 v202, v204, v205
    v_cvt_pk_bf16_f32 v203, v206, v207
    buffer_store_dwordx4 v[200:203], v1, s[8:11], s101 offen offset:1024 sc0 sc1
    buffer_load_dwordx4 v15, s[8:11], s19 offen offset:0  lds
    buffer_load_dwordx4 v15, s[8:11], s19 offen offset:1024  lds
    s_waitcnt lgkmcnt(2)
    v_add_f32 v120, v120, v121
    s_waitcnt lgkmcnt(0)
    v_add_f32 v122, v122, v123
    v_min_f32 v124, v120, v122
    v_add_f32 v120, v120, v122
    v_cmp_le_f32 vcc, 0x1f800000, v124
    s_mov_b64 s[96:97], vcc
    v_cmp_ge_f32 vcc, 0x67800000, v120
    s_and_b64 s[96:97], s[96:97], vcc
    s_cmp_eq_u64 s[96:97], -1
    s_cselect_b32 s96, s25, 1
    s_cmp_lg_u32 s96, 0
    s_cbranch_scc1 L_t1_redo
L_t1_safe:
    v_pk_add_f32 v[224:225], v[224:225], v[240:241]
    v_pk_add_f32 v[226:227], v[226:227], v[242:243]
    v_pk_add_f32 v[228:229], v[228:229], v[244:245]
    v_pk_add_f32 v[230:231], v[230:231], v[246:247]
    v_pk_mul_f32 v[224:225], v[224:225], v[118:119] op_sel_hi:[1,0]
    v_pk_mul_f32 v[226:227], v[226:227], v[118:119] op_sel_hi:[1,0]
    v_pk_mul_f32 v[228:229], v[228:229], v[118:119] op_sel_hi:[1,0]
    v_pk_mul_f32 v[230:231], v[230:231], v[118:119] op_sel_hi:[1,0]
    v_cvt_pk_bf16_f32 v224, v224, v225
    v_cvt_pk_bf16_f32 v225, v226, v227
    v_cvt_pk_bf16_f32 v226, v228, v229
    v_cvt_pk_bf16_f32 v227, v230, v231
    buffer_store_dwordx4 v[224:227], v15, s[8:11], s101 offen offset:0 sc0 sc1
    buffer_load_dwordx4 v15, s[8:11], s19 offen offset:2048  lds
    ds_read_b128 a[128:131], v18 offset:0
    ds_read_b128 a[132:135], v18 offset:1024
    ds_read_b128 a[136:139], v18 offset:2048
    ds_read_b128 a[140:143], v18 offset:3072
    v_pk_add_f32 v[232:233], v[232:233], v[248:249]
    v_pk_add_f32 v[234:235], v[234:235], v[250:251]
    v_pk_add_f32 v[236:237], v[236:237], v[252:253]
    v_pk_add_f32 v[238:239], v[238:239], v[254:255]
    v_pk_mul_f32 v[232:233], v[232:233], v[118:119] op_sel_hi:[1,0]
    v_pk_mul_f32 v[234:235], v[234:235], v[118:119] op_sel_hi:[1,0]
    v_pk_mul_f32 v[236:237], v[236:237], v[118:119] op_sel_hi:[1,0]
    v_pk_mul_f32 v[238:239], v[238:239], v[118:119] op_sel_hi:[1,0]
    v_cvt_pk_bf16_f32 v232, v232, v233
    v_cvt_pk_bf16_f32 v233, v234, v235
    v_cvt_pk_bf16_f32 v234, v236, v237
    v_cvt_pk_bf16_f32 v235, v238, v239
    buffer_store_dwordx4 v[232:235], v15, s[8:11], s101 offen offset:1024 sc0 sc1
    buffer_load_dwordx4 v15, s[8:11], s19 offen offset:3072  lds
    s_xor_b32 s16, s16, 98304
    ds_read_b128 a[144:147], v18 offset:4096
    ds_read_b128 a[148:151], v18 offset:5120
    ds_read_b128 a[152:155], v18 offset:6144
    ds_read_b128 a[156:159], v18 offset:7168
L_t2_start:
    s_waitcnt lgkmcnt(7)
    v_mfma_f32_16x16x32_bf16 v[96:99], a[128:131], a[192:195], v[64:67]
    s_waitcnt lgkmcnt(6)
    s_add_u32 s19, s82, 32768
    s_sub_u32 s82, s12, s13
    s_sub_u32 s82, s82, 1
    v_mfma_f32_16x16x32_bf16 v[96:99], a[132:135], a[196:199], v[96:99]
    s_waitcnt lgkmcnt(5)
    s_cmp_gt_u32 s12, s13
    s_cselect_b32 s82, s82, s12
    s_lshl_b32 s82, s82, 16
    s_add_u32 s82, s82, s81
    v_mfma_f32_16x16x32_bf16 v[96:99], a[136:139], a[200:203], v[96:99]
    s_waitcnt lgkmcnt(4)
    s_cmp_ge_u32 s12, 17
    s_cselect_b32 s82, 2147471360, s82
    s_add_u32 s12, s12, 1
    s_sub_u32 s14, s61, 8
    v_mfma_f32_16x16x32_bf16 v[96:99], a[140:143], a[204:207], v[96:99]
    s_waitcnt lgkmcnt(3)
    v_mfma_f32_16x16x32_bf16 v[100:103], a[144:147], a[192:195], v[64:67]
    s_waitcnt lgkmcnt(2)
    v_mfma_f32_16x16x32_bf16 v[100:103], a[148:151], a[196:199], v[100:103]
    s_waitcnt lgkmcnt(1)
    v_mfma_f32_16x16x32_bf16 v[100:103], a[152:155], a[200:203], v[100:103]
    s_waitcnt lgkmcnt(0)
    v_mfma_f32_16x16x32_bf16 v[100:103], a[156:159], a[204:207], v[100:103]
    v_mfma_f32_16x16x32_bf16 v[104:107], a[128:131], a[208:211], v[68:71]
    v_exp_f32 v96, v96
    v_mfma_f32_16x16x32_bf16 v[104:107], a[132:135], a[212:215], v[104:107]
    v_exp_f32 v97, v97
    v_mfma_f32_16x16x32_bf16 v[104:107], a[136:139], a[216:219], v[104:107]
    v_exp_f32 v98, v98
    v_mfma_f32_16x16x32_bf16 v[104:107], a[140:143], a[220:223], v[104:107]
    v_exp_f32 v99, v99
    v_mfma_f32_16x16x32_bf16 v[108:111], a[144:147], a[208:211], v[68:71]
    v_exp_f32 v100, v100
    v_mfma_f32_16x16x32_bf16 v[108:111], a[148:151], a[212:215], v[108:111]
    v_exp_f32 v101, v101
    v_mfma_f32_16x16x32_bf16 v[108:111], a[152:155], a[216:219], v[108:111]
    v_exp_f32 v102, v102
    v_mfma_f32_16x16x32_bf16 v[108:111], a[156:159], a[220:223], v[108:111]
    v_exp_f32 v103, v103
    v_mfma_f32_16x16x32_bf16 v[112:115], a[128:131], a[224:227], v[72:75]
    v_exp_f32 v104, v104
    v_mfma_f32_16x16x32_bf16 v[112:115], a[132:135], a[228:231], v[112:115]
    v_exp_f32 v105, v105
    v_mfma_f32_16x16x32_bf16 v[112:115], a[136:139], a[232:235], v[112:115]
    v_exp_f32 v106, v106
    v_mfma_f32_16x16x32_bf16 v[112:115], a[140:143], a[236:239], v[112:115]
    v_exp_f32 v107, v107
    v_mfma_f32_16x16x32_bf16 v[120:123], a[128:131], a[240:243], v[76:79]
    v_exp_f32 v108, v108
    v_mfma_f32_16x16x32_bf16 v[120:123], a[132:135], a[244:247], v[120:123]
    v_exp_f32 v109, v109
    v_mfma_f32_16x16x32_bf16 v[120:123], a[136:139], a[248:251], v[120:123]
    v_exp_f32 v110, v110
    v_mfma_f32_16x16x32_bf16 v[120:123], a[140:143], a[252:255], v[120:123]
    v_exp_f32 v111, v111
    v_mfma_f32_16x16x32_bf16 v[116:119], a[144:147], a[224:227], v[72:75]
    ds_read_b128 a[128:131], v18 offset:16384
    v_cvt_pk_bf16_f32 v48, v96, v97
    v_mfma_f32_16x16x32_bf16 v[116:119], a[148:151], a[228:231], v[116:119]
    ds_read_b128 a[132:135], v18 offset:17408
    v_cvt_pk_bf16_f32 v49, v98, v99
    v_mfma_f32_16x16x32_bf16 v[116:119], a[152:155], a[232:235], v[116:119]
    ds_read_b128 a[136:139], v18 offset:18432
    v_cvt_pk_bf16_f32 v50, v100, v101
    v_mfma_f32_16x16x32_bf16 v[116:119], a[156:159], a[236:239], v[116:119]
    ds_read_b128 a[140:143], v18 offset:19456
    v_cvt_pk_bf16_f32 v51, v102, v103
    v_mfma_f32_16x16x32_bf16 v[124:127], a[144:147], a[240:243], v[76:79]
    ds_read_b128 a[144:147], v18 offset:20480
    v_cvt_pk_bf16_f32 v52, v104, v105
    v_mfma_f32_16x16x32_bf16 v[124:127], a[148:151], a[244:247], v[124:127]
    ds_read_b128 a[148:151], v18 offset:21504
    v_cvt_pk_bf16_f32 v53, v106, v107
    v_mfma_f32_16x16x32_bf16 v[124:127], a[152:155], a[248:251], v[124:127]
    ds_read_b128 a[152:155], v18 offset:22528
    v_cvt_pk_bf16_f32 v54, v108, v109
    v_mfma_f32_16x16x32_bf16 v[124:127], a[156:159], a[252:255], v[124:127]
    ds_read_b128 a[156:159], v18 offset:23552
    v_cvt_pk_bf16_f32 v55, v110, v111
    v_xor_b32 v18, 196608, v18
    s_waitcnt vmcnt(0) lgkmcnt(0)
    s_barrier
    v_mfma_f32_16x16x32_bf16 v[96:99], a[128:131], a[192:195], v[64:67]
    s_add_u32 m0, s15, 0
    ds_read_b128 a[160:163], v19 offset:0
    v_mfma_f32_16x16x32_bf16 v[96:99], a[132:135], a[196:199], v[96:99]
    ds_read_b128 a[164:167], v19 offset:1024
    v_mfma_f32_16x16x32_bf16 v[96:99], a[136:139], a[200:203], v[96:99]
    v_exp_f32 v112, v112
    v_mfma_f32_16x16x32_bf16 v[96:99], a[140:143], a[204:207], v[96:99]
    buffer_load_dwordx4 v1, s[8:11], s82 offen offset:0  lds
    v_mfma_f32_16x16x32_bf16 v[104:107], a[128:131], a[208:211], v[68:71]
    v_exp_f32 v113, v113
    v_mfma_f32_16x16x32_bf16 v[104:107], a[132:135], a[212:215], v[104:107]
    ds_read_b128 a[168:171], v19 offset:2048
    v_cvt_pk_bf16_f32 v56, v112, v113
    v_mfma_f32_16x16x32_bf16 v[104:107], a[136:139], a[216:219], v[104:107]
    v_exp_f32 v114, v114
    v_mfma_f32_16x16x32_bf16 v[104:107], a[140:143], a[220:223], v[104:107]
    buffer_load_dwordx4 v1, s[8:11], s82 offen offset:1024  lds
    v_mfma_f32_16x16x32_bf16 v[100:103], a[144:147], a[192:195], v[64:67]
    v_exp_f32 v115, v115
    v_mfma_f32_16x16x32_bf16 v[100:103], a[148:151], a[196:199], v[100:103]
    ds_read_b128 a[172:175], v19 offset:3072
    v_cvt_pk_bf16_f32 v57, v114, v115
    v_mfma_f32_16x16x32_bf16 v[100:103], a[152:155], a[200:203], v[100:103]
    v_exp_f32 v116, v116
    v_mfma_f32_16x16x32_bf16 v[100:103], a[156:159], a[204:207], v[100:103]
    buffer_load_dwordx4 v1, s[8:11], s82 offen offset:2048  lds
    v_mfma_f32_16x16x32_bf16 v[108:111], a[144:147], a[208:211], v[68:71]
    v_exp_f32 v117, v117
    v_mfma_f32_16x16x32_bf16 v[108:111], a[148:151], a[212:215], v[108:111]
    ds_read_b128 a[176:179], v20 offset:4096
    v_cvt_pk_bf16_f32 v58, v116, v117
    v_mfma_f32_16x16x32_bf16 v[108:111], a[152:155], a[216:219], v[108:111]
    v_exp_f32 v118, v118
    v_mfma_f32_16x16x32_bf16 v[108:111], a[156:159], a[220:223], v[108:111]
    buffer_load_dwordx4 v1, s[8:11], s82 offen offset:3072  lds
    v_mfma_f32_16x16x32_bf16 v[32:35], v[28:31], v[48:51], 0
    s_add_u32 m0, s15, 4096
    v_exp_f32 v119, v119
    v_mfma_f32_16x16x32_bf16 v[36:39], v[28:31], v[52:55], 0
    s_waitcnt lgkmcnt(4)
    ds_read_b128 a[180:183], v20 offset:5120
    v_cvt_pk_bf16_f32 v59, v118, v119
    v_mfma_f32_16x16x32_bf16 v[128:131], a[160:163], v[48:51], 0
    v_exp_f32 v120, v120
    v_mfma_f32_16x16x32_bf16 v[160:163], a[160:163], v[52:55], 0
    s_waitcnt lgkmcnt(4)
    v_mfma_f32_16x16x32_bf16 v[132:135], a[164:167], v[48:51], 0
    v_exp_f32 v121, v121
    v_mfma_f32_16x16x32_bf16 v[164:167], a[164:167], v[52:55], 0
    s_waitcnt lgkmcnt(3)
    ds_read_b128 a[184:187], v20 offset:6144
    v_cvt_pk_bf16_f32 v60, v120, v121
    v_mfma_f32_16x16x32_bf16 v[136:139], a[168:171], v[48:51], 0
    s_waitcnt lgkmcnt(3)
    v_exp_f32 v122, v122
    v_mfma_f32_16x16x32_bf16 v[168:171], a[168:171], v[52:55], 0
    buffer_load_dwordx4 v15, s[8:11], s82 offen offset:0  lds
    v_mfma_f32_16x16x32_bf16 v[140:143], a[172:175], v[48:51], 0
    v_exp_f32 v123, v123
    v_mfma_f32_16x16x32_bf16 v[172:175], a[172:175], v[52:55], 0
    s_waitcnt lgkmcnt(2)
    ds_read_b128 a[188:191], v20 offset:7168
    v_cvt_pk_bf16_f32 v61, v122, v123
    v_mfma_f32_16x16x32_bf16 v[144:147], a[176:179], v[48:51], 0
    s_waitcnt lgkmcnt(2)
    v_exp_f32 v124, v124
    v_mfma_f32_16x16x32_bf16 v[176:179], a[176:179], v[52:55], 0
    buffer_load_dwordx4 v15, s[8:11], s82 offen offset:1024  lds
    v_mfma_f32_16x16x32_bf16 v[148:151], a[180:183], v[48:51], 0
    v_exp_f32 v125, v125
    v_mfma_f32_16x16x32_bf16 v[180:183], a[180:183], v[52:55], 0
    s_waitcnt lgkmcnt(1)
    v_cvt_pk_bf16_f32 v62, v124, v125
    v_mfma_f32_16x16x32_bf16 v[152:155], a[184:187], v[48:51], 0
    s_waitcnt lgkmcnt(0)
    v_exp_f32 v126, v126
    v_mfma_f32_16x16x32_bf16 v[184:187], a[184:187], v[52:55], 0
    buffer_load_dwordx4 v15, s[8:11], s82 offen offset:2048  lds
    v_mfma_f32_16x16x32_bf16 v[156:159], a[188:191], v[48:51], 0
    v_exp_f32 v127, v127
    v_mfma_f32_16x16x32_bf16 v[188:191], a[188:191], v[52:55], 0
    v_cvt_pk_bf16_f32 v63, v126, v127
    v_mfma_f32_16x16x32_bf16 v[112:115], a[128:131], a[224:227], v[72:75]
    v_mfma_f32_16x16x32_bf16 v[112:115], a[132:135], a[228:231], v[112:115]
    v_mfma_f32_16x16x32_bf16 v[112:115], a[136:139], a[232:235], v[112:115]
    v_exp_f32 v96, v96
    v_mfma_f32_16x16x32_bf16 v[112:115], a[140:143], a[236:239], v[112:115]
    buffer_load_dwordx4 v15, s[8:11], s82 offen offset:3072  lds
    v_mfma_f32_16x16x32_bf16 v[120:123], a[128:131], a[240:243], v[76:79]
    s_xor_b32 s15, s15, 196608
    v_exp_f32 v97, v97
    v_mfma_f32_16x16x32_bf16 v[120:123], a[132:135], a[244:247], v[120:123]
    s_add_u32 m0, s16, 0
    ds_read_b128 a[128:131], v18 offset:0
    v_cvt_pk_bf16_f32 v48, v96, v97
    v_mfma_f32_16x16x32_bf16 v[120:123], a[136:139], a[248:251], v[120:123]
    v_exp_f32 v98, v98
    v_mfma_f32_16x16x32_bf16 v[120:123], a[140:143], a[252:255], v[120:123]
    buffer_load_dwordx4 v1, s[8:11], s19 offen offset:0  lds
    v_mfma_f32_16x16x32_bf16 v[116:119], a[144:147], a[224:227], v[72:75]
    v_exp_f32 v99, v99
    v_mfma_f32_16x16x32_bf16 v[116:119], a[148:151], a[228:231], v[116:119]
    ds_read_b128 a[132:135], v18 offset:1024
    v_cvt_pk_bf16_f32 v49, v98, v99
    v_mfma_f32_16x16x32_bf16 v[116:119], a[152:155], a[232:235], v[116:119]
    v_exp_f32 v100, v100
    v_mfma_f32_16x16x32_bf16 v[116:119], a[156:159], a[236:239], v[116:119]
    buffer_load_dwordx4 v1, s[8:11], s19 offen offset:1024  lds
    v_mfma_f32_16x16x32_bf16 v[124:127], a[144:147], a[240:243], v[76:79]
    v_exp_f32 v101, v101
    v_mfma_f32_16x16x32_bf16 v[124:127], a[148:151], a[244:247], v[124:127]
    ds_read_b128 a[136:139], v18 offset:2048
    v_cvt_pk_bf16_f32 v50, v100, v101
    v_mfma_f32_16x16x32_bf16 v[124:127], a[152:155], a[248:251], v[124:127]
    v_exp_f32 v102, v102
    v_mfma_f32_16x16x32_bf16 v[124:127], a[156:159], a[252:255], v[124:127]
    buffer_load_dwordx4 v1, s[8:11], s19 offen offset:2048  lds
    v_mfma_f32_16x16x32_bf16 v[40:43], v[28:31], v[56:59], 0
    v_exp_f32 v103, v103
    v_mfma_f32_16x16x32_bf16 v[44:47], v[28:31], v[60:63], 0
    ds_read_b128 a[140:143], v18 offset:3072
    v_cvt_pk_bf16_f32 v51, v102, v103
    v_mfma_f32_16x16x32_bf16 v[192:195], a[160:163], v[56:59], 0
    v_exp_f32 v104, v104
    v_mfma_f32_16x16x32_bf16 v[224:227], a[160:163], v[60:63], 0
    v_mfma_f32_16x16x32_bf16 v[196:199], a[164:167], v[56:59], 0
    v_exp_f32 v105, v105
    v_mfma_f32_16x16x32_bf16 v[228:231], a[164:167], v[60:63], 0
    ds_read_b128 a[144:147], v18 offset:4096
    v_cvt_pk_bf16_f32 v52, v104, v105
    v_mfma_f32_16x16x32_bf16 v[200:203], a[168:171], v[56:59], 0
    v_exp_f32 v106, v106
    v_mfma_f32_16x16x32_bf16 v[232:235], a[168:171], v[60:63], 0
    buffer_load_dwordx4 v1, s[8:11], s19 offen offset:3072  lds
    v_mfma_f32_16x16x32_bf16 v[204:207], a[172:175], v[56:59], 0
    s_add_u32 m0, s16, 4096
    v_exp_f32 v107, v107
    v_mfma_f32_16x16x32_bf16 v[236:239], a[172:175], v[60:63], 0
    ds_read_b128 a[148:151], v18 offset:5120
    v_cvt_pk_bf16_f32 v53, v106, v107
    v_mfma_f32_16x16x32_bf16 v[208:211], a[176:179], v[56:59], 0
    v_exp_f32 v108, v108
    v_mfma_f32_16x16x32_bf16 v[240:243], a[176:179], v[60:63], 0
    buffer_load_dwordx4 v15, s[8:11], s19 offen offset:0  lds
    v_mfma_f32_16x16x32_bf16 v[212:215], a[180:183], v[56:59], 0
    v_exp_f32 v109, v109
    v_mfma_f32_16x16x32_bf16 v[244:247], a[180:183], v[60:63], 0
    ds_read_b128 a[152:155], v18 offset:6144
    v_cvt_pk_bf16_f32 v54, v108, v109
    v_mfma_f32_16x16x32_bf16 v[216:219], a[184:187], v[56:59], 0
    v_exp_f32 v110, v110
    v_mfma_f32_16x16x32_bf16 v[248:251], a[184:187], v[60:63], 0
    buffer_load_dwordx4 v15, s[8:11], s19 offen offset:1024  lds
    v_mfma_f32_16x16x32_bf16 v[220:223], a[188:191], v[56:59], 0
    v_exp_f32 v111, v111
    v_mfma_f32_16x16x32_bf16 v[252:255], a[188:191], v[60:63], 0
    ds_read_b128 a[156:159], v18 offset:7168
    v_cvt_pk_bf16_f32 v55, v110, v111
    s_waitcnt lgkmcnt(7)
    v_mfma_f32_16x16x32_bf16 v[96:99], a[128:131], a[192:195], v[64:67]
    s_waitcnt lgkmcnt(6)
    s_lshr_b32 s101, s2, 3
    s_sub_u32 s101, s101, 4
    ds_read_b128 a[160:163], v19 offset:16384
    v_mfma_f32_16x16x32_bf16 v[96:99], a[132:135], a[196:199], v[96:99]
    s_waitcnt lgkmcnt(6)
    s_and_b32 s101, s101, 31
    ds_read_b128 a[164:167], v19 offset:17408
    v_and_b32 v14, 7, v2
    v_mfma_f32_16x16x32_bf16 v[96:99], a[136:139], a[200:203], v[96:99]
    s_waitcnt lgkmcnt(6)
    v_exp_f32 v112, v112
    v_mfma_f32_16x16x32_bf16 v[96:99], a[140:143], a[204:207], v[96:99]
    buffer_load_dwordx4 v15, s[8:11], s19 offen offset:2048  lds
    v_mfma_f32_16x16x32_bf16 v[104:107], a[128:131], a[208:211], v[68:71]
    v_exp_f32 v113, v113
    v_mfma_f32_16x16x32_bf16 v[104:107], a[132:135], a[212:215], v[104:107]
    ds_read_b128 a[168:171], v19 offset:18432
    v_cvt_pk_bf16_f32 v56, v112, v113
    v_mfma_f32_16x16x32_bf16 v[104:107], a[136:139], a[216:219], v[104:107]
    s_waitcnt lgkmcnt(6)
    v_exp_f32 v114, v114
    v_mfma_f32_16x16x32_bf16 v[104:107], a[140:143], a[220:223], v[104:107]
    buffer_load_dwordx4 v15, s[8:11], s19 offen offset:3072  lds
    v_mfma_f32_16x16x32_bf16 v[100:103], a[144:147], a[192:195], v[64:67]
    s_waitcnt lgkmcnt(5)
    s_xor_b32 s16, s16, 98304
    v_exp_f32 v115, v115
    v_mfma_f32_16x16x32_bf16 v[100:103], a[148:151], a[196:199], v[100:103]
    s_waitcnt lgkmcnt(4)
    s_add_u32 s27, s18, 0
    ds_read_b128 a[172:175], v19 offset:19456
    v_cvt_pk_bf16_f32 v57, v114, v115
    v_mfma_f32_16x16x32_bf16 v[100:103], a[152:155], a[200:203], v[100:103]
    s_waitcnt lgkmcnt(4)
    v_exp_f32 v116, v116
    v_mfma_f32_16x16x32_bf16 v[100:103], a[156:159], a[204:207], v[100:103]
    buffer_store_dwordx4 v[24:27], v17, s[8:11], s27 offen offset:0 sc0 sc1
    v_mfma_f32_16x16x32_bf16 v[108:111], a[144:147], a[208:211], v[68:71]
    s_add_u32 s27, s18, 131072
    v_exp_f32 v117, v117
    v_mfma_f32_16x16x32_bf16 v[108:111], a[148:151], a[212:215], v[108:111]
    ds_read_b128 a[176:179], v20 offset:20480
    v_cvt_pk_bf16_f32 v58, v116, v117
    v_mfma_f32_16x16x32_bf16 v[108:111], a[152:155], a[216:219], v[108:111]
    v_exp_f32 v118, v118
    v_mfma_f32_16x16x32_bf16 v[108:111], a[156:159], a[220:223], v[108:111]
    buffer_store_dwordx4 v[24:27], v17, s[8:11], s27 offen offset:0 sc0 sc1
    v_mfma_f32_16x16x32_bf16 v[32:35], v[28:31], v[48:51], v[32:35]
    v_exp_f32 v119, v119
    v_mfma_f32_16x16x32_bf16 v[36:39], v[28:31], v[52:55], v[36:39]
    s_waitcnt lgkmcnt(4)
    ds_read_b128 a[180:183], v20 offset:21504
    v_cvt_pk_bf16_f32 v59, v118, v119
    v_mfma_f32_16x16x32_bf16 v[128:131], a[160:163], v[48:51], v[128:131]
    v_exp_f32 v120, v120
    v_mfma_f32_16x16x32_bf16 v[160:163], a[160:163], v[52:55], v[160:163]
    s_waitcnt lgkmcnt(4)
    v_lshlrev_b32 v14, 4, v14
    v_lshrrev_b32 v13, 3, v2
    v_mfma_f32_16x16x32_bf16 v[132:135], a[164:167], v[48:51], v[132:135]
    v_exp_f32 v121, v121
    v_mfma_f32_16x16x32_bf16 v[164:167], a[164:167], v[52:55], v[164:167]
    s_waitcnt lgkmcnt(3)
    ds_read_b128 a[184:187], v20 offset:22528
    v_cvt_pk_bf16_f32 v60, v120, v121
    v_mfma_f32_16x16x32_bf16 v[136:139], a[168:171], v[48:51], v[136:139]
    v_exp_f32 v122, v122
    v_mfma_f32_16x16x32_bf16 v[168:171], a[168:171], v[52:55], v[168:171]
    s_waitcnt lgkmcnt(3)
    v_lshl_add_u32 v12, v13, 13, v14
    v_mul_u32_u24 v13, 28672, v13
    v_mfma_f32_16x16x32_bf16 v[140:143], a[172:175], v[48:51], v[140:143]
    v_exp_f32 v123, v123
    v_mfma_f32_16x16x32_bf16 v[172:175], a[172:175], v[52:55], v[172:175]
    s_waitcnt lgkmcnt(2)
    ds_read_b128 a[188:191], v20 offset:23552
    v_cvt_pk_bf16_f32 v61, v122, v123
    v_mfma_f32_16x16x32_bf16 v[144:147], a[176:179], v[48:51], v[144:147]
    v_exp_f32 v124, v124
    v_mfma_f32_16x16x32_bf16 v[176:179], a[176:179], v[52:55], v[176:179]
    s_waitcnt lgkmcnt(2)
    v_add_u32 v13, v13, v14
    v_mfma_f32_16x16x32_bf16 v[148:151], a[180:183], v[48:51], v[148:151]
    s_lshl_b32 s17, s4, 2
    v_exp_f32 v125, v125
    v_mfma_f32_16x16x32_bf16 v[180:183], a[180:183], v[52:55], v[180:183]
    s_waitcnt lgkmcnt(1)
    s_add_u32 s17, s17, s3
    v_cvt_pk_bf16_f32 v62, v124, v125
    v_xor_b32 v19, 98304, v19
    v_mfma_f32_16x16x32_bf16 v[152:155], a[184:187], v[48:51], v[152:155]
    s_lshl_b32 s17, s17, 7
    v_exp_f32 v126, v126
    v_mfma_f32_16x16x32_bf16 v[184:187], a[184:187], v[52:55], v[184:187]
    s_waitcnt lgkmcnt(0)
    s_lshl_b32 s100, s101, 16
    s_add_u32 s17, s17, s100
    v_xor_b32 v20, 98304, v20
    v_mfma_f32_16x16x32_bf16 v[156:159], a[188:191], v[48:51], v[156:159]
    s_add_u32 s17, s17, 4194304
    v_exp_f32 v127, v127
    v_mfma_f32_16x16x32_bf16 v[188:191], a[188:191], v[52:55], v[188:191]
    s_cmp_lt_u32 s101, s26
    s_cselect_b32 s17, s17, 2143285248
    v_cvt_pk_bf16_f32 v63, v126, v127
    buffer_store_dwordx4 a[0:3], v12, s[8:11], s17 offen sc0 sc1
    v_mfma_f32_16x16x32_bf16 v[112:115], a[128:131], a[224:227], v[72:75]
    s_add_u32 s17, s17, 4096
    v_exp_f32 v96, v96
    v_mfma_f32_16x16x32_bf16 v[112:115], a[132:135], a[228:231], v[112:115]
    buffer_store_dwordx4 a[4:7], v12, s[8:11], s17 offen sc0 sc1
    v_mfma_f32_16x16x32_bf16 v[112:115], a[136:139], a[232:235], v[112:115]
    s_add_u32 s27, s18, 0
    v_exp_f32 v97, v97
    v_mfma_f32_16x16x32_bf16 v[112:115], a[140:143], a[236:239], v[112:115]
    v_cvt_pk_bf16_f32 v48, v96, v97
    v_lshrrev_b32 v9, 1, v2
    v_mfma_f32_16x16x32_bf16 v[120:123], a[128:131], a[240:243], v[76:79]
    v_exp_f32 v98, v98
    v_mfma_f32_16x16x32_bf16 v[120:123], a[132:135], a[244:247], v[120:123]
    buffer_store_dwordx4 v[24:27], v17, s[8:11], s27 offen offset:256 sc0 sc1
    v_mfma_f32_16x16x32_bf16 v[120:123], a[136:139], a[248:251], v[120:123]
    s_add_u32 s27, s18, 131072
    v_exp_f32 v99, v99
    v_mfma_f32_16x16x32_bf16 v[120:123], a[140:143], a[252:255], v[120:123]
    buffer_store_dwordx4 v[24:27], v17, s[8:11], s27 offen offset:256 sc0 sc1
    v_mfma_f32_16x16x32_bf16 v[116:119], a[144:147], a[224:227], v[72:75]
    s_add_u32 s27, s18, 0
    v_exp_f32 v100, v100
    v_mfma_f32_16x16x32_bf16 v[116:119], a[148:151], a[228:231], v[116:119]
    ds_read_b128 a[128:131], v18 offset:16384
    v_cvt_pk_bf16_f32 v49, v98, v99
    v_mfma_f32_16x16x32_bf16 v[116:119], a[152:155], a[232:235], v[116:119]
    s_add_u32 s19, s82, 32768
    v_exp_f32 v101, v101
    v_mfma_f32_16x16x32_bf16 v[116:119], a[156:159], a[236:239], v[116:119]
    s_sub_u32 s82, s12, s13
    ds_read_b128 a[132:135], v18 offset:17408
    v_cvt_pk_bf16_f32 v50, v100, v101
    v_mfma_f32_16x16x32_bf16 v[124:127], a[144:147], a[240:243], v[76:79]
    s_sub_u32 s82, s82, 1
    v_exp_f32 v102, v102
    v_mfma_f32_16x16x32_bf16 v[124:127], a[148:151], a[244:247], v[124:127]
    s_cmp_gt_u32 s12, s13
    s_cselect_b32 s82, s82, s12
    s_lshl_b32 s82, s82, 16
    ds_read_b128 a[136:139], v18 offset:18432
    v_mfma_f32_16x16x32_bf16 v[124:127], a[152:155], a[248:251], v[124:127]
    s_add_u32 s82, s82, s81
    v_exp_f32 v103, v103
    v_mfma_f32_16x16x32_bf16 v[124:127], a[156:159], a[252:255], v[124:127]
    s_cmp_ge_u32 s12, 17
    s_cselect_b32 s82, 2147471360, s82
    ds_read_b128 a[140:143], v18 offset:19456
    v_cvt_pk_bf16_f32 v51, v102, v103
    v_mfma_f32_16x16x32_bf16 v[40:43], v[28:31], v[56:59], v[40:43]
    s_add_u32 s12, s12, 1
    v_exp_f32 v104, v104
    v_mfma_f32_16x16x32_bf16 v[44:47], v[28:31], v[60:63], v[44:47]
    ds_read_b128 a[144:147], v18 offset:20480
    v_lshrrev_b32 v10, 4, v2
    v_mfma_f32_16x16x32_bf16 v[192:195], a[160:163], v[56:59], v[192:195]
    v_exp_f32 v105, v105
    v_mfma_f32_16x16x32_bf16 v[224:227], a[160:163], v[60:63], v[224:227]
    ds_read_b128 a[148:151], v18 offset:21504
    v_cvt_pk_bf16_f32 v52, v104, v105
    v_mfma_f32_16x16x32_bf16 v[196:199], a[164:167], v[56:59], v[196:199]
    v_exp_f32 v106, v106
    v_mfma_f32_16x16x32_bf16 v[228:231], a[164:167], v[60:63], v[228:231]
    ds_read_b128 a[152:155], v18 offset:22528
    v_xor_b32 v9, v9, v10
    v_mfma_f32_16x16x32_bf16 v[200:203], a[168:171], v[56:59], v[200:203]
    v_exp_f32 v107, v107
    v_mfma_f32_16x16x32_bf16 v[232:235], a[168:171], v[60:63], v[232:235]
    ds_read_b128 a[156:159], v18 offset:23552
    v_cvt_pk_bf16_f32 v53, v106, v107
    v_mfma_f32_16x16x32_bf16 v[204:207], a[172:175], v[56:59], v[204:207]
    v_exp_f32 v108, v108
    v_mfma_f32_16x16x32_bf16 v[236:239], a[172:175], v[60:63], v[236:239]
    buffer_store_dwordx4 v[24:27], v17, s[8:11], s27 offen offset:512 sc0 sc1
    v_mfma_f32_16x16x32_bf16 v[208:211], a[176:179], v[56:59], v[208:211]
    s_add_u32 s27, s18, 131072
    v_exp_f32 v109, v109
    v_mfma_f32_16x16x32_bf16 v[240:243], a[176:179], v[60:63], v[240:243]
    v_cvt_pk_bf16_f32 v54, v108, v109
    v_xor_b32 v18, 196608, v18
    v_mfma_f32_16x16x32_bf16 v[212:215], a[180:183], v[56:59], v[212:215]
    v_exp_f32 v110, v110
    v_mfma_f32_16x16x32_bf16 v[244:247], a[180:183], v[60:63], v[244:247]
    buffer_store_dwordx4 v[24:27], v17, s[8:11], s27 offen offset:512 sc0 sc1
    v_mfma_f32_16x16x32_bf16 v[216:219], a[184:187], v[56:59], v[216:219]
    s_add_u32 s27, s18, 0
    v_exp_f32 v111, v111
    v_mfma_f32_16x16x32_bf16 v[248:251], a[184:187], v[60:63], v[248:251]
    v_cvt_pk_bf16_f32 v55, v110, v111
    v_and_b32 v9, 3, v9
    v_mfma_f32_16x16x32_bf16 v[220:223], a[188:191], v[56:59], v[220:223]
    buffer_store_dwordx4 v[24:27], v17, s[8:11], s27 offen offset:768 sc0 sc1
    v_mfma_f32_16x16x32_bf16 v[252:255], a[188:191], v[60:63], v[252:255]
    v_lshlrev_b32 v9, 5, v9
    v_and_b32 v10, 1, v2
    v_lshl_add_u32 v9, v10, 4, v9
    v_lshrrev_b32 v8, 3, v2
    s_waitcnt vmcnt(9) lgkmcnt(0)
    s_barrier
    buffer_store_dword v6, v5, s[8:11], s22 offen sc0 sc1
    v_mfma_f32_16x16x32_bf16 v[96:99], a[128:131], a[192:195], v[64:67]
    s_add_u32 m0, s15, 0
    ds_read_b128 a[160:163], v19 offset:0
    v_mfma_f32_16x16x32_bf16 v[96:99], a[132:135], a[196:199], v[96:99]
    ds_read_b128 a[164:167], v19 offset:1024
    v_mfma_f32_16x16x32_bf16 v[96:99], a[136:139], a[200:203], v[96:99]
    v_exp_f32 v112, v112
    v_mfma_f32_16x16x32_bf16 v[96:99], a[140:143], a[204:207], v[96:99]
    buffer_load_dwordx4 v1, s[8:11], s82 offen offset:0  lds
    v_mfma_f32_16x16x32_bf16 v[104:107], a[128:131], a[208:211], v[68:71]
    v_exp_f32 v113, v113
    v_mfma_f32_16x16x32_bf16 v[104:107], a[132:135], a[212:215], v[104:107]
    ds_read_b128 a[168:171], v19 offset:2048
    v_cvt_pk_bf16_f32 v56, v112, v113
    v_mfma_f32_16x16x32_bf16 v[104:107], a[136:139], a[216:219], v[104:107]
    v_exp_f32 v114, v114
    v_mfma_f32_16x16x32_bf16 v[104:107], a[140:143], a[220:223], v[104:107]
    buffer_load_dwordx4 v1, s[8:11], s82 offen offset:1024  lds
    v_mfma_f32_16x16x32_bf16 v[100:103], a[144:147], a[192:195], v[64:67]
    v_exp_f32 v115, v115
    v_mfma_f32_16x16x32_bf16 v[100:103], a[148:151], a[196:199], v[100:103]
    ds_read_b128 a[172:175], v19 offset:3072
    v_cvt_pk_bf16_f32 v57, v114, v115
    v_mfma_f32_16x16x32_bf16 v[100:103], a[152:155], a[200:203], v[100:103]
    v_exp_f32 v116, v116
    v_mfma_f32_16x16x32_bf16 v[100:103], a[156:159], a[204:207], v[100:103]
    buffer_load_dwordx4 v1, s[8:11], s82 offen offset:2048  lds
    v_mfma_f32_16x16x32_bf16 v[108:111], a[144:147], a[208:211], v[68:71]
    v_exp_f32 v117, v117
    v_mfma_f32_16x16x32_bf16 v[108:111], a[148:151], a[212:215], v[108:111]
    ds_read_b128 a[176:179], v20 offset:4096
    v_cvt_pk_bf16_f32 v58, v116, v117
    v_mfma_f32_16x16x32_bf16 v[108:111], a[152:155], a[216:219], v[108:111]
    v_exp_f32 v118, v118
    v_mfma_f32_16x16x32_bf16 v[108:111], a[156:159], a[220:223], v[108:111]
    buffer_load_dwordx4 v1, s[8:11], s82 offen offset:3072  lds
    v_mfma_f32_16x16x32_bf16 v[32:35], v[28:31], v[48:51], v[32:35]
    s_add_u32 m0, s15, 4096
    v_exp_f32 v119, v119
    v_mfma_f32_16x16x32_bf16 v[36:39], v[28:31], v[52:55], v[36:39]
    s_waitcnt lgkmcnt(4)
    ds_read_b128 a[180:183], v20 offset:5120
    v_cvt_pk_bf16_f32 v59, v118, v119
    v_mfma_f32_16x16x32_bf16 v[128:131], a[160:163], v[48:51], v[128:131]
    v_exp_f32 v120, v120
    v_mfma_f32_16x16x32_bf16 v[160:163], a[160:163], v[52:55], v[160:163]
    s_waitcnt lgkmcnt(4)
    v_mfma_f32_16x16x32_bf16 v[132:135], a[164:167], v[48:51], v[132:135]
    v_exp_f32 v121, v121
    v_mfma_f32_16x16x32_bf16 v[164:167], a[164:167], v[52:55], v[164:167]
    s_waitcnt lgkmcnt(3)
    ds_read_b128 a[184:187], v20 offset:6144
    v_cvt_pk_bf16_f32 v60, v120, v121
    v_mfma_f32_16x16x32_bf16 v[136:139], a[168:171], v[48:51], v[136:139]
    s_waitcnt lgkmcnt(3)
    v_exp_f32 v122, v122
    v_mfma_f32_16x16x32_bf16 v[168:171], a[168:171], v[52:55], v[168:171]
    buffer_load_dwordx4 v15, s[8:11], s82 offen offset:0  lds
    v_mfma_f32_16x16x32_bf16 v[140:143], a[172:175], v[48:51], v[140:143]
    v_exp_f32 v123, v123
    v_mfma_f32_16x16x32_bf16 v[172:175], a[172:175], v[52:55], v[172:175]
    s_waitcnt lgkmcnt(2)
    ds_read_b128 a[188:191], v20 offset:7168
    v_cvt_pk_bf16_f32 v61, v122, v123
    v_mfma_f32_16x16x32_bf16 v[144:147], a[176:179], v[48:51], v[144:147]
    s_waitcnt lgkmcnt(2)
    v_exp_f32 v124, v124
    v_mfma_f32_16x16x32_bf16 v[176:179], a[176:179], v[52:55], v[176:179]
    buffer_load_dwordx4 v15, s[8:11], s82 offen offset:1024  lds
    v_mfma_f32_16x16x32_bf16 v[148:151], a[180:183], v[48:51], v[148:151]
    v_exp_f32 v125, v125
    v_mfma_f32_16x16x32_bf16 v[180:183], a[180:183], v[52:55], v[180:183]
    s_waitcnt lgkmcnt(1)
    v_cvt_pk_bf16_f32 v62, v124, v125
    v_mfma_f32_16x16x32_bf16 v[152:155], a[184:187], v[48:51], v[152:155]
    s_waitcnt lgkmcnt(0)
    v_exp_f32 v126, v126
    v_mfma_f32_16x16x32_bf16 v[184:187], a[184:187], v[52:55], v[184:187]
    buffer_load_dwordx4 v15, s[8:11], s82 offen offset:2048  lds
    v_mfma_f32_16x16x32_bf16 v[156:159], a[188:191], v[48:51], v[156:159]
    v_exp_f32 v127, v127
    v_mfma_f32_16x16x32_bf16 v[188:191], a[188:191], v[52:55], v[188:191]
    v_cvt_pk_bf16_f32 v63, v126, v127
    v_mfma_f32_16x16x32_bf16 v[112:115], a[128:131], a[224:227], v[72:75]
    v_mfma_f32_16x16x32_bf16 v[112:115], a[132:135], a[228:231], v[112:115]
    v_mfma_f32_16x16x32_bf16 v[112:115], a[136:139], a[232:235], v[112:115]
    v_exp_f32 v96, v96
    v_mfma_f32_16x16x32_bf16 v[112:115], a[140:143], a[236:239], v[112:115]
    buffer_load_dwordx4 v15, s[8:11], s82 offen offset:3072  lds
    v_mfma_f32_16x16x32_bf16 v[120:123], a[128:131], a[240:243], v[76:79]
    s_xor_b32 s15, s15, 196608
    v_exp_f32 v97, v97
    v_mfma_f32_16x16x32_bf16 v[120:123], a[132:135], a[244:247], v[120:123]
    s_add_u32 m0, s16, 0
    ds_read_b128 a[128:131], v18 offset:0
    v_cvt_pk_bf16_f32 v48, v96, v97
    v_mfma_f32_16x16x32_bf16 v[120:123], a[136:139], a[248:251], v[120:123]
    v_exp_f32 v98, v98
    v_mfma_f32_16x16x32_bf16 v[120:123], a[140:143], a[252:255], v[120:123]
    buffer_load_dwordx4 v1, s[8:11], s19 offen offset:0  lds
    v_mfma_f32_16x16x32_bf16 v[116:119], a[144:147], a[224:227], v[72:75]
    v_exp_f32 v99, v99
    v_mfma_f32_16x16x32_bf16 v[116:119], a[148:151], a[228:231], v[116:119]
    ds_read_b128 a[132:135], v18 offset:1024
    v_cvt_pk_bf16_f32 v49, v98, v99
    v_mfma_f32_16x16x32_bf16 v[116:119], a[152:155], a[232:235], v[116:119]
    v_exp_f32 v100, v100
    v_mfma_f32_16x16x32_bf16 v[116:119], a[156:159], a[236:239], v[116:119]
    buffer_load_dwordx4 v1, s[8:11], s19 offen offset:1024  lds
    v_mfma_f32_16x16x32_bf16 v[124:127], a[144:147], a[240:243], v[76:79]
    v_exp_f32 v101, v101
    v_mfma_f32_16x16x32_bf16 v[124:127], a[148:151], a[244:247], v[124:127]
    ds_read_b128 a[136:139], v18 offset:2048
    v_cvt_pk_bf16_f32 v50, v100, v101
    v_mfma_f32_16x16x32_bf16 v[124:127], a[152:155], a[248:251], v[124:127]
    v_exp_f32 v102, v102
    v_mfma_f32_16x16x32_bf16 v[124:127], a[156:159], a[252:255], v[124:127]
    buffer_load_dwordx4 v1, s[8:11], s19 offen offset:2048  lds
    v_mfma_f32_16x16x32_bf16 v[40:43], v[28:31], v[56:59], v[40:43]
    v_exp_f32 v103, v103
    v_mfma_f32_16x16x32_bf16 v[44:47], v[28:31], v[60:63], v[44:47]
    ds_read_b128 a[140:143], v18 offset:3072
    v_cvt_pk_bf16_f32 v51, v102, v103
    v_mfma_f32_16x16x32_bf16 v[192:195], a[160:163], v[56:59], v[192:195]
    v_exp_f32 v104, v104
    v_mfma_f32_16x16x32_bf16 v[224:227], a[160:163], v[60:63], v[224:227]
    v_mfma_f32_16x16x32_bf16 v[196:199], a[164:167], v[56:59], v[196:199]
    v_exp_f32 v105, v105
    v_mfma_f32_16x16x32_bf16 v[228:231], a[164:167], v[60:63], v[228:231]
    ds_read_b128 a[144:147], v18 offset:4096
    v_cvt_pk_bf16_f32 v52, v104, v105
    v_mfma_f32_16x16x32_bf16 v[200:203], a[168:171], v[56:59], v[200:203]
    v_exp_f32 v106, v106
    v_mfma_f32_16x16x32_bf16 v[232:235], a[168:171], v[60:63], v[232:235]
    buffer_load_dwordx4 v1, s[8:11], s19 offen offset:3072  lds
    v_mfma_f32_16x16x32_bf16 v[204:207], a[172:175], v[56:59], v[204:207]
    s_add_u32 m0, s16, 4096
    v_exp_f32 v107, v107
    v_mfma_f32_16x16x32_bf16 v[236:239], a[172:175], v[60:63], v[236:239]
    ds_read_b128 a[148:151], v18 offset:5120
    v_cvt_pk_bf16_f32 v53, v106, v107
    v_mfma_f32_16x16x32_bf16 v[208:211], a[176:179], v[56:59], v[208:211]
    v_exp_f32 v108, v108
    v_mfma_f32_16x16x32_bf16 v[240:243], a[176:179], v[60:63], v[240:243]
    buffer_load_dwordx4 v15, s[8:11], s19 offen offset:0  lds
    v_mfma_f32_16x16x32_bf16 v[212:215], a[180:183], v[56:59], v[212:215]
    v_exp_f32 v109, v109
    v_mfma_f32_16x16x32_bf16 v[244:247], a[180:183], v[60:63], v[244:247]
    ds_read_b128 a[152:155], v18 offset:6144
    v_cvt_pk_bf16_f32 v54, v108, v109
    v_mfma_f32_16x16x32_bf16 v[216:219], a[184:187], v[56:59], v[216:219]
    v_exp_f32 v110, v110
    v_mfma_f32_16x16x32_bf16 v[248:251], a[184:187], v[60:63], v[248:251]
    buffer_load_dwordx4 v15, s[8:11], s19 offen offset:1024  lds
    v_mfma_f32_16x16x32_bf16 v[220:223], a[188:191], v[56:59], v[220:223]
    v_exp_f32 v111, v111
    v_mfma_f32_16x16x32_bf16 v[252:255], a[188:191], v[60:63], v[252:255]
    ds_read_b128 a[156:159], v18 offset:7168
    v_cvt_pk_bf16_f32 v55, v110, v111
    s_waitcnt lgkmcnt(7)
    v_mfma_f32_16x16x32_bf16 v[96:99], a[128:131], a[192:195], v[64:67]
    s_waitcnt lgkmcnt(6)
    ds_read_b128 a[160:163], v19 offset:16384
    v_mfma_f32_16x16x32_bf16 v[96:99], a[132:135], a[196:199], v[96:99]
    s_waitcnt lgkmcnt(6)
    ds_read_b128 a[164:167], v19 offset:17408
    v_mfma_f32_16x16x32_bf16 v[96:99], a[136:139], a[200:203], v[96:99]
    s_waitcnt lgkmcnt(6)
    v_exp_f32 v112, v112
    v_mfma_f32_16x16x32_bf16 v[96:99], a[140:143], a[204:207], v[96:99]
    buffer_load_dwordx4 v15, s[8:11], s19 offen offset:2048  lds
    v_mfma_f32_16x16x32_bf16 v[104:107], a[128:131], a[208:211], v[68:71]
    v_exp_f32 v113, v113
    v_mfma_f32_16x16x32_bf16 v[104:107], a[132:135], a[212:215], v[104:107]
    ds_read_b128 a[168:171], v19 offset:18432
    v_cvt_pk_bf16_f32 v56, v112, v113
    v_mfma_f32_16x16x32_bf16 v[104:107], a[136:139], a[216:219], v[104:107]
    s_waitcnt lgkmcnt(6)
    v_exp_f32 v114, v114
    v_mfma_f32_16x16x32_bf16 v[104:107], a[140:143], a[220:223], v[104:107]
    buffer_load_dwordx4 v15, s[8:11], s19 offen offset:3072  lds
    v_mfma_f32_16x16x32_bf16 v[100:103], a[144:147], a[192:195], v[64:67]
    s_waitcnt lgkmcnt(5)
    s_xor_b32 s16, s16, 98304
    v_exp_f32 v115, v115
    v_mfma_f32_16x16x32_bf16 v[100:103], a[148:151], a[196:199], v[100:103]
    s_waitcnt lgkmcnt(4)
    s_add_u32 s17, s17, 2093056
    ds_read_b128 a[172:175], v19 offset:19456
    v_cvt_pk_bf16_f32 v57, v114, v115
    v_mfma_f32_16x16x32_bf16 v[100:103], a[152:155], a[200:203], v[100:103]
    s_waitcnt lgkmcnt(4)
    v_exp_f32 v116, v116
    v_mfma_f32_16x16x32_bf16 v[100:103], a[156:159], a[204:207], v[100:103]
    buffer_store_dwordx4 a[8:11], v12, s[8:11], s17 offen sc0 sc1
    v_mfma_f32_16x16x32_bf16 v[108:111], a[144:147], a[208:211], v[68:71]
    s_add_u32 s27, s18, 131072
    v_exp_f32 v117, v117
    v_mfma_f32_16x16x32_bf16 v[108:111], a[148:151], a[212:215], v[108:111]
    ds_read_b128 a[176:179], v20 offset:20480
    v_cvt_pk_bf16_f32 v58, v116, v117
    v_mfma_f32_16x16x32_bf16 v[108:111], a[152:155], a[216:219], v[108:111]
    v_exp_f32 v118, v118
    v_mfma_f32_16x16x32_bf16 v[108:111], a[156:159], a[220:223], v[108:111]
    buffer_store_dwordx4 v[24:27], v17, s[8:11], s27 offen offset:768 sc0 sc1
    v_mfma_f32_16x16x32_bf16 v[32:35], v[28:31], v[48:51], v[32:35]
    s_add_u32 s27, s18, 8388608
    v_exp_f32 v119, v119
    v_mfma_f32_16x16x32_bf16 v[36:39], v[28:31], v[52:55], v[36:39]
    s_waitcnt lgkmcnt(4)
    ds_read_b128 a[180:183], v20 offset:21504
    v_cvt_pk_bf16_f32 v59, v118, v119
    v_mfma_f32_16x16x32_bf16 v[128:131], a[160:163], v[48:51], v[128:131]
    s_waitcnt lgkmcnt(4)
    v_exp_f32 v120, v120
    v_mfma_f32_16x16x32_bf16 v[160:163], a[160:163], v[52:55], v[160:163]
    buffer_store_dwordx4 v[24:27], v17, s[8:11], s27 offen offset:0 sc0 sc1
    v_mfma_f32_16x16x32_bf16 v[132:135], a[164:167], v[48:51], v[132:135]
    s_add_u32 s27, s18, 8519680
    v_exp_f32 v121, v121
    v_mfma_f32_16x16x32_bf16 v[164:167], a[164:167], v[52:55], v[164:167]
    s_waitcnt lgkmcnt(3)
    ds_read_b128 a[184:187], v20 offset:22528
    v_cvt_pk_bf16_f32 v60, v120, v121
    v_mfma_f32_16x16x32_bf16 v[136:139], a[168:171], v[48:51], v[136:139]
    s_waitcnt lgkmcnt(3)
    v_exp_f32 v122, v122
    v_mfma_f32_16x16x32_bf16 v[168:171], a[168:171], v[52:55], v[168:171]
    buffer_store_dwordx4 v[24:27], v17, s[8:11], s27 offen offset:0 sc0 sc1
    v_mfma_f32_16x16x32_bf16 v[140:143], a[172:175], v[48:51], v[140:143]
    v_exp_f32 v123, v123
    v_mfma_f32_16x16x32_bf16 v[172:175], a[172:175], v[52:55], v[172:175]
    s_waitcnt lgkmcnt(2)
    ds_read_b128 a[188:191], v20 offset:23552
    v_cvt_pk_bf16_f32 v61, v122, v123
    v_mfma_f32_16x16x32_bf16 v[144:147], a[176:179], v[48:51], v[144:147]
    v_exp_f32 v124, v124
    v_mfma_f32_16x16x32_bf16 v[176:179], a[176:179], v[52:55], v[176:179]
    s_waitcnt lgkmcnt(2)
    v_mfma_f32_16x16x32_bf16 v[148:151], a[180:183], v[48:51], v[148:151]
    v_exp_f32 v125, v125
    v_mfma_f32_16x16x32_bf16 v[180:183], a[180:183], v[52:55], v[180:183]
    s_waitcnt lgkmcnt(1)
    v_cvt_pk_bf16_f32 v62, v124, v125
    v_xor_b32 v19, 98304, v19
    v_mfma_f32_16x16x32_bf16 v[152:155], a[184:187], v[48:51], v[152:155]
    v_exp_f32 v126, v126
    v_mfma_f32_16x16x32_bf16 v[184:187], a[184:187], v[52:55], v[184:187]
    s_waitcnt lgkmcnt(0)
    v_xor_b32 v20, 98304, v20
    v_mfma_f32_16x16x32_bf16 v[156:159], a[188:191], v[48:51], v[156:159]
    v_exp_f32 v127, v127
    v_mfma_f32_16x16x32_bf16 v[188:191], a[188:191], v[52:55], v[188:191]
    v_cvt_pk_bf16_f32 v63, v126, v127
    v_mfma_f32_16x16x32_bf16 v[112:115], a[128:131], a[224:227], v[72:75]
    s_add_u32 s17, s17, 4096
    v_exp_f32 v96, v96
    v_mfma_f32_16x16x32_bf16 v[112:115], a[132:135], a[228:231], v[112:115]
    buffer_store_dwordx4 a[12:15], v12, s[8:11], s17 offen sc0 sc1
    v_mfma_f32_16x16x32_bf16 v[112:115], a[136:139], a[232:235], v[112:115]
    s_add_u32 s27, s18, 8388608
    v_exp_f32 v97, v97
    v_mfma_f32_16x16x32_bf16 v[112:115], a[140:143], a[236:239], v[112:115]
    v_cvt_pk_bf16_f32 v48, v96, v97
    v_lshl_add_u32 v8, v8, 10, v9
    v_mfma_f32_16x16x32_bf16 v[120:123], a[128:131], a[240:243], v[76:79]
    v_exp_f32 v98, v98
    v_mfma_f32_16x16x32_bf16 v[120:123], a[132:135], a[244:247], v[120:123]
    buffer_store_dwordx4 v[24:27], v17, s[8:11], s27 offen offset:256 sc0 sc1
    v_mfma_f32_16x16x32_bf16 v[120:123], a[136:139], a[248:251], v[120:123]
    s_add_u32 s27, s18, 8519680
    v_exp_f32 v99, v99
    v_mfma_f32_16x16x32_bf16 v[120:123], a[140:143], a[252:255], v[120:123]
    buffer_store_dwordx4 v[24:27], v17, s[8:11], s27 offen offset:256 sc0 sc1
    v_mfma_f32_16x16x32_bf16 v[116:119], a[144:147], a[224:227], v[72:75]
    s_add_u32 s27, s18, 8388608
    v_exp_f32 v100, v100
    v_mfma_f32_16x16x32_bf16 v[116:119], a[148:151], a[228:231], v[116:119]
    ds_read_b128 a[128:131], v18 offset:16384
    v_cvt_pk_bf16_f32 v49, v98, v99
    v_mfma_f32_16x16x32_bf16 v[116:119], a[152:155], a[232:235], v[116:119]
    s_add_u32 s19, s82, 32768
    v_exp_f32 v101, v101
    v_mfma_f32_16x16x32_bf16 v[116:119], a[156:159], a[236:239], v[116:119]
    s_sub_u32 s82, s12, s13
    ds_read_b128 a[132:135], v18 offset:17408
    v_cvt_pk_bf16_f32 v50, v100, v101
    v_mfma_f32_16x16x32_bf16 v[124:127], a[144:147], a[240:243], v[76:79]
    s_sub_u32 s82, s82, 1
    v_exp_f32 v102, v102
    v_mfma_f32_16x16x32_bf16 v[124:127], a[148:151], a[244:247], v[124:127]
    s_cmp_gt_u32 s12, s13
    s_cselect_b32 s82, s82, s12
    s_lshl_b32 s82, s82, 16
    ds_read_b128 a[136:139], v18 offset:18432
    v_mfma_f32_16x16x32_bf16 v[124:127], a[152:155], a[248:251], v[124:127]
    s_add_u32 s82, s82, s81
    v_exp_f32 v103, v103
    v_mfma_f32_16x16x32_bf16 v[124:127], a[156:159], a[252:255], v[124:127]
    s_cmp_ge_u32 s12, 17
    s_cselect_b32 s82, 2147471360, s82
    ds_read_b128 a[140:143], v18 offset:19456
    v_cvt_pk_bf16_f32 v51, v102, v103
    v_mfma_f32_16x16x32_bf16 v[40:43], v[28:31], v[56:59], v[40:43]
    s_add_u32 s12, s12, 1
    v_exp_f32 v104, v104
    v_mfma_f32_16x16x32_bf16 v[44:47], v[28:31], v[60:63], v[44:47]
    ds_read_b128 a[144:147], v18 offset:20480
    v_bfe_u32 v4, v2, 1, 2
    v_mfma_f32_16x16x32_bf16 v[192:195], a[160:163], v[56:59], v[192:195]
    v_exp_f32 v105, v105
    v_mfma_f32_16x16x32_bf16 v[224:227], a[160:163], v[60:63], v[224:227]
    ds_read_b128 a[148:151], v18 offset:21504
    v_cvt_pk_bf16_f32 v52, v104, v105
    v_mfma_f32_16x16x32_bf16 v[196:199], a[164:167], v[56:59], v[196:199]
    v_exp_f32 v106, v106
    v_mfma_f32_16x16x32_bf16 v[228:231], a[164:167], v[60:63], v[228:231]
    ds_read_b128 a[152:155], v18 offset:22528
    v_lshlrev_b32 v4, 11, v4
    v_mfma_f32_16x16x32_bf16 v[200:203], a[168:171], v[56:59], v[200:203]
    v_exp_f32 v107, v107
    v_mfma_f32_16x16x32_bf16 v[232:235], a[168:171], v[60:63], v[232:235]
    ds_read_b128 a[156:159], v18 offset:23552
    v_cvt_pk_bf16_f32 v53, v106, v107
    v_mfma_f32_16x16x32_bf16 v[204:207], a[172:175], v[56:59], v[204:207]
    v_exp_f32 v108, v108
    v_mfma_f32_16x16x32_bf16 v[236:239], a[172:175], v[60:63], v[236:239]
    buffer_store_dwordx4 v[24:27], v17, s[8:11], s27 offen offset:512 sc0 sc1
    v_mfma_f32_16x16x32_bf16 v[208:211], a[176:179], v[56:59], v[208:211]
    s_add_u32 s27, s18, 8519680
    v_exp_f32 v109, v109
    v_mfma_f32_16x16x32_bf16 v[240:243], a[176:179], v[60:63], v[240:243]
    v_cvt_pk_bf16_f32 v54, v108, v109
    v_xor_b32 v18, 196608, v18
    v_mfma_f32_16x16x32_bf16 v[212:215], a[180:183], v[56:59], v[212:215]
    v_exp_f32 v110, v110
    v_mfma_f32_16x16x32_bf16 v[244:247], a[180:183], v[60:63], v[244:247]
    buffer_store_dwordx4 v[24:27], v17, s[8:11], s27 offen offset:512 sc0 sc1
    v_mfma_f32_16x16x32_bf16 v[216:219], a[184:187], v[56:59], v[216:219]
    v_exp_f32 v111, v111
    v_mfma_f32_16x16x32_bf16 v[248:251], a[184:187], v[60:63], v[248:251]
    v_cvt_pk_bf16_f32 v55, v110, v111
    v_lshl_add_u32 v4, v10, 6, v4
    v_mfma_f32_16x16x32_bf16 v[220:223], a[188:191], v[56:59], v[220:223]
    v_add_u32 v9, 7168, v8
    v_add_u32 v10, 14336, v8
    v_mfma_f32_16x16x32_bf16 v[252:255], a[188:191], v[60:63], v[252:255]
    v_add_u32 v11, 21504, v8
    s_waitcnt vmcnt(9) lgkmcnt(0)
    s_barrier
    v_mfma_f32_16x16x32_bf16 v[96:99], a[128:131], a[192:195], v[64:67]
    s_add_u32 m0, s15, 0
    ds_read_b128 a[160:163], v19 offset:0
    v_mfma_f32_16x16x32_bf16 v[96:99], a[132:135], a[196:199], v[96:99]
    ds_read_b128 a[164:167], v19 offset:1024
    v_mfma_f32_16x16x32_bf16 v[96:99], a[136:139], a[200:203], v[96:99]
    v_exp_f32 v112, v112
    v_mfma_f32_16x16x32_bf16 v[96:99], a[140:143], a[204:207], v[96:99]
    buffer_load_dwordx4 v1, s[8:11], s82 offen offset:0  lds
    v_mfma_f32_16x16x32_bf16 v[104:107], a[128:131], a[208:211], v[68:71]
    v_exp_f32 v113, v113
    v_mfma_f32_16x16x32_bf16 v[104:107], a[132:135], a[212:215], v[104:107]
    ds_read_b128 a[168:171], v19 offset:2048
    v_cvt_pk_bf16_f32 v56, v112, v113
    v_mfma_f32_16x16x32_bf16 v[104:107], a[136:139], a[216:219], v[104:107]
    v_exp_f32 v114, v114
    v_mfma_f32_16x16x32_bf16 v[104:107], a[140:143], a[220:223], v[104:107]
    buffer_load_dwordx4 v1, s[8:11], s82 offen offset:1024  lds
    v_mfma_f32_16x16x32_bf16 v[100:103], a[144:147], a[192:195], v[64:67]
    v_exp_f32 v115, v115
    v_mfma_f32_16x16x32_bf16 v[100:103], a[148:151], a[196:199], v[100:103]
    ds_read_b128 a[172:175], v19 offset:3072
    v_cvt_pk_bf16_f32 v57, v114, v115
    v_mfma_f32_16x16x32_bf16 v[100:103], a[152:155], a[200:203], v[100:103]
    v_exp_f32 v116, v116
    v_mfma_f32_16x16x32_bf16 v[100:103], a[156:159], a[204:207], v[100:103]
    buffer_load_dwordx4 v1, s[8:11], s82 offen offset:2048  lds
    v_mfma_f32_16x16x32_bf16 v[108:111], a[144:147], a[208:211], v[68:71]
    v_exp_f32 v117, v117
    v_mfma_f32_16x16x32_bf16 v[108:111], a[148:151], a[212:215], v[108:111]
    ds_read_b128 a[176:179], v20 offset:4096
    v_cvt_pk_bf16_f32 v58, v116, v117
    v_mfma_f32_16x16x32_bf16 v[108:111], a[152:155], a[216:219], v[108:111]
    v_exp_f32 v118, v118
    v_mfma_f32_16x16x32_bf16 v[108:111], a[156:159], a[220:223], v[108:111]
    buffer_load_dwordx4 v1, s[8:11], s82 offen offset:3072  lds
    v_mfma_f32_16x16x32_bf16 v[32:35], v[28:31], v[48:51], v[32:35]
    s_add_u32 m0, s15, 4096
    v_exp_f32 v119, v119
    v_mfma_f32_16x16x32_bf16 v[36:39], v[28:31], v[52:55], v[36:39]
    s_waitcnt lgkmcnt(4)
    ds_read_b128 a[180:183], v20 offset:5120
    v_cvt_pk_bf16_f32 v59, v118, v119
    v_mfma_f32_16x16x32_bf16 v[128:131], a[160:163], v[48:51], v[128:131]
    v_exp_f32 v120, v120
    v_mfma_f32_16x16x32_bf16 v[160:163], a[160:163], v[52:55], v[160:163]
    s_waitcnt lgkmcnt(4)
    v_mfma_f32_16x16x32_bf16 v[132:135], a[164:167], v[48:51], v[132:135]
    v_exp_f32 v121, v121
    v_mfma_f32_16x16x32_bf16 v[164:167], a[164:167], v[52:55], v[164:167]
    s_waitcnt lgkmcnt(3)
    ds_read_b128 a[184:187], v20 offset:6144
    v_cvt_pk_bf16_f32 v60, v120, v121
    v_mfma_f32_16x16x32_bf16 v[136:139], a[168:171], v[48:51], v[136:139]
    s_waitcnt lgkmcnt(3)
    v_exp_f32 v122, v122
    v_mfma_f32_16x16x32_bf16 v[168:171], a[168:171], v[52:55], v[168:171]
    buffer_load_dwordx4 v15, s[8:11], s82 offen offset:0  lds
    v_mfma_f32_16x16x32_bf16 v[140:143], a[172:175], v[48:51], v[140:143]
    v_exp_f32 v123, v123
    v_mfma_f32_16x16x32_bf16 v[172:175], a[172:175], v[52:55], v[172:175]
    s_waitcnt lgkmcnt(2)
    ds_read_b128 a[188:191], v20 offset:7168
    v_cvt_pk_bf16_f32 v61, v122, v123
    v_mfma_f32_16x16x32_bf16 v[144:147], a[176:179], v[48:51], v[144:147]
    s_waitcnt lgkmcnt(2)
    v_exp_f32 v124, v124
    v_mfma_f32_16x16x32_bf16 v[176:179], a[176:179], v[52:55], v[176:179]
    buffer_load_dwordx4 v15, s[8:11], s82 offen offset:1024  lds
    v_mfma_f32_16x16x32_bf16 v[148:151], a[180:183], v[48:51], v[148:151]
    v_exp_f32 v125, v125
    v_mfma_f32_16x16x32_bf16 v[180:183], a[180:183], v[52:55], v[180:183]
    s_waitcnt lgkmcnt(1)
    v_cvt_pk_bf16_f32 v62, v124, v125
    v_mfma_f32_16x16x32_bf16 v[152:155], a[184:187], v[48:51], v[152:155]
    s_waitcnt lgkmcnt(0)
    v_exp_f32 v126, v126
    v_mfma_f32_16x16x32_bf16 v[184:187], a[184:187], v[52:55], v[184:187]
    buffer_load_dwordx4 v15, s[8:11], s82 offen offset:2048  lds
    v_mfma_f32_16x16x32_bf16 v[156:159], a[188:191], v[48:51], v[156:159]
    v_exp_f32 v127, v127
    v_mfma_f32_16x16x32_bf16 v[188:191], a[188:191], v[52:55], v[188:191]
    v_cvt_pk_bf16_f32 v63, v126, v127
    v_mfma_f32_16x16x32_bf16 v[112:115], a[128:131], a[224:227], v[72:75]
    v_mfma_f32_16x16x32_bf16 v[112:115], a[132:135], a[228:231], v[112:115]
    v_mfma_f32_16x16x32_bf16 v[112:115], a[136:139], a[232:235], v[112:115]
    v_exp_f32 v96, v96
    v_mfma_f32_16x16x32_bf16 v[112:115], a[140:143], a[236:239], v[112:115]
    buffer_load_dwordx4 v15, s[8:11], s82 offen offset:3072  lds
    v_mfma_f32_16x16x32_bf16 v[120:123], a[128:131], a[240:243], v[76:79]
    s_xor_b32 s15, s15, 196608
    v_exp_f32 v97, v97
    v_mfma_f32_16x16x32_bf16 v[120:123], a[132:135], a[244:247], v[120:123]
    s_add_u32 m0, s16, 0
    ds_read_b128 a[128:131], v18 offset:0
    v_cvt_pk_bf16_f32 v48, v96, v97
    v_mfma_f32_16x16x32_bf16 v[120:123], a[136:139], a[248:251], v[120:123]
    v_exp_f32 v98, v98
    v_mfma_f32_16x16x32_bf16 v[120:123], a[140:143], a[252:255], v[120:123]
    buffer_load_dwordx4 v1, s[8:11], s19 offen offset:0  lds
    v_mfma_f32_16x16x32_bf16 v[116:119], a[144:147], a[224:227], v[72:75]
    v_exp_f32 v99, v99
    v_mfma_f32_16x16x32_bf16 v[116:119], a[148:151], a[228:231], v[116:119]
    ds_read_b128 a[132:135], v18 offset:1024
    v_cvt_pk_bf16_f32 v49, v98, v99
    v_mfma_f32_16x16x32_bf16 v[116:119], a[152:155], a[232:235], v[116:119]
    v_exp_f32 v100, v100
    v_mfma_f32_16x16x32_bf16 v[116:119], a[156:159], a[236:239], v[116:119]
    buffer_load_dwordx4 v1, s[8:11], s19 offen offset:1024  lds
    v_mfma_f32_16x16x32_bf16 v[124:127], a[144:147], a[240:243], v[76:79]
    v_exp_f32 v101, v101
    v_mfma_f32_16x16x32_bf16 v[124:127], a[148:151], a[244:247], v[124:127]
    ds_read_b128 a[136:139], v18 offset:2048
    v_cvt_pk_bf16_f32 v50, v100, v101
    v_mfma_f32_16x16x32_bf16 v[124:127], a[152:155], a[248:251], v[124:127]
    v_exp_f32 v102, v102
    v_mfma_f32_16x16x32_bf16 v[124:127], a[156:159], a[252:255], v[124:127]
    buffer_load_dwordx4 v1, s[8:11], s19 offen offset:2048  lds
    v_mfma_f32_16x16x32_bf16 v[40:43], v[28:31], v[56:59], v[40:43]
    v_exp_f32 v103, v103
    v_mfma_f32_16x16x32_bf16 v[44:47], v[28:31], v[60:63], v[44:47]
    ds_read_b128 a[140:143], v18 offset:3072
    v_cvt_pk_bf16_f32 v51, v102, v103
    v_mfma_f32_16x16x32_bf16 v[192:195], a[160:163], v[56:59], v[192:195]
    v_exp_f32 v104, v104
    v_mfma_f32_16x16x32_bf16 v[224:227], a[160:163], v[60:63], v[224:227]
    v_mfma_f32_16x16x32_bf16 v[196:199], a[164:167], v[56:59], v[196:199]
    v_exp_f32 v105, v105
    v_mfma_f32_16x16x32_bf16 v[228:231], a[164:167], v[60:63], v[228:231]
    ds_read_b128 a[144:147], v18 offset:4096
    v_cvt_pk_bf16_f32 v52, v104, v105
    v_mfma_f32_16x16x32_bf16 v[200:203], a[168:171], v[56:59], v[200:203]
    v_exp_f32 v106, v106
    v_mfma_f32_16x16x32_bf16 v[232:235], a[168:171], v[60:63], v[232:235]
    buffer_load_dwordx4 v1, s[8:11], s19 offen offset:3072  lds
    v_mfma_f32_16x16x32_bf16 v[204:207], a[172:175], v[56:59], v[204:207]
    s_add_u32 m0, s16, 4096
    v_exp_f32 v107, v107
    v_mfma_f32_16x16x32_bf16 v[236:239], a[172:175], v[60:63], v[236:239]
    ds_read_b128 a[148:151], v18 offset:5120
    v_cvt_pk_bf16_f32 v53, v106, v107
    v_mfma_f32_16x16x32_bf16 v[208:211], a[176:179], v[56:59], v[208:211]
    v_exp_f32 v108, v108
    v_mfma_f32_16x16x32_bf16 v[240:243], a[176:179], v[60:63], v[240:243]
    buffer_load_dwordx4 v15, s[8:11], s19 offen offset:0  lds
    v_mfma_f32_16x16x32_bf16 v[212:215], a[180:183], v[56:59], v[212:215]
    v_exp_f32 v109, v109
    v_mfma_f32_16x16x32_bf16 v[244:247], a[180:183], v[60:63], v[244:247]
    ds_read_b128 a[152:155], v18 offset:6144
    v_cvt_pk_bf16_f32 v54, v108, v109
    v_mfma_f32_16x16x32_bf16 v[216:219], a[184:187], v[56:59], v[216:219]
    v_exp_f32 v110, v110
    v_mfma_f32_16x16x32_bf16 v[248:251], a[184:187], v[60:63], v[248:251]
    buffer_load_dwordx4 v15, s[8:11], s19 offen offset:1024  lds
    v_mfma_f32_16x16x32_bf16 v[220:223], a[188:191], v[56:59], v[220:223]
    v_exp_f32 v111, v111
    v_mfma_f32_16x16x32_bf16 v[252:255], a[188:191], v[60:63], v[252:255]
    ds_read_b128 a[156:159], v18 offset:7168
    v_cvt_pk_bf16_f32 v55, v110, v111
    s_waitcnt lgkmcnt(7)
    v_mfma_f32_16x16x32_bf16 v[96:99], a[128:131], a[192:195], v[64:67]
    s_waitcnt lgkmcnt(6)
    s_mul_i32 s17, s4, 229376
    s_mul_i32 s100, s3, 7168
    ds_read_b128 a[160:163], v19 offset:16384
    v_mfma_f32_16x16x32_bf16 v[96:99], a[132:135], a[196:199], v[96:99]
    s_waitcnt lgkmcnt(6)
    s_add_u32 s17, s17, s100
    s_lshl_b32 s100, s101, 7
    ds_read_b128 a[164:167], v19 offset:17408
    v_mfma_f32_16x16x32_bf16 v[96:99], a[136:139], a[200:203], v[96:99]
    s_waitcnt lgkmcnt(6)
    s_add_u32 s17, s17, s100
    v_exp_f32 v112, v112
    v_mfma_f32_16x16x32_bf16 v[96:99], a[140:143], a[204:207], v[96:99]
    buffer_load_dwordx4 v15, s[8:11], s19 offen offset:2048  lds
    v_mfma_f32_16x16x32_bf16 v[104:107], a[128:131], a[208:211], v[68:71]
    s_add_u32 s17, s17, 8388608
    v_exp_f32 v113, v113
    v_mfma_f32_16x16x32_bf16 v[104:107], a[132:135], a[212:215], v[104:107]
    s_cmp_lt_u32 s101, s26
    s_cselect_b32 s17, s17, 2147479552
    ds_read_b128 a[168:171], v19 offset:18432
    v_cvt_pk_bf16_f32 v56, v112, v113
    v_mfma_f32_16x16x32_bf16 v[104:107], a[136:139], a[216:219], v[104:107]
    s_waitcnt lgkmcnt(6)
    v_exp_f32 v114, v114
    v_mfma_f32_16x16x32_bf16 v[104:107], a[140:143], a[220:223], v[104:107]
    buffer_load_dwordx4 v15, s[8:11], s19 offen offset:3072  lds
    v_mfma_f32_16x16x32_bf16 v[100:103], a[144:147], a[192:195], v[64:67]
    s_waitcnt lgkmcnt(5)
    s_xor_b32 s16, s16, 98304
    v_exp_f32 v115, v115
    v_mfma_f32_16x16x32_bf16 v[100:103], a[148:151], a[196:199], v[100:103]
    s_waitcnt lgkmcnt(4)
    ds_read_b128 a[172:175], v19 offset:19456
    v_cvt_pk_bf16_f32 v57, v114, v115
    v_mfma_f32_16x16x32_bf16 v[100:103], a[152:155], a[200:203], v[100:103]
    s_waitcnt lgkmcnt(4)
    v_exp_f32 v116, v116
    v_mfma_f32_16x16x32_bf16 v[100:103], a[156:159], a[204:207], v[100:103]
    buffer_store_dwordx4 a[16:19], v13, s[8:11], s17 offen sc0 sc1
    v_mfma_f32_16x16x32_bf16 v[108:111], a[144:147], a[208:211], v[68:71]
    s_add_u32 s27, s18, 8388608
    v_exp_f32 v117, v117
    v_mfma_f32_16x16x32_bf16 v[108:111], a[148:151], a[212:215], v[108:111]
    ds_read_b128 a[176:179], v20 offset:20480
    v_cvt_pk_bf16_f32 v58, v116, v117
    v_mfma_f32_16x16x32_bf16 v[108:111], a[152:155], a[216:219], v[108:111]
    v_exp_f32 v118, v118
    v_mfma_f32_16x16x32_bf16 v[108:111], a[156:159], a[220:223], v[108:111]
    buffer_store_dwordx4 v[24:27], v17, s[8:11], s27 offen offset:768 sc0 sc1
    v_mfma_f32_16x16x32_bf16 v[32:35], v[28:31], v[48:51], v[32:35]
    s_add_u32 s27, s18, 8519680
    v_exp_f32 v119, v119
    v_mfma_f32_16x16x32_bf16 v[36:39], v[28:31], v[52:55], v[36:39]
    s_waitcnt lgkmcnt(4)
    ds_read_b128 a[180:183], v20 offset:21504
    v_cvt_pk_bf16_f32 v59, v118, v119
    v_mfma_f32_16x16x32_bf16 v[128:131], a[160:163], v[48:51], v[128:131]
    s_waitcnt lgkmcnt(4)
    v_exp_f32 v120, v120
    v_mfma_f32_16x16x32_bf16 v[160:163], a[160:163], v[52:55], v[160:163]
    buffer_store_dwordx4 v[24:27], v17, s[8:11], s27 offen offset:768 sc0 sc1
    v_mfma_f32_16x16x32_bf16 v[132:135], a[164:167], v[48:51], v[132:135]
    v_exp_f32 v121, v121
    v_mfma_f32_16x16x32_bf16 v[164:167], a[164:167], v[52:55], v[164:167]
    s_waitcnt lgkmcnt(3)
    ds_read_b128 a[184:187], v20 offset:22528
    v_cvt_pk_bf16_f32 v60, v120, v121
    v_mfma_f32_16x16x32_bf16 v[136:139], a[168:171], v[48:51], v[136:139]
    s_waitcnt lgkmcnt(3)
    v_exp_f32 v122, v122
    v_mfma_f32_16x16x32_bf16 v[168:171], a[168:171], v[52:55], v[168:171]
    buffer_load_dword v3, v4, s[8:11], s23 offen sc0 sc1
    v_mfma_f32_16x16x32_bf16 v[140:143], a[172:175], v[48:51], v[140:143]
    v_exp_f32 v123, v123
    v_mfma_f32_16x16x32_bf16 v[172:175], a[172:175], v[52:55], v[172:175]
    s_waitcnt lgkmcnt(2)
    ds_read_b128 a[188:191], v20 offset:23552
    v_cvt_pk_bf16_f32 v61, v122, v123
    v_mfma_f32_16x16x32_bf16 v[144:147], a[176:179], v[48:51], v[144:147]
    v_exp_f32 v124, v124
    v_mfma_f32_16x16x32_bf16 v[176:179], a[176:179], v[52:55], v[176:179]
    s_waitcnt lgkmcnt(2)
    v_mfma_f32_16x16x32_bf16 v[148:151], a[180:183], v[48:51], v[148:151]
    v_exp_f32 v125, v125
    v_mfma_f32_16x16x32_bf16 v[180:183], a[180:183], v[52:55], v[180:183]
    s_waitcnt lgkmcnt(1)
    v_cvt_pk_bf16_f32 v62, v124, v125
    v_xor_b32 v19, 98304, v19
    v_mfma_f32_16x16x32_bf16 v[152:155], a[184:187], v[48:51], v[152:155]
    v_exp_f32 v126, v126
    v_mfma_f32_16x16x32_bf16 v[184:187], a[184:187], v[52:55], v[184:187]
    s_waitcnt lgkmcnt(0)
    v_xor_b32 v20, 98304, v20
    v_mfma_f32_16x16x32_bf16 v[156:159], a[188:191], v[48:51], v[156:159]
    v_exp_f32 v127, v127
    v_mfma_f32_16x16x32_bf16 v[188:191], a[188:191], v[52:55], v[188:191]
    v_cvt_pk_bf16_f32 v63, v126, v127
    v_mfma_f32_16x16x32_bf16 v[112:115], a[128:131], a[224:227], v[72:75]
    v_exp_f32 v96, v96
    v_mfma_f32_16x16x32_bf16 v[112:115], a[132:135], a[228:231], v[112:115]
    buffer_store_dwordx4 a[20:23], v13, s[8:11], s17 offen offset:3584 sc0 sc1
    v_mfma_f32_16x16x32_bf16 v[112:115], a[136:139], a[232:235], v[112:115]
    v_exp_f32 v97, v97
    v_mfma_f32_16x16x32_bf16 v[112:115], a[140:143], a[236:239], v[112:115]
    v_cvt_pk_bf16_f32 v48, v96, v97
    v_lshlrev_b32 v12, 3, v0
    v_mfma_f32_16x16x32_bf16 v[120:123], a[128:131], a[240:243], v[76:79]
    s_lshl_b32 s101, s2, 11
    v_exp_f32 v98, v98
    v_mfma_f32_16x16x32_bf16 v[120:123], a[132:135], a[244:247], v[120:123]
    v_add_f32 v80, 0, v21
    v_min_f32 v80, v80, v64
    v_mfma_f32_16x16x32_bf16 v[120:123], a[136:139], a[248:251], v[120:123]
    s_add_u32 s101, s101, 524288
    v_exp_f32 v99, v99
    v_mfma_f32_16x16x32_bf16 v[120:123], a[140:143], a[252:255], v[120:123]
    buffer_store_dwordx2 v[24:25], v12, s[8:11], s101 offen sc0 sc1
    v_mfma_f32_16x16x32_bf16 v[116:119], a[144:147], a[224:227], v[72:75]
    s_lshl_b32 s101, s2, 6
    v_exp_f32 v100, v100
    v_mfma_f32_16x16x32_bf16 v[116:119], a[148:151], a[228:231], v[116:119]
    s_add_u32 s101, s101, 65536
    ds_read_b128 a[128:131], v18 offset:16384
    v_cvt_pk_bf16_f32 v49, v98, v99
    v_mfma_f32_16x16x32_bf16 v[116:119], a[152:155], a[232:235], v[116:119]
    s_add_u32 s19, s82, 32768
    v_exp_f32 v101, v101
    v_mfma_f32_16x16x32_bf16 v[116:119], a[156:159], a[236:239], v[116:119]
    s_sub_u32 s82, s12, s13
    ds_read_b128 a[132:135], v18 offset:17408
    v_cvt_pk_bf16_f32 v50, v100, v101
    v_mfma_f32_16x16x32_bf16 v[124:127], a[144:147], a[240:243], v[76:79]
    s_sub_u32 s82, s82, 1
    v_exp_f32 v102, v102
    v_mfma_f32_16x16x32_bf16 v[124:127], a[148:151], a[244:247], v[124:127]
    s_cmp_gt_u32 s12, s13
    s_cselect_b32 s82, s82, s12
    s_lshl_b32 s82, s82, 16
    ds_read_b128 a[136:139], v18 offset:18432
    v_mfma_f32_16x16x32_bf16 v[124:127], a[152:155], a[248:251], v[124:127]
    s_add_u32 s82, s82, s81
    v_exp_f32 v103, v103
    v_mfma_f32_16x16x32_bf16 v[124:127], a[156:159], a[252:255], v[124:127]
    s_cmp_ge_u32 s12, 17
    s_cselect_b32 s82, 2147471360, s82
    ds_read_b128 a[140:143], v18 offset:19456
    v_cvt_pk_bf16_f32 v51, v102, v103
    v_mfma_f32_16x16x32_bf16 v[40:43], v[28:31], v[56:59], v[40:43]
    s_add_u32 s12, s12, 1
    v_exp_f32 v104, v104
    v_mfma_f32_16x16x32_bf16 v[44:47], v[28:31], v[60:63], v[44:47]
    ds_read_b128 a[144:147], v18 offset:20480
    v_mov_b32 v13, 0
    v_mfma_f32_16x16x32_bf16 v[192:195], a[160:163], v[56:59], v[192:195]
    v_exp_f32 v105, v105
    v_mfma_f32_16x16x32_bf16 v[224:227], a[160:163], v[60:63], v[224:227]
    ds_read_b128 a[148:151], v18 offset:21504
    v_cvt_pk_bf16_f32 v52, v104, v105
    v_mfma_f32_16x16x32_bf16 v[196:199], a[164:167], v[56:59], v[196:199]
    v_exp_f32 v106, v106
    v_mfma_f32_16x16x32_bf16 v[228:231], a[164:167], v[60:63], v[228:231]
    ds_read_b128 a[152:155], v18 offset:22528
    v_add_f32 v81, 0xf1800000, v21
    v_mfma_f32_16x16x32_bf16 v[200:203], a[168:171], v[56:59], v[200:203]
    v_exp_f32 v107, v107
    v_mfma_f32_16x16x32_bf16 v[232:235], a[168:171], v[60:63], v[232:235]
    ds_read_b128 a[156:159], v18 offset:23552
    v_cvt_pk_bf16_f32 v53, v106, v107
    v_mfma_f32_16x16x32_bf16 v[204:207], a[172:175], v[56:59], v[204:207]
    v_exp_f32 v108, v108
    v_mfma_f32_16x16x32_bf16 v[236:239], a[172:175], v[60:63], v[236:239]
    buffer_store_dword v13, v7, s[8:11], s101 offen sc0 sc1
    v_mfma_f32_16x16x32_bf16 v[208:211], a[176:179], v[56:59], v[208:211]
    s_lshl_b32 s101, s66, 6
    v_exp_f32 v109, v109
    v_mfma_f32_16x16x32_bf16 v[240:243], a[176:179], v[60:63], v[240:243]
    s_add_u32 s101, s101, 81920
    v_cvt_pk_bf16_f32 v54, v108, v109
    v_xor_b32 v18, 196608, v18
    v_mfma_f32_16x16x32_bf16 v[212:215], a[180:183], v[56:59], v[212:215]
    v_exp_f32 v110, v110
    v_mfma_f32_16x16x32_bf16 v[244:247], a[180:183], v[60:63], v[244:247]
    buffer_store_dwordx4 v[24:27], v7, s[8:11], s101 offen sc0 sc1
    v_mfma_f32_16x16x32_bf16 v[216:219], a[184:187], v[56:59], v[216:219]
    v_exp_f32 v111, v111
    v_mfma_f32_16x16x32_bf16 v[248:251], a[184:187], v[60:63], v[248:251]
    v_cvt_pk_bf16_f32 v55, v110, v111
    v_min_f32 v81, v81, v65
    v_mfma_f32_16x16x32_bf16 v[220:223], a[188:191], v[56:59], v[220:223]
    buffer_store_dwordx4 v[24:27], v7, s[8:11], s101 offen offset:16 sc0 sc1
    v_mfma_f32_16x16x32_bf16 v[252:255], a[188:191], v[60:63], v[252:255]
    v_add_f32 v82, 0xf2000000, v21
    v_min_f32 v82, v82, v66
    s_waitcnt vmcnt(9) lgkmcnt(0)
    s_barrier
    v_mfma_f32_16x16x32_bf16 v[96:99], a[128:131], a[192:195], v[64:67]
    s_add_u32 m0, s15, 0
    ds_read_b128 a[160:163], v19 offset:0
    v_mfma_f32_16x16x32_bf16 v[96:99], a[132:135], a[196:199], v[96:99]
    ds_read_b128 a[164:167], v19 offset:1024
    v_mfma_f32_16x16x32_bf16 v[96:99], a[136:139], a[200:203], v[96:99]
    v_exp_f32 v112, v112
    v_mfma_f32_16x16x32_bf16 v[96:99], a[140:143], a[204:207], v[96:99]
    buffer_load_dwordx4 v1, s[8:11], s82 offen offset:0  lds
    v_mfma_f32_16x16x32_bf16 v[104:107], a[128:131], a[208:211], v[68:71]
    v_exp_f32 v113, v113
    v_mfma_f32_16x16x32_bf16 v[104:107], a[132:135], a[212:215], v[104:107]
    ds_read_b128 a[168:171], v19 offset:2048
    v_cvt_pk_bf16_f32 v56, v112, v113
    v_mfma_f32_16x16x32_bf16 v[104:107], a[136:139], a[216:219], v[104:107]
    v_exp_f32 v114, v114
    v_mfma_f32_16x16x32_bf16 v[104:107], a[140:143], a[220:223], v[104:107]
    buffer_load_dwordx4 v1, s[8:11], s82 offen offset:1024  lds
    v_mfma_f32_16x16x32_bf16 v[100:103], a[144:147], a[192:195], v[64:67]
    v_exp_f32 v115, v115
    v_mfma_f32_16x16x32_bf16 v[100:103], a[148:151], a[196:199], v[100:103]
    ds_read_b128 a[172:175], v19 offset:3072
    v_cvt_pk_bf16_f32 v57, v114, v115
    v_mfma_f32_16x16x32_bf16 v[100:103], a[152:155], a[200:203], v[100:103]
    v_exp_f32 v116, v116
    v_mfma_f32_16x16x32_bf16 v[100:103], a[156:159], a[204:207], v[100:103]
    buffer_load_dwordx4 v1, s[8:11], s82 offen offset:2048  lds
    v_mfma_f32_16x16x32_bf16 v[108:111], a[144:147], a[208:211], v[68:71]
    v_exp_f32 v117, v117
    v_mfma_f32_16x16x32_bf16 v[108:111], a[148:151], a[212:215], v[108:111]
    ds_read_b128 a[176:179], v20 offset:4096
    v_cvt_pk_bf16_f32 v58, v116, v117
    v_mfma_f32_16x16x32_bf16 v[108:111], a[152:155], a[216:219], v[108:111]
    v_exp_f32 v118, v118
    v_mfma_f32_16x16x32_bf16 v[108:111], a[156:159], a[220:223], v[108:111]
    buffer_load_dwordx4 v1, s[8:11], s82 offen offset:3072  lds
    v_mfma_f32_16x16x32_bf16 v[32:35], v[28:31], v[48:51], v[32:35]
    s_add_u32 m0, s15, 4096
    v_exp_f32 v119, v119
    v_mfma_f32_16x16x32_bf16 v[36:39], v[28:31], v[52:55], v[36:39]
    s_waitcnt lgkmcnt(4)
    ds_read_b128 a[180:183], v20 offset:5120
    v_cvt_pk_bf16_f32 v59, v118, v119
    v_mfma_f32_16x16x32_bf16 v[128:131], a[160:163], v[48:51], v[128:131]
    v_exp_f32 v120, v120
    v_mfma_f32_16x16x32_bf16 v[160:163], a[160:163], v[52:55], v[160:163]
    s_waitcnt lgkmcnt(4)
    v_mfma_f32_16x16x32_bf16 v[132:135], a[164:167], v[48:51], v[132:135]
    v_exp_f32 v121, v121
    v_mfma_f32_16x16x32_bf16 v[164:167], a[164:167], v[52:55], v[164:167]
    s_waitcnt lgkmcnt(3)
    ds_read_b128 a[184:187], v20 offset:6144
    v_cvt_pk_bf16_f32 v60, v120, v121
    v_mfma_f32_16x16x32_bf16 v[136:139], a[168:171], v[48:51], v[136:139]
    s_waitcnt lgkmcnt(3)
    v_exp_f32 v122, v122
    v_mfma_f32_16x16x32_bf16 v[168:171], a[168:171], v[52:55], v[168:171]
    buffer_load_dwordx4 v15, s[8:11], s82 offen offset:0  lds
    v_mfma_f32_16x16x32_bf16 v[140:143], a[172:175], v[48:51], v[140:143]
    v_exp_f32 v123, v123
    v_mfma_f32_16x16x32_bf16 v[172:175], a[172:175], v[52:55], v[172:175]
    s_waitcnt lgkmcnt(2)
    ds_read_b128 a[188:191], v20 offset:7168
    v_cvt_pk_bf16_f32 v61, v122, v123
    v_mfma_f32_16x16x32_bf16 v[144:147], a[176:179], v[48:51], v[144:147]
    s_waitcnt lgkmcnt(2)
    v_exp_f32 v124, v124
    v_mfma_f32_16x16x32_bf16 v[176:179], a[176:179], v[52:55], v[176:179]
    buffer_load_dwordx4 v15, s[8:11], s82 offen offset:1024  lds
    v_mfma_f32_16x16x32_bf16 v[148:151], a[180:183], v[48:51], v[148:151]
    v_exp_f32 v125, v125
    v_mfma_f32_16x16x32_bf16 v[180:183], a[180:183], v[52:55], v[180:183]
    s_waitcnt lgkmcnt(1)
    v_cvt_pk_bf16_f32 v62, v124, v125
    v_mfma_f32_16x16x32_bf16 v[152:155], a[184:187], v[48:51], v[152:155]
    s_waitcnt lgkmcnt(0)
    v_exp_f32 v126, v126
    v_mfma_f32_16x16x32_bf16 v[184:187], a[184:187], v[52:55], v[184:187]
    buffer_load_dwordx4 v15, s[8:11], s82 offen offset:2048  lds
    v_mfma_f32_16x16x32_bf16 v[156:159], a[188:191], v[48:51], v[156:159]
    v_exp_f32 v127, v127
    v_mfma_f32_16x16x32_bf16 v[188:191], a[188:191], v[52:55], v[188:191]
    v_cvt_pk_bf16_f32 v63, v126, v127
    v_mfma_f32_16x16x32_bf16 v[112:115], a[128:131], a[224:227], v[72:75]
    v_mfma_f32_16x16x32_bf16 v[112:115], a[132:135], a[228:231], v[112:115]
    v_mfma_f32_16x16x32_bf16 v[112:115], a[136:139], a[232:235], v[112:115]
    v_exp_f32 v96, v96
    v_mfma_f32_16x16x32_bf16 v[112:115], a[140:143], a[236:239], v[112:115]
    buffer_load_dwordx4 v15, s[8:11], s82 offen offset:3072  lds
    v_mfma_f32_16x16x32_bf16 v[120:123], a[128:131], a[240:243], v[76:79]
    s_xor_b32 s15, s15, 196608
    v_exp_f32 v97, v97
    v_mfma_f32_16x16x32_bf16 v[120:123], a[132:135], a[244:247], v[120:123]
    s_add_u32 m0, s16, 0
    ds_read_b128 a[128:131], v18 offset:0
    v_cvt_pk_bf16_f32 v48, v96, v97
    v_mfma_f32_16x16x32_bf16 v[120:123], a[136:139], a[248:251], v[120:123]
    v_exp_f32 v98, v98
    v_mfma_f32_16x16x32_bf16 v[120:123], a[140:143], a[252:255], v[120:123]
    buffer_load_dwordx4 v1, s[8:11], s19 offen offset:0  lds
    v_mfma_f32_16x16x32_bf16 v[116:119], a[144:147], a[224:227], v[72:75]
    v_exp_f32 v99, v99
    v_mfma_f32_16x16x32_bf16 v[116:119], a[148:151], a[228:231], v[116:119]
    ds_read_b128 a[132:135], v18 offset:1024
    v_cvt_pk_bf16_f32 v49, v98, v99
    v_mfma_f32_16x16x32_bf16 v[116:119], a[152:155], a[232:235], v[116:119]
    v_exp_f32 v100, v100
    v_mfma_f32_16x16x32_bf16 v[116:119], a[156:159], a[236:239], v[116:119]
    buffer_load_dwordx4 v1, s[8:11], s19 offen offset:1024  lds
    v_mfma_f32_16x16x32_bf16 v[124:127], a[144:147], a[240:243], v[76:79]
    v_exp_f32 v101, v101
    v_mfma_f32_16x16x32_bf16 v[124:127], a[148:151], a[244:247], v[124:127]
    ds_read_b128 a[136:139], v18 offset:2048
    v_cvt_pk_bf16_f32 v50, v100, v101
    v_mfma_f32_16x16x32_bf16 v[124:127], a[152:155], a[248:251], v[124:127]
    v_exp_f32 v102, v102
    v_mfma_f32_16x16x32_bf16 v[124:127], a[156:159], a[252:255], v[124:127]
    buffer_load_dwordx4 v1, s[8:11], s19 offen offset:2048  lds
    v_mfma_f32_16x16x32_bf16 v[40:43], v[28:31], v[56:59], v[40:43]
    v_exp_f32 v103, v103
    v_mfma_f32_16x16x32_bf16 v[44:47], v[28:31], v[60:63], v[44:47]
    ds_read_b128 a[140:143], v18 offset:3072
    v_cvt_pk_bf16_f32 v51, v102, v103
    v_mfma_f32_16x16x32_bf16 v[192:195], a[160:163], v[56:59], v[192:195]
    v_exp_f32 v104, v104
    v_mfma_f32_16x16x32_bf16 v[224:227], a[160:163], v[60:63], v[224:227]
    v_mfma_f32_16x16x32_bf16 v[196:199], a[164:167], v[56:59], v[196:199]
    v_exp_f32 v105, v105
    v_mfma_f32_16x16x32_bf16 v[228:231], a[164:167], v[60:63], v[228:231]
    ds_read_b128 a[144:147], v18 offset:4096
    v_cvt_pk_bf16_f32 v52, v104, v105
    v_mfma_f32_16x16x32_bf16 v[200:203], a[168:171], v[56:59], v[200:203]
    v_exp_f32 v106, v106
    v_mfma_f32_16x16x32_bf16 v[232:235], a[168:171], v[60:63], v[232:235]
    buffer_load_dwordx4 v1, s[8:11], s19 offen offset:3072  lds
    v_mfma_f32_16x16x32_bf16 v[204:207], a[172:175], v[56:59], v[204:207]
    s_add_u32 m0, s16, 4096
    v_exp_f32 v107, v107
    v_mfma_f32_16x16x32_bf16 v[236:239], a[172:175], v[60:63], v[236:239]
    ds_read_b128 a[148:151], v18 offset:5120
    v_cvt_pk_bf16_f32 v53, v106, v107
    v_mfma_f32_16x16x32_bf16 v[208:211], a[176:179], v[56:59], v[208:211]
    v_exp_f32 v108, v108
    v_mfma_f32_16x16x32_bf16 v[240:243], a[176:179], v[60:63], v[240:243]
    buffer_load_dwordx4 v15, s[8:11], s19 offen offset:0  lds
    v_mfma_f32_16x16x32_bf16 v[212:215], a[180:183], v[56:59], v[212:215]
    v_exp_f32 v109, v109
    v_mfma_f32_16x16x32_bf16 v[244:247], a[180:183], v[60:63], v[244:247]
    ds_read_b128 a[152:155], v18 offset:6144
    v_cvt_pk_bf16_f32 v54, v108, v109
    v_mfma_f32_16x16x32_bf16 v[216:219], a[184:187], v[56:59], v[216:219]
    v_exp_f32 v110, v110
    v_mfma_f32_16x16x32_bf16 v[248:251], a[184:187], v[60:63], v[248:251]
    buffer_load_dwordx4 v15, s[8:11], s19 offen offset:1024  lds
    v_mfma_f32_16x16x32_bf16 v[220:223], a[188:191], v[56:59], v[220:223]
    v_exp_f32 v111, v111
    v_mfma_f32_16x16x32_bf16 v[252:255], a[188:191], v[60:63], v[252:255]
    ds_read_b128 a[156:159], v18 offset:7168
    v_cvt_pk_bf16_f32 v55, v110, v111
    s_waitcnt lgkmcnt(7)
    v_mfma_f32_16x16x32_bf16 v[96:99], a[128:131], a[192:195], v[64:67]
    s_waitcnt lgkmcnt(6)
    s_lshl_b32 s24, s60, 2
    s_add_u32 s24, s24, s3
    ds_read_b128 a[160:163], v19 offset:16384
    v_mfma_f32_16x16x32_bf16 v[96:99], a[132:135], a[196:199], v[96:99]
    s_waitcnt lgkmcnt(6)
    s_lshl_b32 s24, s24, 3
    s_add_u32 s24, s24, s4
    ds_read_b128 a[164:167], v19 offset:17408
    v_mfma_f32_16x16x32_bf16 v[96:99], a[136:139], a[200:203], v[96:99]
    s_waitcnt lgkmcnt(6)
    s_lshl_b32 s24, s24, 2
    v_exp_f32 v112, v112
    v_mfma_f32_16x16x32_bf16 v[96:99], a[140:143], a[204:207], v[96:99]
    buffer_load_dwordx4 v15, s[8:11], s19 offen offset:2048  lds
    v_mfma_f32_16x16x32_bf16 v[104:107], a[128:131], a[208:211], v[68:71]
    s_add_u32 s24, s24, s5
    v_exp_f32 v113, v113
    v_mfma_f32_16x16x32_bf16 v[104:107], a[132:135], a[212:215], v[104:107]
    s_lshl_b32 s24, s24, 13
    ds_read_b128 a[168:171], v19 offset:18432
    v_cvt_pk_bf16_f32 v56, v112, v113
    v_mfma_f32_16x16x32_bf16 v[104:107], a[136:139], a[216:219], v[104:107]
    s_waitcnt lgkmcnt(6)
    s_add_u32 s24, s24, 50331648
    v_exp_f32 v114, v114
    s_waitcnt vmcnt(20)
    v_cmp_ne_u32 vcc, 0, v3
    s_cmp_eq_u64 vcc, -1
    s_cbranch_scc0 L_C1_slow_9
L_C1_ok_10:
    v_mfma_f32_16x16x32_bf16 v[104:107], a[140:143], a[220:223], v[104:107]
    buffer_load_dwordx4 v15, s[8:11], s19 offen offset:3072  lds
    v_mfma_f32_16x16x32_bf16 v[100:103], a[144:147], a[192:195], v[64:67]
    s_waitcnt lgkmcnt(5)
    s_xor_b32 s16, s16, 98304
    v_exp_f32 v115, v115
    v_mfma_f32_16x16x32_bf16 v[100:103], a[148:151], a[196:199], v[100:103]
    s_waitcnt lgkmcnt(4)
    s_xor_b32 s74, s24, 0
    ds_read_b128 a[172:175], v19 offset:19456
    v_cvt_pk_bf16_f32 v57, v114, v115
    v_mfma_f32_16x16x32_bf16 v[100:103], a[152:155], a[200:203], v[100:103]
    s_waitcnt lgkmcnt(4)
    v_exp_f32 v116, v116
    v_mfma_f32_16x16x32_bf16 v[100:103], a[156:159], a[204:207], v[100:103]
    buffer_load_dwordx4 a[64:67], v1, s[8:11], s74 offen offset:0
    v_mfma_f32_16x16x32_bf16 v[108:111], a[144:147], a[208:211], v[68:71]
    s_xor_b32 s74, s24, 0
    v_exp_f32 v117, v117
    v_mfma_f32_16x16x32_bf16 v[108:111], a[148:151], a[212:215], v[108:111]
    ds_read_b128 a[176:179], v20 offset:20480
    v_cvt_pk_bf16_f32 v58, v116, v117
    v_mfma_f32_16x16x32_bf16 v[108:111], a[152:155], a[216:219], v[108:111]
    v_exp_f32 v118, v118
    v_mfma_f32_16x16x32_bf16 v[108:111], a[156:159], a[220:223], v[108:111]
    buffer_load_dwordx4 a[68:71], v1, s[8:11], s74 offen offset:1024
    v_mfma_f32_16x16x32_bf16 v[32:35], v[28:31], v[48:51], v[32:35]
    s_xor_b32 s74, s24, 0
    v_exp_f32 v119, v119
    v_mfma_f32_16x16x32_bf16 v[36:39], v[28:31], v[52:55], v[36:39]
    s_waitcnt lgkmcnt(4)
    ds_read_b128 a[180:183], v20 offset:21504
    v_cvt_pk_bf16_f32 v59, v118, v119
    v_mfma_f32_16x16x32_bf16 v[128:131], a[160:163], v[48:51], v[128:131]
    s_waitcnt lgkmcnt(4)
    v_exp_f32 v120, v120
    v_mfma_f32_16x16x32_bf16 v[160:163], a[160:163], v[52:55], v[160:163]
    buffer_load_dwordx4 a[72:75], v1, s[8:11], s74 offen offset:2048
    v_mfma_f32_16x16x32_bf16 v[132:135], a[164:167], v[48:51], v[132:135]
    s_xor_b32 s74, s24, 0
    v_exp_f32 v121, v121
    v_mfma_f32_16x16x32_bf16 v[164:167], a[164:167], v[52:55], v[164:167]
    s_waitcnt lgkmcnt(3)
    ds_read_b128 a[184:187], v20 offset:22528
    v_cvt_pk_bf16_f32 v60, v120, v121
    v_mfma_f32_16x16x32_bf16 v[136:139], a[168:171], v[48:51], v[136:139]
    s_waitcnt lgkmcnt(3)
    v_exp_f32 v122, v122
    v_mfma_f32_16x16x32_bf16 v[168:171], a[168:171], v[52:55], v[168:171]
    buffer_load_dwordx4 a[76:79], v1, s[8:11], s74 offen offset:3072
    v_mfma_f32_16x16x32_bf16 v[140:143], a[172:175], v[48:51], v[140:143]
    s_xor_b32 s74, s24, 4096
    v_exp_f32 v123, v123
    v_mfma_f32_16x16x32_bf16 v[172:175], a[172:175], v[52:55], v[172:175]
    s_waitcnt lgkmcnt(2)
    ds_read_b128 a[188:191], v20 offset:23552
    v_cvt_pk_bf16_f32 v61, v122, v123
    v_mfma_f32_16x16x32_bf16 v[144:147], a[176:179], v[48:51], v[144:147]
    s_waitcnt lgkmcnt(2)
    v_exp_f32 v124, v124
    v_mfma_f32_16x16x32_bf16 v[176:179], a[176:179], v[52:55], v[176:179]
    buffer_load_dwordx4 a[80:83], v1, s[8:11], s74 offen offset:0
    v_mfma_f32_16x16x32_bf16 v[148:151], a[180:183], v[48:51], v[148:151]
    v_exp_f32 v125, v125
    v_mfma_f32_16x16x32_bf16 v[180:183], a[180:183], v[52:55], v[180:183]
    s_waitcnt lgkmcnt(1)
    v_cvt_pk_bf16_f32 v62, v124, v125
    v_xor_b32 v19, 98304, v19
    v_mfma_f32_16x16x32_bf16 v[152:155], a[184:187], v[48:51], v[152:155]
    v_exp_f32 v126, v126
    v_mfma_f32_16x16x32_bf16 v[184:187], a[184:187], v[52:55], v[184:187]
    s_waitcnt lgkmcnt(0)
    v_xor_b32 v20, 98304, v20
    v_mfma_f32_16x16x32_bf16 v[156:159], a[188:191], v[48:51], v[156:159]
    v_exp_f32 v127, v127
    v_mfma_f32_16x16x32_bf16 v[188:191], a[188:191], v[52:55], v[188:191]
    v_cvt_pk_bf16_f32 v63, v126, v127
    v_mfma_f32_16x16x32_bf16 v[112:115], a[128:131], a[224:227], v[72:75]
    s_add_u32 m0, s62, 32768
    v_exp_f32 v96, v96
    v_mfma_f32_16x16x32_bf16 v[112:115], a[132:135], a[228:231], v[112:115]
    v_add_f32 v83, 0xf2400000, v21
    v_min_f32 v83, v83, v67
    v_mfma_f32_16x16x32_bf16 v[112:115], a[136:139], a[232:235], v[112:115]
    s_xor_b32 s98, s65, 0
    v_exp_f32 v97, v97
    v_mfma_f32_16x16x32_bf16 v[112:115], a[140:143], a[236:239], v[112:115]
    v_cvt_pk_bf16_f32 v48, v96, v97
    v_add_f32 v84, 0xf3800000, v21
    v_mfma_f32_16x16x32_bf16 v[120:123], a[128:131], a[240:243], v[76:79]
    v_exp_f32 v98, v98
    v_mfma_f32_16x16x32_bf16 v[120:123], a[132:135], a[244:247], v[120:123]
    buffer_load_dwordx4 v8, s[28:31], s98 offen offset:0   lds
    v_mfma_f32_16x16x32_bf16 v[120:123], a[136:139], a[248:251], v[120:123]
    v_exp_f32 v99, v99
    v_mfma_f32_16x16x32_bf16 v[120:123], a[140:143], a[252:255], v[120:123]
    buffer_load_dwordx4 v9, s[28:31], s98 offen offset:1024   lds
    v_mfma_f32_16x16x32_bf16 v[116:119], a[144:147], a[224:227], v[72:75]
    v_exp_f32 v100, v100
    v_mfma_f32_16x16x32_bf16 v[116:119], a[148:151], a[228:231], v[116:119]
    ds_read_b128 a[128:131], v18 offset:16384
    v_cvt_pk_bf16_f32 v49, v98, v99
    v_mfma_f32_16x16x32_bf16 v[116:119], a[152:155], a[232:235], v[116:119]
    s_add_u32 s19, s82, 32768
    v_exp_f32 v101, v101
    v_mfma_f32_16x16x32_bf16 v[116:119], a[156:159], a[236:239], v[116:119]
    s_sub_u32 s82, s12, s13
    ds_read_b128 a[132:135], v18 offset:17408
    v_cvt_pk_bf16_f32 v50, v100, v101
    v_mfma_f32_16x16x32_bf16 v[124:127], a[144:147], a[240:243], v[76:79]
    s_sub_u32 s82, s82, 1
    v_exp_f32 v102, v102
    v_mfma_f32_16x16x32_bf16 v[124:127], a[148:151], a[244:247], v[124:127]
    s_cmp_gt_u32 s12, s13
    s_cselect_b32 s82, s82, s12
    s_lshl_b32 s82, s82, 16
    ds_read_b128 a[136:139], v18 offset:18432
    v_mfma_f32_16x16x32_bf16 v[124:127], a[152:155], a[248:251], v[124:127]
    s_add_u32 s82, s82, s81
    v_exp_f32 v103, v103
    v_mfma_f32_16x16x32_bf16 v[124:127], a[156:159], a[252:255], v[124:127]
    s_cmp_ge_u32 s12, 17
    s_cselect_b32 s82, 2147471360, s82
    ds_read_b128 a[140:143], v18 offset:19456
    v_cvt_pk_bf16_f32 v51, v102, v103
    v_mfma_f32_16x16x32_bf16 v[40:43], v[28:31], v[56:59], v[40:43]
    s_add_u32 s12, s12, 1
    v_exp_f32 v104, v104
    v_mfma_f32_16x16x32_bf16 v[44:47], v[28:31], v[60:63], v[44:47]
    ds_read_b128 a[144:147], v18 offset:20480
    v_min_f32 v84, v84, v64
    v_mfma_f32_16x16x32_bf16 v[192:195], a[160:163], v[56:59], v[192:195]
    v_exp_f32 v105, v105
    v_mfma_f32_16x16x32_bf16 v[224:227], a[160:163], v[60:63], v[224:227]
    ds_read_b128 a[148:151], v18 offset:21504
    v_cvt_pk_bf16_f32 v52, v104, v105
    v_mfma_f32_16x16x32_bf16 v[196:199], a[164:167], v[56:59], v[196:199]
    v_exp_f32 v106, v106
    v_mfma_f32_16x16x32_bf16 v[228:231], a[164:167], v[60:63], v[228:231]
    ds_read_b128 a[152:155], v18 offset:22528
    v_add_f32 v85, 0xf3880000, v21
    v_mfma_f32_16x16x32_bf16 v[200:203], a[168:171], v[56:59], v[200:203]
    v_exp_f32 v107, v107
    v_mfma_f32_16x16x32_bf16 v[232:235], a[168:171], v[60:63], v[232:235]
    ds_read_b128 a[156:159], v18 offset:23552
    v_cvt_pk_bf16_f32 v53, v106, v107
    v_mfma_f32_16x16x32_bf16 v[204:207], a[172:175], v[56:59], v[204:207]
    v_exp_f32 v108, v108
    v_mfma_f32_16x16x32_bf16 v[236:239], a[172:175], v[60:63], v[236:239]
    buffer_load_dwordx4 v10, s[28:31], s98 offen offset:2048   lds
    v_mfma_f32_16x16x32_bf16 v[208:211], a[176:179], v[56:59], v[208:211]
    v_exp_f32 v109, v109
    v_mfma_f32_16x16x32_bf16 v[240:243], a[176:179], v[60:63], v[240:243]
    v_cvt_pk_bf16_f32 v54, v108, v109
    v_xor_b32 v18, 196608, v18
    v_mfma_f32_16x16x32_bf16 v[212:215], a[180:183], v[56:59], v[212:215]
    v_exp_f32 v110, v110
    v_mfma_f32_16x16x32_bf16 v[244:247], a[180:183], v[60:63], v[244:247]
    buffer_load_dwordx4 v11, s[28:31], s98 offen offset:3072   lds
    v_mfma_f32_16x16x32_bf16 v[216:219], a[184:187], v[56:59], v[216:219]
    s_xor_b32 s74, s24, 4096
    v_exp_f32 v111, v111
    v_mfma_f32_16x16x32_bf16 v[248:251], a[184:187], v[60:63], v[248:251]
    v_cvt_pk_bf16_f32 v55, v110, v111
    v_min_f32 v85, v85, v65
    v_mfma_f32_16x16x32_bf16 v[220:223], a[188:191], v[56:59], v[220:223]
    buffer_load_dwordx4 a[84:87], v1, s[8:11], s74 offen offset:1024
    v_mfma_f32_16x16x32_bf16 v[252:255], a[188:191], v[60:63], v[252:255]
    s_xor_b32 s74, s24, 4096
    buffer_load_dwordx4 a[88:91], v1, s[8:11], s74 offen offset:2048
    s_xor_b32 s74, s24, 4096
    buffer_load_dwordx4 a[92:95], v1, s[8:11], s74 offen offset:3072
    s_waitcnt vmcnt(12) lgkmcnt(0)
    s_barrier
    v_mfma_f32_16x16x32_bf16 v[96:99], a[128:131], a[192:195], v[64:67]
    s_add_u32 m0, s15, 0
    ds_read_b128 a[160:163], v19 offset:0
    v_mfma_f32_16x16x32_bf16 v[96:99], a[132:135], a[196:199], v[96:99]
    ds_read_b128 a[164:167], v19 offset:1024
    v_mfma_f32_16x16x32_bf16 v[96:99], a[136:139], a[200:203], v[96:99]
    v_exp_f32 v112, v112
    v_mfma_f32_16x16x32_bf16 v[96:99], a[140:143], a[204:207], v[96:99]
    buffer_load_dwordx4 v1, s[8:11], s82 offen offset:0  lds
    v_mfma_f32_16x16x32_bf16 v[104:107], a[128:131], a[208:211], v[68:71]
    v_exp_f32 v113, v113
    v_mfma_f32_16x16x32_bf16 v[104:107], a[132:135], a[212:215], v[104:107]
    ds_read_b128 a[168:171], v19 offset:2048
    v_cvt_pk_bf16_f32 v56, v112, v113
    v_mfma_f32_16x16x32_bf16 v[104:107], a[136:139], a[216:219], v[104:107]
    v_exp_f32 v114, v114
    v_mfma_f32_16x16x32_bf16 v[104:107], a[140:143], a[220:223], v[104:107]
    buffer_load_dwordx4 v1, s[8:11], s82 offen offset:1024  lds
    v_mfma_f32_16x16x32_bf16 v[100:103], a[144:147], a[192:195], v[64:67]
    v_exp_f32 v115, v115
    v_mfma_f32_16x16x32_bf16 v[100:103], a[148:151], a[196:199], v[100:103]
    ds_read_b128 a[172:175], v19 offset:3072
    v_cvt_pk_bf16_f32 v57, v114, v115
    v_mfma_f32_16x16x32_bf16 v[100:103], a[152:155], a[200:203], v[100:103]
    v_exp_f32 v116, v116
    v_mfma_f32_16x16x32_bf16 v[100:103], a[156:159], a[204:207], v[100:103]
    buffer_load_dwordx4 v1, s[8:11], s82 offen offset:2048  lds
    v_mfma_f32_16x16x32_bf16 v[108:111], a[144:147], a[208:211], v[68:71]
    v_exp_f32 v117, v117
    v_mfma_f32_16x16x32_bf16 v[108:111], a[148:151], a[212:215], v[108:111]
    ds_read_b128 a[176:179], v20 offset:4096
    v_cvt_pk_bf16_f32 v58, v116, v117
    v_mfma_f32_16x16x32_bf16 v[108:111], a[152:155], a[216:219], v[108:111]
    v_exp_f32 v118, v118
    v_mfma_f32_16x16x32_bf16 v[108:111], a[156:159], a[220:223], v[108:111]
    buffer_load_dwordx4 v1, s[8:11], s82 offen offset:3072  lds
    v_mfma_f32_16x16x32_bf16 v[32:35], v[28:31], v[48:51], v[32:35]
    s_add_u32 m0, s15, 4096
    v_exp_f32 v119, v119
    v_mfma_f32_16x16x32_bf16 v[36:39], v[28:31], v[52:55], v[36:39]
    s_waitcnt lgkmcnt(4)
    ds_read_b128 a[180:183], v20 offset:5120
    v_cvt_pk_bf16_f32 v59, v118, v119
    v_mfma_f32_16x16x32_bf16 v[128:131], a[160:163], v[48:51], v[128:131]
    v_exp_f32 v120, v120
    v_mfma_f32_16x16x32_bf16 v[160:163], a[160:163], v[52:55], v[160:163]
    s_waitcnt lgkmcnt(4)
    v_mfma_f32_16x16x32_bf16 v[132:135], a[164:167], v[48:51], v[132:135]
    v_exp_f32 v121, v121
    v_mfma_f32_16x16x32_bf16 v[164:167], a[164:167], v[52:55], v[164:167]
    s_waitcnt lgkmcnt(3)
    ds_read_b128 a[184:187], v20 offset:6144
    v_cvt_pk_bf16_f32 v60, v120, v121
    v_mfma_f32_16x16x32_bf16 v[136:139], a[168:171], v[48:51], v[136:139]
    s_waitcnt lgkmcnt(3)
    v_exp_f32 v122, v122
    v_mfma_f32_16x16x32_bf16 v[168:171], a[168:171], v[52:55], v[168:171]
    buffer_load_dwordx4 v15, s[8:11], s82 offen offset:0  lds
    v_mfma_f32_16x16x32_bf16 v[140:143], a[172:175], v[48:51], v[140:143]
    v_exp_f32 v123, v123
    v_mfma_f32_16x16x32_bf16 v[172:175], a[172:175], v[52:55], v[172:175]
    s_waitcnt lgkmcnt(2)
    ds_read_b128 a[188:191], v20 offset:7168
    v_cvt_pk_bf16_f32 v61, v122, v123
    v_mfma_f32_16x16x32_bf16 v[144:147], a[176:179], v[48:51], v[144:147]
    s_waitcnt lgkmcnt(2)
    v_exp_f32 v124, v124
    v_mfma_f32_16x16x32_bf16 v[176:179], a[176:179], v[52:55], v[176:179]
    buffer_load_dwordx4 v15, s[8:11], s82 offen offset:1024  lds
    v_mfma_f32_16x16x32_bf16 v[148:151], a[180:183], v[48:51], v[148:151]
    v_exp_f32 v125, v125
    v_mfma_f32_16x16x32_bf16 v[180:183], a[180:183], v[52:55], v[180:183]
    s_waitcnt lgkmcnt(1)
    v_cvt_pk_bf16_f32 v62, v124, v125
    v_mfma_f32_16x16x32_bf16 v[152:155], a[184:187], v[48:51], v[152:155]
    s_waitcnt lgkmcnt(0)
    v_exp_f32 v126, v126
    v_mfma_f32_16x16x32_bf16 v[184:187], a[184:187], v[52:55], v[184:187]
    buffer_load_dwordx4 v15, s[8:11], s82 offen offset:2048  lds
    v_mfma_f32_16x16x32_bf16 v[156:159], a[188:191], v[48:51], v[156:159]
    v_exp_f32 v127, v127
    v_mfma_f32_16x16x32_bf16 v[188:191], a[188:191], v[52:55], v[188:191]
    v_cvt_pk_bf16_f32 v63, v126, v127
    v_mfma_f32_16x16x32_bf16 v[112:115], a[128:131], a[224:227], v[72:75]
    v_mfma_f32_16x16x32_bf16 v[112:115], a[132:135], a[228:231], v[112:115]
    v_mfma_f32_16x16x32_bf16 v[112:115], a[136:139], a[232:235], v[112:115]
    v_exp_f32 v96, v96
    v_mfma_f32_16x16x32_bf16 v[112:115], a[140:143], a[236:239], v[112:115]
    buffer_load_dwordx4 v15, s[8:11], s82 offen offset:3072  lds
    v_mfma_f32_16x16x32_bf16 v[120:123], a[128:131], a[240:243], v[76:79]
    s_xor_b32 s15, s15, 196608
    v_exp_f32 v97, v97
    v_mfma_f32_16x16x32_bf16 v[120:123], a[132:135], a[244:247], v[120:123]
    s_add_u32 m0, s16, 0
    ds_read_b128 a[128:131], v18 offset:0
    v_cvt_pk_bf16_f32 v48, v96, v97
    v_mfma_f32_16x16x32_bf16 v[120:123], a[136:139], a[248:251], v[120:123]
    v_exp_f32 v98, v98
    v_mfma_f32_16x16x32_bf16 v[120:123], a[140:143], a[252:255], v[120:123]
    buffer_load_dwordx4 v1, s[8:11], s19 offen offset:0  lds
    v_mfma_f32_16x16x32_bf16 v[116:119], a[144:147], a[224:227], v[72:75]
    v_exp_f32 v99, v99
    v_mfma_f32_16x16x32_bf16 v[116:119], a[148:151], a[228:231], v[116:119]
    ds_read_b128 a[132:135], v18 offset:1024
    v_cvt_pk_bf16_f32 v49, v98, v99
    v_mfma_f32_16x16x32_bf16 v[116:119], a[152:155], a[232:235], v[116:119]
    v_exp_f32 v100, v100
    v_mfma_f32_16x16x32_bf16 v[116:119], a[156:159], a[236:239], v[116:119]
    buffer_load_dwordx4 v1, s[8:11], s19 offen offset:1024  lds
    v_mfma_f32_16x16x32_bf16 v[124:127], a[144:147], a[240:243], v[76:79]
    v_exp_f32 v101, v101
    v_mfma_f32_16x16x32_bf16 v[124:127], a[148:151], a[244:247], v[124:127]
    ds_read_b128 a[136:139], v18 offset:2048
    v_cvt_pk_bf16_f32 v50, v100, v101
    v_mfma_f32_16x16x32_bf16 v[124:127], a[152:155], a[248:251], v[124:127]
    v_exp_f32 v102, v102
    v_mfma_f32_16x16x32_bf16 v[124:127], a[156:159], a[252:255], v[124:127]
    buffer_load_dwordx4 v1, s[8:11], s19 offen offset:2048  lds
    v_mfma_f32_16x16x32_bf16 v[40:43], v[28:31], v[56:59], v[40:43]
    v_exp_f32 v103, v103
    v_mfma_f32_16x16x32_bf16 v[44:47], v[28:31], v[60:63], v[44:47]
    ds_read_b128 a[140:143], v18 offset:3072
    v_cvt_pk_bf16_f32 v51, v102, v103
    v_mfma_f32_16x16x32_bf16 v[192:195], a[160:163], v[56:59], v[192:195]
    v_exp_f32 v104, v104
    v_mfma_f32_16x16x32_bf16 v[224:227], a[160:163], v[60:63], v[224:227]
    v_mfma_f32_16x16x32_bf16 v[196:199], a[164:167], v[56:59], v[196:199]
    v_exp_f32 v105, v105
    v_mfma_f32_16x16x32_bf16 v[228:231], a[164:167], v[60:63], v[228:231]
    ds_read_b128 a[144:147], v18 offset:4096
    v_cvt_pk_bf16_f32 v52, v104, v105
    v_mfma_f32_16x16x32_bf16 v[200:203], a[168:171], v[56:59], v[200:203]
    v_exp_f32 v106, v106
    v_mfma_f32_16x16x32_bf16 v[232:235], a[168:171], v[60:63], v[232:235]
    buffer_load_dwordx4 v1, s[8:11], s19 offen offset:3072  lds
    v_mfma_f32_16x16x32_bf16 v[204:207], a[172:175], v[56:59], v[204:207]
    s_add_u32 m0, s16, 4096
    v_exp_f32 v107, v107
    v_mfma_f32_16x16x32_bf16 v[236:239], a[172:175], v[60:63], v[236:239]
    ds_read_b128 a[148:151], v18 offset:5120
    v_cvt_pk_bf16_f32 v53, v106, v107
    v_mfma_f32_16x16x32_bf16 v[208:211], a[176:179], v[56:59], v[208:211]
    v_exp_f32 v108, v108
    v_mfma_f32_16x16x32_bf16 v[240:243], a[176:179], v[60:63], v[240:243]
    buffer_load_dwordx4 v15, s[8:11], s19 offen offset:0  lds
    v_mfma_f32_16x16x32_bf16 v[212:215], a[180:183], v[56:59], v[212:215]
    v_exp_f32 v109, v109
    v_mfma_f32_16x16x32_bf16 v[244:247], a[180:183], v[60:63], v[244:247]
    ds_read_b128 a[152:155], v18 offset:6144
    v_cvt_pk_bf16_f32 v54, v108, v109
    v_mfma_f32_16x16x32_bf16 v[216:219], a[184:187], v[56:59], v[216:219]
    v_exp_f32 v110, v110
    v_mfma_f32_16x16x32_bf16 v[248:251], a[184:187], v[60:63], v[248:251]
    buffer_load_dwordx4 v15, s[8:11], s19 offen offset:1024  lds
    v_mfma_f32_16x16x32_bf16 v[220:223], a[188:191], v[56:59], v[220:223]
    v_exp_f32 v111, v111
    v_mfma_f32_16x16x32_bf16 v[252:255], a[188:191], v[60:63], v[252:255]
    ds_read_b128 a[156:159], v18 offset:7168
    v_cvt_pk_bf16_f32 v55, v110, v111
    s_waitcnt lgkmcnt(7)
    v_mfma_f32_16x16x32_bf16 v[96:99], a[128:131], a[192:195], v[64:67]
    s_waitcnt lgkmcnt(6)
    ds_read_b128 a[160:163], v19 offset:16384
    v_mfma_f32_16x16x32_bf16 v[96:99], a[132:135], a[196:199], v[96:99]
    s_waitcnt lgkmcnt(6)
    ds_read_b128 a[164:167], v19 offset:17408
    v_mfma_f32_16x16x32_bf16 v[96:99], a[136:139], a[200:203], v[96:99]
    s_waitcnt lgkmcnt(6)
    v_exp_f32 v112, v112
    v_mfma_f32_16x16x32_bf16 v[96:99], a[140:143], a[204:207], v[96:99]
    buffer_load_dwordx4 v15, s[8:11], s19 offen offset:2048  lds
    v_mfma_f32_16x16x32_bf16 v[104:107], a[128:131], a[208:211], v[68:71]
    v_exp_f32 v113, v113
    v_mfma_f32_16x16x32_bf16 v[104:107], a[132:135], a[212:215], v[104:107]
    ds_read_b128 a[168:171], v19 offset:18432
    v_cvt_pk_bf16_f32 v56, v112, v113
    v_mfma_f32_16x16x32_bf16 v[104:107], a[136:139], a[216:219], v[104:107]
    s_waitcnt lgkmcnt(6)
    v_exp_f32 v114, v114
    v_mfma_f32_16x16x32_bf16 v[104:107], a[140:143], a[220:223], v[104:107]
    buffer_load_dwordx4 v15, s[8:11], s19 offen offset:3072  lds
    v_mfma_f32_16x16x32_bf16 v[100:103], a[144:147], a[192:195], v[64:67]
    s_waitcnt lgkmcnt(5)
    s_xor_b32 s16, s16, 98304
    v_exp_f32 v115, v115
    v_mfma_f32_16x16x32_bf16 v[100:103], a[148:151], a[196:199], v[100:103]
    s_waitcnt lgkmcnt(4)
    s_lshl_b32 s64, s2, 6
    ds_read_b128 a[172:175], v19 offset:19456
    v_cvt_pk_bf16_f32 v57, v114, v115
    v_mfma_f32_16x16x32_bf16 v[100:103], a[152:155], a[200:203], v[100:103]
    s_waitcnt lgkmcnt(4)
    s_add_u32 s64, s64, 1327104
    v_exp_f32 v116, v116
    v_mfma_f32_16x16x32_bf16 v[100:103], a[156:159], a[204:207], v[100:103]
    buffer_store_dword v6, v7, s[8:11], s64 offen sc0 sc1
    v_mfma_f32_16x16x32_bf16 v[108:111], a[144:147], a[208:211], v[68:71]
    s_xor_b32 s74, s24, 8192
    v_exp_f32 v117, v117
    v_mfma_f32_16x16x32_bf16 v[108:111], a[148:151], a[212:215], v[108:111]
    ds_read_b128 a[176:179], v20 offset:20480
    v_cvt_pk_bf16_f32 v58, v116, v117
    v_mfma_f32_16x16x32_bf16 v[108:111], a[152:155], a[216:219], v[108:111]
    v_exp_f32 v118, v118
    v_mfma_f32_16x16x32_bf16 v[108:111], a[156:159], a[220:223], v[108:111]
    buffer_load_dwordx4 a[96:99], v1, s[8:11], s74 offen offset:0
    v_mfma_f32_16x16x32_bf16 v[32:35], v[28:31], v[48:51], v[32:35]
    s_xor_b32 s74, s24, 8192
    v_exp_f32 v119, v119
    v_mfma_f32_16x16x32_bf16 v[36:39], v[28:31], v[52:55], v[36:39]
    s_waitcnt lgkmcnt(4)
    ds_read_b128 a[180:183], v20 offset:21504
    v_cvt_pk_bf16_f32 v59, v118, v119
    v_mfma_f32_16x16x32_bf16 v[128:131], a[160:163], v[48:51], v[128:131]
    s_waitcnt lgkmcnt(4)
    v_exp_f32 v120, v120
    v_mfma_f32_16x16x32_bf16 v[160:163], a[160:163], v[52:55], v[160:163]
    buffer_load_dwordx4 a[100:103], v1, s[8:11], s74 offen offset:1024
    v_mfma_f32_16x16x32_bf16 v[132:135], a[164:167], v[48:51], v[132:135]
    s_xor_b32 s74, s24, 8192
    v_exp_f32 v121, v121
    v_mfma_f32_16x16x32_bf16 v[164:167], a[164:167], v[52:55], v[164:167]
    s_waitcnt lgkmcnt(3)
    ds_read_b128 a[184:187], v20 offset:22528
    v_cvt_pk_bf16_f32 v60, v120, v121
    v_mfma_f32_16x16x32_bf16 v[136:139], a[168:171], v[48:51], v[136:139]
    s_waitcnt lgkmcnt(3)
    v_exp_f32 v122, v122
    v_mfma_f32_16x16x32_bf16 v[168:171], a[168:171], v[52:55], v[168:171]
    buffer_load_dwordx4 a[104:107], v1, s[8:11], s74 offen offset:2048
    v_mfma_f32_16x16x32_bf16 v[140:143], a[172:175], v[48:51], v[140:143]
    s_xor_b32 s74, s24, 8192
    v_exp_f32 v123, v123
    v_mfma_f32_16x16x32_bf16 v[172:175], a[172:175], v[52:55], v[172:175]
    s_waitcnt lgkmcnt(2)
    ds_read_b128 a[188:191], v20 offset:23552
    v_cvt_pk_bf16_f32 v61, v122, v123
    v_mfma_f32_16x16x32_bf16 v[144:147], a[176:179], v[48:51], v[144:147]
    s_waitcnt lgkmcnt(2)
    v_exp_f32 v124, v124
    v_mfma_f32_16x16x32_bf16 v[176:179], a[176:179], v[52:55], v[176:179]
    buffer_load_dwordx4 a[108:111], v1, s[8:11], s74 offen offset:3072
    v_mfma_f32_16x16x32_bf16 v[148:151], a[180:183], v[48:51], v[148:151]
    s_xor_b32 s74, s24, 12288
    v_exp_f32 v125, v125
    v_mfma_f32_16x16x32_bf16 v[180:183], a[180:183], v[52:55], v[180:183]
    s_waitcnt lgkmcnt(1)
    v_cvt_pk_bf16_f32 v62, v124, v125
    v_xor_b32 v19, 98304, v19
    v_mfma_f32_16x16x32_bf16 v[152:155], a[184:187], v[48:51], v[152:155]
    buffer_load_dwordx4 a[112:115], v1, s[8:11], s74 offen offset:0
    v_exp_f32 v126, v126
    v_mfma_f32_16x16x32_bf16 v[184:187], a[184:187], v[52:55], v[184:187]
    s_waitcnt lgkmcnt(0)
    v_xor_b32 v20, 98304, v20
    v_mfma_f32_16x16x32_bf16 v[156:159], a[188:191], v[48:51], v[156:159]
    v_exp_f32 v127, v127
    v_mfma_f32_16x16x32_bf16 v[188:191], a[188:191], v[52:55], v[188:191]
    v_cvt_pk_bf16_f32 v63, v126, v127
    v_mfma_f32_16x16x32_bf16 v[112:115], a[128:131], a[224:227], v[72:75]
    s_add_u32 m0, s62, 36864
    v_exp_f32 v96, v96
    v_mfma_f32_16x16x32_bf16 v[112:115], a[132:135], a[228:231], v[112:115]
    v_add_f32 v86, 0xf3900000, v21
    v_min_f32 v86, v86, v66
    v_mfma_f32_16x16x32_bf16 v[112:115], a[136:139], a[232:235], v[112:115]
    s_xor_b32 s98, s65, 32768
    v_exp_f32 v97, v97
    v_mfma_f32_16x16x32_bf16 v[112:115], a[140:143], a[236:239], v[112:115]
    v_cvt_pk_bf16_f32 v48, v96, v97
    v_add_f32 v87, 0xf3980000, v21
    v_mfma_f32_16x16x32_bf16 v[120:123], a[128:131], a[240:243], v[76:79]
    v_exp_f32 v98, v98
    v_mfma_f32_16x16x32_bf16 v[120:123], a[132:135], a[244:247], v[120:123]
    buffer_load_dwordx4 v8, s[28:31], s98 offen offset:0   lds
    v_mfma_f32_16x16x32_bf16 v[120:123], a[136:139], a[248:251], v[120:123]
    v_exp_f32 v99, v99
    v_mfma_f32_16x16x32_bf16 v[120:123], a[140:143], a[252:255], v[120:123]
    buffer_load_dwordx4 v9, s[28:31], s98 offen offset:1024   lds
    v_mfma_f32_16x16x32_bf16 v[116:119], a[144:147], a[224:227], v[72:75]
    v_exp_f32 v100, v100
    v_mfma_f32_16x16x32_bf16 v[116:119], a[148:151], a[228:231], v[116:119]
    ds_read_b128 a[128:131], v18 offset:16384
    v_cvt_pk_bf16_f32 v49, v98, v99
    v_mfma_f32_16x16x32_bf16 v[116:119], a[152:155], a[232:235], v[116:119]
    s_add_u32 s19, s82, 32768
    v_exp_f32 v101, v101
    v_mfma_f32_16x16x32_bf16 v[116:119], a[156:159], a[236:239], v[116:119]
    s_sub_u32 s82, s12, s13
    ds_read_b128 a[132:135], v18 offset:17408
    v_cvt_pk_bf16_f32 v50, v100, v101
    v_mfma_f32_16x16x32_bf16 v[124:127], a[144:147], a[240:243], v[76:79]
    s_sub_u32 s82, s82, 1
    v_exp_f32 v102, v102
    v_mfma_f32_16x16x32_bf16 v[124:127], a[148:151], a[244:247], v[124:127]
    s_cmp_gt_u32 s12, s13
    s_cselect_b32 s82, s82, s12
    s_lshl_b32 s82, s82, 16
    ds_read_b128 a[136:139], v18 offset:18432
    v_mfma_f32_16x16x32_bf16 v[124:127], a[152:155], a[248:251], v[124:127]
    s_add_u32 s82, s82, s81
    v_exp_f32 v103, v103
    v_mfma_f32_16x16x32_bf16 v[124:127], a[156:159], a[252:255], v[124:127]
    s_cmp_ge_u32 s12, 17
    s_cselect_b32 s82, 2147471360, s82
    ds_read_b128 a[140:143], v18 offset:19456
    v_cvt_pk_bf16_f32 v51, v102, v103
    v_mfma_f32_16x16x32_bf16 v[40:43], v[28:31], v[56:59], v[40:43]
    s_add_u32 s12, s12, 1
    v_exp_f32 v104, v104
    v_mfma_f32_16x16x32_bf16 v[44:47], v[28:31], v[60:63], v[44:47]
    ds_read_b128 a[144:147], v18 offset:20480
    v_min_f32 v87, v87, v67
    v_mfma_f32_16x16x32_bf16 v[192:195], a[160:163], v[56:59], v[192:195]
    v_exp_f32 v105, v105
    v_mfma_f32_16x16x32_bf16 v[224:227], a[160:163], v[60:63], v[224:227]
    ds_read_b128 a[148:151], v18 offset:21504
    v_cvt_pk_bf16_f32 v52, v104, v105
    v_mfma_f32_16x16x32_bf16 v[196:199], a[164:167], v[56:59], v[196:199]
    v_exp_f32 v106, v106
    v_mfma_f32_16x16x32_bf16 v[228:231], a[164:167], v[60:63], v[228:231]
    ds_read_b128 a[152:155], v18 offset:22528
    v_add_f32 v88, 0x73800000, v21
    v_mfma_f32_16x16x32_bf16 v[200:203], a[168:171], v[56:59], v[200:203]
    v_exp_f32 v107, v107
    v_mfma_f32_16x16x32_bf16 v[232:235], a[168:171], v[60:63], v[232:235]
    ds_read_b128 a[156:159], v18 offset:23552
    v_cvt_pk_bf16_f32 v53, v106, v107
    v_mfma_f32_16x16x32_bf16 v[204:207], a[172:175], v[56:59], v[204:207]
    v_exp_f32 v108, v108
    v_mfma_f32_16x16x32_bf16 v[236:239], a[172:175], v[60:63], v[236:239]
    buffer_load_dwordx4 v10, s[28:31], s98 offen offset:2048   lds
    v_mfma_f32_16x16x32_bf16 v[208:211], a[176:179], v[56:59], v[208:211]
    v_exp_f32 v109, v109
    v_mfma_f32_16x16x32_bf16 v[240:243], a[176:179], v[60:63], v[240:243]
    v_cvt_pk_bf16_f32 v54, v108, v109
    v_xor_b32 v18, 196608, v18
    v_mfma_f32_16x16x32_bf16 v[212:215], a[180:183], v[56:59], v[212:215]
    v_exp_f32 v110, v110
    v_mfma_f32_16x16x32_bf16 v[244:247], a[180:183], v[60:63], v[244:247]
    buffer_load_dwordx4 v11, s[28:31], s98 offen offset:3072   lds
    v_mfma_f32_16x16x32_bf16 v[216:219], a[184:187], v[56:59], v[216:219]
    s_xor_b32 s74, s24, 12288
    v_exp_f32 v111, v111
    v_mfma_f32_16x16x32_bf16 v[248:251], a[184:187], v[60:63], v[248:251]
    v_cvt_pk_bf16_f32 v55, v110, v111
    v_min_f32 v88, v88, v68
    v_mfma_f32_16x16x32_bf16 v[220:223], a[188:191], v[56:59], v[220:223]
    buffer_load_dwordx4 a[116:119], v1, s[8:11], s74 offen offset:1024
    v_mfma_f32_16x16x32_bf16 v[252:255], a[188:191], v[60:63], v[252:255]
    s_xor_b32 s74, s24, 12288
    buffer_load_dwordx4 a[120:123], v1, s[8:11], s74 offen offset:2048
    s_xor_b32 s74, s24, 12288
    buffer_load_dwordx4 a[124:127], v1, s[8:11], s74 offen offset:3072
    s_waitcnt vmcnt(13) lgkmcnt(0)
    s_barrier
    v_mfma_f32_16x16x32_bf16 v[96:99], a[128:131], a[192:195], v[64:67]
    s_add_u32 m0, s15, 0
    ds_read_b128 a[160:163], v19 offset:0
    v_mfma_f32_16x16x32_bf16 v[96:99], a[132:135], a[196:199], v[96:99]
    ds_read_b128 a[164:167], v19 offset:1024
    v_mfma_f32_16x16x32_bf16 v[96:99], a[136:139], a[200:203], v[96:99]
    v_exp_f32 v112, v112
    v_mfma_f32_16x16x32_bf16 v[96:99], a[140:143], a[204:207], v[96:99]
    buffer_load_dwordx4 v1, s[8:11], s82 offen offset:0  lds
    v_mfma_f32_16x16x32_bf16 v[104:107], a[128:131], a[208:211], v[68:71]
    v_exp_f32 v113, v113
    v_mfma_f32_16x16x32_bf16 v[104:107], a[132:135], a[212:215], v[104:107]
    ds_read_b128 a[168:171], v19 offset:2048
    v_cvt_pk_bf16_f32 v56, v112, v113
    v_mfma_f32_16x16x32_bf16 v[104:107], a[136:139], a[216:219], v[104:107]
    v_exp_f32 v114, v114
    v_mfma_f32_16x16x32_bf16 v[104:107], a[140:143], a[220:223], v[104:107]
    buffer_load_dwordx4 v1, s[8:11], s82 offen offset:1024  lds
    v_mfma_f32_16x16x32_bf16 v[100:103], a[144:147], a[192:195], v[64:67]
    v_exp_f32 v115, v115
    v_mfma_f32_16x16x32_bf16 v[100:103], a[148:151], a[196:199], v[100:103]
    ds_read_b128 a[172:175], v19 offset:3072
    v_cvt_pk_bf16_f32 v57, v114, v115
    v_mfma_f32_16x16x32_bf16 v[100:103], a[152:155], a[200:203], v[100:103]
    v_exp_f32 v116, v116
    v_mfma_f32_16x16x32_bf16 v[100:103], a[156:159], a[204:207], v[100:103]
    buffer_load_dwordx4 v1, s[8:11], s82 offen offset:2048  lds
    v_mfma_f32_16x16x32_bf16 v[108:111], a[144:147], a[208:211], v[68:71]
    v_exp_f32 v117, v117
    v_mfma_f32_16x16x32_bf16 v[108:111], a[148:151], a[212:215], v[108:111]
    ds_read_b128 a[176:179], v20 offset:4096
    v_cvt_pk_bf16_f32 v58, v116, v117
    v_mfma_f32_16x16x32_bf16 v[108:111], a[152:155], a[216:219], v[108:111]
    v_exp_f32 v118, v118
    v_mfma_f32_16x16x32_bf16 v[108:111], a[156:159], a[220:223], v[108:111]
    buffer_load_dwordx4 v1, s[8:11], s82 offen offset:3072  lds
    v_mfma_f32_16x16x32_bf16 v[32:35], v[28:31], v[48:51], v[32:35]
    s_add_u32 m0, s15, 4096
    v_exp_f32 v119, v119
    v_mfma_f32_16x16x32_bf16 v[36:39], v[28:31], v[52:55], v[36:39]
    s_waitcnt lgkmcnt(4)
    ds_read_b128 a[180:183], v20 offset:5120
    v_cvt_pk_bf16_f32 v59, v118, v119
    v_mfma_f32_16x16x32_bf16 v[128:131], a[160:163], v[48:51], v[128:131]
    v_exp_f32 v120, v120
    v_mfma_f32_16x16x32_bf16 v[160:163], a[160:163], v[52:55], v[160:163]
    s_waitcnt lgkmcnt(4)
    v_mfma_f32_16x16x32_bf16 v[132:135], a[164:167], v[48:51], v[132:135]
    v_exp_f32 v121, v121
    v_mfma_f32_16x16x32_bf16 v[164:167], a[164:167], v[52:55], v[164:167]
    s_waitcnt lgkmcnt(3)
    ds_read_b128 a[184:187], v20 offset:6144
    v_cvt_pk_bf16_f32 v60, v120, v121
    v_mfma_f32_16x16x32_bf16 v[136:139], a[168:171], v[48:51], v[136:139]
    s_waitcnt lgkmcnt(3)
    v_exp_f32 v122, v122
    v_mfma_f32_16x16x32_bf16 v[168:171], a[168:171], v[52:55], v[168:171]
    buffer_load_dwordx4 v15, s[8:11], s82 offen offset:0  lds
    v_mfma_f32_16x16x32_bf16 v[140:143], a[172:175], v[48:51], v[140:143]
    v_exp_f32 v123, v123
    v_mfma_f32_16x16x32_bf16 v[172:175], a[172:175], v[52:55], v[172:175]
    s_waitcnt lgkmcnt(2)
    ds_read_b128 a[188:191], v20 offset:7168
    v_cvt_pk_bf16_f32 v61, v122, v123
    v_mfma_f32_16x16x32_bf16 v[144:147], a[176:179], v[48:51], v[144:147]
    s_waitcnt lgkmcnt(2)
    v_exp_f32 v124, v124
    v_mfma_f32_16x16x32_bf16 v[176:179], a[176:179], v[52:55], v[176:179]
    buffer_load_dwordx4 v15, s[8:11], s82 offen offset:1024  lds
    v_mfma_f32_16x16x32_bf16 v[148:151], a[180:183], v[48:51], v[148:151]
    v_exp_f32 v125, v125
    v_mfma_f32_16x16x32_bf16 v[180:183], a[180:183], v[52:55], v[180:183]
    s_waitcnt lgkmcnt(1)
    v_cvt_pk_bf16_f32 v62, v124, v125
    v_mfma_f32_16x16x32_bf16 v[152:155], a[184:187], v[48:51], v[152:155]
    s_waitcnt lgkmcnt(0)
    v_exp_f32 v126, v126
    v_mfma_f32_16x16x32_bf16 v[184:187], a[184:187], v[52:55], v[184:187]
    buffer_load_dwordx4 v15, s[8:11], s82 offen offset:2048  lds
    v_mfma_f32_16x16x32_bf16 v[156:159], a[188:191], v[48:51], v[156:159]
    v_exp_f32 v127, v127
    v_mfma_f32_16x16x32_bf16 v[188:191], a[188:191], v[52:55], v[188:191]
    v_cvt_pk_bf16_f32 v63, v126, v127
    v_mfma_f32_16x16x32_bf16 v[112:115], a[128:131], a[224:227], v[72:75]
    v_mfma_f32_16x16x32_bf16 v[112:115], a[132:135], a[228:231], v[112:115]
    v_mfma_f32_16x16x32_bf16 v[112:115], a[136:139], a[232:235], v[112:115]
    v_exp_f32 v96, v96
    v_mfma_f32_16x16x32_bf16 v[112:115], a[140:143], a[236:239], v[112:115]
    buffer_load_dwordx4 v15, s[8:11], s82 offen offset:3072  lds
    v_mfma_f32_16x16x32_bf16 v[120:123], a[128:131], a[240:243], v[76:79]
    s_xor_b32 s15, s15, 196608
    v_exp_f32 v97, v97
    v_mfma_f32_16x16x32_bf16 v[120:123], a[132:135], a[244:247], v[120:123]
    s_add_u32 m0, s16, 0
    ds_read_b128 a[128:131], v18 offset:0
    v_cvt_pk_bf16_f32 v48, v96, v97
    v_mfma_f32_16x16x32_bf16 v[120:123], a[136:139], a[248:251], v[120:123]
    v_exp_f32 v98, v98
    v_mfma_f32_16x16x32_bf16 v[120:123], a[140:143], a[252:255], v[120:123]
    buffer_load_dwordx4 v1, s[8:11], s19 offen offset:0  lds
    v_mfma_f32_16x16x32_bf16 v[116:119], a[144:147], a[224:227], v[72:75]
    v_exp_f32 v99, v99
    v_mfma_f32_16x16x32_bf16 v[116:119], a[148:151], a[228:231], v[116:119]
    ds_read_b128 a[132:135], v18 offset:1024
    v_cvt_pk_bf16_f32 v49, v98, v99
    v_mfma_f32_16x16x32_bf16 v[116:119], a[152:155], a[232:235], v[116:119]
    v_exp_f32 v100, v100
    v_mfma_f32_16x16x32_bf16 v[116:119], a[156:159], a[236:239], v[116:119]
    buffer_load_dwordx4 v1, s[8:11], s19 offen offset:1024  lds
    v_mfma_f32_16x16x32_bf16 v[124:127], a[144:147], a[240:243], v[76:79]
    v_exp_f32 v101, v101
    v_mfma_f32_16x16x32_bf16 v[124:127], a[148:151], a[244:247], v[124:127]
    ds_read_b128 a[136:139], v18 offset:2048
    v_cvt_pk_bf16_f32 v50, v100, v101
    v_mfma_f32_16x16x32_bf16 v[124:127], a[152:155], a[248:251], v[124:127]
    v_exp_f32 v102, v102
    v_mfma_f32_16x16x32_bf16 v[124:127], a[156:159], a[252:255], v[124:127]
    buffer_load_dwordx4 v1, s[8:11], s19 offen offset:2048  lds
    v_mfma_f32_16x16x32_bf16 v[40:43], v[28:31], v[56:59], v[40:43]
    v_exp_f32 v103, v103
    v_mfma_f32_16x16x32_bf16 v[44:47], v[28:31], v[60:63], v[44:47]
    ds_read_b128 a[140:143], v18 offset:3072
    v_cvt_pk_bf16_f32 v51, v102, v103
    v_mfma_f32_16x16x32_bf16 v[192:195], a[160:163], v[56:59], v[192:195]
    v_exp_f32 v104, v104
    v_mfma_f32_16x16x32_bf16 v[224:227], a[160:163], v[60:63], v[224:227]
    v_mfma_f32_16x16x32_bf16 v[196:199], a[164:167], v[56:59], v[196:199]
    v_exp_f32 v105, v105
    v_mfma_f32_16x16x32_bf16 v[228:231], a[164:167], v[60:63], v[228:231]
    ds_read_b128 a[144:147], v18 offset:4096
    v_cvt_pk_bf16_f32 v52, v104, v105
    v_mfma_f32_16x16x32_bf16 v[200:203], a[168:171], v[56:59], v[200:203]
    v_exp_f32 v106, v106
    v_mfma_f32_16x16x32_bf16 v[232:235], a[168:171], v[60:63], v[232:235]
    buffer_load_dwordx4 v1, s[8:11], s19 offen offset:3072  lds
    v_mfma_f32_16x16x32_bf16 v[204:207], a[172:175], v[56:59], v[204:207]
    s_add_u32 m0, s16, 4096
    v_exp_f32 v107, v107
    v_mfma_f32_16x16x32_bf16 v[236:239], a[172:175], v[60:63], v[236:239]
    ds_read_b128 a[148:151], v18 offset:5120
    v_cvt_pk_bf16_f32 v53, v106, v107
    v_mfma_f32_16x16x32_bf16 v[208:211], a[176:179], v[56:59], v[208:211]
    v_exp_f32 v108, v108
    v_mfma_f32_16x16x32_bf16 v[240:243], a[176:179], v[60:63], v[240:243]
    buffer_load_dwordx4 v15, s[8:11], s19 offen offset:0  lds
    v_mfma_f32_16x16x32_bf16 v[212:215], a[180:183], v[56:59], v[212:215]
    v_exp_f32 v109, v109
    v_mfma_f32_16x16x32_bf16 v[244:247], a[180:183], v[60:63], v[244:247]
    ds_read_b128 a[152:155], v18 offset:6144
    v_cvt_pk_bf16_f32 v54, v108, v109
    v_mfma_f32_16x16x32_bf16 v[216:219], a[184:187], v[56:59], v[216:219]
    v_exp_f32 v110, v110
    v_mfma_f32_16x16x32_bf16 v[248:251], a[184:187], v[60:63], v[248:251]
    buffer_load_dwordx4 v15, s[8:11], s19 offen offset:1024  lds
    v_mfma_f32_16x16x32_bf16 v[220:223], a[188:191], v[56:59], v[220:223]
    v_exp_f32 v111, v111
    v_mfma_f32_16x16x32_bf16 v[252:255], a[188:191], v[60:63], v[252:255]
    ds_read_b128 a[156:159], v18 offset:7168
    v_cvt_pk_bf16_f32 v55, v110, v111
    s_waitcnt lgkmcnt(7)
    v_mfma_f32_16x16x32_bf16 v[96:99], a[128:131], a[192:195], v[64:67]
    s_waitcnt lgkmcnt(6)
    ds_read_b128 a[160:163], v19 offset:16384
    v_mfma_f32_16x16x32_bf16 v[96:99], a[132:135], a[196:199], v[96:99]
    s_waitcnt lgkmcnt(6)
    ds_read_b128 a[164:167], v19 offset:17408
    v_mfma_f32_16x16x32_bf16 v[96:99], a[136:139], a[200:203], v[96:99]
    s_waitcnt lgkmcnt(6)
    v_exp_f32 v112, v112
    v_mfma_f32_16x16x32_bf16 v[96:99], a[140:143], a[204:207], v[96:99]
    buffer_load_dwordx4 v15, s[8:11], s19 offen offset:2048  lds
    v_mfma_f32_16x16x32_bf16 v[104:107], a[128:131], a[208:211], v[68:71]
    v_exp_f32 v113, v113
    v_mfma_f32_16x16x32_bf16 v[104:107], a[132:135], a[212:215], v[104:107]
    ds_read_b128 a[168:171], v19 offset:18432
    v_cvt_pk_bf16_f32 v56, v112, v113
    v_mfma_f32_16x16x32_bf16 v[104:107], a[136:139], a[216:219], v[104:107]
    s_waitcnt lgkmcnt(6)
    v_exp_f32 v114, v114
    v_mfma_f32_16x16x32_bf16 v[104:107], a[140:143], a[220:223], v[104:107]
    buffer_load_dwordx4 v15, s[8:11], s19 offen offset:3072  lds
    v_mfma_f32_16x16x32_bf16 v[100:103], a[144:147], a[192:195], v[64:67]
    s_waitcnt lgkmcnt(5)
    s_xor_b32 s16, s16, 98304
    v_exp_f32 v115, v115
    v_mfma_f32_16x16x32_bf16 v[100:103], a[148:151], a[196:199], v[100:103]
    s_waitcnt lgkmcnt(4)
    s_xor_b32 s74, s24, 16384
    ds_read_b128 a[172:175], v19 offset:19456
    v_cvt_pk_bf16_f32 v57, v114, v115
    v_mfma_f32_16x16x32_bf16 v[100:103], a[152:155], a[200:203], v[100:103]
    s_waitcnt lgkmcnt(4)
    v_exp_f32 v116, v116
    v_mfma_f32_16x16x32_bf16 v[100:103], a[156:159], a[204:207], v[100:103]
    buffer_load_dwordx4 a[0:3], v1, s[8:11], s74 offen offset:0
    v_mfma_f32_16x16x32_bf16 v[108:111], a[144:147], a[208:211], v[68:71]
    s_xor_b32 s74, s24, 16384
    v_exp_f32 v117, v117
    v_mfma_f32_16x16x32_bf16 v[108:111], a[148:151], a[212:215], v[108:111]
    ds_read_b128 a[176:179], v20 offset:20480
    v_cvt_pk_bf16_f32 v58, v116, v117
    v_mfma_f32_16x16x32_bf16 v[108:111], a[152:155], a[216:219], v[108:111]
    v_exp_f32 v118, v118
    v_mfma_f32_16x16x32_bf16 v[108:111], a[156:159], a[220:223], v[108:111]
    buffer_load_dwordx4 a[4:7], v1, s[8:11], s74 offen offset:1024
    v_mfma_f32_16x16x32_bf16 v[32:35], v[28:31], v[48:51], v[32:35]
    s_xor_b32 s74, s24, 16384
    v_exp_f32 v119, v119
    v_mfma_f32_16x16x32_bf16 v[36:39], v[28:31], v[52:55], v[36:39]
    s_waitcnt lgkmcnt(4)
    ds_read_b128 a[180:183], v20 offset:21504
    v_cvt_pk_bf16_f32 v59, v118, v119
    v_mfma_f32_16x16x32_bf16 v[128:131], a[160:163], v[48:51], v[128:131]
    s_waitcnt lgkmcnt(4)
    v_exp_f32 v120, v120
    v_mfma_f32_16x16x32_bf16 v[160:163], a[160:163], v[52:55], v[160:163]
    buffer_load_dwordx4 a[8:11], v1, s[8:11], s74 offen offset:2048
    v_mfma_f32_16x16x32_bf16 v[132:135], a[164:167], v[48:51], v[132:135]
    s_xor_b32 s74, s24, 16384
    v_exp_f32 v121, v121
    v_mfma_f32_16x16x32_bf16 v[164:167], a[164:167], v[52:55], v[164:167]
    s_waitcnt lgkmcnt(3)
    ds_read_b128 a[184:187], v20 offset:22528
    v_cvt_pk_bf16_f32 v60, v120, v121
    v_mfma_f32_16x16x32_bf16 v[136:139], a[168:171], v[48:51], v[136:139]
    s_waitcnt lgkmcnt(3)
    v_exp_f32 v122, v122
    v_mfma_f32_16x16x32_bf16 v[168:171], a[168:171], v[52:55], v[168:171]
    buffer_load_dwordx4 a[12:15], v1, s[8:11], s74 offen offset:3072
    v_mfma_f32_16x16x32_bf16 v[140:143], a[172:175], v[48:51], v[140:143]
    s_xor_b32 s74, s24, 20480
    v_exp_f32 v123, v123
    v_mfma_f32_16x16x32_bf16 v[172:175], a[172:175], v[52:55], v[172:175]
    s_waitcnt lgkmcnt(2)
    ds_read_b128 a[188:191], v20 offset:23552
    v_cvt_pk_bf16_f32 v61, v122, v123
    v_mfma_f32_16x16x32_bf16 v[144:147], a[176:179], v[48:51], v[144:147]
    s_waitcnt lgkmcnt(2)
    v_exp_f32 v124, v124
    v_mfma_f32_16x16x32_bf16 v[176:179], a[176:179], v[52:55], v[176:179]
    buffer_load_dwordx4 a[16:19], v1, s[8:11], s74 offen offset:0
    v_mfma_f32_16x16x32_bf16 v[148:151], a[180:183], v[48:51], v[148:151]
    s_xor_b32 s74, s24, 20480
    v_exp_f32 v125, v125
    v_mfma_f32_16x16x32_bf16 v[180:183], a[180:183], v[52:55], v[180:183]
    s_waitcnt lgkmcnt(1)
    v_cvt_pk_bf16_f32 v62, v124, v125
    v_xor_b32 v19, 98304, v19
    v_mfma_f32_16x16x32_bf16 v[152:155], a[184:187], v[48:51], v[152:155]
    buffer_load_dwordx4 a[20:23], v1, s[8:11], s74 offen offset:1024
    v_exp_f32 v126, v126
    v_mfma_f32_16x16x32_bf16 v[184:187], a[184:187], v[52:55], v[184:187]
    s_waitcnt lgkmcnt(0)
    v_xor_b32 v20, 98304, v20
    v_mfma_f32_16x16x32_bf16 v[156:159], a[188:191], v[48:51], v[156:159]
    v_exp_f32 v127, v127
    v_mfma_f32_16x16x32_bf16 v[188:191], a[188:191], v[52:55], v[188:191]
    v_cvt_pk_bf16_f32 v63, v126, v127
    v_mfma_f32_16x16x32_bf16 v[112:115], a[128:131], a[224:227], v[72:75]
    s_xor_b32 s74, s24, 20480
    v_exp_f32 v96, v96
    v_mfma_f32_16x16x32_bf16 v[112:115], a[132:135], a[228:231], v[112:115]
    buffer_load_dwordx4 a[24:27], v1, s[8:11], s74 offen offset:2048
    v_mfma_f32_16x16x32_bf16 v[112:115], a[136:139], a[232:235], v[112:115]
    s_xor_b32 s74, s24, 20480
    v_exp_f32 v97, v97
    v_mfma_f32_16x16x32_bf16 v[112:115], a[140:143], a[236:239], v[112:115]
    v_cvt_pk_bf16_f32 v48, v96, v97
    v_add_f32 v89, 0x73700000, v21
    v_mfma_f32_16x16x32_bf16 v[120:123], a[128:131], a[240:243], v[76:79]
    v_exp_f32 v98, v98
    v_mfma_f32_16x16x32_bf16 v[120:123], a[132:135], a[244:247], v[120:123]
    buffer_load_dwordx4 a[28:31], v1, s[8:11], s74 offen offset:3072
    v_mfma_f32_16x16x32_bf16 v[120:123], a[136:139], a[248:251], v[120:123]
    s_xor_b32 s74, s24, 24576
    v_exp_f32 v99, v99
    v_mfma_f32_16x16x32_bf16 v[120:123], a[140:143], a[252:255], v[120:123]
    buffer_load_dwordx4 a[32:35], v1, s[8:11], s74 offen offset:0
    v_mfma_f32_16x16x32_bf16 v[116:119], a[144:147], a[224:227], v[72:75]
    s_xor_b32 s74, s24, 24576
    v_exp_f32 v100, v100
    v_mfma_f32_16x16x32_bf16 v[116:119], a[148:151], a[228:231], v[116:119]
    ds_read_b128 a[128:131], v18 offset:16384
    v_cvt_pk_bf16_f32 v49, v98, v99
    v_mfma_f32_16x16x32_bf16 v[116:119], a[152:155], a[232:235], v[116:119]
    s_add_u32 s19, s82, 32768
    v_exp_f32 v101, v101
    v_mfma_f32_16x16x32_bf16 v[116:119], a[156:159], a[236:239], v[116:119]
    s_sub_u32 s82, s12, s13
    ds_read_b128 a[132:135], v18 offset:17408
    v_cvt_pk_bf16_f32 v50, v100, v101
    v_mfma_f32_16x16x32_bf16 v[124:127], a[144:147], a[240:243], v[76:79]
    s_sub_u32 s82, s82, 1
    v_exp_f32 v102, v102
    v_mfma_f32_16x16x32_bf16 v[124:127], a[148:151], a[244:247], v[124:127]
    s_cmp_gt_u32 s12, s13
    s_cselect_b32 s82, s82, s12
    s_lshl_b32 s82, s82, 16
    ds_read_b128 a[136:139], v18 offset:18432
    v_mfma_f32_16x16x32_bf16 v[124:127], a[152:155], a[248:251], v[124:127]
    s_add_u32 s82, s82, s81
    v_exp_f32 v103, v103
    v_mfma_f32_16x16x32_bf16 v[124:127], a[156:159], a[252:255], v[124:127]
    s_cmp_ge_u32 s12, 17
    s_cselect_b32 s82, 2147471360, s82
    ds_read_b128 a[140:143], v18 offset:19456
    v_cvt_pk_bf16_f32 v51, v102, v103
    v_mfma_f32_16x16x32_bf16 v[40:43], v[28:31], v[56:59], v[40:43]
    s_add_u32 s12, s12, 1
    v_exp_f32 v104, v104
    v_mfma_f32_16x16x32_bf16 v[44:47], v[28:31], v[60:63], v[44:47]
    ds_read_b128 a[144:147], v18 offset:20480
    v_min_f32 v89, v89, v69
    v_mfma_f32_16x16x32_bf16 v[192:195], a[160:163], v[56:59], v[192:195]
    v_exp_f32 v105, v105
    v_mfma_f32_16x16x32_bf16 v[224:227], a[160:163], v[60:63], v[224:227]
    ds_read_b128 a[148:151], v18 offset:21504
    v_cvt_pk_bf16_f32 v52, v104, v105
    v_mfma_f32_16x16x32_bf16 v[196:199], a[164:167], v[56:59], v[196:199]
    v_exp_f32 v106, v106
    v_mfma_f32_16x16x32_bf16 v[228:231], a[164:167], v[60:63], v[228:231]
    ds_read_b128 a[152:155], v18 offset:22528
    v_add_f32 v90, 0x73600000, v21
    v_mfma_f32_16x16x32_bf16 v[200:203], a[168:171], v[56:59], v[200:203]
    v_exp_f32 v107, v107
    v_mfma_f32_16x16x32_bf16 v[232:235], a[168:171], v[60:63], v[232:235]
    ds_read_b128 a[156:159], v18 offset:23552
    v_cvt_pk_bf16_f32 v53, v106, v107
    v_mfma_f32_16x16x32_bf16 v[204:207], a[172:175], v[56:59], v[204:207]
    v_exp_f32 v108, v108
    v_mfma_f32_16x16x32_bf16 v[236:239], a[172:175], v[60:63], v[236:239]
    buffer_load_dwordx4 a[36:39], v1, s[8:11], s74 offen offset:1024
    v_mfma_f32_16x16x32_bf16 v[208:211], a[176:179], v[56:59], v[208:211]
    s_xor_b32 s74, s24, 24576
    v_exp_f32 v109, v109
    v_mfma_f32_16x16x32_bf16 v[240:243], a[176:179], v[60:63], v[240:243]
    v_cvt_pk_bf16_f32 v54, v108, v109
    v_xor_b32 v18, 196608, v18
    v_mfma_f32_16x16x32_bf16 v[212:215], a[180:183], v[56:59], v[212:215]
    v_exp_f32 v110, v110
    v_mfma_f32_16x16x32_bf16 v[244:247], a[180:183], v[60:63], v[244:247]
    buffer_load_dwordx4 a[40:43], v1, s[8:11], s74 offen offset:2048
    v_mfma_f32_16x16x32_bf16 v[216:219], a[184:187], v[56:59], v[216:219]
    s_xor_b32 s74, s24, 24576
    v_exp_f32 v111, v111
    v_mfma_f32_16x16x32_bf16 v[248:251], a[184:187], v[60:63], v[248:251]
    v_cvt_pk_bf16_f32 v55, v110, v111
    v_min_f32 v90, v90, v70
    v_mfma_f32_16x16x32_bf16 v[220:223], a[188:191], v[56:59], v[220:223]
    buffer_load_dwordx4 a[44:47], v1, s[8:11], s74 offen offset:3072
    v_mfma_f32_16x16x32_bf16 v[252:255], a[188:191], v[60:63], v[252:255]
    v_add_f32 v91, 0x73500000, v21
    v_min_f32 v91, v91, v71
    v_add_f32 v92, 0, v21
    v_min_f32 v92, v92, v68
    s_waitcnt vmcnt(12) lgkmcnt(0)
    s_barrier
    v_mfma_f32_16x16x32_bf16 v[96:99], a[128:131], a[192:195], v[64:67]
    s_add_u32 m0, s15, 0
    ds_read_b128 a[160:163], v19 offset:0
    v_mfma_f32_16x16x32_bf16 v[96:99], a[132:135], a[196:199], v[96:99]
    ds_read_b128 a[164:167], v19 offset:1024
    v_mfma_f32_16x16x32_bf16 v[96:99], a[136:139], a[200:203], v[96:99]
    v_exp_f32 v112, v112
    v_mfma_f32_16x16x32_bf16 v[96:99], a[140:143], a[204:207], v[96:99]
    buffer_load_dwordx4 v1, s[8:11], s82 offen offset:0  lds
    v_mfma_f32_16x16x32_bf16 v[104:107], a[128:131], a[208:211], v[68:71]
    v_exp_f32 v113, v113
    v_mfma_f32_16x16x32_bf16 v[104:107], a[132:135], a[212:215], v[104:107]
    ds_read_b128 a[168:171], v19 offset:2048
    v_cvt_pk_bf16_f32 v56, v112, v113
    v_mfma_f32_16x16x32_bf16 v[104:107], a[136:139], a[216:219], v[104:107]
    v_exp_f32 v114, v114
    v_mfma_f32_16x16x32_bf16 v[104:107], a[140:143], a[220:223], v[104:107]
    buffer_load_dwordx4 v1, s[8:11], s82 offen offset:1024  lds
    v_mfma_f32_16x16x32_bf16 v[100:103], a[144:147], a[192:195], v[64:67]
    v_exp_f32 v115, v115
    v_mfma_f32_16x16x32_bf16 v[100:103], a[148:151], a[196:199], v[100:103]
    ds_read_b128 a[172:175], v19 offset:3072
    v_cvt_pk_bf16_f32 v57, v114, v115
    v_mfma_f32_16x16x32_bf16 v[100:103], a[152:155], a[200:203], v[100:103]
    v_exp_f32 v116, v116
    v_mfma_f32_16x16x32_bf16 v[100:103], a[156:159], a[204:207], v[100:103]
    buffer_load_dwordx4 v1, s[8:11], s82 offen offset:2048  lds
    v_mfma_f32_16x16x32_bf16 v[108:111], a[144:147], a[208:211], v[68:71]
    v_exp_f32 v117, v117
    v_mfma_f32_16x16x32_bf16 v[108:111], a[148:151], a[212:215], v[108:111]
    ds_read_b128 a[176:179], v20 offset:4096
    v_cvt_pk_bf16_f32 v58, v116, v117
    v_mfma_f32_16x16x32_bf16 v[108:111], a[152:155], a[216:219], v[108:111]
    v_exp_f32 v118, v118
    v_mfma_f32_16x16x32_bf16 v[108:111], a[156:159], a[220:223], v[108:111]
    buffer_load_dwordx4 v1, s[8:11], s82 offen offset:3072  lds
    v_mfma_f32_16x16x32_bf16 v[32:35], v[28:31], v[48:51], v[32:35]
    s_add_u32 m0, s15, 4096
    v_exp_f32 v119, v119
    v_mfma_f32_16x16x32_bf16 v[36:39], v[28:31], v[52:55], v[36:39]
    s_waitcnt lgkmcnt(4)
    ds_read_b128 a[180:183], v20 offset:5120
    v_cvt_pk_bf16_f32 v59, v118, v119
    v_mfma_f32_16x16x32_bf16 v[128:131], a[160:163], v[48:51], v[128:131]
    v_exp_f32 v120, v120
    v_mfma_f32_16x16x32_bf16 v[160:163], a[160:163], v[52:55], v[160:163]
    s_waitcnt lgkmcnt(4)
    v_mfma_f32_16x16x32_bf16 v[132:135], a[164:167], v[48:51], v[132:135]
    v_exp_f32 v121, v121
    v_mfma_f32_16x16x32_bf16 v[164:167], a[164:167], v[52:55], v[164:167]
    s_waitcnt lgkmcnt(3)
    ds_read_b128 a[184:187], v20 offset:6144
    v_cvt_pk_bf16_f32 v60, v120, v121
    v_mfma_f32_16x16x32_bf16 v[136:139], a[168:171], v[48:51], v[136:139]
    s_waitcnt lgkmcnt(3)
    v_exp_f32 v122, v122
    v_mfma_f32_16x16x32_bf16 v[168:171], a[168:171], v[52:55], v[168:171]
    buffer_load_dwordx4 v15, s[8:11], s82 offen offset:0  lds
    v_mfma_f32_16x16x32_bf16 v[140:143], a[172:175], v[48:51], v[140:143]
    v_exp_f32 v123, v123
    v_mfma_f32_16x16x32_bf16 v[172:175], a[172:175], v[52:55], v[172:175]
    s_waitcnt lgkmcnt(2)
    ds_read_b128 a[188:191], v20 offset:7168
    v_cvt_pk_bf16_f32 v61, v122, v123
    v_mfma_f32_16x16x32_bf16 v[144:147], a[176:179], v[48:51], v[144:147]
    s_waitcnt lgkmcnt(2)
    v_exp_f32 v124, v124
    v_mfma_f32_16x16x32_bf16 v[176:179], a[176:179], v[52:55], v[176:179]
    buffer_load_dwordx4 v15, s[8:11], s82 offen offset:1024  lds
    v_mfma_f32_16x16x32_bf16 v[148:151], a[180:183], v[48:51], v[148:151]
    v_exp_f32 v125, v125
    v_mfma_f32_16x16x32_bf16 v[180:183], a[180:183], v[52:55], v[180:183]
    s_waitcnt lgkmcnt(1)
    v_cvt_pk_bf16_f32 v62, v124, v125
    v_mfma_f32_16x16x32_bf16 v[152:155], a[184:187], v[48:51], v[152:155]
    s_waitcnt lgkmcnt(0)
    v_exp_f32 v126, v126
    v_mfma_f32_16x16x32_bf16 v[184:187], a[184:187], v[52:55], v[184:187]
    buffer_load_dwordx4 v15, s[8:11], s82 offen offset:2048  lds
    v_mfma_f32_16x16x32_bf16 v[156:159], a[188:191], v[48:51], v[156:159]
    v_exp_f32 v127, v127
    v_mfma_f32_16x16x32_bf16 v[188:191], a[188:191], v[52:55], v[188:191]
    v_cvt_pk_bf16_f32 v63, v126, v127
    v_mfma_f32_16x16x32_bf16 v[112:115], a[128:131], a[224:227], v[72:75]
    v_mfma_f32_16x16x32_bf16 v[112:115], a[132:135], a[228:231], v[112:115]
    v_mfma_f32_16x16x32_bf16 v[112:115], a[136:139], a[232:235], v[112:115]
    v_exp_f32 v96, v96
    v_mfma_f32_16x16x32_bf16 v[112:115], a[140:143], a[236:239], v[112:115]
    buffer_load_dwordx4 v15, s[8:11], s82 offen offset:3072  lds
    v_mfma_f32_16x16x32_bf16 v[120:123], a[128:131], a[240:243], v[76:79]
    s_xor_b32 s15, s15, 196608
    v_exp_f32 v97, v97
    v_mfma_f32_16x16x32_bf16 v[120:123], a[132:135], a[244:247], v[120:123]
    s_add_u32 m0, s16, 0
    ds_read_b128 a[128:131], v18 offset:0
    v_cvt_pk_bf16_f32 v48, v96, v97
    v_mfma_f32_16x16x32_bf16 v[120:123], a[136:139], a[248:251], v[120:123]
    v_exp_f32 v98, v98
    v_mfma_f32_16x16x32_bf16 v[120:123], a[140:143], a[252:255], v[120:123]
    buffer_load_dwordx4 v1, s[8:11], s19 offen offset:0  lds
    v_mfma_f32_16x16x32_bf16 v[116:119], a[144:147], a[224:227], v[72:75]
    v_exp_f32 v99, v99
    v_mfma_f32_16x16x32_bf16 v[116:119], a[148:151], a[228:231], v[116:119]
    ds_read_b128 a[132:135], v18 offset:1024
    v_cvt_pk_bf16_f32 v49, v98, v99
    v_mfma_f32_16x16x32_bf16 v[116:119], a[152:155], a[232:235], v[116:119]
    v_exp_f32 v100, v100
    v_mfma_f32_16x16x32_bf16 v[116:119], a[156:159], a[236:239], v[116:119]
    buffer_load_dwordx4 v1, s[8:11], s19 offen offset:1024  lds
    v_mfma_f32_16x16x32_bf16 v[124:127], a[144:147], a[240:243], v[76:79]
    v_exp_f32 v101, v101
    v_mfma_f32_16x16x32_bf16 v[124:127], a[148:151], a[244:247], v[124:127]
    ds_read_b128 a[136:139], v18 offset:2048
    v_cvt_pk_bf16_f32 v50, v100, v101
    v_mfma_f32_16x16x32_bf16 v[124:127], a[152:155], a[248:251], v[124:127]
    v_exp_f32 v102, v102
    v_mfma_f32_16x16x32_bf16 v[124:127], a[156:159], a[252:255], v[124:127]
    buffer_load_dwordx4 v1, s[8:11], s19 offen offset:2048  lds
    v_mfma_f32_16x16x32_bf16 v[40:43], v[28:31], v[56:59], v[40:43]
    v_exp_f32 v103, v103
    v_mfma_f32_16x16x32_bf16 v[44:47], v[28:31], v[60:63], v[44:47]
    ds_read_b128 a[140:143], v18 offset:3072
    v_cvt_pk_bf16_f32 v51, v102, v103
    v_mfma_f32_16x16x32_bf16 v[192:195], a[160:163], v[56:59], v[192:195]
    v_exp_f32 v104, v104
    v_mfma_f32_16x16x32_bf16 v[224:227], a[160:163], v[60:63], v[224:227]
    v_mfma_f32_16x16x32_bf16 v[196:199], a[164:167], v[56:59], v[196:199]
    v_exp_f32 v105, v105
    v_mfma_f32_16x16x32_bf16 v[228:231], a[164:167], v[60:63], v[228:231]
    ds_read_b128 a[144:147], v18 offset:4096
    v_cvt_pk_bf16_f32 v52, v104, v105
    v_mfma_f32_16x16x32_bf16 v[200:203], a[168:171], v[56:59], v[200:203]
    v_exp_f32 v106, v106
    v_mfma_f32_16x16x32_bf16 v[232:235], a[168:171], v[60:63], v[232:235]
    buffer_load_dwordx4 v1, s[8:11], s19 offen offset:3072  lds
    v_mfma_f32_16x16x32_bf16 v[204:207], a[172:175], v[56:59], v[204:207]
    s_add_u32 m0, s16, 4096
    v_exp_f32 v107, v107
    v_mfma_f32_16x16x32_bf16 v[236:239], a[172:175], v[60:63], v[236:239]
    ds_read_b128 a[148:151], v18 offset:5120
    v_cvt_pk_bf16_f32 v53, v106, v107
    v_mfma_f32_16x16x32_bf16 v[208:211], a[176:179], v[56:59], v[208:211]
    v_exp_f32 v108, v108
    v_mfma_f32_16x16x32_bf16 v[240:243], a[176:179], v[60:63], v[240:243]
    buffer_load_dwordx4 v15, s[8:11], s19 offen offset:0  lds
    v_mfma_f32_16x16x32_bf16 v[212:215], a[180:183], v[56:59], v[212:215]
    v_exp_f32 v109, v109
    v_mfma_f32_16x16x32_bf16 v[244:247], a[180:183], v[60:63], v[244:247]
    ds_read_b128 a[152:155], v18 offset:6144
    v_cvt_pk_bf16_f32 v54, v108, v109
    v_mfma_f32_16x16x32_bf16 v[216:219], a[184:187], v[56:59], v[216:219]
    v_exp_f32 v110, v110
    v_mfma_f32_16x16x32_bf16 v[248:251], a[184:187], v[60:63], v[248:251]
    buffer_load_dwordx4 v15, s[8:11], s19 offen offset:1024  lds
    v_mfma_f32_16x16x32_bf16 v[220:223], a[188:191], v[56:59], v[220:223]
    v_exp_f32 v111, v111
    v_mfma_f32_16x16x32_bf16 v[252:255], a[188:191], v[60:63], v[252:255]
    ds_read_b128 a[156:159], v18 offset:7168
    v_cvt_pk_bf16_f32 v55, v110, v111
    s_waitcnt lgkmcnt(7)
    v_mfma_f32_16x16x32_bf16 v[96:99], a[128:131], a[192:195], v[64:67]
    s_waitcnt lgkmcnt(6)
    ds_read_b128 a[160:163], v19 offset:16384
    v_add_f32 v93, 0xf1800000, v21
    v_mfma_f32_16x16x32_bf16 v[96:99], a[132:135], a[196:199], v[96:99]
    s_waitcnt lgkmcnt(6)
    ds_read_b128 a[164:167], v19 offset:17408
    v_min_f32 v93, v93, v69
    v_mfma_f32_16x16x32_bf16 v[96:99], a[136:139], a[200:203], v[96:99]
    s_waitcnt lgkmcnt(6)
    v_exp_f32 v112, v112
    v_mfma_f32_16x16x32_bf16 v[96:99], a[140:143], a[204:207], v[96:99]
    buffer_load_dwordx4 v15, s[8:11], s19 offen offset:2048  lds
    v_mfma_f32_16x16x32_bf16 v[104:107], a[128:131], a[208:211], v[68:71]
    v_exp_f32 v113, v113
    v_mfma_f32_16x16x32_bf16 v[104:107], a[132:135], a[212:215], v[104:107]
    ds_read_b128 a[168:171], v19 offset:18432
    v_cvt_pk_bf16_f32 v56, v112, v113
    v_mfma_f32_16x16x32_bf16 v[104:107], a[136:139], a[216:219], v[104:107]
    s_waitcnt lgkmcnt(6)
    v_exp_f32 v114, v114
    v_mfma_f32_16x16x32_bf16 v[104:107], a[140:143], a[220:223], v[104:107]
    buffer_load_dwordx4 v15, s[8:11], s19 offen offset:3072  lds
    v_mfma_f32_16x16x32_bf16 v[100:103], a[144:147], a[192:195], v[64:67]
    s_waitcnt lgkmcnt(5)
    s_xor_b32 s16, s16, 98304
    v_exp_f32 v115, v115
    v_mfma_f32_16x16x32_bf16 v[100:103], a[148:151], a[196:199], v[100:103]
    s_waitcnt lgkmcnt(4)
    s_xor_b32 s74, s24, 28672
    ds_read_b128 a[172:175], v19 offset:19456
    v_cvt_pk_bf16_f32 v57, v114, v115
    v_mfma_f32_16x16x32_bf16 v[100:103], a[152:155], a[200:203], v[100:103]
    s_waitcnt lgkmcnt(4)
    v_exp_f32 v116, v116
    v_mfma_f32_16x16x32_bf16 v[100:103], a[156:159], a[204:207], v[100:103]
    buffer_load_dwordx4 a[48:51], v1, s[8:11], s74 offen offset:0
    v_mfma_f32_16x16x32_bf16 v[108:111], a[144:147], a[208:211], v[68:71]
    s_xor_b32 s74, s24, 28672
    v_exp_f32 v117, v117
    v_mfma_f32_16x16x32_bf16 v[108:111], a[148:151], a[212:215], v[108:111]
    ds_read_b128 a[176:179], v20 offset:20480
    v_cvt_pk_bf16_f32 v58, v116, v117
    v_mfma_f32_16x16x32_bf16 v[108:111], a[152:155], a[216:219], v[108:111]
    v_exp_f32 v118, v118
    v_mfma_f32_16x16x32_bf16 v[108:111], a[156:159], a[220:223], v[108:111]
    buffer_load_dwordx4 a[52:55], v1, s[8:11], s74 offen offset:1024
    v_mfma_f32_16x16x32_bf16 v[32:35], v[28:31], v[48:51], v[32:35]
    s_xor_b32 s74, s24, 28672
    v_exp_f32 v119, v119
    v_mfma_f32_16x16x32_bf16 v[36:39], v[28:31], v[52:55], v[36:39]
    s_waitcnt lgkmcnt(4)
    ds_read_b128 a[180:183], v20 offset:21504
    v_cvt_pk_bf16_f32 v59, v118, v119
    v_mfma_f32_16x16x32_bf16 v[128:131], a[160:163], v[48:51], v[128:131]
    s_waitcnt lgkmcnt(4)
    v_exp_f32 v120, v120
    v_mfma_f32_16x16x32_bf16 v[160:163], a[160:163], v[52:55], v[160:163]
    buffer_load_dwordx4 a[56:59], v1, s[8:11], s74 offen offset:2048
    v_mfma_f32_16x16x32_bf16 v[132:135], a[164:167], v[48:51], v[132:135]
    s_xor_b32 s74, s24, 28672
    v_exp_f32 v121, v121
    v_mfma_f32_16x16x32_bf16 v[164:167], a[164:167], v[52:55], v[164:167]
    s_waitcnt lgkmcnt(3)
    ds_read_b128 a[184:187], v20 offset:22528
    v_cvt_pk_bf16_f32 v60, v120, v121
    v_mfma_f32_16x16x32_bf16 v[136:139], a[168:171], v[48:51], v[136:139]
    s_waitcnt lgkmcnt(3)
    v_exp_f32 v122, v122
    v_mfma_f32_16x16x32_bf16 v[168:171], a[168:171], v[52:55], v[168:171]
    buffer_load_dwordx4 a[60:63], v1, s[8:11], s74 offen offset:3072
    v_mfma_f32_16x16x32_bf16 v[140:143], a[172:175], v[48:51], v[140:143]
    v_exp_f32 v123, v123
    v_mfma_f32_16x16x32_bf16 v[172:175], a[172:175], v[52:55], v[172:175]
    s_waitcnt lgkmcnt(2)
    ds_read_b128 a[188:191], v20 offset:23552
    v_cvt_pk_bf16_f32 v61, v122, v123
    v_mfma_f32_16x16x32_bf16 v[144:147], a[176:179], v[48:51], v[144:147]
    v_exp_f32 v124, v124
    v_mfma_f32_16x16x32_bf16 v[176:179], a[176:179], v[52:55], v[176:179]
    s_waitcnt lgkmcnt(2)
    v_add_f32 v94, 0xf2000000, v21
    v_min_f32 v94, v94, v70
    v_mfma_f32_16x16x32_bf16 v[148:151], a[180:183], v[48:51], v[148:151]
    v_exp_f32 v125, v125
    v_mfma_f32_16x16x32_bf16 v[180:183], a[180:183], v[52:55], v[180:183]
    s_waitcnt lgkmcnt(1)
    v_cvt_pk_bf16_f32 v62, v124, v125
    v_xor_b32 v19, 98304, v19
    v_mfma_f32_16x16x32_bf16 v[152:155], a[184:187], v[48:51], v[152:155]
    v_exp_f32 v126, v126
    v_mfma_f32_16x16x32_bf16 v[184:187], a[184:187], v[52:55], v[184:187]
    s_waitcnt lgkmcnt(0)
    v_xor_b32 v20, 98304, v20
    v_add_f32 v95, 0xf2400000, v21
    v_mfma_f32_16x16x32_bf16 v[156:159], a[188:191], v[48:51], v[156:159]
    v_exp_f32 v127, v127
    v_mfma_f32_16x16x32_bf16 v[188:191], a[188:191], v[52:55], v[188:191]
    v_cvt_pk_bf16_f32 v63, v126, v127
    v_min_f32 v95, v95, v71
    v_mfma_f32_16x16x32_bf16 v[112:115], a[128:131], a[224:227], v[72:75]
    v_exp_f32 v96, v96
    v_mfma_f32_16x16x32_bf16 v[112:115], a[132:135], a[228:231], v[112:115]
    v_mfma_f32_16x16x32_bf16 v[112:115], a[136:139], a[232:235], v[112:115]
    v_exp_f32 v97, v97
    v_mfma_f32_16x16x32_bf16 v[112:115], a[140:143], a[236:239], v[112:115]
    v_cvt_pk_bf16_f32 v48, v96, v97
    v_mfma_f32_16x16x32_bf16 v[120:123], a[128:131], a[240:243], v[76:79]
    v_exp_f32 v98, v98
    v_mfma_f32_16x16x32_bf16 v[120:123], a[132:135], a[244:247], v[120:123]
    v_mfma_f32_16x16x32_bf16 v[120:123], a[136:139], a[248:251], v[120:123]
    v_exp_f32 v99, v99
    v_mfma_f32_16x16x32_bf16 v[120:123], a[140:143], a[252:255], v[120:123]
    v_mfma_f32_16x16x32_bf16 v[116:119], a[144:147], a[224:227], v[72:75]
    v_exp_f32 v100, v100
    v_mfma_f32_16x16x32_bf16 v[116:119], a[148:151], a[228:231], v[116:119]
    ds_read_b128 a[128:131], v18 offset:16384
    v_cvt_pk_bf16_f32 v49, v98, v99
    v_mfma_f32_16x16x32_bf16 v[116:119], a[152:155], a[232:235], v[116:119]
    s_add_u32 s19, s82, 32768
    v_exp_f32 v101, v101
    v_mfma_f32_16x16x32_bf16 v[116:119], a[156:159], a[236:239], v[116:119]
    s_sub_u32 s82, s12, s13
    ds_read_b128 a[132:135], v18 offset:17408
    v_cvt_pk_bf16_f32 v50, v100, v101
    v_mfma_f32_16x16x32_bf16 v[124:127], a[144:147], a[240:243], v[76:79]
    s_sub_u32 s82, s82, 1
    v_exp_f32 v102, v102
    v_mfma_f32_16x16x32_bf16 v[124:127], a[148:151], a[244:247], v[124:127]
    s_cmp_gt_u32 s12, s13
    s_cselect_b32 s82, s82, s12
    s_lshl_b32 s82, s82, 16
    ds_read_b128 a[136:139], v18 offset:18432
    v_mfma_f32_16x16x32_bf16 v[124:127], a[152:155], a[248:251], v[124:127]
    s_add_u32 s82, s82, s81
    v_exp_f32 v103, v103
    v_mfma_f32_16x16x32_bf16 v[124:127], a[156:159], a[252:255], v[124:127]
    s_cmp_ge_u32 s12, 17
    s_cselect_b32 s82, 2147471360, s82
    ds_read_b128 a[140:143], v18 offset:19456
    v_cvt_pk_bf16_f32 v51, v102, v103
    v_mfma_f32_16x16x32_bf16 v[40:43], v[28:31], v[56:59], v[40:43]
    s_add_u32 s12, s12, 1
    v_exp_f32 v104, v104
    v_mfma_f32_16x16x32_bf16 v[44:47], v[28:31], v[60:63], v[44:47]
    ds_read_b128 a[144:147], v18 offset:20480
    v_mfma_f32_16x16x32_bf16 v[192:195], a[160:163], v[56:59], v[192:195]
    v_exp_f32 v105, v105
    v_mfma_f32_16x16x32_bf16 v[224:227], a[160:163], v[60:63], v[224:227]
    ds_read_b128 a[148:151], v18 offset:21504
    v_cvt_pk_bf16_f32 v52, v104, v105
    v_mfma_f32_16x16x32_bf16 v[196:199], a[164:167], v[56:59], v[196:199]
    v_exp_f32 v106, v106
    v_mfma_f32_16x16x32_bf16 v[228:231], a[164:167], v[60:63], v[228:231]
    ds_read_b128 a[152:155], v18 offset:22528
    v_mfma_f32_16x16x32_bf16 v[200:203], a[168:171], v[56:59], v[200:203]
    v_exp_f32 v107, v107
    v_mfma_f32_16x16x32_bf16 v[232:235], a[168:171], v[60:63], v[232:235]
    ds_read_b128 a[156:159], v18 offset:23552
    v_cvt_pk_bf16_f32 v53, v106, v107
    v_mfma_f32_16x16x32_bf16 v[204:207], a[172:175], v[56:59], v[204:207]
    v_exp_f32 v108, v108
    v_mfma_f32_16x16x32_bf16 v[236:239], a[172:175], v[60:63], v[236:239]
    v_mfma_f32_16x16x32_bf16 v[208:211], a[176:179], v[56:59], v[208:211]
    v_exp_f32 v109, v109
    v_mfma_f32_16x16x32_bf16 v[240:243], a[176:179], v[60:63], v[240:243]
    v_cvt_pk_bf16_f32 v54, v108, v109
    v_xor_b32 v18, 196608, v18
    v_mfma_f32_16x16x32_bf16 v[212:215], a[180:183], v[56:59], v[212:215]
    v_exp_f32 v110, v110
    v_mfma_f32_16x16x32_bf16 v[244:247], a[180:183], v[60:63], v[244:247]
    v_mfma_f32_16x16x32_bf16 v[216:219], a[184:187], v[56:59], v[216:219]
    v_exp_f32 v111, v111
    v_mfma_f32_16x16x32_bf16 v[248:251], a[184:187], v[60:63], v[248:251]
    v_cvt_pk_bf16_f32 v55, v110, v111
    v_mfma_f32_16x16x32_bf16 v[220:223], a[188:191], v[56:59], v[220:223]
    v_mfma_f32_16x16x32_bf16 v[252:255], a[188:191], v[60:63], v[252:255]
    s_waitcnt vmcnt(4) lgkmcnt(0)
    s_barrier
    v_mfma_f32_16x16x32_bf16 v[96:99], a[128:131], a[192:195], v[64:67]
    s_add_u32 m0, s15, 0
    ds_read_b128 a[160:163], v19 offset:0
    v_mfma_f32_16x16x32_bf16 v[96:99], a[132:135], a[196:199], v[96:99]
    ds_read_b128 a[164:167], v19 offset:1024
    v_mfma_f32_16x16x32_bf16 v[96:99], a[136:139], a[200:203], v[96:99]
    v_exp_f32 v112, v112
    v_mfma_f32_16x16x32_bf16 v[96:99], a[140:143], a[204:207], v[96:99]
    buffer_load_dwordx4 v1, s[8:11], s82 offen offset:0  lds
    v_mfma_f32_16x16x32_bf16 v[104:107], a[128:131], a[208:211], v[68:71]
    v_exp_f32 v113, v113
    v_mfma_f32_16x16x32_bf16 v[104:107], a[132:135], a[212:215], v[104:107]
    ds_read_b128 a[168:171], v19 offset:2048
    v_cvt_pk_bf16_f32 v56, v112, v113
    v_mfma_f32_16x16x32_bf16 v[104:107], a[136:139], a[216:219], v[104:107]
    v_exp_f32 v114, v114
    v_mfma_f32_16x16x32_bf16 v[104:107], a[140:143], a[220:223], v[104:107]
    buffer_load_dwordx4 v1, s[8:11], s82 offen offset:1024  lds
    v_mfma_f32_16x16x32_bf16 v[100:103], a[144:147], a[192:195], v[64:67]
    v_exp_f32 v115, v115
    v_mfma_f32_16x16x32_bf16 v[100:103], a[148:151], a[196:199], v[100:103]
    ds_read_b128 a[172:175], v19 offset:3072
    v_cvt_pk_bf16_f32 v57, v114, v115
    v_mfma_f32_16x16x32_bf16 v[100:103], a[152:155], a[200:203], v[100:103]
    v_exp_f32 v116, v116
    v_mfma_f32_16x16x32_bf16 v[100:103], a[156:159], a[204:207], v[100:103]
    buffer_load_dwordx4 v1, s[8:11], s82 offen offset:2048  lds
    v_mfma_f32_16x16x32_bf16 v[108:111], a[144:147], a[208:211], v[68:71]
    v_exp_f32 v117, v117
    v_mfma_f32_16x16x32_bf16 v[108:111], a[148:151], a[212:215], v[108:111]
    ds_read_b128 a[176:179], v20 offset:4096
    v_cvt_pk_bf16_f32 v58, v116, v117
    v_mfma_f32_16x16x32_bf16 v[108:111], a[152:155], a[216:219], v[108:111]
    v_exp_f32 v118, v118
    v_mfma_f32_16x16x32_bf16 v[108:111], a[156:159], a[220:223], v[108:111]
    buffer_load_dwordx4 v1, s[8:11], s82 offen offset:3072  lds
    v_mfma_f32_16x16x32_bf16 v[32:35], v[28:31], v[48:51], v[32:35]
    s_add_u32 m0, s15, 4096
    v_exp_f32 v119, v119
    v_mfma_f32_16x16x32_bf16 v[36:39], v[28:31], v[52:55], v[36:39]
    s_waitcnt lgkmcnt(4)
    ds_read_b128 a[180:183], v20 offset:5120
    v_cvt_pk_bf16_f32 v59, v118, v119
    v_mfma_f32_16x16x32_bf16 v[128:131], a[160:163], v[48:51], v[128:131]
    v_exp_f32 v120, v120
    v_mfma_f32_16x16x32_bf16 v[160:163], a[160:163], v[52:55], v[160:163]
    s_waitcnt lgkmcnt(4)
    v_mfma_f32_16x16x32_bf16 v[132:135], a[164:167], v[48:51], v[132:135]
    v_exp_f32 v121, v121
    v_mfma_f32_16x16x32_bf16 v[164:167], a[164:167], v[52:55], v[164:167]
    s_waitcnt lgkmcnt(3)
    ds_read_b128 a[184:187], v20 offset:6144
    v_cvt_pk_bf16_f32 v60, v120, v121
    v_mfma_f32_16x16x32_bf16 v[136:139], a[168:171], v[48:51], v[136:139]
    s_waitcnt lgkmcnt(3)
    v_exp_f32 v122, v122
    v_mfma_f32_16x16x32_bf16 v[168:171], a[168:171], v[52:55], v[168:171]
    buffer_load_dwordx4 v15, s[8:11], s82 offen offset:0  lds
    v_mfma_f32_16x16x32_bf16 v[140:143], a[172:175], v[48:51], v[140:143]
    v_exp_f32 v123, v123
    v_mfma_f32_16x16x32_bf16 v[172:175], a[172:175], v[52:55], v[172:175]
    s_waitcnt lgkmcnt(2)
    ds_read_b128 a[188:191], v20 offset:7168
    v_cvt_pk_bf16_f32 v61, v122, v123
    v_mfma_f32_16x16x32_bf16 v[144:147], a[176:179], v[48:51], v[144:147]
    s_waitcnt lgkmcnt(2)
    v_exp_f32 v124, v124
    v_mfma_f32_16x16x32_bf16 v[176:179], a[176:179], v[52:55], v[176:179]
    buffer_load_dwordx4 v15, s[8:11], s82 offen offset:1024  lds
    v_mfma_f32_16x16x32_bf16 v[148:151], a[180:183], v[48:51], v[148:151]
    v_exp_f32 v125, v125
    v_mfma_f32_16x16x32_bf16 v[180:183], a[180:183], v[52:55], v[180:183]
    s_waitcnt lgkmcnt(1)
    v_cvt_pk_bf16_f32 v62, v124, v125
    v_mfma_f32_16x16x32_bf16 v[152:155], a[184:187], v[48:51], v[152:155]
    s_waitcnt lgkmcnt(0)
    v_exp_f32 v126, v126
    v_mfma_f32_16x16x32_bf16 v[184:187], a[184:187], v[52:55], v[184:187]
    buffer_load_dwordx4 v15, s[8:11], s82 offen offset:2048  lds
    v_mfma_f32_16x16x32_bf16 v[156:159], a[188:191], v[48:51], v[156:159]
    v_exp_f32 v127, v127
    v_mfma_f32_16x16x32_bf16 v[188:191], a[188:191], v[52:55], v[188:191]
    v_cvt_pk_bf16_f32 v63, v126, v127
    v_mfma_f32_16x16x32_bf16 v[112:115], a[128:131], a[224:227], v[72:75]
    v_mfma_f32_16x16x32_bf16 v[112:115], a[132:135], a[228:231], v[112:115]
    v_mfma_f32_16x16x32_bf16 v[112:115], a[136:139], a[232:235], v[112:115]
    v_exp_f32 v96, v96
    v_mfma_f32_16x16x32_bf16 v[112:115], a[140:143], a[236:239], v[112:115]
    buffer_load_dwordx4 v15, s[8:11], s82 offen offset:3072  lds
    v_mfma_f32_16x16x32_bf16 v[120:123], a[128:131], a[240:243], v[76:79]
    s_xor_b32 s15, s15, 196608
    v_exp_f32 v97, v97
    v_mfma_f32_16x16x32_bf16 v[120:123], a[132:135], a[244:247], v[120:123]
    s_add_u32 m0, s16, 0
    ds_read_b128 a[128:131], v18 offset:0
    v_cvt_pk_bf16_f32 v48, v96, v97
    v_mfma_f32_16x16x32_bf16 v[120:123], a[136:139], a[248:251], v[120:123]
    v_exp_f32 v98, v98
    v_mfma_f32_16x16x32_bf16 v[120:123], a[140:143], a[252:255], v[120:123]
    buffer_load_dwordx4 v1, s[8:11], s19 offen offset:0  lds
    v_mfma_f32_16x16x32_bf16 v[116:119], a[144:147], a[224:227], v[72:75]
    v_exp_f32 v99, v99
    v_mfma_f32_16x16x32_bf16 v[116:119], a[148:151], a[228:231], v[116:119]
    ds_read_b128 a[132:135], v18 offset:1024
    v_cvt_pk_bf16_f32 v49, v98, v99
    v_mfma_f32_16x16x32_bf16 v[116:119], a[152:155], a[232:235], v[116:119]
    v_exp_f32 v100, v100
    v_mfma_f32_16x16x32_bf16 v[116:119], a[156:159], a[236:239], v[116:119]
    buffer_load_dwordx4 v1, s[8:11], s19 offen offset:1024  lds
    v_mfma_f32_16x16x32_bf16 v[124:127], a[144:147], a[240:243], v[76:79]
    v_exp_f32 v101, v101
    v_mfma_f32_16x16x32_bf16 v[124:127], a[148:151], a[244:247], v[124:127]
    ds_read_b128 a[136:139], v18 offset:2048
    v_cvt_pk_bf16_f32 v50, v100, v101
    v_mfma_f32_16x16x32_bf16 v[124:127], a[152:155], a[248:251], v[124:127]
    v_exp_f32 v102, v102
    v_mfma_f32_16x16x32_bf16 v[124:127], a[156:159], a[252:255], v[124:127]
    buffer_load_dwordx4 v1, s[8:11], s19 offen offset:2048  lds
    v_mfma_f32_16x16x32_bf16 v[40:43], v[28:31], v[56:59], v[40:43]
    v_exp_f32 v103, v103
    v_mfma_f32_16x16x32_bf16 v[44:47], v[28:31], v[60:63], v[44:47]
    ds_read_b128 a[140:143], v18 offset:3072
    v_cvt_pk_bf16_f32 v51, v102, v103
    v_mfma_f32_16x16x32_bf16 v[192:195], a[160:163], v[56:59], v[192:195]
    v_exp_f32 v104, v104
    v_mfma_f32_16x16x32_bf16 v[224:227], a[160:163], v[60:63], v[224:227]
    v_mfma_f32_16x16x32_bf16 v[196:199], a[164:167], v[56:59], v[196:199]
    v_exp_f32 v105, v105
    v_mfma_f32_16x16x32_bf16 v[228:231], a[164:167], v[60:63], v[228:231]
    ds_read_b128 a[144:147], v18 offset:4096
    v_cvt_pk_bf16_f32 v52, v104, v105
    v_mfma_f32_16x16x32_bf16 v[200:203], a[168:171], v[56:59], v[200:203]
    v_exp_f32 v106, v106
    v_mfma_f32_16x16x32_bf16 v[232:235], a[168:171], v[60:63], v[232:235]
    buffer_load_dwordx4 v1, s[8:11], s19 offen offset:3072  lds
    v_mfma_f32_16x16x32_bf16 v[204:207], a[172:175], v[56:59], v[204:207]
    s_add_u32 m0, s16, 4096
    v_exp_f32 v107, v107
    v_mfma_f32_16x16x32_bf16 v[236:239], a[172:175], v[60:63], v[236:239]
    ds_read_b128 a[148:151], v18 offset:5120
    v_cvt_pk_bf16_f32 v53, v106, v107
    v_mfma_f32_16x16x32_bf16 v[208:211], a[176:179], v[56:59], v[208:211]
    v_exp_f32 v108, v108
    v_mfma_f32_16x16x32_bf16 v[240:243], a[176:179], v[60:63], v[240:243]
    buffer_load_dwordx4 v15, s[8:11], s19 offen offset:0  lds
    v_mfma_f32_16x16x32_bf16 v[212:215], a[180:183], v[56:59], v[212:215]
    v_exp_f32 v109, v109
    v_mfma_f32_16x16x32_bf16 v[244:247], a[180:183], v[60:63], v[244:247]
    ds_read_b128 a[152:155], v18 offset:6144
    v_cvt_pk_bf16_f32 v54, v108, v109
    v_mfma_f32_16x16x32_bf16 v[216:219], a[184:187], v[56:59], v[216:219]
    v_exp_f32 v110, v110
    v_mfma_f32_16x16x32_bf16 v[248:251], a[184:187], v[60:63], v[248:251]
    buffer_load_dwordx4 v15, s[8:11], s19 offen offset:1024  lds
    v_mfma_f32_16x16x32_bf16 v[220:223], a[188:191], v[56:59], v[220:223]
    v_exp_f32 v111, v111
    v_mfma_f32_16x16x32_bf16 v[252:255], a[188:191], v[60:63], v[252:255]
    ds_read_b128 a[156:159], v18 offset:7168
    v_cvt_pk_bf16_f32 v55, v110, v111
    s_cmp_eq_u32 s14, 0
    s_cbranch_scc1 L_t2_diag
.p2align 3
L_t2_loop:
    s_waitcnt lgkmcnt(7)
    v_mfma_f32_16x16x32_bf16 v[96:99], a[128:131], a[192:195], v[64:67]
    s_waitcnt lgkmcnt(6)
    ds_read_b128 a[160:163], v19 offset:16384
    v_mfma_f32_16x16x32_bf16 v[96:99], a[132:135], a[196:199], v[96:99]
    s_waitcnt lgkmcnt(6)
    ds_read_b128 a[164:167], v19 offset:17408
    v_mfma_f32_16x16x32_bf16 v[96:99], a[136:139], a[200:203], v[96:99]
    s_waitcnt lgkmcnt(6)
    v_exp_f32 v112, v112
    v_mfma_f32_16x16x32_bf16 v[96:99], a[140:143], a[204:207], v[96:99]
    buffer_load_dwordx4 v15, s[8:11], s19 offen offset:2048  lds
    v_mfma_f32_16x16x32_bf16 v[104:107], a[128:131], a[208:211], v[68:71]
    v_exp_f32 v113, v113
    v_mfma_f32_16x16x32_bf16 v[104:107], a[132:135], a[212:215], v[104:107]
    ds_read_b128 a[168:171], v19 offset:18432
    v_cvt_pk_bf16_f32 v56, v112, v113
    v_mfma_f32_16x16x32_bf16 v[104:107], a[136:139], a[216:219], v[104:107]
    s_waitcnt lgkmcnt(6)
    v_exp_f32 v114, v114
    v_mfma_f32_16x16x32_bf16 v[104:107], a[140:143], a[220:223], v[104:107]
    buffer_load_dwordx4 v15, s[8:11], s19 offen offset:3072  lds
    v_mfma_f32_16x16x32_bf16 v[100:103], a[144:147], a[192:195], v[64:67]
    s_waitcnt lgkmcnt(5)
    s_xor_b32 s16, s16, 98304
    v_exp_f32 v115, v115
    v_mfma_f32_16x16x32_bf16 v[100:103], a[148:151], a[196:199], v[100:103]
    s_waitcnt lgkmcnt(4)
    ds_read_b128 a[172:175], v19 offset:19456
    v_cvt_pk_bf16_f32 v57, v114, v115
    v_mfma_f32_16x16x32_bf16 v[100:103], a[152:155], a[200:203], v[100:103]
    s_waitcnt lgkmcnt(4)
    v_exp_f32 v116, v116
    v_mfma_f32_16x16x32_bf16 v[100:103], a[156:159], a[204:207], v[100:103]
    v_mfma_f32_16x16x32_bf16 v[108:111], a[144:147], a[208:211], v[68:71]
    v_exp_f32 v117, v117
    v_mfma_f32_16x16x32_bf16 v[108:111], a[148:151], a[212:215], v[108:111]
    ds_read_b128 a[176:179], v20 offset:20480
    v_cvt_pk_bf16_f32 v58, v116, v117
    v_mfma_f32_16x16x32_bf16 v[108:111], a[152:155], a[216:219], v[108:111]
    v_exp_f32 v118, v118
    v_mfma_f32_16x16x32_bf16 v[108:111], a[156:159], a[220:223], v[108:111]
    v_mfma_f32_16x16x32_bf16 v[32:35], v[28:31], v[48:51], v[32:35]
    v_exp_f32 v119, v119
    v_mfma_f32_16x16x32_bf16 v[36:39], v[28:31], v[52:55], v[36:39]
    s_waitcnt lgkmcnt(4)
    ds_read_b128 a[180:183], v20 offset:21504
    v_cvt_pk_bf16_f32 v59, v118, v119
    v_mfma_f32_16x16x32_bf16 v[128:131], a[160:163], v[48:51], v[128:131]
    v_exp_f32 v120, v120
    v_mfma_f32_16x16x32_bf16 v[160:163], a[160:163], v[52:55], v[160:163]
    s_waitcnt lgkmcnt(4)
    v_mfma_f32_16x16x32_bf16 v[132:135], a[164:167], v[48:51], v[132:135]
    v_exp_f32 v121, v121
    v_mfma_f32_16x16x32_bf16 v[164:167], a[164:167], v[52:55], v[164:167]
    s_waitcnt lgkmcnt(3)
    ds_read_b128 a[184:187], v20 offset:22528
    v_cvt_pk_bf16_f32 v60, v120, v121
    v_mfma_f32_16x16x32_bf16 v[136:139], a[168:171], v[48:51], v[136:139]
    v_exp_f32 v122, v122
    v_mfma_f32_16x16x32_bf16 v[168:171], a[168:171], v[52:55], v[168:171]
    s_waitcnt lgkmcnt(3)
    v_mfma_f32_16x16x32_bf16 v[140:143], a[172:175], v[48:51], v[140:143]
    v_exp_f32 v123, v123
    v_mfma_f32_16x16x32_bf16 v[172:175], a[172:175], v[52:55], v[172:175]
    s_waitcnt lgkmcnt(2)
    ds_read_b128 a[188:191], v20 offset:23552
    v_cvt_pk_bf16_f32 v61, v122, v123
    v_mfma_f32_16x16x32_bf16 v[144:147], a[176:179], v[48:51], v[144:147]
    v_exp_f32 v124, v124
    v_mfma_f32_16x16x32_bf16 v[176:179], a[176:179], v[52:55], v[176:179]
    s_waitcnt lgkmcnt(2)
    v_mfma_f32_16x16x32_bf16 v[148:151], a[180:183], v[48:51], v[148:151]
    v_exp_f32 v125, v125
    v_mfma_f32_16x16x32_bf16 v[180:183], a[180:183], v[52:55], v[180:183]
    s_waitcnt lgkmcnt(1)
    v_cvt_pk_bf16_f32 v62, v124, v125
    v_xor_b32 v19, 98304, v19
    v_mfma_f32_16x16x32_bf16 v[152:155], a[184:187], v[48:51], v[152:155]
    v_exp_f32 v126, v126
    v_mfma_f32_16x16x32_bf16 v[184:187], a[184:187], v[52:55], v[184:187]
    s_waitcnt lgkmcnt(0)
    v_xor_b32 v20, 98304, v20
    v_mfma_f32_16x16x32_bf16 v[156:159], a[188:191], v[48:51], v[156:159]
    v_exp_f32 v127, v127
    v_mfma_f32_16x16x32_bf16 v[188:191], a[188:191], v[52:55], v[188:191]
    v_cvt_pk_bf16_f32 v63, v126, v127
    v_mfma_f32_16x16x32_bf16 v[112:115], a[128:131], a[224:227], v[72:75]
    v_exp_f32 v96, v96
    v_mfma_f32_16x16x32_bf16 v[112:115], a[132:135], a[228:231], v[112:115]
    v_mfma_f32_16x16x32_bf16 v[112:115], a[136:139], a[232:235], v[112:115]
    v_exp_f32 v97, v97
    v_mfma_f32_16x16x32_bf16 v[112:115], a[140:143], a[236:239], v[112:115]
    v_cvt_pk_bf16_f32 v48, v96, v97
    v_mfma_f32_16x16x32_bf16 v[120:123], a[128:131], a[240:243], v[76:79]
    v_exp_f32 v98, v98
    v_mfma_f32_16x16x32_bf16 v[120:123], a[132:135], a[244:247], v[120:123]
    v_mfma_f32_16x16x32_bf16 v[120:123], a[136:139], a[248:251], v[120:123]
    v_exp_f32 v99, v99
    v_mfma_f32_16x16x32_bf16 v[120:123], a[140:143], a[252:255], v[120:123]
    v_mfma_f32_16x16x32_bf16 v[116:119], a[144:147], a[224:227], v[72:75]
    v_exp_f32 v100, v100
    v_mfma_f32_16x16x32_bf16 v[116:119], a[148:151], a[228:231], v[116:119]
    ds_read_b128 a[128:131], v18 offset:16384
    v_cvt_pk_bf16_f32 v49, v98, v99
    v_mfma_f32_16x16x32_bf16 v[116:119], a[152:155], a[232:235], v[116:119]
    s_add_u32 s19, s82, 32768
    v_exp_f32 v101, v101
    v_mfma_f32_16x16x32_bf16 v[116:119], a[156:159], a[236:239], v[116:119]
    s_sub_u32 s82, s12, s13
    ds_read_b128 a[132:135], v18 offset:17408
    v_cvt_pk_bf16_f32 v50, v100, v101
    v_mfma_f32_16x16x32_bf16 v[124:127], a[144:147], a[240:243], v[76:79]
    s_sub_u32 s82, s82, 1
    v_exp_f32 v102, v102
    v_mfma_f32_16x16x32_bf16 v[124:127], a[148:151], a[244:247], v[124:127]
    s_cmp_gt_u32 s12, s13
    s_cselect_b32 s82, s82, s12
    s_lshl_b32 s82, s82, 16
    ds_read_b128 a[136:139], v18 offset:18432
    v_mfma_f32_16x16x32_bf16 v[124:127], a[152:155], a[248:251], v[124:127]
    s_add_u32 s82, s82, s81
    v_exp_f32 v103, v103
    v_mfma_f32_16x16x32_bf16 v[124:127], a[156:159], a[252:255], v[124:127]
    s_cmp_ge_u32 s12, 17
    s_cselect_b32 s82, 2147471360, s82
    ds_read_b128 a[140:143], v18 offset:19456
    v_cvt_pk_bf16_f32 v51, v102, v103
    v_mfma_f32_16x16x32_bf16 v[40:43], v[28:31], v[56:59], v[40:43]
    s_add_u32 s12, s12, 1
    v_exp_f32 v104, v104
    v_mfma_f32_16x16x32_bf16 v[44:47], v[28:31], v[60:63], v[44:47]
    ds_read_b128 a[144:147], v18 offset:20480
    v_mfma_f32_16x16x32_bf16 v[192:195], a[160:163], v[56:59], v[192:195]
    v_exp_f32 v105, v105
    v_mfma_f32_16x16x32_bf16 v[224:227], a[160:163], v[60:63], v[224:227]
    ds_read_b128 a[148:151], v18 offset:21504
    v_cvt_pk_bf16_f32 v52, v104, v105
    v_mfma_f32_16x16x32_bf16 v[196:199], a[164:167], v[56:59], v[196:199]
    v_exp_f32 v106, v106
    v_mfma_f32_16x16x32_bf16 v[228:231], a[164:167], v[60:63], v[228:231]
    ds_read_b128 a[152:155], v18 offset:22528
    v_mfma_f32_16x16x32_bf16 v[200:203], a[168:171], v[56:59], v[200:203]
    v_exp_f32 v107, v107
    v_mfma_f32_16x16x32_bf16 v[232:235], a[168:171], v[60:63], v[232:235]
    ds_read_b128 a[156:159], v18 offset:23552
    v_cvt_pk_bf16_f32 v53, v106, v107
    v_mfma_f32_16x16x32_bf16 v[204:207], a[172:175], v[56:59], v[204:207]
    v_exp_f32 v108, v108
    v_mfma_f32_16x16x32_bf16 v[236:239], a[172:175], v[60:63], v[236:239]
    v_mfma_f32_16x16x32_bf16 v[208:211], a[176:179], v[56:59], v[208:211]
    v_exp_f32 v109, v109
    v_mfma_f32_16x16x32_bf16 v[240:243], a[176:179], v[60:63], v[240:243]
    v_cvt_pk_bf16_f32 v54, v108, v109
    v_xor_b32 v18, 196608, v18
    v_mfma_f32_16x16x32_bf16 v[212:215], a[180:183], v[56:59], v[212:215]
    v_exp_f32 v110, v110
    v_mfma_f32_16x16x32_bf16 v[244:247], a[180:183], v[60:63], v[244:247]
    v_mfma_f32_16x16x32_bf16 v[216:219], a[184:187], v[56:59], v[216:219]
    v_exp_f32 v111, v111
    v_mfma_f32_16x16x32_bf16 v[248:251], a[184:187], v[60:63], v[248:251]
    v_cvt_pk_bf16_f32 v55, v110, v111
    v_mfma_f32_16x16x32_bf16 v[220:223], a[188:191], v[56:59], v[220:223]
    v_mfma_f32_16x16x32_bf16 v[252:255], a[188:191], v[60:63], v[252:255]
    s_waitcnt vmcnt(0) lgkmcnt(0)
    s_barrier
    v_mfma_f32_16x16x32_bf16 v[96:99], a[128:131], a[192:195], v[64:67]
    s_add_u32 m0, s15, 0
    ds_read_b128 a[160:163], v19 offset:0
    v_mfma_f32_16x16x32_bf16 v[96:99], a[132:135], a[196:199], v[96:99]
    ds_read_b128 a[164:167], v19 offset:1024
    v_mfma_f32_16x16x32_bf16 v[96:99], a[136:139], a[200:203], v[96:99]
    v_exp_f32 v112, v112
    v_mfma_f32_16x16x32_bf16 v[96:99], a[140:143], a[204:207], v[96:99]
    buffer_load_dwordx4 v1, s[8:11], s82 offen offset:0  lds
    v_mfma_f32_16x16x32_bf16 v[104:107], a[128:131], a[208:211], v[68:71]
    v_exp_f32 v113, v113
    v_mfma_f32_16x16x32_bf16 v[104:107], a[132:135], a[212:215], v[104:107]
    ds_read_b128 a[168:171], v19 offset:2048
    v_cvt_pk_bf16_f32 v56, v112, v113
    v_mfma_f32_16x16x32_bf16 v[104:107], a[136:139], a[216:219], v[104:107]
    v_exp_f32 v114, v114
    v_mfma_f32_16x16x32_bf16 v[104:107], a[140:143], a[220:223], v[104:107]
    buffer_load_dwordx4 v1, s[8:11], s82 offen offset:1024  lds
    v_mfma_f32_16x16x32_bf16 v[100:103], a[144:147], a[192:195], v[64:67]
    v_exp_f32 v115, v115
    v_mfma_f32_16x16x32_bf16 v[100:103], a[148:151], a[196:199], v[100:103]
    ds_read_b128 a[172:175], v19 offset:3072
    v_cvt_pk_bf16_f32 v57, v114, v115
    v_mfma_f32_16x16x32_bf16 v[100:103], a[152:155], a[200:203], v[100:103]
    v_exp_f32 v116, v116
    v_mfma_f32_16x16x32_bf16 v[100:103], a[156:159], a[204:207], v[100:103]
    buffer_load_dwordx4 v1, s[8:11], s82 offen offset:2048  lds
    v_mfma_f32_16x16x32_bf16 v[108:111], a[144:147], a[208:211], v[68:71]
    v_exp_f32 v117, v117
    v_mfma_f32_16x16x32_bf16 v[108:111], a[148:151], a[212:215], v[108:111]
    ds_read_b128 a[176:179], v20 offset:4096
    v_cvt_pk_bf16_f32 v58, v116, v117
    v_mfma_f32_16x16x32_bf16 v[108:111], a[152:155], a[216:219], v[108:111]
    v_exp_f32 v118, v118
    v_mfma_f32_16x16x32_bf16 v[108:111], a[156:159], a[220:223], v[108:111]
    buffer_load_dwordx4 v1, s[8:11], s82 offen offset:3072  lds
    v_mfma_f32_16x16x32_bf16 v[32:35], v[28:31], v[48:51], v[32:35]
    s_add_u32 m0, s15, 4096
    v_exp_f32 v119, v119
    v_mfma_f32_16x16x32_bf16 v[36:39], v[28:31], v[52:55], v[36:39]
    s_waitcnt lgkmcnt(4)
    ds_read_b128 a[180:183], v20 offset:5120
    v_cvt_pk_bf16_f32 v59, v118, v119
    v_mfma_f32_16x16x32_bf16 v[128:131], a[160:163], v[48:51], v[128:131]
    v_exp_f32 v120, v120
    v_mfma_f32_16x16x32_bf16 v[160:163], a[160:163], v[52:55], v[160:163]
    s_waitcnt lgkmcnt(4)
    v_mfma_f32_16x16x32_bf16 v[132:135], a[164:167], v[48:51], v[132:135]
    v_exp_f32 v121, v121
    v_mfma_f32_16x16x32_bf16 v[164:167], a[164:167], v[52:55], v[164:167]
    s_waitcnt lgkmcnt(3)
    ds_read_b128 a[184:187], v20 offset:6144
    v_cvt_pk_bf16_f32 v60, v120, v121
    v_mfma_f32_16x16x32_bf16 v[136:139], a[168:171], v[48:51], v[136:139]
    s_waitcnt lgkmcnt(3)
    v_exp_f32 v122, v122
    v_mfma_f32_16x16x32_bf16 v[168:171], a[168:171], v[52:55], v[168:171]
    buffer_load_dwordx4 v15, s[8:11], s82 offen offset:0  lds
    v_mfma_f32_16x16x32_bf16 v[140:143], a[172:175], v[48:51], v[140:143]
    v_exp_f32 v123, v123
    v_mfma_f32_16x16x32_bf16 v[172:175], a[172:175], v[52:55], v[172:175]
    s_waitcnt lgkmcnt(2)
    ds_read_b128 a[188:191], v20 offset:7168
    v_cvt_pk_bf16_f32 v61, v122, v123
    v_mfma_f32_16x16x32_bf16 v[144:147], a[176:179], v[48:51], v[144:147]
    s_waitcnt lgkmcnt(2)
    v_exp_f32 v124, v124
    v_mfma_f32_16x16x32_bf16 v[176:179], a[176:179], v[52:55], v[176:179]
    buffer_load_dwordx4 v15, s[8:11], s82 offen offset:1024  lds
    v_mfma_f32_16x16x32_bf16 v[148:151], a[180:183], v[48:51], v[148:151]
    v_exp_f32 v125, v125
    v_mfma_f32_16x16x32_bf16 v[180:183], a[180:183], v[52:55], v[180:183]
    s_waitcnt lgkmcnt(1)
    v_cvt_pk_bf16_f32 v62, v124, v125
    v_mfma_f32_16x16x32_bf16 v[152:155], a[184:187], v[48:51], v[152:155]
    s_waitcnt lgkmcnt(0)
    v_exp_f32 v126, v126
    v_mfma_f32_16x16x32_bf16 v[184:187], a[184:187], v[52:55], v[184:187]
    buffer_load_dwordx4 v15, s[8:11], s82 offen offset:2048  lds
    v_mfma_f32_16x16x32_bf16 v[156:159], a[188:191], v[48:51], v[156:159]
    v_exp_f32 v127, v127
    v_mfma_f32_16x16x32_bf16 v[188:191], a[188:191], v[52:55], v[188:191]
    v_cvt_pk_bf16_f32 v63, v126, v127
    v_mfma_f32_16x16x32_bf16 v[112:115], a[128:131], a[224:227], v[72:75]
    v_mfma_f32_16x16x32_bf16 v[112:115], a[132:135], a[228:231], v[112:115]
    v_mfma_f32_16x16x32_bf16 v[112:115], a[136:139], a[232:235], v[112:115]
    v_exp_f32 v96, v96
    v_mfma_f32_16x16x32_bf16 v[112:115], a[140:143], a[236:239], v[112:115]
    buffer_load_dwordx4 v15, s[8:11], s82 offen offset:3072  lds
    v_mfma_f32_16x16x32_bf16 v[120:123], a[128:131], a[240:243], v[76:79]
    s_xor_b32 s15, s15, 196608
    v_exp_f32 v97, v97
    v_mfma_f32_16x16x32_bf16 v[120:123], a[132:135], a[244:247], v[120:123]
    s_add_u32 m0, s16, 0
    ds_read_b128 a[128:131], v18 offset:0
    v_cvt_pk_bf16_f32 v48, v96, v97
    v_mfma_f32_16x16x32_bf16 v[120:123], a[136:139], a[248:251], v[120:123]
    v_exp_f32 v98, v98
    v_mfma_f32_16x16x32_bf16 v[120:123], a[140:143], a[252:255], v[120:123]
    buffer_load_dwordx4 v1, s[8:11], s19 offen offset:0  lds
    v_mfma_f32_16x16x32_bf16 v[116:119], a[144:147], a[224:227], v[72:75]
    v_exp_f32 v99, v99
    v_mfma_f32_16x16x32_bf16 v[116:119], a[148:151], a[228:231], v[116:119]
    ds_read_b128 a[132:135], v18 offset:1024
    v_cvt_pk_bf16_f32 v49, v98, v99
    v_mfma_f32_16x16x32_bf16 v[116:119], a[152:155], a[232:235], v[116:119]
    v_exp_f32 v100, v100
    v_mfma_f32_16x16x32_bf16 v[116:119], a[156:159], a[236:239], v[116:119]
    buffer_load_dwordx4 v1, s[8:11], s19 offen offset:1024  lds
    v_mfma_f32_16x16x32_bf16 v[124:127], a[144:147], a[240:243], v[76:79]
    v_exp_f32 v101, v101
    v_mfma_f32_16x16x32_bf16 v[124:127], a[148:151], a[244:247], v[124:127]
    ds_read_b128 a[136:139], v18 offset:2048
    v_cvt_pk_bf16_f32 v50, v100, v101
    v_mfma_f32_16x16x32_bf16 v[124:127], a[152:155], a[248:251], v[124:127]
    v_exp_f32 v102, v102
    v_mfma_f32_16x16x32_bf16 v[124:127], a[156:159], a[252:255], v[124:127]
    buffer_load_dwordx4 v1, s[8:11], s19 offen offset:2048  lds
    v_mfma_f32_16x16x32_bf16 v[40:43], v[28:31], v[56:59], v[40:43]
    v_exp_f32 v103, v103
    v_mfma_f32_16x16x32_bf16 v[44:47], v[28:31], v[60:63], v[44:47]
    ds_read_b128 a[140:143], v18 offset:3072
    v_cvt_pk_bf16_f32 v51, v102, v103
    v_mfma_f32_16x16x32_bf16 v[192:195], a[160:163], v[56:59], v[192:195]
    v_exp_f32 v104, v104
    v_mfma_f32_16x16x32_bf16 v[224:227], a[160:163], v[60:63], v[224:227]
    v_mfma_f32_16x16x32_bf16 v[196:199], a[164:167], v[56:59], v[196:199]
    v_exp_f32 v105, v105
    v_mfma_f32_16x16x32_bf16 v[228:231], a[164:167], v[60:63], v[228:231]
    ds_read_b128 a[144:147], v18 offset:4096
    v_cvt_pk_bf16_f32 v52, v104, v105
    v_mfma_f32_16x16x32_bf16 v[200:203], a[168:171], v[56:59], v[200:203]
    v_exp_f32 v106, v106
    v_mfma_f32_16x16x32_bf16 v[232:235], a[168:171], v[60:63], v[232:235]
    buffer_load_dwordx4 v1, s[8:11], s19 offen offset:3072  lds
    v_mfma_f32_16x16x32_bf16 v[204:207], a[172:175], v[56:59], v[204:207]
    s_add_u32 m0, s16, 4096
    v_exp_f32 v107, v107
    v_mfma_f32_16x16x32_bf16 v[236:239], a[172:175], v[60:63], v[236:239]
    ds_read_b128 a[148:151], v18 offset:5120
    v_cvt_pk_bf16_f32 v53, v106, v107
    v_mfma_f32_16x16x32_bf16 v[208:211], a[176:179], v[56:59], v[208:211]
    s_sub_u32 s14, s14, 1
    v_exp_f32 v108, v108
    v_mfma_f32_16x16x32_bf16 v[240:243], a[176:179], v[60:63], v[240:243]
    buffer_load_dwordx4 v15, s[8:11], s19 offen offset:0  lds
    v_mfma_f32_16x16x32_bf16 v[212:215], a[180:183], v[56:59], v[212:215]
    v_exp_f32 v109, v109
    v_mfma_f32_16x16x32_bf16 v[244:247], a[180:183], v[60:63], v[244:247]
    ds_read_b128 a[152:155], v18 offset:6144
    v_cvt_pk_bf16_f32 v54, v108, v109
    v_mfma_f32_16x16x32_bf16 v[216:219], a[184:187], v[56:59], v[216:219]
    v_exp_f32 v110, v110
    v_mfma_f32_16x16x32_bf16 v[248:251], a[184:187], v[60:63], v[248:251]
    buffer_load_dwordx4 v15, s[8:11], s19 offen offset:1024  lds
    v_mfma_f32_16x16x32_bf16 v[220:223], a[188:191], v[56:59], v[220:223]
    v_exp_f32 v111, v111
    v_mfma_f32_16x16x32_bf16 v[252:255], a[188:191], v[60:63], v[252:255]
    ds_read_b128 a[156:159], v18 offset:7168
    v_cvt_pk_bf16_f32 v55, v110, v111
    s_cmp_lg_u32 s14, 0
    s_cbranch_scc1 L_t2_loop
L_t2_diag:
    s_waitcnt lgkmcnt(7)
    v_mfma_f32_16x16x32_bf16 v[96:99], a[128:131], a[192:195], v[80:83]
    s_waitcnt lgkmcnt(6)
    ds_read_b128 a[160:163], v19 offset:16384
    v_mov_b32 v24, v8
    v_mov_b32 v25, v9
    v_mfma_f32_16x16x32_bf16 v[96:99], a[132:135], a[196:199], v[96:99]
    s_waitcnt lgkmcnt(6)
    ds_read_b128 a[164:167], v19 offset:17408
    v_mov_b32 v26, v10
    v_mov_b32 v27, v11
    v_mfma_f32_16x16x32_bf16 v[96:99], a[136:139], a[200:203], v[96:99]
    s_waitcnt lgkmcnt(6)
    v_exp_f32 v112, v112
    v_add_u32 v11, 131072, v16
    v_mfma_f32_16x16x32_bf16 v[96:99], a[140:143], a[204:207], v[96:99]
    buffer_load_dwordx4 v15, s[8:11], s19 offen offset:2048  lds
    v_lshlrev_b32 v12, 6, v0
    v_mfma_f32_16x16x32_bf16 v[104:107], a[128:131], a[208:211], v[88:91]
    s_mov_b32 s71, 1327104
    v_exp_f32 v113, v113
    v_mfma_f32_16x16x32_bf16 v[104:107], a[132:135], a[212:215], v[104:107]
    ds_read_b128 a[168:171], v19 offset:18432
    v_cvt_pk_bf16_f32 v56, v112, v113
    v_mfma_f32_16x16x32_bf16 v[104:107], a[136:139], a[216:219], v[104:107]
    s_waitcnt lgkmcnt(6)
    v_exp_f32 v114, v114
    v_mfma_f32_16x16x32_bf16 v[104:107], a[140:143], a[220:223], v[104:107]
    buffer_load_dwordx4 v15, s[8:11], s19 offen offset:3072  lds
    v_mfma_f32_16x16x32_bf16 v[100:103], a[144:147], a[192:195], v[84:87]
    s_waitcnt lgkmcnt(5)
    s_xor_b32 s16, s16, 98304
    v_exp_f32 v115, v115
    v_mfma_f32_16x16x32_bf16 v[100:103], a[148:151], a[196:199], v[100:103]
    s_waitcnt lgkmcnt(4)
    ds_read_b128 a[172:175], v19 offset:19456
    v_cvt_pk_bf16_f32 v57, v114, v115
    v_mfma_f32_16x16x32_bf16 v[100:103], a[152:155], a[200:203], v[100:103]
    s_waitcnt lgkmcnt(4)
    v_exp_f32 v116, v116
    v_mfma_f32_16x16x32_bf16 v[100:103], a[156:159], a[204:207], v[100:103]
    buffer_load_dword v3, v12, s[8:11], s71 offen sc0 sc1
    v_bfe_u32 v13, v2, 1, 4
    v_mfma_f32_16x16x32_bf16 v[108:111], a[144:147], a[208:211], v[92:95]
    v_exp_f32 v117, v117
    v_lshlrev_b32 v13, 10, v13
    v_mfma_f32_16x16x32_bf16 v[108:111], a[148:151], a[212:215], v[108:111]
    ds_read_b128 a[176:179], v20 offset:20480
    v_cvt_pk_bf16_f32 v58, v116, v117
    v_and_b32 v14, 1, v2
    v_mfma_f32_16x16x32_bf16 v[108:111], a[152:155], a[216:219], v[108:111]
    v_exp_f32 v118, v118
    v_lshl_add_u32 v13, v14, 7, v13
    v_mfma_f32_16x16x32_bf16 v[108:111], a[156:159], a[220:223], v[108:111]
    s_lshl_b32 s74, s6, 2
    s_add_u32 s74, s74, s3
    s_lshl_b32 s74, s74, 14
    v_mfma_f32_16x16x32_bf16 v[32:35], v[28:31], v[48:51], v[32:35]
    v_exp_f32 v119, v119
    v_mfma_f32_16x16x32_bf16 v[36:39], v[28:31], v[52:55], v[36:39]
    s_waitcnt lgkmcnt(4)
    ds_read_b128 a[180:183], v20 offset:21504
    v_cvt_pk_bf16_f32 v59, v118, v119
    v_mfma_f32_16x16x32_bf16 v[128:131], a[160:163], v[48:51], v[128:131]
    s_waitcnt lgkmcnt(4)
    v_exp_f32 v120, v120
    v_mfma_f32_16x16x32_bf16 v[160:163], a[160:163], v[52:55], v[160:163]
    buffer_load_dword v14, v13, s[28:31], s74 offen
    v_mfma_f32_16x16x32_bf16 v[132:135], a[164:167], v[48:51], v[132:135]
    v_exp_f32 v121, v121
    v_mfma_f32_16x16x32_bf16 v[164:167], a[164:167], v[52:55], v[164:167]
    s_waitcnt lgkmcnt(3)
    ds_read_b128 a[184:187], v20 offset:22528
    v_cvt_pk_bf16_f32 v60, v120, v121
    v_mfma_f32_16x16x32_bf16 v[136:139], a[168:171], v[48:51], v[136:139]
    v_exp_f32 v122, v122
    v_mfma_f32_16x16x32_bf16 v[168:171], a[168:171], v[52:55], v[168:171]
    s_waitcnt lgkmcnt(3)
    v_add_f32 v80, 0, v22
    v_min_f32 v80, v80, v72
    v_mfma_f32_16x16x32_bf16 v[140:143], a[172:175], v[48:51], v[140:143]
    v_exp_f32 v123, v123
    v_mfma_f32_16x16x32_bf16 v[172:175], a[172:175], v[52:55], v[172:175]
    s_waitcnt lgkmcnt(2)
    ds_read_b128 a[188:191], v20 offset:23552
    v_cvt_pk_bf16_f32 v61, v122, v123
    v_mfma_f32_16x16x32_bf16 v[144:147], a[176:179], v[48:51], v[144:147]
    v_exp_f32 v124, v124
    v_mfma_f32_16x16x32_bf16 v[176:179], a[176:179], v[52:55], v[176:179]
    s_waitcnt lgkmcnt(2)
    v_add_f32 v81, 0xf1800000, v22
    v_min_f32 v81, v81, v73
    v_mfma_f32_16x16x32_bf16 v[148:151], a[180:183], v[48:51], v[148:151]
    v_exp_f32 v125, v125
    v_mfma_f32_16x16x32_bf16 v[180:183], a[180:183], v[52:55], v[180:183]
    s_waitcnt lgkmcnt(1)
    v_cvt_pk_bf16_f32 v62, v124, v125
    v_xor_b32 v19, 98304, v19
    v_mfma_f32_16x16x32_bf16 v[152:155], a[184:187], v[48:51], v[152:155]
    v_exp_f32 v126, v126
    v_mfma_f32_16x16x32_bf16 v[184:187], a[184:187], v[52:55], v[184:187]
    s_waitcnt lgkmcnt(0)
    v_xor_b32 v20, 98304, v20
    v_add_f32 v82, 0xf2000000, v22
    v_mfma_f32_16x16x32_bf16 v[156:159], a[188:191], v[48:51], v[156:159]
    v_exp_f32 v127, v127
    v_mfma_f32_16x16x32_bf16 v[188:191], a[188:191], v[52:55], v[188:191]
    v_cvt_pk_bf16_f32 v63, v126, v127
    v_min_f32 v82, v82, v74
    v_add_f32 v83, 0xf2400000, v22
    v_min_f32 v83, v83, v75
    v_add_f32 v84, 0xf3800000, v22
    v_min_f32 v84, v84, v72
    v_mfma_f32_16x16x32_bf16 v[112:115], a[128:131], a[224:227], v[72:75]
    v_exp_f32 v96, v96
    v_mfma_f32_16x16x32_bf16 v[112:115], a[132:135], a[228:231], v[112:115]
    v_add_f32 v85, 0xf3880000, v22
    v_min_f32 v85, v85, v73
    s_getpc_b64 s[100:101]
L_ct3:
    s_lshr_b32 s99, s2, 3
    s_lshl_b32 s99, s99, 2
    s_add_u32 s99, s99, s3
    s_mul_i32 s99, s99, 4
    v_min_u32 v13, 3, v2
    v_add_u32 v13, s99, v13
    v_lshlrev_b32 v13, 7, v13
    v_add_u32 v13, L_ct3-L_ct3, v13
    v_min_u32 v13, L_end-L_ct3, v13
    global_load_dword v13, v13, s[100:101]
    v_mfma_f32_16x16x32_bf16 v[112:115], a[136:139], a[232:235], v[112:115]
    v_exp_f32 v97, v97
    v_mfma_f32_16x16x32_bf16 v[112:115], a[140:143], a[236:239], v[112:115]
    v_cvt_pk_bf16_f32 v48, v96, v97
    v_add_f32 v86, 0xf3900000, v22
    v_mfma_f32_16x16x32_bf16 v[120:123], a[128:131], a[240:243], v[76:79]
    v_exp_f32 v98, v98
    v_mfma_f32_16x16x32_bf16 v[120:123], a[132:135], a[244:247], v[120:123]
    v_min_f32 v86, v86, v74
    v_add_f32 v87, 0xf3980000, v22
    v_mfma_f32_16x16x32_bf16 v[120:123], a[136:139], a[248:251], v[120:123]
    v_exp_f32 v99, v99
    v_mfma_f32_16x16x32_bf16 v[120:123], a[140:143], a[252:255], v[120:123]
    v_min_f32 v87, v87, v75
    v_add_f32 v88, 0x73800000, v22
    v_mfma_f32_16x16x32_bf16 v[116:119], a[144:147], a[224:227], v[72:75]
    v_exp_f32 v100, v100
    v_mfma_f32_16x16x32_bf16 v[116:119], a[148:151], a[228:231], v[116:119]
    ds_read_b128 a[128:131], v18 offset:16384
    v_cvt_pk_bf16_f32 v49, v98, v99
    v_mfma_f32_16x16x32_bf16 v[116:119], a[152:155], a[232:235], v[116:119]
    v_exp_f32 v101, v101
    v_mfma_f32_16x16x32_bf16 v[116:119], a[156:159], a[236:239], v[116:119]
    ds_read_b128 a[132:135], v18 offset:17408
    v_cvt_pk_bf16_f32 v50, v100, v101
    v_mfma_f32_16x16x32_bf16 v[124:127], a[144:147], a[240:243], v[76:79]
    v_exp_f32 v102, v102
    v_mfma_f32_16x16x32_bf16 v[124:127], a[148:151], a[244:247], v[124:127]
    ds_read_b128 a[136:139], v18 offset:18432
    v_min_f32 v88, v88, v76
    v_mfma_f32_16x16x32_bf16 v[124:127], a[152:155], a[248:251], v[124:127]
    v_exp_f32 v103, v103
    v_mfma_f32_16x16x32_bf16 v[124:127], a[156:159], a[252:255], v[124:127]
    ds_read_b128 a[140:143], v18 offset:19456
    v_cvt_pk_bf16_f32 v51, v102, v103
    v_mfma_f32_16x16x32_bf16 v[40:43], v[28:31], v[56:59], v[40:43]
    v_exp_f32 v104, v104
    v_mfma_f32_16x16x32_bf16 v[44:47], v[28:31], v[60:63], v[44:47]
    ds_read_b128 a[144:147], v18 offset:20480
    v_add_f32 v89, 0x73700000, v22
    v_mfma_f32_16x16x32_bf16 v[192:195], a[160:163], v[56:59], v[192:195]
    v_exp_f32 v105, v105
    v_mfma_f32_16x16x32_bf16 v[224:227], a[160:163], v[60:63], v[224:227]
    ds_read_b128 a[148:151], v18 offset:21504
    v_cvt_pk_bf16_f32 v52, v104, v105
    v_mfma_f32_16x16x32_bf16 v[196:199], a[164:167], v[56:59], v[196:199]
    v_exp_f32 v106, v106
    v_mfma_f32_16x16x32_bf16 v[228:231], a[164:167], v[60:63], v[228:231]
    ds_read_b128 a[152:155], v18 offset:22528
    v_min_f32 v89, v89, v77
    v_mfma_f32_16x16x32_bf16 v[200:203], a[168:171], v[56:59], v[200:203]
    v_exp_f32 v107, v107
    v_mfma_f32_16x16x32_bf16 v[232:235], a[168:171], v[60:63], v[232:235]
    ds_read_b128 a[156:159], v18 offset:23552
    v_cvt_pk_bf16_f32 v53, v106, v107
    v_mfma_f32_16x16x32_bf16 v[204:207], a[172:175], v[56:59], v[204:207]
    v_exp_f32 v108, v108
    v_mfma_f32_16x16x32_bf16 v[236:239], a[172:175], v[60:63], v[236:239]
    v_add_f32 v90, 0x73600000, v22
    v_min_f32 v90, v90, v78
    v_mfma_f32_16x16x32_bf16 v[208:211], a[176:179], v[56:59], v[208:211]
    v_exp_f32 v109, v109
    v_mfma_f32_16x16x32_bf16 v[240:243], a[176:179], v[60:63], v[240:243]
    v_cvt_pk_bf16_f32 v54, v108, v109
    v_xor_b32 v18, 196608, v18
    v_mfma_f32_16x16x32_bf16 v[212:215], a[180:183], v[56:59], v[212:215]
    v_exp_f32 v110, v110
    v_mfma_f32_16x16x32_bf16 v[244:247], a[180:183], v[60:63], v[244:247]
    v_add_f32 v91, 0x73500000, v22
    v_min_f32 v91, v91, v79
    v_mfma_f32_16x16x32_bf16 v[216:219], a[184:187], v[56:59], v[216:219]
    v_exp_f32 v111, v111
    v_mfma_f32_16x16x32_bf16 v[248:251], a[184:187], v[60:63], v[248:251]
    v_cvt_pk_bf16_f32 v55, v110, v111
    v_add_f32 v92, 0, v22
    s_waitcnt vmcnt(2)
    v_cmp_ne_u32 vcc, 0, v3
    s_cmp_eq_u64 vcc, -1
    s_cbranch_scc0 L_F_slow_11
L_F_ok_12:
    v_mfma_f32_16x16x32_bf16 v[220:223], a[188:191], v[56:59], v[220:223]
    v_min_f32 v92, v92, v76
    v_add_f32 v93, 0xf1800000, v22
    v_mfma_f32_16x16x32_bf16 v[252:255], a[188:191], v[60:63], v[252:255]
    v_min_f32 v93, v93, v77
    v_add_f32 v94, 0xf2000000, v22
    v_min_f32 v94, v94, v78
    v_add_f32 v95, 0xf2400000, v22
    v_min_f32 v95, v95, v79
    s_waitcnt lgkmcnt(0)
    s_barrier
    v_mfma_f32_16x16x32_bf16 v[96:99], a[128:131], a[224:227], v[80:83]
    s_xor_b32 s100, s62, 8192
    s_xor_b32 s98, s65, 262144
    ds_read_b128 a[176:179], v20 offset:4096
    s_waitcnt vmcnt(0)
    v_lshrrev_b32 v13, 1, v1
    v_mfma_f32_16x16x32_bf16 v[96:99], a[132:135], a[228:231], v[96:99]
    s_add_u32 m0, s62, 65536
    ds_read_b128 a[180:183], v20 offset:5120
    v_add_u32 v12, s100, v13
    v_mfma_f32_16x16x32_bf16 v[96:99], a[136:139], a[232:235], v[96:99]
    buffer_load_dwordx4 v24, s[28:31], s98 offen offset:0   lds
    v_exp_f32 v112, v112
    v_mfma_f32_16x16x32_bf16 v[96:99], a[140:143], a[236:239], v[96:99]
    v_exp_f32 v113, v113
    v_mfma_f32_16x16x32_bf16 v[100:103], a[144:147], a[224:227], v[84:87]
    ds_read_b128 a[184:187], v20 offset:6144
    v_cvt_pk_bf16_f32 v56, v112, v113
    v_mfma_f32_16x16x32_bf16 v[100:103], a[148:151], a[228:231], v[100:103]
    v_exp_f32 v114, v114
    v_mfma_f32_16x16x32_bf16 v[100:103], a[152:155], a[232:235], v[100:103]
    buffer_load_dwordx4 v25, s[28:31], s98 offen offset:1024   lds
    v_exp_f32 v115, v115
    v_mfma_f32_16x16x32_bf16 v[100:103], a[156:159], a[236:239], v[100:103]
    ds_read_b128 a[188:191], v20 offset:7168
    v_cvt_pk_bf16_f32 v57, v114, v115
    v_mfma_f32_16x16x32_bf16 v[104:107], a[128:131], a[240:243], v[88:91]
    v_exp_f32 v116, v116
    v_mfma_f32_16x16x32_bf16 v[104:107], a[132:135], a[244:247], v[104:107]
    v_exp_f32 v117, v117
    v_mfma_f32_16x16x32_bf16 v[104:107], a[136:139], a[248:251], v[104:107]
    ds_read_b128 a[160:163], v19 offset:0
    v_cvt_pk_bf16_f32 v58, v116, v117
    v_mfma_f32_16x16x32_bf16 v[104:107], a[140:143], a[252:255], v[104:107]
    buffer_load_dwordx4 v26, s[28:31], s98 offen offset:2048   lds
    v_exp_f32 v118, v118
    v_mfma_f32_16x16x32_bf16 v[108:111], a[144:147], a[240:243], v[92:95]
    v_exp_f32 v119, v119
    v_mfma_f32_16x16x32_bf16 v[108:111], a[148:151], a[244:247], v[108:111]
    ds_read_b128 a[164:167], v19 offset:1024
    v_cvt_pk_bf16_f32 v59, v118, v119
    v_mfma_f32_16x16x32_bf16 v[108:111], a[152:155], a[248:251], v[108:111]
    v_exp_f32 v120, v120
    v_mfma_f32_16x16x32_bf16 v[108:111], a[156:159], a[252:255], v[108:111]
    buffer_load_dwordx4 v27, s[28:31], s98 offen offset:3072   lds
    v_exp_f32 v121, v121
    v_mfma_f32_16x16x32_bf16 v[32:35], v[28:31], v[48:51], v[32:35]
    s_add_u32 m0, s62, 69632
    ds_read_b128 a[168:171], v19 offset:2048
    v_cvt_pk_bf16_f32 v60, v120, v121
    v_mfma_f32_16x16x32_bf16 v[36:39], v[28:31], v[52:55], v[36:39]
    s_waitcnt lgkmcnt(6)
    s_xor_b32 s98, s65, 294912
    v_exp_f32 v122, v122
    v_mfma_f32_16x16x32_bf16 v[144:147], a[176:179], v[48:51], v[144:147]
    v_exp_f32 v123, v123
    v_mfma_f32_16x16x32_bf16 v[176:179], a[176:179], v[52:55], v[176:179]
    s_waitcnt lgkmcnt(5)
    ds_read_b128 a[172:175], v19 offset:3072
    v_cvt_pk_bf16_f32 v61, v122, v123
    v_mfma_f32_16x16x32_bf16 v[148:151], a[180:183], v[48:51], v[148:151]
    buffer_load_dwordx4 v24, s[28:31], s98 offen offset:0   lds
    v_exp_f32 v124, v124
    v_mfma_f32_16x16x32_bf16 v[180:183], a[180:183], v[52:55], v[180:183]
    s_waitcnt lgkmcnt(5)
    v_exp_f32 v125, v125
    v_mfma_f32_16x16x32_bf16 v[152:155], a[184:187], v[48:51], v[152:155]
    s_waitcnt lgkmcnt(4)
    v_exp_f32 v126, v126
    v_mfma_f32_16x16x32_bf16 v[184:187], a[184:187], v[52:55], v[184:187]
    buffer_load_dwordx4 v25, s[28:31], s98 offen offset:1024   lds
    v_exp_f32 v127, v127
    v_mfma_f32_16x16x32_bf16 v[156:159], a[188:191], v[48:51], v[156:159]
    ds_write_b128 v11, v[144:147] offset:0
    v_cvt_pk_bf16_f32 v62, v124, v125
    v_mfma_f32_16x16x32_bf16 v[188:191], a[188:191], v[52:55], v[188:191]
    s_waitcnt lgkmcnt(4)
    v_exp_f32 v96, v96
    v_mfma_f32_16x16x32_bf16 v[128:131], a[160:163], v[48:51], v[128:131]
    v_exp_f32 v97, v97
    v_mfma_f32_16x16x32_bf16 v[160:163], a[160:163], v[52:55], v[160:163]
    s_waitcnt lgkmcnt(3)
    ds_write_b128 v11, v[176:179] offset:1024
    v_cvt_pk_bf16_f32 v63, v126, v127
    v_mfma_f32_16x16x32_bf16 v[132:135], a[164:167], v[48:51], v[132:135]
    s_waitcnt lgkmcnt(3)
    v_exp_f32 v98, v98
    v_mfma_f32_16x16x32_bf16 v[164:167], a[164:167], v[52:55], v[164:167]
    buffer_load_dwordx4 v26, s[28:31], s98 offen offset:2048   lds
    v_exp_f32 v99, v99
    v_mfma_f32_16x16x32_bf16 v[136:139], a[168:171], v[48:51], v[136:139]
    ds_write_b128 v11, v[148:151] offset:2048
    v_mfma_f32_16x16x32_bf16 v[168:171], a[168:171], v[52:55], v[168:171]
    s_waitcnt lgkmcnt(3)
    v_exp_f32 v100, v100
    v_mfma_f32_16x16x32_bf16 v[140:143], a[172:175], v[48:51], v[140:143]
    v_exp_f32 v101, v101
    v_mfma_f32_16x16x32_bf16 v[172:175], a[172:175], v[52:55], v[172:175]
    ds_write_b128 v11, v[180:183] offset:3072
    v_mov_b32 v33, v36
    v_mfma_f32_16x16x32_bf16 v[40:43], v[28:31], v[56:59], v[40:43]
    buffer_load_dwordx4 v27, s[28:31], s98 offen offset:3072   lds
    v_exp_f32 v102, v102
    v_mfma_f32_16x16x32_bf16 v[44:47], v[28:31], v[60:63], v[44:47]
    v_exp_f32 v103, v103
    v_mfma_f32_16x16x32_bf16 v[208:211], a[176:179], v[56:59], v[208:211]
    ds_write_b128 v11, v[152:155] offset:4096
    v_cvt_pk_bf16_f32 v48, v96, v97
    v_mfma_f32_16x16x32_bf16 v[240:243], a[176:179], v[60:63], v[240:243]
    ds_read_b128 a[176:179], v20 offset:20480
    v_exp_f32 v104, v104
    v_mfma_f32_16x16x32_bf16 v[212:215], a[180:183], v[56:59], v[212:215]
    v_exp_f32 v105, v105
    v_mfma_f32_16x16x32_bf16 v[244:247], a[180:183], v[60:63], v[244:247]
    ds_read_b128 a[180:183], v20 offset:21504
    v_exp_f32 v106, v106
    v_mfma_f32_16x16x32_bf16 v[216:219], a[184:187], v[56:59], v[216:219]
    ds_write_b128 v11, v[184:187] offset:5120
    v_cvt_pk_bf16_f32 v49, v98, v99
    v_mfma_f32_16x16x32_bf16 v[248:251], a[184:187], v[60:63], v[248:251]
    ds_read_b128 a[184:187], v20 offset:22528
    v_exp_f32 v107, v107
    v_mfma_f32_16x16x32_bf16 v[220:223], a[188:191], v[56:59], v[220:223]
    v_exp_f32 v108, v108
    v_mfma_f32_16x16x32_bf16 v[252:255], a[188:191], v[60:63], v[252:255]
    ds_read_b128 a[188:191], v20 offset:23552
    v_exp_f32 v109, v109
    v_mfma_f32_16x16x32_bf16 v[192:195], a[160:163], v[56:59], v[192:195]
    ds_write_b128 v11, v[156:159] offset:6144
    v_cvt_pk_bf16_f32 v50, v100, v101
    v_mfma_f32_16x16x32_bf16 v[224:227], a[160:163], v[60:63], v[224:227]
    ds_read_b128 a[160:163], v19 offset:16384
    v_exp_f32 v110, v110
    v_mfma_f32_16x16x32_bf16 v[196:199], a[164:167], v[56:59], v[196:199]
    v_exp_f32 v111, v111
    v_mfma_f32_16x16x32_bf16 v[228:231], a[164:167], v[60:63], v[228:231]
    ds_read_b128 a[164:167], v19 offset:17408
    v_cvt_pk_bf16_f32 v51, v102, v103
    v_mfma_f32_16x16x32_bf16 v[200:203], a[168:171], v[56:59], v[200:203]
    ds_write_b128 v11, v[188:191] offset:7168
    v_cvt_pk_bf16_f32 v52, v104, v105
    v_mfma_f32_16x16x32_bf16 v[232:235], a[168:171], v[60:63], v[232:235]
    ds_read_b128 a[168:171], v19 offset:18432
    v_cvt_pk_bf16_f32 v53, v106, v107
    v_mfma_f32_16x16x32_bf16 v[204:207], a[172:175], v[56:59], v[204:207]
    v_cvt_pk_bf16_f32 v54, v108, v109
    v_cvt_pk_bf16_f32 v55, v110, v111
    v_mfma_f32_16x16x32_bf16 v[236:239], a[172:175], v[60:63], v[236:239]
    ds_read_b128 a[172:175], v19 offset:19456
    ds_write_b64 v12, v[32:33]
    s_add_u32 s101, s62, 98304
    v_xor_b32 v12, 8192, v12
    v_add_u32 v9, s101, v1
    v_xor_b32 v8, 8192, v11
    v_xor_b32 v10, 8192, v9
L_t2_join:
    v_xor_b32 v19, 98304, v19
    v_xor_b32 v20, 98304, v20
    s_waitcnt lgkmcnt(0)
    s_barrier
    v_mfma_f32_16x16x32_bf16 v[40:43], v[28:31], v[48:51], v[40:43]
    s_lshl_b32 s100, s61, 20
    s_add_u32 s101, s100, s21
    ds_read_b64 v[120:121], v12
    v_mfma_f32_16x16x32_bf16 v[44:47], v[28:31], v[52:55], v[44:47]
    s_add_u32 s100, s100, s20
    ds_read_b128 v[144:147], v8 offset:0
    v_lshrrev_b32 v11, 4, v2
    v_mfma_f32_16x16x32_bf16 v[208:211], a[176:179], v[48:51], v[208:211]
    ds_read_b128 v[176:179], v8 offset:1024
    v_lshrrev_b32 v13, 2, v1
    v_mfma_f32_16x16x32_bf16 v[240:243], a[176:179], v[52:55], v[240:243]
    ds_read_b128 v[148:151], v8 offset:2048
    v_add_u32 v13, 131072, v13
    v_mfma_f32_16x16x32_bf16 v[212:215], a[180:183], v[48:51], v[212:215]
    s_xor_b32 s99, s62, 8192
    ds_read_b128 v[180:183], v8 offset:3072
    v_add_u32 v14, s99, v13
    v_mfma_f32_16x16x32_bf16 v[244:247], a[180:183], v[52:55], v[244:247]
    ds_read_b128 v[152:155], v8 offset:4096
    v_cmp_eq_u32 vcc, 1, v11
    v_mfma_f32_16x16x32_bf16 v[216:219], a[184:187], v[48:51], v[216:219]
    ds_read_b128 v[184:187], v8 offset:5120
    s_waitcnt lgkmcnt(6)
    v_add_f32 v112, v120, v32
    v_mfma_f32_16x16x32_bf16 v[248:251], a[184:187], v[52:55], v[248:251]
    ds_read_b128 v[156:159], v8 offset:6144
    v_add_f32 v114, v121, v36
    v_mfma_f32_16x16x32_bf16 v[220:223], a[188:191], v[48:51], v[220:223]
    ds_read_b128 v[188:191], v8 offset:7168
    v_cndmask_b32 v12, v32, v36, vcc
    v_mfma_f32_16x16x32_bf16 v[252:255], a[188:191], v[52:55], v[252:255]
    v_rcp_f32 v112, v112
    v_mfma_f32_16x16x32_bf16 v[192:195], a[160:163], v[48:51], v[192:195]
    v_rcp_f32 v114, v114
    v_mfma_f32_16x16x32_bf16 v[224:227], a[160:163], v[52:55], v[224:227]
    v_cmp_eq_u32 vcc, 2, v11
    v_cmp_eq_u32 s[96:97], 3, v11
    v_mfma_f32_16x16x32_bf16 v[196:199], a[164:167], v[48:51], v[196:199]
    ds_write_b128 v9, v[208:211] offset:0
    v_mfma_f32_16x16x32_bf16 v[228:231], a[164:167], v[52:55], v[228:231]
    v_mfma_f32_16x16x32_bf16 v[200:203], a[168:171], v[48:51], v[200:203]
    ds_write_b128 v9, v[240:243] offset:1024
    v_mfma_f32_16x16x32_bf16 v[232:235], a[168:171], v[52:55], v[232:235]
    v_mfma_f32_16x16x32_bf16 v[204:207], a[172:175], v[48:51], v[204:207]
    ds_write_b128 v9, v[212:215] offset:2048
    v_mfma_f32_16x16x32_bf16 v[236:239], a[172:175], v[52:55], v[236:239]
    v_cndmask_b32 v12, v12, v40, vcc
    v_cndmask_b32 v12, v12, v44, s[96:97]
    ds_write_b128 v9, v[244:247] offset:3072
    s_waitcnt lgkmcnt(11)
    v_pk_add_f32 v[128:129], v[128:129], v[144:145]
    v_pk_add_f32 v[130:131], v[130:131], v[146:147]
    s_waitcnt lgkmcnt(9)
    v_pk_add_f32 v[132:133], v[132:133], v[148:149]
    v_pk_add_f32 v[134:135], v[134:135], v[150:151]
    v_pk_mul_f32 v[128:129], v[128:129], v[112:113] op_sel_hi:[1,0]
    v_pk_mul_f32 v[130:131], v[130:131], v[112:113] op_sel_hi:[1,0]
    v_pk_mul_f32 v[132:133], v[132:133], v[112:113] op_sel_hi:[1,0]
    v_pk_mul_f32 v[134:135], v[134:135], v[112:113] op_sel_hi:[1,0]
    v_cvt_pk_bf16_f32 v128, v128, v129
    v_cvt_pk_bf16_f32 v129, v130, v131
    v_cvt_pk_bf16_f32 v130, v132, v133
    v_lshrrev_b32 v58, 2, v2
    v_and_b32 v57, 3, v2
    ds_write_b128 v9, v[216:219] offset:4096
    v_cvt_pk_bf16_f32 v131, v134, v135
    buffer_store_dwordx4 v[128:131], v1, s[8:11], s100 offen offset:0 sc0 sc1
    s_waitcnt lgkmcnt(8)
    v_pk_add_f32 v[136:137], v[136:137], v[152:153]
    v_pk_add_f32 v[138:139], v[138:139], v[154:155]
    s_waitcnt lgkmcnt(6)
    v_pk_add_f32 v[140:141], v[140:141], v[156:157]
    v_pk_add_f32 v[142:143], v[142:143], v[158:159]
    v_pk_mul_f32 v[136:137], v[136:137], v[112:113] op_sel_hi:[1,0]
    v_pk_mul_f32 v[138:139], v[138:139], v[112:113] op_sel_hi:[1,0]
    v_pk_mul_f32 v[140:141], v[140:141], v[112:113] op_sel_hi:[1,0]
    v_pk_mul_f32 v[142:143], v[142:143], v[112:113] op_sel_hi:[1,0]
    v_cvt_pk_bf16_f32 v136, v136, v137
    v_lshlrev_b32 v56, 7, v58
    v_lshl_add_u32 v56, v57, 3, v56
    v_bfe_u32 v57, v2, 3, 2
    ds_write_b128 v9, v[248:251] offset:5120
    v_cvt_pk_bf16_f32 v137, v138, v139
    v_cvt_pk_bf16_f32 v138, v140, v141
    v_cvt_pk_bf16_f32 v139, v142, v143
    buffer_store_dwordx4 v[136:139], v1, s[8:11], s100 offen offset:1024 sc0 sc1
    v_pk_add_f32 v[160:161], v[160:161], v[176:177]
    v_pk_add_f32 v[162:163], v[162:163], v[178:179]
    v_pk_add_f32 v[164:165], v[164:165], v[180:181]
    v_pk_add_f32 v[166:167], v[166:167], v[182:183]
    v_pk_mul_f32 v[160:161], v[160:161], v[114:115] op_sel_hi:[1,0]
    v_pk_mul_f32 v[162:163], v[162:163], v[114:115] op_sel_hi:[1,0]
    v_pk_mul_f32 v[164:165], v[164:165], v[114:115] op_sel_hi:[1,0]
    v_lshl_add_u32 v56, v57, 5, v56
    v_xor_b32 v57, 32, v56
    ds_write_b128 v9, v[220:223] offset:6144
    v_pk_mul_f32 v[166:167], v[166:167], v[114:115] op_sel_hi:[1,0]
    v_cvt_pk_bf16_f32 v160, v160, v161
    v_cvt_pk_bf16_f32 v161, v162, v163
    v_cvt_pk_bf16_f32 v162, v164, v165
    v_cvt_pk_bf16_f32 v163, v166, v167
    buffer_store_dwordx4 v[160:163], v15, s[8:11], s100 offen offset:0 sc0 sc1
    v_pk_add_f32 v[168:169], v[168:169], v[184:185]
    v_pk_add_f32 v[170:171], v[170:171], v[186:187]
    s_waitcnt lgkmcnt(7)
    v_pk_add_f32 v[172:173], v[172:173], v[188:189]
    v_pk_add_f32 v[174:175], v[174:175], v[190:191]
    v_pk_mul_f32 v[168:169], v[168:169], v[114:115] op_sel_hi:[1,0]
    v_xor_b32 v58, 64, v56
    v_xor_b32 v59, 96, v56
    v_add_u32 v60, 65536, v56
    ds_write_b128 v9, v[252:255] offset:7168
    v_pk_mul_f32 v[170:171], v[170:171], v[114:115] op_sel_hi:[1,0]
    v_pk_mul_f32 v[172:173], v[172:173], v[114:115] op_sel_hi:[1,0]
    v_pk_mul_f32 v[174:175], v[174:175], v[114:115] op_sel_hi:[1,0]
    v_cvt_pk_bf16_f32 v168, v168, v169
    v_cvt_pk_bf16_f32 v169, v170, v171
    v_cvt_pk_bf16_f32 v170, v172, v173
    v_cvt_pk_bf16_f32 v171, v174, v175
    buffer_store_dwordx4 v[168:171], v15, s[8:11], s100 offen offset:1024 sc0 sc1
    v_add_u32 v61, 65536, v57
    v_add_u32 v62, 65536, v58
    v_add_u32 v63, 65536, v59
    ds_write_b32 v14, v12
    v_and_b32 v14, 4294967103, v13
    v_add_u32 v14, s62, v14
    s_waitcnt lgkmcnt(0)
    s_barrier
    ds_read_b32 v116, v14 offset:128
    ds_read_b32 v118, v14 offset:192
    ds_read_b128 v[208:211], v10 offset:0
    ds_read_b128 v[212:215], v10 offset:2048
    ds_read_b128 v[216:219], v10 offset:4096
    ds_read_b128 v[220:223], v10 offset:6144
    ds_read_b128 v[240:243], v10 offset:1024
    ds_read_b128 v[244:247], v10 offset:3072
    ds_read_b128 v[248:251], v10 offset:5120
    ds_read_b128 v[252:255], v10 offset:7168
    ds_read_b32 v120, v13 offset:0
    ds_read_b32 v121, v13 offset:8192
    ds_read_b32 v122, v13 offset:16384
    ds_read_b32 v123, v13 offset:24576
    s_waitcnt lgkmcnt(13)
    v_add_f32 v116, v116, v40
    s_waitcnt lgkmcnt(12)
    v_add_f32 v118, v118, v44
    v_rcp_f32 v116, v116
    v_rcp_f32 v118, v118
    s_waitcnt lgkmcnt(11)
    v_pk_add_f32 v[192:193], v[192:193], v[208:209]
    v_pk_add_f32 v[194:195], v[194:195], v[210:211]
    s_waitcnt lgkmcnt(10)
    v_pk_add_f32 v[196:197], v[196:197], v[212:213]
    v_pk_add_f32 v[198:199], v[198:199], v[214:215]
    v_pk_mul_f32 v[192:193], v[192:193], v[116:117] op_sel_hi:[1,0]
    v_pk_mul_f32 v[194:195], v[194:195], v[116:117] op_sel_hi:[1,0]
    v_pk_mul_f32 v[196:197], v[196:197], v[116:117] op_sel_hi:[1,0]
    v_pk_mul_f32 v[198:199], v[198:199], v[116:117] op_sel_hi:[1,0]
    v_cvt_pk_bf16_f32 v192, v192, v193
    v_cvt_pk_bf16_f32 v193, v194, v195
    v_cvt_pk_bf16_f32 v194, v196, v197
    v_cvt_pk_bf16_f32 v195, v198, v199
    buffer_store_dwordx4 v[192:195], v1, s[8:11], s101 offen offset:0 sc0 sc1
    s_waitcnt lgkmcnt(9)
    v_pk_add_f32 v[200:201], v[200:201], v[216:217]
    v_pk_add_f32 v[202:203], v[202:203], v[218:219]
    s_waitcnt lgkmcnt(8)
    v_pk_add_f32 v[204:205], v[204:205], v[220:221]
    v_pk_add_f32 v[206:207], v[206:207], v[222:223]
    v_pk_mul_f32 v[200:201], v[200:201], v[116:117] op_sel_hi:[1,0]
    v_pk_mul_f32 v[202:203], v[202:203], v[116:117] op_sel_hi:[1,0]
    v_pk_mul_f32 v[204:205], v[204:205], v[116:117] op_sel_hi:[1,0]
    v_pk_mul_f32 v[206:207], v[206:207], v[116:117] op_sel_hi:[1,0]
    v_cvt_pk_bf16_f32 v200, v200, v201
    v_cvt_pk_bf16_f32 v201, v202, v203
    v_cvt_pk_bf16_f32 v202, v204, v205
    v_cvt_pk_bf16_f32 v203, v206, v207
    buffer_store_dwordx4 v[200:203], v1, s[8:11], s101 offen offset:1024 sc0 sc1
    s_waitcnt lgkmcnt(2)
    v_add_f32 v120, v120, v121
    s_waitcnt lgkmcnt(0)
    v_add_f32 v122, v122, v123
    v_min_f32 v124, v120, v122
    v_add_f32 v120, v120, v122
    v_cmp_le_f32 vcc, 0x1f800000, v124
    s_mov_b64 s[96:97], vcc
    v_cmp_ge_f32 vcc, 0x67800000, v120
    s_and_b64 s[96:97], s[96:97], vcc
    s_cmp_eq_u64 s[96:97], -1
    s_cselect_b32 s96, s25, 1
    s_cmp_lg_u32 s96, 0
    s_cbranch_scc1 L_t2_redo
L_t2_safe:
    v_pk_add_f32 v[224:225], v[224:225], v[240:241]
    v_pk_add_f32 v[226:227], v[226:227], v[242:243]
    v_pk_add_f32 v[228:229], v[228:229], v[244:245]
    v_pk_add_f32 v[230:231], v[230:231], v[246:247]
    v_pk_mul_f32 v[224:225], v[224:225], v[118:119] op_sel_hi:[1,0]
    v_pk_mul_f32 v[226:227], v[226:227], v[118:119] op_sel_hi:[1,0]
    v_pk_mul_f32 v[228:229], v[228:229], v[118:119] op_sel_hi:[1,0]
    v_pk_mul_f32 v[230:231], v[230:231], v[118:119] op_sel_hi:[1,0]
    v_cvt_pk_bf16_f32 v224, v224, v225
    v_cvt_pk_bf16_f32 v225, v226, v227
    v_cvt_pk_bf16_f32 v226, v228, v229
    v_cvt_pk_bf16_f32 v227, v230, v231
    buffer_store_dwordx4 v[224:227], v15, s[8:11], s101 offen offset:0 sc0 sc1
    ds_read_b64_tr_b16 a[192:193], v56 offset:32768
    ds_read_b64_tr_b16 a[194:195], v56 offset:34816
    ds_read_b64_tr_b16 a[196:197], v56 offset:36864
    ds_read_b64_tr_b16 a[198:199], v56 offset:38912
    ds_read_b64_tr_b16 a[200:201], v57 offset:32768
    ds_read_b64_tr_b16 a[202:203], v57 offset:34816
    ds_read_b64_tr_b16 a[204:205], v57 offset:36864
    ds_read_b64_tr_b16 a[206:207], v57 offset:38912
    v_pk_add_f32 v[232:233], v[232:233], v[248:249]
    v_pk_add_f32 v[234:235], v[234:235], v[250:251]
    v_pk_add_f32 v[236:237], v[236:237], v[252:253]
    v_pk_add_f32 v[238:239], v[238:239], v[254:255]
    v_pk_mul_f32 v[232:233], v[232:233], v[118:119] op_sel_hi:[1,0]
    v_pk_mul_f32 v[234:235], v[234:235], v[118:119] op_sel_hi:[1,0]
    v_pk_mul_f32 v[236:237], v[236:237], v[118:119] op_sel_hi:[1,0]
    v_pk_mul_f32 v[238:239], v[238:239], v[118:119] op_sel_hi:[1,0]
    v_cvt_pk_bf16_f32 v232, v232, v233
    v_cvt_pk_bf16_f32 v233, v234, v235
    v_cvt_pk_bf16_f32 v234, v236, v237
    v_cvt_pk_bf16_f32 v235, v238, v239
    buffer_store_dwordx4 v[232:235], v15, s[8:11], s101 offen offset:1024 sc0 sc1
    ds_read_b64_tr_b16 a[208:209], v56 offset:40960
    ds_read_b64_tr_b16 a[210:211], v56 offset:43008
    ds_read_b64_tr_b16 a[212:213], v56 offset:45056
    ds_read_b64_tr_b16 a[214:215], v56 offset:47104
    ds_read_b64_tr_b16 a[216:217], v57 offset:40960
    ds_read_b64_tr_b16 a[218:219], v57 offset:43008
    ds_read_b64_tr_b16 a[220:221], v57 offset:45056
    ds_read_b64_tr_b16 a[222:223], v57 offset:47104
    s_waitcnt lgkmcnt(14)
    v_mfma_f32_16x16x32_bf16 v[64:67], a[192:195], a[64:67], 0
    s_waitcnt lgkmcnt(12)
    s_add_u32 m0, s62, 0
    ds_read_b64_tr_b16 a[224:225], v56 offset:49152
    v_mfma_f32_16x16x32_bf16 v[64:67], a[196:199], a[68:71], v[64:67]
    s_xor_b32 s98, s65, 128
    ds_read_b64_tr_b16 a[226:227], v56 offset:51200
    v_mfma_f32_16x16x32_bf16 v[72:75], a[192:195], a[80:83], 0
    buffer_load_dwordx4 v24, s[28:31], s98 offen offset:0   lds
    v_mfma_f32_16x16x32_bf16 v[72:75], a[196:199], a[84:87], v[72:75]
    s_waitcnt lgkmcnt(12)
    ds_read_b64_tr_b16 a[228:229], v56 offset:53248
    v_mfma_f32_16x16x32_bf16 v[68:71], a[200:203], a[64:67], 0
    s_waitcnt lgkmcnt(11)
    ds_read_b64_tr_b16 a[230:231], v56 offset:55296
    v_mfma_f32_16x16x32_bf16 v[68:71], a[204:207], a[68:71], v[68:71]
    s_add_u32 s22, s22, 65536
    ds_read_b64_tr_b16 a[232:233], v57 offset:49152
    v_mfma_f32_16x16x32_bf16 v[76:79], a[200:203], a[80:83], 0
    buffer_load_dwordx4 v25, s[28:31], s98 offen offset:1024   lds
    v_mfma_f32_16x16x32_bf16 v[76:79], a[204:207], a[84:87], v[76:79]
    s_waitcnt lgkmcnt(11)
    s_add_u32 s23, s23, 65536
    ds_read_b64_tr_b16 a[234:235], v57 offset:51200
    v_mfma_f32_16x16x32_bf16 v[64:67], a[208:211], a[72:75], v[64:67]
    s_waitcnt lgkmcnt(10)
    s_lshl_b32 s24, s61, 2
    ds_read_b64_tr_b16 a[236:237], v57 offset:53248
    v_mfma_f32_16x16x32_bf16 v[64:67], a[212:215], a[76:79], v[64:67]
    s_add_u32 s24, s24, s3
    ds_read_b64_tr_b16 a[238:239], v57 offset:55296
    v_mfma_f32_16x16x32_bf16 v[72:75], a[208:211], a[88:91], v[72:75]
    buffer_load_dwordx4 v26, s[28:31], s98 offen offset:2048   lds
    v_mfma_f32_16x16x32_bf16 v[72:75], a[212:215], a[92:95], v[72:75]
    s_waitcnt lgkmcnt(6)
    s_lshl_b32 s24, s24, 3
    ds_read_b64_tr_b16 a[240:241], v56 offset:57344
    v_mfma_f32_16x16x32_bf16 v[68:71], a[216:219], a[72:75], v[68:71]
    s_add_u32 s24, s24, s4
    ds_read_b64_tr_b16 a[242:243], v56 offset:59392
    v_mfma_f32_16x16x32_bf16 v[68:71], a[220:223], a[76:79], v[68:71]
    s_lshl_b32 s24, s24, 2
    ds_read_b64_tr_b16 a[244:245], v56 offset:61440
    v_mfma_f32_16x16x32_bf16 v[76:79], a[216:219], a[88:91], v[76:79]
    buffer_load_dwordx4 v27, s[28:31], s98 offen offset:3072   lds
    v_mfma_f32_16x16x32_bf16 v[76:79], a[220:223], a[92:95], v[76:79]
    s_add_u32 m0, s62, 4096
    ds_read_b64_tr_b16 a[246:247], v56 offset:63488
    v_mfma_f32_16x16x32_bf16 v[64:67], a[224:227], a[96:99], v[64:67]
    s_waitcnt lgkmcnt(7)
    s_xor_b32 s98, s65, 32896
    ds_read_b64_tr_b16 a[248:249], v57 offset:57344
    v_mfma_f32_16x16x32_bf16 v[64:67], a[228:231], a[100:103], v[64:67]
    s_add_u32 s24, s24, s5
    ds_read_b64_tr_b16 a[250:251], v57 offset:59392
    v_mfma_f32_16x16x32_bf16 v[72:75], a[224:227], a[112:115], v[72:75]
    buffer_load_dwordx4 v24, s[28:31], s98 offen offset:0   lds
    v_mfma_f32_16x16x32_bf16 v[72:75], a[228:231], a[116:119], v[72:75]
    s_waitcnt lgkmcnt(6)
    s_lshl_b32 s24, s24, 13
    ds_read_b64_tr_b16 a[252:253], v57 offset:61440
    v_mfma_f32_16x16x32_bf16 v[68:71], a[232:235], a[96:99], v[68:71]
    s_add_u32 s24, s24, 50331648
    ds_read_b64_tr_b16 a[254:255], v57 offset:63488
    v_mfma_f32_16x16x32_bf16 v[68:71], a[236:239], a[100:103], v[68:71]
    ds_read_b64_tr_b16 a[192:193], v58 offset:32768
    v_mfma_f32_16x16x32_bf16 v[76:79], a[232:235], a[112:115], v[76:79]
    buffer_load_dwordx4 v25, s[28:31], s98 offen offset:1024   lds
    v_mfma_f32_16x16x32_bf16 v[76:79], a[236:239], a[116:119], v[76:79]
    s_waitcnt lgkmcnt(6)
    ds_read_b64_tr_b16 a[194:195], v58 offset:34816
    v_mfma_f32_16x16x32_bf16 v[64:67], a[240:243], a[104:107], v[64:67]
    s_waitcnt lgkmcnt(6)
    ds_read_b64_tr_b16 a[196:197], v58 offset:36864
    v_mfma_f32_16x16x32_bf16 v[64:67], a[244:247], a[108:111], v[64:67]
    ds_read_b64_tr_b16 a[198:199], v58 offset:38912
    v_mfma_f32_16x16x32_bf16 v[72:75], a[240:243], a[120:123], v[72:75]
    buffer_load_dwordx4 v26, s[28:31], s98 offen offset:2048   lds
    v_mfma_f32_16x16x32_bf16 v[72:75], a[244:247], a[124:127], v[72:75]
    s_waitcnt lgkmcnt(6)
    ds_read_b64_tr_b16 a[200:201], v59 offset:32768
    v_mfma_f32_16x16x32_bf16 v[68:71], a[248:251], a[104:107], v[68:71]
    s_waitcnt lgkmcnt(5)
    ds_read_b64_tr_b16 a[202:203], v59 offset:34816
    v_mfma_f32_16x16x32_bf16 v[68:71], a[252:255], a[108:111], v[68:71]
    ds_read_b64_tr_b16 a[204:205], v59 offset:36864
    v_mfma_f32_16x16x32_bf16 v[76:79], a[248:251], a[120:123], v[76:79]
    buffer_load_dwordx4 v27, s[28:31], s98 offen offset:3072   lds
    ds_read_b64_tr_b16 a[206:207], v59 offset:38912
    v_mfma_f32_16x16x32_bf16 v[76:79], a[252:255], a[124:127], v[76:79]
    s_waitcnt lgkmcnt(6)
    ds_read_b64_tr_b16 a[208:209], v58 offset:40960
    v_mfma_f32_16x16x32_bf16 v[80:83], a[192:195], a[64:67], 0
    s_waitcnt lgkmcnt(5)
    ds_read_b64_tr_b16 a[210:211], v58 offset:43008
    v_mfma_f32_16x16x32_bf16 v[80:83], a[196:199], a[68:71], v[80:83]
    ds_read_b64_tr_b16 a[212:213], v58 offset:45056
    v_mfma_f32_16x16x32_bf16 v[88:91], a[192:195], a[80:83], 0
    ds_read_b64_tr_b16 a[214:215], v58 offset:47104
    s_waitcnt vmcnt(16)
    s_barrier
    v_mfma_f32_16x16x32_bf16 v[88:91], a[196:199], a[84:87], v[88:91]
    s_waitcnt lgkmcnt(6)
    s_add_u32 m0, s62, 98304
    ds_read_b64_tr_b16 a[216:217], v59 offset:40960
    v_mfma_f32_16x16x32_bf16 v[84:87], a[200:203], a[64:67], 0
    s_waitcnt lgkmcnt(5)
    s_xor_b32 s98, s65, 262272
    ds_read_b64_tr_b16 a[218:219], v59 offset:43008
    v_mfma_f32_16x16x32_bf16 v[84:87], a[204:207], a[68:71], v[84:87]
    buffer_load_dwordx4 v24, s[28:31], s98 offen offset:0   lds
    ds_read_b64_tr_b16 a[220:221], v59 offset:45056
    v_mfma_f32_16x16x32_bf16 v[92:95], a[200:203], a[80:83], 0
    ds_read_b64_tr_b16 a[222:223], v59 offset:47104
    v_mfma_f32_16x16x32_bf16 v[92:95], a[204:207], a[84:87], v[92:95]
    s_waitcnt lgkmcnt(6)
    ds_read_b64_tr_b16 a[224:225], v58 offset:49152
    v_mfma_f32_16x16x32_bf16 v[80:83], a[208:211], a[72:75], v[80:83]
    s_waitcnt lgkmcnt(5)
    ds_read_b64_tr_b16 a[226:227], v58 offset:51200
    v_mfma_f32_16x16x32_bf16 v[80:83], a[212:215], a[76:79], v[80:83]
    buffer_load_dwordx4 v25, s[28:31], s98 offen offset:1024   lds
    v_mfma_f32_16x16x32_bf16 v[88:91], a[208:211], a[88:91], v[88:91]
    ds_read_b64_tr_b16 a[228:229], v58 offset:53248
    v_mfma_f32_16x16x32_bf16 v[88:91], a[212:215], a[92:95], v[88:91]
    s_waitcnt lgkmcnt(5)
    ds_read_b64_tr_b16 a[230:231], v58 offset:55296
    v_mfma_f32_16x16x32_bf16 v[84:87], a[216:219], a[72:75], v[84:87]
    s_waitcnt lgkmcnt(4)
    ds_read_b64_tr_b16 a[232:233], v59 offset:49152
    v_mfma_f32_16x16x32_bf16 v[84:87], a[220:223], a[76:79], v[84:87]
    buffer_load_dwordx4 v26, s[28:31], s98 offen offset:2048   lds
    ds_read_b64_tr_b16 a[234:235], v59 offset:51200
    v_mfma_f32_16x16x32_bf16 v[92:95], a[216:219], a[88:91], v[92:95]
    ds_read_b64_tr_b16 a[236:237], v59 offset:53248
    v_mfma_f32_16x16x32_bf16 v[92:95], a[220:223], a[92:95], v[92:95]
    s_waitcnt lgkmcnt(5)
    ds_read_b64_tr_b16 a[238:239], v59 offset:55296
    v_mfma_f32_16x16x32_bf16 v[80:83], a[224:227], a[96:99], v[80:83]
    s_waitcnt lgkmcnt(4)
    ds_read_b64_tr_b16 a[240:241], v58 offset:57344
    v_mfma_f32_16x16x32_bf16 v[80:83], a[228:231], a[100:103], v[80:83]
    buffer_load_dwordx4 v27, s[28:31], s98 offen offset:3072   lds
    v_mfma_f32_16x16x32_bf16 v[88:91], a[224:227], a[112:115], v[88:91]
    s_add_u32 m0, s62, 102400
    ds_read_b64_tr_b16 a[242:243], v58 offset:59392
    v_mfma_f32_16x16x32_bf16 v[88:91], a[228:231], a[116:119], v[88:91]
    s_waitcnt lgkmcnt(4)
    s_xor_b32 s98, s65, 295040
    ds_read_b64_tr_b16 a[244:245], v58 offset:61440
    v_mfma_f32_16x16x32_bf16 v[84:87], a[232:235], a[96:99], v[84:87]
    s_waitcnt lgkmcnt(3)
    ds_read_b64_tr_b16 a[246:247], v58 offset:63488
    v_mfma_f32_16x16x32_bf16 v[84:87], a[236:239], a[100:103], v[84:87]
    buffer_load_dwordx4 v24, s[28:31], s98 offen offset:0   lds
    ds_read_b64_tr_b16 a[248:249], v59 offset:57344
    v_mfma_f32_16x16x32_bf16 v[92:95], a[232:235], a[112:115], v[92:95]
    ds_read_b64_tr_b16 a[250:251], v59 offset:59392
    v_mfma_f32_16x16x32_bf16 v[92:95], a[236:239], a[116:119], v[92:95]
    s_waitcnt lgkmcnt(4)
    ds_read_b64_tr_b16 a[252:253], v59 offset:61440
    v_mfma_f32_16x16x32_bf16 v[80:83], a[240:243], a[104:107], v[80:83]
    s_waitcnt lgkmcnt(3)
    ds_read_b64_tr_b16 a[254:255], v59 offset:63488
    v_mfma_f32_16x16x32_bf16 v[80:83], a[244:247], a[108:111], v[80:83]
    buffer_load_dwordx4 v25, s[28:31], s98 offen offset:1024   lds
    v_mfma_f32_16x16x32_bf16 v[88:91], a[240:243], a[120:123], v[88:91]
    ds_read_b64_tr_b16 a[192:193], v60 offset:0
    v_mfma_f32_16x16x32_bf16 v[88:91], a[244:247], a[124:127], v[88:91]
    s_waitcnt lgkmcnt(3)
    ds_read_b64_tr_b16 a[194:195], v60 offset:2048
    v_mfma_f32_16x16x32_bf16 v[84:87], a[248:251], a[104:107], v[84:87]
    s_waitcnt lgkmcnt(2)
    ds_read_b64_tr_b16 a[196:197], v60 offset:4096
    v_lshrrev_b32 v46, 2, v2
    v_mfma_f32_16x16x32_bf16 v[84:87], a[252:255], a[108:111], v[84:87]
    buffer_load_dwordx4 v26, s[28:31], s98 offen offset:2048   lds
    ds_read_b64_tr_b16 a[198:199], v60 offset:6144
    v_mfma_f32_16x16x32_bf16 v[92:95], a[248:251], a[120:123], v[92:95]
    ds_read_b64_tr_b16 a[200:201], v61 offset:0
    v_and_b32 v45, 3, v2
    v_mfma_f32_16x16x32_bf16 v[92:95], a[252:255], a[124:127], v[92:95]
    s_waitcnt lgkmcnt(3)
    ds_read_b64_tr_b16 a[202:203], v61 offset:2048
    v_lshlrev_b32 v44, 8, v46
    v_mfma_f32_16x16x32_bf16 v[64:67], a[192:195], a[0:3], v[64:67]
    s_waitcnt lgkmcnt(2)
    ds_read_b64_tr_b16 a[204:205], v61 offset:4096
    v_lshl_add_u32 v44, v45, 4, v44
    v_mfma_f32_16x16x32_bf16 v[64:67], a[196:199], a[4:7], v[64:67]
    buffer_load_dwordx4 v27, s[28:31], s98 offen offset:3072   lds
    ds_read_b64_tr_b16 a[206:207], v61 offset:6144
    v_mfma_f32_16x16x32_bf16 v[72:75], a[192:195], a[16:19], v[72:75]
    ds_read_b64_tr_b16 a[208:209], v60 offset:8192
    v_lshlrev_b32 v45, 3, v45
    v_mfma_f32_16x16x32_bf16 v[72:75], a[196:199], a[20:23], v[72:75]
    s_waitcnt lgkmcnt(3)
    ds_read_b64_tr_b16 a[210:211], v60 offset:10240
    v_lshl_add_u32 v45, v46, 6, v45
    v_mfma_f32_16x16x32_bf16 v[68:71], a[200:203], a[0:3], v[68:71]
    s_waitcnt lgkmcnt(2)
    ds_read_b64_tr_b16 a[212:213], v60 offset:12288
    v_lshlrev_b32 v46, 1, v45
    v_mfma_f32_16x16x32_bf16 v[68:71], a[204:207], a[4:7], v[68:71]
    s_lshl_b32 s70, s2, 15
    ds_read_b64_tr_b16 a[214:215], v60 offset:14336
    v_mfma_f32_16x16x32_bf16 v[76:79], a[200:203], a[16:19], v[76:79]
    s_lshl_b32 s100, s3, 6
    ds_read_b64_tr_b16 a[216:217], v61 offset:8192
    v_mfma_f32_16x16x32_bf16 v[76:79], a[204:207], a[20:23], v[76:79]
    s_waitcnt lgkmcnt(3)
    s_add_u32 s70, s70, s100
    ds_read_b64_tr_b16 a[218:219], v61 offset:10240
    v_mfma_f32_16x16x32_bf16 v[64:67], a[208:211], a[8:11], v[64:67]
    s_waitcnt lgkmcnt(2)
    s_add_u32 s70, s70, 67108864
    ds_read_b64_tr_b16 a[220:221], v61 offset:12288
    v_mfma_f32_16x16x32_bf16 v[64:67], a[212:215], a[12:15], v[64:67]
    s_and_b32 s68, s2, 31
    ds_read_b64_tr_b16 a[222:223], v61 offset:14336
    v_mfma_f32_16x16x32_bf16 v[72:75], a[208:211], a[24:27], v[72:75]
    s_lshl_b32 s68, s68, 2
    ds_read_b64_tr_b16 a[224:225], v60 offset:16384
    v_mfma_f32_16x16x32_bf16 v[72:75], a[212:215], a[28:31], v[72:75]
    s_waitcnt lgkmcnt(3)
    s_add_u32 s68, s68, s3
    ds_read_b64_tr_b16 a[226:227], v60 offset:18432
    v_mfma_f32_16x16x32_bf16 v[68:71], a[216:219], a[8:11], v[68:71]
    s_waitcnt lgkmcnt(2)
    s_lshl_b32 s69, s61, 7
    ds_read_b64_tr_b16 a[228:229], v60 offset:20480
    v_mfma_f32_16x16x32_bf16 v[68:71], a[220:223], a[12:15], v[68:71]
    s_add_u32 s69, s69, s68
    ds_read_b64_tr_b16 a[230:231], v60 offset:22528
    v_mfma_f32_16x16x32_bf16 v[76:79], a[216:219], a[24:27], v[76:79]
    s_lshl_b32 s100, s60, 7
    ds_read_b64_tr_b16 a[232:233], v61 offset:16384
    v_mfma_f32_16x16x32_bf16 v[76:79], a[220:223], a[28:31], v[76:79]
    s_waitcnt lgkmcnt(3)
    s_add_u32 s68, s68, s100
    ds_read_b64_tr_b16 a[234:235], v61 offset:18432
    v_mfma_f32_16x16x32_bf16 v[64:67], a[224:227], a[32:35], v[64:67]
    s_waitcnt lgkmcnt(2)
    s_lshl_b32 s100, s68, 10
    ds_read_b64_tr_b16 a[236:237], v61 offset:20480
    v_mfma_f32_16x16x32_bf16 v[64:67], a[228:231], a[36:39], v[64:67]
    s_lshl_b32 s101, s69, 10
    ds_read_b64_tr_b16 a[238:239], v61 offset:22528
    v_mfma_f32_16x16x32_bf16 v[72:75], a[224:227], a[48:51], v[72:75]
    ds_read_b64_tr_b16 a[240:241], v60 offset:24576
    v_mfma_f32_16x16x32_bf16 v[72:75], a[228:231], a[52:55], v[72:75]
    s_waitcnt lgkmcnt(3)
    ds_read_b64_tr_b16 a[242:243], v60 offset:26624
    v_mfma_f32_16x16x32_bf16 v[68:71], a[232:235], a[32:35], v[68:71]
    s_waitcnt lgkmcnt(2)
    ds_read_b64_tr_b16 a[244:245], v60 offset:28672
    v_mfma_f32_16x16x32_bf16 v[68:71], a[236:239], a[36:39], v[68:71]
    ds_read_b64_tr_b16 a[246:247], v60 offset:30720
    v_mfma_f32_16x16x32_bf16 v[76:79], a[232:235], a[48:51], v[76:79]
    ds_read_b64_tr_b16 a[248:249], v61 offset:24576
    v_mfma_f32_16x16x32_bf16 v[76:79], a[236:239], a[52:55], v[76:79]
    s_waitcnt lgkmcnt(3)
    ds_read_b64_tr_b16 a[250:251], v61 offset:26624
    v_mfma_f32_16x16x32_bf16 v[64:67], a[240:243], a[40:43], v[64:67]
    s_waitcnt lgkmcnt(2)
    ds_read_b64_tr_b16 a[252:253], v61 offset:28672
    v_mfma_f32_16x16x32_bf16 v[64:67], a[244:247], a[44:47], v[64:67]
    ds_read_b64_tr_b16 a[254:255], v61 offset:30720
    v_mfma_f32_16x16x32_bf16 v[72:75], a[240:243], a[56:59], v[72:75]
    s_waitcnt lgkmcnt(2)
    ds_read_b64_tr_b16 a[192:193], v62 offset:0
    s_waitcnt vmcnt(16)
    v_mfma_f32_16x16x32_bf16 v[72:75], a[244:247], a[60:63], v[72:75]
    buffer_store_dword v6, v5, s[8:11], s22 offen sc0 sc1
    ds_read_b64_tr_b16 a[194:195], v62 offset:2048
    v_mfma_f32_16x16x32_bf16 v[68:71], a[248:251], a[40:43], v[68:71]
    s_waitcnt lgkmcnt(2)
    ds_read_b64_tr_b16 a[196:197], v62 offset:4096
    v_mfma_f32_16x16x32_bf16 v[68:71], a[252:255], a[44:47], v[68:71]
    ds_read_b64_tr_b16 a[198:199], v62 offset:6144
    v_mfma_f32_16x16x32_bf16 v[76:79], a[248:251], a[56:59], v[76:79]
    ds_read_b64_tr_b16 a[200:201], v63 offset:0
    v_mfma_f32_16x16x32_bf16 v[76:79], a[252:255], a[60:63], v[76:79]
    s_waitcnt lgkmcnt(3)
    ds_read_b64_tr_b16 a[202:203], v63 offset:2048
    v_mfma_f32_16x16x32_bf16 v[80:83], a[192:195], a[0:3], v[80:83]
    s_waitcnt lgkmcnt(2)
    ds_read_b64_tr_b16 a[204:205], v63 offset:4096
    v_mfma_f32_16x16x32_bf16 v[80:83], a[196:199], a[4:7], v[80:83]
    ds_read_b64_tr_b16 a[206:207], v63 offset:6144
    v_mfma_f32_16x16x32_bf16 v[88:91], a[192:195], a[16:19], v[88:91]
    ds_read_b64_tr_b16 a[208:209], v62 offset:8192
    v_mfma_f32_16x16x32_bf16 v[88:91], a[196:199], a[20:23], v[88:91]
    s_waitcnt lgkmcnt(3)
    ds_read_b64_tr_b16 a[210:211], v62 offset:10240
    v_mfma_f32_16x16x32_bf16 v[84:87], a[200:203], a[0:3], v[84:87]
    s_waitcnt lgkmcnt(2)
    ds_read_b64_tr_b16 a[212:213], v62 offset:12288
    v_mfma_f32_16x16x32_bf16 v[84:87], a[204:207], a[4:7], v[84:87]
    ds_read_b64_tr_b16 a[214:215], v62 offset:14336
    v_mfma_f32_16x16x32_bf16 v[92:95], a[200:203], a[16:19], v[92:95]
    ds_read_b64_tr_b16 a[216:217], v63 offset:8192
    v_cvt_pk_bf16_f32 v64, v64, v65
    s_waitcnt vmcnt(1)
    s_barrier
    v_mfma_f32_16x16x32_bf16 v[92:95], a[204:207], a[20:23], v[92:95]
    s_waitcnt lgkmcnt(1)
    s_xor_b32 s74, s24, 0
    ds_read_b64_tr_b16 a[218:219], v63 offset:10240
    v_cvt_pk_bf16_f32 v65, v66, v67
    v_mfma_f32_16x16x32_bf16 v[80:83], a[208:211], a[8:11], v[80:83]
    buffer_load_dwordx4 v[128:131], v1, s[8:11], s74 offen offset:0
    ds_read_b64_tr_b16 a[220:221], v63 offset:12288
    v_mfma_f32_16x16x32_bf16 v[80:83], a[212:215], a[12:15], v[80:83]
    s_xor_b32 s74, s24, 4096
    ds_read_b64_tr_b16 a[222:223], v63 offset:14336
    v_cvt_pk_bf16_f32 v66, v68, v69
    v_mfma_f32_16x16x32_bf16 v[88:91], a[208:211], a[24:27], v[88:91]
    s_waitcnt lgkmcnt(2)
    ds_read_b64_tr_b16 a[224:225], v62 offset:16384
    v_cvt_pk_bf16_f32 v67, v70, v71
    v_mfma_f32_16x16x32_bf16 v[88:91], a[212:215], a[28:31], v[88:91]
    buffer_load_dwordx4 v[144:147], v1, s[8:11], s74 offen offset:0
    ds_read_b64_tr_b16 a[226:227], v62 offset:18432
    v_mfma_f32_16x16x32_bf16 v[84:87], a[216:219], a[8:11], v[84:87]
    s_waitcnt lgkmcnt(2)
    s_xor_b32 s74, s24, 0
    ds_read_b64_tr_b16 a[228:229], v62 offset:20480
    v_min_u32 v64, -2, v64
    v_mfma_f32_16x16x32_bf16 v[84:87], a[220:223], a[12:15], v[84:87]
    ds_read_b64_tr_b16 a[230:231], v62 offset:22528
    v_min_u32 v65, -2, v65
    v_mfma_f32_16x16x32_bf16 v[92:95], a[216:219], a[24:27], v[92:95]
    buffer_load_dwordx4 v[132:135], v1, s[8:11], s74 offen offset:1024
    ds_read_b64_tr_b16 a[232:233], v63 offset:16384
    v_mfma_f32_16x16x32_bf16 v[92:95], a[220:223], a[28:31], v[92:95]
    s_waitcnt lgkmcnt(3)
    s_xor_b32 s74, s24, 4096
    ds_read_b64_tr_b16 a[234:235], v63 offset:18432
    v_min_u32 v66, -2, v66
    v_mfma_f32_16x16x32_bf16 v[80:83], a[224:227], a[32:35], v[80:83]
    s_waitcnt lgkmcnt(2)
    ds_read_b64_tr_b16 a[236:237], v63 offset:20480
    v_min_u32 v67, -2, v67
    v_mfma_f32_16x16x32_bf16 v[80:83], a[228:231], a[36:39], v[80:83]
    buffer_load_dwordx4 v[148:151], v1, s[8:11], s74 offen offset:1024
    ds_read_b64_tr_b16 a[238:239], v63 offset:22528
    v_mfma_f32_16x16x32_bf16 v[88:91], a[224:227], a[48:51], v[88:91]
    s_xor_b32 s74, s24, 0
    ds_read_b64_tr_b16 a[240:241], v62 offset:24576
    v_mfma_f32_16x16x32_bf16 v[88:91], a[228:231], a[52:55], v[88:91]
    s_waitcnt lgkmcnt(1)
    s_add_u32 s75, s18, 0
    ds_read_b64_tr_b16 a[242:243], v62 offset:26624
    v_mfma_f32_16x16x32_bf16 v[84:87], a[232:235], a[32:35], v[84:87]
    buffer_load_dwordx4 v[136:139], v1, s[8:11], s74 offen offset:2048
    ds_read_b64_tr_b16 a[244:245], v62 offset:28672
    v_mfma_f32_16x16x32_bf16 v[84:87], a[236:239], a[36:39], v[84:87]
    s_waitcnt lgkmcnt(1)
    s_xor_b32 s74, s24, 4096
    ds_read_b64_tr_b16 a[246:247], v62 offset:30720
    v_mfma_f32_16x16x32_bf16 v[92:95], a[232:235], a[48:51], v[92:95]
    buffer_store_dwordx4 v[64:67], v23, s[8:11], s75 offen offset:0 sc0 sc1
    ds_read_b64_tr_b16 a[248:249], v63 offset:24576
    v_mfma_f32_16x16x32_bf16 v[92:95], a[236:239], a[52:55], v[92:95]
    buffer_load_dwordx4 v[152:155], v1, s[8:11], s74 offen offset:2048
    ds_read_b64_tr_b16 a[250:251], v63 offset:26624
    v_mfma_f32_16x16x32_bf16 v[80:83], a[240:243], a[40:43], v[80:83]
    s_waitcnt lgkmcnt(2)
    s_xor_b32 s74, s24, 0
    ds_read_b64_tr_b16 a[252:253], v63 offset:28672
    v_cvt_pk_bf16_f32 v72, v72, v73
    v_mfma_f32_16x16x32_bf16 v[80:83], a[244:247], a[44:47], v[80:83]
    ds_read_b64_tr_b16 a[254:255], v63 offset:30720
    v_cvt_pk_bf16_f32 v73, v74, v75
    v_mfma_f32_16x16x32_bf16 v[88:91], a[240:243], a[56:59], v[88:91]
    buffer_load_dwordx4 v[140:143], v1, s[8:11], s74 offen offset:3072
    ds_read_b64_tr_b16 a[208:209], v56 offset:8192
    v_mfma_f32_16x16x32_bf16 v[88:91], a[244:247], a[60:63], v[88:91]
    s_waitcnt lgkmcnt(3)
    s_xor_b32 s74, s24, 4096
    ds_read_b64_tr_b16 a[192:193], v56 offset:0
    v_cvt_pk_bf16_f32 v74, v76, v77
    v_mfma_f32_16x16x32_bf16 v[84:87], a[248:251], a[40:43], v[84:87]
    s_waitcnt lgkmcnt(2)
    ds_read_b64_tr_b16 a[194:195], v56 offset:2048
    v_cvt_pk_bf16_f32 v75, v78, v79
    v_mfma_f32_16x16x32_bf16 v[84:87], a[252:255], a[44:47], v[84:87]
    buffer_load_dwordx4 v[156:159], v1, s[8:11], s74 offen offset:3072
    ds_read_b64_tr_b16 a[196:197], v56 offset:4096
    v_mfma_f32_16x16x32_bf16 v[92:95], a[248:251], a[56:59], v[92:95]
    ds_read_b64_tr_b16 a[198:199], v56 offset:6144
    v_min_u32 v72, -2, v72
    v_mfma_f32_16x16x32_bf16 v[92:95], a[252:255], a[60:63], v[92:95]
    s_waitcnt lgkmcnt(2)
    ds_read_b64_tr_b16 a[200:201], v57 offset:0
    v_min_u32 v73, -2, v73
    v_mfma_f32_16x16x32_bf16 v[96:99], a[192:195], a[64:67], 0
    s_waitcnt lgkmcnt(1)
    ds_read_b64_tr_b16 a[202:203], v57 offset:2048
    v_min_u32 v74, -2, v74
    v_mfma_f32_16x16x32_bf16 v[96:99], a[196:199], a[68:71], v[96:99]
    ds_read_b64_tr_b16 a[204:205], v57 offset:4096
    v_min_u32 v75, -2, v75
    v_mfma_f32_16x16x32_bf16 v[104:107], a[192:195], a[80:83], 0
    s_waitcnt lgkmcnt(1)
    s_add_u32 s75, s18, 131072
    ds_read_b64_tr_b16 a[206:207], v57 offset:6144
    v_mfma_f32_16x16x32_bf16 v[104:107], a[196:199], a[84:87], v[104:107]
    buffer_store_dwordx4 v[72:75], v23, s[8:11], s75 offen offset:0 sc0 sc1
    ds_read_b64_tr_b16 a[210:211], v56 offset:10240
    v_mfma_f32_16x16x32_bf16 v[100:103], a[200:203], a[64:67], 0
    s_waitcnt lgkmcnt(1)
    ds_read_b64_tr_b16 a[212:213], v56 offset:12288
    v_mfma_f32_16x16x32_bf16 v[100:103], a[204:207], a[68:71], v[100:103]
    ds_read_b64_tr_b16 a[214:215], v56 offset:14336
    v_mfma_f32_16x16x32_bf16 v[108:111], a[200:203], a[80:83], 0
    ds_read_b64_tr_b16 a[216:217], v57 offset:8192
    v_cvt_pk_bf16_f32 v80, v80, v81
    v_mfma_f32_16x16x32_bf16 v[108:111], a[204:207], a[84:87], v[108:111]
    s_waitcnt lgkmcnt(3)
    ds_read_b64_tr_b16 a[218:219], v57 offset:10240
    v_cvt_pk_bf16_f32 v81, v82, v83
    v_mfma_f32_16x16x32_bf16 v[96:99], a[208:211], a[72:75], v[96:99]
    s_waitcnt lgkmcnt(2)
    ds_read_b64_tr_b16 a[220:221], v57 offset:12288
    v_cvt_pk_bf16_f32 v82, v84, v85
    v_mfma_f32_16x16x32_bf16 v[96:99], a[212:215], a[76:79], v[96:99]
    ds_read_b64_tr_b16 a[222:223], v57 offset:14336
    v_cvt_pk_bf16_f32 v83, v86, v87
    v_mfma_f32_16x16x32_bf16 v[104:107], a[208:211], a[88:91], v[104:107]
    ds_read_b64_tr_b16 a[224:225], v56 offset:16384
    v_min_u32 v80, -2, v80
    v_mfma_f32_16x16x32_bf16 v[104:107], a[212:215], a[92:95], v[104:107]
    s_waitcnt lgkmcnt(3)
    ds_read_b64_tr_b16 a[226:227], v56 offset:18432
    v_min_u32 v81, -2, v81
    v_mfma_f32_16x16x32_bf16 v[100:103], a[216:219], a[72:75], v[100:103]
    s_waitcnt lgkmcnt(2)
    ds_read_b64_tr_b16 a[228:229], v56 offset:20480
    v_min_u32 v82, -2, v82
    v_mfma_f32_16x16x32_bf16 v[100:103], a[220:223], a[76:79], v[100:103]
    ds_read_b64_tr_b16 a[230:231], v56 offset:22528
    v_min_u32 v83, -2, v83
    v_mfma_f32_16x16x32_bf16 v[108:111], a[216:219], a[88:91], v[108:111]
    s_waitcnt lgkmcnt(2)
    s_add_u32 s75, s18, 0
    ds_read_b64_tr_b16 a[232:233], v57 offset:16384
    v_mfma_f32_16x16x32_bf16 v[108:111], a[220:223], a[92:95], v[108:111]
    buffer_store_dwordx4 v[80:83], v23, s[8:11], s75 offen offset:256 sc0 sc1
    ds_read_b64_tr_b16 a[234:235], v57 offset:18432
    v_mfma_f32_16x16x32_bf16 v[96:99], a[224:227], a[96:99], v[96:99]
    s_waitcnt lgkmcnt(2)
    ds_read_b64_tr_b16 a[236:237], v57 offset:20480
    v_cvt_pk_bf16_f32 v88, v88, v89
    v_mfma_f32_16x16x32_bf16 v[96:99], a[228:231], a[100:103], v[96:99]
    ds_read_b64_tr_b16 a[238:239], v57 offset:22528
    v_cvt_pk_bf16_f32 v89, v90, v91
    v_mfma_f32_16x16x32_bf16 v[104:107], a[224:227], a[112:115], v[104:107]
    ds_read_b64_tr_b16 a[240:241], v56 offset:24576
    v_cvt_pk_bf16_f32 v90, v92, v93
    v_mfma_f32_16x16x32_bf16 v[104:107], a[228:231], a[116:119], v[104:107]
    s_waitcnt lgkmcnt(3)
    ds_read_b64_tr_b16 a[242:243], v56 offset:26624
    v_cvt_pk_bf16_f32 v91, v94, v95
    v_mfma_f32_16x16x32_bf16 v[100:103], a[232:235], a[96:99], v[100:103]
    s_waitcnt lgkmcnt(2)
    ds_read_b64_tr_b16 a[244:245], v56 offset:28672
    v_min_u32 v88, -2, v88
    v_mfma_f32_16x16x32_bf16 v[100:103], a[236:239], a[100:103], v[100:103]
    ds_read_b64_tr_b16 a[246:247], v56 offset:30720
    v_min_u32 v89, -2, v89
    v_mfma_f32_16x16x32_bf16 v[108:111], a[232:235], a[112:115], v[108:111]
    ds_read_b64_tr_b16 a[248:249], v57 offset:24576
    v_min_u32 v90, -2, v90
    v_mfma_f32_16x16x32_bf16 v[108:111], a[236:239], a[116:119], v[108:111]
    s_waitcnt lgkmcnt(3)
    ds_read_b64_tr_b16 a[250:251], v57 offset:26624
    v_min_u32 v91, -2, v91
    v_mfma_f32_16x16x32_bf16 v[96:99], a[240:243], a[104:107], v[96:99]
    s_waitcnt lgkmcnt(2)
    s_add_u32 s75, s18, 131072
    ds_read_b64_tr_b16 a[252:253], v57 offset:28672
    v_mfma_f32_16x16x32_bf16 v[96:99], a[244:247], a[108:111], v[96:99]
    buffer_store_dwordx4 v[88:91], v23, s[8:11], s75 offen offset:256 sc0 sc1
    ds_read_b64_tr_b16 a[254:255], v57 offset:30720
    v_mfma_f32_16x16x32_bf16 v[104:107], a[240:243], a[120:123], v[104:107]
    ds_read_b64_tr_b16 a[192:193], v60 offset:32768
    v_mfma_f32_16x16x32_bf16 v[104:107], a[244:247], a[124:127], v[104:107]
    s_waitcnt lgkmcnt(3)
    ds_read_b64_tr_b16 a[194:195], v60 offset:34816
    v_mfma_f32_16x16x32_bf16 v[100:103], a[248:251], a[104:107], v[100:103]
    s_waitcnt lgkmcnt(2)
    ds_read_b64_tr_b16 a[196:197], v60 offset:36864
    v_mfma_f32_16x16x32_bf16 v[100:103], a[252:255], a[108:111], v[100:103]
    ds_read_b64_tr_b16 a[198:199], v60 offset:38912
    v_mfma_f32_16x16x32_bf16 v[108:111], a[248:251], a[120:123], v[108:111]
    ds_read_b64_tr_b16 a[200:201], v61 offset:32768
    v_mfma_f32_16x16x32_bf16 v[108:111], a[252:255], a[124:127], v[108:111]
    s_waitcnt lgkmcnt(3)
    ds_read_b64_tr_b16 a[202:203], v61 offset:34816
    v_mfma_f32_16x16x32_bf16 v[96:99], a[192:195], a[0:3], v[96:99]
    s_waitcnt lgkmcnt(2)
    ds_read_b64_tr_b16 a[204:205], v61 offset:36864
    v_mfma_f32_16x16x32_bf16 v[96:99], a[196:199], a[4:7], v[96:99]
    ds_read_b64_tr_b16 a[206:207], v61 offset:38912
    v_mfma_f32_16x16x32_bf16 v[104:107], a[192:195], a[16:19], v[104:107]
    ds_read_b64_tr_b16 a[208:209], v60 offset:40960
    v_mfma_f32_16x16x32_bf16 v[104:107], a[196:199], a[20:23], v[104:107]
    s_waitcnt lgkmcnt(3)
    ds_read_b64_tr_b16 a[210:211], v60 offset:43008
    v_mfma_f32_16x16x32_bf16 v[100:103], a[200:203], a[0:3], v[100:103]
    s_waitcnt lgkmcnt(2)
    ds_read_b64_tr_b16 a[212:213], v60 offset:45056
    v_mfma_f32_16x16x32_bf16 v[100:103], a[204:207], a[4:7], v[100:103]
    ds_read_b64_tr_b16 a[214:215], v60 offset:47104
    v_mfma_f32_16x16x32_bf16 v[108:111], a[200:203], a[16:19], v[108:111]
    ds_read_b64_tr_b16 a[216:217], v61 offset:40960
    v_mfma_f32_16x16x32_bf16 v[108:111], a[204:207], a[20:23], v[108:111]
    s_waitcnt lgkmcnt(3)
    ds_read_b64_tr_b16 a[218:219], v61 offset:43008
    v_mfma_f32_16x16x32_bf16 v[96:99], a[208:211], a[8:11], v[96:99]
    s_waitcnt lgkmcnt(2)
    ds_read_b64_tr_b16 a[220:221], v61 offset:45056
    v_mfma_f32_16x16x32_bf16 v[96:99], a[212:215], a[12:15], v[96:99]
    ds_read_b64_tr_b16 a[222:223], v61 offset:47104
    v_mfma_f32_16x16x32_bf16 v[104:107], a[208:211], a[24:27], v[104:107]
    buffer_load_dword v3, v4, s[8:11], s23 offen sc0 sc1
    v_mfma_f32_16x16x32_bf16 v[104:107], a[212:215], a[28:31], v[104:107]
    s_waitcnt lgkmcnt(2)
    ds_read_b64_tr_b16 a[224:225], v60 offset:49152
    v_mfma_f32_16x16x32_bf16 v[100:103], a[216:219], a[8:11], v[100:103]
    s_waitcnt lgkmcnt(1)
    ds_read_b64_tr_b16 a[226:227], v60 offset:51200
    v_mfma_f32_16x16x32_bf16 v[100:103], a[220:223], a[12:15], v[100:103]
    ds_read_b64_tr_b16 a[228:229], v60 offset:53248
    v_mfma_f32_16x16x32_bf16 v[108:111], a[216:219], a[24:27], v[108:111]
    ds_read_b64_tr_b16 a[230:231], v60 offset:55296
    v_mfma_f32_16x16x32_bf16 v[108:111], a[220:223], a[28:31], v[108:111]
    s_waitcnt lgkmcnt(2)
    ds_read_b64_tr_b16 a[232:233], v61 offset:49152
    v_mfma_f32_16x16x32_bf16 v[96:99], a[224:227], a[32:35], v[96:99]
    s_waitcnt lgkmcnt(1)
    ds_read_b64_tr_b16 a[234:235], v61 offset:51200
    v_mfma_f32_16x16x32_bf16 v[96:99], a[228:231], a[36:39], v[96:99]
    ds_read_b64_tr_b16 a[236:237], v61 offset:53248
    v_mfma_f32_16x16x32_bf16 v[104:107], a[224:227], a[48:51], v[104:107]
    ds_read_b64_tr_b16 a[238:239], v61 offset:55296
    v_mfma_f32_16x16x32_bf16 v[104:107], a[228:231], a[52:55], v[104:107]
    s_waitcnt lgkmcnt(2)
    ds_read_b64_tr_b16 a[240:241], v60 offset:57344
    v_mfma_f32_16x16x32_bf16 v[100:103], a[232:235], a[32:35], v[100:103]
    s_waitcnt lgkmcnt(1)
    ds_read_b64_tr_b16 a[242:243], v60 offset:59392
    v_mfma_f32_16x16x32_bf16 v[100:103], a[236:239], a[36:39], v[100:103]
    ds_read_b64_tr_b16 a[244:245], v60 offset:61440
    v_mfma_f32_16x16x32_bf16 v[108:111], a[232:235], a[48:51], v[108:111]
    ds_read_b64_tr_b16 a[246:247], v60 offset:63488
    v_mfma_f32_16x16x32_bf16 v[108:111], a[236:239], a[52:55], v[108:111]
    s_waitcnt lgkmcnt(2)
    ds_read_b64_tr_b16 a[248:249], v61 offset:57344
    v_mfma_f32_16x16x32_bf16 v[96:99], a[240:243], a[40:43], v[96:99]
    s_waitcnt lgkmcnt(1)
    ds_read_b64_tr_b16 a[250:251], v61 offset:59392
    v_mfma_f32_16x16x32_bf16 v[96:99], a[244:247], a[44:47], v[96:99]
    ds_read_b64_tr_b16 a[252:253], v61 offset:61440
    v_mfma_f32_16x16x32_bf16 v[104:107], a[240:243], a[56:59], v[104:107]
    ds_read_b64_tr_b16 a[254:255], v61 offset:63488
    v_mfma_f32_16x16x32_bf16 v[104:107], a[244:247], a[60:63], v[104:107]
    s_waitcnt lgkmcnt(2)
    ds_read_b64_tr_b16 a[192:193], v58 offset:0
    v_mfma_f32_16x16x32_bf16 v[100:103], a[248:251], a[40:43], v[100:103]
    s_waitcnt lgkmcnt(1)
    ds_read_b64_tr_b16 a[194:195], v58 offset:2048
    v_mfma_f32_16x16x32_bf16 v[100:103], a[252:255], a[44:47], v[100:103]
    ds_read_b64_tr_b16 a[196:197], v58 offset:4096
    v_mfma_f32_16x16x32_bf16 v[108:111], a[248:251], a[56:59], v[108:111]
    ds_read_b64_tr_b16 a[198:199], v58 offset:6144
    v_mfma_f32_16x16x32_bf16 v[108:111], a[252:255], a[60:63], v[108:111]
    s_waitcnt lgkmcnt(2)
    ds_read_b64_tr_b16 a[200:201], v59 offset:0
    v_mfma_f32_16x16x32_bf16 v[112:115], a[192:195], a[64:67], 0
    s_waitcnt lgkmcnt(1)
    ds_read_b64_tr_b16 a[202:203], v59 offset:2048
    v_mfma_f32_16x16x32_bf16 v[112:115], a[196:199], a[68:71], v[112:115]
    ds_read_b64_tr_b16 a[204:205], v59 offset:4096
    v_mfma_f32_16x16x32_bf16 v[120:123], a[192:195], a[80:83], 0
    ds_read_b64_tr_b16 a[206:207], v59 offset:6144
    v_mfma_f32_16x16x32_bf16 v[120:123], a[196:199], a[84:87], v[120:123]
    s_waitcnt lgkmcnt(2)
    ds_read_b64_tr_b16 a[208:209], v58 offset:8192
    v_mfma_f32_16x16x32_bf16 v[116:119], a[200:203], a[64:67], 0
    s_waitcnt lgkmcnt(1)
    ds_read_b64_tr_b16 a[210:211], v58 offset:10240
    v_mfma_f32_16x16x32_bf16 v[116:119], a[204:207], a[68:71], v[116:119]
    ds_read_b64_tr_b16 a[212:213], v58 offset:12288
    v_mfma_f32_16x16x32_bf16 v[124:127], a[200:203], a[80:83], 0
    ds_read_b64_tr_b16 a[214:215], v58 offset:14336
    v_mfma_f32_16x16x32_bf16 v[124:127], a[204:207], a[84:87], v[124:127]
    s_waitcnt lgkmcnt(2)
    ds_read_b64_tr_b16 a[216:217], v59 offset:8192
    v_mfma_f32_16x16x32_bf16 v[112:115], a[208:211], a[72:75], v[112:115]
    s_waitcnt lgkmcnt(1)
    ds_read_b64_tr_b16 a[218:219], v59 offset:10240
    v_cvt_pk_bf16_f32 v96, v96, v97
    s_waitcnt vmcnt(0)
    v_cmp_ne_u32 vcc, 0, v3
    s_cmp_eq_u64 vcc, -1
    s_cbranch_scc0 L_C2_slow_13
L_C2_ok_14:
    v_mfma_f32_16x16x32_bf16 v[112:115], a[212:215], a[76:79], v[112:115]
    s_xor_b32 s74, s24, 8192
    ds_read_b64_tr_b16 a[220:221], v59 offset:12288
    v_cvt_pk_bf16_f32 v97, v98, v99
    v_mfma_f32_16x16x32_bf16 v[120:123], a[208:211], a[88:91], v[120:123]
    buffer_load_dwordx4 v[160:163], v1, s[8:11], s74 offen offset:0
    ds_read_b64_tr_b16 a[222:223], v59 offset:14336
    v_mfma_f32_16x16x32_bf16 v[120:123], a[212:215], a[92:95], v[120:123]
    s_waitcnt lgkmcnt(2)
    s_xor_b32 s74, s24, 12288
    ds_read_b64_tr_b16 a[224:225], v58 offset:16384
    v_cvt_pk_bf16_f32 v98, v100, v101
    v_mfma_f32_16x16x32_bf16 v[116:119], a[216:219], a[72:75], v[116:119]
    s_waitcnt lgkmcnt(1)
    ds_read_b64_tr_b16 a[226:227], v58 offset:18432
    v_cvt_pk_bf16_f32 v99, v102, v103
    v_mfma_f32_16x16x32_bf16 v[116:119], a[220:223], a[76:79], v[116:119]
    ds_read_b64_tr_b16 a[228:229], v58 offset:20480
    v_min_u32 v96, -2, v96
    v_mfma_f32_16x16x32_bf16 v[124:127], a[216:219], a[88:91], v[124:127]
    buffer_load_dwordx4 v[176:179], v1, s[8:11], s74 offen offset:0
    ds_read_b64_tr_b16 a[230:231], v58 offset:22528
    v_mfma_f32_16x16x32_bf16 v[124:127], a[220:223], a[92:95], v[124:127]
    s_waitcnt lgkmcnt(2)
    s_xor_b32 s74, s24, 8192
    ds_read_b64_tr_b16 a[232:233], v59 offset:16384
    v_min_u32 v97, -2, v97
    v_mfma_f32_16x16x32_bf16 v[112:115], a[224:227], a[96:99], v[112:115]
    s_waitcnt lgkmcnt(1)
    ds_read_b64_tr_b16 a[234:235], v59 offset:18432
    v_min_u32 v98, -2, v98
    v_mfma_f32_16x16x32_bf16 v[112:115], a[228:231], a[100:103], v[112:115]
    ds_read_b64_tr_b16 a[236:237], v59 offset:20480
    v_min_u32 v99, -2, v99
    v_mfma_f32_16x16x32_bf16 v[120:123], a[224:227], a[112:115], v[120:123]
    buffer_load_dwordx4 v[164:167], v1, s[8:11], s74 offen offset:1024
    ds_read_b64_tr_b16 a[238:239], v59 offset:22528
    v_mfma_f32_16x16x32_bf16 v[120:123], a[228:231], a[116:119], v[120:123]
    s_waitcnt lgkmcnt(2)
    s_xor_b32 s74, s24, 12288
    ds_read_b64_tr_b16 a[240:241], v58 offset:24576
    v_mfma_f32_16x16x32_bf16 v[116:119], a[232:235], a[96:99], v[116:119]
    s_waitcnt lgkmcnt(1)
    s_add_u32 s75, s18, 0
    ds_read_b64_tr_b16 a[242:243], v58 offset:26624
    v_mfma_f32_16x16x32_bf16 v[116:119], a[236:239], a[100:103], v[116:119]
    buffer_store_dwordx4 v[96:99], v23, s[8:11], s75 offen offset:512 sc0 sc1
    ds_read_b64_tr_b16 a[244:245], v58 offset:28672
    v_mfma_f32_16x16x32_bf16 v[124:127], a[232:235], a[112:115], v[124:127]
    buffer_load_dwordx4 v[180:183], v1, s[8:11], s74 offen offset:1024
    ds_read_b64_tr_b16 a[246:247], v58 offset:30720
    v_mfma_f32_16x16x32_bf16 v[124:127], a[236:239], a[116:119], v[124:127]
    s_waitcnt lgkmcnt(2)
    s_xor_b32 s74, s24, 8192
    ds_read_b64_tr_b16 a[248:249], v59 offset:24576
    v_cvt_pk_bf16_f32 v104, v104, v105
    v_mfma_f32_16x16x32_bf16 v[112:115], a[240:243], a[104:107], v[112:115]
    s_waitcnt lgkmcnt(1)
    ds_read_b64_tr_b16 a[250:251], v59 offset:26624
    v_cvt_pk_bf16_f32 v105, v106, v107
    v_mfma_f32_16x16x32_bf16 v[112:115], a[244:247], a[108:111], v[112:115]
    ds_read_b64_tr_b16 a[252:253], v59 offset:28672
    v_cvt_pk_bf16_f32 v106, v108, v109
    v_mfma_f32_16x16x32_bf16 v[120:123], a[240:243], a[120:123], v[120:123]
    buffer_load_dwordx4 v[168:171], v1, s[8:11], s74 offen offset:2048
    ds_read_b64_tr_b16 a[254:255], v59 offset:30720
    v_mfma_f32_16x16x32_bf16 v[120:123], a[244:247], a[124:127], v[120:123]
    s_waitcnt lgkmcnt(2)
    s_xor_b32 s74, s24, 12288
    ds_read_b64_tr_b16 a[192:193], v62 offset:32768
    v_cvt_pk_bf16_f32 v107, v110, v111
    v_mfma_f32_16x16x32_bf16 v[116:119], a[248:251], a[104:107], v[116:119]
    s_waitcnt lgkmcnt(1)
    ds_read_b64_tr_b16 a[194:195], v62 offset:34816
    v_min_u32 v104, -2, v104
    v_mfma_f32_16x16x32_bf16 v[116:119], a[252:255], a[108:111], v[116:119]
    ds_read_b64_tr_b16 a[196:197], v62 offset:36864
    v_min_u32 v105, -2, v105
    v_mfma_f32_16x16x32_bf16 v[124:127], a[248:251], a[120:123], v[124:127]
    buffer_load_dwordx4 v[184:187], v1, s[8:11], s74 offen offset:2048
    ds_read_b64_tr_b16 a[198:199], v62 offset:38912
    v_mfma_f32_16x16x32_bf16 v[124:127], a[252:255], a[124:127], v[124:127]
    s_waitcnt lgkmcnt(2)
    s_xor_b32 s74, s24, 8192
    ds_read_b64_tr_b16 a[200:201], v63 offset:32768
    v_min_u32 v106, -2, v106
    v_mfma_f32_16x16x32_bf16 v[112:115], a[192:195], a[0:3], v[112:115]
    s_waitcnt lgkmcnt(1)
    ds_read_b64_tr_b16 a[202:203], v63 offset:34816
    v_min_u32 v107, -2, v107
    v_mfma_f32_16x16x32_bf16 v[112:115], a[196:199], a[4:7], v[112:115]
    s_add_u32 s75, s18, 131072
    ds_read_b64_tr_b16 a[204:205], v63 offset:36864
    v_mfma_f32_16x16x32_bf16 v[120:123], a[192:195], a[16:19], v[120:123]
    buffer_load_dwordx4 v[172:175], v1, s[8:11], s74 offen offset:3072
    ds_read_b64_tr_b16 a[206:207], v63 offset:38912
    v_mfma_f32_16x16x32_bf16 v[120:123], a[196:199], a[20:23], v[120:123]
    s_waitcnt lgkmcnt(0)
    s_xor_b32 s74, s24, 12288
    ds_read_b64_tr_b16 a[208:209], v62 offset:40960
    v_mfma_f32_16x16x32_bf16 v[116:119], a[200:203], a[0:3], v[116:119]
    buffer_store_dwordx4 v[104:107], v23, s[8:11], s75 offen offset:512 sc0 sc1
    ds_read_b64_tr_b16 a[210:211], v62 offset:43008
    v_mfma_f32_16x16x32_bf16 v[116:119], a[204:207], a[4:7], v[116:119]
    ds_read_b64_tr_b16 a[212:213], v62 offset:45056
    v_mfma_f32_16x16x32_bf16 v[124:127], a[200:203], a[16:19], v[124:127]
    buffer_load_dwordx4 v[188:191], v1, s[8:11], s74 offen offset:3072
    ds_read_b64_tr_b16 a[214:215], v62 offset:47104
    v_mfma_f32_16x16x32_bf16 v[124:127], a[204:207], a[20:23], v[124:127]
    s_waitcnt lgkmcnt(2)
    ds_read_b64_tr_b16 a[216:217], v63 offset:40960
    v_mfma_f32_16x16x32_bf16 v[112:115], a[208:211], a[8:11], v[112:115]
    s_waitcnt lgkmcnt(1)
    ds_read_b64_tr_b16 a[218:219], v63 offset:43008
    ds_read_b64_tr_b16 a[192:193], v56 offset:32768
    v_mfma_f32_16x16x32_bf16 v[112:115], a[212:215], a[12:15], v[112:115]
    ds_read_b64_tr_b16 a[220:221], v63 offset:45056
    ds_read_b64_tr_b16 a[194:195], v56 offset:34816
    v_mfma_f32_16x16x32_bf16 v[120:123], a[208:211], a[24:27], v[120:123]
    ds_read_b64_tr_b16 a[222:223], v63 offset:47104
    ds_read_b64_tr_b16 a[196:197], v56 offset:36864
    v_mfma_f32_16x16x32_bf16 v[120:123], a[212:215], a[28:31], v[120:123]
    s_waitcnt lgkmcnt(5)
    ds_read_b64_tr_b16 a[224:225], v62 offset:49152
    ds_read_b64_tr_b16 a[198:199], v56 offset:38912
    v_mfma_f32_16x16x32_bf16 v[116:119], a[216:219], a[8:11], v[116:119]
    s_waitcnt lgkmcnt(3)
    ds_read_b64_tr_b16 a[226:227], v62 offset:51200
    ds_read_b64_tr_b16 a[200:201], v57 offset:32768
    v_mfma_f32_16x16x32_bf16 v[116:119], a[220:223], a[12:15], v[116:119]
    ds_read_b64_tr_b16 a[228:229], v62 offset:53248
    ds_read_b64_tr_b16 a[202:203], v57 offset:34816
    v_mfma_f32_16x16x32_bf16 v[124:127], a[216:219], a[24:27], v[124:127]
    ds_read_b64_tr_b16 a[230:231], v62 offset:55296
    ds_read_b64_tr_b16 a[204:205], v57 offset:36864
    v_mfma_f32_16x16x32_bf16 v[124:127], a[220:223], a[28:31], v[124:127]
    s_waitcnt lgkmcnt(5)
    ds_read_b64_tr_b16 a[232:233], v63 offset:49152
    ds_read_b64_tr_b16 a[206:207], v57 offset:38912
    v_mfma_f32_16x16x32_bf16 v[112:115], a[224:227], a[32:35], v[112:115]
    s_waitcnt lgkmcnt(3)
    ds_read_b64_tr_b16 a[234:235], v63 offset:51200
    v_mfma_f32_16x16x32_bf16 v[112:115], a[228:231], a[36:39], v[112:115]
    ds_read_b64_tr_b16 a[236:237], v63 offset:53248
    v_mfma_f32_16x16x32_bf16 v[120:123], a[224:227], a[48:51], v[120:123]
    ds_read_b64_tr_b16 a[238:239], v63 offset:55296
    v_mfma_f32_16x16x32_bf16 v[120:123], a[228:231], a[52:55], v[120:123]
    s_waitcnt lgkmcnt(2)
    ds_read_b64_tr_b16 a[240:241], v62 offset:57344
    v_mfma_f32_16x16x32_bf16 v[116:119], a[232:235], a[32:35], v[116:119]
    s_waitcnt lgkmcnt(1)
    ds_read_b64_tr_b16 a[242:243], v62 offset:59392
    v_mfma_f32_16x16x32_bf16 v[116:119], a[236:239], a[36:39], v[116:119]
    ds_read_b64_tr_b16 a[244:245], v62 offset:61440
    v_mfma_f32_16x16x32_bf16 v[124:127], a[232:235], a[48:51], v[124:127]
    ds_read_b64_tr_b16 a[246:247], v62 offset:63488
    v_mfma_f32_16x16x32_bf16 v[124:127], a[236:239], a[52:55], v[124:127]
    s_waitcnt lgkmcnt(2)
    ds_read_b64_tr_b16 a[248:249], v63 offset:57344
    v_mfma_f32_16x16x32_bf16 v[112:115], a[240:243], a[40:43], v[112:115]
    s_waitcnt lgkmcnt(1)
    ds_read_b64_tr_b16 a[250:251], v63 offset:59392
    v_mfma_f32_16x16x32_bf16 v[112:115], a[244:247], a[44:47], v[112:115]
    ds_read_b64_tr_b16 a[252:253], v63 offset:61440
    v_mfma_f32_16x16x32_bf16 v[120:123], a[240:243], a[56:59], v[120:123]
    s_waitcnt lgkmcnt(1)
    s_xor_b32 s74, s24, 16384
    ds_read_b64_tr_b16 a[254:255], v63 offset:63488
    v_mfma_f32_16x16x32_bf16 v[120:123], a[244:247], a[60:63], v[120:123]
    buffer_load_dwordx4 v[192:195], v1, s[8:11], s74 offen offset:0
    v_mfma_f32_16x16x32_bf16 v[116:119], a[248:251], a[40:43], v[116:119]
    s_waitcnt lgkmcnt(0)
    s_xor_b32 s74, s24, 20480
    ds_read_b64_tr_b16 a[208:209], v56 offset:40960
    v_mfma_f32_16x16x32_bf16 v[116:119], a[252:255], a[44:47], v[116:119]
    ds_read_b64_tr_b16 a[210:211], v56 offset:43008
    v_mfma_f32_16x16x32_bf16 v[124:127], a[248:251], a[56:59], v[124:127]
    ds_read_b64_tr_b16 a[212:213], v56 offset:45056
    v_mfma_f32_16x16x32_bf16 v[124:127], a[252:255], a[60:63], v[124:127]
    ds_read_b64_tr_b16 a[214:215], v56 offset:47104
    v_mfma_f32_16x16x32_bf16 v[64:67], a[192:195], v[128:131], 0
    buffer_load_dwordx4 v[208:211], v1, s[8:11], s74 offen offset:0
    v_mfma_f32_16x16x32_bf16 v[64:67], a[196:199], v[132:135], v[64:67]
    s_xor_b32 s74, s24, 16384
    ds_read_b64_tr_b16 a[216:217], v57 offset:40960
    v_mfma_f32_16x16x32_bf16 v[72:75], a[192:195], v[144:147], 0
    ds_read_b64_tr_b16 a[218:219], v57 offset:43008
    v_mfma_f32_16x16x32_bf16 v[72:75], a[196:199], v[148:151], v[72:75]
    ds_read_b64_tr_b16 a[220:221], v57 offset:45056
    v_mfma_f32_16x16x32_bf16 v[68:71], a[200:203], v[128:131], 0
    ds_read_b64_tr_b16 a[222:223], v57 offset:47104
    v_mfma_f32_16x16x32_bf16 v[68:71], a[204:207], v[132:135], v[68:71]
    buffer_load_dwordx4 v[196:199], v1, s[8:11], s74 offen offset:1024
    v_mfma_f32_16x16x32_bf16 v[76:79], a[200:203], v[144:147], 0
    s_xor_b32 s74, s24, 20480
    ds_read_b64_tr_b16 a[224:225], v56 offset:49152
    v_cvt_pk_bf16_f32 v112, v112, v113
    v_mfma_f32_16x16x32_bf16 v[76:79], a[204:207], v[148:151], v[76:79]
    s_waitcnt lgkmcnt(7)
    ds_read_b64_tr_b16 a[226:227], v56 offset:51200
    v_cvt_pk_bf16_f32 v113, v114, v115
    v_mfma_f32_16x16x32_bf16 v[64:67], a[208:211], v[136:139], v[64:67]
    s_waitcnt lgkmcnt(6)
    ds_read_b64_tr_b16 a[228:229], v56 offset:53248
    v_cvt_pk_bf16_f32 v114, v116, v117
    v_mfma_f32_16x16x32_bf16 v[64:67], a[212:215], v[140:143], v[64:67]
    ds_read_b64_tr_b16 a[230:231], v56 offset:55296
    v_cvt_pk_bf16_f32 v115, v118, v119
    v_mfma_f32_16x16x32_bf16 v[72:75], a[208:211], v[152:155], v[72:75]
    buffer_load_dwordx4 v[212:215], v1, s[8:11], s74 offen offset:1024
    v_mfma_f32_16x16x32_bf16 v[72:75], a[212:215], v[156:159], v[72:75]
    s_waitcnt lgkmcnt(6)
    s_xor_b32 s74, s24, 16384
    ds_read_b64_tr_b16 a[232:233], v57 offset:49152
    v_min_u32 v112, -2, v112
    v_mfma_f32_16x16x32_bf16 v[68:71], a[216:219], v[136:139], v[68:71]
    s_waitcnt lgkmcnt(5)
    ds_read_b64_tr_b16 a[234:235], v57 offset:51200
    v_min_u32 v113, -2, v113
    v_mfma_f32_16x16x32_bf16 v[68:71], a[220:223], v[140:143], v[68:71]
    ds_read_b64_tr_b16 a[236:237], v57 offset:53248
    v_min_u32 v114, -2, v114
    v_mfma_f32_16x16x32_bf16 v[76:79], a[216:219], v[152:155], v[76:79]
    s_waitcnt vmcnt(13) lgkmcnt(5)
    ds_read_b64_tr_b16 a[238:239], v57 offset:55296
    v_min_u32 v115, -2, v115
    v_mfma_f32_16x16x32_bf16 v[76:79], a[220:223], v[156:159], v[76:79]
    buffer_load_dwordx4 v[200:203], v1, s[8:11], s74 offen offset:2048
    v_mfma_f32_16x16x32_bf16 v[64:67], a[224:227], v[160:163], v[64:67]
    s_waitcnt vmcnt(12) lgkmcnt(4)
    s_xor_b32 s74, s24, 20480
    ds_read_b64_tr_b16 a[240:241], v56 offset:57344
    v_mfma_f32_16x16x32_bf16 v[64:67], a[228:231], v[164:167], v[64:67]
    s_waitcnt vmcnt(10)
    s_add_u32 s75, s18, 0
    ds_read_b64_tr_b16 a[242:243], v56 offset:59392
    v_mfma_f32_16x16x32_bf16 v[72:75], a[224:227], v[176:179], v[72:75]
    buffer_store_dwordx4 v[112:115], v23, s[8:11], s75 offen offset:768 sc0 sc1
    v_mfma_f32_16x16x32_bf16 v[72:75], a[228:231], v[180:183], v[72:75]
    s_waitcnt lgkmcnt(2)
    ds_read_b64_tr_b16 a[244:245], v56 offset:61440
    v_cvt_pk_bf16_f32 v120, v120, v121
    v_mfma_f32_16x16x32_bf16 v[68:71], a[232:235], v[160:163], v[68:71]
    buffer_load_dwordx4 v[216:219], v1, s[8:11], s74 offen offset:2048
    ds_read_b64_tr_b16 a[246:247], v56 offset:63488
    v_mfma_f32_16x16x32_bf16 v[68:71], a[236:239], v[164:167], v[68:71]
    s_xor_b32 s74, s24, 16384
    ds_read_b64_tr_b16 a[248:249], v57 offset:57344
    v_cvt_pk_bf16_f32 v121, v122, v123
    v_mfma_f32_16x16x32_bf16 v[76:79], a[232:235], v[176:179], v[76:79]
    ds_read_b64_tr_b16 a[250:251], v57 offset:59392
    v_cvt_pk_bf16_f32 v122, v124, v125
    v_mfma_f32_16x16x32_bf16 v[76:79], a[236:239], v[180:183], v[76:79]
    s_waitcnt vmcnt(11) lgkmcnt(4)
    ds_read_b64_tr_b16 a[252:253], v57 offset:61440
    v_cvt_pk_bf16_f32 v123, v126, v127
    v_mfma_f32_16x16x32_bf16 v[64:67], a[240:243], v[168:171], v[64:67]
    s_waitcnt vmcnt(9) lgkmcnt(3)
    ds_read_b64_tr_b16 a[254:255], v57 offset:63488
    v_min_u32 v120, -2, v120
    v_mfma_f32_16x16x32_bf16 v[64:67], a[244:247], v[172:175], v[64:67]
    buffer_load_dwordx4 v[204:207], v1, s[8:11], s74 offen offset:3072
    v_mfma_f32_16x16x32_bf16 v[72:75], a[240:243], v[184:187], v[72:75]
    s_waitcnt vmcnt(8)
    s_xor_b32 s74, s24, 20480
    ds_read_b64_tr_b16 a[192:193], v58 offset:32768
    v_min_u32 v121, -2, v121
    v_mfma_f32_16x16x32_bf16 v[72:75], a[244:247], v[188:191], v[72:75]
    s_waitcnt lgkmcnt(3)
    ds_read_b64_tr_b16 a[194:195], v58 offset:34816
    v_min_u32 v122, -2, v122
    v_mfma_f32_16x16x32_bf16 v[68:71], a[248:251], v[168:171], v[68:71]
    s_waitcnt lgkmcnt(2)
    ds_read_b64_tr_b16 a[196:197], v58 offset:36864
    v_min_u32 v123, -2, v123
    v_mfma_f32_16x16x32_bf16 v[68:71], a[252:255], v[172:175], v[68:71]
    s_add_u32 s75, s18, 131072
    ds_read_b64_tr_b16 a[198:199], v58 offset:38912
    v_mfma_f32_16x16x32_bf16 v[76:79], a[248:251], v[184:187], v[76:79]
    buffer_load_dwordx4 v[220:223], v1, s[8:11], s74 offen offset:3072
    ds_read_b64_tr_b16 a[200:201], v59 offset:32768
    v_mfma_f32_16x16x32_bf16 v[76:79], a[252:255], v[188:191], v[76:79]
    s_waitcnt lgkmcnt(1)
    s_xor_b32 s74, s24, 24576
    ds_read_b64_tr_b16 a[202:203], v59 offset:34816
    v_mfma_f32_16x16x32_bf16 v[80:83], a[192:195], v[128:131], 0
    buffer_store_dwordx4 v[120:123], v23, s[8:11], s75 offen offset:768 sc0 sc1
    ds_read_b64_tr_b16 a[204:205], v59 offset:36864
    v_mfma_f32_16x16x32_bf16 v[80:83], a[196:199], v[132:135], v[80:83]
    ds_read_b64_tr_b16 a[206:207], v59 offset:38912
    v_mfma_f32_16x16x32_bf16 v[88:91], a[192:195], v[144:147], 0
    s_waitcnt lgkmcnt(2)
    ds_read_b64_tr_b16 a[208:209], v58 offset:40960
    v_mfma_f32_16x16x32_bf16 v[88:91], a[196:199], v[148:151], v[88:91]
    buffer_load_dwordx4 v[224:227], v1, s[8:11], s74 offen offset:0
    ds_read_b64_tr_b16 a[210:211], v58 offset:43008
    v_mfma_f32_16x16x32_bf16 v[84:87], a[200:203], v[128:131], 0
    s_waitcnt lgkmcnt(2)
    s_xor_b32 s74, s24, 28672
    ds_read_b64_tr_b16 a[212:213], v58 offset:45056
    v_mfma_f32_16x16x32_bf16 v[84:87], a[204:207], v[132:135], v[84:87]
    ds_read_b64_tr_b16 a[214:215], v58 offset:47104
    v_mfma_f32_16x16x32_bf16 v[92:95], a[200:203], v[144:147], 0
    ds_read_b64_tr_b16 a[216:217], v59 offset:40960
    v_mfma_f32_16x16x32_bf16 v[92:95], a[204:207], v[148:151], v[92:95]
    s_waitcnt lgkmcnt(1)
    ds_read_b64_tr_b16 a[218:219], v59 offset:43008
    v_mfma_f32_16x16x32_bf16 v[80:83], a[208:211], v[136:139], v[80:83]
    buffer_load_dwordx4 v[240:243], v1, s[8:11], s74 offen offset:0
    ds_read_b64_tr_b16 a[220:221], v59 offset:45056
    v_mfma_f32_16x16x32_bf16 v[80:83], a[212:215], v[140:143], v[80:83]
    s_xor_b32 s74, s24, 24576
    ds_read_b64_tr_b16 a[222:223], v59 offset:47104
    v_mfma_f32_16x16x32_bf16 v[88:91], a[208:211], v[152:155], v[88:91]
    ds_read_b64_tr_b16 a[224:225], v58 offset:49152
    v_mfma_f32_16x16x32_bf16 v[88:91], a[212:215], v[156:159], v[88:91]
    s_waitcnt lgkmcnt(3)
    ds_read_b64_tr_b16 a[226:227], v58 offset:51200
    v_mfma_f32_16x16x32_bf16 v[84:87], a[216:219], v[136:139], v[84:87]
    s_waitcnt lgkmcnt(2)
    ds_read_b64_tr_b16 a[228:229], v58 offset:53248
    v_mfma_f32_16x16x32_bf16 v[84:87], a[220:223], v[140:143], v[84:87]
    buffer_load_dwordx4 v[228:231], v1, s[8:11], s74 offen offset:1024
    ds_read_b64_tr_b16 a[230:231], v58 offset:55296
    v_mfma_f32_16x16x32_bf16 v[92:95], a[216:219], v[152:155], v[92:95]
    s_xor_b32 s74, s24, 28672
    ds_read_b64_tr_b16 a[232:233], v59 offset:49152
    v_mfma_f32_16x16x32_bf16 v[92:95], a[220:223], v[156:159], v[92:95]
    s_waitcnt lgkmcnt(3)
    ds_read_b64_tr_b16 a[234:235], v59 offset:51200
    v_mfma_f32_16x16x32_bf16 v[80:83], a[224:227], v[160:163], v[80:83]
    s_waitcnt lgkmcnt(2)
    ds_read_b64_tr_b16 a[236:237], v59 offset:53248
    v_mfma_f32_16x16x32_bf16 v[80:83], a[228:231], v[164:167], v[80:83]
    ds_read_b64_tr_b16 a[238:239], v59 offset:55296
    v_mfma_f32_16x16x32_bf16 v[88:91], a[224:227], v[176:179], v[88:91]
    buffer_load_dwordx4 v[244:247], v1, s[8:11], s74 offen offset:1024
    v_mfma_f32_16x16x32_bf16 v[88:91], a[228:231], v[180:183], v[88:91]
    s_waitcnt lgkmcnt(2)
    s_xor_b32 s74, s24, 24576
    ds_read_b64_tr_b16 a[240:241], v58 offset:57344
    v_mfma_f32_16x16x32_bf16 v[84:87], a[232:235], v[160:163], v[84:87]
    s_waitcnt lgkmcnt(1)
    ds_read_b64_tr_b16 a[242:243], v58 offset:59392
    v_mfma_f32_16x16x32_bf16 v[84:87], a[236:239], v[164:167], v[84:87]
    ds_read_b64_tr_b16 a[244:245], v58 offset:61440
    v_mfma_f32_16x16x32_bf16 v[92:95], a[232:235], v[176:179], v[92:95]
    s_waitcnt lgkmcnt(1)
    ds_read_b64_tr_b16 a[246:247], v58 offset:63488
    v_mfma_f32_16x16x32_bf16 v[92:95], a[236:239], v[180:183], v[92:95]
    buffer_load_dwordx4 v[232:235], v1, s[8:11], s74 offen offset:2048
    ds_read_b64_tr_b16 a[248:249], v59 offset:57344
    v_mfma_f32_16x16x32_bf16 v[80:83], a[240:243], v[168:171], v[80:83]
    s_waitcnt lgkmcnt(1)
    s_xor_b32 s74, s24, 28672
    ds_read_b64_tr_b16 a[250:251], v59 offset:59392
    v_mfma_f32_16x16x32_bf16 v[80:83], a[244:247], v[172:175], v[80:83]
    ds_read_b64_tr_b16 a[252:253], v59 offset:61440
    v_mfma_f32_16x16x32_bf16 v[88:91], a[240:243], v[184:187], v[88:91]
    ds_read_b64_tr_b16 a[254:255], v59 offset:63488
    v_mfma_f32_16x16x32_bf16 v[88:91], a[244:247], v[188:191], v[88:91]
    s_waitcnt lgkmcnt(0)
    ds_read_b64_tr_b16 a[192:193], v56 offset:0
    v_mfma_f32_16x16x32_bf16 v[84:87], a[248:251], v[168:171], v[84:87]
    buffer_load_dwordx4 v[248:251], v1, s[8:11], s74 offen offset:2048
    ds_read_b64_tr_b16 a[194:195], v56 offset:2048
    v_mfma_f32_16x16x32_bf16 v[84:87], a[252:255], v[172:175], v[84:87]
    s_xor_b32 s74, s24, 24576
    ds_read_b64_tr_b16 a[196:197], v56 offset:4096
    v_mfma_f32_16x16x32_bf16 v[92:95], a[248:251], v[184:187], v[92:95]
    ds_read_b64_tr_b16 a[198:199], v56 offset:6144
    v_mfma_f32_16x16x32_bf16 v[92:95], a[252:255], v[188:191], v[92:95]
    s_waitcnt lgkmcnt(2)
    ds_read_b64_tr_b16 a[200:201], v57 offset:0
    v_mfma_f32_16x16x32_bf16 v[96:99], a[192:195], v[128:131], 0
    s_waitcnt lgkmcnt(1)
    ds_read_b64_tr_b16 a[202:203], v57 offset:2048
    v_mfma_f32_16x16x32_bf16 v[96:99], a[196:199], v[132:135], v[96:99]
    buffer_load_dwordx4 v[236:239], v1, s[8:11], s74 offen offset:3072
    ds_read_b64_tr_b16 a[204:205], v57 offset:4096
    v_mfma_f32_16x16x32_bf16 v[104:107], a[192:195], v[144:147], 0
    s_xor_b32 s74, s24, 28672
    ds_read_b64_tr_b16 a[206:207], v57 offset:6144
    v_mfma_f32_16x16x32_bf16 v[104:107], a[196:199], v[148:151], v[104:107]
    s_waitcnt lgkmcnt(2)
    ds_read_b64_tr_b16 a[208:209], v56 offset:8192
    v_mfma_f32_16x16x32_bf16 v[100:103], a[200:203], v[128:131], 0
    s_waitcnt lgkmcnt(1)
    ds_read_b64_tr_b16 a[210:211], v56 offset:10240
    v_mfma_f32_16x16x32_bf16 v[100:103], a[204:207], v[132:135], v[100:103]
    ds_read_b64_tr_b16 a[212:213], v56 offset:12288
    v_mfma_f32_16x16x32_bf16 v[108:111], a[200:203], v[144:147], 0
    buffer_load_dwordx4 v[252:255], v1, s[8:11], s74 offen offset:3072
    ds_read_b64_tr_b16 a[214:215], v56 offset:14336
    v_mfma_f32_16x16x32_bf16 v[108:111], a[204:207], v[148:151], v[108:111]
    s_waitcnt lgkmcnt(2)
    ds_read_b64_tr_b16 a[216:217], v57 offset:8192
    v_mfma_f32_16x16x32_bf16 v[96:99], a[208:211], v[136:139], v[96:99]
    s_waitcnt lgkmcnt(1)
    ds_read_b64_tr_b16 a[218:219], v57 offset:10240
    v_mfma_f32_16x16x32_bf16 v[96:99], a[212:215], v[140:143], v[96:99]
    ds_read_b64_tr_b16 a[220:221], v57 offset:12288
    v_mfma_f32_16x16x32_bf16 v[104:107], a[208:211], v[152:155], v[104:107]
    ds_read_b64_tr_b16 a[222:223], v57 offset:14336
    v_mfma_f32_16x16x32_bf16 v[104:107], a[212:215], v[156:159], v[104:107]
    s_waitcnt lgkmcnt(2)
    ds_read_b64_tr_b16 a[224:225], v56 offset:16384
    v_mfma_f32_16x16x32_bf16 v[100:103], a[216:219], v[136:139], v[100:103]
    s_waitcnt lgkmcnt(1)
    ds_read_b64_tr_b16 a[226:227], v56 offset:18432
    v_mfma_f32_16x16x32_bf16 v[100:103], a[220:223], v[140:143], v[100:103]
    ds_read_b64_tr_b16 a[228:229], v56 offset:20480
    v_mfma_f32_16x16x32_bf16 v[108:111], a[216:219], v[152:155], v[108:111]
    ds_read_b64_tr_b16 a[230:231], v56 offset:22528
    v_mfma_f32_16x16x32_bf16 v[108:111], a[220:223], v[156:159], v[108:111]
    s_waitcnt lgkmcnt(2)
    ds_read_b64_tr_b16 a[232:233], v57 offset:16384
    v_mfma_f32_16x16x32_bf16 v[96:99], a[224:227], v[160:163], v[96:99]
    s_waitcnt lgkmcnt(1)
    ds_read_b64_tr_b16 a[234:235], v57 offset:18432
    v_mfma_f32_16x16x32_bf16 v[96:99], a[228:231], v[164:167], v[96:99]
    ds_read_b64_tr_b16 a[236:237], v57 offset:20480
    v_mfma_f32_16x16x32_bf16 v[104:107], a[224:227], v[176:179], v[104:107]
    ds_read_b64_tr_b16 a[238:239], v57 offset:22528
    v_mfma_f32_16x16x32_bf16 v[104:107], a[228:231], v[180:183], v[104:107]
    s_waitcnt lgkmcnt(0)
    ds_read_b64_tr_b16 a[240:241], v56 offset:24576
    v_mfma_f32_16x16x32_bf16 v[100:103], a[232:235], v[160:163], v[100:103]
    buffer_load_dwordx2 v[32:33], v45, s[32:35], s100 offen
    ds_read_b64_tr_b16 a[242:243], v56 offset:26624
    v_mfma_f32_16x16x32_bf16 v[100:103], a[236:239], v[164:167], v[100:103]
    ds_read_b64_tr_b16 a[244:245], v56 offset:28672
    v_mfma_f32_16x16x32_bf16 v[108:111], a[232:235], v[176:179], v[108:111]
    ds_read_b64_tr_b16 a[246:247], v56 offset:30720
    v_mfma_f32_16x16x32_bf16 v[108:111], a[236:239], v[180:183], v[108:111]
    s_waitcnt lgkmcnt(0)
    ds_read_b64_tr_b16 a[248:249], v57 offset:24576
    v_mfma_f32_16x16x32_bf16 v[96:99], a[240:243], v[168:171], v[96:99]
    buffer_load_dwordx2 v[34:35], v45, s[32:35], s100 offen offset:32
    ds_read_b64_tr_b16 a[250:251], v57 offset:26624
    v_mfma_f32_16x16x32_bf16 v[96:99], a[244:247], v[172:175], v[96:99]
    ds_read_b64_tr_b16 a[252:253], v57 offset:28672
    v_mfma_f32_16x16x32_bf16 v[104:107], a[240:243], v[184:187], v[104:107]
    ds_read_b64_tr_b16 a[254:255], v57 offset:30720
    v_mfma_f32_16x16x32_bf16 v[104:107], a[244:247], v[188:191], v[104:107]
    s_waitcnt lgkmcnt(0)
    ds_read_b64_tr_b16 a[192:193], v58 offset:0
    v_mfma_f32_16x16x32_bf16 v[100:103], a[248:251], v[168:171], v[100:103]
    buffer_load_dwordx2 v[36:37], v45, s[32:35], s101 offen
    ds_read_b64_tr_b16 a[194:195], v58 offset:2048
    v_mfma_f32_16x16x32_bf16 v[100:103], a[252:255], v[172:175], v[100:103]
    ds_read_b64_tr_b16 a[196:197], v58 offset:4096
    v_mfma_f32_16x16x32_bf16 v[108:111], a[248:251], v[184:187], v[108:111]
    ds_read_b64_tr_b16 a[198:199], v58 offset:6144
    v_mfma_f32_16x16x32_bf16 v[108:111], a[252:255], v[188:191], v[108:111]
    s_waitcnt lgkmcnt(0)
    ds_read_b64_tr_b16 a[200:201], v59 offset:0
    v_mfma_f32_16x16x32_bf16 v[112:115], a[192:195], v[128:131], 0
    buffer_load_dwordx2 v[38:39], v45, s[32:35], s101 offen offset:32
    ds_read_b64_tr_b16 a[202:203], v59 offset:2048
    v_mfma_f32_16x16x32_bf16 v[112:115], a[196:199], v[132:135], v[112:115]
    ds_read_b64_tr_b16 a[204:205], v59 offset:4096
    v_mfma_f32_16x16x32_bf16 v[120:123], a[192:195], v[144:147], 0
    ds_read_b64_tr_b16 a[206:207], v59 offset:6144
    v_mfma_f32_16x16x32_bf16 v[120:123], a[196:199], v[148:151], v[120:123]
    s_waitcnt lgkmcnt(0)
    ds_read_b64_tr_b16 a[208:209], v58 offset:8192
    v_mfma_f32_16x16x32_bf16 v[116:119], a[200:203], v[128:131], 0
    buffer_load_dwordx2 v[40:41], v45, s[56:59], 0 offen
    ds_read_b64_tr_b16 a[210:211], v58 offset:10240
    v_mfma_f32_16x16x32_bf16 v[116:119], a[204:207], v[132:135], v[116:119]
    ds_read_b64_tr_b16 a[212:213], v58 offset:12288
    v_mfma_f32_16x16x32_bf16 v[124:127], a[200:203], v[144:147], 0
    ds_read_b64_tr_b16 a[214:215], v58 offset:14336
    v_mfma_f32_16x16x32_bf16 v[124:127], a[204:207], v[148:151], v[124:127]
    s_waitcnt lgkmcnt(0)
    ds_read_b64_tr_b16 a[216:217], v59 offset:8192
    v_mfma_f32_16x16x32_bf16 v[112:115], a[208:211], v[136:139], v[112:115]
    buffer_load_dwordx2 v[42:43], v45, s[56:59], 0 offen offset:32
    ds_read_b64_tr_b16 a[218:219], v59 offset:10240
    v_mfma_f32_16x16x32_bf16 v[112:115], a[212:215], v[140:143], v[112:115]
    ds_read_b64_tr_b16 a[220:221], v59 offset:12288
    v_mfma_f32_16x16x32_bf16 v[120:123], a[208:211], v[152:155], v[120:123]
    ds_read_b64_tr_b16 a[222:223], v59 offset:14336
    v_mfma_f32_16x16x32_bf16 v[120:123], a[212:215], v[156:159], v[120:123]
    s_waitcnt lgkmcnt(2)
    ds_read_b64_tr_b16 a[224:225], v58 offset:16384
    v_mfma_f32_16x16x32_bf16 v[116:119], a[216:219], v[136:139], v[116:119]
    s_waitcnt lgkmcnt(1)
    ds_read_b64_tr_b16 a[226:227], v58 offset:18432
    v_mfma_f32_16x16x32_bf16 v[116:119], a[220:223], v[140:143], v[116:119]
    ds_read_b64_tr_b16 a[228:229], v58 offset:20480
    v_mfma_f32_16x16x32_bf16 v[124:127], a[216:219], v[152:155], v[124:127]
    ds_read_b64_tr_b16 a[230:231], v58 offset:22528
    v_mfma_f32_16x16x32_bf16 v[124:127], a[220:223], v[156:159], v[124:127]
    s_waitcnt lgkmcnt(2)
    ds_read_b64_tr_b16 a[232:233], v59 offset:16384
    v_mfma_f32_16x16x32_bf16 v[112:115], a[224:227], v[160:163], v[112:115]
    s_waitcnt lgkmcnt(1)
    ds_read_b64_tr_b16 a[234:235], v59 offset:18432
    ds_read_b64_tr_b16 a[208:209], v60 offset:8192
    v_mfma_f32_16x16x32_bf16 v[112:115], a[228:231], v[164:167], v[112:115]
    ds_read_b64_tr_b16 a[236:237], v59 offset:20480
    ds_read_b64_tr_b16 a[210:211], v60 offset:10240
    v_mfma_f32_16x16x32_bf16 v[120:123], a[224:227], v[176:179], v[120:123]
    ds_read_b64_tr_b16 a[238:239], v59 offset:22528
    ds_read_b64_tr_b16 a[212:213], v60 offset:12288
    v_mfma_f32_16x16x32_bf16 v[120:123], a[228:231], v[180:183], v[120:123]
    s_waitcnt lgkmcnt(5)
    ds_read_b64_tr_b16 a[240:241], v58 offset:24576
    ds_read_b64_tr_b16 a[214:215], v60 offset:14336
    v_mfma_f32_16x16x32_bf16 v[116:119], a[232:235], v[160:163], v[116:119]
    s_waitcnt lgkmcnt(3)
    ds_read_b64_tr_b16 a[242:243], v58 offset:26624
    ds_read_b64_tr_b16 a[216:217], v61 offset:8192
    v_mfma_f32_16x16x32_bf16 v[116:119], a[236:239], v[164:167], v[116:119]
    ds_read_b64_tr_b16 a[244:245], v58 offset:28672
    ds_read_b64_tr_b16 a[218:219], v61 offset:10240
    v_mfma_f32_16x16x32_bf16 v[124:127], a[232:235], v[176:179], v[124:127]
    ds_read_b64_tr_b16 a[246:247], v58 offset:30720
    ds_read_b64_tr_b16 a[220:221], v61 offset:12288
    v_mfma_f32_16x16x32_bf16 v[124:127], a[236:239], v[180:183], v[124:127]
    s_waitcnt lgkmcnt(5)
    ds_read_b64_tr_b16 a[248:249], v59 offset:24576
    ds_read_b64_tr_b16 a[222:223], v61 offset:14336
    v_mfma_f32_16x16x32_bf16 v[112:115], a[240:243], v[168:171], v[112:115]
    s_waitcnt lgkmcnt(3)
    ds_read_b64_tr_b16 a[250:251], v59 offset:26624
    v_mfma_f32_16x16x32_bf16 v[112:115], a[244:247], v[172:175], v[112:115]
    ds_read_b64_tr_b16 a[252:253], v59 offset:28672
    v_mfma_f32_16x16x32_bf16 v[120:123], a[240:243], v[184:187], v[120:123]
    ds_read_b64_tr_b16 a[254:255], v59 offset:30720
    v_mfma_f32_16x16x32_bf16 v[120:123], a[244:247], v[188:191], v[120:123]
    s_waitcnt lgkmcnt(2)
    ds_read_b64_tr_b16 a[192:193], v60 offset:0
    v_mfma_f32_16x16x32_bf16 v[116:119], a[248:251], v[168:171], v[116:119]
    s_waitcnt lgkmcnt(1)
    ds_read_b64_tr_b16 a[194:195], v60 offset:2048
    v_mfma_f32_16x16x32_bf16 v[116:119], a[252:255], v[172:175], v[116:119]
    ds_read_b64_tr_b16 a[196:197], v60 offset:4096
    v_mfma_f32_16x16x32_bf16 v[124:127], a[248:251], v[184:187], v[124:127]
    ds_read_b64_tr_b16 a[198:199], v60 offset:6144
    v_mfma_f32_16x16x32_bf16 v[124:127], a[252:255], v[188:191], v[124:127]
    s_waitcnt vmcnt(23) lgkmcnt(2)
    ds_read_b64_tr_b16 a[200:201], v61 offset:0
    v_mfma_f32_16x16x32_bf16 v[64:67], a[192:195], v[192:195], v[64:67]
    s_waitcnt vmcnt(21) lgkmcnt(1)
    ds_read_b64_tr_b16 a[202:203], v61 offset:2048
    v_mfma_f32_16x16x32_bf16 v[64:67], a[196:199], v[196:199], v[64:67]
    ds_read_b64_tr_b16 a[204:205], v61 offset:4096
    v_mfma_f32_16x16x32_bf16 v[72:75], a[192:195], v[208:211], v[72:75]
    s_waitcnt vmcnt(20) lgkmcnt(1)
    s_mov_b32 s74, 8192
    ds_read_b64_tr_b16 a[206:207], v61 offset:6144
    v_mfma_f32_16x16x32_bf16 v[72:75], a[196:199], v[212:215], v[72:75]
    buffer_load_dwordx4 v[168:171], v46, s[8:11], s74 offen
    v_mfma_f32_16x16x32_bf16 v[68:71], a[200:203], v[192:195], v[68:71]
    s_waitcnt lgkmcnt(0)
    ds_read_b64_tr_b16 a[224:225], v60 offset:16384
    v_mfma_f32_16x16x32_bf16 v[68:71], a[204:207], v[196:199], v[68:71]
    ds_read_b64_tr_b16 a[226:227], v60 offset:18432
    v_mfma_f32_16x16x32_bf16 v[76:79], a[200:203], v[208:211], v[76:79]
    buffer_load_dwordx4 v[172:175], v46, s[8:11], s74 offen offset:64
    v_mfma_f32_16x16x32_bf16 v[76:79], a[204:207], v[212:215], v[76:79]
    s_waitcnt vmcnt(21)
    s_mov_b32 s74, 6144
    ds_read_b64_tr_b16 a[228:229], v60 offset:20480
    v_mfma_f32_16x16x32_bf16 v[64:67], a[208:211], v[200:203], v[64:67]
    s_waitcnt vmcnt(18)
    ds_read_b64_tr_b16 a[230:231], v60 offset:22528
    v_mfma_f32_16x16x32_bf16 v[64:67], a[212:215], v[204:207], v[64:67]
    buffer_load_dwordx4 v[176:179], v46, s[8:11], s74 offen
    v_mfma_f32_16x16x32_bf16 v[72:75], a[208:211], v[216:219], v[72:75]
    s_waitcnt vmcnt(18)
    ds_read_b64_tr_b16 a[232:233], v61 offset:16384
    v_mfma_f32_16x16x32_bf16 v[72:75], a[212:215], v[220:223], v[72:75]
    ds_read_b64_tr_b16 a[234:235], v61 offset:18432
    v_mfma_f32_16x16x32_bf16 v[68:71], a[216:219], v[200:203], v[68:71]
    buffer_load_dwordx4 v[180:183], v46, s[8:11], s74 offen offset:64
    ds_read_b64_tr_b16 a[236:237], v61 offset:20480
    v_mfma_f32_16x16x32_bf16 v[68:71], a[220:223], v[204:207], v[68:71]
    s_mov_b32 s74, 4096
    ds_read_b64_tr_b16 a[238:239], v61 offset:22528
    v_mfma_f32_16x16x32_bf16 v[76:79], a[216:219], v[216:219], v[76:79]
    s_waitcnt vmcnt(17) lgkmcnt(6)
    ds_read_b64_tr_b16 a[240:241], v60 offset:24576
    v_mfma_f32_16x16x32_bf16 v[76:79], a[220:223], v[220:223], v[76:79]
    buffer_load_dwordx4 v[160:163], v46, s[8:11], s74 offen
    v_mfma_f32_16x16x32_bf16 v[64:67], a[224:227], v[224:227], v[64:67]
    s_waitcnt vmcnt(16) lgkmcnt(5)
    ds_read_b64_tr_b16 a[242:243], v60 offset:26624
    s_waitcnt vmcnt(6)
    v_lshlrev_b32 v48, 16, v40
    v_mfma_f32_16x16x32_bf16 v[64:67], a[228:231], v[228:231], v[64:67]
    ds_read_b64_tr_b16 a[244:245], v60 offset:28672
    v_and_b32 v49, 0xffff0000, v40
    v_mfma_f32_16x16x32_bf16 v[72:75], a[224:227], v[240:243], v[72:75]
    buffer_load_dwordx4 v[164:167], v46, s[8:11], s74 offen offset:64
    v_mfma_f32_16x16x32_bf16 v[72:75], a[228:231], v[244:247], v[72:75]
    s_waitcnt lgkmcnt(5)
    s_mov_b32 s74, 10240
    ds_read_b64_tr_b16 a[246:247], v60 offset:30720
    v_lshlrev_b32 v50, 16, v41
    v_mfma_f32_16x16x32_bf16 v[68:71], a[232:235], v[224:227], v[68:71]
    s_waitcnt lgkmcnt(4)
    ds_read_b64_tr_b16 a[248:249], v61 offset:24576
    v_and_b32 v51, 0xffff0000, v41
    v_mfma_f32_16x16x32_bf16 v[68:71], a[236:239], v[228:231], v[68:71]
    buffer_load_dwordx4 v[184:187], v46, s[8:11], s74 offen
    ds_read_b64_tr_b16 a[250:251], v61 offset:26624
    v_mfma_f32_16x16x32_bf16 v[76:79], a[232:235], v[240:243], v[76:79]
    ds_read_b64_tr_b16 a[252:253], v61 offset:28672
    s_waitcnt vmcnt(7)
    v_lshlrev_b32 v52, 16, v42
    v_mfma_f32_16x16x32_bf16 v[76:79], a[236:239], v[244:247], v[76:79]
    s_waitcnt lgkmcnt(3)
    ds_read_b64_tr_b16 a[254:255], v61 offset:30720
    v_and_b32 v53, 0xffff0000, v42
    v_mfma_f32_16x16x32_bf16 v[64:67], a[240:243], v[232:235], v[64:67]
    buffer_load_dwordx4 v[188:191], v46, s[8:11], s74 offen offset:64
    v_mfma_f32_16x16x32_bf16 v[64:67], a[244:247], v[236:239], v[64:67]
    ds_read_b64_tr_b16 a[192:193], v62 offset:0
    v_lshlrev_b32 v54, 16, v43
    v_mfma_f32_16x16x32_bf16 v[72:75], a[240:243], v[248:251], v[72:75]
    ds_read_b64_tr_b16 a[194:195], v62 offset:2048
    v_and_b32 v55, 0xffff0000, v43
    v_mfma_f32_16x16x32_bf16 v[72:75], a[244:247], v[252:255], v[72:75]
    s_waitcnt lgkmcnt(4)
    ds_read_b64_tr_b16 a[196:197], v62 offset:4096
    v_mfma_f32_16x16x32_bf16 v[68:71], a[248:251], v[232:235], v[68:71]
    s_waitcnt lgkmcnt(3)
    ds_read_b64_tr_b16 a[198:199], v62 offset:6144
    v_mfma_f32_16x16x32_bf16 v[68:71], a[252:255], v[236:239], v[68:71]
    ds_read_b64_tr_b16 a[200:201], v63 offset:0
    v_mfma_f32_16x16x32_bf16 v[76:79], a[248:251], v[248:251], v[76:79]
    ds_read_b64_tr_b16 a[202:203], v63 offset:2048
    v_mfma_f32_16x16x32_bf16 v[76:79], a[252:255], v[252:255], v[76:79]
    s_waitcnt lgkmcnt(4)
    ds_read_b64_tr_b16 a[204:205], v63 offset:4096
    v_mfma_f32_16x16x32_bf16 v[80:83], a[192:195], v[192:195], v[80:83]
    s_waitcnt lgkmcnt(3)
    ds_read_b64_tr_b16 a[206:207], v63 offset:6144
    v_mfma_f32_16x16x32_bf16 v[80:83], a[196:199], v[196:199], v[80:83]
    ds_read_b64_tr_b16 a[208:209], v62 offset:8192
    v_mfma_f32_16x16x32_bf16 v[88:91], a[192:195], v[208:211], v[88:91]
    ds_read_b64_tr_b16 a[210:211], v62 offset:10240
    v_mfma_f32_16x16x32_bf16 v[88:91], a[196:199], v[212:215], v[88:91]
    s_waitcnt lgkmcnt(4)
    ds_read_b64_tr_b16 a[212:213], v62 offset:12288
    v_mfma_f32_16x16x32_bf16 v[84:87], a[200:203], v[192:195], v[84:87]
    s_waitcnt lgkmcnt(3)
    ds_read_b64_tr_b16 a[214:215], v62 offset:14336
    v_mfma_f32_16x16x32_bf16 v[84:87], a[204:207], v[196:199], v[84:87]
    ds_read_b64_tr_b16 a[216:217], v63 offset:8192
    v_mfma_f32_16x16x32_bf16 v[92:95], a[200:203], v[208:211], v[92:95]
    ds_read_b64_tr_b16 a[218:219], v63 offset:10240
    v_cvt_pk_bf16_f32 v64, v64, v65
    v_mfma_f32_16x16x32_bf16 v[92:95], a[204:207], v[212:215], v[92:95]
    s_waitcnt lgkmcnt(4)
    ds_read_b64_tr_b16 a[220:221], v63 offset:12288
    v_cvt_pk_bf16_f32 v65, v66, v67
    v_mfma_f32_16x16x32_bf16 v[80:83], a[208:211], v[200:203], v[80:83]
    s_waitcnt lgkmcnt(3)
    ds_read_b64_tr_b16 a[222:223], v63 offset:14336
    v_cvt_pk_bf16_f32 v66, v68, v69
    v_mfma_f32_16x16x32_bf16 v[80:83], a[212:215], v[204:207], v[80:83]
    ds_read_b64_tr_b16 a[224:225], v62 offset:16384
    v_cvt_pk_bf16_f32 v67, v70, v71
    v_mfma_f32_16x16x32_bf16 v[88:91], a[208:211], v[216:219], v[88:91]
    ds_read_b64_tr_b16 a[226:227], v62 offset:18432
    v_min_u32 v64, -2, v64
    v_mfma_f32_16x16x32_bf16 v[88:91], a[212:215], v[220:223], v[88:91]
    s_waitcnt lgkmcnt(4)
    ds_read_b64_tr_b16 a[228:229], v62 offset:20480
    v_min_u32 v65, -2, v65
    v_mfma_f32_16x16x32_bf16 v[84:87], a[216:219], v[200:203], v[84:87]
    s_waitcnt lgkmcnt(3)
    ds_read_b64_tr_b16 a[230:231], v62 offset:22528
    v_min_u32 v66, -2, v66
    v_mfma_f32_16x16x32_bf16 v[84:87], a[220:223], v[204:207], v[84:87]
    ds_read_b64_tr_b16 a[232:233], v63 offset:16384
    v_min_u32 v67, -2, v67
    v_mfma_f32_16x16x32_bf16 v[92:95], a[216:219], v[216:219], v[92:95]
    s_waitcnt lgkmcnt(3)
    s_add_u32 s75, s18, 8388608
    ds_read_b64_tr_b16 a[234:235], v63 offset:18432
    v_mfma_f32_16x16x32_bf16 v[92:95], a[220:223], v[220:223], v[92:95]
    buffer_store_dwordx4 v[64:67], v23, s[8:11], s75 offen offset:0 sc0 sc1
    ds_read_b64_tr_b16 a[236:237], v63 offset:20480
    v_mfma_f32_16x16x32_bf16 v[80:83], a[224:227], v[224:227], v[80:83]
    s_waitcnt lgkmcnt(3)
    ds_read_b64_tr_b16 a[238:239], v63 offset:22528
    v_cvt_pk_bf16_f32 v72, v72, v73
    v_mfma_f32_16x16x32_bf16 v[80:83], a[228:231], v[228:231], v[80:83]
    ds_read_b64_tr_b16 a[240:241], v62 offset:24576
    v_cvt_pk_bf16_f32 v73, v74, v75
    v_mfma_f32_16x16x32_bf16 v[88:91], a[224:227], v[240:243], v[88:91]
    ds_read_b64_tr_b16 a[242:243], v62 offset:26624
    v_cvt_pk_bf16_f32 v74, v76, v77
    v_mfma_f32_16x16x32_bf16 v[88:91], a[228:231], v[244:247], v[88:91]
    s_waitcnt lgkmcnt(4)
    ds_read_b64_tr_b16 a[244:245], v62 offset:28672
    v_cvt_pk_bf16_f32 v75, v78, v79
    v_mfma_f32_16x16x32_bf16 v[84:87], a[232:235], v[224:227], v[84:87]
    s_waitcnt lgkmcnt(3)
    ds_read_b64_tr_b16 a[246:247], v62 offset:30720
    v_min_u32 v72, -2, v72
    v_mfma_f32_16x16x32_bf16 v[84:87], a[236:239], v[228:231], v[84:87]
    ds_read_b64_tr_b16 a[248:249], v63 offset:24576
    v_min_u32 v73, -2, v73
    v_mfma_f32_16x16x32_bf16 v[92:95], a[232:235], v[240:243], v[92:95]
    ds_read_b64_tr_b16 a[250:251], v63 offset:26624
    v_min_u32 v74, -2, v74
    v_mfma_f32_16x16x32_bf16 v[92:95], a[236:239], v[244:247], v[92:95]
    s_waitcnt lgkmcnt(4)
    ds_read_b64_tr_b16 a[252:253], v63 offset:28672
    v_min_u32 v75, -2, v75
    v_mfma_f32_16x16x32_bf16 v[80:83], a[240:243], v[232:235], v[80:83]
    s_waitcnt lgkmcnt(3)
    s_add_u32 s75, s18, 8519680
    ds_read_b64_tr_b16 a[254:255], v63 offset:30720
    s_waitcnt vmcnt(8)
    v_mul_f32 v8, v48, v168
    v_mfma_f32_16x16x32_bf16 v[80:83], a[244:247], v[236:239], v[80:83]
    buffer_store_dwordx4 v[72:75], v23, s[8:11], s75 offen offset:0 sc0 sc1
    v_mfma_f32_16x16x32_bf16 v[88:91], a[240:243], v[248:251], v[88:91]
    ds_read_b64_tr_b16 a[192:193], v60 offset:32768
    v_mul_f32 v9, v49, v169
    v_mfma_f32_16x16x32_bf16 v[88:91], a[244:247], v[252:255], v[88:91]
    s_waitcnt lgkmcnt(3)
    ds_read_b64_tr_b16 a[194:195], v60 offset:34816
    v_mul_f32 v10, v50, v170
    v_mfma_f32_16x16x32_bf16 v[84:87], a[248:251], v[232:235], v[84:87]
    s_waitcnt lgkmcnt(2)
    ds_read_b64_tr_b16 a[196:197], v60 offset:36864
    v_mul_f32 v11, v51, v171
    v_mfma_f32_16x16x32_bf16 v[84:87], a[252:255], v[236:239], v[84:87]
    ds_read_b64_tr_b16 a[198:199], v60 offset:38912
    s_waitcnt vmcnt(8)
    v_mul_f32 v12, v52, v172
    v_mfma_f32_16x16x32_bf16 v[92:95], a[248:251], v[248:251], v[92:95]
    ds_read_b64_tr_b16 a[200:201], v61 offset:32768
    v_mul_f32 v13, v53, v173
    v_mfma_f32_16x16x32_bf16 v[92:95], a[252:255], v[252:255], v[92:95]
    s_waitcnt lgkmcnt(3)
    ds_read_b64_tr_b16 a[202:203], v61 offset:34816
    v_mul_f32 v14, v54, v174
    v_mfma_f32_16x16x32_bf16 v[96:99], a[192:195], v[192:195], v[96:99]
    s_waitcnt lgkmcnt(2)
    ds_read_b64_tr_b16 a[204:205], v61 offset:36864
    v_mul_f32 v15, v55, v175
    v_mfma_f32_16x16x32_bf16 v[96:99], a[196:199], v[196:199], v[96:99]
    ds_read_b64_tr_b16 a[206:207], v61 offset:38912
    s_waitcnt vmcnt(7)
    v_mul_f32 v16, v48, v176
    v_mfma_f32_16x16x32_bf16 v[104:107], a[192:195], v[208:211], v[104:107]
    ds_read_b64_tr_b16 a[208:209], v60 offset:40960
    v_fmac_f32 v16, v49, v177
    v_mfma_f32_16x16x32_bf16 v[104:107], a[196:199], v[212:215], v[104:107]
    s_waitcnt lgkmcnt(3)
    ds_read_b64_tr_b16 a[210:211], v60 offset:43008
    v_fmac_f32 v16, v50, v178
    v_mfma_f32_16x16x32_bf16 v[100:103], a[200:203], v[192:195], v[100:103]
    s_waitcnt lgkmcnt(2)
    ds_read_b64_tr_b16 a[212:213], v60 offset:45056
    v_fmac_f32 v16, v51, v179
    v_mfma_f32_16x16x32_bf16 v[100:103], a[204:207], v[196:199], v[100:103]
    ds_read_b64_tr_b16 a[214:215], v60 offset:47104
    s_waitcnt vmcnt(6)
    v_fmac_f32 v16, v52, v180
    v_mfma_f32_16x16x32_bf16 v[108:111], a[200:203], v[208:211], v[108:111]
    ds_read_b64_tr_b16 a[216:217], v61 offset:40960
    v_cvt_pk_bf16_f32 v80, v80, v81
    v_mfma_f32_16x16x32_bf16 v[108:111], a[204:207], v[212:215], v[108:111]
    s_waitcnt lgkmcnt(3)
    ds_read_b64_tr_b16 a[218:219], v61 offset:43008
    v_cvt_pk_bf16_f32 v81, v82, v83
    v_mfma_f32_16x16x32_bf16 v[96:99], a[208:211], v[200:203], v[96:99]
    s_waitcnt lgkmcnt(2)
    ds_read_b64_tr_b16 a[220:221], v61 offset:45056
    v_cvt_pk_bf16_f32 v82, v84, v85
    v_mfma_f32_16x16x32_bf16 v[96:99], a[212:215], v[204:207], v[96:99]
    ds_read_b64_tr_b16 a[222:223], v61 offset:47104
    v_cvt_pk_bf16_f32 v83, v86, v87
    v_mfma_f32_16x16x32_bf16 v[104:107], a[208:211], v[216:219], v[104:107]
    ds_read_b64_tr_b16 a[224:225], v60 offset:49152
    v_min_u32 v80, -2, v80
    v_mfma_f32_16x16x32_bf16 v[104:107], a[212:215], v[220:223], v[104:107]
    s_waitcnt lgkmcnt(3)
    ds_read_b64_tr_b16 a[226:227], v60 offset:51200
    v_min_u32 v81, -2, v81
    v_mfma_f32_16x16x32_bf16 v[100:103], a[216:219], v[200:203], v[100:103]
    s_waitcnt lgkmcnt(2)
    ds_read_b64_tr_b16 a[228:229], v60 offset:53248
    v_min_u32 v82, -2, v82
    v_mfma_f32_16x16x32_bf16 v[100:103], a[220:223], v[204:207], v[100:103]
    ds_read_b64_tr_b16 a[230:231], v60 offset:55296
    v_min_u32 v83, -2, v83
    v_mfma_f32_16x16x32_bf16 v[108:111], a[216:219], v[216:219], v[108:111]
    s_waitcnt lgkmcnt(2)
    s_add_u32 s75, s18, 8388608
    ds_read_b64_tr_b16 a[232:233], v61 offset:49152
    v_fmac_f32 v16, v53, v181
    v_mfma_f32_16x16x32_bf16 v[108:111], a[220:223], v[220:223], v[108:111]
    buffer_store_dwordx4 v[80:83], v23, s[8:11], s75 offen offset:256 sc0 sc1
    ds_read_b64_tr_b16 a[234:235], v61 offset:51200
    v_mfma_f32_16x16x32_bf16 v[96:99], a[224:227], v[224:227], v[96:99]
    s_waitcnt lgkmcnt(2)
    ds_read_b64_tr_b16 a[236:237], v61 offset:53248
    v_cvt_pk_bf16_f32 v88, v88, v89
    v_mfma_f32_16x16x32_bf16 v[96:99], a[228:231], v[228:231], v[96:99]
    ds_read_b64_tr_b16 a[238:239], v61 offset:55296
    v_cvt_pk_bf16_f32 v89, v90, v91
    v_mfma_f32_16x16x32_bf16 v[104:107], a[224:227], v[240:243], v[104:107]
    ds_read_b64_tr_b16 a[240:241], v60 offset:57344
    v_cvt_pk_bf16_f32 v90, v92, v93
    v_mfma_f32_16x16x32_bf16 v[104:107], a[228:231], v[244:247], v[104:107]
    s_waitcnt lgkmcnt(3)
    ds_read_b64_tr_b16 a[242:243], v60 offset:59392
    v_cvt_pk_bf16_f32 v91, v94, v95
    v_mfma_f32_16x16x32_bf16 v[100:103], a[232:235], v[224:227], v[100:103]
    s_waitcnt lgkmcnt(2)
    ds_read_b64_tr_b16 a[244:245], v60 offset:61440
    v_min_u32 v88, -2, v88
    v_mfma_f32_16x16x32_bf16 v[100:103], a[236:239], v[228:231], v[100:103]
    ds_read_b64_tr_b16 a[246:247], v60 offset:63488
    v_min_u32 v89, -2, v89
    v_mfma_f32_16x16x32_bf16 v[108:111], a[232:235], v[240:243], v[108:111]
    ds_read_b64_tr_b16 a[248:249], v61 offset:57344
    v_min_u32 v90, -2, v90
    v_mfma_f32_16x16x32_bf16 v[108:111], a[236:239], v[244:247], v[108:111]
    s_waitcnt lgkmcnt(3)
    ds_read_b64_tr_b16 a[250:251], v61 offset:59392
    v_fmac_f32 v16, v54, v182
    v_mfma_f32_16x16x32_bf16 v[96:99], a[240:243], v[232:235], v[96:99]
    s_waitcnt lgkmcnt(2)
    s_add_u32 s74, s70, 0
    ds_read_b64_tr_b16 a[252:253], v61 offset:61440
    v_min_u32 v91, -2, v91
    v_mfma_f32_16x16x32_bf16 v[96:99], a[244:247], v[236:239], v[96:99]
    buffer_load_dwordx4 v[128:131], v44, s[8:11], s74 offen sc0 sc1
    ds_read_b64_tr_b16 a[254:255], v61 offset:63488
    v_mfma_f32_16x16x32_bf16 v[104:107], a[240:243], v[248:251], v[104:107]
    s_add_u32 s74, s70, 4096
    ds_read_b64_tr_b16 a[192:193], v62 offset:32768
    v_fmac_f32 v16, v55, v183
    v_mfma_f32_16x16x32_bf16 v[104:107], a[244:247], v[252:255], v[104:107]
    s_waitcnt lgkmcnt(1)
    s_add_u32 s75, s18, 8519680
    ds_read_b64_tr_b16 a[194:195], v62 offset:34816
    v_add_f32_dpp v16, v16, v16 quad_perm:[1,0,3,2] row_mask:0xf bank_mask:0xf
    v_mfma_f32_16x16x32_bf16 v[100:103], a[248:251], v[232:235], v[100:103]
    buffer_store_dwordx4 v[88:91], v23, s[8:11], s75 offen offset:256 sc0 sc1
    ds_read_b64_tr_b16 a[196:197], v62 offset:36864
    v_mfma_f32_16x16x32_bf16 v[100:103], a[252:255], v[236:239], v[100:103]
    buffer_load_dwordx4 v[132:135], v44, s[8:11], s74 offen sc0 sc1
    ds_read_b64_tr_b16 a[198:199], v62 offset:38912
    v_mfma_f32_16x16x32_bf16 v[108:111], a[248:251], v[248:251], v[108:111]
    s_add_u32 s74, s70, 8192
    ds_read_b64_tr_b16 a[200:201], v63 offset:32768
    v_add_f32_dpp v16, v16, v16 quad_perm:[2,3,0,1] row_mask:0xf bank_mask:0xf
    v_mfma_f32_16x16x32_bf16 v[108:111], a[252:255], v[252:255], v[108:111]
    s_waitcnt lgkmcnt(3)
    ds_read_b64_tr_b16 a[202:203], v63 offset:34816
    v_add_f32_dpp v16, v16, v16 row_half_mirror row_mask:0xf bank_mask:0xf
    v_mfma_f32_16x16x32_bf16 v[112:115], a[192:195], v[192:195], v[112:115]
    s_waitcnt lgkmcnt(2)
    ds_read_b64_tr_b16 a[204:205], v63 offset:36864
    v_add_f32_dpp v16, v16, v16 row_mirror row_mask:0xf bank_mask:0xf
    v_mfma_f32_16x16x32_bf16 v[112:115], a[196:199], v[196:199], v[112:115]
    buffer_load_dwordx4 v[136:139], v44, s[8:11], s74 offen sc0 sc1
    ds_read_b64_tr_b16 a[206:207], v63 offset:38912
    v_mfma_f32_16x16x32_bf16 v[120:123], a[192:195], v[208:211], v[120:123]
    s_add_u32 s74, s70, 12288
    ds_read_b64_tr_b16 a[208:209], v62 offset:40960
    v_mov_b32 v19, v16
    v_mfma_f32_16x16x32_bf16 v[120:123], a[196:199], v[212:215], v[120:123]
    s_waitcnt lgkmcnt(3)
    ds_read_b64_tr_b16 a[210:211], v62 offset:43008
    v_permlane16_swap_b32 v16, v19
    v_mfma_f32_16x16x32_bf16 v[116:119], a[200:203], v[192:195], v[116:119]
    s_waitcnt lgkmcnt(2)
    ds_read_b64_tr_b16 a[212:213], v62 offset:45056
    v_add_f32 v16, v16, v19
    v_mfma_f32_16x16x32_bf16 v[116:119], a[204:207], v[196:199], v[116:119]
    buffer_load_dwordx4 v[140:143], v44, s[8:11], s74 offen sc0 sc1
    ds_read_b64_tr_b16 a[214:215], v62 offset:47104
    v_mfma_f32_16x16x32_bf16 v[124:127], a[200:203], v[208:211], v[124:127]
    s_add_u32 s74, s70, 16384
    ds_read_b64_tr_b16 a[216:217], v63 offset:40960
    v_cvt_pk_bf16_f32 v96, v96, v97
    v_mfma_f32_16x16x32_bf16 v[124:127], a[204:207], v[212:215], v[124:127]
    s_waitcnt lgkmcnt(3)
    ds_read_b64_tr_b16 a[218:219], v63 offset:43008
    v_cvt_pk_bf16_f32 v97, v98, v99
    v_mfma_f32_16x16x32_bf16 v[112:115], a[208:211], v[200:203], v[112:115]
    s_waitcnt lgkmcnt(2)
    ds_read_b64_tr_b16 a[220:221], v63 offset:45056
    v_cvt_pk_bf16_f32 v98, v100, v101
    v_mfma_f32_16x16x32_bf16 v[112:115], a[212:215], v[204:207], v[112:115]
    buffer_load_dwordx4 v[144:147], v44, s[8:11], s74 offen sc0 sc1
    ds_read_b64_tr_b16 a[222:223], v63 offset:47104
    v_mfma_f32_16x16x32_bf16 v[120:123], a[208:211], v[216:219], v[120:123]
    s_add_u32 s74, s70, 20480
    ds_read_b64_tr_b16 a[224:225], v62 offset:49152
    v_cvt_pk_bf16_f32 v99, v102, v103
    v_mfma_f32_16x16x32_bf16 v[120:123], a[212:215], v[220:223], v[120:123]
    s_waitcnt lgkmcnt(3)
    ds_read_b64_tr_b16 a[226:227], v62 offset:51200
    v_min_u32 v96, -2, v96
    v_mfma_f32_16x16x32_bf16 v[116:119], a[216:219], v[200:203], v[116:119]
    s_waitcnt lgkmcnt(2)
    ds_read_b64_tr_b16 a[228:229], v62 offset:53248
    v_min_u32 v97, -2, v97
    v_mfma_f32_16x16x32_bf16 v[116:119], a[220:223], v[204:207], v[116:119]
    buffer_load_dwordx4 v[148:151], v44, s[8:11], s74 offen sc0 sc1
    ds_read_b64_tr_b16 a[230:231], v62 offset:55296
    v_mfma_f32_16x16x32_bf16 v[124:127], a[216:219], v[216:219], v[124:127]
    s_add_u32 s74, s70, 24576
    ds_read_b64_tr_b16 a[232:233], v63 offset:49152
    v_min_u32 v98, -2, v98
    v_mfma_f32_16x16x32_bf16 v[124:127], a[220:223], v[220:223], v[124:127]
    s_waitcnt lgkmcnt(3)
    ds_read_b64_tr_b16 a[234:235], v63 offset:51200
    v_min_u32 v99, -2, v99
    v_mfma_f32_16x16x32_bf16 v[112:115], a[224:227], v[224:227], v[112:115]
    s_waitcnt lgkmcnt(2)
    s_add_u32 s75, s18, 8388608
    ds_read_b64_tr_b16 a[236:237], v63 offset:53248
    v_mov_b32 v19, v16
    v_mfma_f32_16x16x32_bf16 v[112:115], a[228:231], v[228:231], v[112:115]
    buffer_load_dwordx4 v[152:155], v44, s[8:11], s74 offen sc0 sc1
    ds_read_b64_tr_b16 a[238:239], v63 offset:55296
    v_mfma_f32_16x16x32_bf16 v[120:123], a[224:227], v[240:243], v[120:123]
    s_waitcnt lgkmcnt(2)
    s_add_u32 s74, s70, 28672
    ds_read_b64_tr_b16 a[240:241], v62 offset:57344
    v_permlane32_swap_b32 v16, v19
    v_mfma_f32_16x16x32_bf16 v[120:123], a[228:231], v[244:247], v[120:123]
    buffer_store_dwordx4 v[96:99], v23, s[8:11], s75 offen offset:512 sc0 sc1
    ds_read_b64_tr_b16 a[242:243], v62 offset:59392
    v_add_f32 v16, v16, v19
    v_mfma_f32_16x16x32_bf16 v[116:119], a[232:235], v[224:227], v[116:119]
    s_waitcnt lgkmcnt(2)
    ds_read_b64_tr_b16 a[244:245], v62 offset:61440
    v_cvt_pk_bf16_f32 v104, v104, v105
    v_mfma_f32_16x16x32_bf16 v[116:119], a[236:239], v[228:231], v[116:119]
    buffer_load_dwordx4 v[156:159], v44, s[8:11], s74 offen sc0 sc1
    ds_read_b64_tr_b16 a[246:247], v62 offset:63488
    v_mfma_f32_16x16x32_bf16 v[124:127], a[232:235], v[240:243], v[124:127]
    ds_read_b64_tr_b16 a[248:249], v63 offset:57344
    v_cvt_pk_bf16_f32 v105, v106, v107
    v_mfma_f32_16x16x32_bf16 v[124:127], a[236:239], v[244:247], v[124:127]
    s_waitcnt lgkmcnt(3)
    ds_read_b64_tr_b16 a[250:251], v63 offset:59392
    v_cvt_pk_bf16_f32 v106, v108, v109
    v_mfma_f32_16x16x32_bf16 v[112:115], a[240:243], v[232:235], v[112:115]
    s_waitcnt lgkmcnt(2)
    ds_read_b64_tr_b16 a[252:253], v63 offset:61440
    v_cvt_pk_bf16_f32 v107, v110, v111
    v_mfma_f32_16x16x32_bf16 v[112:115], a[244:247], v[236:239], v[112:115]
    ds_read_b64_tr_b16 a[254:255], v63 offset:63488
    v_min_u32 v104, -2, v104
    v_mfma_f32_16x16x32_bf16 v[120:123], a[240:243], v[248:251], v[120:123]
    v_min_u32 v105, -2, v105
    v_mfma_f32_16x16x32_bf16 v[120:123], a[244:247], v[252:255], v[120:123]
    s_waitcnt lgkmcnt(2)
    v_min_u32 v106, -2, v106
    v_mfma_f32_16x16x32_bf16 v[116:119], a[248:251], v[232:235], v[116:119]
    s_waitcnt lgkmcnt(0)
    v_min_u32 v107, -2, v107
    v_mfma_f32_16x16x32_bf16 v[116:119], a[252:255], v[236:239], v[116:119]
    s_add_u32 s75, s18, 8519680
    v_mfma_f32_16x16x32_bf16 v[124:127], a[248:251], v[248:251], v[124:127]
    buffer_store_dwordx4 v[104:107], v23, s[8:11], s75 offen offset:512 sc0 sc1
    v_mfma_f32_16x16x32_bf16 v[124:127], a[252:255], v[252:255], v[124:127]
    v_cvt_pk_bf16_f32 v112, v112, v113
    v_cvt_pk_bf16_f32 v113, v114, v115
    s_nop 1
    v_cvt_pk_bf16_f32 v114, v116, v117
    v_cvt_pk_bf16_f32 v115, v118, v119
    v_min_u32 v112, -2, v112
    v_min_u32 v113, -2, v113
    v_min_u32 v114, -2, v114
    v_min_u32 v115, -2, v115
    s_add_u32 s75, s18, 8388608
    buffer_store_dwordx4 v[112:115], v23, s[8:11], s75 offen offset:768 sc0 sc1
    v_cvt_pk_bf16_f32 v120, v120, v121
    v_cvt_pk_bf16_f32 v121, v122, v123
    v_cvt_pk_bf16_f32 v122, v124, v125
    v_cvt_pk_bf16_f32 v123, v126, v127
    v_min_u32 v120, -2, v120
    v_min_u32 v121, -2, v121
    v_min_u32 v122, -2, v122
    v_min_u32 v123, -2, v123
    s_add_u32 s75, s18, 8519680
    buffer_store_dwordx4 v[120:123], v23, s[8:11], s75 offen offset:768 sc0 sc1
    s_mov_b32 s12, 0xf000f0
    s_mov_b32 s13, 0xf000f0
    v_mov_b64 v[192:193], -1
    v_mov_b64 v[194:195], -1
    v_mov_b64 v[196:197], -1
    v_mov_b64 v[198:199], -1
    v_mov_b64 v[200:201], -1
    v_mov_b64 v[202:203], -1
    v_mov_b64 v[204:205], -1
    v_mov_b64 v[206:207], -1
    v_mov_b64 v[208:209], -1
    v_mov_b64 v[210:211], -1
    v_mov_b64 v[212:213], -1
    v_mov_b64 v[214:215], -1
    v_mov_b64 v[216:217], -1
    v_mov_b64 v[218:219], -1
    v_mov_b64 v[220:221], -1
    v_mov_b64 v[222:223], -1
    s_mov_b64 exec, s[12:13]
    s_add_u32 s74, s70, 8388608
    buffer_load_dwordx4 v[192:195], v44, s[8:11], s74 offen sc0 sc1
    s_add_u32 s74, s70, 8392704
    buffer_load_dwordx4 v[196:199], v44, s[8:11], s74 offen sc0 sc1
    s_add_u32 s74, s70, 8396800
    buffer_load_dwordx4 v[200:203], v44, s[8:11], s74 offen sc0 sc1
    s_add_u32 s74, s70, 8400896
    buffer_load_dwordx4 v[204:207], v44, s[8:11], s74 offen sc0 sc1
    s_add_u32 s74, s70, 8404992
    buffer_load_dwordx4 v[208:211], v44, s[8:11], s74 offen sc0 sc1
    s_add_u32 s74, s70, 8409088
    buffer_load_dwordx4 v[212:215], v44, s[8:11], s74 offen sc0 sc1
    s_add_u32 s74, s70, 8413184
    buffer_load_dwordx4 v[216:219], v44, s[8:11], s74 offen sc0 sc1
    s_add_u32 s74, s70, 8417280
    buffer_load_dwordx4 v[220:223], v44, s[8:11], s74 offen sc0 sc1
    s_mov_b64 exec, -1
    v_mov_b32 v100, 0x3f80
    v_mov_b32 v101, 0x3f800000
    v_lshlrev_b32 v88, 16, v36
    v_and_b32 v89, 0xffff0000, v36
    v_lshlrev_b32 v90, 16, v37
    v_and_b32 v91, 0xffff0000, v37
    v_lshlrev_b32 v92, 16, v38
    v_and_b32 v93, 0xffff0000, v38
    v_lshlrev_b32 v94, 16, v39
    v_and_b32 v95, 0xffff0000, v39
    v_lshlrev_b32 v72, 16, v32
    v_and_b32 v73, 0xffff0000, v32
    v_lshlrev_b32 v74, 16, v33
    v_and_b32 v75, 0xffff0000, v33
    v_lshlrev_b32 v76, 16, v34
    v_and_b32 v77, 0xffff0000, v34
    v_lshlrev_b32 v78, 16, v35
    v_and_b32 v79, 0xffff0000, v35
    s_waitcnt vmcnt(20)
    v_max_u32 v3, v128, v129
    v_max3_u32 v3, v3, v130, v131
    s_waitcnt vmcnt(18)
    v_max3_u32 v3, v3, v132, v133
    v_max3_u32 v3, v3, v134, v135
    s_waitcnt vmcnt(17)
    v_max3_u32 v3, v3, v136, v137
    v_max3_u32 v3, v3, v138, v139
    s_waitcnt vmcnt(16)
    v_max3_u32 v3, v3, v140, v141
    v_max3_u32 v3, v3, v142, v143
    s_waitcnt vmcnt(15)
    v_max3_u32 v3, v3, v144, v145
    v_max3_u32 v3, v3, v146, v147
    s_waitcnt vmcnt(14)
    v_max3_u32 v3, v3, v148, v149
    v_max3_u32 v3, v3, v150, v151
    s_waitcnt vmcnt(13)
    v_max3_u32 v3, v3, v152, v153
    v_max3_u32 v3, v3, v154, v155
    s_waitcnt vmcnt(11)
    v_max3_u32 v3, v3, v156, v157
    v_max3_u32 v3, v3, v158, v159
    v_cmp_eq_u32 vcc, -1, v3
    s_cbranch_vccnz L_P1_slow_15
L_P1_ok_16:
    v_lshlrev_b32 v64, 16, v128
    v_and_b32 v65, 0xffff0000, v128
    v_lshlrev_b32 v66, 16, v129
    v_and_b32 v67, 0xffff0000, v129
    v_lshlrev_b32 v68, 16, v130
    v_and_b32 v69, 0xffff0000, v130
    v_lshlrev_b32 v70, 16, v131
    v_and_b32 v71, 0xffff0000, v131
    v_dot2c_f32_bf16 v64, v132, v100
    v_dot2c_f32_bf16 v65, v132, v101
    v_dot2c_f32_bf16 v66, v133, v100
    v_dot2c_f32_bf16 v67, v133, v101
    v_dot2c_f32_bf16 v68, v134, v100
    v_dot2c_f32_bf16 v69, v134, v101
    v_dot2c_f32_bf16 v70, v135, v100
    v_dot2c_f32_bf16 v71, v135, v101
    v_dot2c_f32_bf16 v64, v136, v100
    v_dot2c_f32_bf16 v65, v136, v101
    v_dot2c_f32_bf16 v66, v137, v100
    v_dot2c_f32_bf16 v67, v137, v101
    v_dot2c_f32_bf16 v68, v138, v100
    v_dot2c_f32_bf16 v69, v138, v101
    v_dot2c_f32_bf16 v70, v139, v100
    v_dot2c_f32_bf16 v71, v139, v101
    v_dot2c_f32_bf16 v64, v140, v100
    v_dot2c_f32_bf16 v65, v140, v101
    v_dot2c_f32_bf16 v66, v141, v100
    v_dot2c_f32_bf16 v67, v141, v101
    v_dot2c_f32_bf16 v68, v142, v100
    v_dot2c_f32_bf16 v69, v142, v101
    v_dot2c_f32_bf16 v70, v143, v100
    v_dot2c_f32_bf16 v71, v143, v101
    v_dot2c_f32_bf16 v64, v144, v100
    v_dot2c_f32_bf16 v65, v144, v101
    v_dot2c_f32_bf16 v66, v145, v100
    v_dot2c_f32_bf16 v67, v145, v101
    v_dot2c_f32_bf16 v68, v146, v100
    v_dot2c_f32_bf16 v69, v146, v101
    v_dot2c_f32_bf16 v70, v147, v100
    v_dot2c_f32_bf16 v71, v147, v101
    v_dot2c_f32_bf16 v64, v148, v100
    v_dot2c_f32_bf16 v65, v148, v101
    v_dot2c_f32_bf16 v66, v149, v100
    v_dot2c_f32_bf16 v67, v149, v101
    v_dot2c_f32_bf16 v68, v150, v100
    v_dot2c_f32_bf16 v69, v150, v101
    v_dot2c_f32_bf16 v70, v151, v100
    v_dot2c_f32_bf16 v71, v151, v101
    v_dot2c_f32_bf16 v64, v152, v100
    v_dot2c_f32_bf16 v65, v152, v101
    v_dot2c_f32_bf16 v66, v153, v100
    v_dot2c_f32_bf16 v67, v153, v101
    v_dot2c_f32_bf16 v68, v154, v100
    v_dot2c_f32_bf16 v69, v154, v101
    v_dot2c_f32_bf16 v70, v155, v100
    v_dot2c_f32_bf16 v71, v155, v101
    v_dot2c_f32_bf16 v64, v156, v100
    v_dot2c_f32_bf16 v65, v156, v101
    v_dot2c_f32_bf16 v66, v157, v100
    v_dot2c_f32_bf16 v67, v157, v101
    v_dot2c_f32_bf16 v68, v158, v100
    v_dot2c_f32_bf16 v69, v158, v101
    v_dot2c_f32_bf16 v70, v159, v100
    v_dot2c_f32_bf16 v71, v159, v101
    v_pk_fma_f32 v[64:65], v[64:65], v[160:161], v[72:73]
    v_pk_fma_f32 v[66:67], v[66:67], v[162:163], v[74:75]
    v_pk_fma_f32 v[68:69], v[68:69], v[164:165], v[76:77]
    v_pk_fma_f32 v[70:71], v[70:71], v[166:167], v[78:79]
    v_cvt_pk_bf16_f32 v32, v64, v65
    v_cvt_pk_bf16_f32 v33, v66, v67
    v_cvt_pk_bf16_f32 v34, v68, v69
    v_cvt_pk_bf16_f32 v35, v70, v71
    v_lshlrev_b32 v64, 16, v32
    v_and_b32 v65, 0xffff0000, v32
    v_lshlrev_b32 v66, 16, v33
    v_and_b32 v67, 0xffff0000, v33
    v_lshlrev_b32 v68, 16, v34
    v_and_b32 v69, 0xffff0000, v34
    v_lshlrev_b32 v70, 16, v35
    v_and_b32 v71, 0xffff0000, v35
    v_pk_add_f32 v[48:49], v[64:65], v[66:67]
    v_pk_add_f32 v[50:51], v[68:69], v[70:71]
    v_pk_add_f32 v[48:49], v[48:49], v[50:51]
    v_add_f32 v48, v48, v49
    s_nop 1
    v_add_f32_dpp v48, v48, v48 quad_perm:[1,0,3,2] row_mask:0xf bank_mask:0xf
    s_nop 1
    v_add_f32_dpp v48, v48, v48 quad_perm:[2,3,0,1] row_mask:0xf bank_mask:0xf
    s_nop 1
    v_add_f32_dpp v48, v48, v48 row_half_mirror row_mask:0xf bank_mask:0xf
    s_nop 1
    v_add_f32_dpp v48, v48, v48 row_mirror row_mask:0xf bank_mask:0xf
    v_mov_b32 v49, v48
    s_nop 1
    v_permlane16_swap_b32 v48, v49
    v_add_f32 v48, v48, v49
    v_mov_b32 v49, v48
    s_nop 1
    v_permlane32_swap_b32 v48, v49
    v_add_f32 v48, v48, v49
    v_mul_f32 v48, 0xbb000000, v48
    v_pk_add_f32 v[72:73], v[64:65], v[48:49] op_sel_hi:[1,0]
    v_pk_add_f32 v[74:75], v[66:67], v[48:49] op_sel_hi:[1,0]
    v_pk_add_f32 v[76:77], v[68:69], v[48:49] op_sel_hi:[1,0]
    v_pk_add_f32 v[78:79], v[70:71], v[48:49] op_sel_hi:[1,0]
    v_pk_mul_f32 v[50:51], v[72:73], v[72:73]
    v_pk_mul_f32 v[52:53], v[72:73], v[8:9]
    v_pk_fma_f32 v[50:51], v[74:75], v[74:75], v[50:51]
    v_pk_fma_f32 v[52:53], v[74:75], v[10:11], v[52:53]
    v_pk_fma_f32 v[50:51], v[76:77], v[76:77], v[50:51]
    v_pk_fma_f32 v[52:53], v[76:77], v[12:13], v[52:53]
    v_pk_fma_f32 v[50:51], v[78:79], v[78:79], v[50:51]
    v_pk_fma_f32 v[52:53], v[78:79], v[14:15], v[52:53]
    v_add_f32 v50, v50, v51
    v_add_f32 v52, v52, v53
    s_nop 0
    v_add_f32_dpp v50, v50, v50 quad_perm:[1,0,3,2] row_mask:0xf bank_mask:0xf
    v_add_f32_dpp v52, v52, v52 quad_perm:[1,0,3,2] row_mask:0xf bank_mask:0xf
    s_nop 0
    v_add_f32_dpp v50, v50, v50 quad_perm:[2,3,0,1] row_mask:0xf bank_mask:0xf
    v_add_f32_dpp v52, v52, v52 quad_perm:[2,3,0,1] row_mask:0xf bank_mask:0xf
    s_nop 0
    v_add_f32_dpp v50, v50, v50 row_half_mirror row_mask:0xf bank_mask:0xf
    v_add_f32_dpp v52, v52, v52 row_half_mirror row_mask:0xf bank_mask:0xf
    s_nop 0
    v_add_f32_dpp v50, v50, v50 row_mirror row_mask:0xf bank_mask:0xf
    v_add_f32_dpp v52, v52, v52 row_mirror row_mask:0xf bank_mask:0xf
    v_mov_b32 v51, v50
    v_mov_b32 v53, v52
    s_nop 0
    v_permlane16_swap_b32 v50, v51
    v_permlane16_swap_b32 v52, v53
    v_add_f32 v50, v50, v51
    v_add_f32 v52, v52, v53
    v_mov_b32 v51, v50
    v_mov_b32 v53, v52
    s_nop 0
    v_permlane32_swap_b32 v50, v51
    v_permlane32_swap_b32 v52, v53
    v_add_f32 v50, v50, v51
    v_add_f32 v52, v52, v53
    v_mov_b32 v48, 0x3727c5ac
    v_fmac_f32 v48, 0x3b000000, v50
    v_rsq_f32 v48, v48
    s_nop 0
    v_fma_f32 v52, v52, v48, v16
    v_ashrrev_i32 v53, 31, v52
    v_or_b32 v53, 0x80000000, v53
    v_xor_b32 v53, v53, v52
    v_and_b32 v53, 0xfffff800, v53
    v_or_b32 v17, s68, v53
    v_pk_mul_f32 v[72:73], v[72:73], v[48:49] op_sel_hi:[1,0]
    v_pk_mul_f32 v[74:75], v[74:75], v[48:49] op_sel_hi:[1,0]
    v_pk_mul_f32 v[76:77], v[76:77], v[48:49] op_sel_hi:[1,0]
    v_pk_mul_f32 v[78:79], v[78:79], v[48:49] op_sel_hi:[1,0]
    v_pk_fma_f32 v[72:73], v[72:73], v[168:169], v[176:177]
    v_pk_fma_f32 v[74:75], v[74:75], v[170:171], v[178:179]
    v_pk_fma_f32 v[76:77], v[76:77], v[172:173], v[180:181]
    v_pk_fma_f32 v[78:79], v[78:79], v[174:175], v[182:183]
    v_cvt_pk_bf16_f32 v20, v72, v73
    v_cvt_pk_bf16_f32 v21, v74, v75
    v_cvt_pk_bf16_f32 v22, v76, v77
    v_cvt_pk_bf16_f32 v23, v78, v79
    v_lshlrev_b32 v98, 4, v0
    v_cmp_gt_u32 vcc, 224, v0
    v_mov_b32 v99, 2147479552
    s_nop 0
    v_cndmask_b32 v99, v99, v98, vcc
    s_lshl_b32 s17, s66, 13
    s_add_u32 s17, s17, 4194304
    s_cmp_lt_u32 s66, 224
    s_cselect_b32 s17, s17, 2143285248
    s_lshl_b32 s100, s3, 2
    v_mov_b32 v47, s100
    v_mov_b32 v102, 0
    s_lshl_b32 s100, s2, 6
    s_add_u32 s100, s100, 65536
    s_lshl_b32 s101, s2, 11
    s_add_u32 s101, s101, 524288
    s_branch L_pg_17
.p2align 12
L_pg_17:
    s_mov_b32 s99, 0
L_P2_l_18:
    s_waitcnt vmcnt(0)
    v_max_u32 v48, v192, v193
    v_max3_u32 v48, v48, v194, v195
    v_max_u32 v49, v196, v197
    v_max3_u32 v49, v49, v198, v199
    v_max_u32 v50, v200, v201
    v_max3_u32 v50, v50, v202, v203
    v_max_u32 v51, v204, v205
    v_max3_u32 v51, v51, v206, v207
    v_max_u32 v52, v208, v209
    v_max3_u32 v52, v52, v210, v211
    v_max_u32 v53, v212, v213
    v_max3_u32 v53, v53, v214, v215
    v_max_u32 v54, v216, v217
    v_max3_u32 v54, v54, v218, v219
    v_max_u32 v55, v220, v221
    v_max3_u32 v55, v55, v222, v223
    v_max3_u32 v3, v48, v49, v50
    v_max3_u32 v3, v3, v51, v52
    v_max3_u32 v3, v3, v53, v54
    v_max_u32 v3, v3, v55
    v_cmp_eq_u32 vcc, -1, v3
    s_add_u32 s99, s99, 1
    s_cbranch_vccz L_P2_ok_19
    s_cmp_ge_u32 s99, 200000
    s_cbranch_scc1 L_P2_ok_19
    s_sleep 1
    v_cmp_eq_u32 vcc, -1, v48
    s_cbranch_vccz L_P2_s_20
    s_and_b64 s[96:97], vcc, s[12:13]
    s_cselect_b64 exec, s[96:97], vcc
    s_add_u32 s74, s70, 8388608
    buffer_load_dwordx4 v[192:195], v44, s[8:11], s74 offen sc0 sc1
    s_mov_b64 exec, -1
L_P2_s_20:
    v_cmp_eq_u32 vcc, -1, v49
    s_cbranch_vccz L_P2_s_21
    s_and_b64 s[96:97], vcc, s[12:13]
    s_cselect_b64 exec, s[96:97], vcc
    s_add_u32 s74, s70, 8392704
    buffer_load_dwordx4 v[196:199], v44, s[8:11], s74 offen sc0 sc1
    s_mov_b64 exec, -1
L_P2_s_21:
    v_cmp_eq_u32 vcc, -1, v50
    s_cbranch_vccz L_P2_s_22
    s_and_b64 s[96:97], vcc, s[12:13]
    s_cselect_b64 exec, s[96:97], vcc
    s_add_u32 s74, s70, 8396800
    buffer_load_dwordx4 v[200:203], v44, s[8:11], s74 offen sc0 sc1
    s_mov_b64 exec, -1
L_P2_s_22:
    v_cmp_eq_u32 vcc, -1, v51
    s_cbranch_vccz L_P2_s_23
    s_and_b64 s[96:97], vcc, s[12:13]
    s_cselect_b64 exec, s[96:97], vcc
    s_add_u32 s74, s70, 8400896
    buffer_load_dwordx4 v[204:207], v44, s[8:11], s74 offen sc0 sc1
    s_mov_b64 exec, -1
L_P2_s_23:
    v_cmp_eq_u32 vcc, -1, v52
    s_cbranch_vccz L_P2_s_24
    s_and_b64 s[96:97], vcc, s[12:13]
    s_cselect_b64 exec, s[96:97], vcc
    s_add_u32 s74, s70, 8404992
    buffer_load_dwordx4 v[208:211], v44, s[8:11], s74 offen sc0 sc1
    s_mov_b64 exec, -1
L_P2_s_24:
    v_cmp_eq_u32 vcc, -1, v53
    s_cbranch_vccz L_P2_s_25
    s_and_b64 s[96:97], vcc, s[12:13]
    s_cselect_b64 exec, s[96:97], vcc
    s_add_u32 s74, s70, 8409088
    buffer_load_dwordx4 v[212:215], v44, s[8:11], s74 offen sc0 sc1
    s_mov_b64 exec, -1
L_P2_s_25:
    v_cmp_eq_u32 vcc, -1, v54
    s_cbranch_vccz L_P2_s_26
    s_and_b64 s[96:97], vcc, s[12:13]
    s_cselect_b64 exec, s[96:97], vcc
    s_add_u32 s74, s70, 8413184
    buffer_load_dwordx4 v[216:219], v44, s[8:11], s74 offen sc0 sc1
    s_mov_b64 exec, -1
L_P2_s_26:
    v_cmp_eq_u32 vcc, -1, v55
    s_cbranch_vccz L_P2_s_27
    s_and_b64 s[96:97], vcc, s[12:13]
    s_cselect_b64 exec, s[96:97], vcc
    s_add_u32 s74, s70, 8417280
    buffer_load_dwordx4 v[220:223], v44, s[8:11], s74 offen sc0 sc1
    s_mov_b64 exec, -1
L_P2_s_27:
    s_branch L_P2_l_18
L_P2_ok_19:
    v_lshlrev_b32 v80, 16, v192
    v_and_b32 v81, 0xffff0000, v192
    v_lshlrev_b32 v82, 16, v193
    v_and_b32 v83, 0xffff0000, v193
    v_lshlrev_b32 v84, 16, v194
    v_and_b32 v85, 0xffff0000, v194
    v_lshlrev_b32 v86, 16, v195
    v_and_b32 v87, 0xffff0000, v195
    v_dot2c_f32_bf16 v80, v196, v100
    v_dot2c_f32_bf16 v81, v196, v101
    v_dot2c_f32_bf16 v82, v197, v100
    v_dot2c_f32_bf16 v83, v197, v101
    v_dot2c_f32_bf16 v84, v198, v100
    v_dot2c_f32_bf16 v85, v198, v101
    v_dot2c_f32_bf16 v86, v199, v100
    v_dot2c_f32_bf16 v87, v199, v101
    v_dot2c_f32_bf16 v80, v200, v100
    v_dot2c_f32_bf16 v81, v200, v101
    v_dot2c_f32_bf16 v82, v201, v100
    v_dot2c_f32_bf16 v83, v201, v101
    v_dot2c_f32_bf16 v84, v202, v100
    v_dot2c_f32_bf16 v85, v202, v101
    v_dot2c_f32_bf16 v86, v203, v100
    v_dot2c_f32_bf16 v87, v203, v101
    v_dot2c_f32_bf16 v80, v204, v100
    v_dot2c_f32_bf16 v81, v204, v101
    v_dot2c_f32_bf16 v82, v205, v100
    v_dot2c_f32_bf16 v83, v205, v101
    v_dot2c_f32_bf16 v84, v206, v100
    v_dot2c_f32_bf16 v85, v206, v101
    v_dot2c_f32_bf16 v86, v207, v100
    v_dot2c_f32_bf16 v87, v207, v101
    v_dot2c_f32_bf16 v80, v208, v100
    v_dot2c_f32_bf16 v81, v208, v101
    v_dot2c_f32_bf16 v82, v209, v100
    v_dot2c_f32_bf16 v83, v209, v101
    v_dot2c_f32_bf16 v84, v210, v100
    v_dot2c_f32_bf16 v85, v210, v101
    v_dot2c_f32_bf16 v86, v211, v100
    v_dot2c_f32_bf16 v87, v211, v101
    v_dot2c_f32_bf16 v80, v212, v100
    v_dot2c_f32_bf16 v81, v212, v101
    v_dot2c_f32_bf16 v82, v213, v100
    v_dot2c_f32_bf16 v83, v213, v101
    v_dot2c_f32_bf16 v84, v214, v100
    v_dot2c_f32_bf16 v85, v214, v101
    v_dot2c_f32_bf16 v86, v215, v100
    v_dot2c_f32_bf16 v87, v215, v101
    v_dot2c_f32_bf16 v80, v216, v100
    v_dot2c_f32_bf16 v81, v216, v101
    v_dot2c_f32_bf16 v82, v217, v100
    v_dot2c_f32_bf16 v83, v217, v101
    v_dot2c_f32_bf16 v84, v218, v100
    v_dot2c_f32_bf16 v85, v218, v101
    v_dot2c_f32_bf16 v86, v219, v100
    v_dot2c_f32_bf16 v87, v219, v101
    v_dot2c_f32_bf16 v80, v220, v100
    v_dot2c_f32_bf16 v81, v220, v101
    v_dot2c_f32_bf16 v82, v221, v100
    v_dot2c_f32_bf16 v83, v221, v101
    v_dot2c_f32_bf16 v84, v222, v100
    v_dot2c_f32_bf16 v85, v222, v101
    v_dot2c_f32_bf16 v86, v223, v100
    v_dot2c_f32_bf16 v87, v223, v101
    v_pk_fma_f32 v[80:81], v[80:81], v[160:161], v[88:89]
    v_pk_fma_f32 v[82:83], v[82:83], v[162:163], v[90:91]
    v_pk_fma_f32 v[84:85], v[84:85], v[164:165], v[92:93]
    v_pk_fma_f32 v[86:87], v[86:87], v[166:167], v[94:95]
    v_cvt_pk_bf16_f32 v36, v80, v81
    v_cvt_pk_bf16_f32 v37, v82, v83
    v_cvt_pk_bf16_f32 v38, v84, v85
    v_cvt_pk_bf16_f32 v39, v86, v87
    v_lshlrev_b32 v80, 16, v36
    v_and_b32 v81, 0xffff0000, v36
    v_lshlrev_b32 v82, 16, v37
    v_and_b32 v83, 0xffff0000, v37
    v_lshlrev_b32 v84, 16, v38
    v_and_b32 v85, 0xffff0000, v38
    v_lshlrev_b32 v86, 16, v39
    v_and_b32 v87, 0xffff0000, v39
    v_pk_add_f32 v[48:49], v[80:81], v[82:83]
    v_pk_add_f32 v[50:51], v[84:85], v[86:87]
    v_pk_add_f32 v[48:49], v[48:49], v[50:51]
    v_add_f32 v48, v48, v49
    s_nop 1
    v_add_f32_dpp v48, v48, v48 quad_perm:[1,0,3,2] row_mask:0xf bank_mask:0xf
    s_nop 1
    v_add_f32_dpp v48, v48, v48 quad_perm:[2,3,0,1] row_mask:0xf bank_mask:0xf
    s_nop 1
    v_add_f32_dpp v48, v48, v48 row_half_mirror row_mask:0xf bank_mask:0xf
    s_nop 1
    v_add_f32_dpp v48, v48, v48 row_mirror row_mask:0xf bank_mask:0xf
    v_mov_b32 v49, v48
    s_nop 1
    v_permlane16_swap_b32 v48, v49
    v_add_f32 v48, v48, v49
    v_mov_b32 v49, v48
    s_nop 1
    v_permlane32_swap_b32 v48, v49
    v_add_f32 v48, v48, v49
    v_mul_f32 v48, 0xbb000000, v48
    v_pk_add_f32 v[88:89], v[80:81], v[48:49] op_sel_hi:[1,0]
    v_pk_add_f32 v[90:91], v[82:83], v[48:49] op_sel_hi:[1,0]
    v_pk_add_f32 v[92:93], v[84:85], v[48:49] op_sel_hi:[1,0]
    v_pk_add_f32 v[94:95], v[86:87], v[48:49] op_sel_hi:[1,0]
    v_pk_mul_f32 v[50:51], v[88:89], v[88:89]
    v_pk_mul_f32 v[52:53], v[88:89], v[8:9]
    v_pk_fma_f32 v[50:51], v[90:91], v[90:91], v[50:51]
    v_pk_fma_f32 v[52:53], v[90:91], v[10:11], v[52:53]
    v_pk_fma_f32 v[50:51], v[92:93], v[92:93], v[50:51]
    v_pk_fma_f32 v[52:53], v[92:93], v[12:13], v[52:53]
    v_pk_fma_f32 v[50:51], v[94:95], v[94:95], v[50:51]
    v_pk_fma_f32 v[52:53], v[94:95], v[14:15], v[52:53]
    v_add_f32 v50, v50, v51
    v_add_f32 v52, v52, v53
    s_nop 0
    v_add_f32_dpp v50, v50, v50 quad_perm:[1,0,3,2] row_mask:0xf bank_mask:0xf
    v_add_f32_dpp v52, v52, v52 quad_perm:[1,0,3,2] row_mask:0xf bank_mask:0xf
    s_nop 0
    v_add_f32_dpp v50, v50, v50 quad_perm:[2,3,0,1] row_mask:0xf bank_mask:0xf
    v_add_f32_dpp v52, v52, v52 quad_perm:[2,3,0,1] row_mask:0xf bank_mask:0xf
    s_nop 0
    v_add_f32_dpp v50, v50, v50 row_half_mirror row_mask:0xf bank_mask:0xf
    v_add_f32_dpp v52, v52, v52 row_half_mirror row_mask:0xf bank_mask:0xf
    s_nop 0
    v_add_f32_dpp v50, v50, v50 row_mirror row_mask:0xf bank_mask:0xf
    v_add_f32_dpp v52, v52, v52 row_mirror row_mask:0xf bank_mask:0xf
    v_mov_b32 v51, v50
    v_mov_b32 v53, v52
    s_nop 0
    v_permlane16_swap_b32 v50, v51
    v_permlane16_swap_b32 v52, v53
    v_add_f32 v50, v50, v51
    v_add_f32 v52, v52, v53
    v_mov_b32 v51, v50
    v_mov_b32 v53, v52
    s_nop 0
    v_permlane32_swap_b32 v50, v51
    v_permlane32_swap_b32 v52, v53
    v_add_f32 v50, v50, v51
    v_add_f32 v52, v52, v53
    v_mov_b32 v48, 0x3727c5ac
    v_fmac_f32 v48, 0x3b000000, v50
    v_rsq_f32 v48, v48
    s_nop 0
    v_fma_f32 v52, v52, v48, v16
    v_ashrrev_i32 v53, 31, v52
    v_or_b32 v53, 0x80000000, v53
    v_xor_b32 v53, v53, v52
    v_and_b32 v53, 0xfffff800, v53
    v_or_b32 v18, s69, v53
    v_max3_u32 v19, v17, v18, 1
    ds_write_b32 v47, v19
    s_waitcnt lgkmcnt(0)
    s_barrier
    ds_read_b128 v[52:55], v102
    v_pk_mul_f32 v[88:89], v[88:89], v[48:49] op_sel_hi:[1,0]
    v_pk_mul_f32 v[90:91], v[90:91], v[48:49] op_sel_hi:[1,0]
    v_pk_mul_f32 v[92:93], v[92:93], v[48:49] op_sel_hi:[1,0]
    v_pk_mul_f32 v[94:95], v[94:95], v[48:49] op_sel_hi:[1,0]
    v_pk_fma_f32 v[88:89], v[88:89], v[168:169], v[176:177]
    v_pk_fma_f32 v[90:91], v[90:91], v[170:171], v[178:179]
    v_pk_fma_f32 v[92:93], v[92:93], v[172:173], v[180:181]
    v_pk_fma_f32 v[94:95], v[94:95], v[174:175], v[182:183]
    v_cvt_pk_bf16_f32 v24, v88, v89
    v_cvt_pk_bf16_f32 v25, v90, v91
    v_cvt_pk_bf16_f32 v26, v92, v93
    v_cvt_pk_bf16_f32 v27, v94, v95
    s_waitcnt lgkmcnt(0)
    v_max_u32 v52, v52, v53
    v_max3_u32 v52, v52, v54, v55
    v_cmp_eq_u32 vcc, v52, v19
    s_cbranch_vccz L_notbest
    buffer_store_dword v19, v5, s[8:11], s100 offen sc0 sc1
    v_cmp_gt_u32 vcc, v17, v18
    s_nop 1
    v_cndmask_b32 v28, v24, v20, vcc
    v_cndmask_b32 v40, v36, v32, vcc
    v_cndmask_b32 v29, v25, v21, vcc
    v_cndmask_b32 v41, v37, v33, vcc
    v_cndmask_b32 v30, v26, v22, vcc
    v_cndmask_b32 v42, v38, v34, vcc
    v_cndmask_b32 v31, v27, v23, vcc
    v_cndmask_b32 v43, v39, v35, vcc
    v_min_u32 v28, -2, v28
    v_min_u32 v40, -2, v40
    v_min_u32 v29, -2, v29
    v_min_u32 v41, -2, v41
    v_min_u32 v30, -2, v30
    v_min_u32 v42, -2, v42
    v_min_u32 v31, -2, v31
    v_min_u32 v43, -2, v43
    buffer_store_dwordx4 v[28:31], v1, s[8:11], s101 offen sc0 sc1
    buffer_store_dwordx4 v[40:43], v1, s[8:11], s101 offen offset:1024 sc0 sc1
L_notbest:
    buffer_load_dwordx4 v[112:115], v98, s[8:11], s17 offen
    s_add_u32 s17, s17, 4096
    buffer_load_dwordx4 v[116:119], v98, s[8:11], s17 offen
    s_add_u32 s17, s17, 2093056
    buffer_load_dwordx4 v[120:123], v98, s[8:11], s17 offen
    s_add_u32 s17, s17, 4096
    buffer_load_dwordx4 v[124:127], v98, s[8:11], s17 offen
    s_mul_i32 s17, s67, 28672
    s_add_u32 s17, s17, 8388608
    s_cmp_lt_u32 s67, 64
    s_cselect_b32 s17, s17, 2143285248
    buffer_load_dwordx4 v[128:131], v99, s[8:11], s17 offen offset:0
    buffer_load_dwordx4 v[132:135], v99, s[8:11], s17 offen offset:3584
    s_add_u32 s17, s17, 7168
    buffer_load_dwordx4 v[136:139], v99, s[8:11], s17 offen offset:0
    buffer_load_dwordx4 v[140:143], v99, s[8:11], s17 offen offset:3584
    s_add_u32 s17, s17, 7168
    buffer_load_dwordx4 v[144:147], v99, s[8:11], s17 offen offset:0
    buffer_load_dwordx4 v[148:151], v99, s[8:11], s17 offen offset:3584
    s_add_u32 s17, s17, 7168
    buffer_load_dwordx4 v[152:155], v99, s[8:11], s17 offen offset:0
    buffer_load_dwordx4 v[156:159], v99, s[8:11], s17 offen offset:3584
    v_lshlrev_b32 v72, 16, v20
    v_and_b32 v73, 0xffff0000, v20
    v_lshlrev_b32 v74, 16, v21
    v_and_b32 v75, 0xffff0000, v21
    v_lshlrev_b32 v76, 16, v22
    v_and_b32 v77, 0xffff0000, v22
    v_lshlrev_b32 v78, 16, v23
    v_and_b32 v79, 0xffff0000, v23
    v_pk_mul_f32 v[72:73], v[72:73], v[184:185]
    v_pk_mul_f32 v[74:75], v[74:75], v[186:187]
    v_pk_mul_f32 v[76:77], v[76:77], v[188:189]
    v_pk_mul_f32 v[78:79], v[78:79], v[190:191]
    v_cvt_pk_bf16_f32 v56, v72, v73
    v_cvt_pk_bf16_f32 v57, v74, v75
    v_cvt_pk_bf16_f32 v58, v76, v77
    v_cvt_pk_bf16_f32 v59, v78, v79
    v_lshlrev_b32 v72, 16, v56
    v_and_b32 v73, 0xffff0000, v56
    v_lshlrev_b32 v74, 16, v57
    v_and_b32 v75, 0xffff0000, v57
    v_lshlrev_b32 v76, 16, v58
    v_and_b32 v77, 0xffff0000, v58
    v_lshlrev_b32 v78, 16, v59
    v_and_b32 v79, 0xffff0000, v59
    v_pk_add_f32 v[72:73], v[72:73], v[64:65]
    v_pk_add_f32 v[74:75], v[74:75], v[66:67]
    v_pk_add_f32 v[76:77], v[76:77], v[68:69]
    v_pk_add_f32 v[78:79], v[78:79], v[70:71]
    v_cvt_pk_bf16_f32 v56, v72, v73
    v_cvt_pk_bf16_f32 v57, v74, v75
    v_cvt_pk_bf16_f32 v58, v76, v77
    v_cvt_pk_bf16_f32 v59, v78, v79
    v_lshlrev_b32 v88, 16, v24
    v_and_b32 v89, 0xffff0000, v24
    v_lshlrev_b32 v90, 16, v25
    v_and_b32 v91, 0xffff0000, v25
    v_lshlrev_b32 v92, 16, v26
    v_and_b32 v93, 0xffff0000, v26
    v_lshlrev_b32 v94, 16, v27
    v_and_b32 v95, 0xffff0000, v27
    v_pk_mul_f32 v[88:89], v[88:89], v[184:185]
    v_pk_mul_f32 v[90:91], v[90:91], v[186:187]
    v_pk_mul_f32 v[92:93], v[92:93], v[188:189]
    v_pk_mul_f32 v[94:95], v[94:95], v[190:191]
    v_cvt_pk_bf16_f32 v60, v88, v89
    v_cvt_pk_bf16_f32 v61, v90, v91
    v_cvt_pk_bf16_f32 v62, v92, v93
    v_cvt_pk_bf16_f32 v63, v94, v95
    v_lshlrev_b32 v88, 16, v60
    v_and_b32 v89, 0xffff0000, v60
    v_lshlrev_b32 v90, 16, v61
    v_and_b32 v91, 0xffff0000, v61
    v_lshlrev_b32 v92, 16, v62
    v_and_b32 v93, 0xffff0000, v62
    v_lshlrev_b32 v94, 16, v63
    v_and_b32 v95, 0xffff0000, v63
    v_pk_add_f32 v[88:89], v[88:89], v[80:81]
    v_pk_add_f32 v[90:91], v[90:91], v[82:83]
    v_pk_add_f32 v[92:93], v[92:93], v[84:85]
    v_pk_add_f32 v[94:95], v[94:95], v[86:87]
    v_cvt_pk_bf16_f32 v60, v88, v89
    v_cvt_pk_bf16_f32 v61, v90, v91
    v_cvt_pk_bf16_f32 v62, v92, v93
    v_cvt_pk_bf16_f32 v63, v94, v95
    v_lshlrev_b32 v4, 6, v0
    s_mov_b32 s71, 65536
    s_mov_b32 s99, 0
    s_branch L_pg_28
.p2align 12
L_pg_28:
L_kl:
    buffer_load_dword v3, v4, s[8:11], s71 offen sc0 sc1
    s_add_u32 s99, s99, 1
    s_waitcnt vmcnt(0)
    v_cmp_eq_u32 vcc, 0, v3
    s_cbranch_vccz L_kd
    s_cmp_ge_u32 s99, 200000
    s_cbranch_scc1 L_kd
    s_mov_b64 exec, vcc
    s_sleep 2
    s_branch L_kl
L_kd:
    s_mov_b64 exec, -1
    v_max_u32_dpp v3, v3, v3 quad_perm:[1,0,3,2] row_mask:0xf bank_mask:0xf
    s_nop 1
    v_max_u32_dpp v3, v3, v3 quad_perm:[2,3,0,1] row_mask:0xf bank_mask:0xf
    s_nop 1
    v_max_u32_dpp v3, v3, v3 row_half_mirror row_mask:0xf bank_mask:0xf
    s_nop 1
    v_max_u32_dpp v3, v3, v3 row_mirror row_mask:0xf bank_mask:0xf
    v_mov_b32 v19, v3
    s_nop 1
    v_permlane16_swap_b32 v3, v19
    v_max_u32 v3, v3, v19
    v_mov_b32 v19, v3
    s_nop 1
    v_permlane32_swap_b32 v3, v19
    v_max_u32 v3, v3, v19
    ds_write_b32 v47, v3 offset:64
    s_waitcnt lgkmcnt(0)
    s_barrier
    ds_read_b128 v[52:55], v102 offset:64
    v_lshlrev_b32 v4, 2, v0
    s_waitcnt lgkmcnt(0)
    v_max_u32 v52, v52, v53
    v_max3_u32 v52, v52, v54, v55
    s_nop 0
    v_readfirstlane_b32 s71, v52
    s_and_b32 s72, s71, 2047
    s_lshr_b32 s100, s72, 7
    s_sub_u32 s101, 15, s100
    s_min_u32 s100, s100, s101
    s_lshl_b32 s100, s100, 16
    s_and_b32 s101, s72, 1024
    s_cmp_eq_u32 s101, 0
    s_cselect_b32 s73, 31, 31
    s_lshr_b32 s101, s72, 2
    s_and_b32 s73, s73, s101
    s_lshl_b32 s73, s73, 2
    s_lshl_b32 s73, s73, 9
    s_add_u32 s73, s73, s100
    s_add_u32 s73, s73, 524288
    buffer_load_dword v19, v4, s[8:11], s73 offen sc0 sc1
    s_lshl_b32 s100, s68, 10
    s_cmp_eq_u32 s68, s72
    s_cselect_b32 s100, 2147479552, s100
    buffer_store_dwordx2 v[56:57], v45, s[52:55], s100 offen
    buffer_store_dwordx2 v[58:59], v45, s[52:55], s100 offen offset:32
    s_lshl_b32 s100, s69, 10
    s_cmp_eq_u32 s69, s72
    s_cselect_b32 s100, 2147479552, s100
    buffer_store_dwordx2 v[60:61], v45, s[52:55], s100 offen
    buffer_store_dwordx2 v[62:63], v45, s[52:55], s100 offen offset:32
    s_cmp_ge_u32 s66, 224
    s_cbranch_scc1 L_nprod
    v_lshlrev_b32 v160, 16, v112
    v_and_b32 v161, 0xffff0000, v112
    v_lshlrev_b32 v162, 16, v113
    v_and_b32 v163, 0xffff0000, v113
    v_lshlrev_b32 v164, 16, v114
    v_and_b32 v165, 0xffff0000, v114
    v_lshlrev_b32 v166, 16, v115
    v_and_b32 v167, 0xffff0000, v115
    v_lshlrev_b32 v168, 16, v116
    v_and_b32 v169, 0xffff0000, v116
    v_lshlrev_b32 v170, 16, v117
    v_and_b32 v171, 0xffff0000, v117
    v_lshlrev_b32 v172, 16, v118
    v_and_b32 v173, 0xffff0000, v118
    v_lshlrev_b32 v174, 16, v119
    v_and_b32 v175, 0xffff0000, v119
    v_lshlrev_b32 v176, 16, v120
    v_and_b32 v177, 0xffff0000, v120
    v_lshlrev_b32 v178, 16, v121
    v_and_b32 v179, 0xffff0000, v121
    v_lshlrev_b32 v180, 16, v122
    v_and_b32 v181, 0xffff0000, v122
    v_lshlrev_b32 v182, 16, v123
    v_and_b32 v183, 0xffff0000, v123
    v_lshlrev_b32 v184, 16, v124
    v_and_b32 v185, 0xffff0000, v124
    v_lshlrev_b32 v186, 16, v125
    v_and_b32 v187, 0xffff0000, v125
    v_lshlrev_b32 v188, 16, v126
    v_and_b32 v189, 0xffff0000, v126
    v_lshlrev_b32 v190, 16, v127
    v_and_b32 v191, 0xffff0000, v127
    s_mov_b32 s99, 0
    s_waitcnt vmcnt(4)
L_hl:
    v_cmp_eq_u32 vcc, -1, v19
    s_add_u32 s99, s99, 1
    s_cbranch_vccz L_hok
    s_cmp_ge_u32 s99, 200000
    s_cbranch_scc1 L_hok
    buffer_load_dword v19, v4, s[8:11], s73 offen sc0 sc1
    s_waitcnt vmcnt(0)
    s_branch L_hl
L_hok:
    v_lshlrev_b32 v48, 16, v19
    v_and_b32 v50, 0xffff0000, v19
    v_pk_mul_f32 v[64:65], v[160:161], v[48:49] op_sel_hi:[1,0]
    v_pk_mul_f32 v[66:67], v[162:163], v[48:49] op_sel_hi:[1,0]
    v_pk_mul_f32 v[68:69], v[164:165], v[48:49] op_sel_hi:[1,0]
    v_pk_mul_f32 v[70:71], v[166:167], v[48:49] op_sel_hi:[1,0]
    v_pk_mul_f32 v[72:73], v[176:177], v[48:49] op_sel_hi:[1,0]
    v_pk_mul_f32 v[74:75], v[178:179], v[48:49] op_sel_hi:[1,0]
    v_pk_mul_f32 v[76:77], v[180:181], v[48:49] op_sel_hi:[1,0]
    v_pk_mul_f32 v[78:79], v[182:183], v[48:49] op_sel_hi:[1,0]
    v_pk_fma_f32 v[64:65], v[168:169], v[50:51], v[64:65] op_sel_hi:[1,0,1]
    v_pk_fma_f32 v[66:67], v[170:171], v[50:51], v[66:67] op_sel_hi:[1,0,1]
    v_pk_fma_f32 v[68:69], v[172:173], v[50:51], v[68:69] op_sel_hi:[1,0,1]
    v_pk_fma_f32 v[70:71], v[174:175], v[50:51], v[70:71] op_sel_hi:[1,0,1]
    v_pk_fma_f32 v[72:73], v[184:185], v[50:51], v[72:73] op_sel_hi:[1,0,1]
    v_pk_fma_f32 v[74:75], v[186:187], v[50:51], v[74:75] op_sel_hi:[1,0,1]
    v_pk_fma_f32 v[76:77], v[188:189], v[50:51], v[76:77] op_sel_hi:[1,0,1]
    v_pk_fma_f32 v[78:79], v[190:191], v[50:51], v[78:79] op_sel_hi:[1,0,1]
    v_permlane32_swap_b32 v64, v72
    v_permlane32_swap_b32 v65, v73
    v_permlane32_swap_b32 v66, v74
    v_permlane32_swap_b32 v67, v75
    v_permlane32_swap_b32 v68, v76
    v_permlane32_swap_b32 v69, v77
    v_permlane32_swap_b32 v70, v78
    v_permlane32_swap_b32 v71, v79
    v_add_f32 v64, v64, v72
    v_add_f32 v65, v65, v73
    v_add_f32 v66, v66, v74
    v_add_f32 v67, v67, v75
    v_add_f32 v68, v68, v76
    v_add_f32 v69, v69, v77
    v_add_f32 v70, v70, v78
    v_add_f32 v71, v71, v79
    v_permlane16_swap_b32 v64, v68
    v_permlane16_swap_b32 v65, v69
    v_permlane16_swap_b32 v66, v70
    v_permlane16_swap_b32 v67, v71
    v_add_f32 v64, v64, v68
    v_add_f32 v65, v65, v69
    v_add_f32 v66, v66, v70
    v_add_f32 v67, v67, v71
    v_add_f32_dpp v64, v64, v64 quad_perm:[1,0,3,2] row_mask:0xf bank_mask:0xf
    v_add_f32_dpp v65, v65, v65 quad_perm:[1,0,3,2] row_mask:0xf bank_mask:0xf
    v_add_f32_dpp v66, v66, v66 quad_perm:[1,0,3,2] row_mask:0xf bank_mask:0xf
    v_add_f32_dpp v67, v67, v67 quad_perm:[1,0,3,2] row_mask:0xf bank_mask:0xf
    v_add_f32_dpp v64, v64, v64 quad_perm:[2,3,0,1] row_mask:0xf bank_mask:0xf
    v_add_f32_dpp v65, v65, v65 quad_perm:[2,3,0,1] row_mask:0xf bank_mask:0xf
    v_add_f32_dpp v66, v66, v66 quad_perm:[2,3,0,1] row_mask:0xf bank_mask:0xf
    v_add_f32_dpp v67, v67, v67 quad_perm:[2,3,0,1] row_mask:0xf bank_mask:0xf
    v_add_f32_dpp v64, v64, v64 row_half_mirror row_mask:0xf bank_mask:0xf
    v_add_f32_dpp v65, v65, v65 row_half_mirror row_mask:0xf bank_mask:0xf
    v_add_f32_dpp v66, v66, v66 row_half_mirror row_mask:0xf bank_mask:0xf
    v_add_f32_dpp v67, v67, v67 row_half_mirror row_mask:0xf bank_mask:0xf
    v_add_f32_dpp v64, v64, v64 row_mirror row_mask:0xf bank_mask:0xf
    v_add_f32_dpp v65, v65, v65 row_mirror row_mask:0xf bank_mask:0xf
    v_add_f32_dpp v66, v66, v66 row_mirror row_mask:0xf bank_mask:0xf
    v_add_f32_dpp v67, v67, v67 row_mirror row_mask:0xf bank_mask:0xf
    v_and_b32 v50, 15, v2
    v_cmp_eq_u32 vcc, 0, v50
    v_mov_b32 v51, 1024
    s_nop 0
    v_cndmask_b32 v51, v51, v0, vcc
    ds_write_b128 v51, v[64:67] offset:256
    v_lshlrev_b32 v50, 2, v50
    s_waitcnt lgkmcnt(0)
    s_barrier
    s_cmp_lg_u32 s3, 0
    s_cbranch_scc1 L_nprod
    ds_read_b32 v64, v50 offset:256
    ds_read_b32 v65, v50 offset:320
    ds_read_b32 v66, v50 offset:384
    ds_read_b32 v67, v50 offset:448
    v_cmp_gt_u32 vcc, 8, v2
    v_mov_b32 v51, 2147479552
    s_nop 0
    v_cndmask_b32 v51, v51, v50, vcc
    s_lshl_b32 s100, s66, 6
    s_add_u32 s100, s100, 81920
    s_waitcnt lgkmcnt(2)
    v_add_f32 v64, v64, v65
    s_waitcnt lgkmcnt(0)
    v_add_f32 v66, v66, v67
    v_add_f32 v64, v64, v66
    v_cvt_pk_bf16_f32 v64, v64, v64
    v_and_b32 v64, 0xffff0000, v64
    s_nop 1
    v_mov_b32_dpp v65, v64 row_ror:8 row_mask:0xf bank_mask:0xf
    v_mul_f32 v66, 0xbfb8aa3b, v64
    v_exp_f32 v66, v66
    s_nop 0
    v_add_f32 v66, 1.0, v66
    v_rcp_f32 v66, v66
    s_nop 0
    v_mul_f32 v64, v64, v66
    v_cvt_pk_bf16_f32 v64, v64, v64
    v_and_b32 v64, 0xffff0000, v64
    v_mul_f32 v64, v64, v65
    v_cvt_pk_bf16_f32 v64, v64, v64
    v_and_b32 v64, 0xffff0000, v64
    buffer_store_dword v64, v51, s[8:11], s100 offen sc0 sc1
L_nprod:
    s_cmp_ge_u32 s67, 64
    s_cbranch_scc1 L_fin
    v_lshlrev_b32 v4, 6, v0
    v_cmp_gt_u32 vcc, 224, v0
    v_mov_b32 v51, 2147479552
    s_nop 0
    v_cndmask_b32 v4, v51, v4, vcc
    s_mov_b32 s100, 81920
    v_and_b32 v52, 7, v2
    s_lshl_b32 s101, s67, 3
    v_add_u32 v52, s101, v52
    v_lshrrev_b32 v53, 5, v52
    v_lshlrev_b32 v53, 6, v53
    v_and_b32 v54, 12, v52
    v_lshl_add_u32 v53, v54, 2, v53
    v_bfe_u32 v54, v52, 4, 1
    v_lshl_add_u32 v53, v54, 3, v53
    v_and_b32 v54, 2, v52
    v_lshl_add_u32 v53, v54, 1, v53
    v_lshlrev_b32 v54, 2, v52
    s_mov_b32 s101, 10240
    buffer_load_dword v55, v54, s[8:11], s101 offen
    buffer_load_dword v88, v53, s[8:11], s73 offen sc0 sc1
    buffer_load_dword v89, v53, s[8:11], s73 offen offset:1024 sc0 sc1
    v_lshlrev_b32 v192, 16, v128
    v_and_b32 v193, 0xffff0000, v128
    v_lshlrev_b32 v194, 16, v129
    v_and_b32 v195, 0xffff0000, v129
    v_lshlrev_b32 v196, 16, v130
    v_and_b32 v197, 0xffff0000, v130
    v_lshlrev_b32 v198, 16, v131
    v_and_b32 v199, 0xffff0000, v131
    v_lshlrev_b32 v200, 16, v132
    v_and_b32 v201, 0xffff0000, v132
    v_lshlrev_b32 v202, 16, v133
    v_and_b32 v203, 0xffff0000, v133
    v_lshlrev_b32 v204, 16, v134
    v_and_b32 v205, 0xffff0000, v134
    v_lshlrev_b32 v206, 16, v135
    v_and_b32 v207, 0xffff0000, v135
    v_lshlrev_b32 v208, 16, v136
    v_and_b32 v209, 0xffff0000, v136
    v_lshlrev_b32 v210, 16, v137
    v_and_b32 v211, 0xffff0000, v137
    v_lshlrev_b32 v212, 16, v138
    v_and_b32 v213, 0xffff0000, v138
    v_lshlrev_b32 v214, 16, v139
    v_and_b32 v215, 0xffff0000, v139
    v_lshlrev_b32 v216, 16, v140
    v_and_b32 v217, 0xffff0000, v140
    v_lshlrev_b32 v218, 16, v141
    v_and_b32 v219, 0xffff0000, v141
    v_lshlrev_b32 v220, 16, v142
    v_and_b32 v221, 0xffff0000, v142
    v_lshlrev_b32 v222, 16, v143
    v_and_b32 v223, 0xffff0000, v143
    v_lshlrev_b32 v224, 16, v144
    v_and_b32 v225, 0xffff0000, v144
    v_lshlrev_b32 v226, 16, v145
    v_and_b32 v227, 0xffff0000, v145
    v_lshlrev_b32 v228, 16, v146
    v_and_b32 v229, 0xffff0000, v146
    v_lshlrev_b32 v230, 16, v147
    v_and_b32 v231, 0xffff0000, v147
    v_lshlrev_b32 v232, 16, v148
    v_and_b32 v233, 0xffff0000, v148
    v_lshlrev_b32 v234, 16, v149
    v_and_b32 v235, 0xffff0000, v149
    v_lshlrev_b32 v236, 16, v150
    v_and_b32 v237, 0xffff0000, v150
    v_lshlrev_b32 v238, 16, v151
    v_and_b32 v239, 0xffff0000, v151
    v_lshlrev_b32 v240, 16, v152
    v_and_b32 v241, 0xffff0000, v152
    v_lshlrev_b32 v242, 16, v153
    v_and_b32 v243, 0xffff0000, v153
    v_lshlrev_b32 v244, 16, v154
    v_and_b32 v245, 0xffff0000, v154
    v_lshlrev_b32 v246, 16, v155
    v_and_b32 v247, 0xffff0000, v155
    v_lshlrev_b32 v248, 16, v156
    v_and_b32 v249, 0xffff0000, v156
    v_lshlrev_b32 v250, 16, v157
    v_and_b32 v251, 0xffff0000, v157
    v_lshlrev_b32 v252, 16, v158
    v_and_b32 v253, 0xffff0000, v158
    v_lshlrev_b32 v254, 16, v159
    v_and_b32 v255, 0xffff0000, v159
    s_and_b32 s101, s71, 0xfffff800
    s_or_b32 s101, s101, 0x400
    v_mov_b32 v90, s101
    v_not_b32 v91, v90
    v_ashrrev_i32 v91, 31, v91
    v_or_b32 v91, 0x80000000, v91
    v_xor_b32 v90, v90, v91
    v_cvt_pk_bf16_f32 v90, v90, v90
    v_and_b32 v90, 0xffff0000, v90
    v_mul_f32 v90, 0xbfb8aa3b, v90
    v_exp_f32 v90, v90
    s_nop 0
    v_add_f32 v90, 1.0, v90
    v_rcp_f32 v90, v90
    s_nop 0
    v_cvt_pk_bf16_f32 v90, v90, v90
    v_and_b32 v90, 0xffff0000, v90
    s_mov_b32 s99, 0
L_CND_l_29:
    s_waitcnt vmcnt(0)
    v_max_u32 v3, v88, v89
    v_cmp_eq_u32 vcc, -1, v3
    s_add_u32 s99, s99, 1
    s_cbranch_vccz L_CND_ok_30
    s_cmp_ge_u32 s99, 200000
    s_cbranch_scc1 L_CND_ok_30
    s_mov_b64 exec, vcc
    s_sleep 1
    buffer_load_dword v88, v53, s[8:11], s73 offen sc0 sc1
    buffer_load_dword v89, v53, s[8:11], s73 offen offset:1024 sc0 sc1
    s_branch L_CND_l_29
L_CND_ok_30:
    s_mov_b64 exec, -1
    v_and_b32 v51, 1, v52
    v_cmp_eq_u32 vcc, 0, v51
    v_lshlrev_b32 v91, 16, v88
    v_and_b32 v88, 0xffff0000, v88
    v_cndmask_b32 v88, v88, v91, vcc
    v_lshlrev_b32 v91, 16, v89
    v_and_b32 v89, 0xffff0000, v89
    v_cndmask_b32 v89, v89, v91, vcc
    v_and_b32 v50, 15, v2
    v_cmp_eq_u32 vcc, 0, v50
    v_lshrrev_b32 v51, 1, v0
    v_mov_b32 v50, 1024
    v_cndmask_b32 v51, v50, v51, vcc
    v_and_b32 v50, 7, v2
    v_lshlrev_b32 v50, 2, v50
    v_cmp_gt_u32 vcc, 8, v2
    v_lshlrev_b32 v52, 1, v52
    v_mov_b32 v53, 2147479552
    v_cndmask_b32 v52, v53, v52, vcc
    s_cmp_lt_u32 s66, 224
    s_cbranch_scc1 L_asl
    s_sleep 16
L_asl:
    s_sleep 7
    buffer_load_dwordx4 v[80:83], v4, s[8:11], s100 offen sc0 sc1
    buffer_load_dwordx4 v[84:87], v4, s[8:11], s100 offen offset:16 sc0 sc1
    s_mov_b32 s99, 0
L_ACT_l_31:
    s_waitcnt vmcnt(0)
    v_max_u32 v3, v80, v81
    v_max3_u32 v3, v3, v82, v83
    v_max3_u32 v3, v3, v84, v85
    v_max3_u32 v3, v3, v86, v87
    v_cmp_eq_u32 vcc, -1, v3
    s_add_u32 s99, s99, 1
    s_cbranch_vccz L_ACT_ok_32
    s_cmp_ge_u32 s99, 200000
    s_cbranch_scc1 L_ACT_ok_32
    s_mov_b64 exec, vcc
    s_sleep 2
    buffer_load_dwordx4 v[80:83], v4, s[8:11], s100 offen sc0 sc1
    buffer_load_dwordx4 v[84:87], v4, s[8:11], s100 offen offset:16 sc0 sc1
    s_branch L_ACT_l_31
L_ACT_ok_32:
    s_mov_b64 exec, -1
    v_pk_mul_f32 v[64:65], v[192:193], v[80:81] op_sel_hi:[1,0]
    v_pk_mul_f32 v[66:67], v[194:195], v[80:81] op_sel_hi:[1,0]
    v_pk_mul_f32 v[68:69], v[196:197], v[80:81] op_sel_hi:[1,0]
    v_pk_mul_f32 v[70:71], v[198:199], v[80:81] op_sel_hi:[1,0]
    v_pk_fma_f32 v[64:65], v[200:201], v[80:81], v[64:65] op_sel:[0,1,0] op_sel_hi:[1,1,1]
    v_pk_fma_f32 v[66:67], v[202:203], v[80:81], v[66:67] op_sel:[0,1,0] op_sel_hi:[1,1,1]
    v_pk_fma_f32 v[68:69], v[204:205], v[80:81], v[68:69] op_sel:[0,1,0] op_sel_hi:[1,1,1]
    v_pk_fma_f32 v[70:71], v[206:207], v[80:81], v[70:71] op_sel:[0,1,0] op_sel_hi:[1,1,1]
    v_pk_fma_f32 v[64:65], v[208:209], v[82:83], v[64:65] op_sel:[0,0,0] op_sel_hi:[1,0,1]
    v_pk_fma_f32 v[66:67], v[210:211], v[82:83], v[66:67] op_sel:[0,0,0] op_sel_hi:[1,0,1]
    v_pk_fma_f32 v[68:69], v[212:213], v[82:83], v[68:69] op_sel:[0,0,0] op_sel_hi:[1,0,1]
    v_pk_fma_f32 v[70:71], v[214:215], v[82:83], v[70:71] op_sel:[0,0,0] op_sel_hi:[1,0,1]
    v_pk_fma_f32 v[64:65], v[216:217], v[82:83], v[64:65] op_sel:[0,1,0] op_sel_hi:[1,1,1]
    v_pk_fma_f32 v[66:67], v[218:219], v[82:83], v[66:67] op_sel:[0,1,0] op_sel_hi:[1,1,1]
    v_pk_fma_f32 v[68:69], v[220:221], v[82:83], v[68:69] op_sel:[0,1,0] op_sel_hi:[1,1,1]
    v_pk_fma_f32 v[70:71], v[222:223], v[82:83], v[70:71] op_sel:[0,1,0] op_sel_hi:[1,1,1]
    v_pk_fma_f32 v[64:65], v[224:225], v[84:85], v[64:65] op_sel:[0,0,0] op_sel_hi:[1,0,1]
    v_pk_fma_f32 v[66:67], v[226:227], v[84:85], v[66:67] op_sel:[0,0,0] op_sel_hi:[1,0,1]
    v_pk_fma_f32 v[68:69], v[228:229], v[84:85], v[68:69] op_sel:[0,0,0] op_sel_hi:[1,0,1]
    v_pk_fma_f32 v[70:71], v[230:231], v[84:85], v[70:71] op_sel:[0,0,0] op_sel_hi:[1,0,1]
    v_pk_fma_f32 v[64:65], v[232:233], v[84:85], v[64:65] op_sel:[0,1,0] op_sel_hi:[1,1,1]
    v_pk_fma_f32 v[66:67], v[234:235], v[84:85], v[66:67] op_sel:[0,1,0] op_sel_hi:[1,1,1]
    v_pk_fma_f32 v[68:69], v[236:237], v[84:85], v[68:69] op_sel:[0,1,0] op_sel_hi:[1,1,1]
    v_pk_fma_f32 v[70:71], v[238:239], v[84:85], v[70:71] op_sel:[0,1,0] op_sel_hi:[1,1,1]
    v_pk_fma_f32 v[64:65], v[240:241], v[86:87], v[64:65] op_sel:[0,0,0] op_sel_hi:[1,0,1]
    v_pk_fma_f32 v[66:67], v[242:243], v[86:87], v[66:67] op_sel:[0,0,0] op_sel_hi:[1,0,1]
    v_pk_fma_f32 v[68:69], v[244:245], v[86:87], v[68:69] op_sel:[0,0,0] op_sel_hi:[1,0,1]
    v_pk_fma_f32 v[70:71], v[246:247], v[86:87], v[70:71] op_sel:[0,0,0] op_sel_hi:[1,0,1]
    v_pk_fma_f32 v[64:65], v[248:249], v[86:87], v[64:65] op_sel:[0,1,0] op_sel_hi:[1,1,1]
    v_pk_fma_f32 v[66:67], v[250:251], v[86:87], v[66:67] op_sel:[0,1,0] op_sel_hi:[1,1,1]
    v_pk_fma_f32 v[68:69], v[252:253], v[86:87], v[68:69] op_sel:[0,1,0] op_sel_hi:[1,1,1]
    v_pk_fma_f32 v[70:71], v[254:255], v[86:87], v[70:71] op_sel:[0,1,0] op_sel_hi:[1,1,1]
    s_nop 0
    v_permlane32_swap_b32 v64, v68
    v_permlane32_swap_b32 v65, v69
    v_permlane32_swap_b32 v66, v70
    v_permlane32_swap_b32 v67, v71
    v_add_f32 v64, v64, v68
    v_add_f32 v65, v65, v69
    v_add_f32 v66, v66, v70
    v_add_f32 v67, v67, v71
    s_nop 0
    v_permlane16_swap_b32 v64, v66
    v_permlane16_swap_b32 v65, v67
    v_add_f32 v64, v64, v66
    v_add_f32 v65, v65, v67
    s_nop 0
    v_add_f32_dpp v64, v64, v64 quad_perm:[1,0,3,2] row_mask:0xf bank_mask:0xf
    v_add_f32_dpp v65, v65, v65 quad_perm:[1,0,3,2] row_mask:0xf bank_mask:0xf
    s_nop 0
    v_add_f32_dpp v64, v64, v64 quad_perm:[2,3,0,1] row_mask:0xf bank_mask:0xf
    v_add_f32_dpp v65, v65, v65 quad_perm:[2,3,0,1] row_mask:0xf bank_mask:0xf
    s_nop 0
    v_add_f32_dpp v64, v64, v64 row_half_mirror row_mask:0xf bank_mask:0xf
    v_add_f32_dpp v65, v65, v65 row_half_mirror row_mask:0xf bank_mask:0xf
    s_nop 0
    v_add_f32_dpp v64, v64, v64 row_mirror row_mask:0xf bank_mask:0xf
    v_add_f32_dpp v65, v65, v65 row_mirror row_mask:0xf bank_mask:0xf
    ds_write_b64 v51, v[64:65] offset:2048
    s_waitcnt lgkmcnt(0)
    s_barrier
    s_cmp_lg_u32 s3, 0
    s_cbranch_scc1 L_fin
    ds_read_b32 v64, v50 offset:2048
    ds_read_b32 v65, v50 offset:2080
    ds_read_b32 v66, v50 offset:2112
    ds_read_b32 v67, v50 offset:2144
    s_lshl_b32 s100, s72, 10
    s_waitcnt lgkmcnt(2)
    v_add_f32 v64, v64, v65
    s_waitcnt lgkmcnt(0)
    v_add_f32 v66, v66, v67
    v_add_f32 v64, v64, v66
    v_cvt_pk_bf16_f32 v64, v64, v64
    v_and_b32 v64, 0xffff0000, v64
    v_mul_f32 v64, v64, v90
    v_cvt_pk_bf16_f32 v64, v64, v64
    v_and_b32 v64, 0xffff0000, v64
    v_add_f32 v64, v64, v88
    v_cvt_pk_bf16_f32 v64, v64, v64
    v_and_b32 v64, 0xffff0000, v64
    v_mul_f32 v64, v64, v55
    v_cvt_pk_bf16_f32 v64, v64, v64
    v_and_b32 v64, 0xffff0000, v64
    v_add_f32 v64, v64, v89
    v_cvt_pk_bf16_f32 v64, v64, v64
    buffer_store_short v64, v52, s[52:55], s100 offen
L_fin:
L_end:
    s_endpgm
L_E_slow_1:
    s_mov_b32 s99, 0
L_E_slow_1_l:
    s_sleep 20
    buffer_load_dword v3, v4, s[36:39], s67 offen sc0 sc1
    s_add_u32 s99, s99, 1
    s_waitcnt vmcnt(0)
    v_cmp_le_u32 vcc, s68, v3
    s_cmp_eq_u64 vcc, -1
    s_cbranch_scc1 L_E_ok_2
    s_cmp_lt_u32 s99, 200000
    s_cbranch_scc1 L_E_slow_1_l
    s_branch L_E_ok_2
L_H_slow_3:
    s_mov_b32 s99, 0
L_H_slow_3_l:
    s_sleep 4
    buffer_load_dword v3, v16, s[8:11], s78 offen sc0 sc1
    s_add_u32 s99, s99, 1
    s_waitcnt vmcnt(0)
    v_cmp_ne_u32 vcc, 0, v3
    s_cmp_eq_u64 vcc, -1
    s_cbranch_scc1 L_H_ok_4
    s_cmp_lt_u32 s99, 200000
    s_cbranch_scc1 L_H_slow_3_l
    s_branch L_H_ok_4
L_E2_slow_5:
    s_mov_b32 s99, 0
L_E2_slow_5_l:
    s_sleep 4
    buffer_load_dword v118, v119, s[8:11], s69 offen sc0 sc1
    s_add_u32 s99, s99, 1
    s_waitcnt vmcnt(0)
    v_cmp_ne_u32 vcc, 0, v118
    s_cmp_eq_u64 vcc, -1
    s_cbranch_scc1 L_E2_ok_6
    s_cmp_lt_u32 s99, 200000
    s_cbranch_scc1 L_E2_slow_5_l
    s_branch L_E2_ok_6
L_KV_slow_7:
    s_mov_b32 s99, 0
L_KV_slow_7_l:
    s_sleep 4
    buffer_load_dword v3, v17, s[8:11], s74 offen sc0 sc1
    s_add_u32 s99, s99, 1
    s_waitcnt vmcnt(0)
    v_cmp_ne_u32 vcc, 0, v3
    s_cmp_eq_u64 vcc, -1
    s_cbranch_scc1 L_KV_ok_8
    s_cmp_lt_u32 s99, 200000
    s_cbranch_scc1 L_KV_slow_7_l
    s_branch L_KV_ok_8
L_t1_start:
    v_mfma_f32_16x16x32_bf16 v[96:99], a[128:131], a[64:67], v[96:99]
    s_add_u32 s19, s82, 32768
    s_sub_u32 s82, s12, s13
    s_sub_u32 s82, s82, 1
    v_mfma_f32_16x16x32_bf16 v[96:99], a[132:135], a[68:71], v[96:99]
    s_cmp_gt_u32 s12, s13
    s_cselect_b32 s82, s82, s12
    s_lshl_b32 s82, s82, 16
    s_add_u32 s82, s82, s81
    v_mfma_f32_16x16x32_bf16 v[96:99], a[136:139], a[72:75], v[96:99]
    s_cmp_ge_u32 s12, 17
    s_cselect_b32 s82, 2147471360, s82
    s_add_u32 s12, s12, 1
    s_sub_u32 s14, s60, 1
    v_mfma_f32_16x16x32_bf16 v[96:99], a[140:143], a[76:79], v[96:99]
    v_mfma_f32_16x16x32_bf16 v[100:103], a[144:147], a[64:67], v[100:103]
    v_mfma_f32_16x16x32_bf16 v[100:103], a[148:151], a[68:71], v[100:103]
    v_mfma_f32_16x16x32_bf16 v[100:103], a[152:155], a[72:75], v[100:103]
    v_mfma_f32_16x16x32_bf16 v[100:103], a[156:159], a[76:79], v[100:103]
    v_mfma_f32_16x16x32_bf16 v[104:107], a[128:131], a[80:83], v[104:107]
    s_nop 2
    v_exp_f32 v96, v96
    v_mfma_f32_16x16x32_bf16 v[104:107], a[132:135], a[84:87], v[104:107]
    v_exp_f32 v97, v97
    v_mfma_f32_16x16x32_bf16 v[104:107], a[136:139], a[88:91], v[104:107]
    v_exp_f32 v98, v98
    v_mfma_f32_16x16x32_bf16 v[104:107], a[140:143], a[92:95], v[104:107]
    v_exp_f32 v99, v99
    v_mfma_f32_16x16x32_bf16 v[108:111], a[144:147], a[80:83], v[108:111]
    v_exp_f32 v100, v100
    v_mfma_f32_16x16x32_bf16 v[108:111], a[148:151], a[84:87], v[108:111]
    v_exp_f32 v101, v101
    v_mfma_f32_16x16x32_bf16 v[108:111], a[152:155], a[88:91], v[108:111]
    v_exp_f32 v102, v102
    v_mfma_f32_16x16x32_bf16 v[108:111], a[156:159], a[92:95], v[108:111]
    v_exp_f32 v103, v103
    v_mfma_f32_16x16x32_bf16 v[112:115], a[128:131], a[96:99], v[72:75]
    v_exp_f32 v104, v104
    v_mfma_f32_16x16x32_bf16 v[112:115], a[132:135], a[100:103], v[112:115]
    v_exp_f32 v105, v105
    v_mfma_f32_16x16x32_bf16 v[112:115], a[136:139], a[104:107], v[112:115]
    v_exp_f32 v106, v106
    v_mfma_f32_16x16x32_bf16 v[112:115], a[140:143], a[108:111], v[112:115]
    v_exp_f32 v107, v107
    v_mfma_f32_16x16x32_bf16 v[120:123], a[128:131], a[112:115], v[76:79]
    v_exp_f32 v108, v108
    v_mfma_f32_16x16x32_bf16 v[120:123], a[132:135], a[116:119], v[120:123]
    v_exp_f32 v109, v109
    v_mfma_f32_16x16x32_bf16 v[120:123], a[136:139], a[120:123], v[120:123]
    v_exp_f32 v110, v110
    v_mfma_f32_16x16x32_bf16 v[120:123], a[140:143], a[124:127], v[120:123]
    v_exp_f32 v111, v111
    v_mfma_f32_16x16x32_bf16 v[116:119], a[144:147], a[96:99], v[72:75]
    ds_read_b128 a[128:131], v18 offset:16384
    v_cvt_pk_bf16_f32 v48, v96, v97
    v_mfma_f32_16x16x32_bf16 v[116:119], a[148:151], a[100:103], v[116:119]
    ds_read_b128 a[132:135], v18 offset:17408
    v_cvt_pk_bf16_f32 v49, v98, v99
    v_mfma_f32_16x16x32_bf16 v[116:119], a[152:155], a[104:107], v[116:119]
    ds_read_b128 a[136:139], v18 offset:18432
    v_cvt_pk_bf16_f32 v50, v100, v101
    v_mfma_f32_16x16x32_bf16 v[116:119], a[156:159], a[108:111], v[116:119]
    ds_read_b128 a[140:143], v18 offset:19456
    v_cvt_pk_bf16_f32 v51, v102, v103
    v_mfma_f32_16x16x32_bf16 v[124:127], a[144:147], a[112:115], v[76:79]
    ds_read_b128 a[144:147], v18 offset:20480
    v_cvt_pk_bf16_f32 v52, v104, v105
    v_mfma_f32_16x16x32_bf16 v[124:127], a[148:151], a[116:119], v[124:127]
    ds_read_b128 a[148:151], v18 offset:21504
    v_cvt_pk_bf16_f32 v53, v106, v107
    v_mfma_f32_16x16x32_bf16 v[124:127], a[152:155], a[120:123], v[124:127]
    ds_read_b128 a[152:155], v18 offset:22528
    v_cvt_pk_bf16_f32 v54, v108, v109
    v_mfma_f32_16x16x32_bf16 v[124:127], a[156:159], a[124:127], v[124:127]
    ds_read_b128 a[156:159], v18 offset:23552
    v_cvt_pk_bf16_f32 v55, v110, v111
    v_xor_b32 v18, 196608, v18
    s_branch L_t1_p1
L_t1_zero:
    v_mfma_f32_16x16x32_bf16 v[96:99], a[128:131], a[96:99], v[80:83]
    s_xor_b32 s100, s16, 8192
    ds_read_b128 a[176:179], v20 offset:4096
    v_lshrrev_b32 v13, 1, v1
    v_mfma_f32_16x16x32_bf16 v[96:99], a[132:135], a[100:103], v[96:99]
    s_add_u32 m0, s15, 0
    ds_read_b128 a[180:183], v20 offset:5120
    v_add_u32 v12, s100, v13
    v_mfma_f32_16x16x32_bf16 v[96:99], a[136:139], a[104:107], v[96:99]
    buffer_load_dwordx4 v1, s[8:11], s82 offen offset:0  lds
    v_exp_f32 v112, v112
    v_mfma_f32_16x16x32_bf16 v[96:99], a[140:143], a[108:111], v[96:99]
    v_exp_f32 v113, v113
    v_mfma_f32_16x16x32_bf16 v[100:103], a[144:147], a[96:99], v[84:87]
    ds_read_b128 a[184:187], v20 offset:6144
    v_cvt_pk_bf16_f32 v56, v112, v113
    v_mfma_f32_16x16x32_bf16 v[100:103], a[148:151], a[100:103], v[100:103]
    v_exp_f32 v114, v114
    v_mfma_f32_16x16x32_bf16 v[100:103], a[152:155], a[104:107], v[100:103]
    buffer_load_dwordx4 v1, s[8:11], s82 offen offset:1024  lds
    v_exp_f32 v115, v115
    v_mfma_f32_16x16x32_bf16 v[100:103], a[156:159], a[108:111], v[100:103]
    ds_read_b128 a[188:191], v20 offset:7168
    v_cvt_pk_bf16_f32 v57, v114, v115
    v_mfma_f32_16x16x32_bf16 v[104:107], a[128:131], a[112:115], v[88:91]
    v_exp_f32 v116, v116
    v_mfma_f32_16x16x32_bf16 v[104:107], a[132:135], a[116:119], v[104:107]
    v_exp_f32 v117, v117
    v_mfma_f32_16x16x32_bf16 v[104:107], a[136:139], a[120:123], v[104:107]
    ds_read_b128 a[160:163], v19 offset:0
    v_cvt_pk_bf16_f32 v58, v116, v117
    v_mfma_f32_16x16x32_bf16 v[104:107], a[140:143], a[124:127], v[104:107]
    buffer_load_dwordx4 v1, s[8:11], s82 offen offset:2048  lds
    v_exp_f32 v118, v118
    v_mfma_f32_16x16x32_bf16 v[108:111], a[144:147], a[112:115], v[92:95]
    v_exp_f32 v119, v119
    v_mfma_f32_16x16x32_bf16 v[108:111], a[148:151], a[116:119], v[108:111]
    ds_read_b128 a[164:167], v19 offset:1024
    v_cvt_pk_bf16_f32 v59, v118, v119
    v_mfma_f32_16x16x32_bf16 v[108:111], a[152:155], a[120:123], v[108:111]
    v_exp_f32 v120, v120
    v_mfma_f32_16x16x32_bf16 v[108:111], a[156:159], a[124:127], v[108:111]
    buffer_load_dwordx4 v1, s[8:11], s82 offen offset:3072  lds
    v_exp_f32 v121, v121
    v_mfma_f32_16x16x32_bf16 v[32:35], v[28:31], v[48:51], 0
    s_add_u32 m0, s15, 4096
    ds_read_b128 a[168:171], v19 offset:2048
    v_cvt_pk_bf16_f32 v60, v120, v121
    v_mfma_f32_16x16x32_bf16 v[36:39], v[28:31], v[52:55], 0
    s_waitcnt lgkmcnt(6)
    v_exp_f32 v122, v122
    v_mfma_f32_16x16x32_bf16 v[144:147], a[176:179], v[48:51], 0
    v_exp_f32 v123, v123
    v_mfma_f32_16x16x32_bf16 v[176:179], a[176:179], v[52:55], 0
    s_waitcnt lgkmcnt(5)
    ds_read_b128 a[172:175], v19 offset:3072
    v_cvt_pk_bf16_f32 v61, v122, v123
    v_mfma_f32_16x16x32_bf16 v[148:151], a[180:183], v[48:51], 0
    buffer_load_dwordx4 v15, s[8:11], s82 offen offset:0  lds
    v_exp_f32 v124, v124
    v_mfma_f32_16x16x32_bf16 v[180:183], a[180:183], v[52:55], 0
    s_waitcnt lgkmcnt(5)
    v_exp_f32 v125, v125
    v_mfma_f32_16x16x32_bf16 v[152:155], a[184:187], v[48:51], 0
    s_waitcnt lgkmcnt(4)
    v_exp_f32 v126, v126
    v_mfma_f32_16x16x32_bf16 v[184:187], a[184:187], v[52:55], 0
    buffer_load_dwordx4 v15, s[8:11], s82 offen offset:1024  lds
    v_exp_f32 v127, v127
    v_mfma_f32_16x16x32_bf16 v[156:159], a[188:191], v[48:51], 0
    ds_write_b128 v16, v[144:147] offset:32768
    v_cvt_pk_bf16_f32 v62, v124, v125
    v_mfma_f32_16x16x32_bf16 v[188:191], a[188:191], v[52:55], 0
    s_waitcnt lgkmcnt(4)
    v_exp_f32 v96, v96
    v_mfma_f32_16x16x32_bf16 v[128:131], a[160:163], v[48:51], 0
    v_exp_f32 v97, v97
    v_mfma_f32_16x16x32_bf16 v[160:163], a[160:163], v[52:55], 0
    s_waitcnt lgkmcnt(3)
    ds_write_b128 v16, v[176:179] offset:33792
    v_cvt_pk_bf16_f32 v63, v126, v127
    v_mfma_f32_16x16x32_bf16 v[132:135], a[164:167], v[48:51], 0
    s_waitcnt lgkmcnt(3)
    v_exp_f32 v98, v98
    v_mfma_f32_16x16x32_bf16 v[164:167], a[164:167], v[52:55], 0
    buffer_load_dwordx4 v15, s[8:11], s82 offen offset:2048  lds
    v_exp_f32 v99, v99
    v_mfma_f32_16x16x32_bf16 v[136:139], a[168:171], v[48:51], 0
    ds_write_b128 v16, v[148:151] offset:34816
    v_mfma_f32_16x16x32_bf16 v[168:171], a[168:171], v[52:55], 0
    s_waitcnt lgkmcnt(3)
    v_exp_f32 v100, v100
    v_mfma_f32_16x16x32_bf16 v[140:143], a[172:175], v[48:51], 0
    v_exp_f32 v101, v101
    v_mfma_f32_16x16x32_bf16 v[172:175], a[172:175], v[52:55], 0
    ds_write_b128 v16, v[180:183] offset:35840
    v_mov_b32 v33, v36
    v_mfma_f32_16x16x32_bf16 v[40:43], v[28:31], v[56:59], 0
    buffer_load_dwordx4 v15, s[8:11], s82 offen offset:3072  lds
    v_exp_f32 v102, v102
    v_mfma_f32_16x16x32_bf16 v[44:47], v[28:31], v[60:63], 0
    s_xor_b32 s15, s15, 196608
    v_exp_f32 v103, v103
    v_mfma_f32_16x16x32_bf16 v[208:211], a[176:179], v[56:59], 0
    ds_write_b128 v16, v[152:155] offset:36864
    v_cvt_pk_bf16_f32 v48, v96, v97
    v_mfma_f32_16x16x32_bf16 v[240:243], a[176:179], v[60:63], 0
    ds_read_b128 a[176:179], v20 offset:20480
    v_exp_f32 v104, v104
    v_mfma_f32_16x16x32_bf16 v[212:215], a[180:183], v[56:59], 0
    v_exp_f32 v105, v105
    v_mfma_f32_16x16x32_bf16 v[244:247], a[180:183], v[60:63], 0
    ds_read_b128 a[180:183], v20 offset:21504
    v_exp_f32 v106, v106
    v_mfma_f32_16x16x32_bf16 v[216:219], a[184:187], v[56:59], 0
    ds_write_b128 v16, v[184:187] offset:37888
    v_cvt_pk_bf16_f32 v49, v98, v99
    v_mfma_f32_16x16x32_bf16 v[248:251], a[184:187], v[60:63], 0
    ds_read_b128 a[184:187], v20 offset:22528
    v_exp_f32 v107, v107
    v_mfma_f32_16x16x32_bf16 v[220:223], a[188:191], v[56:59], 0
    v_exp_f32 v108, v108
    v_mfma_f32_16x16x32_bf16 v[252:255], a[188:191], v[60:63], 0
    ds_read_b128 a[188:191], v20 offset:23552
    v_exp_f32 v109, v109
    v_mfma_f32_16x16x32_bf16 v[192:195], a[160:163], v[56:59], 0
    ds_write_b128 v16, v[156:159] offset:38912
    v_cvt_pk_bf16_f32 v50, v100, v101
    v_mfma_f32_16x16x32_bf16 v[224:227], a[160:163], v[60:63], 0
    ds_read_b128 a[160:163], v19 offset:16384
    v_exp_f32 v110, v110
    v_mfma_f32_16x16x32_bf16 v[196:199], a[164:167], v[56:59], 0
    v_exp_f32 v111, v111
    v_mfma_f32_16x16x32_bf16 v[228:231], a[164:167], v[60:63], 0
    ds_read_b128 a[164:167], v19 offset:17408
    v_cvt_pk_bf16_f32 v51, v102, v103
    v_mfma_f32_16x16x32_bf16 v[200:203], a[168:171], v[56:59], 0
    ds_write_b128 v16, v[188:191] offset:39936
    v_cvt_pk_bf16_f32 v52, v104, v105
    v_mfma_f32_16x16x32_bf16 v[232:235], a[168:171], v[60:63], 0
    ds_read_b128 a[168:171], v19 offset:18432
    v_cvt_pk_bf16_f32 v53, v106, v107
    v_mfma_f32_16x16x32_bf16 v[204:207], a[172:175], v[56:59], 0
    v_cvt_pk_bf16_f32 v54, v108, v109
    v_cvt_pk_bf16_f32 v55, v110, v111
    v_mfma_f32_16x16x32_bf16 v[236:239], a[172:175], v[60:63], 0
    ds_read_b128 a[172:175], v19 offset:19456
    ds_write_b64 v12, v[32:33]
    s_xor_b32 s101, s16, 98304
    v_xor_b32 v12, 8192, v12
    v_add_u32 v9, s101, v1
    v_xor_b32 v8, 8192, v16
    v_xor_b32 v10, 8192, v9
    s_branch L_t1_join
L_t1_redo:
    s_cmp_eq_u32 s25, 0
    s_cbranch_scc1 L_t1_max
    s_mov_b32 s25, 0
    v_mov_b32 v64, 0
    v_mov_b32 v65, 0
    v_mov_b32 v66, 0
    v_mov_b32 v67, 0
    v_mov_b32 v68, 0
    v_mov_b32 v69, 0
    v_mov_b32 v70, 0
    v_mov_b32 v71, 0
    v_mov_b32 v72, 0
    v_mov_b32 v73, 0
    v_mov_b32 v74, 0
    v_mov_b32 v75, 0
    v_mov_b32 v76, 0
    v_mov_b32 v77, 0
    v_mov_b32 v78, 0
    v_mov_b32 v79, 0
    s_nop 1
    s_branch L_t1_safe
L_t1_max:
    s_waitcnt vmcnt(0) lgkmcnt(0)
    s_barrier
    s_mov_b32 s25, 1
    s_and_b32 s100, s3, 1
    s_lshl_b32 s100, s100, 13
    s_sub_u32 s101, s81, s62
    s_add_u32 s101, s101, s100
    s_mov_b32 s14, s60
    v_mov_b32 v48, 0xff800000
    v_mov_b32 v49, 0xff800000
    v_mov_b32 v50, 0xff800000
    v_mov_b32 v51, 0xff800000
L_t1_maxl:
    s_cmp_eq_u32 s14, 0
    s_cbranch_scc1 L_t1_maxd
    s_add_u32 s100, s101, 0
    buffer_load_dwordx4 a[128:131], v1, s[8:11], s100 offen offset:0
    buffer_load_dwordx4 a[132:135], v1, s[8:11], s100 offen offset:1024
    buffer_load_dwordx4 a[136:139], v1, s[8:11], s100 offen offset:2048
    buffer_load_dwordx4 a[140:143], v1, s[8:11], s100 offen offset:3072
    buffer_load_dwordx4 a[144:147], v15, s[8:11], s100 offen offset:0
    buffer_load_dwordx4 a[148:151], v15, s[8:11], s100 offen offset:1024
    buffer_load_dwordx4 a[152:155], v15, s[8:11], s100 offen offset:2048
    buffer_load_dwordx4 a[156:159], v15, s[8:11], s100 offen offset:3072
    s_waitcnt vmcnt(7)
    v_mfma_f32_16x16x32_bf16 v[96:99], a[128:131], a[64:67], v[64:67]
    s_waitcnt vmcnt(6)
    v_mfma_f32_16x16x32_bf16 v[96:99], a[132:135], a[68:71], v[96:99]
    s_waitcnt vmcnt(5)
    v_mfma_f32_16x16x32_bf16 v[96:99], a[136:139], a[72:75], v[96:99]
    s_waitcnt vmcnt(4)
    v_mfma_f32_16x16x32_bf16 v[96:99], a[140:143], a[76:79], v[96:99]
    v_mfma_f32_16x16x32_bf16 v[104:107], a[128:131], a[80:83], v[68:71]
    v_mfma_f32_16x16x32_bf16 v[104:107], a[132:135], a[84:87], v[104:107]
    v_mfma_f32_16x16x32_bf16 v[104:107], a[136:139], a[88:91], v[104:107]
    v_mfma_f32_16x16x32_bf16 v[104:107], a[140:143], a[92:95], v[104:107]
    s_waitcnt vmcnt(3)
    v_mfma_f32_16x16x32_bf16 v[100:103], a[144:147], a[64:67], v[64:67]
    s_waitcnt vmcnt(2)
    v_mfma_f32_16x16x32_bf16 v[100:103], a[148:151], a[68:71], v[100:103]
    s_waitcnt vmcnt(1)
    v_mfma_f32_16x16x32_bf16 v[100:103], a[152:155], a[72:75], v[100:103]
    s_waitcnt vmcnt(0)
    v_mfma_f32_16x16x32_bf16 v[100:103], a[156:159], a[76:79], v[100:103]
    v_mfma_f32_16x16x32_bf16 v[108:111], a[144:147], a[80:83], v[68:71]
    v_mfma_f32_16x16x32_bf16 v[108:111], a[148:151], a[84:87], v[108:111]
    v_mfma_f32_16x16x32_bf16 v[108:111], a[152:155], a[88:91], v[108:111]
    v_mfma_f32_16x16x32_bf16 v[108:111], a[156:159], a[92:95], v[108:111]
    v_mfma_f32_16x16x32_bf16 v[112:115], a[128:131], a[96:99], v[72:75]
    v_mfma_f32_16x16x32_bf16 v[112:115], a[132:135], a[100:103], v[112:115]
    v_mfma_f32_16x16x32_bf16 v[112:115], a[136:139], a[104:107], v[112:115]
    v_mfma_f32_16x16x32_bf16 v[112:115], a[140:143], a[108:111], v[112:115]
    v_mfma_f32_16x16x32_bf16 v[120:123], a[128:131], a[112:115], v[76:79]
    v_mfma_f32_16x16x32_bf16 v[120:123], a[132:135], a[116:119], v[120:123]
    v_mfma_f32_16x16x32_bf16 v[120:123], a[136:139], a[120:123], v[120:123]
    v_mfma_f32_16x16x32_bf16 v[120:123], a[140:143], a[124:127], v[120:123]
    v_mfma_f32_16x16x32_bf16 v[116:119], a[144:147], a[96:99], v[72:75]
    v_mfma_f32_16x16x32_bf16 v[116:119], a[148:151], a[100:103], v[116:119]
    v_mfma_f32_16x16x32_bf16 v[116:119], a[152:155], a[104:107], v[116:119]
    v_mfma_f32_16x16x32_bf16 v[116:119], a[156:159], a[108:111], v[116:119]
    v_mfma_f32_16x16x32_bf16 v[124:127], a[144:147], a[112:115], v[76:79]
    v_mfma_f32_16x16x32_bf16 v[124:127], a[148:151], a[116:119], v[124:127]
    v_mfma_f32_16x16x32_bf16 v[124:127], a[152:155], a[120:123], v[124:127]
    v_mfma_f32_16x16x32_bf16 v[124:127], a[156:159], a[124:127], v[124:127]
    v_max3_f32 v48, v48, v96, v97
    v_max3_f32 v48, v48, v98, v99
    v_max3_f32 v48, v48, v100, v101
    v_max3_f32 v48, v48, v102, v103
    v_max3_f32 v49, v49, v104, v105
    v_max3_f32 v49, v49, v106, v107
    v_max3_f32 v49, v49, v108, v109
    v_max3_f32 v49, v49, v110, v111
    v_max3_f32 v50, v50, v112, v113
    v_max3_f32 v50, v50, v114, v115
    v_max3_f32 v50, v50, v116, v117
    v_max3_f32 v50, v50, v118, v119
    v_max3_f32 v51, v51, v120, v121
    v_max3_f32 v51, v51, v122, v123
    v_max3_f32 v51, v51, v124, v125
    v_max3_f32 v51, v51, v126, v127
    s_add_u32 s100, s101, 16384
    buffer_load_dwordx4 a[128:131], v1, s[8:11], s100 offen offset:0
    buffer_load_dwordx4 a[132:135], v1, s[8:11], s100 offen offset:1024
    buffer_load_dwordx4 a[136:139], v1, s[8:11], s100 offen offset:2048
    buffer_load_dwordx4 a[140:143], v1, s[8:11], s100 offen offset:3072
    buffer_load_dwordx4 a[144:147], v15, s[8:11], s100 offen offset:0
    buffer_load_dwordx4 a[148:151], v15, s[8:11], s100 offen offset:1024
    buffer_load_dwordx4 a[152:155], v15, s[8:11], s100 offen offset:2048
    buffer_load_dwordx4 a[156:159], v15, s[8:11], s100 offen offset:3072
    s_waitcnt vmcnt(7)
    v_mfma_f32_16x16x32_bf16 v[96:99], a[128:131], a[64:67], v[64:67]
    s_waitcnt vmcnt(6)
    v_mfma_f32_16x16x32_bf16 v[96:99], a[132:135], a[68:71], v[96:99]
    s_waitcnt vmcnt(5)
    v_mfma_f32_16x16x32_bf16 v[96:99], a[136:139], a[72:75], v[96:99]
    s_waitcnt vmcnt(4)
    v_mfma_f32_16x16x32_bf16 v[96:99], a[140:143], a[76:79], v[96:99]
    v_mfma_f32_16x16x32_bf16 v[104:107], a[128:131], a[80:83], v[68:71]
    v_mfma_f32_16x16x32_bf16 v[104:107], a[132:135], a[84:87], v[104:107]
    v_mfma_f32_16x16x32_bf16 v[104:107], a[136:139], a[88:91], v[104:107]
    v_mfma_f32_16x16x32_bf16 v[104:107], a[140:143], a[92:95], v[104:107]
    s_waitcnt vmcnt(3)
    v_mfma_f32_16x16x32_bf16 v[100:103], a[144:147], a[64:67], v[64:67]
    s_waitcnt vmcnt(2)
    v_mfma_f32_16x16x32_bf16 v[100:103], a[148:151], a[68:71], v[100:103]
    s_waitcnt vmcnt(1)
    v_mfma_f32_16x16x32_bf16 v[100:103], a[152:155], a[72:75], v[100:103]
    s_waitcnt vmcnt(0)
    v_mfma_f32_16x16x32_bf16 v[100:103], a[156:159], a[76:79], v[100:103]
    v_mfma_f32_16x16x32_bf16 v[108:111], a[144:147], a[80:83], v[68:71]
    v_mfma_f32_16x16x32_bf16 v[108:111], a[148:151], a[84:87], v[108:111]
    v_mfma_f32_16x16x32_bf16 v[108:111], a[152:155], a[88:91], v[108:111]
    v_mfma_f32_16x16x32_bf16 v[108:111], a[156:159], a[92:95], v[108:111]
    v_mfma_f32_16x16x32_bf16 v[112:115], a[128:131], a[96:99], v[72:75]
    v_mfma_f32_16x16x32_bf16 v[112:115], a[132:135], a[100:103], v[112:115]
    v_mfma_f32_16x16x32_bf16 v[112:115], a[136:139], a[104:107], v[112:115]
    v_mfma_f32_16x16x32_bf16 v[112:115], a[140:143], a[108:111], v[112:115]
    v_mfma_f32_16x16x32_bf16 v[120:123], a[128:131], a[112:115], v[76:79]
    v_mfma_f32_16x16x32_bf16 v[120:123], a[132:135], a[116:119], v[120:123]
    v_mfma_f32_16x16x32_bf16 v[120:123], a[136:139], a[120:123], v[120:123]
    v_mfma_f32_16x16x32_bf16 v[120:123], a[140:143], a[124:127], v[120:123]
    v_mfma_f32_16x16x32_bf16 v[116:119], a[144:147], a[96:99], v[72:75]
    v_mfma_f32_16x16x32_bf16 v[116:119], a[148:151], a[100:103], v[116:119]
    v_mfma_f32_16x16x32_bf16 v[116:119], a[152:155], a[104:107], v[116:119]
    v_mfma_f32_16x16x32_bf16 v[116:119], a[156:159], a[108:111], v[116:119]
    v_mfma_f32_16x16x32_bf16 v[124:127], a[144:147], a[112:115], v[76:79]
    v_mfma_f32_16x16x32_bf16 v[124:127], a[148:151], a[116:119], v[124:127]
    v_mfma_f32_16x16x32_bf16 v[124:127], a[152:155], a[120:123], v[124:127]
    v_mfma_f32_16x16x32_bf16 v[124:127], a[156:159], a[124:127], v[124:127]
    v_max3_f32 v48, v48, v96, v97
    v_max3_f32 v48, v48, v98, v99
    v_max3_f32 v48, v48, v100, v101
    v_max3_f32 v48, v48, v102, v103
    v_max3_f32 v49, v49, v104, v105
    v_max3_f32 v49, v49, v106, v107
    v_max3_f32 v49, v49, v108, v109
    v_max3_f32 v49, v49, v110, v111
    v_max3_f32 v50, v50, v112, v113
    v_max3_f32 v50, v50, v114, v115
    v_max3_f32 v50, v50, v116, v117
    v_max3_f32 v50, v50, v118, v119
    v_max3_f32 v51, v51, v120, v121
    v_max3_f32 v51, v51, v122, v123
    v_max3_f32 v51, v51, v124, v125
    v_max3_f32 v51, v51, v126, v127
    s_add_u32 s101, s101, 65536
    s_sub_u32 s14, s14, 1
    s_nop 7
    s_branch L_t1_maxl
L_t1_maxd:
    s_add_u32 s100, s101, 0
    buffer_load_dwordx4 a[128:131], v1, s[8:11], s100 offen offset:0
    buffer_load_dwordx4 a[132:135], v1, s[8:11], s100 offen offset:1024
    buffer_load_dwordx4 a[136:139], v1, s[8:11], s100 offen offset:2048
    buffer_load_dwordx4 a[140:143], v1, s[8:11], s100 offen offset:3072
    buffer_load_dwordx4 a[144:147], v15, s[8:11], s100 offen offset:0
    buffer_load_dwordx4 a[148:151], v15, s[8:11], s100 offen offset:1024
    buffer_load_dwordx4 a[152:155], v15, s[8:11], s100 offen offset:2048
    buffer_load_dwordx4 a[156:159], v15, s[8:11], s100 offen offset:3072
    v_add_f32 v80, 0, v21
    v_min_f32 v80, v80, v64
    v_add_f32 v81, 0xf1800000, v21
    v_min_f32 v81, v81, v65
    v_add_f32 v82, 0xf2000000, v21
    v_min_f32 v82, v82, v66
    v_add_f32 v83, 0xf2400000, v21
    v_min_f32 v83, v83, v67
    v_add_f32 v84, 0xf3800000, v21
    v_min_f32 v84, v84, v64
    v_add_f32 v85, 0xf3880000, v21
    v_min_f32 v85, v85, v65
    v_add_f32 v86, 0xf3900000, v21
    v_min_f32 v86, v86, v66
    v_add_f32 v87, 0xf3980000, v21
    v_min_f32 v87, v87, v67
    v_add_f32 v88, 0x73800000, v21
    v_min_f32 v88, v88, v68
    v_add_f32 v89, 0x73700000, v21
    v_min_f32 v89, v89, v69
    v_add_f32 v90, 0x73600000, v21
    v_min_f32 v90, v90, v70
    v_add_f32 v91, 0x73500000, v21
    v_min_f32 v91, v91, v71
    v_add_f32 v92, 0, v21
    v_min_f32 v92, v92, v68
    v_add_f32 v93, 0xf1800000, v21
    v_min_f32 v93, v93, v69
    v_add_f32 v94, 0xf2000000, v21
    v_min_f32 v94, v94, v70
    v_add_f32 v95, 0xf2400000, v21
    v_min_f32 v95, v95, v71
    s_waitcnt vmcnt(7)
    v_mfma_f32_16x16x32_bf16 v[96:99], a[128:131], a[64:67], v[80:83]
    s_waitcnt vmcnt(6)
    v_mfma_f32_16x16x32_bf16 v[96:99], a[132:135], a[68:71], v[96:99]
    s_waitcnt vmcnt(5)
    v_mfma_f32_16x16x32_bf16 v[96:99], a[136:139], a[72:75], v[96:99]
    s_waitcnt vmcnt(4)
    v_mfma_f32_16x16x32_bf16 v[96:99], a[140:143], a[76:79], v[96:99]
    v_mfma_f32_16x16x32_bf16 v[104:107], a[128:131], a[80:83], v[88:91]
    v_mfma_f32_16x16x32_bf16 v[104:107], a[132:135], a[84:87], v[104:107]
    v_mfma_f32_16x16x32_bf16 v[104:107], a[136:139], a[88:91], v[104:107]
    v_mfma_f32_16x16x32_bf16 v[104:107], a[140:143], a[92:95], v[104:107]
    s_waitcnt vmcnt(3)
    v_mfma_f32_16x16x32_bf16 v[100:103], a[144:147], a[64:67], v[84:87]
    s_waitcnt vmcnt(2)
    v_mfma_f32_16x16x32_bf16 v[100:103], a[148:151], a[68:71], v[100:103]
    s_waitcnt vmcnt(1)
    v_mfma_f32_16x16x32_bf16 v[100:103], a[152:155], a[72:75], v[100:103]
    s_waitcnt vmcnt(0)
    v_mfma_f32_16x16x32_bf16 v[100:103], a[156:159], a[76:79], v[100:103]
    v_mfma_f32_16x16x32_bf16 v[108:111], a[144:147], a[80:83], v[92:95]
    v_mfma_f32_16x16x32_bf16 v[108:111], a[148:151], a[84:87], v[108:111]
    v_mfma_f32_16x16x32_bf16 v[108:111], a[152:155], a[88:91], v[108:111]
    v_mfma_f32_16x16x32_bf16 v[108:111], a[156:159], a[92:95], v[108:111]
    v_mfma_f32_16x16x32_bf16 v[112:115], a[128:131], a[96:99], v[72:75]
    v_mfma_f32_16x16x32_bf16 v[112:115], a[132:135], a[100:103], v[112:115]
    v_mfma_f32_16x16x32_bf16 v[112:115], a[136:139], a[104:107], v[112:115]
    v_mfma_f32_16x16x32_bf16 v[112:115], a[140:143], a[108:111], v[112:115]
    v_mfma_f32_16x16x32_bf16 v[120:123], a[128:131], a[112:115], v[76:79]
    v_mfma_f32_16x16x32_bf16 v[120:123], a[132:135], a[116:119], v[120:123]
    v_mfma_f32_16x16x32_bf16 v[120:123], a[136:139], a[120:123], v[120:123]
    v_mfma_f32_16x16x32_bf16 v[120:123], a[140:143], a[124:127], v[120:123]
    v_mfma_f32_16x16x32_bf16 v[116:119], a[144:147], a[96:99], v[72:75]
    v_mfma_f32_16x16x32_bf16 v[116:119], a[148:151], a[100:103], v[116:119]
    v_mfma_f32_16x16x32_bf16 v[116:119], a[152:155], a[104:107], v[116:119]
    v_mfma_f32_16x16x32_bf16 v[116:119], a[156:159], a[108:111], v[116:119]
    v_mfma_f32_16x16x32_bf16 v[124:127], a[144:147], a[112:115], v[76:79]
    v_mfma_f32_16x16x32_bf16 v[124:127], a[148:151], a[116:119], v[124:127]
    v_mfma_f32_16x16x32_bf16 v[124:127], a[152:155], a[120:123], v[124:127]
    v_mfma_f32_16x16x32_bf16 v[124:127], a[156:159], a[124:127], v[124:127]
    v_max3_f32 v48, v48, v96, v97
    v_max3_f32 v48, v48, v98, v99
    v_max3_f32 v48, v48, v100, v101
    v_max3_f32 v48, v48, v102, v103
    v_max3_f32 v49, v49, v104, v105
    v_max3_f32 v49, v49, v106, v107
    v_max3_f32 v49, v49, v108, v109
    v_max3_f32 v49, v49, v110, v111
    v_max3_f32 v50, v50, v112, v113
    v_max3_f32 v50, v50, v114, v115
    v_max3_f32 v50, v50, v116, v117
    v_max3_f32 v50, v50, v118, v119
    v_max3_f32 v51, v51, v120, v121
    v_max3_f32 v51, v51, v122, v123
    v_max3_f32 v51, v51, v124, v125
    v_max3_f32 v51, v51, v126, v127
    s_add_u32 s100, s101, 16384
    buffer_load_dwordx4 a[128:131], v1, s[8:11], s100 offen offset:0
    buffer_load_dwordx4 a[132:135], v1, s[8:11], s100 offen offset:1024
    buffer_load_dwordx4 a[136:139], v1, s[8:11], s100 offen offset:2048
    buffer_load_dwordx4 a[140:143], v1, s[8:11], s100 offen offset:3072
    buffer_load_dwordx4 a[144:147], v15, s[8:11], s100 offen offset:0
    buffer_load_dwordx4 a[148:151], v15, s[8:11], s100 offen offset:1024
    buffer_load_dwordx4 a[152:155], v15, s[8:11], s100 offen offset:2048
    buffer_load_dwordx4 a[156:159], v15, s[8:11], s100 offen offset:3072
    v_add_f32 v80, 0, v22
    v_min_f32 v80, v80, v72
    v_add_f32 v81, 0xf1800000, v22
    v_min_f32 v81, v81, v73
    v_add_f32 v82, 0xf2000000, v22
    v_min_f32 v82, v82, v74
    v_add_f32 v83, 0xf2400000, v22
    v_min_f32 v83, v83, v75
    v_add_f32 v84, 0xf3800000, v22
    v_min_f32 v84, v84, v72
    v_add_f32 v85, 0xf3880000, v22
    v_min_f32 v85, v85, v73
    v_add_f32 v86, 0xf3900000, v22
    v_min_f32 v86, v86, v74
    v_add_f32 v87, 0xf3980000, v22
    v_min_f32 v87, v87, v75
    v_add_f32 v88, 0x73800000, v22
    v_min_f32 v88, v88, v76
    v_add_f32 v89, 0x73700000, v22
    v_min_f32 v89, v89, v77
    v_add_f32 v90, 0x73600000, v22
    v_min_f32 v90, v90, v78
    v_add_f32 v91, 0x73500000, v22
    v_min_f32 v91, v91, v79
    v_add_f32 v92, 0, v22
    v_min_f32 v92, v92, v76
    v_add_f32 v93, 0xf1800000, v22
    v_min_f32 v93, v93, v77
    v_add_f32 v94, 0xf2000000, v22
    v_min_f32 v94, v94, v78
    v_add_f32 v95, 0xf2400000, v22
    v_min_f32 v95, v95, v79
    s_waitcnt vmcnt(7)
    v_mfma_f32_16x16x32_bf16 v[96:99], a[128:131], a[96:99], v[80:83]
    s_waitcnt vmcnt(6)
    v_mfma_f32_16x16x32_bf16 v[96:99], a[132:135], a[100:103], v[96:99]
    s_waitcnt vmcnt(5)
    v_mfma_f32_16x16x32_bf16 v[96:99], a[136:139], a[104:107], v[96:99]
    s_waitcnt vmcnt(4)
    v_mfma_f32_16x16x32_bf16 v[96:99], a[140:143], a[108:111], v[96:99]
    v_mfma_f32_16x16x32_bf16 v[104:107], a[128:131], a[112:115], v[88:91]
    v_mfma_f32_16x16x32_bf16 v[104:107], a[132:135], a[116:119], v[104:107]
    v_mfma_f32_16x16x32_bf16 v[104:107], a[136:139], a[120:123], v[104:107]
    v_mfma_f32_16x16x32_bf16 v[104:107], a[140:143], a[124:127], v[104:107]
    s_waitcnt vmcnt(3)
    v_mfma_f32_16x16x32_bf16 v[100:103], a[144:147], a[96:99], v[84:87]
    s_waitcnt vmcnt(2)
    v_mfma_f32_16x16x32_bf16 v[100:103], a[148:151], a[100:103], v[100:103]
    s_waitcnt vmcnt(1)
    v_mfma_f32_16x16x32_bf16 v[100:103], a[152:155], a[104:107], v[100:103]
    s_waitcnt vmcnt(0)
    v_mfma_f32_16x16x32_bf16 v[100:103], a[156:159], a[108:111], v[100:103]
    v_mfma_f32_16x16x32_bf16 v[108:111], a[144:147], a[112:115], v[92:95]
    v_mfma_f32_16x16x32_bf16 v[108:111], a[148:151], a[116:119], v[108:111]
    v_mfma_f32_16x16x32_bf16 v[108:111], a[152:155], a[120:123], v[108:111]
    v_mfma_f32_16x16x32_bf16 v[108:111], a[156:159], a[124:127], v[108:111]
    v_max3_f32 v50, v50, v96, v97
    v_max3_f32 v50, v50, v98, v99
    s_nop 1
    v_max3_f32 v50, v50, v100, v101
    v_max3_f32 v50, v50, v102, v103
    v_max3_f32 v51, v51, v104, v105
    v_max3_f32 v51, v51, v106, v107
    v_max3_f32 v51, v51, v108, v109
    v_max3_f32 v51, v51, v110, v111
    v_mov_b32 v52, v48
    v_mov_b32 v53, v49
    v_mov_b32 v54, v50
    v_mov_b32 v55, v51
    v_permlane16_swap_b32 v48, v52
    v_permlane16_swap_b32 v49, v53
    v_permlane16_swap_b32 v50, v54
    v_permlane16_swap_b32 v51, v55
    v_max_f32 v48, v48, v52
    v_max_f32 v49, v49, v53
    v_max_f32 v50, v50, v54
    v_max_f32 v51, v51, v55
    v_mov_b32 v52, v48
    v_mov_b32 v53, v49
    v_mov_b32 v54, v50
    v_mov_b32 v55, v51
    v_permlane32_swap_b32 v48, v52
    v_permlane32_swap_b32 v49, v53
    v_permlane32_swap_b32 v50, v54
    v_permlane32_swap_b32 v51, v55
    v_max_f32 v48, v48, v52
    v_max_f32 v49, v49, v53
    v_max_f32 v50, v50, v54
    v_max_f32 v51, v51, v55
    ds_write_b128 v16, v[48:51] offset:32768
    v_xor_b32 v8, 8192, v16
    s_waitcnt lgkmcnt(0)
    s_barrier
    ds_read_b128 v[52:55], v8 offset:32768
    s_waitcnt lgkmcnt(0)
    v_max_f32 v48, v48, v52
    v_max_f32 v49, v49, v53
    v_max_f32 v50, v50, v54
    v_max_f32 v51, v51, v55
    v_sub_f32 v64, 0, v48
    v_sub_f32 v65, 0, v48
    v_sub_f32 v66, 0, v48
    v_sub_f32 v67, 0, v48
    v_sub_f32 v68, 0, v49
    v_sub_f32 v69, 0, v49
    v_sub_f32 v70, 0, v49
    v_sub_f32 v71, 0, v49
    v_sub_f32 v72, 0, v50
    v_sub_f32 v73, 0, v50
    v_sub_f32 v74, 0, v50
    v_sub_f32 v75, 0, v50
    v_sub_f32 v76, 0, v51
    v_sub_f32 v77, 0, v51
    v_sub_f32 v78, 0, v51
    v_sub_f32 v79, 0, v51
    s_mov_b32 s12, 0
    s_and_b32 s100, s12, 1
    s_mul_i32 s15, s100, 196608
    s_xor_b32 s15, s15, 65536
    s_mul_i32 s16, s100, 98304
    s_xor_b32 s16, s16, 98304
    v_and_b32 v18, 0x7fff, v18
    v_or_b32 v18, s15, v18
    v_and_b32 v19, 0x7fff, v19
    v_or_b32 v19, s16, v19
    v_and_b32 v20, 0x7fff, v20
    v_or_b32 v20, s16, v20
    s_add_u32 s15, s15, s62
    s_add_u32 s16, s16, s62
    s_add_u32 s12, s12, 2
    s_mov_b32 s82, s81
    s_add_u32 s19, s81, 32768
    s_add_u32 m0, s15, 0
    s_nop 0
    buffer_load_dwordx4 v1, s[8:11], s82 offen offset:0  lds
    buffer_load_dwordx4 v1, s[8:11], s82 offen offset:1024  lds
    buffer_load_dwordx4 v1, s[8:11], s82 offen offset:2048  lds
    buffer_load_dwordx4 v1, s[8:11], s82 offen offset:3072  lds
    s_add_u32 m0, s15, 4096
    s_nop 0
    buffer_load_dwordx4 v15, s[8:11], s82 offen offset:0  lds
    buffer_load_dwordx4 v15, s[8:11], s82 offen offset:1024  lds
    buffer_load_dwordx4 v15, s[8:11], s82 offen offset:2048  lds
    buffer_load_dwordx4 v15, s[8:11], s82 offen offset:3072  lds
    s_xor_b32 s15, s15, 196608
    s_add_u32 m0, s16, 0
    s_nop 0
    buffer_load_dwordx4 v1, s[8:11], s19 offen offset:0  lds
    buffer_load_dwordx4 v1, s[8:11], s19 offen offset:1024  lds
    buffer_load_dwordx4 v1, s[8:11], s19 offen offset:2048  lds
    buffer_load_dwordx4 v1, s[8:11], s19 offen offset:3072  lds
    s_add_u32 m0, s16, 4096
    s_nop 0
    buffer_load_dwordx4 v15, s[8:11], s19 offen offset:0  lds
    buffer_load_dwordx4 v15, s[8:11], s19 offen offset:1024  lds
    buffer_load_dwordx4 v15, s[8:11], s19 offen offset:2048  lds
    buffer_load_dwordx4 v15, s[8:11], s19 offen offset:3072  lds
    s_xor_b32 s16, s16, 98304
    s_min_u32 s82, s60, 1
    s_lshl_b32 s82, s82, 16
    s_add_u32 s82, s82, s81
    s_add_u32 m0, s15, 0
    s_nop 0
    buffer_load_dwordx4 v1, s[8:11], s82 offen offset:0  lds
    buffer_load_dwordx4 v1, s[8:11], s82 offen offset:1024  lds
    buffer_load_dwordx4 v1, s[8:11], s82 offen offset:2048  lds
    buffer_load_dwordx4 v1, s[8:11], s82 offen offset:3072  lds
    s_add_u32 m0, s15, 4096
    s_nop 0
    buffer_load_dwordx4 v15, s[8:11], s82 offen offset:0  lds
    buffer_load_dwordx4 v15, s[8:11], s82 offen offset:1024  lds
    buffer_load_dwordx4 v15, s[8:11], s82 offen offset:2048  lds
    buffer_load_dwordx4 v15, s[8:11], s82 offen offset:3072  lds
    s_xor_b32 s15, s15, 196608
    s_cmp_eq_u32 s60, 0
    s_cselect_b32 s19, 0, 0x76800000
    v_add_f32 v3, s19, v21
    v_add_f32 v96, 0, v3
    v_min_f32 v96, v96, v64
    v_add_f32 v97, 0xf1800000, v3
    v_min_f32 v97, v97, v65
    v_add_f32 v98, 0xf2000000, v3
    v_min_f32 v98, v98, v66
    v_add_f32 v99, 0xf2400000, v3
    v_min_f32 v99, v99, v67
    v_add_f32 v100, 0xf3800000, v3
    v_min_f32 v100, v100, v64
    v_add_f32 v101, 0xf3880000, v3
    v_min_f32 v101, v101, v65
    v_add_f32 v102, 0xf3900000, v3
    v_min_f32 v102, v102, v66
    v_add_f32 v103, 0xf3980000, v3
    v_min_f32 v103, v103, v67
    v_add_f32 v104, 0x73800000, v3
    v_min_f32 v104, v104, v68
    v_add_f32 v105, 0x73700000, v3
    v_min_f32 v105, v105, v69
    v_add_f32 v106, 0x73600000, v3
    v_min_f32 v106, v106, v70
    v_add_f32 v107, 0x73500000, v3
    v_min_f32 v107, v107, v71
    v_add_f32 v108, 0, v3
    v_min_f32 v108, v108, v68
    v_add_f32 v109, 0xf1800000, v3
    v_min_f32 v109, v109, v69
    v_add_f32 v110, 0xf2000000, v3
    v_min_f32 v110, v110, v70
    v_add_f32 v111, 0xf2400000, v3
    v_min_f32 v111, v111, v71
    v_add_f32 v80, 0, v22
    v_min_f32 v80, v80, v72
    v_add_f32 v81, 0xf1800000, v22
    v_min_f32 v81, v81, v73
    v_add_f32 v82, 0xf2000000, v22
    v_min_f32 v82, v82, v74
    v_add_f32 v83, 0xf2400000, v22
    v_min_f32 v83, v83, v75
    v_add_f32 v84, 0xf3800000, v22
    v_min_f32 v84, v84, v72
    v_add_f32 v85, 0xf3880000, v22
    v_min_f32 v85, v85, v73
    v_add_f32 v86, 0xf3900000, v22
    v_min_f32 v86, v86, v74
    v_add_f32 v87, 0xf3980000, v22
    v_min_f32 v87, v87, v75
    v_add_f32 v88, 0x73800000, v22
    v_min_f32 v88, v88, v76
    v_add_f32 v89, 0x73700000, v22
    v_min_f32 v89, v89, v77
    v_add_f32 v90, 0x73600000, v22
    v_min_f32 v90, v90, v78
    v_add_f32 v91, 0x73500000, v22
    v_min_f32 v91, v91, v79
    v_add_f32 v92, 0, v22
    v_min_f32 v92, v92, v76
    v_add_f32 v93, 0xf1800000, v22
    v_min_f32 v93, v93, v77
    v_add_f32 v94, 0xf2000000, v22
    v_min_f32 v94, v94, v78
    v_add_f32 v95, 0xf2400000, v22
    v_min_f32 v95, v95, v79
    s_cmp_eq_u32 s60, 0
    s_cbranch_scc1 L_t1_mk
    v_add_f32 v80, 0, v21
    v_min_f32 v80, v80, v64
    v_add_f32 v81, 0xf1800000, v21
    v_min_f32 v81, v81, v65
    v_add_f32 v82, 0xf2000000, v21
    v_min_f32 v82, v82, v66
    v_add_f32 v83, 0xf2400000, v21
    v_min_f32 v83, v83, v67
    v_add_f32 v84, 0xf3800000, v21
    v_min_f32 v84, v84, v64
    v_add_f32 v85, 0xf3880000, v21
    v_min_f32 v85, v85, v65
    v_add_f32 v86, 0xf3900000, v21
    v_min_f32 v86, v86, v66
    v_add_f32 v87, 0xf3980000, v21
    v_min_f32 v87, v87, v67
    v_add_f32 v88, 0x73800000, v21
    v_min_f32 v88, v88, v68
    v_add_f32 v89, 0x73700000, v21
    v_min_f32 v89, v89, v69
    v_add_f32 v90, 0x73600000, v21
    v_min_f32 v90, v90, v70
    v_add_f32 v91, 0x73500000, v21
    v_min_f32 v91, v91, v71
    v_add_f32 v92, 0, v21
    v_min_f32 v92, v92, v68
    v_add_f32 v93, 0xf1800000, v21
    v_min_f32 v93, v93, v69
    v_add_f32 v94, 0xf2000000, v21
    v_min_f32 v94, v94, v70
    v_add_f32 v95, 0xf2400000, v21
    v_min_f32 v95, v95, v71
L_t1_mk:
    s_waitcnt vmcnt(0) lgkmcnt(0)
    s_barrier
    ds_read_b128 a[128:131], v18 offset:0
    ds_read_b128 a[132:135], v18 offset:1024
    ds_read_b128 a[136:139], v18 offset:2048
    ds_read_b128 a[140:143], v18 offset:3072
    ds_read_b128 a[144:147], v18 offset:4096
    ds_read_b128 a[148:151], v18 offset:5120
    ds_read_b128 a[152:155], v18 offset:6144
    ds_read_b128 a[156:159], v18 offset:7168
    s_waitcnt lgkmcnt(0)
    s_branch L_t1_start
L_C1_slow_9:
    s_mov_b32 s99, 0
L_C1_slow_9_l:
    s_sleep 4
    buffer_load_dword v3, v4, s[8:11], s23 offen sc0 sc1
    s_add_u32 s99, s99, 1
    s_waitcnt vmcnt(0)
    v_cmp_ne_u32 vcc, 0, v3
    s_cmp_eq_u64 vcc, -1
    s_cbranch_scc1 L_C1_ok_10
    s_cmp_lt_u32 s99, 200000
    s_cbranch_scc1 L_C1_slow_9_l
    s_branch L_C1_ok_10
L_F_slow_11:
    s_mov_b32 s99, 0
L_F_slow_11_l:
    s_sleep 4
    buffer_load_dword v3, v12, s[8:11], s71 offen sc0 sc1
    s_add_u32 s99, s99, 1
    s_waitcnt vmcnt(0)
    v_cmp_ne_u32 vcc, 0, v3
    s_cmp_eq_u64 vcc, -1
    s_cbranch_scc1 L_F_ok_12
    s_cmp_lt_u32 s99, 200000
    s_cbranch_scc1 L_F_slow_11_l
    s_branch L_F_ok_12
L_t2_redo:
    s_cmp_eq_u32 s25, 0
    s_cbranch_scc1 L_t2_max
    s_mov_b32 s25, 0
    v_mov_b32 v64, 0
    v_mov_b32 v65, 0
    v_mov_b32 v66, 0
    v_mov_b32 v67, 0
    v_mov_b32 v68, 0
    v_mov_b32 v69, 0
    v_mov_b32 v70, 0
    v_mov_b32 v71, 0
    v_mov_b32 v72, 0
    v_mov_b32 v73, 0
    v_mov_b32 v74, 0
    v_mov_b32 v75, 0
    v_mov_b32 v76, 0
    v_mov_b32 v77, 0
    v_mov_b32 v78, 0
    v_mov_b32 v79, 0
    s_nop 1
    s_branch L_t2_safe
L_t2_max:
    s_waitcnt vmcnt(0) lgkmcnt(0)
    s_barrier
    s_mov_b32 s25, 1
    s_and_b32 s100, s3, 1
    s_lshl_b32 s100, s100, 13
    s_sub_u32 s101, s81, s62
    s_add_u32 s101, s101, s100
    s_mov_b32 s14, s61
    s_mov_b32 s26, 0
    v_mov_b32 v24, -1
    v_mov_b32 v25, -1
    v_mov_b32 v26, -1
    v_mov_b32 v27, -1
    v_mov_b32 v48, 0xff800000
    v_mov_b32 v49, 0xff800000
    v_mov_b32 v50, 0xff800000
    v_mov_b32 v51, 0xff800000
L_t2_maxl:
    s_cmp_eq_u32 s14, 0
    s_cbranch_scc1 L_t2_maxd
    s_add_u32 s100, s101, 0
    buffer_load_dwordx4 a[128:131], v1, s[8:11], s100 offen offset:0
    buffer_load_dwordx4 a[132:135], v1, s[8:11], s100 offen offset:1024
    buffer_load_dwordx4 a[136:139], v1, s[8:11], s100 offen offset:2048
    buffer_load_dwordx4 a[140:143], v1, s[8:11], s100 offen offset:3072
    buffer_load_dwordx4 a[144:147], v15, s[8:11], s100 offen offset:0
    buffer_load_dwordx4 a[148:151], v15, s[8:11], s100 offen offset:1024
    buffer_load_dwordx4 a[152:155], v15, s[8:11], s100 offen offset:2048
    buffer_load_dwordx4 a[156:159], v15, s[8:11], s100 offen offset:3072
    s_waitcnt vmcnt(7)
    v_mfma_f32_16x16x32_bf16 v[96:99], a[128:131], a[192:195], v[64:67]
    s_waitcnt vmcnt(6)
    v_mfma_f32_16x16x32_bf16 v[96:99], a[132:135], a[196:199], v[96:99]
    s_waitcnt vmcnt(5)
    v_mfma_f32_16x16x32_bf16 v[96:99], a[136:139], a[200:203], v[96:99]
    s_waitcnt vmcnt(4)
    v_mfma_f32_16x16x32_bf16 v[96:99], a[140:143], a[204:207], v[96:99]
    v_mfma_f32_16x16x32_bf16 v[104:107], a[128:131], a[208:211], v[68:71]
    v_mfma_f32_16x16x32_bf16 v[104:107], a[132:135], a[212:215], v[104:107]
    v_mfma_f32_16x16x32_bf16 v[104:107], a[136:139], a[216:219], v[104:107]
    v_mfma_f32_16x16x32_bf16 v[104:107], a[140:143], a[220:223], v[104:107]
    s_waitcnt vmcnt(3)
    v_mfma_f32_16x16x32_bf16 v[100:103], a[144:147], a[192:195], v[64:67]
    s_waitcnt vmcnt(2)
    v_mfma_f32_16x16x32_bf16 v[100:103], a[148:151], a[196:199], v[100:103]
    s_waitcnt vmcnt(1)
    v_mfma_f32_16x16x32_bf16 v[100:103], a[152:155], a[200:203], v[100:103]
    s_waitcnt vmcnt(0)
    v_mfma_f32_16x16x32_bf16 v[100:103], a[156:159], a[204:207], v[100:103]
    v_mfma_f32_16x16x32_bf16 v[108:111], a[144:147], a[208:211], v[68:71]
    v_mfma_f32_16x16x32_bf16 v[108:111], a[148:151], a[212:215], v[108:111]
    v_mfma_f32_16x16x32_bf16 v[108:111], a[152:155], a[216:219], v[108:111]
    v_mfma_f32_16x16x32_bf16 v[108:111], a[156:159], a[220:223], v[108:111]
    v_mfma_f32_16x16x32_bf16 v[112:115], a[128:131], a[224:227], v[72:75]
    v_mfma_f32_16x16x32_bf16 v[112:115], a[132:135], a[228:231], v[112:115]
    v_mfma_f32_16x16x32_bf16 v[112:115], a[136:139], a[232:235], v[112:115]
    v_mfma_f32_16x16x32_bf16 v[112:115], a[140:143], a[236:239], v[112:115]
    v_mfma_f32_16x16x32_bf16 v[120:123], a[128:131], a[240:243], v[76:79]
    v_mfma_f32_16x16x32_bf16 v[120:123], a[132:135], a[244:247], v[120:123]
    v_mfma_f32_16x16x32_bf16 v[120:123], a[136:139], a[248:251], v[120:123]
    v_mfma_f32_16x16x32_bf16 v[120:123], a[140:143], a[252:255], v[120:123]
    v_mfma_f32_16x16x32_bf16 v[116:119], a[144:147], a[224:227], v[72:75]
    v_mfma_f32_16x16x32_bf16 v[116:119], a[148:151], a[228:231], v[116:119]
    v_mfma_f32_16x16x32_bf16 v[116:119], a[152:155], a[232:235], v[116:119]
    v_mfma_f32_16x16x32_bf16 v[116:119], a[156:159], a[236:239], v[116:119]
    v_mfma_f32_16x16x32_bf16 v[124:127], a[144:147], a[240:243], v[76:79]
    v_mfma_f32_16x16x32_bf16 v[124:127], a[148:151], a[244:247], v[124:127]
    v_mfma_f32_16x16x32_bf16 v[124:127], a[152:155], a[248:251], v[124:127]
    v_mfma_f32_16x16x32_bf16 v[124:127], a[156:159], a[252:255], v[124:127]
    v_max3_f32 v48, v48, v96, v97
    v_max3_f32 v48, v48, v98, v99
    v_max3_f32 v48, v48, v100, v101
    v_max3_f32 v48, v48, v102, v103
    v_max3_f32 v49, v49, v104, v105
    v_max3_f32 v49, v49, v106, v107
    v_max3_f32 v49, v49, v108, v109
    v_max3_f32 v49, v49, v110, v111
    v_max3_f32 v50, v50, v112, v113
    v_max3_f32 v50, v50, v114, v115
    v_max3_f32 v50, v50, v116, v117
    v_max3_f32 v50, v50, v118, v119
    v_max3_f32 v51, v51, v120, v121
    v_max3_f32 v51, v51, v122, v123
    v_max3_f32 v51, v51, v124, v125
    v_max3_f32 v51, v51, v126, v127
    s_add_u32 s100, s101, 16384
    buffer_load_dwordx4 a[128:131], v1, s[8:11], s100 offen offset:0
    buffer_load_dwordx4 a[132:135], v1, s[8:11], s100 offen offset:1024
    buffer_load_dwordx4 a[136:139], v1, s[8:11], s100 offen offset:2048
    buffer_load_dwordx4 a[140:143], v1, s[8:11], s100 offen offset:3072
    buffer_load_dwordx4 a[144:147], v15, s[8:11], s100 offen offset:0
    buffer_load_dwordx4 a[148:151], v15, s[8:11], s100 offen offset:1024
    buffer_load_dwordx4 a[152:155], v15, s[8:11], s100 offen offset:2048
    buffer_load_dwordx4 a[156:159], v15, s[8:11], s100 offen offset:3072
    s_waitcnt vmcnt(7)
    v_mfma_f32_16x16x32_bf16 v[96:99], a[128:131], a[192:195], v[64:67]
    s_waitcnt vmcnt(6)
    v_mfma_f32_16x16x32_bf16 v[96:99], a[132:135], a[196:199], v[96:99]
    s_waitcnt vmcnt(5)
    v_mfma_f32_16x16x32_bf16 v[96:99], a[136:139], a[200:203], v[96:99]
    s_waitcnt vmcnt(4)
    v_mfma_f32_16x16x32_bf16 v[96:99], a[140:143], a[204:207], v[96:99]
    v_mfma_f32_16x16x32_bf16 v[104:107], a[128:131], a[208:211], v[68:71]
    v_mfma_f32_16x16x32_bf16 v[104:107], a[132:135], a[212:215], v[104:107]
    v_mfma_f32_16x16x32_bf16 v[104:107], a[136:139], a[216:219], v[104:107]
    v_mfma_f32_16x16x32_bf16 v[104:107], a[140:143], a[220:223], v[104:107]
    s_waitcnt vmcnt(3)
    v_mfma_f32_16x16x32_bf16 v[100:103], a[144:147], a[192:195], v[64:67]
    s_waitcnt vmcnt(2)
    v_mfma_f32_16x16x32_bf16 v[100:103], a[148:151], a[196:199], v[100:103]
    s_waitcnt vmcnt(1)
    v_mfma_f32_16x16x32_bf16 v[100:103], a[152:155], a[200:203], v[100:103]
    s_waitcnt vmcnt(0)
    v_mfma_f32_16x16x32_bf16 v[100:103], a[156:159], a[204:207], v[100:103]
    v_mfma_f32_16x16x32_bf16 v[108:111], a[144:147], a[208:211], v[68:71]
    v_mfma_f32_16x16x32_bf16 v[108:111], a[148:151], a[212:215], v[108:111]
    v_mfma_f32_16x16x32_bf16 v[108:111], a[152:155], a[216:219], v[108:111]
    v_mfma_f32_16x16x32_bf16 v[108:111], a[156:159], a[220:223], v[108:111]
    v_mfma_f32_16x16x32_bf16 v[112:115], a[128:131], a[224:227], v[72:75]
    v_mfma_f32_16x16x32_bf16 v[112:115], a[132:135], a[228:231], v[112:115]
    v_mfma_f32_16x16x32_bf16 v[112:115], a[136:139], a[232:235], v[112:115]
    v_mfma_f32_16x16x32_bf16 v[112:115], a[140:143], a[236:239], v[112:115]
    v_mfma_f32_16x16x32_bf16 v[120:123], a[128:131], a[240:243], v[76:79]
    v_mfma_f32_16x16x32_bf16 v[120:123], a[132:135], a[244:247], v[120:123]
    v_mfma_f32_16x16x32_bf16 v[120:123], a[136:139], a[248:251], v[120:123]
    v_mfma_f32_16x16x32_bf16 v[120:123], a[140:143], a[252:255], v[120:123]
    v_mfma_f32_16x16x32_bf16 v[116:119], a[144:147], a[224:227], v[72:75]
    v_mfma_f32_16x16x32_bf16 v[116:119], a[148:151], a[228:231], v[116:119]
    v_mfma_f32_16x16x32_bf16 v[116:119], a[152:155], a[232:235], v[116:119]
    v_mfma_f32_16x16x32_bf16 v[116:119], a[156:159], a[236:239], v[116:119]
    v_mfma_f32_16x16x32_bf16 v[124:127], a[144:147], a[240:243], v[76:79]
    v_mfma_f32_16x16x32_bf16 v[124:127], a[148:151], a[244:247], v[124:127]
    v_mfma_f32_16x16x32_bf16 v[124:127], a[152:155], a[248:251], v[124:127]
    v_mfma_f32_16x16x32_bf16 v[124:127], a[156:159], a[252:255], v[124:127]
    v_max3_f32 v48, v48, v96, v97
    v_max3_f32 v48, v48, v98, v99
    v_max3_f32 v48, v48, v100, v101
    v_max3_f32 v48, v48, v102, v103
    v_max3_f32 v49, v49, v104, v105
    v_max3_f32 v49, v49, v106, v107
    v_max3_f32 v49, v49, v108, v109
    v_max3_f32 v49, v49, v110, v111
    v_max3_f32 v50, v50, v112, v113
    v_max3_f32 v50, v50, v114, v115
    v_max3_f32 v50, v50, v116, v117
    v_max3_f32 v50, v50, v118, v119
    v_max3_f32 v51, v51, v120, v121
    v_max3_f32 v51, v51, v122, v123
    v_max3_f32 v51, v51, v124, v125
    v_max3_f32 v51, v51, v126, v127
    s_add_u32 s101, s101, 65536
    s_sub_u32 s14, s14, 1
    s_nop 7
    s_branch L_t2_maxl
L_t2_maxd:
    s_add_u32 s100, s101, 0
    buffer_load_dwordx4 a[128:131], v1, s[8:11], s100 offen offset:0
    buffer_load_dwordx4 a[132:135], v1, s[8:11], s100 offen offset:1024
    buffer_load_dwordx4 a[136:139], v1, s[8:11], s100 offen offset:2048
    buffer_load_dwordx4 a[140:143], v1, s[8:11], s100 offen offset:3072
    buffer_load_dwordx4 a[144:147], v15, s[8:11], s100 offen offset:0
    buffer_load_dwordx4 a[148:151], v15, s[8:11], s100 offen offset:1024
    buffer_load_dwordx4 a[152:155], v15, s[8:11], s100 offen offset:2048
    buffer_load_dwordx4 a[156:159], v15, s[8:11], s100 offen offset:3072
    v_add_f32 v80, 0, v21
    v_min_f32 v80, v80, v64
    v_add_f32 v81, 0xf1800000, v21
    v_min_f32 v81, v81, v65
    v_add_f32 v82, 0xf2000000, v21
    v_min_f32 v82, v82, v66
    v_add_f32 v83, 0xf2400000, v21
    v_min_f32 v83, v83, v67
    v_add_f32 v84, 0xf3800000, v21
    v_min_f32 v84, v84, v64
    v_add_f32 v85, 0xf3880000, v21
    v_min_f32 v85, v85, v65
    v_add_f32 v86, 0xf3900000, v21
    v_min_f32 v86, v86, v66
    v_add_f32 v87, 0xf3980000, v21
    v_min_f32 v87, v87, v67
    v_add_f32 v88, 0x73800000, v21
    v_min_f32 v88, v88, v68
    v_add_f32 v89, 0x73700000, v21
    v_min_f32 v89, v89, v69
    v_add_f32 v90, 0x73600000, v21
    v_min_f32 v90, v90, v70
    v_add_f32 v91, 0x73500000, v21
    v_min_f32 v91, v91, v71
    v_add_f32 v92, 0, v21
    v_min_f32 v92, v92, v68
    v_add_f32 v93, 0xf1800000, v21
    v_min_f32 v93, v93, v69
    v_add_f32 v94, 0xf2000000, v21
    v_min_f32 v94, v94, v70
    v_add_f32 v95, 0xf2400000, v21
    v_min_f32 v95, v95, v71
    s_waitcnt vmcnt(7)
    v_mfma_f32_16x16x32_bf16 v[96:99], a[128:131], a[192:195], v[80:83]
    s_waitcnt vmcnt(6)
    v_mfma_f32_16x16x32_bf16 v[96:99], a[132:135], a[196:199], v[96:99]
    s_waitcnt vmcnt(5)
    v_mfma_f32_16x16x32_bf16 v[96:99], a[136:139], a[200:203], v[96:99]
    s_waitcnt vmcnt(4)
    v_mfma_f32_16x16x32_bf16 v[96:99], a[140:143], a[204:207], v[96:99]
    v_mfma_f32_16x16x32_bf16 v[104:107], a[128:131], a[208:211], v[88:91]
    v_mfma_f32_16x16x32_bf16 v[104:107], a[132:135], a[212:215], v[104:107]
    v_mfma_f32_16x16x32_bf16 v[104:107], a[136:139], a[216:219], v[104:107]
    v_mfma_f32_16x16x32_bf16 v[104:107], a[140:143], a[220:223], v[104:107]
    s_waitcnt vmcnt(3)
    v_mfma_f32_16x16x32_bf16 v[100:103], a[144:147], a[192:195], v[84:87]
    s_waitcnt vmcnt(2)
    v_mfma_f32_16x16x32_bf16 v[100:103], a[148:151], a[196:199], v[100:103]
    s_waitcnt vmcnt(1)
    v_mfma_f32_16x16x32_bf16 v[100:103], a[152:155], a[200:203], v[100:103]
    s_waitcnt vmcnt(0)
    v_mfma_f32_16x16x32_bf16 v[100:103], a[156:159], a[204:207], v[100:103]
    v_mfma_f32_16x16x32_bf16 v[108:111], a[144:147], a[208:211], v[92:95]
    v_mfma_f32_16x16x32_bf16 v[108:111], a[148:151], a[212:215], v[108:111]
    v_mfma_f32_16x16x32_bf16 v[108:111], a[152:155], a[216:219], v[108:111]
    v_mfma_f32_16x16x32_bf16 v[108:111], a[156:159], a[220:223], v[108:111]
    v_mfma_f32_16x16x32_bf16 v[112:115], a[128:131], a[224:227], v[72:75]
    v_mfma_f32_16x16x32_bf16 v[112:115], a[132:135], a[228:231], v[112:115]
    v_mfma_f32_16x16x32_bf16 v[112:115], a[136:139], a[232:235], v[112:115]
    v_mfma_f32_16x16x32_bf16 v[112:115], a[140:143], a[236:239], v[112:115]
    v_mfma_f32_16x16x32_bf16 v[120:123], a[128:131], a[240:243], v[76:79]
    v_mfma_f32_16x16x32_bf16 v[120:123], a[132:135], a[244:247], v[120:123]
    v_mfma_f32_16x16x32_bf16 v[120:123], a[136:139], a[248:251], v[120:123]
    v_mfma_f32_16x16x32_bf16 v[120:123], a[140:143], a[252:255], v[120:123]
    v_mfma_f32_16x16x32_bf16 v[116:119], a[144:147], a[224:227], v[72:75]
    v_mfma_f32_16x16x32_bf16 v[116:119], a[148:151], a[228:231], v[116:119]
    v_mfma_f32_16x16x32_bf16 v[116:119], a[152:155], a[232:235], v[116:119]
    v_mfma_f32_16x16x32_bf16 v[116:119], a[156:159], a[236:239], v[116:119]
    v_mfma_f32_16x16x32_bf16 v[124:127], a[144:147], a[240:243], v[76:79]
    v_mfma_f32_16x16x32_bf16 v[124:127], a[148:151], a[244:247], v[124:127]
    v_mfma_f32_16x16x32_bf16 v[124:127], a[152:155], a[248:251], v[124:127]
    v_mfma_f32_16x16x32_bf16 v[124:127], a[156:159], a[252:255], v[124:127]
    v_max3_f32 v48, v48, v96, v97
    v_max3_f32 v48, v48, v98, v99
    v_max3_f32 v48, v48, v100, v101
    v_max3_f32 v48, v48, v102, v103
    v_max3_f32 v49, v49, v104, v105
    v_max3_f32 v49, v49, v106, v107
    v_max3_f32 v49, v49, v108, v109
    v_max3_f32 v49, v49, v110, v111
    v_max3_f32 v50, v50, v112, v113
    v_max3_f32 v50, v50, v114, v115
    v_max3_f32 v50, v50, v116, v117
    v_max3_f32 v50, v50, v118, v119
    v_max3_f32 v51, v51, v120, v121
    v_max3_f32 v51, v51, v122, v123
    v_max3_f32 v51, v51, v124, v125
    v_max3_f32 v51, v51, v126, v127
    s_add_u32 s100, s101, 16384
    buffer_load_dwordx4 a[128:131], v1, s[8:11], s100 offen offset:0
    buffer_load_dwordx4 a[132:135], v1, s[8:11], s100 offen offset:1024
    buffer_load_dwordx4 a[136:139], v1, s[8:11], s100 offen offset:2048
    buffer_load_dwordx4 a[140:143], v1, s[8:11], s100 offen offset:3072
    buffer_load_dwordx4 a[144:147], v15, s[8:11], s100 offen offset:0
    buffer_load_dwordx4 a[148:151], v15, s[8:11], s100 offen offset:1024
    buffer_load_dwordx4 a[152:155], v15, s[8:11], s100 offen offset:2048
    buffer_load_dwordx4 a[156:159], v15, s[8:11], s100 offen offset:3072
    v_add_f32 v80, 0, v22
    v_min_f32 v80, v80, v72
    v_add_f32 v81, 0xf1800000, v22
    v_min_f32 v81, v81, v73
    v_add_f32 v82, 0xf2000000, v22
    v_min_f32 v82, v82, v74
    v_add_f32 v83, 0xf2400000, v22
    v_min_f32 v83, v83, v75
    v_add_f32 v84, 0xf3800000, v22
    v_min_f32 v84, v84, v72
    v_add_f32 v85, 0xf3880000, v22
    v_min_f32 v85, v85, v73
    v_add_f32 v86, 0xf3900000, v22
    v_min_f32 v86, v86, v74
    v_add_f32 v87, 0xf3980000, v22
    v_min_f32 v87, v87, v75
    v_add_f32 v88, 0x73800000, v22
    v_min_f32 v88, v88, v76
    v_add_f32 v89, 0x73700000, v22
    v_min_f32 v89, v89, v77
    v_add_f32 v90, 0x73600000, v22
    v_min_f32 v90, v90, v78
    v_add_f32 v91, 0x73500000, v22
    v_min_f32 v91, v91, v79
    v_add_f32 v92, 0, v22
    v_min_f32 v92, v92, v76
    v_add_f32 v93, 0xf1800000, v22
    v_min_f32 v93, v93, v77
    v_add_f32 v94, 0xf2000000, v22
    v_min_f32 v94, v94, v78
    v_add_f32 v95, 0xf2400000, v22
    v_min_f32 v95, v95, v79
    s_waitcnt vmcnt(7)
    v_mfma_f32_16x16x32_bf16 v[96:99], a[128:131], a[224:227], v[80:83]
    s_waitcnt vmcnt(6)
    v_mfma_f32_16x16x32_bf16 v[96:99], a[132:135], a[228:231], v[96:99]
    s_waitcnt vmcnt(5)
    v_mfma_f32_16x16x32_bf16 v[96:99], a[136:139], a[232:235], v[96:99]
    s_waitcnt vmcnt(4)
    v_mfma_f32_16x16x32_bf16 v[96:99], a[140:143], a[236:239], v[96:99]
    v_mfma_f32_16x16x32_bf16 v[104:107], a[128:131], a[240:243], v[88:91]
    v_mfma_f32_16x16x32_bf16 v[104:107], a[132:135], a[244:247], v[104:107]
    v_mfma_f32_16x16x32_bf16 v[104:107], a[136:139], a[248:251], v[104:107]
    v_mfma_f32_16x16x32_bf16 v[104:107], a[140:143], a[252:255], v[104:107]
    s_waitcnt vmcnt(3)
    v_mfma_f32_16x16x32_bf16 v[100:103], a[144:147], a[224:227], v[84:87]
    s_waitcnt vmcnt(2)
    v_mfma_f32_16x16x32_bf16 v[100:103], a[148:151], a[228:231], v[100:103]
    s_waitcnt vmcnt(1)
    v_mfma_f32_16x16x32_bf16 v[100:103], a[152:155], a[232:235], v[100:103]
    s_waitcnt vmcnt(0)
    v_mfma_f32_16x16x32_bf16 v[100:103], a[156:159], a[236:239], v[100:103]
    v_mfma_f32_16x16x32_bf16 v[108:111], a[144:147], a[240:243], v[92:95]
    v_mfma_f32_16x16x32_bf16 v[108:111], a[148:151], a[244:247], v[108:111]
    v_mfma_f32_16x16x32_bf16 v[108:111], a[152:155], a[248:251], v[108:111]
    v_mfma_f32_16x16x32_bf16 v[108:111], a[156:159], a[252:255], v[108:111]
    v_max3_f32 v50, v50, v96, v97
    v_max3_f32 v50, v50, v98, v99
    s_nop 1
    v_max3_f32 v50, v50, v100, v101
    v_max3_f32 v50, v50, v102, v103
    v_max3_f32 v51, v51, v104, v105
    v_max3_f32 v51, v51, v106, v107
    v_max3_f32 v51, v51, v108, v109
    v_max3_f32 v51, v51, v110, v111
    v_mov_b32 v52, v48
    v_mov_b32 v53, v49
    v_mov_b32 v54, v50
    v_mov_b32 v55, v51
    v_permlane16_swap_b32 v48, v52
    v_permlane16_swap_b32 v49, v53
    v_permlane16_swap_b32 v50, v54
    v_permlane16_swap_b32 v51, v55
    v_max_f32 v48, v48, v52
    v_max_f32 v49, v49, v53
    v_max_f32 v50, v50, v54
    v_max_f32 v51, v51, v55
    v_mov_b32 v52, v48
    v_mov_b32 v53, v49
    v_mov_b32 v54, v50
    v_mov_b32 v55, v51
    v_permlane32_swap_b32 v48, v52
    v_permlane32_swap_b32 v49, v53
    v_permlane32_swap_b32 v50, v54
    v_permlane32_swap_b32 v51, v55
    v_max_f32 v48, v48, v52
    v_max_f32 v49, v49, v53
    v_max_f32 v50, v50, v54
    v_max_f32 v51, v51, v55
    ds_write_b128 v16, v[48:51] offset:32768
    v_xor_b32 v8, 8192, v16
    s_waitcnt lgkmcnt(0)
    s_barrier
    ds_read_b128 v[52:55], v8 offset:32768
    s_waitcnt lgkmcnt(0)
    v_max_f32 v48, v48, v52
    v_max_f32 v49, v49, v53
    v_max_f32 v50, v50, v54
    v_max_f32 v51, v51, v55
    v_sub_f32 v64, 0, v48
    v_sub_f32 v65, 0, v48
    v_sub_f32 v66, 0, v48
    v_sub_f32 v67, 0, v48
    v_sub_f32 v68, 0, v49
    v_sub_f32 v69, 0, v49
    v_sub_f32 v70, 0, v49
    v_sub_f32 v71, 0, v49
    v_sub_f32 v72, 0, v50
    v_sub_f32 v73, 0, v50
    v_sub_f32 v74, 0, v50
    v_sub_f32 v75, 0, v50
    v_sub_f32 v76, 0, v51
    v_sub_f32 v77, 0, v51
    v_sub_f32 v78, 0, v51
    v_sub_f32 v79, 0, v51
    s_add_u32 s12, s13, 1
    s_and_b32 s100, s12, 1
    s_mul_i32 s15, s100, 196608
    s_xor_b32 s15, s15, 65536
    s_mul_i32 s16, s100, 98304
    s_xor_b32 s16, s16, 98304
    v_and_b32 v18, 0x7fff, v18
    v_or_b32 v18, s15, v18
    v_and_b32 v19, 0x7fff, v19
    v_or_b32 v19, s16, v19
    v_and_b32 v20, 0x7fff, v20
    v_or_b32 v20, s16, v20
    s_add_u32 s15, s15, s62
    s_add_u32 s16, s16, s62
    s_add_u32 s12, s12, 2
    s_mov_b32 s82, s81
    s_add_u32 s19, s81, 32768
    s_add_u32 m0, s15, 0
    s_nop 0
    buffer_load_dwordx4 v1, s[8:11], s82 offen offset:0  lds
    buffer_load_dwordx4 v1, s[8:11], s82 offen offset:1024  lds
    buffer_load_dwordx4 v1, s[8:11], s82 offen offset:2048  lds
    buffer_load_dwordx4 v1, s[8:11], s82 offen offset:3072  lds
    s_add_u32 m0, s15, 4096
    s_nop 0
    buffer_load_dwordx4 v15, s[8:11], s82 offen offset:0  lds
    buffer_load_dwordx4 v15, s[8:11], s82 offen offset:1024  lds
    buffer_load_dwordx4 v15, s[8:11], s82 offen offset:2048  lds
    buffer_load_dwordx4 v15, s[8:11], s82 offen offset:3072  lds
    s_xor_b32 s15, s15, 196608
    s_add_u32 m0, s16, 0
    s_nop 0
    buffer_load_dwordx4 v1, s[8:11], s19 offen offset:0  lds
    buffer_load_dwordx4 v1, s[8:11], s19 offen offset:1024  lds
    buffer_load_dwordx4 v1, s[8:11], s19 offen offset:2048  lds
    buffer_load_dwordx4 v1, s[8:11], s19 offen offset:3072  lds
    s_add_u32 m0, s16, 4096
    s_nop 0
    buffer_load_dwordx4 v15, s[8:11], s19 offen offset:0  lds
    buffer_load_dwordx4 v15, s[8:11], s19 offen offset:1024  lds
    buffer_load_dwordx4 v15, s[8:11], s19 offen offset:2048  lds
    buffer_load_dwordx4 v15, s[8:11], s19 offen offset:3072  lds
    s_xor_b32 s16, s16, 98304
    s_min_u32 s82, s61, 1
    s_lshl_b32 s82, s82, 16
    s_add_u32 s82, s82, s81
    s_add_u32 m0, s15, 0
    s_nop 0
    buffer_load_dwordx4 v1, s[8:11], s82 offen offset:0  lds
    buffer_load_dwordx4 v1, s[8:11], s82 offen offset:1024  lds
    buffer_load_dwordx4 v1, s[8:11], s82 offen offset:2048  lds
    buffer_load_dwordx4 v1, s[8:11], s82 offen offset:3072  lds
    s_add_u32 m0, s15, 4096
    s_nop 0
    buffer_load_dwordx4 v15, s[8:11], s82 offen offset:0  lds
    buffer_load_dwordx4 v15, s[8:11], s82 offen offset:1024  lds
    buffer_load_dwordx4 v15, s[8:11], s82 offen offset:2048  lds
    buffer_load_dwordx4 v15, s[8:11], s82 offen offset:3072  lds
    s_xor_b32 s15, s15, 196608
    s_waitcnt vmcnt(0) lgkmcnt(0)
    s_barrier
    ds_read_b128 a[128:131], v18 offset:0
    ds_read_b128 a[132:135], v18 offset:1024
    ds_read_b128 a[136:139], v18 offset:2048
    ds_read_b128 a[140:143], v18 offset:3072
    ds_read_b128 a[144:147], v18 offset:4096
    ds_read_b128 a[148:151], v18 offset:5120
    ds_read_b128 a[152:155], v18 offset:6144
    ds_read_b128 a[156:159], v18 offset:7168
    s_waitcnt lgkmcnt(0)
    s_branch L_t2_start
L_C2_slow_13:
    s_mov_b32 s99, 0
L_C2_slow_13_l:
    s_sleep 4
    buffer_load_dword v3, v4, s[8:11], s23 offen sc0 sc1
    s_add_u32 s99, s99, 1
    s_waitcnt vmcnt(0)
    v_cmp_ne_u32 vcc, 0, v3
    s_cmp_eq_u64 vcc, -1
    s_cbranch_scc1 L_C2_ok_14
    s_cmp_lt_u32 s99, 200000
    s_cbranch_scc1 L_C2_slow_13_l
    s_branch L_C2_ok_14
L_P1_slow_15:
    s_mov_b32 s99, 0
L_P2_l_5321:
    s_waitcnt vmcnt(0)
    v_max_u32 v48, v128, v129
    v_max3_u32 v48, v48, v130, v131
    v_max_u32 v49, v132, v133
    v_max3_u32 v49, v49, v134, v135
    v_max_u32 v50, v136, v137
    v_max3_u32 v50, v50, v138, v139
    v_max_u32 v51, v140, v141
    v_max3_u32 v51, v51, v142, v143
    v_max_u32 v52, v144, v145
    v_max3_u32 v52, v52, v146, v147
    v_max_u32 v53, v148, v149
    v_max3_u32 v53, v53, v150, v151
    v_max_u32 v54, v152, v153
    v_max3_u32 v54, v54, v154, v155
    v_max_u32 v55, v156, v157
    v_max3_u32 v55, v55, v158, v159
    v_max3_u32 v3, v48, v49, v50
    v_max3_u32 v3, v3, v51, v52
    v_max3_u32 v3, v3, v53, v54
    v_max_u32 v3, v3, v55
    v_cmp_eq_u32 vcc, -1, v3
    s_add_u32 s99, s99, 1
    s_cbranch_vccz L_P2_ok_5322
    s_cmp_ge_u32 s99, 200000
    s_cbranch_scc1 L_P2_ok_5322
    s_sleep 1
    v_cmp_eq_u32 vcc, -1, v48
    s_cbranch_vccz L_P2_s_5323
    s_and_b64 s[96:97], vcc, s[12:13]
    s_cselect_b64 exec, s[96:97], vcc
    s_add_u32 s74, s70, 0
    buffer_load_dwordx4 v[128:131], v44, s[8:11], s74 offen sc0 sc1
    s_mov_b64 exec, -1
L_P2_s_5323:
    v_cmp_eq_u32 vcc, -1, v49
    s_cbranch_vccz L_P2_s_5324
    s_and_b64 s[96:97], vcc, s[12:13]
    s_cselect_b64 exec, s[96:97], vcc
    s_add_u32 s74, s70, 4096
    buffer_load_dwordx4 v[132:135], v44, s[8:11], s74 offen sc0 sc1
    s_mov_b64 exec, -1
L_P2_s_5324:
    v_cmp_eq_u32 vcc, -1, v50
    s_cbranch_vccz L_P2_s_5325
    s_and_b64 s[96:97], vcc, s[12:13]
    s_cselect_b64 exec, s[96:97], vcc
    s_add_u32 s74, s70, 8192
    buffer_load_dwordx4 v[136:139], v44, s[8:11], s74 offen sc0 sc1
    s_mov_b64 exec, -1
L_P2_s_5325:
    v_cmp_eq_u32 vcc, -1, v51
    s_cbranch_vccz L_P2_s_5326
    s_and_b64 s[96:97], vcc, s[12:13]
    s_cselect_b64 exec, s[96:97], vcc
    s_add_u32 s74, s70, 12288
    buffer_load_dwordx4 v[140:143], v44, s[8:11], s74 offen sc0 sc1
    s_mov_b64 exec, -1
L_P2_s_5326:
    v_cmp_eq_u32 vcc, -1, v52
    s_cbranch_vccz L_P2_s_5327
    s_and_b64 s[96:97], vcc, s[12:13]
    s_cselect_b64 exec, s[96:97], vcc
    s_add_u32 s74, s70, 16384
    buffer_load_dwordx4 v[144:147], v44, s[8:11], s74 offen sc0 sc1
    s_mov_b64 exec, -1
L_P2_s_5327:
    v_cmp_eq_u32 vcc, -1, v53
    s_cbranch_vccz L_P2_s_5328
    s_and_b64 s[96:97], vcc, s[12:13]
    s_cselect_b64 exec, s[96:97], vcc
    s_add_u32 s74, s70, 20480
    buffer_load_dwordx4 v[148:151], v44, s[8:11], s74 offen sc0 sc1
    s_mov_b64 exec, -1
L_P2_s_5328:
    v_cmp_eq_u32 vcc, -1, v54
    s_cbranch_vccz L_P2_s_5329
    s_and_b64 s[96:97], vcc, s[12:13]
    s_cselect_b64 exec, s[96:97], vcc
    s_add_u32 s74, s70, 24576
    buffer_load_dwordx4 v[152:155], v44, s[8:11], s74 offen sc0 sc1
    s_mov_b64 exec, -1
L_P2_s_5329:
    v_cmp_eq_u32 vcc, -1, v55
    s_cbranch_vccz L_P2_s_5330
    s_and_b64 s[96:97], vcc, s[12:13]
    s_cselect_b64 exec, s[96:97], vcc
    s_add_u32 s74, s70, 28672
    buffer_load_dwordx4 v[156:159], v44, s[8:11], s74 offen sc0 sc1
    s_mov_b64 exec, -1
L_P2_s_5330:
    s_branch L_P2_l_5321
L_P2_ok_5322:
    s_branch L_P1_ok_16
L_code_end:
    s_endpgm
.section .rodata,"a"
.p2align 6
.amdhsa_kernel adaLN_cond__compressed_kv_cla__moe_arch_mod__prompt_kernel
  .amdhsa_next_free_vgpr 512
  .amdhsa_next_free_sgpr 102
  .amdhsa_accum_offset 256
  .amdhsa_group_segment_fixed_size 0
  .amdhsa_kernarg_size 128
  .amdhsa_user_sgpr_count 2
  .amdhsa_user_sgpr_kernarg_segment_ptr 1
  .amdhsa_system_sgpr_workgroup_id_x 1
.end_amdhsa_kernel
```

```asm
; @launch grid=(256,1,1) block=(256,1,1) lds=163840
.amdgcn_target "amdgcn-amd-amdhsa--gfx950"
.text
.globl adaLN_cond__compressed_kv_cla__moe_arch_mod__prompt_kernel
.p2align 8
.type adaLN_cond__compressed_kv_cla__moe_arch_mod__prompt_kernel,@function
adaLN_cond__compressed_kv_cla__moe_arch_mod__prompt_kernel:
    s_cmp_ge_u32 s2, 256
    s_cbranch_scc1 L_end
    s_load_dwordx16 s[64:79], s[0:1], 0
    s_load_dwordx16 s[80:95], s[0:1], 64
    s_getpc_b64 s[100:101]
L_pf1:
    v_lshrrev_b32 v3, 6, v0
    v_and_b32 v2, 63, v0
    s_lshr_b32 s5, s2, 3
    s_mul_i32 s98, s5, 24
    v_min_u32 v5, 5, v2
    v_mad_u32_u24 v5, v3, 6, v5
    v_add_u32 v5, s98, v5
    v_lshlrev_b32 v5, 7, v5
    v_min_u32 v5, L_code_end-L_pf1, v5
    global_load_dword a255, v5, s[100:101]
    v_readfirstlane_b32 s3, v3
    v_lshlrev_b32 v1, 4, v2
    s_and_b32 s4, s2, 7
    s_and_b32 s5, s5, 3
    s_lshr_b32 s6, s2, 5
    s_lshl_b32 s7, s4, 2
    s_add_u32 s7, s7, s5
    s_mov_b32 s60, s6
    s_sub_u32 s61, 15, s6
    v_lshrrev_b32 v3, 3, v2
    v_lshrrev_b32 v4, 4, v2
    v_and_b32 v5, 7, v2
    v_xor_b32 v5, v5, v4
    v_lshlrev_b32 v5, 4, v5
    v_lshl_add_u32 v16, v3, 10, v5
    v_xor_b32 v17, 64, v16
    v_add_u32 v17, 7168, v17
    v_add_u32 v18, 14336, v16
    v_add_u32 v19, 14336, v17
    v_bfe_u32 v5, v2, 1, 3
    v_xor_b32 v5, v5, v4
    v_lshlrev_b32 v5, 5, v5
    v_and_b32 v6, 1, v2
    v_lshl_add_u32 v5, v6, 4, v5
    v_lshl_add_u32 v20, v4, 13, v5
    v_add_u32 v21, 31744, v20
    v_xor_b32 v22, 128, v20
    v_add_u32 v22, 63488, v22
    v_add_u32 v23, 31744, v22
    s_lshl_b32 s62, s3, 13
    s_lshl_b32 s63, s3, 12
    s_lshl_b32 s96, s6, 18
    s_lshl_b32 s98, s3, 16
    s_add_u32 s96, s96, s98
    s_lshl_b32 s97, s3, 17
    s_lshl_b32 s99, s5, 0
    s_xor_b32 s99, s99, s6
    s_lshl_b32 s99, s99, 3
    s_and_b32 s99, s99, 7
    s_lshl_b32 s98, s99, 7
    s_add_u32 s96, s96, s98
    s_lshl_b32 s98, s99, 19
    s_add_u32 s97, s97, s98
    v_and_b32 v84, 7, v2
    v_lshrrev_b32 v65, 3, v0
    v_mul_u32_u24 v64, 24576, v65
    v_lshl_add_u32 v64, v84, 4, v64
    v_lshlrev_b32 v65, 3, v65
    v_lshrrev_b32 v85, 3, v2
    v_lshlrev_b32 v86, 10, v84
    v_lshl_add_u32 v86, v85, 4, v86
    s_lshl_b32 s100, s7, 8
    s_waitcnt lgkmcnt(0)
    s_add_u32 s16, s70, s100
    s_addc_u32 s17, s71, 0
    s_sub_u32 s18, 4194304, s100
    s_mov_b32 s19, 0x00020000
    s_mov_b32 s12, s66
    s_mov_b32 s13, s67
    s_mov_b32 s14, 2097152
    s_mov_b32 s15, 0x00020000
    s_add_u32 m0, s63, 98304
    s_xor_b32 s98, s97, 0
    buffer_load_dwordx4 v20, s[16:19], s98 offen offset:0   lds
    buffer_load_dwordx4 v21, s[16:19], s98 offen offset:1024   lds
    buffer_load_dwordx4 v22, s[16:19], s98 offen offset:2048   lds
    buffer_load_dwordx4 v23, s[16:19], s98 offen offset:3072   lds
    s_add_u32 m0, s62, 0
    s_xor_b32 s98, s96, 0
    buffer_load_dwordx4 v16, s[12:15], s98 offen offset:0   lds
    buffer_load_dwordx4 v17, s[12:15], s98 offen offset:1024   lds
    buffer_load_dwordx4 v18, s[12:15], s98 offen offset:2048   lds
    buffer_load_dwordx4 v19, s[12:15], s98 offen offset:3072   lds
    s_add_u32 m0, s62, 4096
    s_xor_b32 s98, s96, 32768
    buffer_load_dwordx4 v16, s[12:15], s98 offen offset:0   lds
    buffer_load_dwordx4 v17, s[12:15], s98 offen offset:1024   lds
    buffer_load_dwordx4 v18, s[12:15], s98 offen offset:2048   lds
    buffer_load_dwordx4 v19, s[12:15], s98 offen offset:3072   lds
    s_mov_b32 s40, s88
    s_mov_b32 s41, s89
    s_mov_b32 s42, 3145728
    s_mov_b32 s43, 0x00020000
    s_mov_b32 s44, s86
    s_mov_b32 s45, s87
    s_mov_b32 s46, 1024
    s_mov_b32 s47, 0x00020000
    s_mov_b32 s32, s64
    s_mov_b32 s33, s65
    s_mov_b32 s34, 2097152
    s_mov_b32 s35, 0x00020000
    s_mov_b32 s8, s94
    s_mov_b32 s9, s95
    s_mov_b32 s10, 268435456
    s_mov_b32 s11, 0x00020000
    s_add_u32 s20, s72, s100
    s_addc_u32 s21, s73, 0
    s_sub_u32 s22, 4194304, s100
    s_mov_b32 s23, 0x00020000
    s_add_u32 s24, s68, s100
    s_addc_u32 s25, s69, 0
    s_sub_u32 s26, 4194304, s100
    s_mov_b32 s27, 0x00020000
    s_mov_b32 s36, s92
    s_mov_b32 s37, s93
    s_mov_b32 s38, 256
    s_mov_b32 s39, 0x00020000
    s_lshl_b32 s100, s4, 19
    s_lshl_b32 s99, s5, 8
    s_add_u32 s100, s100, s99
    s_add_u32 s28, s74, s100
    s_addc_u32 s29, s75, 0
    s_sub_u32 s30, 4194304, s100
    s_mov_b32 s31, 0x00020000
    s_mov_b32 s48, s84
    s_mov_b32 s49, s85
    s_mov_b32 s50, 1835008
    s_mov_b32 s51, 0x00020000
    s_mov_b32 s52, s90
    s_mov_b32 s53, s91
    s_mov_b32 s54, 2097152
    s_mov_b32 s55, 0x00020000
    s_mov_b64 s[92:93], s[80:81]
    s_mov_b64 s[94:95], s[82:83]
    s_mov_b32 s56, s78
    s_mov_b32 s57, s79
    s_mov_b32 s58, 1024
    s_mov_b32 s59, 0x00020000
    s_load_dword s90, s[36:37], 64
    s_load_dword s91, s[8:9], 0x3f00
    s_lshl_b32 s64, s3, 19
    s_and_b32 s100, s97, 3670016
    s_xor_b32 s64, s64, s100
    s_lshr_b32 s100, s6, 1
    s_and_b32 s100, s100, 0
    s_lshl_b32 s1, s100, 12
    s_lshl_b32 s100, s100, 7
    s_add_u32 s64, s64, s100
    s_lshl_b32 s100, s5, 1
    s_xor_b32 s100, s100, s6
    s_and_b32 s100, s100, 0
    s_lshl_b32 s68, s100, 11
    s_lshl_b32 s100, s100, 19
    s_lshl_b32 s0, s3, 17
    s_add_u32 s0, s0, s100
    s_lshl_b32 s81, s7, 20
    s_add_u32 s81, s81, 16777216
    s_lshl_b32 s100, s6, 17
    s_add_u32 s65, s81, s100
    s_lshr_b32 s100, s3, 1
    s_lshl_b32 s100, s100, 16
    s_add_u32 s65, s65, s100
    s_and_b32 s100, s3, 1
    s_lshl_b32 s100, s100, 14
    s_add_u32 s65, s65, s100
    s_add_u32 s81, s81, s62
    s_cmp_eq_u32 s60, 0
    s_cselect_b32 s82, 0, 1
    s_lshl_b32 s82, s82, 16
    s_add_u32 s82, s82, s81
    s_sub_u32 s100, s6, 2
    s_lshl_b32 s69, s100, 7
    s_lshl_b32 s100, s100, 3
    s_add_u32 s100, s100, s4
    s_lshl_b32 s100, s100, 8
    s_mul_i32 s101, s5, 12288
    s_add_u32 s100, s100, s101
    s_add_u32 s100, s100, 16384
    s_cmp_ge_u32 s6, 2
    s_cselect_b32 s66, s100, 2147479552
    s_cselect_b32 s69, s69, 2147479552
    s_cmp_eq_u32 s3, 0
    s_cselect_b32 s66, s66, 2147479552
    s_lshl_b32 s70, s3, 9
    s_add_u32 s70, s70, 16384
    s_lshr_b32 s71, s2, 1
    s_lshl_b32 s71, s71, 14
    s_and_b32 s100, s2, 1
    s_lshl_b32 s100, s100, 7
    s_add_u32 s71, s71, s100
    s_add_u32 s71, s71, s63
    s_add_u32 s71, s71, 2097152
    s_lshl_b32 s72, s2, 2
    s_add_u32 s72, s72, s3
    s_lshl_b32 s72, s72, 6
    s_add_u32 s72, s72, 1048576
    s_lshl_b32 s74, s7, 11
    s_add_u32 s74, s74, 1114112
    s_lshl_b32 s73, s6, 2
    s_add_u32 s73, s73, s3
    s_lshl_b32 s73, s73, 6
    s_add_u32 s73, s73, s74
    s_lshr_b32 s100, s3, 1
    s_sub_u32 s101, 3, s100
    s_and_b32 s98, s3, 1
    s_cselect_b32 s100, s101, s100
    s_lshl_b32 s75, s60, 2
    s_add_u32 s75, s75, s100
    s_lshl_b32 s76, s61, 2
    s_add_u32 s76, s76, s100
    s_sub_u32 s77, s76, s75
    s_lshl_b32 s77, s77, 10
    s_lshl_b32 s78, s75, 10
    s_add_u32 s78, s78, 983040
    s_lshl_b32 s75, s75, 15
    s_add_u32 s75, s75, 2097152
    s_add_u32 s75, s75, s68
    s_lshl_b32 s76, s76, 15
    s_add_u32 s76, s76, 2097152
    s_add_u32 s76, s76, s68
    s_add_u32 s1, s1, s65
    s_cmp_eq_u32 s3, 0
    s_cselect_b32 s68, 32, 0
    s_cselect_b32 s67, 0, 2147479552
    v_and_b32 v48, 15, v2
    v_lshrrev_b32 v49, 4, v2
    v_lshrrev_b32 v50, 1, v48
    v_xor_b32 v50, v50, v49
    v_lshlrev_b32 v50, 4, v50
    v_lshl_add_u32 v28, v48, 7, v50
    v_add_u32 v28, s62, v28
    v_xor_b32 v29, 64, v28
    v_add_u32 v30, 65536, v28
    v_add_u32 v31, 65536, v29
    v_lshrrev_b32 v50, 2, v48
    v_and_b32 v51, 3, v48
    v_lshl_add_u32 v52, v49, 3, v50
    v_lshlrev_b32 v53, 8, v52
    v_lshl_add_u32 v53, v51, 3, v53
    v_add_u32 v53, 98304, v53
    v_and_b32 v54, 1, v49
    v_lshl_add_u32 v54, v54, 2, v50
    v_xor_b32 v55, 0, v54
    v_lshl_add_u32 v8, v55, 5, v53
    v_xor_b32 v55, 1, v54
    v_lshl_add_u32 v9, v55, 5, v53
    v_xor_b32 v55, 2, v54
    v_lshl_add_u32 v10, v55, 5, v53
    v_xor_b32 v55, 3, v54
    v_lshl_add_u32 v11, v55, 5, v53
    v_xor_b32 v55, 4, v54
    v_lshl_add_u32 v12, v55, 5, v53
    v_xor_b32 v55, 5, v54
    v_lshl_add_u32 v13, v55, 5, v53
    v_xor_b32 v55, 6, v54
    v_lshl_add_u32 v14, v55, 5, v53
    v_xor_b32 v55, 7, v54
    v_lshl_add_u32 v15, v55, 5, v53
    v_bfe_u32 v49, v2, 1, 2
    v_bfe_u32 v50, v2, 4, 1
    v_xor_b32 v49, v49, v50
    v_lshlrev_b32 v49, 5, v49
    v_and_b32 v50, 1, v2
    v_lshl_add_u32 v49, v50, 4, v49
    v_lshl_add_u32 v24, v85, 13, v49
    v_xor_b32 v25, 64, v24
    v_add_u32 v25, 64512, v25
    v_add_u32 v26, 129024, v24
    v_add_u32 v27, 129024, v25
    v_cmp_eq_u32 vcc, 0, v2
    v_mov_b32 v6, 2147479552
    s_nop 0
    v_cndmask_b32 v5, v6, v2, vcc
    v_cmp_eq_u32 vcc, 0, v0
    s_nop 1
    v_cndmask_b32 v7, v6, v0, vcc
    v_and_b32 v48, 8, v2
    v_cmp_eq_u32 vcc, 0, v48
    v_lshlrev_b32 v48, 5, v84
    v_lshrrev_b32 v49, 1, v2
    v_and_b32 v49, 24, v49
    v_add_u32 v48, v48, v49
    s_lshl_b32 s100, s3, 8
    s_add_u32 s100, s100, 147456
    v_add_u32 v48, s100, v48
    v_mov_b32 v49, 148480
    v_cndmask_b32 v98, v49, v48, vcc
    v_lshlrev_b32 v99, 5, v84
    v_add_u32 v99, 149504, v99
    s_lshl_b32 s100, s3, 3
    v_add_u32 v100, s100, v99
    v_lshlrev_b32 v106, 5, v85
    v_lshlrev_b32 v107, 8, v85
    v_lshl_add_u32 v107, v84, 4, v107
    s_sub_u32 s100, s2, 64
    s_lshl_b32 s80, s100, 12
    s_add_u32 s80, s80, 1048576
    s_cmp_lt_u32 s100, 64
    s_cselect_b32 s80, s80, 2147479552
    s_mul_i32 s99, s5, 786432
    s_sub_u32 s79, s6, 2
    s_lshl_b32 s79, s79, 3
    s_add_u32 s79, s79, s4
    s_lshl_b32 s79, s79, 7
    s_add_u32 s79, s79, s99
    s_cmp_ge_u32 s6, 2
    s_cselect_b32 s79, s79, 2147414016
    s_lshl_b32 s100, s5, 8
    v_add_u32 v65, s100, v65
    v_mov_b32 v6, 1
    v_and_b32 v4, 1, v2
    v_lshlrev_b32 v4, 7, v4
    buffer_load_dwordx2 v[66:67], v65, s[44:47], 0 offen
    buffer_load_dwordx4 v[68:71], v64, s[40:43], s79 offen
    s_add_u32 s79, s79, 6144
    buffer_load_dwordx4 v[72:75], v64, s[40:43], s79 offen
    s_add_u32 s79, s79, 6144
    buffer_load_dwordx4 v[76:79], v64, s[40:43], s79 offen
    s_add_u32 s79, s79, 6144
    buffer_load_dwordx4 v[80:83], v64, s[40:43], s79 offen
    s_lshl_b32 s79, s2, 5
    s_add_u32 s79, s79, s3
    s_lshl_b32 s79, s79, 8
    buffer_load_dwordx4 v[88:91], v86, s[32:35], s79 offen
    buffer_load_dwordx4 v[92:95], v86, s[32:35], s79 offen offset:128
    s_add_u32 m0, s63, 114688
    s_xor_b32 s98, s97, 524288
    buffer_load_dwordx4 v20, s[16:19], s98 offen offset:0   lds
    buffer_load_dwordx4 v21, s[16:19], s98 offen offset:1024   lds
    buffer_load_dwordx4 v22, s[16:19], s98 offen offset:2048   lds
    buffer_load_dwordx4 v23, s[16:19], s98 offen offset:3072   lds
    s_add_u32 m0, s62, 32768
    s_xor_b32 s98, s96, 128
    buffer_load_dwordx4 v16, s[12:15], s98 offen offset:0   lds
    buffer_load_dwordx4 v17, s[12:15], s98 offen offset:1024   lds
    buffer_load_dwordx4 v18, s[12:15], s98 offen offset:2048   lds
    buffer_load_dwordx4 v19, s[12:15], s98 offen offset:3072   lds
    s_add_u32 m0, s62, 36864
    s_xor_b32 s98, s96, 32896
    buffer_load_dwordx4 v16, s[12:15], s98 offen offset:0   lds
    buffer_load_dwordx4 v17, s[12:15], s98 offen offset:1024   lds
    buffer_load_dwordx4 v18, s[12:15], s98 offen offset:2048   lds
    buffer_load_dwordx4 v19, s[12:15], s98 offen offset:3072   lds
    s_waitcnt vmcnt(19) lgkmcnt(0)
    s_barrier
    ds_read_b64_tr_b16 v[32:33], v8 offset:0
    ds_read_b64_tr_b16 v[34:35], v8 offset:1024
    ds_read_b128 a[0:3], v28 offset:0
    ds_read_b128 a[4:7], v28 offset:2048
    ds_read_b128 a[8:11], v28 offset:4096
    ds_read_b128 a[12:15], v28 offset:6144
    ds_read_b64_tr_b16 v[36:37], v9 offset:0
    ds_read_b64_tr_b16 v[38:39], v9 offset:1024
    ds_read_b64_tr_b16 v[40:41], v10 offset:0
    ds_read_b64_tr_b16 v[42:43], v10 offset:1024
    ds_read_b64_tr_b16 v[44:45], v11 offset:0
    ds_read_b64_tr_b16 v[46:47], v11 offset:1024
    ds_read_b64_tr_b16 v[48:49], v12 offset:0
    ds_read_b64_tr_b16 v[50:51], v12 offset:1024
    ds_read_b64_tr_b16 v[52:53], v13 offset:0
    ds_read_b64_tr_b16 v[54:55], v13 offset:1024
    ds_read_b64_tr_b16 v[56:57], v14 offset:0
    ds_read_b64_tr_b16 v[58:59], v14 offset:1024
    ds_read_b64_tr_b16 v[60:61], v15 offset:0
    ds_read_b64_tr_b16 v[62:63], v15 offset:1024
    s_waitcnt lgkmcnt(15)
    v_mfma_f32_16x16x32_bf16 v[128:131], v[32:35], a[0:3], 0
    v_mfma_f32_16x16x32_bf16 v[160:163], v[32:35], a[4:7], 0
    v_mfma_f32_16x16x32_bf16 v[192:195], v[32:35], a[8:11], 0
    s_waitcnt lgkmcnt(14)
    s_add_u32 m0, s63, 131072
    s_xor_b32 s98, s97, 1048576
    ds_read_b128 a[16:19], v29 offset:0
    v_mfma_f32_16x16x32_bf16 v[224:227], v[32:35], a[12:15], 0
    s_waitcnt lgkmcnt(13)
    ds_read_b128 a[20:23], v29 offset:2048
    v_mfma_f32_16x16x32_bf16 v[132:135], v[36:39], a[0:3], 0
    ds_read_b64_tr_b16 v[32:33], v8 offset:8192
    v_mfma_f32_16x16x32_bf16 v[164:167], v[36:39], a[4:7], 0
    ds_read_b64_tr_b16 v[34:35], v8 offset:9216
    v_mfma_f32_16x16x32_bf16 v[196:199], v[36:39], a[8:11], 0
    ds_read_b128 a[24:27], v29 offset:4096
    v_mfma_f32_16x16x32_bf16 v[228:231], v[36:39], a[12:15], 0
    s_waitcnt lgkmcnt(15)
    ds_read_b128 a[28:31], v29 offset:6144
    v_mfma_f32_16x16x32_bf16 v[136:139], v[40:43], a[0:3], 0
    ds_read_b64_tr_b16 v[36:37], v9 offset:8192
    v_mfma_f32_16x16x32_bf16 v[168:171], v[40:43], a[4:7], 0
    s_waitcnt lgkmcnt(7)
    ds_read_b64_tr_b16 v[38:39], v9 offset:9216
    v_mfma_f32_16x16x32_bf16 v[200:203], v[40:43], a[8:11], 0
    buffer_load_dwordx4 v20, s[16:19], s98 offen offset:0   lds
    v_mfma_f32_16x16x32_bf16 v[232:235], v[40:43], a[12:15], 0
    buffer_load_dwordx4 v21, s[16:19], s98 offen offset:1024   lds
    v_mfma_f32_16x16x32_bf16 v[140:143], v[44:47], a[0:3], 0
    ds_read_b64_tr_b16 v[40:41], v10 offset:8192
    v_mfma_f32_16x16x32_bf16 v[172:175], v[44:47], a[4:7], 0
    ds_read_b64_tr_b16 v[42:43], v10 offset:9216
    v_mfma_f32_16x16x32_bf16 v[204:207], v[44:47], a[8:11], 0
    buffer_load_dwordx4 v22, s[16:19], s98 offen offset:2048   lds
    v_mfma_f32_16x16x32_bf16 v[236:239], v[44:47], a[12:15], 0
    buffer_load_dwordx4 v23, s[16:19], s98 offen offset:3072   lds
    v_mfma_f32_16x16x32_bf16 v[144:147], v[48:51], a[0:3], 0
    s_add_u32 m0, s62, 65536
    s_xor_b32 s98, s96, 256
    ds_read_b64_tr_b16 v[44:45], v11 offset:8192
    v_mfma_f32_16x16x32_bf16 v[176:179], v[48:51], a[4:7], 0
    ds_read_b64_tr_b16 v[46:47], v11 offset:9216
    v_mfma_f32_16x16x32_bf16 v[208:211], v[48:51], a[8:11], 0
    buffer_load_dwordx4 v16, s[12:15], s98 offen offset:0   lds
    v_mfma_f32_16x16x32_bf16 v[240:243], v[48:51], a[12:15], 0
    buffer_load_dwordx4 v17, s[12:15], s98 offen offset:1024   lds
    v_mfma_f32_16x16x32_bf16 v[148:151], v[52:55], a[0:3], 0
    ds_read_b64_tr_b16 v[48:49], v12 offset:8192
    v_mfma_f32_16x16x32_bf16 v[180:183], v[52:55], a[4:7], 0
    ds_read_b64_tr_b16 v[50:51], v12 offset:9216
    v_mfma_f32_16x16x32_bf16 v[212:215], v[52:55], a[8:11], 0
    buffer_load_dwordx4 v18, s[12:15], s98 offen offset:2048   lds
    v_mfma_f32_16x16x32_bf16 v[244:247], v[52:55], a[12:15], 0
    buffer_load_dwordx4 v19, s[12:15], s98 offen offset:3072   lds
    v_mfma_f32_16x16x32_bf16 v[152:155], v[56:59], a[0:3], 0
    s_add_u32 m0, s62, 69632
    s_xor_b32 s98, s96, 33024
    ds_read_b64_tr_b16 v[52:53], v13 offset:8192
    v_mfma_f32_16x16x32_bf16 v[184:187], v[56:59], a[4:7], 0
    ds_read_b64_tr_b16 v[54:55], v13 offset:9216
    v_mfma_f32_16x16x32_bf16 v[216:219], v[56:59], a[8:11], 0
    buffer_load_dwordx4 v16, s[12:15], s98 offen offset:0   lds
    v_mfma_f32_16x16x32_bf16 v[248:251], v[56:59], a[12:15], 0
    buffer_load_dwordx4 v17, s[12:15], s98 offen offset:1024   lds
    v_mfma_f32_16x16x32_bf16 v[156:159], v[60:63], a[0:3], 0
    ds_read_b64_tr_b16 v[56:57], v14 offset:8192
    v_mfma_f32_16x16x32_bf16 v[188:191], v[60:63], a[4:7], 0
    s_waitcnt lgkmcnt(5)
    ds_read_b64_tr_b16 v[58:59], v14 offset:9216
    v_mfma_f32_16x16x32_bf16 v[220:223], v[60:63], a[8:11], 0
    buffer_load_dwordx4 v18, s[12:15], s98 offen offset:2048   lds
    v_mfma_f32_16x16x32_bf16 v[252:255], v[60:63], a[12:15], 0
    buffer_load_dwordx4 v19, s[12:15], s98 offen offset:3072   lds
    v_mfma_f32_16x16x32_bf16 v[128:131], v[32:35], a[16:19], v[128:131]
    ds_read_b64_tr_b16 v[60:61], v15 offset:8192
    v_mfma_f32_16x16x32_bf16 v[160:163], v[32:35], a[20:23], v[160:163]
    ds_read_b64_tr_b16 v[62:63], v15 offset:9216
    v_mfma_f32_16x16x32_bf16 v[192:195], v[32:35], a[24:27], v[192:195]
    v_mfma_f32_16x16x32_bf16 v[224:227], v[32:35], a[28:31], v[224:227]
    v_mfma_f32_16x16x32_bf16 v[132:135], v[36:39], a[16:19], v[132:135]
    v_mfma_f32_16x16x32_bf16 v[164:167], v[36:39], a[20:23], v[164:167]
    v_mfma_f32_16x16x32_bf16 v[196:199], v[36:39], a[24:27], v[196:199]
    v_mfma_f32_16x16x32_bf16 v[228:231], v[36:39], a[28:31], v[228:231]
    v_mfma_f32_16x16x32_bf16 v[136:139], v[40:43], a[16:19], v[136:139]
    s_waitcnt vmcnt(12) lgkmcnt(0)
    s_barrier
    v_mfma_f32_16x16x32_bf16 v[168:171], v[40:43], a[20:23], v[168:171]
    s_add_u32 m0, s63, 98304
    s_xor_b32 s98, s97, 1572864
    ds_read_b64_tr_b16 v[32:33], v8 offset:16384
    v_lshlrev_b32 v102, 16, v66
    v_and_b32 v103, 0xffff0000, v66
    v_lshlrev_b32 v104, 16, v67
    v_mfma_f32_16x16x32_bf16 v[200:203], v[40:43], a[24:27], v[200:203]
    ds_read_b64_tr_b16 v[34:35], v8 offset:17408
    v_and_b32 v105, 0xffff0000, v67
    v_mul_f32 v108, 0xbfb8aa3b, v102
    v_mul_f32 v109, 0xbfb8aa3b, v103
    v_mfma_f32_16x16x32_bf16 v[232:235], v[40:43], a[28:31], v[232:235]
    ds_read_b64_tr_b16 v[36:37], v9 offset:16384
    v_mul_f32 v110, 0xbfb8aa3b, v104
    v_mul_f32 v111, 0xbfb8aa3b, v105
    v_mfma_f32_16x16x32_bf16 v[140:143], v[44:47], a[16:19], v[140:143]
    ds_read_b64_tr_b16 v[38:39], v9 offset:17408
    v_exp_f32 v108, v108
    v_mfma_f32_16x16x32_bf16 v[172:175], v[44:47], a[20:23], v[172:175]
    ds_read_b64_tr_b16 v[40:41], v10 offset:16384
    v_exp_f32 v109, v109
    v_mfma_f32_16x16x32_bf16 v[204:207], v[44:47], a[24:27], v[204:207]
    ds_read_b64_tr_b16 v[42:43], v10 offset:17408
    v_exp_f32 v110, v110
    v_mfma_f32_16x16x32_bf16 v[236:239], v[44:47], a[28:31], v[236:239]
    ds_read_b128 a[32:35], v28 offset:32768
    v_exp_f32 v111, v111
    v_add_f32 v108, 1.0, v108
    v_mfma_f32_16x16x32_bf16 v[144:147], v[48:51], a[16:19], v[144:147]
    ds_read_b64_tr_b16 v[44:45], v11 offset:16384
    v_add_f32 v109, 1.0, v109
    v_add_f32 v110, 1.0, v110
    v_add_f32 v111, 1.0, v111
    v_mfma_f32_16x16x32_bf16 v[176:179], v[48:51], a[20:23], v[176:179]
    ds_read_b64_tr_b16 v[46:47], v11 offset:17408
    v_rcp_f32 v108, v108
    v_mfma_f32_16x16x32_bf16 v[208:211], v[48:51], a[24:27], v[208:211]
    ds_read_b128 a[36:39], v28 offset:34816
    v_mov_b32 v112, 0
    v_rcp_f32 v109, v109
    v_mfma_f32_16x16x32_bf16 v[240:243], v[48:51], a[28:31], v[240:243]
    ds_read_b128 a[40:43], v28 offset:36864
    v_mov_b32 v113, 0
    v_rcp_f32 v110, v110
    v_mfma_f32_16x16x32_bf16 v[148:151], v[52:55], a[16:19], v[148:151]
    ds_read_b64_tr_b16 v[48:49], v12 offset:16384
    v_mov_b32 v114, 0
    v_rcp_f32 v111, v111
    v_mfma_f32_16x16x32_bf16 v[180:183], v[52:55], a[20:23], v[180:183]
    ds_read_b64_tr_b16 v[50:51], v12 offset:17408
    v_mov_b32 v115, 0
    v_mul_f32 v102, v102, v108
    v_mul_f32 v103, v103, v109
    v_mfma_f32_16x16x32_bf16 v[212:215], v[52:55], a[24:27], v[212:215]
    ds_read_b128 a[44:47], v28 offset:38912
    v_lshlrev_b32 v116, 4, v0
    v_mul_f32 v104, v104, v110
    v_mul_f32 v105, v105, v111
    v_mfma_f32_16x16x32_bf16 v[244:247], v[52:55], a[28:31], v[244:247]
    buffer_load_dwordx4 v20, s[16:19], s98 offen offset:0   lds
    v_cvt_pk_bf16_f32 v108, v102, v103
    v_cvt_pk_bf16_f32 v109, v104, v105
    v_mfma_f32_16x16x32_bf16 v[152:155], v[56:59], a[16:19], v[152:155]
    ds_read_b64_tr_b16 v[52:53], v13 offset:16384
    v_lshlrev_b32 v102, 16, v108
    v_and_b32 v103, 0xffff0000, v108
    v_lshlrev_b32 v104, 16, v109
    v_mfma_f32_16x16x32_bf16 v[184:187], v[56:59], a[20:23], v[184:187]
    ds_read_b64_tr_b16 v[54:55], v13 offset:17408
    v_and_b32 v105, 0xffff0000, v109
    v_lshlrev_b32 v108, 16, v68
    v_and_b32 v109, 0xffff0000, v68
    v_mfma_f32_16x16x32_bf16 v[216:219], v[56:59], a[24:27], v[216:219]
    buffer_load_dwordx4 v21, s[16:19], s98 offen offset:1024   lds
    v_mul_f32 v120, v108, v102
    v_mul_f32 v121, v109, v102
    v_mfma_f32_16x16x32_bf16 v[248:251], v[56:59], a[28:31], v[248:251]
    buffer_store_dwordx4 v[112:115], v116, s[8:11], s80 offen sc0 sc1
    v_lshlrev_b32 v110, 16, v69
    v_and_b32 v111, 0xffff0000, v69
    v_mfma_f32_16x16x32_bf16 v[156:159], v[60:63], a[16:19], v[156:159]
    ds_read_b64_tr_b16 v[56:57], v14 offset:16384
    v_lshlrev_b32 v117, 13, v2
    v_mul_f32 v122, v110, v102
    v_mul_f32 v123, v111, v102
    v_mfma_f32_16x16x32_bf16 v[188:191], v[60:63], a[20:23], v[188:191]
    s_lshl_b32 s100, s6, 19
    s_and_b32 s101, s3, 1
    ds_read_b64_tr_b16 v[58:59], v14 offset:17408
    v_lshlrev_b32 v108, 16, v70
    v_and_b32 v109, 0xffff0000, v70
    v_mul_f32 v124, v108, v102
    v_mfma_f32_16x16x32_bf16 v[220:223], v[60:63], a[24:27], v[220:223]
    buffer_load_dwordx4 v22, s[16:19], s98 offen offset:2048   lds
    v_mul_f32 v125, v109, v102
    v_lshlrev_b32 v110, 16, v71
    v_mfma_f32_16x16x32_bf16 v[252:255], v[60:63], a[28:31], v[252:255]
    s_waitcnt lgkmcnt(5)
    s_lshl_b32 s101, s101, 7
    s_add_u32 s100, s100, s101
    v_min_u32 v116, 496, v116
    v_and_b32 v111, 0xffff0000, v71
    v_mul_f32 v126, v110, v102
    v_mul_f32 v127, v111, v102
    v_mfma_f32_16x16x32_bf16 v[128:131], v[32:35], a[32:35], v[128:131]
    s_sub_u32 s80, s80, 1048576
    s_lshr_b32 s80, s80, 3
    ds_read_b64_tr_b16 v[60:61], v15 offset:16384
    v_lshlrev_b32 v108, 16, v72
    v_and_b32 v109, 0xffff0000, v72
    v_fmac_f32 v120, v108, v103
    v_mfma_f32_16x16x32_bf16 v[160:163], v[32:35], a[36:39], v[160:163]
    s_add_u32 s80, s80, 1310720
    s_cmp_lt_u32 s80, 1343488
    s_cselect_b32 s80, s80, 2147479552
    ds_read_b64_tr_b16 v[62:63], v15 offset:17408
    v_fmac_f32 v121, v109, v103
    v_lshlrev_b32 v110, 16, v73
    v_and_b32 v111, 0xffff0000, v73
    v_mfma_f32_16x16x32_bf16 v[192:195], v[32:35], a[40:43], v[192:195]
    s_waitcnt lgkmcnt(5)
    ds_read_b128 a[48:51], v29 offset:32768
    v_fmac_f32 v122, v110, v103
    v_fmac_f32 v123, v111, v103
    v_lshlrev_b32 v108, 16, v74
    v_mfma_f32_16x16x32_bf16 v[224:227], v[32:35], a[44:47], v[224:227]
    ds_read_b128 a[52:55], v29 offset:34816
    v_and_b32 v109, 0xffff0000, v74
    v_fmac_f32 v124, v108, v103
    v_fmac_f32 v125, v109, v103
    v_mfma_f32_16x16x32_bf16 v[132:135], v[36:39], a[32:35], v[132:135]
    ds_read_b64_tr_b16 v[32:33], v8 offset:24576
    v_lshlrev_b32 v110, 16, v75
    v_and_b32 v111, 0xffff0000, v75
    v_fmac_f32 v126, v110, v103
    v_mfma_f32_16x16x32_bf16 v[164:167], v[36:39], a[36:39], v[164:167]
    ds_read_b64_tr_b16 v[34:35], v8 offset:25600
    v_fmac_f32 v127, v111, v103
    v_lshlrev_b32 v108, 16, v76
    v_and_b32 v109, 0xffff0000, v76
    v_mfma_f32_16x16x32_bf16 v[196:199], v[36:39], a[40:43], v[196:199]
    ds_read_b128 a[56:59], v29 offset:36864
    v_fmac_f32 v120, v108, v104
    v_fmac_f32 v121, v109, v104
    v_lshlrev_b32 v110, 16, v77
    v_mfma_f32_16x16x32_bf16 v[228:231], v[36:39], a[44:47], v[228:231]
    ds_read_b128 a[60:63], v29 offset:38912
    v_and_b32 v111, 0xffff0000, v77
    v_fmac_f32 v122, v110, v104
    v_fmac_f32 v123, v111, v104
    v_mfma_f32_16x16x32_bf16 v[136:139], v[40:43], a[32:35], v[136:139]
    ds_read_b64_tr_b16 v[36:37], v9 offset:24576
    v_lshlrev_b32 v108, 16, v78
    v_and_b32 v109, 0xffff0000, v78
    v_fmac_f32 v124, v108, v104
    v_mfma_f32_16x16x32_bf16 v[168:171], v[40:43], a[36:39], v[168:171]
    ds_read_b64_tr_b16 v[38:39], v9 offset:25600
    v_fmac_f32 v125, v109, v104
    v_lshlrev_b32 v110, 16, v79
    v_and_b32 v111, 0xffff0000, v79
    v_mfma_f32_16x16x32_bf16 v[200:203], v[40:43], a[40:43], v[200:203]
    buffer_load_dwordx4 v23, s[16:19], s98 offen offset:3072   lds
    v_fmac_f32 v126, v110, v104
    v_fmac_f32 v127, v111, v104
    v_mfma_f32_16x16x32_bf16 v[232:235], v[40:43], a[44:47], v[232:235]
    buffer_store_dwordx4 v[112:115], v116, s[8:11], s80 offen sc0 sc1
    v_lshlrev_b32 v108, 16, v80
    v_and_b32 v109, 0xffff0000, v80
    v_mfma_f32_16x16x32_bf16 v[140:143], v[44:47], a[32:35], v[140:143]
    s_add_u32 m0, s62, 0
    s_xor_b32 s98, s96, 384
    ds_read_b64_tr_b16 v[40:41], v10 offset:24576
    v_fmac_f32 v120, v108, v105
    v_fmac_f32 v121, v109, v105
    v_lshlrev_b32 v110, 16, v81
    v_mfma_f32_16x16x32_bf16 v[172:175], v[44:47], a[36:39], v[172:175]
    ds_read_b64_tr_b16 v[42:43], v10 offset:25600
    v_and_b32 v111, 0xffff0000, v81
    v_fmac_f32 v122, v110, v105
    v_fmac_f32 v123, v111, v105
    v_mfma_f32_16x16x32_bf16 v[204:207], v[44:47], a[40:43], v[204:207]
    buffer_load_dwordx4 v16, s[12:15], s98 offen offset:0   lds
    v_lshlrev_b32 v108, 16, v82
    v_and_b32 v109, 0xffff0000, v82
    v_mfma_f32_16x16x32_bf16 v[236:239], v[44:47], a[44:47], v[236:239]
    v_fmac_f32 v124, v108, v105
    v_fmac_f32 v125, v109, v105
    v_lshlrev_b32 v110, 16, v83
    v_and_b32 v111, 0xffff0000, v83
    v_mfma_f32_16x16x32_bf16 v[144:147], v[48:51], a[32:35], v[144:147]
    ds_read_b64_tr_b16 v[44:45], v11 offset:24576
    v_fmac_f32 v126, v110, v105
    v_fmac_f32 v127, v111, v105
    v_permlane32_swap_b32 v120, v124
    v_mfma_f32_16x16x32_bf16 v[176:179], v[48:51], a[36:39], v[176:179]
    ds_read_b64_tr_b16 v[46:47], v11 offset:25600
    v_permlane32_swap_b32 v121, v125
    v_permlane32_swap_b32 v122, v126
    v_permlane32_swap_b32 v123, v127
    v_mfma_f32_16x16x32_bf16 v[208:211], v[48:51], a[40:43], v[208:211]
    buffer_load_dwordx4 v17, s[12:15], s98 offen offset:1024   lds
    v_add_f32 v120, v120, v124
    v_add_f32 v121, v121, v125
    v_mfma_f32_16x16x32_bf16 v[240:243], v[48:51], a[44:47], v[240:243]
    s_waitcnt lgkmcnt(4)
    v_add_f32 v122, v122, v126
    v_add_f32 v123, v123, v127
    s_nop 0
    v_permlane16_swap_b32 v120, v122
    v_permlane16_swap_b32 v121, v123
    v_mfma_f32_16x16x32_bf16 v[148:151], v[52:55], a[32:35], v[148:151]
    ds_read_b64_tr_b16 v[48:49], v12 offset:24576
    v_add_f32 v120, v120, v122
    v_add_f32 v121, v121, v123
    s_nop 0
    v_add_f32_dpp v120, v120, v120 row_ror:8 row_mask:0xf bank_mask:0xf
    v_mfma_f32_16x16x32_bf16 v[180:183], v[52:55], a[36:39], v[180:183]
    ds_read_b64_tr_b16 v[50:51], v12 offset:25600
    v_add_f32_dpp v121, v121, v121 row_ror:8 row_mask:0xf bank_mask:0xf
    v_mfma_f32_16x16x32_bf16 v[212:215], v[52:55], a[40:43], v[212:215]
    buffer_load_dwordx4 v18, s[12:15], s98 offen offset:2048   lds
    ds_write_b64 v98, v[120:121]
    v_mfma_f32_16x16x32_bf16 v[244:247], v[52:55], a[44:47], v[244:247]
    v_mfma_f32_16x16x32_bf16 v[152:155], v[56:59], a[32:35], v[152:155]
    ds_read_b64_tr_b16 v[52:53], v13 offset:24576
    v_lshlrev_b32 v64, 16, v88
    v_mfma_f32_16x16x32_bf16 v[184:187], v[56:59], a[36:39], v[184:187]
    ds_read_b64_tr_b16 v[54:55], v13 offset:25600
    v_and_b32 v65, 0xffff0000, v88
    v_mfma_f32_16x16x32_bf16 v[216:219], v[56:59], a[40:43], v[216:219]
    buffer_load_dwordx4 v19, s[12:15], s98 offen offset:3072   lds
    v_mfma_f32_16x16x32_bf16 v[248:251], v[56:59], a[44:47], v[248:251]
    v_lshlrev_b32 v66, 16, v89
    v_and_b32 v67, 0xffff0000, v89
    v_mfma_f32_16x16x32_bf16 v[156:159], v[60:63], a[32:35], v[156:159]
    s_add_u32 m0, s62, 4096
    s_xor_b32 s98, s96, 33152
    ds_read_b64_tr_b16 v[56:57], v14 offset:24576
    v_mfma_f32_16x16x32_bf16 v[188:191], v[60:63], a[36:39], v[188:191]
    ds_read_b64_tr_b16 v[58:59], v14 offset:25600
    v_lshlrev_b32 v68, 16, v90
    v_mfma_f32_16x16x32_bf16 v[220:223], v[60:63], a[40:43], v[220:223]
    buffer_load_dwordx4 v16, s[12:15], s98 offen offset:0   lds
    v_mfma_f32_16x16x32_bf16 v[252:255], v[60:63], a[44:47], v[252:255]
    v_and_b32 v69, 0xffff0000, v90
    v_lshlrev_b32 v70, 16, v91
    v_mfma_f32_16x16x32_bf16 v[128:131], v[32:35], a[48:51], v[128:131]
    ds_read_b64_tr_b16 v[60:61], v15 offset:24576
    v_and_b32 v71, 0xffff0000, v91
    v_mfma_f32_16x16x32_bf16 v[160:163], v[32:35], a[52:55], v[160:163]
    ds_read_b64_tr_b16 v[62:63], v15 offset:25600
    v_lshlrev_b32 v72, 16, v92
    v_mfma_f32_16x16x32_bf16 v[192:195], v[32:35], a[56:59], v[192:195]
    buffer_load_dwordx4 v17, s[12:15], s98 offen offset:1024   lds
    v_mfma_f32_16x16x32_bf16 v[224:227], v[32:35], a[60:63], v[224:227]
    v_and_b32 v73, 0xffff0000, v92
    v_lshlrev_b32 v74, 16, v93
    v_mfma_f32_16x16x32_bf16 v[132:135], v[36:39], a[48:51], v[132:135]
    buffer_load_dwordx4 v18, s[12:15], s98 offen offset:2048   lds
    v_mfma_f32_16x16x32_bf16 v[164:167], v[36:39], a[52:55], v[164:167]
    v_and_b32 v75, 0xffff0000, v93
    v_lshlrev_b32 v76, 16, v94
    v_mfma_f32_16x16x32_bf16 v[196:199], v[36:39], a[56:59], v[196:199]
    buffer_load_dwordx4 v19, s[12:15], s98 offen offset:3072   lds
    s_cmp_eq_u32 s3, 0
    s_cselect_b32 s101, s100, 2147479552
    buffer_load_dword a241, v117, s[20:23], s101 offen offset:4
    v_mfma_f32_16x16x32_bf16 v[228:231], v[36:39], a[60:63], v[228:231]
    s_waitcnt lgkmcnt(2)
    v_and_b32 v77, 0xffff0000, v94
    v_lshlrev_b32 v78, 16, v95
    s_waitcnt vmcnt(9)
    v_mfma_f32_16x16x32_bf16 v[136:139], v[40:43], a[48:51], v[136:139]
    v_and_b32 v79, 0xffff0000, v95
    v_add_f32 v108, v64, v65
    s_waitcnt lgkmcnt(0)
    s_barrier
    v_mfma_f32_16x16x32_bf16 v[168:171], v[40:43], a[52:55], v[168:171]
    s_add_u32 m0, s63, 114688
    s_xor_b32 s98, s97, 2097152
    ds_read_b64_tr_b16 v[32:33], v8 offset:32768
    v_lshrrev_b32 v87, 2, v1
    v_add_u32 v101, 147456, v87
    v_mfma_f32_16x16x32_bf16 v[200:203], v[40:43], a[56:59], v[200:203]
    ds_read_b64_tr_b16 v[34:35], v8 offset:33792
    ds_read_b32 v102, v101
    v_mfma_f32_16x16x32_bf16 v[232:235], v[40:43], a[60:63], v[232:235]
    ds_read_b64_tr_b16 v[36:37], v9 offset:32768
    ds_read_b32 v103, v101 offset:256
    v_mfma_f32_16x16x32_bf16 v[140:143], v[44:47], a[48:51], v[140:143]
    ds_read_b64_tr_b16 v[38:39], v9 offset:33792
    ds_read_b32 v104, v101 offset:512
    v_mfma_f32_16x16x32_bf16 v[172:175], v[44:47], a[52:55], v[172:175]
    ds_read_b64_tr_b16 v[40:41], v10 offset:32768
    ds_read_b32 v105, v101 offset:768
    v_mfma_f32_16x16x32_bf16 v[204:207], v[44:47], a[56:59], v[204:207]
    ds_read_b64_tr_b16 v[42:43], v10 offset:33792
    v_add_f32 v109, v66, v67
    v_mfma_f32_16x16x32_bf16 v[236:239], v[44:47], a[60:63], v[236:239]
    ds_read_b128 a[64:67], v30 offset:0
    v_add_f32 v108, v108, v68
    v_mfma_f32_16x16x32_bf16 v[144:147], v[48:51], a[48:51], v[144:147]
    ds_read_b64_tr_b16 v[44:45], v11 offset:32768
    v_add_f32 v109, v109, v69
    v_mfma_f32_16x16x32_bf16 v[176:179], v[48:51], a[52:55], v[176:179]
    ds_read_b64_tr_b16 v[46:47], v11 offset:33792
    v_add_f32 v108, v108, v70
    v_mfma_f32_16x16x32_bf16 v[208:211], v[48:51], a[56:59], v[208:211]
    ds_read_b128 a[68:71], v30 offset:2048
    v_add_f32 v109, v109, v71
    v_mfma_f32_16x16x32_bf16 v[240:243], v[48:51], a[60:63], v[240:243]
    ds_read_b128 a[72:75], v30 offset:4096
    s_waitcnt lgkmcnt(10)
    v_add_f32 v102, v102, v103
    v_mfma_f32_16x16x32_bf16 v[148:151], v[52:55], a[48:51], v[148:151]
    ds_read_b64_tr_b16 v[48:49], v12 offset:32768
    s_waitcnt lgkmcnt(7)
    v_add_f32 v104, v104, v105
    v_mfma_f32_16x16x32_bf16 v[180:183], v[52:55], a[52:55], v[180:183]
    ds_read_b64_tr_b16 v[50:51], v12 offset:33792
    v_add_f32 v102, v102, v104
    buffer_store_dword v102, v87, s[8:11], s66 offen sc0 sc1
    v_mfma_f32_16x16x32_bf16 v[212:215], v[52:55], a[56:59], v[212:215]
    ds_read_b128 a[76:79], v30 offset:6144
    v_add_f32 v108, v108, v72
    v_mfma_f32_16x16x32_bf16 v[244:247], v[52:55], a[60:63], v[244:247]
    buffer_load_dwordx4 v20, s[16:19], s98 offen offset:0   lds
    v_mfma_f32_16x16x32_bf16 v[152:155], v[56:59], a[48:51], v[152:155]
    s_mov_b32 s40, s92
    s_mov_b32 s41, s93
    ds_read_b64_tr_b16 v[52:53], v13 offset:32768
    v_mfma_f32_16x16x32_bf16 v[184:187], v[56:59], a[52:55], v[184:187]
    s_mov_b32 s42, 1835008
    s_mov_b32 s44, s94
    ds_read_b64_tr_b16 v[54:55], v13 offset:33792
    v_mfma_f32_16x16x32_bf16 v[216:219], v[56:59], a[56:59], v[216:219]
    s_mov_b32 s45, s95
    s_mov_b32 s46, 1835008
    v_add_f32 v109, v109, v73
    v_mfma_f32_16x16x32_bf16 v[248:251], v[56:59], a[60:63], v[248:251]
    buffer_load_dwordx4 v21, s[16:19], s98 offen offset:1024   lds
    v_mfma_f32_16x16x32_bf16 v[156:159], v[60:63], a[48:51], v[156:159]
    ds_read_b64_tr_b16 v[56:57], v14 offset:32768
    v_add_f32 v108, v108, v74
    v_mfma_f32_16x16x32_bf16 v[188:191], v[60:63], a[52:55], v[188:191]
    ds_read_b64_tr_b16 v[58:59], v14 offset:33792
    v_add_f32 v109, v109, v75
    v_mfma_f32_16x16x32_bf16 v[220:223], v[60:63], a[56:59], v[220:223]
    buffer_load_dwordx4 v22, s[16:19], s98 offen offset:2048   lds
    v_mfma_f32_16x16x32_bf16 v[252:255], v[60:63], a[60:63], v[252:255]
    s_waitcnt lgkmcnt(5)
    v_add_f32 v108, v108, v76
    v_add_f32 v109, v109, v77
    v_mfma_f32_16x16x32_bf16 v[128:131], v[32:35], a[64:67], v[128:131]
    ds_read_b64_tr_b16 v[60:61], v15 offset:32768
    v_add_f32 v108, v108, v78
    v_mfma_f32_16x16x32_bf16 v[160:163], v[32:35], a[68:71], v[160:163]
    ds_read_b64_tr_b16 v[62:63], v15 offset:33792
    v_add_f32 v109, v109, v79
    v_mfma_f32_16x16x32_bf16 v[192:195], v[32:35], a[72:75], v[192:195]
    s_waitcnt lgkmcnt(5)
    ds_read_b128 a[80:83], v31 offset:0
    v_add_f32 v108, v108, v109
    v_mfma_f32_16x16x32_bf16 v[224:227], v[32:35], a[76:79], v[224:227]
    ds_read_b128 a[84:87], v31 offset:2048
    v_add_f32_dpp v108, v108, v108 row_ror:8 row_mask:0xf bank_mask:0xf
    v_mfma_f32_16x16x32_bf16 v[132:135], v[36:39], a[64:67], v[132:135]
    ds_read_b64_tr_b16 v[32:33], v8 offset:40960
    v_mov_b32 v110, v108
    v_mfma_f32_16x16x32_bf16 v[164:167], v[36:39], a[68:71], v[164:167]
    ds_read_b64_tr_b16 v[34:35], v8 offset:41984
    v_permlane16_swap_b32 v108, v110
    v_mfma_f32_16x16x32_bf16 v[196:199], v[36:39], a[72:75], v[196:199]
    ds_read_b128 a[88:91], v31 offset:4096
    v_add_f32 v108, v108, v110
    v_mfma_f32_16x16x32_bf16 v[228:231], v[36:39], a[76:79], v[228:231]
    ds_read_b128 a[92:95], v31 offset:6144
    v_mov_b32 v110, v108
    v_mfma_f32_16x16x32_bf16 v[136:139], v[40:43], a[64:67], v[136:139]
    ds_read_b64_tr_b16 v[36:37], v9 offset:40960
    v_permlane32_swap_b32 v108, v110
    v_mfma_f32_16x16x32_bf16 v[168:171], v[40:43], a[68:71], v[168:171]
    ds_read_b64_tr_b16 v[38:39], v9 offset:41984
    v_add_f32 v108, v108, v110
    v_mfma_f32_16x16x32_bf16 v[200:203], v[40:43], a[72:75], v[200:203]
    buffer_load_dwordx4 v23, s[16:19], s98 offen offset:3072   lds
    v_mfma_f32_16x16x32_bf16 v[232:235], v[40:43], a[76:79], v[232:235]
    v_mul_f32 v108, 0x3c000000, v108
    v_sub_f32 v110, v64, v108
    v_mfma_f32_16x16x32_bf16 v[140:143], v[44:47], a[64:67], v[140:143]
    s_add_u32 m0, s62, 32768
    s_xor_b32 s98, s96, 512
    ds_read_b64_tr_b16 v[40:41], v10 offset:40960
    v_mfma_f32_16x16x32_bf16 v[172:175], v[44:47], a[68:71], v[172:175]
    ds_read_b64_tr_b16 v[42:43], v10 offset:41984
    v_mul_f32 v109, v110, v110
    v_mfma_f32_16x16x32_bf16 v[204:207], v[44:47], a[72:75], v[204:207]
    buffer_load_dwordx4 v16, s[12:15], s98 offen offset:0   lds
    v_mfma_f32_16x16x32_bf16 v[236:239], v[44:47], a[76:79], v[236:239]
    v_sub_f32 v111, v65, v108
    v_fmac_f32 v109, v111, v111
    v_mfma_f32_16x16x32_bf16 v[144:147], v[48:51], a[64:67], v[144:147]
    ds_read_b64_tr_b16 v[44:45], v11 offset:40960
    v_sub_f32 v110, v66, v108
    v_mfma_f32_16x16x32_bf16 v[176:179], v[48:51], a[68:71], v[176:179]
    ds_read_b64_tr_b16 v[46:47], v11 offset:41984
    v_fmac_f32 v109, v110, v110
    v_mfma_f32_16x16x32_bf16 v[208:211], v[48:51], a[72:75], v[208:211]
    buffer_load_dwordx4 v17, s[12:15], s98 offen offset:1024   lds
    v_mfma_f32_16x16x32_bf16 v[240:243], v[48:51], a[76:79], v[240:243]
    s_waitcnt lgkmcnt(4)
    v_sub_f32 v111, v67, v108
    v_fmac_f32 v109, v111, v111
    v_mfma_f32_16x16x32_bf16 v[148:151], v[52:55], a[64:67], v[148:151]
    ds_read_b64_tr_b16 v[48:49], v12 offset:40960
    v_sub_f32 v110, v68, v108
    v_mfma_f32_16x16x32_bf16 v[180:183], v[52:55], a[68:71], v[180:183]
    ds_read_b64_tr_b16 v[50:51], v12 offset:41984
    v_fmac_f32 v109, v110, v110
    v_mfma_f32_16x16x32_bf16 v[212:215], v[52:55], a[72:75], v[212:215]
    buffer_load_dwordx4 v18, s[12:15], s98 offen offset:2048   lds
    v_mfma_f32_16x16x32_bf16 v[244:247], v[52:55], a[76:79], v[244:247]
    v_sub_f32 v111, v69, v108
    v_fmac_f32 v109, v111, v111
    v_mfma_f32_16x16x32_bf16 v[152:155], v[56:59], a[64:67], v[152:155]
    ds_read_b64_tr_b16 v[52:53], v13 offset:40960
    v_sub_f32 v110, v70, v108
    v_mfma_f32_16x16x32_bf16 v[184:187], v[56:59], a[68:71], v[184:187]
    ds_read_b64_tr_b16 v[54:55], v13 offset:41984
    v_fmac_f32 v109, v110, v110
    v_mfma_f32_16x16x32_bf16 v[216:219], v[56:59], a[72:75], v[216:219]
    buffer_load_dwordx4 v19, s[12:15], s98 offen offset:3072   lds
    v_mfma_f32_16x16x32_bf16 v[248:251], v[56:59], a[76:79], v[248:251]
    v_sub_f32 v111, v71, v108
    v_fmac_f32 v109, v111, v111
    v_mfma_f32_16x16x32_bf16 v[156:159], v[60:63], a[64:67], v[156:159]
    s_add_u32 m0, s62, 36864
    s_xor_b32 s98, s96, 33280
    ds_read_b64_tr_b16 v[56:57], v14 offset:40960
    v_mfma_f32_16x16x32_bf16 v[188:191], v[60:63], a[68:71], v[188:191]
    ds_read_b64_tr_b16 v[58:59], v14 offset:41984
    v_sub_f32 v110, v72, v108
    v_mfma_f32_16x16x32_bf16 v[220:223], v[60:63], a[72:75], v[220:223]
    buffer_load_dwordx4 v16, s[12:15], s98 offen offset:0   lds
    v_mfma_f32_16x16x32_bf16 v[252:255], v[60:63], a[76:79], v[252:255]
    v_fmac_f32 v109, v110, v110
    v_sub_f32 v111, v73, v108
    v_mfma_f32_16x16x32_bf16 v[128:131], v[32:35], a[80:83], v[128:131]
    ds_read_b64_tr_b16 v[60:61], v15 offset:40960
    v_fmac_f32 v109, v111, v111
    v_mfma_f32_16x16x32_bf16 v[160:163], v[32:35], a[84:87], v[160:163]
    ds_read_b64_tr_b16 v[62:63], v15 offset:41984
    v_sub_f32 v110, v74, v108
    v_mfma_f32_16x16x32_bf16 v[192:195], v[32:35], a[88:91], v[192:195]
    buffer_load_dwordx4 v17, s[12:15], s98 offen offset:1024   lds
    v_mfma_f32_16x16x32_bf16 v[224:227], v[32:35], a[92:95], v[224:227]
    v_fmac_f32 v109, v110, v110
    v_sub_f32 v111, v75, v108
    v_mfma_f32_16x16x32_bf16 v[132:135], v[36:39], a[80:83], v[132:135]
    buffer_load_dwordx4 v18, s[12:15], s98 offen offset:2048   lds
    v_mfma_f32_16x16x32_bf16 v[164:167], v[36:39], a[84:87], v[164:167]
    v_fmac_f32 v109, v111, v111
    v_sub_f32 v110, v76, v108
    v_mfma_f32_16x16x32_bf16 v[196:199], v[36:39], a[88:91], v[196:199]
    buffer_load_dwordx4 v19, s[12:15], s98 offen offset:3072   lds
    s_cmp_eq_u32 s3, 1
    s_cselect_b32 s101, s100, 2147479552
    buffer_load_dword a243, v117, s[20:23], s101 offen offset:4
    v_mfma_f32_16x16x32_bf16 v[228:231], v[36:39], a[92:95], v[228:231]
    s_waitcnt lgkmcnt(2)
    v_fmac_f32 v109, v110, v110
    v_sub_f32 v111, v77, v108
    v_mfma_f32_16x16x32_bf16 v[136:139], v[40:43], a[80:83], v[136:139]
    v_fmac_f32 v109, v111, v111
    v_sub_f32 v110, v78, v108
    s_waitcnt vmcnt(15) lgkmcnt(0)
    s_barrier
    v_mfma_f32_16x16x32_bf16 v[168:171], v[40:43], a[84:87], v[168:171]
    s_add_u32 m0, s63, 131072
    s_xor_b32 s98, s97, 2621440
    ds_read_b64_tr_b16 v[32:33], v8 offset:0
    v_mfma_f32_16x16x32_bf16 v[200:203], v[40:43], a[88:91], v[200:203]
    ds_read_b64_tr_b16 v[34:35], v8 offset:1024
    v_fmac_f32 v109, v110, v110
    v_mfma_f32_16x16x32_bf16 v[232:235], v[40:43], a[92:95], v[232:235]
    ds_read_b64_tr_b16 v[36:37], v9 offset:0
    v_sub_f32 v111, v79, v108
    v_mfma_f32_16x16x32_bf16 v[140:143], v[44:47], a[80:83], v[140:143]
    ds_read_b64_tr_b16 v[38:39], v9 offset:1024
    v_fmac_f32 v109, v111, v111
    v_mfma_f32_16x16x32_bf16 v[172:175], v[44:47], a[84:87], v[172:175]
    ds_read_b64_tr_b16 v[40:41], v10 offset:0
    v_add_f32_dpp v109, v109, v109 row_ror:8 row_mask:0xf bank_mask:0xf
    v_mfma_f32_16x16x32_bf16 v[204:207], v[44:47], a[88:91], v[204:207]
    ds_read_b64_tr_b16 v[42:43], v10 offset:1024
    v_mov_b32 v110, v109
    v_mfma_f32_16x16x32_bf16 v[236:239], v[44:47], a[92:95], v[236:239]
    ds_read_b128 a[96:99], v28 offset:0
    v_permlane16_swap_b32 v109, v110
    v_mfma_f32_16x16x32_bf16 v[144:147], v[48:51], a[80:83], v[144:147]
    ds_read_b64_tr_b16 v[44:45], v11 offset:0
    v_add_f32 v109, v109, v110
    v_mfma_f32_16x16x32_bf16 v[176:179], v[48:51], a[84:87], v[176:179]
    ds_read_b64_tr_b16 v[46:47], v11 offset:1024
    v_mov_b32 v110, v109
    s_waitcnt vmcnt(13)
    buffer_atomic_add v6, v7, s[36:39], s69 offen sc1
    v_mfma_f32_16x16x32_bf16 v[208:211], v[48:51], a[88:91], v[208:211]
    ds_read_b128 a[100:103], v28 offset:2048
    v_permlane32_swap_b32 v109, v110
    v_mfma_f32_16x16x32_bf16 v[240:243], v[48:51], a[92:95], v[240:243]
    ds_read_b128 a[104:107], v28 offset:4096
    v_add_f32 v109, v109, v110
    v_mfma_f32_16x16x32_bf16 v[148:151], v[52:55], a[80:83], v[148:151]
    ds_read_b64_tr_b16 v[48:49], v12 offset:0
    v_mfma_f32_16x16x32_bf16 v[180:183], v[52:55], a[84:87], v[180:183]
    ds_read_b64_tr_b16 v[50:51], v12 offset:1024
    v_mfma_f32_16x16x32_bf16 v[212:215], v[52:55], a[88:91], v[212:215]
    ds_read_b128 a[108:111], v28 offset:6144
    v_mfma_f32_16x16x32_bf16 v[244:247], v[52:55], a[92:95], v[244:247]
    buffer_load_dwordx4 v20, s[16:19], s98 offen offset:0   lds
    v_mfma_f32_16x16x32_bf16 v[152:155], v[56:59], a[80:83], v[152:155]
    ds_read_b64_tr_b16 v[52:53], v13 offset:0
    v_mfma_f32_16x16x32_bf16 v[184:187], v[56:59], a[84:87], v[184:187]
    ds_read_b64_tr_b16 v[54:55], v13 offset:1024
    v_mfma_f32_16x16x32_bf16 v[216:219], v[56:59], a[88:91], v[216:219]
    buffer_load_dwordx4 v21, s[16:19], s98 offen offset:1024   lds
    v_mfma_f32_16x16x32_bf16 v[248:251], v[56:59], a[92:95], v[248:251]
    ds_write_b64 v100, v[108:109]
    v_mfma_f32_16x16x32_bf16 v[156:159], v[60:63], a[80:83], v[156:159]
    ds_read_b64_tr_b16 v[56:57], v14 offset:0
    v_mfma_f32_16x16x32_bf16 v[188:191], v[60:63], a[84:87], v[188:191]
    ds_read_b64_tr_b16 v[58:59], v14 offset:1024
    v_mfma_f32_16x16x32_bf16 v[220:223], v[60:63], a[88:91], v[220:223]
    buffer_load_dwordx4 v22, s[16:19], s98 offen offset:2048   lds
    v_mfma_f32_16x16x32_bf16 v[252:255], v[60:63], a[92:95], v[252:255]
    s_waitcnt lgkmcnt(6)
    v_mfma_f32_16x16x32_bf16 v[128:131], v[32:35], a[96:99], v[128:131]
    ds_read_b64_tr_b16 v[60:61], v15 offset:0
    v_mfma_f32_16x16x32_bf16 v[160:163], v[32:35], a[100:103], v[160:163]
    ds_read_b64_tr_b16 v[62:63], v15 offset:1024
    v_mfma_f32_16x16x32_bf16 v[192:195], v[32:35], a[104:107], v[192:195]
    s_waitcnt lgkmcnt(6)
    ds_read_b128 a[112:115], v29 offset:0
    v_mfma_f32_16x16x32_bf16 v[224:227], v[32:35], a[108:111], v[224:227]
    ds_read_b128 a[116:119], v29 offset:2048
    v_mfma_f32_16x16x32_bf16 v[132:135], v[36:39], a[96:99], v[132:135]
    ds_read_b64_tr_b16 v[32:33], v8 offset:8192
    v_mfma_f32_16x16x32_bf16 v[164:167], v[36:39], a[100:103], v[164:167]
    ds_read_b64_tr_b16 v[34:35], v8 offset:9216
    v_mfma_f32_16x16x32_bf16 v[196:199], v[36:39], a[104:107], v[196:199]
    ds_read_b128 a[120:123], v29 offset:4096
    v_mfma_f32_16x16x32_bf16 v[228:231], v[36:39], a[108:111], v[228:231]
    ds_read_b128 a[124:127], v29 offset:6144
    v_mfma_f32_16x16x32_bf16 v[136:139], v[40:43], a[96:99], v[136:139]
    ds_read_b64_tr_b16 v[36:37], v9 offset:8192
    v_mfma_f32_16x16x32_bf16 v[168:171], v[40:43], a[100:103], v[168:171]
    ds_read_b64_tr_b16 v[38:39], v9 offset:9216
    v_mfma_f32_16x16x32_bf16 v[200:203], v[40:43], a[104:107], v[200:203]
    buffer_load_dwordx4 v23, s[16:19], s98 offen offset:3072   lds
    v_mfma_f32_16x16x32_bf16 v[232:235], v[40:43], a[108:111], v[232:235]
    v_mfma_f32_16x16x32_bf16 v[140:143], v[44:47], a[96:99], v[140:143]
    s_add_u32 m0, s62, 65536
    s_xor_b32 s98, s96, 640
    ds_read_b64_tr_b16 v[40:41], v10 offset:8192
    v_mfma_f32_16x16x32_bf16 v[172:175], v[44:47], a[100:103], v[172:175]
    ds_read_b64_tr_b16 v[42:43], v10 offset:9216
    v_mfma_f32_16x16x32_bf16 v[204:207], v[44:47], a[104:107], v[204:207]
    buffer_load_dwordx4 v16, s[12:15], s98 offen offset:0   lds
    v_mfma_f32_16x16x32_bf16 v[236:239], v[44:47], a[108:111], v[236:239]
    v_mfma_f32_16x16x32_bf16 v[144:147], v[48:51], a[96:99], v[144:147]
    ds_read_b64_tr_b16 v[44:45], v11 offset:8192
    v_mfma_f32_16x16x32_bf16 v[176:179], v[48:51], a[100:103], v[176:179]
    ds_read_b64_tr_b16 v[46:47], v11 offset:9216
    v_mfma_f32_16x16x32_bf16 v[208:211], v[48:51], a[104:107], v[208:211]
    buffer_load_dwordx4 v17, s[12:15], s98 offen offset:1024   lds
    v_mfma_f32_16x16x32_bf16 v[240:243], v[48:51], a[108:111], v[240:243]
    s_waitcnt lgkmcnt(4)
    v_mfma_f32_16x16x32_bf16 v[148:151], v[52:55], a[96:99], v[148:151]
    ds_read_b64_tr_b16 v[48:49], v12 offset:8192
    v_mfma_f32_16x16x32_bf16 v[180:183], v[52:55], a[100:103], v[180:183]
    ds_read_b64_tr_b16 v[50:51], v12 offset:9216
    v_mfma_f32_16x16x32_bf16 v[212:215], v[52:55], a[104:107], v[212:215]
    buffer_load_dwordx4 v18, s[12:15], s98 offen offset:2048   lds
    v_mfma_f32_16x16x32_bf16 v[244:247], v[52:55], a[108:111], v[244:247]
    v_mfma_f32_16x16x32_bf16 v[152:155], v[56:59], a[96:99], v[152:155]
    ds_read_b64_tr_b16 v[52:53], v13 offset:8192
    v_mfma_f32_16x16x32_bf16 v[184:187], v[56:59], a[100:103], v[184:187]
    ds_read_b64_tr_b16 v[54:55], v13 offset:9216
    v_mfma_f32_16x16x32_bf16 v[216:219], v[56:59], a[104:107], v[216:219]
    buffer_load_dwordx4 v19, s[12:15], s98 offen offset:3072   lds
    v_mfma_f32_16x16x32_bf16 v[248:251], v[56:59], a[108:111], v[248:251]
    v_mfma_f32_16x16x32_bf16 v[156:159], v[60:63], a[96:99], v[156:159]
    s_add_u32 m0, s62, 69632
    s_xor_b32 s98, s96, 33408
    ds_read_b64_tr_b16 v[56:57], v14 offset:8192
    v_mfma_f32_16x16x32_bf16 v[188:191], v[60:63], a[100:103], v[188:191]
    ds_read_b64_tr_b16 v[58:59], v14 offset:9216
    v_mfma_f32_16x16x32_bf16 v[220:223], v[60:63], a[104:107], v[220:223]
    buffer_load_dwordx4 v16, s[12:15], s98 offen offset:0   lds
    v_mfma_f32_16x16x32_bf16 v[252:255], v[60:63], a[108:111], v[252:255]
    v_mfma_f32_16x16x32_bf16 v[128:131], v[32:35], a[112:115], v[128:131]
    ds_read_b64_tr_b16 v[60:61], v15 offset:8192
    v_mfma_f32_16x16x32_bf16 v[160:163], v[32:35], a[116:119], v[160:163]
    ds_read_b64_tr_b16 v[62:63], v15 offset:9216
    v_mfma_f32_16x16x32_bf16 v[192:195], v[32:35], a[120:123], v[192:195]
    buffer_load_dwordx4 v17, s[12:15], s98 offen offset:1024   lds
    v_mfma_f32_16x16x32_bf16 v[224:227], v[32:35], a[124:127], v[224:227]
    v_mfma_f32_16x16x32_bf16 v[132:135], v[36:39], a[112:115], v[132:135]
    buffer_load_dwordx4 v18, s[12:15], s98 offen offset:2048   lds
    v_mfma_f32_16x16x32_bf16 v[164:167], v[36:39], a[116:119], v[164:167]
    v_mfma_f32_16x16x32_bf16 v[196:199], v[36:39], a[120:123], v[196:199]
    buffer_load_dwordx4 v19, s[12:15], s98 offen offset:3072   lds
    s_cmp_eq_u32 s3, 2
    s_cselect_b32 s101, s100, 2147479552
    buffer_load_dword a245, v117, s[24:27], s101 offen offset:4
    v_mfma_f32_16x16x32_bf16 v[228:231], v[36:39], a[124:127], v[228:231]
    s_waitcnt lgkmcnt(2)
    v_mfma_f32_16x16x32_bf16 v[136:139], v[40:43], a[112:115], v[136:139]
    s_waitcnt vmcnt(15) lgkmcnt(0)
    s_barrier
    v_mfma_f32_16x16x32_bf16 v[168:171], v[40:43], a[116:119], v[168:171]
    s_add_u32 m0, s63, 98304
    s_xor_b32 s98, s97, 3145728
    ds_read_b64_tr_b16 v[32:33], v8 offset:16384
    v_mfma_f32_16x16x32_bf16 v[200:203], v[40:43], a[120:123], v[200:203]
    ds_read_b64_tr_b16 v[34:35], v8 offset:17408
    v_mfma_f32_16x16x32_bf16 v[232:235], v[40:43], a[124:127], v[232:235]
    ds_read_b64_tr_b16 v[36:37], v9 offset:16384
    v_mfma_f32_16x16x32_bf16 v[140:143], v[44:47], a[112:115], v[140:143]
    ds_read_b64_tr_b16 v[38:39], v9 offset:17408
    v_mfma_f32_16x16x32_bf16 v[172:175], v[44:47], a[116:119], v[172:175]
    ds_read_b64_tr_b16 v[40:41], v10 offset:16384
    v_mfma_f32_16x16x32_bf16 v[204:207], v[44:47], a[120:123], v[204:207]
    ds_read_b64_tr_b16 v[42:43], v10 offset:17408
    v_mfma_f32_16x16x32_bf16 v[236:239], v[44:47], a[124:127], v[236:239]
    ds_read_b128 a[128:131], v28 offset:32768
    v_mfma_f32_16x16x32_bf16 v[144:147], v[48:51], a[112:115], v[144:147]
    ds_read_b64_tr_b16 v[44:45], v11 offset:16384
    v_mfma_f32_16x16x32_bf16 v[176:179], v[48:51], a[116:119], v[176:179]
    ds_read_b64_tr_b16 v[46:47], v11 offset:17408
    v_mfma_f32_16x16x32_bf16 v[208:211], v[48:51], a[120:123], v[208:211]
    ds_read_b128 a[132:135], v28 offset:34816
    v_mfma_f32_16x16x32_bf16 v[240:243], v[48:51], a[124:127], v[240:243]
    ds_read_b128 a[136:139], v28 offset:36864
    v_mfma_f32_16x16x32_bf16 v[148:151], v[52:55], a[112:115], v[148:151]
    ds_read_b64_tr_b16 v[48:49], v12 offset:16384
    v_mfma_f32_16x16x32_bf16 v[180:183], v[52:55], a[116:119], v[180:183]
    ds_read_b64_tr_b16 v[50:51], v12 offset:17408
    v_mfma_f32_16x16x32_bf16 v[212:215], v[52:55], a[120:123], v[212:215]
    ds_read_b128 a[140:143], v28 offset:38912
    v_mfma_f32_16x16x32_bf16 v[244:247], v[52:55], a[124:127], v[244:247]
    buffer_load_dwordx4 v20, s[16:19], s98 offen offset:0   lds
    v_mfma_f32_16x16x32_bf16 v[152:155], v[56:59], a[112:115], v[152:155]
    ds_read_b64_tr_b16 v[52:53], v13 offset:16384
    v_mfma_f32_16x16x32_bf16 v[184:187], v[56:59], a[116:119], v[184:187]
    ds_read_b64_tr_b16 v[54:55], v13 offset:17408
    v_mfma_f32_16x16x32_bf16 v[216:219], v[56:59], a[120:123], v[216:219]
    buffer_load_dwordx4 v21, s[16:19], s98 offen offset:1024   lds
    v_mfma_f32_16x16x32_bf16 v[248:251], v[56:59], a[124:127], v[248:251]
    ds_read_b128 v[88:91], v99
    v_mfma_f32_16x16x32_bf16 v[156:159], v[60:63], a[112:115], v[156:159]
    ds_read_b64_tr_b16 v[56:57], v14 offset:16384
    v_mfma_f32_16x16x32_bf16 v[188:191], v[60:63], a[116:119], v[188:191]
    ds_read_b64_tr_b16 v[58:59], v14 offset:17408
    v_mfma_f32_16x16x32_bf16 v[220:223], v[60:63], a[120:123], v[220:223]
    buffer_load_dwordx4 v22, s[16:19], s98 offen offset:2048   lds
    v_mfma_f32_16x16x32_bf16 v[252:255], v[60:63], a[124:127], v[252:255]
    s_waitcnt lgkmcnt(6)
    ds_read_b128 v[92:95], v99 offset:16
    v_mfma_f32_16x16x32_bf16 v[128:131], v[32:35], a[128:131], v[128:131]
    ds_read_b64_tr_b16 v[60:61], v15 offset:16384
    v_mfma_f32_16x16x32_bf16 v[160:163], v[32:35], a[132:135], v[160:163]
    ds_read_b64_tr_b16 v[62:63], v15 offset:17408
    v_mfma_f32_16x16x32_bf16 v[192:195], v[32:35], a[136:139], v[192:195]
    s_waitcnt lgkmcnt(7)
    ds_read_b128 a[144:147], v29 offset:32768
    v_mfma_f32_16x16x32_bf16 v[224:227], v[32:35], a[140:143], v[224:227]
    ds_read_b128 a[148:151], v29 offset:34816
    v_mfma_f32_16x16x32_bf16 v[132:135], v[36:39], a[128:131], v[132:135]
    ds_read_b64_tr_b16 v[32:33], v8 offset:24576
    v_mfma_f32_16x16x32_bf16 v[164:167], v[36:39], a[132:135], v[164:167]
    ds_read_b64_tr_b16 v[34:35], v8 offset:25600
    v_mfma_f32_16x16x32_bf16 v[196:199], v[36:39], a[136:139], v[196:199]
    ds_read_b128 a[152:155], v29 offset:36864
    v_mfma_f32_16x16x32_bf16 v[228:231], v[36:39], a[140:143], v[228:231]
    ds_read_b128 a[156:159], v29 offset:38912
    s_waitcnt lgkmcnt(11)
    v_add_f32 v108, v88, v90
    v_mfma_f32_16x16x32_bf16 v[136:139], v[40:43], a[128:131], v[136:139]
    ds_read_b64_tr_b16 v[36:37], v9 offset:24576
    s_waitcnt lgkmcnt(9)
    v_add_f32 v109, v92, v94
    v_mfma_f32_16x16x32_bf16 v[168:171], v[40:43], a[132:135], v[168:171]
    ds_read_b64_tr_b16 v[38:39], v9 offset:25600
    v_add_f32 v108, v108, v109
    v_mfma_f32_16x16x32_bf16 v[200:203], v[40:43], a[136:139], v[200:203]
    buffer_load_dwordx4 v23, s[16:19], s98 offen offset:3072   lds
    v_mfma_f32_16x16x32_bf16 v[232:235], v[40:43], a[140:143], v[232:235]
    v_mul_f32 v108, 0x3e800000, v108
    v_add_f32 v109, v89, v91
    v_mfma_f32_16x16x32_bf16 v[140:143], v[44:47], a[128:131], v[140:143]
    s_add_u32 m0, s62, 0
    s_xor_b32 s98, s96, 768
    ds_read_b64_tr_b16 v[40:41], v10 offset:24576
    v_mfma_f32_16x16x32_bf16 v[172:175], v[44:47], a[132:135], v[172:175]
    ds_read_b64_tr_b16 v[42:43], v10 offset:25600
    v_add_f32 v110, v93, v95
    v_mfma_f32_16x16x32_bf16 v[204:207], v[44:47], a[136:139], v[204:207]
    buffer_load_dwordx4 v16, s[12:15], s98 offen offset:0   lds
    v_mfma_f32_16x16x32_bf16 v[236:239], v[44:47], a[140:143], v[236:239]
    v_add_f32 v109, v109, v110
    v_sub_f32 v88, v88, v108
    v_mfma_f32_16x16x32_bf16 v[144:147], v[48:51], a[128:131], v[144:147]
    ds_read_b64_tr_b16 v[44:45], v11 offset:24576
    v_sub_f32 v90, v90, v108
    v_mfma_f32_16x16x32_bf16 v[176:179], v[48:51], a[132:135], v[176:179]
    ds_read_b64_tr_b16 v[46:47], v11 offset:25600
    v_sub_f32 v92, v92, v108
    v_mfma_f32_16x16x32_bf16 v[208:211], v[48:51], a[136:139], v[208:211]
    buffer_load_dwordx4 v17, s[12:15], s98 offen offset:1024   lds
    v_mfma_f32_16x16x32_bf16 v[240:243], v[48:51], a[140:143], v[240:243]
    v_sub_f32 v94, v94, v108
    v_mul_f32 v110, v88, v88
    v_mfma_f32_16x16x32_bf16 v[148:151], v[52:55], a[128:131], v[148:151]
    ds_read_b64_tr_b16 v[48:49], v12 offset:24576
    v_fmac_f32 v110, v90, v90
    v_mfma_f32_16x16x32_bf16 v[180:183], v[52:55], a[132:135], v[180:183]
    ds_read_b64_tr_b16 v[50:51], v12 offset:25600
    v_fmac_f32 v110, v92, v92
    v_mfma_f32_16x16x32_bf16 v[212:215], v[52:55], a[136:139], v[212:215]
    buffer_load_dwordx4 v18, s[12:15], s98 offen offset:2048   lds
    v_mfma_f32_16x16x32_bf16 v[244:247], v[52:55], a[140:143], v[244:247]
    v_fmac_f32 v110, v94, v94
    v_fmac_f32 v109, 0x43000000, v110
    v_mfma_f32_16x16x32_bf16 v[152:155], v[56:59], a[128:131], v[152:155]
    ds_read_b64_tr_b16 v[52:53], v13 offset:24576
    v_mov_b32 v110, 0x3727c5ac
    v_mfma_f32_16x16x32_bf16 v[184:187], v[56:59], a[132:135], v[184:187]
    ds_read_b64_tr_b16 v[54:55], v13 offset:25600
    v_fmac_f32 v110, 0x3b000000, v109
    v_mfma_f32_16x16x32_bf16 v[216:219], v[56:59], a[136:139], v[216:219]
    buffer_load_dwordx4 v19, s[12:15], s98 offen offset:3072   lds
    v_mfma_f32_16x16x32_bf16 v[248:251], v[56:59], a[140:143], v[248:251]
    s_waitcnt lgkmcnt(4)
    v_rsq_f32 v110, v110
    v_mfma_f32_16x16x32_bf16 v[156:159], v[60:63], a[128:131], v[156:159]
    s_add_u32 m0, s62, 4096
    s_xor_b32 s98, s96, 33536
    ds_read_b64_tr_b16 v[56:57], v14 offset:24576
    v_mfma_f32_16x16x32_bf16 v[188:191], v[60:63], a[132:135], v[188:191]
    ds_read_b64_tr_b16 v[58:59], v14 offset:25600
    v_sub_f32 v64, v64, v108
    v_mfma_f32_16x16x32_bf16 v[220:223], v[60:63], a[136:139], v[220:223]
    buffer_load_dwordx4 v16, s[12:15], s98 offen offset:0   lds
    v_mfma_f32_16x16x32_bf16 v[252:255], v[60:63], a[140:143], v[252:255]
    v_sub_f32 v65, v65, v108
    v_sub_f32 v66, v66, v108
    v_mfma_f32_16x16x32_bf16 v[128:131], v[32:35], a[144:147], v[128:131]
    ds_read_b64_tr_b16 v[60:61], v15 offset:24576
    v_sub_f32 v67, v67, v108
    v_mfma_f32_16x16x32_bf16 v[160:163], v[32:35], a[148:151], v[160:163]
    ds_read_b64_tr_b16 v[62:63], v15 offset:25600
    v_sub_f32 v68, v68, v108
    v_mfma_f32_16x16x32_bf16 v[192:195], v[32:35], a[152:155], v[192:195]
    buffer_load_dwordx4 v17, s[12:15], s98 offen offset:1024   lds
    v_mfma_f32_16x16x32_bf16 v[224:227], v[32:35], a[156:159], v[224:227]
    v_sub_f32 v69, v69, v108
    v_sub_f32 v70, v70, v108
    v_mfma_f32_16x16x32_bf16 v[132:135], v[36:39], a[144:147], v[132:135]
    buffer_load_dwordx4 v18, s[12:15], s98 offen offset:2048   lds
    v_mfma_f32_16x16x32_bf16 v[164:167], v[36:39], a[148:151], v[164:167]
    v_sub_f32 v71, v71, v108
    v_sub_f32 v72, v72, v108
    v_mfma_f32_16x16x32_bf16 v[196:199], v[36:39], a[152:155], v[196:199]
    buffer_load_dwordx4 v19, s[12:15], s98 offen offset:3072   lds
    s_cmp_eq_u32 s3, 3
    s_cselect_b32 s101, s100, 2147479552
    buffer_load_dword a247, v117, s[24:27], s101 offen offset:4
    v_mfma_f32_16x16x32_bf16 v[228:231], v[36:39], a[156:159], v[228:231]
    v_sub_f32 v73, v73, v108
    v_sub_f32 v74, v74, v108
    v_mfma_f32_16x16x32_bf16 v[136:139], v[40:43], a[144:147], v[136:139]
    v_sub_f32 v75, v75, v108
    v_sub_f32 v76, v76, v108
    s_waitcnt vmcnt(14) lgkmcnt(0)
    s_barrier
    v_mfma_f32_16x16x32_bf16 v[168:171], v[40:43], a[148:151], v[168:171]
    s_add_u32 m0, s63, 114688
    s_xor_b32 s98, s97, 3670016
    ds_read_b64_tr_b16 v[32:33], v8 offset:32768
    v_mfma_f32_16x16x32_bf16 v[200:203], v[40:43], a[152:155], v[200:203]
    ds_read_b64_tr_b16 v[34:35], v8 offset:33792
    v_sub_f32 v77, v77, v108
    v_mfma_f32_16x16x32_bf16 v[232:235], v[40:43], a[156:159], v[232:235]
    ds_read_b64_tr_b16 v[36:37], v9 offset:32768
    v_sub_f32 v78, v78, v108
    v_mfma_f32_16x16x32_bf16 v[140:143], v[44:47], a[144:147], v[140:143]
    ds_read_b64_tr_b16 v[38:39], v9 offset:33792
    v_sub_f32 v79, v79, v108
    v_mfma_f32_16x16x32_bf16 v[172:175], v[44:47], a[148:151], v[172:175]
    ds_read_b64_tr_b16 v[40:41], v10 offset:32768
    v_mul_f32 v64, v64, v110
    v_mfma_f32_16x16x32_bf16 v[204:207], v[44:47], a[152:155], v[204:207]
    ds_read_b64_tr_b16 v[42:43], v10 offset:33792
    v_mul_f32 v65, v65, v110
    v_mfma_f32_16x16x32_bf16 v[236:239], v[44:47], a[156:159], v[236:239]
    ds_read_b128 a[160:163], v30 offset:0
    v_mul_f32 v66, v66, v110
    v_mfma_f32_16x16x32_bf16 v[144:147], v[48:51], a[144:147], v[144:147]
    ds_read_b64_tr_b16 v[44:45], v11 offset:32768
    v_mul_f32 v67, v67, v110
    v_mfma_f32_16x16x32_bf16 v[176:179], v[48:51], a[148:151], v[176:179]
    ds_read_b64_tr_b16 v[46:47], v11 offset:33792
    v_mul_f32 v68, v68, v110
    v_mfma_f32_16x16x32_bf16 v[208:211], v[48:51], a[152:155], v[208:211]
    ds_read_b128 a[164:167], v30 offset:2048
    v_mul_f32 v69, v69, v110
    v_mfma_f32_16x16x32_bf16 v[240:243], v[48:51], a[156:159], v[240:243]
    ds_read_b128 a[168:171], v30 offset:4096
    v_mul_f32 v70, v70, v110
    v_mfma_f32_16x16x32_bf16 v[148:151], v[52:55], a[144:147], v[148:151]
    ds_read_b64_tr_b16 v[48:49], v12 offset:32768
    v_mul_f32 v71, v71, v110
    v_mfma_f32_16x16x32_bf16 v[180:183], v[52:55], a[148:151], v[180:183]
    ds_read_b64_tr_b16 v[50:51], v12 offset:33792
    v_mul_f32 v72, v72, v110
    v_mfma_f32_16x16x32_bf16 v[212:215], v[52:55], a[152:155], v[212:215]
    ds_read_b128 a[172:175], v30 offset:6144
    v_mul_f32 v73, v73, v110
    buffer_load_dword v3, v4, s[36:39], s67 offen sc0 sc1
    v_mfma_f32_16x16x32_bf16 v[244:247], v[52:55], a[156:159], v[244:247]
    buffer_load_dwordx4 v20, s[16:19], s98 offen offset:0   lds
    v_mfma_f32_16x16x32_bf16 v[152:155], v[56:59], a[144:147], v[152:155]
    ds_read_b64_tr_b16 v[52:53], v13 offset:32768
    v_mul_f32 v74, v74, v110
    v_mfma_f32_16x16x32_bf16 v[184:187], v[56:59], a[148:151], v[184:187]
    ds_read_b64_tr_b16 v[54:55], v13 offset:33792
    v_mul_f32 v75, v75, v110
    v_mfma_f32_16x16x32_bf16 v[216:219], v[56:59], a[152:155], v[216:219]
    buffer_load_dwordx4 v21, s[16:19], s98 offen offset:1024   lds
    v_mfma_f32_16x16x32_bf16 v[248:251], v[56:59], a[156:159], v[248:251]
    v_mul_f32 v76, v76, v110
    v_mul_f32 v77, v77, v110
    v_mfma_f32_16x16x32_bf16 v[156:159], v[60:63], a[144:147], v[156:159]
    ds_read_b64_tr_b16 v[56:57], v14 offset:32768
    v_mul_f32 v78, v78, v110
    v_mfma_f32_16x16x32_bf16 v[188:191], v[60:63], a[148:151], v[188:191]
    ds_read_b64_tr_b16 v[58:59], v14 offset:33792
    v_mul_f32 v79, v79, v110
    v_mfma_f32_16x16x32_bf16 v[220:223], v[60:63], a[152:155], v[220:223]
    buffer_load_dwordx4 v22, s[16:19], s98 offen offset:2048   lds
    v_mfma_f32_16x16x32_bf16 v[252:255], v[60:63], a[156:159], v[252:255]
    s_waitcnt lgkmcnt(5)
    v_mfma_f32_16x16x32_bf16 v[128:131], v[32:35], a[160:163], v[128:131]
    ds_read_b64_tr_b16 v[60:61], v15 offset:32768
    v_and_b32 v96, 31, v2
    v_mfma_f32_16x16x32_bf16 v[160:163], v[32:35], a[164:167], v[160:163]
    ds_read_b64_tr_b16 v[62:63], v15 offset:33792
    v_lshlrev_b32 v96, 4, v96
    v_mfma_f32_16x16x32_bf16 v[192:195], v[32:35], a[168:171], v[192:195]
    s_waitcnt lgkmcnt(5)
    ds_read_b128 a[176:179], v31 offset:0
    v_lshrrev_b32 v97, 5, v2
    v_mfma_f32_16x16x32_bf16 v[224:227], v[32:35], a[172:175], v[224:227]
    ds_read_b128 a[180:183], v31 offset:2048
    v_lshl_add_u32 v96, v97, 11, v96
    v_mfma_f32_16x16x32_bf16 v[132:135], v[36:39], a[160:163], v[132:135]
    ds_read_b64_tr_b16 v[32:33], v8 offset:40960
    v_mfma_f32_16x16x32_bf16 v[164:167], v[36:39], a[164:167], v[164:167]
    ds_read_b64_tr_b16 v[34:35], v8 offset:41984
    v_mfma_f32_16x16x32_bf16 v[196:199], v[36:39], a[168:171], v[196:199]
    ds_read_b128 a[184:187], v31 offset:4096
    v_mfma_f32_16x16x32_bf16 v[228:231], v[36:39], a[172:175], v[228:231]
    ds_read_b128 a[188:191], v31 offset:6144
    v_mfma_f32_16x16x32_bf16 v[136:139], v[40:43], a[160:163], v[136:139]
    ds_read_b64_tr_b16 v[36:37], v9 offset:40960
    v_mfma_f32_16x16x32_bf16 v[168:171], v[40:43], a[164:167], v[168:171]
    ds_read_b64_tr_b16 v[38:39], v9 offset:41984
    v_mfma_f32_16x16x32_bf16 v[200:203], v[40:43], a[168:171], v[200:203]
    buffer_load_dwordx4 v23, s[16:19], s98 offen offset:3072   lds
    v_mfma_f32_16x16x32_bf16 v[232:235], v[40:43], a[172:175], v[232:235]
    v_mfma_f32_16x16x32_bf16 v[140:143], v[44:47], a[160:163], v[140:143]
    s_add_u32 m0, s62, 32768
    s_xor_b32 s98, s96, 896
    ds_read_b64_tr_b16 v[40:41], v10 offset:40960
    v_mfma_f32_16x16x32_bf16 v[172:175], v[44:47], a[164:167], v[172:175]
    ds_read_b64_tr_b16 v[42:43], v10 offset:41984
    v_mfma_f32_16x16x32_bf16 v[204:207], v[44:47], a[168:171], v[204:207]
    buffer_load_dwordx4 v16, s[12:15], s98 offen offset:0   lds
    v_mfma_f32_16x16x32_bf16 v[236:239], v[44:47], a[172:175], v[236:239]
    v_mfma_f32_16x16x32_bf16 v[144:147], v[48:51], a[160:163], v[144:147]
    ds_read_b64_tr_b16 v[44:45], v11 offset:40960
    v_mfma_f32_16x16x32_bf16 v[176:179], v[48:51], a[164:167], v[176:179]
    ds_read_b64_tr_b16 v[46:47], v11 offset:41984
    v_mfma_f32_16x16x32_bf16 v[208:211], v[48:51], a[168:171], v[208:211]
    buffer_load_dwordx4 v17, s[12:15], s98 offen offset:1024   lds
    v_mfma_f32_16x16x32_bf16 v[240:243], v[48:51], a[172:175], v[240:243]
    s_waitcnt lgkmcnt(4)
    v_mfma_f32_16x16x32_bf16 v[148:151], v[52:55], a[160:163], v[148:151]
    ds_read_b64_tr_b16 v[48:49], v12 offset:40960
    v_mfma_f32_16x16x32_bf16 v[180:183], v[52:55], a[164:167], v[180:183]
    ds_read_b64_tr_b16 v[50:51], v12 offset:41984
    v_mfma_f32_16x16x32_bf16 v[212:215], v[52:55], a[168:171], v[212:215]
    buffer_load_dwordx4 v18, s[12:15], s98 offen offset:2048   lds
    v_mfma_f32_16x16x32_bf16 v[244:247], v[52:55], a[172:175], v[244:247]
    v_mfma_f32_16x16x32_bf16 v[152:155], v[56:59], a[160:163], v[152:155]
    ds_read_b64_tr_b16 v[52:53], v13 offset:40960
    v_mfma_f32_16x16x32_bf16 v[184:187], v[56:59], a[164:167], v[184:187]
    ds_read_b64_tr_b16 v[54:55], v13 offset:41984
    v_mfma_f32_16x16x32_bf16 v[216:219], v[56:59], a[168:171], v[216:219]
    buffer_load_dwordx4 v19, s[12:15], s98 offen offset:3072   lds
    v_mfma_f32_16x16x32_bf16 v[248:251], v[56:59], a[172:175], v[248:251]
    v_mfma_f32_16x16x32_bf16 v[156:159], v[60:63], a[160:163], v[156:159]
    s_add_u32 m0, s62, 36864
    s_xor_b32 s98, s96, 33664
    ds_read_b64_tr_b16 v[56:57], v14 offset:40960
    v_mfma_f32_16x16x32_bf16 v[188:191], v[60:63], a[164:167], v[188:191]
    ds_read_b64_tr_b16 v[58:59], v14 offset:41984
    v_mfma_f32_16x16x32_bf16 v[220:223], v[60:63], a[168:171], v[220:223]
    buffer_load_dwordx4 v16, s[12:15], s98 offen offset:0   lds
    v_mfma_f32_16x16x32_bf16 v[252:255], v[60:63], a[172:175], v[252:255]
    v_mfma_f32_16x16x32_bf16 v[128:131], v[32:35], a[176:179], v[128:131]
    ds_read_b64_tr_b16 v[60:61], v15 offset:40960
    v_mfma_f32_16x16x32_bf16 v[160:163], v[32:35], a[180:183], v[160:163]
    ds_read_b64_tr_b16 v[62:63], v15 offset:41984
    v_mfma_f32_16x16x32_bf16 v[192:195], v[32:35], a[184:187], v[192:195]
    buffer_load_dwordx4 v17, s[12:15], s98 offen offset:1024   lds
    v_mfma_f32_16x16x32_bf16 v[224:227], v[32:35], a[188:191], v[224:227]
    v_mfma_f32_16x16x32_bf16 v[132:135], v[36:39], a[176:179], v[132:135]
    buffer_load_dwordx4 v18, s[12:15], s98 offen offset:2048   lds
    v_mfma_f32_16x16x32_bf16 v[164:167], v[36:39], a[180:183], v[164:167]
    v_mfma_f32_16x16x32_bf16 v[196:199], v[36:39], a[184:187], v[196:199]
    buffer_load_dwordx4 v19, s[12:15], s98 offen offset:3072   lds
    v_mfma_f32_16x16x32_bf16 v[228:231], v[36:39], a[188:191], v[228:231]
    s_waitcnt lgkmcnt(2)
    s_waitcnt vmcnt(12)
    v_cmp_le_u32 vcc, s68, v3
    s_cmp_eq_u64 vcc, -1
    s_cbranch_scc0 L_E_slow_1
L_E_ok_2:
    v_mfma_f32_16x16x32_bf16 v[136:139], v[40:43], a[176:179], v[136:139]
    s_waitcnt lgkmcnt(0)
    s_barrier
    v_mfma_f32_16x16x32_bf16 v[168:171], v[40:43], a[180:183], v[168:171]
    s_add_u32 m0, s62, 65536
    s_xor_b32 s98, s64, 0
    ds_read_b64_tr_b16 v[32:33], v8 offset:0
    v_mfma_f32_16x16x32_bf16 v[200:203], v[40:43], a[184:187], v[200:203]
    ds_read_b64_tr_b16 v[34:35], v8 offset:1024
    v_mov_b32 v18, v106
    v_mfma_f32_16x16x32_bf16 v[232:235], v[40:43], a[188:191], v[232:235]
    ds_read_b64_tr_b16 v[36:37], v9 offset:0
    v_mov_b32 v19, v107
    v_mfma_f32_16x16x32_bf16 v[140:143], v[44:47], a[176:179], v[140:143]
    ds_read_b64_tr_b16 v[38:39], v9 offset:1024
    v_mfma_f32_16x16x32_bf16 v[172:175], v[44:47], a[180:183], v[172:175]
    ds_read_b64_tr_b16 v[40:41], v10 offset:0
    v_mfma_f32_16x16x32_bf16 v[204:207], v[44:47], a[184:187], v[204:207]
    ds_read_b64_tr_b16 v[42:43], v10 offset:1024
    v_mfma_f32_16x16x32_bf16 v[236:239], v[44:47], a[188:191], v[236:239]
    ds_read_b128 a[192:195], v28 offset:0
    v_mfma_f32_16x16x32_bf16 v[144:147], v[48:51], a[176:179], v[144:147]
    ds_read_b64_tr_b16 v[44:45], v11 offset:0
    v_mfma_f32_16x16x32_bf16 v[176:179], v[48:51], a[180:183], v[176:179]
    ds_read_b64_tr_b16 v[46:47], v11 offset:1024
    v_mfma_f32_16x16x32_bf16 v[208:211], v[48:51], a[184:187], v[208:211]
    ds_read_b128 a[196:199], v28 offset:2048
    v_mfma_f32_16x16x32_bf16 v[240:243], v[48:51], a[188:191], v[240:243]
    ds_read_b128 a[200:203], v28 offset:4096
    v_mfma_f32_16x16x32_bf16 v[148:151], v[52:55], a[176:179], v[148:151]
    ds_read_b64_tr_b16 v[48:49], v12 offset:0
    v_mfma_f32_16x16x32_bf16 v[180:183], v[52:55], a[180:183], v[180:183]
    ds_read_b64_tr_b16 v[50:51], v12 offset:1024
    v_mfma_f32_16x16x32_bf16 v[212:215], v[52:55], a[184:187], v[212:215]
    ds_read_b128 a[204:207], v28 offset:6144
    v_mfma_f32_16x16x32_bf16 v[244:247], v[52:55], a[188:191], v[244:247]
    buffer_load_dwordx4 v24, s[20:23], s98 offen offset:0   lds
    v_mfma_f32_16x16x32_bf16 v[152:155], v[56:59], a[176:179], v[152:155]
    ds_read_b64_tr_b16 v[52:53], v13 offset:0
    v_mfma_f32_16x16x32_bf16 v[184:187], v[56:59], a[180:183], v[184:187]
    ds_read_b64_tr_b16 v[54:55], v13 offset:1024
    v_mfma_f32_16x16x32_bf16 v[216:219], v[56:59], a[184:187], v[216:219]
    buffer_load_dwordx4 v[80:83], v96, s[8:11], s70 offen
    v_mfma_f32_16x16x32_bf16 v[248:251], v[56:59], a[188:191], v[248:251]
    buffer_load_dwordx4 v25, s[20:23], s98 offen offset:1024   lds
    v_mfma_f32_16x16x32_bf16 v[156:159], v[60:63], a[176:179], v[156:159]
    s_lshl_b32 s80, s2, 6
    s_add_u32 s80, s80, 1310720
    ds_read_b64_tr_b16 v[56:57], v14 offset:0
    v_mfma_f32_16x16x32_bf16 v[188:191], v[60:63], a[180:183], v[188:191]
    s_waitcnt lgkmcnt(6)
    s_add_u32 s70, s70, 12288
    ds_read_b64_tr_b16 v[58:59], v14 offset:1024
    v_mfma_f32_16x16x32_bf16 v[220:223], v[60:63], a[184:187], v[220:223]
    buffer_store_dword v6, v7, s[8:11], s80 offen sc0 sc1
    v_mfma_f32_16x16x32_bf16 v[252:255], v[60:63], a[188:191], v[252:255]
    buffer_load_dwordx4 v26, s[20:23], s98 offen offset:2048   lds
    v_mfma_f32_16x16x32_bf16 v[128:131], v[32:35], a[192:195], v[128:131]
    ds_read_b64_tr_b16 v[60:61], v15 offset:0
    v_mfma_f32_16x16x32_bf16 v[160:163], v[32:35], a[196:199], v[160:163]
    ds_read_b64_tr_b16 v[62:63], v15 offset:1024
    v_mfma_f32_16x16x32_bf16 v[192:195], v[32:35], a[200:203], v[192:195]
    s_waitcnt lgkmcnt(5)
    ds_read_b128 a[208:211], v29 offset:0
    v_mfma_f32_16x16x32_bf16 v[224:227], v[32:35], a[204:207], v[224:227]
    ds_read_b128 a[212:215], v29 offset:2048
    v_mfma_f32_16x16x32_bf16 v[132:135], v[36:39], a[192:195], v[132:135]
    ds_read_b64_tr_b16 v[32:33], v8 offset:8192
    v_mfma_f32_16x16x32_bf16 v[164:167], v[36:39], a[196:199], v[164:167]
    ds_read_b64_tr_b16 v[34:35], v8 offset:9216
    v_mfma_f32_16x16x32_bf16 v[196:199], v[36:39], a[200:203], v[196:199]
    ds_read_b128 a[216:219], v29 offset:4096
    v_mfma_f32_16x16x32_bf16 v[228:231], v[36:39], a[204:207], v[228:231]
    ds_read_b128 a[220:223], v29 offset:6144
    v_mfma_f32_16x16x32_bf16 v[136:139], v[40:43], a[192:195], v[136:139]
    ds_read_b64_tr_b16 v[36:37], v9 offset:8192
    v_mfma_f32_16x16x32_bf16 v[168:171], v[40:43], a[196:199], v[168:171]
    ds_read_b64_tr_b16 v[38:39], v9 offset:9216
    v_mfma_f32_16x16x32_bf16 v[200:203], v[40:43], a[200:203], v[200:203]
    buffer_load_dwordx4 v27, s[20:23], s98 offen offset:3072   lds
    v_mfma_f32_16x16x32_bf16 v[232:235], v[40:43], a[204:207], v[232:235]
    buffer_load_dwordx4 v[84:87], v96, s[8:11], s70 offen
    v_mfma_f32_16x16x32_bf16 v[140:143], v[44:47], a[192:195], v[140:143]
    s_add_u32 m0, s62, 69632
    s_xor_b32 s98, s64, 262144
    ds_read_b64_tr_b16 v[40:41], v10 offset:8192
    v_mfma_f32_16x16x32_bf16 v[172:175], v[44:47], a[196:199], v[172:175]
    s_add_u32 s70, s70, 12288
    ds_read_b64_tr_b16 v[42:43], v10 offset:9216
    v_mfma_f32_16x16x32_bf16 v[204:207], v[44:47], a[200:203], v[204:207]
    buffer_load_dwordx4 v24, s[20:23], s98 offen offset:0   lds
    v_mfma_f32_16x16x32_bf16 v[236:239], v[44:47], a[204:207], v[236:239]
    buffer_load_dwordx4 v[88:91], v96, s[8:11], s70 offen
    v_mfma_f32_16x16x32_bf16 v[144:147], v[48:51], a[192:195], v[144:147]
    s_add_u32 s70, s70, 12288
    ds_read_b64_tr_b16 v[44:45], v11 offset:8192
    v_mfma_f32_16x16x32_bf16 v[176:179], v[48:51], a[196:199], v[176:179]
    s_waitcnt lgkmcnt(5)
    ds_read_b64_tr_b16 v[46:47], v11 offset:9216
    v_mfma_f32_16x16x32_bf16 v[208:211], v[48:51], a[200:203], v[208:211]
    buffer_load_dwordx4 v25, s[20:23], s98 offen offset:1024   lds
    v_mfma_f32_16x16x32_bf16 v[240:243], v[48:51], a[204:207], v[240:243]
    buffer_load_dwordx4 v[92:95], v96, s[8:11], s70 offen
    v_mfma_f32_16x16x32_bf16 v[148:151], v[52:55], a[192:195], v[148:151]
    ds_read_b64_tr_b16 v[48:49], v12 offset:8192
    v_mfma_f32_16x16x32_bf16 v[180:183], v[52:55], a[196:199], v[180:183]
    ds_read_b64_tr_b16 v[50:51], v12 offset:9216
    v_mfma_f32_16x16x32_bf16 v[212:215], v[52:55], a[200:203], v[212:215]
    buffer_load_dwordx4 v26, s[20:23], s98 offen offset:2048   lds
    v_mfma_f32_16x16x32_bf16 v[244:247], v[52:55], a[204:207], v[244:247]
    v_mfma_f32_16x16x32_bf16 v[152:155], v[56:59], a[192:195], v[152:155]
    ds_read_b64_tr_b16 v[52:53], v13 offset:8192
    v_mfma_f32_16x16x32_bf16 v[184:187], v[56:59], a[196:199], v[184:187]
    ds_read_b64_tr_b16 v[54:55], v13 offset:9216
    v_mfma_f32_16x16x32_bf16 v[216:219], v[56:59], a[200:203], v[216:219]
    buffer_load_dwordx4 v27, s[20:23], s98 offen offset:3072   lds
    v_mfma_f32_16x16x32_bf16 v[248:251], v[56:59], a[204:207], v[248:251]
    v_mfma_f32_16x16x32_bf16 v[156:159], v[60:63], a[192:195], v[156:159]
    ds_read_b64_tr_b16 v[56:57], v14 offset:8192
    v_mfma_f32_16x16x32_bf16 v[188:191], v[60:63], a[196:199], v[188:191]
    ds_read_b64_tr_b16 v[58:59], v14 offset:9216
    v_mfma_f32_16x16x32_bf16 v[220:223], v[60:63], a[200:203], v[220:223]
    v_mfma_f32_16x16x32_bf16 v[252:255], v[60:63], a[204:207], v[252:255]
    v_mfma_f32_16x16x32_bf16 v[128:131], v[32:35], a[208:211], v[128:131]
    ds_read_b64_tr_b16 v[60:61], v15 offset:8192
    v_mfma_f32_16x16x32_bf16 v[160:163], v[32:35], a[212:215], v[160:163]
    ds_read_b64_tr_b16 v[62:63], v15 offset:9216
    v_mfma_f32_16x16x32_bf16 v[192:195], v[32:35], a[216:219], v[192:195]
    s_getpc_b64 s[100:101]
L_ct1:
    s_lshr_b32 s99, s2, 3
    s_lshl_b32 s99, s99, 2
    s_add_u32 s99, s99, s3
    s_mul_i32 s99, s99, 2
    v_min_u32 v119, 1, v2
    v_add_u32 v119, s99, v119
    v_lshlrev_b32 v119, 7, v119
    v_add_u32 v119, L_ct1-L_ct1, v119
    v_min_u32 v119, L_attn-L_ct1, v119
    global_load_dword v119, v119, s[100:101]
    v_mfma_f32_16x16x32_bf16 v[224:227], v[32:35], a[220:223], v[224:227]
    s_waitcnt lgkmcnt(4)
    v_mfma_f32_16x16x32_bf16 v[132:135], v[36:39], a[208:211], v[132:135]
    v_mfma_f32_16x16x32_bf16 v[164:167], v[36:39], a[212:215], v[164:167]
    v_mfma_f32_16x16x32_bf16 v[196:199], v[36:39], a[216:219], v[196:199]
    v_mfma_f32_16x16x32_bf16 v[228:231], v[36:39], a[220:223], v[228:231]
    v_mfma_f32_16x16x32_bf16 v[136:139], v[40:43], a[208:211], v[136:139]
    s_waitcnt vmcnt(14) lgkmcnt(0)
    s_barrier
    v_mfma_f32_16x16x32_bf16 v[168:171], v[40:43], a[212:215], v[168:171]
    s_add_u32 m0, s62, 0
    s_xor_b32 s98, s64, 2097152
    ds_read_b64_tr_b16 v[32:33], v8 offset:16384
    v_mfma_f32_16x16x32_bf16 v[200:203], v[40:43], a[216:219], v[200:203]
    ds_read_b64_tr_b16 v[34:35], v8 offset:17408
    v_mfma_f32_16x16x32_bf16 v[232:235], v[40:43], a[220:223], v[232:235]
    ds_read_b64_tr_b16 v[36:37], v9 offset:16384
    v_mfma_f32_16x16x32_bf16 v[140:143], v[44:47], a[208:211], v[140:143]
    ds_read_b64_tr_b16 v[38:39], v9 offset:17408
    v_mfma_f32_16x16x32_bf16 v[172:175], v[44:47], a[212:215], v[172:175]
    ds_read_b64_tr_b16 v[40:41], v10 offset:16384
    v_mfma_f32_16x16x32_bf16 v[204:207], v[44:47], a[216:219], v[204:207]
    ds_read_b64_tr_b16 v[42:43], v10 offset:17408
    v_mfma_f32_16x16x32_bf16 v[236:239], v[44:47], a[220:223], v[236:239]
    ds_read_b128 a[224:227], v28 offset:32768
    v_mfma_f32_16x16x32_bf16 v[144:147], v[48:51], a[208:211], v[144:147]
    ds_read_b64_tr_b16 v[44:45], v11 offset:16384
    v_mfma_f32_16x16x32_bf16 v[176:179], v[48:51], a[212:215], v[176:179]
    ds_read_b64_tr_b16 v[46:47], v11 offset:17408
    v_mfma_f32_16x16x32_bf16 v[208:211], v[48:51], a[216:219], v[208:211]
    ds_read_b128 a[228:231], v28 offset:34816
    v_mfma_f32_16x16x32_bf16 v[240:243], v[48:51], a[220:223], v[240:243]
    ds_read_b128 a[232:235], v28 offset:36864
    v_mfma_f32_16x16x32_bf16 v[148:151], v[52:55], a[208:211], v[148:151]
    ds_read_b64_tr_b16 v[48:49], v12 offset:16384
    v_mfma_f32_16x16x32_bf16 v[180:183], v[52:55], a[212:215], v[180:183]
    ds_read_b64_tr_b16 v[50:51], v12 offset:17408
    v_mfma_f32_16x16x32_bf16 v[212:215], v[52:55], a[216:219], v[212:215]
    ds_read_b128 a[236:239], v28 offset:38912
    v_mfma_f32_16x16x32_bf16 v[244:247], v[52:55], a[220:223], v[244:247]
    buffer_load_dwordx4 v24, s[20:23], s98 offen offset:0   lds
    v_mfma_f32_16x16x32_bf16 v[152:155], v[56:59], a[208:211], v[152:155]
    ds_read_b64_tr_b16 v[52:53], v13 offset:16384
    v_mfma_f32_16x16x32_bf16 v[184:187], v[56:59], a[212:215], v[184:187]
    ds_read_b64_tr_b16 v[54:55], v13 offset:17408
    v_mfma_f32_16x16x32_bf16 v[216:219], v[56:59], a[216:219], v[216:219]
    v_mfma_f32_16x16x32_bf16 v[248:251], v[56:59], a[220:223], v[248:251]
    buffer_load_dwordx4 v25, s[20:23], s98 offen offset:1024   lds
    v_mfma_f32_16x16x32_bf16 v[156:159], v[60:63], a[208:211], v[156:159]
    ds_read_b64_tr_b16 v[56:57], v14 offset:16384
    v_mfma_f32_16x16x32_bf16 v[188:191], v[60:63], a[212:215], v[188:191]
    ds_read_b64_tr_b16 v[58:59], v14 offset:17408
    v_mfma_f32_16x16x32_bf16 v[220:223], v[60:63], a[216:219], v[220:223]
    s_waitcnt lgkmcnt(6)
    v_mfma_f32_16x16x32_bf16 v[252:255], v[60:63], a[220:223], v[252:255]
    buffer_load_dwordx4 v26, s[20:23], s98 offen offset:2048   lds
    v_mfma_f32_16x16x32_bf16 v[128:131], v[32:35], a[224:227], v[128:131]
    ds_read_b64_tr_b16 v[60:61], v15 offset:16384
    v_mfma_f32_16x16x32_bf16 v[160:163], v[32:35], a[228:231], v[160:163]
    ds_read_b64_tr_b16 v[62:63], v15 offset:17408
    v_mfma_f32_16x16x32_bf16 v[192:195], v[32:35], a[232:235], v[192:195]
    s_waitcnt lgkmcnt(5)
    ds_read_b128 a[240:243], v29 offset:32768
    v_mfma_f32_16x16x32_bf16 v[224:227], v[32:35], a[236:239], v[224:227]
    ds_read_b128 a[244:247], v29 offset:34816
    v_mfma_f32_16x16x32_bf16 v[132:135], v[36:39], a[224:227], v[132:135]
    ds_read_b64_tr_b16 v[32:33], v8 offset:24576
    v_mfma_f32_16x16x32_bf16 v[164:167], v[36:39], a[228:231], v[164:167]
    ds_read_b64_tr_b16 v[34:35], v8 offset:25600
    s_waitcnt vmcnt(10)
    v_add_f32 v80, v80, v84
    s_waitcnt vmcnt(6)
    v_add_f32 v88, v88, v92
    v_mfma_f32_16x16x32_bf16 v[196:199], v[36:39], a[232:235], v[196:199]
    ds_read_b128 a[248:251], v29 offset:36864
    v_add_f32 v81, v81, v85
    v_add_f32 v89, v89, v93
    v_mfma_f32_16x16x32_bf16 v[228:231], v[36:39], a[236:239], v[228:231]
    ds_read_b128 a[252:255], v29 offset:38912
    v_add_f32 v82, v82, v86
    v_add_f32 v90, v90, v94
    v_mfma_f32_16x16x32_bf16 v[136:139], v[40:43], a[224:227], v[136:139]
    ds_read_b64_tr_b16 v[36:37], v9 offset:24576
    v_and_b32 v16, 15, v2
    v_add_f32 v83, v83, v87
    v_mfma_f32_16x16x32_bf16 v[168:171], v[40:43], a[228:231], v[168:171]
    ds_read_b64_tr_b16 v[38:39], v9 offset:25600
    v_lshrrev_b32 v17, 4, v2
    v_add_f32 v91, v91, v95
    v_mfma_f32_16x16x32_bf16 v[200:203], v[40:43], a[232:235], v[200:203]
    v_lshrrev_b32 v29, 2, v16
    v_and_b32 v16, 3, v16
    v_add_f32 v80, v80, v88
    v_mfma_f32_16x16x32_bf16 v[232:235], v[40:43], a[236:239], v[232:235]
    buffer_load_dwordx4 v27, s[20:23], s98 offen offset:3072   lds
    v_add_f32 v81, v81, v89
    v_mfma_f32_16x16x32_bf16 v[140:143], v[44:47], a[224:227], v[140:143]
    s_add_u32 m0, s62, 4096
    ds_read_b64_tr_b16 v[40:41], v10 offset:24576
    v_lshl_add_u32 v28, v17, 3, v29
    v_add_f32 v82, v82, v90
    v_mfma_f32_16x16x32_bf16 v[172:175], v[44:47], a[228:231], v[172:175]
    s_xor_b32 s98, s64, 2359296
    ds_read_b64_tr_b16 v[42:43], v10 offset:25600
    v_lshlrev_b32 v28, 7, v28
    v_add_f32 v83, v83, v91
    v_mfma_f32_16x16x32_bf16 v[204:207], v[44:47], a[232:235], v[204:207]
    v_lshl_add_u32 v28, v16, 3, v28
    v_and_b32 v17, 1, v17
    v_lshrrev_b32 v88, 5, v2
    v_mfma_f32_16x16x32_bf16 v[236:239], v[44:47], a[236:239], v[236:239]
    buffer_load_dwordx4 v24, s[20:23], s98 offen offset:0   lds
    v_cvt_f32_u32 v88, v88
    v_mfma_f32_16x16x32_bf16 v[144:147], v[48:51], a[224:227], v[144:147]
    ds_read_b64_tr_b16 v[44:45], v11 offset:24576
    v_lshrrev_b32 v29, 1, v29
    v_cvt_pk_bf16_f32 v84, v80, v81
    v_mfma_f32_16x16x32_bf16 v[176:179], v[48:51], a[228:231], v[176:179]
    ds_read_b64_tr_b16 v[46:47], v11 offset:25600
    v_lshl_add_u32 v29, v17, 1, v29
    v_cvt_pk_bf16_f32 v85, v82, v83
    v_mfma_f32_16x16x32_bf16 v[208:211], v[48:51], a[232:235], v[208:211]
    s_waitcnt lgkmcnt(5)
    v_lshl_add_u32 v28, v29, 5, v28
    v_add_u32 v28, 65536, v28
    v_lshlrev_b32 v80, 16, v84
    v_mfma_f32_16x16x32_bf16 v[240:243], v[48:51], a[236:239], v[240:243]
    buffer_load_dwordx4 v25, s[20:23], s98 offen offset:1024   lds
    v_and_b32 v81, 0xffff0000, v84
    v_mfma_f32_16x16x32_bf16 v[148:151], v[52:55], a[224:227], v[148:151]
    ds_read_b64_tr_b16 v[48:49], v12 offset:24576
    v_xor_b32 v29, 32, v28
    v_lshlrev_b32 v82, 16, v85
    v_mfma_f32_16x16x32_bf16 v[180:183], v[52:55], a[228:231], v[180:183]
    ds_read_b64_tr_b16 v[50:51], v12 offset:25600
    v_xor_b32 v30, 64, v28
    v_and_b32 v83, 0xffff0000, v85
    v_mfma_f32_16x16x32_bf16 v[212:215], v[52:55], a[232:235], v[212:215]
    v_xor_b32 v31, 96, v28
    v_and_b32 v16, 15, v2
    v_add_f32 v80, v80, v88
    v_mfma_f32_16x16x32_bf16 v[244:247], v[52:55], a[236:239], v[244:247]
    buffer_load_dwordx4 v26, s[20:23], s98 offen offset:2048   lds
    v_add_f32 v81, v81, v88
    v_mfma_f32_16x16x32_bf16 v[152:155], v[56:59], a[224:227], v[152:155]
    ds_read_b64_tr_b16 v[52:53], v13 offset:24576
    v_lshlrev_b32 v16, 6, v16
    v_add_f32 v82, v82, v88
    v_mfma_f32_16x16x32_bf16 v[184:187], v[56:59], a[228:231], v[184:187]
    ds_read_b64_tr_b16 v[54:55], v13 offset:25600
    v_add_u32 v16, 65536, v16
    v_add_f32 v83, v83, v88
    v_mfma_f32_16x16x32_bf16 v[216:219], v[56:59], a[232:235], v[216:219]
    v_mad_i32_i24 v16, v17, s77, v16
    v_and_b32 v17, 31, v2
    v_cvt_pk_bf16_f32 v84, v80, v81
    v_mfma_f32_16x16x32_bf16 v[248:251], v[56:59], a[236:239], v[248:251]
    buffer_load_dwordx4 v27, s[20:23], s98 offen offset:3072   lds
    v_cvt_pk_bf16_f32 v85, v82, v83
    v_mfma_f32_16x16x32_bf16 v[156:159], v[60:63], a[224:227], v[156:159]
    ds_read_b64_tr_b16 v[56:57], v14 offset:24576
    v_lshlrev_b32 v17, 6, v17
    v_lshlrev_b32 v80, 16, v84
    v_mfma_f32_16x16x32_bf16 v[188:191], v[60:63], a[228:231], v[188:191]
    ds_read_b64_tr_b16 v[58:59], v14 offset:25600
    v_and_b32 v81, 0xffff0000, v84
    v_lshlrev_b32 v82, 16, v85
    v_mfma_f32_16x16x32_bf16 v[220:223], v[60:63], a[232:235], v[220:223]
    v_and_b32 v83, 0xffff0000, v85
    v_mul_f32 v80, 0x3e0293ee, v80
    v_mul_f32 v81, 0x3e0293ee, v81
    v_mfma_f32_16x16x32_bf16 v[252:255], v[60:63], a[236:239], v[252:255]
    v_mul_f32 v82, 0x3e0293ee, v82
    v_mul_f32 v83, 0x3e0293ee, v83
    v_mfma_f32_16x16x32_bf16 v[128:131], v[32:35], a[240:243], v[128:131]
    s_lshl_b32 s70, s3, 10
    s_add_u32 s70, s70, 151552
    ds_read_b64_tr_b16 v[60:61], v15 offset:24576
    v_add_u32 v88, s70, v1
    v_add_u32 v18, s70, v18
    v_mfma_f32_16x16x32_bf16 v[160:163], v[32:35], a[244:247], v[160:163]
    ds_read_b64_tr_b16 v[62:63], v15 offset:25600
    ds_write_b128 v88, v[80:83]
    v_mfma_f32_16x16x32_bf16 v[192:195], v[32:35], a[248:251], v[192:195]
    v_mfma_f32_16x16x32_bf16 v[224:227], v[32:35], a[252:255], v[224:227]
    s_waitcnt lgkmcnt(5)
    v_mfma_f32_16x16x32_bf16 v[132:135], v[36:39], a[240:243], v[132:135]
    v_mfma_f32_16x16x32_bf16 v[164:167], v[36:39], a[244:247], v[164:167]
    v_mfma_f32_16x16x32_bf16 v[196:199], v[36:39], a[248:251], v[196:199]
    v_mfma_f32_16x16x32_bf16 v[228:231], v[36:39], a[252:255], v[228:231]
    ds_read_b128 v[80:83], v18 offset:0
    v_mfma_f32_16x16x32_bf16 v[136:139], v[40:43], a[240:243], v[136:139]
    ds_read_b128 v[84:87], v18 offset:16
    s_waitcnt vmcnt(9) lgkmcnt(0)
    s_barrier
    v_mfma_f32_16x16x32_bf16 v[168:171], v[40:43], a[244:247], v[168:171]
    s_add_u32 m0, s62, 32768
    s_xor_b32 s98, s64, 128
    ds_read_b64_tr_b16 v[32:33], v28 offset:0
    v_mfma_f32_16x16x32_bf16 v[200:203], v[40:43], a[248:251], v[200:203]
    ds_read_b64_tr_b16 v[34:35], v28 offset:512
    v_mfma_f32_16x16x32_bf16 v[232:235], v[40:43], a[252:255], v[232:235]
    ds_read_b64_tr_b16 v[36:37], v28 offset:4096
    v_mfma_f32_16x16x32_bf16 v[140:143], v[44:47], a[240:243], v[140:143]
    ds_read_b64_tr_b16 v[38:39], v28 offset:4608
    v_mfma_f32_16x16x32_bf16 v[172:175], v[44:47], a[244:247], v[172:175]
    ds_read_b64_tr_b16 v[40:41], v28 offset:8192
    v_mfma_f32_16x16x32_bf16 v[204:207], v[44:47], a[248:251], v[204:207]
    ds_read_b64_tr_b16 v[42:43], v28 offset:8704
    v_mfma_f32_16x16x32_bf16 v[236:239], v[44:47], a[252:255], v[236:239]
    buffer_load_dwordx4 v24, s[20:23], s98 offen offset:0   lds
    v_mfma_f32_16x16x32_bf16 v[144:147], v[48:51], a[240:243], v[144:147]
    ds_read_b64_tr_b16 v[44:45], v28 offset:12288
    v_mfma_f32_16x16x32_bf16 v[176:179], v[48:51], a[244:247], v[176:179]
    ds_read_b64_tr_b16 v[46:47], v28 offset:12800
    v_mfma_f32_16x16x32_bf16 v[208:211], v[48:51], a[248:251], v[208:211]
    ds_read_b128 v[88:91], v18 offset:512
    v_mfma_f32_16x16x32_bf16 v[240:243], v[48:51], a[252:255], v[240:243]
    buffer_load_dwordx4 v25, s[20:23], s98 offen offset:1024   lds
    v_mfma_f32_16x16x32_bf16 v[148:151], v[52:55], a[240:243], v[148:151]
    ds_read_b64_tr_b16 v[48:49], v29 offset:0
    v_mfma_f32_16x16x32_bf16 v[180:183], v[52:55], a[244:247], v[180:183]
    ds_read_b64_tr_b16 v[50:51], v29 offset:512
    v_mfma_f32_16x16x32_bf16 v[212:215], v[52:55], a[248:251], v[212:215]
    ds_read_b128 v[92:95], v18 offset:528
    v_mfma_f32_16x16x32_bf16 v[244:247], v[52:55], a[252:255], v[244:247]
    buffer_load_dwordx4 v26, s[20:23], s98 offen offset:2048   lds
    v_mfma_f32_16x16x32_bf16 v[152:155], v[56:59], a[240:243], v[152:155]
    ds_read_b64_tr_b16 v[52:53], v29 offset:4096
    v_mfma_f32_16x16x32_bf16 v[184:187], v[56:59], a[244:247], v[184:187]
    ds_read_b64_tr_b16 v[54:55], v29 offset:4608
    v_mfma_f32_16x16x32_bf16 v[216:219], v[56:59], a[248:251], v[216:219]
    v_mfma_f32_16x16x32_bf16 v[248:251], v[56:59], a[252:255], v[248:251]
    buffer_load_dwordx4 v27, s[20:23], s98 offen offset:3072   lds
    v_mfma_f32_16x16x32_bf16 v[156:159], v[60:63], a[240:243], v[156:159]
    s_add_u32 m0, s62, 36864
    s_xor_b32 s98, s64, 262272
    ds_read_b64_tr_b16 v[56:57], v29 offset:8192
    v_mfma_f32_16x16x32_bf16 v[188:191], v[60:63], a[244:247], v[188:191]
    ds_read_b64_tr_b16 v[58:59], v29 offset:8704
    s_waitcnt lgkmcnt(7)
    v_fma_f32 v64, v64, v88, v80
    v_mfma_f32_16x16x32_bf16 v[220:223], v[60:63], a[248:251], v[220:223]
    v_fma_f32 v65, v65, v89, v81
    v_fma_f32 v66, v66, v90, v82
    v_mfma_f32_16x16x32_bf16 v[252:255], v[60:63], a[252:255], v[252:255]
    buffer_load_dwordx4 v24, s[20:23], s98 offen offset:0   lds
    v_mfma_f32_16x16x32_bf16 v[96:99], a[0:3], v[32:35], 0
    ds_read_b64_tr_b16 v[60:61], v29 offset:12288
    v_fma_f32 v67, v67, v91, v83
    v_mfma_f32_16x16x32_bf16 v[96:99], a[16:19], v[36:39], v[96:99]
    ds_read_b64_tr_b16 v[62:63], v29 offset:12800
    s_waitcnt lgkmcnt(6)
    v_fma_f32 v68, v68, v92, v84
    v_mfma_f32_16x16x32_bf16 v[96:99], a[32:35], v[40:43], v[96:99]
    v_fma_f32 v69, v69, v93, v85
    v_fma_f32 v70, v70, v94, v86
    v_mfma_f32_16x16x32_bf16 v[96:99], a[48:51], v[44:47], v[96:99]
    buffer_load_dwordx4 v25, s[20:23], s98 offen offset:1024   lds
    v_mfma_f32_16x16x32_bf16 v[100:103], a[4:7], v[32:35], 0
    v_fma_f32 v71, v71, v95, v87
    v_mfma_f32_16x16x32_bf16 v[100:103], a[20:23], v[36:39], v[100:103]
    v_cvt_pk_bf16_f32 v64, v64, v65
    v_cvt_pk_bf16_f32 v65, v66, v67
    v_mfma_f32_16x16x32_bf16 v[100:103], a[36:39], v[40:43], v[100:103]
    v_cvt_pk_bf16_f32 v66, v68, v69
    v_cvt_pk_bf16_f32 v67, v70, v71
    v_mfma_f32_16x16x32_bf16 v[100:103], a[52:55], v[44:47], v[100:103]
    buffer_load_dwordx4 v26, s[20:23], s98 offen offset:2048   lds
    v_mfma_f32_16x16x32_bf16 v[104:107], a[8:11], v[32:35], 0
    buffer_store_dwordx4 v[64:67], v19, s[8:11], s71 offen offset:0 sc0 sc1
    v_mfma_f32_16x16x32_bf16 v[104:107], a[24:27], v[36:39], v[104:107]
    ds_read_b128 v[80:83], v18 offset:256
    v_cvt_pk_bf16_f32 v128, v128, v129
    v_mfma_f32_16x16x32_bf16 v[104:107], a[40:43], v[40:43], v[104:107]
    ds_read_b128 v[84:87], v18 offset:272
    v_cvt_pk_bf16_f32 v129, v130, v131
    v_mfma_f32_16x16x32_bf16 v[104:107], a[56:59], v[44:47], v[104:107]
    buffer_load_dwordx4 v27, s[20:23], s98 offen offset:3072   lds
    v_mfma_f32_16x16x32_bf16 v[108:111], a[12:15], v[32:35], 0
    ds_read_b128 v[88:91], v18 offset:768
    v_cvt_pk_bf16_f32 v130, v132, v133
    v_mfma_f32_16x16x32_bf16 v[108:111], a[28:31], v[36:39], v[108:111]
    s_add_u32 m0, s63, 131072
    s_xor_b32 s98, s0, 0
    ds_read_b64_tr_b16 v[32:33], v28 offset:16384
    v_mfma_f32_16x16x32_bf16 v[108:111], a[44:47], v[40:43], v[108:111]
    ds_read_b64_tr_b16 v[34:35], v28 offset:16896
    v_cvt_pk_bf16_f32 v131, v134, v135
    v_mfma_f32_16x16x32_bf16 v[108:111], a[60:63], v[44:47], v[108:111]
    s_xor_b32 s79, s65, 0
    ds_read_b64_tr_b16 v[36:37], v28 offset:20480
    v_mfma_f32_16x16x32_bf16 v[112:115], a[0:3], v[48:51], 0
    s_waitcnt lgkmcnt(6)
    ds_read_b64_tr_b16 v[38:39], v28 offset:20992
    v_mfma_f32_16x16x32_bf16 v[112:115], a[16:19], v[52:55], v[112:115]
    ds_read_b64_tr_b16 v[40:41], v28 offset:24576
    v_mfma_f32_16x16x32_bf16 v[112:115], a[32:35], v[56:59], v[112:115]
    ds_read_b64_tr_b16 v[42:43], v28 offset:25088
    v_mfma_f32_16x16x32_bf16 v[112:115], a[48:51], v[60:63], v[112:115]
    s_waitcnt vmcnt(17)
    ds_read_b64_tr_b16 v[44:45], v28 offset:28672
    v_mfma_f32_16x16x32_bf16 v[116:119], a[4:7], v[48:51], 0
    s_lshr_b32 s100, s2, 3
    s_mul_i32 s66, s4, 28
    ds_read_b64_tr_b16 v[46:47], v28 offset:29184
    v_mfma_f32_16x16x32_bf16 v[116:119], a[20:23], v[52:55], v[116:119]
    buffer_load_dwordx4 v20, s[24:27], s98 offen offset:0   lds
    v_mfma_f32_16x16x32_bf16 v[116:119], a[36:39], v[56:59], v[116:119]
    s_add_u32 s66, s66, s100
    s_cmp_lt_u32 s100, 28
    s_cselect_b32 s66, s66, 255
    ds_read_b128 v[92:95], v18 offset:784
    v_mfma_f32_16x16x32_bf16 v[116:119], a[52:55], v[60:63], v[116:119]
    buffer_store_dwordx4 v[128:131], v1, s[8:11], s79 offen offset:0 sc0 sc1
    v_mfma_f32_16x16x32_bf16 v[120:123], a[8:11], v[48:51], 0
    s_lshl_b32 s67, s4, 3
    s_add_u32 s67, s67, s100
    s_sub_u32 s67, s67, 24
    v_mfma_f32_16x16x32_bf16 v[120:123], a[24:27], v[52:55], v[120:123]
    buffer_load_dwordx4 v21, s[24:27], s98 offen offset:1024   lds
    v_mfma_f32_16x16x32_bf16 v[120:123], a[40:43], v[56:59], v[120:123]
    s_cmp_ge_u32 s100, 24
    s_cselect_b32 s67, s67, 255
    v_cvt_pk_bf16_f32 v136, v136, v137
    v_cvt_pk_bf16_f32 v137, v138, v139
    v_mfma_f32_16x16x32_bf16 v[120:123], a[56:59], v[60:63], v[120:123]
    v_cvt_pk_bf16_f32 v138, v140, v141
    v_cvt_pk_bf16_f32 v139, v142, v143
    v_mfma_f32_16x16x32_bf16 v[124:127], a[12:15], v[48:51], 0
    v_mfma_f32_16x16x32_bf16 v[124:127], a[28:31], v[52:55], v[124:127]
    s_xor_b32 s79, s65, 0
    ds_read_b64_tr_b16 v[48:49], v29 offset:16384
    s_waitcnt lgkmcnt(10)
    v_fma_f32 v72, v72, v88, v80
    v_mfma_f32_16x16x32_bf16 v[124:127], a[44:47], v[56:59], v[124:127]
    ds_read_b64_tr_b16 v[50:51], v29 offset:16896
    v_fma_f32 v73, v73, v89, v81
    v_mfma_f32_16x16x32_bf16 v[124:127], a[60:63], v[60:63], v[124:127]
    s_waitcnt lgkmcnt(3)
    ds_read_b64_tr_b16 v[52:53], v29 offset:20480
    v_fma_f32 v74, v74, v90, v82
    v_mfma_f32_16x16x32_bf16 v[96:99], a[64:67], v[32:35], v[96:99]
    ds_read_b64_tr_b16 v[54:55], v29 offset:20992
    v_fma_f32 v75, v75, v91, v83
    v_mfma_f32_16x16x32_bf16 v[96:99], a[80:83], v[36:39], v[96:99]
    ds_read_b64_tr_b16 v[56:57], v29 offset:24576
    s_waitcnt lgkmcnt(5)
    v_fma_f32 v76, v76, v92, v84
    v_mfma_f32_16x16x32_bf16 v[96:99], a[96:99], v[40:43], v[96:99]
    ds_read_b64_tr_b16 v[58:59], v29 offset:25088
    v_fma_f32 v77, v77, v93, v85
    v_mfma_f32_16x16x32_bf16 v[96:99], a[112:115], v[44:47], v[96:99]
    ds_read_b64_tr_b16 v[60:61], v29 offset:28672
    v_fma_f32 v78, v78, v94, v86
    v_mfma_f32_16x16x32_bf16 v[100:103], a[68:71], v[32:35], v[100:103]
    ds_read_b64_tr_b16 v[62:63], v29 offset:29184
    v_fma_f32 v79, v79, v95, v87
    v_mfma_f32_16x16x32_bf16 v[100:103], a[84:87], v[36:39], v[100:103]
    buffer_load_dwordx4 v22, s[24:27], s98 offen offset:2048   lds
    v_mfma_f32_16x16x32_bf16 v[100:103], a[100:103], v[40:43], v[100:103]
    v_cvt_pk_bf16_f32 v72, v72, v73
    v_cvt_pk_bf16_f32 v73, v74, v75
    v_mfma_f32_16x16x32_bf16 v[100:103], a[116:119], v[44:47], v[100:103]
    v_cvt_pk_bf16_f32 v74, v76, v77
    v_cvt_pk_bf16_f32 v75, v78, v79
    v_mfma_f32_16x16x32_bf16 v[104:107], a[72:75], v[32:35], v[104:107]
    buffer_store_dwordx4 v[72:75], v19, s[8:11], s71 offen offset:2048 sc0 sc1
    v_mfma_f32_16x16x32_bf16 v[104:107], a[88:91], v[36:39], v[104:107]
    buffer_load_dwordx4 v23, s[24:27], s98 offen offset:3072   lds
    v_mfma_f32_16x16x32_bf16 v[104:107], a[104:107], v[40:43], v[104:107]
    s_add_u32 m0, s63, 98304
    s_xor_b32 s98, s0, 524288
    v_mfma_f32_16x16x32_bf16 v[104:107], a[120:123], v[44:47], v[104:107]
    buffer_store_dwordx4 v[136:139], v1, s[8:11], s79 offen offset:1024 sc0 sc1
    v_mfma_f32_16x16x32_bf16 v[108:111], a[76:79], v[32:35], v[108:111]
    v_mfma_f32_16x16x32_bf16 v[108:111], a[92:95], v[36:39], v[108:111]
    ds_read_b64_tr_b16 v[32:33], v30 offset:0
    v_cvt_pk_bf16_f32 v144, v144, v145
    v_mfma_f32_16x16x32_bf16 v[108:111], a[108:111], v[40:43], v[108:111]
    ds_read_b64_tr_b16 v[34:35], v30 offset:512
    v_cvt_pk_bf16_f32 v145, v146, v147
    v_mfma_f32_16x16x32_bf16 v[108:111], a[124:127], v[44:47], v[108:111]
    s_waitcnt lgkmcnt(2)
    ds_read_b64_tr_b16 v[36:37], v30 offset:4096
    v_cvt_pk_bf16_f32 v146, v148, v149
    v_mfma_f32_16x16x32_bf16 v[112:115], a[64:67], v[48:51], v[112:115]
    ds_read_b64_tr_b16 v[38:39], v30 offset:4608
    v_cvt_pk_bf16_f32 v147, v150, v151
    v_mfma_f32_16x16x32_bf16 v[112:115], a[80:83], v[52:55], v[112:115]
    s_xor_b32 s79, s65, 0
    ds_read_b64_tr_b16 v[40:41], v30 offset:8192
    v_mfma_f32_16x16x32_bf16 v[112:115], a[96:99], v[56:59], v[112:115]
    ds_read_b64_tr_b16 v[42:43], v30 offset:8704
    v_mfma_f32_16x16x32_bf16 v[112:115], a[112:115], v[60:63], v[112:115]
    ds_read_b64_tr_b16 v[44:45], v30 offset:12288
    v_mfma_f32_16x16x32_bf16 v[116:119], a[68:71], v[48:51], v[116:119]
    ds_read_b64_tr_b16 v[46:47], v30 offset:12800
    v_mfma_f32_16x16x32_bf16 v[116:119], a[84:87], v[52:55], v[116:119]
    buffer_load_dwordx4 v20, s[24:27], s98 offen offset:0   lds
    v_mfma_f32_16x16x32_bf16 v[116:119], a[100:103], v[56:59], v[116:119]
    buffer_store_dwordx4 v[144:147], v1, s[8:11], s79 offen offset:2048 sc0 sc1
    v_mfma_f32_16x16x32_bf16 v[116:119], a[116:119], v[60:63], v[116:119]
    v_mfma_f32_16x16x32_bf16 v[120:123], a[72:75], v[48:51], v[120:123]
    v_mfma_f32_16x16x32_bf16 v[120:123], a[88:91], v[52:55], v[120:123]
    buffer_load_dwordx4 v21, s[24:27], s98 offen offset:1024   lds
    v_mfma_f32_16x16x32_bf16 v[120:123], a[104:107], v[56:59], v[120:123]
    v_mfma_f32_16x16x32_bf16 v[120:123], a[120:123], v[60:63], v[120:123]
    v_mfma_f32_16x16x32_bf16 v[124:127], a[76:79], v[48:51], v[124:127]
    v_mfma_f32_16x16x32_bf16 v[124:127], a[92:95], v[52:55], v[124:127]
    ds_read_b64_tr_b16 v[48:49], v31 offset:0
    v_cvt_pk_bf16_f32 v152, v152, v153
    v_mfma_f32_16x16x32_bf16 v[124:127], a[108:111], v[56:59], v[124:127]
    ds_read_b64_tr_b16 v[50:51], v31 offset:512
    v_cvt_pk_bf16_f32 v153, v154, v155
    v_mfma_f32_16x16x32_bf16 v[124:127], a[124:127], v[60:63], v[124:127]
    s_waitcnt lgkmcnt(2)
    ds_read_b64_tr_b16 v[52:53], v31 offset:4096
    v_cvt_pk_bf16_f32 v154, v156, v157
    v_mfma_f32_16x16x32_bf16 v[64:67], a[0:3], v[32:35], 0
    ds_read_b64_tr_b16 v[54:55], v31 offset:4608
    v_cvt_pk_bf16_f32 v155, v158, v159
    v_mfma_f32_16x16x32_bf16 v[64:67], a[16:19], v[36:39], v[64:67]
    s_xor_b32 s79, s65, 0
    ds_read_b64_tr_b16 v[56:57], v31 offset:8192
    v_mfma_f32_16x16x32_bf16 v[64:67], a[32:35], v[40:43], v[64:67]
    ds_read_b64_tr_b16 v[58:59], v31 offset:8704
    v_mfma_f32_16x16x32_bf16 v[64:67], a[48:51], v[44:47], v[64:67]
    ds_read_b64_tr_b16 v[60:61], v31 offset:12288
    v_mfma_f32_16x16x32_bf16 v[68:71], a[4:7], v[32:35], 0
    ds_read_b64_tr_b16 v[62:63], v31 offset:12800
    v_mfma_f32_16x16x32_bf16 v[68:71], a[20:23], v[36:39], v[68:71]
    buffer_load_dwordx4 v22, s[24:27], s98 offen offset:2048   lds
    v_mfma_f32_16x16x32_bf16 v[68:71], a[36:39], v[40:43], v[68:71]
    buffer_store_dwordx4 v[152:155], v1, s[8:11], s79 offen offset:3072 sc0 sc1
    v_mfma_f32_16x16x32_bf16 v[68:71], a[52:55], v[44:47], v[68:71]
    v_mfma_f32_16x16x32_bf16 v[72:75], a[8:11], v[32:35], 0
    v_mfma_f32_16x16x32_bf16 v[72:75], a[24:27], v[36:39], v[72:75]
    buffer_load_dwordx4 v23, s[24:27], s98 offen offset:3072   lds
    v_mfma_f32_16x16x32_bf16 v[72:75], a[40:43], v[40:43], v[72:75]
    v_mfma_f32_16x16x32_bf16 v[72:75], a[56:59], v[44:47], v[72:75]
    v_mfma_f32_16x16x32_bf16 v[76:79], a[12:15], v[32:35], 0
    v_mfma_f32_16x16x32_bf16 v[76:79], a[28:31], v[36:39], v[76:79]
    ds_read_b64_tr_b16 v[32:33], v30 offset:16384
    v_cvt_pk_bf16_f32 v160, v160, v161
    v_mfma_f32_16x16x32_bf16 v[76:79], a[44:47], v[40:43], v[76:79]
    ds_read_b64_tr_b16 v[34:35], v30 offset:16896
    v_cvt_pk_bf16_f32 v161, v162, v163
    v_mfma_f32_16x16x32_bf16 v[76:79], a[60:63], v[44:47], v[76:79]
    s_waitcnt lgkmcnt(2)
    ds_read_b64_tr_b16 v[36:37], v30 offset:20480
    v_cvt_pk_bf16_f32 v162, v164, v165
    v_mfma_f32_16x16x32_bf16 v[80:83], a[0:3], v[48:51], 0
    ds_read_b64_tr_b16 v[38:39], v30 offset:20992
    v_cvt_pk_bf16_f32 v163, v166, v167
    v_mfma_f32_16x16x32_bf16 v[80:83], a[16:19], v[52:55], v[80:83]
    s_xor_b32 s79, s65, 4096
    ds_read_b64_tr_b16 v[40:41], v30 offset:24576
    v_mfma_f32_16x16x32_bf16 v[80:83], a[32:35], v[56:59], v[80:83]
    ds_read_b64_tr_b16 v[42:43], v30 offset:25088
    v_mfma_f32_16x16x32_bf16 v[80:83], a[48:51], v[60:63], v[80:83]
    ds_read_b64_tr_b16 v[44:45], v30 offset:28672
    v_mfma_f32_16x16x32_bf16 v[84:87], a[4:7], v[48:51], 0
    ds_read_b64_tr_b16 v[46:47], v30 offset:29184
    v_mfma_f32_16x16x32_bf16 v[84:87], a[20:23], v[52:55], v[84:87]
    buffer_store_dwordx4 v[160:163], v1, s[8:11], s79 offen offset:0 sc0 sc1
    v_mfma_f32_16x16x32_bf16 v[84:87], a[36:39], v[56:59], v[84:87]
    v_mfma_f32_16x16x32_bf16 v[84:87], a[52:55], v[60:63], v[84:87]
    v_mfma_f32_16x16x32_bf16 v[88:91], a[8:11], v[48:51], 0
    v_mfma_f32_16x16x32_bf16 v[88:91], a[24:27], v[52:55], v[88:91]
    v_mfma_f32_16x16x32_bf16 v[88:91], a[40:43], v[56:59], v[88:91]
    v_mfma_f32_16x16x32_bf16 v[88:91], a[56:59], v[60:63], v[88:91]
    v_mfma_f32_16x16x32_bf16 v[92:95], a[12:15], v[48:51], 0
    v_mfma_f32_16x16x32_bf16 v[92:95], a[28:31], v[52:55], v[92:95]
    ds_read_b64_tr_b16 v[48:49], v31 offset:16384
    v_cvt_pk_bf16_f32 v168, v168, v169
    v_mfma_f32_16x16x32_bf16 v[92:95], a[44:47], v[56:59], v[92:95]
    ds_read_b64_tr_b16 v[50:51], v31 offset:16896
    v_cvt_pk_bf16_f32 v169, v170, v171
    v_mfma_f32_16x16x32_bf16 v[92:95], a[60:63], v[60:63], v[92:95]
    s_waitcnt lgkmcnt(2)
    ds_read_b64_tr_b16 v[52:53], v31 offset:20480
    v_cvt_pk_bf16_f32 v170, v172, v173
    v_mfma_f32_16x16x32_bf16 v[64:67], a[64:67], v[32:35], v[64:67]
    ds_read_b64_tr_b16 v[54:55], v31 offset:20992
    v_cvt_pk_bf16_f32 v171, v174, v175
    v_mfma_f32_16x16x32_bf16 v[64:67], a[80:83], v[36:39], v[64:67]
    s_xor_b32 s79, s65, 4096
    ds_read_b64_tr_b16 v[56:57], v31 offset:24576
    v_mfma_f32_16x16x32_bf16 v[64:67], a[96:99], v[40:43], v[64:67]
    ds_read_b64_tr_b16 v[58:59], v31 offset:25088
    v_mfma_f32_16x16x32_bf16 v[64:67], a[112:115], v[44:47], v[64:67]
    ds_read_b64_tr_b16 v[60:61], v31 offset:28672
    v_mfma_f32_16x16x32_bf16 v[68:71], a[68:71], v[32:35], v[68:71]
    ds_read_b64_tr_b16 v[62:63], v31 offset:29184
    v_mfma_f32_16x16x32_bf16 v[68:71], a[84:87], v[36:39], v[68:71]
    buffer_store_dwordx4 v[168:171], v1, s[8:11], s79 offen offset:1024 sc0 sc1
    v_mfma_f32_16x16x32_bf16 v[68:71], a[100:103], v[40:43], v[68:71]
    v_mfma_f32_16x16x32_bf16 v[68:71], a[116:119], v[44:47], v[68:71]
    v_mfma_f32_16x16x32_bf16 v[72:75], a[72:75], v[32:35], v[72:75]
    v_mfma_f32_16x16x32_bf16 v[72:75], a[88:91], v[36:39], v[72:75]
    v_mfma_f32_16x16x32_bf16 v[72:75], a[104:107], v[40:43], v[72:75]
    v_mfma_f32_16x16x32_bf16 v[72:75], a[120:123], v[44:47], v[72:75]
    v_mfma_f32_16x16x32_bf16 v[76:79], a[76:79], v[32:35], v[76:79]
    v_mfma_f32_16x16x32_bf16 v[76:79], a[92:95], v[36:39], v[76:79]
    v_mfma_f32_16x16x32_bf16 v[76:79], a[108:111], v[40:43], v[76:79]
    v_xor_b32 v28, 65536, v28
    v_cvt_pk_bf16_f32 v176, v176, v177
    s_waitcnt vmcnt(24) lgkmcnt(0)
    s_barrier
    s_waitcnt vmcnt(10)
    v_mfma_f32_16x16x32_bf16 v[76:79], a[124:127], v[44:47], v[76:79]
    s_add_u32 m0, s62, 65536
    s_xor_b32 s98, s64, 2097280
    ds_read_b64_tr_b16 v[32:33], v28 offset:0
    v_mfma_f32_16x16x32_bf16 v[80:83], a[64:67], v[48:51], v[80:83]
    ds_read_b64_tr_b16 v[34:35], v28 offset:512
    v_cvt_pk_bf16_f32 v177, v178, v179
    v_mfma_f32_16x16x32_bf16 v[80:83], a[80:83], v[52:55], v[80:83]
    ds_read_b64_tr_b16 v[36:37], v28 offset:4096
    v_cvt_pk_bf16_f32 v178, v180, v181
    v_mfma_f32_16x16x32_bf16 v[80:83], a[96:99], v[56:59], v[80:83]
    ds_read_b64_tr_b16 v[38:39], v28 offset:4608
    v_cvt_pk_bf16_f32 v179, v182, v183
    v_mfma_f32_16x16x32_bf16 v[80:83], a[112:115], v[60:63], v[80:83]
    s_xor_b32 s79, s65, 4096
    ds_read_b64_tr_b16 v[40:41], v28 offset:8192
    v_mfma_f32_16x16x32_bf16 v[84:87], a[68:71], v[48:51], v[84:87]
    ds_read_b64_tr_b16 v[42:43], v28 offset:8704
    v_mfma_f32_16x16x32_bf16 v[84:87], a[84:87], v[52:55], v[84:87]
    ds_read_b64_tr_b16 v[44:45], v28 offset:12288
    v_mfma_f32_16x16x32_bf16 v[84:87], a[100:103], v[56:59], v[84:87]
    ds_read_b64_tr_b16 v[46:47], v28 offset:12800
    v_mfma_f32_16x16x32_bf16 v[84:87], a[116:119], v[60:63], v[84:87]
    buffer_load_dwordx4 v24, s[20:23], s98 offen offset:0   lds
    v_mfma_f32_16x16x32_bf16 v[88:91], a[72:75], v[48:51], v[88:91]
    buffer_store_dword v6, v5, s[8:11], s72 offen sc0 sc1
    v_mfma_f32_16x16x32_bf16 v[88:91], a[88:91], v[52:55], v[88:91]
    buffer_store_dwordx4 v[176:179], v1, s[8:11], s79 offen offset:2048 sc0 sc1
    v_mfma_f32_16x16x32_bf16 v[88:91], a[104:107], v[56:59], v[88:91]
    buffer_load_dwordx4 v25, s[20:23], s98 offen offset:1024   lds
    v_mfma_f32_16x16x32_bf16 v[88:91], a[120:123], v[60:63], v[88:91]
    v_mfma_f32_16x16x32_bf16 v[92:95], a[76:79], v[48:51], v[92:95]
    v_xor_b32 v29, 65536, v29
    v_mfma_f32_16x16x32_bf16 v[92:95], a[92:95], v[52:55], v[92:95]
    ds_read_b64_tr_b16 v[48:49], v29 offset:0
    v_mfma_f32_16x16x32_bf16 v[92:95], a[108:111], v[56:59], v[92:95]
    ds_read_b64_tr_b16 v[50:51], v29 offset:512
    v_mfma_f32_16x16x32_bf16 v[92:95], a[124:127], v[60:63], v[92:95]
    s_waitcnt lgkmcnt(3)
    ds_read_b64_tr_b16 v[52:53], v29 offset:4096
    v_cvt_pk_bf16_f32 v184, v184, v185
    v_mfma_f32_16x16x32_bf16 v[96:99], a[128:131], v[32:35], v[96:99]
    ds_read_b64_tr_b16 v[54:55], v29 offset:4608
    v_cvt_pk_bf16_f32 v185, v186, v187
    v_mfma_f32_16x16x32_bf16 v[96:99], a[144:147], v[36:39], v[96:99]
    ds_read_b64_tr_b16 v[56:57], v29 offset:8192
    v_cvt_pk_bf16_f32 v186, v188, v189
    v_mfma_f32_16x16x32_bf16 v[96:99], a[160:163], v[40:43], v[96:99]
    s_waitcnt lgkmcnt(5)
    ds_read_b64_tr_b16 v[58:59], v29 offset:8704
    v_cvt_pk_bf16_f32 v187, v190, v191
    v_mfma_f32_16x16x32_bf16 v[96:99], a[176:179], v[44:47], v[96:99]
    s_xor_b32 s79, s65, 4096
    ds_read_b64_tr_b16 v[60:61], v29 offset:12288
    v_mfma_f32_16x16x32_bf16 v[100:103], a[132:135], v[32:35], v[100:103]
    ds_read_b64_tr_b16 v[62:63], v29 offset:12800
    v_mfma_f32_16x16x32_bf16 v[100:103], a[148:151], v[36:39], v[100:103]
    buffer_load_dwordx4 v26, s[20:23], s98 offen offset:2048   lds
    v_mfma_f32_16x16x32_bf16 v[100:103], a[164:167], v[40:43], v[100:103]
    buffer_store_dwordx4 v[184:187], v1, s[8:11], s79 offen offset:3072 sc0 sc1
    v_mfma_f32_16x16x32_bf16 v[100:103], a[180:183], v[44:47], v[100:103]
    v_mfma_f32_16x16x32_bf16 v[104:107], a[136:139], v[32:35], v[104:107]
    buffer_load_dwordx4 v27, s[20:23], s98 offen offset:3072   lds
    v_mfma_f32_16x16x32_bf16 v[104:107], a[152:155], v[36:39], v[104:107]
    s_add_u32 m0, s62, 69632
    s_xor_b32 s98, s64, 2359424
    v_mfma_f32_16x16x32_bf16 v[104:107], a[168:171], v[40:43], v[104:107]
    v_mfma_f32_16x16x32_bf16 v[104:107], a[184:187], v[44:47], v[104:107]
    buffer_load_dwordx4 v24, s[20:23], s98 offen offset:0   lds
    v_mfma_f32_16x16x32_bf16 v[108:111], a[140:143], v[32:35], v[108:111]
    v_mfma_f32_16x16x32_bf16 v[108:111], a[156:159], v[36:39], v[108:111]
    ds_read_b64_tr_b16 v[32:33], v28 offset:16384
    v_mfma_f32_16x16x32_bf16 v[108:111], a[172:175], v[40:43], v[108:111]
    ds_read_b64_tr_b16 v[34:35], v28 offset:16896
    v_mfma_f32_16x16x32_bf16 v[108:111], a[188:191], v[44:47], v[108:111]
    s_waitcnt lgkmcnt(2)
    ds_read_b64_tr_b16 v[36:37], v28 offset:20480
    v_mfma_f32_16x16x32_bf16 v[112:115], a[128:131], v[48:51], v[112:115]
    ds_read_b64_tr_b16 v[38:39], v28 offset:20992
    v_cvt_pk_bf16_f32 v192, v192, v193
    v_mfma_f32_16x16x32_bf16 v[112:115], a[144:147], v[52:55], v[112:115]
    ds_read_b64_tr_b16 v[40:41], v28 offset:24576
    v_cvt_pk_bf16_f32 v193, v194, v195
    v_mfma_f32_16x16x32_bf16 v[112:115], a[160:163], v[56:59], v[112:115]
    ds_read_b64_tr_b16 v[42:43], v28 offset:25088
    v_cvt_pk_bf16_f32 v194, v196, v197
    v_mfma_f32_16x16x32_bf16 v[112:115], a[176:179], v[60:63], v[112:115]
    ds_read_b64_tr_b16 v[44:45], v28 offset:28672
    v_cvt_pk_bf16_f32 v195, v198, v199
    v_mfma_f32_16x16x32_bf16 v[116:119], a[132:135], v[48:51], v[116:119]
    s_xor_b32 s79, s65, 8192
    ds_read_b64_tr_b16 v[46:47], v28 offset:29184
    v_mfma_f32_16x16x32_bf16 v[116:119], a[148:151], v[52:55], v[116:119]
    buffer_load_dwordx4 v25, s[20:23], s98 offen offset:1024   lds
    v_mfma_f32_16x16x32_bf16 v[116:119], a[164:167], v[56:59], v[116:119]
    buffer_store_dwordx4 v[192:195], v1, s[8:11], s79 offen offset:0 sc0 sc1
    v_mfma_f32_16x16x32_bf16 v[116:119], a[180:183], v[60:63], v[116:119]
    v_mfma_f32_16x16x32_bf16 v[120:123], a[136:139], v[48:51], v[120:123]
    buffer_load_dwordx4 v26, s[20:23], s98 offen offset:2048   lds
    v_mfma_f32_16x16x32_bf16 v[120:123], a[152:155], v[52:55], v[120:123]
    v_mfma_f32_16x16x32_bf16 v[120:123], a[168:171], v[56:59], v[120:123]
    v_mfma_f32_16x16x32_bf16 v[120:123], a[184:187], v[60:63], v[120:123]
    buffer_load_dwordx4 v27, s[20:23], s98 offen offset:3072   lds
    v_mfma_f32_16x16x32_bf16 v[124:127], a[140:143], v[48:51], v[124:127]
    v_mfma_f32_16x16x32_bf16 v[124:127], a[156:159], v[52:55], v[124:127]
    s_add_u32 m0, s63, 114688
    s_xor_b32 s98, s0, 1048576
    ds_read_b64_tr_b16 v[48:49], v29 offset:16384
    v_mfma_f32_16x16x32_bf16 v[124:127], a[172:175], v[56:59], v[124:127]
    ds_read_b64_tr_b16 v[50:51], v29 offset:16896
    v_mfma_f32_16x16x32_bf16 v[124:127], a[188:191], v[60:63], v[124:127]
    s_waitcnt lgkmcnt(2)
    ds_read_b64_tr_b16 v[52:53], v29 offset:20480
    v_mfma_f32_16x16x32_bf16 v[96:99], a[192:195], v[32:35], v[96:99]
    ds_read_b64_tr_b16 v[54:55], v29 offset:20992
    v_mfma_f32_16x16x32_bf16 v[96:99], a[208:211], v[36:39], v[96:99]
    ds_read_b64_tr_b16 v[56:57], v29 offset:24576
    v_cvt_pk_bf16_f32 v200, v200, v201
    v_mfma_f32_16x16x32_bf16 v[96:99], a[224:227], v[40:43], v[96:99]
    ds_read_b64_tr_b16 v[58:59], v29 offset:25088
    v_cvt_pk_bf16_f32 v201, v202, v203
    v_mfma_f32_16x16x32_bf16 v[96:99], a[240:243], v[44:47], v[96:99]
    ds_read_b64_tr_b16 v[60:61], v29 offset:28672
    v_cvt_pk_bf16_f32 v202, v204, v205
    v_mfma_f32_16x16x32_bf16 v[100:103], a[196:199], v[32:35], v[100:103]
    ds_read_b64_tr_b16 v[62:63], v29 offset:29184
    v_cvt_pk_bf16_f32 v203, v206, v207
    v_mfma_f32_16x16x32_bf16 v[100:103], a[212:215], v[36:39], v[100:103]
    buffer_load_dwordx4 v20, s[24:27], s98 offen offset:0   lds
    v_mfma_f32_16x16x32_bf16 v[100:103], a[228:231], v[40:43], v[100:103]
    s_xor_b32 s79, s65, 8192
    v_mfma_f32_16x16x32_bf16 v[100:103], a[244:247], v[44:47], v[100:103]
    buffer_store_dwordx4 v[200:203], v1, s[8:11], s79 offen offset:1024 sc0 sc1
    v_mfma_f32_16x16x32_bf16 v[104:107], a[200:203], v[32:35], v[104:107]
    buffer_load_dwordx4 v21, s[24:27], s98 offen offset:1024   lds
    v_mfma_f32_16x16x32_bf16 v[104:107], a[216:219], v[36:39], v[104:107]
    v_mfma_f32_16x16x32_bf16 v[104:107], a[232:235], v[40:43], v[104:107]
    v_mfma_f32_16x16x32_bf16 v[104:107], a[248:251], v[44:47], v[104:107]
    buffer_load_dwordx4 v22, s[24:27], s98 offen offset:2048   lds
    v_mfma_f32_16x16x32_bf16 v[108:111], a[204:207], v[32:35], v[108:111]
    v_xor_b32 v30, 65536, v30
    v_mfma_f32_16x16x32_bf16 v[108:111], a[220:223], v[36:39], v[108:111]
    ds_read_b64_tr_b16 v[32:33], v30 offset:0
    v_mfma_f32_16x16x32_bf16 v[108:111], a[236:239], v[40:43], v[108:111]
    ds_read_b64_tr_b16 v[34:35], v30 offset:512
    v_mfma_f32_16x16x32_bf16 v[108:111], a[252:255], v[44:47], v[108:111]
    s_waitcnt lgkmcnt(2)
    ds_read_b64_tr_b16 v[36:37], v30 offset:4096
    v_mfma_f32_16x16x32_bf16 v[112:115], a[192:195], v[48:51], v[112:115]
    ds_read_b64_tr_b16 v[38:39], v30 offset:4608
    v_mfma_f32_16x16x32_bf16 v[112:115], a[208:211], v[52:55], v[112:115]
    ds_read_b64_tr_b16 v[40:41], v30 offset:8192
    v_mfma_f32_16x16x32_bf16 v[112:115], a[224:227], v[56:59], v[112:115]
    ds_read_b64_tr_b16 v[42:43], v30 offset:8704
    v_cvt_pk_bf16_f32 v208, v208, v209
    v_mfma_f32_16x16x32_bf16 v[112:115], a[240:243], v[60:63], v[112:115]
    ds_read_b64_tr_b16 v[44:45], v30 offset:12288
    v_cvt_pk_bf16_f32 v209, v210, v211
    v_mfma_f32_16x16x32_bf16 v[116:119], a[196:199], v[48:51], v[116:119]
    ds_read_b64_tr_b16 v[46:47], v30 offset:12800
    v_cvt_pk_bf16_f32 v210, v212, v213
    v_mfma_f32_16x16x32_bf16 v[116:119], a[212:215], v[52:55], v[116:119]
    buffer_load_dwordx4 v23, s[24:27], s98 offen offset:3072   lds
    v_mfma_f32_16x16x32_bf16 v[116:119], a[228:231], v[56:59], v[116:119]
    s_add_u32 m0, s63, 147456
    s_xor_b32 s98, s0, 1572864
    v_cvt_pk_bf16_f32 v211, v214, v215
    v_mfma_f32_16x16x32_bf16 v[116:119], a[244:247], v[60:63], v[116:119]
    s_xor_b32 s79, s65, 8192
    v_mfma_f32_16x16x32_bf16 v[120:123], a[200:203], v[48:51], v[120:123]
    buffer_load_dwordx4 v20, s[24:27], s98 offen offset:0   lds
    v_mfma_f32_16x16x32_bf16 v[120:123], a[216:219], v[52:55], v[120:123]
    buffer_store_dwordx4 v[208:211], v1, s[8:11], s79 offen offset:2048 sc0 sc1
    v_mfma_f32_16x16x32_bf16 v[120:123], a[232:235], v[56:59], v[120:123]
    v_mfma_f32_16x16x32_bf16 v[120:123], a[248:251], v[60:63], v[120:123]
    buffer_load_dwordx4 v21, s[24:27], s98 offen offset:1024   lds
    v_mfma_f32_16x16x32_bf16 v[124:127], a[204:207], v[48:51], v[124:127]
    v_xor_b32 v31, 65536, v31
    v_mfma_f32_16x16x32_bf16 v[124:127], a[220:223], v[52:55], v[124:127]
    ds_read_b64_tr_b16 v[48:49], v31 offset:0
    v_mfma_f32_16x16x32_bf16 v[124:127], a[236:239], v[56:59], v[124:127]
    ds_read_b64_tr_b16 v[50:51], v31 offset:512
    v_mfma_f32_16x16x32_bf16 v[124:127], a[252:255], v[60:63], v[124:127]
    s_waitcnt lgkmcnt(2)
    ds_read_b64_tr_b16 v[52:53], v31 offset:4096
    v_mfma_f32_16x16x32_bf16 v[64:67], a[128:131], v[32:35], v[64:67]
    ds_read_b64_tr_b16 v[54:55], v31 offset:4608
    v_mfma_f32_16x16x32_bf16 v[64:67], a[144:147], v[36:39], v[64:67]
    ds_read_b64_tr_b16 v[56:57], v31 offset:8192
    v_mfma_f32_16x16x32_bf16 v[64:67], a[160:163], v[40:43], v[64:67]
    ds_read_b64_tr_b16 v[58:59], v31 offset:8704
    v_mfma_f32_16x16x32_bf16 v[64:67], a[176:179], v[44:47], v[64:67]
    ds_read_b64_tr_b16 v[60:61], v31 offset:12288
    v_mfma_f32_16x16x32_bf16 v[68:71], a[132:135], v[32:35], v[68:71]
    ds_read_b64_tr_b16 v[62:63], v31 offset:12800
    v_mfma_f32_16x16x32_bf16 v[68:71], a[148:151], v[36:39], v[68:71]
    buffer_load_dwordx4 v22, s[24:27], s98 offen offset:2048   lds
    v_mfma_f32_16x16x32_bf16 v[68:71], a[164:167], v[40:43], v[68:71]
    v_cvt_pk_bf16_f32 v96, v96, v97
    v_cvt_pk_bf16_f32 v97, v98, v99
    v_mfma_f32_16x16x32_bf16 v[68:71], a[180:183], v[44:47], v[68:71]
    v_cvt_pk_bf16_f32 v98, v100, v101
    v_cvt_pk_bf16_f32 v99, v102, v103
    v_mfma_f32_16x16x32_bf16 v[72:75], a[136:139], v[32:35], v[72:75]
    buffer_load_dwordx4 v23, s[24:27], s98 offen offset:3072   lds
    v_mfma_f32_16x16x32_bf16 v[72:75], a[152:155], v[36:39], v[72:75]
    s_xor_b32 s79, s1, 32768
    v_mfma_f32_16x16x32_bf16 v[72:75], a[168:171], v[40:43], v[72:75]
    buffer_store_dwordx4 v[96:99], v1, s[8:11], s79 offen offset:0 sc0 sc1
    v_mfma_f32_16x16x32_bf16 v[72:75], a[184:187], v[44:47], v[72:75]
    v_mfma_f32_16x16x32_bf16 v[76:79], a[140:143], v[32:35], v[76:79]
    v_mfma_f32_16x16x32_bf16 v[76:79], a[156:159], v[36:39], v[76:79]
    ds_read_b64_tr_b16 v[32:33], v30 offset:16384
    v_mfma_f32_16x16x32_bf16 v[76:79], a[172:175], v[40:43], v[76:79]
    ds_read_b64_tr_b16 v[34:35], v30 offset:16896
    v_mfma_f32_16x16x32_bf16 v[76:79], a[188:191], v[44:47], v[76:79]
    s_waitcnt lgkmcnt(2)
    ds_read_b64_tr_b16 v[36:37], v30 offset:20480
    v_mfma_f32_16x16x32_bf16 v[80:83], a[128:131], v[48:51], v[80:83]
    ds_read_b64_tr_b16 v[38:39], v30 offset:20992
    v_mfma_f32_16x16x32_bf16 v[80:83], a[144:147], v[52:55], v[80:83]
    ds_read_b64_tr_b16 v[40:41], v30 offset:24576
    v_mfma_f32_16x16x32_bf16 v[80:83], a[160:163], v[56:59], v[80:83]
    ds_read_b64_tr_b16 v[42:43], v30 offset:25088
    v_mfma_f32_16x16x32_bf16 v[80:83], a[176:179], v[60:63], v[80:83]
    ds_read_b64_tr_b16 v[44:45], v30 offset:28672
    v_mfma_f32_16x16x32_bf16 v[84:87], a[132:135], v[48:51], v[84:87]
    ds_read_b64_tr_b16 v[46:47], v30 offset:29184
    v_cvt_pk_bf16_f32 v104, v104, v105
    v_mfma_f32_16x16x32_bf16 v[84:87], a[148:151], v[52:55], v[84:87]
    v_cvt_pk_bf16_f32 v105, v106, v107
    v_cvt_pk_bf16_f32 v106, v108, v109
    v_mfma_f32_16x16x32_bf16 v[84:87], a[164:167], v[56:59], v[84:87]
    v_cvt_pk_bf16_f32 v107, v110, v111
    v_mfma_f32_16x16x32_bf16 v[84:87], a[180:183], v[60:63], v[84:87]
    s_xor_b32 s79, s1, 40960
    v_mfma_f32_16x16x32_bf16 v[88:91], a[136:139], v[48:51], v[88:91]
    buffer_store_dwordx4 v[104:107], v1, s[8:11], s79 offen offset:0 sc0 sc1
    v_mfma_f32_16x16x32_bf16 v[88:91], a[152:155], v[52:55], v[88:91]
    v_mfma_f32_16x16x32_bf16 v[88:91], a[168:171], v[56:59], v[88:91]
    v_mfma_f32_16x16x32_bf16 v[88:91], a[184:187], v[60:63], v[88:91]
    v_mfma_f32_16x16x32_bf16 v[92:95], a[140:143], v[48:51], v[92:95]
    v_mfma_f32_16x16x32_bf16 v[92:95], a[156:159], v[52:55], v[92:95]
    ds_read_b64_tr_b16 v[48:49], v31 offset:16384
    v_mfma_f32_16x16x32_bf16 v[92:95], a[172:175], v[56:59], v[92:95]
    ds_read_b64_tr_b16 v[50:51], v31 offset:16896
    v_mfma_f32_16x16x32_bf16 v[92:95], a[188:191], v[60:63], v[92:95]
    s_waitcnt lgkmcnt(2)
    ds_read_b64_tr_b16 v[52:53], v31 offset:20480
    v_mfma_f32_16x16x32_bf16 v[64:67], a[192:195], v[32:35], v[64:67]
    ds_read_b64_tr_b16 v[54:55], v31 offset:20992
    v_mfma_f32_16x16x32_bf16 v[64:67], a[208:211], v[36:39], v[64:67]
    ds_read_b64_tr_b16 v[56:57], v31 offset:24576
    v_mfma_f32_16x16x32_bf16 v[64:67], a[224:227], v[40:43], v[64:67]
    ds_read_b64_tr_b16 v[58:59], v31 offset:25088
    v_cvt_pk_bf16_f32 v112, v112, v113
    v_mfma_f32_16x16x32_bf16 v[64:67], a[240:243], v[44:47], v[64:67]
    ds_read_b64_tr_b16 v[60:61], v31 offset:28672
    v_cvt_pk_bf16_f32 v113, v114, v115
    v_mfma_f32_16x16x32_bf16 v[68:71], a[196:199], v[32:35], v[68:71]
    ds_read_b64_tr_b16 v[62:63], v31 offset:29184
    v_cvt_pk_bf16_f32 v114, v116, v117
    v_mfma_f32_16x16x32_bf16 v[68:71], a[212:215], v[36:39], v[68:71]
    v_cvt_pk_bf16_f32 v115, v118, v119
    v_mfma_f32_16x16x32_bf16 v[68:71], a[228:231], v[40:43], v[68:71]
    s_xor_b32 s79, s1, 32768
    v_mfma_f32_16x16x32_bf16 v[68:71], a[244:247], v[44:47], v[68:71]
    buffer_store_dwordx4 v[112:115], v1, s[8:11], s79 offen offset:1024 sc0 sc1
    v_mfma_f32_16x16x32_bf16 v[72:75], a[200:203], v[32:35], v[72:75]
    v_mfma_f32_16x16x32_bf16 v[72:75], a[216:219], v[36:39], v[72:75]
    v_mfma_f32_16x16x32_bf16 v[72:75], a[232:235], v[40:43], v[72:75]
    v_mfma_f32_16x16x32_bf16 v[72:75], a[248:251], v[44:47], v[72:75]
    v_mfma_f32_16x16x32_bf16 v[76:79], a[204:207], v[32:35], v[76:79]
    v_mfma_f32_16x16x32_bf16 v[76:79], a[220:223], v[36:39], v[76:79]
    v_mfma_f32_16x16x32_bf16 v[76:79], a[236:239], v[40:43], v[76:79]
    s_waitcnt lgkmcnt(0)
    s_barrier
    v_mfma_f32_16x16x32_bf16 v[76:79], a[252:255], v[44:47], v[76:79]
    s_add_u32 m0, s63, 0
    s_xor_b32 s98, s0, 2097152
    ds_read_b64_tr_b16 v[32:33], v28 offset:32768
    v_mfma_f32_16x16x32_bf16 v[80:83], a[192:195], v[48:51], v[80:83]
    ds_read_b64_tr_b16 v[34:35], v28 offset:33280
    v_cvt_pk_bf16_f32 v120, v120, v121
    v_mfma_f32_16x16x32_bf16 v[80:83], a[208:211], v[52:55], v[80:83]
    ds_read_b64_tr_b16 v[36:37], v28 offset:36864
    v_cvt_pk_bf16_f32 v121, v122, v123
    v_mfma_f32_16x16x32_bf16 v[80:83], a[224:227], v[56:59], v[80:83]
    ds_read_b64_tr_b16 v[38:39], v28 offset:37376
    v_cvt_pk_bf16_f32 v122, v124, v125
    v_mfma_f32_16x16x32_bf16 v[80:83], a[240:243], v[60:63], v[80:83]
    ds_read_b64_tr_b16 v[40:41], v28 offset:40960
    v_cvt_pk_bf16_f32 v123, v126, v127
    v_mfma_f32_16x16x32_bf16 v[84:87], a[196:199], v[48:51], v[84:87]
    s_xor_b32 s79, s1, 40960
    ds_read_b64_tr_b16 v[42:43], v28 offset:41472
    v_mfma_f32_16x16x32_bf16 v[84:87], a[212:215], v[52:55], v[84:87]
    ds_read_b64_tr_b16 v[44:45], v28 offset:45056
    v_mfma_f32_16x16x32_bf16 v[84:87], a[228:231], v[56:59], v[84:87]
    ds_read_b64_tr_b16 v[46:47], v28 offset:45568
    v_mfma_f32_16x16x32_bf16 v[84:87], a[244:247], v[60:63], v[84:87]
    buffer_load_dwordx4 v20, s[24:27], s98 offen offset:0   lds
    v_mfma_f32_16x16x32_bf16 v[88:91], a[200:203], v[48:51], v[88:91]
    buffer_store_dwordx4 v[120:123], v1, s[8:11], s79 offen offset:1024 sc0 sc1
    v_mfma_f32_16x16x32_bf16 v[88:91], a[216:219], v[52:55], v[88:91]
    v_mfma_f32_16x16x32_bf16 v[88:91], a[232:235], v[56:59], v[88:91]
    v_mfma_f32_16x16x32_bf16 v[88:91], a[248:251], v[60:63], v[88:91]
    v_mfma_f32_16x16x32_bf16 v[92:95], a[204:207], v[48:51], v[92:95]
    v_mfma_f32_16x16x32_bf16 v[92:95], a[220:223], v[52:55], v[92:95]
    ds_read_b64_tr_b16 v[48:49], v29 offset:32768
    v_mfma_f32_16x16x32_bf16 v[92:95], a[236:239], v[56:59], v[92:95]
    ds_read_b64_tr_b16 v[50:51], v29 offset:33280
    v_mfma_f32_16x16x32_bf16 v[92:95], a[252:255], v[60:63], v[92:95]
    s_waitcnt lgkmcnt(3)
    ds_read_b64_tr_b16 v[52:53], v29 offset:36864
    v_mfma_f32_16x16x32_bf16 v[96:99], a[0:3], v[32:35], 0
    ds_read_b64_tr_b16 v[54:55], v29 offset:37376
    v_mfma_f32_16x16x32_bf16 v[96:99], a[16:19], v[36:39], v[96:99]
    ds_read_b64_tr_b16 v[56:57], v29 offset:40960
    v_mfma_f32_16x16x32_bf16 v[96:99], a[32:35], v[40:43], v[96:99]
    s_waitcnt lgkmcnt(5)
    ds_read_b64_tr_b16 v[58:59], v29 offset:41472
    v_mfma_f32_16x16x32_bf16 v[96:99], a[48:51], v[44:47], v[96:99]
    ds_read_b64_tr_b16 v[60:61], v29 offset:45056
    v_mfma_f32_16x16x32_bf16 v[100:103], a[4:7], v[32:35], 0
    ds_read_b64_tr_b16 v[62:63], v29 offset:45568
    v_mfma_f32_16x16x32_bf16 v[100:103], a[20:23], v[36:39], v[100:103]
    buffer_load_dwordx4 v21, s[24:27], s98 offen offset:1024   lds
    v_mfma_f32_16x16x32_bf16 v[100:103], a[36:39], v[40:43], v[100:103]
    v_cvt_pk_bf16_f32 v64, v64, v65
    v_cvt_pk_bf16_f32 v65, v66, v67
    v_mfma_f32_16x16x32_bf16 v[100:103], a[52:55], v[44:47], v[100:103]
    v_cvt_pk_bf16_f32 v66, v68, v69
    v_cvt_pk_bf16_f32 v67, v70, v71
    v_mfma_f32_16x16x32_bf16 v[104:107], a[8:11], v[32:35], 0
    s_xor_b32 s79, s1, 32768
    v_mfma_f32_16x16x32_bf16 v[104:107], a[24:27], v[36:39], v[104:107]
    buffer_store_dwordx4 v[64:67], v1, s[8:11], s79 offen offset:2048 sc0 sc1
    v_mfma_f32_16x16x32_bf16 v[104:107], a[40:43], v[40:43], v[104:107]
    v_mfma_f32_16x16x32_bf16 v[104:107], a[56:59], v[44:47], v[104:107]
    buffer_load_dwordx4 v22, s[24:27], s98 offen offset:2048   lds
    v_mfma_f32_16x16x32_bf16 v[108:111], a[12:15], v[32:35], 0
    v_mfma_f32_16x16x32_bf16 v[108:111], a[28:31], v[36:39], v[108:111]
    ds_read_b64_tr_b16 v[32:33], v28 offset:49152
    v_mfma_f32_16x16x32_bf16 v[108:111], a[44:47], v[40:43], v[108:111]
    ds_read_b64_tr_b16 v[34:35], v28 offset:49664
    v_mfma_f32_16x16x32_bf16 v[108:111], a[60:63], v[44:47], v[108:111]
    s_waitcnt lgkmcnt(2)
    ds_read_b64_tr_b16 v[36:37], v28 offset:53248
    v_mfma_f32_16x16x32_bf16 v[112:115], a[0:3], v[48:51], 0
    ds_read_b64_tr_b16 v[38:39], v28 offset:53760
    v_mfma_f32_16x16x32_bf16 v[112:115], a[16:19], v[52:55], v[112:115]
    ds_read_b64_tr_b16 v[40:41], v28 offset:57344
    v_mfma_f32_16x16x32_bf16 v[112:115], a[32:35], v[56:59], v[112:115]
    ds_read_b64_tr_b16 v[42:43], v28 offset:57856
    v_mfma_f32_16x16x32_bf16 v[112:115], a[48:51], v[60:63], v[112:115]
    ds_read_b64_tr_b16 v[44:45], v28 offset:61440
    v_mfma_f32_16x16x32_bf16 v[116:119], a[4:7], v[48:51], 0
    ds_read_b64_tr_b16 v[46:47], v28 offset:61952
    v_cvt_pk_bf16_f32 v72, v72, v73
    v_mfma_f32_16x16x32_bf16 v[116:119], a[20:23], v[52:55], v[116:119]
    buffer_load_dwordx4 v23, s[24:27], s98 offen offset:3072   lds
    v_mfma_f32_16x16x32_bf16 v[116:119], a[36:39], v[56:59], v[116:119]
    s_add_u32 m0, s63, 16384
    s_xor_b32 s98, s0, 2621440
    v_cvt_pk_bf16_f32 v73, v74, v75
    v_mfma_f32_16x16x32_bf16 v[116:119], a[52:55], v[60:63], v[116:119]
    v_cvt_pk_bf16_f32 v74, v76, v77
    v_cvt_pk_bf16_f32 v75, v78, v79
    v_mfma_f32_16x16x32_bf16 v[120:123], a[8:11], v[48:51], 0
    s_xor_b32 s79, s1, 40960
    v_mfma_f32_16x16x32_bf16 v[120:123], a[24:27], v[52:55], v[120:123]
    buffer_store_dwordx4 v[72:75], v1, s[8:11], s79 offen offset:2048 sc0 sc1
    v_mfma_f32_16x16x32_bf16 v[120:123], a[40:43], v[56:59], v[120:123]
    v_mfma_f32_16x16x32_bf16 v[120:123], a[56:59], v[60:63], v[120:123]
    buffer_load_dwordx4 v20, s[24:27], s98 offen offset:0   lds
    v_mfma_f32_16x16x32_bf16 v[124:127], a[12:15], v[48:51], 0
    v_mfma_f32_16x16x32_bf16 v[124:127], a[28:31], v[52:55], v[124:127]
    ds_read_b64_tr_b16 v[48:49], v29 offset:49152
    v_mfma_f32_16x16x32_bf16 v[124:127], a[44:47], v[56:59], v[124:127]
    ds_read_b64_tr_b16 v[50:51], v29 offset:49664
    v_mfma_f32_16x16x32_bf16 v[124:127], a[60:63], v[60:63], v[124:127]
    s_waitcnt lgkmcnt(2)
    ds_read_b64_tr_b16 v[52:53], v29 offset:53248
    v_mfma_f32_16x16x32_bf16 v[96:99], a[64:67], v[32:35], v[96:99]
    ds_read_b64_tr_b16 v[54:55], v29 offset:53760
    v_mfma_f32_16x16x32_bf16 v[96:99], a[80:83], v[36:39], v[96:99]
    ds_read_b64_tr_b16 v[56:57], v29 offset:57344
    v_mfma_f32_16x16x32_bf16 v[96:99], a[96:99], v[40:43], v[96:99]
    ds_read_b64_tr_b16 v[58:59], v29 offset:57856
    v_cvt_pk_bf16_f32 v80, v80, v81
    v_mfma_f32_16x16x32_bf16 v[96:99], a[112:115], v[44:47], v[96:99]
    ds_read_b64_tr_b16 v[60:61], v29 offset:61440
    v_cvt_pk_bf16_f32 v81, v82, v83
    v_mfma_f32_16x16x32_bf16 v[100:103], a[68:71], v[32:35], v[100:103]
    ds_read_b64_tr_b16 v[62:63], v29 offset:61952
    v_cvt_pk_bf16_f32 v82, v84, v85
    v_mfma_f32_16x16x32_bf16 v[100:103], a[84:87], v[36:39], v[100:103]
    buffer_load_dwordx4 v21, s[24:27], s98 offen offset:1024   lds
    v_mfma_f32_16x16x32_bf16 v[100:103], a[100:103], v[40:43], v[100:103]
    v_cvt_pk_bf16_f32 v83, v86, v87
    v_mfma_f32_16x16x32_bf16 v[100:103], a[116:119], v[44:47], v[100:103]
    s_xor_b32 s79, s1, 32768
    v_mfma_f32_16x16x32_bf16 v[104:107], a[72:75], v[32:35], v[104:107]
    buffer_store_dwordx4 v[80:83], v1, s[8:11], s79 offen offset:3072 sc0 sc1
    v_mfma_f32_16x16x32_bf16 v[104:107], a[88:91], v[36:39], v[104:107]
    v_mfma_f32_16x16x32_bf16 v[104:107], a[104:107], v[40:43], v[104:107]
    v_mfma_f32_16x16x32_bf16 v[104:107], a[120:123], v[44:47], v[104:107]
    buffer_load_dwordx4 v22, s[24:27], s98 offen offset:2048   lds
    v_mfma_f32_16x16x32_bf16 v[108:111], a[76:79], v[32:35], v[108:111]
    v_mfma_f32_16x16x32_bf16 v[108:111], a[92:95], v[36:39], v[108:111]
    ds_read_b64_tr_b16 v[32:33], v30 offset:32768
    v_mfma_f32_16x16x32_bf16 v[108:111], a[108:111], v[40:43], v[108:111]
    ds_read_b64_tr_b16 v[34:35], v30 offset:33280
    v_mfma_f32_16x16x32_bf16 v[108:111], a[124:127], v[44:47], v[108:111]
    s_waitcnt lgkmcnt(2)
    ds_read_b64_tr_b16 v[36:37], v30 offset:36864
    v_mfma_f32_16x16x32_bf16 v[112:115], a[64:67], v[48:51], v[112:115]
    ds_read_b64_tr_b16 v[38:39], v30 offset:37376
    v_cvt_pk_bf16_f32 v88, v88, v89
    v_mfma_f32_16x16x32_bf16 v[112:115], a[80:83], v[52:55], v[112:115]
    ds_read_b64_tr_b16 v[40:41], v30 offset:40960
    v_cvt_pk_bf16_f32 v89, v90, v91
    v_mfma_f32_16x16x32_bf16 v[112:115], a[96:99], v[56:59], v[112:115]
    ds_read_b64_tr_b16 v[42:43], v30 offset:41472
    v_cvt_pk_bf16_f32 v90, v92, v93
    v_mfma_f32_16x16x32_bf16 v[112:115], a[112:115], v[60:63], v[112:115]
    ds_read_b64_tr_b16 v[44:45], v30 offset:45056
    v_cvt_pk_bf16_f32 v91, v94, v95
    v_mfma_f32_16x16x32_bf16 v[116:119], a[68:71], v[48:51], v[116:119]
    s_xor_b32 s79, s1, 40960
    ds_read_b64_tr_b16 v[46:47], v30 offset:45568
    v_mfma_f32_16x16x32_bf16 v[116:119], a[84:87], v[52:55], v[116:119]
    buffer_load_dwordx4 v23, s[24:27], s98 offen offset:3072   lds
    v_mfma_f32_16x16x32_bf16 v[116:119], a[100:103], v[56:59], v[116:119]
    buffer_store_dwordx4 v[88:91], v1, s[8:11], s79 offen offset:3072 sc0 sc1
    v_mfma_f32_16x16x32_bf16 v[116:119], a[116:119], v[60:63], v[116:119]
    v_mfma_f32_16x16x32_bf16 v[120:123], a[72:75], v[48:51], v[120:123]
    v_mfma_f32_16x16x32_bf16 v[120:123], a[88:91], v[52:55], v[120:123]
    v_mfma_f32_16x16x32_bf16 v[120:123], a[104:107], v[56:59], v[120:123]
    v_mfma_f32_16x16x32_bf16 v[120:123], a[120:123], v[60:63], v[120:123]
    v_mfma_f32_16x16x32_bf16 v[124:127], a[76:79], v[48:51], v[124:127]
    v_mfma_f32_16x16x32_bf16 v[124:127], a[92:95], v[52:55], v[124:127]
    ds_read_b64_tr_b16 v[48:49], v31 offset:32768
    v_mfma_f32_16x16x32_bf16 v[124:127], a[108:111], v[56:59], v[124:127]
    ds_read_b64_tr_b16 v[50:51], v31 offset:33280
    v_mfma_f32_16x16x32_bf16 v[124:127], a[124:127], v[60:63], v[124:127]
    s_waitcnt lgkmcnt(2)
    ds_read_b64_tr_b16 v[52:53], v31 offset:36864
    v_mfma_f32_16x16x32_bf16 v[64:67], a[0:3], v[32:35], 0
    ds_read_b64_tr_b16 v[54:55], v31 offset:37376
    v_mfma_f32_16x16x32_bf16 v[64:67], a[16:19], v[36:39], v[64:67]
    ds_read_b64_tr_b16 v[56:57], v31 offset:40960
    v_mfma_f32_16x16x32_bf16 v[64:67], a[32:35], v[40:43], v[64:67]
    ds_read_b64_tr_b16 v[58:59], v31 offset:41472
    v_cvt_pk_bf16_f32 v216, v216, v217
    v_mfma_f32_16x16x32_bf16 v[64:67], a[48:51], v[44:47], v[64:67]
    ds_read_b64_tr_b16 v[60:61], v31 offset:45056
    v_cvt_pk_bf16_f32 v217, v218, v219
    v_mfma_f32_16x16x32_bf16 v[68:71], a[4:7], v[32:35], 0
    ds_read_b64_tr_b16 v[62:63], v31 offset:45568
    v_cvt_pk_bf16_f32 v218, v220, v221
    v_mfma_f32_16x16x32_bf16 v[68:71], a[20:23], v[36:39], v[68:71]
    v_cvt_pk_bf16_f32 v219, v222, v223
    v_mfma_f32_16x16x32_bf16 v[68:71], a[36:39], v[40:43], v[68:71]
    s_xor_b32 s79, s65, 8192
    v_mfma_f32_16x16x32_bf16 v[68:71], a[52:55], v[44:47], v[68:71]
    buffer_store_dwordx4 v[216:219], v1, s[8:11], s79 offen offset:3072 sc0 sc1
    v_mfma_f32_16x16x32_bf16 v[72:75], a[8:11], v[32:35], 0
    v_mfma_f32_16x16x32_bf16 v[72:75], a[24:27], v[36:39], v[72:75]
    v_mfma_f32_16x16x32_bf16 v[72:75], a[40:43], v[40:43], v[72:75]
    v_mfma_f32_16x16x32_bf16 v[72:75], a[56:59], v[44:47], v[72:75]
    v_mfma_f32_16x16x32_bf16 v[76:79], a[12:15], v[32:35], 0
    v_mfma_f32_16x16x32_bf16 v[76:79], a[28:31], v[36:39], v[76:79]
    ds_read_b64_tr_b16 v[32:33], v30 offset:49152
    v_mfma_f32_16x16x32_bf16 v[76:79], a[44:47], v[40:43], v[76:79]
    ds_read_b64_tr_b16 v[34:35], v30 offset:49664
    v_mfma_f32_16x16x32_bf16 v[76:79], a[60:63], v[44:47], v[76:79]
    s_waitcnt lgkmcnt(2)
    ds_read_b64_tr_b16 v[36:37], v30 offset:53248
    v_mfma_f32_16x16x32_bf16 v[80:83], a[0:3], v[48:51], 0
    ds_read_b64_tr_b16 v[38:39], v30 offset:53760
    v_mfma_f32_16x16x32_bf16 v[80:83], a[16:19], v[52:55], v[80:83]
    ds_read_b64_tr_b16 v[40:41], v30 offset:57344
    v_mfma_f32_16x16x32_bf16 v[80:83], a[32:35], v[56:59], v[80:83]
    ds_read_b64_tr_b16 v[42:43], v30 offset:57856
    v_mfma_f32_16x16x32_bf16 v[80:83], a[48:51], v[60:63], v[80:83]
    ds_read_b64_tr_b16 v[44:45], v30 offset:61440
    v_mfma_f32_16x16x32_bf16 v[84:87], a[4:7], v[48:51], 0
    ds_read_b64_tr_b16 v[46:47], v30 offset:61952
    v_mfma_f32_16x16x32_bf16 v[84:87], a[20:23], v[52:55], v[84:87]
    buffer_load_dword v3, v16, s[8:11], s78 offen sc0 sc1
    v_mfma_f32_16x16x32_bf16 v[84:87], a[36:39], v[56:59], v[84:87]
    v_mfma_f32_16x16x32_bf16 v[84:87], a[52:55], v[60:63], v[84:87]
    v_mfma_f32_16x16x32_bf16 v[88:91], a[8:11], v[48:51], 0
    v_cvt_pk_bf16_f32 v224, v224, v225
    v_cvt_pk_bf16_f32 v225, v226, v227
    v_mfma_f32_16x16x32_bf16 v[88:91], a[24:27], v[52:55], v[88:91]
    v_cvt_pk_bf16_f32 v226, v228, v229
    v_cvt_pk_bf16_f32 v227, v230, v231
    v_mfma_f32_16x16x32_bf16 v[88:91], a[40:43], v[56:59], v[88:91]
    s_xor_b32 s79, s65, 12288
    v_mfma_f32_16x16x32_bf16 v[88:91], a[56:59], v[60:63], v[88:91]
    buffer_store_dwordx4 v[224:227], v1, s[8:11], s79 offen offset:0 sc0 sc1
    v_mfma_f32_16x16x32_bf16 v[92:95], a[12:15], v[48:51], 0
    v_mfma_f32_16x16x32_bf16 v[92:95], a[28:31], v[52:55], v[92:95]
    ds_read_b64_tr_b16 v[48:49], v31 offset:49152
    v_mfma_f32_16x16x32_bf16 v[92:95], a[44:47], v[56:59], v[92:95]
    ds_read_b64_tr_b16 v[50:51], v31 offset:49664
    v_mfma_f32_16x16x32_bf16 v[92:95], a[60:63], v[60:63], v[92:95]
    s_waitcnt lgkmcnt(2)
    ds_read_b64_tr_b16 v[52:53], v31 offset:53248
    v_mfma_f32_16x16x32_bf16 v[64:67], a[64:67], v[32:35], v[64:67]
    ds_read_b64_tr_b16 v[54:55], v31 offset:53760
    v_mfma_f32_16x16x32_bf16 v[64:67], a[80:83], v[36:39], v[64:67]
    ds_read_b64_tr_b16 v[56:57], v31 offset:57344
    v_mfma_f32_16x16x32_bf16 v[64:67], a[96:99], v[40:43], v[64:67]
    ds_read_b64_tr_b16 v[58:59], v31 offset:57856
    v_mfma_f32_16x16x32_bf16 v[64:67], a[112:115], v[44:47], v[64:67]
    ds_read_b64_tr_b16 v[60:61], v31 offset:61440
    v_mfma_f32_16x16x32_bf16 v[68:71], a[68:71], v[32:35], v[68:71]
    ds_read_b64_tr_b16 v[62:63], v31 offset:61952
    v_mfma_f32_16x16x32_bf16 v[68:71], a[84:87], v[36:39], v[68:71]
    v_mfma_f32_16x16x32_bf16 v[68:71], a[100:103], v[40:43], v[68:71]
    v_mfma_f32_16x16x32_bf16 v[68:71], a[116:119], v[44:47], v[68:71]
    v_mfma_f32_16x16x32_bf16 v[72:75], a[72:75], v[32:35], v[72:75]
    v_mfma_f32_16x16x32_bf16 v[72:75], a[88:91], v[36:39], v[72:75]
    v_mfma_f32_16x16x32_bf16 v[72:75], a[104:107], v[40:43], v[72:75]
    v_mfma_f32_16x16x32_bf16 v[72:75], a[120:123], v[44:47], v[72:75]
    v_mfma_f32_16x16x32_bf16 v[76:79], a[76:79], v[32:35], v[76:79]
    v_mfma_f32_16x16x32_bf16 v[76:79], a[92:95], v[36:39], v[76:79]
    v_mfma_f32_16x16x32_bf16 v[76:79], a[108:111], v[40:43], v[76:79]
    v_xor_b32 v28, 65536, v28
    v_cvt_pk_bf16_f32 v232, v232, v233
    s_waitcnt vmcnt(29) lgkmcnt(0)
    s_barrier
    v_mfma_f32_16x16x32_bf16 v[76:79], a[124:127], v[44:47], v[76:79]
    s_add_u32 m0, s63, 32768
    s_xor_b32 s98, s0, 3145728
    ds_read_b64_tr_b16 v[32:33], v28 offset:0
    v_mfma_f32_16x16x32_bf16 v[80:83], a[64:67], v[48:51], v[80:83]
    ds_read_b64_tr_b16 v[34:35], v28 offset:512
    v_cvt_pk_bf16_f32 v233, v234, v235
    v_mfma_f32_16x16x32_bf16 v[80:83], a[80:83], v[52:55], v[80:83]
    ds_read_b64_tr_b16 v[36:37], v28 offset:4096
    v_cvt_pk_bf16_f32 v234, v236, v237
    v_mfma_f32_16x16x32_bf16 v[80:83], a[96:99], v[56:59], v[80:83]
    ds_read_b64_tr_b16 v[38:39], v28 offset:4608
    v_cvt_pk_bf16_f32 v235, v238, v239
    v_mfma_f32_16x16x32_bf16 v[80:83], a[112:115], v[60:63], v[80:83]
    s_xor_b32 s79, s65, 12288
    ds_read_b64_tr_b16 v[40:41], v28 offset:8192
    v_mfma_f32_16x16x32_bf16 v[84:87], a[68:71], v[48:51], v[84:87]
    ds_read_b64_tr_b16 v[42:43], v28 offset:8704
    v_mfma_f32_16x16x32_bf16 v[84:87], a[84:87], v[52:55], v[84:87]
    ds_read_b64_tr_b16 v[44:45], v28 offset:12288
    v_mfma_f32_16x16x32_bf16 v[84:87], a[100:103], v[56:59], v[84:87]
    ds_read_b64_tr_b16 v[46:47], v28 offset:12800
    v_mfma_f32_16x16x32_bf16 v[84:87], a[116:119], v[60:63], v[84:87]
    buffer_load_dwordx4 v20, s[24:27], s98 offen offset:0   lds
    v_mfma_f32_16x16x32_bf16 v[88:91], a[72:75], v[48:51], v[88:91]
    buffer_store_dwordx4 v[232:235], v1, s[8:11], s79 offen offset:1024 sc0 sc1
    v_mfma_f32_16x16x32_bf16 v[88:91], a[88:91], v[52:55], v[88:91]
    v_mfma_f32_16x16x32_bf16 v[88:91], a[104:107], v[56:59], v[88:91]
    v_mfma_f32_16x16x32_bf16 v[88:91], a[120:123], v[60:63], v[88:91]
    v_mfma_f32_16x16x32_bf16 v[92:95], a[76:79], v[48:51], v[92:95]
    v_xor_b32 v29, 65536, v29
    v_mfma_f32_16x16x32_bf16 v[92:95], a[92:95], v[52:55], v[92:95]
    ds_read_b64_tr_b16 v[48:49], v29 offset:0
    v_mfma_f32_16x16x32_bf16 v[92:95], a[108:111], v[56:59], v[92:95]
    ds_read_b64_tr_b16 v[50:51], v29 offset:512
    v_mfma_f32_16x16x32_bf16 v[92:95], a[124:127], v[60:63], v[92:95]
    s_waitcnt lgkmcnt(3)
    ds_read_b64_tr_b16 v[52:53], v29 offset:4096
    v_mfma_f32_16x16x32_bf16 v[96:99], a[128:131], v[32:35], v[96:99]
    ds_read_b64_tr_b16 v[54:55], v29 offset:4608
    s_waitcnt vmcnt(3)
    v_cmp_ne_u32 vcc, 0, v3
    s_cmp_eq_u64 vcc, -1
    s_cbranch_scc0 L_H_slow_3
L_H_ok_4:
    v_mfma_f32_16x16x32_bf16 v[96:99], a[144:147], v[36:39], v[96:99]
    ds_read_b64_tr_b16 v[56:57], v29 offset:8192
    v_mfma_f32_16x16x32_bf16 v[96:99], a[160:163], v[40:43], v[96:99]
    s_waitcnt lgkmcnt(5)
    s_xor_b32 s80, s75, 0
    ds_read_b64_tr_b16 v[58:59], v29 offset:8704
    v_mfma_f32_16x16x32_bf16 v[96:99], a[176:179], v[44:47], v[96:99]
    ds_read_b64_tr_b16 v[60:61], v29 offset:12288
    v_mfma_f32_16x16x32_bf16 v[100:103], a[132:135], v[32:35], v[100:103]
    ds_read_b64_tr_b16 v[62:63], v29 offset:12800
    v_cvt_pk_bf16_f32 v240, v240, v241
    v_mfma_f32_16x16x32_bf16 v[100:103], a[148:151], v[36:39], v[100:103]
    buffer_load_dwordx4 v21, s[24:27], s98 offen offset:1024   lds
    v_mfma_f32_16x16x32_bf16 v[100:103], a[164:167], v[40:43], v[100:103]
    v_cvt_pk_bf16_f32 v241, v242, v243
    v_cvt_pk_bf16_f32 v242, v244, v245
    v_mfma_f32_16x16x32_bf16 v[100:103], a[180:183], v[44:47], v[100:103]
    v_cvt_pk_bf16_f32 v243, v246, v247
    v_mfma_f32_16x16x32_bf16 v[104:107], a[136:139], v[32:35], v[104:107]
    s_xor_b32 s79, s65, 12288
    v_mfma_f32_16x16x32_bf16 v[104:107], a[152:155], v[36:39], v[104:107]
    buffer_store_dwordx4 v[240:243], v1, s[8:11], s79 offen offset:2048 sc0 sc1
    v_mfma_f32_16x16x32_bf16 v[104:107], a[168:171], v[40:43], v[104:107]
    buffer_load_dwordx4 a[0:3], v1, s[8:11], s80 offen offset:0
    v_mfma_f32_16x16x32_bf16 v[104:107], a[184:187], v[44:47], v[104:107]
    buffer_load_dwordx4 v22, s[24:27], s98 offen offset:2048   lds
    v_mfma_f32_16x16x32_bf16 v[108:111], a[140:143], v[32:35], v[108:111]
    v_mfma_f32_16x16x32_bf16 v[108:111], a[156:159], v[36:39], v[108:111]
    s_xor_b32 s80, s75, 16384
    ds_read_b64_tr_b16 v[32:33], v28 offset:16384
    v_mfma_f32_16x16x32_bf16 v[108:111], a[172:175], v[40:43], v[108:111]
    ds_read_b64_tr_b16 v[34:35], v28 offset:16896
    v_mfma_f32_16x16x32_bf16 v[108:111], a[188:191], v[44:47], v[108:111]
    s_waitcnt lgkmcnt(2)
    ds_read_b64_tr_b16 v[36:37], v28 offset:20480
    v_mfma_f32_16x16x32_bf16 v[112:115], a[128:131], v[48:51], v[112:115]
    ds_read_b64_tr_b16 v[38:39], v28 offset:20992
    v_mfma_f32_16x16x32_bf16 v[112:115], a[144:147], v[52:55], v[112:115]
    ds_read_b64_tr_b16 v[40:41], v28 offset:24576
    v_mfma_f32_16x16x32_bf16 v[112:115], a[160:163], v[56:59], v[112:115]
    ds_read_b64_tr_b16 v[42:43], v28 offset:25088
    v_mfma_f32_16x16x32_bf16 v[112:115], a[176:179], v[60:63], v[112:115]
    ds_read_b64_tr_b16 v[44:45], v28 offset:28672
    v_mfma_f32_16x16x32_bf16 v[116:119], a[132:135], v[48:51], v[116:119]
    ds_read_b64_tr_b16 v[46:47], v28 offset:29184
    v_mfma_f32_16x16x32_bf16 v[116:119], a[148:151], v[52:55], v[116:119]
    buffer_load_dwordx4 v23, s[24:27], s98 offen offset:3072   lds
    v_mfma_f32_16x16x32_bf16 v[116:119], a[164:167], v[56:59], v[116:119]
    s_add_u32 m0, s63, 49152
    s_xor_b32 s98, s0, 3670016
    v_mfma_f32_16x16x32_bf16 v[116:119], a[180:183], v[60:63], v[116:119]
    buffer_load_dwordx4 a[4:7], v1, s[8:11], s80 offen offset:0
    v_mfma_f32_16x16x32_bf16 v[120:123], a[136:139], v[48:51], v[120:123]
    v_mfma_f32_16x16x32_bf16 v[120:123], a[152:155], v[52:55], v[120:123]
    v_mfma_f32_16x16x32_bf16 v[120:123], a[168:171], v[56:59], v[120:123]
    s_xor_b32 s80, s76, 0
    v_cvt_pk_bf16_f32 v248, v248, v249
    v_cvt_pk_bf16_f32 v249, v250, v251
    v_mfma_f32_16x16x32_bf16 v[120:123], a[184:187], v[60:63], v[120:123]
    buffer_load_dwordx4 v20, s[24:27], s98 offen offset:0   lds
    v_mfma_f32_16x16x32_bf16 v[124:127], a[140:143], v[48:51], v[124:127]
    v_cvt_pk_bf16_f32 v250, v252, v253
    v_cvt_pk_bf16_f32 v251, v254, v255
    v_mfma_f32_16x16x32_bf16 v[124:127], a[156:159], v[52:55], v[124:127]
    s_xor_b32 s79, s65, 12288
    ds_read_b64_tr_b16 v[48:49], v29 offset:16384
    v_mfma_f32_16x16x32_bf16 v[124:127], a[172:175], v[56:59], v[124:127]
    ds_read_b64_tr_b16 v[50:51], v29 offset:16896
    v_mfma_f32_16x16x32_bf16 v[124:127], a[188:191], v[60:63], v[124:127]
    s_waitcnt lgkmcnt(2)
    ds_read_b64_tr_b16 v[52:53], v29 offset:20480
    v_mfma_f32_16x16x32_bf16 v[96:99], a[192:195], v[32:35], v[96:99]
    ds_read_b64_tr_b16 v[54:55], v29 offset:20992
    v_mfma_f32_16x16x32_bf16 v[96:99], a[208:211], v[36:39], v[96:99]
    ds_read_b64_tr_b16 v[56:57], v29 offset:24576
    v_mfma_f32_16x16x32_bf16 v[96:99], a[224:227], v[40:43], v[96:99]
    ds_read_b64_tr_b16 v[58:59], v29 offset:25088
    v_mfma_f32_16x16x32_bf16 v[96:99], a[240:243], v[44:47], v[96:99]
    ds_read_b64_tr_b16 v[60:61], v29 offset:28672
    v_mfma_f32_16x16x32_bf16 v[100:103], a[196:199], v[32:35], v[100:103]
    ds_read_b64_tr_b16 v[62:63], v29 offset:29184
    v_mfma_f32_16x16x32_bf16 v[100:103], a[212:215], v[36:39], v[100:103]
    buffer_load_dwordx4 v21, s[24:27], s98 offen offset:1024   lds
    v_mfma_f32_16x16x32_bf16 v[100:103], a[228:231], v[40:43], v[100:103]
    buffer_store_dwordx4 v[248:251], v1, s[8:11], s79 offen offset:3072 sc0 sc1
    v_mfma_f32_16x16x32_bf16 v[100:103], a[244:247], v[44:47], v[100:103]
    buffer_load_dwordx4 a[8:11], v1, s[8:11], s80 offen offset:0
    v_mfma_f32_16x16x32_bf16 v[104:107], a[200:203], v[32:35], v[104:107]
    s_xor_b32 s80, s76, 16384
    v_mfma_f32_16x16x32_bf16 v[104:107], a[216:219], v[36:39], v[104:107]
    buffer_load_dwordx4 a[12:15], v1, s[8:11], s80 offen offset:0
    v_mfma_f32_16x16x32_bf16 v[104:107], a[232:235], v[40:43], v[104:107]
    v_mfma_f32_16x16x32_bf16 v[104:107], a[248:251], v[44:47], v[104:107]
    buffer_load_dwordx4 v22, s[24:27], s98 offen offset:2048   lds
    v_mfma_f32_16x16x32_bf16 v[108:111], a[204:207], v[32:35], v[108:111]
    s_xor_b32 s80, s75, 0
    v_xor_b32 v30, 65536, v30
    v_mfma_f32_16x16x32_bf16 v[108:111], a[220:223], v[36:39], v[108:111]
    ds_read_b64_tr_b16 v[32:33], v30 offset:0
    v_mfma_f32_16x16x32_bf16 v[108:111], a[236:239], v[40:43], v[108:111]
    ds_read_b64_tr_b16 v[34:35], v30 offset:512
    v_mfma_f32_16x16x32_bf16 v[108:111], a[252:255], v[44:47], v[108:111]
    s_waitcnt lgkmcnt(2)
    ds_read_b64_tr_b16 v[36:37], v30 offset:4096
    v_mfma_f32_16x16x32_bf16 v[112:115], a[192:195], v[48:51], v[112:115]
    ds_read_b64_tr_b16 v[38:39], v30 offset:4608
    v_mfma_f32_16x16x32_bf16 v[112:115], a[208:211], v[52:55], v[112:115]
    ds_read_b64_tr_b16 v[40:41], v30 offset:8192
    v_mfma_f32_16x16x32_bf16 v[112:115], a[224:227], v[56:59], v[112:115]
    ds_read_b64_tr_b16 v[42:43], v30 offset:8704
    v_mfma_f32_16x16x32_bf16 v[112:115], a[240:243], v[60:63], v[112:115]
    ds_read_b64_tr_b16 v[44:45], v30 offset:12288
    v_mfma_f32_16x16x32_bf16 v[116:119], a[196:199], v[48:51], v[116:119]
    ds_read_b64_tr_b16 v[46:47], v30 offset:12800
    v_mfma_f32_16x16x32_bf16 v[116:119], a[212:215], v[52:55], v[116:119]
    buffer_load_dwordx4 v23, s[24:27], s98 offen offset:3072   lds
    v_mfma_f32_16x16x32_bf16 v[116:119], a[228:231], v[56:59], v[116:119]
    buffer_load_dwordx4 a[16:19], v1, s[8:11], s80 offen offset:1024
    v_mfma_f32_16x16x32_bf16 v[116:119], a[244:247], v[60:63], v[116:119]
    s_xor_b32 s80, s75, 16384
    v_mfma_f32_16x16x32_bf16 v[120:123], a[200:203], v[48:51], v[120:123]
    buffer_load_dwordx4 a[20:23], v1, s[8:11], s80 offen offset:1024
    v_mfma_f32_16x16x32_bf16 v[120:123], a[216:219], v[52:55], v[120:123]
    s_xor_b32 s80, s76, 0
    v_mfma_f32_16x16x32_bf16 v[120:123], a[232:235], v[56:59], v[120:123]
    buffer_load_dwordx4 a[24:27], v1, s[8:11], s80 offen offset:1024
    v_mfma_f32_16x16x32_bf16 v[120:123], a[248:251], v[60:63], v[120:123]
    v_mfma_f32_16x16x32_bf16 v[124:127], a[204:207], v[48:51], v[124:127]
    s_xor_b32 s80, s76, 16384
    v_xor_b32 v31, 65536, v31
    v_mfma_f32_16x16x32_bf16 v[124:127], a[220:223], v[52:55], v[124:127]
    ds_read_b64_tr_b16 v[48:49], v31 offset:0
    v_mfma_f32_16x16x32_bf16 v[124:127], a[236:239], v[56:59], v[124:127]
    ds_read_b64_tr_b16 v[50:51], v31 offset:512
    v_mfma_f32_16x16x32_bf16 v[124:127], a[252:255], v[60:63], v[124:127]
    s_waitcnt lgkmcnt(2)
    ds_read_b64_tr_b16 v[52:53], v31 offset:4096
    v_mfma_f32_16x16x32_bf16 v[64:67], a[128:131], v[32:35], v[64:67]
    ds_read_b64_tr_b16 v[54:55], v31 offset:4608
    v_mfma_f32_16x16x32_bf16 v[64:67], a[144:147], v[36:39], v[64:67]
    ds_read_b64_tr_b16 v[56:57], v31 offset:8192
    v_mfma_f32_16x16x32_bf16 v[64:67], a[160:163], v[40:43], v[64:67]
    ds_read_b64_tr_b16 v[58:59], v31 offset:8704
    v_mfma_f32_16x16x32_bf16 v[64:67], a[176:179], v[44:47], v[64:67]
    ds_read_b64_tr_b16 v[60:61], v31 offset:12288
    v_mfma_f32_16x16x32_bf16 v[68:71], a[132:135], v[32:35], v[68:71]
    ds_read_b64_tr_b16 v[62:63], v31 offset:12800
    v_mfma_f32_16x16x32_bf16 v[68:71], a[148:151], v[36:39], v[68:71]
    buffer_load_dwordx4 a[28:31], v1, s[8:11], s80 offen offset:1024
    v_mfma_f32_16x16x32_bf16 v[68:71], a[164:167], v[40:43], v[68:71]
    s_xor_b32 s80, s75, 2048
    v_cvt_pk_bf16_f32 v96, v96, v97
    v_cvt_pk_bf16_f32 v97, v98, v99
    v_mfma_f32_16x16x32_bf16 v[68:71], a[180:183], v[44:47], v[68:71]
    v_cvt_pk_bf16_f32 v98, v100, v101
    v_cvt_pk_bf16_f32 v99, v102, v103
    v_mfma_f32_16x16x32_bf16 v[72:75], a[136:139], v[32:35], v[72:75]
    s_xor_b32 s79, s1, 36864
    v_mfma_f32_16x16x32_bf16 v[72:75], a[152:155], v[36:39], v[72:75]
    buffer_store_dwordx4 v[96:99], v1, s[8:11], s79 offen offset:0 sc0 sc1
    v_mfma_f32_16x16x32_bf16 v[72:75], a[168:171], v[40:43], v[72:75]
    buffer_load_dwordx4 a[32:35], v1, s[8:11], s80 offen offset:0
    v_mfma_f32_16x16x32_bf16 v[72:75], a[184:187], v[44:47], v[72:75]
    v_mfma_f32_16x16x32_bf16 v[76:79], a[140:143], v[32:35], v[76:79]
    v_mfma_f32_16x16x32_bf16 v[76:79], a[156:159], v[36:39], v[76:79]
    s_xor_b32 s80, s75, 18432
    ds_read_b64_tr_b16 v[32:33], v30 offset:16384
    v_mfma_f32_16x16x32_bf16 v[76:79], a[172:175], v[40:43], v[76:79]
    ds_read_b64_tr_b16 v[34:35], v30 offset:16896
    v_mfma_f32_16x16x32_bf16 v[76:79], a[188:191], v[44:47], v[76:79]
    s_waitcnt lgkmcnt(2)
    ds_read_b64_tr_b16 v[36:37], v30 offset:20480
    v_mfma_f32_16x16x32_bf16 v[80:83], a[128:131], v[48:51], v[80:83]
    ds_read_b64_tr_b16 v[38:39], v30 offset:20992
    v_mfma_f32_16x16x32_bf16 v[80:83], a[144:147], v[52:55], v[80:83]
    ds_read_b64_tr_b16 v[40:41], v30 offset:24576
    v_mfma_f32_16x16x32_bf16 v[80:83], a[160:163], v[56:59], v[80:83]
    ds_read_b64_tr_b16 v[42:43], v30 offset:25088
    v_mfma_f32_16x16x32_bf16 v[80:83], a[176:179], v[60:63], v[80:83]
    ds_read_b64_tr_b16 v[44:45], v30 offset:28672
    v_mfma_f32_16x16x32_bf16 v[84:87], a[132:135], v[48:51], v[84:87]
    ds_read_b64_tr_b16 v[46:47], v30 offset:29184
    v_mfma_f32_16x16x32_bf16 v[84:87], a[148:151], v[52:55], v[84:87]
    buffer_load_dwordx4 a[36:39], v1, s[8:11], s80 offen offset:0
    v_mfma_f32_16x16x32_bf16 v[84:87], a[164:167], v[56:59], v[84:87]
    s_xor_b32 s80, s76, 2048
    v_cvt_pk_bf16_f32 v104, v104, v105
    v_cvt_pk_bf16_f32 v105, v106, v107
    v_mfma_f32_16x16x32_bf16 v[84:87], a[180:183], v[60:63], v[84:87]
    v_cvt_pk_bf16_f32 v106, v108, v109
    v_cvt_pk_bf16_f32 v107, v110, v111
    v_mfma_f32_16x16x32_bf16 v[88:91], a[136:139], v[48:51], v[88:91]
    s_xor_b32 s79, s1, 45056
    v_mfma_f32_16x16x32_bf16 v[88:91], a[152:155], v[52:55], v[88:91]
    buffer_store_dwordx4 v[104:107], v1, s[8:11], s79 offen offset:0 sc0 sc1
    v_mfma_f32_16x16x32_bf16 v[88:91], a[168:171], v[56:59], v[88:91]
    buffer_load_dwordx4 a[40:43], v1, s[8:11], s80 offen offset:0
    v_mfma_f32_16x16x32_bf16 v[88:91], a[184:187], v[60:63], v[88:91]
    v_mfma_f32_16x16x32_bf16 v[92:95], a[140:143], v[48:51], v[92:95]
    v_mfma_f32_16x16x32_bf16 v[92:95], a[156:159], v[52:55], v[92:95]
    s_xor_b32 s80, s76, 18432
    ds_read_b64_tr_b16 v[48:49], v31 offset:16384
    v_mfma_f32_16x16x32_bf16 v[92:95], a[172:175], v[56:59], v[92:95]
    ds_read_b64_tr_b16 v[50:51], v31 offset:16896
    v_mfma_f32_16x16x32_bf16 v[92:95], a[188:191], v[60:63], v[92:95]
    s_waitcnt lgkmcnt(2)
    ds_read_b64_tr_b16 v[52:53], v31 offset:20480
    v_mfma_f32_16x16x32_bf16 v[64:67], a[192:195], v[32:35], v[64:67]
    ds_read_b64_tr_b16 v[54:55], v31 offset:20992
    v_mfma_f32_16x16x32_bf16 v[64:67], a[208:211], v[36:39], v[64:67]
    ds_read_b64_tr_b16 v[56:57], v31 offset:24576
    v_mfma_f32_16x16x32_bf16 v[64:67], a[224:227], v[40:43], v[64:67]
    ds_read_b64_tr_b16 v[58:59], v31 offset:25088
    v_mfma_f32_16x16x32_bf16 v[64:67], a[240:243], v[44:47], v[64:67]
    ds_read_b64_tr_b16 v[60:61], v31 offset:28672
    v_mfma_f32_16x16x32_bf16 v[68:71], a[196:199], v[32:35], v[68:71]
    ds_read_b64_tr_b16 v[62:63], v31 offset:29184
    v_mfma_f32_16x16x32_bf16 v[68:71], a[212:215], v[36:39], v[68:71]
    buffer_load_dwordx4 a[44:47], v1, s[8:11], s80 offen offset:0
    v_mfma_f32_16x16x32_bf16 v[68:71], a[228:231], v[40:43], v[68:71]
    s_xor_b32 s80, s75, 2048
    v_cvt_pk_bf16_f32 v112, v112, v113
    v_cvt_pk_bf16_f32 v113, v114, v115
    v_mfma_f32_16x16x32_bf16 v[68:71], a[244:247], v[44:47], v[68:71]
    v_cvt_pk_bf16_f32 v114, v116, v117
    v_cvt_pk_bf16_f32 v115, v118, v119
    v_mfma_f32_16x16x32_bf16 v[72:75], a[200:203], v[32:35], v[72:75]
    s_xor_b32 s79, s1, 36864
    v_mfma_f32_16x16x32_bf16 v[72:75], a[216:219], v[36:39], v[72:75]
    buffer_store_dwordx4 v[112:115], v1, s[8:11], s79 offen offset:1024 sc0 sc1
    v_mfma_f32_16x16x32_bf16 v[72:75], a[232:235], v[40:43], v[72:75]
    buffer_load_dwordx4 a[48:51], v1, s[8:11], s80 offen offset:1024
    v_mfma_f32_16x16x32_bf16 v[72:75], a[248:251], v[44:47], v[72:75]
    s_xor_b32 s80, s75, 18432
    v_mfma_f32_16x16x32_bf16 v[76:79], a[204:207], v[32:35], v[76:79]
    buffer_load_dwordx4 a[52:55], v1, s[8:11], s80 offen offset:1024
    v_mfma_f32_16x16x32_bf16 v[76:79], a[220:223], v[36:39], v[76:79]
    v_mfma_f32_16x16x32_bf16 v[76:79], a[236:239], v[40:43], v[76:79]
    s_xor_b32 s80, s76, 2048
    s_waitcnt lgkmcnt(0)
    s_barrier
    v_mfma_f32_16x16x32_bf16 v[76:79], a[252:255], v[44:47], v[76:79]
    ds_read_b64_tr_b16 v[32:33], v8 offset:32768
    v_mfma_f32_16x16x32_bf16 v[80:83], a[192:195], v[48:51], v[80:83]
    ds_read_b64_tr_b16 v[34:35], v8 offset:33792
    v_mfma_f32_16x16x32_bf16 v[80:83], a[208:211], v[52:55], v[80:83]
    ds_read_b64_tr_b16 v[36:37], v9 offset:32768
    v_mfma_f32_16x16x32_bf16 v[80:83], a[224:227], v[56:59], v[80:83]
    ds_read_b64_tr_b16 v[38:39], v9 offset:33792
    v_mfma_f32_16x16x32_bf16 v[80:83], a[240:243], v[60:63], v[80:83]
    ds_read_b64_tr_b16 v[40:41], v10 offset:32768
    v_mfma_f32_16x16x32_bf16 v[84:87], a[196:199], v[48:51], v[84:87]
    ds_read_b64_tr_b16 v[42:43], v10 offset:33792
    v_mfma_f32_16x16x32_bf16 v[84:87], a[212:215], v[52:55], v[84:87]
    ds_read_b64_tr_b16 v[44:45], v11 offset:32768
    v_mfma_f32_16x16x32_bf16 v[84:87], a[228:231], v[56:59], v[84:87]
    ds_read_b64_tr_b16 v[46:47], v11 offset:33792
    v_cvt_pk_bf16_f32 v120, v120, v121
    v_mfma_f32_16x16x32_bf16 v[84:87], a[244:247], v[60:63], v[84:87]
    v_cvt_pk_bf16_f32 v121, v122, v123
    v_cvt_pk_bf16_f32 v122, v124, v125
    v_mfma_f32_16x16x32_bf16 v[88:91], a[200:203], v[48:51], v[88:91]
    v_cvt_pk_bf16_f32 v123, v126, v127
    v_mfma_f32_16x16x32_bf16 v[88:91], a[216:219], v[52:55], v[88:91]
    s_xor_b32 s79, s1, 45056
    v_mfma_f32_16x16x32_bf16 v[88:91], a[232:235], v[56:59], v[88:91]
    buffer_store_dwordx4 v[120:123], v1, s[8:11], s79 offen offset:1024 sc0 sc1
    v_mfma_f32_16x16x32_bf16 v[88:91], a[248:251], v[60:63], v[88:91]
    buffer_load_dwordx4 a[56:59], v1, s[8:11], s80 offen offset:1024
    v_mfma_f32_16x16x32_bf16 v[92:95], a[204:207], v[48:51], v[92:95]
    v_mfma_f32_16x16x32_bf16 v[92:95], a[220:223], v[52:55], v[92:95]
    s_xor_b32 s80, s76, 18432
    ds_read_b64_tr_b16 v[48:49], v12 offset:32768
    v_mfma_f32_16x16x32_bf16 v[92:95], a[236:239], v[56:59], v[92:95]
    ds_read_b64_tr_b16 v[50:51], v12 offset:33792
    v_mfma_f32_16x16x32_bf16 v[92:95], a[252:255], v[60:63], v[92:95]
    s_waitcnt vmcnt(25) lgkmcnt(3)
    ds_read_b64_tr_b16 v[52:53], v13 offset:32768
    v_mfma_f32_16x16x32_bf16 v[128:131], v[32:35], a[0:3], 0
    s_waitcnt vmcnt(22)
    ds_read_b64_tr_b16 v[54:55], v13 offset:33792
    v_mfma_f32_16x16x32_bf16 v[160:163], v[32:35], a[4:7], 0
    s_waitcnt vmcnt(18)
    ds_read_b64_tr_b16 v[56:57], v14 offset:32768
    v_mfma_f32_16x16x32_bf16 v[192:195], v[32:35], a[8:11], 0
    s_waitcnt vmcnt(17)
    ds_read_b64_tr_b16 v[58:59], v14 offset:33792
    v_mfma_f32_16x16x32_bf16 v[224:227], v[32:35], a[12:15], 0
    ds_read_b64_tr_b16 v[60:61], v15 offset:32768
    v_mfma_f32_16x16x32_bf16 v[132:135], v[36:39], a[0:3], 0
    ds_read_b64_tr_b16 v[62:63], v15 offset:33792
    v_mfma_f32_16x16x32_bf16 v[164:167], v[36:39], a[4:7], 0
    ds_read_b64_tr_b16 v[32:33], v8 offset:40960
    v_mfma_f32_16x16x32_bf16 v[196:199], v[36:39], a[8:11], 0
    ds_read_b64_tr_b16 v[34:35], v8 offset:41984
    v_cvt_pk_bf16_f32 v64, v64, v65
    v_mfma_f32_16x16x32_bf16 v[228:231], v[36:39], a[12:15], 0
    buffer_load_dwordx4 a[60:63], v1, s[8:11], s80 offen offset:1024
    v_mfma_f32_16x16x32_bf16 v[136:139], v[40:43], a[0:3], 0
    s_xor_b32 s80, s75, 4096
    ds_read_b64_tr_b16 v[36:37], v9 offset:40960
    v_cvt_pk_bf16_f32 v65, v66, v67
    v_mfma_f32_16x16x32_bf16 v[168:171], v[40:43], a[4:7], 0
    ds_read_b64_tr_b16 v[38:39], v9 offset:41984
    v_cvt_pk_bf16_f32 v66, v68, v69
    v_mfma_f32_16x16x32_bf16 v[200:203], v[40:43], a[8:11], 0
    s_waitcnt lgkmcnt(8)
    v_cvt_pk_bf16_f32 v67, v70, v71
    v_mfma_f32_16x16x32_bf16 v[232:235], v[40:43], a[12:15], 0
    buffer_load_dwordx4 a[64:67], v1, s[8:11], s80 offen offset:0
    v_mfma_f32_16x16x32_bf16 v[140:143], v[44:47], a[0:3], 0
    s_xor_b32 s79, s1, 36864
    s_xor_b32 s80, s75, 20480
    ds_read_b64_tr_b16 v[40:41], v10 offset:40960
    v_mfma_f32_16x16x32_bf16 v[172:175], v[44:47], a[4:7], 0
    ds_read_b64_tr_b16 v[42:43], v10 offset:41984
    v_mfma_f32_16x16x32_bf16 v[204:207], v[44:47], a[8:11], 0
    buffer_store_dwordx4 v[64:67], v1, s[8:11], s79 offen offset:2048 sc0 sc1
    v_mfma_f32_16x16x32_bf16 v[236:239], v[44:47], a[12:15], 0
    buffer_load_dwordx4 a[68:71], v1, s[8:11], s80 offen offset:0
    v_mfma_f32_16x16x32_bf16 v[144:147], v[48:51], a[0:3], 0
    s_xor_b32 s80, s76, 4096
    ds_read_b64_tr_b16 v[44:45], v11 offset:40960
    v_mfma_f32_16x16x32_bf16 v[176:179], v[48:51], a[4:7], 0
    ds_read_b64_tr_b16 v[46:47], v11 offset:41984
    v_mfma_f32_16x16x32_bf16 v[208:211], v[48:51], a[8:11], 0
    buffer_load_dwordx4 a[72:75], v1, s[8:11], s80 offen offset:0
    v_mfma_f32_16x16x32_bf16 v[240:243], v[48:51], a[12:15], 0
    v_mfma_f32_16x16x32_bf16 v[148:151], v[52:55], a[0:3], 0
    s_xor_b32 s80, s76, 20480
    ds_read_b64_tr_b16 v[48:49], v12 offset:40960
    v_mfma_f32_16x16x32_bf16 v[180:183], v[52:55], a[4:7], 0
    ds_read_b64_tr_b16 v[50:51], v12 offset:41984
    v_mfma_f32_16x16x32_bf16 v[212:215], v[52:55], a[8:11], 0
    buffer_load_dwordx4 a[76:79], v1, s[8:11], s80 offen offset:0
    v_mfma_f32_16x16x32_bf16 v[244:247], v[52:55], a[12:15], 0
    s_waitcnt lgkmcnt(4)
    v_mfma_f32_16x16x32_bf16 v[152:155], v[56:59], a[0:3], 0
    s_xor_b32 s80, s75, 4096
    ds_read_b64_tr_b16 v[52:53], v13 offset:40960
    v_cvt_pk_bf16_f32 v72, v72, v73
    v_mfma_f32_16x16x32_bf16 v[184:187], v[56:59], a[4:7], 0
    ds_read_b64_tr_b16 v[54:55], v13 offset:41984
    v_cvt_pk_bf16_f32 v73, v74, v75
    v_mfma_f32_16x16x32_bf16 v[216:219], v[56:59], a[8:11], 0
    v_cvt_pk_bf16_f32 v74, v76, v77
    v_cvt_pk_bf16_f32 v75, v78, v79
    v_mfma_f32_16x16x32_bf16 v[248:251], v[56:59], a[12:15], 0
    buffer_load_dwordx4 a[80:83], v1, s[8:11], s80 offen offset:1024
    v_mfma_f32_16x16x32_bf16 v[156:159], v[60:63], a[0:3], 0
    s_xor_b32 s79, s1, 45056
    s_xor_b32 s80, s75, 20480
    ds_read_b64_tr_b16 v[56:57], v14 offset:40960
    v_mfma_f32_16x16x32_bf16 v[188:191], v[60:63], a[4:7], 0
    s_waitcnt vmcnt(21)
    ds_read_b64_tr_b16 v[58:59], v14 offset:41984
    v_mfma_f32_16x16x32_bf16 v[220:223], v[60:63], a[8:11], 0
    buffer_store_dwordx4 v[72:75], v1, s[8:11], s79 offen offset:2048 sc0 sc1
    v_mfma_f32_16x16x32_bf16 v[252:255], v[60:63], a[12:15], 0
    buffer_load_dwordx4 a[84:87], v1, s[8:11], s80 offen offset:1024
    v_mfma_f32_16x16x32_bf16 v[128:131], v[32:35], a[16:19], v[128:131]
    s_waitcnt vmcnt(22)
    s_xor_b32 s80, s76, 4096
    ds_read_b64_tr_b16 v[60:61], v15 offset:40960
    v_mfma_f32_16x16x32_bf16 v[160:163], v[32:35], a[20:23], v[160:163]
    s_waitcnt vmcnt(20)
    ds_read_b64_tr_b16 v[62:63], v15 offset:41984
    v_mfma_f32_16x16x32_bf16 v[192:195], v[32:35], a[24:27], v[192:195]
    buffer_load_dwordx4 a[88:91], v1, s[8:11], s80 offen offset:1024
    v_mfma_f32_16x16x32_bf16 v[224:227], v[32:35], a[28:31], v[224:227]
    v_mfma_f32_16x16x32_bf16 v[132:135], v[36:39], a[16:19], v[132:135]
    s_xor_b32 s80, s76, 20480
    ds_read_b64_tr_b16 v[32:33], v8 offset:0
    v_mfma_f32_16x16x32_bf16 v[164:167], v[36:39], a[20:23], v[164:167]
    ds_read_b64_tr_b16 v[34:35], v8 offset:1024
    v_mfma_f32_16x16x32_bf16 v[196:199], v[36:39], a[24:27], v[196:199]
    buffer_load_dwordx4 a[92:95], v1, s[8:11], s80 offen offset:1024
    v_mfma_f32_16x16x32_bf16 v[228:231], v[36:39], a[28:31], v[228:231]
    v_mfma_f32_16x16x32_bf16 v[136:139], v[40:43], a[16:19], v[136:139]
    ds_read_b64_tr_b16 v[36:37], v9 offset:0
    v_cvt_pk_bf16_f32 v80, v80, v81
    v_mfma_f32_16x16x32_bf16 v[168:171], v[40:43], a[20:23], v[168:171]
    s_xor_b32 s80, s75, 6144
    ds_read_b64_tr_b16 v[38:39], v9 offset:1024
    v_cvt_pk_bf16_f32 v81, v82, v83
    v_mfma_f32_16x16x32_bf16 v[200:203], v[40:43], a[24:27], v[200:203]
    s_waitcnt lgkmcnt(5)
    v_cvt_pk_bf16_f32 v82, v84, v85
    v_cvt_pk_bf16_f32 v83, v86, v87
    v_mfma_f32_16x16x32_bf16 v[232:235], v[40:43], a[28:31], v[232:235]
    buffer_load_dwordx4 a[96:99], v1, s[8:11], s80 offen offset:0
    v_mfma_f32_16x16x32_bf16 v[140:143], v[44:47], a[16:19], v[140:143]
    s_xor_b32 s79, s1, 36864
    ds_read_b64_tr_b16 v[40:41], v10 offset:0
    v_mfma_f32_16x16x32_bf16 v[172:175], v[44:47], a[20:23], v[172:175]
    ds_read_b64_tr_b16 v[42:43], v10 offset:1024
    v_mfma_f32_16x16x32_bf16 v[204:207], v[44:47], a[24:27], v[204:207]
    buffer_store_dwordx4 v[80:83], v1, s[8:11], s79 offen offset:3072 sc0 sc1
    v_mfma_f32_16x16x32_bf16 v[236:239], v[44:47], a[28:31], v[236:239]
    v_mfma_f32_16x16x32_bf16 v[144:147], v[48:51], a[16:19], v[144:147]
    s_xor_b32 s80, s75, 22528
    ds_read_b64_tr_b16 v[44:45], v11 offset:0
    v_mfma_f32_16x16x32_bf16 v[176:179], v[48:51], a[20:23], v[176:179]
    ds_read_b64_tr_b16 v[46:47], v11 offset:1024
    v_mfma_f32_16x16x32_bf16 v[208:211], v[48:51], a[24:27], v[208:211]
    buffer_load_dwordx4 a[100:103], v1, s[8:11], s80 offen offset:0
    v_mfma_f32_16x16x32_bf16 v[240:243], v[48:51], a[28:31], v[240:243]
    v_mfma_f32_16x16x32_bf16 v[148:151], v[52:55], a[16:19], v[148:151]
    ds_read_b64_tr_b16 v[48:49], v12 offset:0
    v_mfma_f32_16x16x32_bf16 v[180:183], v[52:55], a[20:23], v[180:183]
    ds_read_b64_tr_b16 v[50:51], v12 offset:1024
    v_mfma_f32_16x16x32_bf16 v[212:215], v[52:55], a[24:27], v[212:215]
    v_mfma_f32_16x16x32_bf16 v[244:247], v[52:55], a[28:31], v[244:247]
    v_mfma_f32_16x16x32_bf16 v[152:155], v[56:59], a[16:19], v[152:155]
    s_xor_b32 s80, s76, 6144
    ds_read_b64_tr_b16 v[52:53], v13 offset:0
    v_cvt_pk_bf16_f32 v88, v88, v89
    v_mfma_f32_16x16x32_bf16 v[184:187], v[56:59], a[20:23], v[184:187]
    ds_read_b64_tr_b16 v[54:55], v13 offset:1024
    v_cvt_pk_bf16_f32 v89, v90, v91
    v_mfma_f32_16x16x32_bf16 v[216:219], v[56:59], a[24:27], v[216:219]
    s_waitcnt lgkmcnt(5)
    v_cvt_pk_bf16_f32 v90, v92, v93
    v_cvt_pk_bf16_f32 v91, v94, v95
    v_mfma_f32_16x16x32_bf16 v[248:251], v[56:59], a[28:31], v[248:251]
    buffer_load_dwordx4 a[104:107], v1, s[8:11], s80 offen offset:0
    v_mfma_f32_16x16x32_bf16 v[156:159], v[60:63], a[16:19], v[156:159]
    s_xor_b32 s79, s1, 45056
    ds_read_b64_tr_b16 v[56:57], v14 offset:0
    v_mfma_f32_16x16x32_bf16 v[188:191], v[60:63], a[20:23], v[188:191]
    ds_read_b64_tr_b16 v[58:59], v14 offset:1024
    v_mfma_f32_16x16x32_bf16 v[220:223], v[60:63], a[24:27], v[220:223]
    buffer_store_dwordx4 v[88:91], v1, s[8:11], s79 offen offset:3072 sc0 sc1
    v_mfma_f32_16x16x32_bf16 v[252:255], v[60:63], a[28:31], v[252:255]
    s_waitcnt vmcnt(25)
    v_mfma_f32_16x16x32_bf16 v[128:131], v[32:35], a[32:35], v[128:131]
    s_waitcnt vmcnt(24)
    s_xor_b32 s80, s76, 22528
    ds_read_b64_tr_b16 v[60:61], v15 offset:0
    v_mfma_f32_16x16x32_bf16 v[160:163], v[32:35], a[36:39], v[160:163]
    s_waitcnt vmcnt(21)
    ds_read_b64_tr_b16 v[62:63], v15 offset:1024
    v_mfma_f32_16x16x32_bf16 v[192:195], v[32:35], a[40:43], v[192:195]
    buffer_load_dwordx4 a[108:111], v1, s[8:11], s80 offen offset:0
    v_mfma_f32_16x16x32_bf16 v[224:227], v[32:35], a[44:47], v[224:227]
    v_mfma_f32_16x16x32_bf16 v[132:135], v[36:39], a[32:35], v[132:135]
    ds_read_b64_tr_b16 v[32:33], v8 offset:8192
    v_mfma_f32_16x16x32_bf16 v[164:167], v[36:39], a[36:39], v[164:167]
    s_xor_b32 s80, s75, 6144
    ds_read_b64_tr_b16 v[34:35], v8 offset:9216
    v_mfma_f32_16x16x32_bf16 v[196:199], v[36:39], a[40:43], v[196:199]
    buffer_load_dwordx4 a[112:115], v1, s[8:11], s80 offen offset:1024
    v_mfma_f32_16x16x32_bf16 v[228:231], v[36:39], a[44:47], v[228:231]
    v_mfma_f32_16x16x32_bf16 v[136:139], v[40:43], a[32:35], v[136:139]
    ds_read_b64_tr_b16 v[36:37], v9 offset:8192
    v_mfma_f32_16x16x32_bf16 v[168:171], v[40:43], a[36:39], v[168:171]
    ds_read_b64_tr_b16 v[38:39], v9 offset:9216
    v_mfma_f32_16x16x32_bf16 v[200:203], v[40:43], a[40:43], v[200:203]
    v_mfma_f32_16x16x32_bf16 v[232:235], v[40:43], a[44:47], v[232:235]
    s_waitcnt lgkmcnt(4)
    v_mfma_f32_16x16x32_bf16 v[140:143], v[44:47], a[32:35], v[140:143]
    s_xor_b32 s80, s75, 22528
    ds_read_b64_tr_b16 v[40:41], v10 offset:8192
    v_mfma_f32_16x16x32_bf16 v[172:175], v[44:47], a[36:39], v[172:175]
    ds_read_b64_tr_b16 v[42:43], v10 offset:9216
    v_mfma_f32_16x16x32_bf16 v[204:207], v[44:47], a[40:43], v[204:207]
    buffer_load_dwordx4 a[116:119], v1, s[8:11], s80 offen offset:1024
    v_mfma_f32_16x16x32_bf16 v[236:239], v[44:47], a[44:47], v[236:239]
    v_mfma_f32_16x16x32_bf16 v[144:147], v[48:51], a[32:35], v[144:147]
    ds_read_b64_tr_b16 v[44:45], v11 offset:8192
    v_mfma_f32_16x16x32_bf16 v[176:179], v[48:51], a[36:39], v[176:179]
    ds_read_b64_tr_b16 v[46:47], v11 offset:9216
    v_mfma_f32_16x16x32_bf16 v[208:211], v[48:51], a[40:43], v[208:211]
    v_mfma_f32_16x16x32_bf16 v[240:243], v[48:51], a[44:47], v[240:243]
    v_mfma_f32_16x16x32_bf16 v[148:151], v[52:55], a[32:35], v[148:151]
    s_xor_b32 s80, s76, 6144
    ds_read_b64_tr_b16 v[48:49], v12 offset:8192
    v_mfma_f32_16x16x32_bf16 v[180:183], v[52:55], a[36:39], v[180:183]
    ds_read_b64_tr_b16 v[50:51], v12 offset:9216
    v_mfma_f32_16x16x32_bf16 v[212:215], v[52:55], a[40:43], v[212:215]
    buffer_load_dwordx4 a[120:123], v1, s[8:11], s80 offen offset:1024
    v_mfma_f32_16x16x32_bf16 v[244:247], v[52:55], a[44:47], v[244:247]
    v_mfma_f32_16x16x32_bf16 v[152:155], v[56:59], a[32:35], v[152:155]
    ds_read_b64_tr_b16 v[52:53], v13 offset:8192
    v_mfma_f32_16x16x32_bf16 v[184:187], v[56:59], a[36:39], v[184:187]
    ds_read_b64_tr_b16 v[54:55], v13 offset:9216
    v_mfma_f32_16x16x32_bf16 v[216:219], v[56:59], a[40:43], v[216:219]
    v_mfma_f32_16x16x32_bf16 v[248:251], v[56:59], a[44:47], v[248:251]
    v_mfma_f32_16x16x32_bf16 v[156:159], v[60:63], a[32:35], v[156:159]
    s_xor_b32 s80, s76, 22528
    ds_read_b64_tr_b16 v[56:57], v14 offset:8192
    v_mfma_f32_16x16x32_bf16 v[188:191], v[60:63], a[36:39], v[188:191]
    ds_read_b64_tr_b16 v[58:59], v14 offset:9216
    v_mfma_f32_16x16x32_bf16 v[220:223], v[60:63], a[40:43], v[220:223]
    buffer_load_dwordx4 a[124:127], v1, s[8:11], s80 offen offset:1024
    v_mfma_f32_16x16x32_bf16 v[252:255], v[60:63], a[44:47], v[252:255]
    s_waitcnt vmcnt(24) lgkmcnt(4)
    v_mfma_f32_16x16x32_bf16 v[128:131], v[32:35], a[48:51], v[128:131]
    s_waitcnt vmcnt(23)
    ds_read_b64_tr_b16 v[60:61], v15 offset:8192
    v_mfma_f32_16x16x32_bf16 v[160:163], v[32:35], a[52:55], v[160:163]
    s_waitcnt vmcnt(20)
    s_xor_b32 s80, s75, 8192
    ds_read_b64_tr_b16 v[62:63], v15 offset:9216
    v_mfma_f32_16x16x32_bf16 v[192:195], v[32:35], a[56:59], v[192:195]
    buffer_load_dwordx4 a[128:131], v1, s[8:11], s80 offen offset:0
    v_mfma_f32_16x16x32_bf16 v[224:227], v[32:35], a[60:63], v[224:227]
    v_mfma_f32_16x16x32_bf16 v[132:135], v[36:39], a[48:51], v[132:135]
    ds_read_b64_tr_b16 v[32:33], v8 offset:16384
    v_mfma_f32_16x16x32_bf16 v[164:167], v[36:39], a[52:55], v[164:167]
    ds_read_b64_tr_b16 v[34:35], v8 offset:17408
    v_mfma_f32_16x16x32_bf16 v[196:199], v[36:39], a[56:59], v[196:199]
    v_mfma_f32_16x16x32_bf16 v[228:231], v[36:39], a[60:63], v[228:231]
    v_mfma_f32_16x16x32_bf16 v[136:139], v[40:43], a[48:51], v[136:139]
    s_xor_b32 s80, s75, 24576
    ds_read_b64_tr_b16 v[36:37], v9 offset:16384
    v_mfma_f32_16x16x32_bf16 v[168:171], v[40:43], a[52:55], v[168:171]
    ds_read_b64_tr_b16 v[38:39], v9 offset:17408
    v_mfma_f32_16x16x32_bf16 v[200:203], v[40:43], a[56:59], v[200:203]
    buffer_load_dwordx4 a[132:135], v1, s[8:11], s80 offen offset:0
    v_mfma_f32_16x16x32_bf16 v[232:235], v[40:43], a[60:63], v[232:235]
    v_mfma_f32_16x16x32_bf16 v[140:143], v[44:47], a[48:51], v[140:143]
    ds_read_b64_tr_b16 v[40:41], v10 offset:16384
    v_mfma_f32_16x16x32_bf16 v[172:175], v[44:47], a[52:55], v[172:175]
    ds_read_b64_tr_b16 v[42:43], v10 offset:17408
    v_mfma_f32_16x16x32_bf16 v[204:207], v[44:47], a[56:59], v[204:207]
    v_mfma_f32_16x16x32_bf16 v[236:239], v[44:47], a[60:63], v[236:239]
    v_mfma_f32_16x16x32_bf16 v[144:147], v[48:51], a[48:51], v[144:147]
    s_xor_b32 s80, s76, 8192
    ds_read_b64_tr_b16 v[44:45], v11 offset:16384
    v_mfma_f32_16x16x32_bf16 v[176:179], v[48:51], a[52:55], v[176:179]
    ds_read_b64_tr_b16 v[46:47], v11 offset:17408
    v_mfma_f32_16x16x32_bf16 v[208:211], v[48:51], a[56:59], v[208:211]
    buffer_load_dwordx4 a[136:139], v1, s[8:11], s80 offen offset:0
    v_mfma_f32_16x16x32_bf16 v[240:243], v[48:51], a[60:63], v[240:243]
    s_waitcnt lgkmcnt(4)
    v_mfma_f32_16x16x32_bf16 v[148:151], v[52:55], a[48:51], v[148:151]
    ds_read_b64_tr_b16 v[48:49], v12 offset:16384
    v_mfma_f32_16x16x32_bf16 v[180:183], v[52:55], a[52:55], v[180:183]
    ds_read_b64_tr_b16 v[50:51], v12 offset:17408
    v_mfma_f32_16x16x32_bf16 v[212:215], v[52:55], a[56:59], v[212:215]
    v_mfma_f32_16x16x32_bf16 v[244:247], v[52:55], a[60:63], v[244:247]
    v_mfma_f32_16x16x32_bf16 v[152:155], v[56:59], a[48:51], v[152:155]
    s_xor_b32 s80, s76, 24576
    ds_read_b64_tr_b16 v[52:53], v13 offset:16384
    v_mfma_f32_16x16x32_bf16 v[184:187], v[56:59], a[52:55], v[184:187]
    ds_read_b64_tr_b16 v[54:55], v13 offset:17408
    v_mfma_f32_16x16x32_bf16 v[216:219], v[56:59], a[56:59], v[216:219]
    buffer_load_dwordx4 a[140:143], v1, s[8:11], s80 offen offset:0
    s_waitcnt vmcnt(9)
    v_mfma_f32_16x16x32_bf16 v[248:251], v[56:59], a[60:63], v[248:251]
    buffer_store_dword v6, v5, s[8:11], s73 offen sc0 sc1
    v_mfma_f32_16x16x32_bf16 v[156:159], v[60:63], a[48:51], v[156:159]
    ds_read_b64_tr_b16 v[56:57], v14 offset:16384
    v_mfma_f32_16x16x32_bf16 v[188:191], v[60:63], a[52:55], v[188:191]
    s_xor_b32 s80, s75, 8192
    ds_read_b64_tr_b16 v[58:59], v14 offset:17408
    v_mfma_f32_16x16x32_bf16 v[220:223], v[60:63], a[56:59], v[220:223]
    buffer_load_dwordx4 a[144:147], v1, s[8:11], s80 offen offset:1024
    v_mfma_f32_16x16x32_bf16 v[252:255], v[60:63], a[60:63], v[252:255]
    v_mfma_f32_16x16x32_bf16 v[128:131], v[32:35], a[64:67], v[128:131]
    ds_read_b64_tr_b16 v[60:61], v15 offset:16384
    v_mfma_f32_16x16x32_bf16 v[160:163], v[32:35], a[68:71], v[160:163]
    ds_read_b64_tr_b16 v[62:63], v15 offset:17408
    v_mfma_f32_16x16x32_bf16 v[192:195], v[32:35], a[72:75], v[192:195]
    v_mfma_f32_16x16x32_bf16 v[224:227], v[32:35], a[76:79], v[224:227]
    v_mfma_f32_16x16x32_bf16 v[132:135], v[36:39], a[64:67], v[132:135]
    s_xor_b32 s80, s75, 24576
    ds_read_b64_tr_b16 v[32:33], v8 offset:24576
    v_mfma_f32_16x16x32_bf16 v[164:167], v[36:39], a[68:71], v[164:167]
    ds_read_b64_tr_b16 v[34:35], v8 offset:25600
    v_mfma_f32_16x16x32_bf16 v[196:199], v[36:39], a[72:75], v[196:199]
    buffer_load_dwordx4 a[148:151], v1, s[8:11], s80 offen offset:1024
    v_mfma_f32_16x16x32_bf16 v[228:231], v[36:39], a[76:79], v[228:231]
    s_waitcnt lgkmcnt(4)
    v_mfma_f32_16x16x32_bf16 v[136:139], v[40:43], a[64:67], v[136:139]
    ds_read_b64_tr_b16 v[36:37], v9 offset:24576
    v_mfma_f32_16x16x32_bf16 v[168:171], v[40:43], a[68:71], v[168:171]
    ds_read_b64_tr_b16 v[38:39], v9 offset:25600
    v_mfma_f32_16x16x32_bf16 v[200:203], v[40:43], a[72:75], v[200:203]
    v_mfma_f32_16x16x32_bf16 v[232:235], v[40:43], a[76:79], v[232:235]
    v_mfma_f32_16x16x32_bf16 v[140:143], v[44:47], a[64:67], v[140:143]
    s_xor_b32 s80, s76, 8192
    ds_read_b64_tr_b16 v[40:41], v10 offset:24576
    v_mfma_f32_16x16x32_bf16 v[172:175], v[44:47], a[68:71], v[172:175]
    ds_read_b64_tr_b16 v[42:43], v10 offset:25600
    v_mfma_f32_16x16x32_bf16 v[204:207], v[44:47], a[72:75], v[204:207]
    buffer_load_dwordx4 a[152:155], v1, s[8:11], s80 offen offset:1024
    v_mfma_f32_16x16x32_bf16 v[236:239], v[44:47], a[76:79], v[236:239]
    v_mfma_f32_16x16x32_bf16 v[144:147], v[48:51], a[64:67], v[144:147]
    ds_read_b64_tr_b16 v[44:45], v11 offset:24576
    v_mfma_f32_16x16x32_bf16 v[176:179], v[48:51], a[68:71], v[176:179]
    ds_read_b64_tr_b16 v[46:47], v11 offset:25600
    v_mfma_f32_16x16x32_bf16 v[208:211], v[48:51], a[72:75], v[208:211]
    v_mfma_f32_16x16x32_bf16 v[240:243], v[48:51], a[76:79], v[240:243]
    v_mfma_f32_16x16x32_bf16 v[148:151], v[52:55], a[64:67], v[148:151]
    s_xor_b32 s80, s76, 24576
    ds_read_b64_tr_b16 v[48:49], v12 offset:24576
    v_mfma_f32_16x16x32_bf16 v[180:183], v[52:55], a[68:71], v[180:183]
    ds_read_b64_tr_b16 v[50:51], v12 offset:25600
    v_mfma_f32_16x16x32_bf16 v[212:215], v[52:55], a[72:75], v[212:215]
    buffer_load_dwordx4 a[156:159], v1, s[8:11], s80 offen offset:1024
    v_mfma_f32_16x16x32_bf16 v[244:247], v[52:55], a[76:79], v[244:247]
    v_mfma_f32_16x16x32_bf16 v[152:155], v[56:59], a[64:67], v[152:155]
    ds_read_b64_tr_b16 v[52:53], v13 offset:24576
    v_lshlrev_b32 v116, 2, v0
    v_mfma_f32_16x16x32_bf16 v[184:187], v[56:59], a[68:71], v[184:187]
    s_xor_b32 s80, s75, 10240
    ds_read_b64_tr_b16 v[54:55], v13 offset:25600
    v_cmp_gt_u32 vcc, 8, v0
    v_mfma_f32_16x16x32_bf16 v[216:219], v[56:59], a[72:75], v[216:219]
    buffer_load_dwordx4 a[160:163], v1, s[8:11], s80 offen offset:0
    v_mfma_f32_16x16x32_bf16 v[248:251], v[56:59], a[76:79], v[248:251]
    s_waitcnt lgkmcnt(4)
    v_mov_b32 v117, 2147479552
    v_cndmask_b32 v116, v117, v116, vcc
    v_mfma_f32_16x16x32_bf16 v[156:159], v[60:63], a[64:67], v[156:159]
    s_lshl_b32 s70, s2, 5
    s_add_u32 s70, s70, 20480
    ds_read_b64_tr_b16 v[56:57], v14 offset:24576
    v_mfma_f32_16x16x32_bf16 v[188:191], v[60:63], a[68:71], v[188:191]
    ds_read_b64_tr_b16 v[58:59], v14 offset:25600
    v_and_b32 v119, 3, v2
    v_mfma_f32_16x16x32_bf16 v[220:223], v[60:63], a[72:75], v[220:223]
    v_lshlrev_b32 v119, 9, v119
    v_mfma_f32_16x16x32_bf16 v[252:255], v[60:63], a[76:79], v[252:255]
    v_mfma_f32_16x16x32_bf16 v[128:131], v[32:35], a[80:83], v[128:131]
    s_xor_b32 s80, s75, 26624
    s_lshr_b32 s69, s2, 6
    ds_read_b64_tr_b16 v[60:61], v15 offset:24576
    v_mfma_f32_16x16x32_bf16 v[160:163], v[32:35], a[84:87], v[160:163]
    s_add_u32 s69, s69, 4
    s_lshl_b32 s69, s69, 5
    ds_read_b64_tr_b16 v[62:63], v15 offset:25600
    v_mfma_f32_16x16x32_bf16 v[192:195], v[32:35], a[88:91], v[192:195]
    buffer_load_dwordx4 a[164:167], v1, s[8:11], s80 offen offset:0
    v_mfma_f32_16x16x32_bf16 v[224:227], v[32:35], a[92:95], v[224:227]
    s_bfe_u32 s68, s2, 196611
    s_add_u32 s69, s69, s68
    s_lshl_b32 s69, s69, 6
    v_mfma_f32_16x16x32_bf16 v[132:135], v[36:39], a[80:83], v[132:135]
    s_add_u32 s69, s69, 1310720
    s_and_b32 s100, s3, 1
    ds_read_b64_tr_b16 v[32:33], v8 offset:49152
    v_mfma_f32_16x16x32_bf16 v[164:167], v[36:39], a[84:87], v[164:167]
    s_lshr_b32 s101, s3, 1
    s_lshl_b32 s19, s100, 13
    ds_read_b64_tr_b16 v[34:35], v8 offset:50176
    v_mfma_f32_16x16x32_bf16 v[196:199], v[36:39], a[88:91], v[196:199]
    buffer_load_dword v118, v119, s[8:11], s69 offen sc0 sc1
    v_mfma_f32_16x16x32_bf16 v[228:231], v[36:39], a[92:95], v[228:231]
    s_add_u32 s19, s19, 65536
    v_add_u32 v18, s19, v1
    v_mfma_f32_16x16x32_bf16 v[136:139], v[40:43], a[80:83], v[136:139]
    s_xor_b32 s80, s76, 10240
    s_mul_i32 s19, s100, 12288
    ds_read_b64_tr_b16 v[36:37], v9 offset:49152
    v_mfma_f32_16x16x32_bf16 v[168:171], v[40:43], a[84:87], v[168:171]
    s_add_u32 s19, s19, 98304
    ds_read_b64_tr_b16 v[38:39], v9 offset:50176
    v_add_u32 v19, s19, v1
    v_mfma_f32_16x16x32_bf16 v[200:203], v[40:43], a[88:91], v[200:203]
    buffer_load_dwordx4 a[168:171], v1, s[8:11], s80 offen offset:0
    v_mfma_f32_16x16x32_bf16 v[232:235], v[40:43], a[92:95], v[232:235]
    v_mfma_f32_16x16x32_bf16 v[140:143], v[44:47], a[80:83], v[140:143]
    s_lshl_b32 s19, s100, 12
    s_add_u32 s19, s19, 98304
    ds_read_b64_tr_b16 v[40:41], v10 offset:49152
    v_mfma_f32_16x16x32_bf16 v[172:175], v[44:47], a[84:87], v[172:175]
    ds_read_b64_tr_b16 v[42:43], v10 offset:50176
    v_add_u32 v20, s19, v1
    v_mfma_f32_16x16x32_bf16 v[204:207], v[44:47], a[88:91], v[204:207]
    v_and_b32 v23, 15, v2
    v_lshrrev_b32 v24, 4, v2
    v_mfma_f32_16x16x32_bf16 v[236:239], v[44:47], a[92:95], v[236:239]
    s_waitcnt lgkmcnt(4)
    v_mfma_f32_16x16x32_bf16 v[144:147], v[48:51], a[80:83], v[144:147]
    s_xor_b32 s80, s76, 26624
    ds_read_b64_tr_b16 v[44:45], v11 offset:49152
    v_lshlrev_b32 v25, 2, v24
    v_mfma_f32_16x16x32_bf16 v[176:179], v[48:51], a[84:87], v[176:179]
    ds_read_b64_tr_b16 v[46:47], v11 offset:50176
    v_sub_u32 v25, v23, v25
    v_mfma_f32_16x16x32_bf16 v[208:211], v[48:51], a[88:91], v[208:211]
    buffer_load_dwordx4 a[172:175], v1, s[8:11], s80 offen offset:0
    v_mfma_f32_16x16x32_bf16 v[240:243], v[48:51], a[92:95], v[240:243]
    v_mfma_f32_16x16x32_bf16 v[148:151], v[52:55], a[80:83], v[148:151]
    s_sub_i32 s19, s101, s100
    s_lshl_b32 s19, s19, 5
    ds_read_b64_tr_b16 v[48:49], v12 offset:49152
    v_mfma_f32_16x16x32_bf16 v[180:183], v[52:55], a[84:87], v[180:183]
    s_xor_b32 s80, s75, 10240
    ds_read_b64_tr_b16 v[50:51], v12 offset:50176
    v_add_u32 v21, s19, v25
    v_mfma_f32_16x16x32_bf16 v[212:215], v[52:55], a[88:91], v[212:215]
    buffer_load_dwordx4 a[176:179], v1, s[8:11], s80 offen offset:1024
    v_mfma_f32_16x16x32_bf16 v[244:247], v[52:55], a[92:95], v[244:247]
    v_mfma_f32_16x16x32_bf16 v[152:155], v[56:59], a[80:83], v[152:155]
    s_add_u32 s19, s101, s100
    s_sub_i32 s19, 1, s19
    ds_read_b64_tr_b16 v[52:53], v13 offset:49152
    v_mfma_f32_16x16x32_bf16 v[184:187], v[56:59], a[84:87], v[184:187]
    s_lshl_b32 s19, s19, 5
    ds_read_b64_tr_b16 v[54:55], v13 offset:50176
    v_add_u32 v22, s19, v25
    v_mfma_f32_16x16x32_bf16 v[216:219], v[56:59], a[88:91], v[216:219]
    v_cvt_f32_i32 v21, v21
    v_cvt_f32_i32 v22, v22
    v_mfma_f32_16x16x32_bf16 v[248:251], v[56:59], a[92:95], v[248:251]
    v_mfma_f32_16x16x32_bf16 v[156:159], v[60:63], a[80:83], v[156:159]
    s_xor_b32 s80, s75, 26624
    ds_read_b64_tr_b16 v[56:57], v14 offset:49152
    v_add_f32 v21, 0.5, v21
    v_mfma_f32_16x16x32_bf16 v[188:191], v[60:63], a[84:87], v[188:191]
    ds_read_b64_tr_b16 v[58:59], v14 offset:50176
    v_add_f32 v22, 0.5, v22
    v_mfma_f32_16x16x32_bf16 v[220:223], v[60:63], a[88:91], v[220:223]
    buffer_load_dwordx4 a[180:183], v1, s[8:11], s80 offen offset:1024
    v_mfma_f32_16x16x32_bf16 v[252:255], v[60:63], a[92:95], v[252:255]
    v_mul_f32 v21, 0x71800000, v21
    v_mul_f32 v22, 0x71800000, v22
    v_mfma_f32_16x16x32_bf16 v[128:131], v[32:35], a[96:99], v[128:131]
    ds_read_b64_tr_b16 v[60:61], v15 offset:49152
    v_lshrrev_b32 v25, 2, v23
    v_mfma_f32_16x16x32_bf16 v[160:163], v[32:35], a[100:103], v[160:163]
    ds_read_b64_tr_b16 v[62:63], v15 offset:50176
    v_and_b32 v23, 3, v23
    v_mfma_f32_16x16x32_bf16 v[192:195], v[32:35], a[104:107], v[192:195]
    s_waitcnt vmcnt(20)
    v_lshlrev_b32 v23, 6, v23
    v_lshl_add_u32 v23, v25, 15, v23
    v_mfma_f32_16x16x32_bf16 v[224:227], v[32:35], a[108:111], v[224:227]
    s_waitcnt lgkmcnt(4)
    v_mfma_f32_16x16x32_bf16 v[132:135], v[36:39], a[96:99], v[132:135]
    s_xor_b32 s80, s76, 10240
    ds_read_b64_tr_b16 v[32:33], v8 offset:57344
    v_lshl_add_u32 v23, v24, 4, v23
    v_mfma_f32_16x16x32_bf16 v[164:167], v[36:39], a[100:103], v[164:167]
    s_lshl_b32 s18, s6, 20
    s_lshl_b32 s19, s3, 18
    ds_read_b64_tr_b16 v[34:35], v8 offset:58368
    v_mfma_f32_16x16x32_bf16 v[196:199], v[36:39], a[104:107], v[196:199]
    buffer_load_dwordx4 a[184:187], v1, s[8:11], s80 offen offset:1024
    v_mfma_f32_16x16x32_bf16 v[228:231], v[36:39], a[108:111], v[228:231]
    s_add_u32 s18, s18, s19
    s_lshl_b32 s19, s7, 10
    s_add_u32 s18, s18, s19
    v_mfma_f32_16x16x32_bf16 v[136:139], v[40:43], a[96:99], v[136:139]
    s_add_u32 s18, s18, 67108864
    s_mov_b32 s13, s60
    ds_read_b64_tr_b16 v[36:37], v9 offset:57344
    v_mfma_f32_16x16x32_bf16 v[168:171], v[40:43], a[100:103], v[168:171]
    s_mov_b32 s12, 2
    s_mov_b32 s25, 0
    ds_read_b64_tr_b16 v[38:39], v9 offset:58368
    v_mfma_f32_16x16x32_bf16 v[200:203], v[40:43], a[104:107], v[200:203]
    s_mov_b32 s26, 28
    s_mov_b32 s64, 128
    s_lshl_b32 s65, s5, 1
    v_mfma_f32_16x16x32_bf16 v[232:235], v[40:43], a[108:111], v[232:235]
    v_mfma_f32_16x16x32_bf16 v[140:143], v[44:47], a[96:99], v[140:143]
    s_xor_b32 s80, s76, 26624
    s_and_b32 s65, s65, 7
    ds_read_b64_tr_b16 v[40:41], v10 offset:57344
    v_mfma_f32_16x16x32_bf16 v[172:175], v[44:47], a[100:103], v[172:175]
    s_xor_b32 s65, s65, s3
    s_lshl_b32 s65, s65, 16
    ds_read_b64_tr_b16 v[42:43], v10 offset:58368
    v_mfma_f32_16x16x32_bf16 v[204:207], v[44:47], a[104:107], v[204:207]
    buffer_load_dwordx4 a[188:191], v1, s[8:11], s80 offen offset:1024
    v_mfma_f32_16x16x32_bf16 v[236:239], v[44:47], a[108:111], v[236:239]
    s_add_u32 s15, s62, 65536
    s_add_u32 s16, s62, 0
    s_lshl_b32 s20, s7, 13
    v_mfma_f32_16x16x32_bf16 v[144:147], v[48:51], a[96:99], v[144:147]
    s_lshl_b32 s19, s100, 11
    s_add_u32 s20, s20, s19
    ds_read_b64_tr_b16 v[44:45], v11 offset:57344
    v_mfma_f32_16x16x32_bf16 v[176:179], v[48:51], a[100:103], v[176:179]
    s_xor_b32 s80, s75, 12288
    s_add_u32 s20, s20, 50331648
    ds_read_b64_tr_b16 v[46:47], v11 offset:58368
    v_mfma_f32_16x16x32_bf16 v[208:211], v[48:51], a[104:107], v[208:211]
    buffer_load_dwordx4 a[192:195], v1, s[8:11], s80 offen offset:0
    v_mfma_f32_16x16x32_bf16 v[240:243], v[48:51], a[108:111], v[240:243]
    s_sub_u32 s19, 3, s101
    s_lshl_b32 s19, s19, 18
    s_add_u32 s21, s20, s19
    v_mfma_f32_16x16x32_bf16 v[148:151], v[52:55], a[96:99], v[148:151]
    s_lshl_b32 s19, s101, 18
    s_add_u32 s20, s20, s19
    ds_read_b64_tr_b16 v[48:49], v12 offset:57344
    v_mfma_f32_16x16x32_bf16 v[180:183], v[52:55], a[100:103], v[180:183]
    s_add_u32 s22, s72, 131072
    s_and_b32 s23, s2, 231
    ds_read_b64_tr_b16 v[50:51], v12 offset:58368
    v_mfma_f32_16x16x32_bf16 v[212:215], v[52:55], a[104:107], v[212:215]
    s_lshl_b32 s23, s23, 8
    s_sub_u32 s19, 3, s3
    s_min_u32 s19, s19, s3
    v_mfma_f32_16x16x32_bf16 v[244:247], v[52:55], a[108:111], v[244:247]
    s_waitcnt lgkmcnt(4)
    v_mfma_f32_16x16x32_bf16 v[152:155], v[56:59], a[96:99], v[152:155]
    s_xor_b32 s80, s75, 28672
    s_lshl_b32 s19, s19, 7
    ds_read_b64_tr_b16 v[52:53], v13 offset:57344
    s_waitcnt vmcnt(7)
    v_cmp_ne_u32 vcc, 0, v118
    s_cmp_eq_u64 vcc, -1
    s_cbranch_scc0 L_E2_slow_5
L_E2_ok_6:
    v_mfma_f32_16x16x32_bf16 v[184:187], v[56:59], a[100:103], v[184:187]
    s_add_u32 s23, s23, s19
    s_add_u32 s23, s23, 1179648
    ds_read_b64_tr_b16 v[54:55], v13 offset:58368
    v_mfma_f32_16x16x32_bf16 v[216:219], v[56:59], a[104:107], v[216:219]
    buffer_load_dwordx4 a[196:199], v1, s[8:11], s80 offen offset:0
    v_mfma_f32_16x16x32_bf16 v[248:251], v[56:59], a[108:111], v[248:251]
    buffer_load_dword v112, v116, s[8:11], s70 offen
    v_mfma_f32_16x16x32_bf16 v[156:159], v[60:63], a[96:99], v[156:159]
    s_add_u32 s70, s70, 12288
    s_lshl_b32 s71, s2, 2
    ds_read_b64_tr_b16 v[56:57], v14 offset:57344
    v_mfma_f32_16x16x32_bf16 v[188:191], v[60:63], a[100:103], v[188:191]
    s_add_u32 s71, s71, s3
    s_and_b32 s100, s71, 31
    ds_read_b64_tr_b16 v[58:59], v14 offset:58368
    v_mfma_f32_16x16x32_bf16 v[220:223], v[60:63], a[104:107], v[220:223]
    buffer_load_dword v113, v116, s[8:11], s70 offen
    v_mfma_f32_16x16x32_bf16 v[252:255], v[60:63], a[108:111], v[252:255]
    s_lshr_b32 s101, s71, 5
    s_sub_u32 s101, s101, 4
    s_and_b32 s101, s101, 31
    v_mfma_f32_16x16x32_bf16 v[128:131], v[32:35], a[112:115], v[128:131]
    s_xor_b32 s80, s76, 12288
    s_add_u32 s70, s70, 12288
    ds_read_b64_tr_b16 v[60:61], v15 offset:57344
    v_mfma_f32_16x16x32_bf16 v[160:163], v[32:35], a[116:119], v[160:163]
    ds_read_b64_tr_b16 v[62:63], v15 offset:58368
    v_and_b32 v121, 7, v2
    v_mfma_f32_16x16x32_bf16 v[192:195], v[32:35], a[120:123], v[192:195]
    buffer_load_dwordx4 a[200:203], v1, s[8:11], s80 offen offset:0
    v_mfma_f32_16x16x32_bf16 v[224:227], v[32:35], a[124:127], v[224:227]
    buffer_load_dword v114, v116, s[8:11], s70 offen
    v_mfma_f32_16x16x32_bf16 v[132:135], v[36:39], a[112:115], v[132:135]
    s_add_u32 s70, s70, 12288
    v_and_b32 v120, 4, v121
    v_and_b32 v122, 2, v121
    v_mfma_f32_16x16x32_bf16 v[164:167], v[36:39], a[116:119], v[164:167]
    buffer_load_dword v115, v116, s[8:11], s70 offen
    v_mfma_f32_16x16x32_bf16 v[196:199], v[36:39], a[120:123], v[196:199]
    s_add_u32 s70, s70, 12288
    v_lshl_add_u32 v120, v122, 3, v120
    v_and_b32 v122, 1, v121
    v_mfma_f32_16x16x32_bf16 v[228:231], v[36:39], a[124:127], v[228:231]
    v_lshl_add_u32 v120, v122, 1, v120
    v_mul_u32_u24 v120, 3584, v120
    v_mfma_f32_16x16x32_bf16 v[136:139], v[40:43], a[112:115], v[136:139]
    s_xor_b32 s80, s76, 28672
    v_subrev_u32 v8, 98304, v8
    v_subrev_u32 v9, 98304, v9
    s_waitcnt lgkmcnt(0)
    s_barrier
    v_mfma_f32_16x16x32_bf16 v[168:171], v[40:43], a[116:119], v[168:171]
    ds_read_b64_tr_b16 v[32:33], v8 offset:0
    v_lshrrev_b32 v122, 3, v2
    v_mfma_f32_16x16x32_bf16 v[200:203], v[40:43], a[120:123], v[200:203]
    ds_read_b64_tr_b16 v[34:35], v8 offset:1024
    v_lshl_add_u32 v120, v122, 4, v120
    v_mfma_f32_16x16x32_bf16 v[232:235], v[40:43], a[124:127], v[232:235]
    ds_read_b64_tr_b16 v[36:37], v9 offset:0
    v_subrev_u32 v10, 98304, v10
    v_mfma_f32_16x16x32_bf16 v[140:143], v[44:47], a[112:115], v[140:143]
    ds_read_b64_tr_b16 v[38:39], v9 offset:1024
    v_lshlrev_b32 v121, 13, v121
    v_mfma_f32_16x16x32_bf16 v[172:175], v[44:47], a[116:119], v[172:175]
    ds_read_b64_tr_b16 v[40:41], v10 offset:0
    v_lshl_add_u32 v121, v122, 4, v121
    v_mfma_f32_16x16x32_bf16 v[204:207], v[44:47], a[120:123], v[204:207]
    s_lshr_b32 s71, s100, 1
    s_lshl_b32 s71, s71, 2
    ds_read_b64_tr_b16 v[42:43], v10 offset:1024
    v_mfma_f32_16x16x32_bf16 v[236:239], v[44:47], a[124:127], v[236:239]
    s_and_b32 s100, s100, 1
    s_add_u32 s71, s71, s100
    v_subrev_u32 v11, 98304, v11
    v_mfma_f32_16x16x32_bf16 v[144:147], v[48:51], a[112:115], v[144:147]
    s_mul_i32 s71, s71, 28672
    s_lshl_b32 s100, s101, 7
    ds_read_b64_tr_b16 v[44:45], v11 offset:0
    v_mfma_f32_16x16x32_bf16 v[176:179], v[48:51], a[116:119], v[176:179]
    s_add_u32 s71, s71, s100
    s_cmp_lt_u32 s101, 28
    s_cselect_b32 s71, s71, 2147479552
    ds_read_b64_tr_b16 v[46:47], v11 offset:1024
    v_mfma_f32_16x16x32_bf16 v[208:211], v[48:51], a[120:123], v[208:211]
    buffer_load_dwordx4 a[204:207], v1, s[8:11], s80 offen offset:0
    v_mfma_f32_16x16x32_bf16 v[240:243], v[48:51], a[124:127], v[240:243]
    s_xor_b32 s80, s75, 12288
    v_subrev_u32 v12, 98304, v12
    v_mfma_f32_16x16x32_bf16 v[148:151], v[52:55], a[112:115], v[148:151]
    ds_read_b64_tr_b16 v[48:49], v12 offset:0
    v_mfma_f32_16x16x32_bf16 v[180:183], v[52:55], a[116:119], v[180:183]
    ds_read_b64_tr_b16 v[50:51], v12 offset:1024
    v_mfma_f32_16x16x32_bf16 v[212:215], v[52:55], a[120:123], v[212:215]
    buffer_load_dwordx4 a[208:211], v1, s[8:11], s80 offen offset:1024
    v_mfma_f32_16x16x32_bf16 v[244:247], v[52:55], a[124:127], v[244:247]
    s_xor_b32 s80, s75, 28672
    v_subrev_u32 v13, 98304, v13
    v_mfma_f32_16x16x32_bf16 v[152:155], v[56:59], a[112:115], v[152:155]
    ds_read_b64_tr_b16 v[52:53], v13 offset:0
    v_mfma_f32_16x16x32_bf16 v[184:187], v[56:59], a[116:119], v[184:187]
    ds_read_b64_tr_b16 v[54:55], v13 offset:1024
    v_mfma_f32_16x16x32_bf16 v[216:219], v[56:59], a[120:123], v[216:219]
    buffer_load_dwordx4 a[212:215], v1, s[8:11], s80 offen offset:1024
    v_mfma_f32_16x16x32_bf16 v[248:251], v[56:59], a[124:127], v[248:251]
    s_xor_b32 s80, s76, 12288
    v_subrev_u32 v14, 98304, v14
    v_mfma_f32_16x16x32_bf16 v[156:159], v[60:63], a[112:115], v[156:159]
    ds_read_b64_tr_b16 v[56:57], v14 offset:0
    v_mfma_f32_16x16x32_bf16 v[188:191], v[60:63], a[116:119], v[188:191]
    ds_read_b64_tr_b16 v[58:59], v14 offset:1024
    v_mfma_f32_16x16x32_bf16 v[220:223], v[60:63], a[120:123], v[220:223]
    buffer_load_dwordx4 a[216:219], v1, s[8:11], s80 offen offset:1024
    v_mfma_f32_16x16x32_bf16 v[252:255], v[60:63], a[124:127], v[252:255]
    s_waitcnt lgkmcnt(4)
    v_subrev_u32 v15, 98304, v15
    v_mfma_f32_16x16x32_bf16 v[128:131], v[32:35], a[128:131], v[128:131]
    ds_read_b64_tr_b16 v[60:61], v15 offset:0
    v_mfma_f32_16x16x32_bf16 v[160:163], v[32:35], a[132:135], v[160:163]
    ds_read_b64_tr_b16 v[62:63], v15 offset:1024
    v_mfma_f32_16x16x32_bf16 v[192:195], v[32:35], a[136:139], v[192:195]
    buffer_load_dword v3, v17, s[8:11], s74 offen sc0 sc1
    v_mfma_f32_16x16x32_bf16 v[224:227], v[32:35], a[140:143], v[224:227]
    v_mfma_f32_16x16x32_bf16 v[132:135], v[36:39], a[128:131], v[132:135]
    s_xor_b32 s80, s76, 28672
    ds_read_b64_tr_b16 v[32:33], v8 offset:8192
    v_mfma_f32_16x16x32_bf16 v[164:167], v[36:39], a[132:135], v[164:167]
    ds_read_b64_tr_b16 v[34:35], v8 offset:9216
    v_mfma_f32_16x16x32_bf16 v[196:199], v[36:39], a[136:139], v[196:199]
    buffer_load_dwordx4 a[220:223], v1, s[8:11], s80 offen offset:1024
    v_mfma_f32_16x16x32_bf16 v[228:231], v[36:39], a[140:143], v[228:231]
    v_mfma_f32_16x16x32_bf16 v[136:139], v[40:43], a[128:131], v[136:139]
    ds_read_b64_tr_b16 v[36:37], v9 offset:8192
    v_mfma_f32_16x16x32_bf16 v[168:171], v[40:43], a[132:135], v[168:171]
    s_xor_b32 s80, s75, 14336
    ds_read_b64_tr_b16 v[38:39], v9 offset:9216
    v_mfma_f32_16x16x32_bf16 v[200:203], v[40:43], a[136:139], v[200:203]
    buffer_load_dwordx4 a[224:227], v1, s[8:11], s80 offen offset:0
    v_mfma_f32_16x16x32_bf16 v[232:235], v[40:43], a[140:143], v[232:235]
    v_mfma_f32_16x16x32_bf16 v[140:143], v[44:47], a[128:131], v[140:143]
    ds_read_b64_tr_b16 v[40:41], v10 offset:8192
    v_mfma_f32_16x16x32_bf16 v[172:175], v[44:47], a[132:135], v[172:175]
    ds_read_b64_tr_b16 v[42:43], v10 offset:9216
    v_mfma_f32_16x16x32_bf16 v[204:207], v[44:47], a[136:139], v[204:207]
    v_mfma_f32_16x16x32_bf16 v[236:239], v[44:47], a[140:143], v[236:239]
    v_mfma_f32_16x16x32_bf16 v[144:147], v[48:51], a[128:131], v[144:147]
    s_xor_b32 s80, s75, 30720
    ds_read_b64_tr_b16 v[44:45], v11 offset:8192
    v_mfma_f32_16x16x32_bf16 v[176:179], v[48:51], a[132:135], v[176:179]
    ds_read_b64_tr_b16 v[46:47], v11 offset:9216
    v_mfma_f32_16x16x32_bf16 v[208:211], v[48:51], a[136:139], v[208:211]
    buffer_load_dwordx4 a[228:231], v1, s[8:11], s80 offen offset:0
    v_mfma_f32_16x16x32_bf16 v[240:243], v[48:51], a[140:143], v[240:243]
    s_waitcnt lgkmcnt(4)
    v_mfma_f32_16x16x32_bf16 v[148:151], v[52:55], a[128:131], v[148:151]
    ds_read_b64_tr_b16 v[48:49], v12 offset:8192
    v_mfma_f32_16x16x32_bf16 v[180:183], v[52:55], a[132:135], v[180:183]
    ds_read_b64_tr_b16 v[50:51], v12 offset:9216
    v_mfma_f32_16x16x32_bf16 v[212:215], v[52:55], a[136:139], v[212:215]
    v_mfma_f32_16x16x32_bf16 v[244:247], v[52:55], a[140:143], v[244:247]
    v_mfma_f32_16x16x32_bf16 v[152:155], v[56:59], a[128:131], v[152:155]
    s_xor_b32 s80, s76, 14336
    ds_read_b64_tr_b16 v[52:53], v13 offset:8192
    v_mfma_f32_16x16x32_bf16 v[184:187], v[56:59], a[132:135], v[184:187]
    ds_read_b64_tr_b16 v[54:55], v13 offset:9216
    v_mfma_f32_16x16x32_bf16 v[216:219], v[56:59], a[136:139], v[216:219]
    buffer_load_dwordx4 a[232:235], v1, s[8:11], s80 offen offset:0
    s_waitcnt vmcnt(4)
    v_cmp_ne_u32 vcc, 0, v3
    s_cmp_eq_u64 vcc, -1
    s_cbranch_scc0 L_KV_slow_7
L_KV_ok_8:
    v_mfma_f32_16x16x32_bf16 v[248:251], v[56:59], a[140:143], v[248:251]
    v_mfma_f32_16x16x32_bf16 v[156:159], v[60:63], a[128:131], v[156:159]
    s_add_u32 m0, s62, 65536
    s_add_u32 s98, s81, 0
    ds_read_b64_tr_b16 v[56:57], v14 offset:8192
    v_mfma_f32_16x16x32_bf16 v[188:191], v[60:63], a[132:135], v[188:191]
    ds_read_b64_tr_b16 v[58:59], v14 offset:9216
    v_add_u32 v16, s62, v1
    v_mfma_f32_16x16x32_bf16 v[220:223], v[60:63], a[136:139], v[220:223]
    buffer_load_dwordx4 v1, s[8:11], s98 offen offset:0   lds
    v_mfma_f32_16x16x32_bf16 v[252:255], v[60:63], a[140:143], v[252:255]
    v_and_b32 v17, 4294959103, v16
    v_mov_b32 v24, -1
    v_mfma_f32_16x16x32_bf16 v[128:131], v[32:35], a[144:147], v[128:131]
    s_xor_b32 s80, s76, 30720
    ds_read_b64_tr_b16 v[60:61], v15 offset:8192
    v_mov_b32 v28, 0x3f803f80
    v_mfma_f32_16x16x32_bf16 v[160:163], v[32:35], a[148:151], v[160:163]
    ds_read_b64_tr_b16 v[62:63], v15 offset:9216
    v_mov_b32 v25, -1
    v_mfma_f32_16x16x32_bf16 v[192:195], v[32:35], a[152:155], v[192:195]
    buffer_load_dwordx4 a[236:239], v1, s[8:11], s80 offen offset:0
    v_mfma_f32_16x16x32_bf16 v[224:227], v[32:35], a[156:159], v[224:227]
    buffer_load_dwordx4 v1, s[8:11], s98 offen offset:1024   lds
    v_mfma_f32_16x16x32_bf16 v[132:135], v[36:39], a[144:147], v[132:135]
    ds_read_b64_tr_b16 v[32:33], v8 offset:16384
    v_add_f32 v112, v112, v113
    v_mfma_f32_16x16x32_bf16 v[164:167], v[36:39], a[148:151], v[164:167]
    s_xor_b32 s80, s75, 14336
    ds_read_b64_tr_b16 v[34:35], v8 offset:17408
    v_add_f32 v114, v114, v115
    v_mfma_f32_16x16x32_bf16 v[196:199], v[36:39], a[152:155], v[196:199]
    buffer_load_dwordx4 a[240:243], v1, s[8:11], s80 offen offset:1024
    v_mfma_f32_16x16x32_bf16 v[228:231], v[36:39], a[156:159], v[228:231]
    s_waitcnt lgkmcnt(4)
    ds_read_b64_tr_b16 a[24:25], v8 offset:49152
    v_add_f32 v112, v112, v114
    v_mfma_f32_16x16x32_bf16 v[136:139], v[40:43], a[144:147], v[136:139]
    ds_read_b64_tr_b16 v[36:37], v9 offset:16384
    v_cvt_pk_bf16_f32 v112, v112, v112
    v_mfma_f32_16x16x32_bf16 v[168:171], v[40:43], a[148:151], v[168:171]
    ds_read_b64_tr_b16 v[38:39], v9 offset:17408
    v_and_b32 v112, 0xffff0000, v112
    v_mfma_f32_16x16x32_bf16 v[200:203], v[40:43], a[152:155], v[200:203]
    s_lshr_b32 s70, s2, 6
    s_cmp_eq_u32 s70, 2
    s_cselect_b32 s70, 1.0, 0
    ds_read_b64_tr_b16 a[26:27], v8 offset:50176
    v_mfma_f32_16x16x32_bf16 v[232:235], v[40:43], a[156:159], v[232:235]
    buffer_load_dwordx4 v1, s[8:11], s98 offen offset:2048   lds
    v_mfma_f32_16x16x32_bf16 v[140:143], v[44:47], a[144:147], v[140:143]
    s_xor_b32 s80, s75, 30720
    ds_read_b64_tr_b16 v[40:41], v10 offset:16384
    v_add_f32 v112, s70, v112
    v_mfma_f32_16x16x32_bf16 v[172:175], v[44:47], a[148:151], v[172:175]
    ds_read_b64_tr_b16 v[42:43], v10 offset:17408
    v_cvt_pk_bf16_f32 v112, v112, v112
    v_mfma_f32_16x16x32_bf16 v[204:207], v[44:47], a[152:155], v[204:207]
    ds_read_b64_tr_b16 a[28:29], v9 offset:49152
    v_and_b32 v112, 0xffff0000, v112
    v_mfma_f32_16x16x32_bf16 v[236:239], v[44:47], a[156:159], v[236:239]
    buffer_load_dwordx4 a[244:247], v1, s[8:11], s80 offen offset:1024
    v_mfma_f32_16x16x32_bf16 v[144:147], v[48:51], a[144:147], v[144:147]
    s_lshl_b32 s70, s2, 5
    s_add_u32 s70, s70, 4096
    ds_read_b64_tr_b16 v[44:45], v11 offset:16384
    v_mfma_f32_16x16x32_bf16 v[176:179], v[48:51], a[148:151], v[176:179]
    ds_read_b64_tr_b16 v[46:47], v11 offset:17408
    v_mov_b32 v29, 0x3f803f80
    v_mfma_f32_16x16x32_bf16 v[208:211], v[48:51], a[152:155], v[208:211]
    ds_read_b64_tr_b16 a[30:31], v9 offset:50176
    v_mov_b32 v26, -1
    v_mfma_f32_16x16x32_bf16 v[240:243], v[48:51], a[156:159], v[240:243]
    buffer_store_dword v112, v116, s[8:11], s70 offen sc0 sc1
    v_mfma_f32_16x16x32_bf16 v[148:151], v[52:55], a[144:147], v[148:151]
    s_xor_b32 s80, s76, 14336
    ds_read_b64_tr_b16 v[48:49], v12 offset:16384
    v_mov_b32 v30, 0x3f803f80
    v_mfma_f32_16x16x32_bf16 v[180:183], v[52:55], a[148:151], v[180:183]
    ds_read_b64_tr_b16 v[50:51], v12 offset:17408
    v_mov_b32 v27, -1
    v_mfma_f32_16x16x32_bf16 v[212:215], v[52:55], a[152:155], v[212:215]
    ds_read_b64_tr_b16 a[32:33], v10 offset:49152
    v_mov_b32 v31, 0x3f803f80
    v_mfma_f32_16x16x32_bf16 v[244:247], v[52:55], a[156:159], v[244:247]
    buffer_load_dwordx4 a[248:251], v1, s[8:11], s80 offen offset:1024
    v_mfma_f32_16x16x32_bf16 v[152:155], v[56:59], a[144:147], v[152:155]
    ds_read_b64_tr_b16 v[52:53], v13 offset:16384
    v_mov_b32 v64, 0
    v_mfma_f32_16x16x32_bf16 v[184:187], v[56:59], a[148:151], v[184:187]
    ds_read_b64_tr_b16 v[54:55], v13 offset:17408
    v_mov_b32 v65, 0
    v_mfma_f32_16x16x32_bf16 v[216:219], v[56:59], a[152:155], v[216:219]
    s_waitcnt lgkmcnt(7)
    s_xor_b32 s80, s76, 30720
    ds_read_b64_tr_b16 a[34:35], v10 offset:50176
    v_mov_b32 v66, 0
    v_mfma_f32_16x16x32_bf16 v[248:251], v[56:59], a[156:159], v[248:251]
    buffer_load_dwordx4 a[252:255], v1, s[8:11], s80 offen offset:1024
    v_mfma_f32_16x16x32_bf16 v[156:159], v[60:63], a[144:147], v[156:159]
    ds_read_b64_tr_b16 v[56:57], v14 offset:16384
    v_mov_b32 v67, 0
    v_mfma_f32_16x16x32_bf16 v[188:191], v[60:63], a[148:151], v[188:191]
    ds_read_b64_tr_b16 v[58:59], v14 offset:17408
    v_mov_b32 v68, 0
    v_mfma_f32_16x16x32_bf16 v[220:223], v[60:63], a[152:155], v[220:223]
    ds_read_b64_tr_b16 a[36:37], v11 offset:49152
    v_mov_b32 v69, 0
    v_mfma_f32_16x16x32_bf16 v[252:255], v[60:63], a[156:159], v[252:255]
    buffer_load_dwordx4 v1, s[8:11], s98 offen offset:3072   lds
    v_mfma_f32_16x16x32_bf16 v[128:131], v[32:35], a[160:163], v[128:131]
    s_add_u32 m0, s62, 69632
    s_add_u32 s98, s81, 4096
    ds_read_b64_tr_b16 v[60:61], v15 offset:16384
    v_mfma_f32_16x16x32_bf16 v[160:163], v[32:35], a[164:167], v[160:163]
    ds_read_b64_tr_b16 v[62:63], v15 offset:17408
    v_mov_b32 v70, 0
    v_mfma_f32_16x16x32_bf16 v[192:195], v[32:35], a[168:171], v[192:195]
    ds_read_b64_tr_b16 a[38:39], v11 offset:50176
    v_mov_b32 v71, 0
    v_mfma_f32_16x16x32_bf16 v[224:227], v[32:35], a[172:175], v[224:227]
    buffer_load_dwordx4 v1, s[8:11], s98 offen offset:0   lds
    v_mfma_f32_16x16x32_bf16 v[132:135], v[36:39], a[160:163], v[132:135]
    ds_read_b64_tr_b16 v[32:33], v8 offset:24576
    v_mov_b32 v72, 0
    v_mfma_f32_16x16x32_bf16 v[164:167], v[36:39], a[164:167], v[164:167]
    ds_read_b64_tr_b16 v[34:35], v8 offset:25600
    v_mov_b32 v73, 0
    v_mfma_f32_16x16x32_bf16 v[196:199], v[36:39], a[168:171], v[196:199]
    ds_read_b64_tr_b16 a[40:41], v12 offset:49152
    v_mov_b32 v74, 0
    v_mfma_f32_16x16x32_bf16 v[228:231], v[36:39], a[172:175], v[228:231]
    buffer_load_dwordx4 v1, s[8:11], s98 offen offset:1024   lds
    v_mfma_f32_16x16x32_bf16 v[136:139], v[40:43], a[160:163], v[136:139]
    ds_read_b64_tr_b16 v[36:37], v9 offset:24576
    v_mov_b32 v75, 0
    v_mfma_f32_16x16x32_bf16 v[168:171], v[40:43], a[164:167], v[168:171]
    ds_read_b64_tr_b16 v[38:39], v9 offset:25600
    v_mov_b32 v76, 0
    v_mfma_f32_16x16x32_bf16 v[200:203], v[40:43], a[168:171], v[200:203]
    s_waitcnt lgkmcnt(7)
    ds_read_b64_tr_b16 a[42:43], v12 offset:50176
    v_mov_b32 v77, 0
    v_mfma_f32_16x16x32_bf16 v[232:235], v[40:43], a[172:175], v[232:235]
    buffer_load_dwordx4 v1, s[8:11], s98 offen offset:2048   lds
    v_mfma_f32_16x16x32_bf16 v[140:143], v[44:47], a[160:163], v[140:143]
    ds_read_b64_tr_b16 v[40:41], v10 offset:24576
    v_mov_b32 v78, 0
    v_mfma_f32_16x16x32_bf16 v[172:175], v[44:47], a[164:167], v[172:175]
    ds_read_b64_tr_b16 v[42:43], v10 offset:25600
    v_mov_b32 v79, 0
    v_mfma_f32_16x16x32_bf16 v[204:207], v[44:47], a[168:171], v[204:207]
    s_cmp_eq_u32 s60, 0
    s_cselect_b32 s19, 0, 0x76800000
    ds_read_b64_tr_b16 a[44:45], v13 offset:49152
    v_add_f32 v3, s19, v21
    v_mfma_f32_16x16x32_bf16 v[236:239], v[44:47], a[172:175], v[236:239]
    buffer_load_dwordx4 v1, s[8:11], s98 offen offset:3072   lds
    v_mfma_f32_16x16x32_bf16 v[144:147], v[48:51], a[160:163], v[144:147]
    s_add_u32 m0, s62, 98304
    s_add_u32 s98, s81, 32768
    ds_read_b64_tr_b16 v[44:45], v11 offset:24576
    v_mfma_f32_16x16x32_bf16 v[176:179], v[48:51], a[164:167], v[176:179]
    ds_read_b64_tr_b16 v[46:47], v11 offset:25600
    v_add_f32 v96, 0, v3
    v_mfma_f32_16x16x32_bf16 v[208:211], v[48:51], a[168:171], v[208:211]
    ds_read_b64_tr_b16 a[46:47], v13 offset:50176
    v_min_f32 v96, v96, v64
    v_mfma_f32_16x16x32_bf16 v[240:243], v[48:51], a[172:175], v[240:243]
    buffer_load_dwordx4 v1, s[8:11], s98 offen offset:0   lds
    v_mfma_f32_16x16x32_bf16 v[148:151], v[52:55], a[160:163], v[148:151]
    ds_read_b64_tr_b16 v[48:49], v12 offset:24576
    v_add_f32 v97, 0xf1800000, v3
    v_mfma_f32_16x16x32_bf16 v[180:183], v[52:55], a[164:167], v[180:183]
    ds_read_b64_tr_b16 v[50:51], v12 offset:25600
    v_min_f32 v97, v97, v65
    v_mfma_f32_16x16x32_bf16 v[212:215], v[52:55], a[168:171], v[212:215]
    ds_read_b64_tr_b16 a[48:49], v14 offset:49152
    v_add_f32 v98, 0xf2000000, v3
    v_mfma_f32_16x16x32_bf16 v[244:247], v[52:55], a[172:175], v[244:247]
    buffer_load_dwordx4 v1, s[8:11], s98 offen offset:1024   lds
    v_mfma_f32_16x16x32_bf16 v[152:155], v[56:59], a[160:163], v[152:155]
    ds_read_b64_tr_b16 v[52:53], v13 offset:24576
    v_min_f32 v98, v98, v66
    v_mfma_f32_16x16x32_bf16 v[184:187], v[56:59], a[164:167], v[184:187]
    ds_read_b64_tr_b16 v[54:55], v13 offset:25600
    v_add_f32 v99, 0xf2400000, v3
    v_mfma_f32_16x16x32_bf16 v[216:219], v[56:59], a[168:171], v[216:219]
    s_waitcnt lgkmcnt(7)
    ds_read_b64_tr_b16 a[50:51], v14 offset:50176
    v_min_f32 v99, v99, v67
    v_mfma_f32_16x16x32_bf16 v[248:251], v[56:59], a[172:175], v[248:251]
    buffer_load_dwordx4 v1, s[8:11], s98 offen offset:2048   lds
    v_mfma_f32_16x16x32_bf16 v[156:159], v[60:63], a[160:163], v[156:159]
    ds_read_b64_tr_b16 v[56:57], v14 offset:24576
    v_add_f32 v100, 0xf3800000, v3
    v_mfma_f32_16x16x32_bf16 v[188:191], v[60:63], a[164:167], v[188:191]
    ds_read_b64_tr_b16 v[58:59], v14 offset:25600
    v_min_f32 v100, v100, v64
    v_mfma_f32_16x16x32_bf16 v[220:223], v[60:63], a[168:171], v[220:223]
    ds_read_b64_tr_b16 a[52:53], v15 offset:49152
    v_add_f32 v101, 0xf3880000, v3
    v_mfma_f32_16x16x32_bf16 v[252:255], v[60:63], a[172:175], v[252:255]
    buffer_load_dwordx4 v1, s[8:11], s98 offen offset:3072   lds
    v_mfma_f32_16x16x32_bf16 v[128:131], v[32:35], a[176:179], v[128:131]
    s_add_u32 m0, s62, 102400
    s_add_u32 s98, s81, 36864
    ds_read_b64_tr_b16 v[60:61], v15 offset:24576
    v_mfma_f32_16x16x32_bf16 v[160:163], v[32:35], a[180:183], v[160:163]
    ds_read_b64_tr_b16 v[62:63], v15 offset:25600
    v_min_f32 v101, v101, v65
    v_mfma_f32_16x16x32_bf16 v[192:195], v[32:35], a[184:187], v[192:195]
    ds_read_b64_tr_b16 a[54:55], v15 offset:50176
    v_add_f32 v102, 0xf3900000, v3
    v_mfma_f32_16x16x32_bf16 v[224:227], v[32:35], a[188:191], v[224:227]
    buffer_load_dwordx4 v1, s[8:11], s98 offen offset:0   lds
    v_mfma_f32_16x16x32_bf16 v[132:135], v[36:39], a[176:179], v[132:135]
    ds_read_b64_tr_b16 v[32:33], v8 offset:32768
    v_min_f32 v102, v102, v66
    v_mfma_f32_16x16x32_bf16 v[164:167], v[36:39], a[180:183], v[164:167]
    ds_read_b64_tr_b16 v[34:35], v8 offset:33792
    v_add_f32 v103, 0xf3980000, v3
    v_mfma_f32_16x16x32_bf16 v[196:199], v[36:39], a[184:187], v[196:199]
    ds_read_b64_tr_b16 a[64:65], v8 offset:57344
    v_min_f32 v103, v103, v67
    v_mfma_f32_16x16x32_bf16 v[228:231], v[36:39], a[188:191], v[228:231]
    buffer_load_dwordx4 v1, s[8:11], s98 offen offset:1024   lds
    v_mfma_f32_16x16x32_bf16 v[136:139], v[40:43], a[176:179], v[136:139]
    ds_read_b64_tr_b16 v[36:37], v9 offset:32768
    v_add_f32 v104, 0x73800000, v3
    v_mfma_f32_16x16x32_bf16 v[168:171], v[40:43], a[180:183], v[168:171]
    ds_read_b64_tr_b16 v[38:39], v9 offset:33792
    v_min_f32 v104, v104, v68
    v_mfma_f32_16x16x32_bf16 v[200:203], v[40:43], a[184:187], v[200:203]
    s_waitcnt lgkmcnt(7)
    ds_read_b64_tr_b16 a[66:67], v8 offset:58368
    v_add_f32 v105, 0x73700000, v3
    v_mfma_f32_16x16x32_bf16 v[232:235], v[40:43], a[188:191], v[232:235]
    buffer_load_dwordx4 v1, s[8:11], s98 offen offset:2048   lds
    v_mfma_f32_16x16x32_bf16 v[140:143], v[44:47], a[176:179], v[140:143]
    ds_read_b64_tr_b16 v[40:41], v10 offset:32768
    v_min_f32 v105, v105, v69
    v_mfma_f32_16x16x32_bf16 v[172:175], v[44:47], a[180:183], v[172:175]
    ds_read_b64_tr_b16 v[42:43], v10 offset:33792
    v_add_f32 v106, 0x73600000, v3
    v_mfma_f32_16x16x32_bf16 v[204:207], v[44:47], a[184:187], v[204:207]
    ds_read_b64_tr_b16 a[68:69], v9 offset:57344
    v_min_f32 v106, v106, v70
    v_mfma_f32_16x16x32_bf16 v[236:239], v[44:47], a[188:191], v[236:239]
    buffer_load_dwordx4 v1, s[8:11], s98 offen offset:3072   lds
    v_mfma_f32_16x16x32_bf16 v[144:147], v[48:51], a[176:179], v[144:147]
    s_add_u32 m0, s62, 131072
    s_add_u32 s98, s82, 0
    ds_read_b64_tr_b16 v[44:45], v11 offset:32768
    v_mfma_f32_16x16x32_bf16 v[176:179], v[48:51], a[180:183], v[176:179]
    ds_read_b64_tr_b16 v[46:47], v11 offset:33792
    v_add_f32 v107, 0x73500000, v3
    v_mfma_f32_16x16x32_bf16 v[208:211], v[48:51], a[184:187], v[208:211]
    ds_read_b64_tr_b16 a[70:71], v9 offset:58368
    v_min_f32 v107, v107, v71
    v_mfma_f32_16x16x32_bf16 v[240:243], v[48:51], a[188:191], v[240:243]
    buffer_load_dwordx4 v1, s[8:11], s98 offen offset:0   lds
    v_mfma_f32_16x16x32_bf16 v[148:151], v[52:55], a[176:179], v[148:151]
    ds_read_b64_tr_b16 v[48:49], v12 offset:32768
    v_add_f32 v108, 0, v3
    v_mfma_f32_16x16x32_bf16 v[180:183], v[52:55], a[180:183], v[180:183]
    ds_read_b64_tr_b16 v[50:51], v12 offset:33792
    v_min_f32 v108, v108, v68
    v_mfma_f32_16x16x32_bf16 v[212:215], v[52:55], a[184:187], v[212:215]
    ds_read_b64_tr_b16 a[72:73], v10 offset:57344
    v_add_f32 v109, 0xf1800000, v3
    v_mfma_f32_16x16x32_bf16 v[244:247], v[52:55], a[188:191], v[244:247]
    buffer_load_dwordx4 v1, s[8:11], s98 offen offset:1024   lds
    v_mfma_f32_16x16x32_bf16 v[152:155], v[56:59], a[176:179], v[152:155]
    ds_read_b64_tr_b16 v[52:53], v13 offset:32768
    v_min_f32 v109, v109, v69
    v_mfma_f32_16x16x32_bf16 v[184:187], v[56:59], a[180:183], v[184:187]
    ds_read_b64_tr_b16 v[54:55], v13 offset:33792
    v_add_f32 v110, 0xf2000000, v3
    v_mfma_f32_16x16x32_bf16 v[216:219], v[56:59], a[184:187], v[216:219]
    s_waitcnt lgkmcnt(7)
    ds_read_b64_tr_b16 a[74:75], v10 offset:58368
    v_min_f32 v110, v110, v70
    v_mfma_f32_16x16x32_bf16 v[248:251], v[56:59], a[188:191], v[248:251]
    buffer_load_dwordx4 v1, s[8:11], s98 offen offset:2048   lds
    v_mfma_f32_16x16x32_bf16 v[156:159], v[60:63], a[176:179], v[156:159]
    ds_read_b64_tr_b16 v[56:57], v14 offset:32768
    v_add_f32 v111, 0xf2400000, v3
    v_mfma_f32_16x16x32_bf16 v[188:191], v[60:63], a[180:183], v[188:191]
    ds_read_b64_tr_b16 v[58:59], v14 offset:33792
    v_min_f32 v111, v111, v71
    v_mfma_f32_16x16x32_bf16 v[220:223], v[60:63], a[184:187], v[220:223]
    s_cmp_eq_u32 s60, 0
    s_cselect_b32 s19, 1.0, 0
    ds_read_b64_tr_b16 a[76:77], v11 offset:57344
    v_sub_f32 v3, v22, v21
    v_mfma_f32_16x16x32_bf16 v[252:255], v[60:63], a[188:191], v[252:255]
    buffer_load_dwordx4 v1, s[8:11], s98 offen offset:3072   lds
    v_mfma_f32_16x16x32_bf16 v[128:131], v[32:35], a[192:195], v[128:131]
    s_add_u32 m0, s62, 135168
    s_add_u32 s98, s82, 4096
    ds_read_b64_tr_b16 v[60:61], v15 offset:32768
    v_mfma_f32_16x16x32_bf16 v[160:163], v[32:35], a[196:199], v[160:163]
    ds_read_b64_tr_b16 v[62:63], v15 offset:33792
    v_fma_f32 v3, s19, v3, v21
    v_mfma_f32_16x16x32_bf16 v[192:195], v[32:35], a[200:203], v[192:195]
    ds_read_b64_tr_b16 a[78:79], v11 offset:58368
    v_add_f32 v80, 0, v3
    v_mfma_f32_16x16x32_bf16 v[224:227], v[32:35], a[204:207], v[224:227]
    buffer_load_dwordx4 v1, s[8:11], s98 offen offset:0   lds
    v_mfma_f32_16x16x32_bf16 v[132:135], v[36:39], a[192:195], v[132:135]
    ds_read_b64_tr_b16 v[32:33], v8 offset:40960
    v_min_f32 v80, v80, v64
    v_mfma_f32_16x16x32_bf16 v[164:167], v[36:39], a[196:199], v[164:167]
    ds_read_b64_tr_b16 v[34:35], v8 offset:41984
    v_add_f32 v81, 0xf1800000, v3
    v_mfma_f32_16x16x32_bf16 v[196:199], v[36:39], a[200:203], v[196:199]
    ds_read_b64_tr_b16 a[80:81], v12 offset:57344
    v_min_f32 v81, v81, v65
    v_mfma_f32_16x16x32_bf16 v[228:231], v[36:39], a[204:207], v[228:231]
    buffer_load_dwordx4 v1, s[8:11], s98 offen offset:1024   lds
    v_mfma_f32_16x16x32_bf16 v[136:139], v[40:43], a[192:195], v[136:139]
    ds_read_b64_tr_b16 v[36:37], v9 offset:40960
    v_add_f32 v82, 0xf2000000, v3
    v_mfma_f32_16x16x32_bf16 v[168:171], v[40:43], a[196:199], v[168:171]
    ds_read_b64_tr_b16 v[38:39], v9 offset:41984
    v_min_f32 v82, v82, v66
    v_mfma_f32_16x16x32_bf16 v[200:203], v[40:43], a[200:203], v[200:203]
    s_waitcnt lgkmcnt(7)
    ds_read_b64_tr_b16 a[82:83], v12 offset:58368
    v_add_f32 v83, 0xf2400000, v3
    v_mfma_f32_16x16x32_bf16 v[232:235], v[40:43], a[204:207], v[232:235]
    buffer_load_dwordx4 v1, s[8:11], s98 offen offset:2048   lds
    v_mfma_f32_16x16x32_bf16 v[140:143], v[44:47], a[192:195], v[140:143]
    ds_read_b64_tr_b16 v[40:41], v10 offset:40960
    v_min_f32 v83, v83, v67
    v_mfma_f32_16x16x32_bf16 v[172:175], v[44:47], a[196:199], v[172:175]
    ds_read_b64_tr_b16 v[42:43], v10 offset:41984
    v_add_f32 v84, 0xf3800000, v3
    v_mfma_f32_16x16x32_bf16 v[204:207], v[44:47], a[200:203], v[204:207]
    ds_read_b64_tr_b16 a[84:85], v13 offset:57344
    v_min_f32 v84, v84, v64
    v_mfma_f32_16x16x32_bf16 v[236:239], v[44:47], a[204:207], v[236:239]
    buffer_load_dwordx4 v1, s[8:11], s98 offen offset:3072   lds
    v_mfma_f32_16x16x32_bf16 v[144:147], v[48:51], a[192:195], v[144:147]
    ds_read_b64_tr_b16 v[44:45], v11 offset:40960
    v_add_f32 v85, 0xf3880000, v3
    v_mfma_f32_16x16x32_bf16 v[176:179], v[48:51], a[196:199], v[176:179]
    ds_read_b64_tr_b16 v[46:47], v11 offset:41984
    v_min_f32 v85, v85, v65
    v_mfma_f32_16x16x32_bf16 v[208:211], v[48:51], a[200:203], v[208:211]
    ds_read_b64_tr_b16 a[86:87], v13 offset:58368
    v_add_f32 v86, 0xf3900000, v3
    v_mfma_f32_16x16x32_bf16 v[240:243], v[48:51], a[204:207], v[240:243]
    buffer_load_dwordx4 a[0:3], v120, s[40:43], s71 offen
    v_mfma_f32_16x16x32_bf16 v[148:151], v[52:55], a[192:195], v[148:151]
    ds_read_b64_tr_b16 v[48:49], v12 offset:40960
    v_min_f32 v86, v86, v66
    v_mfma_f32_16x16x32_bf16 v[180:183], v[52:55], a[196:199], v[180:183]
    ds_read_b64_tr_b16 v[50:51], v12 offset:41984
    v_add_f32 v87, 0xf3980000, v3
    v_mfma_f32_16x16x32_bf16 v[212:215], v[52:55], a[200:203], v[212:215]
    ds_read_b64_tr_b16 a[88:89], v14 offset:57344
    v_min_f32 v87, v87, v67
    v_mfma_f32_16x16x32_bf16 v[244:247], v[52:55], a[204:207], v[244:247]
    buffer_load_dwordx4 a[4:7], v120, s[40:43], s71 offen offset:3584
    v_mfma_f32_16x16x32_bf16 v[152:155], v[56:59], a[192:195], v[152:155]
    ds_read_b64_tr_b16 v[52:53], v13 offset:40960
    v_add_f32 v88, 0x73800000, v3
    v_mfma_f32_16x16x32_bf16 v[184:187], v[56:59], a[196:199], v[184:187]
    ds_read_b64_tr_b16 v[54:55], v13 offset:41984
    v_min_f32 v88, v88, v68
    v_mfma_f32_16x16x32_bf16 v[216:219], v[56:59], a[200:203], v[216:219]
    s_waitcnt lgkmcnt(7)
    ds_read_b64_tr_b16 a[90:91], v14 offset:58368
    v_add_f32 v89, 0x73700000, v3
    v_mfma_f32_16x16x32_bf16 v[248:251], v[56:59], a[204:207], v[248:251]
    buffer_load_dwordx4 a[8:11], v120, s[44:47], s71 offen
    v_mfma_f32_16x16x32_bf16 v[156:159], v[60:63], a[192:195], v[156:159]
    ds_read_b64_tr_b16 v[56:57], v14 offset:40960
    v_min_f32 v89, v89, v69
    v_mfma_f32_16x16x32_bf16 v[188:191], v[60:63], a[196:199], v[188:191]
    ds_read_b64_tr_b16 v[58:59], v14 offset:41984
    v_add_f32 v90, 0x73600000, v3
    v_mfma_f32_16x16x32_bf16 v[220:223], v[60:63], a[200:203], v[220:223]
    ds_read_b64_tr_b16 a[92:93], v15 offset:57344
    v_min_f32 v90, v90, v70
    v_mfma_f32_16x16x32_bf16 v[252:255], v[60:63], a[204:207], v[252:255]
    buffer_load_dwordx4 a[12:15], v120, s[44:47], s71 offen offset:3584
    v_mfma_f32_16x16x32_bf16 v[192:195], v[32:35], a[216:219], v[192:195]
    s_waitcnt vmcnt(34)
    s_lshl_b32 s71, s101, 16
    ds_read_b64_tr_b16 v[60:61], v15 offset:40960
    v_add_f32 v91, 0x73500000, v3
    v_mfma_f32_16x16x32_bf16 v[192:195], a[24:27], a[232:235], v[192:195]
    s_waitcnt vmcnt(26)
    s_lshl_b32 s100, s3, 11
    ds_read_b64_tr_b16 v[62:63], v15 offset:41984
    v_min_f32 v91, v91, v71
    v_mfma_f32_16x16x32_bf16 v[192:195], a[64:67], a[248:251], v[192:195]
    s_add_u32 s71, s71, s100
    ds_read_b64_tr_b16 a[94:95], v15 offset:58368
    v_add_f32 v92, 0, v3
    v_mfma_f32_16x16x32_bf16 v[196:199], v[36:39], a[216:219], v[196:199]
    s_lshl_b32 s100, s4, 7
    v_min_f32 v92, v92, v68
    v_add_f32 v93, 0xf1800000, v3
    v_mfma_f32_16x16x32_bf16 v[196:199], a[28:31], a[232:235], v[196:199]
    s_add_u32 s71, s71, s100
    v_min_f32 v93, v93, v69
    v_add_f32 v94, 0xf2000000, v3
    v_mfma_f32_16x16x32_bf16 v[196:199], a[68:71], a[248:251], v[196:199]
    v_min_f32 v94, v94, v70
    v_add_f32 v95, 0xf2400000, v3
    v_mfma_f32_16x16x32_bf16 v[224:227], v[32:35], a[220:223], v[224:227]
    buffer_load_dwordx4 a[16:19], v121, s[48:51], s71 offen
    v_mfma_f32_16x16x32_bf16 v[224:227], a[24:27], a[236:239], v[224:227]
    s_waitcnt vmcnt(26)
    v_min_f32 v95, v95, v71
    s_waitcnt lgkmcnt(0)
    s_barrier
    v_mfma_f32_16x16x32_bf16 v[224:227], a[64:67], a[252:255], v[224:227]
    buffer_load_dwordx4 a[20:23], v121, s[48:51], s71 offen offset:1024
    v_mfma_f32_16x16x32_bf16 v[228:231], v[36:39], a[220:223], v[228:231]
    v_cvt_pk_bf16_f32 v192, v192, v193
    v_cvt_pk_bf16_f32 v193, v194, v195
    v_mfma_f32_16x16x32_bf16 v[228:231], a[28:31], a[236:239], v[228:231]
    v_cvt_pk_bf16_f32 v194, v196, v197
    v_cvt_pk_bf16_f32 v195, v198, v199
    v_mfma_f32_16x16x32_bf16 v[228:231], a[68:71], a[252:255], v[228:231]
    ds_write_b128 v16, v[192:195] offset:32768
    v_lshrrev_b32 v121, 1, v2
    v_mfma_f32_16x16x32_bf16 v[128:131], v[32:35], a[208:211], v[128:131]
    v_and_b32 v121, 15, v121
    v_lshlrev_b32 v121, 10, v121
    v_mfma_f32_16x16x32_bf16 v[128:131], a[24:27], a[224:227], v[128:131]
    v_and_b32 v122, 1, v2
    v_lshl_add_u32 v121, v122, 7, v121
    v_mfma_f32_16x16x32_bf16 v[128:131], a[64:67], a[240:243], v[128:131]
    v_mfma_f32_16x16x32_bf16 v[132:135], v[36:39], a[208:211], v[132:135]
    s_lshl_b32 s71, s6, 2
    v_cvt_pk_bf16_f32 v224, v224, v225
    v_cvt_pk_bf16_f32 v225, v226, v227
    v_mfma_f32_16x16x32_bf16 v[132:135], a[28:31], a[224:227], v[132:135]
    s_add_u32 s71, s71, s3
    v_cvt_pk_bf16_f32 v226, v228, v229
    v_cvt_pk_bf16_f32 v227, v230, v231
    v_mfma_f32_16x16x32_bf16 v[132:135], a[68:71], a[240:243], v[132:135]
    s_lshl_b32 s71, s71, 14
    ds_write_b128 v16, v[224:227] offset:36864
    v_mfma_f32_16x16x32_bf16 v[160:163], v[32:35], a[212:215], v[160:163]
    buffer_load_dword a60, v121, s[28:31], s71 offen
    v_mfma_f32_16x16x32_bf16 v[160:163], a[24:27], a[228:231], v[160:163]
    v_mfma_f32_16x16x32_bf16 v[160:163], a[64:67], a[244:247], v[160:163]
    s_getpc_b64 s[100:101]
L_ct2:
    s_lshr_b32 s99, s2, 3
    s_lshl_b32 s99, s99, 2
    s_add_u32 s99, s99, s3
    s_mul_i32 s99, s99, 6
    v_min_u32 v123, 5, v2
    v_add_u32 v123, s99, v123
    v_lshlrev_b32 v123, 7, v123
    v_add_u32 v123, L_attn-L_ct2, v123
    v_min_u32 v123, L_code_end-L_ct2, v123
    global_load_dword a61, v123, s[100:101]
    v_mfma_f32_16x16x32_bf16 v[164:167], v[36:39], a[212:215], v[164:167]
    v_cvt_pk_bf16_f32 v128, v128, v129
    v_cvt_pk_bf16_f32 v129, v130, v131
    v_mfma_f32_16x16x32_bf16 v[164:167], a[28:31], a[228:231], v[164:167]
    v_cvt_pk_bf16_f32 v130, v132, v133
    v_cvt_pk_bf16_f32 v131, v134, v135
    v_mfma_f32_16x16x32_bf16 v[164:167], a[68:71], a[244:247], v[164:167]
    ds_write_b128 v16, v[128:131] offset:0
    v_mfma_f32_16x16x32_bf16 v[200:203], v[40:43], a[216:219], v[200:203]
    v_mfma_f32_16x16x32_bf16 v[200:203], a[32:35], a[232:235], v[200:203]
    v_mfma_f32_16x16x32_bf16 v[200:203], a[72:75], a[248:251], v[200:203]
    v_mfma_f32_16x16x32_bf16 v[204:207], v[44:47], a[216:219], v[204:207]
    v_cvt_pk_bf16_f32 v160, v160, v161
    v_cvt_pk_bf16_f32 v161, v162, v163
    v_mfma_f32_16x16x32_bf16 v[204:207], a[36:39], a[232:235], v[204:207]
    v_cvt_pk_bf16_f32 v162, v164, v165
    v_cvt_pk_bf16_f32 v163, v166, v167
    v_mfma_f32_16x16x32_bf16 v[204:207], a[76:79], a[248:251], v[204:207]
    ds_write_b128 v16, v[160:163] offset:4096
    v_mfma_f32_16x16x32_bf16 v[232:235], v[40:43], a[220:223], v[232:235]
    v_mfma_f32_16x16x32_bf16 v[232:235], a[32:35], a[236:239], v[232:235]
    v_mfma_f32_16x16x32_bf16 v[232:235], a[72:75], a[252:255], v[232:235]
    v_mfma_f32_16x16x32_bf16 v[236:239], v[44:47], a[220:223], v[236:239]
    v_cvt_pk_bf16_f32 v200, v200, v201
    v_cvt_pk_bf16_f32 v201, v202, v203
    v_mfma_f32_16x16x32_bf16 v[236:239], a[36:39], a[236:239], v[236:239]
    v_cvt_pk_bf16_f32 v202, v204, v205
    v_cvt_pk_bf16_f32 v203, v206, v207
    v_mfma_f32_16x16x32_bf16 v[236:239], a[76:79], a[252:255], v[236:239]
    ds_write_b128 v16, v[200:203] offset:33792
    v_mfma_f32_16x16x32_bf16 v[136:139], v[40:43], a[208:211], v[136:139]
    v_mfma_f32_16x16x32_bf16 v[136:139], a[32:35], a[224:227], v[136:139]
    v_mfma_f32_16x16x32_bf16 v[136:139], a[72:75], a[240:243], v[136:139]
    v_mfma_f32_16x16x32_bf16 v[140:143], v[44:47], a[208:211], v[140:143]
    v_cvt_pk_bf16_f32 v232, v232, v233
    v_cvt_pk_bf16_f32 v233, v234, v235
    v_mfma_f32_16x16x32_bf16 v[140:143], a[36:39], a[224:227], v[140:143]
    v_cvt_pk_bf16_f32 v234, v236, v237
    v_cvt_pk_bf16_f32 v235, v238, v239
    v_mfma_f32_16x16x32_bf16 v[140:143], a[76:79], a[240:243], v[140:143]
    ds_write_b128 v16, v[232:235] offset:37888
    v_mfma_f32_16x16x32_bf16 v[168:171], v[40:43], a[212:215], v[168:171]
    v_mfma_f32_16x16x32_bf16 v[168:171], a[32:35], a[228:231], v[168:171]
    v_mfma_f32_16x16x32_bf16 v[168:171], a[72:75], a[244:247], v[168:171]
    v_mfma_f32_16x16x32_bf16 v[172:175], v[44:47], a[212:215], v[172:175]
    v_cvt_pk_bf16_f32 v136, v136, v137
    v_cvt_pk_bf16_f32 v137, v138, v139
    v_mfma_f32_16x16x32_bf16 v[172:175], a[36:39], a[228:231], v[172:175]
    v_cvt_pk_bf16_f32 v138, v140, v141
    v_cvt_pk_bf16_f32 v139, v142, v143
    v_mfma_f32_16x16x32_bf16 v[172:175], a[76:79], a[244:247], v[172:175]
    ds_write_b128 v16, v[136:139] offset:1024
    v_mfma_f32_16x16x32_bf16 v[208:211], v[48:51], a[216:219], v[208:211]
    v_mfma_f32_16x16x32_bf16 v[208:211], a[40:43], a[232:235], v[208:211]
    v_mfma_f32_16x16x32_bf16 v[208:211], a[80:83], a[248:251], v[208:211]
    v_mfma_f32_16x16x32_bf16 v[212:215], v[52:55], a[216:219], v[212:215]
    v_cvt_pk_bf16_f32 v168, v168, v169
    v_cvt_pk_bf16_f32 v169, v170, v171
    v_mfma_f32_16x16x32_bf16 v[212:215], a[44:47], a[232:235], v[212:215]
    v_cvt_pk_bf16_f32 v170, v172, v173
    v_cvt_pk_bf16_f32 v171, v174, v175
    v_mfma_f32_16x16x32_bf16 v[212:215], a[84:87], a[248:251], v[212:215]
    ds_write_b128 v16, v[168:171] offset:5120
    v_mfma_f32_16x16x32_bf16 v[240:243], v[48:51], a[220:223], v[240:243]
    v_mfma_f32_16x16x32_bf16 v[240:243], a[40:43], a[236:239], v[240:243]
    v_mfma_f32_16x16x32_bf16 v[240:243], a[80:83], a[252:255], v[240:243]
    v_mfma_f32_16x16x32_bf16 v[244:247], v[52:55], a[220:223], v[244:247]
    v_cvt_pk_bf16_f32 v208, v208, v209
    v_cvt_pk_bf16_f32 v209, v210, v211
    v_mfma_f32_16x16x32_bf16 v[244:247], a[44:47], a[236:239], v[244:247]
    v_cvt_pk_bf16_f32 v210, v212, v213
    v_cvt_pk_bf16_f32 v211, v214, v215
    v_mfma_f32_16x16x32_bf16 v[244:247], a[84:87], a[252:255], v[244:247]
    ds_write_b128 v16, v[208:211] offset:34816
    v_mfma_f32_16x16x32_bf16 v[144:147], v[48:51], a[208:211], v[144:147]
    v_mfma_f32_16x16x32_bf16 v[144:147], a[40:43], a[224:227], v[144:147]
    v_mfma_f32_16x16x32_bf16 v[144:147], a[80:83], a[240:243], v[144:147]
    v_mfma_f32_16x16x32_bf16 v[148:151], v[52:55], a[208:211], v[148:151]
    v_cvt_pk_bf16_f32 v240, v240, v241
    v_cvt_pk_bf16_f32 v241, v242, v243
    v_mfma_f32_16x16x32_bf16 v[148:151], a[44:47], a[224:227], v[148:151]
    v_cvt_pk_bf16_f32 v242, v244, v245
    v_cvt_pk_bf16_f32 v243, v246, v247
    v_mfma_f32_16x16x32_bf16 v[148:151], a[84:87], a[240:243], v[148:151]
    ds_write_b128 v16, v[240:243] offset:38912
    v_mfma_f32_16x16x32_bf16 v[176:179], v[48:51], a[212:215], v[176:179]
    v_mfma_f32_16x16x32_bf16 v[176:179], a[40:43], a[228:231], v[176:179]
    v_mfma_f32_16x16x32_bf16 v[176:179], a[80:83], a[244:247], v[176:179]
    v_mfma_f32_16x16x32_bf16 v[180:183], v[52:55], a[212:215], v[180:183]
    v_cvt_pk_bf16_f32 v144, v144, v145
    v_cvt_pk_bf16_f32 v145, v146, v147
    v_mfma_f32_16x16x32_bf16 v[180:183], a[44:47], a[228:231], v[180:183]
    v_cvt_pk_bf16_f32 v146, v148, v149
    v_cvt_pk_bf16_f32 v147, v150, v151
    v_mfma_f32_16x16x32_bf16 v[180:183], a[84:87], a[244:247], v[180:183]
    ds_write_b128 v16, v[144:147] offset:2048
    v_mfma_f32_16x16x32_bf16 v[216:219], v[56:59], a[216:219], v[216:219]
    v_mfma_f32_16x16x32_bf16 v[216:219], a[48:51], a[232:235], v[216:219]
    v_mfma_f32_16x16x32_bf16 v[216:219], a[88:91], a[248:251], v[216:219]
    v_mfma_f32_16x16x32_bf16 v[220:223], v[60:63], a[216:219], v[220:223]
    v_cvt_pk_bf16_f32 v176, v176, v177
    v_cvt_pk_bf16_f32 v177, v178, v179
    v_mfma_f32_16x16x32_bf16 v[220:223], a[52:55], a[232:235], v[220:223]
    v_cvt_pk_bf16_f32 v178, v180, v181
    v_cvt_pk_bf16_f32 v179, v182, v183
    v_mfma_f32_16x16x32_bf16 v[220:223], a[92:95], a[248:251], v[220:223]
    ds_write_b128 v16, v[176:179] offset:6144
    v_mfma_f32_16x16x32_bf16 v[248:251], v[56:59], a[220:223], v[248:251]
    v_mfma_f32_16x16x32_bf16 v[248:251], a[48:51], a[236:239], v[248:251]
    v_mfma_f32_16x16x32_bf16 v[248:251], a[88:91], a[252:255], v[248:251]
    v_mfma_f32_16x16x32_bf16 v[252:255], v[60:63], a[220:223], v[252:255]
    v_cvt_pk_bf16_f32 v216, v216, v217
    v_cvt_pk_bf16_f32 v217, v218, v219
    v_mfma_f32_16x16x32_bf16 v[252:255], a[52:55], a[236:239], v[252:255]
    v_cvt_pk_bf16_f32 v218, v220, v221
    v_cvt_pk_bf16_f32 v219, v222, v223
    v_mfma_f32_16x16x32_bf16 v[252:255], a[92:95], a[252:255], v[252:255]
    ds_write_b128 v16, v[216:219] offset:35840
    v_mfma_f32_16x16x32_bf16 v[152:155], v[56:59], a[208:211], v[152:155]
    v_mfma_f32_16x16x32_bf16 v[152:155], a[48:51], a[224:227], v[152:155]
    v_mfma_f32_16x16x32_bf16 v[152:155], a[88:91], a[240:243], v[152:155]
    v_mfma_f32_16x16x32_bf16 v[156:159], v[60:63], a[208:211], v[156:159]
    v_cvt_pk_bf16_f32 v248, v248, v249
    v_cvt_pk_bf16_f32 v249, v250, v251
    v_mfma_f32_16x16x32_bf16 v[156:159], a[52:55], a[224:227], v[156:159]
    v_cvt_pk_bf16_f32 v250, v252, v253
    v_cvt_pk_bf16_f32 v251, v254, v255
    v_mfma_f32_16x16x32_bf16 v[156:159], a[92:95], a[240:243], v[156:159]
    ds_write_b128 v16, v[248:251] offset:39936
    v_mfma_f32_16x16x32_bf16 v[184:187], v[56:59], a[212:215], v[184:187]
    v_mfma_f32_16x16x32_bf16 v[184:187], a[48:51], a[228:231], v[184:187]
    v_mfma_f32_16x16x32_bf16 v[184:187], a[88:91], a[244:247], v[184:187]
    v_mfma_f32_16x16x32_bf16 v[188:191], v[60:63], a[212:215], v[188:191]
    v_cvt_pk_bf16_f32 v152, v152, v153
    v_cvt_pk_bf16_f32 v153, v154, v155
    v_mfma_f32_16x16x32_bf16 v[188:191], a[52:55], a[228:231], v[188:191]
    v_cvt_pk_bf16_f32 v154, v156, v157
    v_cvt_pk_bf16_f32 v155, v158, v159
    v_mfma_f32_16x16x32_bf16 v[188:191], a[92:95], a[244:247], v[188:191]
    ds_write_b128 v16, v[152:155] offset:3072
L_attn:
    v_add_u32 v15, 4096, v1
    v_cvt_pk_bf16_f32 v184, v184, v185
    v_cvt_pk_bf16_f32 v185, v186, v187
    s_nop 3
    v_cvt_pk_bf16_f32 v186, v188, v189
    v_cvt_pk_bf16_f32 v187, v190, v191
    ds_write_b128 v16, v[184:187] offset:7168
    s_waitcnt vmcnt(24) lgkmcnt(0)
    s_barrier
    ds_read_b128 a[64:67], v17 offset:0
    ds_read_b128 a[128:131], v18 offset:0
    ds_read_b128 a[68:71], v17 offset:1024
    ds_read_b128 a[132:135], v18 offset:1024
    ds_read_b128 a[72:75], v17 offset:2048
    ds_read_b128 a[136:139], v18 offset:2048
    ds_read_b128 a[76:79], v17 offset:3072
    ds_read_b128 a[140:143], v18 offset:3072
    ds_read_b128 a[144:147], v18 offset:4096
    ds_read_b128 a[148:151], v18 offset:5120
    ds_read_b128 a[152:155], v18 offset:6144
    ds_read_b128 a[156:159], v18 offset:7168
    ds_read_b128 a[80:83], v17 offset:4096
    ds_read_b128 a[84:87], v17 offset:5120
    ds_read_b128 a[88:91], v17 offset:6144
    ds_read_b128 a[92:95], v17 offset:7168
    s_waitcnt lgkmcnt(14)
    v_mfma_f32_16x16x32_bf16 v[96:99], a[128:131], a[64:67], v[96:99]
    s_waitcnt lgkmcnt(12)
    s_add_u32 s19, s82, 32768
    s_sub_u32 s82, s12, s13
    ds_read_b128 a[96:99], v17 offset:8192
    v_mfma_f32_16x16x32_bf16 v[96:99], a[132:135], a[68:71], v[96:99]
    s_waitcnt lgkmcnt(11)
    s_sub_u32 s82, s82, 1
    s_cmp_gt_u32 s12, s13
    s_cselect_b32 s82, s82, s12
    ds_read_b128 a[100:103], v17 offset:9216
    v_mfma_f32_16x16x32_bf16 v[96:99], a[136:139], a[72:75], v[96:99]
    s_waitcnt lgkmcnt(10)
    s_lshl_b32 s82, s82, 16
    s_add_u32 s82, s82, s81
    ds_read_b128 a[104:107], v17 offset:10240
    v_mfma_f32_16x16x32_bf16 v[96:99], a[140:143], a[76:79], v[96:99]
    s_waitcnt lgkmcnt(10)
    s_cmp_ge_u32 s12, 17
    s_cselect_b32 s82, 2147471360, s82
    s_add_u32 s12, s12, 1
    ds_read_b128 a[108:111], v17 offset:11264
    v_mfma_f32_16x16x32_bf16 v[100:103], a[144:147], a[64:67], v[100:103]
    s_waitcnt lgkmcnt(10)
    s_sub_u32 s14, s60, 1
    ds_read_b128 a[112:115], v17 offset:12288
    v_mfma_f32_16x16x32_bf16 v[100:103], a[148:151], a[68:71], v[100:103]
    s_waitcnt lgkmcnt(10)
    ds_read_b128 a[116:119], v17 offset:13312
    v_mfma_f32_16x16x32_bf16 v[100:103], a[152:155], a[72:75], v[100:103]
    s_waitcnt lgkmcnt(10)
    ds_read_b128 a[120:123], v17 offset:14336
    v_mfma_f32_16x16x32_bf16 v[100:103], a[156:159], a[76:79], v[100:103]
    s_waitcnt lgkmcnt(10)
    ds_read_b128 a[124:127], v17 offset:15360
    v_mfma_f32_16x16x32_bf16 v[104:107], a[128:131], a[80:83], v[104:107]
    s_waitcnt lgkmcnt(10)
    ds_read_b128 a[192:195], v17 offset:32768
    v_exp_f32 v96, v96
    v_mfma_f32_16x16x32_bf16 v[104:107], a[132:135], a[84:87], v[104:107]
    s_waitcnt lgkmcnt(10)
    ds_read_b128 a[196:199], v17 offset:33792
    v_exp_f32 v97, v97
    v_mfma_f32_16x16x32_bf16 v[104:107], a[136:139], a[88:91], v[104:107]
    s_waitcnt lgkmcnt(10)
    ds_read_b128 a[200:203], v17 offset:34816
    v_exp_f32 v98, v98
    v_mfma_f32_16x16x32_bf16 v[104:107], a[140:143], a[92:95], v[104:107]
    ds_read_b128 a[204:207], v17 offset:35840
    v_exp_f32 v99, v99
    v_mfma_f32_16x16x32_bf16 v[108:111], a[144:147], a[80:83], v[108:111]
    ds_read_b128 a[208:211], v17 offset:36864
    v_exp_f32 v100, v100
    v_mfma_f32_16x16x32_bf16 v[108:111], a[148:151], a[84:87], v[108:111]
    ds_read_b128 a[212:215], v17 offset:37888
    v_exp_f32 v101, v101
    v_mfma_f32_16x16x32_bf16 v[108:111], a[152:155], a[88:91], v[108:111]
    ds_read_b128 a[216:219], v17 offset:38912
    v_exp_f32 v102, v102
    v_mfma_f32_16x16x32_bf16 v[108:111], a[156:159], a[92:95], v[108:111]
    s_waitcnt lgkmcnt(14)
    ds_read_b128 a[220:223], v17 offset:39936
    v_exp_f32 v103, v103
    v_mfma_f32_16x16x32_bf16 v[112:115], a[128:131], a[96:99], v[72:75]
    s_waitcnt lgkmcnt(14)
    ds_read_b128 a[224:227], v17 offset:40960
    v_exp_f32 v104, v104
    v_mfma_f32_16x16x32_bf16 v[112:115], a[132:135], a[100:103], v[112:115]
    s_waitcnt lgkmcnt(14)
    ds_read_b128 a[228:231], v17 offset:41984
    v_exp_f32 v105, v105
    v_mfma_f32_16x16x32_bf16 v[112:115], a[136:139], a[104:107], v[112:115]
    s_waitcnt lgkmcnt(14)
    ds_read_b128 a[232:235], v17 offset:43008
    v_exp_f32 v106, v106
    v_mfma_f32_16x16x32_bf16 v[112:115], a[140:143], a[108:111], v[112:115]
    s_waitcnt lgkmcnt(14)
    ds_read_b128 a[236:239], v17 offset:44032
    v_exp_f32 v107, v107
    v_mfma_f32_16x16x32_bf16 v[120:123], a[128:131], a[112:115], v[76:79]
    s_waitcnt lgkmcnt(14)
    ds_read_b128 a[240:243], v17 offset:45056
    v_exp_f32 v108, v108
    v_mfma_f32_16x16x32_bf16 v[120:123], a[132:135], a[116:119], v[120:123]
    s_waitcnt lgkmcnt(14)
    ds_read_b128 a[244:247], v17 offset:46080
    v_exp_f32 v109, v109
    v_mfma_f32_16x16x32_bf16 v[120:123], a[136:139], a[120:123], v[120:123]
    s_waitcnt lgkmcnt(14)
    ds_read_b128 a[248:251], v17 offset:47104
    v_exp_f32 v110, v110
    v_mfma_f32_16x16x32_bf16 v[120:123], a[140:143], a[124:127], v[120:123]
    ds_read_b128 a[252:255], v17 offset:48128
    v_exp_f32 v111, v111
    v_mfma_f32_16x16x32_bf16 v[116:119], a[144:147], a[96:99], v[72:75]
    ds_read_b128 a[128:131], v18 offset:16384
    v_cvt_pk_bf16_f32 v48, v96, v97
    v_mfma_f32_16x16x32_bf16 v[116:119], a[148:151], a[100:103], v[116:119]
    ds_read_b128 a[132:135], v18 offset:17408
    v_cvt_pk_bf16_f32 v49, v98, v99
    v_mfma_f32_16x16x32_bf16 v[116:119], a[152:155], a[104:107], v[116:119]
    ds_read_b128 a[136:139], v18 offset:18432
    v_cvt_pk_bf16_f32 v50, v100, v101
    v_mfma_f32_16x16x32_bf16 v[116:119], a[156:159], a[108:111], v[116:119]
    ds_read_b128 a[140:143], v18 offset:19456
    v_cvt_pk_bf16_f32 v51, v102, v103
    v_mfma_f32_16x16x32_bf16 v[124:127], a[144:147], a[112:115], v[76:79]
    ds_read_b128 a[144:147], v18 offset:20480
    v_cvt_pk_bf16_f32 v52, v104, v105
    v_mfma_f32_16x16x32_bf16 v[124:127], a[148:151], a[116:119], v[124:127]
    ds_read_b128 a[148:151], v18 offset:21504
    v_cvt_pk_bf16_f32 v53, v106, v107
    v_mfma_f32_16x16x32_bf16 v[124:127], a[152:155], a[120:123], v[124:127]
    ds_read_b128 a[152:155], v18 offset:22528
    v_cvt_pk_bf16_f32 v54, v108, v109
    v_mfma_f32_16x16x32_bf16 v[124:127], a[156:159], a[124:127], v[124:127]
    ds_read_b128 a[156:159], v18 offset:23552
    v_cvt_pk_bf16_f32 v55, v110, v111
    v_xor_b32 v18, 196608, v18
    v_lshrrev_b32 v17, 4, v2
    v_lshlrev_b32 v17, 15, v17
    v_and_b32 v14, 255, v1
    v_add_u32 v17, v17, v14
L_t1_p1:
    s_waitcnt vmcnt(8) lgkmcnt(0)
    s_barrier
    s_cmp_eq_u32 s60, 0
    s_cbranch_scc1 L_t1_zero
    v_mfma_f32_16x16x32_bf16 v[96:99], a[128:131], a[64:67], v[64:67]
    s_add_u32 m0, s15, 0
    ds_read_b128 a[160:163], v19 offset:0
    v_mfma_f32_16x16x32_bf16 v[96:99], a[132:135], a[68:71], v[96:99]
    ds_read_b128 a[164:167], v19 offset:1024
    v_mfma_f32_16x16x32_bf16 v[96:99], a[136:139], a[72:75], v[96:99]
    v_exp_f32 v112, v112
    v_mfma_f32_16x16x32_bf16 v[96:99], a[140:143], a[76:79], v[96:99]
    buffer_load_dwordx4 v1, s[8:11], s82 offen offset:0  lds
    v_mfma_f32_16x16x32_bf16 v[104:107], a[128:131], a[80:83], v[68:71]
    v_exp_f32 v113, v113
    v_mfma_f32_16x16x32_bf16 v[104:107], a[132:135], a[84:87], v[104:107]
    ds_read_b128 a[168:171], v19 offset:2048
    v_cvt_pk_bf16_f32 v56, v112, v113
    v_mfma_f32_16x16x32_bf16 v[104:107], a[136:139], a[88:91], v[104:107]
    v_exp_f32 v114, v114
    v_mfma_f32_16x16x32_bf16 v[104:107], a[140:143], a[92:95], v[104:107]
    buffer_load_dwordx4 v1, s[8:11], s82 offen offset:1024  lds
    v_mfma_f32_16x16x32_bf16 v[100:103], a[144:147], a[64:67], v[64:67]
    v_exp_f32 v115, v115
    v_mfma_f32_16x16x32_bf16 v[100:103], a[148:151], a[68:71], v[100:103]
    ds_read_b128 a[172:175], v19 offset:3072
    v_cvt_pk_bf16_f32 v57, v114, v115
    v_mfma_f32_16x16x32_bf16 v[100:103], a[152:155], a[72:75], v[100:103]
    v_exp_f32 v116, v116
    v_mfma_f32_16x16x32_bf16 v[100:103], a[156:159], a[76:79], v[100:103]
    buffer_load_dwordx4 v1, s[8:11], s82 offen offset:2048  lds
    v_mfma_f32_16x16x32_bf16 v[108:111], a[144:147], a[80:83], v[68:71]
    v_exp_f32 v117, v117
    v_mfma_f32_16x16x32_bf16 v[108:111], a[148:151], a[84:87], v[108:111]
    ds_read_b128 a[176:179], v20 offset:4096
    v_cvt_pk_bf16_f32 v58, v116, v117
    v_mfma_f32_16x16x32_bf16 v[108:111], a[152:155], a[88:91], v[108:111]
    v_exp_f32 v118, v118
    v_mfma_f32_16x16x32_bf16 v[108:111], a[156:159], a[92:95], v[108:111]
    buffer_load_dwordx4 v1, s[8:11], s82 offen offset:3072  lds
    v_mfma_f32_16x16x32_bf16 v[32:35], v[28:31], v[48:51], 0
    s_add_u32 m0, s15, 4096
    v_exp_f32 v119, v119
    v_mfma_f32_16x16x32_bf16 v[36:39], v[28:31], v[52:55], 0
    s_waitcnt lgkmcnt(4)
    ds_read_b128 a[180:183], v20 offset:5120
    v_cvt_pk_bf16_f32 v59, v118, v119
    v_mfma_f32_16x16x32_bf16 v[128:131], a[160:163], v[48:51], 0
    v_exp_f32 v120, v120
    v_mfma_f32_16x16x32_bf16 v[160:163], a[160:163], v[52:55], 0
    s_waitcnt lgkmcnt(4)
    v_mfma_f32_16x16x32_bf16 v[132:135], a[164:167], v[48:51], 0
    v_exp_f32 v121, v121
    v_mfma_f32_16x16x32_bf16 v[164:167], a[164:167], v[52:55], 0
    s_waitcnt lgkmcnt(3)
    ds_read_b128 a[184:187], v20 offset:6144
    v_cvt_pk_bf16_f32 v60, v120, v121
    v_mfma_f32_16x16x32_bf16 v[136:139], a[168:171], v[48:51], 0
    s_waitcnt lgkmcnt(3)
    v_exp_f32 v122, v122
    v_mfma_f32_16x16x32_bf16 v[168:171], a[168:171], v[52:55], 0
    buffer_load_dwordx4 v15, s[8:11], s82 offen offset:0  lds
    v_mfma_f32_16x16x32_bf16 v[140:143], a[172:175], v[48:51], 0
    v_exp_f32 v123, v123
    v_mfma_f32_16x16x32_bf16 v[172:175], a[172:175], v[52:55], 0
    s_waitcnt lgkmcnt(2)
    ds_read_b128 a[188:191], v20 offset:7168
    v_cvt_pk_bf16_f32 v61, v122, v123
    v_mfma_f32_16x16x32_bf16 v[144:147], a[176:179], v[48:51], 0
    s_waitcnt lgkmcnt(2)
    v_exp_f32 v124, v124
    v_mfma_f32_16x16x32_bf16 v[176:179], a[176:179], v[52:55], 0
    buffer_load_dwordx4 v15, s[8:11], s82 offen offset:1024  lds
    v_mfma_f32_16x16x32_bf16 v[148:151], a[180:183], v[48:51], 0
    v_exp_f32 v125, v125
    v_mfma_f32_16x16x32_bf16 v[180:183], a[180:183], v[52:55], 0
    s_waitcnt lgkmcnt(1)
    v_cvt_pk_bf16_f32 v62, v124, v125
    v_mfma_f32_16x16x32_bf16 v[152:155], a[184:187], v[48:51], 0
    s_waitcnt lgkmcnt(0)
    v_exp_f32 v126, v126
    v_mfma_f32_16x16x32_bf16 v[184:187], a[184:187], v[52:55], 0
    buffer_load_dwordx4 v15, s[8:11], s82 offen offset:2048  lds
    v_mfma_f32_16x16x32_bf16 v[156:159], a[188:191], v[48:51], 0
    v_exp_f32 v127, v127
    v_mfma_f32_16x16x32_bf16 v[188:191], a[188:191], v[52:55], 0
    v_cvt_pk_bf16_f32 v63, v126, v127
    v_mfma_f32_16x16x32_bf16 v[112:115], a[128:131], a[96:99], v[72:75]
    v_mfma_f32_16x16x32_bf16 v[112:115], a[132:135], a[100:103], v[112:115]
    v_mfma_f32_16x16x32_bf16 v[112:115], a[136:139], a[104:107], v[112:115]
    v_exp_f32 v96, v96
    v_mfma_f32_16x16x32_bf16 v[112:115], a[140:143], a[108:111], v[112:115]
    buffer_load_dwordx4 v15, s[8:11], s82 offen offset:3072  lds
    v_mfma_f32_16x16x32_bf16 v[120:123], a[128:131], a[112:115], v[76:79]
    s_xor_b32 s15, s15, 196608
    v_exp_f32 v97, v97
    v_mfma_f32_16x16x32_bf16 v[120:123], a[132:135], a[116:119], v[120:123]
    s_add_u32 m0, s16, 0
    ds_read_b128 a[128:131], v18 offset:0
    v_cvt_pk_bf16_f32 v48, v96, v97
    v_mfma_f32_16x16x32_bf16 v[120:123], a[136:139], a[120:123], v[120:123]
    v_exp_f32 v98, v98
    v_mfma_f32_16x16x32_bf16 v[120:123], a[140:143], a[124:127], v[120:123]
    buffer_load_dwordx4 v1, s[8:11], s19 offen offset:0  lds
    v_mfma_f32_16x16x32_bf16 v[116:119], a[144:147], a[96:99], v[72:75]
    v_exp_f32 v99, v99
    v_mfma_f32_16x16x32_bf16 v[116:119], a[148:151], a[100:103], v[116:119]
    ds_read_b128 a[132:135], v18 offset:1024
    v_cvt_pk_bf16_f32 v49, v98, v99
    v_mfma_f32_16x16x32_bf16 v[116:119], a[152:155], a[104:107], v[116:119]
    v_exp_f32 v100, v100
    v_mfma_f32_16x16x32_bf16 v[116:119], a[156:159], a[108:111], v[116:119]
    buffer_load_dwordx4 v1, s[8:11], s19 offen offset:1024  lds
    v_mfma_f32_16x16x32_bf16 v[124:127], a[144:147], a[112:115], v[76:79]
    v_exp_f32 v101, v101
    v_mfma_f32_16x16x32_bf16 v[124:127], a[148:151], a[116:119], v[124:127]
    ds_read_b128 a[136:139], v18 offset:2048
    v_cvt_pk_bf16_f32 v50, v100, v101
    v_mfma_f32_16x16x32_bf16 v[124:127], a[152:155], a[120:123], v[124:127]
    v_exp_f32 v102, v102
    v_mfma_f32_16x16x32_bf16 v[124:127], a[156:159], a[124:127], v[124:127]
    buffer_load_dwordx4 v1, s[8:11], s19 offen offset:2048  lds
    v_mfma_f32_16x16x32_bf16 v[40:43], v[28:31], v[56:59], 0
    v_exp_f32 v103, v103
    v_mfma_f32_16x16x32_bf16 v[44:47], v[28:31], v[60:63], 0
    ds_read_b128 a[140:143], v18 offset:3072
    v_cvt_pk_bf16_f32 v51, v102, v103
    v_mfma_f32_16x16x32_bf16 v[192:195], a[160:163], v[56:59], 0
    v_exp_f32 v104, v104
    v_mfma_f32_16x16x32_bf16 v[224:227], a[160:163], v[60:63], 0
    v_mfma_f32_16x16x32_bf16 v[196:199], a[164:167], v[56:59], 0
    v_exp_f32 v105, v105
    v_mfma_f32_16x16x32_bf16 v[228:231], a[164:167], v[60:63], 0
    ds_read_b128 a[144:147], v18 offset:4096
    v_cvt_pk_bf16_f32 v52, v104, v105
    v_mfma_f32_16x16x32_bf16 v[200:203], a[168:171], v[56:59], 0
    v_exp_f32 v106, v106
    v_mfma_f32_16x16x32_bf16 v[232:235], a[168:171], v[60:63], 0
    buffer_load_dwordx4 v1, s[8:11], s19 offen offset:3072  lds
    v_mfma_f32_16x16x32_bf16 v[204:207], a[172:175], v[56:59], 0
    s_add_u32 m0, s16, 4096
    v_exp_f32 v107, v107
    v_mfma_f32_16x16x32_bf16 v[236:239], a[172:175], v[60:63], 0
    ds_read_b128 a[148:151], v18 offset:5120
    v_cvt_pk_bf16_f32 v53, v106, v107
    v_mfma_f32_16x16x32_bf16 v[208:211], a[176:179], v[56:59], 0
    v_exp_f32 v108, v108
    v_mfma_f32_16x16x32_bf16 v[240:243], a[176:179], v[60:63], 0
    buffer_load_dwordx4 v15, s[8:11], s19 offen offset:0  lds
    v_mfma_f32_16x16x32_bf16 v[212:215], a[180:183], v[56:59], 0
    v_exp_f32 v109, v109
    v_mfma_f32_16x16x32_bf16 v[244:247], a[180:183], v[60:63], 0
    ds_read_b128 a[152:155], v18 offset:6144
    v_cvt_pk_bf16_f32 v54, v108, v109
    v_mfma_f32_16x16x32_bf16 v[216:219], a[184:187], v[56:59], 0
    v_exp_f32 v110, v110
    v_mfma_f32_16x16x32_bf16 v[248:251], a[184:187], v[60:63], 0
    buffer_load_dwordx4 v15, s[8:11], s19 offen offset:1024  lds
    v_mfma_f32_16x16x32_bf16 v[220:223], a[188:191], v[56:59], 0
    v_exp_f32 v111, v111
    v_mfma_f32_16x16x32_bf16 v[252:255], a[188:191], v[60:63], 0
    ds_read_b128 a[156:159], v18 offset:7168
    v_cvt_pk_bf16_f32 v55, v110, v111
    s_cmp_eq_u32 s14, 0
    s_cbranch_scc1 L_t1_diag
.p2align 3
L_t1_loop:
    s_waitcnt lgkmcnt(7)
    v_mfma_f32_16x16x32_bf16 v[96:99], a[128:131], a[64:67], v[64:67]
    s_waitcnt lgkmcnt(6)
    ds_read_b128 a[160:163], v19 offset:16384
    v_mfma_f32_16x16x32_bf16 v[96:99], a[132:135], a[68:71], v[96:99]
    s_waitcnt lgkmcnt(6)
    ds_read_b128 a[164:167], v19 offset:17408
    v_mfma_f32_16x16x32_bf16 v[96:99], a[136:139], a[72:75], v[96:99]
    s_waitcnt lgkmcnt(6)
    v_exp_f32 v112, v112
    v_mfma_f32_16x16x32_bf16 v[96:99], a[140:143], a[76:79], v[96:99]
    buffer_load_dwordx4 v15, s[8:11], s19 offen offset:2048  lds
    v_mfma_f32_16x16x32_bf16 v[104:107], a[128:131], a[80:83], v[68:71]
    v_exp_f32 v113, v113
    v_mfma_f32_16x16x32_bf16 v[104:107], a[132:135], a[84:87], v[104:107]
    ds_read_b128 a[168:171], v19 offset:18432
    v_cvt_pk_bf16_f32 v56, v112, v113
    v_mfma_f32_16x16x32_bf16 v[104:107], a[136:139], a[88:91], v[104:107]
    s_waitcnt lgkmcnt(6)
    v_exp_f32 v114, v114
    v_mfma_f32_16x16x32_bf16 v[104:107], a[140:143], a[92:95], v[104:107]
    buffer_load_dwordx4 v15, s[8:11], s19 offen offset:3072  lds
    v_mfma_f32_16x16x32_bf16 v[100:103], a[144:147], a[64:67], v[64:67]
    s_waitcnt lgkmcnt(5)
    s_xor_b32 s16, s16, 98304
    v_exp_f32 v115, v115
    v_mfma_f32_16x16x32_bf16 v[100:103], a[148:151], a[68:71], v[100:103]
    s_waitcnt lgkmcnt(4)
    ds_read_b128 a[172:175], v19 offset:19456
    v_cvt_pk_bf16_f32 v57, v114, v115
    v_mfma_f32_16x16x32_bf16 v[100:103], a[152:155], a[72:75], v[100:103]
    s_waitcnt lgkmcnt(4)
    v_exp_f32 v116, v116
    v_mfma_f32_16x16x32_bf16 v[100:103], a[156:159], a[76:79], v[100:103]
    v_mfma_f32_16x16x32_bf16 v[108:111], a[144:147], a[80:83], v[68:71]
    v_exp_f32 v117, v117
    v_mfma_f32_16x16x32_bf16 v[108:111], a[148:151], a[84:87], v[108:111]
    ds_read_b128 a[176:179], v20 offset:20480
    v_cvt_pk_bf16_f32 v58, v116, v117
    v_mfma_f32_16x16x32_bf16 v[108:111], a[152:155], a[88:91], v[108:111]
    v_exp_f32 v118, v118
    v_mfma_f32_16x16x32_bf16 v[108:111], a[156:159], a[92:95], v[108:111]
    v_mfma_f32_16x16x32_bf16 v[32:35], v[28:31], v[48:51], v[32:35]
    v_exp_f32 v119, v119
    v_mfma_f32_16x16x32_bf16 v[36:39], v[28:31], v[52:55], v[36:39]
    s_waitcnt lgkmcnt(4)
    ds_read_b128 a[180:183], v20 offset:21504
    v_cvt_pk_bf16_f32 v59, v118, v119
    v_mfma_f32_16x16x32_bf16 v[128:131], a[160:163], v[48:51], v[128:131]
    v_exp_f32 v120, v120
    v_mfma_f32_16x16x32_bf16 v[160:163], a[160:163], v[52:55], v[160:163]
    s_waitcnt lgkmcnt(4)
    v_mfma_f32_16x16x32_bf16 v[132:135], a[164:167], v[48:51], v[132:135]
    v_exp_f32 v121, v121
    v_mfma_f32_16x16x32_bf16 v[164:167], a[164:167], v[52:55], v[164:167]
    s_waitcnt lgkmcnt(3)
    ds_read_b128 a[184:187], v20 offset:22528
    v_cvt_pk_bf16_f32 v60, v120, v121
    v_mfma_f32_16x16x32_bf16 v[136:139], a[168:171], v[48:51], v[136:139]
    v_exp_f32 v122, v122
    v_mfma_f32_16x16x32_bf16 v[168:171], a[168:171], v[52:55], v[168:171]
    s_waitcnt lgkmcnt(3)
    v_mfma_f32_16x16x32_bf16 v[140:143], a[172:175], v[48:51], v[140:143]
    v_exp_f32 v123, v123
    v_mfma_f32_16x16x32_bf16 v[172:175], a[172:175], v[52:55], v[172:175]
    s_waitcnt lgkmcnt(2)
    ds_read_b128 a[188:191], v20 offset:23552
    v_cvt_pk_bf16_f32 v61, v122, v123
    v_mfma_f32_16x16x32_bf16 v[144:147], a[176:179], v[48:51], v[144:147]
    v_exp_f32 v124, v124
    v_mfma_f32_16x16x32_bf16 v[176:179], a[176:179], v[52:55], v[176:179]
    s_waitcnt lgkmcnt(2)
    v_mfma_f32_16x16x32_bf16 v[148:151], a[180:183], v[48:51], v[148:151]
    v_exp_f32 v125, v125
    v_mfma_f32_16x16x32_bf16 v[180:183], a[180:183], v[52:55], v[180:183]
    s_waitcnt lgkmcnt(1)
    v_cvt_pk_bf16_f32 v62, v124, v125
    v_xor_b32 v19, 98304, v19
    v_mfma_f32_16x16x32_bf16 v[152:155], a[184:187], v[48:51], v[152:155]
    v_exp_f32 v126, v126
    v_mfma_f32_16x16x32_bf16 v[184:187], a[184:187], v[52:55], v[184:187]
    s_waitcnt lgkmcnt(0)
    v_xor_b32 v20, 98304, v20
    v_mfma_f32_16x16x32_bf16 v[156:159], a[188:191], v[48:51], v[156:159]
    v_exp_f32 v127, v127
    v_mfma_f32_16x16x32_bf16 v[188:191], a[188:191], v[52:55], v[188:191]
    v_cvt_pk_bf16_f32 v63, v126, v127
    v_mfma_f32_16x16x32_bf16 v[112:115], a[128:131], a[96:99], v[72:75]
    v_exp_f32 v96, v96
    v_mfma_f32_16x16x32_bf16 v[112:115], a[132:135], a[100:103], v[112:115]
    v_mfma_f32_16x16x32_bf16 v[112:115], a[136:139], a[104:107], v[112:115]
    v_exp_f32 v97, v97
    v_mfma_f32_16x16x32_bf16 v[112:115], a[140:143], a[108:111], v[112:115]
    v_cvt_pk_bf16_f32 v48, v96, v97
    v_mfma_f32_16x16x32_bf16 v[120:123], a[128:131], a[112:115], v[76:79]
    v_exp_f32 v98, v98
    v_mfma_f32_16x16x32_bf16 v[120:123], a[132:135], a[116:119], v[120:123]
    v_mfma_f32_16x16x32_bf16 v[120:123], a[136:139], a[120:123], v[120:123]
    v_exp_f32 v99, v99
    v_mfma_f32_16x16x32_bf16 v[120:123], a[140:143], a[124:127], v[120:123]
    v_mfma_f32_16x16x32_bf16 v[116:119], a[144:147], a[96:99], v[72:75]
    v_exp_f32 v100, v100
    v_mfma_f32_16x16x32_bf16 v[116:119], a[148:151], a[100:103], v[116:119]
    ds_read_b128 a[128:131], v18 offset:16384
    v_cvt_pk_bf16_f32 v49, v98, v99
    v_mfma_f32_16x16x32_bf16 v[116:119], a[152:155], a[104:107], v[116:119]
    s_add_u32 s19, s82, 32768
    v_exp_f32 v101, v101
    v_mfma_f32_16x16x32_bf16 v[116:119], a[156:159], a[108:111], v[116:119]
    s_sub_u32 s82, s12, s13
    ds_read_b128 a[132:135], v18 offset:17408
    v_cvt_pk_bf16_f32 v50, v100, v101
    v_mfma_f32_16x16x32_bf16 v[124:127], a[144:147], a[112:115], v[76:79]
    s_sub_u32 s82, s82, 1
    v_exp_f32 v102, v102
    v_mfma_f32_16x16x32_bf16 v[124:127], a[148:151], a[116:119], v[124:127]
    s_cmp_gt_u32 s12, s13
    s_cselect_b32 s82, s82, s12
    s_lshl_b32 s82, s82, 16
    ds_read_b128 a[136:139], v18 offset:18432
    v_mfma_f32_16x16x32_bf16 v[124:127], a[152:155], a[120:123], v[124:127]
    s_add_u32 s82, s82, s81
    v_exp_f32 v103, v103
    v_mfma_f32_16x16x32_bf16 v[124:127], a[156:159], a[124:127], v[124:127]
    s_cmp_ge_u32 s12, 17
    s_cselect_b32 s82, 2147471360, s82
    ds_read_b128 a[140:143], v18 offset:19456
    v_cvt_pk_bf16_f32 v51, v102, v103
    v_mfma_f32_16x16x32_bf16 v[40:43], v[28:31], v[56:59], v[40:43]
    s_add_u32 s12, s12, 1
    v_exp_f32 v104, v104
    v_mfma_f32_16x16x32_bf16 v[44:47], v[28:31], v[60:63], v[44:47]
    ds_read_b128 a[144:147], v18 offset:20480
    v_mfma_f32_16x16x32_bf16 v[192:195], a[160:163], v[56:59], v[192:195]
    v_exp_f32 v105, v105
    v_mfma_f32_16x16x32_bf16 v[224:227], a[160:163], v[60:63], v[224:227]
    ds_read_b128 a[148:151], v18 offset:21504
    v_cvt_pk_bf16_f32 v52, v104, v105
    v_mfma_f32_16x16x32_bf16 v[196:199], a[164:167], v[56:59], v[196:199]
    v_exp_f32 v106, v106
    v_mfma_f32_16x16x32_bf16 v[228:231], a[164:167], v[60:63], v[228:231]
    ds_read_b128 a[152:155], v18 offset:22528
    v_mfma_f32_16x16x32_bf16 v[200:203], a[168:171], v[56:59], v[200:203]
    v_exp_f32 v107, v107
    v_mfma_f32_16x16x32_bf16 v[232:235], a[168:171], v[60:63], v[232:235]
    ds_read_b128 a[156:159], v18 offset:23552
    v_cvt_pk_bf16_f32 v53, v106, v107
    v_mfma_f32_16x16x32_bf16 v[204:207], a[172:175], v[56:59], v[204:207]
    v_exp_f32 v108, v108
    v_mfma_f32_16x16x32_bf16 v[236:239], a[172:175], v[60:63], v[236:239]
    v_mfma_f32_16x16x32_bf16 v[208:211], a[176:179], v[56:59], v[208:211]
    v_exp_f32 v109, v109
    v_mfma_f32_16x16x32_bf16 v[240:243], a[176:179], v[60:63], v[240:243]
    v_cvt_pk_bf16_f32 v54, v108, v109
    v_xor_b32 v18, 196608, v18
    v_mfma_f32_16x16x32_bf16 v[212:215], a[180:183], v[56:59], v[212:215]
    v_exp_f32 v110, v110
    v_mfma_f32_16x16x32_bf16 v[244:247], a[180:183], v[60:63], v[244:247]
    v_mfma_f32_16x16x32_bf16 v[216:219], a[184:187], v[56:59], v[216:219]
    v_exp_f32 v111, v111
    v_mfma_f32_16x16x32_bf16 v[248:251], a[184:187], v[60:63], v[248:251]
    v_cvt_pk_bf16_f32 v55, v110, v111
    v_mfma_f32_16x16x32_bf16 v[220:223], a[188:191], v[56:59], v[220:223]
    v_mfma_f32_16x16x32_bf16 v[252:255], a[188:191], v[60:63], v[252:255]
    s_waitcnt vmcnt(0) lgkmcnt(0)
    s_barrier
    v_mfma_f32_16x16x32_bf16 v[96:99], a[128:131], a[64:67], v[64:67]
    s_add_u32 m0, s15, 0
    ds_read_b128 a[160:163], v19 offset:0
    v_mfma_f32_16x16x32_bf16 v[96:99], a[132:135], a[68:71], v[96:99]
    ds_read_b128 a[164:167], v19 offset:1024
    v_mfma_f32_16x16x32_bf16 v[96:99], a[136:139], a[72:75], v[96:99]
    v_exp_f32 v112, v112
    v_mfma_f32_16x16x32_bf16 v[96:99], a[140:143], a[76:79], v[96:99]
    buffer_load_dwordx4 v1, s[8:11], s82 offen offset:0  lds
    v_mfma_f32_16x16x32_bf16 v[104:107], a[128:131], a[80:83], v[68:71]
    v_exp_f32 v113, v113
    v_mfma_f32_16x16x32_bf16 v[104:107], a[132:135], a[84:87], v[104:107]
    ds_read_b128 a[168:171], v19 offset:2048
    v_cvt_pk_bf16_f32 v56, v112, v113
    v_mfma_f32_16x16x32_bf16 v[104:107], a[136:139], a[88:91], v[104:107]
    v_exp_f32 v114, v114
    v_mfma_f32_16x16x32_bf16 v[104:107], a[140:143], a[92:95], v[104:107]
    buffer_load_dwordx4 v1, s[8:11], s82 offen offset:1024  lds
    v_mfma_f32_16x16x32_bf16 v[100:103], a[144:147], a[64:67], v[64:67]
    v_exp_f32 v115, v115
    v_mfma_f32_16x16x32_bf16 v[100:103], a[148:151], a[68:71], v[100:103]
    ds_read_b128 a[172:175], v19 offset:3072
    v_cvt_pk_bf16_f32 v57, v114, v115
    v_mfma_f32_16x16x32_bf16 v[100:103], a[152:155], a[72:75], v[100:103]
    v_exp_f32 v116, v116
    v_mfma_f32_16x16x32_bf16 v[100:103], a[156:159], a[76:79], v[100:103]
    buffer_load_dwordx4 v1, s[8:11], s82 offen offset:2048  lds
    v_mfma_f32_16x16x32_bf16 v[108:111], a[144:147], a[80:83], v[68:71]
    v_exp_f32 v117, v117
    v_mfma_f32_16x16x32_bf16 v[108:111], a[148:151], a[84:87], v[108:111]
    ds_read_b128 a[176:179], v20 offset:4096
    v_cvt_pk_bf16_f32 v58, v116, v117
    v_mfma_f32_16x16x32_bf16 v[108:111], a[152:155], a[88:91], v[108:111]
    v_exp_f32 v118, v118
    v_mfma_f32_16x16x32_bf16 v[108:111], a[156:159], a[92:95], v[108:111]
    buffer_load_dwordx4 v1, s[8:11], s82 offen offset:3072  lds
    v_mfma_f32_16x16x32_bf16 v[32:35], v[28:31], v[48:51], v[32:35]
    s_add_u32 m0, s15, 4096
    v_exp_f32 v119, v119
    v_mfma_f32_16x16x32_bf16 v[36:39], v[28:31], v[52:55], v[36:39]
    s_waitcnt lgkmcnt(4)
    ds_read_b128 a[180:183], v20 offset:5120
    v_cvt_pk_bf16_f32 v59, v118, v119
    v_mfma_f32_16x16x32_bf16 v[128:131], a[160:163], v[48:51], v[128:131]
    v_exp_f32 v120, v120
    v_mfma_f32_16x16x32_bf16 v[160:163], a[160:163], v[52:55], v[160:163]
    s_waitcnt lgkmcnt(4)
    v_mfma_f32_16x16x32_bf16 v[132:135], a[164:167], v[48:51], v[132:135]
    v_exp_f32 v121, v121
    v_mfma_f32_16x16x32_bf16 v[164:167], a[164:167], v[52:55], v[164:167]
    s_waitcnt lgkmcnt(3)
    ds_read_b128 a[184:187], v20 offset:6144
    v_cvt_pk_bf16_f32 v60, v120, v121
    v_mfma_f32_16x16x32_bf16 v[136:139], a[168:171], v[48:51], v[136:139]
    s_waitcnt lgkmcnt(3)
    v_exp_f32 v122, v122
    v_mfma_f32_16x16x32_bf16 v[168:171], a[168:171], v[52:55], v[168:171]
    buffer_load_dwordx4 v15, s[8:11], s82 offen offset:0  lds
    v_mfma_f32_16x16x32_bf16 v[140:143], a[172:175], v[48:51], v[140:143]
    v_exp_f32 v123, v123
    v_mfma_f32_16x16x32_bf16 v[172:175], a[172:175], v[52:55], v[172:175]
    s_waitcnt lgkmcnt(2)
    ds_read_b128 a[188:191], v20 offset:7168
    v_cvt_pk_bf16_f32 v61, v122, v123
    v_mfma_f32_16x16x32_bf16 v[144:147], a[176:179], v[48:51], v[144:147]
    s_waitcnt lgkmcnt(2)
    v_exp_f32 v124, v124
    v_mfma_f32_16x16x32_bf16 v[176:179], a[176:179], v[52:55], v[176:179]
    buffer_load_dwordx4 v15, s[8:11], s82 offen offset:1024  lds
    v_mfma_f32_16x16x32_bf16 v[148:151], a[180:183], v[48:51], v[148:151]
    v_exp_f32 v125, v125
    v_mfma_f32_16x16x32_bf16 v[180:183], a[180:183], v[52:55], v[180:183]
    s_waitcnt lgkmcnt(1)
    v_cvt_pk_bf16_f32 v62, v124, v125
    v_mfma_f32_16x16x32_bf16 v[152:155], a[184:187], v[48:51], v[152:155]
    s_waitcnt lgkmcnt(0)
    v_exp_f32 v126, v126
    v_mfma_f32_16x16x32_bf16 v[184:187], a[184:187], v[52:55], v[184:187]
    buffer_load_dwordx4 v15, s[8:11], s82 offen offset:2048  lds
    v_mfma_f32_16x16x32_bf16 v[156:159], a[188:191], v[48:51], v[156:159]
    v_exp_f32 v127, v127
    v_mfma_f32_16x16x32_bf16 v[188:191], a[188:191], v[52:55], v[188:191]
    v_cvt_pk_bf16_f32 v63, v126, v127
    v_mfma_f32_16x16x32_bf16 v[112:115], a[128:131], a[96:99], v[72:75]
    v_mfma_f32_16x16x32_bf16 v[112:115], a[132:135], a[100:103], v[112:115]
    v_mfma_f32_16x16x32_bf16 v[112:115], a[136:139], a[104:107], v[112:115]
    v_exp_f32 v96, v96
    v_mfma_f32_16x16x32_bf16 v[112:115], a[140:143], a[108:111], v[112:115]
    buffer_load_dwordx4 v15, s[8:11], s82 offen offset:3072  lds
    v_mfma_f32_16x16x32_bf16 v[120:123], a[128:131], a[112:115], v[76:79]
    s_xor_b32 s15, s15, 196608
    v_exp_f32 v97, v97
    v_mfma_f32_16x16x32_bf16 v[120:123], a[132:135], a[116:119], v[120:123]
    s_add_u32 m0, s16, 0
    ds_read_b128 a[128:131], v18 offset:0
    v_cvt_pk_bf16_f32 v48, v96, v97
    v_mfma_f32_16x16x32_bf16 v[120:123], a[136:139], a[120:123], v[120:123]
    v_exp_f32 v98, v98
    v_mfma_f32_16x16x32_bf16 v[120:123], a[140:143], a[124:127], v[120:123]
    buffer_load_dwordx4 v1, s[8:11], s19 offen offset:0  lds
    v_mfma_f32_16x16x32_bf16 v[116:119], a[144:147], a[96:99], v[72:75]
    v_exp_f32 v99, v99
    v_mfma_f32_16x16x32_bf16 v[116:119], a[148:151], a[100:103], v[116:119]
    ds_read_b128 a[132:135], v18 offset:1024
    v_cvt_pk_bf16_f32 v49, v98, v99
    v_mfma_f32_16x16x32_bf16 v[116:119], a[152:155], a[104:107], v[116:119]
    v_exp_f32 v100, v100
    v_mfma_f32_16x16x32_bf16 v[116:119], a[156:159], a[108:111], v[116:119]
    buffer_load_dwordx4 v1, s[8:11], s19 offen offset:1024  lds
    v_mfma_f32_16x16x32_bf16 v[124:127], a[144:147], a[112:115], v[76:79]
    v_exp_f32 v101, v101
    v_mfma_f32_16x16x32_bf16 v[124:127], a[148:151], a[116:119], v[124:127]
    ds_read_b128 a[136:139], v18 offset:2048
    v_cvt_pk_bf16_f32 v50, v100, v101
    v_mfma_f32_16x16x32_bf16 v[124:127], a[152:155], a[120:123], v[124:127]
    v_exp_f32 v102, v102
    v_mfma_f32_16x16x32_bf16 v[124:127], a[156:159], a[124:127], v[124:127]
    buffer_load_dwordx4 v1, s[8:11], s19 offen offset:2048  lds
    v_mfma_f32_16x16x32_bf16 v[40:43], v[28:31], v[56:59], v[40:43]
    v_exp_f32 v103, v103
    v_mfma_f32_16x16x32_bf16 v[44:47], v[28:31], v[60:63], v[44:47]
    ds_read_b128 a[140:143], v18 offset:3072
    v_cvt_pk_bf16_f32 v51, v102, v103
    v_mfma_f32_16x16x32_bf16 v[192:195], a[160:163], v[56:59], v[192:195]
    v_exp_f32 v104, v104
    v_mfma_f32_16x16x32_bf16 v[224:227], a[160:163], v[60:63], v[224:227]
    v_mfma_f32_16x16x32_bf16 v[196:199], a[164:167], v[56:59], v[196:199]
    v_exp_f32 v105, v105
    v_mfma_f32_16x16x32_bf16 v[228:231], a[164:167], v[60:63], v[228:231]
    ds_read_b128 a[144:147], v18 offset:4096
    v_cvt_pk_bf16_f32 v52, v104, v105
    v_mfma_f32_16x16x32_bf16 v[200:203], a[168:171], v[56:59], v[200:203]
    v_exp_f32 v106, v106
    v_mfma_f32_16x16x32_bf16 v[232:235], a[168:171], v[60:63], v[232:235]
    buffer_load_dwordx4 v1, s[8:11], s19 offen offset:3072  lds
    v_mfma_f32_16x16x32_bf16 v[204:207], a[172:175], v[56:59], v[204:207]
    s_add_u32 m0, s16, 4096
    v_exp_f32 v107, v107
    v_mfma_f32_16x16x32_bf16 v[236:239], a[172:175], v[60:63], v[236:239]
    ds_read_b128 a[148:151], v18 offset:5120
    v_cvt_pk_bf16_f32 v53, v106, v107
    v_mfma_f32_16x16x32_bf16 v[208:211], a[176:179], v[56:59], v[208:211]
    s_sub_u32 s14, s14, 1
    v_exp_f32 v108, v108
    v_mfma_f32_16x16x32_bf16 v[240:243], a[176:179], v[60:63], v[240:243]
    buffer_load_dwordx4 v15, s[8:11], s19 offen offset:0  lds
    v_mfma_f32_16x16x32_bf16 v[212:215], a[180:183], v[56:59], v[212:215]
    v_exp_f32 v109, v109
    v_mfma_f32_16x16x32_bf16 v[244:247], a[180:183], v[60:63], v[244:247]
    ds_read_b128 a[152:155], v18 offset:6144
    v_cvt_pk_bf16_f32 v54, v108, v109
    v_mfma_f32_16x16x32_bf16 v[216:219], a[184:187], v[56:59], v[216:219]
    v_exp_f32 v110, v110
    v_mfma_f32_16x16x32_bf16 v[248:251], a[184:187], v[60:63], v[248:251]
    buffer_load_dwordx4 v15, s[8:11], s19 offen offset:1024  lds
    v_mfma_f32_16x16x32_bf16 v[220:223], a[188:191], v[56:59], v[220:223]
    v_exp_f32 v111, v111
    v_mfma_f32_16x16x32_bf16 v[252:255], a[188:191], v[60:63], v[252:255]
    ds_read_b128 a[156:159], v18 offset:7168
    v_cvt_pk_bf16_f32 v55, v110, v111
    s_cmp_lg_u32 s14, 0
    s_cbranch_scc1 L_t1_loop
L_t1_diag:
    s_waitcnt lgkmcnt(7)
    v_mfma_f32_16x16x32_bf16 v[96:99], a[128:131], a[64:67], v[80:83]
    s_waitcnt lgkmcnt(6)
    ds_read_b128 a[160:163], v19 offset:16384
    v_mfma_f32_16x16x32_bf16 v[96:99], a[132:135], a[68:71], v[96:99]
    s_waitcnt lgkmcnt(6)
    ds_read_b128 a[164:167], v19 offset:17408
    v_mfma_f32_16x16x32_bf16 v[96:99], a[136:139], a[72:75], v[96:99]
    s_waitcnt lgkmcnt(6)
    v_exp_f32 v112, v112
    v_mfma_f32_16x16x32_bf16 v[96:99], a[140:143], a[76:79], v[96:99]
    buffer_load_dwordx4 v15, s[8:11], s19 offen offset:2048  lds
    v_mfma_f32_16x16x32_bf16 v[104:107], a[128:131], a[80:83], v[88:91]
    v_exp_f32 v113, v113
    v_mfma_f32_16x16x32_bf16 v[104:107], a[132:135], a[84:87], v[104:107]
    ds_read_b128 a[168:171], v19 offset:18432
    v_cvt_pk_bf16_f32 v56, v112, v113
    v_mfma_f32_16x16x32_bf16 v[104:107], a[136:139], a[88:91], v[104:107]
    s_waitcnt lgkmcnt(6)
    v_exp_f32 v114, v114
    v_mfma_f32_16x16x32_bf16 v[104:107], a[140:143], a[92:95], v[104:107]
    buffer_load_dwordx4 v15, s[8:11], s19 offen offset:3072  lds
    v_mfma_f32_16x16x32_bf16 v[100:103], a[144:147], a[64:67], v[84:87]
    s_waitcnt lgkmcnt(5)
    s_xor_b32 s16, s16, 98304
    v_exp_f32 v115, v115
    v_mfma_f32_16x16x32_bf16 v[100:103], a[148:151], a[68:71], v[100:103]
    s_waitcnt lgkmcnt(4)
    ds_read_b128 a[172:175], v19 offset:19456
    v_cvt_pk_bf16_f32 v57, v114, v115
    v_mfma_f32_16x16x32_bf16 v[100:103], a[152:155], a[72:75], v[100:103]
    s_waitcnt lgkmcnt(4)
    v_exp_f32 v116, v116
    v_mfma_f32_16x16x32_bf16 v[100:103], a[156:159], a[76:79], v[100:103]
    v_mfma_f32_16x16x32_bf16 v[108:111], a[144:147], a[80:83], v[92:95]
    v_exp_f32 v117, v117
    v_mfma_f32_16x16x32_bf16 v[108:111], a[148:151], a[84:87], v[108:111]
    ds_read_b128 a[176:179], v20 offset:20480
    v_cvt_pk_bf16_f32 v58, v116, v117
    v_mfma_f32_16x16x32_bf16 v[108:111], a[152:155], a[88:91], v[108:111]
    v_exp_f32 v118, v118
    v_mfma_f32_16x16x32_bf16 v[108:111], a[156:159], a[92:95], v[108:111]
    v_mfma_f32_16x16x32_bf16 v[32:35], v[28:31], v[48:51], v[32:35]
    v_exp_f32 v119, v119
    v_mfma_f32_16x16x32_bf16 v[36:39], v[28:31], v[52:55], v[36:39]
    s_waitcnt lgkmcnt(4)
    ds_read_b128 a[180:183], v20 offset:21504
    v_cvt_pk_bf16_f32 v59, v118, v119
    v_mfma_f32_16x16x32_bf16 v[128:131], a[160:163], v[48:51], v[128:131]
    v_exp_f32 v120, v120
    v_mfma_f32_16x16x32_bf16 v[160:163], a[160:163], v[52:55], v[160:163]
    s_waitcnt lgkmcnt(4)
    v_add_f32 v80, 0, v22
    v_min_f32 v80, v80, v72
    v_mfma_f32_16x16x32_bf16 v[132:135], a[164:167], v[48:51], v[132:135]
    v_exp_f32 v121, v121
    v_mfma_f32_16x16x32_bf16 v[164:167], a[164:167], v[52:55], v[164:167]
    s_waitcnt lgkmcnt(3)
    ds_read_b128 a[184:187], v20 offset:22528
    v_cvt_pk_bf16_f32 v60, v120, v121
    v_mfma_f32_16x16x32_bf16 v[136:139], a[168:171], v[48:51], v[136:139]
    v_exp_f32 v122, v122
    v_mfma_f32_16x16x32_bf16 v[168:171], a[168:171], v[52:55], v[168:171]
    s_waitcnt lgkmcnt(3)
    v_add_f32 v81, 0xf1800000, v22
    v_min_f32 v81, v81, v73
    v_mfma_f32_16x16x32_bf16 v[140:143], a[172:175], v[48:51], v[140:143]
    v_exp_f32 v123, v123
    v_mfma_f32_16x16x32_bf16 v[172:175], a[172:175], v[52:55], v[172:175]
    s_waitcnt lgkmcnt(2)
    ds_read_b128 a[188:191], v20 offset:23552
    v_cvt_pk_bf16_f32 v61, v122, v123
    v_mfma_f32_16x16x32_bf16 v[144:147], a[176:179], v[48:51], v[144:147]
    v_exp_f32 v124, v124
    v_mfma_f32_16x16x32_bf16 v[176:179], a[176:179], v[52:55], v[176:179]
    s_waitcnt lgkmcnt(2)
    v_add_f32 v82, 0xf2000000, v22
    v_min_f32 v82, v82, v74
    v_mfma_f32_16x16x32_bf16 v[148:151], a[180:183], v[48:51], v[148:151]
    v_exp_f32 v125, v125
    v_mfma_f32_16x16x32_bf16 v[180:183], a[180:183], v[52:55], v[180:183]
    s_waitcnt lgkmcnt(1)
    v_cvt_pk_bf16_f32 v62, v124, v125
    v_xor_b32 v19, 98304, v19
    v_mfma_f32_16x16x32_bf16 v[152:155], a[184:187], v[48:51], v[152:155]
    v_exp_f32 v126, v126
    v_mfma_f32_16x16x32_bf16 v[184:187], a[184:187], v[52:55], v[184:187]
    s_waitcnt lgkmcnt(0)
    v_xor_b32 v20, 98304, v20
    v_add_f32 v83, 0xf2400000, v22
    v_mfma_f32_16x16x32_bf16 v[156:159], a[188:191], v[48:51], v[156:159]
    v_exp_f32 v127, v127
    v_mfma_f32_16x16x32_bf16 v[188:191], a[188:191], v[52:55], v[188:191]
    v_cvt_pk_bf16_f32 v63, v126, v127
    v_min_f32 v83, v83, v75
    v_add_f32 v84, 0xf3800000, v22
    v_min_f32 v84, v84, v72
    v_mfma_f32_16x16x32_bf16 v[112:115], a[128:131], a[96:99], v[72:75]
    v_exp_f32 v96, v96
    v_mfma_f32_16x16x32_bf16 v[112:115], a[132:135], a[100:103], v[112:115]
    v_mfma_f32_16x16x32_bf16 v[112:115], a[136:139], a[104:107], v[112:115]
    v_exp_f32 v97, v97
    v_mfma_f32_16x16x32_bf16 v[112:115], a[140:143], a[108:111], v[112:115]
    v_cvt_pk_bf16_f32 v48, v96, v97
    v_add_f32 v85, 0xf3880000, v22
    v_mfma_f32_16x16x32_bf16 v[120:123], a[128:131], a[112:115], v[76:79]
    v_exp_f32 v98, v98
    v_mfma_f32_16x16x32_bf16 v[120:123], a[132:135], a[116:119], v[120:123]
    v_min_f32 v85, v85, v73
    v_add_f32 v86, 0xf3900000, v22
    v_mfma_f32_16x16x32_bf16 v[120:123], a[136:139], a[120:123], v[120:123]
    v_exp_f32 v99, v99
    v_mfma_f32_16x16x32_bf16 v[120:123], a[140:143], a[124:127], v[120:123]
    v_min_f32 v86, v86, v74
    v_add_f32 v87, 0xf3980000, v22
    v_mfma_f32_16x16x32_bf16 v[116:119], a[144:147], a[96:99], v[72:75]
    v_exp_f32 v100, v100
    v_mfma_f32_16x16x32_bf16 v[116:119], a[148:151], a[100:103], v[116:119]
    ds_read_b128 a[128:131], v18 offset:16384
    v_cvt_pk_bf16_f32 v49, v98, v99
    v_mfma_f32_16x16x32_bf16 v[116:119], a[152:155], a[104:107], v[116:119]
    s_add_u32 s19, s82, 32768
    v_exp_f32 v101, v101
    v_mfma_f32_16x16x32_bf16 v[116:119], a[156:159], a[108:111], v[116:119]
    s_sub_u32 s82, s12, s13
    ds_read_b128 a[132:135], v18 offset:17408
    v_cvt_pk_bf16_f32 v50, v100, v101
    v_mfma_f32_16x16x32_bf16 v[124:127], a[144:147], a[112:115], v[76:79]
    s_sub_u32 s82, s82, 1
    v_exp_f32 v102, v102
    v_mfma_f32_16x16x32_bf16 v[124:127], a[148:151], a[116:119], v[124:127]
    s_cmp_gt_u32 s12, s13
    s_cselect_b32 s82, s82, s12
    s_lshl_b32 s82, s82, 16
    ds_read_b128 a[136:139], v18 offset:18432
    v_mfma_f32_16x16x32_bf16 v[124:127], a[152:155], a[120:123], v[124:127]
    s_add_u32 s82, s82, s81
    v_exp_f32 v103, v103
    v_mfma_f32_16x16x32_bf16 v[124:127], a[156:159], a[124:127], v[124:127]
    s_cmp_ge_u32 s12, 17
    s_cselect_b32 s82, 2147471360, s82
    ds_read_b128 a[140:143], v18 offset:19456
    v_cvt_pk_bf16_f32 v51, v102, v103
    v_mfma_f32_16x16x32_bf16 v[40:43], v[28:31], v[56:59], v[40:43]
    s_add_u32 s12, s12, 1
    v_exp_f32 v104, v104
    v_mfma_f32_16x16x32_bf16 v[44:47], v[28:31], v[60:63], v[44:47]
    ds_read_b128 a[144:147], v18 offset:20480
    v_min_f32 v87, v87, v75
    v_mfma_f32_16x16x32_bf16 v[192:195], a[160:163], v[56:59], v[192:195]
    v_exp_f32 v105, v105
    v_mfma_f32_16x16x32_bf16 v[224:227], a[160:163], v[60:63], v[224:227]
    ds_read_b128 a[148:151], v18 offset:21504
    v_cvt_pk_bf16_f32 v52, v104, v105
    v_mfma_f32_16x16x32_bf16 v[196:199], a[164:167], v[56:59], v[196:199]
    v_exp_f32 v106, v106
    v_mfma_f32_16x16x32_bf16 v[228:231], a[164:167], v[60:63], v[228:231]
    ds_read_b128 a[152:155], v18 offset:22528
    v_add_f32 v88, 0x73800000, v22
    v_mfma_f32_16x16x32_bf16 v[200:203], a[168:171], v[56:59], v[200:203]
    v_exp_f32 v107, v107
    v_mfma_f32_16x16x32_bf16 v[232:235], a[168:171], v[60:63], v[232:235]
    ds_read_b128 a[156:159], v18 offset:23552
    v_cvt_pk_bf16_f32 v53, v106, v107
    v_mfma_f32_16x16x32_bf16 v[204:207], a[172:175], v[56:59], v[204:207]
    v_exp_f32 v108, v108
    v_mfma_f32_16x16x32_bf16 v[236:239], a[172:175], v[60:63], v[236:239]
    v_min_f32 v88, v88, v76
    v_add_f32 v89, 0x73700000, v22
    v_mfma_f32_16x16x32_bf16 v[208:211], a[176:179], v[56:59], v[208:211]
    v_exp_f32 v109, v109
    v_mfma_f32_16x16x32_bf16 v[240:243], a[176:179], v[60:63], v[240:243]
    v_cvt_pk_bf16_f32 v54, v108, v109
    v_xor_b32 v18, 196608, v18
    v_mfma_f32_16x16x32_bf16 v[212:215], a[180:183], v[56:59], v[212:215]
    v_exp_f32 v110, v110
    v_mfma_f32_16x16x32_bf16 v[244:247], a[180:183], v[60:63], v[244:247]
    v_min_f32 v89, v89, v77
    v_add_f32 v90, 0x73600000, v22
    v_mfma_f32_16x16x32_bf16 v[216:219], a[184:187], v[56:59], v[216:219]
    v_exp_f32 v111, v111
    v_mfma_f32_16x16x32_bf16 v[248:251], a[184:187], v[60:63], v[248:251]
    v_cvt_pk_bf16_f32 v55, v110, v111
    v_min_f32 v90, v90, v78
    v_mfma_f32_16x16x32_bf16 v[220:223], a[188:191], v[56:59], v[220:223]
    v_add_f32 v91, 0x73500000, v22
    v_min_f32 v91, v91, v79
    v_mfma_f32_16x16x32_bf16 v[252:255], a[188:191], v[60:63], v[252:255]
    v_add_f32 v92, 0, v22
    v_min_f32 v92, v92, v76
    v_add_f32 v93, 0xf1800000, v22
    v_min_f32 v93, v93, v77
    v_add_f32 v94, 0xf2000000, v22
    v_min_f32 v94, v94, v78
    v_add_f32 v95, 0xf2400000, v22
    v_min_f32 v95, v95, v79
    s_waitcnt vmcnt(0) lgkmcnt(0)
    s_barrier
    v_mfma_f32_16x16x32_bf16 v[96:99], a[128:131], a[96:99], v[80:83]
    s_xor_b32 s100, s16, 8192
    ds_read_b128 a[176:179], v20 offset:4096
    v_lshrrev_b32 v13, 1, v1
    v_mfma_f32_16x16x32_bf16 v[96:99], a[132:135], a[100:103], v[96:99]
    s_add_u32 m0, s15, 0
    ds_read_b128 a[180:183], v20 offset:5120
    v_add_u32 v12, s100, v13
    v_mfma_f32_16x16x32_bf16 v[96:99], a[136:139], a[104:107], v[96:99]
    buffer_load_dwordx4 v1, s[8:11], s82 offen offset:0  lds
    v_exp_f32 v112, v112
    v_mfma_f32_16x16x32_bf16 v[96:99], a[140:143], a[108:111], v[96:99]
    v_exp_f32 v113, v113
    v_mfma_f32_16x16x32_bf16 v[100:103], a[144:147], a[96:99], v[84:87]
    ds_read_b128 a[184:187], v20 offset:6144
    v_cvt_pk_bf16_f32 v56, v112, v113
    v_mfma_f32_16x16x32_bf16 v[100:103], a[148:151], a[100:103], v[100:103]
    v_exp_f32 v114, v114
    v_mfma_f32_16x16x32_bf16 v[100:103], a[152:155], a[104:107], v[100:103]
    buffer_load_dwordx4 v1, s[8:11], s82 offen offset:1024  lds
    v_exp_f32 v115, v115
    v_mfma_f32_16x16x32_bf16 v[100:103], a[156:159], a[108:111], v[100:103]
    ds_read_b128 a[188:191], v20 offset:7168
    v_cvt_pk_bf16_f32 v57, v114, v115
    v_mfma_f32_16x16x32_bf16 v[104:107], a[128:131], a[112:115], v[88:91]
    v_exp_f32 v116, v116
    v_mfma_f32_16x16x32_bf16 v[104:107], a[132:135], a[116:119], v[104:107]
    v_exp_f32 v117, v117
    v_mfma_f32_16x16x32_bf16 v[104:107], a[136:139], a[120:123], v[104:107]
    ds_read_b128 a[160:163], v19 offset:0
    v_cvt_pk_bf16_f32 v58, v116, v117
    v_mfma_f32_16x16x32_bf16 v[104:107], a[140:143], a[124:127], v[104:107]
    buffer_load_dwordx4 v1, s[8:11], s82 offen offset:2048  lds
    v_exp_f32 v118, v118
    v_mfma_f32_16x16x32_bf16 v[108:111], a[144:147], a[112:115], v[92:95]
    v_exp_f32 v119, v119
    v_mfma_f32_16x16x32_bf16 v[108:111], a[148:151], a[116:119], v[108:111]
    ds_read_b128 a[164:167], v19 offset:1024
    v_cvt_pk_bf16_f32 v59, v118, v119
    v_mfma_f32_16x16x32_bf16 v[108:111], a[152:155], a[120:123], v[108:111]
    v_exp_f32 v120, v120
    v_mfma_f32_16x16x32_bf16 v[108:111], a[156:159], a[124:127], v[108:111]
    buffer_load_dwordx4 v1, s[8:11], s82 offen offset:3072  lds
    v_exp_f32 v121, v121
    v_mfma_f32_16x16x32_bf16 v[32:35], v[28:31], v[48:51], v[32:35]
    s_add_u32 m0, s15, 4096
    ds_read_b128 a[168:171], v19 offset:2048
    v_cvt_pk_bf16_f32 v60, v120, v121
    v_mfma_f32_16x16x32_bf16 v[36:39], v[28:31], v[52:55], v[36:39]
    s_waitcnt lgkmcnt(6)
    v_exp_f32 v122, v122
    v_mfma_f32_16x16x32_bf16 v[144:147], a[176:179], v[48:51], v[144:147]
    v_exp_f32 v123, v123
    v_mfma_f32_16x16x32_bf16 v[176:179], a[176:179], v[52:55], v[176:179]
    s_waitcnt lgkmcnt(5)
    ds_read_b128 a[172:175], v19 offset:3072
    v_cvt_pk_bf16_f32 v61, v122, v123
    v_mfma_f32_16x16x32_bf16 v[148:151], a[180:183], v[48:51], v[148:151]
    buffer_load_dwordx4 v15, s[8:11], s82 offen offset:0  lds
    v_exp_f32 v124, v124
    v_mfma_f32_16x16x32_bf16 v[180:183], a[180:183], v[52:55], v[180:183]
    s_waitcnt lgkmcnt(5)
    v_exp_f32 v125, v125
    v_mfma_f32_16x16x32_bf16 v[152:155], a[184:187], v[48:51], v[152:155]
    s_waitcnt lgkmcnt(4)
    v_exp_f32 v126, v126
    v_mfma_f32_16x16x32_bf16 v[184:187], a[184:187], v[52:55], v[184:187]
    buffer_load_dwordx4 v15, s[8:11], s82 offen offset:1024  lds
    v_exp_f32 v127, v127
    v_mfma_f32_16x16x32_bf16 v[156:159], a[188:191], v[48:51], v[156:159]
    ds_write_b128 v16, v[144:147] offset:32768
    v_cvt_pk_bf16_f32 v62, v124, v125
    v_mfma_f32_16x16x32_bf16 v[188:191], a[188:191], v[52:55], v[188:191]
    s_waitcnt lgkmcnt(4)
    v_exp_f32 v96, v96
    v_mfma_f32_16x16x32_bf16 v[128:131], a[160:163], v[48:51], v[128:131]
    v_exp_f32 v97, v97
    v_mfma_f32_16x16x32_bf16 v[160:163], a[160:163], v[52:55], v[160:163]
    s_waitcnt lgkmcnt(3)
    ds_write_b128 v16, v[176:179] offset:33792
    v_cvt_pk_bf16_f32 v63, v126, v127
    v_mfma_f32_16x16x32_bf16 v[132:135], a[164:167], v[48:51], v[132:135]
    s_waitcnt lgkmcnt(3)
    v_exp_f32 v98, v98
    v_mfma_f32_16x16x32_bf16 v[164:167], a[164:167], v[52:55], v[164:167]
    buffer_load_dwordx4 v15, s[8:11], s82 offen offset:2048  lds
    v_exp_f32 v99, v99
    v_mfma_f32_16x16x32_bf16 v[136:139], a[168:171], v[48:51], v[136:139]
    ds_write_b128 v16, v[148:151] offset:34816
    v_mfma_f32_16x16x32_bf16 v[168:171], a[168:171], v[52:55], v[168:171]
    s_waitcnt lgkmcnt(3)
    v_exp_f32 v100, v100
    v_mfma_f32_16x16x32_bf16 v[140:143], a[172:175], v[48:51], v[140:143]
    v_exp_f32 v101, v101
    v_mfma_f32_16x16x32_bf16 v[172:175], a[172:175], v[52:55], v[172:175]
    ds_write_b128 v16, v[180:183] offset:35840
    v_mov_b32 v33, v36
    v_mfma_f32_16x16x32_bf16 v[40:43], v[28:31], v[56:59], v[40:43]
    buffer_load_dwordx4 v15, s[8:11], s82 offen offset:3072  lds
    v_exp_f32 v102, v102
    v_mfma_f32_16x16x32_bf16 v[44:47], v[28:31], v[60:63], v[44:47]
    s_xor_b32 s15, s15, 196608
    v_exp_f32 v103, v103
    v_mfma_f32_16x16x32_bf16 v[208:211], a[176:179], v[56:59], v[208:211]
    ds_write_b128 v16, v[152:155] offset:36864
    v_cvt_pk_bf16_f32 v48, v96, v97
    v_mfma_f32_16x16x32_bf16 v[240:243], a[176:179], v[60:63], v[240:243]
    ds_read_b128 a[176:179], v20 offset:20480
    v_exp_f32 v104, v104
    v_mfma_f32_16x16x32_bf16 v[212:215], a[180:183], v[56:59], v[212:215]
    v_exp_f32 v105, v105
    v_mfma_f32_16x16x32_bf16 v[244:247], a[180:183], v[60:63], v[244:247]
    ds_read_b128 a[180:183], v20 offset:21504
    v_exp_f32 v106, v106
    v_mfma_f32_16x16x32_bf16 v[216:219], a[184:187], v[56:59], v[216:219]
    ds_write_b128 v16, v[184:187] offset:37888
    v_cvt_pk_bf16_f32 v49, v98, v99
    v_mfma_f32_16x16x32_bf16 v[248:251], a[184:187], v[60:63], v[248:251]
    ds_read_b128 a[184:187], v20 offset:22528
    v_exp_f32 v107, v107
    v_mfma_f32_16x16x32_bf16 v[220:223], a[188:191], v[56:59], v[220:223]
    v_exp_f32 v108, v108
    v_mfma_f32_16x16x32_bf16 v[252:255], a[188:191], v[60:63], v[252:255]
    ds_read_b128 a[188:191], v20 offset:23552
    v_exp_f32 v109, v109
    v_mfma_f32_16x16x32_bf16 v[192:195], a[160:163], v[56:59], v[192:195]
    ds_write_b128 v16, v[156:159] offset:38912
    v_cvt_pk_bf16_f32 v50, v100, v101
    v_mfma_f32_16x16x32_bf16 v[224:227], a[160:163], v[60:63], v[224:227]
    ds_read_b128 a[160:163], v19 offset:16384
    v_exp_f32 v110, v110
    v_mfma_f32_16x16x32_bf16 v[196:199], a[164:167], v[56:59], v[196:199]
    v_exp_f32 v111, v111
    v_mfma_f32_16x16x32_bf16 v[228:231], a[164:167], v[60:63], v[228:231]
    ds_read_b128 a[164:167], v19 offset:17408
    v_cvt_pk_bf16_f32 v51, v102, v103
    v_mfma_f32_16x16x32_bf16 v[200:203], a[168:171], v[56:59], v[200:203]
    ds_write_b128 v16, v[188:191] offset:39936
    v_cvt_pk_bf16_f32 v52, v104, v105
    v_mfma_f32_16x16x32_bf16 v[232:235], a[168:171], v[60:63], v[232:235]
    ds_read_b128 a[168:171], v19 offset:18432
    v_cvt_pk_bf16_f32 v53, v106, v107
    v_mfma_f32_16x16x32_bf16 v[204:207], a[172:175], v[56:59], v[204:207]
    v_cvt_pk_bf16_f32 v54, v108, v109
    v_cvt_pk_bf16_f32 v55, v110, v111
    v_mfma_f32_16x16x32_bf16 v[236:239], a[172:175], v[60:63], v[236:239]
    ds_read_b128 a[172:175], v19 offset:19456
    ds_write_b64 v12, v[32:33]
    s_xor_b32 s101, s16, 98304
    v_xor_b32 v12, 8192, v12
    v_add_u32 v9, s101, v1
    v_xor_b32 v8, 8192, v16
    v_xor_b32 v10, 8192, v9
L_t1_join:
    v_xor_b32 v19, 98304, v19
    v_xor_b32 v20, 98304, v20
    s_waitcnt lgkmcnt(0)
    s_barrier
    v_mfma_f32_16x16x32_bf16 v[40:43], v[28:31], v[48:51], v[40:43]
    s_lshl_b32 s100, s60, 20
    s_add_u32 s101, s100, s21
    ds_read_b64 v[120:121], v12
    v_mfma_f32_16x16x32_bf16 v[44:47], v[28:31], v[52:55], v[44:47]
    s_add_u32 s100, s100, s20
    ds_read_b128 v[144:147], v8 offset:32768
    v_lshrrev_b32 v11, 4, v2
    v_mfma_f32_16x16x32_bf16 v[208:211], a[176:179], v[48:51], v[208:211]
    ds_read_b128 v[176:179], v8 offset:33792
    v_lshrrev_b32 v13, 2, v1
    v_mfma_f32_16x16x32_bf16 v[240:243], a[176:179], v[52:55], v[240:243]
    ds_read_b128 v[148:151], v8 offset:34816
    v_add_u32 v13, 32768, v13
    v_mfma_f32_16x16x32_bf16 v[212:215], a[180:183], v[48:51], v[212:215]
    s_xor_b32 s99, s62, 8192
    ds_read_b128 v[180:183], v8 offset:35840
    v_add_u32 v14, s99, v13
    v_mfma_f32_16x16x32_bf16 v[244:247], a[180:183], v[52:55], v[244:247]
    ds_read_b128 v[152:155], v8 offset:36864
    v_cmp_eq_u32 vcc, 1, v11
    v_mfma_f32_16x16x32_bf16 v[216:219], a[184:187], v[48:51], v[216:219]
    ds_read_b128 v[184:187], v8 offset:37888
    s_waitcnt lgkmcnt(6)
    v_add_f32 v112, v120, v32
    v_mfma_f32_16x16x32_bf16 v[248:251], a[184:187], v[52:55], v[248:251]
    ds_read_b128 v[156:159], v8 offset:38912
    v_add_f32 v114, v121, v36
    v_mfma_f32_16x16x32_bf16 v[220:223], a[188:191], v[48:51], v[220:223]
    ds_read_b128 v[188:191], v8 offset:39936
    v_cndmask_b32 v12, v32, v36, vcc
    v_mfma_f32_16x16x32_bf16 v[252:255], a[188:191], v[52:55], v[252:255]
    v_rcp_f32 v112, v112
    v_mfma_f32_16x16x32_bf16 v[192:195], a[160:163], v[48:51], v[192:195]
    v_rcp_f32 v114, v114
    v_mfma_f32_16x16x32_bf16 v[224:227], a[160:163], v[52:55], v[224:227]
    v_cmp_eq_u32 vcc, 2, v11
    v_cmp_eq_u32 s[96:97], 3, v11
    v_mfma_f32_16x16x32_bf16 v[196:199], a[164:167], v[48:51], v[196:199]
    ds_write_b128 v9, v[208:211] offset:0
    v_mfma_f32_16x16x32_bf16 v[228:231], a[164:167], v[52:55], v[228:231]
    v_mfma_f32_16x16x32_bf16 v[200:203], a[168:171], v[48:51], v[200:203]
    ds_write_b128 v9, v[240:243] offset:1024
    v_mfma_f32_16x16x32_bf16 v[232:235], a[168:171], v[52:55], v[232:235]
    v_mfma_f32_16x16x32_bf16 v[204:207], a[172:175], v[48:51], v[204:207]
    ds_write_b128 v9, v[212:215] offset:2048
    v_mfma_f32_16x16x32_bf16 v[236:239], a[172:175], v[52:55], v[236:239]
    v_cndmask_b32 v12, v12, v40, vcc
    v_cndmask_b32 v12, v12, v44, s[96:97]
    ds_write_b128 v9, v[244:247] offset:3072
    s_waitcnt lgkmcnt(11)
    v_pk_add_f32 v[128:129], v[128:129], v[144:145]
    v_pk_add_f32 v[130:131], v[130:131], v[146:147]
    s_waitcnt lgkmcnt(9)
    v_pk_add_f32 v[132:133], v[132:133], v[148:149]
    v_pk_add_f32 v[134:135], v[134:135], v[150:151]
    v_pk_mul_f32 v[128:129], v[128:129], v[112:113] op_sel_hi:[1,0]
    v_pk_mul_f32 v[130:131], v[130:131], v[112:113] op_sel_hi:[1,0]
    v_pk_mul_f32 v[132:133], v[132:133], v[112:113] op_sel_hi:[1,0]
    v_pk_mul_f32 v[134:135], v[134:135], v[112:113] op_sel_hi:[1,0]
    v_cvt_pk_bf16_f32 v128, v128, v129
    v_cvt_pk_bf16_f32 v129, v130, v131
    v_cvt_pk_bf16_f32 v130, v132, v133
    s_add_u32 m0, s16, 0
    ds_write_b128 v9, v[216:219] offset:4096
    v_cvt_pk_bf16_f32 v131, v134, v135
    buffer_store_dwordx4 v[128:131], v1, s[8:11], s100 offen offset:0 sc0 sc1
    s_waitcnt lgkmcnt(8)
    v_pk_add_f32 v[136:137], v[136:137], v[152:153]
    v_pk_add_f32 v[138:139], v[138:139], v[154:155]
    s_waitcnt lgkmcnt(6)
    v_pk_add_f32 v[140:141], v[140:141], v[156:157]
    v_pk_add_f32 v[142:143], v[142:143], v[158:159]
    v_pk_mul_f32 v[136:137], v[136:137], v[112:113] op_sel_hi:[1,0]
    v_pk_mul_f32 v[138:139], v[138:139], v[112:113] op_sel_hi:[1,0]
    v_pk_mul_f32 v[140:141], v[140:141], v[112:113] op_sel_hi:[1,0]
    v_pk_mul_f32 v[142:143], v[142:143], v[112:113] op_sel_hi:[1,0]
    v_cvt_pk_bf16_f32 v136, v136, v137
    buffer_load_dwordx4 v1, s[8:11], s19 offen offset:0  lds
    ds_write_b128 v9, v[248:251] offset:5120
    v_cvt_pk_bf16_f32 v137, v138, v139
    v_cvt_pk_bf16_f32 v138, v140, v141
    v_cvt_pk_bf16_f32 v139, v142, v143
    buffer_store_dwordx4 v[136:139], v1, s[8:11], s100 offen offset:1024 sc0 sc1
    v_pk_add_f32 v[160:161], v[160:161], v[176:177]
    v_pk_add_f32 v[162:163], v[162:163], v[178:179]
    v_pk_add_f32 v[164:165], v[164:165], v[180:181]
    v_pk_add_f32 v[166:167], v[166:167], v[182:183]
    v_pk_mul_f32 v[160:161], v[160:161], v[114:115] op_sel_hi:[1,0]
    v_pk_mul_f32 v[162:163], v[162:163], v[114:115] op_sel_hi:[1,0]
    v_pk_mul_f32 v[164:165], v[164:165], v[114:115] op_sel_hi:[1,0]
    buffer_load_dwordx4 v1, s[8:11], s19 offen offset:1024  lds
    ds_write_b128 v9, v[220:223] offset:6144
    v_pk_mul_f32 v[166:167], v[166:167], v[114:115] op_sel_hi:[1,0]
    v_cvt_pk_bf16_f32 v160, v160, v161
    v_cvt_pk_bf16_f32 v161, v162, v163
    v_cvt_pk_bf16_f32 v162, v164, v165
    v_cvt_pk_bf16_f32 v163, v166, v167
    buffer_store_dwordx4 v[160:163], v15, s[8:11], s100 offen offset:0 sc0 sc1
    v_pk_add_f32 v[168:169], v[168:169], v[184:185]
    v_pk_add_f32 v[170:171], v[170:171], v[186:187]
    s_waitcnt lgkmcnt(7)
    v_pk_add_f32 v[172:173], v[172:173], v[188:189]
    v_pk_add_f32 v[174:175], v[174:175], v[190:191]
    v_pk_mul_f32 v[168:169], v[168:169], v[114:115] op_sel_hi:[1,0]
    buffer_load_dwordx4 v1, s[8:11], s19 offen offset:2048  lds
    ds_write_b128 v9, v[252:255] offset:7168
    v_pk_mul_f32 v[170:171], v[170:171], v[114:115] op_sel_hi:[1,0]
    v_pk_mul_f32 v[172:173], v[172:173], v[114:115] op_sel_hi:[1,0]
    v_pk_mul_f32 v[174:175], v[174:175], v[114:115] op_sel_hi:[1,0]
    v_cvt_pk_bf16_f32 v168, v168, v169
    v_cvt_pk_bf16_f32 v169, v170, v171
    v_cvt_pk_bf16_f32 v170, v172, v173
    v_cvt_pk_bf16_f32 v171, v174, v175
    buffer_store_dwordx4 v[168:171], v15, s[8:11], s100 offen offset:1024 sc0 sc1
    buffer_load_dwordx4 v1, s[8:11], s19 offen offset:3072  lds
    ds_write_b32 v14, v12
    v_and_b32 v14, 4294967103, v13
    v_add_u32 v14, s62, v14
    s_waitcnt lgkmcnt(0)
    s_barrier
    ds_read_b32 v116, v14 offset:128
    ds_read_b32 v118, v14 offset:192
    ds_read_b128 v[208:211], v10 offset:0
    ds_read_b128 v[212:215], v10 offset:2048
    ds_read_b128 v[216:219], v10 offset:4096
    ds_read_b128 v[220:223], v10 offset:6144
    ds_read_b128 v[240:243], v10 offset:1024
    ds_read_b128 v[244:247], v10 offset:3072
    ds_read_b128 v[248:251], v10 offset:5120
    ds_read_b128 v[252:255], v10 offset:7168
    ds_read_b32 v120, v13 offset:0
    ds_read_b32 v121, v13 offset:8192
    ds_read_b32 v122, v13 offset:16384
    ds_read_b32 v123, v13 offset:24576
    s_waitcnt lgkmcnt(13)
    v_add_f32 v116, v116, v40
    s_waitcnt lgkmcnt(12)
    v_add_f32 v118, v118, v44
    v_rcp_f32 v116, v116
    v_rcp_f32 v118, v118
    s_waitcnt lgkmcnt(11)
    v_pk_add_f32 v[192:193], v[192:193], v[208:209]
    v_pk_add_f32 v[194:195], v[194:195], v[210:211]
    s_waitcnt lgkmcnt(10)
    v_pk_add_f32 v[196:197], v[196:197], v[212:213]
    v_pk_add_f32 v[198:199], v[198:199], v[214:215]
    v_pk_mul_f32 v[192:193], v[192:193], v[116:117] op_sel_hi:[1,0]
    v_pk_mul_f32 v[194:195], v[194:195], v[116:117] op_sel_hi:[1,0]
    v_pk_mul_f32 v[196:197], v[196:197], v[116:117] op_sel_hi:[1,0]
    v_pk_mul_f32 v[198:199], v[198:199], v[116:117] op_sel_hi:[1,0]
    v_cvt_pk_bf16_f32 v192, v192, v193
    v_cvt_pk_bf16_f32 v193, v194, v195
    v_cvt_pk_bf16_f32 v194, v196, v197
    v_cvt_pk_bf16_f32 v195, v198, v199
    buffer_store_dwordx4 v[192:195], v1, s[8:11], s101 offen offset:0 sc0 sc1
    s_add_u32 m0, s16, 4096
    s_waitcnt lgkmcnt(9)
    v_pk_add_f32 v[200:201], v[200:201], v[216:217]
    v_pk_add_f32 v[202:203], v[202:203], v[218:219]
    s_waitcnt lgkmcnt(8)
    v_pk_add_f32 v[204:205], v[204:205], v[220:221]
    v_pk_add_f32 v[206:207], v[206:207], v[222:223]
    v_pk_mul_f32 v[200:201], v[200:201], v[116:117] op_sel_hi:[1,0]
    v_pk_mul_f32 v[202:203], v[202:203], v[116:117] op_sel_hi:[1,0]
    v_pk_mul_f32 v[204:205], v[204:205], v[116:117] op_sel_hi:[1,0]
    v_pk_mul_f32 v[206:207], v[206:207], v[116:117] op_sel_hi:[1,0]
    v_cvt_pk_bf16_f32 v200, v200, v201
    v_cvt_pk_bf16_f32 v201, v202, v203
    v_cvt_pk_bf16_f32 v202, v204, v205
    v_cvt_pk_bf16_f32 v203, v206, v207
    buffer_store_dwordx4 v[200:203], v1, s[8:11], s101 offen offset:1024 sc0 sc1
    buffer_load_dwordx4 v15, s[8:11], s19 offen offset:0  lds
    buffer_load_dwordx4 v15, s[8:11], s19 offen offset:1024  lds
    s_waitcnt lgkmcnt(2)
    v_add_f32 v120, v120, v121
    s_waitcnt lgkmcnt(0)
    v_add_f32 v122, v122, v123
    v_min_f32 v124, v120, v122
    v_add_f32 v120, v120, v122
    v_cmp_le_f32 vcc, 0x1f800000, v124
    s_mov_b64 s[96:97], vcc
    v_cmp_ge_f32 vcc, 0x67800000, v120
    s_and_b64 s[96:97], s[96:97], vcc
    s_cmp_eq_u64 s[96:97], -1
    s_cselect_b32 s96, s25, 1
    s_cmp_lg_u32 s96, 0
    s_cbranch_scc1 L_t1_redo
L_t1_safe:
    v_pk_add_f32 v[224:225], v[224:225], v[240:241]
    v_pk_add_f32 v[226:227], v[226:227], v[242:243]
    v_pk_add_f32 v[228:229], v[228:229], v[244:245]
    v_pk_add_f32 v[230:231], v[230:231], v[246:247]
    v_pk_mul_f32 v[224:225], v[224:225], v[118:119] op_sel_hi:[1,0]
    v_pk_mul_f32 v[226:227], v[226:227], v[118:119] op_sel_hi:[1,0]
    v_pk_mul_f32 v[228:229], v[228:229], v[118:119] op_sel_hi:[1,0]
    v_pk_mul_f32 v[230:231], v[230:231], v[118:119] op_sel_hi:[1,0]
    v_cvt_pk_bf16_f32 v224, v224, v225
    v_cvt_pk_bf16_f32 v225, v226, v227
    v_cvt_pk_bf16_f32 v226, v228, v229
    v_cvt_pk_bf16_f32 v227, v230, v231
    buffer_store_dwordx4 v[224:227], v15, s[8:11], s101 offen offset:0 sc0 sc1
    buffer_load_dwordx4 v15, s[8:11], s19 offen offset:2048  lds
    ds_read_b128 a[128:131], v18 offset:0
    ds_read_b128 a[132:135], v18 offset:1024
    ds_read_b128 a[136:139], v18 offset:2048
    ds_read_b128 a[140:143], v18 offset:3072
    v_pk_add_f32 v[232:233], v[232:233], v[248:249]
    v_pk_add_f32 v[234:235], v[234:235], v[250:251]
    v_pk_add_f32 v[236:237], v[236:237], v[252:253]
    v_pk_add_f32 v[238:239], v[238:239], v[254:255]
    v_pk_mul_f32 v[232:233], v[232:233], v[118:119] op_sel_hi:[1,0]
    v_pk_mul_f32 v[234:235], v[234:235], v[118:119] op_sel_hi:[1,0]
    v_pk_mul_f32 v[236:237], v[236:237], v[118:119] op_sel_hi:[1,0]
    v_pk_mul_f32 v[238:239], v[238:239], v[118:119] op_sel_hi:[1,0]
    v_cvt_pk_bf16_f32 v232, v232, v233
    v_cvt_pk_bf16_f32 v233, v234, v235
    v_cvt_pk_bf16_f32 v234, v236, v237
    v_cvt_pk_bf16_f32 v235, v238, v239
    buffer_store_dwordx4 v[232:235], v15, s[8:11], s101 offen offset:1024 sc0 sc1
    buffer_load_dwordx4 v15, s[8:11], s19 offen offset:3072  lds
    s_xor_b32 s16, s16, 98304
    ds_read_b128 a[144:147], v18 offset:4096
    ds_read_b128 a[148:151], v18 offset:5120
    ds_read_b128 a[152:155], v18 offset:6144
    ds_read_b128 a[156:159], v18 offset:7168
L_t2_start:
    s_waitcnt lgkmcnt(7)
    v_mfma_f32_16x16x32_bf16 v[96:99], a[128:131], a[192:195], v[64:67]
    s_waitcnt lgkmcnt(6)
    s_add_u32 s19, s82, 32768
    s_sub_u32 s82, s12, s13
    s_sub_u32 s82, s82, 1
    v_mfma_f32_16x16x32_bf16 v[96:99], a[132:135], a[196:199], v[96:99]
    s_waitcnt lgkmcnt(5)
    s_cmp_gt_u32 s12, s13
    s_cselect_b32 s82, s82, s12
    s_lshl_b32 s82, s82, 16
    s_add_u32 s82, s82, s81
    v_mfma_f32_16x16x32_bf16 v[96:99], a[136:139], a[200:203], v[96:99]
    s_waitcnt lgkmcnt(4)
    s_cmp_ge_u32 s12, 17
    s_cselect_b32 s82, 2147471360, s82
    s_add_u32 s12, s12, 1
    s_sub_u32 s14, s61, 8
    v_mfma_f32_16x16x32_bf16 v[96:99], a[140:143], a[204:207], v[96:99]
    s_waitcnt lgkmcnt(3)
    v_mfma_f32_16x16x32_bf16 v[100:103], a[144:147], a[192:195], v[64:67]
    s_waitcnt lgkmcnt(2)
    v_mfma_f32_16x16x32_bf16 v[100:103], a[148:151], a[196:199], v[100:103]
    s_waitcnt lgkmcnt(1)
    v_mfma_f32_16x16x32_bf16 v[100:103], a[152:155], a[200:203], v[100:103]
    s_waitcnt lgkmcnt(0)
    v_mfma_f32_16x16x32_bf16 v[100:103], a[156:159], a[204:207], v[100:103]
    v_mfma_f32_16x16x32_bf16 v[104:107], a[128:131], a[208:211], v[68:71]
    v_exp_f32 v96, v96
    v_mfma_f32_16x16x32_bf16 v[104:107], a[132:135], a[212:215], v[104:107]
    v_exp_f32 v97, v97
    v_mfma_f32_16x16x32_bf16 v[104:107], a[136:139], a[216:219], v[104:107]
    v_exp_f32 v98, v98
    v_mfma_f32_16x16x32_bf16 v[104:107], a[140:143], a[220:223], v[104:107]
    v_exp_f32 v99, v99
    v_mfma_f32_16x16x32_bf16 v[108:111], a[144:147], a[208:211], v[68:71]
    v_exp_f32 v100, v100
    v_mfma_f32_16x16x32_bf16 v[108:111], a[148:151], a[212:215], v[108:111]
    v_exp_f32 v101, v101
    v_mfma_f32_16x16x32_bf16 v[108:111], a[152:155], a[216:219], v[108:111]
    v_exp_f32 v102, v102
    v_mfma_f32_16x16x32_bf16 v[108:111], a[156:159], a[220:223], v[108:111]
    v_exp_f32 v103, v103
    v_mfma_f32_16x16x32_bf16 v[112:115], a[128:131], a[224:227], v[72:75]
    v_exp_f32 v104, v104
    v_mfma_f32_16x16x32_bf16 v[112:115], a[132:135], a[228:231], v[112:115]
    v_exp_f32 v105, v105
    v_mfma_f32_16x16x32_bf16 v[112:115], a[136:139], a[232:235], v[112:115]
    v_exp_f32 v106, v106
    v_mfma_f32_16x16x32_bf16 v[112:115], a[140:143], a[236:239], v[112:115]
    v_exp_f32 v107, v107
    v_mfma_f32_16x16x32_bf16 v[120:123], a[128:131], a[240:243], v[76:79]
    v_exp_f32 v108, v108
    v_mfma_f32_16x16x32_bf16 v[120:123], a[132:135], a[244:247], v[120:123]
    v_exp_f32 v109, v109
    v_mfma_f32_16x16x32_bf16 v[120:123], a[136:139], a[248:251], v[120:123]
    v_exp_f32 v110, v110
    v_mfma_f32_16x16x32_bf16 v[120:123], a[140:143], a[252:255], v[120:123]
    v_exp_f32 v111, v111
    v_mfma_f32_16x16x32_bf16 v[116:119], a[144:147], a[224:227], v[72:75]
    ds_read_b128 a[128:131], v18 offset:16384
    v_cvt_pk_bf16_f32 v48, v96, v97
    v_mfma_f32_16x16x32_bf16 v[116:119], a[148:151], a[228:231], v[116:119]
    ds_read_b128 a[132:135], v18 offset:17408
    v_cvt_pk_bf16_f32 v49, v98, v99
    v_mfma_f32_16x16x32_bf16 v[116:119], a[152:155], a[232:235], v[116:119]
    ds_read_b128 a[136:139], v18 offset:18432
    v_cvt_pk_bf16_f32 v50, v100, v101
    v_mfma_f32_16x16x32_bf16 v[116:119], a[156:159], a[236:239], v[116:119]
    ds_read_b128 a[140:143], v18 offset:19456
    v_cvt_pk_bf16_f32 v51, v102, v103
    v_mfma_f32_16x16x32_bf16 v[124:127], a[144:147], a[240:243], v[76:79]
    ds_read_b128 a[144:147], v18 offset:20480
    v_cvt_pk_bf16_f32 v52, v104, v105
    v_mfma_f32_16x16x32_bf16 v[124:127], a[148:151], a[244:247], v[124:127]
    ds_read_b128 a[148:151], v18 offset:21504
    v_cvt_pk_bf16_f32 v53, v106, v107
    v_mfma_f32_16x16x32_bf16 v[124:127], a[152:155], a[248:251], v[124:127]
    ds_read_b128 a[152:155], v18 offset:22528
    v_cvt_pk_bf16_f32 v54, v108, v109
    v_mfma_f32_16x16x32_bf16 v[124:127], a[156:159], a[252:255], v[124:127]
    ds_read_b128 a[156:159], v18 offset:23552
    v_cvt_pk_bf16_f32 v55, v110, v111
    v_xor_b32 v18, 196608, v18
    s_waitcnt vmcnt(0) lgkmcnt(0)
    s_barrier
    v_mfma_f32_16x16x32_bf16 v[96:99], a[128:131], a[192:195], v[64:67]
    s_add_u32 m0, s15, 0
    ds_read_b128 a[160:163], v19 offset:0
    v_mfma_f32_16x16x32_bf16 v[96:99], a[132:135], a[196:199], v[96:99]
    ds_read_b128 a[164:167], v19 offset:1024
    v_mfma_f32_16x16x32_bf16 v[96:99], a[136:139], a[200:203], v[96:99]
    v_exp_f32 v112, v112
    v_mfma_f32_16x16x32_bf16 v[96:99], a[140:143], a[204:207], v[96:99]
    buffer_load_dwordx4 v1, s[8:11], s82 offen offset:0  lds
    v_mfma_f32_16x16x32_bf16 v[104:107], a[128:131], a[208:211], v[68:71]
    v_exp_f32 v113, v113
    v_mfma_f32_16x16x32_bf16 v[104:107], a[132:135], a[212:215], v[104:107]
    ds_read_b128 a[168:171], v19 offset:2048
    v_cvt_pk_bf16_f32 v56, v112, v113
    v_mfma_f32_16x16x32_bf16 v[104:107], a[136:139], a[216:219], v[104:107]
    v_exp_f32 v114, v114
    v_mfma_f32_16x16x32_bf16 v[104:107], a[140:143], a[220:223], v[104:107]
    buffer_load_dwordx4 v1, s[8:11], s82 offen offset:1024  lds
    v_mfma_f32_16x16x32_bf16 v[100:103], a[144:147], a[192:195], v[64:67]
    v_exp_f32 v115, v115
    v_mfma_f32_16x16x32_bf16 v[100:103], a[148:151], a[196:199], v[100:103]
    ds_read_b128 a[172:175], v19 offset:3072
    v_cvt_pk_bf16_f32 v57, v114, v115
    v_mfma_f32_16x16x32_bf16 v[100:103], a[152:155], a[200:203], v[100:103]
    v_exp_f32 v116, v116
    v_mfma_f32_16x16x32_bf16 v[100:103], a[156:159], a[204:207], v[100:103]
    buffer_load_dwordx4 v1, s[8:11], s82 offen offset:2048  lds
    v_mfma_f32_16x16x32_bf16 v[108:111], a[144:147], a[208:211], v[68:71]
    v_exp_f32 v117, v117
    v_mfma_f32_16x16x32_bf16 v[108:111], a[148:151], a[212:215], v[108:111]
    ds_read_b128 a[176:179], v20 offset:4096
    v_cvt_pk_bf16_f32 v58, v116, v117
    v_mfma_f32_16x16x32_bf16 v[108:111], a[152:155], a[216:219], v[108:111]
    v_exp_f32 v118, v118
    v_mfma_f32_16x16x32_bf16 v[108:111], a[156:159], a[220:223], v[108:111]
    buffer_load_dwordx4 v1, s[8:11], s82 offen offset:3072  lds
    v_mfma_f32_16x16x32_bf16 v[32:35], v[28:31], v[48:51], 0
    s_add_u32 m0, s15, 4096
    v_exp_f32 v119, v119
    v_mfma_f32_16x16x32_bf16 v[36:39], v[28:31], v[52:55], 0
    s_waitcnt lgkmcnt(4)
    ds_read_b128 a[180:183], v20 offset:5120
    v_cvt_pk_bf16_f32 v59, v118, v119
    v_mfma_f32_16x16x32_bf16 v[128:131], a[160:163], v[48:51], 0
    v_exp_f32 v120, v120
    v_mfma_f32_16x16x32_bf16 v[160:163], a[160:163], v[52:55], 0
    s_waitcnt lgkmcnt(4)
    v_mfma_f32_16x16x32_bf16 v[132:135], a[164:167], v[48:51], 0
    v_exp_f32 v121, v121
    v_mfma_f32_16x16x32_bf16 v[164:167], a[164:167], v[52:55], 0
    s_waitcnt lgkmcnt(3)
    ds_read_b128 a[184:187], v20 offset:6144
    v_cvt_pk_bf16_f32 v60, v120, v121
    v_mfma_f32_16x16x32_bf16 v[136:139], a[168:171], v[48:51], 0
    s_waitcnt lgkmcnt(3)
    v_exp_f32 v122, v122
    v_mfma_f32_16x16x32_bf16 v[168:171], a[168:171], v[52:55], 0
    buffer_load_dwordx4 v15, s[8:11], s82 offen offset:0  lds
    v_mfma_f32_16x16x32_bf16 v[140:143], a[172:175], v[48:51], 0
    v_exp_f32 v123, v123
    v_mfma_f32_16x16x32_bf16 v[172:175], a[172:175], v[52:55], 0
    s_waitcnt lgkmcnt(2)
    ds_read_b128 a[188:191], v20 offset:7168
    v_cvt_pk_bf16_f32 v61, v122, v123
    v_mfma_f32_16x16x32_bf16 v[144:147], a[176:179], v[48:51], 0
    s_waitcnt lgkmcnt(2)
    v_exp_f32 v124, v124
    v_mfma_f32_16x16x32_bf16 v[176:179], a[176:179], v[52:55], 0
    buffer_load_dwordx4 v15, s[8:11], s82 offen offset:1024  lds
    v_mfma_f32_16x16x32_bf16 v[148:151], a[180:183], v[48:51], 0
    v_exp_f32 v125, v125
    v_mfma_f32_16x16x32_bf16 v[180:183], a[180:183], v[52:55], 0
    s_waitcnt lgkmcnt(1)
    v_cvt_pk_bf16_f32 v62, v124, v125
    v_mfma_f32_16x16x32_bf16 v[152:155], a[184:187], v[48:51], 0
    s_waitcnt lgkmcnt(0)
    v_exp_f32 v126, v126
    v_mfma_f32_16x16x32_bf16 v[184:187], a[184:187], v[52:55], 0
    buffer_load_dwordx4 v15, s[8:11], s82 offen offset:2048  lds
    v_mfma_f32_16x16x32_bf16 v[156:159], a[188:191], v[48:51], 0
    v_exp_f32 v127, v127
    v_mfma_f32_16x16x32_bf16 v[188:191], a[188:191], v[52:55], 0
    v_cvt_pk_bf16_f32 v63, v126, v127
    v_mfma_f32_16x16x32_bf16 v[112:115], a[128:131], a[224:227], v[72:75]
    v_mfma_f32_16x16x32_bf16 v[112:115], a[132:135], a[228:231], v[112:115]
    v_mfma_f32_16x16x32_bf16 v[112:115], a[136:139], a[232:235], v[112:115]
    v_exp_f32 v96, v96
    v_mfma_f32_16x16x32_bf16 v[112:115], a[140:143], a[236:239], v[112:115]
    buffer_load_dwordx4 v15, s[8:11], s82 offen offset:3072  lds
    v_mfma_f32_16x16x32_bf16 v[120:123], a[128:131], a[240:243], v[76:79]
    s_xor_b32 s15, s15, 196608
    v_exp_f32 v97, v97
    v_mfma_f32_16x16x32_bf16 v[120:123], a[132:135], a[244:247], v[120:123]
    s_add_u32 m0, s16, 0
    ds_read_b128 a[128:131], v18 offset:0
    v_cvt_pk_bf16_f32 v48, v96, v97
    v_mfma_f32_16x16x32_bf16 v[120:123], a[136:139], a[248:251], v[120:123]
    v_exp_f32 v98, v98
    v_mfma_f32_16x16x32_bf16 v[120:123], a[140:143], a[252:255], v[120:123]
    buffer_load_dwordx4 v1, s[8:11], s19 offen offset:0  lds
    v_mfma_f32_16x16x32_bf16 v[116:119], a[144:147], a[224:227], v[72:75]
    v_exp_f32 v99, v99
    v_mfma_f32_16x16x32_bf16 v[116:119], a[148:151], a[228:231], v[116:119]
    ds_read_b128 a[132:135], v18 offset:1024
    v_cvt_pk_bf16_f32 v49, v98, v99
    v_mfma_f32_16x16x32_bf16 v[116:119], a[152:155], a[232:235], v[116:119]
    v_exp_f32 v100, v100
    v_mfma_f32_16x16x32_bf16 v[116:119], a[156:159], a[236:239], v[116:119]
    buffer_load_dwordx4 v1, s[8:11], s19 offen offset:1024  lds
    v_mfma_f32_16x16x32_bf16 v[124:127], a[144:147], a[240:243], v[76:79]
    v_exp_f32 v101, v101
    v_mfma_f32_16x16x32_bf16 v[124:127], a[148:151], a[244:247], v[124:127]
    ds_read_b128 a[136:139], v18 offset:2048
    v_cvt_pk_bf16_f32 v50, v100, v101
    v_mfma_f32_16x16x32_bf16 v[124:127], a[152:155], a[248:251], v[124:127]
    v_exp_f32 v102, v102
    v_mfma_f32_16x16x32_bf16 v[124:127], a[156:159], a[252:255], v[124:127]
    buffer_load_dwordx4 v1, s[8:11], s19 offen offset:2048  lds
    v_mfma_f32_16x16x32_bf16 v[40:43], v[28:31], v[56:59], 0
    v_exp_f32 v103, v103
    v_mfma_f32_16x16x32_bf16 v[44:47], v[28:31], v[60:63], 0
    ds_read_b128 a[140:143], v18 offset:3072
    v_cvt_pk_bf16_f32 v51, v102, v103
    v_mfma_f32_16x16x32_bf16 v[192:195], a[160:163], v[56:59], 0
    v_exp_f32 v104, v104
    v_mfma_f32_16x16x32_bf16 v[224:227], a[160:163], v[60:63], 0
    v_mfma_f32_16x16x32_bf16 v[196:199], a[164:167], v[56:59], 0
    v_exp_f32 v105, v105
    v_mfma_f32_16x16x32_bf16 v[228:231], a[164:167], v[60:63], 0
    ds_read_b128 a[144:147], v18 offset:4096
    v_cvt_pk_bf16_f32 v52, v104, v105
    v_mfma_f32_16x16x32_bf16 v[200:203], a[168:171], v[56:59], 0
    v_exp_f32 v106, v106
    v_mfma_f32_16x16x32_bf16 v[232:235], a[168:171], v[60:63], 0
    buffer_load_dwordx4 v1, s[8:11], s19 offen offset:3072  lds
    v_mfma_f32_16x16x32_bf16 v[204:207], a[172:175], v[56:59], 0
    s_add_u32 m0, s16, 4096
    v_exp_f32 v107, v107
    v_mfma_f32_16x16x32_bf16 v[236:239], a[172:175], v[60:63], 0
    ds_read_b128 a[148:151], v18 offset:5120
    v_cvt_pk_bf16_f32 v53, v106, v107
    v_mfma_f32_16x16x32_bf16 v[208:211], a[176:179], v[56:59], 0
    v_exp_f32 v108, v108
    v_mfma_f32_16x16x32_bf16 v[240:243], a[176:179], v[60:63], 0
    buffer_load_dwordx4 v15, s[8:11], s19 offen offset:0  lds
    v_mfma_f32_16x16x32_bf16 v[212:215], a[180:183], v[56:59], 0
    v_exp_f32 v109, v109
    v_mfma_f32_16x16x32_bf16 v[244:247], a[180:183], v[60:63], 0
    ds_read_b128 a[152:155], v18 offset:6144
    v_cvt_pk_bf16_f32 v54, v108, v109
    v_mfma_f32_16x16x32_bf16 v[216:219], a[184:187], v[56:59], 0
    v_exp_f32 v110, v110
    v_mfma_f32_16x16x32_bf16 v[248:251], a[184:187], v[60:63], 0
    buffer_load_dwordx4 v15, s[8:11], s19 offen offset:1024  lds
    v_mfma_f32_16x16x32_bf16 v[220:223], a[188:191], v[56:59], 0
    v_exp_f32 v111, v111
    v_mfma_f32_16x16x32_bf16 v[252:255], a[188:191], v[60:63], 0
    ds_read_b128 a[156:159], v18 offset:7168
    v_cvt_pk_bf16_f32 v55, v110, v111
    s_waitcnt lgkmcnt(7)
    v_mfma_f32_16x16x32_bf16 v[96:99], a[128:131], a[192:195], v[64:67]
    s_waitcnt lgkmcnt(6)
    s_lshr_b32 s101, s2, 3
    s_sub_u32 s101, s101, 4
    ds_read_b128 a[160:163], v19 offset:16384
    v_mfma_f32_16x16x32_bf16 v[96:99], a[132:135], a[196:199], v[96:99]
    s_waitcnt lgkmcnt(6)
    s_and_b32 s101, s101, 31
    ds_read_b128 a[164:167], v19 offset:17408
    v_and_b32 v14, 7, v2
    v_mfma_f32_16x16x32_bf16 v[96:99], a[136:139], a[200:203], v[96:99]
    s_waitcnt lgkmcnt(6)
    v_exp_f32 v112, v112
    v_mfma_f32_16x16x32_bf16 v[96:99], a[140:143], a[204:207], v[96:99]
    buffer_load_dwordx4 v15, s[8:11], s19 offen offset:2048  lds
    v_mfma_f32_16x16x32_bf16 v[104:107], a[128:131], a[208:211], v[68:71]
    v_exp_f32 v113, v113
    v_mfma_f32_16x16x32_bf16 v[104:107], a[132:135], a[212:215], v[104:107]
    ds_read_b128 a[168:171], v19 offset:18432
    v_cvt_pk_bf16_f32 v56, v112, v113
    v_mfma_f32_16x16x32_bf16 v[104:107], a[136:139], a[216:219], v[104:107]
    s_waitcnt lgkmcnt(6)
    v_exp_f32 v114, v114
    v_mfma_f32_16x16x32_bf16 v[104:107], a[140:143], a[220:223], v[104:107]
    buffer_load_dwordx4 v15, s[8:11], s19 offen offset:3072  lds
    v_mfma_f32_16x16x32_bf16 v[100:103], a[144:147], a[192:195], v[64:67]
    s_waitcnt lgkmcnt(5)
    s_xor_b32 s16, s16, 98304
    v_exp_f32 v115, v115
    v_mfma_f32_16x16x32_bf16 v[100:103], a[148:151], a[196:199], v[100:103]
    s_waitcnt lgkmcnt(4)
    s_add_u32 s27, s18, 0
    ds_read_b128 a[172:175], v19 offset:19456
    v_cvt_pk_bf16_f32 v57, v114, v115
    v_mfma_f32_16x16x32_bf16 v[100:103], a[152:155], a[200:203], v[100:103]
    s_waitcnt lgkmcnt(4)
    v_exp_f32 v116, v116
    v_mfma_f32_16x16x32_bf16 v[100:103], a[156:159], a[204:207], v[100:103]
    buffer_store_dwordx4 v[24:27], v17, s[8:11], s27 offen offset:0 sc0 sc1
    v_mfma_f32_16x16x32_bf16 v[108:111], a[144:147], a[208:211], v[68:71]
    s_add_u32 s27, s18, 131072
    v_exp_f32 v117, v117
    v_mfma_f32_16x16x32_bf16 v[108:111], a[148:151], a[212:215], v[108:111]
    ds_read_b128 a[176:179], v20 offset:20480
    v_cvt_pk_bf16_f32 v58, v116, v117
    v_mfma_f32_16x16x32_bf16 v[108:111], a[152:155], a[216:219], v[108:111]
    v_exp_f32 v118, v118
    v_mfma_f32_16x16x32_bf16 v[108:111], a[156:159], a[220:223], v[108:111]
    buffer_store_dwordx4 v[24:27], v17, s[8:11], s27 offen offset:0 sc0 sc1
    v_mfma_f32_16x16x32_bf16 v[32:35], v[28:31], v[48:51], v[32:35]
    v_exp_f32 v119, v119
    v_mfma_f32_16x16x32_bf16 v[36:39], v[28:31], v[52:55], v[36:39]
    s_waitcnt lgkmcnt(4)
    ds_read_b128 a[180:183], v20 offset:21504
    v_cvt_pk_bf16_f32 v59, v118, v119
    v_mfma_f32_16x16x32_bf16 v[128:131], a[160:163], v[48:51], v[128:131]
    v_exp_f32 v120, v120
    v_mfma_f32_16x16x32_bf16 v[160:163], a[160:163], v[52:55], v[160:163]
    s_waitcnt lgkmcnt(4)
    v_lshlrev_b32 v14, 4, v14
    v_lshrrev_b32 v13, 3, v2
    v_mfma_f32_16x16x32_bf16 v[132:135], a[164:167], v[48:51], v[132:135]
    v_exp_f32 v121, v121
    v_mfma_f32_16x16x32_bf16 v[164:167], a[164:167], v[52:55], v[164:167]
    s_waitcnt lgkmcnt(3)
    ds_read_b128 a[184:187], v20 offset:22528
    v_cvt_pk_bf16_f32 v60, v120, v121
    v_mfma_f32_16x16x32_bf16 v[136:139], a[168:171], v[48:51], v[136:139]
    v_exp_f32 v122, v122
    v_mfma_f32_16x16x32_bf16 v[168:171], a[168:171], v[52:55], v[168:171]
    s_waitcnt lgkmcnt(3)
    v_lshl_add_u32 v12, v13, 13, v14
    v_mul_u32_u24 v13, 28672, v13
    v_mfma_f32_16x16x32_bf16 v[140:143], a[172:175], v[48:51], v[140:143]
    v_exp_f32 v123, v123
    v_mfma_f32_16x16x32_bf16 v[172:175], a[172:175], v[52:55], v[172:175]
    s_waitcnt lgkmcnt(2)
    ds_read_b128 a[188:191], v20 offset:23552
    v_cvt_pk_bf16_f32 v61, v122, v123
    v_mfma_f32_16x16x32_bf16 v[144:147], a[176:179], v[48:51], v[144:147]
    v_exp_f32 v124, v124
    v_mfma_f32_16x16x32_bf16 v[176:179], a[176:179], v[52:55], v[176:179]
    s_waitcnt lgkmcnt(2)
    v_add_u32 v13, v13, v14
    v_mfma_f32_16x16x32_bf16 v[148:151], a[180:183], v[48:51], v[148:151]
    s_lshl_b32 s17, s4, 2
    v_exp_f32 v125, v125
    v_mfma_f32_16x16x32_bf16 v[180:183], a[180:183], v[52:55], v[180:183]
    s_waitcnt lgkmcnt(1)
    s_add_u32 s17, s17, s3
    v_cvt_pk_bf16_f32 v62, v124, v125
    v_xor_b32 v19, 98304, v19
    v_mfma_f32_16x16x32_bf16 v[152:155], a[184:187], v[48:51], v[152:155]
    s_lshl_b32 s17, s17, 7
    v_exp_f32 v126, v126
    v_mfma_f32_16x16x32_bf16 v[184:187], a[184:187], v[52:55], v[184:187]
    s_waitcnt lgkmcnt(0)
    s_lshl_b32 s100, s101, 16
    s_add_u32 s17, s17, s100
    v_xor_b32 v20, 98304, v20
    v_mfma_f32_16x16x32_bf16 v[156:159], a[188:191], v[48:51], v[156:159]
    s_add_u32 s17, s17, 4194304
    v_exp_f32 v127, v127
    v_mfma_f32_16x16x32_bf16 v[188:191], a[188:191], v[52:55], v[188:191]
    s_cmp_lt_u32 s101, s26
    s_cselect_b32 s17, s17, 2143285248
    v_cvt_pk_bf16_f32 v63, v126, v127
    buffer_store_dwordx4 a[0:3], v12, s[8:11], s17 offen sc0 sc1
    v_mfma_f32_16x16x32_bf16 v[112:115], a[128:131], a[224:227], v[72:75]
    s_add_u32 s17, s17, 4096
    v_exp_f32 v96, v96
    v_mfma_f32_16x16x32_bf16 v[112:115], a[132:135], a[228:231], v[112:115]
    buffer_store_dwordx4 a[4:7], v12, s[8:11], s17 offen sc0 sc1
    v_mfma_f32_16x16x32_bf16 v[112:115], a[136:139], a[232:235], v[112:115]
    s_add_u32 s27, s18, 0
    v_exp_f32 v97, v97
    v_mfma_f32_16x16x32_bf16 v[112:115], a[140:143], a[236:239], v[112:115]
    v_cvt_pk_bf16_f32 v48, v96, v97
    v_lshrrev_b32 v9, 1, v2
    v_mfma_f32_16x16x32_bf16 v[120:123], a[128:131], a[240:243], v[76:79]
    v_exp_f32 v98, v98
    v_mfma_f32_16x16x32_bf16 v[120:123], a[132:135], a[244:247], v[120:123]
    buffer_store_dwordx4 v[24:27], v17, s[8:11], s27 offen offset:256 sc0 sc1
    v_mfma_f32_16x16x32_bf16 v[120:123], a[136:139], a[248:251], v[120:123]
    s_add_u32 s27, s18, 131072
    v_exp_f32 v99, v99
    v_mfma_f32_16x16x32_bf16 v[120:123], a[140:143], a[252:255], v[120:123]
    buffer_store_dwordx4 v[24:27], v17, s[8:11], s27 offen offset:256 sc0 sc1
    v_mfma_f32_16x16x32_bf16 v[116:119], a[144:147], a[224:227], v[72:75]
    s_add_u32 s27, s18, 0
    v_exp_f32 v100, v100
    v_mfma_f32_16x16x32_bf16 v[116:119], a[148:151], a[228:231], v[116:119]
    ds_read_b128 a[128:131], v18 offset:16384
    v_cvt_pk_bf16_f32 v49, v98, v99
    v_mfma_f32_16x16x32_bf16 v[116:119], a[152:155], a[232:235], v[116:119]
    s_add_u32 s19, s82, 32768
    v_exp_f32 v101, v101
    v_mfma_f32_16x16x32_bf16 v[116:119], a[156:159], a[236:239], v[116:119]
    s_sub_u32 s82, s12, s13
    ds_read_b128 a[132:135], v18 offset:17408
    v_cvt_pk_bf16_f32 v50, v100, v101
    v_mfma_f32_16x16x32_bf16 v[124:127], a[144:147], a[240:243], v[76:79]
    s_sub_u32 s82, s82, 1
    v_exp_f32 v102, v102
    v_mfma_f32_16x16x32_bf16 v[124:127], a[148:151], a[244:247], v[124:127]
    s_cmp_gt_u32 s12, s13
    s_cselect_b32 s82, s82, s12
    s_lshl_b32 s82, s82, 16
    ds_read_b128 a[136:139], v18 offset:18432
    v_mfma_f32_16x16x32_bf16 v[124:127], a[152:155], a[248:251], v[124:127]
    s_add_u32 s82, s82, s81
    v_exp_f32 v103, v103
    v_mfma_f32_16x16x32_bf16 v[124:127], a[156:159], a[252:255], v[124:127]
    s_cmp_ge_u32 s12, 17
    s_cselect_b32 s82, 2147471360, s82
    ds_read_b128 a[140:143], v18 offset:19456
    v_cvt_pk_bf16_f32 v51, v102, v103
    v_mfma_f32_16x16x32_bf16 v[40:43], v[28:31], v[56:59], v[40:43]
    s_add_u32 s12, s12, 1
    v_exp_f32 v104, v104
    v_mfma_f32_16x16x32_bf16 v[44:47], v[28:31], v[60:63], v[44:47]
    ds_read_b128 a[144:147], v18 offset:20480
    v_lshrrev_b32 v10, 4, v2
    v_mfma_f32_16x16x32_bf16 v[192:195], a[160:163], v[56:59], v[192:195]
    v_exp_f32 v105, v105
    v_mfma_f32_16x16x32_bf16 v[224:227], a[160:163], v[60:63], v[224:227]
    ds_read_b128 a[148:151], v18 offset:21504
    v_cvt_pk_bf16_f32 v52, v104, v105
    v_mfma_f32_16x16x32_bf16 v[196:199], a[164:167], v[56:59], v[196:199]
    v_exp_f32 v106, v106
    v_mfma_f32_16x16x32_bf16 v[228:231], a[164:167], v[60:63], v[228:231]
    ds_read_b128 a[152:155], v18 offset:22528
    v_xor_b32 v9, v9, v10
    v_mfma_f32_16x16x32_bf16 v[200:203], a[168:171], v[56:59], v[200:203]
    v_exp_f32 v107, v107
    v_mfma_f32_16x16x32_bf16 v[232:235], a[168:171], v[60:63], v[232:235]
    ds_read_b128 a[156:159], v18 offset:23552
    v_cvt_pk_bf16_f32 v53, v106, v107
    v_mfma_f32_16x16x32_bf16 v[204:207], a[172:175], v[56:59], v[204:207]
    v_exp_f32 v108, v108
    v_mfma_f32_16x16x32_bf16 v[236:239], a[172:175], v[60:63], v[236:239]
    buffer_store_dwordx4 v[24:27], v17, s[8:11], s27 offen offset:512 sc0 sc1
    v_mfma_f32_16x16x32_bf16 v[208:211], a[176:179], v[56:59], v[208:211]
    s_add_u32 s27, s18, 131072
    v_exp_f32 v109, v109
    v_mfma_f32_16x16x32_bf16 v[240:243], a[176:179], v[60:63], v[240:243]
    v_cvt_pk_bf16_f32 v54, v108, v109
    v_xor_b32 v18, 196608, v18
    v_mfma_f32_16x16x32_bf16 v[212:215], a[180:183], v[56:59], v[212:215]
    v_exp_f32 v110, v110
    v_mfma_f32_16x16x32_bf16 v[244:247], a[180:183], v[60:63], v[244:247]
    buffer_store_dwordx4 v[24:27], v17, s[8:11], s27 offen offset:512 sc0 sc1
    v_mfma_f32_16x16x32_bf16 v[216:219], a[184:187], v[56:59], v[216:219]
    s_add_u32 s27, s18, 0
    v_exp_f32 v111, v111
    v_mfma_f32_16x16x32_bf16 v[248:251], a[184:187], v[60:63], v[248:251]
    v_cvt_pk_bf16_f32 v55, v110, v111
    v_and_b32 v9, 3, v9
    v_mfma_f32_16x16x32_bf16 v[220:223], a[188:191], v[56:59], v[220:223]
    buffer_store_dwordx4 v[24:27], v17, s[8:11], s27 offen offset:768 sc0 sc1
    v_mfma_f32_16x16x32_bf16 v[252:255], a[188:191], v[60:63], v[252:255]
    v_lshlrev_b32 v9, 5, v9
    v_and_b32 v10, 1, v2
    v_lshl_add_u32 v9, v10, 4, v9
    v_lshrrev_b32 v8, 3, v2
    s_waitcnt vmcnt(9) lgkmcnt(0)
    s_barrier
    buffer_store_dword v6, v5, s[8:11], s22 offen sc0 sc1
    v_mfma_f32_16x16x32_bf16 v[96:99], a[128:131], a[192:195], v[64:67]
    s_add_u32 m0, s15, 0
    ds_read_b128 a[160:163], v19 offset:0
    v_mfma_f32_16x16x32_bf16 v[96:99], a[132:135], a[196:199], v[96:99]
    ds_read_b128 a[164:167], v19 offset:1024
    v_mfma_f32_16x16x32_bf16 v[96:99], a[136:139], a[200:203], v[96:99]
    v_exp_f32 v112, v112
    v_mfma_f32_16x16x32_bf16 v[96:99], a[140:143], a[204:207], v[96:99]
    buffer_load_dwordx4 v1, s[8:11], s82 offen offset:0  lds
    v_mfma_f32_16x16x32_bf16 v[104:107], a[128:131], a[208:211], v[68:71]
    v_exp_f32 v113, v113
    v_mfma_f32_16x16x32_bf16 v[104:107], a[132:135], a[212:215], v[104:107]
    ds_read_b128 a[168:171], v19 offset:2048
    v_cvt_pk_bf16_f32 v56, v112, v113
    v_mfma_f32_16x16x32_bf16 v[104:107], a[136:139], a[216:219], v[104:107]
    v_exp_f32 v114, v114
    v_mfma_f32_16x16x32_bf16 v[104:107], a[140:143], a[220:223], v[104:107]
    buffer_load_dwordx4 v1, s[8:11], s82 offen offset:1024  lds
    v_mfma_f32_16x16x32_bf16 v[100:103], a[144:147], a[192:195], v[64:67]
    v_exp_f32 v115, v115
    v_mfma_f32_16x16x32_bf16 v[100:103], a[148:151], a[196:199], v[100:103]
    ds_read_b128 a[172:175], v19 offset:3072
    v_cvt_pk_bf16_f32 v57, v114, v115
    v_mfma_f32_16x16x32_bf16 v[100:103], a[152:155], a[200:203], v[100:103]
    v_exp_f32 v116, v116
    v_mfma_f32_16x16x32_bf16 v[100:103], a[156:159], a[204:207], v[100:103]
    buffer_load_dwordx4 v1, s[8:11], s82 offen offset:2048  lds
    v_mfma_f32_16x16x32_bf16 v[108:111], a[144:147], a[208:211], v[68:71]
    v_exp_f32 v117, v117
    v_mfma_f32_16x16x32_bf16 v[108:111], a[148:151], a[212:215], v[108:111]
    ds_read_b128 a[176:179], v20 offset:4096
    v_cvt_pk_bf16_f32 v58, v116, v117
    v_mfma_f32_16x16x32_bf16 v[108:111], a[152:155], a[216:219], v[108:111]
    v_exp_f32 v118, v118
    v_mfma_f32_16x16x32_bf16 v[108:111], a[156:159], a[220:223], v[108:111]
    buffer_load_dwordx4 v1, s[8:11], s82 offen offset:3072  lds
    v_mfma_f32_16x16x32_bf16 v[32:35], v[28:31], v[48:51], v[32:35]
    s_add_u32 m0, s15, 4096
    v_exp_f32 v119, v119
    v_mfma_f32_16x16x32_bf16 v[36:39], v[28:31], v[52:55], v[36:39]
    s_waitcnt lgkmcnt(4)
    ds_read_b128 a[180:183], v20 offset:5120
    v_cvt_pk_bf16_f32 v59, v118, v119
    v_mfma_f32_16x16x32_bf16 v[128:131], a[160:163], v[48:51], v[128:131]
    v_exp_f32 v120, v120
    v_mfma_f32_16x16x32_bf16 v[160:163], a[160:163], v[52:55], v[160:163]
    s_waitcnt lgkmcnt(4)
    v_mfma_f32_16x16x32_bf16 v[132:135], a[164:167], v[48:51], v[132:135]
    v_exp_f32 v121, v121
    v_mfma_f32_16x16x32_bf16 v[164:167], a[164:167], v[52:55], v[164:167]
    s_waitcnt lgkmcnt(3)
    ds_read_b128 a[184:187], v20 offset:6144
    v_cvt_pk_bf16_f32 v60, v120, v121
    v_mfma_f32_16x16x32_bf16 v[136:139], a[168:171], v[48:51], v[136:139]
    s_waitcnt lgkmcnt(3)
    v_exp_f32 v122, v122
    v_mfma_f32_16x16x32_bf16 v[168:171], a[168:171], v[52:55], v[168:171]
    buffer_load_dwordx4 v15, s[8:11], s82 offen offset:0  lds
    v_mfma_f32_16x16x32_bf16 v[140:143], a[172:175], v[48:51], v[140:143]
    v_exp_f32 v123, v123
    v_mfma_f32_16x16x32_bf16 v[172:175], a[172:175], v[52:55], v[172:175]
    s_waitcnt lgkmcnt(2)
    ds_read_b128 a[188:191], v20 offset:7168
    v_cvt_pk_bf16_f32 v61, v122, v123
    v_mfma_f32_16x16x32_bf16 v[144:147], a[176:179], v[48:51], v[144:147]
    s_waitcnt lgkmcnt(2)
    v_exp_f32 v124, v124
    v_mfma_f32_16x16x32_bf16 v[176:179], a[176:179], v[52:55], v[176:179]
    buffer_load_dwordx4 v15, s[8:11], s82 offen offset:1024  lds
    v_mfma_f32_16x16x32_bf16 v[148:151], a[180:183], v[48:51], v[148:151]
    v_exp_f32 v125, v125
    v_mfma_f32_16x16x32_bf16 v[180:183], a[180:183], v[52:55], v[180:183]
    s_waitcnt lgkmcnt(1)
    v_cvt_pk_bf16_f32 v62, v124, v125
    v_mfma_f32_16x16x32_bf16 v[152:155], a[184:187], v[48:51], v[152:155]
    s_waitcnt lgkmcnt(0)
    v_exp_f32 v126, v126
    v_mfma_f32_16x16x32_bf16 v[184:187], a[184:187], v[52:55], v[184:187]
    buffer_load_dwordx4 v15, s[8:11], s82 offen offset:2048  lds
    v_mfma_f32_16x16x32_bf16 v[156:159], a[188:191], v[48:51], v[156:159]
    v_exp_f32 v127, v127
    v_mfma_f32_16x16x32_bf16 v[188:191], a[188:191], v[52:55], v[188:191]
    v_cvt_pk_bf16_f32 v63, v126, v127
    v_mfma_f32_16x16x32_bf16 v[112:115], a[128:131], a[224:227], v[72:75]
    v_mfma_f32_16x16x32_bf16 v[112:115], a[132:135], a[228:231], v[112:115]
    v_mfma_f32_16x16x32_bf16 v[112:115], a[136:139], a[232:235], v[112:115]
    v_exp_f32 v96, v96
    v_mfma_f32_16x16x32_bf16 v[112:115], a[140:143], a[236:239], v[112:115]
    buffer_load_dwordx4 v15, s[8:11], s82 offen offset:3072  lds
    v_mfma_f32_16x16x32_bf16 v[120:123], a[128:131], a[240:243], v[76:79]
    s_xor_b32 s15, s15, 196608
    v_exp_f32 v97, v97
    v_mfma_f32_16x16x32_bf16 v[120:123], a[132:135], a[244:247], v[120:123]
    s_add_u32 m0, s16, 0
    ds_read_b128 a[128:131], v18 offset:0
    v_cvt_pk_bf16_f32 v48, v96, v97
    v_mfma_f32_16x16x32_bf16 v[120:123], a[136:139], a[248:251], v[120:123]
    v_exp_f32 v98, v98
    v_mfma_f32_16x16x32_bf16 v[120:123], a[140:143], a[252:255], v[120:123]
    buffer_load_dwordx4 v1, s[8:11], s19 offen offset:0  lds
    v_mfma_f32_16x16x32_bf16 v[116:119], a[144:147], a[224:227], v[72:75]
    v_exp_f32 v99, v99
    v_mfma_f32_16x16x32_bf16 v[116:119], a[148:151], a[228:231], v[116:119]
    ds_read_b128 a[132:135], v18 offset:1024
    v_cvt_pk_bf16_f32 v49, v98, v99
    v_mfma_f32_16x16x32_bf16 v[116:119], a[152:155], a[232:235], v[116:119]
    v_exp_f32 v100, v100
    v_mfma_f32_16x16x32_bf16 v[116:119], a[156:159], a[236:239], v[116:119]
    buffer_load_dwordx4 v1, s[8:11], s19 offen offset:1024  lds
    v_mfma_f32_16x16x32_bf16 v[124:127], a[144:147], a[240:243], v[76:79]
    v_exp_f32 v101, v101
    v_mfma_f32_16x16x32_bf16 v[124:127], a[148:151], a[244:247], v[124:127]
    ds_read_b128 a[136:139], v18 offset:2048
    v_cvt_pk_bf16_f32 v50, v100, v101
    v_mfma_f32_16x16x32_bf16 v[124:127], a[152:155], a[248:251], v[124:127]
    v_exp_f32 v102, v102
    v_mfma_f32_16x16x32_bf16 v[124:127], a[156:159], a[252:255], v[124:127]
    buffer_load_dwordx4 v1, s[8:11], s19 offen offset:2048  lds
    v_mfma_f32_16x16x32_bf16 v[40:43], v[28:31], v[56:59], v[40:43]
    v_exp_f32 v103, v103
    v_mfma_f32_16x16x32_bf16 v[44:47], v[28:31], v[60:63], v[44:47]
    ds_read_b128 a[140:143], v18 offset:3072
    v_cvt_pk_bf16_f32 v51, v102, v103
    v_mfma_f32_16x16x32_bf16 v[192:195], a[160:163], v[56:59], v[192:195]
    v_exp_f32 v104, v104
    v_mfma_f32_16x16x32_bf16 v[224:227], a[160:163], v[60:63], v[224:227]
    v_mfma_f32_16x16x32_bf16 v[196:199], a[164:167], v[56:59], v[196:199]
    v_exp_f32 v105, v105
    v_mfma_f32_16x16x32_bf16 v[228:231], a[164:167], v[60:63], v[228:231]
    ds_read_b128 a[144:147], v18 offset:4096
    v_cvt_pk_bf16_f32 v52, v104, v105
    v_mfma_f32_16x16x32_bf16 v[200:203], a[168:171], v[56:59], v[200:203]
    v_exp_f32 v106, v106
    v_mfma_f32_16x16x32_bf16 v[232:235], a[168:171], v[60:63], v[232:235]
    buffer_load_dwordx4 v1, s[8:11], s19 offen offset:3072  lds
    v_mfma_f32_16x16x32_bf16 v[204:207], a[172:175], v[56:59], v[204:207]
    s_add_u32 m0, s16, 4096
    v_exp_f32 v107, v107
    v_mfma_f32_16x16x32_bf16 v[236:239], a[172:175], v[60:63], v[236:239]
    ds_read_b128 a[148:151], v18 offset:5120
    v_cvt_pk_bf16_f32 v53, v106, v107
    v_mfma_f32_16x16x32_bf16 v[208:211], a[176:179], v[56:59], v[208:211]
    v_exp_f32 v108, v108
    v_mfma_f32_16x16x32_bf16 v[240:243], a[176:179], v[60:63], v[240:243]
    buffer_load_dwordx4 v15, s[8:11], s19 offen offset:0  lds
    v_mfma_f32_16x16x32_bf16 v[212:215], a[180:183], v[56:59], v[212:215]
    v_exp_f32 v109, v109
    v_mfma_f32_16x16x32_bf16 v[244:247], a[180:183], v[60:63], v[244:247]
    ds_read_b128 a[152:155], v18 offset:6144
    v_cvt_pk_bf16_f32 v54, v108, v109
    v_mfma_f32_16x16x32_bf16 v[216:219], a[184:187], v[56:59], v[216:219]
    v_exp_f32 v110, v110
    v_mfma_f32_16x16x32_bf16 v[248:251], a[184:187], v[60:63], v[248:251]
    buffer_load_dwordx4 v15, s[8:11], s19 offen offset:1024  lds
    v_mfma_f32_16x16x32_bf16 v[220:223], a[188:191], v[56:59], v[220:223]
    v_exp_f32 v111, v111
    v_mfma_f32_16x16x32_bf16 v[252:255], a[188:191], v[60:63], v[252:255]
    ds_read_b128 a[156:159], v18 offset:7168
    v_cvt_pk_bf16_f32 v55, v110, v111
    s_waitcnt lgkmcnt(7)
    v_mfma_f32_16x16x32_bf16 v[96:99], a[128:131], a[192:195], v[64:67]
    s_waitcnt lgkmcnt(6)
    ds_read_b128 a[160:163], v19 offset:16384
    v_mfma_f32_16x16x32_bf16 v[96:99], a[132:135], a[196:199], v[96:99]
    s_waitcnt lgkmcnt(6)
    ds_read_b128 a[164:167], v19 offset:17408
    v_mfma_f32_16x16x32_bf16 v[96:99], a[136:139], a[200:203], v[96:99]
    s_waitcnt lgkmcnt(6)
    v_exp_f32 v112, v112
    v_mfma_f32_16x16x32_bf16 v[96:99], a[140:143], a[204:207], v[96:99]
    buffer_load_dwordx4 v15, s[8:11], s19 offen offset:2048  lds
    v_mfma_f32_16x16x32_bf16 v[104:107], a[128:131], a[208:211], v[68:71]
    v_exp_f32 v113, v113
    v_mfma_f32_16x16x32_bf16 v[104:107], a[132:135], a[212:215], v[104:107]
    ds_read_b128 a[168:171], v19 offset:18432
    v_cvt_pk_bf16_f32 v56, v112, v113
    v_mfma_f32_16x16x32_bf16 v[104:107], a[136:139], a[216:219], v[104:107]
    s_waitcnt lgkmcnt(6)
    v_exp_f32 v114, v114
    v_mfma_f32_16x16x32_bf16 v[104:107], a[140:143], a[220:223], v[104:107]
    buffer_load_dwordx4 v15, s[8:11], s19 offen offset:3072  lds
    v_mfma_f32_16x16x32_bf16 v[100:103], a[144:147], a[192:195], v[64:67]
    s_waitcnt lgkmcnt(5)
    s_xor_b32 s16, s16, 98304
    v_exp_f32 v115, v115
    v_mfma_f32_16x16x32_bf16 v[100:103], a[148:151], a[196:199], v[100:103]
    s_waitcnt lgkmcnt(4)
    s_add_u32 s17, s17, 2093056
    ds_read_b128 a[172:175], v19 offset:19456
    v_cvt_pk_bf16_f32 v57, v114, v115
    v_mfma_f32_16x16x32_bf16 v[100:103], a[152:155], a[200:203], v[100:103]
    s_waitcnt lgkmcnt(4)
    v_exp_f32 v116, v116
    v_mfma_f32_16x16x32_bf16 v[100:103], a[156:159], a[204:207], v[100:103]
    buffer_store_dwordx4 a[8:11], v12, s[8:11], s17 offen sc0 sc1
    v_mfma_f32_16x16x32_bf16 v[108:111], a[144:147], a[208:211], v[68:71]
    s_add_u32 s27, s18, 131072
    v_exp_f32 v117, v117
    v_mfma_f32_16x16x32_bf16 v[108:111], a[148:151], a[212:215], v[108:111]
    ds_read_b128 a[176:179], v20 offset:20480
    v_cvt_pk_bf16_f32 v58, v116, v117
    v_mfma_f32_16x16x32_bf16 v[108:111], a[152:155], a[216:219], v[108:111]
    v_exp_f32 v118, v118
    v_mfma_f32_16x16x32_bf16 v[108:111], a[156:159], a[220:223], v[108:111]
    buffer_store_dwordx4 v[24:27], v17, s[8:11], s27 offen offset:768 sc0 sc1
    v_mfma_f32_16x16x32_bf16 v[32:35], v[28:31], v[48:51], v[32:35]
    s_add_u32 s27, s18, 8388608
    v_exp_f32 v119, v119
    v_mfma_f32_16x16x32_bf16 v[36:39], v[28:31], v[52:55], v[36:39]
    s_waitcnt lgkmcnt(4)
    ds_read_b128 a[180:183], v20 offset:21504
    v_cvt_pk_bf16_f32 v59, v118, v119
    v_mfma_f32_16x16x32_bf16 v[128:131], a[160:163], v[48:51], v[128:131]
    s_waitcnt lgkmcnt(4)
    v_exp_f32 v120, v120
    v_mfma_f32_16x16x32_bf16 v[160:163], a[160:163], v[52:55], v[160:163]
    buffer_store_dwordx4 v[24:27], v17, s[8:11], s27 offen offset:0 sc0 sc1
    v_mfma_f32_16x16x32_bf16 v[132:135], a[164:167], v[48:51], v[132:135]
    s_add_u32 s27, s18, 8519680
    v_exp_f32 v121, v121
    v_mfma_f32_16x16x32_bf16 v[164:167], a[164:167], v[52:55], v[164:167]
    s_waitcnt lgkmcnt(3)
    ds_read_b128 a[184:187], v20 offset:22528
    v_cvt_pk_bf16_f32 v60, v120, v121
    v_mfma_f32_16x16x32_bf16 v[136:139], a[168:171], v[48:51], v[136:139]
    s_waitcnt lgkmcnt(3)
    v_exp_f32 v122, v122
    v_mfma_f32_16x16x32_bf16 v[168:171], a[168:171], v[52:55], v[168:171]
    buffer_store_dwordx4 v[24:27], v17, s[8:11], s27 offen offset:0 sc0 sc1
    v_mfma_f32_16x16x32_bf16 v[140:143], a[172:175], v[48:51], v[140:143]
    v_exp_f32 v123, v123
    v_mfma_f32_16x16x32_bf16 v[172:175], a[172:175], v[52:55], v[172:175]
    s_waitcnt lgkmcnt(2)
    ds_read_b128 a[188:191], v20 offset:23552
    v_cvt_pk_bf16_f32 v61, v122, v123
    v_mfma_f32_16x16x32_bf16 v[144:147], a[176:179], v[48:51], v[144:147]
    v_exp_f32 v124, v124
    v_mfma_f32_16x16x32_bf16 v[176:179], a[176:179], v[52:55], v[176:179]
    s_waitcnt lgkmcnt(2)
    v_mfma_f32_16x16x32_bf16 v[148:151], a[180:183], v[48:51], v[148:151]
    v_exp_f32 v125, v125
    v_mfma_f32_16x16x32_bf16 v[180:183], a[180:183], v[52:55], v[180:183]
    s_waitcnt lgkmcnt(1)
    v_cvt_pk_bf16_f32 v62, v124, v125
    v_xor_b32 v19, 98304, v19
    v_mfma_f32_16x16x32_bf16 v[152:155], a[184:187], v[48:51], v[152:155]
    v_exp_f32 v126, v126
    v_mfma_f32_16x16x32_bf16 v[184:187], a[184:187], v[52:55], v[184:187]
    s_waitcnt lgkmcnt(0)
    v_xor_b32 v20, 98304, v20
    v_mfma_f32_16x16x32_bf16 v[156:159], a[188:191], v[48:51], v[156:159]
    v_exp_f32 v127, v127
    v_mfma_f32_16x16x32_bf16 v[188:191], a[188:191], v[52:55], v[188:191]
    v_cvt_pk_bf16_f32 v63, v126, v127
    v_mfma_f32_16x16x32_bf16 v[112:115], a[128:131], a[224:227], v[72:75]
    s_add_u32 s17, s17, 4096
    v_exp_f32 v96, v96
    v_mfma_f32_16x16x32_bf16 v[112:115], a[132:135], a[228:231], v[112:115]
    buffer_store_dwordx4 a[12:15], v12, s[8:11], s17 offen sc0 sc1
    v_mfma_f32_16x16x32_bf16 v[112:115], a[136:139], a[232:235], v[112:115]
    s_add_u32 s27, s18, 8388608
    v_exp_f32 v97, v97
    v_mfma_f32_16x16x32_bf16 v[112:115], a[140:143], a[236:239], v[112:115]
    v_cvt_pk_bf16_f32 v48, v96, v97
    v_lshl_add_u32 v8, v8, 10, v9
    v_mfma_f32_16x16x32_bf16 v[120:123], a[128:131], a[240:243], v[76:79]
    v_exp_f32 v98, v98
    v_mfma_f32_16x16x32_bf16 v[120:123], a[132:135], a[244:247], v[120:123]
    buffer_store_dwordx4 v[24:27], v17, s[8:11], s27 offen offset:256 sc0 sc1
    v_mfma_f32_16x16x32_bf16 v[120:123], a[136:139], a[248:251], v[120:123]
    s_add_u32 s27, s18, 8519680
    v_exp_f32 v99, v99
    v_mfma_f32_16x16x32_bf16 v[120:123], a[140:143], a[252:255], v[120:123]
    buffer_store_dwordx4 v[24:27], v17, s[8:11], s27 offen offset:256 sc0 sc1
    v_mfma_f32_16x16x32_bf16 v[116:119], a[144:147], a[224:227], v[72:75]
    s_add_u32 s27, s18, 8388608
    v_exp_f32 v100, v100
    v_mfma_f32_16x16x32_bf16 v[116:119], a[148:151], a[228:231], v[116:119]
    ds_read_b128 a[128:131], v18 offset:16384
    v_cvt_pk_bf16_f32 v49, v98, v99
    v_mfma_f32_16x16x32_bf16 v[116:119], a[152:155], a[232:235], v[116:119]
    s_add_u32 s19, s82, 32768
    v_exp_f32 v101, v101
    v_mfma_f32_16x16x32_bf16 v[116:119], a[156:159], a[236:239], v[116:119]
    s_sub_u32 s82, s12, s13
    ds_read_b128 a[132:135], v18 offset:17408
    v_cvt_pk_bf16_f32 v50, v100, v101
    v_mfma_f32_16x16x32_bf16 v[124:127], a[144:147], a[240:243], v[76:79]
    s_sub_u32 s82, s82, 1
    v_exp_f32 v102, v102
    v_mfma_f32_16x16x32_bf16 v[124:127], a[148:151], a[244:247], v[124:127]
    s_cmp_gt_u32 s12, s13
    s_cselect_b32 s82, s82, s12
    s_lshl_b32 s82, s82, 16
    ds_read_b128 a[136:139], v18 offset:18432
    v_mfma_f32_16x16x32_bf16 v[124:127], a[152:155], a[248:251], v[124:127]
    s_add_u32 s82, s82, s81
    v_exp_f32 v103, v103
    v_mfma_f32_16x16x32_bf16 v[124:127], a[156:159], a[252:255], v[124:127]
    s_cmp_ge_u32 s12, 17
    s_cselect_b32 s82, 2147471360, s82
    ds_read_b128 a[140:143], v18 offset:19456
    v_cvt_pk_bf16_f32 v51, v102, v103
    v_mfma_f32_16x16x32_bf16 v[40:43], v[28:31], v[56:59], v[40:43]
    s_add_u32 s12, s12, 1
    v_exp_f32 v104, v104
    v_mfma_f32_16x16x32_bf16 v[44:47], v[28:31], v[60:63], v[44:47]
    ds_read_b128 a[144:147], v18 offset:20480
    v_bfe_u32 v4, v2, 1, 2
    v_mfma_f32_16x16x32_bf16 v[192:195], a[160:163], v[56:59], v[192:195]
    v_exp_f32 v105, v105
    v_mfma_f32_16x16x32_bf16 v[224:227], a[160:163], v[60:63], v[224:227]
    ds_read_b128 a[148:151], v18 offset:21504
    v_cvt_pk_bf16_f32 v52, v104, v105
    v_mfma_f32_16x16x32_bf16 v[196:199], a[164:167], v[56:59], v[196:199]
    v_exp_f32 v106, v106
    v_mfma_f32_16x16x32_bf16 v[228:231], a[164:167], v[60:63], v[228:231]
    ds_read_b128 a[152:155], v18 offset:22528
    v_lshlrev_b32 v4, 11, v4
    v_mfma_f32_16x16x32_bf16 v[200:203], a[168:171], v[56:59], v[200:203]
    v_exp_f32 v107, v107
    v_mfma_f32_16x16x32_bf16 v[232:235], a[168:171], v[60:63], v[232:235]
    ds_read_b128 a[156:159], v18 offset:23552
    v_cvt_pk_bf16_f32 v53, v106, v107
    v_mfma_f32_16x16x32_bf16 v[204:207], a[172:175], v[56:59], v[204:207]
    v_exp_f32 v108, v108
    v_mfma_f32_16x16x32_bf16 v[236:239], a[172:175], v[60:63], v[236:239]
    buffer_store_dwordx4 v[24:27], v17, s[8:11], s27 offen offset:512 sc0 sc1
    v_mfma_f32_16x16x32_bf16 v[208:211], a[176:179], v[56:59], v[208:211]
    s_add_u32 s27, s18, 8519680
    v_exp_f32 v109, v109
    v_mfma_f32_16x16x32_bf16 v[240:243], a[176:179], v[60:63], v[240:243]
    v_cvt_pk_bf16_f32 v54, v108, v109
    v_xor_b32 v18, 196608, v18
    v_mfma_f32_16x16x32_bf16 v[212:215], a[180:183], v[56:59], v[212:215]
    v_exp_f32 v110, v110
    v_mfma_f32_16x16x32_bf16 v[244:247], a[180:183], v[60:63], v[244:247]
    buffer_store_dwordx4 v[24:27], v17, s[8:11], s27 offen offset:512 sc0 sc1
    v_mfma_f32_16x16x32_bf16 v[216:219], a[184:187], v[56:59], v[216:219]
    v_exp_f32 v111, v111
    v_mfma_f32_16x16x32_bf16 v[248:251], a[184:187], v[60:63], v[248:251]
    v_cvt_pk_bf16_f32 v55, v110, v111
    v_lshl_add_u32 v4, v10, 6, v4
    v_mfma_f32_16x16x32_bf16 v[220:223], a[188:191], v[56:59], v[220:223]
    v_add_u32 v9, 7168, v8
    v_add_u32 v10, 14336, v8
    v_mfma_f32_16x16x32_bf16 v[252:255], a[188:191], v[60:63], v[252:255]
    v_add_u32 v11, 21504, v8
    s_waitcnt vmcnt(9) lgkmcnt(0)
    s_barrier
    v_mfma_f32_16x16x32_bf16 v[96:99], a[128:131], a[192:195], v[64:67]
    s_add_u32 m0, s15, 0
    ds_read_b128 a[160:163], v19 offset:0
    v_mfma_f32_16x16x32_bf16 v[96:99], a[132:135], a[196:199], v[96:99]
    ds_read_b128 a[164:167], v19 offset:1024
    v_mfma_f32_16x16x32_bf16 v[96:99], a[136:139], a[200:203], v[96:99]
    v_exp_f32 v112, v112
    v_mfma_f32_16x16x32_bf16 v[96:99], a[140:143], a[204:207], v[96:99]
    buffer_load_dwordx4 v1, s[8:11], s82 offen offset:0  lds
    v_mfma_f32_16x16x32_bf16 v[104:107], a[128:131], a[208:211], v[68:71]
    v_exp_f32 v113, v113
    v_mfma_f32_16x16x32_bf16 v[104:107], a[132:135], a[212:215], v[104:107]
    ds_read_b128 a[168:171], v19 offset:2048
    v_cvt_pk_bf16_f32 v56, v112, v113
    v_mfma_f32_16x16x32_bf16 v[104:107], a[136:139], a[216:219], v[104:107]
    v_exp_f32 v114, v114
    v_mfma_f32_16x16x32_bf16 v[104:107], a[140:143], a[220:223], v[104:107]
    buffer_load_dwordx4 v1, s[8:11], s82 offen offset:1024  lds
    v_mfma_f32_16x16x32_bf16 v[100:103], a[144:147], a[192:195], v[64:67]
    v_exp_f32 v115, v115
    v_mfma_f32_16x16x32_bf16 v[100:103], a[148:151], a[196:199], v[100:103]
    ds_read_b128 a[172:175], v19 offset:3072
    v_cvt_pk_bf16_f32 v57, v114, v115
    v_mfma_f32_16x16x32_bf16 v[100:103], a[152:155], a[200:203], v[100:103]
    v_exp_f32 v116, v116
    v_mfma_f32_16x16x32_bf16 v[100:103], a[156:159], a[204:207], v[100:103]
    buffer_load_dwordx4 v1, s[8:11], s82 offen offset:2048  lds
    v_mfma_f32_16x16x32_bf16 v[108:111], a[144:147], a[208:211], v[68:71]
    v_exp_f32 v117, v117
    v_mfma_f32_16x16x32_bf16 v[108:111], a[148:151], a[212:215], v[108:111]
    ds_read_b128 a[176:179], v20 offset:4096
    v_cvt_pk_bf16_f32 v58, v116, v117
    v_mfma_f32_16x16x32_bf16 v[108:111], a[152:155], a[216:219], v[108:111]
    v_exp_f32 v118, v118
    v_mfma_f32_16x16x32_bf16 v[108:111], a[156:159], a[220:223], v[108:111]
    buffer_load_dwordx4 v1, s[8:11], s82 offen offset:3072  lds
    v_mfma_f32_16x16x32_bf16 v[32:35], v[28:31], v[48:51], v[32:35]
    s_add_u32 m0, s15, 4096
    v_exp_f32 v119, v119
    v_mfma_f32_16x16x32_bf16 v[36:39], v[28:31], v[52:55], v[36:39]
    s_waitcnt lgkmcnt(4)
    ds_read_b128 a[180:183], v20 offset:5120
    v_cvt_pk_bf16_f32 v59, v118, v119
    v_mfma_f32_16x16x32_bf16 v[128:131], a[160:163], v[48:51], v[128:131]
    v_exp_f32 v120, v120
    v_mfma_f32_16x16x32_bf16 v[160:163], a[160:163], v[52:55], v[160:163]
    s_waitcnt lgkmcnt(4)
    v_mfma_f32_16x16x32_bf16 v[132:135], a[164:167], v[48:51], v[132:135]
    v_exp_f32 v121, v121
    v_mfma_f32_16x16x32_bf16 v[164:167], a[164:167], v[52:55], v[164:167]
    s_waitcnt lgkmcnt(3)
    ds_read_b128 a[184:187], v20 offset:6144
    v_cvt_pk_bf16_f32 v60, v120, v121
    v_mfma_f32_16x16x32_bf16 v[136:139], a[168:171], v[48:51], v[136:139]
    s_waitcnt lgkmcnt(3)
    v_exp_f32 v122, v122
    v_mfma_f32_16x16x32_bf16 v[168:171], a[168:171], v[52:55], v[168:171]
    buffer_load_dwordx4 v15, s[8:11], s82 offen offset:0  lds
    v_mfma_f32_16x16x32_bf16 v[140:143], a[172:175], v[48:51], v[140:143]
    v_exp_f32 v123, v123
    v_mfma_f32_16x16x32_bf16 v[172:175], a[172:175], v[52:55], v[172:175]
    s_waitcnt lgkmcnt(2)
    ds_read_b128 a[188:191], v20 offset:7168
    v_cvt_pk_bf16_f32 v61, v122, v123
    v_mfma_f32_16x16x32_bf16 v[144:147], a[176:179], v[48:51], v[144:147]
    s_waitcnt lgkmcnt(2)
    v_exp_f32 v124, v124
    v_mfma_f32_16x16x32_bf16 v[176:179], a[176:179], v[52:55], v[176:179]
    buffer_load_dwordx4 v15, s[8:11], s82 offen offset:1024  lds
    v_mfma_f32_16x16x32_bf16 v[148:151], a[180:183], v[48:51], v[148:151]
    v_exp_f32 v125, v125
    v_mfma_f32_16x16x32_bf16 v[180:183], a[180:183], v[52:55], v[180:183]
    s_waitcnt lgkmcnt(1)
    v_cvt_pk_bf16_f32 v62, v124, v125
    v_mfma_f32_16x16x32_bf16 v[152:155], a[184:187], v[48:51], v[152:155]
    s_waitcnt lgkmcnt(0)
    v_exp_f32 v126, v126
    v_mfma_f32_16x16x32_bf16 v[184:187], a[184:187], v[52:55], v[184:187]
    buffer_load_dwordx4 v15, s[8:11], s82 offen offset:2048  lds
    v_mfma_f32_16x16x32_bf16 v[156:159], a[188:191], v[48:51], v[156:159]
    v_exp_f32 v127, v127
    v_mfma_f32_16x16x32_bf16 v[188:191], a[188:191], v[52:55], v[188:191]
    v_cvt_pk_bf16_f32 v63, v126, v127
    v_mfma_f32_16x16x32_bf16 v[112:115], a[128:131], a[224:227], v[72:75]
    v_mfma_f32_16x16x32_bf16 v[112:115], a[132:135], a[228:231], v[112:115]
    v_mfma_f32_16x16x32_bf16 v[112:115], a[136:139], a[232:235], v[112:115]
    v_exp_f32 v96, v96
    v_mfma_f32_16x16x32_bf16 v[112:115], a[140:143], a[236:239], v[112:115]
    buffer_load_dwordx4 v15, s[8:11], s82 offen offset:3072  lds
    v_mfma_f32_16x16x32_bf16 v[120:123], a[128:131], a[240:243], v[76:79]
    s_xor_b32 s15, s15, 196608
    v_exp_f32 v97, v97
    v_mfma_f32_16x16x32_bf16 v[120:123], a[132:135], a[244:247], v[120:123]
    s_add_u32 m0, s16, 0
    ds_read_b128 a[128:131], v18 offset:0
    v_cvt_pk_bf16_f32 v48, v96, v97
    v_mfma_f32_16x16x32_bf16 v[120:123], a[136:139], a[248:251], v[120:123]
    v_exp_f32 v98, v98
    v_mfma_f32_16x16x32_bf16 v[120:123], a[140:143], a[252:255], v[120:123]
    buffer_load_dwordx4 v1, s[8:11], s19 offen offset:0  lds
    v_mfma_f32_16x16x32_bf16 v[116:119], a[144:147], a[224:227], v[72:75]
    v_exp_f32 v99, v99
    v_mfma_f32_16x16x32_bf16 v[116:119], a[148:151], a[228:231], v[116:119]
    ds_read_b128 a[132:135], v18 offset:1024
    v_cvt_pk_bf16_f32 v49, v98, v99
    v_mfma_f32_16x16x32_bf16 v[116:119], a[152:155], a[232:235], v[116:119]
    v_exp_f32 v100, v100
    v_mfma_f32_16x16x32_bf16 v[116:119], a[156:159], a[236:239], v[116:119]
    buffer_load_dwordx4 v1, s[8:11], s19 offen offset:1024  lds
    v_mfma_f32_16x16x32_bf16 v[124:127], a[144:147], a[240:243], v[76:79]
    v_exp_f32 v101, v101
    v_mfma_f32_16x16x32_bf16 v[124:127], a[148:151], a[244:247], v[124:127]
    ds_read_b128 a[136:139], v18 offset:2048
    v_cvt_pk_bf16_f32 v50, v100, v101
    v_mfma_f32_16x16x32_bf16 v[124:127], a[152:155], a[248:251], v[124:127]
    v_exp_f32 v102, v102
    v_mfma_f32_16x16x32_bf16 v[124:127], a[156:159], a[252:255], v[124:127]
    buffer_load_dwordx4 v1, s[8:11], s19 offen offset:2048  lds
    v_mfma_f32_16x16x32_bf16 v[40:43], v[28:31], v[56:59], v[40:43]
    v_exp_f32 v103, v103
    v_mfma_f32_16x16x32_bf16 v[44:47], v[28:31], v[60:63], v[44:47]
    ds_read_b128 a[140:143], v18 offset:3072
    v_cvt_pk_bf16_f32 v51, v102, v103
    v_mfma_f32_16x16x32_bf16 v[192:195], a[160:163], v[56:59], v[192:195]
    v_exp_f32 v104, v104
    v_mfma_f32_16x16x32_bf16 v[224:227], a[160:163], v[60:63], v[224:227]
    v_mfma_f32_16x16x32_bf16 v[196:199], a[164:167], v[56:59], v[196:199]
    v_exp_f32 v105, v105
    v_mfma_f32_16x16x32_bf16 v[228:231], a[164:167], v[60:63], v[228:231]
    ds_read_b128 a[144:147], v18 offset:4096
    v_cvt_pk_bf16_f32 v52, v104, v105
    v_mfma_f32_16x16x32_bf16 v[200:203], a[168:171], v[56:59], v[200:203]
    v_exp_f32 v106, v106
    v_mfma_f32_16x16x32_bf16 v[232:235], a[168:171], v[60:63], v[232:235]
    buffer_load_dwordx4 v1, s[8:11], s19 offen offset:3072  lds
    v_mfma_f32_16x16x32_bf16 v[204:207], a[172:175], v[56:59], v[204:207]
    s_add_u32 m0, s16, 4096
    v_exp_f32 v107, v107
    v_mfma_f32_16x16x32_bf16 v[236:239], a[172:175], v[60:63], v[236:239]
    ds_read_b128 a[148:151], v18 offset:5120
    v_cvt_pk_bf16_f32 v53, v106, v107
    v_mfma_f32_16x16x32_bf16 v[208:211], a[176:179], v[56:59], v[208:211]
    v_exp_f32 v108, v108
    v_mfma_f32_16x16x32_bf16 v[240:243], a[176:179], v[60:63], v[240:243]
    buffer_load_dwordx4 v15, s[8:11], s19 offen offset:0  lds
    v_mfma_f32_16x16x32_bf16 v[212:215], a[180:183], v[56:59], v[212:215]
    v_exp_f32 v109, v109
    v_mfma_f32_16x16x32_bf16 v[244:247], a[180:183], v[60:63], v[244:247]
    ds_read_b128 a[152:155], v18 offset:6144
    v_cvt_pk_bf16_f32 v54, v108, v109
    v_mfma_f32_16x16x32_bf16 v[216:219], a[184:187], v[56:59], v[216:219]
    v_exp_f32 v110, v110
    v_mfma_f32_16x16x32_bf16 v[248:251], a[184:187], v[60:63], v[248:251]
    buffer_load_dwordx4 v15, s[8:11], s19 offen offset:1024  lds
    v_mfma_f32_16x16x32_bf16 v[220:223], a[188:191], v[56:59], v[220:223]
    v_exp_f32 v111, v111
    v_mfma_f32_16x16x32_bf16 v[252:255], a[188:191], v[60:63], v[252:255]
    ds_read_b128 a[156:159], v18 offset:7168
    v_cvt_pk_bf16_f32 v55, v110, v111
    s_waitcnt lgkmcnt(7)
    v_mfma_f32_16x16x32_bf16 v[96:99], a[128:131], a[192:195], v[64:67]
    s_waitcnt lgkmcnt(6)
    s_mul_i32 s17, s4, 229376
    s_mul_i32 s100, s3, 7168
    ds_read_b128 a[160:163], v19 offset:16384
    v_mfma_f32_16x16x32_bf16 v[96:99], a[132:135], a[196:199], v[96:99]
    s_waitcnt lgkmcnt(6)
    s_add_u32 s17, s17, s100
    s_lshl_b32 s100, s101, 7
    ds_read_b128 a[164:167], v19 offset:17408
    v_mfma_f32_16x16x32_bf16 v[96:99], a[136:139], a[200:203], v[96:99]
    s_waitcnt lgkmcnt(6)
    s_add_u32 s17, s17, s100
    v_exp_f32 v112, v112
    v_mfma_f32_16x16x32_bf16 v[96:99], a[140:143], a[204:207], v[96:99]
    buffer_load_dwordx4 v15, s[8:11], s19 offen offset:2048  lds
    v_mfma_f32_16x16x32_bf16 v[104:107], a[128:131], a[208:211], v[68:71]
    s_add_u32 s17, s17, 8388608
    v_exp_f32 v113, v113
    v_mfma_f32_16x16x32_bf16 v[104:107], a[132:135], a[212:215], v[104:107]
    s_cmp_lt_u32 s101, s26
    s_cselect_b32 s17, s17, 2147479552
    ds_read_b128 a[168:171], v19 offset:18432
    v_cvt_pk_bf16_f32 v56, v112, v113
    v_mfma_f32_16x16x32_bf16 v[104:107], a[136:139], a[216:219], v[104:107]
    s_waitcnt lgkmcnt(6)
    v_exp_f32 v114, v114
    v_mfma_f32_16x16x32_bf16 v[104:107], a[140:143], a[220:223], v[104:107]
    buffer_load_dwordx4 v15, s[8:11], s19 offen offset:3072  lds
    v_mfma_f32_16x16x32_bf16 v[100:103], a[144:147], a[192:195], v[64:67]
    s_waitcnt lgkmcnt(5)
    s_xor_b32 s16, s16, 98304
    v_exp_f32 v115, v115
    v_mfma_f32_16x16x32_bf16 v[100:103], a[148:151], a[196:199], v[100:103]
    s_waitcnt lgkmcnt(4)
    ds_read_b128 a[172:175], v19 offset:19456
    v_cvt_pk_bf16_f32 v57, v114, v115
    v_mfma_f32_16x16x32_bf16 v[100:103], a[152:155], a[200:203], v[100:103]
    s_waitcnt lgkmcnt(4)
    v_exp_f32 v116, v116
    v_mfma_f32_16x16x32_bf16 v[100:103], a[156:159], a[204:207], v[100:103]
    buffer_store_dwordx4 a[16:19], v13, s[8:11], s17 offen sc0 sc1
    v_mfma_f32_16x16x32_bf16 v[108:111], a[144:147], a[208:211], v[68:71]
    s_add_u32 s27, s18, 8388608
    v_exp_f32 v117, v117
    v_mfma_f32_16x16x32_bf16 v[108:111], a[148:151], a[212:215], v[108:111]
    ds_read_b128 a[176:179], v20 offset:20480
    v_cvt_pk_bf16_f32 v58, v116, v117
    v_mfma_f32_16x16x32_bf16 v[108:111], a[152:155], a[216:219], v[108:111]
    v_exp_f32 v118, v118
    v_mfma_f32_16x16x32_bf16 v[108:111], a[156:159], a[220:223], v[108:111]
    buffer_store_dwordx4 v[24:27], v17, s[8:11], s27 offen offset:768 sc0 sc1
    v_mfma_f32_16x16x32_bf16 v[32:35], v[28:31], v[48:51], v[32:35]
    s_add_u32 s27, s18, 8519680
    v_exp_f32 v119, v119
    v_mfma_f32_16x16x32_bf16 v[36:39], v[28:31], v[52:55], v[36:39]
    s_waitcnt lgkmcnt(4)
    ds_read_b128 a[180:183], v20 offset:21504
    v_cvt_pk_bf16_f32 v59, v118, v119
    v_mfma_f32_16x16x32_bf16 v[128:131], a[160:163], v[48:51], v[128:131]
    s_waitcnt lgkmcnt(4)
    v_exp_f32 v120, v120
    v_mfma_f32_16x16x32_bf16 v[160:163], a[160:163], v[52:55], v[160:163]
    buffer_store_dwordx4 v[24:27], v17, s[8:11], s27 offen offset:768 sc0 sc1
    v_mfma_f32_16x16x32_bf16 v[132:135], a[164:167], v[48:51], v[132:135]
    v_exp_f32 v121, v121
    v_mfma_f32_16x16x32_bf16 v[164:167], a[164:167], v[52:55], v[164:167]
    s_waitcnt lgkmcnt(3)
    ds_read_b128 a[184:187], v20 offset:22528
    v_cvt_pk_bf16_f32 v60, v120, v121
    v_mfma_f32_16x16x32_bf16 v[136:139], a[168:171], v[48:51], v[136:139]
    s_waitcnt lgkmcnt(3)
    v_exp_f32 v122, v122
    v_mfma_f32_16x16x32_bf16 v[168:171], a[168:171], v[52:55], v[168:171]
    buffer_load_dword v3, v4, s[8:11], s23 offen sc0 sc1
    v_mfma_f32_16x16x32_bf16 v[140:143], a[172:175], v[48:51], v[140:143]
    v_exp_f32 v123, v123
    v_mfma_f32_16x16x32_bf16 v[172:175], a[172:175], v[52:55], v[172:175]
    s_waitcnt lgkmcnt(2)
    ds_read_b128 a[188:191], v20 offset:23552
    v_cvt_pk_bf16_f32 v61, v122, v123
    v_mfma_f32_16x16x32_bf16 v[144:147], a[176:179], v[48:51], v[144:147]
    v_exp_f32 v124, v124
    v_mfma_f32_16x16x32_bf16 v[176:179], a[176:179], v[52:55], v[176:179]
    s_waitcnt lgkmcnt(2)
    v_mfma_f32_16x16x32_bf16 v[148:151], a[180:183], v[48:51], v[148:151]
    v_exp_f32 v125, v125
    v_mfma_f32_16x16x32_bf16 v[180:183], a[180:183], v[52:55], v[180:183]
    s_waitcnt lgkmcnt(1)
    v_cvt_pk_bf16_f32 v62, v124, v125
    v_xor_b32 v19, 98304, v19
    v_mfma_f32_16x16x32_bf16 v[152:155], a[184:187], v[48:51], v[152:155]
    v_exp_f32 v126, v126
    v_mfma_f32_16x16x32_bf16 v[184:187], a[184:187], v[52:55], v[184:187]
    s_waitcnt lgkmcnt(0)
    v_xor_b32 v20, 98304, v20
    v_mfma_f32_16x16x32_bf16 v[156:159], a[188:191], v[48:51], v[156:159]
    v_exp_f32 v127, v127
    v_mfma_f32_16x16x32_bf16 v[188:191], a[188:191], v[52:55], v[188:191]
    v_cvt_pk_bf16_f32 v63, v126, v127
    v_mfma_f32_16x16x32_bf16 v[112:115], a[128:131], a[224:227], v[72:75]
    v_exp_f32 v96, v96
    v_mfma_f32_16x16x32_bf16 v[112:115], a[132:135], a[228:231], v[112:115]
    buffer_store_dwordx4 a[20:23], v13, s[8:11], s17 offen offset:3584 sc0 sc1
    v_mfma_f32_16x16x32_bf16 v[112:115], a[136:139], a[232:235], v[112:115]
    v_exp_f32 v97, v97
    v_mfma_f32_16x16x32_bf16 v[112:115], a[140:143], a[236:239], v[112:115]
    v_cvt_pk_bf16_f32 v48, v96, v97
    v_lshlrev_b32 v12, 3, v0
    v_mfma_f32_16x16x32_bf16 v[120:123], a[128:131], a[240:243], v[76:79]
    s_lshl_b32 s101, s2, 11
    v_exp_f32 v98, v98
    v_mfma_f32_16x16x32_bf16 v[120:123], a[132:135], a[244:247], v[120:123]
    v_add_f32 v80, 0, v21
    v_min_f32 v80, v80, v64
    v_mfma_f32_16x16x32_bf16 v[120:123], a[136:139], a[248:251], v[120:123]
    s_add_u32 s101, s101, 524288
    v_exp_f32 v99, v99
    v_mfma_f32_16x16x32_bf16 v[120:123], a[140:143], a[252:255], v[120:123]
    buffer_store_dwordx2 v[24:25], v12, s[8:11], s101 offen sc0 sc1
    v_mfma_f32_16x16x32_bf16 v[116:119], a[144:147], a[224:227], v[72:75]
    s_lshl_b32 s101, s2, 6
    v_exp_f32 v100, v100
    v_mfma_f32_16x16x32_bf16 v[116:119], a[148:151], a[228:231], v[116:119]
    s_add_u32 s101, s101, 65536
    ds_read_b128 a[128:131], v18 offset:16384
    v_cvt_pk_bf16_f32 v49, v98, v99
    v_mfma_f32_16x16x32_bf16 v[116:119], a[152:155], a[232:235], v[116:119]
    s_add_u32 s19, s82, 32768
    v_exp_f32 v101, v101
    v_mfma_f32_16x16x32_bf16 v[116:119], a[156:159], a[236:239], v[116:119]
    s_sub_u32 s82, s12, s13
    ds_read_b128 a[132:135], v18 offset:17408
    v_cvt_pk_bf16_f32 v50, v100, v101
    v_mfma_f32_16x16x32_bf16 v[124:127], a[144:147], a[240:243], v[76:79]
    s_sub_u32 s82, s82, 1
    v_exp_f32 v102, v102
    v_mfma_f32_16x16x32_bf16 v[124:127], a[148:151], a[244:247], v[124:127]
    s_cmp_gt_u32 s12, s13
    s_cselect_b32 s82, s82, s12
    s_lshl_b32 s82, s82, 16
    ds_read_b128 a[136:139], v18 offset:18432
    v_mfma_f32_16x16x32_bf16 v[124:127], a[152:155], a[248:251], v[124:127]
    s_add_u32 s82, s82, s81
    v_exp_f32 v103, v103
    v_mfma_f32_16x16x32_bf16 v[124:127], a[156:159], a[252:255], v[124:127]
    s_cmp_ge_u32 s12, 17
    s_cselect_b32 s82, 2147471360, s82
    ds_read_b128 a[140:143], v18 offset:19456
    v_cvt_pk_bf16_f32 v51, v102, v103
    v_mfma_f32_16x16x32_bf16 v[40:43], v[28:31], v[56:59], v[40:43]
    s_add_u32 s12, s12, 1
    v_exp_f32 v104, v104
    v_mfma_f32_16x16x32_bf16 v[44:47], v[28:31], v[60:63], v[44:47]
    ds_read_b128 a[144:147], v18 offset:20480
    v_mov_b32 v13, 0
    v_mfma_f32_16x16x32_bf16 v[192:195], a[160:163], v[56:59], v[192:195]
    v_exp_f32 v105, v105
    v_mfma_f32_16x16x32_bf16 v[224:227], a[160:163], v[60:63], v[224:227]
    ds_read_b128 a[148:151], v18 offset:21504
    v_cvt_pk_bf16_f32 v52, v104, v105
    v_mfma_f32_16x16x32_bf16 v[196:199], a[164:167], v[56:59], v[196:199]
    v_exp_f32 v106, v106
    v_mfma_f32_16x16x32_bf16 v[228:231], a[164:167], v[60:63], v[228:231]
    ds_read_b128 a[152:155], v18 offset:22528
    v_add_f32 v81, 0xf1800000, v21
    v_mfma_f32_16x16x32_bf16 v[200:203], a[168:171], v[56:59], v[200:203]
    v_exp_f32 v107, v107
    v_mfma_f32_16x16x32_bf16 v[232:235], a[168:171], v[60:63], v[232:235]
    ds_read_b128 a[156:159], v18 offset:23552
    v_cvt_pk_bf16_f32 v53, v106, v107
    v_mfma_f32_16x16x32_bf16 v[204:207], a[172:175], v[56:59], v[204:207]
    v_exp_f32 v108, v108
    v_mfma_f32_16x16x32_bf16 v[236:239], a[172:175], v[60:63], v[236:239]
    buffer_store_dword v13, v7, s[8:11], s101 offen sc0 sc1
    v_mfma_f32_16x16x32_bf16 v[208:211], a[176:179], v[56:59], v[208:211]
    s_lshl_b32 s101, s66, 6
    v_exp_f32 v109, v109
    v_mfma_f32_16x16x32_bf16 v[240:243], a[176:179], v[60:63], v[240:243]
    s_add_u32 s101, s101, 81920
    v_cvt_pk_bf16_f32 v54, v108, v109
    v_xor_b32 v18, 196608, v18
    v_mfma_f32_16x16x32_bf16 v[212:215], a[180:183], v[56:59], v[212:215]
    v_exp_f32 v110, v110
    v_mfma_f32_16x16x32_bf16 v[244:247], a[180:183], v[60:63], v[244:247]
    buffer_store_dwordx4 v[24:27], v7, s[8:11], s101 offen sc0 sc1
    v_mfma_f32_16x16x32_bf16 v[216:219], a[184:187], v[56:59], v[216:219]
    v_exp_f32 v111, v111
    v_mfma_f32_16x16x32_bf16 v[248:251], a[184:187], v[60:63], v[248:251]
    v_cvt_pk_bf16_f32 v55, v110, v111
    v_min_f32 v81, v81, v65
    v_mfma_f32_16x16x32_bf16 v[220:223], a[188:191], v[56:59], v[220:223]
    buffer_store_dwordx4 v[24:27], v7, s[8:11], s101 offen offset:16 sc0 sc1
    v_mfma_f32_16x16x32_bf16 v[252:255], a[188:191], v[60:63], v[252:255]
    v_add_f32 v82, 0xf2000000, v21
    v_min_f32 v82, v82, v66
    s_waitcnt vmcnt(9) lgkmcnt(0)
    s_barrier
    v_mfma_f32_16x16x32_bf16 v[96:99], a[128:131], a[192:195], v[64:67]
    s_add_u32 m0, s15, 0
    ds_read_b128 a[160:163], v19 offset:0
    v_mfma_f32_16x16x32_bf16 v[96:99], a[132:135], a[196:199], v[96:99]
    ds_read_b128 a[164:167], v19 offset:1024
    v_mfma_f32_16x16x32_bf16 v[96:99], a[136:139], a[200:203], v[96:99]
    v_exp_f32 v112, v112
    v_mfma_f32_16x16x32_bf16 v[96:99], a[140:143], a[204:207], v[96:99]
    buffer_load_dwordx4 v1, s[8:11], s82 offen offset:0  lds
    v_mfma_f32_16x16x32_bf16 v[104:107], a[128:131], a[208:211], v[68:71]
    v_exp_f32 v113, v113
    v_mfma_f32_16x16x32_bf16 v[104:107], a[132:135], a[212:215], v[104:107]
    ds_read_b128 a[168:171], v19 offset:2048
    v_cvt_pk_bf16_f32 v56, v112, v113
    v_mfma_f32_16x16x32_bf16 v[104:107], a[136:139], a[216:219], v[104:107]
    v_exp_f32 v114, v114
    v_mfma_f32_16x16x32_bf16 v[104:107], a[140:143], a[220:223], v[104:107]
    buffer_load_dwordx4 v1, s[8:11], s82 offen offset:1024  lds
    v_mfma_f32_16x16x32_bf16 v[100:103], a[144:147], a[192:195], v[64:67]
    v_exp_f32 v115, v115
    v_mfma_f32_16x16x32_bf16 v[100:103], a[148:151], a[196:199], v[100:103]
    ds_read_b128 a[172:175], v19 offset:3072
    v_cvt_pk_bf16_f32 v57, v114, v115
    v_mfma_f32_16x16x32_bf16 v[100:103], a[152:155], a[200:203], v[100:103]
    v_exp_f32 v116, v116
    v_mfma_f32_16x16x32_bf16 v[100:103], a[156:159], a[204:207], v[100:103]
    buffer_load_dwordx4 v1, s[8:11], s82 offen offset:2048  lds
    v_mfma_f32_16x16x32_bf16 v[108:111], a[144:147], a[208:211], v[68:71]
    v_exp_f32 v117, v117
    v_mfma_f32_16x16x32_bf16 v[108:111], a[148:151], a[212:215], v[108:111]
    ds_read_b128 a[176:179], v20 offset:4096
    v_cvt_pk_bf16_f32 v58, v116, v117
    v_mfma_f32_16x16x32_bf16 v[108:111], a[152:155], a[216:219], v[108:111]
    v_exp_f32 v118, v118
    v_mfma_f32_16x16x32_bf16 v[108:111], a[156:159], a[220:223], v[108:111]
    buffer_load_dwordx4 v1, s[8:11], s82 offen offset:3072  lds
    v_mfma_f32_16x16x32_bf16 v[32:35], v[28:31], v[48:51], v[32:35]
    s_add_u32 m0, s15, 4096
    v_exp_f32 v119, v119
    v_mfma_f32_16x16x32_bf16 v[36:39], v[28:31], v[52:55], v[36:39]
    s_waitcnt lgkmcnt(4)
    ds_read_b128 a[180:183], v20 offset:5120
    v_cvt_pk_bf16_f32 v59, v118, v119
    v_mfma_f32_16x16x32_bf16 v[128:131], a[160:163], v[48:51], v[128:131]
    v_exp_f32 v120, v120
    v_mfma_f32_16x16x32_bf16 v[160:163], a[160:163], v[52:55], v[160:163]
    s_waitcnt lgkmcnt(4)
    v_mfma_f32_16x16x32_bf16 v[132:135], a[164:167], v[48:51], v[132:135]
    v_exp_f32 v121, v121
    v_mfma_f32_16x16x32_bf16 v[164:167], a[164:167], v[52:55], v[164:167]
    s_waitcnt lgkmcnt(3)
    ds_read_b128 a[184:187], v20 offset:6144
    v_cvt_pk_bf16_f32 v60, v120, v121
    v_mfma_f32_16x16x32_bf16 v[136:139], a[168:171], v[48:51], v[136:139]
    s_waitcnt lgkmcnt(3)
    v_exp_f32 v122, v122
    v_mfma_f32_16x16x32_bf16 v[168:171], a[168:171], v[52:55], v[168:171]
    buffer_load_dwordx4 v15, s[8:11], s82 offen offset:0  lds
    v_mfma_f32_16x16x32_bf16 v[140:143], a[172:175], v[48:51], v[140:143]
    v_exp_f32 v123, v123
    v_mfma_f32_16x16x32_bf16 v[172:175], a[172:175], v[52:55], v[172:175]
    s_waitcnt lgkmcnt(2)
    ds_read_b128 a[188:191], v20 offset:7168
    v_cvt_pk_bf16_f32 v61, v122, v123
    v_mfma_f32_16x16x32_bf16 v[144:147], a[176:179], v[48:51], v[144:147]
    s_waitcnt lgkmcnt(2)
    v_exp_f32 v124, v124
    v_mfma_f32_16x16x32_bf16 v[176:179], a[176:179], v[52:55], v[176:179]
    buffer_load_dwordx4 v15, s[8:11], s82 offen offset:1024  lds
    v_mfma_f32_16x16x32_bf16 v[148:151], a[180:183], v[48:51], v[148:151]
    v_exp_f32 v125, v125
    v_mfma_f32_16x16x32_bf16 v[180:183], a[180:183], v[52:55], v[180:183]
    s_waitcnt lgkmcnt(1)
    v_cvt_pk_bf16_f32 v62, v124, v125
    v_mfma_f32_16x16x32_bf16 v[152:155], a[184:187], v[48:51], v[152:155]
    s_waitcnt lgkmcnt(0)
    v_exp_f32 v126, v126
    v_mfma_f32_16x16x32_bf16 v[184:187], a[184:187], v[52:55], v[184:187]
    buffer_load_dwordx4 v15, s[8:11], s82 offen offset:2048  lds
    v_mfma_f32_16x16x32_bf16 v[156:159], a[188:191], v[48:51], v[156:159]
    v_exp_f32 v127, v127
    v_mfma_f32_16x16x32_bf16 v[188:191], a[188:191], v[52:55], v[188:191]
    v_cvt_pk_bf16_f32 v63, v126, v127
    v_mfma_f32_16x16x32_bf16 v[112:115], a[128:131], a[224:227], v[72:75]
    v_mfma_f32_16x16x32_bf16 v[112:115], a[132:135], a[228:231], v[112:115]
    v_mfma_f32_16x16x32_bf16 v[112:115], a[136:139], a[232:235], v[112:115]
    v_exp_f32 v96, v96
    v_mfma_f32_16x16x32_bf16 v[112:115], a[140:143], a[236:239], v[112:115]
    buffer_load_dwordx4 v15, s[8:11], s82 offen offset:3072  lds
    v_mfma_f32_16x16x32_bf16 v[120:123], a[128:131], a[240:243], v[76:79]
    s_xor_b32 s15, s15, 196608
    v_exp_f32 v97, v97
    v_mfma_f32_16x16x32_bf16 v[120:123], a[132:135], a[244:247], v[120:123]
    s_add_u32 m0, s16, 0
    ds_read_b128 a[128:131], v18 offset:0
    v_cvt_pk_bf16_f32 v48, v96, v97
    v_mfma_f32_16x16x32_bf16 v[120:123], a[136:139], a[248:251], v[120:123]
    v_exp_f32 v98, v98
    v_mfma_f32_16x16x32_bf16 v[120:123], a[140:143], a[252:255], v[120:123]
    buffer_load_dwordx4 v1, s[8:11], s19 offen offset:0  lds
    v_mfma_f32_16x16x32_bf16 v[116:119], a[144:147], a[224:227], v[72:75]
    v_exp_f32 v99, v99
    v_mfma_f32_16x16x32_bf16 v[116:119], a[148:151], a[228:231], v[116:119]
    ds_read_b128 a[132:135], v18 offset:1024
    v_cvt_pk_bf16_f32 v49, v98, v99
    v_mfma_f32_16x16x32_bf16 v[116:119], a[152:155], a[232:235], v[116:119]
    v_exp_f32 v100, v100
    v_mfma_f32_16x16x32_bf16 v[116:119], a[156:159], a[236:239], v[116:119]
    buffer_load_dwordx4 v1, s[8:11], s19 offen offset:1024  lds
    v_mfma_f32_16x16x32_bf16 v[124:127], a[144:147], a[240:243], v[76:79]
    v_exp_f32 v101, v101
    v_mfma_f32_16x16x32_bf16 v[124:127], a[148:151], a[244:247], v[124:127]
    ds_read_b128 a[136:139], v18 offset:2048
    v_cvt_pk_bf16_f32 v50, v100, v101
    v_mfma_f32_16x16x32_bf16 v[124:127], a[152:155], a[248:251], v[124:127]
    v_exp_f32 v102, v102
    v_mfma_f32_16x16x32_bf16 v[124:127], a[156:159], a[252:255], v[124:127]
    buffer_load_dwordx4 v1, s[8:11], s19 offen offset:2048  lds
    v_mfma_f32_16x16x32_bf16 v[40:43], v[28:31], v[56:59], v[40:43]
    v_exp_f32 v103, v103
    v_mfma_f32_16x16x32_bf16 v[44:47], v[28:31], v[60:63], v[44:47]
    ds_read_b128 a[140:143], v18 offset:3072
    v_cvt_pk_bf16_f32 v51, v102, v103
    v_mfma_f32_16x16x32_bf16 v[192:195], a[160:163], v[56:59], v[192:195]
    v_exp_f32 v104, v104
    v_mfma_f32_16x16x32_bf16 v[224:227], a[160:163], v[60:63], v[224:227]
    v_mfma_f32_16x16x32_bf16 v[196:199], a[164:167], v[56:59], v[196:199]
    v_exp_f32 v105, v105
    v_mfma_f32_16x16x32_bf16 v[228:231], a[164:167], v[60:63], v[228:231]
    ds_read_b128 a[144:147], v18 offset:4096
    v_cvt_pk_bf16_f32 v52, v104, v105
    v_mfma_f32_16x16x32_bf16 v[200:203], a[168:171], v[56:59], v[200:203]
    v_exp_f32 v106, v106
    v_mfma_f32_16x16x32_bf16 v[232:235], a[168:171], v[60:63], v[232:235]
    buffer_load_dwordx4 v1, s[8:11], s19 offen offset:3072  lds
    v_mfma_f32_16x16x32_bf16 v[204:207], a[172:175], v[56:59], v[204:207]
    s_add_u32 m0, s16, 4096
    v_exp_f32 v107, v107
    v_mfma_f32_16x16x32_bf16 v[236:239], a[172:175], v[60:63], v[236:239]
    ds_read_b128 a[148:151], v18 offset:5120
    v_cvt_pk_bf16_f32 v53, v106, v107
    v_mfma_f32_16x16x32_bf16 v[208:211], a[176:179], v[56:59], v[208:211]
    v_exp_f32 v108, v108
    v_mfma_f32_16x16x32_bf16 v[240:243], a[176:179], v[60:63], v[240:243]
    buffer_load_dwordx4 v15, s[8:11], s19 offen offset:0  lds
    v_mfma_f32_16x16x32_bf16 v[212:215], a[180:183], v[56:59], v[212:215]
    v_exp_f32 v109, v109
    v_mfma_f32_16x16x32_bf16 v[244:247], a[180:183], v[60:63], v[244:247]
    ds_read_b128 a[152:155], v18 offset:6144
    v_cvt_pk_bf16_f32 v54, v108, v109
    v_mfma_f32_16x16x32_bf16 v[216:219], a[184:187], v[56:59], v[216:219]
    v_exp_f32 v110, v110
    v_mfma_f32_16x16x32_bf16 v[248:251], a[184:187], v[60:63], v[248:251]
    buffer_load_dwordx4 v15, s[8:11], s19 offen offset:1024  lds
    v_mfma_f32_16x16x32_bf16 v[220:223], a[188:191], v[56:59], v[220:223]
    v_exp_f32 v111, v111
    v_mfma_f32_16x16x32_bf16 v[252:255], a[188:191], v[60:63], v[252:255]
    ds_read_b128 a[156:159], v18 offset:7168
    v_cvt_pk_bf16_f32 v55, v110, v111
    s_waitcnt lgkmcnt(7)
    v_mfma_f32_16x16x32_bf16 v[96:99], a[128:131], a[192:195], v[64:67]
    s_waitcnt lgkmcnt(6)
    s_lshl_b32 s24, s60, 2
    s_add_u32 s24, s24, s3
    ds_read_b128 a[160:163], v19 offset:16384
    v_mfma_f32_16x16x32_bf16 v[96:99], a[132:135], a[196:199], v[96:99]
    s_waitcnt lgkmcnt(6)
    s_lshl_b32 s24, s24, 3
    s_add_u32 s24, s24, s4
    ds_read_b128 a[164:167], v19 offset:17408
    v_mfma_f32_16x16x32_bf16 v[96:99], a[136:139], a[200:203], v[96:99]
    s_waitcnt lgkmcnt(6)
    s_lshl_b32 s24, s24, 2
    v_exp_f32 v112, v112
    v_mfma_f32_16x16x32_bf16 v[96:99], a[140:143], a[204:207], v[96:99]
    buffer_load_dwordx4 v15, s[8:11], s19 offen offset:2048  lds
    v_mfma_f32_16x16x32_bf16 v[104:107], a[128:131], a[208:211], v[68:71]
    s_add_u32 s24, s24, s5
    v_exp_f32 v113, v113
    v_mfma_f32_16x16x32_bf16 v[104:107], a[132:135], a[212:215], v[104:107]
    s_lshl_b32 s24, s24, 13
    ds_read_b128 a[168:171], v19 offset:18432
    v_cvt_pk_bf16_f32 v56, v112, v113
    v_mfma_f32_16x16x32_bf16 v[104:107], a[136:139], a[216:219], v[104:107]
    s_waitcnt lgkmcnt(6)
    s_add_u32 s24, s24, 50331648
    v_exp_f32 v114, v114
    s_waitcnt vmcnt(20)
    v_cmp_ne_u32 vcc, 0, v3
    s_cmp_eq_u64 vcc, -1
    s_cbranch_scc0 L_C1_slow_9
L_C1_ok_10:
    v_mfma_f32_16x16x32_bf16 v[104:107], a[140:143], a[220:223], v[104:107]
    buffer_load_dwordx4 v15, s[8:11], s19 offen offset:3072  lds
    v_mfma_f32_16x16x32_bf16 v[100:103], a[144:147], a[192:195], v[64:67]
    s_waitcnt lgkmcnt(5)
    s_xor_b32 s16, s16, 98304
    v_exp_f32 v115, v115
    v_mfma_f32_16x16x32_bf16 v[100:103], a[148:151], a[196:199], v[100:103]
    s_waitcnt lgkmcnt(4)
    s_xor_b32 s74, s24, 0
    ds_read_b128 a[172:175], v19 offset:19456
    v_cvt_pk_bf16_f32 v57, v114, v115
    v_mfma_f32_16x16x32_bf16 v[100:103], a[152:155], a[200:203], v[100:103]
    s_waitcnt lgkmcnt(4)
    v_exp_f32 v116, v116
    v_mfma_f32_16x16x32_bf16 v[100:103], a[156:159], a[204:207], v[100:103]
    buffer_load_dwordx4 a[64:67], v1, s[8:11], s74 offen offset:0
    v_mfma_f32_16x16x32_bf16 v[108:111], a[144:147], a[208:211], v[68:71]
    s_xor_b32 s74, s24, 0
    v_exp_f32 v117, v117
    v_mfma_f32_16x16x32_bf16 v[108:111], a[148:151], a[212:215], v[108:111]
    ds_read_b128 a[176:179], v20 offset:20480
    v_cvt_pk_bf16_f32 v58, v116, v117
    v_mfma_f32_16x16x32_bf16 v[108:111], a[152:155], a[216:219], v[108:111]
    v_exp_f32 v118, v118
    v_mfma_f32_16x16x32_bf16 v[108:111], a[156:159], a[220:223], v[108:111]
    buffer_load_dwordx4 a[68:71], v1, s[8:11], s74 offen offset:1024
    v_mfma_f32_16x16x32_bf16 v[32:35], v[28:31], v[48:51], v[32:35]
    s_xor_b32 s74, s24, 0
    v_exp_f32 v119, v119
    v_mfma_f32_16x16x32_bf16 v[36:39], v[28:31], v[52:55], v[36:39]
    s_waitcnt lgkmcnt(4)
    ds_read_b128 a[180:183], v20 offset:21504
    v_cvt_pk_bf16_f32 v59, v118, v119
    v_mfma_f32_16x16x32_bf16 v[128:131], a[160:163], v[48:51], v[128:131]
    s_waitcnt lgkmcnt(4)
    v_exp_f32 v120, v120
    v_mfma_f32_16x16x32_bf16 v[160:163], a[160:163], v[52:55], v[160:163]
    buffer_load_dwordx4 a[72:75], v1, s[8:11], s74 offen offset:2048
    v_mfma_f32_16x16x32_bf16 v[132:135], a[164:167], v[48:51], v[132:135]
    s_xor_b32 s74, s24, 0
    v_exp_f32 v121, v121
    v_mfma_f32_16x16x32_bf16 v[164:167], a[164:167], v[52:55], v[164:167]
    s_waitcnt lgkmcnt(3)
    ds_read_b128 a[184:187], v20 offset:22528
    v_cvt_pk_bf16_f32 v60, v120, v121
    v_mfma_f32_16x16x32_bf16 v[136:139], a[168:171], v[48:51], v[136:139]
    s_waitcnt lgkmcnt(3)
    v_exp_f32 v122, v122
    v_mfma_f32_16x16x32_bf16 v[168:171], a[168:171], v[52:55], v[168:171]
    buffer_load_dwordx4 a[76:79], v1, s[8:11], s74 offen offset:3072
    v_mfma_f32_16x16x32_bf16 v[140:143], a[172:175], v[48:51], v[140:143]
    s_xor_b32 s74, s24, 4096
    v_exp_f32 v123, v123
    v_mfma_f32_16x16x32_bf16 v[172:175], a[172:175], v[52:55], v[172:175]
    s_waitcnt lgkmcnt(2)
    ds_read_b128 a[188:191], v20 offset:23552
    v_cvt_pk_bf16_f32 v61, v122, v123
    v_mfma_f32_16x16x32_bf16 v[144:147], a[176:179], v[48:51], v[144:147]
    s_waitcnt lgkmcnt(2)
    v_exp_f32 v124, v124
    v_mfma_f32_16x16x32_bf16 v[176:179], a[176:179], v[52:55], v[176:179]
    buffer_load_dwordx4 a[80:83], v1, s[8:11], s74 offen offset:0
    v_mfma_f32_16x16x32_bf16 v[148:151], a[180:183], v[48:51], v[148:151]
    v_exp_f32 v125, v125
    v_mfma_f32_16x16x32_bf16 v[180:183], a[180:183], v[52:55], v[180:183]
    s_waitcnt lgkmcnt(1)
    v_cvt_pk_bf16_f32 v62, v124, v125
    v_xor_b32 v19, 98304, v19
    v_mfma_f32_16x16x32_bf16 v[152:155], a[184:187], v[48:51], v[152:155]
    v_exp_f32 v126, v126
    v_mfma_f32_16x16x32_bf16 v[184:187], a[184:187], v[52:55], v[184:187]
    s_waitcnt lgkmcnt(0)
    v_xor_b32 v20, 98304, v20
    v_mfma_f32_16x16x32_bf16 v[156:159], a[188:191], v[48:51], v[156:159]
    v_exp_f32 v127, v127
    v_mfma_f32_16x16x32_bf16 v[188:191], a[188:191], v[52:55], v[188:191]
    v_cvt_pk_bf16_f32 v63, v126, v127
    v_mfma_f32_16x16x32_bf16 v[112:115], a[128:131], a[224:227], v[72:75]
    s_add_u32 m0, s62, 32768
    v_exp_f32 v96, v96
    v_mfma_f32_16x16x32_bf16 v[112:115], a[132:135], a[228:231], v[112:115]
    v_add_f32 v83, 0xf2400000, v21
    v_min_f32 v83, v83, v67
    v_mfma_f32_16x16x32_bf16 v[112:115], a[136:139], a[232:235], v[112:115]
    s_xor_b32 s98, s65, 0
    v_exp_f32 v97, v97
    v_mfma_f32_16x16x32_bf16 v[112:115], a[140:143], a[236:239], v[112:115]
    v_cvt_pk_bf16_f32 v48, v96, v97
    v_add_f32 v84, 0xf3800000, v21
    v_mfma_f32_16x16x32_bf16 v[120:123], a[128:131], a[240:243], v[76:79]
    v_exp_f32 v98, v98
    v_mfma_f32_16x16x32_bf16 v[120:123], a[132:135], a[244:247], v[120:123]
    buffer_load_dwordx4 v8, s[28:31], s98 offen offset:0   lds
    v_mfma_f32_16x16x32_bf16 v[120:123], a[136:139], a[248:251], v[120:123]
    v_exp_f32 v99, v99
    v_mfma_f32_16x16x32_bf16 v[120:123], a[140:143], a[252:255], v[120:123]
    buffer_load_dwordx4 v9, s[28:31], s98 offen offset:1024   lds
    v_mfma_f32_16x16x32_bf16 v[116:119], a[144:147], a[224:227], v[72:75]
    v_exp_f32 v100, v100
    v_mfma_f32_16x16x32_bf16 v[116:119], a[148:151], a[228:231], v[116:119]
    ds_read_b128 a[128:131], v18 offset:16384
    v_cvt_pk_bf16_f32 v49, v98, v99
    v_mfma_f32_16x16x32_bf16 v[116:119], a[152:155], a[232:235], v[116:119]
    s_add_u32 s19, s82, 32768
    v_exp_f32 v101, v101
    v_mfma_f32_16x16x32_bf16 v[116:119], a[156:159], a[236:239], v[116:119]
    s_sub_u32 s82, s12, s13
    ds_read_b128 a[132:135], v18 offset:17408
    v_cvt_pk_bf16_f32 v50, v100, v101
    v_mfma_f32_16x16x32_bf16 v[124:127], a[144:147], a[240:243], v[76:79]
    s_sub_u32 s82, s82, 1
    v_exp_f32 v102, v102
    v_mfma_f32_16x16x32_bf16 v[124:127], a[148:151], a[244:247], v[124:127]
    s_cmp_gt_u32 s12, s13
    s_cselect_b32 s82, s82, s12
    s_lshl_b32 s82, s82, 16
    ds_read_b128 a[136:139], v18 offset:18432
    v_mfma_f32_16x16x32_bf16 v[124:127], a[152:155], a[248:251], v[124:127]
    s_add_u32 s82, s82, s81
    v_exp_f32 v103, v103
    v_mfma_f32_16x16x32_bf16 v[124:127], a[156:159], a[252:255], v[124:127]
    s_cmp_ge_u32 s12, 17
    s_cselect_b32 s82, 2147471360, s82
    ds_read_b128 a[140:143], v18 offset:19456
    v_cvt_pk_bf16_f32 v51, v102, v103
    v_mfma_f32_16x16x32_bf16 v[40:43], v[28:31], v[56:59], v[40:43]
    s_add_u32 s12, s12, 1
    v_exp_f32 v104, v104
    v_mfma_f32_16x16x32_bf16 v[44:47], v[28:31], v[60:63], v[44:47]
    ds_read_b128 a[144:147], v18 offset:20480
    v_min_f32 v84, v84, v64
    v_mfma_f32_16x16x32_bf16 v[192:195], a[160:163], v[56:59], v[192:195]
    v_exp_f32 v105, v105
    v_mfma_f32_16x16x32_bf16 v[224:227], a[160:163], v[60:63], v[224:227]
    ds_read_b128 a[148:151], v18 offset:21504
    v_cvt_pk_bf16_f32 v52, v104, v105
    v_mfma_f32_16x16x32_bf16 v[196:199], a[164:167], v[56:59], v[196:199]
    v_exp_f32 v106, v106
    v_mfma_f32_16x16x32_bf16 v[228:231], a[164:167], v[60:63], v[228:231]
    ds_read_b128 a[152:155], v18 offset:22528
    v_add_f32 v85, 0xf3880000, v21
    v_mfma_f32_16x16x32_bf16 v[200:203], a[168:171], v[56:59], v[200:203]
    v_exp_f32 v107, v107
    v_mfma_f32_16x16x32_bf16 v[232:235], a[168:171], v[60:63], v[232:235]
    ds_read_b128 a[156:159], v18 offset:23552
    v_cvt_pk_bf16_f32 v53, v106, v107
    v_mfma_f32_16x16x32_bf16 v[204:207], a[172:175], v[56:59], v[204:207]
    v_exp_f32 v108, v108
    v_mfma_f32_16x16x32_bf16 v[236:239], a[172:175], v[60:63], v[236:239]
    buffer_load_dwordx4 v10, s[28:31], s98 offen offset:2048   lds
    v_mfma_f32_16x16x32_bf16 v[208:211], a[176:179], v[56:59], v[208:211]
    v_exp_f32 v109, v109
    v_mfma_f32_16x16x32_bf16 v[240:243], a[176:179], v[60:63], v[240:243]
    v_cvt_pk_bf16_f32 v54, v108, v109
    v_xor_b32 v18, 196608, v18
    v_mfma_f32_16x16x32_bf16 v[212:215], a[180:183], v[56:59], v[212:215]
    v_exp_f32 v110, v110
    v_mfma_f32_16x16x32_bf16 v[244:247], a[180:183], v[60:63], v[244:247]
    buffer_load_dwordx4 v11, s[28:31], s98 offen offset:3072   lds
    v_mfma_f32_16x16x32_bf16 v[216:219], a[184:187], v[56:59], v[216:219]
    s_xor_b32 s74, s24, 4096
    v_exp_f32 v111, v111
    v_mfma_f32_16x16x32_bf16 v[248:251], a[184:187], v[60:63], v[248:251]
    v_cvt_pk_bf16_f32 v55, v110, v111
    v_min_f32 v85, v85, v65
    v_mfma_f32_16x16x32_bf16 v[220:223], a[188:191], v[56:59], v[220:223]
    buffer_load_dwordx4 a[84:87], v1, s[8:11], s74 offen offset:1024
    v_mfma_f32_16x16x32_bf16 v[252:255], a[188:191], v[60:63], v[252:255]
    s_xor_b32 s74, s24, 4096
    buffer_load_dwordx4 a[88:91], v1, s[8:11], s74 offen offset:2048
    s_xor_b32 s74, s24, 4096
    buffer_load_dwordx4 a[92:95], v1, s[8:11], s74 offen offset:3072
    s_waitcnt vmcnt(12) lgkmcnt(0)
    s_barrier
    v_mfma_f32_16x16x32_bf16 v[96:99], a[128:131], a[192:195], v[64:67]
    s_add_u32 m0, s15, 0
    ds_read_b128 a[160:163], v19 offset:0
    v_mfma_f32_16x16x32_bf16 v[96:99], a[132:135], a[196:199], v[96:99]
    ds_read_b128 a[164:167], v19 offset:1024
    v_mfma_f32_16x16x32_bf16 v[96:99], a[136:139], a[200:203], v[96:99]
    v_exp_f32 v112, v112
    v_mfma_f32_16x16x32_bf16 v[96:99], a[140:143], a[204:207], v[96:99]
    buffer_load_dwordx4 v1, s[8:11], s82 offen offset:0  lds
    v_mfma_f32_16x16x32_bf16 v[104:107], a[128:131], a[208:211], v[68:71]
    v_exp_f32 v113, v113
    v_mfma_f32_16x16x32_bf16 v[104:107], a[132:135], a[212:215], v[104:107]
    ds_read_b128 a[168:171], v19 offset:2048
    v_cvt_pk_bf16_f32 v56, v112, v113
    v_mfma_f32_16x16x32_bf16 v[104:107], a[136:139], a[216:219], v[104:107]
    v_exp_f32 v114, v114
    v_mfma_f32_16x16x32_bf16 v[104:107], a[140:143], a[220:223], v[104:107]
    buffer_load_dwordx4 v1, s[8:11], s82 offen offset:1024  lds
    v_mfma_f32_16x16x32_bf16 v[100:103], a[144:147], a[192:195], v[64:67]
    v_exp_f32 v115, v115
    v_mfma_f32_16x16x32_bf16 v[100:103], a[148:151], a[196:199], v[100:103]
    ds_read_b128 a[172:175], v19 offset:3072
    v_cvt_pk_bf16_f32 v57, v114, v115
    v_mfma_f32_16x16x32_bf16 v[100:103], a[152:155], a[200:203], v[100:103]
    v_exp_f32 v116, v116
    v_mfma_f32_16x16x32_bf16 v[100:103], a[156:159], a[204:207], v[100:103]
    buffer_load_dwordx4 v1, s[8:11], s82 offen offset:2048  lds
    v_mfma_f32_16x16x32_bf16 v[108:111], a[144:147], a[208:211], v[68:71]
    v_exp_f32 v117, v117
    v_mfma_f32_16x16x32_bf16 v[108:111], a[148:151], a[212:215], v[108:111]
    ds_read_b128 a[176:179], v20 offset:4096
    v_cvt_pk_bf16_f32 v58, v116, v117
    v_mfma_f32_16x16x32_bf16 v[108:111], a[152:155], a[216:219], v[108:111]
    v_exp_f32 v118, v118
    v_mfma_f32_16x16x32_bf16 v[108:111], a[156:159], a[220:223], v[108:111]
    buffer_load_dwordx4 v1, s[8:11], s82 offen offset:3072  lds
    v_mfma_f32_16x16x32_bf16 v[32:35], v[28:31], v[48:51], v[32:35]
    s_add_u32 m0, s15, 4096
    v_exp_f32 v119, v119
    v_mfma_f32_16x16x32_bf16 v[36:39], v[28:31], v[52:55], v[36:39]
    s_waitcnt lgkmcnt(4)
    ds_read_b128 a[180:183], v20 offset:5120
    v_cvt_pk_bf16_f32 v59, v118, v119
    v_mfma_f32_16x16x32_bf16 v[128:131], a[160:163], v[48:51], v[128:131]
    v_exp_f32 v120, v120
    v_mfma_f32_16x16x32_bf16 v[160:163], a[160:163], v[52:55], v[160:163]
    s_waitcnt lgkmcnt(4)
    v_mfma_f32_16x16x32_bf16 v[132:135], a[164:167], v[48:51], v[132:135]
    v_exp_f32 v121, v121
    v_mfma_f32_16x16x32_bf16 v[164:167], a[164:167], v[52:55], v[164:167]
    s_waitcnt lgkmcnt(3)
    ds_read_b128 a[184:187], v20 offset:6144
    v_cvt_pk_bf16_f32 v60, v120, v121
    v_mfma_f32_16x16x32_bf16 v[136:139], a[168:171], v[48:51], v[136:139]
    s_waitcnt lgkmcnt(3)
    v_exp_f32 v122, v122
    v_mfma_f32_16x16x32_bf16 v[168:171], a[168:171], v[52:55], v[168:171]
    buffer_load_dwordx4 v15, s[8:11], s82 offen offset:0  lds
    v_mfma_f32_16x16x32_bf16 v[140:143], a[172:175], v[48:51], v[140:143]
    v_exp_f32 v123, v123
    v_mfma_f32_16x16x32_bf16 v[172:175], a[172:175], v[52:55], v[172:175]
    s_waitcnt lgkmcnt(2)
    ds_read_b128 a[188:191], v20 offset:7168
    v_cvt_pk_bf16_f32 v61, v122, v123
    v_mfma_f32_16x16x32_bf16 v[144:147], a[176:179], v[48:51], v[144:147]
    s_waitcnt lgkmcnt(2)
    v_exp_f32 v124, v124
    v_mfma_f32_16x16x32_bf16 v[176:179], a[176:179], v[52:55], v[176:179]
    buffer_load_dwordx4 v15, s[8:11], s82 offen offset:1024  lds
    v_mfma_f32_16x16x32_bf16 v[148:151], a[180:183], v[48:51], v[148:151]
    v_exp_f32 v125, v125
    v_mfma_f32_16x16x32_bf16 v[180:183], a[180:183], v[52:55], v[180:183]
    s_waitcnt lgkmcnt(1)
    v_cvt_pk_bf16_f32 v62, v124, v125
    v_mfma_f32_16x16x32_bf16 v[152:155], a[184:187], v[48:51], v[152:155]
    s_waitcnt lgkmcnt(0)
    v_exp_f32 v126, v126
    v_mfma_f32_16x16x32_bf16 v[184:187], a[184:187], v[52:55], v[184:187]
    buffer_load_dwordx4 v15, s[8:11], s82 offen offset:2048  lds
    v_mfma_f32_16x16x32_bf16 v[156:159], a[188:191], v[48:51], v[156:159]
    v_exp_f32 v127, v127
    v_mfma_f32_16x16x32_bf16 v[188:191], a[188:191], v[52:55], v[188:191]
    v_cvt_pk_bf16_f32 v63, v126, v127
    v_mfma_f32_16x16x32_bf16 v[112:115], a[128:131], a[224:227], v[72:75]
    v_mfma_f32_16x16x32_bf16 v[112:115], a[132:135], a[228:231], v[112:115]
    v_mfma_f32_16x16x32_bf16 v[112:115], a[136:139], a[232:235], v[112:115]
    v_exp_f32 v96, v96
    v_mfma_f32_16x16x32_bf16 v[112:115], a[140:143], a[236:239], v[112:115]
    buffer_load_dwordx4 v15, s[8:11], s82 offen offset:3072  lds
    v_mfma_f32_16x16x32_bf16 v[120:123], a[128:131], a[240:243], v[76:79]
    s_xor_b32 s15, s15, 196608
    v_exp_f32 v97, v97
    v_mfma_f32_16x16x32_bf16 v[120:123], a[132:135], a[244:247], v[120:123]
    s_add_u32 m0, s16, 0
    ds_read_b128 a[128:131], v18 offset:0
    v_cvt_pk_bf16_f32 v48, v96, v97
    v_mfma_f32_16x16x32_bf16 v[120:123], a[136:139], a[248:251], v[120:123]
    v_exp_f32 v98, v98
    v_mfma_f32_16x16x32_bf16 v[120:123], a[140:143], a[252:255], v[120:123]
    buffer_load_dwordx4 v1, s[8:11], s19 offen offset:0  lds
    v_mfma_f32_16x16x32_bf16 v[116:119], a[144:147], a[224:227], v[72:75]
    v_exp_f32 v99, v99
    v_mfma_f32_16x16x32_bf16 v[116:119], a[148:151], a[228:231], v[116:119]
    ds_read_b128 a[132:135], v18 offset:1024
    v_cvt_pk_bf16_f32 v49, v98, v99
    v_mfma_f32_16x16x32_bf16 v[116:119], a[152:155], a[232:235], v[116:119]
    v_exp_f32 v100, v100
    v_mfma_f32_16x16x32_bf16 v[116:119], a[156:159], a[236:239], v[116:119]
    buffer_load_dwordx4 v1, s[8:11], s19 offen offset:1024  lds
    v_mfma_f32_16x16x32_bf16 v[124:127], a[144:147], a[240:243], v[76:79]
    v_exp_f32 v101, v101
    v_mfma_f32_16x16x32_bf16 v[124:127], a[148:151], a[244:247], v[124:127]
    ds_read_b128 a[136:139], v18 offset:2048
    v_cvt_pk_bf16_f32 v50, v100, v101
    v_mfma_f32_16x16x32_bf16 v[124:127], a[152:155], a[248:251], v[124:127]
    v_exp_f32 v102, v102
    v_mfma_f32_16x16x32_bf16 v[124:127], a[156:159], a[252:255], v[124:127]
    buffer_load_dwordx4 v1, s[8:11], s19 offen offset:2048  lds
    v_mfma_f32_16x16x32_bf16 v[40:43], v[28:31], v[56:59], v[40:43]
    v_exp_f32 v103, v103
    v_mfma_f32_16x16x32_bf16 v[44:47], v[28:31], v[60:63], v[44:47]
    ds_read_b128 a[140:143], v18 offset:3072
    v_cvt_pk_bf16_f32 v51, v102, v103
    v_mfma_f32_16x16x32_bf16 v[192:195], a[160:163], v[56:59], v[192:195]
    v_exp_f32 v104, v104
    v_mfma_f32_16x16x32_bf16 v[224:227], a[160:163], v[60:63], v[224:227]
    v_mfma_f32_16x16x32_bf16 v[196:199], a[164:167], v[56:59], v[196:199]
    v_exp_f32 v105, v105
    v_mfma_f32_16x16x32_bf16 v[228:231], a[164:167], v[60:63], v[228:231]
    ds_read_b128 a[144:147], v18 offset:4096
    v_cvt_pk_bf16_f32 v52, v104, v105
    v_mfma_f32_16x16x32_bf16 v[200:203], a[168:171], v[56:59], v[200:203]
    v_exp_f32 v106, v106
    v_mfma_f32_16x16x32_bf16 v[232:235], a[168:171], v[60:63], v[232:235]
    buffer_load_dwordx4 v1, s[8:11], s19 offen offset:3072  lds
    v_mfma_f32_16x16x32_bf16 v[204:207], a[172:175], v[56:59], v[204:207]
    s_add_u32 m0, s16, 4096
    v_exp_f32 v107, v107
    v_mfma_f32_16x16x32_bf16 v[236:239], a[172:175], v[60:63], v[236:239]
    ds_read_b128 a[148:151], v18 offset:5120
    v_cvt_pk_bf16_f32 v53, v106, v107
    v_mfma_f32_16x16x32_bf16 v[208:211], a[176:179], v[56:59], v[208:211]
    v_exp_f32 v108, v108
    v_mfma_f32_16x16x32_bf16 v[240:243], a[176:179], v[60:63], v[240:243]
    buffer_load_dwordx4 v15, s[8:11], s19 offen offset:0  lds
    v_mfma_f32_16x16x32_bf16 v[212:215], a[180:183], v[56:59], v[212:215]
    v_exp_f32 v109, v109
    v_mfma_f32_16x16x32_bf16 v[244:247], a[180:183], v[60:63], v[244:247]
    ds_read_b128 a[152:155], v18 offset:6144
    v_cvt_pk_bf16_f32 v54, v108, v109
    v_mfma_f32_16x16x32_bf16 v[216:219], a[184:187], v[56:59], v[216:219]
    v_exp_f32 v110, v110
    v_mfma_f32_16x16x32_bf16 v[248:251], a[184:187], v[60:63], v[248:251]
    buffer_load_dwordx4 v15, s[8:11], s19 offen offset:1024  lds
    v_mfma_f32_16x16x32_bf16 v[220:223], a[188:191], v[56:59], v[220:223]
    v_exp_f32 v111, v111
    v_mfma_f32_16x16x32_bf16 v[252:255], a[188:191], v[60:63], v[252:255]
    ds_read_b128 a[156:159], v18 offset:7168
    v_cvt_pk_bf16_f32 v55, v110, v111
    s_waitcnt lgkmcnt(7)
    v_mfma_f32_16x16x32_bf16 v[96:99], a[128:131], a[192:195], v[64:67]
    s_waitcnt lgkmcnt(6)
    ds_read_b128 a[160:163], v19 offset:16384
    v_mfma_f32_16x16x32_bf16 v[96:99], a[132:135], a[196:199], v[96:99]
    s_waitcnt lgkmcnt(6)
    ds_read_b128 a[164:167], v19 offset:17408
    v_mfma_f32_16x16x32_bf16 v[96:99], a[136:139], a[200:203], v[96:99]
    s_waitcnt lgkmcnt(6)
    v_exp_f32 v112, v112
    v_mfma_f32_16x16x32_bf16 v[96:99], a[140:143], a[204:207], v[96:99]
    buffer_load_dwordx4 v15, s[8:11], s19 offen offset:2048  lds
    v_mfma_f32_16x16x32_bf16 v[104:107], a[128:131], a[208:211], v[68:71]
    v_exp_f32 v113, v113
    v_mfma_f32_16x16x32_bf16 v[104:107], a[132:135], a[212:215], v[104:107]
    ds_read_b128 a[168:171], v19 offset:18432
    v_cvt_pk_bf16_f32 v56, v112, v113
    v_mfma_f32_16x16x32_bf16 v[104:107], a[136:139], a[216:219], v[104:107]
    s_waitcnt lgkmcnt(6)
    v_exp_f32 v114, v114
    v_mfma_f32_16x16x32_bf16 v[104:107], a[140:143], a[220:223], v[104:107]
    buffer_load_dwordx4 v15, s[8:11], s19 offen offset:3072  lds
    v_mfma_f32_16x16x32_bf16 v[100:103], a[144:147], a[192:195], v[64:67]
    s_waitcnt lgkmcnt(5)
    s_xor_b32 s16, s16, 98304
    v_exp_f32 v115, v115
    v_mfma_f32_16x16x32_bf16 v[100:103], a[148:151], a[196:199], v[100:103]
    s_waitcnt lgkmcnt(4)
    s_lshl_b32 s64, s2, 6
    ds_read_b128 a[172:175], v19 offset:19456
    v_cvt_pk_bf16_f32 v57, v114, v115
    v_mfma_f32_16x16x32_bf16 v[100:103], a[152:155], a[200:203], v[100:103]
    s_waitcnt lgkmcnt(4)
    s_add_u32 s64, s64, 1327104
    v_exp_f32 v116, v116
    v_mfma_f32_16x16x32_bf16 v[100:103], a[156:159], a[204:207], v[100:103]
    buffer_store_dword v6, v7, s[8:11], s64 offen sc0 sc1
    v_mfma_f32_16x16x32_bf16 v[108:111], a[144:147], a[208:211], v[68:71]
    s_xor_b32 s74, s24, 8192
    v_exp_f32 v117, v117
    v_mfma_f32_16x16x32_bf16 v[108:111], a[148:151], a[212:215], v[108:111]
    ds_read_b128 a[176:179], v20 offset:20480
    v_cvt_pk_bf16_f32 v58, v116, v117
    v_mfma_f32_16x16x32_bf16 v[108:111], a[152:155], a[216:219], v[108:111]
    v_exp_f32 v118, v118
    v_mfma_f32_16x16x32_bf16 v[108:111], a[156:159], a[220:223], v[108:111]
    buffer_load_dwordx4 a[96:99], v1, s[8:11], s74 offen offset:0
    v_mfma_f32_16x16x32_bf16 v[32:35], v[28:31], v[48:51], v[32:35]
    s_xor_b32 s74, s24, 8192
    v_exp_f32 v119, v119
    v_mfma_f32_16x16x32_bf16 v[36:39], v[28:31], v[52:55], v[36:39]
    s_waitcnt lgkmcnt(4)
    ds_read_b128 a[180:183], v20 offset:21504
    v_cvt_pk_bf16_f32 v59, v118, v119
    v_mfma_f32_16x16x32_bf16 v[128:131], a[160:163], v[48:51], v[128:131]
    s_waitcnt lgkmcnt(4)
    v_exp_f32 v120, v120
    v_mfma_f32_16x16x32_bf16 v[160:163], a[160:163], v[52:55], v[160:163]
    buffer_load_dwordx4 a[100:103], v1, s[8:11], s74 offen offset:1024
    v_mfma_f32_16x16x32_bf16 v[132:135], a[164:167], v[48:51], v[132:135]
    s_xor_b32 s74, s24, 8192
    v_exp_f32 v121, v121
    v_mfma_f32_16x16x32_bf16 v[164:167], a[164:167], v[52:55], v[164:167]
    s_waitcnt lgkmcnt(3)
    ds_read_b128 a[184:187], v20 offset:22528
    v_cvt_pk_bf16_f32 v60, v120, v121
    v_mfma_f32_16x16x32_bf16 v[136:139], a[168:171], v[48:51], v[136:139]
    s_waitcnt lgkmcnt(3)
    v_exp_f32 v122, v122
    v_mfma_f32_16x16x32_bf16 v[168:171], a[168:171], v[52:55], v[168:171]
    buffer_load_dwordx4 a[104:107], v1, s[8:11], s74 offen offset:2048
    v_mfma_f32_16x16x32_bf16 v[140:143], a[172:175], v[48:51], v[140:143]
    s_xor_b32 s74, s24, 8192
    v_exp_f32 v123, v123
    v_mfma_f32_16x16x32_bf16 v[172:175], a[172:175], v[52:55], v[172:175]
    s_waitcnt lgkmcnt(2)
    ds_read_b128 a[188:191], v20 offset:23552
    v_cvt_pk_bf16_f32 v61, v122, v123
    v_mfma_f32_16x16x32_bf16 v[144:147], a[176:179], v[48:51], v[144:147]
    s_waitcnt lgkmcnt(2)
    v_exp_f32 v124, v124
    v_mfma_f32_16x16x32_bf16 v[176:179], a[176:179], v[52:55], v[176:179]
    buffer_load_dwordx4 a[108:111], v1, s[8:11], s74 offen offset:3072
    v_mfma_f32_16x16x32_bf16 v[148:151], a[180:183], v[48:51], v[148:151]
    s_xor_b32 s74, s24, 12288
    v_exp_f32 v125, v125
    v_mfma_f32_16x16x32_bf16 v[180:183], a[180:183], v[52:55], v[180:183]
    s_waitcnt lgkmcnt(1)
    v_cvt_pk_bf16_f32 v62, v124, v125
    v_xor_b32 v19, 98304, v19
    v_mfma_f32_16x16x32_bf16 v[152:155], a[184:187], v[48:51], v[152:155]
    buffer_load_dwordx4 a[112:115], v1, s[8:11], s74 offen offset:0
    v_exp_f32 v126, v126
    v_mfma_f32_16x16x32_bf16 v[184:187], a[184:187], v[52:55], v[184:187]
    s_waitcnt lgkmcnt(0)
    v_xor_b32 v20, 98304, v20
    v_mfma_f32_16x16x32_bf16 v[156:159], a[188:191], v[48:51], v[156:159]
    v_exp_f32 v127, v127
    v_mfma_f32_16x16x32_bf16 v[188:191], a[188:191], v[52:55], v[188:191]
    v_cvt_pk_bf16_f32 v63, v126, v127
    v_mfma_f32_16x16x32_bf16 v[112:115], a[128:131], a[224:227], v[72:75]
    s_add_u32 m0, s62, 36864
    v_exp_f32 v96, v96
    v_mfma_f32_16x16x32_bf16 v[112:115], a[132:135], a[228:231], v[112:115]
    v_add_f32 v86, 0xf3900000, v21
    v_min_f32 v86, v86, v66
    v_mfma_f32_16x16x32_bf16 v[112:115], a[136:139], a[232:235], v[112:115]
    s_xor_b32 s98, s65, 32768
    v_exp_f32 v97, v97
    v_mfma_f32_16x16x32_bf16 v[112:115], a[140:143], a[236:239], v[112:115]
    v_cvt_pk_bf16_f32 v48, v96, v97
    v_add_f32 v87, 0xf3980000, v21
    v_mfma_f32_16x16x32_bf16 v[120:123], a[128:131], a[240:243], v[76:79]
    v_exp_f32 v98, v98
    v_mfma_f32_16x16x32_bf16 v[120:123], a[132:135], a[244:247], v[120:123]
    buffer_load_dwordx4 v8, s[28:31], s98 offen offset:0   lds
    v_mfma_f32_16x16x32_bf16 v[120:123], a[136:139], a[248:251], v[120:123]
    v_exp_f32 v99, v99
    v_mfma_f32_16x16x32_bf16 v[120:123], a[140:143], a[252:255], v[120:123]
    buffer_load_dwordx4 v9, s[28:31], s98 offen offset:1024   lds
    v_mfma_f32_16x16x32_bf16 v[116:119], a[144:147], a[224:227], v[72:75]
    v_exp_f32 v100, v100
    v_mfma_f32_16x16x32_bf16 v[116:119], a[148:151], a[228:231], v[116:119]
    ds_read_b128 a[128:131], v18 offset:16384
    v_cvt_pk_bf16_f32 v49, v98, v99
    v_mfma_f32_16x16x32_bf16 v[116:119], a[152:155], a[232:235], v[116:119]
    s_add_u32 s19, s82, 32768
    v_exp_f32 v101, v101
    v_mfma_f32_16x16x32_bf16 v[116:119], a[156:159], a[236:239], v[116:119]
    s_sub_u32 s82, s12, s13
    ds_read_b128 a[132:135], v18 offset:17408
    v_cvt_pk_bf16_f32 v50, v100, v101
    v_mfma_f32_16x16x32_bf16 v[124:127], a[144:147], a[240:243], v[76:79]
    s_sub_u32 s82, s82, 1
    v_exp_f32 v102, v102
    v_mfma_f32_16x16x32_bf16 v[124:127], a[148:151], a[244:247], v[124:127]
    s_cmp_gt_u32 s12, s13
    s_cselect_b32 s82, s82, s12
    s_lshl_b32 s82, s82, 16
    ds_read_b128 a[136:139], v18 offset:18432
    v_mfma_f32_16x16x32_bf16 v[124:127], a[152:155], a[248:251], v[124:127]
    s_add_u32 s82, s82, s81
    v_exp_f32 v103, v103
    v_mfma_f32_16x16x32_bf16 v[124:127], a[156:159], a[252:255], v[124:127]
    s_cmp_ge_u32 s12, 17
    s_cselect_b32 s82, 2147471360, s82
    ds_read_b128 a[140:143], v18 offset:19456
    v_cvt_pk_bf16_f32 v51, v102, v103
    v_mfma_f32_16x16x32_bf16 v[40:43], v[28:31], v[56:59], v[40:43]
    s_add_u32 s12, s12, 1
    v_exp_f32 v104, v104
    v_mfma_f32_16x16x32_bf16 v[44:47], v[28:31], v[60:63], v[44:47]
    ds_read_b128 a[144:147], v18 offset:20480
    v_min_f32 v87, v87, v67
    v_mfma_f32_16x16x32_bf16 v[192:195], a[160:163], v[56:59], v[192:195]
    v_exp_f32 v105, v105
    v_mfma_f32_16x16x32_bf16 v[224:227], a[160:163], v[60:63], v[224:227]
    ds_read_b128 a[148:151], v18 offset:21504
    v_cvt_pk_bf16_f32 v52, v104, v105
    v_mfma_f32_16x16x32_bf16 v[196:199], a[164:167], v[56:59], v[196:199]
    v_exp_f32 v106, v106
    v_mfma_f32_16x16x32_bf16 v[228:231], a[164:167], v[60:63], v[228:231]
    ds_read_b128 a[152:155], v18 offset:22528
    v_add_f32 v88, 0x73800000, v21
    v_mfma_f32_16x16x32_bf16 v[200:203], a[168:171], v[56:59], v[200:203]
    v_exp_f32 v107, v107
    v_mfma_f32_16x16x32_bf16 v[232:235], a[168:171], v[60:63], v[232:235]
    ds_read_b128 a[156:159], v18 offset:23552
    v_cvt_pk_bf16_f32 v53, v106, v107
    v_mfma_f32_16x16x32_bf16 v[204:207], a[172:175], v[56:59], v[204:207]
    v_exp_f32 v108, v108
    v_mfma_f32_16x16x32_bf16 v[236:239], a[172:175], v[60:63], v[236:239]
    buffer_load_dwordx4 v10, s[28:31], s98 offen offset:2048   lds
    v_mfma_f32_16x16x32_bf16 v[208:211], a[176:179], v[56:59], v[208:211]
    v_exp_f32 v109, v109
    v_mfma_f32_16x16x32_bf16 v[240:243], a[176:179], v[60:63], v[240:243]
    v_cvt_pk_bf16_f32 v54, v108, v109
    v_xor_b32 v18, 196608, v18
    v_mfma_f32_16x16x32_bf16 v[212:215], a[180:183], v[56:59], v[212:215]
    v_exp_f32 v110, v110
    v_mfma_f32_16x16x32_bf16 v[244:247], a[180:183], v[60:63], v[244:247]
    buffer_load_dwordx4 v11, s[28:31], s98 offen offset:3072   lds
    v_mfma_f32_16x16x32_bf16 v[216:219], a[184:187], v[56:59], v[216:219]
    s_xor_b32 s74, s24, 12288
    v_exp_f32 v111, v111
    v_mfma_f32_16x16x32_bf16 v[248:251], a[184:187], v[60:63], v[248:251]
    v_cvt_pk_bf16_f32 v55, v110, v111
    v_min_f32 v88, v88, v68
    v_mfma_f32_16x16x32_bf16 v[220:223], a[188:191], v[56:59], v[220:223]
    buffer_load_dwordx4 a[116:119], v1, s[8:11], s74 offen offset:1024
    v_mfma_f32_16x16x32_bf16 v[252:255], a[188:191], v[60:63], v[252:255]
    s_xor_b32 s74, s24, 12288
    buffer_load_dwordx4 a[120:123], v1, s[8:11], s74 offen offset:2048
    s_xor_b32 s74, s24, 12288
    buffer_load_dwordx4 a[124:127], v1, s[8:11], s74 offen offset:3072
    s_waitcnt vmcnt(13) lgkmcnt(0)
    s_barrier
    v_mfma_f32_16x16x32_bf16 v[96:99], a[128:131], a[192:195], v[64:67]
    s_add_u32 m0, s15, 0
    ds_read_b128 a[160:163], v19 offset:0
    v_mfma_f32_16x16x32_bf16 v[96:99], a[132:135], a[196:199], v[96:99]
    ds_read_b128 a[164:167], v19 offset:1024
    v_mfma_f32_16x16x32_bf16 v[96:99], a[136:139], a[200:203], v[96:99]
    v_exp_f32 v112, v112
    v_mfma_f32_16x16x32_bf16 v[96:99], a[140:143], a[204:207], v[96:99]
    buffer_load_dwordx4 v1, s[8:11], s82 offen offset:0  lds
    v_mfma_f32_16x16x32_bf16 v[104:107], a[128:131], a[208:211], v[68:71]
    v_exp_f32 v113, v113
    v_mfma_f32_16x16x32_bf16 v[104:107], a[132:135], a[212:215], v[104:107]
    ds_read_b128 a[168:171], v19 offset:2048
    v_cvt_pk_bf16_f32 v56, v112, v113
    v_mfma_f32_16x16x32_bf16 v[104:107], a[136:139], a[216:219], v[104:107]
    v_exp_f32 v114, v114
    v_mfma_f32_16x16x32_bf16 v[104:107], a[140:143], a[220:223], v[104:107]
    buffer_load_dwordx4 v1, s[8:11], s82 offen offset:1024  lds
    v_mfma_f32_16x16x32_bf16 v[100:103], a[144:147], a[192:195], v[64:67]
    v_exp_f32 v115, v115
    v_mfma_f32_16x16x32_bf16 v[100:103], a[148:151], a[196:199], v[100:103]
    ds_read_b128 a[172:175], v19 offset:3072
    v_cvt_pk_bf16_f32 v57, v114, v115
    v_mfma_f32_16x16x32_bf16 v[100:103], a[152:155], a[200:203], v[100:103]
    v_exp_f32 v116, v116
    v_mfma_f32_16x16x32_bf16 v[100:103], a[156:159], a[204:207], v[100:103]
    buffer_load_dwordx4 v1, s[8:11], s82 offen offset:2048  lds
    v_mfma_f32_16x16x32_bf16 v[108:111], a[144:147], a[208:211], v[68:71]
    v_exp_f32 v117, v117
    v_mfma_f32_16x16x32_bf16 v[108:111], a[148:151], a[212:215], v[108:111]
    ds_read_b128 a[176:179], v20 offset:4096
    v_cvt_pk_bf16_f32 v58, v116, v117
    v_mfma_f32_16x16x32_bf16 v[108:111], a[152:155], a[216:219], v[108:111]
    v_exp_f32 v118, v118
    v_mfma_f32_16x16x32_bf16 v[108:111], a[156:159], a[220:223], v[108:111]
    buffer_load_dwordx4 v1, s[8:11], s82 offen offset:3072  lds
    v_mfma_f32_16x16x32_bf16 v[32:35], v[28:31], v[48:51], v[32:35]
    s_add_u32 m0, s15, 4096
    v_exp_f32 v119, v119
    v_mfma_f32_16x16x32_bf16 v[36:39], v[28:31], v[52:55], v[36:39]
    s_waitcnt lgkmcnt(4)
    ds_read_b128 a[180:183], v20 offset:5120
    v_cvt_pk_bf16_f32 v59, v118, v119
    v_mfma_f32_16x16x32_bf16 v[128:131], a[160:163], v[48:51], v[128:131]
    v_exp_f32 v120, v120
    v_mfma_f32_16x16x32_bf16 v[160:163], a[160:163], v[52:55], v[160:163]
    s_waitcnt lgkmcnt(4)
    v_mfma_f32_16x16x32_bf16 v[132:135], a[164:167], v[48:51], v[132:135]
    v_exp_f32 v121, v121
    v_mfma_f32_16x16x32_bf16 v[164:167], a[164:167], v[52:55], v[164:167]
    s_waitcnt lgkmcnt(3)
    ds_read_b128 a[184:187], v20 offset:6144
    v_cvt_pk_bf16_f32 v60, v120, v121
    v_mfma_f32_16x16x32_bf16 v[136:139], a[168:171], v[48:51], v[136:139]
    s_waitcnt lgkmcnt(3)
    v_exp_f32 v122, v122
    v_mfma_f32_16x16x32_bf16 v[168:171], a[168:171], v[52:55], v[168:171]
    buffer_load_dwordx4 v15, s[8:11], s82 offen offset:0  lds
    v_mfma_f32_16x16x32_bf16 v[140:143], a[172:175], v[48:51], v[140:143]
    v_exp_f32 v123, v123
    v_mfma_f32_16x16x32_bf16 v[172:175], a[172:175], v[52:55], v[172:175]
    s_waitcnt lgkmcnt(2)
    ds_read_b128 a[188:191], v20 offset:7168
    v_cvt_pk_bf16_f32 v61, v122, v123
    v_mfma_f32_16x16x32_bf16 v[144:147], a[176:179], v[48:51], v[144:147]
    s_waitcnt lgkmcnt(2)
    v_exp_f32 v124, v124
    v_mfma_f32_16x16x32_bf16 v[176:179], a[176:179], v[52:55], v[176:179]
    buffer_load_dwordx4 v15, s[8:11], s82 offen offset:1024  lds
    v_mfma_f32_16x16x32_bf16 v[148:151], a[180:183], v[48:51], v[148:151]
    v_exp_f32 v125, v125
    v_mfma_f32_16x16x32_bf16 v[180:183], a[180:183], v[52:55], v[180:183]
    s_waitcnt lgkmcnt(1)
    v_cvt_pk_bf16_f32 v62, v124, v125
    v_mfma_f32_16x16x32_bf16 v[152:155], a[184:187], v[48:51], v[152:155]
    s_waitcnt lgkmcnt(0)
    v_exp_f32 v126, v126
    v_mfma_f32_16x16x32_bf16 v[184:187], a[184:187], v[52:55], v[184:187]
    buffer_load_dwordx4 v15, s[8:11], s82 offen offset:2048  lds
    v_mfma_f32_16x16x32_bf16 v[156:159], a[188:191], v[48:51], v[156:159]
    v_exp_f32 v127, v127
    v_mfma_f32_16x16x32_bf16 v[188:191], a[188:191], v[52:55], v[188:191]
    v_cvt_pk_bf16_f32 v63, v126, v127
    v_mfma_f32_16x16x32_bf16 v[112:115], a[128:131], a[224:227], v[72:75]
    v_mfma_f32_16x16x32_bf16 v[112:115], a[132:135], a[228:231], v[112:115]
    v_mfma_f32_16x16x32_bf16 v[112:115], a[136:139], a[232:235], v[112:115]
    v_exp_f32 v96, v96
    v_mfma_f32_16x16x32_bf16 v[112:115], a[140:143], a[236:239], v[112:115]
    buffer_load_dwordx4 v15, s[8:11], s82 offen offset:3072  lds
    v_mfma_f32_16x16x32_bf16 v[120:123], a[128:131], a[240:243], v[76:79]
    s_xor_b32 s15, s15, 196608
    v_exp_f32 v97, v97
    v_mfma_f32_16x16x32_bf16 v[120:123], a[132:135], a[244:247], v[120:123]
    s_add_u32 m0, s16, 0
    ds_read_b128 a[128:131], v18 offset:0
    v_cvt_pk_bf16_f32 v48, v96, v97
    v_mfma_f32_16x16x32_bf16 v[120:123], a[136:139], a[248:251], v[120:123]
    v_exp_f32 v98, v98
    v_mfma_f32_16x16x32_bf16 v[120:123], a[140:143], a[252:255], v[120:123]
    buffer_load_dwordx4 v1, s[8:11], s19 offen offset:0  lds
    v_mfma_f32_16x16x32_bf16 v[116:119], a[144:147], a[224:227], v[72:75]
    v_exp_f32 v99, v99
    v_mfma_f32_16x16x32_bf16 v[116:119], a[148:151], a[228:231], v[116:119]
    ds_read_b128 a[132:135], v18 offset:1024
    v_cvt_pk_bf16_f32 v49, v98, v99
    v_mfma_f32_16x16x32_bf16 v[116:119], a[152:155], a[232:235], v[116:119]
    v_exp_f32 v100, v100
    v_mfma_f32_16x16x32_bf16 v[116:119], a[156:159], a[236:239], v[116:119]
    buffer_load_dwordx4 v1, s[8:11], s19 offen offset:1024  lds
    v_mfma_f32_16x16x32_bf16 v[124:127], a[144:147], a[240:243], v[76:79]
    v_exp_f32 v101, v101
    v_mfma_f32_16x16x32_bf16 v[124:127], a[148:151], a[244:247], v[124:127]
    ds_read_b128 a[136:139], v18 offset:2048
    v_cvt_pk_bf16_f32 v50, v100, v101
    v_mfma_f32_16x16x32_bf16 v[124:127], a[152:155], a[248:251], v[124:127]
    v_exp_f32 v102, v102
    v_mfma_f32_16x16x32_bf16 v[124:127], a[156:159], a[252:255], v[124:127]
    buffer_load_dwordx4 v1, s[8:11], s19 offen offset:2048  lds
    v_mfma_f32_16x16x32_bf16 v[40:43], v[28:31], v[56:59], v[40:43]
    v_exp_f32 v103, v103
    v_mfma_f32_16x16x32_bf16 v[44:47], v[28:31], v[60:63], v[44:47]
    ds_read_b128 a[140:143], v18 offset:3072
    v_cvt_pk_bf16_f32 v51, v102, v103
    v_mfma_f32_16x16x32_bf16 v[192:195], a[160:163], v[56:59], v[192:195]
    v_exp_f32 v104, v104
    v_mfma_f32_16x16x32_bf16 v[224:227], a[160:163], v[60:63], v[224:227]
    v_mfma_f32_16x16x32_bf16 v[196:199], a[164:167], v[56:59], v[196:199]
    v_exp_f32 v105, v105
    v_mfma_f32_16x16x32_bf16 v[228:231], a[164:167], v[60:63], v[228:231]
    ds_read_b128 a[144:147], v18 offset:4096
    v_cvt_pk_bf16_f32 v52, v104, v105
    v_mfma_f32_16x16x32_bf16 v[200:203], a[168:171], v[56:59], v[200:203]
    v_exp_f32 v106, v106
    v_mfma_f32_16x16x32_bf16 v[232:235], a[168:171], v[60:63], v[232:235]
    buffer_load_dwordx4 v1, s[8:11], s19 offen offset:3072  lds
    v_mfma_f32_16x16x32_bf16 v[204:207], a[172:175], v[56:59], v[204:207]
    s_add_u32 m0, s16, 4096
    v_exp_f32 v107, v107
    v_mfma_f32_16x16x32_bf16 v[236:239], a[172:175], v[60:63], v[236:239]
    ds_read_b128 a[148:151], v18 offset:5120
    v_cvt_pk_bf16_f32 v53, v106, v107
    v_mfma_f32_16x16x32_bf16 v[208:211], a[176:179], v[56:59], v[208:211]
    v_exp_f32 v108, v108
    v_mfma_f32_16x16x32_bf16 v[240:243], a[176:179], v[60:63], v[240:243]
    buffer_load_dwordx4 v15, s[8:11], s19 offen offset:0  lds
    v_mfma_f32_16x16x32_bf16 v[212:215], a[180:183], v[56:59], v[212:215]
    v_exp_f32 v109, v109
    v_mfma_f32_16x16x32_bf16 v[244:247], a[180:183], v[60:63], v[244:247]
    ds_read_b128 a[152:155], v18 offset:6144
    v_cvt_pk_bf16_f32 v54, v108, v109
    v_mfma_f32_16x16x32_bf16 v[216:219], a[184:187], v[56:59], v[216:219]
    v_exp_f32 v110, v110
    v_mfma_f32_16x16x32_bf16 v[248:251], a[184:187], v[60:63], v[248:251]
    buffer_load_dwordx4 v15, s[8:11], s19 offen offset:1024  lds
    v_mfma_f32_16x16x32_bf16 v[220:223], a[188:191], v[56:59], v[220:223]
    v_exp_f32 v111, v111
    v_mfma_f32_16x16x32_bf16 v[252:255], a[188:191], v[60:63], v[252:255]
    ds_read_b128 a[156:159], v18 offset:7168
    v_cvt_pk_bf16_f32 v55, v110, v111
    s_waitcnt lgkmcnt(7)
    v_mfma_f32_16x16x32_bf16 v[96:99], a[128:131], a[192:195], v[64:67]
    s_waitcnt lgkmcnt(6)
    ds_read_b128 a[160:163], v19 offset:16384
    v_mfma_f32_16x16x32_bf16 v[96:99], a[132:135], a[196:199], v[96:99]
    s_waitcnt lgkmcnt(6)
    ds_read_b128 a[164:167], v19 offset:17408
    v_mfma_f32_16x16x32_bf16 v[96:99], a[136:139], a[200:203], v[96:99]
    s_waitcnt lgkmcnt(6)
    v_exp_f32 v112, v112
    v_mfma_f32_16x16x32_bf16 v[96:99], a[140:143], a[204:207], v[96:99]
    buffer_load_dwordx4 v15, s[8:11], s19 offen offset:2048  lds
    v_mfma_f32_16x16x32_bf16 v[104:107], a[128:131], a[208:211], v[68:71]
    v_exp_f32 v113, v113
    v_mfma_f32_16x16x32_bf16 v[104:107], a[132:135], a[212:215], v[104:107]
    ds_read_b128 a[168:171], v19 offset:18432
    v_cvt_pk_bf16_f32 v56, v112, v113
    v_mfma_f32_16x16x32_bf16 v[104:107], a[136:139], a[216:219], v[104:107]
    s_waitcnt lgkmcnt(6)
    v_exp_f32 v114, v114
    v_mfma_f32_16x16x32_bf16 v[104:107], a[140:143], a[220:223], v[104:107]
    buffer_load_dwordx4 v15, s[8:11], s19 offen offset:3072  lds
    v_mfma_f32_16x16x32_bf16 v[100:103], a[144:147], a[192:195], v[64:67]
    s_waitcnt lgkmcnt(5)
    s_xor_b32 s16, s16, 98304
    v_exp_f32 v115, v115
    v_mfma_f32_16x16x32_bf16 v[100:103], a[148:151], a[196:199], v[100:103]
    s_waitcnt lgkmcnt(4)
    s_xor_b32 s74, s24, 16384
    ds_read_b128 a[172:175], v19 offset:19456
    v_cvt_pk_bf16_f32 v57, v114, v115
    v_mfma_f32_16x16x32_bf16 v[100:103], a[152:155], a[200:203], v[100:103]
    s_waitcnt lgkmcnt(4)
    v_exp_f32 v116, v116
    v_mfma_f32_16x16x32_bf16 v[100:103], a[156:159], a[204:207], v[100:103]
    buffer_load_dwordx4 a[0:3], v1, s[8:11], s74 offen offset:0
    v_mfma_f32_16x16x32_bf16 v[108:111], a[144:147], a[208:211], v[68:71]
    s_xor_b32 s74, s24, 16384
    v_exp_f32 v117, v117
    v_mfma_f32_16x16x32_bf16 v[108:111], a[148:151], a[212:215], v[108:111]
    ds_read_b128 a[176:179], v20 offset:20480
    v_cvt_pk_bf16_f32 v58, v116, v117
    v_mfma_f32_16x16x32_bf16 v[108:111], a[152:155], a[216:219], v[108:111]
    v_exp_f32 v118, v118
    v_mfma_f32_16x16x32_bf16 v[108:111], a[156:159], a[220:223], v[108:111]
    buffer_load_dwordx4 a[4:7], v1, s[8:11], s74 offen offset:1024
    v_mfma_f32_16x16x32_bf16 v[32:35], v[28:31], v[48:51], v[32:35]
    s_xor_b32 s74, s24, 16384
    v_exp_f32 v119, v119
    v_mfma_f32_16x16x32_bf16 v[36:39], v[28:31], v[52:55], v[36:39]
    s_waitcnt lgkmcnt(4)
    ds_read_b128 a[180:183], v20 offset:21504
    v_cvt_pk_bf16_f32 v59, v118, v119
    v_mfma_f32_16x16x32_bf16 v[128:131], a[160:163], v[48:51], v[128:131]
    s_waitcnt lgkmcnt(4)
    v_exp_f32 v120, v120
    v_mfma_f32_16x16x32_bf16 v[160:163], a[160:163], v[52:55], v[160:163]
    buffer_load_dwordx4 a[8:11], v1, s[8:11], s74 offen offset:2048
    v_mfma_f32_16x16x32_bf16 v[132:135], a[164:167], v[48:51], v[132:135]
    s_xor_b32 s74, s24, 16384
    v_exp_f32 v121, v121
    v_mfma_f32_16x16x32_bf16 v[164:167], a[164:167], v[52:55], v[164:167]
    s_waitcnt lgkmcnt(3)
    ds_read_b128 a[184:187], v20 offset:22528
    v_cvt_pk_bf16_f32 v60, v120, v121
    v_mfma_f32_16x16x32_bf16 v[136:139], a[168:171], v[48:51], v[136:139]
    s_waitcnt lgkmcnt(3)
    v_exp_f32 v122, v122
    v_mfma_f32_16x16x32_bf16 v[168:171], a[168:171], v[52:55], v[168:171]
    buffer_load_dwordx4 a[12:15], v1, s[8:11], s74 offen offset:3072
    v_mfma_f32_16x16x32_bf16 v[140:143], a[172:175], v[48:51], v[140:143]
    s_xor_b32 s74, s24, 20480
    v_exp_f32 v123, v123
    v_mfma_f32_16x16x32_bf16 v[172:175], a[172:175], v[52:55], v[172:175]
    s_waitcnt lgkmcnt(2)
    ds_read_b128 a[188:191], v20 offset:23552
    v_cvt_pk_bf16_f32 v61, v122, v123
    v_mfma_f32_16x16x32_bf16 v[144:147], a[176:179], v[48:51], v[144:147]
    s_waitcnt lgkmcnt(2)
    v_exp_f32 v124, v124
    v_mfma_f32_16x16x32_bf16 v[176:179], a[176:179], v[52:55], v[176:179]
    buffer_load_dwordx4 a[16:19], v1, s[8:11], s74 offen offset:0
    v_mfma_f32_16x16x32_bf16 v[148:151], a[180:183], v[48:51], v[148:151]
    s_xor_b32 s74, s24, 20480
    v_exp_f32 v125, v125
    v_mfma_f32_16x16x32_bf16 v[180:183], a[180:183], v[52:55], v[180:183]
    s_waitcnt lgkmcnt(1)
    v_cvt_pk_bf16_f32 v62, v124, v125
    v_xor_b32 v19, 98304, v19
    v_mfma_f32_16x16x32_bf16 v[152:155], a[184:187], v[48:51], v[152:155]
    buffer_load_dwordx4 a[20:23], v1, s[8:11], s74 offen offset:1024
    v_exp_f32 v126, v126
    v_mfma_f32_16x16x32_bf16 v[184:187], a[184:187], v[52:55], v[184:187]
    s_waitcnt lgkmcnt(0)
    v_xor_b32 v20, 98304, v20
    v_mfma_f32_16x16x32_bf16 v[156:159], a[188:191], v[48:51], v[156:159]
    v_exp_f32 v127, v127
    v_mfma_f32_16x16x32_bf16 v[188:191], a[188:191], v[52:55], v[188:191]
    v_cvt_pk_bf16_f32 v63, v126, v127
    v_mfma_f32_16x16x32_bf16 v[112:115], a[128:131], a[224:227], v[72:75]
    s_xor_b32 s74, s24, 20480
    v_exp_f32 v96, v96
    v_mfma_f32_16x16x32_bf16 v[112:115], a[132:135], a[228:231], v[112:115]
    buffer_load_dwordx4 a[24:27], v1, s[8:11], s74 offen offset:2048
    v_mfma_f32_16x16x32_bf16 v[112:115], a[136:139], a[232:235], v[112:115]
    s_xor_b32 s74, s24, 20480
    v_exp_f32 v97, v97
    v_mfma_f32_16x16x32_bf16 v[112:115], a[140:143], a[236:239], v[112:115]
    v_cvt_pk_bf16_f32 v48, v96, v97
    v_add_f32 v89, 0x73700000, v21
    v_mfma_f32_16x16x32_bf16 v[120:123], a[128:131], a[240:243], v[76:79]
    v_exp_f32 v98, v98
    v_mfma_f32_16x16x32_bf16 v[120:123], a[132:135], a[244:247], v[120:123]
    buffer_load_dwordx4 a[28:31], v1, s[8:11], s74 offen offset:3072
    v_mfma_f32_16x16x32_bf16 v[120:123], a[136:139], a[248:251], v[120:123]
    s_xor_b32 s74, s24, 24576
    v_exp_f32 v99, v99
    v_mfma_f32_16x16x32_bf16 v[120:123], a[140:143], a[252:255], v[120:123]
    buffer_load_dwordx4 a[32:35], v1, s[8:11], s74 offen offset:0
    v_mfma_f32_16x16x32_bf16 v[116:119], a[144:147], a[224:227], v[72:75]
    s_xor_b32 s74, s24, 24576
    v_exp_f32 v100, v100
    v_mfma_f32_16x16x32_bf16 v[116:119], a[148:151], a[228:231], v[116:119]
    ds_read_b128 a[128:131], v18 offset:16384
    v_cvt_pk_bf16_f32 v49, v98, v99
    v_mfma_f32_16x16x32_bf16 v[116:119], a[152:155], a[232:235], v[116:119]
    s_add_u32 s19, s82, 32768
    v_exp_f32 v101, v101
    v_mfma_f32_16x16x32_bf16 v[116:119], a[156:159], a[236:239], v[116:119]
    s_sub_u32 s82, s12, s13
    ds_read_b128 a[132:135], v18 offset:17408
    v_cvt_pk_bf16_f32 v50, v100, v101
    v_mfma_f32_16x16x32_bf16 v[124:127], a[144:147], a[240:243], v[76:79]
    s_sub_u32 s82, s82, 1
    v_exp_f32 v102, v102
    v_mfma_f32_16x16x32_bf16 v[124:127], a[148:151], a[244:247], v[124:127]
    s_cmp_gt_u32 s12, s13
    s_cselect_b32 s82, s82, s12
    s_lshl_b32 s82, s82, 16
    ds_read_b128 a[136:139], v18 offset:18432
    v_mfma_f32_16x16x32_bf16 v[124:127], a[152:155], a[248:251], v[124:127]
    s_add_u32 s82, s82, s81
    v_exp_f32 v103, v103
    v_mfma_f32_16x16x32_bf16 v[124:127], a[156:159], a[252:255], v[124:127]
    s_cmp_ge_u32 s12, 17
    s_cselect_b32 s82, 2147471360, s82
    ds_read_b128 a[140:143], v18 offset:19456
    v_cvt_pk_bf16_f32 v51, v102, v103
    v_mfma_f32_16x16x32_bf16 v[40:43], v[28:31], v[56:59], v[40:43]
    s_add_u32 s12, s12, 1
    v_exp_f32 v104, v104
    v_mfma_f32_16x16x32_bf16 v[44:47], v[28:31], v[60:63], v[44:47]
    ds_read_b128 a[144:147], v18 offset:20480
    v_min_f32 v89, v89, v69
    v_mfma_f32_16x16x32_bf16 v[192:195], a[160:163], v[56:59], v[192:195]
    v_exp_f32 v105, v105
    v_mfma_f32_16x16x32_bf16 v[224:227], a[160:163], v[60:63], v[224:227]
    ds_read_b128 a[148:151], v18 offset:21504
    v_cvt_pk_bf16_f32 v52, v104, v105
    v_mfma_f32_16x16x32_bf16 v[196:199], a[164:167], v[56:59], v[196:199]
    v_exp_f32 v106, v106
    v_mfma_f32_16x16x32_bf16 v[228:231], a[164:167], v[60:63], v[228:231]
    ds_read_b128 a[152:155], v18 offset:22528
    v_add_f32 v90, 0x73600000, v21
    v_mfma_f32_16x16x32_bf16 v[200:203], a[168:171], v[56:59], v[200:203]
    v_exp_f32 v107, v107
    v_mfma_f32_16x16x32_bf16 v[232:235], a[168:171], v[60:63], v[232:235]
    ds_read_b128 a[156:159], v18 offset:23552
    v_cvt_pk_bf16_f32 v53, v106, v107
    v_mfma_f32_16x16x32_bf16 v[204:207], a[172:175], v[56:59], v[204:207]
    v_exp_f32 v108, v108
    v_mfma_f32_16x16x32_bf16 v[236:239], a[172:175], v[60:63], v[236:239]
    buffer_load_dwordx4 a[36:39], v1, s[8:11], s74 offen offset:1024
    v_mfma_f32_16x16x32_bf16 v[208:211], a[176:179], v[56:59], v[208:211]
    s_xor_b32 s74, s24, 24576
    v_exp_f32 v109, v109
    v_mfma_f32_16x16x32_bf16 v[240:243], a[176:179], v[60:63], v[240:243]
    v_cvt_pk_bf16_f32 v54, v108, v109
    v_xor_b32 v18, 196608, v18
    v_mfma_f32_16x16x32_bf16 v[212:215], a[180:183], v[56:59], v[212:215]
    v_exp_f32 v110, v110
    v_mfma_f32_16x16x32_bf16 v[244:247], a[180:183], v[60:63], v[244:247]
    buffer_load_dwordx4 a[40:43], v1, s[8:11], s74 offen offset:2048
    v_mfma_f32_16x16x32_bf16 v[216:219], a[184:187], v[56:59], v[216:219]
    s_xor_b32 s74, s24, 24576
    v_exp_f32 v111, v111
    v_mfma_f32_16x16x32_bf16 v[248:251], a[184:187], v[60:63], v[248:251]
    v_cvt_pk_bf16_f32 v55, v110, v111
    v_min_f32 v90, v90, v70
    v_mfma_f32_16x16x32_bf16 v[220:223], a[188:191], v[56:59], v[220:223]
    buffer_load_dwordx4 a[44:47], v1, s[8:11], s74 offen offset:3072
    v_mfma_f32_16x16x32_bf16 v[252:255], a[188:191], v[60:63], v[252:255]
    v_add_f32 v91, 0x73500000, v21
    v_min_f32 v91, v91, v71
    v_add_f32 v92, 0, v21
    v_min_f32 v92, v92, v68
    s_waitcnt vmcnt(12) lgkmcnt(0)
    s_barrier
    v_mfma_f32_16x16x32_bf16 v[96:99], a[128:131], a[192:195], v[64:67]
    s_add_u32 m0, s15, 0
    ds_read_b128 a[160:163], v19 offset:0
    v_mfma_f32_16x16x32_bf16 v[96:99], a[132:135], a[196:199], v[96:99]
    ds_read_b128 a[164:167], v19 offset:1024
    v_mfma_f32_16x16x32_bf16 v[96:99], a[136:139], a[200:203], v[96:99]
    v_exp_f32 v112, v112
    v_mfma_f32_16x16x32_bf16 v[96:99], a[140:143], a[204:207], v[96:99]
    buffer_load_dwordx4 v1, s[8:11], s82 offen offset:0  lds
    v_mfma_f32_16x16x32_bf16 v[104:107], a[128:131], a[208:211], v[68:71]
    v_exp_f32 v113, v113
    v_mfma_f32_16x16x32_bf16 v[104:107], a[132:135], a[212:215], v[104:107]
    ds_read_b128 a[168:171], v19 offset:2048
    v_cvt_pk_bf16_f32 v56, v112, v113
    v_mfma_f32_16x16x32_bf16 v[104:107], a[136:139], a[216:219], v[104:107]
    v_exp_f32 v114, v114
    v_mfma_f32_16x16x32_bf16 v[104:107], a[140:143], a[220:223], v[104:107]
    buffer_load_dwordx4 v1, s[8:11], s82 offen offset:1024  lds
    v_mfma_f32_16x16x32_bf16 v[100:103], a[144:147], a[192:195], v[64:67]
    v_exp_f32 v115, v115
    v_mfma_f32_16x16x32_bf16 v[100:103], a[148:151], a[196:199], v[100:103]
    ds_read_b128 a[172:175], v19 offset:3072
    v_cvt_pk_bf16_f32 v57, v114, v115
    v_mfma_f32_16x16x32_bf16 v[100:103], a[152:155], a[200:203], v[100:103]
    v_exp_f32 v116, v116
    v_mfma_f32_16x16x32_bf16 v[100:103], a[156:159], a[204:207], v[100:103]
    buffer_load_dwordx4 v1, s[8:11], s82 offen offset:2048  lds
    v_mfma_f32_16x16x32_bf16 v[108:111], a[144:147], a[208:211], v[68:71]
    v_exp_f32 v117, v117
    v_mfma_f32_16x16x32_bf16 v[108:111], a[148:151], a[212:215], v[108:111]
    ds_read_b128 a[176:179], v20 offset:4096
    v_cvt_pk_bf16_f32 v58, v116, v117
    v_mfma_f32_16x16x32_bf16 v[108:111], a[152:155], a[216:219], v[108:111]
    v_exp_f32 v118, v118
    v_mfma_f32_16x16x32_bf16 v[108:111], a[156:159], a[220:223], v[108:111]
    buffer_load_dwordx4 v1, s[8:11], s82 offen offset:3072  lds
    v_mfma_f32_16x16x32_bf16 v[32:35], v[28:31], v[48:51], v[32:35]
    s_add_u32 m0, s15, 4096
    v_exp_f32 v119, v119
    v_mfma_f32_16x16x32_bf16 v[36:39], v[28:31], v[52:55], v[36:39]
    s_waitcnt lgkmcnt(4)
    ds_read_b128 a[180:183], v20 offset:5120
    v_cvt_pk_bf16_f32 v59, v118, v119
    v_mfma_f32_16x16x32_bf16 v[128:131], a[160:163], v[48:51], v[128:131]
    v_exp_f32 v120, v120
    v_mfma_f32_16x16x32_bf16 v[160:163], a[160:163], v[52:55], v[160:163]
    s_waitcnt lgkmcnt(4)
    v_mfma_f32_16x16x32_bf16 v[132:135], a[164:167], v[48:51], v[132:135]
    v_exp_f32 v121, v121
    v_mfma_f32_16x16x32_bf16 v[164:167], a[164:167], v[52:55], v[164:167]
    s_waitcnt lgkmcnt(3)
    ds_read_b128 a[184:187], v20 offset:6144
    v_cvt_pk_bf16_f32 v60, v120, v121
    v_mfma_f32_16x16x32_bf16 v[136:139], a[168:171], v[48:51], v[136:139]
    s_waitcnt lgkmcnt(3)
    v_exp_f32 v122, v122
    v_mfma_f32_16x16x32_bf16 v[168:171], a[168:171], v[52:55], v[168:171]
    buffer_load_dwordx4 v15, s[8:11], s82 offen offset:0  lds
    v_mfma_f32_16x16x32_bf16 v[140:143], a[172:175], v[48:51], v[140:143]
    v_exp_f32 v123, v123
    v_mfma_f32_16x16x32_bf16 v[172:175], a[172:175], v[52:55], v[172:175]
    s_waitcnt lgkmcnt(2)
    ds_read_b128 a[188:191], v20 offset:7168
    v_cvt_pk_bf16_f32 v61, v122, v123
    v_mfma_f32_16x16x32_bf16 v[144:147], a[176:179], v[48:51], v[144:147]
    s_waitcnt lgkmcnt(2)
    v_exp_f32 v124, v124
    v_mfma_f32_16x16x32_bf16 v[176:179], a[176:179], v[52:55], v[176:179]
    buffer_load_dwordx4 v15, s[8:11], s82 offen offset:1024  lds
    v_mfma_f32_16x16x32_bf16 v[148:151], a[180:183], v[48:51], v[148:151]
    v_exp_f32 v125, v125
    v_mfma_f32_16x16x32_bf16 v[180:183], a[180:183], v[52:55], v[180:183]
    s_waitcnt lgkmcnt(1)
    v_cvt_pk_bf16_f32 v62, v124, v125
    v_mfma_f32_16x16x32_bf16 v[152:155], a[184:187], v[48:51], v[152:155]
    s_waitcnt lgkmcnt(0)
    v_exp_f32 v126, v126
    v_mfma_f32_16x16x32_bf16 v[184:187], a[184:187], v[52:55], v[184:187]
    buffer_load_dwordx4 v15, s[8:11], s82 offen offset:2048  lds
    v_mfma_f32_16x16x32_bf16 v[156:159], a[188:191], v[48:51], v[156:159]
    v_exp_f32 v127, v127
    v_mfma_f32_16x16x32_bf16 v[188:191], a[188:191], v[52:55], v[188:191]
    v_cvt_pk_bf16_f32 v63, v126, v127
    v_mfma_f32_16x16x32_bf16 v[112:115], a[128:131], a[224:227], v[72:75]
    v_mfma_f32_16x16x32_bf16 v[112:115], a[132:135], a[228:231], v[112:115]
    v_mfma_f32_16x16x32_bf16 v[112:115], a[136:139], a[232:235], v[112:115]
    v_exp_f32 v96, v96
    v_mfma_f32_16x16x32_bf16 v[112:115], a[140:143], a[236:239], v[112:115]
    buffer_load_dwordx4 v15, s[8:11], s82 offen offset:3072  lds
    v_mfma_f32_16x16x32_bf16 v[120:123], a[128:131], a[240:243], v[76:79]
    s_xor_b32 s15, s15, 196608
    v_exp_f32 v97, v97
    v_mfma_f32_16x16x32_bf16 v[120:123], a[132:135], a[244:247], v[120:123]
    s_add_u32 m0, s16, 0
    ds_read_b128 a[128:131], v18 offset:0
    v_cvt_pk_bf16_f32 v48, v96, v97
    v_mfma_f32_16x16x32_bf16 v[120:123], a[136:139], a[248:251], v[120:123]
    v_exp_f32 v98, v98
    v_mfma_f32_16x16x32_bf16 v[120:123], a[140:143], a[252:255], v[120:123]
    buffer_load_dwordx4 v1, s[8:11], s19 offen offset:0  lds
    v_mfma_f32_16x16x32_bf16 v[116:119], a[144:147], a[224:227], v[72:75]
    v_exp_f32 v99, v99
    v_mfma_f32_16x16x32_bf16 v[116:119], a[148:151], a[228:231], v[116:119]
    ds_read_b128 a[132:135], v18 offset:1024
    v_cvt_pk_bf16_f32 v49, v98, v99
    v_mfma_f32_16x16x32_bf16 v[116:119], a[152:155], a[232:235], v[116:119]
    v_exp_f32 v100, v100
    v_mfma_f32_16x16x32_bf16 v[116:119], a[156:159], a[236:239], v[116:119]
    buffer_load_dwordx4 v1, s[8:11], s19 offen offset:1024  lds
    v_mfma_f32_16x16x32_bf16 v[124:127], a[144:147], a[240:243], v[76:79]
    v_exp_f32 v101, v101
    v_mfma_f32_16x16x32_bf16 v[124:127], a[148:151], a[244:247], v[124:127]
    ds_read_b128 a[136:139], v18 offset:2048
    v_cvt_pk_bf16_f32 v50, v100, v101
    v_mfma_f32_16x16x32_bf16 v[124:127], a[152:155], a[248:251], v[124:127]
    v_exp_f32 v102, v102
    v_mfma_f32_16x16x32_bf16 v[124:127], a[156:159], a[252:255], v[124:127]
    buffer_load_dwordx4 v1, s[8:11], s19 offen offset:2048  lds
    v_mfma_f32_16x16x32_bf16 v[40:43], v[28:31], v[56:59], v[40:43]
    v_exp_f32 v103, v103
    v_mfma_f32_16x16x32_bf16 v[44:47], v[28:31], v[60:63], v[44:47]
    ds_read_b128 a[140:143], v18 offset:3072
    v_cvt_pk_bf16_f32 v51, v102, v103
    v_mfma_f32_16x16x32_bf16 v[192:195], a[160:163], v[56:59], v[192:195]
    v_exp_f32 v104, v104
    v_mfma_f32_16x16x32_bf16 v[224:227], a[160:163], v[60:63], v[224:227]
    v_mfma_f32_16x16x32_bf16 v[196:199], a[164:167], v[56:59], v[196:199]
    v_exp_f32 v105, v105
    v_mfma_f32_16x16x32_bf16 v[228:231], a[164:167], v[60:63], v[228:231]
    ds_read_b128 a[144:147], v18 offset:4096
    v_cvt_pk_bf16_f32 v52, v104, v105
    v_mfma_f32_16x16x32_bf16 v[200:203], a[168:171], v[56:59], v[200:203]
    v_exp_f32 v106, v106
    v_mfma_f32_16x16x32_bf16 v[232:235], a[168:171], v[60:63], v[232:235]
    buffer_load_dwordx4 v1, s[8:11], s19 offen offset:3072  lds
    v_mfma_f32_16x16x32_bf16 v[204:207], a[172:175], v[56:59], v[204:207]
    s_add_u32 m0, s16, 4096
    v_exp_f32 v107, v107
    v_mfma_f32_16x16x32_bf16 v[236:239], a[172:175], v[60:63], v[236:239]
    ds_read_b128 a[148:151], v18 offset:5120
    v_cvt_pk_bf16_f32 v53, v106, v107
    v_mfma_f32_16x16x32_bf16 v[208:211], a[176:179], v[56:59], v[208:211]
    v_exp_f32 v108, v108
    v_mfma_f32_16x16x32_bf16 v[240:243], a[176:179], v[60:63], v[240:243]
    buffer_load_dwordx4 v15, s[8:11], s19 offen offset:0  lds
    v_mfma_f32_16x16x32_bf16 v[212:215], a[180:183], v[56:59], v[212:215]
    v_exp_f32 v109, v109
    v_mfma_f32_16x16x32_bf16 v[244:247], a[180:183], v[60:63], v[244:247]
    ds_read_b128 a[152:155], v18 offset:6144
    v_cvt_pk_bf16_f32 v54, v108, v109
    v_mfma_f32_16x16x32_bf16 v[216:219], a[184:187], v[56:59], v[216:219]
    v_exp_f32 v110, v110
    v_mfma_f32_16x16x32_bf16 v[248:251], a[184:187], v[60:63], v[248:251]
    buffer_load_dwordx4 v15, s[8:11], s19 offen offset:1024  lds
    v_mfma_f32_16x16x32_bf16 v[220:223], a[188:191], v[56:59], v[220:223]
    v_exp_f32 v111, v111
    v_mfma_f32_16x16x32_bf16 v[252:255], a[188:191], v[60:63], v[252:255]
    ds_read_b128 a[156:159], v18 offset:7168
    v_cvt_pk_bf16_f32 v55, v110, v111
    s_waitcnt lgkmcnt(7)
    v_mfma_f32_16x16x32_bf16 v[96:99], a[128:131], a[192:195], v[64:67]
    s_waitcnt lgkmcnt(6)
    ds_read_b128 a[160:163], v19 offset:16384
    v_add_f32 v93, 0xf1800000, v21
    v_mfma_f32_16x16x32_bf16 v[96:99], a[132:135], a[196:199], v[96:99]
    s_waitcnt lgkmcnt(6)
    ds_read_b128 a[164:167], v19 offset:17408
    v_min_f32 v93, v93, v69
    v_mfma_f32_16x16x32_bf16 v[96:99], a[136:139], a[200:203], v[96:99]
    s_waitcnt lgkmcnt(6)
    v_exp_f32 v112, v112
    v_mfma_f32_16x16x32_bf16 v[96:99], a[140:143], a[204:207], v[96:99]
    buffer_load_dwordx4 v15, s[8:11], s19 offen offset:2048  lds
    v_mfma_f32_16x16x32_bf16 v[104:107], a[128:131], a[208:211], v[68:71]
    v_exp_f32 v113, v113
    v_mfma_f32_16x16x32_bf16 v[104:107], a[132:135], a[212:215], v[104:107]
    ds_read_b128 a[168:171], v19 offset:18432
    v_cvt_pk_bf16_f32 v56, v112, v113
    v_mfma_f32_16x16x32_bf16 v[104:107], a[136:139], a[216:219], v[104:107]
    s_waitcnt lgkmcnt(6)
    v_exp_f32 v114, v114
    v_mfma_f32_16x16x32_bf16 v[104:107], a[140:143], a[220:223], v[104:107]
    buffer_load_dwordx4 v15, s[8:11], s19 offen offset:3072  lds
    v_mfma_f32_16x16x32_bf16 v[100:103], a[144:147], a[192:195], v[64:67]
    s_waitcnt lgkmcnt(5)
    s_xor_b32 s16, s16, 98304
    v_exp_f32 v115, v115
    v_mfma_f32_16x16x32_bf16 v[100:103], a[148:151], a[196:199], v[100:103]
    s_waitcnt lgkmcnt(4)
    s_xor_b32 s74, s24, 28672
    ds_read_b128 a[172:175], v19 offset:19456
    v_cvt_pk_bf16_f32 v57, v114, v115
    v_mfma_f32_16x16x32_bf16 v[100:103], a[152:155], a[200:203], v[100:103]
    s_waitcnt lgkmcnt(4)
    v_exp_f32 v116, v116
    v_mfma_f32_16x16x32_bf16 v[100:103], a[156:159], a[204:207], v[100:103]
    buffer_load_dwordx4 a[48:51], v1, s[8:11], s74 offen offset:0
    v_mfma_f32_16x16x32_bf16 v[108:111], a[144:147], a[208:211], v[68:71]
    s_xor_b32 s74, s24, 28672
    v_exp_f32 v117, v117
    v_mfma_f32_16x16x32_bf16 v[108:111], a[148:151], a[212:215], v[108:111]
    ds_read_b128 a[176:179], v20 offset:20480
    v_cvt_pk_bf16_f32 v58, v116, v117
    v_mfma_f32_16x16x32_bf16 v[108:111], a[152:155], a[216:219], v[108:111]
    v_exp_f32 v118, v118
    v_mfma_f32_16x16x32_bf16 v[108:111], a[156:159], a[220:223], v[108:111]
    buffer_load_dwordx4 a[52:55], v1, s[8:11], s74 offen offset:1024
    v_mfma_f32_16x16x32_bf16 v[32:35], v[28:31], v[48:51], v[32:35]
    s_xor_b32 s74, s24, 28672
    v_exp_f32 v119, v119
    v_mfma_f32_16x16x32_bf16 v[36:39], v[28:31], v[52:55], v[36:39]
    s_waitcnt lgkmcnt(4)
    ds_read_b128 a[180:183], v20 offset:21504
    v_cvt_pk_bf16_f32 v59, v118, v119
    v_mfma_f32_16x16x32_bf16 v[128:131], a[160:163], v[48:51], v[128:131]
    s_waitcnt lgkmcnt(4)
    v_exp_f32 v120, v120
    v_mfma_f32_16x16x32_bf16 v[160:163], a[160:163], v[52:55], v[160:163]
    buffer_load_dwordx4 a[56:59], v1, s[8:11], s74 offen offset:2048
    v_mfma_f32_16x16x32_bf16 v[132:135], a[164:167], v[48:51], v[132:135]
    s_xor_b32 s74, s24, 28672
    v_exp_f32 v121, v121
    v_mfma_f32_16x16x32_bf16 v[164:167], a[164:167], v[52:55], v[164:167]
    s_waitcnt lgkmcnt(3)
    ds_read_b128 a[184:187], v20 offset:22528
    v_cvt_pk_bf16_f32 v60, v120, v121
    v_mfma_f32_16x16x32_bf16 v[136:139], a[168:171], v[48:51], v[136:139]
    s_waitcnt lgkmcnt(3)
    v_exp_f32 v122, v122
    v_mfma_f32_16x16x32_bf16 v[168:171], a[168:171], v[52:55], v[168:171]
    buffer_load_dwordx4 a[60:63], v1, s[8:11], s74 offen offset:3072
    v_mfma_f32_16x16x32_bf16 v[140:143], a[172:175], v[48:51], v[140:143]
    v_exp_f32 v123, v123
    v_mfma_f32_16x16x32_bf16 v[172:175], a[172:175], v[52:55], v[172:175]
    s_waitcnt lgkmcnt(2)
    ds_read_b128 a[188:191], v20 offset:23552
    v_cvt_pk_bf16_f32 v61, v122, v123
    v_mfma_f32_16x16x32_bf16 v[144:147], a[176:179], v[48:51], v[144:147]
    v_exp_f32 v124, v124
    v_mfma_f32_16x16x32_bf16 v[176:179], a[176:179], v[52:55], v[176:179]
    s_waitcnt lgkmcnt(2)
    v_add_f32 v94, 0xf2000000, v21
    v_min_f32 v94, v94, v70
    v_mfma_f32_16x16x32_bf16 v[148:151], a[180:183], v[48:51], v[148:151]
    v_exp_f32 v125, v125
    v_mfma_f32_16x16x32_bf16 v[180:183], a[180:183], v[52:55], v[180:183]
    s_waitcnt lgkmcnt(1)
    v_cvt_pk_bf16_f32 v62, v124, v125
    v_xor_b32 v19, 98304, v19
    v_mfma_f32_16x16x32_bf16 v[152:155], a[184:187], v[48:51], v[152:155]
    v_exp_f32 v126, v126
    v_mfma_f32_16x16x32_bf16 v[184:187], a[184:187], v[52:55], v[184:187]
    s_waitcnt lgkmcnt(0)
    v_xor_b32 v20, 98304, v20
    v_add_f32 v95, 0xf2400000, v21
    v_mfma_f32_16x16x32_bf16 v[156:159], a[188:191], v[48:51], v[156:159]
    v_exp_f32 v127, v127
    v_mfma_f32_16x16x32_bf16 v[188:191], a[188:191], v[52:55], v[188:191]
    v_cvt_pk_bf16_f32 v63, v126, v127
    v_min_f32 v95, v95, v71
    v_mfma_f32_16x16x32_bf16 v[112:115], a[128:131], a[224:227], v[72:75]
    v_exp_f32 v96, v96
    v_mfma_f32_16x16x32_bf16 v[112:115], a[132:135], a[228:231], v[112:115]
    v_mfma_f32_16x16x32_bf16 v[112:115], a[136:139], a[232:235], v[112:115]
    v_exp_f32 v97, v97
    v_mfma_f32_16x16x32_bf16 v[112:115], a[140:143], a[236:239], v[112:115]
    v_cvt_pk_bf16_f32 v48, v96, v97
    v_mfma_f32_16x16x32_bf16 v[120:123], a[128:131], a[240:243], v[76:79]
    v_exp_f32 v98, v98
    v_mfma_f32_16x16x32_bf16 v[120:123], a[132:135], a[244:247], v[120:123]
    v_mfma_f32_16x16x32_bf16 v[120:123], a[136:139], a[248:251], v[120:123]
    v_exp_f32 v99, v99
    v_mfma_f32_16x16x32_bf16 v[120:123], a[140:143], a[252:255], v[120:123]
    v_mfma_f32_16x16x32_bf16 v[116:119], a[144:147], a[224:227], v[72:75]
    v_exp_f32 v100, v100
    v_mfma_f32_16x16x32_bf16 v[116:119], a[148:151], a[228:231], v[116:119]
    ds_read_b128 a[128:131], v18 offset:16384
    v_cvt_pk_bf16_f32 v49, v98, v99
    v_mfma_f32_16x16x32_bf16 v[116:119], a[152:155], a[232:235], v[116:119]
    s_add_u32 s19, s82, 32768
    v_exp_f32 v101, v101
    v_mfma_f32_16x16x32_bf16 v[116:119], a[156:159], a[236:239], v[116:119]
    s_sub_u32 s82, s12, s13
    ds_read_b128 a[132:135], v18 offset:17408
    v_cvt_pk_bf16_f32 v50, v100, v101
    v_mfma_f32_16x16x32_bf16 v[124:127], a[144:147], a[240:243], v[76:79]
    s_sub_u32 s82, s82, 1
    v_exp_f32 v102, v102
    v_mfma_f32_16x16x32_bf16 v[124:127], a[148:151], a[244:247], v[124:127]
    s_cmp_gt_u32 s12, s13
    s_cselect_b32 s82, s82, s12
    s_lshl_b32 s82, s82, 16
    ds_read_b128 a[136:139], v18 offset:18432
    v_mfma_f32_16x16x32_bf16 v[124:127], a[152:155], a[248:251], v[124:127]
    s_add_u32 s82, s82, s81
    v_exp_f32 v103, v103
    v_mfma_f32_16x16x32_bf16 v[124:127], a[156:159], a[252:255], v[124:127]
    s_cmp_ge_u32 s12, 17
    s_cselect_b32 s82, 2147471360, s82
    ds_read_b128 a[140:143], v18 offset:19456
    v_cvt_pk_bf16_f32 v51, v102, v103
    v_mfma_f32_16x16x32_bf16 v[40:43], v[28:31], v[56:59], v[40:43]
    s_add_u32 s12, s12, 1
    v_exp_f32 v104, v104
    v_mfma_f32_16x16x32_bf16 v[44:47], v[28:31], v[60:63], v[44:47]
    ds_read_b128 a[144:147], v18 offset:20480
    v_mfma_f32_16x16x32_bf16 v[192:195], a[160:163], v[56:59], v[192:195]
    v_exp_f32 v105, v105
    v_mfma_f32_16x16x32_bf16 v[224:227], a[160:163], v[60:63], v[224:227]
    ds_read_b128 a[148:151], v18 offset:21504
    v_cvt_pk_bf16_f32 v52, v104, v105
    v_mfma_f32_16x16x32_bf16 v[196:199], a[164:167], v[56:59], v[196:199]
    v_exp_f32 v106, v106
    v_mfma_f32_16x16x32_bf16 v[228:231], a[164:167], v[60:63], v[228:231]
    ds_read_b128 a[152:155], v18 offset:22528
    v_mfma_f32_16x16x32_bf16 v[200:203], a[168:171], v[56:59], v[200:203]
    v_exp_f32 v107, v107
    v_mfma_f32_16x16x32_bf16 v[232:235], a[168:171], v[60:63], v[232:235]
    ds_read_b128 a[156:159], v18 offset:23552
    v_cvt_pk_bf16_f32 v53, v106, v107
    v_mfma_f32_16x16x32_bf16 v[204:207], a[172:175], v[56:59], v[204:207]
    v_exp_f32 v108, v108
    v_mfma_f32_16x16x32_bf16 v[236:239], a[172:175], v[60:63], v[236:239]
    v_mfma_f32_16x16x32_bf16 v[208:211], a[176:179], v[56:59], v[208:211]
    v_exp_f32 v109, v109
    v_mfma_f32_16x16x32_bf16 v[240:243], a[176:179], v[60:63], v[240:243]
    v_cvt_pk_bf16_f32 v54, v108, v109
    v_xor_b32 v18, 196608, v18
    v_mfma_f32_16x16x32_bf16 v[212:215], a[180:183], v[56:59], v[212:215]
    v_exp_f32 v110, v110
    v_mfma_f32_16x16x32_bf16 v[244:247], a[180:183], v[60:63], v[244:247]
    v_mfma_f32_16x16x32_bf16 v[216:219], a[184:187], v[56:59], v[216:219]
    v_exp_f32 v111, v111
    v_mfma_f32_16x16x32_bf16 v[248:251], a[184:187], v[60:63], v[248:251]
    v_cvt_pk_bf16_f32 v55, v110, v111
    v_mfma_f32_16x16x32_bf16 v[220:223], a[188:191], v[56:59], v[220:223]
    v_mfma_f32_16x16x32_bf16 v[252:255], a[188:191], v[60:63], v[252:255]
    s_waitcnt vmcnt(4) lgkmcnt(0)
    s_barrier
    v_mfma_f32_16x16x32_bf16 v[96:99], a[128:131], a[192:195], v[64:67]
    s_add_u32 m0, s15, 0
    ds_read_b128 a[160:163], v19 offset:0
    v_mfma_f32_16x16x32_bf16 v[96:99], a[132:135], a[196:199], v[96:99]
    ds_read_b128 a[164:167], v19 offset:1024
    v_mfma_f32_16x16x32_bf16 v[96:99], a[136:139], a[200:203], v[96:99]
    v_exp_f32 v112, v112
    v_mfma_f32_16x16x32_bf16 v[96:99], a[140:143], a[204:207], v[96:99]
    buffer_load_dwordx4 v1, s[8:11], s82 offen offset:0  lds
    v_mfma_f32_16x16x32_bf16 v[104:107], a[128:131], a[208:211], v[68:71]
    v_exp_f32 v113, v113
    v_mfma_f32_16x16x32_bf16 v[104:107], a[132:135], a[212:215], v[104:107]
    ds_read_b128 a[168:171], v19 offset:2048
    v_cvt_pk_bf16_f32 v56, v112, v113
    v_mfma_f32_16x16x32_bf16 v[104:107], a[136:139], a[216:219], v[104:107]
    v_exp_f32 v114, v114
    v_mfma_f32_16x16x32_bf16 v[104:107], a[140:143], a[220:223], v[104:107]
    buffer_load_dwordx4 v1, s[8:11], s82 offen offset:1024  lds
    v_mfma_f32_16x16x32_bf16 v[100:103], a[144:147], a[192:195], v[64:67]
    v_exp_f32 v115, v115
    v_mfma_f32_16x16x32_bf16 v[100:103], a[148:151], a[196:199], v[100:103]
    ds_read_b128 a[172:175], v19 offset:3072
    v_cvt_pk_bf16_f32 v57, v114, v115
    v_mfma_f32_16x16x32_bf16 v[100:103], a[152:155], a[200:203], v[100:103]
    v_exp_f32 v116, v116
    v_mfma_f32_16x16x32_bf16 v[100:103], a[156:159], a[204:207], v[100:103]
    buffer_load_dwordx4 v1, s[8:11], s82 offen offset:2048  lds
    v_mfma_f32_16x16x32_bf16 v[108:111], a[144:147], a[208:211], v[68:71]
    v_exp_f32 v117, v117
    v_mfma_f32_16x16x32_bf16 v[108:111], a[148:151], a[212:215], v[108:111]
    ds_read_b128 a[176:179], v20 offset:4096
    v_cvt_pk_bf16_f32 v58, v116, v117
    v_mfma_f32_16x16x32_bf16 v[108:111], a[152:155], a[216:219], v[108:111]
    v_exp_f32 v118, v118
    v_mfma_f32_16x16x32_bf16 v[108:111], a[156:159], a[220:223], v[108:111]
    buffer_load_dwordx4 v1, s[8:11], s82 offen offset:3072  lds
    v_mfma_f32_16x16x32_bf16 v[32:35], v[28:31], v[48:51], v[32:35]
    s_add_u32 m0, s15, 4096
    v_exp_f32 v119, v119
    v_mfma_f32_16x16x32_bf16 v[36:39], v[28:31], v[52:55], v[36:39]
    s_waitcnt lgkmcnt(4)
    ds_read_b128 a[180:183], v20 offset:5120
    v_cvt_pk_bf16_f32 v59, v118, v119
    v_mfma_f32_16x16x32_bf16 v[128:131], a[160:163], v[48:51], v[128:131]
    v_exp_f32 v120, v120
    v_mfma_f32_16x16x32_bf16 v[160:163], a[160:163], v[52:55], v[160:163]
    s_waitcnt lgkmcnt(4)
    v_mfma_f32_16x16x32_bf16 v[132:135], a[164:167], v[48:51], v[132:135]
    v_exp_f32 v121, v121
    v_mfma_f32_16x16x32_bf16 v[164:167], a[164:167], v[52:55], v[164:167]
    s_waitcnt lgkmcnt(3)
    ds_read_b128 a[184:187], v20 offset:6144
    v_cvt_pk_bf16_f32 v60, v120, v121
    v_mfma_f32_16x16x32_bf16 v[136:139], a[168:171], v[48:51], v[136:139]
    s_waitcnt lgkmcnt(3)
    v_exp_f32 v122, v122
    v_mfma_f32_16x16x32_bf16 v[168:171], a[168:171], v[52:55], v[168:171]
    buffer_load_dwordx4 v15, s[8:11], s82 offen offset:0  lds
    v_mfma_f32_16x16x32_bf16 v[140:143], a[172:175], v[48:51], v[140:143]
    v_exp_f32 v123, v123
    v_mfma_f32_16x16x32_bf16 v[172:175], a[172:175], v[52:55], v[172:175]
    s_waitcnt lgkmcnt(2)
    ds_read_b128 a[188:191], v20 offset:7168
    v_cvt_pk_bf16_f32 v61, v122, v123
    v_mfma_f32_16x16x32_bf16 v[144:147], a[176:179], v[48:51], v[144:147]
    s_waitcnt lgkmcnt(2)
    v_exp_f32 v124, v124
    v_mfma_f32_16x16x32_bf16 v[176:179], a[176:179], v[52:55], v[176:179]
    buffer_load_dwordx4 v15, s[8:11], s82 offen offset:1024  lds
    v_mfma_f32_16x16x32_bf16 v[148:151], a[180:183], v[48:51], v[148:151]
    v_exp_f32 v125, v125
    v_mfma_f32_16x16x32_bf16 v[180:183], a[180:183], v[52:55], v[180:183]
    s_waitcnt lgkmcnt(1)
    v_cvt_pk_bf16_f32 v62, v124, v125
    v_mfma_f32_16x16x32_bf16 v[152:155], a[184:187], v[48:51], v[152:155]
    s_waitcnt lgkmcnt(0)
    v_exp_f32 v126, v126
    v_mfma_f32_16x16x32_bf16 v[184:187], a[184:187], v[52:55], v[184:187]
    buffer_load_dwordx4 v15, s[8:11], s82 offen offset:2048  lds
    v_mfma_f32_16x16x32_bf16 v[156:159], a[188:191], v[48:51], v[156:159]
    v_exp_f32 v127, v127
    v_mfma_f32_16x16x32_bf16 v[188:191], a[188:191], v[52:55], v[188:191]
    v_cvt_pk_bf16_f32 v63, v126, v127
    v_mfma_f32_16x16x32_bf16 v[112:115], a[128:131], a[224:227], v[72:75]
    v_mfma_f32_16x16x32_bf16 v[112:115], a[132:135], a[228:231], v[112:115]
    v_mfma_f32_16x16x32_bf16 v[112:115], a[136:139], a[232:235], v[112:115]
    v_exp_f32 v96, v96
    v_mfma_f32_16x16x32_bf16 v[112:115], a[140:143], a[236:239], v[112:115]
    buffer_load_dwordx4 v15, s[8:11], s82 offen offset:3072  lds
    v_mfma_f32_16x16x32_bf16 v[120:123], a[128:131], a[240:243], v[76:79]
    s_xor_b32 s15, s15, 196608
    v_exp_f32 v97, v97
    v_mfma_f32_16x16x32_bf16 v[120:123], a[132:135], a[244:247], v[120:123]
    s_add_u32 m0, s16, 0
    ds_read_b128 a[128:131], v18 offset:0
    v_cvt_pk_bf16_f32 v48, v96, v97
    v_mfma_f32_16x16x32_bf16 v[120:123], a[136:139], a[248:251], v[120:123]
    v_exp_f32 v98, v98
    v_mfma_f32_16x16x32_bf16 v[120:123], a[140:143], a[252:255], v[120:123]
    buffer_load_dwordx4 v1, s[8:11], s19 offen offset:0  lds
    v_mfma_f32_16x16x32_bf16 v[116:119], a[144:147], a[224:227], v[72:75]
    v_exp_f32 v99, v99
    v_mfma_f32_16x16x32_bf16 v[116:119], a[148:151], a[228:231], v[116:119]
    ds_read_b128 a[132:135], v18 offset:1024
    v_cvt_pk_bf16_f32 v49, v98, v99
    v_mfma_f32_16x16x32_bf16 v[116:119], a[152:155], a[232:235], v[116:119]
    v_exp_f32 v100, v100
    v_mfma_f32_16x16x32_bf16 v[116:119], a[156:159], a[236:239], v[116:119]
    buffer_load_dwordx4 v1, s[8:11], s19 offen offset:1024  lds
    v_mfma_f32_16x16x32_bf16 v[124:127], a[144:147], a[240:243], v[76:79]
    v_exp_f32 v101, v101
    v_mfma_f32_16x16x32_bf16 v[124:127], a[148:151], a[244:247], v[124:127]
    ds_read_b128 a[136:139], v18 offset:2048
    v_cvt_pk_bf16_f32 v50, v100, v101
    v_mfma_f32_16x16x32_bf16 v[124:127], a[152:155], a[248:251], v[124:127]
    v_exp_f32 v102, v102
    v_mfma_f32_16x16x32_bf16 v[124:127], a[156:159], a[252:255], v[124:127]
    buffer_load_dwordx4 v1, s[8:11], s19 offen offset:2048  lds
    v_mfma_f32_16x16x32_bf16 v[40:43], v[28:31], v[56:59], v[40:43]
    v_exp_f32 v103, v103
    v_mfma_f32_16x16x32_bf16 v[44:47], v[28:31], v[60:63], v[44:47]
    ds_read_b128 a[140:143], v18 offset:3072
    v_cvt_pk_bf16_f32 v51, v102, v103
    v_mfma_f32_16x16x32_bf16 v[192:195], a[160:163], v[56:59], v[192:195]
    v_exp_f32 v104, v104
    v_mfma_f32_16x16x32_bf16 v[224:227], a[160:163], v[60:63], v[224:227]
    v_mfma_f32_16x16x32_bf16 v[196:199], a[164:167], v[56:59], v[196:199]
    v_exp_f32 v105, v105
    v_mfma_f32_16x16x32_bf16 v[228:231], a[164:167], v[60:63], v[228:231]
    ds_read_b128 a[144:147], v18 offset:4096
    v_cvt_pk_bf16_f32 v52, v104, v105
    v_mfma_f32_16x16x32_bf16 v[200:203], a[168:171], v[56:59], v[200:203]
    v_exp_f32 v106, v106
    v_mfma_f32_16x16x32_bf16 v[232:235], a[168:171], v[60:63], v[232:235]
    buffer_load_dwordx4 v1, s[8:11], s19 offen offset:3072  lds
    v_mfma_f32_16x16x32_bf16 v[204:207], a[172:175], v[56:59], v[204:207]
    s_add_u32 m0, s16, 4096
    v_exp_f32 v107, v107
    v_mfma_f32_16x16x32_bf16 v[236:239], a[172:175], v[60:63], v[236:239]
    ds_read_b128 a[148:151], v18 offset:5120
    v_cvt_pk_bf16_f32 v53, v106, v107
    v_mfma_f32_16x16x32_bf16 v[208:211], a[176:179], v[56:59], v[208:211]
    v_exp_f32 v108, v108
    v_mfma_f32_16x16x32_bf16 v[240:243], a[176:179], v[60:63], v[240:243]
    buffer_load_dwordx4 v15, s[8:11], s19 offen offset:0  lds
    v_mfma_f32_16x16x32_bf16 v[212:215], a[180:183], v[56:59], v[212:215]
    v_exp_f32 v109, v109
    v_mfma_f32_16x16x32_bf16 v[244:247], a[180:183], v[60:63], v[244:247]
    ds_read_b128 a[152:155], v18 offset:6144
    v_cvt_pk_bf16_f32 v54, v108, v109
    v_mfma_f32_16x16x32_bf16 v[216:219], a[184:187], v[56:59], v[216:219]
    v_exp_f32 v110, v110
    v_mfma_f32_16x16x32_bf16 v[248:251], a[184:187], v[60:63], v[248:251]
    buffer_load_dwordx4 v15, s[8:11], s19 offen offset:1024  lds
    v_mfma_f32_16x16x32_bf16 v[220:223], a[188:191], v[56:59], v[220:223]
    v_exp_f32 v111, v111
    v_mfma_f32_16x16x32_bf16 v[252:255], a[188:191], v[60:63], v[252:255]
    ds_read_b128 a[156:159], v18 offset:7168
    v_cvt_pk_bf16_f32 v55, v110, v111
    s_cmp_eq_u32 s14, 0
    s_cbranch_scc1 L_t2_diag
.p2align 3
L_t2_loop:
    s_waitcnt lgkmcnt(7)
    v_mfma_f32_16x16x32_bf16 v[96:99], a[128:131], a[192:195], v[64:67]
    s_waitcnt lgkmcnt(6)
    ds_read_b128 a[160:163], v19 offset:16384
    v_mfma_f32_16x16x32_bf16 v[96:99], a[132:135], a[196:199], v[96:99]
    s_waitcnt lgkmcnt(6)
    ds_read_b128 a[164:167], v19 offset:17408
    v_mfma_f32_16x16x32_bf16 v[96:99], a[136:139], a[200:203], v[96:99]
    s_waitcnt lgkmcnt(6)
    v_exp_f32 v112, v112
    v_mfma_f32_16x16x32_bf16 v[96:99], a[140:143], a[204:207], v[96:99]
    buffer_load_dwordx4 v15, s[8:11], s19 offen offset:2048  lds
    v_mfma_f32_16x16x32_bf16 v[104:107], a[128:131], a[208:211], v[68:71]
    v_exp_f32 v113, v113
    v_mfma_f32_16x16x32_bf16 v[104:107], a[132:135], a[212:215], v[104:107]
    ds_read_b128 a[168:171], v19 offset:18432
    v_cvt_pk_bf16_f32 v56, v112, v113
    v_mfma_f32_16x16x32_bf16 v[104:107], a[136:139], a[216:219], v[104:107]
    s_waitcnt lgkmcnt(6)
    v_exp_f32 v114, v114
    v_mfma_f32_16x16x32_bf16 v[104:107], a[140:143], a[220:223], v[104:107]
    buffer_load_dwordx4 v15, s[8:11], s19 offen offset:3072  lds
    v_mfma_f32_16x16x32_bf16 v[100:103], a[144:147], a[192:195], v[64:67]
    s_waitcnt lgkmcnt(5)
    s_xor_b32 s16, s16, 98304
    v_exp_f32 v115, v115
    v_mfma_f32_16x16x32_bf16 v[100:103], a[148:151], a[196:199], v[100:103]
    s_waitcnt lgkmcnt(4)
    ds_read_b128 a[172:175], v19 offset:19456
    v_cvt_pk_bf16_f32 v57, v114, v115
    v_mfma_f32_16x16x32_bf16 v[100:103], a[152:155], a[200:203], v[100:103]
    s_waitcnt lgkmcnt(4)
    v_exp_f32 v116, v116
    v_mfma_f32_16x16x32_bf16 v[100:103], a[156:159], a[204:207], v[100:103]
    v_mfma_f32_16x16x32_bf16 v[108:111], a[144:147], a[208:211], v[68:71]
    v_exp_f32 v117, v117
    v_mfma_f32_16x16x32_bf16 v[108:111], a[148:151], a[212:215], v[108:111]
    ds_read_b128 a[176:179], v20 offset:20480
    v_cvt_pk_bf16_f32 v58, v116, v117
    v_mfma_f32_16x16x32_bf16 v[108:111], a[152:155], a[216:219], v[108:111]
    v_exp_f32 v118, v118
    v_mfma_f32_16x16x32_bf16 v[108:111], a[156:159], a[220:223], v[108:111]
    v_mfma_f32_16x16x32_bf16 v[32:35], v[28:31], v[48:51], v[32:35]
    v_exp_f32 v119, v119
    v_mfma_f32_16x16x32_bf16 v[36:39], v[28:31], v[52:55], v[36:39]
    s_waitcnt lgkmcnt(4)
    ds_read_b128 a[180:183], v20 offset:21504
    v_cvt_pk_bf16_f32 v59, v118, v119
    v_mfma_f32_16x16x32_bf16 v[128:131], a[160:163], v[48:51], v[128:131]
    v_exp_f32 v120, v120
    v_mfma_f32_16x16x32_bf16 v[160:163], a[160:163], v[52:55], v[160:163]
    s_waitcnt lgkmcnt(4)
    v_mfma_f32_16x16x32_bf16 v[132:135], a[164:167], v[48:51], v[132:135]
    v_exp_f32 v121, v121
    v_mfma_f32_16x16x32_bf16 v[164:167], a[164:167], v[52:55], v[164:167]
    s_waitcnt lgkmcnt(3)
    ds_read_b128 a[184:187], v20 offset:22528
    v_cvt_pk_bf16_f32 v60, v120, v121
    v_mfma_f32_16x16x32_bf16 v[136:139], a[168:171], v[48:51], v[136:139]
    v_exp_f32 v122, v122
    v_mfma_f32_16x16x32_bf16 v[168:171], a[168:171], v[52:55], v[168:171]
    s_waitcnt lgkmcnt(3)
    v_mfma_f32_16x16x32_bf16 v[140:143], a[172:175], v[48:51], v[140:143]
    v_exp_f32 v123, v123
    v_mfma_f32_16x16x32_bf16 v[172:175], a[172:175], v[52:55], v[172:175]
    s_waitcnt lgkmcnt(2)
    ds_read_b128 a[188:191], v20 offset:23552
    v_cvt_pk_bf16_f32 v61, v122, v123
    v_mfma_f32_16x16x32_bf16 v[144:147], a[176:179], v[48:51], v[144:147]
    v_exp_f32 v124, v124
    v_mfma_f32_16x16x32_bf16 v[176:179], a[176:179], v[52:55], v[176:179]
    s_waitcnt lgkmcnt(2)
    v_mfma_f32_16x16x32_bf16 v[148:151], a[180:183], v[48:51], v[148:151]
    v_exp_f32 v125, v125
    v_mfma_f32_16x16x32_bf16 v[180:183], a[180:183], v[52:55], v[180:183]
    s_waitcnt lgkmcnt(1)
    v_cvt_pk_bf16_f32 v62, v124, v125
    v_xor_b32 v19, 98304, v19
    v_mfma_f32_16x16x32_bf16 v[152:155], a[184:187], v[48:51], v[152:155]
    v_exp_f32 v126, v126
    v_mfma_f32_16x16x32_bf16 v[184:187], a[184:187], v[52:55], v[184:187]
    s_waitcnt lgkmcnt(0)
    v_xor_b32 v20, 98304, v20
    v_mfma_f32_16x16x32_bf16 v[156:159], a[188:191], v[48:51], v[156:159]
    v_exp_f32 v127, v127
    v_mfma_f32_16x16x32_bf16 v[188:191], a[188:191], v[52:55], v[188:191]
    v_cvt_pk_bf16_f32 v63, v126, v127
    v_mfma_f32_16x16x32_bf16 v[112:115], a[128:131], a[224:227], v[72:75]
    v_exp_f32 v96, v96
    v_mfma_f32_16x16x32_bf16 v[112:115], a[132:135], a[228:231], v[112:115]
    v_mfma_f32_16x16x32_bf16 v[112:115], a[136:139], a[232:235], v[112:115]
    v_exp_f32 v97, v97
    v_mfma_f32_16x16x32_bf16 v[112:115], a[140:143], a[236:239], v[112:115]
    v_cvt_pk_bf16_f32 v48, v96, v97
    v_mfma_f32_16x16x32_bf16 v[120:123], a[128:131], a[240:243], v[76:79]
    v_exp_f32 v98, v98
    v_mfma_f32_16x16x32_bf16 v[120:123], a[132:135], a[244:247], v[120:123]
    v_mfma_f32_16x16x32_bf16 v[120:123], a[136:139], a[248:251], v[120:123]
    v_exp_f32 v99, v99
    v_mfma_f32_16x16x32_bf16 v[120:123], a[140:143], a[252:255], v[120:123]
    v_mfma_f32_16x16x32_bf16 v[116:119], a[144:147], a[224:227], v[72:75]
    v_exp_f32 v100, v100
    v_mfma_f32_16x16x32_bf16 v[116:119], a[148:151], a[228:231], v[116:119]
    ds_read_b128 a[128:131], v18 offset:16384
    v_cvt_pk_bf16_f32 v49, v98, v99
    v_mfma_f32_16x16x32_bf16 v[116:119], a[152:155], a[232:235], v[116:119]
    s_add_u32 s19, s82, 32768
    v_exp_f32 v101, v101
    v_mfma_f32_16x16x32_bf16 v[116:119], a[156:159], a[236:239], v[116:119]
    s_sub_u32 s82, s12, s13
    ds_read_b128 a[132:135], v18 offset:17408
    v_cvt_pk_bf16_f32 v50, v100, v101
    v_mfma_f32_16x16x32_bf16 v[124:127], a[144:147], a[240:243], v[76:79]
    s_sub_u32 s82, s82, 1
    v_exp_f32 v102, v102
    v_mfma_f32_16x16x32_bf16 v[124:127], a[148:151], a[244:247], v[124:127]
    s_cmp_gt_u32 s12, s13
    s_cselect_b32 s82, s82, s12
    s_lshl_b32 s82, s82, 16
    ds_read_b128 a[136:139], v18 offset:18432
    v_mfma_f32_16x16x32_bf16 v[124:127], a[152:155], a[248:251], v[124:127]
    s_add_u32 s82, s82, s81
    v_exp_f32 v103, v103
    v_mfma_f32_16x16x32_bf16 v[124:127], a[156:159], a[252:255], v[124:127]
    s_cmp_ge_u32 s12, 17
    s_cselect_b32 s82, 2147471360, s82
    ds_read_b128 a[140:143], v18 offset:19456
    v_cvt_pk_bf16_f32 v51, v102, v103
    v_mfma_f32_16x16x32_bf16 v[40:43], v[28:31], v[56:59], v[40:43]
    s_add_u32 s12, s12, 1
    v_exp_f32 v104, v104
    v_mfma_f32_16x16x32_bf16 v[44:47], v[28:31], v[60:63], v[44:47]
    ds_read_b128 a[144:147], v18 offset:20480
    v_mfma_f32_16x16x32_bf16 v[192:195], a[160:163], v[56:59], v[192:195]
    v_exp_f32 v105, v105
    v_mfma_f32_16x16x32_bf16 v[224:227], a[160:163], v[60:63], v[224:227]
    ds_read_b128 a[148:151], v18 offset:21504
    v_cvt_pk_bf16_f32 v52, v104, v105
    v_mfma_f32_16x16x32_bf16 v[196:199], a[164:167], v[56:59], v[196:199]
    v_exp_f32 v106, v106
    v_mfma_f32_16x16x32_bf16 v[228:231], a[164:167], v[60:63], v[228:231]
    ds_read_b128 a[152:155], v18 offset:22528
    v_mfma_f32_16x16x32_bf16 v[200:203], a[168:171], v[56:59], v[200:203]
    v_exp_f32 v107, v107
    v_mfma_f32_16x16x32_bf16 v[232:235], a[168:171], v[60:63], v[232:235]
    ds_read_b128 a[156:159], v18 offset:23552
    v_cvt_pk_bf16_f32 v53, v106, v107
    v_mfma_f32_16x16x32_bf16 v[204:207], a[172:175], v[56:59], v[204:207]
    v_exp_f32 v108, v108
    v_mfma_f32_16x16x32_bf16 v[236:239], a[172:175], v[60:63], v[236:239]
    v_mfma_f32_16x16x32_bf16 v[208:211], a[176:179], v[56:59], v[208:211]
    v_exp_f32 v109, v109
    v_mfma_f32_16x16x32_bf16 v[240:243], a[176:179], v[60:63], v[240:243]
    v_cvt_pk_bf16_f32 v54, v108, v109
    v_xor_b32 v18, 196608, v18
    v_mfma_f32_16x16x32_bf16 v[212:215], a[180:183], v[56:59], v[212:215]
    v_exp_f32 v110, v110
    v_mfma_f32_16x16x32_bf16 v[244:247], a[180:183], v[60:63], v[244:247]
    v_mfma_f32_16x16x32_bf16 v[216:219], a[184:187], v[56:59], v[216:219]
    v_exp_f32 v111, v111
    v_mfma_f32_16x16x32_bf16 v[248:251], a[184:187], v[60:63], v[248:251]
    v_cvt_pk_bf16_f32 v55, v110, v111
    v_mfma_f32_16x16x32_bf16 v[220:223], a[188:191], v[56:59], v[220:223]
    v_mfma_f32_16x16x32_bf16 v[252:255], a[188:191], v[60:63], v[252:255]
    s_waitcnt vmcnt(0) lgkmcnt(0)
    s_barrier
    v_mfma_f32_16x16x32_bf16 v[96:99], a[128:131], a[192:195], v[64:67]
    s_add_u32 m0, s15, 0
    ds_read_b128 a[160:163], v19 offset:0
    v_mfma_f32_16x16x32_bf16 v[96:99], a[132:135], a[196:199], v[96:99]
    ds_read_b128 a[164:167], v19 offset:1024
    v_mfma_f32_16x16x32_bf16 v[96:99], a[136:139], a[200:203], v[96:99]
    v_exp_f32 v112, v112
    v_mfma_f32_16x16x32_bf16 v[96:99], a[140:143], a[204:207], v[96:99]
    buffer_load_dwordx4 v1, s[8:11], s82 offen offset:0  lds
    v_mfma_f32_16x16x32_bf16 v[104:107], a[128:131], a[208:211], v[68:71]
    v_exp_f32 v113, v113
    v_mfma_f32_16x16x32_bf16 v[104:107], a[132:135], a[212:215], v[104:107]
    ds_read_b128 a[168:171], v19 offset:2048
    v_cvt_pk_bf16_f32 v56, v112, v113
    v_mfma_f32_16x16x32_bf16 v[104:107], a[136:139], a[216:219], v[104:107]
    v_exp_f32 v114, v114
    v_mfma_f32_16x16x32_bf16 v[104:107], a[140:143], a[220:223], v[104:107]
    buffer_load_dwordx4 v1, s[8:11], s82 offen offset:1024  lds
    v_mfma_f32_16x16x32_bf16 v[100:103], a[144:147], a[192:195], v[64:67]
    v_exp_f32 v115, v115
    v_mfma_f32_16x16x32_bf16 v[100:103], a[148:151], a[196:199], v[100:103]
    ds_read_b128 a[172:175], v19 offset:3072
    v_cvt_pk_bf16_f32 v57, v114, v115
    v_mfma_f32_16x16x32_bf16 v[100:103], a[152:155], a[200:203], v[100:103]
    v_exp_f32 v116, v116
    v_mfma_f32_16x16x32_bf16 v[100:103], a[156:159], a[204:207], v[100:103]
    buffer_load_dwordx4 v1, s[8:11], s82 offen offset:2048  lds
    v_mfma_f32_16x16x32_bf16 v[108:111], a[144:147], a[208:211], v[68:71]
    v_exp_f32 v117, v117
    v_mfma_f32_16x16x32_bf16 v[108:111], a[148:151], a[212:215], v[108:111]
    ds_read_b128 a[176:179], v20 offset:4096
    v_cvt_pk_bf16_f32 v58, v116, v117
    v_mfma_f32_16x16x32_bf16 v[108:111], a[152:155], a[216:219], v[108:111]
    v_exp_f32 v118, v118
    v_mfma_f32_16x16x32_bf16 v[108:111], a[156:159], a[220:223], v[108:111]
    buffer_load_dwordx4 v1, s[8:11], s82 offen offset:3072  lds
    v_mfma_f32_16x16x32_bf16 v[32:35], v[28:31], v[48:51], v[32:35]
    s_add_u32 m0, s15, 4096
    v_exp_f32 v119, v119
    v_mfma_f32_16x16x32_bf16 v[36:39], v[28:31], v[52:55], v[36:39]
    s_waitcnt lgkmcnt(4)
    ds_read_b128 a[180:183], v20 offset:5120
    v_cvt_pk_bf16_f32 v59, v118, v119
    v_mfma_f32_16x16x32_bf16 v[128:131], a[160:163], v[48:51], v[128:131]
    v_exp_f32 v120, v120
    v_mfma_f32_16x16x32_bf16 v[160:163], a[160:163], v[52:55], v[160:163]
    s_waitcnt lgkmcnt(4)
    v_mfma_f32_16x16x32_bf16 v[132:135], a[164:167], v[48:51], v[132:135]
    v_exp_f32 v121, v121
    v_mfma_f32_16x16x32_bf16 v[164:167], a[164:167], v[52:55], v[164:167]
    s_waitcnt lgkmcnt(3)
    ds_read_b128 a[184:187], v20 offset:6144
    v_cvt_pk_bf16_f32 v60, v120, v121
    v_mfma_f32_16x16x32_bf16 v[136:139], a[168:171], v[48:51], v[136:139]
    s_waitcnt lgkmcnt(3)
    v_exp_f32 v122, v122
    v_mfma_f32_16x16x32_bf16 v[168:171], a[168:171], v[52:55], v[168:171]
    buffer_load_dwordx4 v15, s[8:11], s82 offen offset:0  lds
    v_mfma_f32_16x16x32_bf16 v[140:143], a[172:175], v[48:51], v[140:143]
    v_exp_f32 v123, v123
    v_mfma_f32_16x16x32_bf16 v[172:175], a[172:175], v[52:55], v[172:175]
    s_waitcnt lgkmcnt(2)
    ds_read_b128 a[188:191], v20 offset:7168
    v_cvt_pk_bf16_f32 v61, v122, v123
    v_mfma_f32_16x16x32_bf16 v[144:147], a[176:179], v[48:51], v[144:147]
    s_waitcnt lgkmcnt(2)
    v_exp_f32 v124, v124
    v_mfma_f32_16x16x32_bf16 v[176:179], a[176:179], v[52:55], v[176:179]
    buffer_load_dwordx4 v15, s[8:11], s82 offen offset:1024  lds
    v_mfma_f32_16x16x32_bf16 v[148:151], a[180:183], v[48:51], v[148:151]
    v_exp_f32 v125, v125
    v_mfma_f32_16x16x32_bf16 v[180:183], a[180:183], v[52:55], v[180:183]
    s_waitcnt lgkmcnt(1)
    v_cvt_pk_bf16_f32 v62, v124, v125
    v_mfma_f32_16x16x32_bf16 v[152:155], a[184:187], v[48:51], v[152:155]
    s_waitcnt lgkmcnt(0)
    v_exp_f32 v126, v126
    v_mfma_f32_16x16x32_bf16 v[184:187], a[184:187], v[52:55], v[184:187]
    buffer_load_dwordx4 v15, s[8:11], s82 offen offset:2048  lds
    v_mfma_f32_16x16x32_bf16 v[156:159], a[188:191], v[48:51], v[156:159]
    v_exp_f32 v127, v127
    v_mfma_f32_16x16x32_bf16 v[188:191], a[188:191], v[52:55], v[188:191]
    v_cvt_pk_bf16_f32 v63, v126, v127
    v_mfma_f32_16x16x32_bf16 v[112:115], a[128:131], a[224:227], v[72:75]
    v_mfma_f32_16x16x32_bf16 v[112:115], a[132:135], a[228:231], v[112:115]
    v_mfma_f32_16x16x32_bf16 v[112:115], a[136:139], a[232:235], v[112:115]
    v_exp_f32 v96, v96
    v_mfma_f32_16x16x32_bf16 v[112:115], a[140:143], a[236:239], v[112:115]
    buffer_load_dwordx4 v15, s[8:11], s82 offen offset:3072  lds
    v_mfma_f32_16x16x32_bf16 v[120:123], a[128:131], a[240:243], v[76:79]
    s_xor_b32 s15, s15, 196608
    v_exp_f32 v97, v97
    v_mfma_f32_16x16x32_bf16 v[120:123], a[132:135], a[244:247], v[120:123]
    s_add_u32 m0, s16, 0
    ds_read_b128 a[128:131], v18 offset:0
    v_cvt_pk_bf16_f32 v48, v96, v97
    v_mfma_f32_16x16x32_bf16 v[120:123], a[136:139], a[248:251], v[120:123]
    v_exp_f32 v98, v98
    v_mfma_f32_16x16x32_bf16 v[120:123], a[140:143], a[252:255], v[120:123]
    buffer_load_dwordx4 v1, s[8:11], s19 offen offset:0  lds
    v_mfma_f32_16x16x32_bf16 v[116:119], a[144:147], a[224:227], v[72:75]
    v_exp_f32 v99, v99
    v_mfma_f32_16x16x32_bf16 v[116:119], a[148:151], a[228:231], v[116:119]
    ds_read_b128 a[132:135], v18 offset:1024
    v_cvt_pk_bf16_f32 v49, v98, v99
    v_mfma_f32_16x16x32_bf16 v[116:119], a[152:155], a[232:235], v[116:119]
    v_exp_f32 v100, v100
    v_mfma_f32_16x16x32_bf16 v[116:119], a[156:159], a[236:239], v[116:119]
    buffer_load_dwordx4 v1, s[8:11], s19 offen offset:1024  lds
    v_mfma_f32_16x16x32_bf16 v[124:127], a[144:147], a[240:243], v[76:79]
    v_exp_f32 v101, v101
    v_mfma_f32_16x16x32_bf16 v[124:127], a[148:151], a[244:247], v[124:127]
    ds_read_b128 a[136:139], v18 offset:2048
    v_cvt_pk_bf16_f32 v50, v100, v101
    v_mfma_f32_16x16x32_bf16 v[124:127], a[152:155], a[248:251], v[124:127]
    v_exp_f32 v102, v102
    v_mfma_f32_16x16x32_bf16 v[124:127], a[156:159], a[252:255], v[124:127]
    buffer_load_dwordx4 v1, s[8:11], s19 offen offset:2048  lds
    v_mfma_f32_16x16x32_bf16 v[40:43], v[28:31], v[56:59], v[40:43]
    v_exp_f32 v103, v103
    v_mfma_f32_16x16x32_bf16 v[44:47], v[28:31], v[60:63], v[44:47]
    ds_read_b128 a[140:143], v18 offset:3072
    v_cvt_pk_bf16_f32 v51, v102, v103
    v_mfma_f32_16x16x32_bf16 v[192:195], a[160:163], v[56:59], v[192:195]
    v_exp_f32 v104, v104
    v_mfma_f32_16x16x32_bf16 v[224:227], a[160:163], v[60:63], v[224:227]
    v_mfma_f32_16x16x32_bf16 v[196:199], a[164:167], v[56:59], v[196:199]
    v_exp_f32 v105, v105
    v_mfma_f32_16x16x32_bf16 v[228:231], a[164:167], v[60:63], v[228:231]
    ds_read_b128 a[144:147], v18 offset:4096
    v_cvt_pk_bf16_f32 v52, v104, v105
    v_mfma_f32_16x16x32_bf16 v[200:203], a[168:171], v[56:59], v[200:203]
    v_exp_f32 v106, v106
    v_mfma_f32_16x16x32_bf16 v[232:235], a[168:171], v[60:63], v[232:235]
    buffer_load_dwordx4 v1, s[8:11], s19 offen offset:3072  lds
    v_mfma_f32_16x16x32_bf16 v[204:207], a[172:175], v[56:59], v[204:207]
    s_add_u32 m0, s16, 4096
    v_exp_f32 v107, v107
    v_mfma_f32_16x16x32_bf16 v[236:239], a[172:175], v[60:63], v[236:239]
    ds_read_b128 a[148:151], v18 offset:5120
    v_cvt_pk_bf16_f32 v53, v106, v107
    v_mfma_f32_16x16x32_bf16 v[208:211], a[176:179], v[56:59], v[208:211]
    s_sub_u32 s14, s14, 1
    v_exp_f32 v108, v108
    v_mfma_f32_16x16x32_bf16 v[240:243], a[176:179], v[60:63], v[240:243]
    buffer_load_dwordx4 v15, s[8:11], s19 offen offset:0  lds
    v_mfma_f32_16x16x32_bf16 v[212:215], a[180:183], v[56:59], v[212:215]
    v_exp_f32 v109, v109
    v_mfma_f32_16x16x32_bf16 v[244:247], a[180:183], v[60:63], v[244:247]
    ds_read_b128 a[152:155], v18 offset:6144
    v_cvt_pk_bf16_f32 v54, v108, v109
    v_mfma_f32_16x16x32_bf16 v[216:219], a[184:187], v[56:59], v[216:219]
    v_exp_f32 v110, v110
    v_mfma_f32_16x16x32_bf16 v[248:251], a[184:187], v[60:63], v[248:251]
    buffer_load_dwordx4 v15, s[8:11], s19 offen offset:1024  lds
    v_mfma_f32_16x16x32_bf16 v[220:223], a[188:191], v[56:59], v[220:223]
    v_exp_f32 v111, v111
    v_mfma_f32_16x16x32_bf16 v[252:255], a[188:191], v[60:63], v[252:255]
    ds_read_b128 a[156:159], v18 offset:7168
    v_cvt_pk_bf16_f32 v55, v110, v111
    s_cmp_lg_u32 s14, 0
    s_cbranch_scc1 L_t2_loop
L_t2_diag:
    s_waitcnt lgkmcnt(7)
    v_mfma_f32_16x16x32_bf16 v[96:99], a[128:131], a[192:195], v[80:83]
    s_waitcnt lgkmcnt(6)
    ds_read_b128 a[160:163], v19 offset:16384
    v_mov_b32 v24, v8
    v_mov_b32 v25, v9
    v_mfma_f32_16x16x32_bf16 v[96:99], a[132:135], a[196:199], v[96:99]
    s_waitcnt lgkmcnt(6)
    ds_read_b128 a[164:167], v19 offset:17408
    v_mov_b32 v26, v10
    v_mov_b32 v27, v11
    v_mfma_f32_16x16x32_bf16 v[96:99], a[136:139], a[200:203], v[96:99]
    s_waitcnt lgkmcnt(6)
    v_exp_f32 v112, v112
    v_add_u32 v11, 131072, v16
    v_mfma_f32_16x16x32_bf16 v[96:99], a[140:143], a[204:207], v[96:99]
    buffer_load_dwordx4 v15, s[8:11], s19 offen offset:2048  lds
    v_lshlrev_b32 v12, 6, v0
    v_mfma_f32_16x16x32_bf16 v[104:107], a[128:131], a[208:211], v[88:91]
    s_mov_b32 s71, 1327104
    v_exp_f32 v113, v113
    v_mfma_f32_16x16x32_bf16 v[104:107], a[132:135], a[212:215], v[104:107]
    ds_read_b128 a[168:171], v19 offset:18432
    v_cvt_pk_bf16_f32 v56, v112, v113
    v_mfma_f32_16x16x32_bf16 v[104:107], a[136:139], a[216:219], v[104:107]
    s_waitcnt lgkmcnt(6)
    v_exp_f32 v114, v114
    v_mfma_f32_16x16x32_bf16 v[104:107], a[140:143], a[220:223], v[104:107]
    buffer_load_dwordx4 v15, s[8:11], s19 offen offset:3072  lds
    v_mfma_f32_16x16x32_bf16 v[100:103], a[144:147], a[192:195], v[84:87]
    s_waitcnt lgkmcnt(5)
    s_xor_b32 s16, s16, 98304
    v_exp_f32 v115, v115
    v_mfma_f32_16x16x32_bf16 v[100:103], a[148:151], a[196:199], v[100:103]
    s_waitcnt lgkmcnt(4)
    ds_read_b128 a[172:175], v19 offset:19456
    v_cvt_pk_bf16_f32 v57, v114, v115
    v_mfma_f32_16x16x32_bf16 v[100:103], a[152:155], a[200:203], v[100:103]
    s_waitcnt lgkmcnt(4)
    v_exp_f32 v116, v116
    v_mfma_f32_16x16x32_bf16 v[100:103], a[156:159], a[204:207], v[100:103]
    buffer_load_dword v3, v12, s[8:11], s71 offen sc0 sc1
    v_bfe_u32 v13, v2, 1, 4
    v_mfma_f32_16x16x32_bf16 v[108:111], a[144:147], a[208:211], v[92:95]
    v_exp_f32 v117, v117
    v_lshlrev_b32 v13, 10, v13
    v_mfma_f32_16x16x32_bf16 v[108:111], a[148:151], a[212:215], v[108:111]
    ds_read_b128 a[176:179], v20 offset:20480
    v_cvt_pk_bf16_f32 v58, v116, v117
    v_and_b32 v14, 1, v2
    v_mfma_f32_16x16x32_bf16 v[108:111], a[152:155], a[216:219], v[108:111]
    v_exp_f32 v118, v118
    v_lshl_add_u32 v13, v14, 7, v13
    v_mfma_f32_16x16x32_bf16 v[108:111], a[156:159], a[220:223], v[108:111]
    s_lshl_b32 s74, s6, 2
    s_add_u32 s74, s74, s3
    s_lshl_b32 s74, s74, 14
    v_mfma_f32_16x16x32_bf16 v[32:35], v[28:31], v[48:51], v[32:35]
    v_exp_f32 v119, v119
    v_mfma_f32_16x16x32_bf16 v[36:39], v[28:31], v[52:55], v[36:39]
    s_waitcnt lgkmcnt(4)
    ds_read_b128 a[180:183], v20 offset:21504
    v_cvt_pk_bf16_f32 v59, v118, v119
    v_mfma_f32_16x16x32_bf16 v[128:131], a[160:163], v[48:51], v[128:131]
    s_waitcnt lgkmcnt(4)
    v_exp_f32 v120, v120
    v_mfma_f32_16x16x32_bf16 v[160:163], a[160:163], v[52:55], v[160:163]
    buffer_load_dword v14, v13, s[28:31], s74 offen
    v_mfma_f32_16x16x32_bf16 v[132:135], a[164:167], v[48:51], v[132:135]
    v_exp_f32 v121, v121
    v_mfma_f32_16x16x32_bf16 v[164:167], a[164:167], v[52:55], v[164:167]
    s_waitcnt lgkmcnt(3)
    ds_read_b128 a[184:187], v20 offset:22528
    v_cvt_pk_bf16_f32 v60, v120, v121
    v_mfma_f32_16x16x32_bf16 v[136:139], a[168:171], v[48:51], v[136:139]
    v_exp_f32 v122, v122
    v_mfma_f32_16x16x32_bf16 v[168:171], a[168:171], v[52:55], v[168:171]
    s_waitcnt lgkmcnt(3)
    v_add_f32 v80, 0, v22
    v_min_f32 v80, v80, v72
    v_mfma_f32_16x16x32_bf16 v[140:143], a[172:175], v[48:51], v[140:143]
    v_exp_f32 v123, v123
    v_mfma_f32_16x16x32_bf16 v[172:175], a[172:175], v[52:55], v[172:175]
    s_waitcnt lgkmcnt(2)
    ds_read_b128 a[188:191], v20 offset:23552
    v_cvt_pk_bf16_f32 v61, v122, v123
    v_mfma_f32_16x16x32_bf16 v[144:147], a[176:179], v[48:51], v[144:147]
    v_exp_f32 v124, v124
    v_mfma_f32_16x16x32_bf16 v[176:179], a[176:179], v[52:55], v[176:179]
    s_waitcnt lgkmcnt(2)
    v_add_f32 v81, 0xf1800000, v22
    v_min_f32 v81, v81, v73
    v_mfma_f32_16x16x32_bf16 v[148:151], a[180:183], v[48:51], v[148:151]
    v_exp_f32 v125, v125
    v_mfma_f32_16x16x32_bf16 v[180:183], a[180:183], v[52:55], v[180:183]
    s_waitcnt lgkmcnt(1)
    v_cvt_pk_bf16_f32 v62, v124, v125
    v_xor_b32 v19, 98304, v19
    v_mfma_f32_16x16x32_bf16 v[152:155], a[184:187], v[48:51], v[152:155]
    v_exp_f32 v126, v126
    v_mfma_f32_16x16x32_bf16 v[184:187], a[184:187], v[52:55], v[184:187]
    s_waitcnt lgkmcnt(0)
    v_xor_b32 v20, 98304, v20
    v_add_f32 v82, 0xf2000000, v22
    v_mfma_f32_16x16x32_bf16 v[156:159], a[188:191], v[48:51], v[156:159]
    v_exp_f32 v127, v127
    v_mfma_f32_16x16x32_bf16 v[188:191], a[188:191], v[52:55], v[188:191]
    v_cvt_pk_bf16_f32 v63, v126, v127
    v_min_f32 v82, v82, v74
    v_add_f32 v83, 0xf2400000, v22
    v_min_f32 v83, v83, v75
    v_add_f32 v84, 0xf3800000, v22
    v_min_f32 v84, v84, v72
    v_mfma_f32_16x16x32_bf16 v[112:115], a[128:131], a[224:227], v[72:75]
    v_exp_f32 v96, v96
    v_mfma_f32_16x16x32_bf16 v[112:115], a[132:135], a[228:231], v[112:115]
    v_add_f32 v85, 0xf3880000, v22
    v_min_f32 v85, v85, v73
    s_getpc_b64 s[100:101]
L_ct3:
    s_lshr_b32 s99, s2, 3
    s_lshl_b32 s99, s99, 2
    s_add_u32 s99, s99, s3
    s_mul_i32 s99, s99, 4
    v_min_u32 v13, 3, v2
    v_add_u32 v13, s99, v13
    v_lshlrev_b32 v13, 7, v13
    v_add_u32 v13, L_ct3-L_ct3, v13
    v_min_u32 v13, L_end-L_ct3, v13
    global_load_dword v13, v13, s[100:101]
    v_mfma_f32_16x16x32_bf16 v[112:115], a[136:139], a[232:235], v[112:115]
    s_and_b32 s68, s2, 31
    v_exp_f32 v97, v97
    v_mfma_f32_16x16x32_bf16 v[112:115], a[140:143], a[236:239], v[112:115]
    s_lshl_b32 s68, s68, 2
    s_add_u32 s68, s68, s3
    v_cvt_pk_bf16_f32 v48, v96, v97
    v_mfma_f32_16x16x32_bf16 v[120:123], a[128:131], a[240:243], v[76:79]
    s_lshl_b32 s69, s60, 7
    v_exp_f32 v98, v98
    v_mfma_f32_16x16x32_bf16 v[120:123], a[132:135], a[244:247], v[120:123]
    v_add_f32 v86, 0xf3900000, v22
    v_min_f32 v86, v86, v74
    v_mfma_f32_16x16x32_bf16 v[120:123], a[136:139], a[248:251], v[120:123]
    s_add_u32 s68, s68, s69
    v_exp_f32 v99, v99
    v_mfma_f32_16x16x32_bf16 v[120:123], a[140:143], a[252:255], v[120:123]
    v_add_f32 v87, 0xf3980000, v22
    v_min_f32 v87, v87, v75
    v_mfma_f32_16x16x32_bf16 v[116:119], a[144:147], a[224:227], v[72:75]
    s_lshl_b32 s68, s68, 10
    v_exp_f32 v100, v100
    v_mfma_f32_16x16x32_bf16 v[116:119], a[148:151], a[228:231], v[116:119]
    s_sub_u32 s69, s61, s60
    ds_read_b128 a[128:131], v18 offset:16384
    v_cvt_pk_bf16_f32 v49, v98, v99
    v_mfma_f32_16x16x32_bf16 v[116:119], a[152:155], a[232:235], v[116:119]
    s_lshl_b32 s69, s69, 17
    v_exp_f32 v101, v101
    v_mfma_f32_16x16x32_bf16 v[116:119], a[156:159], a[236:239], v[116:119]
    ds_read_b128 a[132:135], v18 offset:17408
    v_cvt_pk_bf16_f32 v50, v100, v101
    v_mfma_f32_16x16x32_bf16 v[124:127], a[144:147], a[240:243], v[76:79]
    v_exp_f32 v102, v102
    v_mfma_f32_16x16x32_bf16 v[124:127], a[148:151], a[244:247], v[124:127]
    ds_read_b128 a[136:139], v18 offset:18432
    v_bfe_u32 v9, v2, 3, 1
    v_mfma_f32_16x16x32_bf16 v[124:127], a[152:155], a[248:251], v[124:127]
    v_exp_f32 v103, v103
    v_mfma_f32_16x16x32_bf16 v[124:127], a[156:159], a[252:255], v[124:127]
    ds_read_b128 a[140:143], v18 offset:19456
    v_cvt_pk_bf16_f32 v51, v102, v103
    v_mfma_f32_16x16x32_bf16 v[40:43], v[28:31], v[56:59], v[40:43]
    v_exp_f32 v104, v104
    v_mfma_f32_16x16x32_bf16 v[44:47], v[28:31], v[60:63], v[44:47]
    ds_read_b128 a[144:147], v18 offset:20480
    v_mul_lo_u32 v9, v9, s69
    v_mfma_f32_16x16x32_bf16 v[192:195], a[160:163], v[56:59], v[192:195]
    v_exp_f32 v105, v105
    v_mfma_f32_16x16x32_bf16 v[224:227], a[160:163], v[60:63], v[224:227]
    ds_read_b128 a[148:151], v18 offset:21504
    v_cvt_pk_bf16_f32 v52, v104, v105
    v_mfma_f32_16x16x32_bf16 v[196:199], a[164:167], v[56:59], v[196:199]
    v_exp_f32 v106, v106
    v_mfma_f32_16x16x32_bf16 v[228:231], a[164:167], v[60:63], v[228:231]
    ds_read_b128 a[152:155], v18 offset:22528
    v_and_b32 v8, 7, v2
    v_mfma_f32_16x16x32_bf16 v[200:203], a[168:171], v[56:59], v[200:203]
    v_exp_f32 v107, v107
    v_mfma_f32_16x16x32_bf16 v[232:235], a[168:171], v[60:63], v[232:235]
    ds_read_b128 a[156:159], v18 offset:23552
    v_cvt_pk_bf16_f32 v53, v106, v107
    v_mfma_f32_16x16x32_bf16 v[204:207], a[172:175], v[56:59], v[204:207]
    v_exp_f32 v108, v108
    v_mfma_f32_16x16x32_bf16 v[236:239], a[172:175], v[60:63], v[236:239]
    v_lshl_add_u32 v9, v8, 7, v9
    v_add_f32 v88, 0x73800000, v22
    v_mfma_f32_16x16x32_bf16 v[208:211], a[176:179], v[56:59], v[208:211]
    v_exp_f32 v109, v109
    v_mfma_f32_16x16x32_bf16 v[240:243], a[176:179], v[60:63], v[240:243]
    v_cvt_pk_bf16_f32 v54, v108, v109
    v_xor_b32 v18, 196608, v18
    v_mfma_f32_16x16x32_bf16 v[212:215], a[180:183], v[56:59], v[212:215]
    v_exp_f32 v110, v110
    v_mfma_f32_16x16x32_bf16 v[244:247], a[180:183], v[60:63], v[244:247]
    buffer_load_dword v8, v9, s[32:35], s68 offen
    v_mfma_f32_16x16x32_bf16 v[216:219], a[184:187], v[56:59], v[216:219]
    v_exp_f32 v111, v111
    v_mfma_f32_16x16x32_bf16 v[248:251], a[184:187], v[60:63], v[248:251]
    v_cvt_pk_bf16_f32 v55, v110, v111
    v_min_f32 v88, v88, v76
    s_waitcnt vmcnt(3)
    v_cmp_ne_u32 vcc, 0, v3
    s_cmp_eq_u64 vcc, -1
    s_cbranch_scc0 L_F_slow_11
L_F_ok_12:
    v_mfma_f32_16x16x32_bf16 v[220:223], a[188:191], v[56:59], v[220:223]
    v_add_f32 v89, 0x73700000, v22
    v_min_f32 v89, v89, v77
    v_mfma_f32_16x16x32_bf16 v[252:255], a[188:191], v[60:63], v[252:255]
    v_add_f32 v90, 0x73600000, v22
    v_min_f32 v90, v90, v78
    v_add_f32 v91, 0x73500000, v22
    v_min_f32 v91, v91, v79
    v_add_f32 v92, 0, v22
    v_min_f32 v92, v92, v76
    v_add_f32 v93, 0xf1800000, v22
    v_min_f32 v93, v93, v77
    v_add_f32 v94, 0xf2000000, v22
    v_min_f32 v94, v94, v78
    v_add_f32 v95, 0xf2400000, v22
    v_min_f32 v95, v95, v79
    s_waitcnt lgkmcnt(0)
    s_barrier
    v_mfma_f32_16x16x32_bf16 v[96:99], a[128:131], a[224:227], v[80:83]
    s_xor_b32 s100, s62, 8192
    s_xor_b32 s98, s65, 262144
    ds_read_b128 a[176:179], v20 offset:4096
    s_waitcnt vmcnt(1)
    v_lshrrev_b32 v13, 1, v1
    v_mfma_f32_16x16x32_bf16 v[96:99], a[132:135], a[228:231], v[96:99]
    s_add_u32 m0, s62, 65536
    ds_read_b128 a[180:183], v20 offset:5120
    v_add_u32 v12, s100, v13
    v_mfma_f32_16x16x32_bf16 v[96:99], a[136:139], a[232:235], v[96:99]
    buffer_load_dwordx4 v24, s[28:31], s98 offen offset:0   lds
    v_exp_f32 v112, v112
    v_mfma_f32_16x16x32_bf16 v[96:99], a[140:143], a[236:239], v[96:99]
    v_exp_f32 v113, v113
    v_mfma_f32_16x16x32_bf16 v[100:103], a[144:147], a[224:227], v[84:87]
    ds_read_b128 a[184:187], v20 offset:6144
    v_cvt_pk_bf16_f32 v56, v112, v113
    v_mfma_f32_16x16x32_bf16 v[100:103], a[148:151], a[228:231], v[100:103]
    v_exp_f32 v114, v114
    v_mfma_f32_16x16x32_bf16 v[100:103], a[152:155], a[232:235], v[100:103]
    buffer_load_dwordx4 v25, s[28:31], s98 offen offset:1024   lds
    v_exp_f32 v115, v115
    v_mfma_f32_16x16x32_bf16 v[100:103], a[156:159], a[236:239], v[100:103]
    ds_read_b128 a[188:191], v20 offset:7168
    v_cvt_pk_bf16_f32 v57, v114, v115
    v_mfma_f32_16x16x32_bf16 v[104:107], a[128:131], a[240:243], v[88:91]
    v_exp_f32 v116, v116
    v_mfma_f32_16x16x32_bf16 v[104:107], a[132:135], a[244:247], v[104:107]
    v_exp_f32 v117, v117
    v_mfma_f32_16x16x32_bf16 v[104:107], a[136:139], a[248:251], v[104:107]
    ds_read_b128 a[160:163], v19 offset:0
    v_cvt_pk_bf16_f32 v58, v116, v117
    v_mfma_f32_16x16x32_bf16 v[104:107], a[140:143], a[252:255], v[104:107]
    buffer_load_dwordx4 v26, s[28:31], s98 offen offset:2048   lds
    v_exp_f32 v118, v118
    v_mfma_f32_16x16x32_bf16 v[108:111], a[144:147], a[240:243], v[92:95]
    v_exp_f32 v119, v119
    v_mfma_f32_16x16x32_bf16 v[108:111], a[148:151], a[244:247], v[108:111]
    ds_read_b128 a[164:167], v19 offset:1024
    v_cvt_pk_bf16_f32 v59, v118, v119
    v_mfma_f32_16x16x32_bf16 v[108:111], a[152:155], a[248:251], v[108:111]
    v_exp_f32 v120, v120
    v_mfma_f32_16x16x32_bf16 v[108:111], a[156:159], a[252:255], v[108:111]
    buffer_load_dwordx4 v27, s[28:31], s98 offen offset:3072   lds
    v_exp_f32 v121, v121
    v_mfma_f32_16x16x32_bf16 v[32:35], v[28:31], v[48:51], v[32:35]
    s_add_u32 m0, s62, 69632
    ds_read_b128 a[168:171], v19 offset:2048
    v_cvt_pk_bf16_f32 v60, v120, v121
    v_mfma_f32_16x16x32_bf16 v[36:39], v[28:31], v[52:55], v[36:39]
    s_waitcnt lgkmcnt(6)
    s_xor_b32 s98, s65, 294912
    v_exp_f32 v122, v122
    v_mfma_f32_16x16x32_bf16 v[144:147], a[176:179], v[48:51], v[144:147]
    v_exp_f32 v123, v123
    v_mfma_f32_16x16x32_bf16 v[176:179], a[176:179], v[52:55], v[176:179]
    s_waitcnt lgkmcnt(5)
    ds_read_b128 a[172:175], v19 offset:3072
    v_cvt_pk_bf16_f32 v61, v122, v123
    v_mfma_f32_16x16x32_bf16 v[148:151], a[180:183], v[48:51], v[148:151]
    buffer_load_dwordx4 v24, s[28:31], s98 offen offset:0   lds
    v_exp_f32 v124, v124
    v_mfma_f32_16x16x32_bf16 v[180:183], a[180:183], v[52:55], v[180:183]
    s_waitcnt lgkmcnt(5)
    v_exp_f32 v125, v125
    v_mfma_f32_16x16x32_bf16 v[152:155], a[184:187], v[48:51], v[152:155]
    s_waitcnt lgkmcnt(4)
    v_exp_f32 v126, v126
    v_mfma_f32_16x16x32_bf16 v[184:187], a[184:187], v[52:55], v[184:187]
    buffer_load_dwordx4 v25, s[28:31], s98 offen offset:1024   lds
    v_exp_f32 v127, v127
    v_mfma_f32_16x16x32_bf16 v[156:159], a[188:191], v[48:51], v[156:159]
    ds_write_b128 v11, v[144:147] offset:0
    v_cvt_pk_bf16_f32 v62, v124, v125
    v_mfma_f32_16x16x32_bf16 v[188:191], a[188:191], v[52:55], v[188:191]
    s_waitcnt lgkmcnt(4)
    v_exp_f32 v96, v96
    v_mfma_f32_16x16x32_bf16 v[128:131], a[160:163], v[48:51], v[128:131]
    v_exp_f32 v97, v97
    v_mfma_f32_16x16x32_bf16 v[160:163], a[160:163], v[52:55], v[160:163]
    s_waitcnt lgkmcnt(3)
    ds_write_b128 v11, v[176:179] offset:1024
    v_cvt_pk_bf16_f32 v63, v126, v127
    v_mfma_f32_16x16x32_bf16 v[132:135], a[164:167], v[48:51], v[132:135]
    s_waitcnt lgkmcnt(3)
    v_exp_f32 v98, v98
    v_mfma_f32_16x16x32_bf16 v[164:167], a[164:167], v[52:55], v[164:167]
    buffer_load_dwordx4 v26, s[28:31], s98 offen offset:2048   lds
    v_exp_f32 v99, v99
    v_mfma_f32_16x16x32_bf16 v[136:139], a[168:171], v[48:51], v[136:139]
    ds_write_b128 v11, v[148:151] offset:2048
    v_mfma_f32_16x16x32_bf16 v[168:171], a[168:171], v[52:55], v[168:171]
    s_waitcnt lgkmcnt(3)
    v_exp_f32 v100, v100
    v_mfma_f32_16x16x32_bf16 v[140:143], a[172:175], v[48:51], v[140:143]
    v_exp_f32 v101, v101
    v_mfma_f32_16x16x32_bf16 v[172:175], a[172:175], v[52:55], v[172:175]
    ds_write_b128 v11, v[180:183] offset:3072
    v_mov_b32 v33, v36
    v_mfma_f32_16x16x32_bf16 v[40:43], v[28:31], v[56:59], v[40:43]
    buffer_load_dwordx4 v27, s[28:31], s98 offen offset:3072   lds
    v_exp_f32 v102, v102
    v_mfma_f32_16x16x32_bf16 v[44:47], v[28:31], v[60:63], v[44:47]
    v_exp_f32 v103, v103
    v_mfma_f32_16x16x32_bf16 v[208:211], a[176:179], v[56:59], v[208:211]
    ds_write_b128 v11, v[152:155] offset:4096
    v_cvt_pk_bf16_f32 v48, v96, v97
    v_mfma_f32_16x16x32_bf16 v[240:243], a[176:179], v[60:63], v[240:243]
    ds_read_b128 a[176:179], v20 offset:20480
    v_exp_f32 v104, v104
    v_mfma_f32_16x16x32_bf16 v[212:215], a[180:183], v[56:59], v[212:215]
    v_exp_f32 v105, v105
    v_mfma_f32_16x16x32_bf16 v[244:247], a[180:183], v[60:63], v[244:247]
    ds_read_b128 a[180:183], v20 offset:21504
    v_exp_f32 v106, v106
    v_mfma_f32_16x16x32_bf16 v[216:219], a[184:187], v[56:59], v[216:219]
    ds_write_b128 v11, v[184:187] offset:5120
    v_cvt_pk_bf16_f32 v49, v98, v99
    v_mfma_f32_16x16x32_bf16 v[248:251], a[184:187], v[60:63], v[248:251]
    ds_read_b128 a[184:187], v20 offset:22528
    v_exp_f32 v107, v107
    v_mfma_f32_16x16x32_bf16 v[220:223], a[188:191], v[56:59], v[220:223]
    v_exp_f32 v108, v108
    v_mfma_f32_16x16x32_bf16 v[252:255], a[188:191], v[60:63], v[252:255]
    ds_read_b128 a[188:191], v20 offset:23552
    v_exp_f32 v109, v109
    v_mfma_f32_16x16x32_bf16 v[192:195], a[160:163], v[56:59], v[192:195]
    ds_write_b128 v11, v[156:159] offset:6144
    v_cvt_pk_bf16_f32 v50, v100, v101
    v_mfma_f32_16x16x32_bf16 v[224:227], a[160:163], v[60:63], v[224:227]
    ds_read_b128 a[160:163], v19 offset:16384
    v_exp_f32 v110, v110
    v_mfma_f32_16x16x32_bf16 v[196:199], a[164:167], v[56:59], v[196:199]
    v_exp_f32 v111, v111
    v_mfma_f32_16x16x32_bf16 v[228:231], a[164:167], v[60:63], v[228:231]
    ds_read_b128 a[164:167], v19 offset:17408
    v_cvt_pk_bf16_f32 v51, v102, v103
    v_mfma_f32_16x16x32_bf16 v[200:203], a[168:171], v[56:59], v[200:203]
    ds_write_b128 v11, v[188:191] offset:7168
    v_cvt_pk_bf16_f32 v52, v104, v105
    v_mfma_f32_16x16x32_bf16 v[232:235], a[168:171], v[60:63], v[232:235]
    ds_read_b128 a[168:171], v19 offset:18432
    v_cvt_pk_bf16_f32 v53, v106, v107
    v_mfma_f32_16x16x32_bf16 v[204:207], a[172:175], v[56:59], v[204:207]
    v_cvt_pk_bf16_f32 v54, v108, v109
    v_cvt_pk_bf16_f32 v55, v110, v111
    v_mfma_f32_16x16x32_bf16 v[236:239], a[172:175], v[60:63], v[236:239]
    ds_read_b128 a[172:175], v19 offset:19456
    ds_write_b64 v12, v[32:33]
    s_add_u32 s101, s62, 98304
    v_xor_b32 v12, 8192, v12
    v_add_u32 v9, s101, v1
    s_waitcnt vmcnt(8)
    v_xor_b32 v8, 8192, v11
    v_xor_b32 v10, 8192, v9
L_t2_join:
    v_xor_b32 v19, 98304, v19
    v_xor_b32 v20, 98304, v20
    s_waitcnt lgkmcnt(0)
    s_barrier
    v_mfma_f32_16x16x32_bf16 v[40:43], v[28:31], v[48:51], v[40:43]
    s_lshl_b32 s100, s61, 20
    s_add_u32 s101, s100, s21
    ds_read_b64 v[120:121], v12
    v_mfma_f32_16x16x32_bf16 v[44:47], v[28:31], v[52:55], v[44:47]
    s_add_u32 s100, s100, s20
    ds_read_b128 v[144:147], v8 offset:0
    v_lshrrev_b32 v11, 4, v2
    v_mfma_f32_16x16x32_bf16 v[208:211], a[176:179], v[48:51], v[208:211]
    ds_read_b128 v[176:179], v8 offset:1024
    v_lshrrev_b32 v13, 2, v1
    v_mfma_f32_16x16x32_bf16 v[240:243], a[176:179], v[52:55], v[240:243]
    ds_read_b128 v[148:151], v8 offset:2048
    v_add_u32 v13, 131072, v13
    v_mfma_f32_16x16x32_bf16 v[212:215], a[180:183], v[48:51], v[212:215]
    s_xor_b32 s99, s62, 8192
    ds_read_b128 v[180:183], v8 offset:3072
    v_add_u32 v14, s99, v13
    v_mfma_f32_16x16x32_bf16 v[244:247], a[180:183], v[52:55], v[244:247]
    ds_read_b128 v[152:155], v8 offset:4096
    v_cmp_eq_u32 vcc, 1, v11
    v_mfma_f32_16x16x32_bf16 v[216:219], a[184:187], v[48:51], v[216:219]
    ds_read_b128 v[184:187], v8 offset:5120
    s_waitcnt lgkmcnt(6)
    v_add_f32 v112, v120, v32
    v_mfma_f32_16x16x32_bf16 v[248:251], a[184:187], v[52:55], v[248:251]
    ds_read_b128 v[156:159], v8 offset:6144
    v_add_f32 v114, v121, v36
    v_mfma_f32_16x16x32_bf16 v[220:223], a[188:191], v[48:51], v[220:223]
    ds_read_b128 v[188:191], v8 offset:7168
    v_cndmask_b32 v12, v32, v36, vcc
    v_mfma_f32_16x16x32_bf16 v[252:255], a[188:191], v[52:55], v[252:255]
    v_rcp_f32 v112, v112
    v_mfma_f32_16x16x32_bf16 v[192:195], a[160:163], v[48:51], v[192:195]
    v_rcp_f32 v114, v114
    v_mfma_f32_16x16x32_bf16 v[224:227], a[160:163], v[52:55], v[224:227]
    v_cmp_eq_u32 vcc, 2, v11
    v_cmp_eq_u32 s[96:97], 3, v11
    v_mfma_f32_16x16x32_bf16 v[196:199], a[164:167], v[48:51], v[196:199]
    ds_write_b128 v9, v[208:211] offset:0
    v_mfma_f32_16x16x32_bf16 v[228:231], a[164:167], v[52:55], v[228:231]
    v_mfma_f32_16x16x32_bf16 v[200:203], a[168:171], v[48:51], v[200:203]
    ds_write_b128 v9, v[240:243] offset:1024
    v_mfma_f32_16x16x32_bf16 v[232:235], a[168:171], v[52:55], v[232:235]
    v_mfma_f32_16x16x32_bf16 v[204:207], a[172:175], v[48:51], v[204:207]
    ds_write_b128 v9, v[212:215] offset:2048
    v_mfma_f32_16x16x32_bf16 v[236:239], a[172:175], v[52:55], v[236:239]
    v_cndmask_b32 v12, v12, v40, vcc
    v_cndmask_b32 v12, v12, v44, s[96:97]
    ds_write_b128 v9, v[244:247] offset:3072
    s_waitcnt lgkmcnt(11)
    v_pk_add_f32 v[128:129], v[128:129], v[144:145]
    v_pk_add_f32 v[130:131], v[130:131], v[146:147]
    s_waitcnt lgkmcnt(9)
    v_pk_add_f32 v[132:133], v[132:133], v[148:149]
    v_pk_add_f32 v[134:135], v[134:135], v[150:151]
    v_pk_mul_f32 v[128:129], v[128:129], v[112:113] op_sel_hi:[1,0]
    v_pk_mul_f32 v[130:131], v[130:131], v[112:113] op_sel_hi:[1,0]
    v_pk_mul_f32 v[132:133], v[132:133], v[112:113] op_sel_hi:[1,0]
    v_pk_mul_f32 v[134:135], v[134:135], v[112:113] op_sel_hi:[1,0]
    v_cvt_pk_bf16_f32 v128, v128, v129
    v_cvt_pk_bf16_f32 v129, v130, v131
    v_cvt_pk_bf16_f32 v130, v132, v133
    v_lshrrev_b32 v58, 2, v2
    v_and_b32 v57, 3, v2
    ds_write_b128 v9, v[216:219] offset:4096
    v_cvt_pk_bf16_f32 v131, v134, v135
    buffer_store_dwordx4 v[128:131], v1, s[8:11], s100 offen offset:0 sc0 sc1
    s_waitcnt lgkmcnt(8)
    v_pk_add_f32 v[136:137], v[136:137], v[152:153]
    v_pk_add_f32 v[138:139], v[138:139], v[154:155]
    s_waitcnt lgkmcnt(6)
    v_pk_add_f32 v[140:141], v[140:141], v[156:157]
    v_pk_add_f32 v[142:143], v[142:143], v[158:159]
    v_pk_mul_f32 v[136:137], v[136:137], v[112:113] op_sel_hi:[1,0]
    v_pk_mul_f32 v[138:139], v[138:139], v[112:113] op_sel_hi:[1,0]
    v_pk_mul_f32 v[140:141], v[140:141], v[112:113] op_sel_hi:[1,0]
    v_pk_mul_f32 v[142:143], v[142:143], v[112:113] op_sel_hi:[1,0]
    v_cvt_pk_bf16_f32 v136, v136, v137
    v_lshlrev_b32 v56, 7, v58
    v_lshl_add_u32 v56, v57, 3, v56
    v_bfe_u32 v57, v2, 3, 2
    ds_write_b128 v9, v[248:251] offset:5120
    v_cvt_pk_bf16_f32 v137, v138, v139
    v_cvt_pk_bf16_f32 v138, v140, v141
    v_cvt_pk_bf16_f32 v139, v142, v143
    buffer_store_dwordx4 v[136:139], v1, s[8:11], s100 offen offset:1024 sc0 sc1
    v_pk_add_f32 v[160:161], v[160:161], v[176:177]
    v_pk_add_f32 v[162:163], v[162:163], v[178:179]
    v_pk_add_f32 v[164:165], v[164:165], v[180:181]
    v_pk_add_f32 v[166:167], v[166:167], v[182:183]
    v_pk_mul_f32 v[160:161], v[160:161], v[114:115] op_sel_hi:[1,0]
    v_pk_mul_f32 v[162:163], v[162:163], v[114:115] op_sel_hi:[1,0]
    v_pk_mul_f32 v[164:165], v[164:165], v[114:115] op_sel_hi:[1,0]
    v_lshl_add_u32 v56, v57, 5, v56
    v_xor_b32 v57, 32, v56
    ds_write_b128 v9, v[220:223] offset:6144
    v_pk_mul_f32 v[166:167], v[166:167], v[114:115] op_sel_hi:[1,0]
    v_cvt_pk_bf16_f32 v160, v160, v161
    v_cvt_pk_bf16_f32 v161, v162, v163
    v_cvt_pk_bf16_f32 v162, v164, v165
    v_cvt_pk_bf16_f32 v163, v166, v167
    buffer_store_dwordx4 v[160:163], v15, s[8:11], s100 offen offset:0 sc0 sc1
    v_pk_add_f32 v[168:169], v[168:169], v[184:185]
    v_pk_add_f32 v[170:171], v[170:171], v[186:187]
    s_waitcnt lgkmcnt(7)
    v_pk_add_f32 v[172:173], v[172:173], v[188:189]
    v_pk_add_f32 v[174:175], v[174:175], v[190:191]
    v_pk_mul_f32 v[168:169], v[168:169], v[114:115] op_sel_hi:[1,0]
    v_xor_b32 v58, 64, v56
    v_xor_b32 v59, 96, v56
    v_add_u32 v60, 65536, v56
    ds_write_b128 v9, v[252:255] offset:7168
    v_pk_mul_f32 v[170:171], v[170:171], v[114:115] op_sel_hi:[1,0]
    v_pk_mul_f32 v[172:173], v[172:173], v[114:115] op_sel_hi:[1,0]
    v_pk_mul_f32 v[174:175], v[174:175], v[114:115] op_sel_hi:[1,0]
    v_cvt_pk_bf16_f32 v168, v168, v169
    v_cvt_pk_bf16_f32 v169, v170, v171
    v_cvt_pk_bf16_f32 v170, v172, v173
    v_cvt_pk_bf16_f32 v171, v174, v175
    buffer_store_dwordx4 v[168:171], v15, s[8:11], s100 offen offset:1024 sc0 sc1
    v_add_u32 v61, 65536, v57
    v_add_u32 v62, 65536, v58
    v_add_u32 v63, 65536, v59
    ds_write_b32 v14, v12
    v_and_b32 v14, 4294967103, v13
    v_add_u32 v14, s62, v14
    s_waitcnt lgkmcnt(0)
    s_barrier
    ds_read_b32 v116, v14 offset:128
    ds_read_b32 v118, v14 offset:192
    ds_read_b128 v[208:211], v10 offset:0
    ds_read_b128 v[212:215], v10 offset:2048
    ds_read_b128 v[216:219], v10 offset:4096
    ds_read_b128 v[220:223], v10 offset:6144
    ds_read_b128 v[240:243], v10 offset:1024
    ds_read_b128 v[244:247], v10 offset:3072
    ds_read_b128 v[248:251], v10 offset:5120
    ds_read_b128 v[252:255], v10 offset:7168
    ds_read_b32 v120, v13 offset:0
    ds_read_b32 v121, v13 offset:8192
    ds_read_b32 v122, v13 offset:16384
    ds_read_b32 v123, v13 offset:24576
    s_waitcnt lgkmcnt(13)
    v_add_f32 v116, v116, v40
    s_waitcnt lgkmcnt(12)
    v_add_f32 v118, v118, v44
    v_rcp_f32 v116, v116
    v_rcp_f32 v118, v118
    s_waitcnt lgkmcnt(11)
    v_pk_add_f32 v[192:193], v[192:193], v[208:209]
    v_pk_add_f32 v[194:195], v[194:195], v[210:211]
    s_waitcnt lgkmcnt(10)
    v_pk_add_f32 v[196:197], v[196:197], v[212:213]
    v_pk_add_f32 v[198:199], v[198:199], v[214:215]
    v_pk_mul_f32 v[192:193], v[192:193], v[116:117] op_sel_hi:[1,0]
    v_pk_mul_f32 v[194:195], v[194:195], v[116:117] op_sel_hi:[1,0]
    v_pk_mul_f32 v[196:197], v[196:197], v[116:117] op_sel_hi:[1,0]
    v_pk_mul_f32 v[198:199], v[198:199], v[116:117] op_sel_hi:[1,0]
    v_cvt_pk_bf16_f32 v192, v192, v193
    v_cvt_pk_bf16_f32 v193, v194, v195
    v_cvt_pk_bf16_f32 v194, v196, v197
    v_cvt_pk_bf16_f32 v195, v198, v199
    buffer_store_dwordx4 v[192:195], v1, s[8:11], s101 offen offset:0 sc0 sc1
    s_waitcnt lgkmcnt(9)
    v_pk_add_f32 v[200:201], v[200:201], v[216:217]
    v_pk_add_f32 v[202:203], v[202:203], v[218:219]
    s_waitcnt lgkmcnt(8)
    v_pk_add_f32 v[204:205], v[204:205], v[220:221]
    v_pk_add_f32 v[206:207], v[206:207], v[222:223]
    v_pk_mul_f32 v[200:201], v[200:201], v[116:117] op_sel_hi:[1,0]
    v_pk_mul_f32 v[202:203], v[202:203], v[116:117] op_sel_hi:[1,0]
    v_pk_mul_f32 v[204:205], v[204:205], v[116:117] op_sel_hi:[1,0]
    v_pk_mul_f32 v[206:207], v[206:207], v[116:117] op_sel_hi:[1,0]
    v_cvt_pk_bf16_f32 v200, v200, v201
    v_cvt_pk_bf16_f32 v201, v202, v203
    v_cvt_pk_bf16_f32 v202, v204, v205
    v_cvt_pk_bf16_f32 v203, v206, v207
    buffer_store_dwordx4 v[200:203], v1, s[8:11], s101 offen offset:1024 sc0 sc1
    s_waitcnt lgkmcnt(2)
    v_add_f32 v120, v120, v121
    s_waitcnt lgkmcnt(0)
    v_add_f32 v122, v122, v123
    v_min_f32 v124, v120, v122
    v_add_f32 v120, v120, v122
    v_cmp_le_f32 vcc, 0x1f800000, v124
    s_mov_b64 s[96:97], vcc
    v_cmp_ge_f32 vcc, 0x67800000, v120
    s_and_b64 s[96:97], s[96:97], vcc
    s_cmp_eq_u64 s[96:97], -1
    s_cselect_b32 s96, s25, 1
    s_cmp_lg_u32 s96, 0
    s_cbranch_scc1 L_t2_redo
L_t2_safe:
    v_pk_add_f32 v[224:225], v[224:225], v[240:241]
    v_pk_add_f32 v[226:227], v[226:227], v[242:243]
    v_pk_add_f32 v[228:229], v[228:229], v[244:245]
    v_pk_add_f32 v[230:231], v[230:231], v[246:247]
    v_pk_mul_f32 v[224:225], v[224:225], v[118:119] op_sel_hi:[1,0]
    v_pk_mul_f32 v[226:227], v[226:227], v[118:119] op_sel_hi:[1,0]
    v_pk_mul_f32 v[228:229], v[228:229], v[118:119] op_sel_hi:[1,0]
    v_pk_mul_f32 v[230:231], v[230:231], v[118:119] op_sel_hi:[1,0]
    v_cvt_pk_bf16_f32 v224, v224, v225
    v_cvt_pk_bf16_f32 v225, v226, v227
    v_cvt_pk_bf16_f32 v226, v228, v229
    v_cvt_pk_bf16_f32 v227, v230, v231
    buffer_store_dwordx4 v[224:227], v15, s[8:11], s101 offen offset:0 sc0 sc1
    ds_read_b64_tr_b16 a[192:193], v56 offset:32768
    ds_read_b64_tr_b16 a[194:195], v56 offset:34816
    ds_read_b64_tr_b16 a[196:197], v56 offset:36864
    ds_read_b64_tr_b16 a[198:199], v56 offset:38912
    ds_read_b64_tr_b16 a[200:201], v57 offset:32768
    ds_read_b64_tr_b16 a[202:203], v57 offset:34816
    ds_read_b64_tr_b16 a[204:205], v57 offset:36864
    ds_read_b64_tr_b16 a[206:207], v57 offset:38912
    v_pk_add_f32 v[232:233], v[232:233], v[248:249]
    v_pk_add_f32 v[234:235], v[234:235], v[250:251]
    v_pk_add_f32 v[236:237], v[236:237], v[252:253]
    v_pk_add_f32 v[238:239], v[238:239], v[254:255]
    v_pk_mul_f32 v[232:233], v[232:233], v[118:119] op_sel_hi:[1,0]
    v_pk_mul_f32 v[234:235], v[234:235], v[118:119] op_sel_hi:[1,0]
    v_pk_mul_f32 v[236:237], v[236:237], v[118:119] op_sel_hi:[1,0]
    v_pk_mul_f32 v[238:239], v[238:239], v[118:119] op_sel_hi:[1,0]
    v_cvt_pk_bf16_f32 v232, v232, v233
    v_cvt_pk_bf16_f32 v233, v234, v235
    v_cvt_pk_bf16_f32 v234, v236, v237
    v_cvt_pk_bf16_f32 v235, v238, v239
    buffer_store_dwordx4 v[232:235], v15, s[8:11], s101 offen offset:1024 sc0 sc1
    ds_read_b64_tr_b16 a[208:209], v56 offset:40960
    ds_read_b64_tr_b16 a[210:211], v56 offset:43008
    ds_read_b64_tr_b16 a[212:213], v56 offset:45056
    ds_read_b64_tr_b16 a[214:215], v56 offset:47104
    ds_read_b64_tr_b16 a[216:217], v57 offset:40960
    ds_read_b64_tr_b16 a[218:219], v57 offset:43008
    ds_read_b64_tr_b16 a[220:221], v57 offset:45056
    ds_read_b64_tr_b16 a[222:223], v57 offset:47104
    s_waitcnt lgkmcnt(14)
    v_mfma_f32_16x16x32_bf16 v[64:67], a[192:195], a[64:67], 0
    s_waitcnt lgkmcnt(12)
    s_add_u32 m0, s62, 0
    ds_read_b64_tr_b16 a[224:225], v56 offset:49152
    v_mfma_f32_16x16x32_bf16 v[64:67], a[196:199], a[68:71], v[64:67]
    s_xor_b32 s98, s65, 128
    ds_read_b64_tr_b16 a[226:227], v56 offset:51200
    v_mfma_f32_16x16x32_bf16 v[72:75], a[192:195], a[80:83], 0
    buffer_load_dwordx4 v24, s[28:31], s98 offen offset:0   lds
    v_mfma_f32_16x16x32_bf16 v[72:75], a[196:199], a[84:87], v[72:75]
    s_waitcnt lgkmcnt(12)
    ds_read_b64_tr_b16 a[228:229], v56 offset:53248
    v_mfma_f32_16x16x32_bf16 v[68:71], a[200:203], a[64:67], 0
    s_waitcnt lgkmcnt(11)
    ds_read_b64_tr_b16 a[230:231], v56 offset:55296
    v_mfma_f32_16x16x32_bf16 v[68:71], a[204:207], a[68:71], v[68:71]
    s_add_u32 s22, s22, 65536
    ds_read_b64_tr_b16 a[232:233], v57 offset:49152
    v_mfma_f32_16x16x32_bf16 v[76:79], a[200:203], a[80:83], 0
    buffer_load_dwordx4 v25, s[28:31], s98 offen offset:1024   lds
    ds_read_b64_tr_b16 a[234:235], v57 offset:51200
    v_mfma_f32_16x16x32_bf16 v[76:79], a[204:207], a[84:87], v[76:79]
    s_waitcnt lgkmcnt(12)
    s_add_u32 s23, s23, 65536
    ds_read_b64_tr_b16 a[236:237], v57 offset:53248
    v_mfma_f32_16x16x32_bf16 v[64:67], a[208:211], a[72:75], v[64:67]
    s_waitcnt lgkmcnt(11)
    s_lshl_b32 s24, s61, 2
    ds_read_b64_tr_b16 a[238:239], v57 offset:55296
    v_mfma_f32_16x16x32_bf16 v[64:67], a[212:215], a[76:79], v[64:67]
    s_add_u32 s24, s24, s3
    ds_read_b64_tr_b16 a[240:241], v56 offset:57344
    v_mfma_f32_16x16x32_bf16 v[72:75], a[208:211], a[88:91], v[72:75]
    buffer_load_dwordx4 v26, s[28:31], s98 offen offset:2048   lds
    v_mfma_f32_16x16x32_bf16 v[72:75], a[212:215], a[92:95], v[72:75]
    s_waitcnt lgkmcnt(7)
    s_lshl_b32 s24, s24, 3
    ds_read_b64_tr_b16 a[242:243], v56 offset:59392
    v_mfma_f32_16x16x32_bf16 v[68:71], a[216:219], a[72:75], v[68:71]
    s_add_u32 s24, s24, s4
    ds_read_b64_tr_b16 a[244:245], v56 offset:61440
    v_mfma_f32_16x16x32_bf16 v[68:71], a[220:223], a[76:79], v[68:71]
    s_lshl_b32 s24, s24, 2
    ds_read_b64_tr_b16 a[246:247], v56 offset:63488
    v_mfma_f32_16x16x32_bf16 v[76:79], a[216:219], a[88:91], v[76:79]
    buffer_load_dwordx4 v27, s[28:31], s98 offen offset:3072   lds
    ds_read_b64_tr_b16 a[248:249], v57 offset:57344
    v_mfma_f32_16x16x32_bf16 v[76:79], a[220:223], a[92:95], v[76:79]
    s_add_u32 m0, s62, 4096
    ds_read_b64_tr_b16 a[250:251], v57 offset:59392
    v_mfma_f32_16x16x32_bf16 v[64:67], a[224:227], a[96:99], v[64:67]
    s_waitcnt lgkmcnt(8)
    s_xor_b32 s98, s65, 32896
    ds_read_b64_tr_b16 a[252:253], v57 offset:61440
    v_mfma_f32_16x16x32_bf16 v[64:67], a[228:231], a[100:103], v[64:67]
    s_add_u32 s24, s24, s5
    ds_read_b64_tr_b16 a[254:255], v57 offset:63488
    v_mfma_f32_16x16x32_bf16 v[72:75], a[224:227], a[112:115], v[72:75]
    buffer_load_dwordx4 v24, s[28:31], s98 offen offset:0   lds
    v_mfma_f32_16x16x32_bf16 v[72:75], a[228:231], a[116:119], v[72:75]
    s_lshl_b32 s24, s24, 13
    ds_read_b64_tr_b16 a[192:193], v58 offset:32768
    v_mfma_f32_16x16x32_bf16 v[68:71], a[232:235], a[96:99], v[68:71]
    s_waitcnt lgkmcnt(8)
    s_add_u32 s24, s24, 50331648
    ds_read_b64_tr_b16 a[194:195], v58 offset:34816
    v_mfma_f32_16x16x32_bf16 v[68:71], a[236:239], a[100:103], v[68:71]
    ds_read_b64_tr_b16 a[196:197], v58 offset:36864
    v_mfma_f32_16x16x32_bf16 v[76:79], a[232:235], a[112:115], v[76:79]
    buffer_load_dwordx4 v25, s[28:31], s98 offen offset:1024   lds
    ds_read_b64_tr_b16 a[198:199], v58 offset:38912
    v_mfma_f32_16x16x32_bf16 v[76:79], a[236:239], a[116:119], v[76:79]
    s_waitcnt lgkmcnt(8)
    ds_read_b64_tr_b16 a[200:201], v59 offset:32768
    v_mfma_f32_16x16x32_bf16 v[64:67], a[240:243], a[104:107], v[64:67]
    ds_read_b64_tr_b16 a[202:203], v59 offset:34816
    v_mfma_f32_16x16x32_bf16 v[64:67], a[244:247], a[108:111], v[64:67]
    ds_read_b64_tr_b16 a[204:205], v59 offset:36864
    v_mfma_f32_16x16x32_bf16 v[72:75], a[240:243], a[120:123], v[72:75]
    buffer_load_dwordx4 v26, s[28:31], s98 offen offset:2048   lds
    ds_read_b64_tr_b16 a[206:207], v59 offset:38912
    v_mfma_f32_16x16x32_bf16 v[72:75], a[244:247], a[124:127], v[72:75]
    s_waitcnt lgkmcnt(8)
    ds_read_b64_tr_b16 a[208:209], v58 offset:40960
    v_mfma_f32_16x16x32_bf16 v[68:71], a[248:251], a[104:107], v[68:71]
    ds_read_b64_tr_b16 a[210:211], v58 offset:43008
    v_mfma_f32_16x16x32_bf16 v[68:71], a[252:255], a[108:111], v[68:71]
    ds_read_b64_tr_b16 a[212:213], v58 offset:45056
    v_mfma_f32_16x16x32_bf16 v[76:79], a[248:251], a[120:123], v[76:79]
    buffer_load_dwordx4 v27, s[28:31], s98 offen offset:3072   lds
    ds_read_b64_tr_b16 a[214:215], v58 offset:47104
    v_mfma_f32_16x16x32_bf16 v[76:79], a[252:255], a[124:127], v[76:79]
    s_waitcnt lgkmcnt(9)
    ds_read_b64_tr_b16 a[216:217], v59 offset:40960
    v_mfma_f32_16x16x32_bf16 v[80:83], a[192:195], a[64:67], 0
    s_waitcnt lgkmcnt(9)
    ds_read_b64_tr_b16 a[218:219], v59 offset:43008
    v_mfma_f32_16x16x32_bf16 v[80:83], a[196:199], a[68:71], v[80:83]
    ds_read_b64_tr_b16 a[220:221], v59 offset:45056
    v_mfma_f32_16x16x32_bf16 v[88:91], a[192:195], a[80:83], 0
    ds_read_b64_tr_b16 a[222:223], v59 offset:47104
    s_waitcnt vmcnt(16)
    s_barrier
    v_mfma_f32_16x16x32_bf16 v[88:91], a[196:199], a[84:87], v[88:91]
    s_waitcnt lgkmcnt(9)
    s_add_u32 m0, s62, 98304
    ds_read_b64_tr_b16 a[224:225], v58 offset:49152
    v_mfma_f32_16x16x32_bf16 v[84:87], a[200:203], a[64:67], 0
    s_waitcnt lgkmcnt(9)
    s_xor_b32 s98, s65, 262272
    ds_read_b64_tr_b16 a[226:227], v58 offset:51200
    v_mfma_f32_16x16x32_bf16 v[84:87], a[204:207], a[68:71], v[84:87]
    buffer_load_dwordx4 v24, s[28:31], s98 offen offset:0   lds
    ds_read_b64_tr_b16 a[228:229], v58 offset:53248
    v_mfma_f32_16x16x32_bf16 v[92:95], a[200:203], a[80:83], 0
    ds_read_b64_tr_b16 a[230:231], v58 offset:55296
    v_mfma_f32_16x16x32_bf16 v[92:95], a[204:207], a[84:87], v[92:95]
    s_waitcnt lgkmcnt(9)
    ds_read_b64_tr_b16 a[232:233], v59 offset:49152
    v_mfma_f32_16x16x32_bf16 v[80:83], a[208:211], a[72:75], v[80:83]
    s_waitcnt lgkmcnt(9)
    ds_read_b64_tr_b16 a[234:235], v59 offset:51200
    v_mfma_f32_16x16x32_bf16 v[80:83], a[212:215], a[76:79], v[80:83]
    buffer_load_dwordx4 v25, s[28:31], s98 offen offset:1024   lds
    ds_read_b64_tr_b16 a[236:237], v59 offset:53248
    v_mfma_f32_16x16x32_bf16 v[88:91], a[208:211], a[88:91], v[88:91]
    ds_read_b64_tr_b16 a[238:239], v59 offset:55296
    v_mfma_f32_16x16x32_bf16 v[88:91], a[212:215], a[92:95], v[88:91]
    s_waitcnt lgkmcnt(9)
    ds_read_b64_tr_b16 a[240:241], v58 offset:57344
    v_mfma_f32_16x16x32_bf16 v[84:87], a[216:219], a[72:75], v[84:87]
    s_waitcnt lgkmcnt(9)
    ds_read_b64_tr_b16 a[242:243], v58 offset:59392
    v_mfma_f32_16x16x32_bf16 v[84:87], a[220:223], a[76:79], v[84:87]
    buffer_load_dwordx4 v26, s[28:31], s98 offen offset:2048   lds
    ds_read_b64_tr_b16 a[244:245], v58 offset:61440
    v_mfma_f32_16x16x32_bf16 v[92:95], a[216:219], a[88:91], v[92:95]
    ds_read_b64_tr_b16 a[246:247], v58 offset:63488
    v_mfma_f32_16x16x32_bf16 v[92:95], a[220:223], a[92:95], v[92:95]
    s_waitcnt lgkmcnt(9)
    ds_read_b64_tr_b16 a[248:249], v59 offset:57344
    v_mfma_f32_16x16x32_bf16 v[80:83], a[224:227], a[96:99], v[80:83]
    s_waitcnt lgkmcnt(9)
    ds_read_b64_tr_b16 a[250:251], v59 offset:59392
    v_mfma_f32_16x16x32_bf16 v[80:83], a[228:231], a[100:103], v[80:83]
    buffer_load_dwordx4 v27, s[28:31], s98 offen offset:3072   lds
    ds_read_b64_tr_b16 a[252:253], v59 offset:61440
    v_mfma_f32_16x16x32_bf16 v[88:91], a[224:227], a[112:115], v[88:91]
    s_add_u32 m0, s62, 102400
    ds_read_b64_tr_b16 a[254:255], v59 offset:63488
    v_mfma_f32_16x16x32_bf16 v[88:91], a[228:231], a[116:119], v[88:91]
    s_waitcnt lgkmcnt(9)
    s_xor_b32 s98, s65, 295040
    ds_read_b64_tr_b16 a[192:193], v60 offset:0
    v_mfma_f32_16x16x32_bf16 v[84:87], a[232:235], a[96:99], v[84:87]
    s_waitcnt lgkmcnt(9)
    ds_read_b64_tr_b16 a[194:195], v60 offset:2048
    v_mfma_f32_16x16x32_bf16 v[84:87], a[236:239], a[100:103], v[84:87]
    buffer_load_dwordx4 v24, s[28:31], s98 offen offset:0   lds
    ds_read_b64_tr_b16 a[196:197], v60 offset:4096
    v_mfma_f32_16x16x32_bf16 v[92:95], a[232:235], a[112:115], v[92:95]
    ds_read_b64_tr_b16 a[198:199], v60 offset:6144
    v_mfma_f32_16x16x32_bf16 v[92:95], a[236:239], a[116:119], v[92:95]
    s_waitcnt lgkmcnt(9)
    ds_read_b64_tr_b16 a[200:201], v61 offset:0
    v_mfma_f32_16x16x32_bf16 v[80:83], a[240:243], a[104:107], v[80:83]
    s_waitcnt lgkmcnt(9)
    ds_read_b64_tr_b16 a[202:203], v61 offset:2048
    v_mfma_f32_16x16x32_bf16 v[80:83], a[244:247], a[108:111], v[80:83]
    buffer_load_dwordx4 v25, s[28:31], s98 offen offset:1024   lds
    ds_read_b64_tr_b16 a[204:205], v61 offset:4096
    v_mfma_f32_16x16x32_bf16 v[88:91], a[240:243], a[120:123], v[88:91]
    ds_read_b64_tr_b16 a[206:207], v61 offset:6144
    v_mfma_f32_16x16x32_bf16 v[88:91], a[244:247], a[124:127], v[88:91]
    s_waitcnt lgkmcnt(9)
    ds_read_b64_tr_b16 a[208:209], v60 offset:8192
    v_mfma_f32_16x16x32_bf16 v[84:87], a[248:251], a[104:107], v[84:87]
    s_waitcnt lgkmcnt(9)
    ds_read_b64_tr_b16 a[210:211], v60 offset:10240
    v_lshrrev_b32 v46, 2, v2
    v_mfma_f32_16x16x32_bf16 v[84:87], a[252:255], a[108:111], v[84:87]
    buffer_load_dwordx4 v26, s[28:31], s98 offen offset:2048   lds
    ds_read_b64_tr_b16 a[212:213], v60 offset:12288
    v_mfma_f32_16x16x32_bf16 v[92:95], a[248:251], a[120:123], v[92:95]
    ds_read_b64_tr_b16 a[214:215], v60 offset:14336
    v_and_b32 v45, 3, v2
    v_mfma_f32_16x16x32_bf16 v[92:95], a[252:255], a[124:127], v[92:95]
    s_waitcnt lgkmcnt(9)
    ds_read_b64_tr_b16 a[216:217], v61 offset:8192
    v_lshlrev_b32 v44, 8, v46
    v_mfma_f32_16x16x32_bf16 v[64:67], a[192:195], a[0:3], v[64:67]
    s_waitcnt lgkmcnt(9)
    ds_read_b64_tr_b16 a[218:219], v61 offset:10240
    v_lshl_add_u32 v44, v45, 4, v44
    v_mfma_f32_16x16x32_bf16 v[64:67], a[196:199], a[4:7], v[64:67]
    buffer_load_dwordx4 v27, s[28:31], s98 offen offset:3072   lds
    ds_read_b64_tr_b16 a[220:221], v61 offset:12288
    v_mfma_f32_16x16x32_bf16 v[72:75], a[192:195], a[16:19], v[72:75]
    ds_read_b64_tr_b16 a[222:223], v61 offset:14336
    v_lshlrev_b32 v45, 3, v45
    v_mfma_f32_16x16x32_bf16 v[72:75], a[196:199], a[20:23], v[72:75]
    s_waitcnt lgkmcnt(9)
    ds_read_b64_tr_b16 a[224:225], v60 offset:16384
    v_lshl_add_u32 v45, v46, 6, v45
    v_mfma_f32_16x16x32_bf16 v[68:71], a[200:203], a[0:3], v[68:71]
    s_waitcnt lgkmcnt(9)
    ds_read_b64_tr_b16 a[226:227], v60 offset:18432
    v_lshlrev_b32 v46, 1, v45
    v_mfma_f32_16x16x32_bf16 v[68:71], a[204:207], a[4:7], v[68:71]
    s_lshl_b32 s70, s2, 15
    ds_read_b64_tr_b16 a[228:229], v60 offset:20480
    v_mfma_f32_16x16x32_bf16 v[76:79], a[200:203], a[16:19], v[76:79]
    s_lshl_b32 s100, s3, 6
    ds_read_b64_tr_b16 a[230:231], v60 offset:22528
    v_mfma_f32_16x16x32_bf16 v[76:79], a[204:207], a[20:23], v[76:79]
    s_waitcnt lgkmcnt(9)
    s_add_u32 s70, s70, s100
    ds_read_b64_tr_b16 a[232:233], v61 offset:16384
    v_mfma_f32_16x16x32_bf16 v[64:67], a[208:211], a[8:11], v[64:67]
    s_waitcnt lgkmcnt(9)
    s_add_u32 s70, s70, 67108864
    ds_read_b64_tr_b16 a[234:235], v61 offset:18432
    v_mfma_f32_16x16x32_bf16 v[64:67], a[212:215], a[12:15], v[64:67]
    s_and_b32 s68, s2, 31
    ds_read_b64_tr_b16 a[236:237], v61 offset:20480
    v_mfma_f32_16x16x32_bf16 v[72:75], a[208:211], a[24:27], v[72:75]
    s_lshl_b32 s68, s68, 2
    ds_read_b64_tr_b16 a[238:239], v61 offset:22528
    v_mfma_f32_16x16x32_bf16 v[72:75], a[212:215], a[28:31], v[72:75]
    s_waitcnt lgkmcnt(9)
    s_add_u32 s68, s68, s3
    ds_read_b64_tr_b16 a[240:241], v60 offset:24576
    v_mfma_f32_16x16x32_bf16 v[68:71], a[216:219], a[8:11], v[68:71]
    s_waitcnt lgkmcnt(9)
    s_lshl_b32 s69, s61, 7
    ds_read_b64_tr_b16 a[242:243], v60 offset:26624
    v_mfma_f32_16x16x32_bf16 v[68:71], a[220:223], a[12:15], v[68:71]
    s_add_u32 s69, s69, s68
    ds_read_b64_tr_b16 a[244:245], v60 offset:28672
    v_mfma_f32_16x16x32_bf16 v[76:79], a[216:219], a[24:27], v[76:79]
    s_lshl_b32 s100, s60, 7
    ds_read_b64_tr_b16 a[246:247], v60 offset:30720
    v_mfma_f32_16x16x32_bf16 v[76:79], a[220:223], a[28:31], v[76:79]
    s_waitcnt lgkmcnt(9)
    s_add_u32 s68, s68, s100
    ds_read_b64_tr_b16 a[248:249], v61 offset:24576
    v_mfma_f32_16x16x32_bf16 v[64:67], a[224:227], a[32:35], v[64:67]
    s_waitcnt lgkmcnt(9)
    s_lshl_b32 s100, s68, 10
    ds_read_b64_tr_b16 a[250:251], v61 offset:26624
    v_mfma_f32_16x16x32_bf16 v[64:67], a[228:231], a[36:39], v[64:67]
    s_lshl_b32 s101, s69, 10
    ds_read_b64_tr_b16 a[252:253], v61 offset:28672
    v_mfma_f32_16x16x32_bf16 v[72:75], a[224:227], a[48:51], v[72:75]
    ds_read_b64_tr_b16 a[254:255], v61 offset:30720
    ds_read_b64_tr_b16 a[208:209], v62 offset:8192
    v_mfma_f32_16x16x32_bf16 v[72:75], a[228:231], a[52:55], v[72:75]
    s_waitcnt lgkmcnt(10)
    ds_read_b64_tr_b16 a[192:193], v62 offset:0
    ds_read_b64_tr_b16 a[210:211], v62 offset:10240
    v_mfma_f32_16x16x32_bf16 v[68:71], a[232:235], a[32:35], v[68:71]
    s_waitcnt lgkmcnt(11)
    ds_read_b64_tr_b16 a[194:195], v62 offset:2048
    ds_read_b64_tr_b16 a[212:213], v62 offset:12288
    v_mfma_f32_16x16x32_bf16 v[68:71], a[236:239], a[36:39], v[68:71]
    ds_read_b64_tr_b16 a[196:197], v62 offset:4096
    ds_read_b64_tr_b16 a[214:215], v62 offset:14336
    v_mfma_f32_16x16x32_bf16 v[76:79], a[232:235], a[48:51], v[76:79]
    ds_read_b64_tr_b16 a[198:199], v62 offset:6144
    ds_read_b64_tr_b16 a[216:217], v63 offset:8192
    v_mfma_f32_16x16x32_bf16 v[76:79], a[236:239], a[52:55], v[76:79]
    s_waitcnt lgkmcnt(14)
    ds_read_b64_tr_b16 a[200:201], v63 offset:0
    ds_read_b64_tr_b16 a[218:219], v63 offset:10240
    v_mfma_f32_16x16x32_bf16 v[64:67], a[240:243], a[40:43], v[64:67]
    s_waitcnt lgkmcnt(15)
    ds_read_b64_tr_b16 a[202:203], v63 offset:2048
    ds_read_b64_tr_b16 a[220:221], v63 offset:12288
    v_mfma_f32_16x16x32_bf16 v[64:67], a[244:247], a[44:47], v[64:67]
    ds_read_b64_tr_b16 a[204:205], v63 offset:4096
    ds_read_b64_tr_b16 a[222:223], v63 offset:14336
    v_mfma_f32_16x16x32_bf16 v[72:75], a[240:243], a[56:59], v[72:75]
    s_waitcnt lgkmcnt(15)
    ds_read_b64_tr_b16 a[206:207], v63 offset:6144
    s_waitcnt vmcnt(16)
    v_mfma_f32_16x16x32_bf16 v[72:75], a[244:247], a[60:63], v[72:75]
    buffer_store_dword v6, v5, s[8:11], s22 offen sc0 sc1
    v_mfma_f32_16x16x32_bf16 v[68:71], a[248:251], a[40:43], v[68:71]
    ds_read_b64_tr_b16 a[224:225], v62 offset:16384
    v_mfma_f32_16x16x32_bf16 v[68:71], a[252:255], a[44:47], v[68:71]
    ds_read_b64_tr_b16 a[226:227], v62 offset:18432
    v_mfma_f32_16x16x32_bf16 v[76:79], a[248:251], a[56:59], v[76:79]
    ds_read_b64_tr_b16 a[228:229], v62 offset:20480
    v_mfma_f32_16x16x32_bf16 v[76:79], a[252:255], a[60:63], v[76:79]
    s_waitcnt lgkmcnt(12)
    ds_read_b64_tr_b16 a[230:231], v62 offset:22528
    v_mfma_f32_16x16x32_bf16 v[80:83], a[192:195], a[0:3], v[80:83]
    s_waitcnt lgkmcnt(11)
    ds_read_b64_tr_b16 a[232:233], v63 offset:16384
    v_mfma_f32_16x16x32_bf16 v[80:83], a[196:199], a[4:7], v[80:83]
    ds_read_b64_tr_b16 a[234:235], v63 offset:18432
    v_mfma_f32_16x16x32_bf16 v[88:91], a[192:195], a[16:19], v[88:91]
    ds_read_b64_tr_b16 a[236:237], v63 offset:20480
    v_mfma_f32_16x16x32_bf16 v[88:91], a[196:199], a[20:23], v[88:91]
    s_waitcnt lgkmcnt(8)
    ds_read_b64_tr_b16 a[238:239], v63 offset:22528
    v_mfma_f32_16x16x32_bf16 v[84:87], a[200:203], a[0:3], v[84:87]
    s_waitcnt lgkmcnt(8)
    ds_read_b64_tr_b16 a[240:241], v62 offset:24576
    v_mfma_f32_16x16x32_bf16 v[84:87], a[204:207], a[4:7], v[84:87]
    ds_read_b64_tr_b16 a[242:243], v62 offset:26624
    v_mfma_f32_16x16x32_bf16 v[92:95], a[200:203], a[16:19], v[92:95]
    ds_read_b64_tr_b16 a[244:245], v62 offset:28672
    v_cvt_pk_bf16_f32 v64, v64, v65
    s_waitcnt vmcnt(1)
    s_barrier
    v_mfma_f32_16x16x32_bf16 v[92:95], a[204:207], a[20:23], v[92:95]
    s_xor_b32 s74, s24, 0
    ds_read_b64_tr_b16 a[246:247], v62 offset:30720
    v_cvt_pk_bf16_f32 v65, v66, v67
    v_mfma_f32_16x16x32_bf16 v[80:83], a[208:211], a[8:11], v[80:83]
    buffer_load_dwordx4 v[128:131], v1, s[8:11], s74 offen offset:0
    v_mfma_f32_16x16x32_bf16 v[80:83], a[212:215], a[12:15], v[80:83]
    s_xor_b32 s74, s24, 4096
    ds_read_b64_tr_b16 a[248:249], v63 offset:24576
    v_cvt_pk_bf16_f32 v66, v68, v69
    v_mfma_f32_16x16x32_bf16 v[88:91], a[208:211], a[24:27], v[88:91]
    ds_read_b64_tr_b16 a[250:251], v63 offset:26624
    v_cvt_pk_bf16_f32 v67, v70, v71
    v_mfma_f32_16x16x32_bf16 v[88:91], a[212:215], a[28:31], v[88:91]
    buffer_load_dwordx4 v[144:147], v1, s[8:11], s74 offen offset:0
    ds_read_b64_tr_b16 a[252:253], v63 offset:28672
    v_mfma_f32_16x16x32_bf16 v[84:87], a[216:219], a[8:11], v[84:87]
    s_xor_b32 s74, s24, 0
    ds_read_b64_tr_b16 a[254:255], v63 offset:30720
    v_min_u32 v64, -2, v64
    v_mfma_f32_16x16x32_bf16 v[84:87], a[220:223], a[12:15], v[84:87]
    ds_read_b64_tr_b16 a[192:193], v56 offset:0
    v_min_u32 v65, -2, v65
    v_mfma_f32_16x16x32_bf16 v[92:95], a[216:219], a[24:27], v[92:95]
    buffer_load_dwordx4 v[132:135], v1, s[8:11], s74 offen offset:1024
    v_mfma_f32_16x16x32_bf16 v[92:95], a[220:223], a[28:31], v[92:95]
    s_waitcnt lgkmcnt(7)
    s_xor_b32 s74, s24, 4096
    ds_read_b64_tr_b16 a[194:195], v56 offset:2048
    v_min_u32 v66, -2, v66
    v_mfma_f32_16x16x32_bf16 v[80:83], a[224:227], a[32:35], v[80:83]
    ds_read_b64_tr_b16 a[196:197], v56 offset:4096
    v_min_u32 v67, -2, v67
    v_mfma_f32_16x16x32_bf16 v[80:83], a[228:231], a[36:39], v[80:83]
    buffer_load_dwordx4 v[148:151], v1, s[8:11], s74 offen offset:1024
    v_mfma_f32_16x16x32_bf16 v[88:91], a[224:227], a[48:51], v[88:91]
    s_xor_b32 s74, s24, 0
    ds_read_b64_tr_b16 a[198:199], v56 offset:6144
    v_mfma_f32_16x16x32_bf16 v[88:91], a[228:231], a[52:55], v[88:91]
    s_add_u32 s75, s18, 0
    ds_read_b64_tr_b16 a[200:201], v57 offset:0
    v_mfma_f32_16x16x32_bf16 v[84:87], a[232:235], a[32:35], v[84:87]
    buffer_load_dwordx4 v[136:139], v1, s[8:11], s74 offen offset:2048
    ds_read_b64_tr_b16 a[202:203], v57 offset:2048
    v_mfma_f32_16x16x32_bf16 v[84:87], a[236:239], a[36:39], v[84:87]
    s_xor_b32 s74, s24, 4096
    ds_read_b64_tr_b16 a[204:205], v57 offset:4096
    v_mfma_f32_16x16x32_bf16 v[92:95], a[232:235], a[48:51], v[92:95]
    buffer_store_dwordx4 v[64:67], v23, s[8:11], s75 offen offset:0 sc0 sc1
    ds_read_b64_tr_b16 a[206:207], v57 offset:6144
    v_mfma_f32_16x16x32_bf16 v[92:95], a[236:239], a[52:55], v[92:95]
    buffer_load_dwordx4 v[152:155], v1, s[8:11], s74 offen offset:2048
    v_mfma_f32_16x16x32_bf16 v[80:83], a[240:243], a[40:43], v[80:83]
    s_waitcnt lgkmcnt(7)
    s_xor_b32 s74, s24, 0
    ds_read_b64_tr_b16 a[208:209], v56 offset:8192
    v_cvt_pk_bf16_f32 v72, v72, v73
    v_mfma_f32_16x16x32_bf16 v[80:83], a[244:247], a[44:47], v[80:83]
    ds_read_b64_tr_b16 a[210:211], v56 offset:10240
    v_cvt_pk_bf16_f32 v73, v74, v75
    v_mfma_f32_16x16x32_bf16 v[88:91], a[240:243], a[56:59], v[88:91]
    buffer_load_dwordx4 v[140:143], v1, s[8:11], s74 offen offset:3072
    v_mfma_f32_16x16x32_bf16 v[88:91], a[244:247], a[60:63], v[88:91]
    s_xor_b32 s74, s24, 4096
    ds_read_b64_tr_b16 a[212:213], v56 offset:12288
    v_cvt_pk_bf16_f32 v74, v76, v77
    v_mfma_f32_16x16x32_bf16 v[84:87], a[248:251], a[40:43], v[84:87]
    ds_read_b64_tr_b16 a[214:215], v56 offset:14336
    v_cvt_pk_bf16_f32 v75, v78, v79
    v_mfma_f32_16x16x32_bf16 v[84:87], a[252:255], a[44:47], v[84:87]
    buffer_load_dwordx4 v[156:159], v1, s[8:11], s74 offen offset:3072
    ds_read_b64_tr_b16 a[216:217], v57 offset:8192
    v_mfma_f32_16x16x32_bf16 v[92:95], a[248:251], a[56:59], v[92:95]
    ds_read_b64_tr_b16 a[218:219], v57 offset:10240
    v_min_u32 v72, -2, v72
    v_mfma_f32_16x16x32_bf16 v[92:95], a[252:255], a[60:63], v[92:95]
    s_waitcnt lgkmcnt(7)
    ds_read_b64_tr_b16 a[220:221], v57 offset:12288
    v_min_u32 v73, -2, v73
    v_mfma_f32_16x16x32_bf16 v[96:99], a[192:195], a[64:67], 0
    ds_read_b64_tr_b16 a[222:223], v57 offset:14336
    v_min_u32 v74, -2, v74
    v_mfma_f32_16x16x32_bf16 v[96:99], a[196:199], a[68:71], v[96:99]
    ds_read_b64_tr_b16 a[224:225], v56 offset:16384
    v_min_u32 v75, -2, v75
    v_mfma_f32_16x16x32_bf16 v[104:107], a[192:195], a[80:83], 0
    s_add_u32 s75, s18, 131072
    ds_read_b64_tr_b16 a[226:227], v56 offset:18432
    v_mfma_f32_16x16x32_bf16 v[104:107], a[196:199], a[84:87], v[104:107]
    buffer_store_dwordx4 v[72:75], v23, s[8:11], s75 offen offset:0 sc0 sc1
    ds_read_b64_tr_b16 a[228:229], v56 offset:20480
    v_mfma_f32_16x16x32_bf16 v[100:103], a[200:203], a[64:67], 0
    s_waitcnt lgkmcnt(9)
    ds_read_b64_tr_b16 a[230:231], v56 offset:22528
    v_mfma_f32_16x16x32_bf16 v[100:103], a[204:207], a[68:71], v[100:103]
    ds_read_b64_tr_b16 a[232:233], v57 offset:16384
    v_mfma_f32_16x16x32_bf16 v[108:111], a[200:203], a[80:83], 0
    ds_read_b64_tr_b16 a[234:235], v57 offset:18432
    v_mfma_f32_16x16x32_bf16 v[108:111], a[204:207], a[84:87], v[108:111]
    ds_read_b64_tr_b16 a[236:237], v57 offset:20480
    v_mfma_f32_16x16x32_bf16 v[96:99], a[208:211], a[72:75], v[96:99]
    s_waitcnt lgkmcnt(9)
    ds_read_b64_tr_b16 a[238:239], v57 offset:22528
    v_mfma_f32_16x16x32_bf16 v[96:99], a[212:215], a[76:79], v[96:99]
    ds_read_b64_tr_b16 a[240:241], v56 offset:24576
    v_mfma_f32_16x16x32_bf16 v[104:107], a[208:211], a[88:91], v[104:107]
    ds_read_b64_tr_b16 a[242:243], v56 offset:26624
    v_mfma_f32_16x16x32_bf16 v[104:107], a[212:215], a[92:95], v[104:107]
    ds_read_b64_tr_b16 a[244:245], v56 offset:28672
    v_mfma_f32_16x16x32_bf16 v[100:103], a[216:219], a[72:75], v[100:103]
    s_waitcnt lgkmcnt(9)
    ds_read_b64_tr_b16 a[246:247], v56 offset:30720
    v_mfma_f32_16x16x32_bf16 v[100:103], a[220:223], a[76:79], v[100:103]
    ds_read_b64_tr_b16 a[248:249], v57 offset:24576
    v_mfma_f32_16x16x32_bf16 v[108:111], a[216:219], a[88:91], v[108:111]
    ds_read_b64_tr_b16 a[250:251], v57 offset:26624
    v_mfma_f32_16x16x32_bf16 v[108:111], a[220:223], a[92:95], v[108:111]
    ds_read_b64_tr_b16 a[252:253], v57 offset:28672
    v_mfma_f32_16x16x32_bf16 v[96:99], a[224:227], a[96:99], v[96:99]
    s_waitcnt lgkmcnt(9)
    ds_read_b64_tr_b16 a[254:255], v57 offset:30720
    v_mfma_f32_16x16x32_bf16 v[96:99], a[228:231], a[100:103], v[96:99]
    ds_read_b64_tr_b16 a[192:193], v60 offset:32768
    v_mfma_f32_16x16x32_bf16 v[104:107], a[224:227], a[112:115], v[104:107]
    ds_read_b64_tr_b16 a[194:195], v60 offset:34816
    v_mfma_f32_16x16x32_bf16 v[104:107], a[228:231], a[116:119], v[104:107]
    ds_read_b64_tr_b16 a[196:197], v60 offset:36864
    v_mfma_f32_16x16x32_bf16 v[100:103], a[232:235], a[96:99], v[100:103]
    s_waitcnt lgkmcnt(9)
    ds_read_b64_tr_b16 a[198:199], v60 offset:38912
    v_cvt_pk_bf16_f32 v80, v80, v81
    v_mfma_f32_16x16x32_bf16 v[100:103], a[236:239], a[100:103], v[100:103]
    ds_read_b64_tr_b16 a[200:201], v61 offset:32768
    v_cvt_pk_bf16_f32 v81, v82, v83
    v_mfma_f32_16x16x32_bf16 v[108:111], a[232:235], a[112:115], v[108:111]
    ds_read_b64_tr_b16 a[202:203], v61 offset:34816
    v_cvt_pk_bf16_f32 v82, v84, v85
    v_mfma_f32_16x16x32_bf16 v[108:111], a[236:239], a[116:119], v[108:111]
    ds_read_b64_tr_b16 a[204:205], v61 offset:36864
    v_cvt_pk_bf16_f32 v83, v86, v87
    v_mfma_f32_16x16x32_bf16 v[96:99], a[240:243], a[104:107], v[96:99]
    s_waitcnt lgkmcnt(9)
    ds_read_b64_tr_b16 a[206:207], v61 offset:38912
    v_min_u32 v80, -2, v80
    v_mfma_f32_16x16x32_bf16 v[96:99], a[244:247], a[108:111], v[96:99]
    ds_read_b64_tr_b16 a[208:209], v60 offset:40960
    v_min_u32 v81, -2, v81
    v_mfma_f32_16x16x32_bf16 v[104:107], a[240:243], a[120:123], v[104:107]
    ds_read_b64_tr_b16 a[210:211], v60 offset:43008
    v_min_u32 v82, -2, v82
    v_mfma_f32_16x16x32_bf16 v[104:107], a[244:247], a[124:127], v[104:107]
    buffer_load_dword v3, v4, s[8:11], s23 offen sc0 sc1
    ds_read_b64_tr_b16 a[212:213], v60 offset:45056
    v_mfma_f32_16x16x32_bf16 v[100:103], a[248:251], a[104:107], v[100:103]
    s_waitcnt lgkmcnt(9)
    ds_read_b64_tr_b16 a[214:215], v60 offset:47104
    v_min_u32 v83, -2, v83
    v_mfma_f32_16x16x32_bf16 v[100:103], a[252:255], a[108:111], v[100:103]
    s_add_u32 s75, s18, 0
    ds_read_b64_tr_b16 a[216:217], v61 offset:40960
    v_mfma_f32_16x16x32_bf16 v[108:111], a[248:251], a[120:123], v[108:111]
    buffer_store_dwordx4 v[80:83], v23, s[8:11], s75 offen offset:256 sc0 sc1
    ds_read_b64_tr_b16 a[218:219], v61 offset:43008
    v_mfma_f32_16x16x32_bf16 v[108:111], a[252:255], a[124:127], v[108:111]
    ds_read_b64_tr_b16 a[220:221], v61 offset:45056
    v_cvt_pk_bf16_f32 v88, v88, v89
    v_mfma_f32_16x16x32_bf16 v[96:99], a[192:195], a[0:3], v[96:99]
    s_waitcnt lgkmcnt(9)
    ds_read_b64_tr_b16 a[222:223], v61 offset:47104
    v_cvt_pk_bf16_f32 v89, v90, v91
    v_mfma_f32_16x16x32_bf16 v[96:99], a[196:199], a[4:7], v[96:99]
    ds_read_b64_tr_b16 a[224:225], v60 offset:49152
    v_cvt_pk_bf16_f32 v90, v92, v93
    v_mfma_f32_16x16x32_bf16 v[104:107], a[192:195], a[16:19], v[104:107]
    ds_read_b64_tr_b16 a[226:227], v60 offset:51200
    v_cvt_pk_bf16_f32 v91, v94, v95
    v_mfma_f32_16x16x32_bf16 v[104:107], a[196:199], a[20:23], v[104:107]
    ds_read_b64_tr_b16 a[228:229], v60 offset:53248
    v_min_u32 v88, -2, v88
    v_mfma_f32_16x16x32_bf16 v[100:103], a[200:203], a[0:3], v[100:103]
    s_waitcnt lgkmcnt(9)
    ds_read_b64_tr_b16 a[230:231], v60 offset:55296
    v_min_u32 v89, -2, v89
    v_mfma_f32_16x16x32_bf16 v[100:103], a[204:207], a[4:7], v[100:103]
    ds_read_b64_tr_b16 a[232:233], v61 offset:49152
    v_min_u32 v90, -2, v90
    v_mfma_f32_16x16x32_bf16 v[108:111], a[200:203], a[16:19], v[108:111]
    ds_read_b64_tr_b16 a[234:235], v61 offset:51200
    v_min_u32 v91, -2, v91
    v_mfma_f32_16x16x32_bf16 v[108:111], a[204:207], a[20:23], v[108:111]
    s_waitcnt lgkmcnt(9)
    s_add_u32 s75, s18, 131072
    ds_read_b64_tr_b16 a[236:237], v61 offset:53248
    v_mfma_f32_16x16x32_bf16 v[96:99], a[208:211], a[8:11], v[96:99]
    buffer_store_dwordx4 v[88:91], v23, s[8:11], s75 offen offset:256 sc0 sc1
    ds_read_b64_tr_b16 a[238:239], v61 offset:55296
    v_mfma_f32_16x16x32_bf16 v[96:99], a[212:215], a[12:15], v[96:99]
    ds_read_b64_tr_b16 a[240:241], v60 offset:57344
    v_mfma_f32_16x16x32_bf16 v[104:107], a[208:211], a[24:27], v[104:107]
    ds_read_b64_tr_b16 a[242:243], v60 offset:59392
    v_mfma_f32_16x16x32_bf16 v[104:107], a[212:215], a[28:31], v[104:107]
    s_waitcnt lgkmcnt(9)
    ds_read_b64_tr_b16 a[244:245], v60 offset:61440
    v_mfma_f32_16x16x32_bf16 v[100:103], a[216:219], a[8:11], v[100:103]
    ds_read_b64_tr_b16 a[246:247], v60 offset:63488
    v_mfma_f32_16x16x32_bf16 v[100:103], a[220:223], a[12:15], v[100:103]
    ds_read_b64_tr_b16 a[248:249], v61 offset:57344
    v_mfma_f32_16x16x32_bf16 v[108:111], a[216:219], a[24:27], v[108:111]
    ds_read_b64_tr_b16 a[250:251], v61 offset:59392
    v_mfma_f32_16x16x32_bf16 v[108:111], a[220:223], a[28:31], v[108:111]
    s_waitcnt lgkmcnt(9)
    ds_read_b64_tr_b16 a[252:253], v61 offset:61440
    v_mfma_f32_16x16x32_bf16 v[96:99], a[224:227], a[32:35], v[96:99]
    ds_read_b64_tr_b16 a[254:255], v61 offset:63488
    v_mfma_f32_16x16x32_bf16 v[96:99], a[228:231], a[36:39], v[96:99]
    ds_read_b64_tr_b16 a[192:193], v58 offset:0
    v_mfma_f32_16x16x32_bf16 v[104:107], a[224:227], a[48:51], v[104:107]
    ds_read_b64_tr_b16 a[194:195], v58 offset:2048
    v_mfma_f32_16x16x32_bf16 v[104:107], a[228:231], a[52:55], v[104:107]
    s_waitcnt lgkmcnt(9)
    ds_read_b64_tr_b16 a[196:197], v58 offset:4096
    v_mfma_f32_16x16x32_bf16 v[100:103], a[232:235], a[32:35], v[100:103]
    ds_read_b64_tr_b16 a[198:199], v58 offset:6144
    v_mfma_f32_16x16x32_bf16 v[100:103], a[236:239], a[36:39], v[100:103]
    ds_read_b64_tr_b16 a[200:201], v59 offset:0
    v_mfma_f32_16x16x32_bf16 v[108:111], a[232:235], a[48:51], v[108:111]
    ds_read_b64_tr_b16 a[202:203], v59 offset:2048
    v_mfma_f32_16x16x32_bf16 v[108:111], a[236:239], a[52:55], v[108:111]
    s_waitcnt lgkmcnt(9)
    ds_read_b64_tr_b16 a[204:205], v59 offset:4096
    v_mfma_f32_16x16x32_bf16 v[96:99], a[240:243], a[40:43], v[96:99]
    ds_read_b64_tr_b16 a[206:207], v59 offset:6144
    v_mfma_f32_16x16x32_bf16 v[96:99], a[244:247], a[44:47], v[96:99]
    ds_read_b64_tr_b16 a[208:209], v58 offset:8192
    v_mfma_f32_16x16x32_bf16 v[104:107], a[240:243], a[56:59], v[104:107]
    ds_read_b64_tr_b16 a[210:211], v58 offset:10240
    v_mfma_f32_16x16x32_bf16 v[104:107], a[244:247], a[60:63], v[104:107]
    s_waitcnt lgkmcnt(9)
    ds_read_b64_tr_b16 a[212:213], v58 offset:12288
    v_mfma_f32_16x16x32_bf16 v[100:103], a[248:251], a[40:43], v[100:103]
    ds_read_b64_tr_b16 a[214:215], v58 offset:14336
    v_mfma_f32_16x16x32_bf16 v[100:103], a[252:255], a[44:47], v[100:103]
    ds_read_b64_tr_b16 a[216:217], v59 offset:8192
    v_mfma_f32_16x16x32_bf16 v[108:111], a[248:251], a[56:59], v[108:111]
    ds_read_b64_tr_b16 a[218:219], v59 offset:10240
    v_mfma_f32_16x16x32_bf16 v[108:111], a[252:255], a[60:63], v[108:111]
    s_waitcnt lgkmcnt(9)
    ds_read_b64_tr_b16 a[220:221], v59 offset:12288
    v_mfma_f32_16x16x32_bf16 v[112:115], a[192:195], a[64:67], 0
    ds_read_b64_tr_b16 a[222:223], v59 offset:14336
    v_mfma_f32_16x16x32_bf16 v[112:115], a[196:199], a[68:71], v[112:115]
    ds_read_b64_tr_b16 a[224:225], v58 offset:16384
    v_mfma_f32_16x16x32_bf16 v[120:123], a[192:195], a[80:83], 0
    ds_read_b64_tr_b16 a[226:227], v58 offset:18432
    v_mfma_f32_16x16x32_bf16 v[120:123], a[196:199], a[84:87], v[120:123]
    s_waitcnt lgkmcnt(9)
    ds_read_b64_tr_b16 a[228:229], v58 offset:20480
    v_mfma_f32_16x16x32_bf16 v[116:119], a[200:203], a[64:67], 0
    ds_read_b64_tr_b16 a[230:231], v58 offset:22528
    v_mfma_f32_16x16x32_bf16 v[116:119], a[204:207], a[68:71], v[116:119]
    ds_read_b64_tr_b16 a[232:233], v59 offset:16384
    v_mfma_f32_16x16x32_bf16 v[124:127], a[200:203], a[80:83], 0
    ds_read_b64_tr_b16 a[234:235], v59 offset:18432
    v_mfma_f32_16x16x32_bf16 v[124:127], a[204:207], a[84:87], v[124:127]
    s_waitcnt lgkmcnt(9)
    ds_read_b64_tr_b16 a[236:237], v59 offset:20480
    v_mfma_f32_16x16x32_bf16 v[112:115], a[208:211], a[72:75], v[112:115]
    ds_read_b64_tr_b16 a[238:239], v59 offset:22528
    v_cvt_pk_bf16_f32 v96, v96, v97
    s_waitcnt vmcnt(2)
    v_cmp_ne_u32 vcc, 0, v3
    s_cmp_eq_u64 vcc, -1
    s_cbranch_scc0 L_C2_slow_13
L_C2_ok_14:
    v_mfma_f32_16x16x32_bf16 v[112:115], a[212:215], a[76:79], v[112:115]
    s_xor_b32 s74, s24, 8192
    ds_read_b64_tr_b16 a[240:241], v58 offset:24576
    v_cvt_pk_bf16_f32 v97, v98, v99
    v_mfma_f32_16x16x32_bf16 v[120:123], a[208:211], a[88:91], v[120:123]
    buffer_load_dwordx4 v[160:163], v1, s[8:11], s74 offen offset:0
    v_mfma_f32_16x16x32_bf16 v[120:123], a[212:215], a[92:95], v[120:123]
    s_waitcnt lgkmcnt(8)
    s_xor_b32 s74, s24, 12288
    ds_read_b64_tr_b16 a[242:243], v58 offset:26624
    v_cvt_pk_bf16_f32 v98, v100, v101
    v_mfma_f32_16x16x32_bf16 v[116:119], a[216:219], a[72:75], v[116:119]
    ds_read_b64_tr_b16 a[244:245], v58 offset:28672
    v_cvt_pk_bf16_f32 v99, v102, v103
    v_mfma_f32_16x16x32_bf16 v[116:119], a[220:223], a[76:79], v[116:119]
    ds_read_b64_tr_b16 a[246:247], v58 offset:30720
    v_min_u32 v96, -2, v96
    v_mfma_f32_16x16x32_bf16 v[124:127], a[216:219], a[88:91], v[124:127]
    buffer_load_dwordx4 v[176:179], v1, s[8:11], s74 offen offset:0
    ds_read_b64_tr_b16 a[248:249], v59 offset:24576
    v_mfma_f32_16x16x32_bf16 v[124:127], a[220:223], a[92:95], v[124:127]
    s_waitcnt lgkmcnt(8)
    s_xor_b32 s74, s24, 8192
    ds_read_b64_tr_b16 a[250:251], v59 offset:26624
    v_min_u32 v97, -2, v97
    v_mfma_f32_16x16x32_bf16 v[112:115], a[224:227], a[96:99], v[112:115]
    ds_read_b64_tr_b16 a[252:253], v59 offset:28672
    v_min_u32 v98, -2, v98
    v_mfma_f32_16x16x32_bf16 v[112:115], a[228:231], a[100:103], v[112:115]
    ds_read_b64_tr_b16 a[254:255], v59 offset:30720
    v_min_u32 v99, -2, v99
    v_mfma_f32_16x16x32_bf16 v[120:123], a[224:227], a[112:115], v[120:123]
    buffer_load_dwordx4 v[164:167], v1, s[8:11], s74 offen offset:1024
    v_mfma_f32_16x16x32_bf16 v[120:123], a[228:231], a[116:119], v[120:123]
    s_waitcnt lgkmcnt(7)
    s_xor_b32 s74, s24, 12288
    ds_read_b64_tr_b16 a[192:193], v62 offset:32768
    v_mfma_f32_16x16x32_bf16 v[116:119], a[232:235], a[96:99], v[116:119]
    s_add_u32 s75, s18, 0
    ds_read_b64_tr_b16 a[194:195], v62 offset:34816
    v_mfma_f32_16x16x32_bf16 v[116:119], a[236:239], a[100:103], v[116:119]
    buffer_store_dwordx4 v[96:99], v23, s[8:11], s75 offen offset:512 sc0 sc1
    ds_read_b64_tr_b16 a[196:197], v62 offset:36864
    v_mfma_f32_16x16x32_bf16 v[124:127], a[232:235], a[112:115], v[124:127]
    buffer_load_dwordx4 v[180:183], v1, s[8:11], s74 offen offset:1024
    ds_read_b64_tr_b16 a[198:199], v62 offset:38912
    v_mfma_f32_16x16x32_bf16 v[124:127], a[236:239], a[116:119], v[124:127]
    s_waitcnt lgkmcnt(8)
    s_xor_b32 s74, s24, 8192
    ds_read_b64_tr_b16 a[200:201], v63 offset:32768
    v_cvt_pk_bf16_f32 v104, v104, v105
    v_mfma_f32_16x16x32_bf16 v[112:115], a[240:243], a[104:107], v[112:115]
    ds_read_b64_tr_b16 a[202:203], v63 offset:34816
    v_cvt_pk_bf16_f32 v105, v106, v107
    v_mfma_f32_16x16x32_bf16 v[112:115], a[244:247], a[108:111], v[112:115]
    ds_read_b64_tr_b16 a[204:205], v63 offset:36864
    v_cvt_pk_bf16_f32 v106, v108, v109
    v_mfma_f32_16x16x32_bf16 v[120:123], a[240:243], a[120:123], v[120:123]
    buffer_load_dwordx4 v[168:171], v1, s[8:11], s74 offen offset:2048
    ds_read_b64_tr_b16 a[206:207], v63 offset:38912
    v_mfma_f32_16x16x32_bf16 v[120:123], a[244:247], a[124:127], v[120:123]
    s_waitcnt lgkmcnt(8)
    s_xor_b32 s74, s24, 12288
    ds_read_b64_tr_b16 a[208:209], v62 offset:40960
    v_cvt_pk_bf16_f32 v107, v110, v111
    v_mfma_f32_16x16x32_bf16 v[116:119], a[248:251], a[104:107], v[116:119]
    ds_read_b64_tr_b16 a[210:211], v62 offset:43008
    v_min_u32 v104, -2, v104
    v_mfma_f32_16x16x32_bf16 v[116:119], a[252:255], a[108:111], v[116:119]
    ds_read_b64_tr_b16 a[212:213], v62 offset:45056
    v_min_u32 v105, -2, v105
    v_mfma_f32_16x16x32_bf16 v[124:127], a[248:251], a[120:123], v[124:127]
    buffer_load_dwordx4 v[184:187], v1, s[8:11], s74 offen offset:2048
    ds_read_b64_tr_b16 a[214:215], v62 offset:47104
    v_mfma_f32_16x16x32_bf16 v[124:127], a[252:255], a[124:127], v[124:127]
    s_waitcnt lgkmcnt(9)
    s_xor_b32 s74, s24, 8192
    ds_read_b64_tr_b16 a[216:217], v63 offset:40960
    v_min_u32 v106, -2, v106
    v_mfma_f32_16x16x32_bf16 v[112:115], a[192:195], a[0:3], v[112:115]
    s_waitcnt lgkmcnt(9)
    ds_read_b64_tr_b16 a[218:219], v63 offset:43008
    v_min_u32 v107, -2, v107
    v_mfma_f32_16x16x32_bf16 v[112:115], a[196:199], a[4:7], v[112:115]
    s_add_u32 s75, s18, 131072
    ds_read_b64_tr_b16 a[220:221], v63 offset:45056
    v_mfma_f32_16x16x32_bf16 v[120:123], a[192:195], a[16:19], v[120:123]
    buffer_load_dwordx4 v[172:175], v1, s[8:11], s74 offen offset:3072
    ds_read_b64_tr_b16 a[222:223], v63 offset:47104
    v_mfma_f32_16x16x32_bf16 v[120:123], a[196:199], a[20:23], v[120:123]
    s_waitcnt lgkmcnt(8)
    s_xor_b32 s74, s24, 12288
    ds_read_b64_tr_b16 a[224:225], v62 offset:49152
    v_mfma_f32_16x16x32_bf16 v[116:119], a[200:203], a[0:3], v[116:119]
    buffer_store_dwordx4 v[104:107], v23, s[8:11], s75 offen offset:512 sc0 sc1
    ds_read_b64_tr_b16 a[226:227], v62 offset:51200
    v_mfma_f32_16x16x32_bf16 v[116:119], a[204:207], a[4:7], v[116:119]
    ds_read_b64_tr_b16 a[228:229], v62 offset:53248
    v_mfma_f32_16x16x32_bf16 v[124:127], a[200:203], a[16:19], v[124:127]
    buffer_load_dwordx4 v[188:191], v1, s[8:11], s74 offen offset:3072
    ds_read_b64_tr_b16 a[230:231], v62 offset:55296
    v_mfma_f32_16x16x32_bf16 v[124:127], a[204:207], a[20:23], v[124:127]
    s_waitcnt lgkmcnt(9)
    ds_read_b64_tr_b16 a[232:233], v63 offset:49152
    v_mfma_f32_16x16x32_bf16 v[112:115], a[208:211], a[8:11], v[112:115]
    s_waitcnt lgkmcnt(9)
    ds_read_b64_tr_b16 a[234:235], v63 offset:51200
    v_mfma_f32_16x16x32_bf16 v[112:115], a[212:215], a[12:15], v[112:115]
    ds_read_b64_tr_b16 a[236:237], v63 offset:53248
    v_mfma_f32_16x16x32_bf16 v[120:123], a[208:211], a[24:27], v[120:123]
    ds_read_b64_tr_b16 a[238:239], v63 offset:55296
    v_mfma_f32_16x16x32_bf16 v[120:123], a[212:215], a[28:31], v[120:123]
    s_waitcnt lgkmcnt(9)
    ds_read_b64_tr_b16 a[240:241], v62 offset:57344
    v_mfma_f32_16x16x32_bf16 v[116:119], a[216:219], a[8:11], v[116:119]
    s_waitcnt lgkmcnt(9)
    ds_read_b64_tr_b16 a[242:243], v62 offset:59392
    v_mfma_f32_16x16x32_bf16 v[116:119], a[220:223], a[12:15], v[116:119]
    ds_read_b64_tr_b16 a[244:245], v62 offset:61440
    v_mfma_f32_16x16x32_bf16 v[124:127], a[216:219], a[24:27], v[124:127]
    ds_read_b64_tr_b16 a[246:247], v62 offset:63488
    v_mfma_f32_16x16x32_bf16 v[124:127], a[220:223], a[28:31], v[124:127]
    s_waitcnt lgkmcnt(9)
    ds_read_b64_tr_b16 a[248:249], v63 offset:57344
    v_mfma_f32_16x16x32_bf16 v[112:115], a[224:227], a[32:35], v[112:115]
    s_waitcnt lgkmcnt(9)
    ds_read_b64_tr_b16 a[250:251], v63 offset:59392
    ds_read_b64_tr_b16 a[208:209], v56 offset:40960
    v_mfma_f32_16x16x32_bf16 v[112:115], a[228:231], a[36:39], v[112:115]
    ds_read_b64_tr_b16 a[252:253], v63 offset:61440
    ds_read_b64_tr_b16 a[210:211], v56 offset:43008
    v_mfma_f32_16x16x32_bf16 v[120:123], a[224:227], a[48:51], v[120:123]
    ds_read_b64_tr_b16 a[254:255], v63 offset:63488
    ds_read_b64_tr_b16 a[212:213], v56 offset:45056
    v_mfma_f32_16x16x32_bf16 v[120:123], a[228:231], a[52:55], v[120:123]
    s_waitcnt lgkmcnt(12)
    ds_read_b64_tr_b16 a[192:193], v56 offset:32768
    ds_read_b64_tr_b16 a[214:215], v56 offset:47104
    v_mfma_f32_16x16x32_bf16 v[116:119], a[232:235], a[32:35], v[116:119]
    s_waitcnt lgkmcnt(13)
    ds_read_b64_tr_b16 a[194:195], v56 offset:34816
    ds_read_b64_tr_b16 a[216:217], v57 offset:40960
    v_mfma_f32_16x16x32_bf16 v[116:119], a[236:239], a[36:39], v[116:119]
    ds_read_b64_tr_b16 a[196:197], v56 offset:36864
    ds_read_b64_tr_b16 a[218:219], v57 offset:43008
    v_mfma_f32_16x16x32_bf16 v[124:127], a[232:235], a[48:51], v[124:127]
    ds_read_b64_tr_b16 a[198:199], v56 offset:38912
    ds_read_b64_tr_b16 a[220:221], v57 offset:45056
    v_mfma_f32_16x16x32_bf16 v[124:127], a[236:239], a[52:55], v[124:127]
    s_waitcnt lgkmcnt(15)
    ds_read_b64_tr_b16 a[200:201], v57 offset:32768
    ds_read_b64_tr_b16 a[222:223], v57 offset:47104
    v_mfma_f32_16x16x32_bf16 v[112:115], a[240:243], a[40:43], v[112:115]
    ds_read_b64_tr_b16 a[202:203], v57 offset:34816
    v_mfma_f32_16x16x32_bf16 v[112:115], a[244:247], a[44:47], v[112:115]
    ds_read_b64_tr_b16 a[204:205], v57 offset:36864
    v_mfma_f32_16x16x32_bf16 v[120:123], a[240:243], a[56:59], v[120:123]
    s_waitcnt lgkmcnt(15)
    s_xor_b32 s74, s24, 16384
    ds_read_b64_tr_b16 a[206:207], v57 offset:38912
    v_mfma_f32_16x16x32_bf16 v[120:123], a[244:247], a[60:63], v[120:123]
    buffer_load_dwordx4 v[192:195], v1, s[8:11], s74 offen offset:0
    v_mfma_f32_16x16x32_bf16 v[116:119], a[248:251], a[40:43], v[116:119]
    s_waitcnt lgkmcnt(13)
    s_xor_b32 s74, s24, 20480
    ds_read_b64_tr_b16 a[224:225], v56 offset:49152
    v_mfma_f32_16x16x32_bf16 v[116:119], a[252:255], a[44:47], v[116:119]
    ds_read_b64_tr_b16 a[226:227], v56 offset:51200
    v_mfma_f32_16x16x32_bf16 v[124:127], a[248:251], a[56:59], v[124:127]
    ds_read_b64_tr_b16 a[228:229], v56 offset:53248
    v_mfma_f32_16x16x32_bf16 v[124:127], a[252:255], a[60:63], v[124:127]
    s_waitcnt lgkmcnt(9)
    ds_read_b64_tr_b16 a[230:231], v56 offset:55296
    v_mfma_f32_16x16x32_bf16 v[64:67], a[192:195], v[128:131], 0
    buffer_load_dwordx4 v[208:211], v1, s[8:11], s74 offen offset:0
    v_mfma_f32_16x16x32_bf16 v[64:67], a[196:199], v[132:135], v[64:67]
    s_xor_b32 s74, s24, 16384
    ds_read_b64_tr_b16 a[232:233], v57 offset:49152
    v_mfma_f32_16x16x32_bf16 v[72:75], a[192:195], v[144:147], 0
    ds_read_b64_tr_b16 a[234:235], v57 offset:51200
    v_mfma_f32_16x16x32_bf16 v[72:75], a[196:199], v[148:151], v[72:75]
    s_waitcnt lgkmcnt(7)
    ds_read_b64_tr_b16 a[236:237], v57 offset:53248
    v_mfma_f32_16x16x32_bf16 v[68:71], a[200:203], v[128:131], 0
    s_waitcnt lgkmcnt(7)
    ds_read_b64_tr_b16 a[238:239], v57 offset:55296
    v_mfma_f32_16x16x32_bf16 v[68:71], a[204:207], v[132:135], v[68:71]
    buffer_load_dwordx4 v[196:199], v1, s[8:11], s74 offen offset:1024
    v_mfma_f32_16x16x32_bf16 v[76:79], a[200:203], v[144:147], 0
    s_xor_b32 s74, s24, 20480
    ds_read_b64_tr_b16 a[240:241], v56 offset:57344
    v_cvt_pk_bf16_f32 v112, v112, v113
    v_mfma_f32_16x16x32_bf16 v[76:79], a[204:207], v[148:151], v[76:79]
    ds_read_b64_tr_b16 a[242:243], v56 offset:59392
    v_cvt_pk_bf16_f32 v113, v114, v115
    v_mfma_f32_16x16x32_bf16 v[64:67], a[208:211], v[136:139], v[64:67]
    ds_read_b64_tr_b16 a[244:245], v56 offset:61440
    v_cvt_pk_bf16_f32 v114, v116, v117
    v_mfma_f32_16x16x32_bf16 v[64:67], a[212:215], v[140:143], v[64:67]
    ds_read_b64_tr_b16 a[246:247], v56 offset:63488
    v_cvt_pk_bf16_f32 v115, v118, v119
    v_mfma_f32_16x16x32_bf16 v[72:75], a[208:211], v[152:155], v[72:75]
    buffer_load_dwordx4 v[212:215], v1, s[8:11], s74 offen offset:1024
    v_mfma_f32_16x16x32_bf16 v[72:75], a[212:215], v[156:159], v[72:75]
    s_xor_b32 s74, s24, 16384
    ds_read_b64_tr_b16 a[248:249], v57 offset:57344
    v_min_u32 v112, -2, v112
    v_mfma_f32_16x16x32_bf16 v[68:71], a[216:219], v[136:139], v[68:71]
    ds_read_b64_tr_b16 a[250:251], v57 offset:59392
    v_min_u32 v113, -2, v113
    v_mfma_f32_16x16x32_bf16 v[68:71], a[220:223], v[140:143], v[68:71]
    ds_read_b64_tr_b16 a[252:253], v57 offset:61440
    v_min_u32 v114, -2, v114
    v_mfma_f32_16x16x32_bf16 v[76:79], a[216:219], v[152:155], v[76:79]
    s_waitcnt vmcnt(13) lgkmcnt(7)
    ds_read_b64_tr_b16 a[254:255], v57 offset:63488
    v_min_u32 v115, -2, v115
    v_mfma_f32_16x16x32_bf16 v[76:79], a[220:223], v[156:159], v[76:79]
    buffer_load_dwordx4 v[200:203], v1, s[8:11], s74 offen offset:2048
    v_mfma_f32_16x16x32_bf16 v[64:67], a[224:227], v[160:163], v[64:67]
    s_waitcnt vmcnt(12)
    s_xor_b32 s74, s24, 20480
    ds_read_b64_tr_b16 a[192:193], v58 offset:32768
    v_mfma_f32_16x16x32_bf16 v[64:67], a[228:231], v[164:167], v[64:67]
    s_waitcnt vmcnt(10)
    s_add_u32 s75, s18, 0
    ds_read_b64_tr_b16 a[194:195], v58 offset:34816
    v_mfma_f32_16x16x32_bf16 v[72:75], a[224:227], v[176:179], v[72:75]
    buffer_store_dwordx4 v[112:115], v23, s[8:11], s75 offen offset:768 sc0 sc1
    v_mfma_f32_16x16x32_bf16 v[72:75], a[228:231], v[180:183], v[72:75]
    ds_read_b64_tr_b16 a[196:197], v58 offset:36864
    v_cvt_pk_bf16_f32 v120, v120, v121
    v_mfma_f32_16x16x32_bf16 v[68:71], a[232:235], v[160:163], v[68:71]
    buffer_load_dwordx4 v[216:219], v1, s[8:11], s74 offen offset:2048
    ds_read_b64_tr_b16 a[198:199], v58 offset:38912
    v_mfma_f32_16x16x32_bf16 v[68:71], a[236:239], v[164:167], v[68:71]
    s_xor_b32 s74, s24, 16384
    ds_read_b64_tr_b16 a[200:201], v59 offset:32768
    v_cvt_pk_bf16_f32 v121, v122, v123
    v_mfma_f32_16x16x32_bf16 v[76:79], a[232:235], v[176:179], v[76:79]
    ds_read_b64_tr_b16 a[202:203], v59 offset:34816
    v_cvt_pk_bf16_f32 v122, v124, v125
    v_mfma_f32_16x16x32_bf16 v[76:79], a[236:239], v[180:183], v[76:79]
    s_waitcnt vmcnt(11) lgkmcnt(7)
    ds_read_b64_tr_b16 a[204:205], v59 offset:36864
    v_cvt_pk_bf16_f32 v123, v126, v127
    v_mfma_f32_16x16x32_bf16 v[64:67], a[240:243], v[168:171], v[64:67]
    s_waitcnt vmcnt(9)
    ds_read_b64_tr_b16 a[206:207], v59 offset:38912
    v_min_u32 v120, -2, v120
    v_mfma_f32_16x16x32_bf16 v[64:67], a[244:247], v[172:175], v[64:67]
    buffer_load_dwordx4 v[204:207], v1, s[8:11], s74 offen offset:3072
    v_mfma_f32_16x16x32_bf16 v[72:75], a[240:243], v[184:187], v[72:75]
    s_waitcnt vmcnt(8)
    s_xor_b32 s74, s24, 20480
    ds_read_b64_tr_b16 a[208:209], v58 offset:40960
    v_min_u32 v121, -2, v121
    v_mfma_f32_16x16x32_bf16 v[72:75], a[244:247], v[188:191], v[72:75]
    ds_read_b64_tr_b16 a[210:211], v58 offset:43008
    v_min_u32 v122, -2, v122
    v_mfma_f32_16x16x32_bf16 v[68:71], a[248:251], v[168:171], v[68:71]
    s_waitcnt lgkmcnt(8)
    ds_read_b64_tr_b16 a[212:213], v58 offset:45056
    v_min_u32 v123, -2, v123
    v_mfma_f32_16x16x32_bf16 v[68:71], a[252:255], v[172:175], v[68:71]
    s_add_u32 s75, s18, 131072
    ds_read_b64_tr_b16 a[214:215], v58 offset:47104
    v_mfma_f32_16x16x32_bf16 v[76:79], a[248:251], v[184:187], v[76:79]
    buffer_load_dwordx4 v[220:223], v1, s[8:11], s74 offen offset:3072
    ds_read_b64_tr_b16 a[216:217], v59 offset:40960
    v_mfma_f32_16x16x32_bf16 v[76:79], a[252:255], v[188:191], v[76:79]
    s_waitcnt lgkmcnt(8)
    s_xor_b32 s74, s24, 24576
    ds_read_b64_tr_b16 a[218:219], v59 offset:43008
    v_mfma_f32_16x16x32_bf16 v[80:83], a[192:195], v[128:131], 0
    buffer_store_dwordx4 v[120:123], v23, s[8:11], s75 offen offset:768 sc0 sc1
    ds_read_b64_tr_b16 a[220:221], v59 offset:45056
    v_mfma_f32_16x16x32_bf16 v[80:83], a[196:199], v[132:135], v[80:83]
    ds_read_b64_tr_b16 a[222:223], v59 offset:47104
    v_mfma_f32_16x16x32_bf16 v[88:91], a[192:195], v[144:147], 0
    s_waitcnt lgkmcnt(8)
    ds_read_b64_tr_b16 a[224:225], v58 offset:49152
    v_mfma_f32_16x16x32_bf16 v[88:91], a[196:199], v[148:151], v[88:91]
    buffer_load_dwordx4 v[224:227], v1, s[8:11], s74 offen offset:0
    ds_read_b64_tr_b16 a[226:227], v58 offset:51200
    v_mfma_f32_16x16x32_bf16 v[84:87], a[200:203], v[128:131], 0
    s_xor_b32 s74, s24, 28672
    ds_read_b64_tr_b16 a[228:229], v58 offset:53248
    v_mfma_f32_16x16x32_bf16 v[84:87], a[204:207], v[132:135], v[84:87]
    ds_read_b64_tr_b16 a[230:231], v58 offset:55296
    v_mfma_f32_16x16x32_bf16 v[92:95], a[200:203], v[144:147], 0
    ds_read_b64_tr_b16 a[232:233], v59 offset:49152
    v_mfma_f32_16x16x32_bf16 v[92:95], a[204:207], v[148:151], v[92:95]
    s_waitcnt lgkmcnt(9)
    ds_read_b64_tr_b16 a[234:235], v59 offset:51200
    v_mfma_f32_16x16x32_bf16 v[80:83], a[208:211], v[136:139], v[80:83]
    buffer_load_dwordx4 v[240:243], v1, s[8:11], s74 offen offset:0
    ds_read_b64_tr_b16 a[236:237], v59 offset:53248
    v_mfma_f32_16x16x32_bf16 v[80:83], a[212:215], v[140:143], v[80:83]
    s_xor_b32 s74, s24, 24576
    ds_read_b64_tr_b16 a[238:239], v59 offset:55296
    v_mfma_f32_16x16x32_bf16 v[88:91], a[208:211], v[152:155], v[88:91]
    ds_read_b64_tr_b16 a[240:241], v58 offset:57344
    v_mfma_f32_16x16x32_bf16 v[88:91], a[212:215], v[156:159], v[88:91]
    s_waitcnt lgkmcnt(9)
    ds_read_b64_tr_b16 a[242:243], v58 offset:59392
    v_mfma_f32_16x16x32_bf16 v[84:87], a[216:219], v[136:139], v[84:87]
    ds_read_b64_tr_b16 a[244:245], v58 offset:61440
    v_mfma_f32_16x16x32_bf16 v[84:87], a[220:223], v[140:143], v[84:87]
    buffer_load_dwordx4 v[228:231], v1, s[8:11], s74 offen offset:1024
    ds_read_b64_tr_b16 a[246:247], v58 offset:63488
    v_mfma_f32_16x16x32_bf16 v[92:95], a[216:219], v[152:155], v[92:95]
    s_xor_b32 s74, s24, 28672
    ds_read_b64_tr_b16 a[248:249], v59 offset:57344
    v_mfma_f32_16x16x32_bf16 v[92:95], a[220:223], v[156:159], v[92:95]
    s_waitcnt lgkmcnt(9)
    ds_read_b64_tr_b16 a[250:251], v59 offset:59392
    v_mfma_f32_16x16x32_bf16 v[80:83], a[224:227], v[160:163], v[80:83]
    ds_read_b64_tr_b16 a[252:253], v59 offset:61440
    v_mfma_f32_16x16x32_bf16 v[80:83], a[228:231], v[164:167], v[80:83]
    ds_read_b64_tr_b16 a[254:255], v59 offset:63488
    v_mfma_f32_16x16x32_bf16 v[88:91], a[224:227], v[176:179], v[88:91]
    buffer_load_dwordx4 v[244:247], v1, s[8:11], s74 offen offset:1024
    v_mfma_f32_16x16x32_bf16 v[88:91], a[228:231], v[180:183], v[88:91]
    s_waitcnt lgkmcnt(8)
    s_xor_b32 s74, s24, 24576
    ds_read_b64_tr_b16 a[192:193], v56 offset:0
    v_mfma_f32_16x16x32_bf16 v[84:87], a[232:235], v[160:163], v[84:87]
    ds_read_b64_tr_b16 a[194:195], v56 offset:2048
    v_mfma_f32_16x16x32_bf16 v[84:87], a[236:239], v[164:167], v[84:87]
    ds_read_b64_tr_b16 a[196:197], v56 offset:4096
    v_mfma_f32_16x16x32_bf16 v[92:95], a[232:235], v[176:179], v[92:95]
    s_waitcnt lgkmcnt(8)
    ds_read_b64_tr_b16 a[198:199], v56 offset:6144
    v_mfma_f32_16x16x32_bf16 v[92:95], a[236:239], v[180:183], v[92:95]
    buffer_load_dwordx4 v[232:235], v1, s[8:11], s74 offen offset:2048
    ds_read_b64_tr_b16 a[200:201], v57 offset:0
    v_mfma_f32_16x16x32_bf16 v[80:83], a[240:243], v[168:171], v[80:83]
    s_waitcnt lgkmcnt(8)
    s_xor_b32 s74, s24, 28672
    ds_read_b64_tr_b16 a[202:203], v57 offset:2048
    v_mfma_f32_16x16x32_bf16 v[80:83], a[244:247], v[172:175], v[80:83]
    ds_read_b64_tr_b16 a[204:205], v57 offset:4096
    v_mfma_f32_16x16x32_bf16 v[88:91], a[240:243], v[184:187], v[88:91]
    ds_read_b64_tr_b16 a[206:207], v57 offset:6144
    v_mfma_f32_16x16x32_bf16 v[88:91], a[244:247], v[188:191], v[88:91]
    s_waitcnt lgkmcnt(8)
    ds_read_b64_tr_b16 a[208:209], v56 offset:8192
    v_mfma_f32_16x16x32_bf16 v[84:87], a[248:251], v[168:171], v[84:87]
    buffer_load_dwordx4 v[248:251], v1, s[8:11], s74 offen offset:2048
    ds_read_b64_tr_b16 a[210:211], v56 offset:10240
    v_mfma_f32_16x16x32_bf16 v[84:87], a[252:255], v[172:175], v[84:87]
    s_xor_b32 s74, s24, 24576
    ds_read_b64_tr_b16 a[212:213], v56 offset:12288
    v_mfma_f32_16x16x32_bf16 v[92:95], a[248:251], v[184:187], v[92:95]
    ds_read_b64_tr_b16 a[214:215], v56 offset:14336
    v_mfma_f32_16x16x32_bf16 v[92:95], a[252:255], v[188:191], v[92:95]
    s_waitcnt lgkmcnt(9)
    ds_read_b64_tr_b16 a[216:217], v57 offset:8192
    v_mfma_f32_16x16x32_bf16 v[96:99], a[192:195], v[128:131], 0
    s_waitcnt lgkmcnt(9)
    ds_read_b64_tr_b16 a[218:219], v57 offset:10240
    v_mfma_f32_16x16x32_bf16 v[96:99], a[196:199], v[132:135], v[96:99]
    buffer_load_dwordx4 v[236:239], v1, s[8:11], s74 offen offset:3072
    ds_read_b64_tr_b16 a[220:221], v57 offset:12288
    v_mfma_f32_16x16x32_bf16 v[104:107], a[192:195], v[144:147], 0
    s_xor_b32 s74, s24, 28672
    ds_read_b64_tr_b16 a[222:223], v57 offset:14336
    v_mfma_f32_16x16x32_bf16 v[104:107], a[196:199], v[148:151], v[104:107]
    s_waitcnt lgkmcnt(9)
    ds_read_b64_tr_b16 a[224:225], v56 offset:16384
    v_mfma_f32_16x16x32_bf16 v[100:103], a[200:203], v[128:131], 0
    s_waitcnt lgkmcnt(9)
    ds_read_b64_tr_b16 a[226:227], v56 offset:18432
    v_mfma_f32_16x16x32_bf16 v[100:103], a[204:207], v[132:135], v[100:103]
    ds_read_b64_tr_b16 a[228:229], v56 offset:20480
    v_mfma_f32_16x16x32_bf16 v[108:111], a[200:203], v[144:147], 0
    buffer_load_dwordx4 v[252:255], v1, s[8:11], s74 offen offset:3072
    ds_read_b64_tr_b16 a[230:231], v56 offset:22528
    v_mfma_f32_16x16x32_bf16 v[108:111], a[204:207], v[148:151], v[108:111]
    s_waitcnt lgkmcnt(9)
    ds_read_b64_tr_b16 a[232:233], v57 offset:16384
    v_mfma_f32_16x16x32_bf16 v[96:99], a[208:211], v[136:139], v[96:99]
    s_waitcnt lgkmcnt(9)
    ds_read_b64_tr_b16 a[234:235], v57 offset:18432
    v_mfma_f32_16x16x32_bf16 v[96:99], a[212:215], v[140:143], v[96:99]
    ds_read_b64_tr_b16 a[236:237], v57 offset:20480
    v_mfma_f32_16x16x32_bf16 v[104:107], a[208:211], v[152:155], v[104:107]
    ds_read_b64_tr_b16 a[238:239], v57 offset:22528
    v_mfma_f32_16x16x32_bf16 v[104:107], a[212:215], v[156:159], v[104:107]
    s_waitcnt lgkmcnt(9)
    ds_read_b64_tr_b16 a[240:241], v56 offset:24576
    v_mfma_f32_16x16x32_bf16 v[100:103], a[216:219], v[136:139], v[100:103]
    s_waitcnt lgkmcnt(9)
    ds_read_b64_tr_b16 a[242:243], v56 offset:26624
    v_mfma_f32_16x16x32_bf16 v[100:103], a[220:223], v[140:143], v[100:103]
    ds_read_b64_tr_b16 a[244:245], v56 offset:28672
    v_mfma_f32_16x16x32_bf16 v[108:111], a[216:219], v[152:155], v[108:111]
    ds_read_b64_tr_b16 a[246:247], v56 offset:30720
    v_mfma_f32_16x16x32_bf16 v[108:111], a[220:223], v[156:159], v[108:111]
    s_waitcnt lgkmcnt(9)
    ds_read_b64_tr_b16 a[248:249], v57 offset:24576
    v_mfma_f32_16x16x32_bf16 v[96:99], a[224:227], v[160:163], v[96:99]
    s_waitcnt lgkmcnt(9)
    ds_read_b64_tr_b16 a[250:251], v57 offset:26624
    v_mfma_f32_16x16x32_bf16 v[96:99], a[228:231], v[164:167], v[96:99]
    ds_read_b64_tr_b16 a[252:253], v57 offset:28672
    v_mfma_f32_16x16x32_bf16 v[104:107], a[224:227], v[176:179], v[104:107]
    ds_read_b64_tr_b16 a[254:255], v57 offset:30720
    v_mfma_f32_16x16x32_bf16 v[104:107], a[228:231], v[180:183], v[104:107]
    s_waitcnt lgkmcnt(8)
    ds_read_b64_tr_b16 a[192:193], v58 offset:0
    v_mfma_f32_16x16x32_bf16 v[100:103], a[232:235], v[160:163], v[100:103]
    buffer_load_dwordx2 v[32:33], v45, s[32:35], s100 offen
    ds_read_b64_tr_b16 a[194:195], v58 offset:2048
    v_mfma_f32_16x16x32_bf16 v[100:103], a[236:239], v[164:167], v[100:103]
    ds_read_b64_tr_b16 a[196:197], v58 offset:4096
    v_mfma_f32_16x16x32_bf16 v[108:111], a[232:235], v[176:179], v[108:111]
    ds_read_b64_tr_b16 a[198:199], v58 offset:6144
    v_mfma_f32_16x16x32_bf16 v[108:111], a[236:239], v[180:183], v[108:111]
    s_waitcnt lgkmcnt(8)
    ds_read_b64_tr_b16 a[200:201], v59 offset:0
    v_mfma_f32_16x16x32_bf16 v[96:99], a[240:243], v[168:171], v[96:99]
    buffer_load_dwordx2 v[34:35], v45, s[32:35], s100 offen offset:32
    ds_read_b64_tr_b16 a[202:203], v59 offset:2048
    v_mfma_f32_16x16x32_bf16 v[96:99], a[244:247], v[172:175], v[96:99]
    ds_read_b64_tr_b16 a[204:205], v59 offset:4096
    v_mfma_f32_16x16x32_bf16 v[104:107], a[240:243], v[184:187], v[104:107]
    ds_read_b64_tr_b16 a[206:207], v59 offset:6144
    v_mfma_f32_16x16x32_bf16 v[104:107], a[244:247], v[188:191], v[104:107]
    s_waitcnt lgkmcnt(8)
    ds_read_b64_tr_b16 a[208:209], v58 offset:8192
    v_mfma_f32_16x16x32_bf16 v[100:103], a[248:251], v[168:171], v[100:103]
    buffer_load_dwordx2 v[36:37], v45, s[32:35], s101 offen
    ds_read_b64_tr_b16 a[210:211], v58 offset:10240
    v_mfma_f32_16x16x32_bf16 v[100:103], a[252:255], v[172:175], v[100:103]
    ds_read_b64_tr_b16 a[212:213], v58 offset:12288
    v_mfma_f32_16x16x32_bf16 v[108:111], a[248:251], v[184:187], v[108:111]
    ds_read_b64_tr_b16 a[214:215], v58 offset:14336
    v_mfma_f32_16x16x32_bf16 v[108:111], a[252:255], v[188:191], v[108:111]
    s_waitcnt lgkmcnt(8)
    ds_read_b64_tr_b16 a[216:217], v59 offset:8192
    v_mfma_f32_16x16x32_bf16 v[112:115], a[192:195], v[128:131], 0
    buffer_load_dwordx2 v[38:39], v45, s[32:35], s101 offen offset:32
    ds_read_b64_tr_b16 a[218:219], v59 offset:10240
    v_mfma_f32_16x16x32_bf16 v[112:115], a[196:199], v[132:135], v[112:115]
    ds_read_b64_tr_b16 a[220:221], v59 offset:12288
    v_mfma_f32_16x16x32_bf16 v[120:123], a[192:195], v[144:147], 0
    ds_read_b64_tr_b16 a[222:223], v59 offset:14336
    v_mfma_f32_16x16x32_bf16 v[120:123], a[196:199], v[148:151], v[120:123]
    s_waitcnt lgkmcnt(8)
    ds_read_b64_tr_b16 a[224:225], v58 offset:16384
    v_mfma_f32_16x16x32_bf16 v[116:119], a[200:203], v[128:131], 0
    buffer_load_dwordx2 v[40:41], v45, s[56:59], 0 offen
    ds_read_b64_tr_b16 a[226:227], v58 offset:18432
    v_mfma_f32_16x16x32_bf16 v[116:119], a[204:207], v[132:135], v[116:119]
    ds_read_b64_tr_b16 a[228:229], v58 offset:20480
    v_mfma_f32_16x16x32_bf16 v[124:127], a[200:203], v[144:147], 0
    ds_read_b64_tr_b16 a[230:231], v58 offset:22528
    v_mfma_f32_16x16x32_bf16 v[124:127], a[204:207], v[148:151], v[124:127]
    s_waitcnt lgkmcnt(8)
    ds_read_b64_tr_b16 a[232:233], v59 offset:16384
    v_mfma_f32_16x16x32_bf16 v[112:115], a[208:211], v[136:139], v[112:115]
    buffer_load_dwordx2 v[42:43], v45, s[56:59], 0 offen offset:32
    ds_read_b64_tr_b16 a[234:235], v59 offset:18432
    v_mfma_f32_16x16x32_bf16 v[112:115], a[212:215], v[140:143], v[112:115]
    ds_read_b64_tr_b16 a[236:237], v59 offset:20480
    v_mfma_f32_16x16x32_bf16 v[120:123], a[208:211], v[152:155], v[120:123]
    ds_read_b64_tr_b16 a[238:239], v59 offset:22528
    v_mfma_f32_16x16x32_bf16 v[120:123], a[212:215], v[156:159], v[120:123]
    s_waitcnt lgkmcnt(9)
    ds_read_b64_tr_b16 a[240:241], v58 offset:24576
    v_mfma_f32_16x16x32_bf16 v[116:119], a[216:219], v[136:139], v[116:119]
    s_waitcnt lgkmcnt(9)
    ds_read_b64_tr_b16 a[242:243], v58 offset:26624
    v_mfma_f32_16x16x32_bf16 v[116:119], a[220:223], v[140:143], v[116:119]
    ds_read_b64_tr_b16 a[244:245], v58 offset:28672
    v_mfma_f32_16x16x32_bf16 v[124:127], a[216:219], v[152:155], v[124:127]
    ds_read_b64_tr_b16 a[246:247], v58 offset:30720
    v_mfma_f32_16x16x32_bf16 v[124:127], a[220:223], v[156:159], v[124:127]
    s_waitcnt lgkmcnt(9)
    ds_read_b64_tr_b16 a[248:249], v59 offset:24576
    v_mfma_f32_16x16x32_bf16 v[112:115], a[224:227], v[160:163], v[112:115]
    s_waitcnt lgkmcnt(9)
    ds_read_b64_tr_b16 a[250:251], v59 offset:26624
    v_mfma_f32_16x16x32_bf16 v[112:115], a[228:231], v[164:167], v[112:115]
    ds_read_b64_tr_b16 a[252:253], v59 offset:28672
    v_mfma_f32_16x16x32_bf16 v[120:123], a[224:227], v[176:179], v[120:123]
    ds_read_b64_tr_b16 a[254:255], v59 offset:30720
    v_mfma_f32_16x16x32_bf16 v[120:123], a[228:231], v[180:183], v[120:123]
    s_waitcnt lgkmcnt(9)
    ds_read_b64_tr_b16 a[192:193], v60 offset:0
    v_mfma_f32_16x16x32_bf16 v[116:119], a[232:235], v[160:163], v[116:119]
    s_waitcnt lgkmcnt(9)
    ds_read_b64_tr_b16 a[194:195], v60 offset:2048
    v_mfma_f32_16x16x32_bf16 v[116:119], a[236:239], v[164:167], v[116:119]
    ds_read_b64_tr_b16 a[196:197], v60 offset:4096
    v_mfma_f32_16x16x32_bf16 v[124:127], a[232:235], v[176:179], v[124:127]
    ds_read_b64_tr_b16 a[198:199], v60 offset:6144
    v_mfma_f32_16x16x32_bf16 v[124:127], a[236:239], v[180:183], v[124:127]
    s_waitcnt lgkmcnt(9)
    ds_read_b64_tr_b16 a[200:201], v61 offset:0
    v_mfma_f32_16x16x32_bf16 v[112:115], a[240:243], v[168:171], v[112:115]
    s_waitcnt lgkmcnt(9)
    ds_read_b64_tr_b16 a[202:203], v61 offset:2048
    ds_read_b64_tr_b16 a[224:225], v60 offset:16384
    v_mfma_f32_16x16x32_bf16 v[112:115], a[244:247], v[172:175], v[112:115]
    ds_read_b64_tr_b16 a[204:205], v61 offset:4096
    ds_read_b64_tr_b16 a[226:227], v60 offset:18432
    v_mfma_f32_16x16x32_bf16 v[120:123], a[240:243], v[184:187], v[120:123]
    ds_read_b64_tr_b16 a[206:207], v61 offset:6144
    ds_read_b64_tr_b16 a[228:229], v60 offset:20480
    v_mfma_f32_16x16x32_bf16 v[120:123], a[244:247], v[188:191], v[120:123]
    s_waitcnt lgkmcnt(12)
    ds_read_b64_tr_b16 a[208:209], v60 offset:8192
    ds_read_b64_tr_b16 a[230:231], v60 offset:22528
    v_mfma_f32_16x16x32_bf16 v[116:119], a[248:251], v[168:171], v[116:119]
    s_waitcnt lgkmcnt(13)
    ds_read_b64_tr_b16 a[210:211], v60 offset:10240
    ds_read_b64_tr_b16 a[232:233], v61 offset:16384
    v_mfma_f32_16x16x32_bf16 v[116:119], a[252:255], v[172:175], v[116:119]
    ds_read_b64_tr_b16 a[212:213], v60 offset:12288
    ds_read_b64_tr_b16 a[234:235], v61 offset:18432
    v_mfma_f32_16x16x32_bf16 v[124:127], a[248:251], v[184:187], v[124:127]
    ds_read_b64_tr_b16 a[214:215], v60 offset:14336
    ds_read_b64_tr_b16 a[236:237], v61 offset:20480
    v_mfma_f32_16x16x32_bf16 v[124:127], a[252:255], v[188:191], v[124:127]
    s_waitcnt vmcnt(23) lgkmcnt(15)
    ds_read_b64_tr_b16 a[216:217], v61 offset:8192
    ds_read_b64_tr_b16 a[238:239], v61 offset:22528
    v_mfma_f32_16x16x32_bf16 v[64:67], a[192:195], v[192:195], v[64:67]
    s_waitcnt vmcnt(21)
    ds_read_b64_tr_b16 a[218:219], v61 offset:10240
    v_mfma_f32_16x16x32_bf16 v[64:67], a[196:199], v[196:199], v[64:67]
    ds_read_b64_tr_b16 a[220:221], v61 offset:12288
    v_mfma_f32_16x16x32_bf16 v[72:75], a[192:195], v[208:211], v[72:75]
    s_waitcnt vmcnt(20) lgkmcnt(15)
    s_mov_b32 s74, 8192
    ds_read_b64_tr_b16 a[222:223], v61 offset:14336
    v_mfma_f32_16x16x32_bf16 v[72:75], a[196:199], v[212:215], v[72:75]
    buffer_load_dwordx4 v[168:171], v46, s[8:11], s74 offen
    v_mfma_f32_16x16x32_bf16 v[68:71], a[200:203], v[192:195], v[68:71]
    s_waitcnt lgkmcnt(13)
    ds_read_b64_tr_b16 a[240:241], v60 offset:24576
    v_mfma_f32_16x16x32_bf16 v[68:71], a[204:207], v[196:199], v[68:71]
    ds_read_b64_tr_b16 a[242:243], v60 offset:26624
    v_mfma_f32_16x16x32_bf16 v[76:79], a[200:203], v[208:211], v[76:79]
    buffer_load_dwordx4 v[172:175], v46, s[8:11], s74 offen offset:64
    v_mfma_f32_16x16x32_bf16 v[76:79], a[204:207], v[212:215], v[76:79]
    s_waitcnt vmcnt(21) lgkmcnt(9)
    s_mov_b32 s74, 6144
    ds_read_b64_tr_b16 a[244:245], v60 offset:28672
    v_mfma_f32_16x16x32_bf16 v[64:67], a[208:211], v[200:203], v[64:67]
    s_waitcnt vmcnt(18) lgkmcnt(8)
    ds_read_b64_tr_b16 a[246:247], v60 offset:30720
    v_mfma_f32_16x16x32_bf16 v[64:67], a[212:215], v[204:207], v[64:67]
    buffer_load_dwordx4 v[176:179], v46, s[8:11], s74 offen
    v_mfma_f32_16x16x32_bf16 v[72:75], a[208:211], v[216:219], v[72:75]
    s_waitcnt vmcnt(18)
    ds_read_b64_tr_b16 a[248:249], v61 offset:24576
    v_mfma_f32_16x16x32_bf16 v[72:75], a[212:215], v[220:223], v[72:75]
    s_waitcnt lgkmcnt(5)
    ds_read_b64_tr_b16 a[250:251], v61 offset:26624
    v_mfma_f32_16x16x32_bf16 v[68:71], a[216:219], v[200:203], v[68:71]
    buffer_load_dwordx4 v[180:183], v46, s[8:11], s74 offen offset:64
    ds_read_b64_tr_b16 a[252:253], v61 offset:28672
    v_mfma_f32_16x16x32_bf16 v[68:71], a[220:223], v[204:207], v[68:71]
    s_mov_b32 s74, 4096
    ds_read_b64_tr_b16 a[254:255], v61 offset:30720
    v_mfma_f32_16x16x32_bf16 v[76:79], a[216:219], v[216:219], v[76:79]
    s_waitcnt vmcnt(17)
    ds_read_b64_tr_b16 a[192:193], v62 offset:0
    v_mfma_f32_16x16x32_bf16 v[76:79], a[220:223], v[220:223], v[76:79]
    buffer_load_dwordx4 v[160:163], v46, s[8:11], s74 offen
    v_mfma_f32_16x16x32_bf16 v[64:67], a[224:227], v[224:227], v[64:67]
    s_waitcnt vmcnt(16)
    ds_read_b64_tr_b16 a[194:195], v62 offset:2048
    s_waitcnt vmcnt(6)
    v_lshlrev_b32 v48, 16, v40
    v_mfma_f32_16x16x32_bf16 v[64:67], a[228:231], v[228:231], v[64:67]
    ds_read_b64_tr_b16 a[196:197], v62 offset:4096
    v_and_b32 v49, 0xffff0000, v40
    v_mfma_f32_16x16x32_bf16 v[72:75], a[224:227], v[240:243], v[72:75]
    buffer_load_dwordx4 v[164:167], v46, s[8:11], s74 offen offset:64
    v_mfma_f32_16x16x32_bf16 v[72:75], a[228:231], v[244:247], v[72:75]
    s_mov_b32 s74, 10240
    ds_read_b64_tr_b16 a[198:199], v62 offset:6144
    v_lshlrev_b32 v50, 16, v41
    v_mfma_f32_16x16x32_bf16 v[68:71], a[232:235], v[224:227], v[68:71]
    ds_read_b64_tr_b16 a[200:201], v63 offset:0
    v_and_b32 v51, 0xffff0000, v41
    v_mfma_f32_16x16x32_bf16 v[68:71], a[236:239], v[228:231], v[68:71]
    buffer_load_dwordx4 v[184:187], v46, s[8:11], s74 offen
    ds_read_b64_tr_b16 a[202:203], v63 offset:2048
    v_mfma_f32_16x16x32_bf16 v[76:79], a[232:235], v[240:243], v[76:79]
    ds_read_b64_tr_b16 a[204:205], v63 offset:4096
    s_waitcnt vmcnt(7)
    v_lshlrev_b32 v52, 16, v42
    v_mfma_f32_16x16x32_bf16 v[76:79], a[236:239], v[244:247], v[76:79]
    s_waitcnt lgkmcnt(7)
    ds_read_b64_tr_b16 a[206:207], v63 offset:6144
    v_and_b32 v53, 0xffff0000, v42
    v_mfma_f32_16x16x32_bf16 v[64:67], a[240:243], v[232:235], v[64:67]
    buffer_load_dwordx4 v[188:191], v46, s[8:11], s74 offen offset:64
    v_mfma_f32_16x16x32_bf16 v[64:67], a[244:247], v[236:239], v[64:67]
    ds_read_b64_tr_b16 a[208:209], v62 offset:8192
    v_lshlrev_b32 v54, 16, v43
    v_mfma_f32_16x16x32_bf16 v[72:75], a[240:243], v[248:251], v[72:75]
    ds_read_b64_tr_b16 a[210:211], v62 offset:10240
    v_and_b32 v55, 0xffff0000, v43
    v_mfma_f32_16x16x32_bf16 v[72:75], a[244:247], v[252:255], v[72:75]
    ds_read_b64_tr_b16 a[212:213], v62 offset:12288
    v_mfma_f32_16x16x32_bf16 v[68:71], a[248:251], v[232:235], v[68:71]
    ds_read_b64_tr_b16 a[214:215], v62 offset:14336
    v_mfma_f32_16x16x32_bf16 v[68:71], a[252:255], v[236:239], v[68:71]
    ds_read_b64_tr_b16 a[216:217], v63 offset:8192
    v_mfma_f32_16x16x32_bf16 v[76:79], a[248:251], v[248:251], v[76:79]
    ds_read_b64_tr_b16 a[218:219], v63 offset:10240
    v_mfma_f32_16x16x32_bf16 v[76:79], a[252:255], v[252:255], v[76:79]
    s_waitcnt lgkmcnt(8)
    ds_read_b64_tr_b16 a[220:221], v63 offset:12288
    v_mfma_f32_16x16x32_bf16 v[80:83], a[192:195], v[192:195], v[80:83]
    ds_read_b64_tr_b16 a[222:223], v63 offset:14336
    v_mfma_f32_16x16x32_bf16 v[80:83], a[196:199], v[196:199], v[80:83]
    ds_read_b64_tr_b16 a[224:225], v62 offset:16384
    v_mfma_f32_16x16x32_bf16 v[88:91], a[192:195], v[208:211], v[88:91]
    ds_read_b64_tr_b16 a[226:227], v62 offset:18432
    v_mfma_f32_16x16x32_bf16 v[88:91], a[196:199], v[212:215], v[88:91]
    ds_read_b64_tr_b16 a[228:229], v62 offset:20480
    v_mfma_f32_16x16x32_bf16 v[84:87], a[200:203], v[192:195], v[84:87]
    s_waitcnt lgkmcnt(9)
    ds_read_b64_tr_b16 a[230:231], v62 offset:22528
    v_mfma_f32_16x16x32_bf16 v[84:87], a[204:207], v[196:199], v[84:87]
    ds_read_b64_tr_b16 a[232:233], v63 offset:16384
    v_mfma_f32_16x16x32_bf16 v[92:95], a[200:203], v[208:211], v[92:95]
    ds_read_b64_tr_b16 a[234:235], v63 offset:18432
    v_cvt_pk_bf16_f32 v64, v64, v65
    v_mfma_f32_16x16x32_bf16 v[92:95], a[204:207], v[212:215], v[92:95]
    ds_read_b64_tr_b16 a[236:237], v63 offset:20480
    v_cvt_pk_bf16_f32 v65, v66, v67
    v_mfma_f32_16x16x32_bf16 v[80:83], a[208:211], v[200:203], v[80:83]
    s_waitcnt lgkmcnt(9)
    ds_read_b64_tr_b16 a[238:239], v63 offset:22528
    v_cvt_pk_bf16_f32 v66, v68, v69
    v_mfma_f32_16x16x32_bf16 v[80:83], a[212:215], v[204:207], v[80:83]
    ds_read_b64_tr_b16 a[240:241], v62 offset:24576
    v_cvt_pk_bf16_f32 v67, v70, v71
    v_mfma_f32_16x16x32_bf16 v[88:91], a[208:211], v[216:219], v[88:91]
    ds_read_b64_tr_b16 a[242:243], v62 offset:26624
    v_min_u32 v64, -2, v64
    v_mfma_f32_16x16x32_bf16 v[88:91], a[212:215], v[220:223], v[88:91]
    ds_read_b64_tr_b16 a[244:245], v62 offset:28672
    v_min_u32 v65, -2, v65
    v_mfma_f32_16x16x32_bf16 v[84:87], a[216:219], v[200:203], v[84:87]
    s_waitcnt lgkmcnt(9)
    ds_read_b64_tr_b16 a[246:247], v62 offset:30720
    v_min_u32 v66, -2, v66
    v_mfma_f32_16x16x32_bf16 v[84:87], a[220:223], v[204:207], v[84:87]
    ds_read_b64_tr_b16 a[248:249], v63 offset:24576
    v_min_u32 v67, -2, v67
    v_mfma_f32_16x16x32_bf16 v[92:95], a[216:219], v[216:219], v[92:95]
    s_add_u32 s75, s18, 8388608
    ds_read_b64_tr_b16 a[250:251], v63 offset:26624
    v_mfma_f32_16x16x32_bf16 v[92:95], a[220:223], v[220:223], v[92:95]
    buffer_store_dwordx4 v[64:67], v23, s[8:11], s75 offen offset:0 sc0 sc1
    ds_read_b64_tr_b16 a[252:253], v63 offset:28672
    v_mfma_f32_16x16x32_bf16 v[80:83], a[224:227], v[224:227], v[80:83]
    s_waitcnt lgkmcnt(9)
    ds_read_b64_tr_b16 a[254:255], v63 offset:30720
    v_cvt_pk_bf16_f32 v72, v72, v73
    v_mfma_f32_16x16x32_bf16 v[80:83], a[228:231], v[228:231], v[80:83]
    ds_read_b64_tr_b16 a[192:193], v60 offset:32768
    v_cvt_pk_bf16_f32 v73, v74, v75
    v_mfma_f32_16x16x32_bf16 v[88:91], a[224:227], v[240:243], v[88:91]
    ds_read_b64_tr_b16 a[194:195], v60 offset:34816
    v_cvt_pk_bf16_f32 v74, v76, v77
    v_mfma_f32_16x16x32_bf16 v[88:91], a[228:231], v[244:247], v[88:91]
    ds_read_b64_tr_b16 a[196:197], v60 offset:36864
    v_cvt_pk_bf16_f32 v75, v78, v79
    v_mfma_f32_16x16x32_bf16 v[84:87], a[232:235], v[224:227], v[84:87]
    s_waitcnt lgkmcnt(9)
    ds_read_b64_tr_b16 a[198:199], v60 offset:38912
    v_min_u32 v72, -2, v72
    v_mfma_f32_16x16x32_bf16 v[84:87], a[236:239], v[228:231], v[84:87]
    ds_read_b64_tr_b16 a[200:201], v61 offset:32768
    v_min_u32 v73, -2, v73
    v_mfma_f32_16x16x32_bf16 v[92:95], a[232:235], v[240:243], v[92:95]
    ds_read_b64_tr_b16 a[202:203], v61 offset:34816
    v_min_u32 v74, -2, v74
    v_mfma_f32_16x16x32_bf16 v[92:95], a[236:239], v[244:247], v[92:95]
    ds_read_b64_tr_b16 a[204:205], v61 offset:36864
    v_min_u32 v75, -2, v75
    v_mfma_f32_16x16x32_bf16 v[80:83], a[240:243], v[232:235], v[80:83]
    s_waitcnt lgkmcnt(9)
    s_add_u32 s75, s18, 8519680
    ds_read_b64_tr_b16 a[206:207], v61 offset:38912
    s_waitcnt vmcnt(8)
    v_mul_f32 v8, v48, v168
    v_mfma_f32_16x16x32_bf16 v[80:83], a[244:247], v[236:239], v[80:83]
    buffer_store_dwordx4 v[72:75], v23, s[8:11], s75 offen offset:0 sc0 sc1
    v_mfma_f32_16x16x32_bf16 v[88:91], a[240:243], v[248:251], v[88:91]
    ds_read_b64_tr_b16 a[208:209], v60 offset:40960
    v_mul_f32 v9, v49, v169
    v_mfma_f32_16x16x32_bf16 v[88:91], a[244:247], v[252:255], v[88:91]
    ds_read_b64_tr_b16 a[210:211], v60 offset:43008
    v_mul_f32 v10, v50, v170
    v_mfma_f32_16x16x32_bf16 v[84:87], a[248:251], v[232:235], v[84:87]
    s_waitcnt lgkmcnt(8)
    ds_read_b64_tr_b16 a[212:213], v60 offset:45056
    v_mul_f32 v11, v51, v171
    v_mfma_f32_16x16x32_bf16 v[84:87], a[252:255], v[236:239], v[84:87]
    ds_read_b64_tr_b16 a[214:215], v60 offset:47104
    s_waitcnt vmcnt(8)
    v_mul_f32 v12, v52, v172
    v_mfma_f32_16x16x32_bf16 v[92:95], a[248:251], v[248:251], v[92:95]
    ds_read_b64_tr_b16 a[216:217], v61 offset:40960
    v_mul_f32 v13, v53, v173
    v_mfma_f32_16x16x32_bf16 v[92:95], a[252:255], v[252:255], v[92:95]
    ds_read_b64_tr_b16 a[218:219], v61 offset:43008
    v_mul_f32 v14, v54, v174
    v_mfma_f32_16x16x32_bf16 v[96:99], a[192:195], v[192:195], v[96:99]
    s_waitcnt lgkmcnt(8)
    ds_read_b64_tr_b16 a[220:221], v61 offset:45056
    v_mul_f32 v15, v55, v175
    v_mfma_f32_16x16x32_bf16 v[96:99], a[196:199], v[196:199], v[96:99]
    ds_read_b64_tr_b16 a[222:223], v61 offset:47104
    s_waitcnt vmcnt(7)
    v_mul_f32 v16, v48, v176
    v_mfma_f32_16x16x32_bf16 v[104:107], a[192:195], v[208:211], v[104:107]
    ds_read_b64_tr_b16 a[224:225], v60 offset:49152
    v_fmac_f32 v16, v49, v177
    v_mfma_f32_16x16x32_bf16 v[104:107], a[196:199], v[212:215], v[104:107]
    ds_read_b64_tr_b16 a[226:227], v60 offset:51200
    v_fmac_f32 v16, v50, v178
    v_mfma_f32_16x16x32_bf16 v[100:103], a[200:203], v[192:195], v[100:103]
    s_waitcnt lgkmcnt(9)
    ds_read_b64_tr_b16 a[228:229], v60 offset:53248
    v_fmac_f32 v16, v51, v179
    v_mfma_f32_16x16x32_bf16 v[100:103], a[204:207], v[196:199], v[100:103]
    ds_read_b64_tr_b16 a[230:231], v60 offset:55296
    s_waitcnt vmcnt(6)
    v_fmac_f32 v16, v52, v180
    v_mfma_f32_16x16x32_bf16 v[108:111], a[200:203], v[208:211], v[108:111]
    ds_read_b64_tr_b16 a[232:233], v61 offset:49152
    v_cvt_pk_bf16_f32 v80, v80, v81
    v_mfma_f32_16x16x32_bf16 v[108:111], a[204:207], v[212:215], v[108:111]
    s_waitcnt lgkmcnt(9)
    ds_read_b64_tr_b16 a[234:235], v61 offset:51200
    v_cvt_pk_bf16_f32 v81, v82, v83
    v_mfma_f32_16x16x32_bf16 v[96:99], a[208:211], v[200:203], v[96:99]
    ds_read_b64_tr_b16 a[236:237], v61 offset:53248
    v_cvt_pk_bf16_f32 v82, v84, v85
    v_mfma_f32_16x16x32_bf16 v[96:99], a[212:215], v[204:207], v[96:99]
    ds_read_b64_tr_b16 a[238:239], v61 offset:55296
    v_cvt_pk_bf16_f32 v83, v86, v87
    v_mfma_f32_16x16x32_bf16 v[104:107], a[208:211], v[216:219], v[104:107]
    ds_read_b64_tr_b16 a[240:241], v60 offset:57344
    v_min_u32 v80, -2, v80
    v_mfma_f32_16x16x32_bf16 v[104:107], a[212:215], v[220:223], v[104:107]
    s_waitcnt lgkmcnt(9)
    ds_read_b64_tr_b16 a[242:243], v60 offset:59392
    v_min_u32 v81, -2, v81
    v_mfma_f32_16x16x32_bf16 v[100:103], a[216:219], v[200:203], v[100:103]
    ds_read_b64_tr_b16 a[244:245], v60 offset:61440
    v_min_u32 v82, -2, v82
    v_mfma_f32_16x16x32_bf16 v[100:103], a[220:223], v[204:207], v[100:103]
    ds_read_b64_tr_b16 a[246:247], v60 offset:63488
    v_min_u32 v83, -2, v83
    v_mfma_f32_16x16x32_bf16 v[108:111], a[216:219], v[216:219], v[108:111]
    s_waitcnt lgkmcnt(9)
    s_add_u32 s75, s18, 8388608
    ds_read_b64_tr_b16 a[248:249], v61 offset:57344
    v_fmac_f32 v16, v53, v181
    v_mfma_f32_16x16x32_bf16 v[108:111], a[220:223], v[220:223], v[108:111]
    buffer_store_dwordx4 v[80:83], v23, s[8:11], s75 offen offset:256 sc0 sc1
    ds_read_b64_tr_b16 a[250:251], v61 offset:59392
    v_mfma_f32_16x16x32_bf16 v[96:99], a[224:227], v[224:227], v[96:99]
    s_waitcnt lgkmcnt(9)
    ds_read_b64_tr_b16 a[252:253], v61 offset:61440
    v_cvt_pk_bf16_f32 v88, v88, v89
    v_mfma_f32_16x16x32_bf16 v[96:99], a[228:231], v[228:231], v[96:99]
    ds_read_b64_tr_b16 a[254:255], v61 offset:63488
    v_cvt_pk_bf16_f32 v89, v90, v91
    v_mfma_f32_16x16x32_bf16 v[104:107], a[224:227], v[240:243], v[104:107]
    ds_read_b64_tr_b16 a[192:193], v62 offset:32768
    v_cvt_pk_bf16_f32 v90, v92, v93
    v_mfma_f32_16x16x32_bf16 v[104:107], a[228:231], v[244:247], v[104:107]
    s_waitcnt lgkmcnt(9)
    ds_read_b64_tr_b16 a[194:195], v62 offset:34816
    v_cvt_pk_bf16_f32 v91, v94, v95
    v_mfma_f32_16x16x32_bf16 v[100:103], a[232:235], v[224:227], v[100:103]
    ds_read_b64_tr_b16 a[196:197], v62 offset:36864
    v_min_u32 v88, -2, v88
    v_mfma_f32_16x16x32_bf16 v[100:103], a[236:239], v[228:231], v[100:103]
    ds_read_b64_tr_b16 a[198:199], v62 offset:38912
    v_min_u32 v89, -2, v89
    v_mfma_f32_16x16x32_bf16 v[108:111], a[232:235], v[240:243], v[108:111]
    ds_read_b64_tr_b16 a[200:201], v63 offset:32768
    v_min_u32 v90, -2, v90
    v_mfma_f32_16x16x32_bf16 v[108:111], a[236:239], v[244:247], v[108:111]
    s_waitcnt lgkmcnt(9)
    ds_read_b64_tr_b16 a[202:203], v63 offset:34816
    v_fmac_f32 v16, v54, v182
    v_mfma_f32_16x16x32_bf16 v[96:99], a[240:243], v[232:235], v[96:99]
    s_add_u32 s74, s70, 0
    ds_read_b64_tr_b16 a[204:205], v63 offset:36864
    v_min_u32 v91, -2, v91
    v_mfma_f32_16x16x32_bf16 v[96:99], a[244:247], v[236:239], v[96:99]
    buffer_load_dwordx4 v[128:131], v44, s[8:11], s74 offen sc0 sc1
    ds_read_b64_tr_b16 a[206:207], v63 offset:38912
    v_mfma_f32_16x16x32_bf16 v[104:107], a[240:243], v[248:251], v[104:107]
    s_add_u32 s74, s70, 4096
    ds_read_b64_tr_b16 a[208:209], v62 offset:40960
    v_fmac_f32 v16, v55, v183
    v_mfma_f32_16x16x32_bf16 v[104:107], a[244:247], v[252:255], v[104:107]
    s_waitcnt lgkmcnt(9)
    s_add_u32 s75, s18, 8519680
    ds_read_b64_tr_b16 a[210:211], v62 offset:43008
    v_add_f32_dpp v16, v16, v16 quad_perm:[1,0,3,2] row_mask:0xf bank_mask:0xf
    v_mfma_f32_16x16x32_bf16 v[100:103], a[248:251], v[232:235], v[100:103]
    buffer_store_dwordx4 v[88:91], v23, s[8:11], s75 offen offset:256 sc0 sc1
    ds_read_b64_tr_b16 a[212:213], v62 offset:45056
    v_mfma_f32_16x16x32_bf16 v[100:103], a[252:255], v[236:239], v[100:103]
    buffer_load_dwordx4 v[132:135], v44, s[8:11], s74 offen sc0 sc1
    ds_read_b64_tr_b16 a[214:215], v62 offset:47104
    v_mfma_f32_16x16x32_bf16 v[108:111], a[248:251], v[248:251], v[108:111]
    s_add_u32 s74, s70, 8192
    ds_read_b64_tr_b16 a[216:217], v63 offset:40960
    v_add_f32_dpp v16, v16, v16 quad_perm:[2,3,0,1] row_mask:0xf bank_mask:0xf
    v_mfma_f32_16x16x32_bf16 v[108:111], a[252:255], v[252:255], v[108:111]
    s_waitcnt lgkmcnt(9)
    ds_read_b64_tr_b16 a[218:219], v63 offset:43008
    v_add_f32_dpp v16, v16, v16 row_half_mirror row_mask:0xf bank_mask:0xf
    v_mfma_f32_16x16x32_bf16 v[112:115], a[192:195], v[192:195], v[112:115]
    ds_read_b64_tr_b16 a[220:221], v63 offset:45056
    v_add_f32_dpp v16, v16, v16 row_mirror row_mask:0xf bank_mask:0xf
    v_mfma_f32_16x16x32_bf16 v[112:115], a[196:199], v[196:199], v[112:115]
    buffer_load_dwordx4 v[136:139], v44, s[8:11], s74 offen sc0 sc1
    ds_read_b64_tr_b16 a[222:223], v63 offset:47104
    v_mfma_f32_16x16x32_bf16 v[120:123], a[192:195], v[208:211], v[120:123]
    s_add_u32 s74, s70, 12288
    ds_read_b64_tr_b16 a[224:225], v62 offset:49152
    v_mov_b32 v19, v16
    v_mfma_f32_16x16x32_bf16 v[120:123], a[196:199], v[212:215], v[120:123]
    s_waitcnt lgkmcnt(9)
    ds_read_b64_tr_b16 a[226:227], v62 offset:51200
    v_permlane16_swap_b32 v16, v19
    v_mfma_f32_16x16x32_bf16 v[116:119], a[200:203], v[192:195], v[116:119]
    ds_read_b64_tr_b16 a[228:229], v62 offset:53248
    v_add_f32 v16, v16, v19
    v_mfma_f32_16x16x32_bf16 v[116:119], a[204:207], v[196:199], v[116:119]
    buffer_load_dwordx4 v[140:143], v44, s[8:11], s74 offen sc0 sc1
    ds_read_b64_tr_b16 a[230:231], v62 offset:55296
    v_mfma_f32_16x16x32_bf16 v[124:127], a[200:203], v[208:211], v[124:127]
    s_add_u32 s74, s70, 16384
    ds_read_b64_tr_b16 a[232:233], v63 offset:49152
    v_cvt_pk_bf16_f32 v96, v96, v97
    v_mfma_f32_16x16x32_bf16 v[124:127], a[204:207], v[212:215], v[124:127]
    s_waitcnt lgkmcnt(9)
    ds_read_b64_tr_b16 a[234:235], v63 offset:51200
    v_cvt_pk_bf16_f32 v97, v98, v99
    v_mfma_f32_16x16x32_bf16 v[112:115], a[208:211], v[200:203], v[112:115]
    ds_read_b64_tr_b16 a[236:237], v63 offset:53248
    v_cvt_pk_bf16_f32 v98, v100, v101
    v_mfma_f32_16x16x32_bf16 v[112:115], a[212:215], v[204:207], v[112:115]
    buffer_load_dwordx4 v[144:147], v44, s[8:11], s74 offen sc0 sc1
    ds_read_b64_tr_b16 a[238:239], v63 offset:55296
    v_mfma_f32_16x16x32_bf16 v[120:123], a[208:211], v[216:219], v[120:123]
    s_add_u32 s74, s70, 20480
    ds_read_b64_tr_b16 a[240:241], v62 offset:57344
    v_cvt_pk_bf16_f32 v99, v102, v103
    v_mfma_f32_16x16x32_bf16 v[120:123], a[212:215], v[220:223], v[120:123]
    s_waitcnt lgkmcnt(9)
    ds_read_b64_tr_b16 a[242:243], v62 offset:59392
    v_min_u32 v96, -2, v96
    v_mfma_f32_16x16x32_bf16 v[116:119], a[216:219], v[200:203], v[116:119]
    ds_read_b64_tr_b16 a[244:245], v62 offset:61440
    v_min_u32 v97, -2, v97
    v_mfma_f32_16x16x32_bf16 v[116:119], a[220:223], v[204:207], v[116:119]
    buffer_load_dwordx4 v[148:151], v44, s[8:11], s74 offen sc0 sc1
    ds_read_b64_tr_b16 a[246:247], v62 offset:63488
    v_mfma_f32_16x16x32_bf16 v[124:127], a[216:219], v[216:219], v[124:127]
    s_add_u32 s74, s70, 24576
    ds_read_b64_tr_b16 a[248:249], v63 offset:57344
    v_min_u32 v98, -2, v98
    v_mfma_f32_16x16x32_bf16 v[124:127], a[220:223], v[220:223], v[124:127]
    s_waitcnt lgkmcnt(9)
    ds_read_b64_tr_b16 a[250:251], v63 offset:59392
    v_min_u32 v99, -2, v99
    v_mfma_f32_16x16x32_bf16 v[112:115], a[224:227], v[224:227], v[112:115]
    s_add_u32 s75, s18, 8388608
    ds_read_b64_tr_b16 a[252:253], v63 offset:61440
    v_mov_b32 v19, v16
    v_mfma_f32_16x16x32_bf16 v[112:115], a[228:231], v[228:231], v[112:115]
    buffer_load_dwordx4 v[152:155], v44, s[8:11], s74 offen sc0 sc1
    ds_read_b64_tr_b16 a[254:255], v63 offset:63488
    v_mfma_f32_16x16x32_bf16 v[120:123], a[224:227], v[240:243], v[120:123]
    s_waitcnt lgkmcnt(9)
    s_add_u32 s74, s70, 28672
    v_permlane32_swap_b32 v16, v19
    v_mfma_f32_16x16x32_bf16 v[120:123], a[228:231], v[244:247], v[120:123]
    buffer_store_dwordx4 v[96:99], v23, s[8:11], s75 offen offset:512 sc0 sc1
    v_add_f32 v16, v16, v19
    v_mfma_f32_16x16x32_bf16 v[116:119], a[232:235], v[224:227], v[116:119]
    s_waitcnt lgkmcnt(7)
    v_cvt_pk_bf16_f32 v104, v104, v105
    v_mfma_f32_16x16x32_bf16 v[116:119], a[236:239], v[228:231], v[116:119]
    buffer_load_dwordx4 v[156:159], v44, s[8:11], s74 offen sc0 sc1
    v_mfma_f32_16x16x32_bf16 v[124:127], a[232:235], v[240:243], v[124:127]
    v_cvt_pk_bf16_f32 v105, v106, v107
    v_mfma_f32_16x16x32_bf16 v[124:127], a[236:239], v[244:247], v[124:127]
    s_waitcnt lgkmcnt(4)
    v_cvt_pk_bf16_f32 v106, v108, v109
    v_mfma_f32_16x16x32_bf16 v[112:115], a[240:243], v[232:235], v[112:115]
    v_cvt_pk_bf16_f32 v107, v110, v111
    v_mfma_f32_16x16x32_bf16 v[112:115], a[244:247], v[236:239], v[112:115]
    v_min_u32 v104, -2, v104
    v_mfma_f32_16x16x32_bf16 v[120:123], a[240:243], v[248:251], v[120:123]
    v_min_u32 v105, -2, v105
    v_mfma_f32_16x16x32_bf16 v[120:123], a[244:247], v[252:255], v[120:123]
    s_waitcnt lgkmcnt(0)
    v_min_u32 v106, -2, v106
    v_mfma_f32_16x16x32_bf16 v[116:119], a[248:251], v[232:235], v[116:119]
    v_min_u32 v107, -2, v107
    v_mfma_f32_16x16x32_bf16 v[116:119], a[252:255], v[236:239], v[116:119]
    s_add_u32 s75, s18, 8519680
    v_mfma_f32_16x16x32_bf16 v[124:127], a[248:251], v[248:251], v[124:127]
    buffer_store_dwordx4 v[104:107], v23, s[8:11], s75 offen offset:512 sc0 sc1
    v_mfma_f32_16x16x32_bf16 v[124:127], a[252:255], v[252:255], v[124:127]
    v_cvt_pk_bf16_f32 v112, v112, v113
    v_cvt_pk_bf16_f32 v113, v114, v115
    s_nop 1
    v_cvt_pk_bf16_f32 v114, v116, v117
    v_cvt_pk_bf16_f32 v115, v118, v119
    v_min_u32 v112, -2, v112
    v_min_u32 v113, -2, v113
    v_min_u32 v114, -2, v114
    v_min_u32 v115, -2, v115
    s_add_u32 s75, s18, 8388608
    buffer_store_dwordx4 v[112:115], v23, s[8:11], s75 offen offset:768 sc0 sc1
    v_cvt_pk_bf16_f32 v120, v120, v121
    v_cvt_pk_bf16_f32 v121, v122, v123
    v_cvt_pk_bf16_f32 v122, v124, v125
    v_cvt_pk_bf16_f32 v123, v126, v127
    v_min_u32 v120, -2, v120
    v_min_u32 v121, -2, v121
    v_min_u32 v122, -2, v122
    v_min_u32 v123, -2, v123
    s_add_u32 s75, s18, 8519680
    buffer_store_dwordx4 v[120:123], v23, s[8:11], s75 offen offset:768 sc0 sc1
    s_mov_b32 s12, 0xf000f0
    s_mov_b32 s13, 0xf000f0
    v_mov_b64 v[192:193], -1
    v_mov_b64 v[194:195], -1
    v_mov_b64 v[196:197], -1
    v_mov_b64 v[198:199], -1
    v_mov_b64 v[200:201], -1
    v_mov_b64 v[202:203], -1
    v_mov_b64 v[204:205], -1
    v_mov_b64 v[206:207], -1
    v_mov_b64 v[208:209], -1
    v_mov_b64 v[210:211], -1
    v_mov_b64 v[212:213], -1
    v_mov_b64 v[214:215], -1
    v_mov_b64 v[216:217], -1
    v_mov_b64 v[218:219], -1
    v_mov_b64 v[220:221], -1
    v_mov_b64 v[222:223], -1
    s_mov_b64 exec, s[12:13]
    s_add_u32 s74, s70, 8388608
    buffer_load_dwordx4 v[192:195], v44, s[8:11], s74 offen sc0 sc1
    s_add_u32 s74, s70, 8392704
    buffer_load_dwordx4 v[196:199], v44, s[8:11], s74 offen sc0 sc1
    s_add_u32 s74, s70, 8396800
    buffer_load_dwordx4 v[200:203], v44, s[8:11], s74 offen sc0 sc1
    s_add_u32 s74, s70, 8400896
    buffer_load_dwordx4 v[204:207], v44, s[8:11], s74 offen sc0 sc1
    s_add_u32 s74, s70, 8404992
    buffer_load_dwordx4 v[208:211], v44, s[8:11], s74 offen sc0 sc1
    s_add_u32 s74, s70, 8409088
    buffer_load_dwordx4 v[212:215], v44, s[8:11], s74 offen sc0 sc1
    s_add_u32 s74, s70, 8413184
    buffer_load_dwordx4 v[216:219], v44, s[8:11], s74 offen sc0 sc1
    s_add_u32 s74, s70, 8417280
    buffer_load_dwordx4 v[220:223], v44, s[8:11], s74 offen sc0 sc1
    s_mov_b64 exec, -1
    v_mov_b32 v100, 0x3f80
    v_mov_b32 v101, 0x3f800000
    v_lshlrev_b32 v88, 16, v36
    v_and_b32 v89, 0xffff0000, v36
    v_lshlrev_b32 v90, 16, v37
    v_and_b32 v91, 0xffff0000, v37
    v_lshlrev_b32 v92, 16, v38
    v_and_b32 v93, 0xffff0000, v38
    v_lshlrev_b32 v94, 16, v39
    v_and_b32 v95, 0xffff0000, v39
    v_lshlrev_b32 v72, 16, v32
    v_and_b32 v73, 0xffff0000, v32
    v_lshlrev_b32 v74, 16, v33
    v_and_b32 v75, 0xffff0000, v33
    v_lshlrev_b32 v76, 16, v34
    v_and_b32 v77, 0xffff0000, v34
    v_lshlrev_b32 v78, 16, v35
    v_and_b32 v79, 0xffff0000, v35
    s_waitcnt vmcnt(20)
    v_max_u32 v3, v128, v129
    v_max3_u32 v3, v3, v130, v131
    s_waitcnt vmcnt(18)
    v_max3_u32 v3, v3, v132, v133
    v_max3_u32 v3, v3, v134, v135
    s_waitcnt vmcnt(17)
    v_max3_u32 v3, v3, v136, v137
    v_max3_u32 v3, v3, v138, v139
    s_waitcnt vmcnt(16)
    v_max3_u32 v3, v3, v140, v141
    v_max3_u32 v3, v3, v142, v143
    s_waitcnt vmcnt(15)
    v_max3_u32 v3, v3, v144, v145
    v_max3_u32 v3, v3, v146, v147
    s_waitcnt vmcnt(14)
    v_max3_u32 v3, v3, v148, v149
    v_max3_u32 v3, v3, v150, v151
    s_waitcnt vmcnt(13)
    v_max3_u32 v3, v3, v152, v153
    v_max3_u32 v3, v3, v154, v155
    s_waitcnt vmcnt(11)
    v_max3_u32 v3, v3, v156, v157
    v_max3_u32 v3, v3, v158, v159
    v_cmp_eq_u32 vcc, -1, v3
    s_cbranch_vccnz L_P1_slow_15
L_P1_ok_16:
    v_lshlrev_b32 v64, 16, v128
    v_and_b32 v65, 0xffff0000, v128
    v_lshlrev_b32 v66, 16, v129
    v_and_b32 v67, 0xffff0000, v129
    v_lshlrev_b32 v68, 16, v130
    v_and_b32 v69, 0xffff0000, v130
    v_lshlrev_b32 v70, 16, v131
    v_and_b32 v71, 0xffff0000, v131
    v_dot2c_f32_bf16 v64, v132, v100
    v_dot2c_f32_bf16 v65, v132, v101
    v_dot2c_f32_bf16 v66, v133, v100
    v_dot2c_f32_bf16 v67, v133, v101
    v_dot2c_f32_bf16 v68, v134, v100
    v_dot2c_f32_bf16 v69, v134, v101
    v_dot2c_f32_bf16 v70, v135, v100
    v_dot2c_f32_bf16 v71, v135, v101
    v_dot2c_f32_bf16 v64, v136, v100
    v_dot2c_f32_bf16 v65, v136, v101
    v_dot2c_f32_bf16 v66, v137, v100
    v_dot2c_f32_bf16 v67, v137, v101
    v_dot2c_f32_bf16 v68, v138, v100
    v_dot2c_f32_bf16 v69, v138, v101
    v_dot2c_f32_bf16 v70, v139, v100
    v_dot2c_f32_bf16 v71, v139, v101
    v_dot2c_f32_bf16 v64, v140, v100
    v_dot2c_f32_bf16 v65, v140, v101
    v_dot2c_f32_bf16 v66, v141, v100
    v_dot2c_f32_bf16 v67, v141, v101
    v_dot2c_f32_bf16 v68, v142, v100
    v_dot2c_f32_bf16 v69, v142, v101
    v_dot2c_f32_bf16 v70, v143, v100
    v_dot2c_f32_bf16 v71, v143, v101
    v_dot2c_f32_bf16 v64, v144, v100
    v_dot2c_f32_bf16 v65, v144, v101
    v_dot2c_f32_bf16 v66, v145, v100
    v_dot2c_f32_bf16 v67, v145, v101
    v_dot2c_f32_bf16 v68, v146, v100
    v_dot2c_f32_bf16 v69, v146, v101
    v_dot2c_f32_bf16 v70, v147, v100
    v_dot2c_f32_bf16 v71, v147, v101
    v_dot2c_f32_bf16 v64, v148, v100
    v_dot2c_f32_bf16 v65, v148, v101
    v_dot2c_f32_bf16 v66, v149, v100
    v_dot2c_f32_bf16 v67, v149, v101
    v_dot2c_f32_bf16 v68, v150, v100
    v_dot2c_f32_bf16 v69, v150, v101
    v_dot2c_f32_bf16 v70, v151, v100
    v_dot2c_f32_bf16 v71, v151, v101
    v_dot2c_f32_bf16 v64, v152, v100
    v_dot2c_f32_bf16 v65, v152, v101
    v_dot2c_f32_bf16 v66, v153, v100
    v_dot2c_f32_bf16 v67, v153, v101
    v_dot2c_f32_bf16 v68, v154, v100
    v_dot2c_f32_bf16 v69, v154, v101
    v_dot2c_f32_bf16 v70, v155, v100
    v_dot2c_f32_bf16 v71, v155, v101
    v_dot2c_f32_bf16 v64, v156, v100
    v_dot2c_f32_bf16 v65, v156, v101
    v_dot2c_f32_bf16 v66, v157, v100
    v_dot2c_f32_bf16 v67, v157, v101
    v_dot2c_f32_bf16 v68, v158, v100
    v_dot2c_f32_bf16 v69, v158, v101
    v_dot2c_f32_bf16 v70, v159, v100
    v_dot2c_f32_bf16 v71, v159, v101
    v_pk_fma_f32 v[64:65], v[64:65], v[160:161], v[72:73]
    v_pk_fma_f32 v[66:67], v[66:67], v[162:163], v[74:75]
    v_pk_fma_f32 v[68:69], v[68:69], v[164:165], v[76:77]
    v_pk_fma_f32 v[70:71], v[70:71], v[166:167], v[78:79]
    v_cvt_pk_bf16_f32 v32, v64, v65
    v_cvt_pk_bf16_f32 v33, v66, v67
    v_cvt_pk_bf16_f32 v34, v68, v69
    v_cvt_pk_bf16_f32 v35, v70, v71
    v_lshlrev_b32 v64, 16, v32
    v_and_b32 v65, 0xffff0000, v32
    v_lshlrev_b32 v66, 16, v33
    v_and_b32 v67, 0xffff0000, v33
    v_lshlrev_b32 v68, 16, v34
    v_and_b32 v69, 0xffff0000, v34
    v_lshlrev_b32 v70, 16, v35
    v_and_b32 v71, 0xffff0000, v35
    v_pk_add_f32 v[48:49], v[64:65], v[66:67]
    v_pk_add_f32 v[50:51], v[68:69], v[70:71]
    v_pk_add_f32 v[48:49], v[48:49], v[50:51]
    v_add_f32 v48, v48, v49
    s_nop 1
    v_add_f32_dpp v48, v48, v48 quad_perm:[1,0,3,2] row_mask:0xf bank_mask:0xf
    s_nop 1
    v_add_f32_dpp v48, v48, v48 quad_perm:[2,3,0,1] row_mask:0xf bank_mask:0xf
    s_nop 1
    v_add_f32_dpp v48, v48, v48 row_half_mirror row_mask:0xf bank_mask:0xf
    s_nop 1
    v_add_f32_dpp v48, v48, v48 row_mirror row_mask:0xf bank_mask:0xf
    v_mov_b32 v49, v48
    s_nop 1
    v_permlane16_swap_b32 v48, v49
    v_add_f32 v48, v48, v49
    v_mov_b32 v49, v48
    s_nop 1
    v_permlane32_swap_b32 v48, v49
    v_add_f32 v48, v48, v49
    v_mul_f32 v48, 0xbb000000, v48
    v_pk_add_f32 v[72:73], v[64:65], v[48:49] op_sel_hi:[1,0]
    v_pk_add_f32 v[74:75], v[66:67], v[48:49] op_sel_hi:[1,0]
    v_pk_add_f32 v[76:77], v[68:69], v[48:49] op_sel_hi:[1,0]
    v_pk_add_f32 v[78:79], v[70:71], v[48:49] op_sel_hi:[1,0]
    v_pk_mul_f32 v[50:51], v[72:73], v[72:73]
    v_pk_mul_f32 v[52:53], v[72:73], v[8:9]
    v_pk_fma_f32 v[50:51], v[74:75], v[74:75], v[50:51]
    v_pk_fma_f32 v[52:53], v[74:75], v[10:11], v[52:53]
    v_pk_fma_f32 v[50:51], v[76:77], v[76:77], v[50:51]
    v_pk_fma_f32 v[52:53], v[76:77], v[12:13], v[52:53]
    v_pk_fma_f32 v[50:51], v[78:79], v[78:79], v[50:51]
    v_pk_fma_f32 v[52:53], v[78:79], v[14:15], v[52:53]
    v_add_f32 v50, v50, v51
    v_add_f32 v52, v52, v53
    s_nop 0
    v_add_f32_dpp v50, v50, v50 quad_perm:[1,0,3,2] row_mask:0xf bank_mask:0xf
    v_add_f32_dpp v52, v52, v52 quad_perm:[1,0,3,2] row_mask:0xf bank_mask:0xf
    s_nop 0
    v_add_f32_dpp v50, v50, v50 quad_perm:[2,3,0,1] row_mask:0xf bank_mask:0xf
    v_add_f32_dpp v52, v52, v52 quad_perm:[2,3,0,1] row_mask:0xf bank_mask:0xf
    s_nop 0
    v_add_f32_dpp v50, v50, v50 row_half_mirror row_mask:0xf bank_mask:0xf
    v_add_f32_dpp v52, v52, v52 row_half_mirror row_mask:0xf bank_mask:0xf
    s_nop 0
    v_add_f32_dpp v50, v50, v50 row_mirror row_mask:0xf bank_mask:0xf
    v_add_f32_dpp v52, v52, v52 row_mirror row_mask:0xf bank_mask:0xf
    v_mov_b32 v51, v50
    v_mov_b32 v53, v52
    s_nop 0
    v_permlane16_swap_b32 v50, v51
    v_permlane16_swap_b32 v52, v53
    v_add_f32 v50, v50, v51
    v_add_f32 v52, v52, v53
    v_mov_b32 v51, v50
    v_mov_b32 v53, v52
    s_nop 0
    v_permlane32_swap_b32 v50, v51
    v_permlane32_swap_b32 v52, v53
    v_add_f32 v50, v50, v51
    v_add_f32 v52, v52, v53
    v_mov_b32 v48, 0x3727c5ac
    v_fmac_f32 v48, 0x3b000000, v50
    v_rsq_f32 v48, v48
    s_nop 0
    v_fma_f32 v52, v52, v48, v16
    v_ashrrev_i32 v53, 31, v52
    v_or_b32 v53, 0x80000000, v53
    v_xor_b32 v53, v53, v52
    v_and_b32 v53, 0xfffff800, v53
    v_or_b32 v17, s68, v53
    v_pk_mul_f32 v[72:73], v[72:73], v[48:49] op_sel_hi:[1,0]
    v_pk_mul_f32 v[74:75], v[74:75], v[48:49] op_sel_hi:[1,0]
    v_pk_mul_f32 v[76:77], v[76:77], v[48:49] op_sel_hi:[1,0]
    v_pk_mul_f32 v[78:79], v[78:79], v[48:49] op_sel_hi:[1,0]
    v_pk_fma_f32 v[72:73], v[72:73], v[168:169], v[176:177]
    v_pk_fma_f32 v[74:75], v[74:75], v[170:171], v[178:179]
    v_pk_fma_f32 v[76:77], v[76:77], v[172:173], v[180:181]
    v_pk_fma_f32 v[78:79], v[78:79], v[174:175], v[182:183]
    v_cvt_pk_bf16_f32 v20, v72, v73
    v_cvt_pk_bf16_f32 v21, v74, v75
    v_cvt_pk_bf16_f32 v22, v76, v77
    v_cvt_pk_bf16_f32 v23, v78, v79
    v_lshlrev_b32 v98, 4, v0
    v_cmp_gt_u32 vcc, 224, v0
    v_mov_b32 v99, 2147479552
    s_nop 0
    v_cndmask_b32 v99, v99, v98, vcc
    s_lshl_b32 s17, s66, 13
    s_add_u32 s17, s17, 4194304
    s_cmp_lt_u32 s66, 224
    s_cselect_b32 s17, s17, 2143285248
    s_lshl_b32 s100, s3, 2
    v_mov_b32 v47, s100
    v_mov_b32 v102, 0
    s_lshl_b32 s100, s2, 6
    s_add_u32 s100, s100, 65536
    s_lshl_b32 s101, s2, 11
    s_add_u32 s101, s101, 524288
    s_branch L_pg_17
.p2align 12
L_pg_17:
    s_mov_b32 s99, 0
L_P2_l_18:
    s_waitcnt vmcnt(0)
    v_max_u32 v48, v192, v193
    v_max3_u32 v48, v48, v194, v195
    v_max_u32 v49, v196, v197
    v_max3_u32 v49, v49, v198, v199
    v_max_u32 v50, v200, v201
    v_max3_u32 v50, v50, v202, v203
    v_max_u32 v51, v204, v205
    v_max3_u32 v51, v51, v206, v207
    v_max_u32 v52, v208, v209
    v_max3_u32 v52, v52, v210, v211
    v_max_u32 v53, v212, v213
    v_max3_u32 v53, v53, v214, v215
    v_max_u32 v54, v216, v217
    v_max3_u32 v54, v54, v218, v219
    v_max_u32 v55, v220, v221
    v_max3_u32 v55, v55, v222, v223
    v_max3_u32 v3, v48, v49, v50
    v_max3_u32 v3, v3, v51, v52
    v_max3_u32 v3, v3, v53, v54
    v_max_u32 v3, v3, v55
    v_cmp_eq_u32 vcc, -1, v3
    s_add_u32 s99, s99, 1
    s_cbranch_vccz L_P2_ok_19
    s_cmp_ge_u32 s99, 200000
    s_cbranch_scc1 L_P2_ok_19
    s_sleep 1
    v_cmp_eq_u32 vcc, -1, v48
    s_cbranch_vccz L_P2_s_20
    s_and_b64 s[96:97], vcc, s[12:13]
    s_cselect_b64 exec, s[96:97], vcc
    s_add_u32 s74, s70, 8388608
    buffer_load_dwordx4 v[192:195], v44, s[8:11], s74 offen sc0 sc1
    s_mov_b64 exec, -1
L_P2_s_20:
    v_cmp_eq_u32 vcc, -1, v49
    s_cbranch_vccz L_P2_s_21
    s_and_b64 s[96:97], vcc, s[12:13]
    s_cselect_b64 exec, s[96:97], vcc
    s_add_u32 s74, s70, 8392704
    buffer_load_dwordx4 v[196:199], v44, s[8:11], s74 offen sc0 sc1
    s_mov_b64 exec, -1
L_P2_s_21:
    v_cmp_eq_u32 vcc, -1, v50
    s_cbranch_vccz L_P2_s_22
    s_and_b64 s[96:97], vcc, s[12:13]
    s_cselect_b64 exec, s[96:97], vcc
    s_add_u32 s74, s70, 8396800
    buffer_load_dwordx4 v[200:203], v44, s[8:11], s74 offen sc0 sc1
    s_mov_b64 exec, -1
L_P2_s_22:
    v_cmp_eq_u32 vcc, -1, v51
    s_cbranch_vccz L_P2_s_23
    s_and_b64 s[96:97], vcc, s[12:13]
    s_cselect_b64 exec, s[96:97], vcc
    s_add_u32 s74, s70, 8400896
    buffer_load_dwordx4 v[204:207], v44, s[8:11], s74 offen sc0 sc1
    s_mov_b64 exec, -1
L_P2_s_23:
    v_cmp_eq_u32 vcc, -1, v52
    s_cbranch_vccz L_P2_s_24
    s_and_b64 s[96:97], vcc, s[12:13]
    s_cselect_b64 exec, s[96:97], vcc
    s_add_u32 s74, s70, 8404992
    buffer_load_dwordx4 v[208:211], v44, s[8:11], s74 offen sc0 sc1
    s_mov_b64 exec, -1
L_P2_s_24:
    v_cmp_eq_u32 vcc, -1, v53
    s_cbranch_vccz L_P2_s_25
    s_and_b64 s[96:97], vcc, s[12:13]
    s_cselect_b64 exec, s[96:97], vcc
    s_add_u32 s74, s70, 8409088
    buffer_load_dwordx4 v[212:215], v44, s[8:11], s74 offen sc0 sc1
    s_mov_b64 exec, -1
L_P2_s_25:
    v_cmp_eq_u32 vcc, -1, v54
    s_cbranch_vccz L_P2_s_26
    s_and_b64 s[96:97], vcc, s[12:13]
    s_cselect_b64 exec, s[96:97], vcc
    s_add_u32 s74, s70, 8413184
    buffer_load_dwordx4 v[216:219], v44, s[8:11], s74 offen sc0 sc1
    s_mov_b64 exec, -1
L_P2_s_26:
    v_cmp_eq_u32 vcc, -1, v55
    s_cbranch_vccz L_P2_s_27
    s_and_b64 s[96:97], vcc, s[12:13]
    s_cselect_b64 exec, s[96:97], vcc
    s_add_u32 s74, s70, 8417280
    buffer_load_dwordx4 v[220:223], v44, s[8:11], s74 offen sc0 sc1
    s_mov_b64 exec, -1
L_P2_s_27:
    s_branch L_P2_l_18
L_P2_ok_19:
    v_lshlrev_b32 v80, 16, v192
    v_and_b32 v81, 0xffff0000, v192
    v_lshlrev_b32 v82, 16, v193
    v_and_b32 v83, 0xffff0000, v193
    v_lshlrev_b32 v84, 16, v194
    v_and_b32 v85, 0xffff0000, v194
    v_lshlrev_b32 v86, 16, v195
    v_and_b32 v87, 0xffff0000, v195
    v_dot2c_f32_bf16 v80, v196, v100
    v_dot2c_f32_bf16 v81, v196, v101
    v_dot2c_f32_bf16 v82, v197, v100
    v_dot2c_f32_bf16 v83, v197, v101
    v_dot2c_f32_bf16 v84, v198, v100
    v_dot2c_f32_bf16 v85, v198, v101
    v_dot2c_f32_bf16 v86, v199, v100
    v_dot2c_f32_bf16 v87, v199, v101
    v_dot2c_f32_bf16 v80, v200, v100
    v_dot2c_f32_bf16 v81, v200, v101
    v_dot2c_f32_bf16 v82, v201, v100
    v_dot2c_f32_bf16 v83, v201, v101
    v_dot2c_f32_bf16 v84, v202, v100
    v_dot2c_f32_bf16 v85, v202, v101
    v_dot2c_f32_bf16 v86, v203, v100
    v_dot2c_f32_bf16 v87, v203, v101
    v_dot2c_f32_bf16 v80, v204, v100
    v_dot2c_f32_bf16 v81, v204, v101
    v_dot2c_f32_bf16 v82, v205, v100
    v_dot2c_f32_bf16 v83, v205, v101
    v_dot2c_f32_bf16 v84, v206, v100
    v_dot2c_f32_bf16 v85, v206, v101
    v_dot2c_f32_bf16 v86, v207, v100
    v_dot2c_f32_bf16 v87, v207, v101
    v_dot2c_f32_bf16 v80, v208, v100
    v_dot2c_f32_bf16 v81, v208, v101
    v_dot2c_f32_bf16 v82, v209, v100
    v_dot2c_f32_bf16 v83, v209, v101
    v_dot2c_f32_bf16 v84, v210, v100
    v_dot2c_f32_bf16 v85, v210, v101
    v_dot2c_f32_bf16 v86, v211, v100
    v_dot2c_f32_bf16 v87, v211, v101
    v_dot2c_f32_bf16 v80, v212, v100
    v_dot2c_f32_bf16 v81, v212, v101
    v_dot2c_f32_bf16 v82, v213, v100
    v_dot2c_f32_bf16 v83, v213, v101
    v_dot2c_f32_bf16 v84, v214, v100
    v_dot2c_f32_bf16 v85, v214, v101
    v_dot2c_f32_bf16 v86, v215, v100
    v_dot2c_f32_bf16 v87, v215, v101
    v_dot2c_f32_bf16 v80, v216, v100
    v_dot2c_f32_bf16 v81, v216, v101
    v_dot2c_f32_bf16 v82, v217, v100
    v_dot2c_f32_bf16 v83, v217, v101
    v_dot2c_f32_bf16 v84, v218, v100
    v_dot2c_f32_bf16 v85, v218, v101
    v_dot2c_f32_bf16 v86, v219, v100
    v_dot2c_f32_bf16 v87, v219, v101
    v_dot2c_f32_bf16 v80, v220, v100
    v_dot2c_f32_bf16 v81, v220, v101
    v_dot2c_f32_bf16 v82, v221, v100
    v_dot2c_f32_bf16 v83, v221, v101
    v_dot2c_f32_bf16 v84, v222, v100
    v_dot2c_f32_bf16 v85, v222, v101
    v_dot2c_f32_bf16 v86, v223, v100
    v_dot2c_f32_bf16 v87, v223, v101
    v_pk_fma_f32 v[80:81], v[80:81], v[160:161], v[88:89]
    v_pk_fma_f32 v[82:83], v[82:83], v[162:163], v[90:91]
    v_pk_fma_f32 v[84:85], v[84:85], v[164:165], v[92:93]
    v_pk_fma_f32 v[86:87], v[86:87], v[166:167], v[94:95]
    v_cvt_pk_bf16_f32 v36, v80, v81
    v_cvt_pk_bf16_f32 v37, v82, v83
    v_cvt_pk_bf16_f32 v38, v84, v85
    v_cvt_pk_bf16_f32 v39, v86, v87
    v_lshlrev_b32 v80, 16, v36
    v_and_b32 v81, 0xffff0000, v36
    v_lshlrev_b32 v82, 16, v37
    v_and_b32 v83, 0xffff0000, v37
    v_lshlrev_b32 v84, 16, v38
    v_and_b32 v85, 0xffff0000, v38
    v_lshlrev_b32 v86, 16, v39
    v_and_b32 v87, 0xffff0000, v39
    v_pk_add_f32 v[48:49], v[80:81], v[82:83]
    v_pk_add_f32 v[50:51], v[84:85], v[86:87]
    v_pk_add_f32 v[48:49], v[48:49], v[50:51]
    v_add_f32 v48, v48, v49
    s_nop 1
    v_add_f32_dpp v48, v48, v48 quad_perm:[1,0,3,2] row_mask:0xf bank_mask:0xf
    s_nop 1
    v_add_f32_dpp v48, v48, v48 quad_perm:[2,3,0,1] row_mask:0xf bank_mask:0xf
    s_nop 1
    v_add_f32_dpp v48, v48, v48 row_half_mirror row_mask:0xf bank_mask:0xf
    s_nop 1
    v_add_f32_dpp v48, v48, v48 row_mirror row_mask:0xf bank_mask:0xf
    v_mov_b32 v49, v48
    s_nop 1
    v_permlane16_swap_b32 v48, v49
    v_add_f32 v48, v48, v49
    v_mov_b32 v49, v48
    s_nop 1
    v_permlane32_swap_b32 v48, v49
    v_add_f32 v48, v48, v49
    v_mul_f32 v48, 0xbb000000, v48
    v_pk_add_f32 v[88:89], v[80:81], v[48:49] op_sel_hi:[1,0]
    v_pk_add_f32 v[90:91], v[82:83], v[48:49] op_sel_hi:[1,0]
    v_pk_add_f32 v[92:93], v[84:85], v[48:49] op_sel_hi:[1,0]
    v_pk_add_f32 v[94:95], v[86:87], v[48:49] op_sel_hi:[1,0]
    v_pk_mul_f32 v[50:51], v[88:89], v[88:89]
    v_pk_mul_f32 v[52:53], v[88:89], v[8:9]
    v_pk_fma_f32 v[50:51], v[90:91], v[90:91], v[50:51]
    v_pk_fma_f32 v[52:53], v[90:91], v[10:11], v[52:53]
    v_pk_fma_f32 v[50:51], v[92:93], v[92:93], v[50:51]
    v_pk_fma_f32 v[52:53], v[92:93], v[12:13], v[52:53]
    v_pk_fma_f32 v[50:51], v[94:95], v[94:95], v[50:51]
    v_pk_fma_f32 v[52:53], v[94:95], v[14:15], v[52:53]
    v_add_f32 v50, v50, v51
    v_add_f32 v52, v52, v53
    s_nop 0
    v_add_f32_dpp v50, v50, v50 quad_perm:[1,0,3,2] row_mask:0xf bank_mask:0xf
    v_add_f32_dpp v52, v52, v52 quad_perm:[1,0,3,2] row_mask:0xf bank_mask:0xf
    s_nop 0
    v_add_f32_dpp v50, v50, v50 quad_perm:[2,3,0,1] row_mask:0xf bank_mask:0xf
    v_add_f32_dpp v52, v52, v52 quad_perm:[2,3,0,1] row_mask:0xf bank_mask:0xf
    s_nop 0
    v_add_f32_dpp v50, v50, v50 row_half_mirror row_mask:0xf bank_mask:0xf
    v_add_f32_dpp v52, v52, v52 row_half_mirror row_mask:0xf bank_mask:0xf
    s_nop 0
    v_add_f32_dpp v50, v50, v50 row_mirror row_mask:0xf bank_mask:0xf
    v_add_f32_dpp v52, v52, v52 row_mirror row_mask:0xf bank_mask:0xf
    v_mov_b32 v51, v50
    v_mov_b32 v53, v52
    s_nop 0
    v_permlane16_swap_b32 v50, v51
    v_permlane16_swap_b32 v52, v53
    v_add_f32 v50, v50, v51
    v_add_f32 v52, v52, v53
    v_mov_b32 v51, v50
    v_mov_b32 v53, v52
    s_nop 0
    v_permlane32_swap_b32 v50, v51
    v_permlane32_swap_b32 v52, v53
    v_add_f32 v50, v50, v51
    v_add_f32 v52, v52, v53
    v_mov_b32 v48, 0x3727c5ac
    v_fmac_f32 v48, 0x3b000000, v50
    v_rsq_f32 v48, v48
    s_nop 0
    v_fma_f32 v52, v52, v48, v16
    v_ashrrev_i32 v53, 31, v52
    v_or_b32 v53, 0x80000000, v53
    v_xor_b32 v53, v53, v52
    v_and_b32 v53, 0xfffff800, v53
    v_or_b32 v18, s69, v53
    v_max3_u32 v19, v17, v18, 1
    ds_write_b32 v47, v19
    s_waitcnt lgkmcnt(0)
    s_barrier
    ds_read_b128 v[52:55], v102
    v_pk_mul_f32 v[88:89], v[88:89], v[48:49] op_sel_hi:[1,0]
    v_pk_mul_f32 v[90:91], v[90:91], v[48:49] op_sel_hi:[1,0]
    v_pk_mul_f32 v[92:93], v[92:93], v[48:49] op_sel_hi:[1,0]
    v_pk_mul_f32 v[94:95], v[94:95], v[48:49] op_sel_hi:[1,0]
    v_pk_fma_f32 v[88:89], v[88:89], v[168:169], v[176:177]
    v_pk_fma_f32 v[90:91], v[90:91], v[170:171], v[178:179]
    v_pk_fma_f32 v[92:93], v[92:93], v[172:173], v[180:181]
    v_pk_fma_f32 v[94:95], v[94:95], v[174:175], v[182:183]
    v_cvt_pk_bf16_f32 v24, v88, v89
    v_cvt_pk_bf16_f32 v25, v90, v91
    v_cvt_pk_bf16_f32 v26, v92, v93
    v_cvt_pk_bf16_f32 v27, v94, v95
    s_waitcnt lgkmcnt(0)
    v_max_u32 v52, v52, v53
    v_max3_u32 v52, v52, v54, v55
    v_cmp_eq_u32 vcc, v52, v19
    s_cbranch_vccz L_notbest
    buffer_store_dword v19, v5, s[8:11], s100 offen sc0 sc1
    v_cmp_gt_u32 vcc, v17, v18
    s_nop 1
    v_cndmask_b32 v28, v24, v20, vcc
    v_cndmask_b32 v40, v36, v32, vcc
    v_cndmask_b32 v29, v25, v21, vcc
    v_cndmask_b32 v41, v37, v33, vcc
    v_cndmask_b32 v30, v26, v22, vcc
    v_cndmask_b32 v42, v38, v34, vcc
    v_cndmask_b32 v31, v27, v23, vcc
    v_cndmask_b32 v43, v39, v35, vcc
    v_min_u32 v28, -2, v28
    v_min_u32 v40, -2, v40
    v_min_u32 v29, -2, v29
    v_min_u32 v41, -2, v41
    v_min_u32 v30, -2, v30
    v_min_u32 v42, -2, v42
    v_min_u32 v31, -2, v31
    v_min_u32 v43, -2, v43
    buffer_store_dwordx4 v[28:31], v1, s[8:11], s101 offen sc0 sc1
    buffer_store_dwordx4 v[40:43], v1, s[8:11], s101 offen offset:1024 sc0 sc1
L_notbest:
    buffer_load_dwordx4 v[112:115], v98, s[8:11], s17 offen
    s_add_u32 s17, s17, 4096
    buffer_load_dwordx4 v[116:119], v98, s[8:11], s17 offen
    s_add_u32 s17, s17, 2093056
    buffer_load_dwordx4 v[120:123], v98, s[8:11], s17 offen
    s_add_u32 s17, s17, 4096
    buffer_load_dwordx4 v[124:127], v98, s[8:11], s17 offen
    s_mul_i32 s17, s67, 28672
    s_add_u32 s17, s17, 8388608
    s_cmp_lt_u32 s67, 64
    s_cselect_b32 s17, s17, 2143285248
    buffer_load_dwordx4 v[128:131], v99, s[8:11], s17 offen offset:0
    buffer_load_dwordx4 v[132:135], v99, s[8:11], s17 offen offset:3584
    s_add_u32 s17, s17, 7168
    buffer_load_dwordx4 v[136:139], v99, s[8:11], s17 offen offset:0
    buffer_load_dwordx4 v[140:143], v99, s[8:11], s17 offen offset:3584
    s_add_u32 s17, s17, 7168
    buffer_load_dwordx4 v[144:147], v99, s[8:11], s17 offen offset:0
    buffer_load_dwordx4 v[148:151], v99, s[8:11], s17 offen offset:3584
    s_add_u32 s17, s17, 7168
    buffer_load_dwordx4 v[152:155], v99, s[8:11], s17 offen offset:0
    buffer_load_dwordx4 v[156:159], v99, s[8:11], s17 offen offset:3584
    v_lshlrev_b32 v72, 16, v20
    v_and_b32 v73, 0xffff0000, v20
    v_lshlrev_b32 v74, 16, v21
    v_and_b32 v75, 0xffff0000, v21
    v_lshlrev_b32 v76, 16, v22
    v_and_b32 v77, 0xffff0000, v22
    v_lshlrev_b32 v78, 16, v23
    v_and_b32 v79, 0xffff0000, v23
    v_pk_mul_f32 v[72:73], v[72:73], v[184:185]
    v_pk_mul_f32 v[74:75], v[74:75], v[186:187]
    v_pk_mul_f32 v[76:77], v[76:77], v[188:189]
    v_pk_mul_f32 v[78:79], v[78:79], v[190:191]
    v_cvt_pk_bf16_f32 v56, v72, v73
    v_cvt_pk_bf16_f32 v57, v74, v75
    v_cvt_pk_bf16_f32 v58, v76, v77
    v_cvt_pk_bf16_f32 v59, v78, v79
    v_lshlrev_b32 v72, 16, v56
    v_and_b32 v73, 0xffff0000, v56
    v_lshlrev_b32 v74, 16, v57
    v_and_b32 v75, 0xffff0000, v57
    v_lshlrev_b32 v76, 16, v58
    v_and_b32 v77, 0xffff0000, v58
    v_lshlrev_b32 v78, 16, v59
    v_and_b32 v79, 0xffff0000, v59
    v_pk_add_f32 v[72:73], v[72:73], v[64:65]
    v_pk_add_f32 v[74:75], v[74:75], v[66:67]
    v_pk_add_f32 v[76:77], v[76:77], v[68:69]
    v_pk_add_f32 v[78:79], v[78:79], v[70:71]
    v_cvt_pk_bf16_f32 v56, v72, v73
    v_cvt_pk_bf16_f32 v57, v74, v75
    v_cvt_pk_bf16_f32 v58, v76, v77
    v_cvt_pk_bf16_f32 v59, v78, v79
    v_lshlrev_b32 v88, 16, v24
    v_and_b32 v89, 0xffff0000, v24
    v_lshlrev_b32 v90, 16, v25
    v_and_b32 v91, 0xffff0000, v25
    v_lshlrev_b32 v92, 16, v26
    v_and_b32 v93, 0xffff0000, v26
    v_lshlrev_b32 v94, 16, v27
    v_and_b32 v95, 0xffff0000, v27
    v_pk_mul_f32 v[88:89], v[88:89], v[184:185]
    v_pk_mul_f32 v[90:91], v[90:91], v[186:187]
    v_pk_mul_f32 v[92:93], v[92:93], v[188:189]
    v_pk_mul_f32 v[94:95], v[94:95], v[190:191]
    v_cvt_pk_bf16_f32 v60, v88, v89
    v_cvt_pk_bf16_f32 v61, v90, v91
    v_cvt_pk_bf16_f32 v62, v92, v93
    v_cvt_pk_bf16_f32 v63, v94, v95
    v_lshlrev_b32 v88, 16, v60
    v_and_b32 v89, 0xffff0000, v60
    v_lshlrev_b32 v90, 16, v61
    v_and_b32 v91, 0xffff0000, v61
    v_lshlrev_b32 v92, 16, v62
    v_and_b32 v93, 0xffff0000, v62
    v_lshlrev_b32 v94, 16, v63
    v_and_b32 v95, 0xffff0000, v63
    v_pk_add_f32 v[88:89], v[88:89], v[80:81]
    v_pk_add_f32 v[90:91], v[90:91], v[82:83]
    v_pk_add_f32 v[92:93], v[92:93], v[84:85]
    v_pk_add_f32 v[94:95], v[94:95], v[86:87]
    v_cvt_pk_bf16_f32 v60, v88, v89
    v_cvt_pk_bf16_f32 v61, v90, v91
    v_cvt_pk_bf16_f32 v62, v92, v93
    v_cvt_pk_bf16_f32 v63, v94, v95
    v_lshlrev_b32 v4, 6, v0
    s_mov_b32 s71, 65536
    s_mov_b32 s99, 0
    s_branch L_pg_28
.p2align 12
L_pg_28:
L_kl:
    buffer_load_dword v3, v4, s[8:11], s71 offen sc0 sc1
    s_add_u32 s99, s99, 1
    s_waitcnt vmcnt(0)
    v_cmp_eq_u32 vcc, 0, v3
    s_cbranch_vccz L_kd
    s_cmp_ge_u32 s99, 200000
    s_cbranch_scc1 L_kd
    s_mov_b64 exec, vcc
    s_sleep 2
    s_branch L_kl
L_kd:
    s_mov_b64 exec, -1
    v_max_u32_dpp v3, v3, v3 quad_perm:[1,0,3,2] row_mask:0xf bank_mask:0xf
    s_nop 1
    v_max_u32_dpp v3, v3, v3 quad_perm:[2,3,0,1] row_mask:0xf bank_mask:0xf
    s_nop 1
    v_max_u32_dpp v3, v3, v3 row_half_mirror row_mask:0xf bank_mask:0xf
    s_nop 1
    v_max_u32_dpp v3, v3, v3 row_mirror row_mask:0xf bank_mask:0xf
    v_mov_b32 v19, v3
    s_nop 1
    v_permlane16_swap_b32 v3, v19
    v_max_u32 v3, v3, v19
    v_mov_b32 v19, v3
    s_nop 1
    v_permlane32_swap_b32 v3, v19
    v_max_u32 v3, v3, v19
    ds_write_b32 v47, v3 offset:64
    s_waitcnt lgkmcnt(0)
    s_barrier
    ds_read_b128 v[52:55], v102 offset:64
    v_lshlrev_b32 v4, 2, v0
    s_waitcnt lgkmcnt(0)
    v_max_u32 v52, v52, v53
    v_max3_u32 v52, v52, v54, v55
    s_nop 0
    v_readfirstlane_b32 s71, v52
    s_and_b32 s72, s71, 2047
    s_lshr_b32 s100, s72, 7
    s_sub_u32 s101, 15, s100
    s_min_u32 s100, s100, s101
    s_lshl_b32 s100, s100, 16
    s_and_b32 s101, s72, 1024
    s_cmp_eq_u32 s101, 0
    s_cselect_b32 s73, 31, 31
    s_lshr_b32 s101, s72, 2
    s_and_b32 s73, s73, s101
    s_lshl_b32 s73, s73, 2
    s_lshl_b32 s73, s73, 9
    s_add_u32 s73, s73, s100
    s_add_u32 s73, s73, 524288
    buffer_load_dword v19, v4, s[8:11], s73 offen sc0 sc1
    s_lshl_b32 s100, s68, 10
    s_cmp_eq_u32 s68, s72
    s_cselect_b32 s100, 2147479552, s100
    buffer_store_dwordx2 v[56:57], v45, s[52:55], s100 offen
    buffer_store_dwordx2 v[58:59], v45, s[52:55], s100 offen offset:32
    s_lshl_b32 s100, s69, 10
    s_cmp_eq_u32 s69, s72
    s_cselect_b32 s100, 2147479552, s100
    buffer_store_dwordx2 v[60:61], v45, s[52:55], s100 offen
    buffer_store_dwordx2 v[62:63], v45, s[52:55], s100 offen offset:32
    s_cmp_ge_u32 s66, 224
    s_cbranch_scc1 L_nprod
    v_lshlrev_b32 v160, 16, v112
    v_and_b32 v161, 0xffff0000, v112
    v_lshlrev_b32 v162, 16, v113
    v_and_b32 v163, 0xffff0000, v113
    v_lshlrev_b32 v164, 16, v114
    v_and_b32 v165, 0xffff0000, v114
    v_lshlrev_b32 v166, 16, v115
    v_and_b32 v167, 0xffff0000, v115
    v_lshlrev_b32 v168, 16, v116
    v_and_b32 v169, 0xffff0000, v116
    v_lshlrev_b32 v170, 16, v117
    v_and_b32 v171, 0xffff0000, v117
    v_lshlrev_b32 v172, 16, v118
    v_and_b32 v173, 0xffff0000, v118
    v_lshlrev_b32 v174, 16, v119
    v_and_b32 v175, 0xffff0000, v119
    v_lshlrev_b32 v176, 16, v120
    v_and_b32 v177, 0xffff0000, v120
    v_lshlrev_b32 v178, 16, v121
    v_and_b32 v179, 0xffff0000, v121
    v_lshlrev_b32 v180, 16, v122
    v_and_b32 v181, 0xffff0000, v122
    v_lshlrev_b32 v182, 16, v123
    v_and_b32 v183, 0xffff0000, v123
    v_lshlrev_b32 v184, 16, v124
    v_and_b32 v185, 0xffff0000, v124
    v_lshlrev_b32 v186, 16, v125
    v_and_b32 v187, 0xffff0000, v125
    v_lshlrev_b32 v188, 16, v126
    v_and_b32 v189, 0xffff0000, v126
    v_lshlrev_b32 v190, 16, v127
    v_and_b32 v191, 0xffff0000, v127
    s_mov_b32 s99, 0
    s_waitcnt vmcnt(4)
L_hl:
    v_cmp_eq_u32 vcc, -1, v19
    s_add_u32 s99, s99, 1
    s_cbranch_vccz L_hok
    s_cmp_ge_u32 s99, 200000
    s_cbranch_scc1 L_hok
    buffer_load_dword v19, v4, s[8:11], s73 offen sc0 sc1
    s_waitcnt vmcnt(0)
    s_branch L_hl
L_hok:
    v_lshlrev_b32 v48, 16, v19
    v_and_b32 v50, 0xffff0000, v19
    v_pk_mul_f32 v[64:65], v[160:161], v[48:49] op_sel_hi:[1,0]
    v_pk_mul_f32 v[66:67], v[162:163], v[48:49] op_sel_hi:[1,0]
    v_pk_mul_f32 v[68:69], v[164:165], v[48:49] op_sel_hi:[1,0]
    v_pk_mul_f32 v[70:71], v[166:167], v[48:49] op_sel_hi:[1,0]
    v_pk_mul_f32 v[72:73], v[176:177], v[48:49] op_sel_hi:[1,0]
    v_pk_mul_f32 v[74:75], v[178:179], v[48:49] op_sel_hi:[1,0]
    v_pk_mul_f32 v[76:77], v[180:181], v[48:49] op_sel_hi:[1,0]
    v_pk_mul_f32 v[78:79], v[182:183], v[48:49] op_sel_hi:[1,0]
    v_pk_fma_f32 v[64:65], v[168:169], v[50:51], v[64:65] op_sel_hi:[1,0,1]
    v_pk_fma_f32 v[66:67], v[170:171], v[50:51], v[66:67] op_sel_hi:[1,0,1]
    v_pk_fma_f32 v[68:69], v[172:173], v[50:51], v[68:69] op_sel_hi:[1,0,1]
    v_pk_fma_f32 v[70:71], v[174:175], v[50:51], v[70:71] op_sel_hi:[1,0,1]
    v_pk_fma_f32 v[72:73], v[184:185], v[50:51], v[72:73] op_sel_hi:[1,0,1]
    v_pk_fma_f32 v[74:75], v[186:187], v[50:51], v[74:75] op_sel_hi:[1,0,1]
    v_pk_fma_f32 v[76:77], v[188:189], v[50:51], v[76:77] op_sel_hi:[1,0,1]
    v_pk_fma_f32 v[78:79], v[190:191], v[50:51], v[78:79] op_sel_hi:[1,0,1]
    v_permlane32_swap_b32 v64, v72
    v_permlane32_swap_b32 v65, v73
    v_permlane32_swap_b32 v66, v74
    v_permlane32_swap_b32 v67, v75
    v_permlane32_swap_b32 v68, v76
    v_permlane32_swap_b32 v69, v77
    v_permlane32_swap_b32 v70, v78
    v_permlane32_swap_b32 v71, v79
    v_add_f32 v64, v64, v72
    v_add_f32 v65, v65, v73
    v_add_f32 v66, v66, v74
    v_add_f32 v67, v67, v75
    v_add_f32 v68, v68, v76
    v_add_f32 v69, v69, v77
    v_add_f32 v70, v70, v78
    v_add_f32 v71, v71, v79
    v_permlane16_swap_b32 v64, v68
    v_permlane16_swap_b32 v65, v69
    v_permlane16_swap_b32 v66, v70
    v_permlane16_swap_b32 v67, v71
    v_add_f32 v64, v64, v68
    v_add_f32 v65, v65, v69
    v_add_f32 v66, v66, v70
    v_add_f32 v67, v67, v71
    v_add_f32_dpp v64, v64, v64 quad_perm:[1,0,3,2] row_mask:0xf bank_mask:0xf
    v_add_f32_dpp v65, v65, v65 quad_perm:[1,0,3,2] row_mask:0xf bank_mask:0xf
    v_add_f32_dpp v66, v66, v66 quad_perm:[1,0,3,2] row_mask:0xf bank_mask:0xf
    v_add_f32_dpp v67, v67, v67 quad_perm:[1,0,3,2] row_mask:0xf bank_mask:0xf
    v_add_f32_dpp v64, v64, v64 quad_perm:[2,3,0,1] row_mask:0xf bank_mask:0xf
    v_add_f32_dpp v65, v65, v65 quad_perm:[2,3,0,1] row_mask:0xf bank_mask:0xf
    v_add_f32_dpp v66, v66, v66 quad_perm:[2,3,0,1] row_mask:0xf bank_mask:0xf
    v_add_f32_dpp v67, v67, v67 quad_perm:[2,3,0,1] row_mask:0xf bank_mask:0xf
    v_add_f32_dpp v64, v64, v64 row_half_mirror row_mask:0xf bank_mask:0xf
    v_add_f32_dpp v65, v65, v65 row_half_mirror row_mask:0xf bank_mask:0xf
    v_add_f32_dpp v66, v66, v66 row_half_mirror row_mask:0xf bank_mask:0xf
    v_add_f32_dpp v67, v67, v67 row_half_mirror row_mask:0xf bank_mask:0xf
    v_add_f32_dpp v64, v64, v64 row_mirror row_mask:0xf bank_mask:0xf
    v_add_f32_dpp v65, v65, v65 row_mirror row_mask:0xf bank_mask:0xf
    v_add_f32_dpp v66, v66, v66 row_mirror row_mask:0xf bank_mask:0xf
    v_add_f32_dpp v67, v67, v67 row_mirror row_mask:0xf bank_mask:0xf
    v_and_b32 v50, 15, v2
    v_cmp_eq_u32 vcc, 0, v50
    v_mov_b32 v51, 1024
    s_nop 0
    v_cndmask_b32 v51, v51, v0, vcc
    ds_write_b128 v51, v[64:67] offset:256
    v_lshlrev_b32 v50, 2, v50
    s_waitcnt lgkmcnt(0)
    s_barrier
    s_cmp_lg_u32 s3, 0
    s_cbranch_scc1 L_nprod
    ds_read_b32 v64, v50 offset:256
    ds_read_b32 v65, v50 offset:320
    ds_read_b32 v66, v50 offset:384
    ds_read_b32 v67, v50 offset:448
    v_cmp_gt_u32 vcc, 8, v2
    v_mov_b32 v51, 2147479552
    s_nop 0
    v_cndmask_b32 v51, v51, v50, vcc
    s_lshl_b32 s100, s66, 6
    s_add_u32 s100, s100, 81920
    s_waitcnt lgkmcnt(2)
    v_add_f32 v64, v64, v65
    s_waitcnt lgkmcnt(0)
    v_add_f32 v66, v66, v67
    v_add_f32 v64, v64, v66
    v_cvt_pk_bf16_f32 v64, v64, v64
    v_and_b32 v64, 0xffff0000, v64
    s_nop 1
    v_mov_b32_dpp v65, v64 row_ror:8 row_mask:0xf bank_mask:0xf
    v_mul_f32 v66, 0xbfb8aa3b, v64
    v_exp_f32 v66, v66
    s_nop 0
    v_add_f32 v66, 1.0, v66
    v_rcp_f32 v66, v66
    s_nop 0
    v_mul_f32 v64, v64, v66
    v_cvt_pk_bf16_f32 v64, v64, v64
    v_and_b32 v64, 0xffff0000, v64
    v_mul_f32 v64, v64, v65
    v_cvt_pk_bf16_f32 v64, v64, v64
    v_and_b32 v64, 0xffff0000, v64
    buffer_store_dword v64, v51, s[8:11], s100 offen sc0 sc1
L_nprod:
    s_cmp_ge_u32 s67, 64
    s_cbranch_scc1 L_fin
    v_lshlrev_b32 v4, 6, v0
    v_cmp_gt_u32 vcc, 224, v0
    v_mov_b32 v51, 2147479552
    s_nop 0
    v_cndmask_b32 v4, v51, v4, vcc
    s_mov_b32 s100, 81920
    v_and_b32 v52, 7, v2
    s_lshl_b32 s101, s67, 3
    v_add_u32 v52, s101, v52
    v_lshrrev_b32 v53, 5, v52
    v_lshlrev_b32 v53, 6, v53
    v_and_b32 v54, 12, v52
    v_lshl_add_u32 v53, v54, 2, v53
    v_bfe_u32 v54, v52, 4, 1
    v_lshl_add_u32 v53, v54, 3, v53
    v_and_b32 v54, 2, v52
    v_lshl_add_u32 v53, v54, 1, v53
    v_lshlrev_b32 v54, 2, v52
    s_mov_b32 s101, 10240
    buffer_load_dword v55, v54, s[8:11], s101 offen
    buffer_load_dword v88, v53, s[8:11], s73 offen sc0 sc1
    buffer_load_dword v89, v53, s[8:11], s73 offen offset:1024 sc0 sc1
    v_lshlrev_b32 v192, 16, v128
    v_and_b32 v193, 0xffff0000, v128
    v_lshlrev_b32 v194, 16, v129
    v_and_b32 v195, 0xffff0000, v129
    v_lshlrev_b32 v196, 16, v130
    v_and_b32 v197, 0xffff0000, v130
    v_lshlrev_b32 v198, 16, v131
    v_and_b32 v199, 0xffff0000, v131
    v_lshlrev_b32 v200, 16, v132
    v_and_b32 v201, 0xffff0000, v132
    v_lshlrev_b32 v202, 16, v133
    v_and_b32 v203, 0xffff0000, v133
    v_lshlrev_b32 v204, 16, v134
    v_and_b32 v205, 0xffff0000, v134
    v_lshlrev_b32 v206, 16, v135
    v_and_b32 v207, 0xffff0000, v135
    v_lshlrev_b32 v208, 16, v136
    v_and_b32 v209, 0xffff0000, v136
    v_lshlrev_b32 v210, 16, v137
    v_and_b32 v211, 0xffff0000, v137
    v_lshlrev_b32 v212, 16, v138
    v_and_b32 v213, 0xffff0000, v138
    v_lshlrev_b32 v214, 16, v139
    v_and_b32 v215, 0xffff0000, v139
    v_lshlrev_b32 v216, 16, v140
    v_and_b32 v217, 0xffff0000, v140
    v_lshlrev_b32 v218, 16, v141
    v_and_b32 v219, 0xffff0000, v141
    v_lshlrev_b32 v220, 16, v142
    v_and_b32 v221, 0xffff0000, v142
    v_lshlrev_b32 v222, 16, v143
    v_and_b32 v223, 0xffff0000, v143
    v_lshlrev_b32 v224, 16, v144
    v_and_b32 v225, 0xffff0000, v144
    v_lshlrev_b32 v226, 16, v145
    v_and_b32 v227, 0xffff0000, v145
    v_lshlrev_b32 v228, 16, v146
    v_and_b32 v229, 0xffff0000, v146
    v_lshlrev_b32 v230, 16, v147
    v_and_b32 v231, 0xffff0000, v147
    v_lshlrev_b32 v232, 16, v148
    v_and_b32 v233, 0xffff0000, v148
    v_lshlrev_b32 v234, 16, v149
    v_and_b32 v235, 0xffff0000, v149
    v_lshlrev_b32 v236, 16, v150
    v_and_b32 v237, 0xffff0000, v150
    v_lshlrev_b32 v238, 16, v151
    v_and_b32 v239, 0xffff0000, v151
    v_lshlrev_b32 v240, 16, v152
    v_and_b32 v241, 0xffff0000, v152
    v_lshlrev_b32 v242, 16, v153
    v_and_b32 v243, 0xffff0000, v153
    v_lshlrev_b32 v244, 16, v154
    v_and_b32 v245, 0xffff0000, v154
    v_lshlrev_b32 v246, 16, v155
    v_and_b32 v247, 0xffff0000, v155
    v_lshlrev_b32 v248, 16, v156
    v_and_b32 v249, 0xffff0000, v156
    v_lshlrev_b32 v250, 16, v157
    v_and_b32 v251, 0xffff0000, v157
    v_lshlrev_b32 v252, 16, v158
    v_and_b32 v253, 0xffff0000, v158
    v_lshlrev_b32 v254, 16, v159
    v_and_b32 v255, 0xffff0000, v159
    s_and_b32 s101, s71, 0xfffff800
    s_or_b32 s101, s101, 0x400
    v_mov_b32 v90, s101
    v_not_b32 v91, v90
    v_ashrrev_i32 v91, 31, v91
    v_or_b32 v91, 0x80000000, v91
    v_xor_b32 v90, v90, v91
    v_cvt_pk_bf16_f32 v90, v90, v90
    v_and_b32 v90, 0xffff0000, v90
    v_mul_f32 v90, 0xbfb8aa3b, v90
    v_exp_f32 v90, v90
    s_nop 0
    v_add_f32 v90, 1.0, v90
    v_rcp_f32 v90, v90
    s_nop 0
    v_cvt_pk_bf16_f32 v90, v90, v90
    v_and_b32 v90, 0xffff0000, v90
    s_mov_b32 s99, 0
L_CND_l_29:
    s_waitcnt vmcnt(0)
    v_max_u32 v3, v88, v89
    v_cmp_eq_u32 vcc, -1, v3
    s_add_u32 s99, s99, 1
    s_cbranch_vccz L_CND_ok_30
    s_cmp_ge_u32 s99, 200000
    s_cbranch_scc1 L_CND_ok_30
    s_mov_b64 exec, vcc
    s_sleep 1
    buffer_load_dword v88, v53, s[8:11], s73 offen sc0 sc1
    buffer_load_dword v89, v53, s[8:11], s73 offen offset:1024 sc0 sc1
    s_branch L_CND_l_29
L_CND_ok_30:
    s_mov_b64 exec, -1
    v_and_b32 v51, 1, v52
    v_cmp_eq_u32 vcc, 0, v51
    v_lshlrev_b32 v91, 16, v88
    v_and_b32 v88, 0xffff0000, v88
    v_cndmask_b32 v88, v88, v91, vcc
    v_lshlrev_b32 v91, 16, v89
    v_and_b32 v89, 0xffff0000, v89
    v_cndmask_b32 v89, v89, v91, vcc
    v_and_b32 v50, 15, v2
    v_cmp_eq_u32 vcc, 0, v50
    v_lshrrev_b32 v51, 1, v0
    v_mov_b32 v50, 1024
    v_cndmask_b32 v51, v50, v51, vcc
    v_and_b32 v50, 7, v2
    v_lshlrev_b32 v50, 2, v50
    v_cmp_gt_u32 vcc, 8, v2
    v_lshlrev_b32 v52, 1, v52
    v_mov_b32 v53, 2147479552
    v_cndmask_b32 v52, v53, v52, vcc
    s_cmp_lt_u32 s66, 224
    s_cbranch_scc1 L_asl
    s_sleep 16
L_asl:
    s_sleep 7
    buffer_load_dwordx4 v[80:83], v4, s[8:11], s100 offen sc0 sc1
    buffer_load_dwordx4 v[84:87], v4, s[8:11], s100 offen offset:16 sc0 sc1
    s_mov_b32 s99, 0
L_ACT_l_31:
    s_waitcnt vmcnt(0)
    v_max_u32 v3, v80, v81
    v_max3_u32 v3, v3, v82, v83
    v_max3_u32 v3, v3, v84, v85
    v_max3_u32 v3, v3, v86, v87
    v_cmp_eq_u32 vcc, -1, v3
    s_add_u32 s99, s99, 1
    s_cbranch_vccz L_ACT_ok_32
    s_cmp_ge_u32 s99, 200000
    s_cbranch_scc1 L_ACT_ok_32
    s_mov_b64 exec, vcc
    s_sleep 2
    buffer_load_dwordx4 v[80:83], v4, s[8:11], s100 offen sc0 sc1
    buffer_load_dwordx4 v[84:87], v4, s[8:11], s100 offen offset:16 sc0 sc1
    s_branch L_ACT_l_31
L_ACT_ok_32:
    s_mov_b64 exec, -1
    v_pk_mul_f32 v[64:65], v[192:193], v[80:81] op_sel_hi:[1,0]
    v_pk_mul_f32 v[66:67], v[194:195], v[80:81] op_sel_hi:[1,0]
    v_pk_mul_f32 v[68:69], v[196:197], v[80:81] op_sel_hi:[1,0]
    v_pk_mul_f32 v[70:71], v[198:199], v[80:81] op_sel_hi:[1,0]
    v_pk_fma_f32 v[64:65], v[200:201], v[80:81], v[64:65] op_sel:[0,1,0] op_sel_hi:[1,1,1]
    v_pk_fma_f32 v[66:67], v[202:203], v[80:81], v[66:67] op_sel:[0,1,0] op_sel_hi:[1,1,1]
    v_pk_fma_f32 v[68:69], v[204:205], v[80:81], v[68:69] op_sel:[0,1,0] op_sel_hi:[1,1,1]
    v_pk_fma_f32 v[70:71], v[206:207], v[80:81], v[70:71] op_sel:[0,1,0] op_sel_hi:[1,1,1]
    v_pk_fma_f32 v[64:65], v[208:209], v[82:83], v[64:65] op_sel:[0,0,0] op_sel_hi:[1,0,1]
    v_pk_fma_f32 v[66:67], v[210:211], v[82:83], v[66:67] op_sel:[0,0,0] op_sel_hi:[1,0,1]
    v_pk_fma_f32 v[68:69], v[212:213], v[82:83], v[68:69] op_sel:[0,0,0] op_sel_hi:[1,0,1]
    v_pk_fma_f32 v[70:71], v[214:215], v[82:83], v[70:71] op_sel:[0,0,0] op_sel_hi:[1,0,1]
    v_pk_fma_f32 v[64:65], v[216:217], v[82:83], v[64:65] op_sel:[0,1,0] op_sel_hi:[1,1,1]
    v_pk_fma_f32 v[66:67], v[218:219], v[82:83], v[66:67] op_sel:[0,1,0] op_sel_hi:[1,1,1]
    v_pk_fma_f32 v[68:69], v[220:221], v[82:83], v[68:69] op_sel:[0,1,0] op_sel_hi:[1,1,1]
    v_pk_fma_f32 v[70:71], v[222:223], v[82:83], v[70:71] op_sel:[0,1,0] op_sel_hi:[1,1,1]
    v_pk_fma_f32 v[64:65], v[224:225], v[84:85], v[64:65] op_sel:[0,0,0] op_sel_hi:[1,0,1]
    v_pk_fma_f32 v[66:67], v[226:227], v[84:85], v[66:67] op_sel:[0,0,0] op_sel_hi:[1,0,1]
    v_pk_fma_f32 v[68:69], v[228:229], v[84:85], v[68:69] op_sel:[0,0,0] op_sel_hi:[1,0,1]
    v_pk_fma_f32 v[70:71], v[230:231], v[84:85], v[70:71] op_sel:[0,0,0] op_sel_hi:[1,0,1]
    v_pk_fma_f32 v[64:65], v[232:233], v[84:85], v[64:65] op_sel:[0,1,0] op_sel_hi:[1,1,1]
    v_pk_fma_f32 v[66:67], v[234:235], v[84:85], v[66:67] op_sel:[0,1,0] op_sel_hi:[1,1,1]
    v_pk_fma_f32 v[68:69], v[236:237], v[84:85], v[68:69] op_sel:[0,1,0] op_sel_hi:[1,1,1]
    v_pk_fma_f32 v[70:71], v[238:239], v[84:85], v[70:71] op_sel:[0,1,0] op_sel_hi:[1,1,1]
    v_pk_fma_f32 v[64:65], v[240:241], v[86:87], v[64:65] op_sel:[0,0,0] op_sel_hi:[1,0,1]
    v_pk_fma_f32 v[66:67], v[242:243], v[86:87], v[66:67] op_sel:[0,0,0] op_sel_hi:[1,0,1]
    v_pk_fma_f32 v[68:69], v[244:245], v[86:87], v[68:69] op_sel:[0,0,0] op_sel_hi:[1,0,1]
    v_pk_fma_f32 v[70:71], v[246:247], v[86:87], v[70:71] op_sel:[0,0,0] op_sel_hi:[1,0,1]
    v_pk_fma_f32 v[64:65], v[248:249], v[86:87], v[64:65] op_sel:[0,1,0] op_sel_hi:[1,1,1]
    v_pk_fma_f32 v[66:67], v[250:251], v[86:87], v[66:67] op_sel:[0,1,0] op_sel_hi:[1,1,1]
    v_pk_fma_f32 v[68:69], v[252:253], v[86:87], v[68:69] op_sel:[0,1,0] op_sel_hi:[1,1,1]
    v_pk_fma_f32 v[70:71], v[254:255], v[86:87], v[70:71] op_sel:[0,1,0] op_sel_hi:[1,1,1]
    s_nop 0
    v_permlane32_swap_b32 v64, v68
    v_permlane32_swap_b32 v65, v69
    v_permlane32_swap_b32 v66, v70
    v_permlane32_swap_b32 v67, v71
    v_add_f32 v64, v64, v68
    v_add_f32 v65, v65, v69
    v_add_f32 v66, v66, v70
    v_add_f32 v67, v67, v71
    s_nop 0
    v_permlane16_swap_b32 v64, v66
    v_permlane16_swap_b32 v65, v67
    v_add_f32 v64, v64, v66
    v_add_f32 v65, v65, v67
    s_nop 0
    v_add_f32_dpp v64, v64, v64 quad_perm:[1,0,3,2] row_mask:0xf bank_mask:0xf
    v_add_f32_dpp v65, v65, v65 quad_perm:[1,0,3,2] row_mask:0xf bank_mask:0xf
    s_nop 0
    v_add_f32_dpp v64, v64, v64 quad_perm:[2,3,0,1] row_mask:0xf bank_mask:0xf
    v_add_f32_dpp v65, v65, v65 quad_perm:[2,3,0,1] row_mask:0xf bank_mask:0xf
    s_nop 0
    v_add_f32_dpp v64, v64, v64 row_half_mirror row_mask:0xf bank_mask:0xf
    v_add_f32_dpp v65, v65, v65 row_half_mirror row_mask:0xf bank_mask:0xf
    s_nop 0
    v_add_f32_dpp v64, v64, v64 row_mirror row_mask:0xf bank_mask:0xf
    v_add_f32_dpp v65, v65, v65 row_mirror row_mask:0xf bank_mask:0xf
    ds_write_b64 v51, v[64:65] offset:2048
    s_waitcnt lgkmcnt(0)
    s_barrier
    s_cmp_lg_u32 s3, 0
    s_cbranch_scc1 L_fin
    ds_read_b32 v64, v50 offset:2048
    ds_read_b32 v65, v50 offset:2080
    ds_read_b32 v66, v50 offset:2112
    ds_read_b32 v67, v50 offset:2144
    s_lshl_b32 s100, s72, 10
    s_waitcnt lgkmcnt(2)
    v_add_f32 v64, v64, v65
    s_waitcnt lgkmcnt(0)
    v_add_f32 v66, v66, v67
    v_add_f32 v64, v64, v66
    v_cvt_pk_bf16_f32 v64, v64, v64
    v_and_b32 v64, 0xffff0000, v64
    v_mul_f32 v64, v64, v90
    v_cvt_pk_bf16_f32 v64, v64, v64
    v_and_b32 v64, 0xffff0000, v64
    v_add_f32 v64, v64, v88
    v_cvt_pk_bf16_f32 v64, v64, v64
    v_and_b32 v64, 0xffff0000, v64
    v_mul_f32 v64, v64, v55
    v_cvt_pk_bf16_f32 v64, v64, v64
    v_and_b32 v64, 0xffff0000, v64
    v_add_f32 v64, v64, v89
    v_cvt_pk_bf16_f32 v64, v64, v64
    buffer_store_short v64, v52, s[52:55], s100 offen
L_fin:
L_end:
    s_endpgm
L_E_slow_1:
    s_mov_b32 s99, 0
L_E_slow_1_l:
    s_sleep 20
    buffer_load_dword v3, v4, s[36:39], s67 offen sc0 sc1
    s_add_u32 s99, s99, 1
    s_waitcnt vmcnt(0)
    v_cmp_le_u32 vcc, s68, v3
    s_cmp_eq_u64 vcc, -1
    s_cbranch_scc1 L_E_ok_2
    s_cmp_lt_u32 s99, 200000
    s_cbranch_scc1 L_E_slow_1_l
    s_branch L_E_ok_2
L_H_slow_3:
    s_mov_b32 s99, 0
L_H_slow_3_l:
    s_sleep 4
    buffer_load_dword v3, v16, s[8:11], s78 offen sc0 sc1
    s_add_u32 s99, s99, 1
    s_waitcnt vmcnt(0)
    v_cmp_ne_u32 vcc, 0, v3
    s_cmp_eq_u64 vcc, -1
    s_cbranch_scc1 L_H_ok_4
    s_cmp_lt_u32 s99, 200000
    s_cbranch_scc1 L_H_slow_3_l
    s_branch L_H_ok_4
L_E2_slow_5:
    s_mov_b32 s99, 0
L_E2_slow_5_l:
    s_sleep 4
    buffer_load_dword v118, v119, s[8:11], s69 offen sc0 sc1
    s_add_u32 s99, s99, 1
    s_waitcnt vmcnt(0)
    v_cmp_ne_u32 vcc, 0, v118
    s_cmp_eq_u64 vcc, -1
    s_cbranch_scc1 L_E2_ok_6
    s_cmp_lt_u32 s99, 200000
    s_cbranch_scc1 L_E2_slow_5_l
    s_branch L_E2_ok_6
L_KV_slow_7:
    s_mov_b32 s99, 0
L_KV_slow_7_l:
    s_sleep 4
    buffer_load_dword v3, v17, s[8:11], s74 offen sc0 sc1
    s_add_u32 s99, s99, 1
    s_waitcnt vmcnt(0)
    v_cmp_ne_u32 vcc, 0, v3
    s_cmp_eq_u64 vcc, -1
    s_cbranch_scc1 L_KV_ok_8
    s_cmp_lt_u32 s99, 200000
    s_cbranch_scc1 L_KV_slow_7_l
    s_branch L_KV_ok_8
L_t1_start:
    v_mfma_f32_16x16x32_bf16 v[96:99], a[128:131], a[64:67], v[96:99]
    s_add_u32 s19, s82, 32768
    s_sub_u32 s82, s12, s13
    s_sub_u32 s82, s82, 1
    v_mfma_f32_16x16x32_bf16 v[96:99], a[132:135], a[68:71], v[96:99]
    s_cmp_gt_u32 s12, s13
    s_cselect_b32 s82, s82, s12
    s_lshl_b32 s82, s82, 16
    s_add_u32 s82, s82, s81
    v_mfma_f32_16x16x32_bf16 v[96:99], a[136:139], a[72:75], v[96:99]
    s_cmp_ge_u32 s12, 17
    s_cselect_b32 s82, 2147471360, s82
    s_add_u32 s12, s12, 1
    s_sub_u32 s14, s60, 1
    v_mfma_f32_16x16x32_bf16 v[96:99], a[140:143], a[76:79], v[96:99]
    v_mfma_f32_16x16x32_bf16 v[100:103], a[144:147], a[64:67], v[100:103]
    v_mfma_f32_16x16x32_bf16 v[100:103], a[148:151], a[68:71], v[100:103]
    v_mfma_f32_16x16x32_bf16 v[100:103], a[152:155], a[72:75], v[100:103]
    v_mfma_f32_16x16x32_bf16 v[100:103], a[156:159], a[76:79], v[100:103]
    v_mfma_f32_16x16x32_bf16 v[104:107], a[128:131], a[80:83], v[104:107]
    s_nop 2
    v_exp_f32 v96, v96
    v_mfma_f32_16x16x32_bf16 v[104:107], a[132:135], a[84:87], v[104:107]
    v_exp_f32 v97, v97
    v_mfma_f32_16x16x32_bf16 v[104:107], a[136:139], a[88:91], v[104:107]
    v_exp_f32 v98, v98
    v_mfma_f32_16x16x32_bf16 v[104:107], a[140:143], a[92:95], v[104:107]
    v_exp_f32 v99, v99
    v_mfma_f32_16x16x32_bf16 v[108:111], a[144:147], a[80:83], v[108:111]
    v_exp_f32 v100, v100
    v_mfma_f32_16x16x32_bf16 v[108:111], a[148:151], a[84:87], v[108:111]
    v_exp_f32 v101, v101
    v_mfma_f32_16x16x32_bf16 v[108:111], a[152:155], a[88:91], v[108:111]
    v_exp_f32 v102, v102
    v_mfma_f32_16x16x32_bf16 v[108:111], a[156:159], a[92:95], v[108:111]
    v_exp_f32 v103, v103
    v_mfma_f32_16x16x32_bf16 v[112:115], a[128:131], a[96:99], v[72:75]
    v_exp_f32 v104, v104
    v_mfma_f32_16x16x32_bf16 v[112:115], a[132:135], a[100:103], v[112:115]
    v_exp_f32 v105, v105
    v_mfma_f32_16x16x32_bf16 v[112:115], a[136:139], a[104:107], v[112:115]
    v_exp_f32 v106, v106
    v_mfma_f32_16x16x32_bf16 v[112:115], a[140:143], a[108:111], v[112:115]
    v_exp_f32 v107, v107
    v_mfma_f32_16x16x32_bf16 v[120:123], a[128:131], a[112:115], v[76:79]
    v_exp_f32 v108, v108
    v_mfma_f32_16x16x32_bf16 v[120:123], a[132:135], a[116:119], v[120:123]
    v_exp_f32 v109, v109
    v_mfma_f32_16x16x32_bf16 v[120:123], a[136:139], a[120:123], v[120:123]
    v_exp_f32 v110, v110
    v_mfma_f32_16x16x32_bf16 v[120:123], a[140:143], a[124:127], v[120:123]
    v_exp_f32 v111, v111
    v_mfma_f32_16x16x32_bf16 v[116:119], a[144:147], a[96:99], v[72:75]
    ds_read_b128 a[128:131], v18 offset:16384
    v_cvt_pk_bf16_f32 v48, v96, v97
    v_mfma_f32_16x16x32_bf16 v[116:119], a[148:151], a[100:103], v[116:119]
    ds_read_b128 a[132:135], v18 offset:17408
    v_cvt_pk_bf16_f32 v49, v98, v99
    v_mfma_f32_16x16x32_bf16 v[116:119], a[152:155], a[104:107], v[116:119]
    ds_read_b128 a[136:139], v18 offset:18432
    v_cvt_pk_bf16_f32 v50, v100, v101
    v_mfma_f32_16x16x32_bf16 v[116:119], a[156:159], a[108:111], v[116:119]
    ds_read_b128 a[140:143], v18 offset:19456
    v_cvt_pk_bf16_f32 v51, v102, v103
    v_mfma_f32_16x16x32_bf16 v[124:127], a[144:147], a[112:115], v[76:79]
    ds_read_b128 a[144:147], v18 offset:20480
    v_cvt_pk_bf16_f32 v52, v104, v105
    v_mfma_f32_16x16x32_bf16 v[124:127], a[148:151], a[116:119], v[124:127]
    ds_read_b128 a[148:151], v18 offset:21504
    v_cvt_pk_bf16_f32 v53, v106, v107
    v_mfma_f32_16x16x32_bf16 v[124:127], a[152:155], a[120:123], v[124:127]
    ds_read_b128 a[152:155], v18 offset:22528
    v_cvt_pk_bf16_f32 v54, v108, v109
    v_mfma_f32_16x16x32_bf16 v[124:127], a[156:159], a[124:127], v[124:127]
    ds_read_b128 a[156:159], v18 offset:23552
    v_cvt_pk_bf16_f32 v55, v110, v111
    v_xor_b32 v18, 196608, v18
    s_branch L_t1_p1
L_t1_zero:
    v_mfma_f32_16x16x32_bf16 v[96:99], a[128:131], a[96:99], v[80:83]
    s_xor_b32 s100, s16, 8192
    ds_read_b128 a[176:179], v20 offset:4096
    v_lshrrev_b32 v13, 1, v1
    v_mfma_f32_16x16x32_bf16 v[96:99], a[132:135], a[100:103], v[96:99]
    s_add_u32 m0, s15, 0
    ds_read_b128 a[180:183], v20 offset:5120
    v_add_u32 v12, s100, v13
    v_mfma_f32_16x16x32_bf16 v[96:99], a[136:139], a[104:107], v[96:99]
    buffer_load_dwordx4 v1, s[8:11], s82 offen offset:0  lds
    v_exp_f32 v112, v112
    v_mfma_f32_16x16x32_bf16 v[96:99], a[140:143], a[108:111], v[96:99]
    v_exp_f32 v113, v113
    v_mfma_f32_16x16x32_bf16 v[100:103], a[144:147], a[96:99], v[84:87]
    ds_read_b128 a[184:187], v20 offset:6144
    v_cvt_pk_bf16_f32 v56, v112, v113
    v_mfma_f32_16x16x32_bf16 v[100:103], a[148:151], a[100:103], v[100:103]
    v_exp_f32 v114, v114
    v_mfma_f32_16x16x32_bf16 v[100:103], a[152:155], a[104:107], v[100:103]
    buffer_load_dwordx4 v1, s[8:11], s82 offen offset:1024  lds
    v_exp_f32 v115, v115
    v_mfma_f32_16x16x32_bf16 v[100:103], a[156:159], a[108:111], v[100:103]
    ds_read_b128 a[188:191], v20 offset:7168
    v_cvt_pk_bf16_f32 v57, v114, v115
    v_mfma_f32_16x16x32_bf16 v[104:107], a[128:131], a[112:115], v[88:91]
    v_exp_f32 v116, v116
    v_mfma_f32_16x16x32_bf16 v[104:107], a[132:135], a[116:119], v[104:107]
    v_exp_f32 v117, v117
    v_mfma_f32_16x16x32_bf16 v[104:107], a[136:139], a[120:123], v[104:107]
    ds_read_b128 a[160:163], v19 offset:0
    v_cvt_pk_bf16_f32 v58, v116, v117
    v_mfma_f32_16x16x32_bf16 v[104:107], a[140:143], a[124:127], v[104:107]
    buffer_load_dwordx4 v1, s[8:11], s82 offen offset:2048  lds
    v_exp_f32 v118, v118
    v_mfma_f32_16x16x32_bf16 v[108:111], a[144:147], a[112:115], v[92:95]
    v_exp_f32 v119, v119
    v_mfma_f32_16x16x32_bf16 v[108:111], a[148:151], a[116:119], v[108:111]
    ds_read_b128 a[164:167], v19 offset:1024
    v_cvt_pk_bf16_f32 v59, v118, v119
    v_mfma_f32_16x16x32_bf16 v[108:111], a[152:155], a[120:123], v[108:111]
    v_exp_f32 v120, v120
    v_mfma_f32_16x16x32_bf16 v[108:111], a[156:159], a[124:127], v[108:111]
    buffer_load_dwordx4 v1, s[8:11], s82 offen offset:3072  lds
    v_exp_f32 v121, v121
    v_mfma_f32_16x16x32_bf16 v[32:35], v[28:31], v[48:51], 0
    s_add_u32 m0, s15, 4096
    ds_read_b128 a[168:171], v19 offset:2048
    v_cvt_pk_bf16_f32 v60, v120, v121
    v_mfma_f32_16x16x32_bf16 v[36:39], v[28:31], v[52:55], 0
    s_waitcnt lgkmcnt(6)
    v_exp_f32 v122, v122
    v_mfma_f32_16x16x32_bf16 v[144:147], a[176:179], v[48:51], 0
    v_exp_f32 v123, v123
    v_mfma_f32_16x16x32_bf16 v[176:179], a[176:179], v[52:55], 0
    s_waitcnt lgkmcnt(5)
    ds_read_b128 a[172:175], v19 offset:3072
    v_cvt_pk_bf16_f32 v61, v122, v123
    v_mfma_f32_16x16x32_bf16 v[148:151], a[180:183], v[48:51], 0
    buffer_load_dwordx4 v15, s[8:11], s82 offen offset:0  lds
    v_exp_f32 v124, v124
    v_mfma_f32_16x16x32_bf16 v[180:183], a[180:183], v[52:55], 0
    s_waitcnt lgkmcnt(5)
    v_exp_f32 v125, v125
    v_mfma_f32_16x16x32_bf16 v[152:155], a[184:187], v[48:51], 0
    s_waitcnt lgkmcnt(4)
    v_exp_f32 v126, v126
    v_mfma_f32_16x16x32_bf16 v[184:187], a[184:187], v[52:55], 0
    buffer_load_dwordx4 v15, s[8:11], s82 offen offset:1024  lds
    v_exp_f32 v127, v127
    v_mfma_f32_16x16x32_bf16 v[156:159], a[188:191], v[48:51], 0
    ds_write_b128 v16, v[144:147] offset:32768
    v_cvt_pk_bf16_f32 v62, v124, v125
    v_mfma_f32_16x16x32_bf16 v[188:191], a[188:191], v[52:55], 0
    s_waitcnt lgkmcnt(4)
    v_exp_f32 v96, v96
    v_mfma_f32_16x16x32_bf16 v[128:131], a[160:163], v[48:51], 0
    v_exp_f32 v97, v97
    v_mfma_f32_16x16x32_bf16 v[160:163], a[160:163], v[52:55], 0
    s_waitcnt lgkmcnt(3)
    ds_write_b128 v16, v[176:179] offset:33792
    v_cvt_pk_bf16_f32 v63, v126, v127
    v_mfma_f32_16x16x32_bf16 v[132:135], a[164:167], v[48:51], 0
    s_waitcnt lgkmcnt(3)
    v_exp_f32 v98, v98
    v_mfma_f32_16x16x32_bf16 v[164:167], a[164:167], v[52:55], 0
    buffer_load_dwordx4 v15, s[8:11], s82 offen offset:2048  lds
    v_exp_f32 v99, v99
    v_mfma_f32_16x16x32_bf16 v[136:139], a[168:171], v[48:51], 0
    ds_write_b128 v16, v[148:151] offset:34816
    v_mfma_f32_16x16x32_bf16 v[168:171], a[168:171], v[52:55], 0
    s_waitcnt lgkmcnt(3)
    v_exp_f32 v100, v100
    v_mfma_f32_16x16x32_bf16 v[140:143], a[172:175], v[48:51], 0
    v_exp_f32 v101, v101
    v_mfma_f32_16x16x32_bf16 v[172:175], a[172:175], v[52:55], 0
    ds_write_b128 v16, v[180:183] offset:35840
    v_mov_b32 v33, v36
    v_mfma_f32_16x16x32_bf16 v[40:43], v[28:31], v[56:59], 0
    buffer_load_dwordx4 v15, s[8:11], s82 offen offset:3072  lds
    v_exp_f32 v102, v102
    v_mfma_f32_16x16x32_bf16 v[44:47], v[28:31], v[60:63], 0
    s_xor_b32 s15, s15, 196608
    v_exp_f32 v103, v103
    v_mfma_f32_16x16x32_bf16 v[208:211], a[176:179], v[56:59], 0
    ds_write_b128 v16, v[152:155] offset:36864
    v_cvt_pk_bf16_f32 v48, v96, v97
    v_mfma_f32_16x16x32_bf16 v[240:243], a[176:179], v[60:63], 0
    ds_read_b128 a[176:179], v20 offset:20480
    v_exp_f32 v104, v104
    v_mfma_f32_16x16x32_bf16 v[212:215], a[180:183], v[56:59], 0
    v_exp_f32 v105, v105
    v_mfma_f32_16x16x32_bf16 v[244:247], a[180:183], v[60:63], 0
    ds_read_b128 a[180:183], v20 offset:21504
    v_exp_f32 v106, v106
    v_mfma_f32_16x16x32_bf16 v[216:219], a[184:187], v[56:59], 0
    ds_write_b128 v16, v[184:187] offset:37888
    v_cvt_pk_bf16_f32 v49, v98, v99
    v_mfma_f32_16x16x32_bf16 v[248:251], a[184:187], v[60:63], 0
    ds_read_b128 a[184:187], v20 offset:22528
    v_exp_f32 v107, v107
    v_mfma_f32_16x16x32_bf16 v[220:223], a[188:191], v[56:59], 0
    v_exp_f32 v108, v108
    v_mfma_f32_16x16x32_bf16 v[252:255], a[188:191], v[60:63], 0
    ds_read_b128 a[188:191], v20 offset:23552
    v_exp_f32 v109, v109
    v_mfma_f32_16x16x32_bf16 v[192:195], a[160:163], v[56:59], 0
    ds_write_b128 v16, v[156:159] offset:38912
    v_cvt_pk_bf16_f32 v50, v100, v101
    v_mfma_f32_16x16x32_bf16 v[224:227], a[160:163], v[60:63], 0
    ds_read_b128 a[160:163], v19 offset:16384
    v_exp_f32 v110, v110
    v_mfma_f32_16x16x32_bf16 v[196:199], a[164:167], v[56:59], 0
    v_exp_f32 v111, v111
    v_mfma_f32_16x16x32_bf16 v[228:231], a[164:167], v[60:63], 0
    ds_read_b128 a[164:167], v19 offset:17408
    v_cvt_pk_bf16_f32 v51, v102, v103
    v_mfma_f32_16x16x32_bf16 v[200:203], a[168:171], v[56:59], 0
    ds_write_b128 v16, v[188:191] offset:39936
    v_cvt_pk_bf16_f32 v52, v104, v105
    v_mfma_f32_16x16x32_bf16 v[232:235], a[168:171], v[60:63], 0
    ds_read_b128 a[168:171], v19 offset:18432
    v_cvt_pk_bf16_f32 v53, v106, v107
    v_mfma_f32_16x16x32_bf16 v[204:207], a[172:175], v[56:59], 0
    v_cvt_pk_bf16_f32 v54, v108, v109
    v_cvt_pk_bf16_f32 v55, v110, v111
    v_mfma_f32_16x16x32_bf16 v[236:239], a[172:175], v[60:63], 0
    ds_read_b128 a[172:175], v19 offset:19456
    ds_write_b64 v12, v[32:33]
    s_xor_b32 s101, s16, 98304
    v_xor_b32 v12, 8192, v12
    v_add_u32 v9, s101, v1
    v_xor_b32 v8, 8192, v16
    v_xor_b32 v10, 8192, v9
    s_branch L_t1_join
L_t1_redo:
    s_cmp_eq_u32 s25, 0
    s_cbranch_scc1 L_t1_max
    s_mov_b32 s25, 0
    v_mov_b32 v64, 0
    v_mov_b32 v65, 0
    v_mov_b32 v66, 0
    v_mov_b32 v67, 0
    v_mov_b32 v68, 0
    v_mov_b32 v69, 0
    v_mov_b32 v70, 0
    v_mov_b32 v71, 0
    v_mov_b32 v72, 0
    v_mov_b32 v73, 0
    v_mov_b32 v74, 0
    v_mov_b32 v75, 0
    v_mov_b32 v76, 0
    v_mov_b32 v77, 0
    v_mov_b32 v78, 0
    v_mov_b32 v79, 0
    s_nop 1
    s_branch L_t1_safe
L_t1_max:
    s_waitcnt vmcnt(0) lgkmcnt(0)
    s_barrier
    s_mov_b32 s25, 1
    s_and_b32 s100, s3, 1
    s_lshl_b32 s100, s100, 13
    s_sub_u32 s101, s81, s62
    s_add_u32 s101, s101, s100
    s_mov_b32 s14, s60
    v_mov_b32 v48, 0xff800000
    v_mov_b32 v49, 0xff800000
    v_mov_b32 v50, 0xff800000
    v_mov_b32 v51, 0xff800000
L_t1_maxl:
    s_cmp_eq_u32 s14, 0
    s_cbranch_scc1 L_t1_maxd
    s_add_u32 s100, s101, 0
    buffer_load_dwordx4 a[128:131], v1, s[8:11], s100 offen offset:0
    buffer_load_dwordx4 a[132:135], v1, s[8:11], s100 offen offset:1024
    buffer_load_dwordx4 a[136:139], v1, s[8:11], s100 offen offset:2048
    buffer_load_dwordx4 a[140:143], v1, s[8:11], s100 offen offset:3072
    buffer_load_dwordx4 a[144:147], v15, s[8:11], s100 offen offset:0
    buffer_load_dwordx4 a[148:151], v15, s[8:11], s100 offen offset:1024
    buffer_load_dwordx4 a[152:155], v15, s[8:11], s100 offen offset:2048
    buffer_load_dwordx4 a[156:159], v15, s[8:11], s100 offen offset:3072
    s_waitcnt vmcnt(7)
    v_mfma_f32_16x16x32_bf16 v[96:99], a[128:131], a[64:67], v[64:67]
    s_waitcnt vmcnt(6)
    v_mfma_f32_16x16x32_bf16 v[96:99], a[132:135], a[68:71], v[96:99]
    s_waitcnt vmcnt(5)
    v_mfma_f32_16x16x32_bf16 v[96:99], a[136:139], a[72:75], v[96:99]
    s_waitcnt vmcnt(4)
    v_mfma_f32_16x16x32_bf16 v[96:99], a[140:143], a[76:79], v[96:99]
    v_mfma_f32_16x16x32_bf16 v[104:107], a[128:131], a[80:83], v[68:71]
    v_mfma_f32_16x16x32_bf16 v[104:107], a[132:135], a[84:87], v[104:107]
    v_mfma_f32_16x16x32_bf16 v[104:107], a[136:139], a[88:91], v[104:107]
    v_mfma_f32_16x16x32_bf16 v[104:107], a[140:143], a[92:95], v[104:107]
    s_waitcnt vmcnt(3)
    v_mfma_f32_16x16x32_bf16 v[100:103], a[144:147], a[64:67], v[64:67]
    s_waitcnt vmcnt(2)
    v_mfma_f32_16x16x32_bf16 v[100:103], a[148:151], a[68:71], v[100:103]
    s_waitcnt vmcnt(1)
    v_mfma_f32_16x16x32_bf16 v[100:103], a[152:155], a[72:75], v[100:103]
    s_waitcnt vmcnt(0)
    v_mfma_f32_16x16x32_bf16 v[100:103], a[156:159], a[76:79], v[100:103]
    v_mfma_f32_16x16x32_bf16 v[108:111], a[144:147], a[80:83], v[68:71]
    v_mfma_f32_16x16x32_bf16 v[108:111], a[148:151], a[84:87], v[108:111]
    v_mfma_f32_16x16x32_bf16 v[108:111], a[152:155], a[88:91], v[108:111]
    v_mfma_f32_16x16x32_bf16 v[108:111], a[156:159], a[92:95], v[108:111]
    v_mfma_f32_16x16x32_bf16 v[112:115], a[128:131], a[96:99], v[72:75]
    v_mfma_f32_16x16x32_bf16 v[112:115], a[132:135], a[100:103], v[112:115]
    v_mfma_f32_16x16x32_bf16 v[112:115], a[136:139], a[104:107], v[112:115]
    v_mfma_f32_16x16x32_bf16 v[112:115], a[140:143], a[108:111], v[112:115]
    v_mfma_f32_16x16x32_bf16 v[120:123], a[128:131], a[112:115], v[76:79]
    v_mfma_f32_16x16x32_bf16 v[120:123], a[132:135], a[116:119], v[120:123]
    v_mfma_f32_16x16x32_bf16 v[120:123], a[136:139], a[120:123], v[120:123]
    v_mfma_f32_16x16x32_bf16 v[120:123], a[140:143], a[124:127], v[120:123]
    v_mfma_f32_16x16x32_bf16 v[116:119], a[144:147], a[96:99], v[72:75]
    v_mfma_f32_16x16x32_bf16 v[116:119], a[148:151], a[100:103], v[116:119]
    v_mfma_f32_16x16x32_bf16 v[116:119], a[152:155], a[104:107], v[116:119]
    v_mfma_f32_16x16x32_bf16 v[116:119], a[156:159], a[108:111], v[116:119]
    v_mfma_f32_16x16x32_bf16 v[124:127], a[144:147], a[112:115], v[76:79]
    v_mfma_f32_16x16x32_bf16 v[124:127], a[148:151], a[116:119], v[124:127]
    v_mfma_f32_16x16x32_bf16 v[124:127], a[152:155], a[120:123], v[124:127]
    v_mfma_f32_16x16x32_bf16 v[124:127], a[156:159], a[124:127], v[124:127]
    v_max3_f32 v48, v48, v96, v97
    v_max3_f32 v48, v48, v98, v99
    v_max3_f32 v48, v48, v100, v101
    v_max3_f32 v48, v48, v102, v103
    v_max3_f32 v49, v49, v104, v105
    v_max3_f32 v49, v49, v106, v107
    v_max3_f32 v49, v49, v108, v109
    v_max3_f32 v49, v49, v110, v111
    v_max3_f32 v50, v50, v112, v113
    v_max3_f32 v50, v50, v114, v115
    v_max3_f32 v50, v50, v116, v117
    v_max3_f32 v50, v50, v118, v119
    v_max3_f32 v51, v51, v120, v121
    v_max3_f32 v51, v51, v122, v123
    v_max3_f32 v51, v51, v124, v125
    v_max3_f32 v51, v51, v126, v127
    s_add_u32 s100, s101, 16384
    buffer_load_dwordx4 a[128:131], v1, s[8:11], s100 offen offset:0
    buffer_load_dwordx4 a[132:135], v1, s[8:11], s100 offen offset:1024
    buffer_load_dwordx4 a[136:139], v1, s[8:11], s100 offen offset:2048
    buffer_load_dwordx4 a[140:143], v1, s[8:11], s100 offen offset:3072
    buffer_load_dwordx4 a[144:147], v15, s[8:11], s100 offen offset:0
    buffer_load_dwordx4 a[148:151], v15, s[8:11], s100 offen offset:1024
    buffer_load_dwordx4 a[152:155], v15, s[8:11], s100 offen offset:2048
    buffer_load_dwordx4 a[156:159], v15, s[8:11], s100 offen offset:3072
    s_waitcnt vmcnt(7)
    v_mfma_f32_16x16x32_bf16 v[96:99], a[128:131], a[64:67], v[64:67]
    s_waitcnt vmcnt(6)
    v_mfma_f32_16x16x32_bf16 v[96:99], a[132:135], a[68:71], v[96:99]
    s_waitcnt vmcnt(5)
    v_mfma_f32_16x16x32_bf16 v[96:99], a[136:139], a[72:75], v[96:99]
    s_waitcnt vmcnt(4)
    v_mfma_f32_16x16x32_bf16 v[96:99], a[140:143], a[76:79], v[96:99]
    v_mfma_f32_16x16x32_bf16 v[104:107], a[128:131], a[80:83], v[68:71]
    v_mfma_f32_16x16x32_bf16 v[104:107], a[132:135], a[84:87], v[104:107]
    v_mfma_f32_16x16x32_bf16 v[104:107], a[136:139], a[88:91], v[104:107]
    v_mfma_f32_16x16x32_bf16 v[104:107], a[140:143], a[92:95], v[104:107]
    s_waitcnt vmcnt(3)
    v_mfma_f32_16x16x32_bf16 v[100:103], a[144:147], a[64:67], v[64:67]
    s_waitcnt vmcnt(2)
    v_mfma_f32_16x16x32_bf16 v[100:103], a[148:151], a[68:71], v[100:103]
    s_waitcnt vmcnt(1)
    v_mfma_f32_16x16x32_bf16 v[100:103], a[152:155], a[72:75], v[100:103]
    s_waitcnt vmcnt(0)
    v_mfma_f32_16x16x32_bf16 v[100:103], a[156:159], a[76:79], v[100:103]
    v_mfma_f32_16x16x32_bf16 v[108:111], a[144:147], a[80:83], v[68:71]
    v_mfma_f32_16x16x32_bf16 v[108:111], a[148:151], a[84:87], v[108:111]
    v_mfma_f32_16x16x32_bf16 v[108:111], a[152:155], a[88:91], v[108:111]
    v_mfma_f32_16x16x32_bf16 v[108:111], a[156:159], a[92:95], v[108:111]
    v_mfma_f32_16x16x32_bf16 v[112:115], a[128:131], a[96:99], v[72:75]
    v_mfma_f32_16x16x32_bf16 v[112:115], a[132:135], a[100:103], v[112:115]
    v_mfma_f32_16x16x32_bf16 v[112:115], a[136:139], a[104:107], v[112:115]
    v_mfma_f32_16x16x32_bf16 v[112:115], a[140:143], a[108:111], v[112:115]
    v_mfma_f32_16x16x32_bf16 v[120:123], a[128:131], a[112:115], v[76:79]
    v_mfma_f32_16x16x32_bf16 v[120:123], a[132:135], a[116:119], v[120:123]
    v_mfma_f32_16x16x32_bf16 v[120:123], a[136:139], a[120:123], v[120:123]
    v_mfma_f32_16x16x32_bf16 v[120:123], a[140:143], a[124:127], v[120:123]
    v_mfma_f32_16x16x32_bf16 v[116:119], a[144:147], a[96:99], v[72:75]
    v_mfma_f32_16x16x32_bf16 v[116:119], a[148:151], a[100:103], v[116:119]
    v_mfma_f32_16x16x32_bf16 v[116:119], a[152:155], a[104:107], v[116:119]
    v_mfma_f32_16x16x32_bf16 v[116:119], a[156:159], a[108:111], v[116:119]
    v_mfma_f32_16x16x32_bf16 v[124:127], a[144:147], a[112:115], v[76:79]
    v_mfma_f32_16x16x32_bf16 v[124:127], a[148:151], a[116:119], v[124:127]
    v_mfma_f32_16x16x32_bf16 v[124:127], a[152:155], a[120:123], v[124:127]
    v_mfma_f32_16x16x32_bf16 v[124:127], a[156:159], a[124:127], v[124:127]
    v_max3_f32 v48, v48, v96, v97
    v_max3_f32 v48, v48, v98, v99
    v_max3_f32 v48, v48, v100, v101
    v_max3_f32 v48, v48, v102, v103
    v_max3_f32 v49, v49, v104, v105
    v_max3_f32 v49, v49, v106, v107
    v_max3_f32 v49, v49, v108, v109
    v_max3_f32 v49, v49, v110, v111
    v_max3_f32 v50, v50, v112, v113
    v_max3_f32 v50, v50, v114, v115
    v_max3_f32 v50, v50, v116, v117
    v_max3_f32 v50, v50, v118, v119
    v_max3_f32 v51, v51, v120, v121
    v_max3_f32 v51, v51, v122, v123
    v_max3_f32 v51, v51, v124, v125
    v_max3_f32 v51, v51, v126, v127
    s_add_u32 s101, s101, 65536
    s_sub_u32 s14, s14, 1
    s_nop 7
    s_branch L_t1_maxl
L_t1_maxd:
    s_add_u32 s100, s101, 0
    buffer_load_dwordx4 a[128:131], v1, s[8:11], s100 offen offset:0
    buffer_load_dwordx4 a[132:135], v1, s[8:11], s100 offen offset:1024
    buffer_load_dwordx4 a[136:139], v1, s[8:11], s100 offen offset:2048
    buffer_load_dwordx4 a[140:143], v1, s[8:11], s100 offen offset:3072
    buffer_load_dwordx4 a[144:147], v15, s[8:11], s100 offen offset:0
    buffer_load_dwordx4 a[148:151], v15, s[8:11], s100 offen offset:1024
    buffer_load_dwordx4 a[152:155], v15, s[8:11], s100 offen offset:2048
    buffer_load_dwordx4 a[156:159], v15, s[8:11], s100 offen offset:3072
    v_add_f32 v80, 0, v21
    v_min_f32 v80, v80, v64
    v_add_f32 v81, 0xf1800000, v21
    v_min_f32 v81, v81, v65
    v_add_f32 v82, 0xf2000000, v21
    v_min_f32 v82, v82, v66
    v_add_f32 v83, 0xf2400000, v21
    v_min_f32 v83, v83, v67
    v_add_f32 v84, 0xf3800000, v21
    v_min_f32 v84, v84, v64
    v_add_f32 v85, 0xf3880000, v21
    v_min_f32 v85, v85, v65
    v_add_f32 v86, 0xf3900000, v21
    v_min_f32 v86, v86, v66
    v_add_f32 v87, 0xf3980000, v21
    v_min_f32 v87, v87, v67
    v_add_f32 v88, 0x73800000, v21
    v_min_f32 v88, v88, v68
    v_add_f32 v89, 0x73700000, v21
    v_min_f32 v89, v89, v69
    v_add_f32 v90, 0x73600000, v21
    v_min_f32 v90, v90, v70
    v_add_f32 v91, 0x73500000, v21
    v_min_f32 v91, v91, v71
    v_add_f32 v92, 0, v21
    v_min_f32 v92, v92, v68
    v_add_f32 v93, 0xf1800000, v21
    v_min_f32 v93, v93, v69
    v_add_f32 v94, 0xf2000000, v21
    v_min_f32 v94, v94, v70
    v_add_f32 v95, 0xf2400000, v21
    v_min_f32 v95, v95, v71
    s_waitcnt vmcnt(7)
    v_mfma_f32_16x16x32_bf16 v[96:99], a[128:131], a[64:67], v[80:83]
    s_waitcnt vmcnt(6)
    v_mfma_f32_16x16x32_bf16 v[96:99], a[132:135], a[68:71], v[96:99]
    s_waitcnt vmcnt(5)
    v_mfma_f32_16x16x32_bf16 v[96:99], a[136:139], a[72:75], v[96:99]
    s_waitcnt vmcnt(4)
    v_mfma_f32_16x16x32_bf16 v[96:99], a[140:143], a[76:79], v[96:99]
    v_mfma_f32_16x16x32_bf16 v[104:107], a[128:131], a[80:83], v[88:91]
    v_mfma_f32_16x16x32_bf16 v[104:107], a[132:135], a[84:87], v[104:107]
    v_mfma_f32_16x16x32_bf16 v[104:107], a[136:139], a[88:91], v[104:107]
    v_mfma_f32_16x16x32_bf16 v[104:107], a[140:143], a[92:95], v[104:107]
    s_waitcnt vmcnt(3)
    v_mfma_f32_16x16x32_bf16 v[100:103], a[144:147], a[64:67], v[84:87]
    s_waitcnt vmcnt(2)
    v_mfma_f32_16x16x32_bf16 v[100:103], a[148:151], a[68:71], v[100:103]
    s_waitcnt vmcnt(1)
    v_mfma_f32_16x16x32_bf16 v[100:103], a[152:155], a[72:75], v[100:103]
    s_waitcnt vmcnt(0)
    v_mfma_f32_16x16x32_bf16 v[100:103], a[156:159], a[76:79], v[100:103]
    v_mfma_f32_16x16x32_bf16 v[108:111], a[144:147], a[80:83], v[92:95]
    v_mfma_f32_16x16x32_bf16 v[108:111], a[148:151], a[84:87], v[108:111]
    v_mfma_f32_16x16x32_bf16 v[108:111], a[152:155], a[88:91], v[108:111]
    v_mfma_f32_16x16x32_bf16 v[108:111], a[156:159], a[92:95], v[108:111]
    v_mfma_f32_16x16x32_bf16 v[112:115], a[128:131], a[96:99], v[72:75]
    v_mfma_f32_16x16x32_bf16 v[112:115], a[132:135], a[100:103], v[112:115]
    v_mfma_f32_16x16x32_bf16 v[112:115], a[136:139], a[104:107], v[112:115]
    v_mfma_f32_16x16x32_bf16 v[112:115], a[140:143], a[108:111], v[112:115]
    v_mfma_f32_16x16x32_bf16 v[120:123], a[128:131], a[112:115], v[76:79]
    v_mfma_f32_16x16x32_bf16 v[120:123], a[132:135], a[116:119], v[120:123]
    v_mfma_f32_16x16x32_bf16 v[120:123], a[136:139], a[120:123], v[120:123]
    v_mfma_f32_16x16x32_bf16 v[120:123], a[140:143], a[124:127], v[120:123]
    v_mfma_f32_16x16x32_bf16 v[116:119], a[144:147], a[96:99], v[72:75]
    v_mfma_f32_16x16x32_bf16 v[116:119], a[148:151], a[100:103], v[116:119]
    v_mfma_f32_16x16x32_bf16 v[116:119], a[152:155], a[104:107], v[116:119]
    v_mfma_f32_16x16x32_bf16 v[116:119], a[156:159], a[108:111], v[116:119]
    v_mfma_f32_16x16x32_bf16 v[124:127], a[144:147], a[112:115], v[76:79]
    v_mfma_f32_16x16x32_bf16 v[124:127], a[148:151], a[116:119], v[124:127]
    v_mfma_f32_16x16x32_bf16 v[124:127], a[152:155], a[120:123], v[124:127]
    v_mfma_f32_16x16x32_bf16 v[124:127], a[156:159], a[124:127], v[124:127]
    v_max3_f32 v48, v48, v96, v97
    v_max3_f32 v48, v48, v98, v99
    v_max3_f32 v48, v48, v100, v101
    v_max3_f32 v48, v48, v102, v103
    v_max3_f32 v49, v49, v104, v105
    v_max3_f32 v49, v49, v106, v107
    v_max3_f32 v49, v49, v108, v109
    v_max3_f32 v49, v49, v110, v111
    v_max3_f32 v50, v50, v112, v113
    v_max3_f32 v50, v50, v114, v115
    v_max3_f32 v50, v50, v116, v117
    v_max3_f32 v50, v50, v118, v119
    v_max3_f32 v51, v51, v120, v121
    v_max3_f32 v51, v51, v122, v123
    v_max3_f32 v51, v51, v124, v125
    v_max3_f32 v51, v51, v126, v127
    s_add_u32 s100, s101, 16384
    buffer_load_dwordx4 a[128:131], v1, s[8:11], s100 offen offset:0
    buffer_load_dwordx4 a[132:135], v1, s[8:11], s100 offen offset:1024
    buffer_load_dwordx4 a[136:139], v1, s[8:11], s100 offen offset:2048
    buffer_load_dwordx4 a[140:143], v1, s[8:11], s100 offen offset:3072
    buffer_load_dwordx4 a[144:147], v15, s[8:11], s100 offen offset:0
    buffer_load_dwordx4 a[148:151], v15, s[8:11], s100 offen offset:1024
    buffer_load_dwordx4 a[152:155], v15, s[8:11], s100 offen offset:2048
    buffer_load_dwordx4 a[156:159], v15, s[8:11], s100 offen offset:3072
    v_add_f32 v80, 0, v22
    v_min_f32 v80, v80, v72
    v_add_f32 v81, 0xf1800000, v22
    v_min_f32 v81, v81, v73
    v_add_f32 v82, 0xf2000000, v22
    v_min_f32 v82, v82, v74
    v_add_f32 v83, 0xf2400000, v22
    v_min_f32 v83, v83, v75
    v_add_f32 v84, 0xf3800000, v22
    v_min_f32 v84, v84, v72
    v_add_f32 v85, 0xf3880000, v22
    v_min_f32 v85, v85, v73
    v_add_f32 v86, 0xf3900000, v22
    v_min_f32 v86, v86, v74
    v_add_f32 v87, 0xf3980000, v22
    v_min_f32 v87, v87, v75
    v_add_f32 v88, 0x73800000, v22
    v_min_f32 v88, v88, v76
    v_add_f32 v89, 0x73700000, v22
    v_min_f32 v89, v89, v77
    v_add_f32 v90, 0x73600000, v22
    v_min_f32 v90, v90, v78
    v_add_f32 v91, 0x73500000, v22
    v_min_f32 v91, v91, v79
    v_add_f32 v92, 0, v22
    v_min_f32 v92, v92, v76
    v_add_f32 v93, 0xf1800000, v22
    v_min_f32 v93, v93, v77
    v_add_f32 v94, 0xf2000000, v22
    v_min_f32 v94, v94, v78
    v_add_f32 v95, 0xf2400000, v22
    v_min_f32 v95, v95, v79
    s_waitcnt vmcnt(7)
    v_mfma_f32_16x16x32_bf16 v[96:99], a[128:131], a[96:99], v[80:83]
    s_waitcnt vmcnt(6)
    v_mfma_f32_16x16x32_bf16 v[96:99], a[132:135], a[100:103], v[96:99]
    s_waitcnt vmcnt(5)
    v_mfma_f32_16x16x32_bf16 v[96:99], a[136:139], a[104:107], v[96:99]
    s_waitcnt vmcnt(4)
    v_mfma_f32_16x16x32_bf16 v[96:99], a[140:143], a[108:111], v[96:99]
    v_mfma_f32_16x16x32_bf16 v[104:107], a[128:131], a[112:115], v[88:91]
    v_mfma_f32_16x16x32_bf16 v[104:107], a[132:135], a[116:119], v[104:107]
    v_mfma_f32_16x16x32_bf16 v[104:107], a[136:139], a[120:123], v[104:107]
    v_mfma_f32_16x16x32_bf16 v[104:107], a[140:143], a[124:127], v[104:107]
    s_waitcnt vmcnt(3)
    v_mfma_f32_16x16x32_bf16 v[100:103], a[144:147], a[96:99], v[84:87]
    s_waitcnt vmcnt(2)
    v_mfma_f32_16x16x32_bf16 v[100:103], a[148:151], a[100:103], v[100:103]
    s_waitcnt vmcnt(1)
    v_mfma_f32_16x16x32_bf16 v[100:103], a[152:155], a[104:107], v[100:103]
    s_waitcnt vmcnt(0)
    v_mfma_f32_16x16x32_bf16 v[100:103], a[156:159], a[108:111], v[100:103]
    v_mfma_f32_16x16x32_bf16 v[108:111], a[144:147], a[112:115], v[92:95]
    v_mfma_f32_16x16x32_bf16 v[108:111], a[148:151], a[116:119], v[108:111]
    v_mfma_f32_16x16x32_bf16 v[108:111], a[152:155], a[120:123], v[108:111]
    v_mfma_f32_16x16x32_bf16 v[108:111], a[156:159], a[124:127], v[108:111]
    v_max3_f32 v50, v50, v96, v97
    v_max3_f32 v50, v50, v98, v99
    s_nop 1
    v_max3_f32 v50, v50, v100, v101
    v_max3_f32 v50, v50, v102, v103
    v_max3_f32 v51, v51, v104, v105
    v_max3_f32 v51, v51, v106, v107
    v_max3_f32 v51, v51, v108, v109
    v_max3_f32 v51, v51, v110, v111
    v_mov_b32 v52, v48
    v_mov_b32 v53, v49
    v_mov_b32 v54, v50
    v_mov_b32 v55, v51
    v_permlane16_swap_b32 v48, v52
    v_permlane16_swap_b32 v49, v53
    v_permlane16_swap_b32 v50, v54
    v_permlane16_swap_b32 v51, v55
    v_max_f32 v48, v48, v52
    v_max_f32 v49, v49, v53
    v_max_f32 v50, v50, v54
    v_max_f32 v51, v51, v55
    v_mov_b32 v52, v48
    v_mov_b32 v53, v49
    v_mov_b32 v54, v50
    v_mov_b32 v55, v51
    v_permlane32_swap_b32 v48, v52
    v_permlane32_swap_b32 v49, v53
    v_permlane32_swap_b32 v50, v54
    v_permlane32_swap_b32 v51, v55
    v_max_f32 v48, v48, v52
    v_max_f32 v49, v49, v53
    v_max_f32 v50, v50, v54
    v_max_f32 v51, v51, v55
    ds_write_b128 v16, v[48:51] offset:32768
    v_xor_b32 v8, 8192, v16
    s_waitcnt lgkmcnt(0)
    s_barrier
    ds_read_b128 v[52:55], v8 offset:32768
    s_waitcnt lgkmcnt(0)
    v_max_f32 v48, v48, v52
    v_max_f32 v49, v49, v53
    v_max_f32 v50, v50, v54
    v_max_f32 v51, v51, v55
    v_sub_f32 v64, 0, v48
    v_sub_f32 v65, 0, v48
    v_sub_f32 v66, 0, v48
    v_sub_f32 v67, 0, v48
    v_sub_f32 v68, 0, v49
    v_sub_f32 v69, 0, v49
    v_sub_f32 v70, 0, v49
    v_sub_f32 v71, 0, v49
    v_sub_f32 v72, 0, v50
    v_sub_f32 v73, 0, v50
    v_sub_f32 v74, 0, v50
    v_sub_f32 v75, 0, v50
    v_sub_f32 v76, 0, v51
    v_sub_f32 v77, 0, v51
    v_sub_f32 v78, 0, v51
    v_sub_f32 v79, 0, v51
    s_mov_b32 s12, 0
    s_and_b32 s100, s12, 1
    s_mul_i32 s15, s100, 196608
    s_xor_b32 s15, s15, 65536
    s_mul_i32 s16, s100, 98304
    s_xor_b32 s16, s16, 98304
    v_and_b32 v18, 0x7fff, v18
    v_or_b32 v18, s15, v18
    v_and_b32 v19, 0x7fff, v19
    v_or_b32 v19, s16, v19
    v_and_b32 v20, 0x7fff, v20
    v_or_b32 v20, s16, v20
    s_add_u32 s15, s15, s62
    s_add_u32 s16, s16, s62
    s_add_u32 s12, s12, 2
    s_mov_b32 s82, s81
    s_add_u32 s19, s82, 32768
    s_add_u32 m0, s15, 0
    s_nop 0
    buffer_load_dwordx4 v1, s[8:11], s82 offen offset:0  lds
    buffer_load_dwordx4 v1, s[8:11], s82 offen offset:1024  lds
    buffer_load_dwordx4 v1, s[8:11], s82 offen offset:2048  lds
    buffer_load_dwordx4 v1, s[8:11], s82 offen offset:3072  lds
    s_add_u32 m0, s15, 4096
    s_nop 0
    buffer_load_dwordx4 v15, s[8:11], s82 offen offset:0  lds
    buffer_load_dwordx4 v15, s[8:11], s82 offen offset:1024  lds
    buffer_load_dwordx4 v15, s[8:11], s82 offen offset:2048  lds
    buffer_load_dwordx4 v15, s[8:11], s82 offen offset:3072  lds
    s_xor_b32 s15, s15, 196608
    s_add_u32 m0, s16, 0
    s_nop 0
    buffer_load_dwordx4 v1, s[8:11], s19 offen offset:0  lds
    buffer_load_dwordx4 v1, s[8:11], s19 offen offset:1024  lds
    buffer_load_dwordx4 v1, s[8:11], s19 offen offset:2048  lds
    buffer_load_dwordx4 v1, s[8:11], s19 offen offset:3072  lds
    s_add_u32 m0, s16, 4096
    s_nop 0
    buffer_load_dwordx4 v15, s[8:11], s19 offen offset:0  lds
    buffer_load_dwordx4 v15, s[8:11], s19 offen offset:1024  lds
    buffer_load_dwordx4 v15, s[8:11], s19 offen offset:2048  lds
    buffer_load_dwordx4 v15, s[8:11], s19 offen offset:3072  lds
    s_xor_b32 s16, s16, 98304
    s_cmp_eq_u32 s60, 0
    s_cselect_b32 s82, 0, 1
    s_lshl_b32 s82, s82, 16
    s_add_u32 s82, s82, s81
    s_add_u32 m0, s15, 0
    s_nop 0
    buffer_load_dwordx4 v1, s[8:11], s82 offen offset:0  lds
    buffer_load_dwordx4 v1, s[8:11], s82 offen offset:1024  lds
    buffer_load_dwordx4 v1, s[8:11], s82 offen offset:2048  lds
    buffer_load_dwordx4 v1, s[8:11], s82 offen offset:3072  lds
    s_add_u32 m0, s15, 4096
    s_nop 0
    buffer_load_dwordx4 v15, s[8:11], s82 offen offset:0  lds
    buffer_load_dwordx4 v15, s[8:11], s82 offen offset:1024  lds
    buffer_load_dwordx4 v15, s[8:11], s82 offen offset:2048  lds
    buffer_load_dwordx4 v15, s[8:11], s82 offen offset:3072  lds
    s_xor_b32 s15, s15, 196608
    s_cmp_eq_u32 s60, 0
    s_cselect_b32 s19, 0, 0x76800000
    v_add_f32 v3, s19, v21
    v_add_f32 v96, 0, v3
    v_min_f32 v96, v96, v64
    v_add_f32 v97, 0xf1800000, v3
    v_min_f32 v97, v97, v65
    v_add_f32 v98, 0xf2000000, v3
    v_min_f32 v98, v98, v66
    v_add_f32 v99, 0xf2400000, v3
    v_min_f32 v99, v99, v67
    v_add_f32 v100, 0xf3800000, v3
    v_min_f32 v100, v100, v64
    v_add_f32 v101, 0xf3880000, v3
    v_min_f32 v101, v101, v65
    v_add_f32 v102, 0xf3900000, v3
    v_min_f32 v102, v102, v66
    v_add_f32 v103, 0xf3980000, v3
    v_min_f32 v103, v103, v67
    v_add_f32 v104, 0x73800000, v3
    v_min_f32 v104, v104, v68
    v_add_f32 v105, 0x73700000, v3
    v_min_f32 v105, v105, v69
    v_add_f32 v106, 0x73600000, v3
    v_min_f32 v106, v106, v70
    v_add_f32 v107, 0x73500000, v3
    v_min_f32 v107, v107, v71
    v_add_f32 v108, 0, v3
    v_min_f32 v108, v108, v68
    v_add_f32 v109, 0xf1800000, v3
    v_min_f32 v109, v109, v69
    v_add_f32 v110, 0xf2000000, v3
    v_min_f32 v110, v110, v70
    v_add_f32 v111, 0xf2400000, v3
    v_min_f32 v111, v111, v71
    v_add_f32 v80, 0, v22
    v_min_f32 v80, v80, v72
    v_add_f32 v81, 0xf1800000, v22
    v_min_f32 v81, v81, v73
    v_add_f32 v82, 0xf2000000, v22
    v_min_f32 v82, v82, v74
    v_add_f32 v83, 0xf2400000, v22
    v_min_f32 v83, v83, v75
    v_add_f32 v84, 0xf3800000, v22
    v_min_f32 v84, v84, v72
    v_add_f32 v85, 0xf3880000, v22
    v_min_f32 v85, v85, v73
    v_add_f32 v86, 0xf3900000, v22
    v_min_f32 v86, v86, v74
    v_add_f32 v87, 0xf3980000, v22
    v_min_f32 v87, v87, v75
    v_add_f32 v88, 0x73800000, v22
    v_min_f32 v88, v88, v76
    v_add_f32 v89, 0x73700000, v22
    v_min_f32 v89, v89, v77
    v_add_f32 v90, 0x73600000, v22
    v_min_f32 v90, v90, v78
    v_add_f32 v91, 0x73500000, v22
    v_min_f32 v91, v91, v79
    v_add_f32 v92, 0, v22
    v_min_f32 v92, v92, v76
    v_add_f32 v93, 0xf1800000, v22
    v_min_f32 v93, v93, v77
    v_add_f32 v94, 0xf2000000, v22
    v_min_f32 v94, v94, v78
    v_add_f32 v95, 0xf2400000, v22
    v_min_f32 v95, v95, v79
    s_cmp_eq_u32 s60, 0
    s_cbranch_scc1 L_t1_mk
    v_add_f32 v80, 0, v21
    v_min_f32 v80, v80, v64
    v_add_f32 v81, 0xf1800000, v21
    v_min_f32 v81, v81, v65
    v_add_f32 v82, 0xf2000000, v21
    v_min_f32 v82, v82, v66
    v_add_f32 v83, 0xf2400000, v21
    v_min_f32 v83, v83, v67
    v_add_f32 v84, 0xf3800000, v21
    v_min_f32 v84, v84, v64
    v_add_f32 v85, 0xf3880000, v21
    v_min_f32 v85, v85, v65
    v_add_f32 v86, 0xf3900000, v21
    v_min_f32 v86, v86, v66
    v_add_f32 v87, 0xf3980000, v21
    v_min_f32 v87, v87, v67
    v_add_f32 v88, 0x73800000, v21
    v_min_f32 v88, v88, v68
    v_add_f32 v89, 0x73700000, v21
    v_min_f32 v89, v89, v69
    v_add_f32 v90, 0x73600000, v21
    v_min_f32 v90, v90, v70
    v_add_f32 v91, 0x73500000, v21
    v_min_f32 v91, v91, v71
    v_add_f32 v92, 0, v21
    v_min_f32 v92, v92, v68
    v_add_f32 v93, 0xf1800000, v21
    v_min_f32 v93, v93, v69
    v_add_f32 v94, 0xf2000000, v21
    v_min_f32 v94, v94, v70
    v_add_f32 v95, 0xf2400000, v21
    v_min_f32 v95, v95, v71
L_t1_mk:
    s_waitcnt vmcnt(0) lgkmcnt(0)
    s_barrier
    ds_read_b128 a[128:131], v18 offset:0
    ds_read_b128 a[132:135], v18 offset:1024
    ds_read_b128 a[136:139], v18 offset:2048
    ds_read_b128 a[140:143], v18 offset:3072
    ds_read_b128 a[144:147], v18 offset:4096
    ds_read_b128 a[148:151], v18 offset:5120
    ds_read_b128 a[152:155], v18 offset:6144
    ds_read_b128 a[156:159], v18 offset:7168
    s_waitcnt lgkmcnt(0)
    s_branch L_t1_start
L_C1_slow_9:
    s_mov_b32 s99, 0
L_C1_slow_9_l:
    s_sleep 4
    buffer_load_dword v3, v4, s[8:11], s23 offen sc0 sc1
    s_add_u32 s99, s99, 1
    s_waitcnt vmcnt(0)
    v_cmp_ne_u32 vcc, 0, v3
    s_cmp_eq_u64 vcc, -1
    s_cbranch_scc1 L_C1_ok_10
    s_cmp_lt_u32 s99, 200000
    s_cbranch_scc1 L_C1_slow_9_l
    s_branch L_C1_ok_10
L_F_slow_11:
    s_mov_b32 s99, 0
L_F_slow_11_l:
    s_sleep 4
    buffer_load_dword v3, v12, s[8:11], s71 offen sc0 sc1
    s_add_u32 s99, s99, 1
    s_waitcnt vmcnt(0)
    v_cmp_ne_u32 vcc, 0, v3
    s_cmp_eq_u64 vcc, -1
    s_cbranch_scc1 L_F_ok_12
    s_cmp_lt_u32 s99, 200000
    s_cbranch_scc1 L_F_slow_11_l
    s_branch L_F_ok_12
L_t2_redo:
    s_cmp_eq_u32 s25, 0
    s_cbranch_scc1 L_t2_max
    s_mov_b32 s25, 0
    v_mov_b32 v64, 0
    v_mov_b32 v65, 0
    v_mov_b32 v66, 0
    v_mov_b32 v67, 0
    v_mov_b32 v68, 0
    v_mov_b32 v69, 0
    v_mov_b32 v70, 0
    v_mov_b32 v71, 0
    v_mov_b32 v72, 0
    v_mov_b32 v73, 0
    v_mov_b32 v74, 0
    v_mov_b32 v75, 0
    v_mov_b32 v76, 0
    v_mov_b32 v77, 0
    v_mov_b32 v78, 0
    v_mov_b32 v79, 0
    s_nop 1
    s_branch L_t2_safe
L_t2_max:
    s_waitcnt vmcnt(0) lgkmcnt(0)
    s_barrier
    s_mov_b32 s25, 1
    s_and_b32 s100, s3, 1
    s_lshl_b32 s100, s100, 13
    s_sub_u32 s101, s81, s62
    s_add_u32 s101, s101, s100
    s_mov_b32 s14, s61
    s_mov_b32 s26, 0
    v_mov_b32 v24, -1
    v_mov_b32 v25, -1
    v_mov_b32 v26, -1
    v_mov_b32 v27, -1
    v_mov_b32 v48, 0xff800000
    v_mov_b32 v49, 0xff800000
    v_mov_b32 v50, 0xff800000
    v_mov_b32 v51, 0xff800000
L_t2_maxl:
    s_cmp_eq_u32 s14, 0
    s_cbranch_scc1 L_t2_maxd
    s_add_u32 s100, s101, 0
    buffer_load_dwordx4 a[128:131], v1, s[8:11], s100 offen offset:0
    buffer_load_dwordx4 a[132:135], v1, s[8:11], s100 offen offset:1024
    buffer_load_dwordx4 a[136:139], v1, s[8:11], s100 offen offset:2048
    buffer_load_dwordx4 a[140:143], v1, s[8:11], s100 offen offset:3072
    buffer_load_dwordx4 a[144:147], v15, s[8:11], s100 offen offset:0
    buffer_load_dwordx4 a[148:151], v15, s[8:11], s100 offen offset:1024
    buffer_load_dwordx4 a[152:155], v15, s[8:11], s100 offen offset:2048
    buffer_load_dwordx4 a[156:159], v15, s[8:11], s100 offen offset:3072
    s_waitcnt vmcnt(7)
    v_mfma_f32_16x16x32_bf16 v[96:99], a[128:131], a[192:195], v[64:67]
    s_waitcnt vmcnt(6)
    v_mfma_f32_16x16x32_bf16 v[96:99], a[132:135], a[196:199], v[96:99]
    s_waitcnt vmcnt(5)
    v_mfma_f32_16x16x32_bf16 v[96:99], a[136:139], a[200:203], v[96:99]
    s_waitcnt vmcnt(4)
    v_mfma_f32_16x16x32_bf16 v[96:99], a[140:143], a[204:207], v[96:99]
    v_mfma_f32_16x16x32_bf16 v[104:107], a[128:131], a[208:211], v[68:71]
    v_mfma_f32_16x16x32_bf16 v[104:107], a[132:135], a[212:215], v[104:107]
    v_mfma_f32_16x16x32_bf16 v[104:107], a[136:139], a[216:219], v[104:107]
    v_mfma_f32_16x16x32_bf16 v[104:107], a[140:143], a[220:223], v[104:107]
    s_waitcnt vmcnt(3)
    v_mfma_f32_16x16x32_bf16 v[100:103], a[144:147], a[192:195], v[64:67]
    s_waitcnt vmcnt(2)
    v_mfma_f32_16x16x32_bf16 v[100:103], a[148:151], a[196:199], v[100:103]
    s_waitcnt vmcnt(1)
    v_mfma_f32_16x16x32_bf16 v[100:103], a[152:155], a[200:203], v[100:103]
    s_waitcnt vmcnt(0)
    v_mfma_f32_16x16x32_bf16 v[100:103], a[156:159], a[204:207], v[100:103]
    v_mfma_f32_16x16x32_bf16 v[108:111], a[144:147], a[208:211], v[68:71]
    v_mfma_f32_16x16x32_bf16 v[108:111], a[148:151], a[212:215], v[108:111]
    v_mfma_f32_16x16x32_bf16 v[108:111], a[152:155], a[216:219], v[108:111]
    v_mfma_f32_16x16x32_bf16 v[108:111], a[156:159], a[220:223], v[108:111]
    v_mfma_f32_16x16x32_bf16 v[112:115], a[128:131], a[224:227], v[72:75]
    v_mfma_f32_16x16x32_bf16 v[112:115], a[132:135], a[228:231], v[112:115]
    v_mfma_f32_16x16x32_bf16 v[112:115], a[136:139], a[232:235], v[112:115]
    v_mfma_f32_16x16x32_bf16 v[112:115], a[140:143], a[236:239], v[112:115]
    v_mfma_f32_16x16x32_bf16 v[120:123], a[128:131], a[240:243], v[76:79]
    v_mfma_f32_16x16x32_bf16 v[120:123], a[132:135], a[244:247], v[120:123]
    v_mfma_f32_16x16x32_bf16 v[120:123], a[136:139], a[248:251], v[120:123]
    v_mfma_f32_16x16x32_bf16 v[120:123], a[140:143], a[252:255], v[120:123]
    v_mfma_f32_16x16x32_bf16 v[116:119], a[144:147], a[224:227], v[72:75]
    v_mfma_f32_16x16x32_bf16 v[116:119], a[148:151], a[228:231], v[116:119]
    v_mfma_f32_16x16x32_bf16 v[116:119], a[152:155], a[232:235], v[116:119]
    v_mfma_f32_16x16x32_bf16 v[116:119], a[156:159], a[236:239], v[116:119]
    v_mfma_f32_16x16x32_bf16 v[124:127], a[144:147], a[240:243], v[76:79]
    v_mfma_f32_16x16x32_bf16 v[124:127], a[148:151], a[244:247], v[124:127]
    v_mfma_f32_16x16x32_bf16 v[124:127], a[152:155], a[248:251], v[124:127]
    v_mfma_f32_16x16x32_bf16 v[124:127], a[156:159], a[252:255], v[124:127]
    v_max3_f32 v48, v48, v96, v97
    v_max3_f32 v48, v48, v98, v99
    v_max3_f32 v48, v48, v100, v101
    v_max3_f32 v48, v48, v102, v103
    v_max3_f32 v49, v49, v104, v105
    v_max3_f32 v49, v49, v106, v107
    v_max3_f32 v49, v49, v108, v109
    v_max3_f32 v49, v49, v110, v111
    v_max3_f32 v50, v50, v112, v113
    v_max3_f32 v50, v50, v114, v115
    v_max3_f32 v50, v50, v116, v117
    v_max3_f32 v50, v50, v118, v119
    v_max3_f32 v51, v51, v120, v121
    v_max3_f32 v51, v51, v122, v123
    v_max3_f32 v51, v51, v124, v125
    v_max3_f32 v51, v51, v126, v127
    s_add_u32 s100, s101, 16384
    buffer_load_dwordx4 a[128:131], v1, s[8:11], s100 offen offset:0
    buffer_load_dwordx4 a[132:135], v1, s[8:11], s100 offen offset:1024
    buffer_load_dwordx4 a[136:139], v1, s[8:11], s100 offen offset:2048
    buffer_load_dwordx4 a[140:143], v1, s[8:11], s100 offen offset:3072
    buffer_load_dwordx4 a[144:147], v15, s[8:11], s100 offen offset:0
    buffer_load_dwordx4 a[148:151], v15, s[8:11], s100 offen offset:1024
    buffer_load_dwordx4 a[152:155], v15, s[8:11], s100 offen offset:2048
    buffer_load_dwordx4 a[156:159], v15, s[8:11], s100 offen offset:3072
    s_waitcnt vmcnt(7)
    v_mfma_f32_16x16x32_bf16 v[96:99], a[128:131], a[192:195], v[64:67]
    s_waitcnt vmcnt(6)
    v_mfma_f32_16x16x32_bf16 v[96:99], a[132:135], a[196:199], v[96:99]
    s_waitcnt vmcnt(5)
    v_mfma_f32_16x16x32_bf16 v[96:99], a[136:139], a[200:203], v[96:99]
    s_waitcnt vmcnt(4)
    v_mfma_f32_16x16x32_bf16 v[96:99], a[140:143], a[204:207], v[96:99]
    v_mfma_f32_16x16x32_bf16 v[104:107], a[128:131], a[208:211], v[68:71]
    v_mfma_f32_16x16x32_bf16 v[104:107], a[132:135], a[212:215], v[104:107]
    v_mfma_f32_16x16x32_bf16 v[104:107], a[136:139], a[216:219], v[104:107]
    v_mfma_f32_16x16x32_bf16 v[104:107], a[140:143], a[220:223], v[104:107]
    s_waitcnt vmcnt(3)
    v_mfma_f32_16x16x32_bf16 v[100:103], a[144:147], a[192:195], v[64:67]
    s_waitcnt vmcnt(2)
    v_mfma_f32_16x16x32_bf16 v[100:103], a[148:151], a[196:199], v[100:103]
    s_waitcnt vmcnt(1)
    v_mfma_f32_16x16x32_bf16 v[100:103], a[152:155], a[200:203], v[100:103]
    s_waitcnt vmcnt(0)
    v_mfma_f32_16x16x32_bf16 v[100:103], a[156:159], a[204:207], v[100:103]
    v_mfma_f32_16x16x32_bf16 v[108:111], a[144:147], a[208:211], v[68:71]
    v_mfma_f32_16x16x32_bf16 v[108:111], a[148:151], a[212:215], v[108:111]
    v_mfma_f32_16x16x32_bf16 v[108:111], a[152:155], a[216:219], v[108:111]
    v_mfma_f32_16x16x32_bf16 v[108:111], a[156:159], a[220:223], v[108:111]
    v_mfma_f32_16x16x32_bf16 v[112:115], a[128:131], a[224:227], v[72:75]
    v_mfma_f32_16x16x32_bf16 v[112:115], a[132:135], a[228:231], v[112:115]
    v_mfma_f32_16x16x32_bf16 v[112:115], a[136:139], a[232:235], v[112:115]
    v_mfma_f32_16x16x32_bf16 v[112:115], a[140:143], a[236:239], v[112:115]
    v_mfma_f32_16x16x32_bf16 v[120:123], a[128:131], a[240:243], v[76:79]
    v_mfma_f32_16x16x32_bf16 v[120:123], a[132:135], a[244:247], v[120:123]
    v_mfma_f32_16x16x32_bf16 v[120:123], a[136:139], a[248:251], v[120:123]
    v_mfma_f32_16x16x32_bf16 v[120:123], a[140:143], a[252:255], v[120:123]
    v_mfma_f32_16x16x32_bf16 v[116:119], a[144:147], a[224:227], v[72:75]
    v_mfma_f32_16x16x32_bf16 v[116:119], a[148:151], a[228:231], v[116:119]
    v_mfma_f32_16x16x32_bf16 v[116:119], a[152:155], a[232:235], v[116:119]
    v_mfma_f32_16x16x32_bf16 v[116:119], a[156:159], a[236:239], v[116:119]
    v_mfma_f32_16x16x32_bf16 v[124:127], a[144:147], a[240:243], v[76:79]
    v_mfma_f32_16x16x32_bf16 v[124:127], a[148:151], a[244:247], v[124:127]
    v_mfma_f32_16x16x32_bf16 v[124:127], a[152:155], a[248:251], v[124:127]
    v_mfma_f32_16x16x32_bf16 v[124:127], a[156:159], a[252:255], v[124:127]
    v_max3_f32 v48, v48, v96, v97
    v_max3_f32 v48, v48, v98, v99
    v_max3_f32 v48, v48, v100, v101
    v_max3_f32 v48, v48, v102, v103
    v_max3_f32 v49, v49, v104, v105
    v_max3_f32 v49, v49, v106, v107
    v_max3_f32 v49, v49, v108, v109
    v_max3_f32 v49, v49, v110, v111
    v_max3_f32 v50, v50, v112, v113
    v_max3_f32 v50, v50, v114, v115
    v_max3_f32 v50, v50, v116, v117
    v_max3_f32 v50, v50, v118, v119
    v_max3_f32 v51, v51, v120, v121
    v_max3_f32 v51, v51, v122, v123
    v_max3_f32 v51, v51, v124, v125
    v_max3_f32 v51, v51, v126, v127
    s_add_u32 s101, s101, 65536
    s_sub_u32 s14, s14, 1
    s_nop 7
    s_branch L_t2_maxl
L_t2_maxd:
    s_add_u32 s100, s101, 0
    buffer_load_dwordx4 a[128:131], v1, s[8:11], s100 offen offset:0
    buffer_load_dwordx4 a[132:135], v1, s[8:11], s100 offen offset:1024
    buffer_load_dwordx4 a[136:139], v1, s[8:11], s100 offen offset:2048
    buffer_load_dwordx4 a[140:143], v1, s[8:11], s100 offen offset:3072
    buffer_load_dwordx4 a[144:147], v15, s[8:11], s100 offen offset:0
    buffer_load_dwordx4 a[148:151], v15, s[8:11], s100 offen offset:1024
    buffer_load_dwordx4 a[152:155], v15, s[8:11], s100 offen offset:2048
    buffer_load_dwordx4 a[156:159], v15, s[8:11], s100 offen offset:3072
    v_add_f32 v80, 0, v21
    v_min_f32 v80, v80, v64
    v_add_f32 v81, 0xf1800000, v21
    v_min_f32 v81, v81, v65
    v_add_f32 v82, 0xf2000000, v21
    v_min_f32 v82, v82, v66
    v_add_f32 v83, 0xf2400000, v21
    v_min_f32 v83, v83, v67
    v_add_f32 v84, 0xf3800000, v21
    v_min_f32 v84, v84, v64
    v_add_f32 v85, 0xf3880000, v21
    v_min_f32 v85, v85, v65
    v_add_f32 v86, 0xf3900000, v21
    v_min_f32 v86, v86, v66
    v_add_f32 v87, 0xf3980000, v21
    v_min_f32 v87, v87, v67
    v_add_f32 v88, 0x73800000, v21
    v_min_f32 v88, v88, v68
    v_add_f32 v89, 0x73700000, v21
    v_min_f32 v89, v89, v69
    v_add_f32 v90, 0x73600000, v21
    v_min_f32 v90, v90, v70
    v_add_f32 v91, 0x73500000, v21
    v_min_f32 v91, v91, v71
    v_add_f32 v92, 0, v21
    v_min_f32 v92, v92, v68
    v_add_f32 v93, 0xf1800000, v21
    v_min_f32 v93, v93, v69
    v_add_f32 v94, 0xf2000000, v21
    v_min_f32 v94, v94, v70
    v_add_f32 v95, 0xf2400000, v21
    v_min_f32 v95, v95, v71
    s_waitcnt vmcnt(7)
    v_mfma_f32_16x16x32_bf16 v[96:99], a[128:131], a[192:195], v[80:83]
    s_waitcnt vmcnt(6)
    v_mfma_f32_16x16x32_bf16 v[96:99], a[132:135], a[196:199], v[96:99]
    s_waitcnt vmcnt(5)
    v_mfma_f32_16x16x32_bf16 v[96:99], a[136:139], a[200:203], v[96:99]
    s_waitcnt vmcnt(4)
    v_mfma_f32_16x16x32_bf16 v[96:99], a[140:143], a[204:207], v[96:99]
    v_mfma_f32_16x16x32_bf16 v[104:107], a[128:131], a[208:211], v[88:91]
    v_mfma_f32_16x16x32_bf16 v[104:107], a[132:135], a[212:215], v[104:107]
    v_mfma_f32_16x16x32_bf16 v[104:107], a[136:139], a[216:219], v[104:107]
    v_mfma_f32_16x16x32_bf16 v[104:107], a[140:143], a[220:223], v[104:107]
    s_waitcnt vmcnt(3)
    v_mfma_f32_16x16x32_bf16 v[100:103], a[144:147], a[192:195], v[84:87]
    s_waitcnt vmcnt(2)
    v_mfma_f32_16x16x32_bf16 v[100:103], a[148:151], a[196:199], v[100:103]
    s_waitcnt vmcnt(1)
    v_mfma_f32_16x16x32_bf16 v[100:103], a[152:155], a[200:203], v[100:103]
    s_waitcnt vmcnt(0)
    v_mfma_f32_16x16x32_bf16 v[100:103], a[156:159], a[204:207], v[100:103]
    v_mfma_f32_16x16x32_bf16 v[108:111], a[144:147], a[208:211], v[92:95]
    v_mfma_f32_16x16x32_bf16 v[108:111], a[148:151], a[212:215], v[108:111]
    v_mfma_f32_16x16x32_bf16 v[108:111], a[152:155], a[216:219], v[108:111]
    v_mfma_f32_16x16x32_bf16 v[108:111], a[156:159], a[220:223], v[108:111]
    v_mfma_f32_16x16x32_bf16 v[112:115], a[128:131], a[224:227], v[72:75]
    v_mfma_f32_16x16x32_bf16 v[112:115], a[132:135], a[228:231], v[112:115]
    v_mfma_f32_16x16x32_bf16 v[112:115], a[136:139], a[232:235], v[112:115]
    v_mfma_f32_16x16x32_bf16 v[112:115], a[140:143], a[236:239], v[112:115]
    v_mfma_f32_16x16x32_bf16 v[120:123], a[128:131], a[240:243], v[76:79]
    v_mfma_f32_16x16x32_bf16 v[120:123], a[132:135], a[244:247], v[120:123]
    v_mfma_f32_16x16x32_bf16 v[120:123], a[136:139], a[248:251], v[120:123]
    v_mfma_f32_16x16x32_bf16 v[120:123], a[140:143], a[252:255], v[120:123]
    v_mfma_f32_16x16x32_bf16 v[116:119], a[144:147], a[224:227], v[72:75]
    v_mfma_f32_16x16x32_bf16 v[116:119], a[148:151], a[228:231], v[116:119]
    v_mfma_f32_16x16x32_bf16 v[116:119], a[152:155], a[232:235], v[116:119]
    v_mfma_f32_16x16x32_bf16 v[116:119], a[156:159], a[236:239], v[116:119]
    v_mfma_f32_16x16x32_bf16 v[124:127], a[144:147], a[240:243], v[76:79]
    v_mfma_f32_16x16x32_bf16 v[124:127], a[148:151], a[244:247], v[124:127]
    v_mfma_f32_16x16x32_bf16 v[124:127], a[152:155], a[248:251], v[124:127]
    v_mfma_f32_16x16x32_bf16 v[124:127], a[156:159], a[252:255], v[124:127]
    v_max3_f32 v48, v48, v96, v97
    v_max3_f32 v48, v48, v98, v99
    v_max3_f32 v48, v48, v100, v101
    v_max3_f32 v48, v48, v102, v103
    v_max3_f32 v49, v49, v104, v105
    v_max3_f32 v49, v49, v106, v107
    v_max3_f32 v49, v49, v108, v109
    v_max3_f32 v49, v49, v110, v111
    v_max3_f32 v50, v50, v112, v113
    v_max3_f32 v50, v50, v114, v115
    v_max3_f32 v50, v50, v116, v117
    v_max3_f32 v50, v50, v118, v119
    v_max3_f32 v51, v51, v120, v121
    v_max3_f32 v51, v51, v122, v123
    v_max3_f32 v51, v51, v124, v125
    v_max3_f32 v51, v51, v126, v127
    s_add_u32 s100, s101, 16384
    buffer_load_dwordx4 a[128:131], v1, s[8:11], s100 offen offset:0
    buffer_load_dwordx4 a[132:135], v1, s[8:11], s100 offen offset:1024
    buffer_load_dwordx4 a[136:139], v1, s[8:11], s100 offen offset:2048
    buffer_load_dwordx4 a[140:143], v1, s[8:11], s100 offen offset:3072
    buffer_load_dwordx4 a[144:147], v15, s[8:11], s100 offen offset:0
    buffer_load_dwordx4 a[148:151], v15, s[8:11], s100 offen offset:1024
    buffer_load_dwordx4 a[152:155], v15, s[8:11], s100 offen offset:2048
    buffer_load_dwordx4 a[156:159], v15, s[8:11], s100 offen offset:3072
    v_add_f32 v80, 0, v22
    v_min_f32 v80, v80, v72
    v_add_f32 v81, 0xf1800000, v22
    v_min_f32 v81, v81, v73
    v_add_f32 v82, 0xf2000000, v22
    v_min_f32 v82, v82, v74
    v_add_f32 v83, 0xf2400000, v22
    v_min_f32 v83, v83, v75
    v_add_f32 v84, 0xf3800000, v22
    v_min_f32 v84, v84, v72
    v_add_f32 v85, 0xf3880000, v22
    v_min_f32 v85, v85, v73
    v_add_f32 v86, 0xf3900000, v22
    v_min_f32 v86, v86, v74
    v_add_f32 v87, 0xf3980000, v22
    v_min_f32 v87, v87, v75
    v_add_f32 v88, 0x73800000, v22
    v_min_f32 v88, v88, v76
    v_add_f32 v89, 0x73700000, v22
    v_min_f32 v89, v89, v77
    v_add_f32 v90, 0x73600000, v22
    v_min_f32 v90, v90, v78
    v_add_f32 v91, 0x73500000, v22
    v_min_f32 v91, v91, v79
    v_add_f32 v92, 0, v22
    v_min_f32 v92, v92, v76
    v_add_f32 v93, 0xf1800000, v22
    v_min_f32 v93, v93, v77
    v_add_f32 v94, 0xf2000000, v22
    v_min_f32 v94, v94, v78
    v_add_f32 v95, 0xf2400000, v22
    v_min_f32 v95, v95, v79
    s_waitcnt vmcnt(7)
    v_mfma_f32_16x16x32_bf16 v[96:99], a[128:131], a[224:227], v[80:83]
    s_waitcnt vmcnt(6)
    v_mfma_f32_16x16x32_bf16 v[96:99], a[132:135], a[228:231], v[96:99]
    s_waitcnt vmcnt(5)
    v_mfma_f32_16x16x32_bf16 v[96:99], a[136:139], a[232:235], v[96:99]
    s_waitcnt vmcnt(4)
    v_mfma_f32_16x16x32_bf16 v[96:99], a[140:143], a[236:239], v[96:99]
    v_mfma_f32_16x16x32_bf16 v[104:107], a[128:131], a[240:243], v[88:91]
    v_mfma_f32_16x16x32_bf16 v[104:107], a[132:135], a[244:247], v[104:107]
    v_mfma_f32_16x16x32_bf16 v[104:107], a[136:139], a[248:251], v[104:107]
    v_mfma_f32_16x16x32_bf16 v[104:107], a[140:143], a[252:255], v[104:107]
    s_waitcnt vmcnt(3)
    v_mfma_f32_16x16x32_bf16 v[100:103], a[144:147], a[224:227], v[84:87]
    s_waitcnt vmcnt(2)
    v_mfma_f32_16x16x32_bf16 v[100:103], a[148:151], a[228:231], v[100:103]
    s_waitcnt vmcnt(1)
    v_mfma_f32_16x16x32_bf16 v[100:103], a[152:155], a[232:235], v[100:103]
    s_waitcnt vmcnt(0)
    v_mfma_f32_16x16x32_bf16 v[100:103], a[156:159], a[236:239], v[100:103]
    v_mfma_f32_16x16x32_bf16 v[108:111], a[144:147], a[240:243], v[92:95]
    v_mfma_f32_16x16x32_bf16 v[108:111], a[148:151], a[244:247], v[108:111]
    v_mfma_f32_16x16x32_bf16 v[108:111], a[152:155], a[248:251], v[108:111]
    v_mfma_f32_16x16x32_bf16 v[108:111], a[156:159], a[252:255], v[108:111]
    v_max3_f32 v50, v50, v96, v97
    v_max3_f32 v50, v50, v98, v99
    s_nop 1
    v_max3_f32 v50, v50, v100, v101
    v_max3_f32 v50, v50, v102, v103
    v_max3_f32 v51, v51, v104, v105
    v_max3_f32 v51, v51, v106, v107
    v_max3_f32 v51, v51, v108, v109
    v_max3_f32 v51, v51, v110, v111
    v_mov_b32 v52, v48
    v_mov_b32 v53, v49
    v_mov_b32 v54, v50
    v_mov_b32 v55, v51
    v_permlane16_swap_b32 v48, v52
    v_permlane16_swap_b32 v49, v53
    v_permlane16_swap_b32 v50, v54
    v_permlane16_swap_b32 v51, v55
    v_max_f32 v48, v48, v52
    v_max_f32 v49, v49, v53
    v_max_f32 v50, v50, v54
    v_max_f32 v51, v51, v55
    v_mov_b32 v52, v48
    v_mov_b32 v53, v49
    v_mov_b32 v54, v50
    v_mov_b32 v55, v51
    v_permlane32_swap_b32 v48, v52
    v_permlane32_swap_b32 v49, v53
    v_permlane32_swap_b32 v50, v54
    v_permlane32_swap_b32 v51, v55
    v_max_f32 v48, v48, v52
    v_max_f32 v49, v49, v53
    v_max_f32 v50, v50, v54
    v_max_f32 v51, v51, v55
    ds_write_b128 v16, v[48:51] offset:32768
    v_xor_b32 v8, 8192, v16
    s_waitcnt lgkmcnt(0)
    s_barrier
    ds_read_b128 v[52:55], v8 offset:32768
    s_waitcnt lgkmcnt(0)
    v_max_f32 v48, v48, v52
    v_max_f32 v49, v49, v53
    v_max_f32 v50, v50, v54
    v_max_f32 v51, v51, v55
    v_sub_f32 v64, 0, v48
    v_sub_f32 v65, 0, v48
    v_sub_f32 v66, 0, v48
    v_sub_f32 v67, 0, v48
    v_sub_f32 v68, 0, v49
    v_sub_f32 v69, 0, v49
    v_sub_f32 v70, 0, v49
    v_sub_f32 v71, 0, v49
    v_sub_f32 v72, 0, v50
    v_sub_f32 v73, 0, v50
    v_sub_f32 v74, 0, v50
    v_sub_f32 v75, 0, v50
    v_sub_f32 v76, 0, v51
    v_sub_f32 v77, 0, v51
    v_sub_f32 v78, 0, v51
    v_sub_f32 v79, 0, v51
    s_add_u32 s12, s13, 1
    s_and_b32 s100, s12, 1
    s_mul_i32 s15, s100, 196608
    s_xor_b32 s15, s15, 65536
    s_mul_i32 s16, s100, 98304
    s_xor_b32 s16, s16, 98304
    v_and_b32 v18, 0x7fff, v18
    v_or_b32 v18, s15, v18
    v_and_b32 v19, 0x7fff, v19
    v_or_b32 v19, s16, v19
    v_and_b32 v20, 0x7fff, v20
    v_or_b32 v20, s16, v20
    s_add_u32 s15, s15, s62
    s_add_u32 s16, s16, s62
    s_add_u32 s12, s12, 2
    s_mov_b32 s82, s81
    s_add_u32 s19, s82, 32768
    s_add_u32 m0, s15, 0
    s_nop 0
    buffer_load_dwordx4 v1, s[8:11], s82 offen offset:0  lds
    buffer_load_dwordx4 v1, s[8:11], s82 offen offset:1024  lds
    buffer_load_dwordx4 v1, s[8:11], s82 offen offset:2048  lds
    buffer_load_dwordx4 v1, s[8:11], s82 offen offset:3072  lds
    s_add_u32 m0, s15, 4096
    s_nop 0
    buffer_load_dwordx4 v15, s[8:11], s82 offen offset:0  lds
    buffer_load_dwordx4 v15, s[8:11], s82 offen offset:1024  lds
    buffer_load_dwordx4 v15, s[8:11], s82 offen offset:2048  lds
    buffer_load_dwordx4 v15, s[8:11], s82 offen offset:3072  lds
    s_xor_b32 s15, s15, 196608
    s_add_u32 m0, s16, 0
    s_nop 0
    buffer_load_dwordx4 v1, s[8:11], s19 offen offset:0  lds
    buffer_load_dwordx4 v1, s[8:11], s19 offen offset:1024  lds
    buffer_load_dwordx4 v1, s[8:11], s19 offen offset:2048  lds
    buffer_load_dwordx4 v1, s[8:11], s19 offen offset:3072  lds
    s_add_u32 m0, s16, 4096
    s_nop 0
    buffer_load_dwordx4 v15, s[8:11], s19 offen offset:0  lds
    buffer_load_dwordx4 v15, s[8:11], s19 offen offset:1024  lds
    buffer_load_dwordx4 v15, s[8:11], s19 offen offset:2048  lds
    buffer_load_dwordx4 v15, s[8:11], s19 offen offset:3072  lds
    s_xor_b32 s16, s16, 98304
    s_cmp_eq_u32 s61, 0
    s_cselect_b32 s82, 0, 1
    s_lshl_b32 s82, s82, 16
    s_add_u32 s82, s82, s81
    s_add_u32 m0, s15, 0
    s_nop 0
    buffer_load_dwordx4 v1, s[8:11], s82 offen offset:0  lds
    buffer_load_dwordx4 v1, s[8:11], s82 offen offset:1024  lds
    buffer_load_dwordx4 v1, s[8:11], s82 offen offset:2048  lds
    buffer_load_dwordx4 v1, s[8:11], s82 offen offset:3072  lds
    s_add_u32 m0, s15, 4096
    s_nop 0
    buffer_load_dwordx4 v15, s[8:11], s82 offen offset:0  lds
    buffer_load_dwordx4 v15, s[8:11], s82 offen offset:1024  lds
    buffer_load_dwordx4 v15, s[8:11], s82 offen offset:2048  lds
    buffer_load_dwordx4 v15, s[8:11], s82 offen offset:3072  lds
    s_xor_b32 s15, s15, 196608
    s_waitcnt vmcnt(0) lgkmcnt(0)
    s_barrier
    ds_read_b128 a[128:131], v18 offset:0
    ds_read_b128 a[132:135], v18 offset:1024
    ds_read_b128 a[136:139], v18 offset:2048
    ds_read_b128 a[140:143], v18 offset:3072
    ds_read_b128 a[144:147], v18 offset:4096
    ds_read_b128 a[148:151], v18 offset:5120
    ds_read_b128 a[152:155], v18 offset:6144
    ds_read_b128 a[156:159], v18 offset:7168
    s_waitcnt lgkmcnt(0)
    s_branch L_t2_start
L_C2_slow_13:
    s_mov_b32 s99, 0
L_C2_slow_13_l:
    s_sleep 4
    buffer_load_dword v3, v4, s[8:11], s23 offen sc0 sc1
    s_add_u32 s99, s99, 1
    s_waitcnt vmcnt(0)
    v_cmp_ne_u32 vcc, 0, v3
    s_cmp_eq_u64 vcc, -1
    s_cbranch_scc1 L_C2_ok_14
    s_cmp_lt_u32 s99, 200000
    s_cbranch_scc1 L_C2_slow_13_l
    s_branch L_C2_ok_14
L_P1_slow_15:
    s_mov_b32 s14, 0xf000f000
    s_mov_b32 s15, 0xf000f000
    s_mov_b32 s99, 0
L_P2_l_5321:
    s_waitcnt vmcnt(0)
    v_max_u32 v48, v128, v129
    v_max3_u32 v48, v48, v130, v131
    v_max_u32 v49, v132, v133
    v_max3_u32 v49, v49, v134, v135
    v_max_u32 v50, v136, v137
    v_max3_u32 v50, v50, v138, v139
    v_max_u32 v51, v140, v141
    v_max3_u32 v51, v51, v142, v143
    v_max_u32 v52, v144, v145
    v_max3_u32 v52, v52, v146, v147
    v_max_u32 v53, v148, v149
    v_max3_u32 v53, v53, v150, v151
    v_max_u32 v54, v152, v153
    v_max3_u32 v54, v54, v154, v155
    v_max_u32 v55, v156, v157
    v_max3_u32 v55, v55, v158, v159
    v_max3_u32 v3, v48, v49, v50
    v_max3_u32 v3, v3, v51, v52
    v_max3_u32 v3, v3, v53, v54
    v_max_u32 v3, v3, v55
    v_cmp_eq_u32 vcc, -1, v3
    s_add_u32 s99, s99, 1
    s_cbranch_vccz L_P2_ok_5322
    s_cmp_ge_u32 s99, 200000
    s_cbranch_scc1 L_P2_ok_5322
    s_sleep 1
    v_cmp_eq_u32 vcc, -1, v48
    s_cbranch_vccz L_P2_s_5323
    s_and_b64 s[96:97], vcc, s[14:15]
    s_cselect_b64 exec, s[96:97], vcc
    s_add_u32 s74, s70, 0
    buffer_load_dwordx4 v[128:131], v44, s[8:11], s74 offen sc0 sc1
    s_mov_b64 exec, -1
L_P2_s_5323:
    v_cmp_eq_u32 vcc, -1, v49
    s_cbranch_vccz L_P2_s_5324
    s_and_b64 s[96:97], vcc, s[14:15]
    s_cselect_b64 exec, s[96:97], vcc
    s_add_u32 s74, s70, 4096
    buffer_load_dwordx4 v[132:135], v44, s[8:11], s74 offen sc0 sc1
    s_mov_b64 exec, -1
L_P2_s_5324:
    v_cmp_eq_u32 vcc, -1, v50
    s_cbranch_vccz L_P2_s_5325
    s_and_b64 s[96:97], vcc, s[14:15]
    s_cselect_b64 exec, s[96:97], vcc
    s_add_u32 s74, s70, 8192
    buffer_load_dwordx4 v[136:139], v44, s[8:11], s74 offen sc0 sc1
    s_mov_b64 exec, -1
L_P2_s_5325:
    v_cmp_eq_u32 vcc, -1, v51
    s_cbranch_vccz L_P2_s_5326
    s_and_b64 s[96:97], vcc, s[14:15]
    s_cselect_b64 exec, s[96:97], vcc
    s_add_u32 s74, s70, 12288
    buffer_load_dwordx4 v[140:143], v44, s[8:11], s74 offen sc0 sc1
    s_mov_b64 exec, -1
L_P2_s_5326:
    v_cmp_eq_u32 vcc, -1, v52
    s_cbranch_vccz L_P2_s_5327
    s_and_b64 s[96:97], vcc, s[14:15]
    s_cselect_b64 exec, s[96:97], vcc
    s_add_u32 s74, s70, 16384
    buffer_load_dwordx4 v[144:147], v44, s[8:11], s74 offen sc0 sc1
    s_mov_b64 exec, -1
L_P2_s_5327:
    v_cmp_eq_u32 vcc, -1, v53
    s_cbranch_vccz L_P2_s_5328
    s_and_b64 s[96:97], vcc, s[14:15]
    s_cselect_b64 exec, s[96:97], vcc
    s_add_u32 s74, s70, 20480
    buffer_load_dwordx4 v[148:151], v44, s[8:11], s74 offen sc0 sc1
    s_mov_b64 exec, -1
L_P2_s_5328:
    v_cmp_eq_u32 vcc, -1, v54
    s_cbranch_vccz L_P2_s_5329
    s_and_b64 s[96:97], vcc, s[14:15]
    s_cselect_b64 exec, s[96:97], vcc
    s_add_u32 s74, s70, 24576
    buffer_load_dwordx4 v[152:155], v44, s[8:11], s74 offen sc0 sc1
    s_mov_b64 exec, -1
L_P2_s_5329:
    v_cmp_eq_u32 vcc, -1, v55
    s_cbranch_vccz L_P2_s_5330
    s_and_b64 s[96:97], vcc, s[14:15]
    s_cselect_b64 exec, s[96:97], vcc
    s_add_u32 s74, s70, 28672
    buffer_load_dwordx4 v[156:159], v44, s[8:11], s74 offen sc0 sc1
    s_mov_b64 exec, -1
L_P2_s_5330:
    s_branch L_P2_l_5321
L_P2_ok_5322:
    s_branch L_P1_ok_16
L_code_end:
    s_endpgm
.section .rodata,"a"
.p2align 6
.amdhsa_kernel adaLN_cond__compressed_kv_cla__moe_arch_mod__prompt_kernel
  .amdhsa_next_free_vgpr 512
  .amdhsa_next_free_sgpr 102
  .amdhsa_accum_offset 256
  .amdhsa_group_segment_fixed_size 0
  .amdhsa_kernarg_size 128
  .amdhsa_user_sgpr_count 2
  .amdhsa_user_sgpr_kernarg_segment_ptr 1
  .amdhsa_system_sgpr_workgroup_id_x 1
.end_amdhsa_kernel
```

```asm
; @launch grid=(256,1,1) block=(256,1,1) lds=163840
.amdgcn_target "amdgcn-amd-amdhsa--gfx950"
.text
.globl adaLN_cond__compressed_kv_cla__moe_arch_mod__prompt_kernel
.p2align 8
.type adaLN_cond__compressed_kv_cla__moe_arch_mod__prompt_kernel,@function
adaLN_cond__compressed_kv_cla__moe_arch_mod__prompt_kernel:
    s_cmp_ge_u32 s2, 256
    s_cbranch_scc1 L_end
    s_load_dwordx16 s[64:79], s[0:1], 0
    s_load_dwordx16 s[80:95], s[0:1], 64
    s_getpc_b64 s[100:101]
L_pf1:
    v_lshrrev_b32 v3, 6, v0
    v_and_b32 v2, 63, v0
    s_lshr_b32 s5, s2, 3
    s_mul_i32 s98, s5, 24
    v_min_u32 v5, 5, v2
    v_mad_u32_u24 v5, v3, 6, v5
    v_add_u32 v5, s98, v5
    v_lshlrev_b32 v5, 7, v5
    v_min_u32 v5, L_code_end-L_pf1, v5
    global_load_dword a255, v5, s[100:101]
    v_readfirstlane_b32 s3, v3
    v_lshlrev_b32 v1, 4, v2
    s_and_b32 s4, s2, 7
    s_and_b32 s5, s5, 3
    s_lshr_b32 s6, s2, 5
    s_lshl_b32 s7, s4, 2
    s_add_u32 s7, s7, s5
    s_mov_b32 s60, s6
    s_sub_u32 s61, 15, s6
    v_lshrrev_b32 v3, 3, v2
    v_lshrrev_b32 v4, 4, v2
    v_and_b32 v5, 7, v2
    v_xor_b32 v5, v5, v4
    v_lshlrev_b32 v5, 4, v5
    v_lshl_add_u32 v16, v3, 10, v5
    v_xor_b32 v17, 64, v16
    v_add_u32 v17, 7168, v17
    v_add_u32 v18, 14336, v16
    v_add_u32 v19, 14336, v17
    v_bfe_u32 v5, v2, 1, 3
    v_xor_b32 v5, v5, v4
    v_lshlrev_b32 v5, 5, v5
    v_and_b32 v6, 1, v2
    v_lshl_add_u32 v5, v6, 4, v5
    v_lshl_add_u32 v20, v4, 13, v5
    v_add_u32 v21, 31744, v20
    v_xor_b32 v22, 128, v20
    v_add_u32 v22, 63488, v22
    v_add_u32 v23, 31744, v22
    s_lshl_b32 s62, s3, 13
    s_lshl_b32 s63, s3, 12
    s_lshl_b32 s96, s6, 18
    s_lshl_b32 s98, s3, 16
    s_add_u32 s96, s96, s98
    s_lshl_b32 s97, s3, 17
    s_lshl_b32 s99, s5, 0
    s_xor_b32 s99, s99, s6
    s_lshl_b32 s99, s99, 3
    s_and_b32 s99, s99, 7
    s_lshl_b32 s98, s99, 7
    s_add_u32 s96, s96, s98
    s_lshl_b32 s98, s99, 19
    s_add_u32 s97, s97, s98
    v_and_b32 v84, 7, v2
    v_lshrrev_b32 v65, 3, v0
    v_mul_u32_u24 v64, 24576, v65
    v_lshl_add_u32 v64, v84, 4, v64
    v_lshlrev_b32 v65, 3, v65
    v_lshrrev_b32 v85, 3, v2
    v_lshlrev_b32 v86, 10, v84
    v_lshl_add_u32 v86, v85, 4, v86
    s_lshl_b32 s100, s7, 8
    s_waitcnt lgkmcnt(0)
    s_add_u32 s16, s70, s100
    s_addc_u32 s17, s71, 0
    s_sub_u32 s18, 4194304, s100
    s_mov_b32 s19, 0x00020000
    s_mov_b32 s12, s66
    s_mov_b32 s13, s67
    s_mov_b32 s14, 2097152
    s_mov_b32 s15, 0x00020000
    s_add_u32 m0, s63, 98304
    s_xor_b32 s98, s97, 0
    buffer_load_dwordx4 v20, s[16:19], s98 offen offset:0   lds
    buffer_load_dwordx4 v21, s[16:19], s98 offen offset:1024   lds
    buffer_load_dwordx4 v22, s[16:19], s98 offen offset:2048   lds
    buffer_load_dwordx4 v23, s[16:19], s98 offen offset:3072   lds
    s_add_u32 m0, s62, 0
    s_xor_b32 s98, s96, 0
    buffer_load_dwordx4 v16, s[12:15], s98 offen offset:0   lds
    buffer_load_dwordx4 v17, s[12:15], s98 offen offset:1024   lds
    buffer_load_dwordx4 v18, s[12:15], s98 offen offset:2048   lds
    buffer_load_dwordx4 v19, s[12:15], s98 offen offset:3072   lds
    s_add_u32 m0, s62, 4096
    s_xor_b32 s98, s96, 32768
    buffer_load_dwordx4 v16, s[12:15], s98 offen offset:0   lds
    buffer_load_dwordx4 v17, s[12:15], s98 offen offset:1024   lds
    buffer_load_dwordx4 v18, s[12:15], s98 offen offset:2048   lds
    buffer_load_dwordx4 v19, s[12:15], s98 offen offset:3072   lds
    s_mov_b32 s40, s88
    s_mov_b32 s41, s89
    s_mov_b32 s42, 3145728
    s_mov_b32 s43, 0x00020000
    s_mov_b32 s44, s86
    s_mov_b32 s45, s87
    s_mov_b32 s46, 1024
    s_mov_b32 s47, 0x00020000
    s_mov_b32 s32, s64
    s_mov_b32 s33, s65
    s_mov_b32 s34, 2097152
    s_mov_b32 s35, 0x00020000
    s_mov_b32 s8, s94
    s_mov_b32 s9, s95
    s_mov_b32 s10, 268435456
    s_mov_b32 s11, 0x00020000
    s_add_u32 s20, s72, s100
    s_addc_u32 s21, s73, 0
    s_sub_u32 s22, 4194304, s100
    s_mov_b32 s23, 0x00020000
    s_add_u32 s24, s68, s100
    s_addc_u32 s25, s69, 0
    s_sub_u32 s26, 4194304, s100
    s_mov_b32 s27, 0x00020000
    s_mov_b32 s36, s92
    s_mov_b32 s37, s93
    s_mov_b32 s38, 256
    s_mov_b32 s39, 0x00020000
    s_lshl_b32 s100, s4, 19
    s_lshl_b32 s99, s5, 8
    s_add_u32 s100, s100, s99
    s_add_u32 s28, s74, s100
    s_addc_u32 s29, s75, 0
    s_sub_u32 s30, 4194304, s100
    s_mov_b32 s31, 0x00020000
    s_mov_b32 s48, s84
    s_mov_b32 s49, s85
    s_mov_b32 s50, 1835008
    s_mov_b32 s51, 0x00020000
    s_mov_b32 s52, s90
    s_mov_b32 s53, s91
    s_mov_b32 s54, 2097152
    s_mov_b32 s55, 0x00020000
    s_mov_b64 s[92:93], s[80:81]
    s_mov_b64 s[94:95], s[82:83]
    s_mov_b32 s56, s78
    s_mov_b32 s57, s79
    s_mov_b32 s58, 1024
    s_mov_b32 s59, 0x00020000
    s_load_dword s90, s[36:37], 64
    s_load_dword s91, s[8:9], 0x3f00
    s_lshl_b32 s64, s3, 19
    s_and_b32 s100, s97, 3670016
    s_xor_b32 s64, s64, s100
    s_lshr_b32 s100, s6, 1
    s_and_b32 s100, s100, 0
    s_lshl_b32 s1, s100, 12
    s_lshl_b32 s100, s100, 7
    s_add_u32 s64, s64, s100
    s_lshl_b32 s100, s5, 1
    s_xor_b32 s100, s100, s6
    s_and_b32 s100, s100, 0
    s_lshl_b32 s68, s100, 11
    s_lshl_b32 s100, s100, 19
    s_lshl_b32 s0, s3, 17
    s_add_u32 s0, s0, s100
    s_mul_i32 s81, s7, 1048576
    s_add_u32 s81, s81, 16777216
    s_mul_i32 s100, s6, 131072
    s_add_u32 s65, s81, s100
    s_lshr_b32 s100, s3, 1
    s_mul_i32 s100, s100, 65536
    s_add_u32 s65, s65, s100
    s_and_b32 s100, s3, 1
    s_lshl_b32 s100, s100, 14
    s_add_u32 s65, s65, s100
    s_add_u32 s81, s81, s62
    s_cmp_eq_u32 s60, 0
    s_cselect_b32 s82, 0, 1
    s_mul_i32 s82, s82, 65536
    s_add_u32 s82, s82, s81
    s_sub_u32 s100, s6, 2
    s_lshl_b32 s69, s100, 7
    s_lshl_b32 s100, s100, 3
    s_add_u32 s100, s100, s4
    s_lshl_b32 s100, s100, 8
    s_mul_i32 s101, s5, 12288
    s_add_u32 s100, s100, s101
    s_add_u32 s100, s100, 16384
    s_cmp_ge_u32 s6, 2
    s_cselect_b32 s66, s100, 2147479552
    s_cselect_b32 s69, s69, 2147479552
    s_cmp_eq_u32 s3, 0
    s_cselect_b32 s66, s66, 2147479552
    s_lshl_b32 s70, s3, 9
    s_add_u32 s70, s70, 16384
    s_lshr_b32 s71, s2, 1
    s_lshl_b32 s71, s71, 14
    s_and_b32 s100, s2, 1
    s_lshl_b32 s100, s100, 7
    s_add_u32 s71, s71, s100
    s_add_u32 s71, s71, s63
    s_add_u32 s71, s71, 2097152
    s_lshl_b32 s72, s2, 2
    s_add_u32 s72, s72, s3
    s_lshl_b32 s72, s72, 6
    s_add_u32 s72, s72, 1048576
    s_lshl_b32 s74, s7, 11
    s_add_u32 s74, s74, 1114112
    s_lshl_b32 s73, s6, 2
    s_add_u32 s73, s73, s3
    s_lshl_b32 s73, s73, 6
    s_add_u32 s73, s73, s74
    s_lshr_b32 s100, s3, 1
    s_sub_u32 s101, 3, s100
    s_and_b32 s98, s3, 1
    s_cselect_b32 s100, s101, s100
    s_lshl_b32 s75, s60, 2
    s_add_u32 s75, s75, s100
    s_lshl_b32 s76, s61, 2
    s_add_u32 s76, s76, s100
    s_sub_u32 s77, s76, s75
    s_lshl_b32 s77, s77, 10
    s_lshl_b32 s78, s75, 10
    s_add_u32 s78, s78, 983040
    s_lshl_b32 s75, s75, 15
    s_add_u32 s75, s75, 2097152
    s_add_u32 s75, s75, s68
    s_lshl_b32 s76, s76, 15
    s_add_u32 s76, s76, 2097152
    s_add_u32 s76, s76, s68
    s_add_u32 s1, s1, s65
    s_cmp_eq_u32 s3, 0
    s_cselect_b32 s68, 32, 0
    s_cselect_b32 s67, 0, 2147479552
    v_and_b32 v48, 15, v2
    v_lshrrev_b32 v49, 4, v2
    v_lshrrev_b32 v50, 1, v48
    v_xor_b32 v50, v50, v49
    v_lshlrev_b32 v50, 4, v50
    v_lshl_add_u32 v28, v48, 7, v50
    v_add_u32 v28, s62, v28
    v_xor_b32 v29, 64, v28
    v_add_u32 v30, 65536, v28
    v_add_u32 v31, 65536, v29
    v_lshrrev_b32 v50, 2, v48
    v_and_b32 v51, 3, v48
    v_lshl_add_u32 v52, v49, 3, v50
    v_lshlrev_b32 v53, 8, v52
    v_lshl_add_u32 v53, v51, 3, v53
    v_add_u32 v53, 98304, v53
    v_and_b32 v54, 1, v49
    v_lshl_add_u32 v54, v54, 2, v50
    v_xor_b32 v55, 0, v54
    v_lshl_add_u32 v8, v55, 5, v53
    v_xor_b32 v55, 1, v54
    v_lshl_add_u32 v9, v55, 5, v53
    v_xor_b32 v55, 2, v54
    v_lshl_add_u32 v10, v55, 5, v53
    v_xor_b32 v55, 3, v54
    v_lshl_add_u32 v11, v55, 5, v53
    v_xor_b32 v55, 4, v54
    v_lshl_add_u32 v12, v55, 5, v53
    v_xor_b32 v55, 5, v54
    v_lshl_add_u32 v13, v55, 5, v53
    v_xor_b32 v55, 6, v54
    v_lshl_add_u32 v14, v55, 5, v53
    v_xor_b32 v55, 7, v54
    v_lshl_add_u32 v15, v55, 5, v53
    v_bfe_u32 v49, v2, 1, 2
    v_bfe_u32 v50, v2, 4, 1
    v_xor_b32 v49, v49, v50
    v_lshlrev_b32 v49, 5, v49
    v_and_b32 v50, 1, v2
    v_lshl_add_u32 v49, v50, 4, v49
    v_lshl_add_u32 v24, v85, 13, v49
    v_xor_b32 v25, 64, v24
    v_add_u32 v25, 64512, v25
    v_add_u32 v26, 129024, v24
    v_add_u32 v27, 129024, v25
    v_cmp_eq_u32 vcc, 0, v2
    v_mov_b32 v6, 2147479552
    s_nop 0
    v_cndmask_b32 v5, v6, v2, vcc
    v_cmp_eq_u32 vcc, 0, v0
    s_nop 1
    v_cndmask_b32 v7, v6, v0, vcc
    v_and_b32 v48, 8, v2
    v_cmp_eq_u32 vcc, 0, v48
    v_lshlrev_b32 v48, 5, v84
    v_lshrrev_b32 v49, 1, v2
    v_and_b32 v49, 24, v49
    v_add_u32 v48, v48, v49
    s_lshl_b32 s100, s3, 8
    s_add_u32 s100, s100, 147456
    v_add_u32 v48, s100, v48
    v_mov_b32 v49, 148480
    v_cndmask_b32 v98, v49, v48, vcc
    v_lshlrev_b32 v99, 5, v84
    v_add_u32 v99, 149504, v99
    s_lshl_b32 s100, s3, 3
    v_add_u32 v100, s100, v99
    v_lshlrev_b32 v106, 5, v85
    v_lshlrev_b32 v107, 8, v85
    v_lshl_add_u32 v107, v84, 4, v107
    s_sub_u32 s100, s2, 64
    s_lshl_b32 s80, s100, 12
    s_add_u32 s80, s80, 1048576
    s_cmp_lt_u32 s100, 64
    s_cselect_b32 s80, s80, 2147479552
    s_mul_i32 s99, s5, 786432
    s_sub_u32 s79, s6, 2
    s_lshl_b32 s79, s79, 3
    s_add_u32 s79, s79, s4
    s_lshl_b32 s79, s79, 7
    s_add_u32 s79, s79, s99
    s_cmp_ge_u32 s6, 2
    s_cselect_b32 s79, s79, 2147414016
    s_lshl_b32 s100, s5, 8
    v_add_u32 v65, s100, v65
    v_mov_b32 v6, 1
    v_and_b32 v4, 1, v2
    v_lshlrev_b32 v4, 7, v4
    buffer_load_dwordx2 v[66:67], v65, s[44:47], 0 offen
    buffer_load_dwordx4 v[68:71], v64, s[40:43], s79 offen
    s_add_u32 s79, s79, 6144
    buffer_load_dwordx4 v[72:75], v64, s[40:43], s79 offen
    s_add_u32 s79, s79, 6144
    buffer_load_dwordx4 v[76:79], v64, s[40:43], s79 offen
    s_add_u32 s79, s79, 6144
    buffer_load_dwordx4 v[80:83], v64, s[40:43], s79 offen
    s_lshl_b32 s79, s2, 5
    s_add_u32 s79, s79, s3
    s_lshl_b32 s79, s79, 8
    buffer_load_dwordx4 v[88:91], v86, s[32:35], s79 offen
    buffer_load_dwordx4 v[92:95], v86, s[32:35], s79 offen offset:128
    s_add_u32 m0, s63, 114688
    s_xor_b32 s98, s97, 524288
    buffer_load_dwordx4 v20, s[16:19], s98 offen offset:0   lds
    buffer_load_dwordx4 v21, s[16:19], s98 offen offset:1024   lds
    buffer_load_dwordx4 v22, s[16:19], s98 offen offset:2048   lds
    buffer_load_dwordx4 v23, s[16:19], s98 offen offset:3072   lds
    s_add_u32 m0, s62, 32768
    s_xor_b32 s98, s96, 128
    buffer_load_dwordx4 v16, s[12:15], s98 offen offset:0   lds
    buffer_load_dwordx4 v17, s[12:15], s98 offen offset:1024   lds
    buffer_load_dwordx4 v18, s[12:15], s98 offen offset:2048   lds
    buffer_load_dwordx4 v19, s[12:15], s98 offen offset:3072   lds
    s_add_u32 m0, s62, 36864
    s_xor_b32 s98, s96, 32896
    buffer_load_dwordx4 v16, s[12:15], s98 offen offset:0   lds
    buffer_load_dwordx4 v17, s[12:15], s98 offen offset:1024   lds
    buffer_load_dwordx4 v18, s[12:15], s98 offen offset:2048   lds
    buffer_load_dwordx4 v19, s[12:15], s98 offen offset:3072   lds
    s_waitcnt vmcnt(19) lgkmcnt(0)
    s_barrier
    ds_read_b64_tr_b16 v[32:33], v8 offset:0
    ds_read_b64_tr_b16 v[34:35], v8 offset:1024
    ds_read_b128 a[0:3], v28 offset:0
    ds_read_b128 a[4:7], v28 offset:2048
    ds_read_b128 a[8:11], v28 offset:4096
    ds_read_b128 a[12:15], v28 offset:6144
    ds_read_b64_tr_b16 v[36:37], v9 offset:0
    ds_read_b64_tr_b16 v[38:39], v9 offset:1024
    ds_read_b64_tr_b16 v[40:41], v10 offset:0
    ds_read_b64_tr_b16 v[42:43], v10 offset:1024
    ds_read_b64_tr_b16 v[44:45], v11 offset:0
    ds_read_b64_tr_b16 v[46:47], v11 offset:1024
    ds_read_b64_tr_b16 v[48:49], v12 offset:0
    ds_read_b64_tr_b16 v[50:51], v12 offset:1024
    ds_read_b64_tr_b16 v[52:53], v13 offset:0
    ds_read_b64_tr_b16 v[54:55], v13 offset:1024
    ds_read_b64_tr_b16 v[56:57], v14 offset:0
    ds_read_b64_tr_b16 v[58:59], v14 offset:1024
    ds_read_b64_tr_b16 v[60:61], v15 offset:0
    ds_read_b64_tr_b16 v[62:63], v15 offset:1024
    s_waitcnt lgkmcnt(15)
    v_mfma_f32_16x16x32_bf16 v[128:131], v[32:35], a[0:3], 0
    v_mfma_f32_16x16x32_bf16 v[160:163], v[32:35], a[4:7], 0
    v_mfma_f32_16x16x32_bf16 v[192:195], v[32:35], a[8:11], 0
    s_waitcnt lgkmcnt(14)
    s_add_u32 m0, s63, 131072
    s_xor_b32 s98, s97, 1048576
    ds_read_b128 a[16:19], v29 offset:0
    v_mfma_f32_16x16x32_bf16 v[224:227], v[32:35], a[12:15], 0
    s_waitcnt lgkmcnt(13)
    ds_read_b128 a[20:23], v29 offset:2048
    v_mfma_f32_16x16x32_bf16 v[132:135], v[36:39], a[0:3], 0
    ds_read_b64_tr_b16 v[32:33], v8 offset:8192
    v_mfma_f32_16x16x32_bf16 v[164:167], v[36:39], a[4:7], 0
    ds_read_b64_tr_b16 v[34:35], v8 offset:9216
    v_mfma_f32_16x16x32_bf16 v[196:199], v[36:39], a[8:11], 0
    ds_read_b128 a[24:27], v29 offset:4096
    v_mfma_f32_16x16x32_bf16 v[228:231], v[36:39], a[12:15], 0
    s_waitcnt lgkmcnt(15)
    ds_read_b128 a[28:31], v29 offset:6144
    v_mfma_f32_16x16x32_bf16 v[136:139], v[40:43], a[0:3], 0
    ds_read_b64_tr_b16 v[36:37], v9 offset:8192
    v_mfma_f32_16x16x32_bf16 v[168:171], v[40:43], a[4:7], 0
    s_waitcnt lgkmcnt(7)
    ds_read_b64_tr_b16 v[38:39], v9 offset:9216
    v_mfma_f32_16x16x32_bf16 v[200:203], v[40:43], a[8:11], 0
    buffer_load_dwordx4 v20, s[16:19], s98 offen offset:0   lds
    v_mfma_f32_16x16x32_bf16 v[232:235], v[40:43], a[12:15], 0
    buffer_load_dwordx4 v21, s[16:19], s98 offen offset:1024   lds
    v_mfma_f32_16x16x32_bf16 v[140:143], v[44:47], a[0:3], 0
    ds_read_b64_tr_b16 v[40:41], v10 offset:8192
    v_mfma_f32_16x16x32_bf16 v[172:175], v[44:47], a[4:7], 0
    ds_read_b64_tr_b16 v[42:43], v10 offset:9216
    v_mfma_f32_16x16x32_bf16 v[204:207], v[44:47], a[8:11], 0
    buffer_load_dwordx4 v22, s[16:19], s98 offen offset:2048   lds
    v_mfma_f32_16x16x32_bf16 v[236:239], v[44:47], a[12:15], 0
    buffer_load_dwordx4 v23, s[16:19], s98 offen offset:3072   lds
    v_mfma_f32_16x16x32_bf16 v[144:147], v[48:51], a[0:3], 0
    s_add_u32 m0, s62, 65536
    s_xor_b32 s98, s96, 256
    ds_read_b64_tr_b16 v[44:45], v11 offset:8192
    v_mfma_f32_16x16x32_bf16 v[176:179], v[48:51], a[4:7], 0
    ds_read_b64_tr_b16 v[46:47], v11 offset:9216
    v_mfma_f32_16x16x32_bf16 v[208:211], v[48:51], a[8:11], 0
    buffer_load_dwordx4 v16, s[12:15], s98 offen offset:0   lds
    v_mfma_f32_16x16x32_bf16 v[240:243], v[48:51], a[12:15], 0
    buffer_load_dwordx4 v17, s[12:15], s98 offen offset:1024   lds
    v_mfma_f32_16x16x32_bf16 v[148:151], v[52:55], a[0:3], 0
    ds_read_b64_tr_b16 v[48:49], v12 offset:8192
    v_mfma_f32_16x16x32_bf16 v[180:183], v[52:55], a[4:7], 0
    ds_read_b64_tr_b16 v[50:51], v12 offset:9216
    v_mfma_f32_16x16x32_bf16 v[212:215], v[52:55], a[8:11], 0
    buffer_load_dwordx4 v18, s[12:15], s98 offen offset:2048   lds
    v_mfma_f32_16x16x32_bf16 v[244:247], v[52:55], a[12:15], 0
    buffer_load_dwordx4 v19, s[12:15], s98 offen offset:3072   lds
    v_mfma_f32_16x16x32_bf16 v[152:155], v[56:59], a[0:3], 0
    s_add_u32 m0, s62, 69632
    s_xor_b32 s98, s96, 33024
    ds_read_b64_tr_b16 v[52:53], v13 offset:8192
    v_mfma_f32_16x16x32_bf16 v[184:187], v[56:59], a[4:7], 0
    ds_read_b64_tr_b16 v[54:55], v13 offset:9216
    v_mfma_f32_16x16x32_bf16 v[216:219], v[56:59], a[8:11], 0
    buffer_load_dwordx4 v16, s[12:15], s98 offen offset:0   lds
    v_mfma_f32_16x16x32_bf16 v[248:251], v[56:59], a[12:15], 0
    buffer_load_dwordx4 v17, s[12:15], s98 offen offset:1024   lds
    v_mfma_f32_16x16x32_bf16 v[156:159], v[60:63], a[0:3], 0
    ds_read_b64_tr_b16 v[56:57], v14 offset:8192
    v_mfma_f32_16x16x32_bf16 v[188:191], v[60:63], a[4:7], 0
    s_waitcnt lgkmcnt(5)
    ds_read_b64_tr_b16 v[58:59], v14 offset:9216
    v_mfma_f32_16x16x32_bf16 v[220:223], v[60:63], a[8:11], 0
    buffer_load_dwordx4 v18, s[12:15], s98 offen offset:2048   lds
    v_mfma_f32_16x16x32_bf16 v[252:255], v[60:63], a[12:15], 0
    buffer_load_dwordx4 v19, s[12:15], s98 offen offset:3072   lds
    v_mfma_f32_16x16x32_bf16 v[128:131], v[32:35], a[16:19], v[128:131]
    ds_read_b64_tr_b16 v[60:61], v15 offset:8192
    v_mfma_f32_16x16x32_bf16 v[160:163], v[32:35], a[20:23], v[160:163]
    ds_read_b64_tr_b16 v[62:63], v15 offset:9216
    v_mfma_f32_16x16x32_bf16 v[192:195], v[32:35], a[24:27], v[192:195]
    v_mfma_f32_16x16x32_bf16 v[224:227], v[32:35], a[28:31], v[224:227]
    v_mfma_f32_16x16x32_bf16 v[132:135], v[36:39], a[16:19], v[132:135]
    v_mfma_f32_16x16x32_bf16 v[164:167], v[36:39], a[20:23], v[164:167]
    v_mfma_f32_16x16x32_bf16 v[196:199], v[36:39], a[24:27], v[196:199]
    v_mfma_f32_16x16x32_bf16 v[228:231], v[36:39], a[28:31], v[228:231]
    v_mfma_f32_16x16x32_bf16 v[136:139], v[40:43], a[16:19], v[136:139]
    s_waitcnt vmcnt(12) lgkmcnt(0)
    s_barrier
    v_mfma_f32_16x16x32_bf16 v[168:171], v[40:43], a[20:23], v[168:171]
    s_add_u32 m0, s63, 98304
    s_xor_b32 s98, s97, 1572864
    ds_read_b64_tr_b16 v[32:33], v8 offset:16384
    v_lshlrev_b32 v102, 16, v66
    v_and_b32 v103, 0xffff0000, v66
    v_lshlrev_b32 v104, 16, v67
    v_mfma_f32_16x16x32_bf16 v[200:203], v[40:43], a[24:27], v[200:203]
    ds_read_b64_tr_b16 v[34:35], v8 offset:17408
    v_and_b32 v105, 0xffff0000, v67
    v_mul_f32 v108, 0xbfb8aa3b, v102
    v_mul_f32 v109, 0xbfb8aa3b, v103
    v_mfma_f32_16x16x32_bf16 v[232:235], v[40:43], a[28:31], v[232:235]
    ds_read_b64_tr_b16 v[36:37], v9 offset:16384
    v_mul_f32 v110, 0xbfb8aa3b, v104
    v_mul_f32 v111, 0xbfb8aa3b, v105
    v_mfma_f32_16x16x32_bf16 v[140:143], v[44:47], a[16:19], v[140:143]
    ds_read_b64_tr_b16 v[38:39], v9 offset:17408
    v_exp_f32 v108, v108
    v_mfma_f32_16x16x32_bf16 v[172:175], v[44:47], a[20:23], v[172:175]
    ds_read_b64_tr_b16 v[40:41], v10 offset:16384
    v_exp_f32 v109, v109
    v_mfma_f32_16x16x32_bf16 v[204:207], v[44:47], a[24:27], v[204:207]
    ds_read_b64_tr_b16 v[42:43], v10 offset:17408
    v_exp_f32 v110, v110
    v_mfma_f32_16x16x32_bf16 v[236:239], v[44:47], a[28:31], v[236:239]
    ds_read_b128 a[32:35], v28 offset:32768
    v_exp_f32 v111, v111
    v_add_f32 v108, 1.0, v108
    v_mfma_f32_16x16x32_bf16 v[144:147], v[48:51], a[16:19], v[144:147]
    ds_read_b64_tr_b16 v[44:45], v11 offset:16384
    v_add_f32 v109, 1.0, v109
    v_add_f32 v110, 1.0, v110
    v_add_f32 v111, 1.0, v111
    v_mfma_f32_16x16x32_bf16 v[176:179], v[48:51], a[20:23], v[176:179]
    ds_read_b64_tr_b16 v[46:47], v11 offset:17408
    v_rcp_f32 v108, v108
    v_mfma_f32_16x16x32_bf16 v[208:211], v[48:51], a[24:27], v[208:211]
    ds_read_b128 a[36:39], v28 offset:34816
    v_mov_b32 v112, 0
    v_rcp_f32 v109, v109
    v_mfma_f32_16x16x32_bf16 v[240:243], v[48:51], a[28:31], v[240:243]
    ds_read_b128 a[40:43], v28 offset:36864
    v_mov_b32 v113, 0
    v_rcp_f32 v110, v110
    v_mfma_f32_16x16x32_bf16 v[148:151], v[52:55], a[16:19], v[148:151]
    ds_read_b64_tr_b16 v[48:49], v12 offset:16384
    v_mov_b32 v114, 0
    v_rcp_f32 v111, v111
    v_mfma_f32_16x16x32_bf16 v[180:183], v[52:55], a[20:23], v[180:183]
    ds_read_b64_tr_b16 v[50:51], v12 offset:17408
    v_mov_b32 v115, 0
    v_mul_f32 v102, v102, v108
    v_mul_f32 v103, v103, v109
    v_mfma_f32_16x16x32_bf16 v[212:215], v[52:55], a[24:27], v[212:215]
    ds_read_b128 a[44:47], v28 offset:38912
    v_lshlrev_b32 v116, 4, v0
    v_mul_f32 v104, v104, v110
    v_mul_f32 v105, v105, v111
    v_mfma_f32_16x16x32_bf16 v[244:247], v[52:55], a[28:31], v[244:247]
    buffer_load_dwordx4 v20, s[16:19], s98 offen offset:0   lds
    v_cvt_pk_bf16_f32 v108, v102, v103
    v_cvt_pk_bf16_f32 v109, v104, v105
    v_mfma_f32_16x16x32_bf16 v[152:155], v[56:59], a[16:19], v[152:155]
    ds_read_b64_tr_b16 v[52:53], v13 offset:16384
    v_lshlrev_b32 v102, 16, v108
    v_and_b32 v103, 0xffff0000, v108
    v_lshlrev_b32 v104, 16, v109
    v_mfma_f32_16x16x32_bf16 v[184:187], v[56:59], a[20:23], v[184:187]
    ds_read_b64_tr_b16 v[54:55], v13 offset:17408
    v_and_b32 v105, 0xffff0000, v109
    v_lshlrev_b32 v108, 16, v68
    v_and_b32 v109, 0xffff0000, v68
    v_mfma_f32_16x16x32_bf16 v[216:219], v[56:59], a[24:27], v[216:219]
    buffer_load_dwordx4 v21, s[16:19], s98 offen offset:1024   lds
    v_mul_f32 v120, v108, v102
    v_mul_f32 v121, v109, v102
    v_mfma_f32_16x16x32_bf16 v[248:251], v[56:59], a[28:31], v[248:251]
    buffer_store_dwordx4 v[112:115], v116, s[8:11], s80 offen sc0 sc1
    v_lshlrev_b32 v110, 16, v69
    v_and_b32 v111, 0xffff0000, v69
    v_mfma_f32_16x16x32_bf16 v[156:159], v[60:63], a[16:19], v[156:159]
    ds_read_b64_tr_b16 v[56:57], v14 offset:16384
    v_lshlrev_b32 v117, 13, v2
    v_mul_f32 v122, v110, v102
    v_mul_f32 v123, v111, v102
    v_mfma_f32_16x16x32_bf16 v[188:191], v[60:63], a[20:23], v[188:191]
    s_lshl_b32 s100, s6, 19
    s_and_b32 s101, s3, 1
    ds_read_b64_tr_b16 v[58:59], v14 offset:17408
    v_lshlrev_b32 v108, 16, v70
    v_and_b32 v109, 0xffff0000, v70
    v_mul_f32 v124, v108, v102
    v_mfma_f32_16x16x32_bf16 v[220:223], v[60:63], a[24:27], v[220:223]
    buffer_load_dwordx4 v22, s[16:19], s98 offen offset:2048   lds
    v_mul_f32 v125, v109, v102
    v_lshlrev_b32 v110, 16, v71
    v_mfma_f32_16x16x32_bf16 v[252:255], v[60:63], a[28:31], v[252:255]
    s_waitcnt lgkmcnt(5)
    s_lshl_b32 s101, s101, 7
    s_add_u32 s100, s100, s101
    v_min_u32 v116, 496, v116
    v_and_b32 v111, 0xffff0000, v71
    v_mul_f32 v126, v110, v102
    v_mul_f32 v127, v111, v102
    v_mfma_f32_16x16x32_bf16 v[128:131], v[32:35], a[32:35], v[128:131]
    s_sub_u32 s80, s80, 1048576
    s_lshr_b32 s80, s80, 3
    ds_read_b64_tr_b16 v[60:61], v15 offset:16384
    v_lshlrev_b32 v108, 16, v72
    v_and_b32 v109, 0xffff0000, v72
    v_fmac_f32 v120, v108, v103
    v_mfma_f32_16x16x32_bf16 v[160:163], v[32:35], a[36:39], v[160:163]
    s_add_u32 s80, s80, 1310720
    s_cmp_lt_u32 s80, 1343488
    s_cselect_b32 s80, s80, 2147479552
    ds_read_b64_tr_b16 v[62:63], v15 offset:17408
    v_fmac_f32 v121, v109, v103
    v_lshlrev_b32 v110, 16, v73
    v_and_b32 v111, 0xffff0000, v73
    v_mfma_f32_16x16x32_bf16 v[192:195], v[32:35], a[40:43], v[192:195]
    s_waitcnt lgkmcnt(5)
    ds_read_b128 a[48:51], v29 offset:32768
    v_fmac_f32 v122, v110, v103
    v_fmac_f32 v123, v111, v103
    v_lshlrev_b32 v108, 16, v74
    v_mfma_f32_16x16x32_bf16 v[224:227], v[32:35], a[44:47], v[224:227]
    ds_read_b128 a[52:55], v29 offset:34816
    v_and_b32 v109, 0xffff0000, v74
    v_fmac_f32 v124, v108, v103
    v_fmac_f32 v125, v109, v103
    v_mfma_f32_16x16x32_bf16 v[132:135], v[36:39], a[32:35], v[132:135]
    ds_read_b64_tr_b16 v[32:33], v8 offset:24576
    v_lshlrev_b32 v110, 16, v75
    v_and_b32 v111, 0xffff0000, v75
    v_fmac_f32 v126, v110, v103
    v_mfma_f32_16x16x32_bf16 v[164:167], v[36:39], a[36:39], v[164:167]
    ds_read_b64_tr_b16 v[34:35], v8 offset:25600
    v_fmac_f32 v127, v111, v103
    v_lshlrev_b32 v108, 16, v76
    v_and_b32 v109, 0xffff0000, v76
    v_mfma_f32_16x16x32_bf16 v[196:199], v[36:39], a[40:43], v[196:199]
    ds_read_b128 a[56:59], v29 offset:36864
    v_fmac_f32 v120, v108, v104
    v_fmac_f32 v121, v109, v104
    v_lshlrev_b32 v110, 16, v77
    v_mfma_f32_16x16x32_bf16 v[228:231], v[36:39], a[44:47], v[228:231]
    ds_read_b128 a[60:63], v29 offset:38912
    v_and_b32 v111, 0xffff0000, v77
    v_fmac_f32 v122, v110, v104
    v_fmac_f32 v123, v111, v104
    v_mfma_f32_16x16x32_bf16 v[136:139], v[40:43], a[32:35], v[136:139]
    ds_read_b64_tr_b16 v[36:37], v9 offset:24576
    v_lshlrev_b32 v108, 16, v78
    v_and_b32 v109, 0xffff0000, v78
    v_fmac_f32 v124, v108, v104
    v_mfma_f32_16x16x32_bf16 v[168:171], v[40:43], a[36:39], v[168:171]
    ds_read_b64_tr_b16 v[38:39], v9 offset:25600
    v_fmac_f32 v125, v109, v104
    v_lshlrev_b32 v110, 16, v79
    v_and_b32 v111, 0xffff0000, v79
    v_mfma_f32_16x16x32_bf16 v[200:203], v[40:43], a[40:43], v[200:203]
    buffer_load_dwordx4 v23, s[16:19], s98 offen offset:3072   lds
    v_fmac_f32 v126, v110, v104
    v_fmac_f32 v127, v111, v104
    v_mfma_f32_16x16x32_bf16 v[232:235], v[40:43], a[44:47], v[232:235]
    buffer_store_dwordx4 v[112:115], v116, s[8:11], s80 offen sc0 sc1
    v_lshlrev_b32 v108, 16, v80
    v_and_b32 v109, 0xffff0000, v80
    v_mfma_f32_16x16x32_bf16 v[140:143], v[44:47], a[32:35], v[140:143]
    s_add_u32 m0, s62, 0
    s_xor_b32 s98, s96, 384
    ds_read_b64_tr_b16 v[40:41], v10 offset:24576
    v_fmac_f32 v120, v108, v105
    v_fmac_f32 v121, v109, v105
    v_lshlrev_b32 v110, 16, v81
    v_mfma_f32_16x16x32_bf16 v[172:175], v[44:47], a[36:39], v[172:175]
    ds_read_b64_tr_b16 v[42:43], v10 offset:25600
    v_and_b32 v111, 0xffff0000, v81
    v_fmac_f32 v122, v110, v105
    v_fmac_f32 v123, v111, v105
    v_mfma_f32_16x16x32_bf16 v[204:207], v[44:47], a[40:43], v[204:207]
    buffer_load_dwordx4 v16, s[12:15], s98 offen offset:0   lds
    v_lshlrev_b32 v108, 16, v82
    v_and_b32 v109, 0xffff0000, v82
    v_mfma_f32_16x16x32_bf16 v[236:239], v[44:47], a[44:47], v[236:239]
    v_fmac_f32 v124, v108, v105
    v_fmac_f32 v125, v109, v105
    v_lshlrev_b32 v110, 16, v83
    v_and_b32 v111, 0xffff0000, v83
    v_mfma_f32_16x16x32_bf16 v[144:147], v[48:51], a[32:35], v[144:147]
    ds_read_b64_tr_b16 v[44:45], v11 offset:24576
    v_fmac_f32 v126, v110, v105
    v_fmac_f32 v127, v111, v105
    v_permlane32_swap_b32 v120, v124
    v_mfma_f32_16x16x32_bf16 v[176:179], v[48:51], a[36:39], v[176:179]
    ds_read_b64_tr_b16 v[46:47], v11 offset:25600
    v_permlane32_swap_b32 v121, v125
    v_permlane32_swap_b32 v122, v126
    v_permlane32_swap_b32 v123, v127
    v_mfma_f32_16x16x32_bf16 v[208:211], v[48:51], a[40:43], v[208:211]
    buffer_load_dwordx4 v17, s[12:15], s98 offen offset:1024   lds
    v_add_f32 v120, v120, v124
    v_add_f32 v121, v121, v125
    v_mfma_f32_16x16x32_bf16 v[240:243], v[48:51], a[44:47], v[240:243]
    s_waitcnt lgkmcnt(4)
    v_add_f32 v122, v122, v126
    v_add_f32 v123, v123, v127
    s_nop 0
    v_permlane16_swap_b32 v120, v122
    v_permlane16_swap_b32 v121, v123
    v_mfma_f32_16x16x32_bf16 v[148:151], v[52:55], a[32:35], v[148:151]
    ds_read_b64_tr_b16 v[48:49], v12 offset:24576
    v_add_f32 v120, v120, v122
    v_add_f32 v121, v121, v123
    s_nop 0
    v_add_f32_dpp v120, v120, v120 row_ror:8 row_mask:0xf bank_mask:0xf
    v_mfma_f32_16x16x32_bf16 v[180:183], v[52:55], a[36:39], v[180:183]
    ds_read_b64_tr_b16 v[50:51], v12 offset:25600
    v_add_f32_dpp v121, v121, v121 row_ror:8 row_mask:0xf bank_mask:0xf
    v_mfma_f32_16x16x32_bf16 v[212:215], v[52:55], a[40:43], v[212:215]
    buffer_load_dwordx4 v18, s[12:15], s98 offen offset:2048   lds
    ds_write_b64 v98, v[120:121]
    v_mfma_f32_16x16x32_bf16 v[244:247], v[52:55], a[44:47], v[244:247]
    v_mfma_f32_16x16x32_bf16 v[152:155], v[56:59], a[32:35], v[152:155]
    ds_read_b64_tr_b16 v[52:53], v13 offset:24576
    v_lshlrev_b32 v64, 16, v88
    v_mfma_f32_16x16x32_bf16 v[184:187], v[56:59], a[36:39], v[184:187]
    ds_read_b64_tr_b16 v[54:55], v13 offset:25600
    v_and_b32 v65, 0xffff0000, v88
    v_mfma_f32_16x16x32_bf16 v[216:219], v[56:59], a[40:43], v[216:219]
    buffer_load_dwordx4 v19, s[12:15], s98 offen offset:3072   lds
    v_mfma_f32_16x16x32_bf16 v[248:251], v[56:59], a[44:47], v[248:251]
    v_lshlrev_b32 v66, 16, v89
    v_and_b32 v67, 0xffff0000, v89
    v_mfma_f32_16x16x32_bf16 v[156:159], v[60:63], a[32:35], v[156:159]
    s_add_u32 m0, s62, 4096
    s_xor_b32 s98, s96, 33152
    ds_read_b64_tr_b16 v[56:57], v14 offset:24576
    v_mfma_f32_16x16x32_bf16 v[188:191], v[60:63], a[36:39], v[188:191]
    ds_read_b64_tr_b16 v[58:59], v14 offset:25600
    v_lshlrev_b32 v68, 16, v90
    v_mfma_f32_16x16x32_bf16 v[220:223], v[60:63], a[40:43], v[220:223]
    buffer_load_dwordx4 v16, s[12:15], s98 offen offset:0   lds
    v_mfma_f32_16x16x32_bf16 v[252:255], v[60:63], a[44:47], v[252:255]
    v_and_b32 v69, 0xffff0000, v90
    v_lshlrev_b32 v70, 16, v91
    v_mfma_f32_16x16x32_bf16 v[128:131], v[32:35], a[48:51], v[128:131]
    ds_read_b64_tr_b16 v[60:61], v15 offset:24576
    v_and_b32 v71, 0xffff0000, v91
    v_mfma_f32_16x16x32_bf16 v[160:163], v[32:35], a[52:55], v[160:163]
    ds_read_b64_tr_b16 v[62:63], v15 offset:25600
    v_lshlrev_b32 v72, 16, v92
    v_mfma_f32_16x16x32_bf16 v[192:195], v[32:35], a[56:59], v[192:195]
    buffer_load_dwordx4 v17, s[12:15], s98 offen offset:1024   lds
    v_mfma_f32_16x16x32_bf16 v[224:227], v[32:35], a[60:63], v[224:227]
    v_and_b32 v73, 0xffff0000, v92
    v_lshlrev_b32 v74, 16, v93
    v_mfma_f32_16x16x32_bf16 v[132:135], v[36:39], a[48:51], v[132:135]
    buffer_load_dwordx4 v18, s[12:15], s98 offen offset:2048   lds
    v_mfma_f32_16x16x32_bf16 v[164:167], v[36:39], a[52:55], v[164:167]
    v_and_b32 v75, 0xffff0000, v93
    v_lshlrev_b32 v76, 16, v94
    v_mfma_f32_16x16x32_bf16 v[196:199], v[36:39], a[56:59], v[196:199]
    buffer_load_dwordx4 v19, s[12:15], s98 offen offset:3072   lds
    s_cmp_eq_u32 s3, 0
    s_cselect_b32 s101, s100, 2147479552
    buffer_load_dword a241, v117, s[20:23], s101 offen offset:4
    v_mfma_f32_16x16x32_bf16 v[228:231], v[36:39], a[60:63], v[228:231]
    s_waitcnt lgkmcnt(2)
    v_and_b32 v77, 0xffff0000, v94
    v_lshlrev_b32 v78, 16, v95
    s_waitcnt vmcnt(9)
    v_mfma_f32_16x16x32_bf16 v[136:139], v[40:43], a[48:51], v[136:139]
    v_and_b32 v79, 0xffff0000, v95
    v_add_f32 v108, v64, v65
    s_waitcnt lgkmcnt(0)
    s_barrier
    v_mfma_f32_16x16x32_bf16 v[168:171], v[40:43], a[52:55], v[168:171]
    s_add_u32 m0, s63, 114688
    s_xor_b32 s98, s97, 2097152
    ds_read_b64_tr_b16 v[32:33], v8 offset:32768
    v_lshrrev_b32 v87, 2, v1
    v_add_u32 v101, 147456, v87
    v_mfma_f32_16x16x32_bf16 v[200:203], v[40:43], a[56:59], v[200:203]
    ds_read_b64_tr_b16 v[34:35], v8 offset:33792
    ds_read_b32 v102, v101
    v_mfma_f32_16x16x32_bf16 v[232:235], v[40:43], a[60:63], v[232:235]
    ds_read_b64_tr_b16 v[36:37], v9 offset:32768
    ds_read_b32 v103, v101 offset:256
    v_mfma_f32_16x16x32_bf16 v[140:143], v[44:47], a[48:51], v[140:143]
    ds_read_b64_tr_b16 v[38:39], v9 offset:33792
    ds_read_b32 v104, v101 offset:512
    v_mfma_f32_16x16x32_bf16 v[172:175], v[44:47], a[52:55], v[172:175]
    ds_read_b64_tr_b16 v[40:41], v10 offset:32768
    ds_read_b32 v105, v101 offset:768
    v_mfma_f32_16x16x32_bf16 v[204:207], v[44:47], a[56:59], v[204:207]
    ds_read_b64_tr_b16 v[42:43], v10 offset:33792
    v_add_f32 v109, v66, v67
    v_mfma_f32_16x16x32_bf16 v[236:239], v[44:47], a[60:63], v[236:239]
    ds_read_b128 a[64:67], v30 offset:0
    v_add_f32 v108, v108, v68
    v_mfma_f32_16x16x32_bf16 v[144:147], v[48:51], a[48:51], v[144:147]
    ds_read_b64_tr_b16 v[44:45], v11 offset:32768
    v_add_f32 v109, v109, v69
    v_mfma_f32_16x16x32_bf16 v[176:179], v[48:51], a[52:55], v[176:179]
    ds_read_b64_tr_b16 v[46:47], v11 offset:33792
    v_add_f32 v108, v108, v70
    v_mfma_f32_16x16x32_bf16 v[208:211], v[48:51], a[56:59], v[208:211]
    ds_read_b128 a[68:71], v30 offset:2048
    v_add_f32 v109, v109, v71
    v_mfma_f32_16x16x32_bf16 v[240:243], v[48:51], a[60:63], v[240:243]
    ds_read_b128 a[72:75], v30 offset:4096
    s_waitcnt lgkmcnt(10)
    v_add_f32 v102, v102, v103
    v_mfma_f32_16x16x32_bf16 v[148:151], v[52:55], a[48:51], v[148:151]
    ds_read_b64_tr_b16 v[48:49], v12 offset:32768
    s_waitcnt lgkmcnt(7)
    v_add_f32 v104, v104, v105
    v_mfma_f32_16x16x32_bf16 v[180:183], v[52:55], a[52:55], v[180:183]
    ds_read_b64_tr_b16 v[50:51], v12 offset:33792
    v_add_f32 v102, v102, v104
    buffer_store_dword v102, v87, s[8:11], s66 offen sc0 sc1
    v_mfma_f32_16x16x32_bf16 v[212:215], v[52:55], a[56:59], v[212:215]
    ds_read_b128 a[76:79], v30 offset:6144
    v_add_f32 v108, v108, v72
    v_mfma_f32_16x16x32_bf16 v[244:247], v[52:55], a[60:63], v[244:247]
    buffer_load_dwordx4 v20, s[16:19], s98 offen offset:0   lds
    v_mfma_f32_16x16x32_bf16 v[152:155], v[56:59], a[48:51], v[152:155]
    s_mov_b32 s40, s92
    s_mov_b32 s41, s93
    ds_read_b64_tr_b16 v[52:53], v13 offset:32768
    v_mfma_f32_16x16x32_bf16 v[184:187], v[56:59], a[52:55], v[184:187]
    s_mov_b32 s42, 1835008
    s_mov_b32 s44, s94
    ds_read_b64_tr_b16 v[54:55], v13 offset:33792
    v_mfma_f32_16x16x32_bf16 v[216:219], v[56:59], a[56:59], v[216:219]
    s_mov_b32 s45, s95
    s_mov_b32 s46, 1835008
    v_add_f32 v109, v109, v73
    v_mfma_f32_16x16x32_bf16 v[248:251], v[56:59], a[60:63], v[248:251]
    buffer_load_dwordx4 v21, s[16:19], s98 offen offset:1024   lds
    v_mfma_f32_16x16x32_bf16 v[156:159], v[60:63], a[48:51], v[156:159]
    ds_read_b64_tr_b16 v[56:57], v14 offset:32768
    v_add_f32 v108, v108, v74
    v_mfma_f32_16x16x32_bf16 v[188:191], v[60:63], a[52:55], v[188:191]
    ds_read_b64_tr_b16 v[58:59], v14 offset:33792
    v_add_f32 v109, v109, v75
    v_mfma_f32_16x16x32_bf16 v[220:223], v[60:63], a[56:59], v[220:223]
    buffer_load_dwordx4 v22, s[16:19], s98 offen offset:2048   lds
    v_mfma_f32_16x16x32_bf16 v[252:255], v[60:63], a[60:63], v[252:255]
    s_waitcnt lgkmcnt(5)
    v_add_f32 v108, v108, v76
    v_add_f32 v109, v109, v77
    v_mfma_f32_16x16x32_bf16 v[128:131], v[32:35], a[64:67], v[128:131]
    ds_read_b64_tr_b16 v[60:61], v15 offset:32768
    v_add_f32 v108, v108, v78
    v_mfma_f32_16x16x32_bf16 v[160:163], v[32:35], a[68:71], v[160:163]
    ds_read_b64_tr_b16 v[62:63], v15 offset:33792
    v_add_f32 v109, v109, v79
    v_mfma_f32_16x16x32_bf16 v[192:195], v[32:35], a[72:75], v[192:195]
    s_waitcnt lgkmcnt(5)
    ds_read_b128 a[80:83], v31 offset:0
    v_add_f32 v108, v108, v109
    v_mfma_f32_16x16x32_bf16 v[224:227], v[32:35], a[76:79], v[224:227]
    ds_read_b128 a[84:87], v31 offset:2048
    v_add_f32_dpp v108, v108, v108 row_ror:8 row_mask:0xf bank_mask:0xf
    v_mfma_f32_16x16x32_bf16 v[132:135], v[36:39], a[64:67], v[132:135]
    ds_read_b64_tr_b16 v[32:33], v8 offset:40960
    v_mov_b32 v110, v108
    v_mfma_f32_16x16x32_bf16 v[164:167], v[36:39], a[68:71], v[164:167]
    ds_read_b64_tr_b16 v[34:35], v8 offset:41984
    v_permlane16_swap_b32 v108, v110
    v_mfma_f32_16x16x32_bf16 v[196:199], v[36:39], a[72:75], v[196:199]
    ds_read_b128 a[88:91], v31 offset:4096
    v_add_f32 v108, v108, v110
    v_mfma_f32_16x16x32_bf16 v[228:231], v[36:39], a[76:79], v[228:231]
    ds_read_b128 a[92:95], v31 offset:6144
    v_mov_b32 v110, v108
    v_mfma_f32_16x16x32_bf16 v[136:139], v[40:43], a[64:67], v[136:139]
    ds_read_b64_tr_b16 v[36:37], v9 offset:40960
    v_permlane32_swap_b32 v108, v110
    v_mfma_f32_16x16x32_bf16 v[168:171], v[40:43], a[68:71], v[168:171]
    ds_read_b64_tr_b16 v[38:39], v9 offset:41984
    v_add_f32 v108, v108, v110
    v_mfma_f32_16x16x32_bf16 v[200:203], v[40:43], a[72:75], v[200:203]
    buffer_load_dwordx4 v23, s[16:19], s98 offen offset:3072   lds
    v_mfma_f32_16x16x32_bf16 v[232:235], v[40:43], a[76:79], v[232:235]
    v_mul_f32 v108, 0x3c000000, v108
    v_sub_f32 v110, v64, v108
    v_mfma_f32_16x16x32_bf16 v[140:143], v[44:47], a[64:67], v[140:143]
    s_add_u32 m0, s62, 32768
    s_xor_b32 s98, s96, 512
    ds_read_b64_tr_b16 v[40:41], v10 offset:40960
    v_mfma_f32_16x16x32_bf16 v[172:175], v[44:47], a[68:71], v[172:175]
    ds_read_b64_tr_b16 v[42:43], v10 offset:41984
    v_mul_f32 v109, v110, v110
    v_mfma_f32_16x16x32_bf16 v[204:207], v[44:47], a[72:75], v[204:207]
    buffer_load_dwordx4 v16, s[12:15], s98 offen offset:0   lds
    v_mfma_f32_16x16x32_bf16 v[236:239], v[44:47], a[76:79], v[236:239]
    v_sub_f32 v111, v65, v108
    v_fmac_f32 v109, v111, v111
    v_mfma_f32_16x16x32_bf16 v[144:147], v[48:51], a[64:67], v[144:147]
    ds_read_b64_tr_b16 v[44:45], v11 offset:40960
    v_sub_f32 v110, v66, v108
    v_mfma_f32_16x16x32_bf16 v[176:179], v[48:51], a[68:71], v[176:179]
    ds_read_b64_tr_b16 v[46:47], v11 offset:41984
    v_fmac_f32 v109, v110, v110
    v_mfma_f32_16x16x32_bf16 v[208:211], v[48:51], a[72:75], v[208:211]
    buffer_load_dwordx4 v17, s[12:15], s98 offen offset:1024   lds
    v_mfma_f32_16x16x32_bf16 v[240:243], v[48:51], a[76:79], v[240:243]
    s_waitcnt lgkmcnt(4)
    v_sub_f32 v111, v67, v108
    v_fmac_f32 v109, v111, v111
    v_mfma_f32_16x16x32_bf16 v[148:151], v[52:55], a[64:67], v[148:151]
    ds_read_b64_tr_b16 v[48:49], v12 offset:40960
    v_sub_f32 v110, v68, v108
    v_mfma_f32_16x16x32_bf16 v[180:183], v[52:55], a[68:71], v[180:183]
    ds_read_b64_tr_b16 v[50:51], v12 offset:41984
    v_fmac_f32 v109, v110, v110
    v_mfma_f32_16x16x32_bf16 v[212:215], v[52:55], a[72:75], v[212:215]
    buffer_load_dwordx4 v18, s[12:15], s98 offen offset:2048   lds
    v_mfma_f32_16x16x32_bf16 v[244:247], v[52:55], a[76:79], v[244:247]
    v_sub_f32 v111, v69, v108
    v_fmac_f32 v109, v111, v111
    v_mfma_f32_16x16x32_bf16 v[152:155], v[56:59], a[64:67], v[152:155]
    ds_read_b64_tr_b16 v[52:53], v13 offset:40960
    v_sub_f32 v110, v70, v108
    v_mfma_f32_16x16x32_bf16 v[184:187], v[56:59], a[68:71], v[184:187]
    ds_read_b64_tr_b16 v[54:55], v13 offset:41984
    v_fmac_f32 v109, v110, v110
    v_mfma_f32_16x16x32_bf16 v[216:219], v[56:59], a[72:75], v[216:219]
    buffer_load_dwordx4 v19, s[12:15], s98 offen offset:3072   lds
    v_mfma_f32_16x16x32_bf16 v[248:251], v[56:59], a[76:79], v[248:251]
    v_sub_f32 v111, v71, v108
    v_fmac_f32 v109, v111, v111
    v_mfma_f32_16x16x32_bf16 v[156:159], v[60:63], a[64:67], v[156:159]
    s_add_u32 m0, s62, 36864
    s_xor_b32 s98, s96, 33280
    ds_read_b64_tr_b16 v[56:57], v14 offset:40960
    v_mfma_f32_16x16x32_bf16 v[188:191], v[60:63], a[68:71], v[188:191]
    ds_read_b64_tr_b16 v[58:59], v14 offset:41984
    v_sub_f32 v110, v72, v108
    v_mfma_f32_16x16x32_bf16 v[220:223], v[60:63], a[72:75], v[220:223]
    buffer_load_dwordx4 v16, s[12:15], s98 offen offset:0   lds
    v_mfma_f32_16x16x32_bf16 v[252:255], v[60:63], a[76:79], v[252:255]
    v_fmac_f32 v109, v110, v110
    v_sub_f32 v111, v73, v108
    v_mfma_f32_16x16x32_bf16 v[128:131], v[32:35], a[80:83], v[128:131]
    ds_read_b64_tr_b16 v[60:61], v15 offset:40960
    v_fmac_f32 v109, v111, v111
    v_mfma_f32_16x16x32_bf16 v[160:163], v[32:35], a[84:87], v[160:163]
    ds_read_b64_tr_b16 v[62:63], v15 offset:41984
    v_sub_f32 v110, v74, v108
    v_mfma_f32_16x16x32_bf16 v[192:195], v[32:35], a[88:91], v[192:195]
    buffer_load_dwordx4 v17, s[12:15], s98 offen offset:1024   lds
    v_mfma_f32_16x16x32_bf16 v[224:227], v[32:35], a[92:95], v[224:227]
    v_fmac_f32 v109, v110, v110
    v_sub_f32 v111, v75, v108
    v_mfma_f32_16x16x32_bf16 v[132:135], v[36:39], a[80:83], v[132:135]
    buffer_load_dwordx4 v18, s[12:15], s98 offen offset:2048   lds
    v_mfma_f32_16x16x32_bf16 v[164:167], v[36:39], a[84:87], v[164:167]
    v_fmac_f32 v109, v111, v111
    v_sub_f32 v110, v76, v108
    v_mfma_f32_16x16x32_bf16 v[196:199], v[36:39], a[88:91], v[196:199]
    buffer_load_dwordx4 v19, s[12:15], s98 offen offset:3072   lds
    s_cmp_eq_u32 s3, 1
    s_cselect_b32 s101, s100, 2147479552
    buffer_load_dword a243, v117, s[20:23], s101 offen offset:4
    v_mfma_f32_16x16x32_bf16 v[228:231], v[36:39], a[92:95], v[228:231]
    s_waitcnt lgkmcnt(2)
    v_fmac_f32 v109, v110, v110
    v_sub_f32 v111, v77, v108
    v_mfma_f32_16x16x32_bf16 v[136:139], v[40:43], a[80:83], v[136:139]
    v_fmac_f32 v109, v111, v111
    v_sub_f32 v110, v78, v108
    s_waitcnt vmcnt(15) lgkmcnt(0)
    s_barrier
    v_mfma_f32_16x16x32_bf16 v[168:171], v[40:43], a[84:87], v[168:171]
    s_add_u32 m0, s63, 131072
    s_xor_b32 s98, s97, 2621440
    ds_read_b64_tr_b16 v[32:33], v8 offset:0
    v_mfma_f32_16x16x32_bf16 v[200:203], v[40:43], a[88:91], v[200:203]
    ds_read_b64_tr_b16 v[34:35], v8 offset:1024
    v_fmac_f32 v109, v110, v110
    v_mfma_f32_16x16x32_bf16 v[232:235], v[40:43], a[92:95], v[232:235]
    ds_read_b64_tr_b16 v[36:37], v9 offset:0
    v_sub_f32 v111, v79, v108
    v_mfma_f32_16x16x32_bf16 v[140:143], v[44:47], a[80:83], v[140:143]
    ds_read_b64_tr_b16 v[38:39], v9 offset:1024
    v_fmac_f32 v109, v111, v111
    v_mfma_f32_16x16x32_bf16 v[172:175], v[44:47], a[84:87], v[172:175]
    ds_read_b64_tr_b16 v[40:41], v10 offset:0
    v_add_f32_dpp v109, v109, v109 row_ror:8 row_mask:0xf bank_mask:0xf
    v_mfma_f32_16x16x32_bf16 v[204:207], v[44:47], a[88:91], v[204:207]
    ds_read_b64_tr_b16 v[42:43], v10 offset:1024
    v_mov_b32 v110, v109
    v_mfma_f32_16x16x32_bf16 v[236:239], v[44:47], a[92:95], v[236:239]
    ds_read_b128 a[96:99], v28 offset:0
    v_permlane16_swap_b32 v109, v110
    v_mfma_f32_16x16x32_bf16 v[144:147], v[48:51], a[80:83], v[144:147]
    ds_read_b64_tr_b16 v[44:45], v11 offset:0
    v_add_f32 v109, v109, v110
    v_mfma_f32_16x16x32_bf16 v[176:179], v[48:51], a[84:87], v[176:179]
    ds_read_b64_tr_b16 v[46:47], v11 offset:1024
    v_mov_b32 v110, v109
    s_waitcnt vmcnt(13)
    buffer_atomic_add v6, v7, s[36:39], s69 offen sc1
    v_mfma_f32_16x16x32_bf16 v[208:211], v[48:51], a[88:91], v[208:211]
    ds_read_b128 a[100:103], v28 offset:2048
    v_permlane32_swap_b32 v109, v110
    v_mfma_f32_16x16x32_bf16 v[240:243], v[48:51], a[92:95], v[240:243]
    ds_read_b128 a[104:107], v28 offset:4096
    v_add_f32 v109, v109, v110
    v_mfma_f32_16x16x32_bf16 v[148:151], v[52:55], a[80:83], v[148:151]
    ds_read_b64_tr_b16 v[48:49], v12 offset:0
    v_mfma_f32_16x16x32_bf16 v[180:183], v[52:55], a[84:87], v[180:183]
    ds_read_b64_tr_b16 v[50:51], v12 offset:1024
    v_mfma_f32_16x16x32_bf16 v[212:215], v[52:55], a[88:91], v[212:215]
    ds_read_b128 a[108:111], v28 offset:6144
    v_mfma_f32_16x16x32_bf16 v[244:247], v[52:55], a[92:95], v[244:247]
    buffer_load_dwordx4 v20, s[16:19], s98 offen offset:0   lds
    v_mfma_f32_16x16x32_bf16 v[152:155], v[56:59], a[80:83], v[152:155]
    ds_read_b64_tr_b16 v[52:53], v13 offset:0
    v_mfma_f32_16x16x32_bf16 v[184:187], v[56:59], a[84:87], v[184:187]
    ds_read_b64_tr_b16 v[54:55], v13 offset:1024
    v_mfma_f32_16x16x32_bf16 v[216:219], v[56:59], a[88:91], v[216:219]
    buffer_load_dwordx4 v21, s[16:19], s98 offen offset:1024   lds
    v_mfma_f32_16x16x32_bf16 v[248:251], v[56:59], a[92:95], v[248:251]
    ds_write_b64 v100, v[108:109]
    v_mfma_f32_16x16x32_bf16 v[156:159], v[60:63], a[80:83], v[156:159]
    ds_read_b64_tr_b16 v[56:57], v14 offset:0
    v_mfma_f32_16x16x32_bf16 v[188:191], v[60:63], a[84:87], v[188:191]
    ds_read_b64_tr_b16 v[58:59], v14 offset:1024
    v_mfma_f32_16x16x32_bf16 v[220:223], v[60:63], a[88:91], v[220:223]
    buffer_load_dwordx4 v22, s[16:19], s98 offen offset:2048   lds
    v_mfma_f32_16x16x32_bf16 v[252:255], v[60:63], a[92:95], v[252:255]
    s_waitcnt lgkmcnt(6)
    v_mfma_f32_16x16x32_bf16 v[128:131], v[32:35], a[96:99], v[128:131]
    ds_read_b64_tr_b16 v[60:61], v15 offset:0
    v_mfma_f32_16x16x32_bf16 v[160:163], v[32:35], a[100:103], v[160:163]
    ds_read_b64_tr_b16 v[62:63], v15 offset:1024
    v_mfma_f32_16x16x32_bf16 v[192:195], v[32:35], a[104:107], v[192:195]
    s_waitcnt lgkmcnt(6)
    ds_read_b128 a[112:115], v29 offset:0
    v_mfma_f32_16x16x32_bf16 v[224:227], v[32:35], a[108:111], v[224:227]
    ds_read_b128 a[116:119], v29 offset:2048
    v_mfma_f32_16x16x32_bf16 v[132:135], v[36:39], a[96:99], v[132:135]
    ds_read_b64_tr_b16 v[32:33], v8 offset:8192
    v_mfma_f32_16x16x32_bf16 v[164:167], v[36:39], a[100:103], v[164:167]
    ds_read_b64_tr_b16 v[34:35], v8 offset:9216
    v_mfma_f32_16x16x32_bf16 v[196:199], v[36:39], a[104:107], v[196:199]
    ds_read_b128 a[120:123], v29 offset:4096
    v_mfma_f32_16x16x32_bf16 v[228:231], v[36:39], a[108:111], v[228:231]
    ds_read_b128 a[124:127], v29 offset:6144
    v_mfma_f32_16x16x32_bf16 v[136:139], v[40:43], a[96:99], v[136:139]
    ds_read_b64_tr_b16 v[36:37], v9 offset:8192
    v_mfma_f32_16x16x32_bf16 v[168:171], v[40:43], a[100:103], v[168:171]
    ds_read_b64_tr_b16 v[38:39], v9 offset:9216
    v_mfma_f32_16x16x32_bf16 v[200:203], v[40:43], a[104:107], v[200:203]
    buffer_load_dwordx4 v23, s[16:19], s98 offen offset:3072   lds
    v_mfma_f32_16x16x32_bf16 v[232:235], v[40:43], a[108:111], v[232:235]
    v_mfma_f32_16x16x32_bf16 v[140:143], v[44:47], a[96:99], v[140:143]
    s_add_u32 m0, s62, 65536
    s_xor_b32 s98, s96, 640
    ds_read_b64_tr_b16 v[40:41], v10 offset:8192
    v_mfma_f32_16x16x32_bf16 v[172:175], v[44:47], a[100:103], v[172:175]
    ds_read_b64_tr_b16 v[42:43], v10 offset:9216
    v_mfma_f32_16x16x32_bf16 v[204:207], v[44:47], a[104:107], v[204:207]
    buffer_load_dwordx4 v16, s[12:15], s98 offen offset:0   lds
    v_mfma_f32_16x16x32_bf16 v[236:239], v[44:47], a[108:111], v[236:239]
    v_mfma_f32_16x16x32_bf16 v[144:147], v[48:51], a[96:99], v[144:147]
    ds_read_b64_tr_b16 v[44:45], v11 offset:8192
    v_mfma_f32_16x16x32_bf16 v[176:179], v[48:51], a[100:103], v[176:179]
    ds_read_b64_tr_b16 v[46:47], v11 offset:9216
    v_mfma_f32_16x16x32_bf16 v[208:211], v[48:51], a[104:107], v[208:211]
    buffer_load_dwordx4 v17, s[12:15], s98 offen offset:1024   lds
    v_mfma_f32_16x16x32_bf16 v[240:243], v[48:51], a[108:111], v[240:243]
    s_waitcnt lgkmcnt(4)
    v_mfma_f32_16x16x32_bf16 v[148:151], v[52:55], a[96:99], v[148:151]
    ds_read_b64_tr_b16 v[48:49], v12 offset:8192
    v_mfma_f32_16x16x32_bf16 v[180:183], v[52:55], a[100:103], v[180:183]
    ds_read_b64_tr_b16 v[50:51], v12 offset:9216
    v_mfma_f32_16x16x32_bf16 v[212:215], v[52:55], a[104:107], v[212:215]
    buffer_load_dwordx4 v18, s[12:15], s98 offen offset:2048   lds
    v_mfma_f32_16x16x32_bf16 v[244:247], v[52:55], a[108:111], v[244:247]
    v_mfma_f32_16x16x32_bf16 v[152:155], v[56:59], a[96:99], v[152:155]
    ds_read_b64_tr_b16 v[52:53], v13 offset:8192
    v_mfma_f32_16x16x32_bf16 v[184:187], v[56:59], a[100:103], v[184:187]
    ds_read_b64_tr_b16 v[54:55], v13 offset:9216
    v_mfma_f32_16x16x32_bf16 v[216:219], v[56:59], a[104:107], v[216:219]
    buffer_load_dwordx4 v19, s[12:15], s98 offen offset:3072   lds
    v_mfma_f32_16x16x32_bf16 v[248:251], v[56:59], a[108:111], v[248:251]
    v_mfma_f32_16x16x32_bf16 v[156:159], v[60:63], a[96:99], v[156:159]
    s_add_u32 m0, s62, 69632
    s_xor_b32 s98, s96, 33408
    ds_read_b64_tr_b16 v[56:57], v14 offset:8192
    v_mfma_f32_16x16x32_bf16 v[188:191], v[60:63], a[100:103], v[188:191]
    ds_read_b64_tr_b16 v[58:59], v14 offset:9216
    v_mfma_f32_16x16x32_bf16 v[220:223], v[60:63], a[104:107], v[220:223]
    buffer_load_dwordx4 v16, s[12:15], s98 offen offset:0   lds
    v_mfma_f32_16x16x32_bf16 v[252:255], v[60:63], a[108:111], v[252:255]
    v_mfma_f32_16x16x32_bf16 v[128:131], v[32:35], a[112:115], v[128:131]
    ds_read_b64_tr_b16 v[60:61], v15 offset:8192
    v_mfma_f32_16x16x32_bf16 v[160:163], v[32:35], a[116:119], v[160:163]
    ds_read_b64_tr_b16 v[62:63], v15 offset:9216
    v_mfma_f32_16x16x32_bf16 v[192:195], v[32:35], a[120:123], v[192:195]
    buffer_load_dwordx4 v17, s[12:15], s98 offen offset:1024   lds
    v_mfma_f32_16x16x32_bf16 v[224:227], v[32:35], a[124:127], v[224:227]
    v_mfma_f32_16x16x32_bf16 v[132:135], v[36:39], a[112:115], v[132:135]
    buffer_load_dwordx4 v18, s[12:15], s98 offen offset:2048   lds
    v_mfma_f32_16x16x32_bf16 v[164:167], v[36:39], a[116:119], v[164:167]
    v_mfma_f32_16x16x32_bf16 v[196:199], v[36:39], a[120:123], v[196:199]
    buffer_load_dwordx4 v19, s[12:15], s98 offen offset:3072   lds
    s_cmp_eq_u32 s3, 2
    s_cselect_b32 s101, s100, 2147479552
    buffer_load_dword a245, v117, s[24:27], s101 offen offset:4
    v_mfma_f32_16x16x32_bf16 v[228:231], v[36:39], a[124:127], v[228:231]
    s_waitcnt lgkmcnt(2)
    v_mfma_f32_16x16x32_bf16 v[136:139], v[40:43], a[112:115], v[136:139]
    s_waitcnt vmcnt(15) lgkmcnt(0)
    s_barrier
    v_mfma_f32_16x16x32_bf16 v[168:171], v[40:43], a[116:119], v[168:171]
    s_add_u32 m0, s63, 98304
    s_xor_b32 s98, s97, 3145728
    ds_read_b64_tr_b16 v[32:33], v8 offset:16384
    v_mfma_f32_16x16x32_bf16 v[200:203], v[40:43], a[120:123], v[200:203]
    ds_read_b64_tr_b16 v[34:35], v8 offset:17408
    v_mfma_f32_16x16x32_bf16 v[232:235], v[40:43], a[124:127], v[232:235]
    ds_read_b64_tr_b16 v[36:37], v9 offset:16384
    v_mfma_f32_16x16x32_bf16 v[140:143], v[44:47], a[112:115], v[140:143]
    ds_read_b64_tr_b16 v[38:39], v9 offset:17408
    v_mfma_f32_16x16x32_bf16 v[172:175], v[44:47], a[116:119], v[172:175]
    ds_read_b64_tr_b16 v[40:41], v10 offset:16384
    v_mfma_f32_16x16x32_bf16 v[204:207], v[44:47], a[120:123], v[204:207]
    ds_read_b64_tr_b16 v[42:43], v10 offset:17408
    v_mfma_f32_16x16x32_bf16 v[236:239], v[44:47], a[124:127], v[236:239]
    ds_read_b128 a[128:131], v28 offset:32768
    v_mfma_f32_16x16x32_bf16 v[144:147], v[48:51], a[112:115], v[144:147]
    ds_read_b64_tr_b16 v[44:45], v11 offset:16384
    v_mfma_f32_16x16x32_bf16 v[176:179], v[48:51], a[116:119], v[176:179]
    ds_read_b64_tr_b16 v[46:47], v11 offset:17408
    v_mfma_f32_16x16x32_bf16 v[208:211], v[48:51], a[120:123], v[208:211]
    ds_read_b128 a[132:135], v28 offset:34816
    v_mfma_f32_16x16x32_bf16 v[240:243], v[48:51], a[124:127], v[240:243]
    ds_read_b128 a[136:139], v28 offset:36864
    v_mfma_f32_16x16x32_bf16 v[148:151], v[52:55], a[112:115], v[148:151]
    ds_read_b64_tr_b16 v[48:49], v12 offset:16384
    v_mfma_f32_16x16x32_bf16 v[180:183], v[52:55], a[116:119], v[180:183]
    ds_read_b64_tr_b16 v[50:51], v12 offset:17408
    v_mfma_f32_16x16x32_bf16 v[212:215], v[52:55], a[120:123], v[212:215]
    ds_read_b128 a[140:143], v28 offset:38912
    v_mfma_f32_16x16x32_bf16 v[244:247], v[52:55], a[124:127], v[244:247]
    buffer_load_dwordx4 v20, s[16:19], s98 offen offset:0   lds
    v_mfma_f32_16x16x32_bf16 v[152:155], v[56:59], a[112:115], v[152:155]
    ds_read_b64_tr_b16 v[52:53], v13 offset:16384
    v_mfma_f32_16x16x32_bf16 v[184:187], v[56:59], a[116:119], v[184:187]
    ds_read_b64_tr_b16 v[54:55], v13 offset:17408
    v_mfma_f32_16x16x32_bf16 v[216:219], v[56:59], a[120:123], v[216:219]
    buffer_load_dwordx4 v21, s[16:19], s98 offen offset:1024   lds
    v_mfma_f32_16x16x32_bf16 v[248:251], v[56:59], a[124:127], v[248:251]
    ds_read_b128 v[88:91], v99
    v_mfma_f32_16x16x32_bf16 v[156:159], v[60:63], a[112:115], v[156:159]
    ds_read_b64_tr_b16 v[56:57], v14 offset:16384
    v_mfma_f32_16x16x32_bf16 v[188:191], v[60:63], a[116:119], v[188:191]
    ds_read_b64_tr_b16 v[58:59], v14 offset:17408
    v_mfma_f32_16x16x32_bf16 v[220:223], v[60:63], a[120:123], v[220:223]
    buffer_load_dwordx4 v22, s[16:19], s98 offen offset:2048   lds
    v_mfma_f32_16x16x32_bf16 v[252:255], v[60:63], a[124:127], v[252:255]
    s_waitcnt lgkmcnt(6)
    ds_read_b128 v[92:95], v99 offset:16
    v_mfma_f32_16x16x32_bf16 v[128:131], v[32:35], a[128:131], v[128:131]
    ds_read_b64_tr_b16 v[60:61], v15 offset:16384
    v_mfma_f32_16x16x32_bf16 v[160:163], v[32:35], a[132:135], v[160:163]
    ds_read_b64_tr_b16 v[62:63], v15 offset:17408
    v_mfma_f32_16x16x32_bf16 v[192:195], v[32:35], a[136:139], v[192:195]
    s_waitcnt lgkmcnt(7)
    ds_read_b128 a[144:147], v29 offset:32768
    v_mfma_f32_16x16x32_bf16 v[224:227], v[32:35], a[140:143], v[224:227]
    ds_read_b128 a[148:151], v29 offset:34816
    v_mfma_f32_16x16x32_bf16 v[132:135], v[36:39], a[128:131], v[132:135]
    ds_read_b64_tr_b16 v[32:33], v8 offset:24576
    v_mfma_f32_16x16x32_bf16 v[164:167], v[36:39], a[132:135], v[164:167]
    ds_read_b64_tr_b16 v[34:35], v8 offset:25600
    v_mfma_f32_16x16x32_bf16 v[196:199], v[36:39], a[136:139], v[196:199]
    ds_read_b128 a[152:155], v29 offset:36864
    v_mfma_f32_16x16x32_bf16 v[228:231], v[36:39], a[140:143], v[228:231]
    ds_read_b128 a[156:159], v29 offset:38912
    s_waitcnt lgkmcnt(11)
    v_add_f32 v108, v88, v90
    v_mfma_f32_16x16x32_bf16 v[136:139], v[40:43], a[128:131], v[136:139]
    ds_read_b64_tr_b16 v[36:37], v9 offset:24576
    s_waitcnt lgkmcnt(9)
    v_add_f32 v109, v92, v94
    v_mfma_f32_16x16x32_bf16 v[168:171], v[40:43], a[132:135], v[168:171]
    ds_read_b64_tr_b16 v[38:39], v9 offset:25600
    v_add_f32 v108, v108, v109
    v_mfma_f32_16x16x32_bf16 v[200:203], v[40:43], a[136:139], v[200:203]
    buffer_load_dwordx4 v23, s[16:19], s98 offen offset:3072   lds
    v_mfma_f32_16x16x32_bf16 v[232:235], v[40:43], a[140:143], v[232:235]
    v_mul_f32 v108, 0x3e800000, v108
    v_add_f32 v109, v89, v91
    v_mfma_f32_16x16x32_bf16 v[140:143], v[44:47], a[128:131], v[140:143]
    s_add_u32 m0, s62, 0
    s_xor_b32 s98, s96, 768
    ds_read_b64_tr_b16 v[40:41], v10 offset:24576
    v_mfma_f32_16x16x32_bf16 v[172:175], v[44:47], a[132:135], v[172:175]
    ds_read_b64_tr_b16 v[42:43], v10 offset:25600
    v_add_f32 v110, v93, v95
    v_mfma_f32_16x16x32_bf16 v[204:207], v[44:47], a[136:139], v[204:207]
    buffer_load_dwordx4 v16, s[12:15], s98 offen offset:0   lds
    v_mfma_f32_16x16x32_bf16 v[236:239], v[44:47], a[140:143], v[236:239]
    v_add_f32 v109, v109, v110
    v_sub_f32 v88, v88, v108
    v_mfma_f32_16x16x32_bf16 v[144:147], v[48:51], a[128:131], v[144:147]
    ds_read_b64_tr_b16 v[44:45], v11 offset:24576
    v_sub_f32 v90, v90, v108
    v_mfma_f32_16x16x32_bf16 v[176:179], v[48:51], a[132:135], v[176:179]
    ds_read_b64_tr_b16 v[46:47], v11 offset:25600
    v_sub_f32 v92, v92, v108
    v_mfma_f32_16x16x32_bf16 v[208:211], v[48:51], a[136:139], v[208:211]
    buffer_load_dwordx4 v17, s[12:15], s98 offen offset:1024   lds
    v_mfma_f32_16x16x32_bf16 v[240:243], v[48:51], a[140:143], v[240:243]
    v_sub_f32 v94, v94, v108
    v_mul_f32 v110, v88, v88
    v_mfma_f32_16x16x32_bf16 v[148:151], v[52:55], a[128:131], v[148:151]
    ds_read_b64_tr_b16 v[48:49], v12 offset:24576
    v_fmac_f32 v110, v90, v90
    v_mfma_f32_16x16x32_bf16 v[180:183], v[52:55], a[132:135], v[180:183]
    ds_read_b64_tr_b16 v[50:51], v12 offset:25600
    v_fmac_f32 v110, v92, v92
    v_mfma_f32_16x16x32_bf16 v[212:215], v[52:55], a[136:139], v[212:215]
    buffer_load_dwordx4 v18, s[12:15], s98 offen offset:2048   lds
    v_mfma_f32_16x16x32_bf16 v[244:247], v[52:55], a[140:143], v[244:247]
    v_fmac_f32 v110, v94, v94
    v_fmac_f32 v109, 0x43000000, v110
    v_mfma_f32_16x16x32_bf16 v[152:155], v[56:59], a[128:131], v[152:155]
    ds_read_b64_tr_b16 v[52:53], v13 offset:24576
    v_mov_b32 v110, 0x3727c5ac
    v_mfma_f32_16x16x32_bf16 v[184:187], v[56:59], a[132:135], v[184:187]
    ds_read_b64_tr_b16 v[54:55], v13 offset:25600
    v_fmac_f32 v110, 0x3b000000, v109
    v_mfma_f32_16x16x32_bf16 v[216:219], v[56:59], a[136:139], v[216:219]
    buffer_load_dwordx4 v19, s[12:15], s98 offen offset:3072   lds
    v_mfma_f32_16x16x32_bf16 v[248:251], v[56:59], a[140:143], v[248:251]
    s_waitcnt lgkmcnt(4)
    v_rsq_f32 v110, v110
    v_mfma_f32_16x16x32_bf16 v[156:159], v[60:63], a[128:131], v[156:159]
    s_add_u32 m0, s62, 4096
    s_xor_b32 s98, s96, 33536
    ds_read_b64_tr_b16 v[56:57], v14 offset:24576
    v_mfma_f32_16x16x32_bf16 v[188:191], v[60:63], a[132:135], v[188:191]
    ds_read_b64_tr_b16 v[58:59], v14 offset:25600
    v_sub_f32 v64, v64, v108
    v_mfma_f32_16x16x32_bf16 v[220:223], v[60:63], a[136:139], v[220:223]
    buffer_load_dwordx4 v16, s[12:15], s98 offen offset:0   lds
    v_mfma_f32_16x16x32_bf16 v[252:255], v[60:63], a[140:143], v[252:255]
    v_sub_f32 v65, v65, v108
    v_sub_f32 v66, v66, v108
    v_mfma_f32_16x16x32_bf16 v[128:131], v[32:35], a[144:147], v[128:131]
    ds_read_b64_tr_b16 v[60:61], v15 offset:24576
    v_sub_f32 v67, v67, v108
    v_mfma_f32_16x16x32_bf16 v[160:163], v[32:35], a[148:151], v[160:163]
    ds_read_b64_tr_b16 v[62:63], v15 offset:25600
    v_sub_f32 v68, v68, v108
    v_mfma_f32_16x16x32_bf16 v[192:195], v[32:35], a[152:155], v[192:195]
    buffer_load_dwordx4 v17, s[12:15], s98 offen offset:1024   lds
    v_mfma_f32_16x16x32_bf16 v[224:227], v[32:35], a[156:159], v[224:227]
    v_sub_f32 v69, v69, v108
    v_sub_f32 v70, v70, v108
    v_mfma_f32_16x16x32_bf16 v[132:135], v[36:39], a[144:147], v[132:135]
    buffer_load_dwordx4 v18, s[12:15], s98 offen offset:2048   lds
    v_mfma_f32_16x16x32_bf16 v[164:167], v[36:39], a[148:151], v[164:167]
    v_sub_f32 v71, v71, v108
    v_sub_f32 v72, v72, v108
    v_mfma_f32_16x16x32_bf16 v[196:199], v[36:39], a[152:155], v[196:199]
    buffer_load_dwordx4 v19, s[12:15], s98 offen offset:3072   lds
    s_cmp_eq_u32 s3, 3
    s_cselect_b32 s101, s100, 2147479552
    buffer_load_dword a247, v117, s[24:27], s101 offen offset:4
    v_mfma_f32_16x16x32_bf16 v[228:231], v[36:39], a[156:159], v[228:231]
    v_sub_f32 v73, v73, v108
    v_sub_f32 v74, v74, v108
    v_mfma_f32_16x16x32_bf16 v[136:139], v[40:43], a[144:147], v[136:139]
    v_sub_f32 v75, v75, v108
    v_sub_f32 v76, v76, v108
    s_waitcnt vmcnt(14) lgkmcnt(0)
    s_barrier
    v_mfma_f32_16x16x32_bf16 v[168:171], v[40:43], a[148:151], v[168:171]
    s_add_u32 m0, s63, 114688
    s_xor_b32 s98, s97, 3670016
    ds_read_b64_tr_b16 v[32:33], v8 offset:32768
    v_mfma_f32_16x16x32_bf16 v[200:203], v[40:43], a[152:155], v[200:203]
    ds_read_b64_tr_b16 v[34:35], v8 offset:33792
    v_sub_f32 v77, v77, v108
    v_mfma_f32_16x16x32_bf16 v[232:235], v[40:43], a[156:159], v[232:235]
    ds_read_b64_tr_b16 v[36:37], v9 offset:32768
    v_sub_f32 v78, v78, v108
    v_mfma_f32_16x16x32_bf16 v[140:143], v[44:47], a[144:147], v[140:143]
    ds_read_b64_tr_b16 v[38:39], v9 offset:33792
    v_sub_f32 v79, v79, v108
    v_mfma_f32_16x16x32_bf16 v[172:175], v[44:47], a[148:151], v[172:175]
    ds_read_b64_tr_b16 v[40:41], v10 offset:32768
    v_mul_f32 v64, v64, v110
    v_mfma_f32_16x16x32_bf16 v[204:207], v[44:47], a[152:155], v[204:207]
    ds_read_b64_tr_b16 v[42:43], v10 offset:33792
    v_mul_f32 v65, v65, v110
    v_mfma_f32_16x16x32_bf16 v[236:239], v[44:47], a[156:159], v[236:239]
    ds_read_b128 a[160:163], v30 offset:0
    v_mul_f32 v66, v66, v110
    v_mfma_f32_16x16x32_bf16 v[144:147], v[48:51], a[144:147], v[144:147]
    ds_read_b64_tr_b16 v[44:45], v11 offset:32768
    v_mul_f32 v67, v67, v110
    v_mfma_f32_16x16x32_bf16 v[176:179], v[48:51], a[148:151], v[176:179]
    ds_read_b64_tr_b16 v[46:47], v11 offset:33792
    v_mul_f32 v68, v68, v110
    v_mfma_f32_16x16x32_bf16 v[208:211], v[48:51], a[152:155], v[208:211]
    ds_read_b128 a[164:167], v30 offset:2048
    v_mul_f32 v69, v69, v110
    v_mfma_f32_16x16x32_bf16 v[240:243], v[48:51], a[156:159], v[240:243]
    ds_read_b128 a[168:171], v30 offset:4096
    v_mul_f32 v70, v70, v110
    v_mfma_f32_16x16x32_bf16 v[148:151], v[52:55], a[144:147], v[148:151]
    ds_read_b64_tr_b16 v[48:49], v12 offset:32768
    v_mul_f32 v71, v71, v110
    v_mfma_f32_16x16x32_bf16 v[180:183], v[52:55], a[148:151], v[180:183]
    ds_read_b64_tr_b16 v[50:51], v12 offset:33792
    v_mul_f32 v72, v72, v110
    v_mfma_f32_16x16x32_bf16 v[212:215], v[52:55], a[152:155], v[212:215]
    ds_read_b128 a[172:175], v30 offset:6144
    v_mul_f32 v73, v73, v110
    buffer_load_dword v3, v4, s[36:39], s67 offen sc0 sc1
    v_mfma_f32_16x16x32_bf16 v[244:247], v[52:55], a[156:159], v[244:247]
    buffer_load_dwordx4 v20, s[16:19], s98 offen offset:0   lds
    v_mfma_f32_16x16x32_bf16 v[152:155], v[56:59], a[144:147], v[152:155]
    ds_read_b64_tr_b16 v[52:53], v13 offset:32768
    v_mul_f32 v74, v74, v110
    v_mfma_f32_16x16x32_bf16 v[184:187], v[56:59], a[148:151], v[184:187]
    ds_read_b64_tr_b16 v[54:55], v13 offset:33792
    v_mul_f32 v75, v75, v110
    v_mfma_f32_16x16x32_bf16 v[216:219], v[56:59], a[152:155], v[216:219]
    buffer_load_dwordx4 v21, s[16:19], s98 offen offset:1024   lds
    v_mfma_f32_16x16x32_bf16 v[248:251], v[56:59], a[156:159], v[248:251]
    v_mul_f32 v76, v76, v110
    v_mul_f32 v77, v77, v110
    v_mfma_f32_16x16x32_bf16 v[156:159], v[60:63], a[144:147], v[156:159]
    ds_read_b64_tr_b16 v[56:57], v14 offset:32768
    v_mul_f32 v78, v78, v110
    v_mfma_f32_16x16x32_bf16 v[188:191], v[60:63], a[148:151], v[188:191]
    ds_read_b64_tr_b16 v[58:59], v14 offset:33792
    v_mul_f32 v79, v79, v110
    v_mfma_f32_16x16x32_bf16 v[220:223], v[60:63], a[152:155], v[220:223]
    buffer_load_dwordx4 v22, s[16:19], s98 offen offset:2048   lds
    v_mfma_f32_16x16x32_bf16 v[252:255], v[60:63], a[156:159], v[252:255]
    s_waitcnt lgkmcnt(5)
    v_mfma_f32_16x16x32_bf16 v[128:131], v[32:35], a[160:163], v[128:131]
    ds_read_b64_tr_b16 v[60:61], v15 offset:32768
    v_and_b32 v96, 31, v2
    v_mfma_f32_16x16x32_bf16 v[160:163], v[32:35], a[164:167], v[160:163]
    ds_read_b64_tr_b16 v[62:63], v15 offset:33792
    v_lshlrev_b32 v96, 4, v96
    v_mfma_f32_16x16x32_bf16 v[192:195], v[32:35], a[168:171], v[192:195]
    s_waitcnt lgkmcnt(5)
    ds_read_b128 a[176:179], v31 offset:0
    v_lshrrev_b32 v97, 5, v2
    v_mfma_f32_16x16x32_bf16 v[224:227], v[32:35], a[172:175], v[224:227]
    ds_read_b128 a[180:183], v31 offset:2048
    v_lshl_add_u32 v96, v97, 11, v96
    v_mfma_f32_16x16x32_bf16 v[132:135], v[36:39], a[160:163], v[132:135]
    ds_read_b64_tr_b16 v[32:33], v8 offset:40960
    v_mfma_f32_16x16x32_bf16 v[164:167], v[36:39], a[164:167], v[164:167]
    ds_read_b64_tr_b16 v[34:35], v8 offset:41984
    v_mfma_f32_16x16x32_bf16 v[196:199], v[36:39], a[168:171], v[196:199]
    ds_read_b128 a[184:187], v31 offset:4096
    v_mfma_f32_16x16x32_bf16 v[228:231], v[36:39], a[172:175], v[228:231]
    ds_read_b128 a[188:191], v31 offset:6144
    v_mfma_f32_16x16x32_bf16 v[136:139], v[40:43], a[160:163], v[136:139]
    ds_read_b64_tr_b16 v[36:37], v9 offset:40960
    v_mfma_f32_16x16x32_bf16 v[168:171], v[40:43], a[164:167], v[168:171]
    ds_read_b64_tr_b16 v[38:39], v9 offset:41984
    v_mfma_f32_16x16x32_bf16 v[200:203], v[40:43], a[168:171], v[200:203]
    buffer_load_dwordx4 v23, s[16:19], s98 offen offset:3072   lds
    v_mfma_f32_16x16x32_bf16 v[232:235], v[40:43], a[172:175], v[232:235]
    v_mfma_f32_16x16x32_bf16 v[140:143], v[44:47], a[160:163], v[140:143]
    s_add_u32 m0, s62, 32768
    s_xor_b32 s98, s96, 896
    ds_read_b64_tr_b16 v[40:41], v10 offset:40960
    v_mfma_f32_16x16x32_bf16 v[172:175], v[44:47], a[164:167], v[172:175]
    ds_read_b64_tr_b16 v[42:43], v10 offset:41984
    v_mfma_f32_16x16x32_bf16 v[204:207], v[44:47], a[168:171], v[204:207]
    buffer_load_dwordx4 v16, s[12:15], s98 offen offset:0   lds
    v_mfma_f32_16x16x32_bf16 v[236:239], v[44:47], a[172:175], v[236:239]
    v_mfma_f32_16x16x32_bf16 v[144:147], v[48:51], a[160:163], v[144:147]
    ds_read_b64_tr_b16 v[44:45], v11 offset:40960
    v_mfma_f32_16x16x32_bf16 v[176:179], v[48:51], a[164:167], v[176:179]
    ds_read_b64_tr_b16 v[46:47], v11 offset:41984
    v_mfma_f32_16x16x32_bf16 v[208:211], v[48:51], a[168:171], v[208:211]
    buffer_load_dwordx4 v17, s[12:15], s98 offen offset:1024   lds
    v_mfma_f32_16x16x32_bf16 v[240:243], v[48:51], a[172:175], v[240:243]
    s_waitcnt lgkmcnt(4)
    v_mfma_f32_16x16x32_bf16 v[148:151], v[52:55], a[160:163], v[148:151]
    ds_read_b64_tr_b16 v[48:49], v12 offset:40960
    v_mfma_f32_16x16x32_bf16 v[180:183], v[52:55], a[164:167], v[180:183]
    ds_read_b64_tr_b16 v[50:51], v12 offset:41984
    v_mfma_f32_16x16x32_bf16 v[212:215], v[52:55], a[168:171], v[212:215]
    buffer_load_dwordx4 v18, s[12:15], s98 offen offset:2048   lds
    v_mfma_f32_16x16x32_bf16 v[244:247], v[52:55], a[172:175], v[244:247]
    v_mfma_f32_16x16x32_bf16 v[152:155], v[56:59], a[160:163], v[152:155]
    ds_read_b64_tr_b16 v[52:53], v13 offset:40960
    v_mfma_f32_16x16x32_bf16 v[184:187], v[56:59], a[164:167], v[184:187]
    ds_read_b64_tr_b16 v[54:55], v13 offset:41984
    v_mfma_f32_16x16x32_bf16 v[216:219], v[56:59], a[168:171], v[216:219]
    buffer_load_dwordx4 v19, s[12:15], s98 offen offset:3072   lds
    v_mfma_f32_16x16x32_bf16 v[248:251], v[56:59], a[172:175], v[248:251]
    v_mfma_f32_16x16x32_bf16 v[156:159], v[60:63], a[160:163], v[156:159]
    s_add_u32 m0, s62, 36864
    s_xor_b32 s98, s96, 33664
    ds_read_b64_tr_b16 v[56:57], v14 offset:40960
    v_mfma_f32_16x16x32_bf16 v[188:191], v[60:63], a[164:167], v[188:191]
    ds_read_b64_tr_b16 v[58:59], v14 offset:41984
    v_mfma_f32_16x16x32_bf16 v[220:223], v[60:63], a[168:171], v[220:223]
    buffer_load_dwordx4 v16, s[12:15], s98 offen offset:0   lds
    v_mfma_f32_16x16x32_bf16 v[252:255], v[60:63], a[172:175], v[252:255]
    v_mfma_f32_16x16x32_bf16 v[128:131], v[32:35], a[176:179], v[128:131]
    ds_read_b64_tr_b16 v[60:61], v15 offset:40960
    v_mfma_f32_16x16x32_bf16 v[160:163], v[32:35], a[180:183], v[160:163]
    ds_read_b64_tr_b16 v[62:63], v15 offset:41984
    v_mfma_f32_16x16x32_bf16 v[192:195], v[32:35], a[184:187], v[192:195]
    buffer_load_dwordx4 v17, s[12:15], s98 offen offset:1024   lds
    v_mfma_f32_16x16x32_bf16 v[224:227], v[32:35], a[188:191], v[224:227]
    v_mfma_f32_16x16x32_bf16 v[132:135], v[36:39], a[176:179], v[132:135]
    buffer_load_dwordx4 v18, s[12:15], s98 offen offset:2048   lds
    v_mfma_f32_16x16x32_bf16 v[164:167], v[36:39], a[180:183], v[164:167]
    v_mfma_f32_16x16x32_bf16 v[196:199], v[36:39], a[184:187], v[196:199]
    buffer_load_dwordx4 v19, s[12:15], s98 offen offset:3072   lds
    v_mfma_f32_16x16x32_bf16 v[228:231], v[36:39], a[188:191], v[228:231]
    s_waitcnt lgkmcnt(2)
    s_waitcnt vmcnt(12)
    v_cmp_le_u32 vcc, s68, v3
    s_cmp_eq_u64 vcc, -1
    s_cbranch_scc0 L_E_slow_1
L_E_ok_2:
    v_mfma_f32_16x16x32_bf16 v[136:139], v[40:43], a[176:179], v[136:139]
    s_waitcnt lgkmcnt(0)
    s_barrier
    v_mfma_f32_16x16x32_bf16 v[168:171], v[40:43], a[180:183], v[168:171]
    s_add_u32 m0, s62, 65536
    s_xor_b32 s98, s64, 0
    ds_read_b64_tr_b16 v[32:33], v8 offset:0
    v_mfma_f32_16x16x32_bf16 v[200:203], v[40:43], a[184:187], v[200:203]
    ds_read_b64_tr_b16 v[34:35], v8 offset:1024
    v_mov_b32 v18, v106
    v_mfma_f32_16x16x32_bf16 v[232:235], v[40:43], a[188:191], v[232:235]
    ds_read_b64_tr_b16 v[36:37], v9 offset:0
    v_mov_b32 v19, v107
    v_mfma_f32_16x16x32_bf16 v[140:143], v[44:47], a[176:179], v[140:143]
    ds_read_b64_tr_b16 v[38:39], v9 offset:1024
    v_mfma_f32_16x16x32_bf16 v[172:175], v[44:47], a[180:183], v[172:175]
    ds_read_b64_tr_b16 v[40:41], v10 offset:0
    v_mfma_f32_16x16x32_bf16 v[204:207], v[44:47], a[184:187], v[204:207]
    ds_read_b64_tr_b16 v[42:43], v10 offset:1024
    v_mfma_f32_16x16x32_bf16 v[236:239], v[44:47], a[188:191], v[236:239]
    ds_read_b128 a[192:195], v28 offset:0
    v_mfma_f32_16x16x32_bf16 v[144:147], v[48:51], a[176:179], v[144:147]
    ds_read_b64_tr_b16 v[44:45], v11 offset:0
    v_mfma_f32_16x16x32_bf16 v[176:179], v[48:51], a[180:183], v[176:179]
    ds_read_b64_tr_b16 v[46:47], v11 offset:1024
    v_mfma_f32_16x16x32_bf16 v[208:211], v[48:51], a[184:187], v[208:211]
    ds_read_b128 a[196:199], v28 offset:2048
    v_mfma_f32_16x16x32_bf16 v[240:243], v[48:51], a[188:191], v[240:243]
    ds_read_b128 a[200:203], v28 offset:4096
    v_mfma_f32_16x16x32_bf16 v[148:151], v[52:55], a[176:179], v[148:151]
    ds_read_b64_tr_b16 v[48:49], v12 offset:0
    v_mfma_f32_16x16x32_bf16 v[180:183], v[52:55], a[180:183], v[180:183]
    ds_read_b64_tr_b16 v[50:51], v12 offset:1024
    v_mfma_f32_16x16x32_bf16 v[212:215], v[52:55], a[184:187], v[212:215]
    ds_read_b128 a[204:207], v28 offset:6144
    v_mfma_f32_16x16x32_bf16 v[244:247], v[52:55], a[188:191], v[244:247]
    buffer_load_dwordx4 v24, s[20:23], s98 offen offset:0   lds
    v_mfma_f32_16x16x32_bf16 v[152:155], v[56:59], a[176:179], v[152:155]
    ds_read_b64_tr_b16 v[52:53], v13 offset:0
    v_mfma_f32_16x16x32_bf16 v[184:187], v[56:59], a[180:183], v[184:187]
    ds_read_b64_tr_b16 v[54:55], v13 offset:1024
    v_mfma_f32_16x16x32_bf16 v[216:219], v[56:59], a[184:187], v[216:219]
    buffer_load_dwordx4 v[80:83], v96, s[8:11], s70 offen
    v_mfma_f32_16x16x32_bf16 v[248:251], v[56:59], a[188:191], v[248:251]
    buffer_load_dwordx4 v25, s[20:23], s98 offen offset:1024   lds
    v_mfma_f32_16x16x32_bf16 v[156:159], v[60:63], a[176:179], v[156:159]
    s_lshl_b32 s80, s2, 6
    s_add_u32 s80, s80, 1310720
    ds_read_b64_tr_b16 v[56:57], v14 offset:0
    v_mfma_f32_16x16x32_bf16 v[188:191], v[60:63], a[180:183], v[188:191]
    s_waitcnt lgkmcnt(6)
    s_add_u32 s70, s70, 12288
    ds_read_b64_tr_b16 v[58:59], v14 offset:1024
    v_mfma_f32_16x16x32_bf16 v[220:223], v[60:63], a[184:187], v[220:223]
    buffer_store_dword v6, v7, s[8:11], s80 offen sc0 sc1
    v_mfma_f32_16x16x32_bf16 v[252:255], v[60:63], a[188:191], v[252:255]
    buffer_load_dwordx4 v26, s[20:23], s98 offen offset:2048   lds
    v_mfma_f32_16x16x32_bf16 v[128:131], v[32:35], a[192:195], v[128:131]
    ds_read_b64_tr_b16 v[60:61], v15 offset:0
    v_mfma_f32_16x16x32_bf16 v[160:163], v[32:35], a[196:199], v[160:163]
    ds_read_b64_tr_b16 v[62:63], v15 offset:1024
    v_mfma_f32_16x16x32_bf16 v[192:195], v[32:35], a[200:203], v[192:195]
    s_waitcnt lgkmcnt(5)
    ds_read_b128 a[208:211], v29 offset:0
    v_mfma_f32_16x16x32_bf16 v[224:227], v[32:35], a[204:207], v[224:227]
    ds_read_b128 a[212:215], v29 offset:2048
    v_mfma_f32_16x16x32_bf16 v[132:135], v[36:39], a[192:195], v[132:135]
    ds_read_b64_tr_b16 v[32:33], v8 offset:8192
    v_mfma_f32_16x16x32_bf16 v[164:167], v[36:39], a[196:199], v[164:167]
    ds_read_b64_tr_b16 v[34:35], v8 offset:9216
    v_mfma_f32_16x16x32_bf16 v[196:199], v[36:39], a[200:203], v[196:199]
    ds_read_b128 a[216:219], v29 offset:4096
    v_mfma_f32_16x16x32_bf16 v[228:231], v[36:39], a[204:207], v[228:231]
    ds_read_b128 a[220:223], v29 offset:6144
    v_mfma_f32_16x16x32_bf16 v[136:139], v[40:43], a[192:195], v[136:139]
    ds_read_b64_tr_b16 v[36:37], v9 offset:8192
    v_mfma_f32_16x16x32_bf16 v[168:171], v[40:43], a[196:199], v[168:171]
    ds_read_b64_tr_b16 v[38:39], v9 offset:9216
    v_mfma_f32_16x16x32_bf16 v[200:203], v[40:43], a[200:203], v[200:203]
    buffer_load_dwordx4 v27, s[20:23], s98 offen offset:3072   lds
    v_mfma_f32_16x16x32_bf16 v[232:235], v[40:43], a[204:207], v[232:235]
    buffer_load_dwordx4 v[84:87], v96, s[8:11], s70 offen
    v_mfma_f32_16x16x32_bf16 v[140:143], v[44:47], a[192:195], v[140:143]
    s_add_u32 m0, s62, 69632
    s_xor_b32 s98, s64, 262144
    ds_read_b64_tr_b16 v[40:41], v10 offset:8192
    v_mfma_f32_16x16x32_bf16 v[172:175], v[44:47], a[196:199], v[172:175]
    s_add_u32 s70, s70, 12288
    ds_read_b64_tr_b16 v[42:43], v10 offset:9216
    v_mfma_f32_16x16x32_bf16 v[204:207], v[44:47], a[200:203], v[204:207]
    buffer_load_dwordx4 v24, s[20:23], s98 offen offset:0   lds
    v_mfma_f32_16x16x32_bf16 v[236:239], v[44:47], a[204:207], v[236:239]
    buffer_load_dwordx4 v[88:91], v96, s[8:11], s70 offen
    v_mfma_f32_16x16x32_bf16 v[144:147], v[48:51], a[192:195], v[144:147]
    s_add_u32 s70, s70, 12288
    ds_read_b64_tr_b16 v[44:45], v11 offset:8192
    v_mfma_f32_16x16x32_bf16 v[176:179], v[48:51], a[196:199], v[176:179]
    s_waitcnt lgkmcnt(5)
    ds_read_b64_tr_b16 v[46:47], v11 offset:9216
    v_mfma_f32_16x16x32_bf16 v[208:211], v[48:51], a[200:203], v[208:211]
    buffer_load_dwordx4 v25, s[20:23], s98 offen offset:1024   lds
    v_mfma_f32_16x16x32_bf16 v[240:243], v[48:51], a[204:207], v[240:243]
    buffer_load_dwordx4 v[92:95], v96, s[8:11], s70 offen
    v_mfma_f32_16x16x32_bf16 v[148:151], v[52:55], a[192:195], v[148:151]
    ds_read_b64_tr_b16 v[48:49], v12 offset:8192
    v_mfma_f32_16x16x32_bf16 v[180:183], v[52:55], a[196:199], v[180:183]
    ds_read_b64_tr_b16 v[50:51], v12 offset:9216
    v_mfma_f32_16x16x32_bf16 v[212:215], v[52:55], a[200:203], v[212:215]
    buffer_load_dwordx4 v26, s[20:23], s98 offen offset:2048   lds
    v_mfma_f32_16x16x32_bf16 v[244:247], v[52:55], a[204:207], v[244:247]
    v_mfma_f32_16x16x32_bf16 v[152:155], v[56:59], a[192:195], v[152:155]
    ds_read_b64_tr_b16 v[52:53], v13 offset:8192
    v_mfma_f32_16x16x32_bf16 v[184:187], v[56:59], a[196:199], v[184:187]
    ds_read_b64_tr_b16 v[54:55], v13 offset:9216
    v_mfma_f32_16x16x32_bf16 v[216:219], v[56:59], a[200:203], v[216:219]
    buffer_load_dwordx4 v27, s[20:23], s98 offen offset:3072   lds
    v_mfma_f32_16x16x32_bf16 v[248:251], v[56:59], a[204:207], v[248:251]
    v_mfma_f32_16x16x32_bf16 v[156:159], v[60:63], a[192:195], v[156:159]
    ds_read_b64_tr_b16 v[56:57], v14 offset:8192
    v_mfma_f32_16x16x32_bf16 v[188:191], v[60:63], a[196:199], v[188:191]
    ds_read_b64_tr_b16 v[58:59], v14 offset:9216
    v_mfma_f32_16x16x32_bf16 v[220:223], v[60:63], a[200:203], v[220:223]
    v_mfma_f32_16x16x32_bf16 v[252:255], v[60:63], a[204:207], v[252:255]
    v_mfma_f32_16x16x32_bf16 v[128:131], v[32:35], a[208:211], v[128:131]
    ds_read_b64_tr_b16 v[60:61], v15 offset:8192
    v_mfma_f32_16x16x32_bf16 v[160:163], v[32:35], a[212:215], v[160:163]
    ds_read_b64_tr_b16 v[62:63], v15 offset:9216
    v_mfma_f32_16x16x32_bf16 v[192:195], v[32:35], a[216:219], v[192:195]
    s_getpc_b64 s[100:101]
L_ct1:
    s_lshr_b32 s99, s2, 3
    s_lshl_b32 s99, s99, 2
    s_add_u32 s99, s99, s3
    s_mul_i32 s99, s99, 2
    v_min_u32 v3, 1, v2
    v_add_u32 v3, s99, v3
    v_lshlrev_b32 v3, 7, v3
    v_add_u32 v3, L_ct1-L_ct1, v3
    v_min_u32 v3, L_attn-L_ct1, v3
    global_load_dword v3, v3, s[100:101]
    v_mfma_f32_16x16x32_bf16 v[224:227], v[32:35], a[220:223], v[224:227]
    s_waitcnt lgkmcnt(4)
    v_mfma_f32_16x16x32_bf16 v[132:135], v[36:39], a[208:211], v[132:135]
    v_mfma_f32_16x16x32_bf16 v[164:167], v[36:39], a[212:215], v[164:167]
    v_mfma_f32_16x16x32_bf16 v[196:199], v[36:39], a[216:219], v[196:199]
    v_mfma_f32_16x16x32_bf16 v[228:231], v[36:39], a[220:223], v[228:231]
    v_mfma_f32_16x16x32_bf16 v[136:139], v[40:43], a[208:211], v[136:139]
    s_waitcnt vmcnt(14) lgkmcnt(0)
    s_barrier
    v_mfma_f32_16x16x32_bf16 v[168:171], v[40:43], a[212:215], v[168:171]
    s_add_u32 m0, s62, 0
    s_xor_b32 s98, s64, 2097152
    ds_read_b64_tr_b16 v[32:33], v8 offset:16384
    v_mfma_f32_16x16x32_bf16 v[200:203], v[40:43], a[216:219], v[200:203]
    ds_read_b64_tr_b16 v[34:35], v8 offset:17408
    v_mfma_f32_16x16x32_bf16 v[232:235], v[40:43], a[220:223], v[232:235]
    ds_read_b64_tr_b16 v[96:97], v8 offset:24576
    v_mfma_f32_16x16x32_bf16 v[140:143], v[44:47], a[208:211], v[140:143]
    ds_read_b64_tr_b16 v[98:99], v8 offset:25600
    v_mfma_f32_16x16x32_bf16 v[172:175], v[44:47], a[212:215], v[172:175]
    ds_read_b128 a[224:227], v28 offset:32768
    v_mfma_f32_16x16x32_bf16 v[204:207], v[44:47], a[216:219], v[204:207]
    ds_read_b128 a[240:243], v29 offset:32768
    v_mfma_f32_16x16x32_bf16 v[236:239], v[44:47], a[220:223], v[236:239]
    ds_read_b64_tr_b16 v[36:37], v9 offset:16384
    v_mfma_f32_16x16x32_bf16 v[144:147], v[48:51], a[208:211], v[144:147]
    ds_read_b64_tr_b16 v[38:39], v9 offset:17408
    v_mfma_f32_16x16x32_bf16 v[176:179], v[48:51], a[212:215], v[176:179]
    ds_read_b64_tr_b16 v[100:101], v9 offset:24576
    v_mfma_f32_16x16x32_bf16 v[208:211], v[48:51], a[216:219], v[208:211]
    ds_read_b64_tr_b16 v[102:103], v9 offset:25600
    v_mfma_f32_16x16x32_bf16 v[240:243], v[48:51], a[220:223], v[240:243]
    ds_read_b128 a[228:231], v28 offset:34816
    v_mfma_f32_16x16x32_bf16 v[148:151], v[52:55], a[208:211], v[148:151]
    ds_read_b128 a[244:247], v29 offset:34816
    v_mfma_f32_16x16x32_bf16 v[180:183], v[52:55], a[212:215], v[180:183]
    ds_read_b128 a[232:235], v28 offset:36864
    v_mfma_f32_16x16x32_bf16 v[212:215], v[52:55], a[216:219], v[212:215]
    ds_read_b128 a[248:251], v29 offset:36864
    v_mfma_f32_16x16x32_bf16 v[244:247], v[52:55], a[220:223], v[244:247]
    ds_read_b128 a[236:239], v28 offset:38912
    v_mfma_f32_16x16x32_bf16 v[152:155], v[56:59], a[208:211], v[152:155]
    ds_read_b128 a[252:255], v29 offset:38912
    v_mfma_f32_16x16x32_bf16 v[184:187], v[56:59], a[212:215], v[184:187]
    ds_read_b64_tr_b16 v[40:41], v10 offset:16384
    v_and_b32 v16, 15, v2
    v_mfma_f32_16x16x32_bf16 v[216:219], v[56:59], a[216:219], v[216:219]
    ds_read_b64_tr_b16 v[42:43], v10 offset:17408
    v_lshrrev_b32 v17, 4, v2
    v_mfma_f32_16x16x32_bf16 v[248:251], v[56:59], a[220:223], v[248:251]
    ds_read_b64_tr_b16 v[104:105], v10 offset:24576
    v_lshrrev_b32 v29, 2, v16
    v_mfma_f32_16x16x32_bf16 v[156:159], v[60:63], a[208:211], v[156:159]
    ds_read_b64_tr_b16 v[106:107], v10 offset:25600
    v_and_b32 v16, 3, v16
    v_mfma_f32_16x16x32_bf16 v[188:191], v[60:63], a[212:215], v[188:191]
    ds_read_b64_tr_b16 v[44:45], v11 offset:16384
    v_lshl_add_u32 v28, v17, 3, v29
    v_mfma_f32_16x16x32_bf16 v[220:223], v[60:63], a[216:219], v[220:223]
    ds_read_b64_tr_b16 v[46:47], v11 offset:17408
    v_lshlrev_b32 v28, 7, v28
    v_mfma_f32_16x16x32_bf16 v[252:255], v[60:63], a[220:223], v[252:255]
    s_waitcnt lgkmcnt(9)
    ds_read_b64_tr_b16 v[108:109], v11 offset:24576
    v_lshl_add_u32 v28, v16, 3, v28
    v_mfma_f32_16x16x32_bf16 v[128:131], v[32:35], a[224:227], v[128:131]
    ds_read_b64_tr_b16 v[110:111], v11 offset:25600
    v_and_b32 v17, 1, v17
    v_mfma_f32_16x16x32_bf16 v[128:131], v[96:99], a[240:243], v[128:131]
    v_lshrrev_b32 v29, 1, v29
    v_lshl_add_u32 v29, v17, 1, v29
    v_mfma_f32_16x16x32_bf16 v[132:135], v[36:39], a[224:227], v[132:135]
    v_lshl_add_u32 v28, v29, 5, v28
    v_add_u32 v28, 65536, v28
    v_mfma_f32_16x16x32_bf16 v[132:135], v[100:103], a[240:243], v[132:135]
    v_xor_b32 v29, 32, v28
    v_xor_b32 v30, 64, v28
    v_mfma_f32_16x16x32_bf16 v[160:163], v[32:35], a[228:231], v[160:163]
    v_xor_b32 v31, 96, v28
    v_and_b32 v16, 15, v2
    v_mfma_f32_16x16x32_bf16 v[160:163], v[96:99], a[244:247], v[160:163]
    v_lshlrev_b32 v16, 6, v16
    v_add_u32 v16, 65536, v16
    s_waitcnt vmcnt(7)
    v_add_f32 v80, v80, v84
    v_mfma_f32_16x16x32_bf16 v[164:167], v[36:39], a[228:231], v[164:167]
    v_mad_i32_i24 v16, v17, s77, v16
    v_and_b32 v17, 31, v2
    s_waitcnt vmcnt(3)
    v_add_f32 v88, v88, v92
    v_mfma_f32_16x16x32_bf16 v[164:167], v[100:103], a[244:247], v[164:167]
    buffer_load_dwordx4 v24, s[20:23], s98 offen offset:0   lds
    v_add_f32 v81, v81, v85
    v_mfma_f32_16x16x32_bf16 v[192:195], v[32:35], a[232:235], v[192:195]
    s_waitcnt lgkmcnt(2)
    ds_read_b64_tr_b16 v[48:49], v12 offset:16384
    v_lshlrev_b32 v17, 6, v17
    v_add_f32 v89, v89, v93
    v_mfma_f32_16x16x32_bf16 v[192:195], v[96:99], a[248:251], v[192:195]
    ds_read_b64_tr_b16 v[50:51], v12 offset:17408
    v_add_f32 v82, v82, v86
    v_add_f32 v90, v90, v94
    v_mfma_f32_16x16x32_bf16 v[196:199], v[36:39], a[232:235], v[196:199]
    ds_read_b64_tr_b16 v[112:113], v12 offset:24576
    v_add_f32 v83, v83, v87
    v_add_f32 v91, v91, v95
    v_mfma_f32_16x16x32_bf16 v[196:199], v[100:103], a[248:251], v[196:199]
    ds_read_b64_tr_b16 v[114:115], v12 offset:25600
    v_add_f32 v80, v80, v88
    v_add_f32 v81, v81, v89
    v_mfma_f32_16x16x32_bf16 v[224:227], v[32:35], a[236:239], v[224:227]
    ds_read_b64_tr_b16 v[52:53], v13 offset:16384
    v_add_f32 v82, v82, v90
    v_add_f32 v83, v83, v91
    v_mfma_f32_16x16x32_bf16 v[224:227], v[96:99], a[252:255], v[224:227]
    ds_read_b64_tr_b16 v[54:55], v13 offset:17408
    v_lshrrev_b32 v88, 5, v2
    v_cvt_f32_u32 v88, v88
    v_mfma_f32_16x16x32_bf16 v[228:231], v[36:39], a[236:239], v[228:231]
    ds_read_b64_tr_b16 v[116:117], v13 offset:24576
    v_cvt_pk_bf16_f32 v84, v80, v81
    v_cvt_pk_bf16_f32 v85, v82, v83
    v_mfma_f32_16x16x32_bf16 v[228:231], v[100:103], a[252:255], v[228:231]
    ds_read_b64_tr_b16 v[118:119], v13 offset:25600
    v_lshlrev_b32 v80, 16, v84
    v_and_b32 v81, 0xffff0000, v84
    v_mfma_f32_16x16x32_bf16 v[136:139], v[40:43], a[224:227], v[136:139]
    buffer_load_dwordx4 v25, s[20:23], s98 offen offset:1024   lds
    v_lshlrev_b32 v82, 16, v85
    v_mfma_f32_16x16x32_bf16 v[136:139], v[104:107], a[240:243], v[136:139]
    s_waitcnt lgkmcnt(8)
    v_and_b32 v83, 0xffff0000, v85
    v_add_f32 v80, v80, v88
    v_add_f32 v81, v81, v88
    v_mfma_f32_16x16x32_bf16 v[140:143], v[44:47], a[224:227], v[140:143]
    buffer_load_dwordx4 v26, s[20:23], s98 offen offset:2048   lds
    v_add_f32 v82, v82, v88
    v_mfma_f32_16x16x32_bf16 v[140:143], v[108:111], a[240:243], v[140:143]
    v_add_f32 v83, v83, v88
    v_cvt_pk_bf16_f32 v84, v80, v81
    v_cvt_pk_bf16_f32 v85, v82, v83
    v_mfma_f32_16x16x32_bf16 v[168:171], v[40:43], a[228:231], v[168:171]
    buffer_load_dwordx4 v27, s[20:23], s98 offen offset:3072   lds
    v_lshlrev_b32 v80, 16, v84
    v_mfma_f32_16x16x32_bf16 v[168:171], v[104:107], a[244:247], v[168:171]
    s_add_u32 m0, s62, 4096
    s_xor_b32 s98, s64, 2359296
    v_and_b32 v81, 0xffff0000, v84
    v_lshlrev_b32 v82, 16, v85
    v_and_b32 v83, 0xffff0000, v85
    v_mfma_f32_16x16x32_bf16 v[172:175], v[44:47], a[228:231], v[172:175]
    buffer_load_dwordx4 v24, s[20:23], s98 offen offset:0   lds
    v_mul_f32 v80, 0x3e0293ee, v80
    v_mfma_f32_16x16x32_bf16 v[172:175], v[108:111], a[244:247], v[172:175]
    v_mul_f32 v81, 0x3e0293ee, v81
    v_mul_f32 v82, 0x3e0293ee, v82
    v_mul_f32 v83, 0x3e0293ee, v83
    v_mfma_f32_16x16x32_bf16 v[200:203], v[40:43], a[232:235], v[200:203]
    s_lshl_b32 s70, s3, 10
    s_add_u32 s70, s70, 151552
    ds_read_b64_tr_b16 v[56:57], v14 offset:16384
    v_add_u32 v88, s70, v1
    v_add_u32 v18, s70, v18
    v_mfma_f32_16x16x32_bf16 v[200:203], v[104:107], a[248:251], v[200:203]
    ds_read_b64_tr_b16 v[58:59], v14 offset:17408
    ds_write_b128 v88, v[80:83]
    v_mfma_f32_16x16x32_bf16 v[204:207], v[44:47], a[232:235], v[204:207]
    ds_read_b64_tr_b16 v[120:121], v14 offset:24576
    v_cvt_pk_bf16_f32 v128, v128, v129
    v_mfma_f32_16x16x32_bf16 v[204:207], v[108:111], a[248:251], v[204:207]
    ds_read_b64_tr_b16 v[122:123], v14 offset:25600
    v_cvt_pk_bf16_f32 v129, v130, v131
    v_mfma_f32_16x16x32_bf16 v[232:235], v[40:43], a[236:239], v[232:235]
    ds_read_b64_tr_b16 v[60:61], v15 offset:16384
    v_cvt_pk_bf16_f32 v130, v132, v133
    v_mfma_f32_16x16x32_bf16 v[232:235], v[104:107], a[252:255], v[232:235]
    ds_read_b64_tr_b16 v[62:63], v15 offset:17408
    v_cvt_pk_bf16_f32 v131, v134, v135
    v_mfma_f32_16x16x32_bf16 v[236:239], v[44:47], a[236:239], v[236:239]
    s_xor_b32 s79, s65, 0
    ds_read_b64_tr_b16 v[124:125], v15 offset:24576
    v_mfma_f32_16x16x32_bf16 v[236:239], v[108:111], a[252:255], v[236:239]
    s_waitcnt lgkmcnt(8)
    ds_read_b64_tr_b16 v[126:127], v15 offset:25600
    v_mfma_f32_16x16x32_bf16 v[144:147], v[48:51], a[224:227], v[144:147]
    buffer_load_dwordx4 v25, s[20:23], s98 offen offset:1024   lds
    v_mfma_f32_16x16x32_bf16 v[144:147], v[112:115], a[240:243], v[144:147]
    ds_read_b128 v[80:83], v18 offset:0
    v_mfma_f32_16x16x32_bf16 v[148:151], v[52:55], a[224:227], v[148:151]
    buffer_load_dwordx4 v26, s[20:23], s98 offen offset:2048   lds
    v_mfma_f32_16x16x32_bf16 v[148:151], v[116:119], a[240:243], v[148:151]
    ds_read_b128 v[84:87], v18 offset:16
    v_mfma_f32_16x16x32_bf16 v[176:179], v[48:51], a[228:231], v[176:179]
    buffer_load_dwordx4 v27, s[20:23], s98 offen offset:3072   lds
    v_mfma_f32_16x16x32_bf16 v[176:179], v[112:115], a[244:247], v[176:179]
    ds_read_b128 v[88:91], v18 offset:512
    v_mfma_f32_16x16x32_bf16 v[180:183], v[52:55], a[228:231], v[180:183]
    ds_read_b128 v[92:95], v18 offset:528
    v_mfma_f32_16x16x32_bf16 v[180:183], v[116:119], a[244:247], v[180:183]
    buffer_store_dwordx4 v[128:131], v1, s[8:11], s79 offen offset:0 sc0 sc1
    v_mfma_f32_16x16x32_bf16 v[208:211], v[48:51], a[232:235], v[208:211]
    v_cvt_pk_bf16_f32 v160, v160, v161
    v_cvt_pk_bf16_f32 v161, v162, v163
    s_waitcnt vmcnt(10) lgkmcnt(0)
    s_barrier
    v_mfma_f32_16x16x32_bf16 v[208:211], v[112:115], a[248:251], v[208:211]
    s_add_u32 m0, s62, 32768
    s_xor_b32 s98, s64, 128
    ds_read_b64_tr_b16 v[32:33], v28 offset:0
    v_mfma_f32_16x16x32_bf16 v[212:215], v[52:55], a[232:235], v[212:215]
    ds_read_b64_tr_b16 v[34:35], v28 offset:512
    v_cvt_pk_bf16_f32 v162, v164, v165
    v_mfma_f32_16x16x32_bf16 v[212:215], v[116:119], a[248:251], v[212:215]
    ds_read_b64_tr_b16 v[36:37], v28 offset:4096
    v_cvt_pk_bf16_f32 v163, v166, v167
    v_mfma_f32_16x16x32_bf16 v[240:243], v[48:51], a[236:239], v[240:243]
    s_xor_b32 s79, s65, 4096
    ds_read_b64_tr_b16 v[38:39], v28 offset:4608
    v_fma_f32 v64, v64, v88, v80
    v_mfma_f32_16x16x32_bf16 v[240:243], v[112:115], a[252:255], v[240:243]
    ds_read_b64_tr_b16 v[40:41], v28 offset:8192
    v_fma_f32 v65, v65, v89, v81
    v_mfma_f32_16x16x32_bf16 v[244:247], v[52:55], a[236:239], v[244:247]
    ds_read_b64_tr_b16 v[42:43], v28 offset:8704
    v_fma_f32 v66, v66, v90, v82
    v_mfma_f32_16x16x32_bf16 v[244:247], v[116:119], a[252:255], v[244:247]
    ds_read_b64_tr_b16 v[44:45], v28 offset:12288
    v_fma_f32 v67, v67, v91, v83
    v_mfma_f32_16x16x32_bf16 v[152:155], v[56:59], a[224:227], v[152:155]
    ds_read_b64_tr_b16 v[46:47], v28 offset:12800
    v_fma_f32 v68, v68, v92, v84
    v_mfma_f32_16x16x32_bf16 v[152:155], v[120:123], a[240:243], v[152:155]
    ds_read_b64_tr_b16 v[48:49], v29 offset:0
    v_fma_f32 v69, v69, v93, v85
    v_mfma_f32_16x16x32_bf16 v[156:159], v[60:63], a[224:227], v[156:159]
    ds_read_b64_tr_b16 v[50:51], v29 offset:512
    v_fma_f32 v70, v70, v94, v86
    v_mfma_f32_16x16x32_bf16 v[156:159], v[124:127], a[240:243], v[156:159]
    ds_read_b64_tr_b16 v[52:53], v29 offset:4096
    v_fma_f32 v71, v71, v95, v87
    v_mfma_f32_16x16x32_bf16 v[184:187], v[56:59], a[228:231], v[184:187]
    ds_read_b64_tr_b16 v[54:55], v29 offset:4608
    v_cvt_pk_bf16_f32 v64, v64, v65
    v_mfma_f32_16x16x32_bf16 v[184:187], v[120:123], a[244:247], v[184:187]
    buffer_load_dwordx4 v24, s[20:23], s98 offen offset:0   lds
    v_mfma_f32_16x16x32_bf16 v[188:191], v[60:63], a[228:231], v[188:191]
    v_cvt_pk_bf16_f32 v65, v66, v67
    v_cvt_pk_bf16_f32 v66, v68, v69
    v_mfma_f32_16x16x32_bf16 v[188:191], v[124:127], a[244:247], v[188:191]
    ds_read_b128 v[80:83], v18 offset:256
    v_cvt_pk_bf16_f32 v67, v70, v71
    v_mfma_f32_16x16x32_bf16 v[216:219], v[56:59], a[232:235], v[216:219]
    buffer_store_dwordx4 v[64:67], v19, s[8:11], s71 offen offset:0 sc0 sc1
    v_mfma_f32_16x16x32_bf16 v[216:219], v[120:123], a[248:251], v[216:219]
    buffer_load_dwordx4 v25, s[20:23], s98 offen offset:1024   lds
    v_mfma_f32_16x16x32_bf16 v[220:223], v[60:63], a[232:235], v[220:223]
    ds_read_b128 v[84:87], v18 offset:272
    v_mfma_f32_16x16x32_bf16 v[220:223], v[124:127], a[248:251], v[220:223]
    ds_read_b128 v[88:91], v18 offset:768
    v_mfma_f32_16x16x32_bf16 v[248:251], v[56:59], a[236:239], v[248:251]
    ds_read_b128 v[92:95], v18 offset:784
    v_mfma_f32_16x16x32_bf16 v[248:251], v[120:123], a[252:255], v[248:251]
    buffer_load_dwordx4 v26, s[20:23], s98 offen offset:2048   lds
    v_mfma_f32_16x16x32_bf16 v[252:255], v[60:63], a[236:239], v[252:255]
    buffer_store_dwordx4 v[160:163], v1, s[8:11], s79 offen offset:0 sc0 sc1
    v_mfma_f32_16x16x32_bf16 v[252:255], v[124:127], a[252:255], v[252:255]
    s_waitcnt lgkmcnt(4)
    v_mfma_f32_16x16x32_bf16 v[96:99], a[0:3], v[32:35], 0
    ds_read_b64_tr_b16 v[56:57], v29 offset:8192
    v_cvt_pk_bf16_f32 v192, v192, v193
    v_mfma_f32_16x16x32_bf16 v[96:99], a[16:19], v[36:39], v[96:99]
    ds_read_b64_tr_b16 v[58:59], v29 offset:8704
    v_cvt_pk_bf16_f32 v193, v194, v195
    v_mfma_f32_16x16x32_bf16 v[96:99], a[32:35], v[40:43], v[96:99]
    ds_read_b64_tr_b16 v[60:61], v29 offset:12288
    s_waitcnt lgkmcnt(4)
    v_fma_f32 v72, v72, v88, v80
    v_mfma_f32_16x16x32_bf16 v[96:99], a[48:51], v[44:47], v[96:99]
    ds_read_b64_tr_b16 v[62:63], v29 offset:12800
    v_fma_f32 v73, v73, v89, v81
    v_mfma_f32_16x16x32_bf16 v[100:103], a[4:7], v[32:35], 0
    buffer_load_dwordx4 v27, s[20:23], s98 offen offset:3072   lds
    v_mfma_f32_16x16x32_bf16 v[100:103], a[20:23], v[36:39], v[100:103]
    s_add_u32 m0, s62, 36864
    s_xor_b32 s98, s64, 262272
    v_fma_f32 v74, v74, v90, v82
    v_mfma_f32_16x16x32_bf16 v[100:103], a[36:39], v[40:43], v[100:103]
    v_fma_f32 v75, v75, v91, v83
    s_waitcnt lgkmcnt(4)
    v_fma_f32 v76, v76, v92, v84
    v_mfma_f32_16x16x32_bf16 v[100:103], a[52:55], v[44:47], v[100:103]
    v_fma_f32 v77, v77, v93, v85
    v_fma_f32 v78, v78, v94, v86
    v_mfma_f32_16x16x32_bf16 v[104:107], a[8:11], v[32:35], 0
    buffer_load_dwordx4 v24, s[20:23], s98 offen offset:0   lds
    v_mfma_f32_16x16x32_bf16 v[104:107], a[24:27], v[36:39], v[104:107]
    v_fma_f32 v79, v79, v95, v87
    v_cvt_pk_bf16_f32 v194, v196, v197
    v_mfma_f32_16x16x32_bf16 v[104:107], a[40:43], v[40:43], v[104:107]
    v_cvt_pk_bf16_f32 v72, v72, v73
    v_cvt_pk_bf16_f32 v73, v74, v75
    v_mfma_f32_16x16x32_bf16 v[104:107], a[56:59], v[44:47], v[104:107]
    v_cvt_pk_bf16_f32 v74, v76, v77
    v_cvt_pk_bf16_f32 v75, v78, v79
    v_mfma_f32_16x16x32_bf16 v[108:111], a[12:15], v[32:35], 0
    buffer_load_dwordx4 v25, s[20:23], s98 offen offset:1024   lds
    v_mfma_f32_16x16x32_bf16 v[108:111], a[28:31], v[36:39], v[108:111]
    ds_read_b64_tr_b16 v[32:33], v28 offset:16384
    v_cvt_pk_bf16_f32 v195, v198, v199
    v_mfma_f32_16x16x32_bf16 v[108:111], a[44:47], v[40:43], v[108:111]
    s_xor_b32 s79, s65, 8192
    ds_read_b64_tr_b16 v[34:35], v28 offset:16896
    v_mfma_f32_16x16x32_bf16 v[108:111], a[60:63], v[44:47], v[108:111]
    ds_read_b64_tr_b16 v[36:37], v28 offset:20480
    v_mfma_f32_16x16x32_bf16 v[112:115], a[0:3], v[48:51], 0
    ds_read_b64_tr_b16 v[38:39], v28 offset:20992
    v_mfma_f32_16x16x32_bf16 v[112:115], a[16:19], v[52:55], v[112:115]
    s_waitcnt lgkmcnt(4)
    ds_read_b64_tr_b16 v[40:41], v28 offset:24576
    v_mfma_f32_16x16x32_bf16 v[112:115], a[32:35], v[56:59], v[112:115]
    ds_read_b64_tr_b16 v[42:43], v28 offset:25088
    v_mfma_f32_16x16x32_bf16 v[112:115], a[48:51], v[60:63], v[112:115]
    ds_read_b64_tr_b16 v[44:45], v28 offset:28672
    v_mfma_f32_16x16x32_bf16 v[116:119], a[4:7], v[48:51], 0
    s_lshr_b32 s100, s2, 3
    s_mul_i32 s66, s4, 28
    ds_read_b64_tr_b16 v[46:47], v28 offset:29184
    v_mfma_f32_16x16x32_bf16 v[116:119], a[20:23], v[52:55], v[116:119]
    buffer_load_dwordx4 v26, s[20:23], s98 offen offset:2048   lds
    v_mfma_f32_16x16x32_bf16 v[116:119], a[36:39], v[56:59], v[116:119]
    buffer_store_dwordx4 v[72:75], v19, s[8:11], s71 offen offset:2048 sc0 sc1
    v_mfma_f32_16x16x32_bf16 v[116:119], a[52:55], v[60:63], v[116:119]
    buffer_store_dwordx4 v[192:195], v1, s[8:11], s79 offen offset:0 sc0 sc1
    v_mfma_f32_16x16x32_bf16 v[120:123], a[8:11], v[48:51], 0
    s_add_u32 s66, s66, s100
    s_cmp_lt_u32 s100, 28
    s_cselect_b32 s66, s66, 255
    s_lshl_b32 s67, s4, 3
    v_mfma_f32_16x16x32_bf16 v[120:123], a[24:27], v[52:55], v[120:123]
    buffer_load_dwordx4 v27, s[20:23], s98 offen offset:3072   lds
    v_mfma_f32_16x16x32_bf16 v[120:123], a[40:43], v[56:59], v[120:123]
    s_add_u32 m0, s63, 131072
    s_xor_b32 s98, s0, 0
    v_cvt_pk_bf16_f32 v224, v224, v225
    v_mfma_f32_16x16x32_bf16 v[120:123], a[56:59], v[60:63], v[120:123]
    s_add_u32 s67, s67, s100
    v_cvt_pk_bf16_f32 v225, v226, v227
    v_cvt_pk_bf16_f32 v226, v228, v229
    v_mfma_f32_16x16x32_bf16 v[124:127], a[12:15], v[48:51], 0
    v_mfma_f32_16x16x32_bf16 v[124:127], a[28:31], v[52:55], v[124:127]
    s_sub_u32 s67, s67, 24
    ds_read_b64_tr_b16 v[48:49], v29 offset:16384
    v_cvt_pk_bf16_f32 v227, v230, v231
    v_mfma_f32_16x16x32_bf16 v[124:127], a[44:47], v[56:59], v[124:127]
    s_xor_b32 s79, s65, 12288
    s_cmp_ge_u32 s100, 24
    s_cselect_b32 s67, s67, 255
    ds_read_b64_tr_b16 v[50:51], v29 offset:16896
    v_mfma_f32_16x16x32_bf16 v[124:127], a[60:63], v[60:63], v[124:127]
    s_waitcnt lgkmcnt(2)
    ds_read_b64_tr_b16 v[52:53], v29 offset:20480
    v_mfma_f32_16x16x32_bf16 v[96:99], a[64:67], v[32:35], v[96:99]
    ds_read_b64_tr_b16 v[54:55], v29 offset:20992
    v_mfma_f32_16x16x32_bf16 v[96:99], a[80:83], v[36:39], v[96:99]
    ds_read_b64_tr_b16 v[56:57], v29 offset:24576
    v_mfma_f32_16x16x32_bf16 v[96:99], a[96:99], v[40:43], v[96:99]
    ds_read_b64_tr_b16 v[58:59], v29 offset:25088
    v_mfma_f32_16x16x32_bf16 v[96:99], a[112:115], v[44:47], v[96:99]
    ds_read_b64_tr_b16 v[60:61], v29 offset:28672
    v_mfma_f32_16x16x32_bf16 v[100:103], a[68:71], v[32:35], v[100:103]
    ds_read_b64_tr_b16 v[62:63], v29 offset:29184
    v_mfma_f32_16x16x32_bf16 v[100:103], a[84:87], v[36:39], v[100:103]
    buffer_load_dwordx4 v20, s[24:27], s98 offen offset:0   lds
    v_mfma_f32_16x16x32_bf16 v[100:103], a[100:103], v[40:43], v[100:103]
    buffer_store_dwordx4 v[224:227], v1, s[8:11], s79 offen offset:0 sc0 sc1
    v_mfma_f32_16x16x32_bf16 v[100:103], a[116:119], v[44:47], v[100:103]
    v_cvt_pk_bf16_f32 v136, v136, v137
    v_cvt_pk_bf16_f32 v137, v138, v139
    v_mfma_f32_16x16x32_bf16 v[104:107], a[72:75], v[32:35], v[104:107]
    v_cvt_pk_bf16_f32 v138, v140, v141
    v_cvt_pk_bf16_f32 v139, v142, v143
    v_mfma_f32_16x16x32_bf16 v[104:107], a[88:91], v[36:39], v[104:107]
    buffer_load_dwordx4 v21, s[24:27], s98 offen offset:1024   lds
    v_mfma_f32_16x16x32_bf16 v[104:107], a[104:107], v[40:43], v[104:107]
    s_xor_b32 s79, s65, 0
    v_mfma_f32_16x16x32_bf16 v[104:107], a[120:123], v[44:47], v[104:107]
    buffer_store_dwordx4 v[136:139], v1, s[8:11], s79 offen offset:1024 sc0 sc1
    v_mfma_f32_16x16x32_bf16 v[108:111], a[76:79], v[32:35], v[108:111]
    v_mfma_f32_16x16x32_bf16 v[108:111], a[92:95], v[36:39], v[108:111]
    ds_read_b64_tr_b16 v[32:33], v30 offset:0
    v_cvt_pk_bf16_f32 v168, v168, v169
    v_mfma_f32_16x16x32_bf16 v[108:111], a[108:111], v[40:43], v[108:111]
    ds_read_b64_tr_b16 v[34:35], v30 offset:512
    v_cvt_pk_bf16_f32 v169, v170, v171
    v_mfma_f32_16x16x32_bf16 v[108:111], a[124:127], v[44:47], v[108:111]
    s_waitcnt lgkmcnt(2)
    ds_read_b64_tr_b16 v[36:37], v30 offset:4096
    v_cvt_pk_bf16_f32 v170, v172, v173
    v_mfma_f32_16x16x32_bf16 v[112:115], a[64:67], v[48:51], v[112:115]
    ds_read_b64_tr_b16 v[38:39], v30 offset:4608
    v_cvt_pk_bf16_f32 v171, v174, v175
    v_mfma_f32_16x16x32_bf16 v[112:115], a[80:83], v[52:55], v[112:115]
    s_xor_b32 s79, s65, 4096
    ds_read_b64_tr_b16 v[40:41], v30 offset:8192
    v_mfma_f32_16x16x32_bf16 v[112:115], a[96:99], v[56:59], v[112:115]
    ds_read_b64_tr_b16 v[42:43], v30 offset:8704
    v_mfma_f32_16x16x32_bf16 v[112:115], a[112:115], v[60:63], v[112:115]
    ds_read_b64_tr_b16 v[44:45], v30 offset:12288
    v_mfma_f32_16x16x32_bf16 v[116:119], a[68:71], v[48:51], v[116:119]
    ds_read_b64_tr_b16 v[46:47], v30 offset:12800
    v_mfma_f32_16x16x32_bf16 v[116:119], a[84:87], v[52:55], v[116:119]
    buffer_load_dwordx4 v22, s[24:27], s98 offen offset:2048   lds
    v_mfma_f32_16x16x32_bf16 v[116:119], a[100:103], v[56:59], v[116:119]
    buffer_store_dwordx4 v[168:171], v1, s[8:11], s79 offen offset:1024 sc0 sc1
    v_mfma_f32_16x16x32_bf16 v[116:119], a[116:119], v[60:63], v[116:119]
    v_cvt_pk_bf16_f32 v200, v200, v201
    v_cvt_pk_bf16_f32 v201, v202, v203
    v_mfma_f32_16x16x32_bf16 v[120:123], a[72:75], v[48:51], v[120:123]
    v_cvt_pk_bf16_f32 v202, v204, v205
    v_cvt_pk_bf16_f32 v203, v206, v207
    v_mfma_f32_16x16x32_bf16 v[120:123], a[88:91], v[52:55], v[120:123]
    buffer_load_dwordx4 v23, s[24:27], s98 offen offset:3072   lds
    v_mfma_f32_16x16x32_bf16 v[120:123], a[104:107], v[56:59], v[120:123]
    s_add_u32 m0, s63, 98304
    s_xor_b32 s98, s0, 524288
    s_xor_b32 s79, s65, 8192
    v_mfma_f32_16x16x32_bf16 v[120:123], a[120:123], v[60:63], v[120:123]
    buffer_store_dwordx4 v[200:203], v1, s[8:11], s79 offen offset:1024 sc0 sc1
    v_mfma_f32_16x16x32_bf16 v[124:127], a[76:79], v[48:51], v[124:127]
    v_mfma_f32_16x16x32_bf16 v[124:127], a[92:95], v[52:55], v[124:127]
    ds_read_b64_tr_b16 v[48:49], v31 offset:0
    v_cvt_pk_bf16_f32 v232, v232, v233
    v_mfma_f32_16x16x32_bf16 v[124:127], a[108:111], v[56:59], v[124:127]
    ds_read_b64_tr_b16 v[50:51], v31 offset:512
    v_cvt_pk_bf16_f32 v233, v234, v235
    v_mfma_f32_16x16x32_bf16 v[124:127], a[124:127], v[60:63], v[124:127]
    s_waitcnt lgkmcnt(2)
    ds_read_b64_tr_b16 v[52:53], v31 offset:4096
    v_cvt_pk_bf16_f32 v234, v236, v237
    v_mfma_f32_16x16x32_bf16 v[64:67], a[0:3], v[32:35], 0
    ds_read_b64_tr_b16 v[54:55], v31 offset:4608
    v_cvt_pk_bf16_f32 v235, v238, v239
    v_mfma_f32_16x16x32_bf16 v[64:67], a[16:19], v[36:39], v[64:67]
    s_xor_b32 s79, s65, 12288
    ds_read_b64_tr_b16 v[56:57], v31 offset:8192
    v_mfma_f32_16x16x32_bf16 v[64:67], a[32:35], v[40:43], v[64:67]
    ds_read_b64_tr_b16 v[58:59], v31 offset:8704
    v_mfma_f32_16x16x32_bf16 v[64:67], a[48:51], v[44:47], v[64:67]
    ds_read_b64_tr_b16 v[60:61], v31 offset:12288
    v_mfma_f32_16x16x32_bf16 v[68:71], a[4:7], v[32:35], 0
    ds_read_b64_tr_b16 v[62:63], v31 offset:12800
    v_mfma_f32_16x16x32_bf16 v[68:71], a[20:23], v[36:39], v[68:71]
    buffer_load_dwordx4 v20, s[24:27], s98 offen offset:0   lds
    v_mfma_f32_16x16x32_bf16 v[68:71], a[36:39], v[40:43], v[68:71]
    buffer_store_dwordx4 v[232:235], v1, s[8:11], s79 offen offset:1024 sc0 sc1
    v_mfma_f32_16x16x32_bf16 v[68:71], a[52:55], v[44:47], v[68:71]
    v_mfma_f32_16x16x32_bf16 v[72:75], a[8:11], v[32:35], 0
    v_mfma_f32_16x16x32_bf16 v[72:75], a[24:27], v[36:39], v[72:75]
    buffer_load_dwordx4 v21, s[24:27], s98 offen offset:1024   lds
    v_mfma_f32_16x16x32_bf16 v[72:75], a[40:43], v[40:43], v[72:75]
    v_cvt_pk_bf16_f32 v144, v144, v145
    v_cvt_pk_bf16_f32 v145, v146, v147
    v_mfma_f32_16x16x32_bf16 v[72:75], a[56:59], v[44:47], v[72:75]
    v_cvt_pk_bf16_f32 v146, v148, v149
    v_cvt_pk_bf16_f32 v147, v150, v151
    v_mfma_f32_16x16x32_bf16 v[76:79], a[12:15], v[32:35], 0
    v_mfma_f32_16x16x32_bf16 v[76:79], a[28:31], v[36:39], v[76:79]
    s_xor_b32 s79, s65, 0
    ds_read_b64_tr_b16 v[32:33], v30 offset:16384
    v_mfma_f32_16x16x32_bf16 v[76:79], a[44:47], v[40:43], v[76:79]
    ds_read_b64_tr_b16 v[34:35], v30 offset:16896
    v_mfma_f32_16x16x32_bf16 v[76:79], a[60:63], v[44:47], v[76:79]
    s_waitcnt lgkmcnt(2)
    ds_read_b64_tr_b16 v[36:37], v30 offset:20480
    v_mfma_f32_16x16x32_bf16 v[80:83], a[0:3], v[48:51], 0
    ds_read_b64_tr_b16 v[38:39], v30 offset:20992
    v_mfma_f32_16x16x32_bf16 v[80:83], a[16:19], v[52:55], v[80:83]
    ds_read_b64_tr_b16 v[40:41], v30 offset:24576
    v_mfma_f32_16x16x32_bf16 v[80:83], a[32:35], v[56:59], v[80:83]
    ds_read_b64_tr_b16 v[42:43], v30 offset:25088
    v_mfma_f32_16x16x32_bf16 v[80:83], a[48:51], v[60:63], v[80:83]
    ds_read_b64_tr_b16 v[44:45], v30 offset:28672
    v_mfma_f32_16x16x32_bf16 v[84:87], a[4:7], v[48:51], 0
    ds_read_b64_tr_b16 v[46:47], v30 offset:29184
    v_mfma_f32_16x16x32_bf16 v[84:87], a[20:23], v[52:55], v[84:87]
    buffer_load_dwordx4 v22, s[24:27], s98 offen offset:2048   lds
    v_mfma_f32_16x16x32_bf16 v[84:87], a[36:39], v[56:59], v[84:87]
    buffer_store_dwordx4 v[144:147], v1, s[8:11], s79 offen offset:2048 sc0 sc1
    v_mfma_f32_16x16x32_bf16 v[84:87], a[52:55], v[60:63], v[84:87]
    v_mfma_f32_16x16x32_bf16 v[88:91], a[8:11], v[48:51], 0
    v_mfma_f32_16x16x32_bf16 v[88:91], a[24:27], v[52:55], v[88:91]
    buffer_load_dwordx4 v23, s[24:27], s98 offen offset:3072   lds
    v_mfma_f32_16x16x32_bf16 v[88:91], a[40:43], v[56:59], v[88:91]
    v_mfma_f32_16x16x32_bf16 v[88:91], a[56:59], v[60:63], v[88:91]
    v_mfma_f32_16x16x32_bf16 v[92:95], a[12:15], v[48:51], 0
    v_cvt_pk_bf16_f32 v176, v176, v177
    v_cvt_pk_bf16_f32 v177, v178, v179
    s_waitcnt vmcnt(16)
    v_mfma_f32_16x16x32_bf16 v[92:95], a[28:31], v[52:55], v[92:95]
    ds_read_b64_tr_b16 v[48:49], v31 offset:16384
    v_cvt_pk_bf16_f32 v178, v180, v181
    v_mfma_f32_16x16x32_bf16 v[92:95], a[44:47], v[56:59], v[92:95]
    ds_read_b64_tr_b16 v[50:51], v31 offset:16896
    v_cvt_pk_bf16_f32 v179, v182, v183
    v_mfma_f32_16x16x32_bf16 v[92:95], a[60:63], v[60:63], v[92:95]
    s_waitcnt lgkmcnt(2)
    s_xor_b32 s79, s65, 4096
    ds_read_b64_tr_b16 v[52:53], v31 offset:20480
    v_mfma_f32_16x16x32_bf16 v[64:67], a[64:67], v[32:35], v[64:67]
    ds_read_b64_tr_b16 v[54:55], v31 offset:20992
    v_mfma_f32_16x16x32_bf16 v[64:67], a[80:83], v[36:39], v[64:67]
    ds_read_b64_tr_b16 v[56:57], v31 offset:24576
    v_mfma_f32_16x16x32_bf16 v[64:67], a[96:99], v[40:43], v[64:67]
    ds_read_b64_tr_b16 v[58:59], v31 offset:25088
    v_mfma_f32_16x16x32_bf16 v[64:67], a[112:115], v[44:47], v[64:67]
    ds_read_b64_tr_b16 v[60:61], v31 offset:28672
    v_mfma_f32_16x16x32_bf16 v[68:71], a[68:71], v[32:35], v[68:71]
    ds_read_b64_tr_b16 v[62:63], v31 offset:29184
    v_mfma_f32_16x16x32_bf16 v[68:71], a[84:87], v[36:39], v[68:71]
    buffer_store_dword v6, v5, s[8:11], s72 offen sc0 sc1
    v_mfma_f32_16x16x32_bf16 v[68:71], a[100:103], v[40:43], v[68:71]
    buffer_store_dwordx4 v[176:179], v1, s[8:11], s79 offen offset:2048 sc0 sc1
    v_mfma_f32_16x16x32_bf16 v[68:71], a[116:119], v[44:47], v[68:71]
    v_mfma_f32_16x16x32_bf16 v[72:75], a[72:75], v[32:35], v[72:75]
    v_mfma_f32_16x16x32_bf16 v[72:75], a[88:91], v[36:39], v[72:75]
    v_mfma_f32_16x16x32_bf16 v[72:75], a[104:107], v[40:43], v[72:75]
    v_cvt_pk_bf16_f32 v208, v208, v209
    v_cvt_pk_bf16_f32 v209, v210, v211
    v_mfma_f32_16x16x32_bf16 v[72:75], a[120:123], v[44:47], v[72:75]
    v_cvt_pk_bf16_f32 v210, v212, v213
    v_cvt_pk_bf16_f32 v211, v214, v215
    v_mfma_f32_16x16x32_bf16 v[76:79], a[76:79], v[32:35], v[76:79]
    v_mfma_f32_16x16x32_bf16 v[76:79], a[92:95], v[36:39], v[76:79]
    v_mfma_f32_16x16x32_bf16 v[76:79], a[108:111], v[40:43], v[76:79]
    s_xor_b32 s79, s65, 8192
    v_xor_b32 v28, 65536, v28
    s_waitcnt lgkmcnt(0)
    s_barrier
    v_mfma_f32_16x16x32_bf16 v[76:79], a[124:127], v[44:47], v[76:79]
    s_add_u32 m0, s62, 65536
    s_xor_b32 s98, s64, 2097280
    ds_read_b64_tr_b16 v[32:33], v28 offset:0
    v_mfma_f32_16x16x32_bf16 v[80:83], a[64:67], v[48:51], v[80:83]
    ds_read_b64_tr_b16 v[34:35], v28 offset:512
    v_mfma_f32_16x16x32_bf16 v[80:83], a[80:83], v[52:55], v[80:83]
    ds_read_b64_tr_b16 v[36:37], v28 offset:4096
    v_mfma_f32_16x16x32_bf16 v[80:83], a[96:99], v[56:59], v[80:83]
    ds_read_b64_tr_b16 v[38:39], v28 offset:4608
    v_mfma_f32_16x16x32_bf16 v[80:83], a[112:115], v[60:63], v[80:83]
    ds_read_b64_tr_b16 v[40:41], v28 offset:8192
    v_mfma_f32_16x16x32_bf16 v[84:87], a[68:71], v[48:51], v[84:87]
    ds_read_b64_tr_b16 v[42:43], v28 offset:8704
    v_mfma_f32_16x16x32_bf16 v[84:87], a[84:87], v[52:55], v[84:87]
    ds_read_b64_tr_b16 v[44:45], v28 offset:12288
    v_mfma_f32_16x16x32_bf16 v[84:87], a[100:103], v[56:59], v[84:87]
    ds_read_b64_tr_b16 v[46:47], v28 offset:12800
    v_mfma_f32_16x16x32_bf16 v[84:87], a[116:119], v[60:63], v[84:87]
    buffer_load_dwordx4 v24, s[20:23], s98 offen offset:0   lds
    v_mfma_f32_16x16x32_bf16 v[88:91], a[72:75], v[48:51], v[88:91]
    buffer_store_dwordx4 v[208:211], v1, s[8:11], s79 offen offset:2048 sc0 sc1
    v_mfma_f32_16x16x32_bf16 v[88:91], a[88:91], v[52:55], v[88:91]
    v_mfma_f32_16x16x32_bf16 v[88:91], a[104:107], v[56:59], v[88:91]
    buffer_load_dwordx4 v25, s[20:23], s98 offen offset:1024   lds
    v_mfma_f32_16x16x32_bf16 v[88:91], a[120:123], v[60:63], v[88:91]
    v_mfma_f32_16x16x32_bf16 v[92:95], a[76:79], v[48:51], v[92:95]
    v_xor_b32 v29, 65536, v29
    v_cvt_pk_bf16_f32 v240, v240, v241
    v_mfma_f32_16x16x32_bf16 v[92:95], a[92:95], v[52:55], v[92:95]
    ds_read_b64_tr_b16 v[48:49], v29 offset:0
    v_cvt_pk_bf16_f32 v241, v242, v243
    v_mfma_f32_16x16x32_bf16 v[92:95], a[108:111], v[56:59], v[92:95]
    ds_read_b64_tr_b16 v[50:51], v29 offset:512
    v_cvt_pk_bf16_f32 v242, v244, v245
    v_mfma_f32_16x16x32_bf16 v[92:95], a[124:127], v[60:63], v[92:95]
    s_waitcnt lgkmcnt(3)
    ds_read_b64_tr_b16 v[52:53], v29 offset:4096
    v_cvt_pk_bf16_f32 v243, v246, v247
    v_mfma_f32_16x16x32_bf16 v[96:99], a[128:131], v[32:35], v[96:99]
    s_xor_b32 s79, s65, 12288
    ds_read_b64_tr_b16 v[54:55], v29 offset:4608
    v_mfma_f32_16x16x32_bf16 v[96:99], a[144:147], v[36:39], v[96:99]
    ds_read_b64_tr_b16 v[56:57], v29 offset:8192
    v_mfma_f32_16x16x32_bf16 v[96:99], a[160:163], v[40:43], v[96:99]
    s_waitcnt lgkmcnt(5)
    ds_read_b64_tr_b16 v[58:59], v29 offset:8704
    v_mfma_f32_16x16x32_bf16 v[96:99], a[176:179], v[44:47], v[96:99]
    ds_read_b64_tr_b16 v[60:61], v29 offset:12288
    v_mfma_f32_16x16x32_bf16 v[100:103], a[132:135], v[32:35], v[100:103]
    ds_read_b64_tr_b16 v[62:63], v29 offset:12800
    v_mfma_f32_16x16x32_bf16 v[100:103], a[148:151], v[36:39], v[100:103]
    buffer_load_dwordx4 v26, s[20:23], s98 offen offset:2048   lds
    v_mfma_f32_16x16x32_bf16 v[100:103], a[164:167], v[40:43], v[100:103]
    buffer_store_dwordx4 v[240:243], v1, s[8:11], s79 offen offset:2048 sc0 sc1
    v_mfma_f32_16x16x32_bf16 v[100:103], a[180:183], v[44:47], v[100:103]
    v_mfma_f32_16x16x32_bf16 v[104:107], a[136:139], v[32:35], v[104:107]
    buffer_load_dwordx4 v27, s[20:23], s98 offen offset:3072   lds
    v_mfma_f32_16x16x32_bf16 v[104:107], a[152:155], v[36:39], v[104:107]
    s_add_u32 m0, s62, 69632
    s_xor_b32 s98, s64, 2359424
    v_mfma_f32_16x16x32_bf16 v[104:107], a[168:171], v[40:43], v[104:107]
    v_cvt_pk_bf16_f32 v152, v152, v153
    v_cvt_pk_bf16_f32 v153, v154, v155
    v_mfma_f32_16x16x32_bf16 v[104:107], a[184:187], v[44:47], v[104:107]
    buffer_load_dwordx4 v24, s[20:23], s98 offen offset:0   lds
    v_mfma_f32_16x16x32_bf16 v[108:111], a[140:143], v[32:35], v[108:111]
    v_cvt_pk_bf16_f32 v154, v156, v157
    v_cvt_pk_bf16_f32 v155, v158, v159
    v_mfma_f32_16x16x32_bf16 v[108:111], a[156:159], v[36:39], v[108:111]
    s_xor_b32 s79, s65, 0
    ds_read_b64_tr_b16 v[32:33], v28 offset:16384
    v_mfma_f32_16x16x32_bf16 v[108:111], a[172:175], v[40:43], v[108:111]
    ds_read_b64_tr_b16 v[34:35], v28 offset:16896
    v_mfma_f32_16x16x32_bf16 v[108:111], a[188:191], v[44:47], v[108:111]
    s_waitcnt lgkmcnt(2)
    ds_read_b64_tr_b16 v[36:37], v28 offset:20480
    v_mfma_f32_16x16x32_bf16 v[112:115], a[128:131], v[48:51], v[112:115]
    ds_read_b64_tr_b16 v[38:39], v28 offset:20992
    v_mfma_f32_16x16x32_bf16 v[112:115], a[144:147], v[52:55], v[112:115]
    ds_read_b64_tr_b16 v[40:41], v28 offset:24576
    v_mfma_f32_16x16x32_bf16 v[112:115], a[160:163], v[56:59], v[112:115]
    ds_read_b64_tr_b16 v[42:43], v28 offset:25088
    v_mfma_f32_16x16x32_bf16 v[112:115], a[176:179], v[60:63], v[112:115]
    ds_read_b64_tr_b16 v[44:45], v28 offset:28672
    v_mfma_f32_16x16x32_bf16 v[116:119], a[132:135], v[48:51], v[116:119]
    ds_read_b64_tr_b16 v[46:47], v28 offset:29184
    v_mfma_f32_16x16x32_bf16 v[116:119], a[148:151], v[52:55], v[116:119]
    buffer_load_dwordx4 v25, s[20:23], s98 offen offset:1024   lds
    v_mfma_f32_16x16x32_bf16 v[116:119], a[164:167], v[56:59], v[116:119]
    buffer_store_dwordx4 v[152:155], v1, s[8:11], s79 offen offset:3072 sc0 sc1
    v_mfma_f32_16x16x32_bf16 v[116:119], a[180:183], v[60:63], v[116:119]
    v_mfma_f32_16x16x32_bf16 v[120:123], a[136:139], v[48:51], v[120:123]
    buffer_load_dwordx4 v26, s[20:23], s98 offen offset:2048   lds
    v_mfma_f32_16x16x32_bf16 v[120:123], a[152:155], v[52:55], v[120:123]
    v_mfma_f32_16x16x32_bf16 v[120:123], a[168:171], v[56:59], v[120:123]
    v_cvt_pk_bf16_f32 v184, v184, v185
    v_cvt_pk_bf16_f32 v185, v186, v187
    v_mfma_f32_16x16x32_bf16 v[120:123], a[184:187], v[60:63], v[120:123]
    buffer_load_dwordx4 v27, s[20:23], s98 offen offset:3072   lds
    v_mfma_f32_16x16x32_bf16 v[124:127], a[140:143], v[48:51], v[124:127]
    v_cvt_pk_bf16_f32 v186, v188, v189
    v_cvt_pk_bf16_f32 v187, v190, v191
    v_mfma_f32_16x16x32_bf16 v[124:127], a[156:159], v[52:55], v[124:127]
    s_add_u32 m0, s63, 114688
    s_xor_b32 s98, s0, 1048576
    ds_read_b64_tr_b16 v[48:49], v29 offset:16384
    v_mfma_f32_16x16x32_bf16 v[124:127], a[172:175], v[56:59], v[124:127]
    s_xor_b32 s79, s65, 4096
    ds_read_b64_tr_b16 v[50:51], v29 offset:16896
    v_mfma_f32_16x16x32_bf16 v[124:127], a[188:191], v[60:63], v[124:127]
    s_waitcnt lgkmcnt(2)
    ds_read_b64_tr_b16 v[52:53], v29 offset:20480
    v_mfma_f32_16x16x32_bf16 v[96:99], a[192:195], v[32:35], v[96:99]
    ds_read_b64_tr_b16 v[54:55], v29 offset:20992
    v_mfma_f32_16x16x32_bf16 v[96:99], a[208:211], v[36:39], v[96:99]
    ds_read_b64_tr_b16 v[56:57], v29 offset:24576
    v_mfma_f32_16x16x32_bf16 v[96:99], a[224:227], v[40:43], v[96:99]
    ds_read_b64_tr_b16 v[58:59], v29 offset:25088
    v_mfma_f32_16x16x32_bf16 v[96:99], a[240:243], v[44:47], v[96:99]
    ds_read_b64_tr_b16 v[60:61], v29 offset:28672
    v_mfma_f32_16x16x32_bf16 v[100:103], a[196:199], v[32:35], v[100:103]
    ds_read_b64_tr_b16 v[62:63], v29 offset:29184
    v_mfma_f32_16x16x32_bf16 v[100:103], a[212:215], v[36:39], v[100:103]
    buffer_load_dwordx4 v20, s[24:27], s98 offen offset:0   lds
    v_mfma_f32_16x16x32_bf16 v[100:103], a[228:231], v[40:43], v[100:103]
    buffer_store_dwordx4 v[184:187], v1, s[8:11], s79 offen offset:3072 sc0 sc1
    v_mfma_f32_16x16x32_bf16 v[100:103], a[244:247], v[44:47], v[100:103]
    v_mfma_f32_16x16x32_bf16 v[104:107], a[200:203], v[32:35], v[104:107]
    buffer_load_dwordx4 v21, s[24:27], s98 offen offset:1024   lds
    v_mfma_f32_16x16x32_bf16 v[104:107], a[216:219], v[36:39], v[104:107]
    v_mfma_f32_16x16x32_bf16 v[104:107], a[232:235], v[40:43], v[104:107]
    v_mfma_f32_16x16x32_bf16 v[104:107], a[248:251], v[44:47], v[104:107]
    buffer_load_dwordx4 v22, s[24:27], s98 offen offset:2048   lds
    v_mfma_f32_16x16x32_bf16 v[108:111], a[204:207], v[32:35], v[108:111]
    v_xor_b32 v30, 65536, v30
    v_cvt_pk_bf16_f32 v216, v216, v217
    v_mfma_f32_16x16x32_bf16 v[108:111], a[220:223], v[36:39], v[108:111]
    ds_read_b64_tr_b16 v[32:33], v30 offset:0
    v_cvt_pk_bf16_f32 v217, v218, v219
    v_mfma_f32_16x16x32_bf16 v[108:111], a[236:239], v[40:43], v[108:111]
    ds_read_b64_tr_b16 v[34:35], v30 offset:512
    v_cvt_pk_bf16_f32 v218, v220, v221
    v_mfma_f32_16x16x32_bf16 v[108:111], a[252:255], v[44:47], v[108:111]
    s_waitcnt lgkmcnt(2)
    ds_read_b64_tr_b16 v[36:37], v30 offset:4096
    v_cvt_pk_bf16_f32 v219, v222, v223
    v_mfma_f32_16x16x32_bf16 v[112:115], a[192:195], v[48:51], v[112:115]
    s_xor_b32 s79, s65, 8192
    ds_read_b64_tr_b16 v[38:39], v30 offset:4608
    v_mfma_f32_16x16x32_bf16 v[112:115], a[208:211], v[52:55], v[112:115]
    ds_read_b64_tr_b16 v[40:41], v30 offset:8192
    v_mfma_f32_16x16x32_bf16 v[112:115], a[224:227], v[56:59], v[112:115]
    ds_read_b64_tr_b16 v[42:43], v30 offset:8704
    v_mfma_f32_16x16x32_bf16 v[112:115], a[240:243], v[60:63], v[112:115]
    ds_read_b64_tr_b16 v[44:45], v30 offset:12288
    v_mfma_f32_16x16x32_bf16 v[116:119], a[196:199], v[48:51], v[116:119]
    ds_read_b64_tr_b16 v[46:47], v30 offset:12800
    v_mfma_f32_16x16x32_bf16 v[116:119], a[212:215], v[52:55], v[116:119]
    buffer_load_dwordx4 v23, s[24:27], s98 offen offset:3072   lds
    v_mfma_f32_16x16x32_bf16 v[116:119], a[228:231], v[56:59], v[116:119]
    s_add_u32 m0, s63, 147456
    s_xor_b32 s98, s0, 1572864
    v_mfma_f32_16x16x32_bf16 v[116:119], a[244:247], v[60:63], v[116:119]
    buffer_store_dwordx4 v[216:219], v1, s[8:11], s79 offen offset:3072 sc0 sc1
    v_mfma_f32_16x16x32_bf16 v[120:123], a[200:203], v[48:51], v[120:123]
    buffer_load_dwordx4 v20, s[24:27], s98 offen offset:0   lds
    v_mfma_f32_16x16x32_bf16 v[120:123], a[216:219], v[52:55], v[120:123]
    v_mfma_f32_16x16x32_bf16 v[120:123], a[232:235], v[56:59], v[120:123]
    v_mfma_f32_16x16x32_bf16 v[120:123], a[248:251], v[60:63], v[120:123]
    buffer_load_dwordx4 v21, s[24:27], s98 offen offset:1024   lds
    v_mfma_f32_16x16x32_bf16 v[124:127], a[204:207], v[48:51], v[124:127]
    v_xor_b32 v31, 65536, v31
    v_mfma_f32_16x16x32_bf16 v[124:127], a[220:223], v[52:55], v[124:127]
    ds_read_b64_tr_b16 v[48:49], v31 offset:0
    v_mfma_f32_16x16x32_bf16 v[124:127], a[236:239], v[56:59], v[124:127]
    ds_read_b64_tr_b16 v[50:51], v31 offset:512
    v_mfma_f32_16x16x32_bf16 v[124:127], a[252:255], v[60:63], v[124:127]
    s_waitcnt lgkmcnt(2)
    ds_read_b64_tr_b16 v[52:53], v31 offset:4096
    v_mfma_f32_16x16x32_bf16 v[64:67], a[128:131], v[32:35], v[64:67]
    ds_read_b64_tr_b16 v[54:55], v31 offset:4608
    v_mfma_f32_16x16x32_bf16 v[64:67], a[144:147], v[36:39], v[64:67]
    ds_read_b64_tr_b16 v[56:57], v31 offset:8192
    v_mfma_f32_16x16x32_bf16 v[64:67], a[160:163], v[40:43], v[64:67]
    ds_read_b64_tr_b16 v[58:59], v31 offset:8704
    v_mfma_f32_16x16x32_bf16 v[64:67], a[176:179], v[44:47], v[64:67]
    ds_read_b64_tr_b16 v[60:61], v31 offset:12288
    v_mfma_f32_16x16x32_bf16 v[68:71], a[132:135], v[32:35], v[68:71]
    ds_read_b64_tr_b16 v[62:63], v31 offset:12800
    v_mfma_f32_16x16x32_bf16 v[68:71], a[148:151], v[36:39], v[68:71]
    buffer_load_dwordx4 v22, s[24:27], s98 offen offset:2048   lds
    v_mfma_f32_16x16x32_bf16 v[68:71], a[164:167], v[40:43], v[68:71]
    v_cvt_pk_bf16_f32 v96, v96, v97
    v_cvt_pk_bf16_f32 v97, v98, v99
    v_mfma_f32_16x16x32_bf16 v[68:71], a[180:183], v[44:47], v[68:71]
    v_cvt_pk_bf16_f32 v98, v100, v101
    v_cvt_pk_bf16_f32 v99, v102, v103
    v_mfma_f32_16x16x32_bf16 v[72:75], a[136:139], v[32:35], v[72:75]
    buffer_load_dwordx4 v23, s[24:27], s98 offen offset:3072   lds
    v_mfma_f32_16x16x32_bf16 v[72:75], a[152:155], v[36:39], v[72:75]
    s_xor_b32 s79, s1, 32768
    v_mfma_f32_16x16x32_bf16 v[72:75], a[168:171], v[40:43], v[72:75]
    buffer_store_dwordx4 v[96:99], v1, s[8:11], s79 offen offset:0 sc0 sc1
    v_mfma_f32_16x16x32_bf16 v[72:75], a[184:187], v[44:47], v[72:75]
    v_mfma_f32_16x16x32_bf16 v[76:79], a[140:143], v[32:35], v[76:79]
    v_mfma_f32_16x16x32_bf16 v[76:79], a[156:159], v[36:39], v[76:79]
    ds_read_b64_tr_b16 v[32:33], v30 offset:16384
    v_mfma_f32_16x16x32_bf16 v[76:79], a[172:175], v[40:43], v[76:79]
    ds_read_b64_tr_b16 v[34:35], v30 offset:16896
    v_mfma_f32_16x16x32_bf16 v[76:79], a[188:191], v[44:47], v[76:79]
    s_waitcnt lgkmcnt(2)
    ds_read_b64_tr_b16 v[36:37], v30 offset:20480
    v_mfma_f32_16x16x32_bf16 v[80:83], a[128:131], v[48:51], v[80:83]
    ds_read_b64_tr_b16 v[38:39], v30 offset:20992
    v_mfma_f32_16x16x32_bf16 v[80:83], a[144:147], v[52:55], v[80:83]
    ds_read_b64_tr_b16 v[40:41], v30 offset:24576
    v_mfma_f32_16x16x32_bf16 v[80:83], a[160:163], v[56:59], v[80:83]
    ds_read_b64_tr_b16 v[42:43], v30 offset:25088
    v_mfma_f32_16x16x32_bf16 v[80:83], a[176:179], v[60:63], v[80:83]
    ds_read_b64_tr_b16 v[44:45], v30 offset:28672
    v_mfma_f32_16x16x32_bf16 v[84:87], a[132:135], v[48:51], v[84:87]
    ds_read_b64_tr_b16 v[46:47], v30 offset:29184
    v_cvt_pk_bf16_f32 v104, v104, v105
    v_mfma_f32_16x16x32_bf16 v[84:87], a[148:151], v[52:55], v[84:87]
    v_cvt_pk_bf16_f32 v105, v106, v107
    v_cvt_pk_bf16_f32 v106, v108, v109
    v_mfma_f32_16x16x32_bf16 v[84:87], a[164:167], v[56:59], v[84:87]
    v_cvt_pk_bf16_f32 v107, v110, v111
    v_mfma_f32_16x16x32_bf16 v[84:87], a[180:183], v[60:63], v[84:87]
    s_xor_b32 s79, s1, 40960
    v_mfma_f32_16x16x32_bf16 v[88:91], a[136:139], v[48:51], v[88:91]
    buffer_store_dwordx4 v[104:107], v1, s[8:11], s79 offen offset:0 sc0 sc1
    v_mfma_f32_16x16x32_bf16 v[88:91], a[152:155], v[52:55], v[88:91]
    v_mfma_f32_16x16x32_bf16 v[88:91], a[168:171], v[56:59], v[88:91]
    v_mfma_f32_16x16x32_bf16 v[88:91], a[184:187], v[60:63], v[88:91]
    v_mfma_f32_16x16x32_bf16 v[92:95], a[140:143], v[48:51], v[92:95]
    v_mfma_f32_16x16x32_bf16 v[92:95], a[156:159], v[52:55], v[92:95]
    ds_read_b64_tr_b16 v[48:49], v31 offset:16384
    v_mfma_f32_16x16x32_bf16 v[92:95], a[172:175], v[56:59], v[92:95]
    ds_read_b64_tr_b16 v[50:51], v31 offset:16896
    v_mfma_f32_16x16x32_bf16 v[92:95], a[188:191], v[60:63], v[92:95]
    s_waitcnt lgkmcnt(2)
    ds_read_b64_tr_b16 v[52:53], v31 offset:20480
    v_mfma_f32_16x16x32_bf16 v[64:67], a[192:195], v[32:35], v[64:67]
    ds_read_b64_tr_b16 v[54:55], v31 offset:20992
    v_mfma_f32_16x16x32_bf16 v[64:67], a[208:211], v[36:39], v[64:67]
    ds_read_b64_tr_b16 v[56:57], v31 offset:24576
    v_mfma_f32_16x16x32_bf16 v[64:67], a[224:227], v[40:43], v[64:67]
    ds_read_b64_tr_b16 v[58:59], v31 offset:25088
    v_cvt_pk_bf16_f32 v112, v112, v113
    v_mfma_f32_16x16x32_bf16 v[64:67], a[240:243], v[44:47], v[64:67]
    ds_read_b64_tr_b16 v[60:61], v31 offset:28672
    v_cvt_pk_bf16_f32 v113, v114, v115
    v_mfma_f32_16x16x32_bf16 v[68:71], a[196:199], v[32:35], v[68:71]
    ds_read_b64_tr_b16 v[62:63], v31 offset:29184
    v_cvt_pk_bf16_f32 v114, v116, v117
    v_mfma_f32_16x16x32_bf16 v[68:71], a[212:215], v[36:39], v[68:71]
    v_cvt_pk_bf16_f32 v115, v118, v119
    v_mfma_f32_16x16x32_bf16 v[68:71], a[228:231], v[40:43], v[68:71]
    s_xor_b32 s79, s1, 32768
    v_mfma_f32_16x16x32_bf16 v[68:71], a[244:247], v[44:47], v[68:71]
    buffer_store_dwordx4 v[112:115], v1, s[8:11], s79 offen offset:1024 sc0 sc1
    v_mfma_f32_16x16x32_bf16 v[72:75], a[200:203], v[32:35], v[72:75]
    v_mfma_f32_16x16x32_bf16 v[72:75], a[216:219], v[36:39], v[72:75]
    v_mfma_f32_16x16x32_bf16 v[72:75], a[232:235], v[40:43], v[72:75]
    v_mfma_f32_16x16x32_bf16 v[72:75], a[248:251], v[44:47], v[72:75]
    v_mfma_f32_16x16x32_bf16 v[76:79], a[204:207], v[32:35], v[76:79]
    v_mfma_f32_16x16x32_bf16 v[76:79], a[220:223], v[36:39], v[76:79]
    v_mfma_f32_16x16x32_bf16 v[76:79], a[236:239], v[40:43], v[76:79]
    s_waitcnt vmcnt(40) lgkmcnt(0)
    s_barrier
    v_mfma_f32_16x16x32_bf16 v[76:79], a[252:255], v[44:47], v[76:79]
    s_add_u32 m0, s63, 0
    s_xor_b32 s98, s0, 2097152
    ds_read_b64_tr_b16 v[32:33], v28 offset:32768
    v_mfma_f32_16x16x32_bf16 v[80:83], a[192:195], v[48:51], v[80:83]
    ds_read_b64_tr_b16 v[34:35], v28 offset:33280
    v_cvt_pk_bf16_f32 v120, v120, v121
    v_mfma_f32_16x16x32_bf16 v[80:83], a[208:211], v[52:55], v[80:83]
    ds_read_b64_tr_b16 v[36:37], v28 offset:36864
    v_cvt_pk_bf16_f32 v121, v122, v123
    v_mfma_f32_16x16x32_bf16 v[80:83], a[224:227], v[56:59], v[80:83]
    ds_read_b64_tr_b16 v[38:39], v28 offset:37376
    v_cvt_pk_bf16_f32 v122, v124, v125
    v_mfma_f32_16x16x32_bf16 v[80:83], a[240:243], v[60:63], v[80:83]
    ds_read_b64_tr_b16 v[40:41], v28 offset:40960
    v_cvt_pk_bf16_f32 v123, v126, v127
    v_mfma_f32_16x16x32_bf16 v[84:87], a[196:199], v[48:51], v[84:87]
    s_xor_b32 s79, s1, 40960
    ds_read_b64_tr_b16 v[42:43], v28 offset:41472
    v_mfma_f32_16x16x32_bf16 v[84:87], a[212:215], v[52:55], v[84:87]
    ds_read_b64_tr_b16 v[44:45], v28 offset:45056
    v_mfma_f32_16x16x32_bf16 v[84:87], a[228:231], v[56:59], v[84:87]
    ds_read_b64_tr_b16 v[46:47], v28 offset:45568
    v_mfma_f32_16x16x32_bf16 v[84:87], a[244:247], v[60:63], v[84:87]
    buffer_load_dwordx4 v20, s[24:27], s98 offen offset:0   lds
    v_mfma_f32_16x16x32_bf16 v[88:91], a[200:203], v[48:51], v[88:91]
    buffer_store_dwordx4 v[120:123], v1, s[8:11], s79 offen offset:1024 sc0 sc1
    v_mfma_f32_16x16x32_bf16 v[88:91], a[216:219], v[52:55], v[88:91]
    v_mfma_f32_16x16x32_bf16 v[88:91], a[232:235], v[56:59], v[88:91]
    v_mfma_f32_16x16x32_bf16 v[88:91], a[248:251], v[60:63], v[88:91]
    v_mfma_f32_16x16x32_bf16 v[92:95], a[204:207], v[48:51], v[92:95]
    v_mfma_f32_16x16x32_bf16 v[92:95], a[220:223], v[52:55], v[92:95]
    ds_read_b64_tr_b16 v[48:49], v29 offset:32768
    v_mfma_f32_16x16x32_bf16 v[92:95], a[236:239], v[56:59], v[92:95]
    ds_read_b64_tr_b16 v[50:51], v29 offset:33280
    v_mfma_f32_16x16x32_bf16 v[92:95], a[252:255], v[60:63], v[92:95]
    s_waitcnt lgkmcnt(3)
    ds_read_b64_tr_b16 v[52:53], v29 offset:36864
    v_mfma_f32_16x16x32_bf16 v[96:99], a[0:3], v[32:35], 0
    ds_read_b64_tr_b16 v[54:55], v29 offset:37376
    v_mfma_f32_16x16x32_bf16 v[96:99], a[16:19], v[36:39], v[96:99]
    ds_read_b64_tr_b16 v[56:57], v29 offset:40960
    v_mfma_f32_16x16x32_bf16 v[96:99], a[32:35], v[40:43], v[96:99]
    s_waitcnt lgkmcnt(5)
    ds_read_b64_tr_b16 v[58:59], v29 offset:41472
    v_mfma_f32_16x16x32_bf16 v[96:99], a[48:51], v[44:47], v[96:99]
    ds_read_b64_tr_b16 v[60:61], v29 offset:45056
    v_mfma_f32_16x16x32_bf16 v[100:103], a[4:7], v[32:35], 0
    ds_read_b64_tr_b16 v[62:63], v29 offset:45568
    v_mfma_f32_16x16x32_bf16 v[100:103], a[20:23], v[36:39], v[100:103]
    buffer_load_dwordx4 v21, s[24:27], s98 offen offset:1024   lds
    v_mfma_f32_16x16x32_bf16 v[100:103], a[36:39], v[40:43], v[100:103]
    v_cvt_pk_bf16_f32 v64, v64, v65
    v_cvt_pk_bf16_f32 v65, v66, v67
    v_mfma_f32_16x16x32_bf16 v[100:103], a[52:55], v[44:47], v[100:103]
    v_cvt_pk_bf16_f32 v66, v68, v69
    v_cvt_pk_bf16_f32 v67, v70, v71
    v_mfma_f32_16x16x32_bf16 v[104:107], a[8:11], v[32:35], 0
    s_xor_b32 s79, s1, 32768
    v_mfma_f32_16x16x32_bf16 v[104:107], a[24:27], v[36:39], v[104:107]
    buffer_store_dwordx4 v[64:67], v1, s[8:11], s79 offen offset:2048 sc0 sc1
    v_mfma_f32_16x16x32_bf16 v[104:107], a[40:43], v[40:43], v[104:107]
    v_mfma_f32_16x16x32_bf16 v[104:107], a[56:59], v[44:47], v[104:107]
    buffer_load_dwordx4 v22, s[24:27], s98 offen offset:2048   lds
    v_mfma_f32_16x16x32_bf16 v[108:111], a[12:15], v[32:35], 0
    v_mfma_f32_16x16x32_bf16 v[108:111], a[28:31], v[36:39], v[108:111]
    ds_read_b64_tr_b16 v[32:33], v28 offset:49152
    v_mfma_f32_16x16x32_bf16 v[108:111], a[44:47], v[40:43], v[108:111]
    ds_read_b64_tr_b16 v[34:35], v28 offset:49664
    v_mfma_f32_16x16x32_bf16 v[108:111], a[60:63], v[44:47], v[108:111]
    s_waitcnt lgkmcnt(2)
    ds_read_b64_tr_b16 v[36:37], v28 offset:53248
    v_mfma_f32_16x16x32_bf16 v[112:115], a[0:3], v[48:51], 0
    ds_read_b64_tr_b16 v[38:39], v28 offset:53760
    v_mfma_f32_16x16x32_bf16 v[112:115], a[16:19], v[52:55], v[112:115]
    ds_read_b64_tr_b16 v[40:41], v28 offset:57344
    v_mfma_f32_16x16x32_bf16 v[112:115], a[32:35], v[56:59], v[112:115]
    ds_read_b64_tr_b16 v[42:43], v28 offset:57856
    v_mfma_f32_16x16x32_bf16 v[112:115], a[48:51], v[60:63], v[112:115]
    ds_read_b64_tr_b16 v[44:45], v28 offset:61440
    v_mfma_f32_16x16x32_bf16 v[116:119], a[4:7], v[48:51], 0
    ds_read_b64_tr_b16 v[46:47], v28 offset:61952
    v_cvt_pk_bf16_f32 v72, v72, v73
    v_mfma_f32_16x16x32_bf16 v[116:119], a[20:23], v[52:55], v[116:119]
    buffer_load_dwordx4 v23, s[24:27], s98 offen offset:3072   lds
    v_mfma_f32_16x16x32_bf16 v[116:119], a[36:39], v[56:59], v[116:119]
    s_add_u32 m0, s63, 16384
    s_xor_b32 s98, s0, 2621440
    v_cvt_pk_bf16_f32 v73, v74, v75
    v_mfma_f32_16x16x32_bf16 v[116:119], a[52:55], v[60:63], v[116:119]
    v_cvt_pk_bf16_f32 v74, v76, v77
    v_cvt_pk_bf16_f32 v75, v78, v79
    v_mfma_f32_16x16x32_bf16 v[120:123], a[8:11], v[48:51], 0
    s_xor_b32 s79, s1, 40960
    v_mfma_f32_16x16x32_bf16 v[120:123], a[24:27], v[52:55], v[120:123]
    buffer_store_dwordx4 v[72:75], v1, s[8:11], s79 offen offset:2048 sc0 sc1
    v_mfma_f32_16x16x32_bf16 v[120:123], a[40:43], v[56:59], v[120:123]
    v_mfma_f32_16x16x32_bf16 v[120:123], a[56:59], v[60:63], v[120:123]
    buffer_load_dwordx4 v20, s[24:27], s98 offen offset:0   lds
    v_mfma_f32_16x16x32_bf16 v[124:127], a[12:15], v[48:51], 0
    v_mfma_f32_16x16x32_bf16 v[124:127], a[28:31], v[52:55], v[124:127]
    ds_read_b64_tr_b16 v[48:49], v29 offset:49152
    v_mfma_f32_16x16x32_bf16 v[124:127], a[44:47], v[56:59], v[124:127]
    ds_read_b64_tr_b16 v[50:51], v29 offset:49664
    v_mfma_f32_16x16x32_bf16 v[124:127], a[60:63], v[60:63], v[124:127]
    s_waitcnt lgkmcnt(2)
    ds_read_b64_tr_b16 v[52:53], v29 offset:53248
    v_mfma_f32_16x16x32_bf16 v[96:99], a[64:67], v[32:35], v[96:99]
    ds_read_b64_tr_b16 v[54:55], v29 offset:53760
    v_mfma_f32_16x16x32_bf16 v[96:99], a[80:83], v[36:39], v[96:99]
    ds_read_b64_tr_b16 v[56:57], v29 offset:57344
    v_mfma_f32_16x16x32_bf16 v[96:99], a[96:99], v[40:43], v[96:99]
    ds_read_b64_tr_b16 v[58:59], v29 offset:57856
    v_cvt_pk_bf16_f32 v80, v80, v81
    v_mfma_f32_16x16x32_bf16 v[96:99], a[112:115], v[44:47], v[96:99]
    ds_read_b64_tr_b16 v[60:61], v29 offset:61440
    v_cvt_pk_bf16_f32 v81, v82, v83
    v_mfma_f32_16x16x32_bf16 v[100:103], a[68:71], v[32:35], v[100:103]
    ds_read_b64_tr_b16 v[62:63], v29 offset:61952
    v_cvt_pk_bf16_f32 v82, v84, v85
    v_mfma_f32_16x16x32_bf16 v[100:103], a[84:87], v[36:39], v[100:103]
    buffer_load_dwordx4 v21, s[24:27], s98 offen offset:1024   lds
    v_mfma_f32_16x16x32_bf16 v[100:103], a[100:103], v[40:43], v[100:103]
    v_cvt_pk_bf16_f32 v83, v86, v87
    v_mfma_f32_16x16x32_bf16 v[100:103], a[116:119], v[44:47], v[100:103]
    s_xor_b32 s79, s1, 32768
    v_mfma_f32_16x16x32_bf16 v[104:107], a[72:75], v[32:35], v[104:107]
    buffer_store_dwordx4 v[80:83], v1, s[8:11], s79 offen offset:3072 sc0 sc1
    v_mfma_f32_16x16x32_bf16 v[104:107], a[88:91], v[36:39], v[104:107]
    v_mfma_f32_16x16x32_bf16 v[104:107], a[104:107], v[40:43], v[104:107]
    v_mfma_f32_16x16x32_bf16 v[104:107], a[120:123], v[44:47], v[104:107]
    buffer_load_dwordx4 v22, s[24:27], s98 offen offset:2048   lds
    v_mfma_f32_16x16x32_bf16 v[108:111], a[76:79], v[32:35], v[108:111]
    v_mfma_f32_16x16x32_bf16 v[108:111], a[92:95], v[36:39], v[108:111]
    ds_read_b64_tr_b16 v[32:33], v30 offset:32768
    v_mfma_f32_16x16x32_bf16 v[108:111], a[108:111], v[40:43], v[108:111]
    ds_read_b64_tr_b16 v[34:35], v30 offset:33280
    v_mfma_f32_16x16x32_bf16 v[108:111], a[124:127], v[44:47], v[108:111]
    s_waitcnt lgkmcnt(2)
    ds_read_b64_tr_b16 v[36:37], v30 offset:36864
    v_mfma_f32_16x16x32_bf16 v[112:115], a[64:67], v[48:51], v[112:115]
    ds_read_b64_tr_b16 v[38:39], v30 offset:37376
    v_cvt_pk_bf16_f32 v88, v88, v89
    v_mfma_f32_16x16x32_bf16 v[112:115], a[80:83], v[52:55], v[112:115]
    ds_read_b64_tr_b16 v[40:41], v30 offset:40960
    v_cvt_pk_bf16_f32 v89, v90, v91
    v_mfma_f32_16x16x32_bf16 v[112:115], a[96:99], v[56:59], v[112:115]
    ds_read_b64_tr_b16 v[42:43], v30 offset:41472
    v_cvt_pk_bf16_f32 v90, v92, v93
    v_mfma_f32_16x16x32_bf16 v[112:115], a[112:115], v[60:63], v[112:115]
    ds_read_b64_tr_b16 v[44:45], v30 offset:45056
    v_cvt_pk_bf16_f32 v91, v94, v95
    v_mfma_f32_16x16x32_bf16 v[116:119], a[68:71], v[48:51], v[116:119]
    s_xor_b32 s79, s1, 40960
    ds_read_b64_tr_b16 v[46:47], v30 offset:45568
    v_mfma_f32_16x16x32_bf16 v[116:119], a[84:87], v[52:55], v[116:119]
    buffer_load_dwordx4 v23, s[24:27], s98 offen offset:3072   lds
    v_mfma_f32_16x16x32_bf16 v[116:119], a[100:103], v[56:59], v[116:119]
    buffer_store_dwordx4 v[88:91], v1, s[8:11], s79 offen offset:3072 sc0 sc1
    v_mfma_f32_16x16x32_bf16 v[116:119], a[116:119], v[60:63], v[116:119]
    v_mfma_f32_16x16x32_bf16 v[120:123], a[72:75], v[48:51], v[120:123]
    v_mfma_f32_16x16x32_bf16 v[120:123], a[88:91], v[52:55], v[120:123]
    v_mfma_f32_16x16x32_bf16 v[120:123], a[104:107], v[56:59], v[120:123]
    v_mfma_f32_16x16x32_bf16 v[120:123], a[120:123], v[60:63], v[120:123]
    v_mfma_f32_16x16x32_bf16 v[124:127], a[76:79], v[48:51], v[124:127]
    v_mfma_f32_16x16x32_bf16 v[124:127], a[92:95], v[52:55], v[124:127]
    ds_read_b64_tr_b16 v[48:49], v31 offset:32768
    v_mfma_f32_16x16x32_bf16 v[124:127], a[108:111], v[56:59], v[124:127]
    ds_read_b64_tr_b16 v[50:51], v31 offset:33280
    v_mfma_f32_16x16x32_bf16 v[124:127], a[124:127], v[60:63], v[124:127]
    s_waitcnt lgkmcnt(2)
    ds_read_b64_tr_b16 v[52:53], v31 offset:36864
    v_mfma_f32_16x16x32_bf16 v[64:67], a[0:3], v[32:35], 0
    ds_read_b64_tr_b16 v[54:55], v31 offset:37376
    v_mfma_f32_16x16x32_bf16 v[64:67], a[16:19], v[36:39], v[64:67]
    ds_read_b64_tr_b16 v[56:57], v31 offset:40960
    v_mfma_f32_16x16x32_bf16 v[64:67], a[32:35], v[40:43], v[64:67]
    ds_read_b64_tr_b16 v[58:59], v31 offset:41472
    v_mfma_f32_16x16x32_bf16 v[64:67], a[48:51], v[44:47], v[64:67]
    ds_read_b64_tr_b16 v[60:61], v31 offset:45056
    v_mfma_f32_16x16x32_bf16 v[68:71], a[4:7], v[32:35], 0
    ds_read_b64_tr_b16 v[62:63], v31 offset:45568
    v_mfma_f32_16x16x32_bf16 v[68:71], a[20:23], v[36:39], v[68:71]
    v_mfma_f32_16x16x32_bf16 v[68:71], a[36:39], v[40:43], v[68:71]
    v_mfma_f32_16x16x32_bf16 v[68:71], a[52:55], v[44:47], v[68:71]
    v_mfma_f32_16x16x32_bf16 v[72:75], a[8:11], v[32:35], 0
    v_mfma_f32_16x16x32_bf16 v[72:75], a[24:27], v[36:39], v[72:75]
    v_mfma_f32_16x16x32_bf16 v[72:75], a[40:43], v[40:43], v[72:75]
    v_cvt_pk_bf16_f32 v248, v248, v249
    v_cvt_pk_bf16_f32 v249, v250, v251
    v_mfma_f32_16x16x32_bf16 v[72:75], a[56:59], v[44:47], v[72:75]
    v_cvt_pk_bf16_f32 v250, v252, v253
    v_cvt_pk_bf16_f32 v251, v254, v255
    v_mfma_f32_16x16x32_bf16 v[76:79], a[12:15], v[32:35], 0
    v_mfma_f32_16x16x32_bf16 v[76:79], a[28:31], v[36:39], v[76:79]
    s_xor_b32 s79, s65, 12288
    ds_read_b64_tr_b16 v[32:33], v30 offset:49152
    v_mfma_f32_16x16x32_bf16 v[76:79], a[44:47], v[40:43], v[76:79]
    ds_read_b64_tr_b16 v[34:35], v30 offset:49664
    v_mfma_f32_16x16x32_bf16 v[76:79], a[60:63], v[44:47], v[76:79]
    s_waitcnt lgkmcnt(2)
    ds_read_b64_tr_b16 v[36:37], v30 offset:53248
    v_mfma_f32_16x16x32_bf16 v[80:83], a[0:3], v[48:51], 0
    ds_read_b64_tr_b16 v[38:39], v30 offset:53760
    v_mfma_f32_16x16x32_bf16 v[80:83], a[16:19], v[52:55], v[80:83]
    ds_read_b64_tr_b16 v[40:41], v30 offset:57344
    v_mfma_f32_16x16x32_bf16 v[80:83], a[32:35], v[56:59], v[80:83]
    ds_read_b64_tr_b16 v[42:43], v30 offset:57856
    v_mfma_f32_16x16x32_bf16 v[80:83], a[48:51], v[60:63], v[80:83]
    ds_read_b64_tr_b16 v[44:45], v30 offset:61440
    v_mfma_f32_16x16x32_bf16 v[84:87], a[4:7], v[48:51], 0
    ds_read_b64_tr_b16 v[46:47], v30 offset:61952
    v_mfma_f32_16x16x32_bf16 v[84:87], a[20:23], v[52:55], v[84:87]
    buffer_store_dwordx4 v[248:251], v1, s[8:11], s79 offen offset:3072 sc0 sc1
    v_mfma_f32_16x16x32_bf16 v[84:87], a[36:39], v[56:59], v[84:87]
    buffer_load_dword v3, v16, s[8:11], s78 offen sc0 sc1
    v_mfma_f32_16x16x32_bf16 v[84:87], a[52:55], v[60:63], v[84:87]
    v_mfma_f32_16x16x32_bf16 v[88:91], a[8:11], v[48:51], 0
    v_mfma_f32_16x16x32_bf16 v[88:91], a[24:27], v[52:55], v[88:91]
    v_mfma_f32_16x16x32_bf16 v[88:91], a[40:43], v[56:59], v[88:91]
    v_mfma_f32_16x16x32_bf16 v[88:91], a[56:59], v[60:63], v[88:91]
    v_mfma_f32_16x16x32_bf16 v[92:95], a[12:15], v[48:51], 0
    v_mfma_f32_16x16x32_bf16 v[92:95], a[28:31], v[52:55], v[92:95]
    ds_read_b64_tr_b16 v[48:49], v31 offset:49152
    v_mfma_f32_16x16x32_bf16 v[92:95], a[44:47], v[56:59], v[92:95]
    ds_read_b64_tr_b16 v[50:51], v31 offset:49664
    v_mfma_f32_16x16x32_bf16 v[92:95], a[60:63], v[60:63], v[92:95]
    s_waitcnt lgkmcnt(2)
    ds_read_b64_tr_b16 v[52:53], v31 offset:53248
    v_mfma_f32_16x16x32_bf16 v[64:67], a[64:67], v[32:35], v[64:67]
    ds_read_b64_tr_b16 v[54:55], v31 offset:53760
    v_mfma_f32_16x16x32_bf16 v[64:67], a[80:83], v[36:39], v[64:67]
    ds_read_b64_tr_b16 v[56:57], v31 offset:57344
    v_mfma_f32_16x16x32_bf16 v[64:67], a[96:99], v[40:43], v[64:67]
    ds_read_b64_tr_b16 v[58:59], v31 offset:57856
    v_mfma_f32_16x16x32_bf16 v[64:67], a[112:115], v[44:47], v[64:67]
    ds_read_b64_tr_b16 v[60:61], v31 offset:61440
    v_mfma_f32_16x16x32_bf16 v[68:71], a[68:71], v[32:35], v[68:71]
    ds_read_b64_tr_b16 v[62:63], v31 offset:61952
    v_mfma_f32_16x16x32_bf16 v[68:71], a[84:87], v[36:39], v[68:71]
    v_mfma_f32_16x16x32_bf16 v[68:71], a[100:103], v[40:43], v[68:71]
    v_mfma_f32_16x16x32_bf16 v[68:71], a[116:119], v[44:47], v[68:71]
    v_mfma_f32_16x16x32_bf16 v[72:75], a[72:75], v[32:35], v[72:75]
    v_mfma_f32_16x16x32_bf16 v[72:75], a[88:91], v[36:39], v[72:75]
    v_mfma_f32_16x16x32_bf16 v[72:75], a[104:107], v[40:43], v[72:75]
    v_mfma_f32_16x16x32_bf16 v[72:75], a[120:123], v[44:47], v[72:75]
    v_mfma_f32_16x16x32_bf16 v[76:79], a[76:79], v[32:35], v[76:79]
    v_mfma_f32_16x16x32_bf16 v[76:79], a[92:95], v[36:39], v[76:79]
    v_mfma_f32_16x16x32_bf16 v[76:79], a[108:111], v[40:43], v[76:79]
    v_xor_b32 v28, 65536, v28
    s_waitcnt vmcnt(28) lgkmcnt(0)
    s_barrier
    v_mfma_f32_16x16x32_bf16 v[76:79], a[124:127], v[44:47], v[76:79]
    s_add_u32 m0, s63, 32768
    s_xor_b32 s98, s0, 3145728
    ds_read_b64_tr_b16 v[32:33], v28 offset:0
    v_mfma_f32_16x16x32_bf16 v[80:83], a[64:67], v[48:51], v[80:83]
    ds_read_b64_tr_b16 v[34:35], v28 offset:512
    v_mfma_f32_16x16x32_bf16 v[80:83], a[80:83], v[52:55], v[80:83]
    ds_read_b64_tr_b16 v[36:37], v28 offset:4096
    v_mfma_f32_16x16x32_bf16 v[80:83], a[96:99], v[56:59], v[80:83]
    ds_read_b64_tr_b16 v[38:39], v28 offset:4608
    v_mfma_f32_16x16x32_bf16 v[80:83], a[112:115], v[60:63], v[80:83]
    ds_read_b64_tr_b16 v[40:41], v28 offset:8192
    v_mfma_f32_16x16x32_bf16 v[84:87], a[68:71], v[48:51], v[84:87]
    ds_read_b64_tr_b16 v[42:43], v28 offset:8704
    v_mfma_f32_16x16x32_bf16 v[84:87], a[84:87], v[52:55], v[84:87]
    ds_read_b64_tr_b16 v[44:45], v28 offset:12288
    v_mfma_f32_16x16x32_bf16 v[84:87], a[100:103], v[56:59], v[84:87]
    ds_read_b64_tr_b16 v[46:47], v28 offset:12800
    v_mfma_f32_16x16x32_bf16 v[84:87], a[116:119], v[60:63], v[84:87]
    buffer_load_dwordx4 v20, s[24:27], s98 offen offset:0   lds
    v_mfma_f32_16x16x32_bf16 v[88:91], a[72:75], v[48:51], v[88:91]
    v_mfma_f32_16x16x32_bf16 v[88:91], a[88:91], v[52:55], v[88:91]
    v_mfma_f32_16x16x32_bf16 v[88:91], a[104:107], v[56:59], v[88:91]
    v_mfma_f32_16x16x32_bf16 v[88:91], a[120:123], v[60:63], v[88:91]
    v_mfma_f32_16x16x32_bf16 v[92:95], a[76:79], v[48:51], v[92:95]
    v_xor_b32 v29, 65536, v29
    v_mfma_f32_16x16x32_bf16 v[92:95], a[92:95], v[52:55], v[92:95]
    ds_read_b64_tr_b16 v[48:49], v29 offset:0
    v_mfma_f32_16x16x32_bf16 v[92:95], a[108:111], v[56:59], v[92:95]
    ds_read_b64_tr_b16 v[50:51], v29 offset:512
    v_mfma_f32_16x16x32_bf16 v[92:95], a[124:127], v[60:63], v[92:95]
    s_waitcnt lgkmcnt(3)
    ds_read_b64_tr_b16 v[52:53], v29 offset:4096
    v_mfma_f32_16x16x32_bf16 v[96:99], a[128:131], v[32:35], v[96:99]
    ds_read_b64_tr_b16 v[54:55], v29 offset:4608
    s_waitcnt vmcnt(1)
    v_cmp_ne_u32 vcc, 0, v3
    s_cmp_eq_u64 vcc, -1
    s_cbranch_scc0 L_H_slow_3
L_H_ok_4:
    v_mfma_f32_16x16x32_bf16 v[96:99], a[144:147], v[36:39], v[96:99]
    ds_read_b64_tr_b16 v[56:57], v29 offset:8192
    v_mfma_f32_16x16x32_bf16 v[96:99], a[160:163], v[40:43], v[96:99]
    s_waitcnt lgkmcnt(5)
    s_xor_b32 s80, s75, 0
    ds_read_b64_tr_b16 v[58:59], v29 offset:8704
    v_mfma_f32_16x16x32_bf16 v[96:99], a[176:179], v[44:47], v[96:99]
    ds_read_b64_tr_b16 v[60:61], v29 offset:12288
    v_mfma_f32_16x16x32_bf16 v[100:103], a[132:135], v[32:35], v[100:103]
    ds_read_b64_tr_b16 v[62:63], v29 offset:12800
    v_mfma_f32_16x16x32_bf16 v[100:103], a[148:151], v[36:39], v[100:103]
    buffer_load_dwordx4 v21, s[24:27], s98 offen offset:1024   lds
    v_mfma_f32_16x16x32_bf16 v[100:103], a[164:167], v[40:43], v[100:103]
    buffer_load_dwordx4 a[0:3], v1, s[8:11], s80 offen offset:0
    v_mfma_f32_16x16x32_bf16 v[100:103], a[180:183], v[44:47], v[100:103]
    v_mfma_f32_16x16x32_bf16 v[104:107], a[136:139], v[32:35], v[104:107]
    s_xor_b32 s80, s75, 16384
    v_mfma_f32_16x16x32_bf16 v[104:107], a[152:155], v[36:39], v[104:107]
    buffer_load_dwordx4 a[4:7], v1, s[8:11], s80 offen offset:0
    v_mfma_f32_16x16x32_bf16 v[104:107], a[168:171], v[40:43], v[104:107]
    v_mfma_f32_16x16x32_bf16 v[104:107], a[184:187], v[44:47], v[104:107]
    buffer_load_dwordx4 v22, s[24:27], s98 offen offset:2048   lds
    v_mfma_f32_16x16x32_bf16 v[108:111], a[140:143], v[32:35], v[108:111]
    v_mfma_f32_16x16x32_bf16 v[108:111], a[156:159], v[36:39], v[108:111]
    ds_read_b64_tr_b16 v[32:33], v28 offset:16384
    v_mfma_f32_16x16x32_bf16 v[108:111], a[172:175], v[40:43], v[108:111]
    ds_read_b64_tr_b16 v[34:35], v28 offset:16896
    v_mfma_f32_16x16x32_bf16 v[108:111], a[188:191], v[44:47], v[108:111]
    s_waitcnt lgkmcnt(2)
    s_xor_b32 s80, s76, 0
    ds_read_b64_tr_b16 v[36:37], v28 offset:20480
    v_mfma_f32_16x16x32_bf16 v[112:115], a[128:131], v[48:51], v[112:115]
    ds_read_b64_tr_b16 v[38:39], v28 offset:20992
    v_mfma_f32_16x16x32_bf16 v[112:115], a[144:147], v[52:55], v[112:115]
    ds_read_b64_tr_b16 v[40:41], v28 offset:24576
    v_mfma_f32_16x16x32_bf16 v[112:115], a[160:163], v[56:59], v[112:115]
    ds_read_b64_tr_b16 v[42:43], v28 offset:25088
    v_mfma_f32_16x16x32_bf16 v[112:115], a[176:179], v[60:63], v[112:115]
    ds_read_b64_tr_b16 v[44:45], v28 offset:28672
    v_mfma_f32_16x16x32_bf16 v[116:119], a[132:135], v[48:51], v[116:119]
    ds_read_b64_tr_b16 v[46:47], v28 offset:29184
    v_mfma_f32_16x16x32_bf16 v[116:119], a[148:151], v[52:55], v[116:119]
    buffer_load_dwordx4 v23, s[24:27], s98 offen offset:3072   lds
    v_mfma_f32_16x16x32_bf16 v[116:119], a[164:167], v[56:59], v[116:119]
    s_add_u32 m0, s63, 49152
    s_xor_b32 s98, s0, 3670016
    v_mfma_f32_16x16x32_bf16 v[116:119], a[180:183], v[60:63], v[116:119]
    buffer_load_dwordx4 a[8:11], v1, s[8:11], s80 offen offset:0
    v_mfma_f32_16x16x32_bf16 v[120:123], a[136:139], v[48:51], v[120:123]
    s_xor_b32 s80, s76, 16384
    v_mfma_f32_16x16x32_bf16 v[120:123], a[152:155], v[52:55], v[120:123]
    buffer_load_dwordx4 a[12:15], v1, s[8:11], s80 offen offset:0
    v_mfma_f32_16x16x32_bf16 v[120:123], a[168:171], v[56:59], v[120:123]
    v_mfma_f32_16x16x32_bf16 v[120:123], a[184:187], v[60:63], v[120:123]
    buffer_load_dwordx4 v20, s[24:27], s98 offen offset:0   lds
    v_mfma_f32_16x16x32_bf16 v[124:127], a[140:143], v[48:51], v[124:127]
    v_mfma_f32_16x16x32_bf16 v[124:127], a[156:159], v[52:55], v[124:127]
    s_xor_b32 s80, s75, 0
    ds_read_b64_tr_b16 v[48:49], v29 offset:16384
    v_mfma_f32_16x16x32_bf16 v[124:127], a[172:175], v[56:59], v[124:127]
    ds_read_b64_tr_b16 v[50:51], v29 offset:16896
    v_mfma_f32_16x16x32_bf16 v[124:127], a[188:191], v[60:63], v[124:127]
    s_waitcnt lgkmcnt(2)
    ds_read_b64_tr_b16 v[52:53], v29 offset:20480
    v_mfma_f32_16x16x32_bf16 v[96:99], a[192:195], v[32:35], v[96:99]
    ds_read_b64_tr_b16 v[54:55], v29 offset:20992
    v_mfma_f32_16x16x32_bf16 v[96:99], a[208:211], v[36:39], v[96:99]
    ds_read_b64_tr_b16 v[56:57], v29 offset:24576
    v_mfma_f32_16x16x32_bf16 v[96:99], a[224:227], v[40:43], v[96:99]
    ds_read_b64_tr_b16 v[58:59], v29 offset:25088
    v_mfma_f32_16x16x32_bf16 v[96:99], a[240:243], v[44:47], v[96:99]
    ds_read_b64_tr_b16 v[60:61], v29 offset:28672
    v_mfma_f32_16x16x32_bf16 v[100:103], a[196:199], v[32:35], v[100:103]
    ds_read_b64_tr_b16 v[62:63], v29 offset:29184
    v_mfma_f32_16x16x32_bf16 v[100:103], a[212:215], v[36:39], v[100:103]
    buffer_load_dwordx4 v21, s[24:27], s98 offen offset:1024   lds
    v_mfma_f32_16x16x32_bf16 v[100:103], a[228:231], v[40:43], v[100:103]
    buffer_load_dwordx4 a[16:19], v1, s[8:11], s80 offen offset:1024
    v_mfma_f32_16x16x32_bf16 v[100:103], a[244:247], v[44:47], v[100:103]
    s_xor_b32 s80, s75, 16384
    v_mfma_f32_16x16x32_bf16 v[104:107], a[200:203], v[32:35], v[104:107]
    buffer_load_dwordx4 a[20:23], v1, s[8:11], s80 offen offset:1024
    v_mfma_f32_16x16x32_bf16 v[104:107], a[216:219], v[36:39], v[104:107]
    v_mfma_f32_16x16x32_bf16 v[104:107], a[232:235], v[40:43], v[104:107]
    v_mfma_f32_16x16x32_bf16 v[104:107], a[248:251], v[44:47], v[104:107]
    buffer_load_dwordx4 v22, s[24:27], s98 offen offset:2048   lds
    v_mfma_f32_16x16x32_bf16 v[108:111], a[204:207], v[32:35], v[108:111]
    s_xor_b32 s80, s76, 0
    v_xor_b32 v30, 65536, v30
    v_mfma_f32_16x16x32_bf16 v[108:111], a[220:223], v[36:39], v[108:111]
    ds_read_b64_tr_b16 v[32:33], v30 offset:0
    v_mfma_f32_16x16x32_bf16 v[108:111], a[236:239], v[40:43], v[108:111]
    ds_read_b64_tr_b16 v[34:35], v30 offset:512
    v_mfma_f32_16x16x32_bf16 v[108:111], a[252:255], v[44:47], v[108:111]
    s_waitcnt lgkmcnt(2)
    ds_read_b64_tr_b16 v[36:37], v30 offset:4096
    v_mfma_f32_16x16x32_bf16 v[112:115], a[192:195], v[48:51], v[112:115]
    ds_read_b64_tr_b16 v[38:39], v30 offset:4608
    v_mfma_f32_16x16x32_bf16 v[112:115], a[208:211], v[52:55], v[112:115]
    ds_read_b64_tr_b16 v[40:41], v30 offset:8192
    v_mfma_f32_16x16x32_bf16 v[112:115], a[224:227], v[56:59], v[112:115]
    ds_read_b64_tr_b16 v[42:43], v30 offset:8704
    v_mfma_f32_16x16x32_bf16 v[112:115], a[240:243], v[60:63], v[112:115]
    ds_read_b64_tr_b16 v[44:45], v30 offset:12288
    v_mfma_f32_16x16x32_bf16 v[116:119], a[196:199], v[48:51], v[116:119]
    ds_read_b64_tr_b16 v[46:47], v30 offset:12800
    v_mfma_f32_16x16x32_bf16 v[116:119], a[212:215], v[52:55], v[116:119]
    buffer_load_dwordx4 v23, s[24:27], s98 offen offset:3072   lds
    v_mfma_f32_16x16x32_bf16 v[116:119], a[228:231], v[56:59], v[116:119]
    buffer_load_dwordx4 a[24:27], v1, s[8:11], s80 offen offset:1024
    v_mfma_f32_16x16x32_bf16 v[116:119], a[244:247], v[60:63], v[116:119]
    s_xor_b32 s80, s76, 16384
    v_mfma_f32_16x16x32_bf16 v[120:123], a[200:203], v[48:51], v[120:123]
    buffer_load_dwordx4 a[28:31], v1, s[8:11], s80 offen offset:1024
    v_mfma_f32_16x16x32_bf16 v[120:123], a[216:219], v[52:55], v[120:123]
    s_xor_b32 s80, s75, 2048
    v_mfma_f32_16x16x32_bf16 v[120:123], a[232:235], v[56:59], v[120:123]
    buffer_load_dwordx4 a[32:35], v1, s[8:11], s80 offen offset:0
    v_mfma_f32_16x16x32_bf16 v[120:123], a[248:251], v[60:63], v[120:123]
    v_mfma_f32_16x16x32_bf16 v[124:127], a[204:207], v[48:51], v[124:127]
    v_xor_b32 v31, 65536, v31
    v_mfma_f32_16x16x32_bf16 v[124:127], a[220:223], v[52:55], v[124:127]
    ds_read_b64_tr_b16 v[48:49], v31 offset:0
    v_mfma_f32_16x16x32_bf16 v[124:127], a[236:239], v[56:59], v[124:127]
    ds_read_b64_tr_b16 v[50:51], v31 offset:512
    v_mfma_f32_16x16x32_bf16 v[124:127], a[252:255], v[60:63], v[124:127]
    s_waitcnt lgkmcnt(2)
    ds_read_b64_tr_b16 v[52:53], v31 offset:4096
    v_mfma_f32_16x16x32_bf16 v[64:67], a[128:131], v[32:35], v[64:67]
    s_xor_b32 s80, s75, 18432
    ds_read_b64_tr_b16 v[54:55], v31 offset:4608
    v_mfma_f32_16x16x32_bf16 v[64:67], a[144:147], v[36:39], v[64:67]
    ds_read_b64_tr_b16 v[56:57], v31 offset:8192
    v_mfma_f32_16x16x32_bf16 v[64:67], a[160:163], v[40:43], v[64:67]
    ds_read_b64_tr_b16 v[58:59], v31 offset:8704
    v_mfma_f32_16x16x32_bf16 v[64:67], a[176:179], v[44:47], v[64:67]
    ds_read_b64_tr_b16 v[60:61], v31 offset:12288
    v_mfma_f32_16x16x32_bf16 v[68:71], a[132:135], v[32:35], v[68:71]
    ds_read_b64_tr_b16 v[62:63], v31 offset:12800
    v_mfma_f32_16x16x32_bf16 v[68:71], a[148:151], v[36:39], v[68:71]
    buffer_load_dwordx4 a[36:39], v1, s[8:11], s80 offen offset:0
    v_mfma_f32_16x16x32_bf16 v[68:71], a[164:167], v[40:43], v[68:71]
    v_cvt_pk_bf16_f32 v96, v96, v97
    v_cvt_pk_bf16_f32 v97, v98, v99
    v_mfma_f32_16x16x32_bf16 v[68:71], a[180:183], v[44:47], v[68:71]
    s_xor_b32 s80, s76, 2048
    v_cvt_pk_bf16_f32 v98, v100, v101
    v_cvt_pk_bf16_f32 v99, v102, v103
    v_mfma_f32_16x16x32_bf16 v[72:75], a[136:139], v[32:35], v[72:75]
    s_xor_b32 s79, s1, 36864
    v_mfma_f32_16x16x32_bf16 v[72:75], a[152:155], v[36:39], v[72:75]
    buffer_store_dwordx4 v[96:99], v1, s[8:11], s79 offen offset:0 sc0 sc1
    v_mfma_f32_16x16x32_bf16 v[72:75], a[168:171], v[40:43], v[72:75]
    buffer_load_dwordx4 a[40:43], v1, s[8:11], s80 offen offset:0
    v_mfma_f32_16x16x32_bf16 v[72:75], a[184:187], v[44:47], v[72:75]
    v_mfma_f32_16x16x32_bf16 v[76:79], a[140:143], v[32:35], v[76:79]
    v_mfma_f32_16x16x32_bf16 v[76:79], a[156:159], v[36:39], v[76:79]
    ds_read_b64_tr_b16 v[32:33], v30 offset:16384
    v_mfma_f32_16x16x32_bf16 v[76:79], a[172:175], v[40:43], v[76:79]
    s_xor_b32 s80, s76, 18432
    ds_read_b64_tr_b16 v[34:35], v30 offset:16896
    v_mfma_f32_16x16x32_bf16 v[76:79], a[188:191], v[44:47], v[76:79]
    s_waitcnt lgkmcnt(2)
    ds_read_b64_tr_b16 v[36:37], v30 offset:20480
    v_mfma_f32_16x16x32_bf16 v[80:83], a[128:131], v[48:51], v[80:83]
    ds_read_b64_tr_b16 v[38:39], v30 offset:20992
    v_mfma_f32_16x16x32_bf16 v[80:83], a[144:147], v[52:55], v[80:83]
    ds_read_b64_tr_b16 v[40:41], v30 offset:24576
    v_mfma_f32_16x16x32_bf16 v[80:83], a[160:163], v[56:59], v[80:83]
    ds_read_b64_tr_b16 v[42:43], v30 offset:25088
    v_mfma_f32_16x16x32_bf16 v[80:83], a[176:179], v[60:63], v[80:83]
    ds_read_b64_tr_b16 v[44:45], v30 offset:28672
    v_mfma_f32_16x16x32_bf16 v[84:87], a[132:135], v[48:51], v[84:87]
    ds_read_b64_tr_b16 v[46:47], v30 offset:29184
    v_mfma_f32_16x16x32_bf16 v[84:87], a[148:151], v[52:55], v[84:87]
    buffer_load_dwordx4 a[44:47], v1, s[8:11], s80 offen offset:0
    v_mfma_f32_16x16x32_bf16 v[84:87], a[164:167], v[56:59], v[84:87]
    s_xor_b32 s80, s75, 2048
    v_cvt_pk_bf16_f32 v104, v104, v105
    v_cvt_pk_bf16_f32 v105, v106, v107
    v_mfma_f32_16x16x32_bf16 v[84:87], a[180:183], v[60:63], v[84:87]
    v_cvt_pk_bf16_f32 v106, v108, v109
    v_cvt_pk_bf16_f32 v107, v110, v111
    v_mfma_f32_16x16x32_bf16 v[88:91], a[136:139], v[48:51], v[88:91]
    s_xor_b32 s79, s1, 45056
    v_mfma_f32_16x16x32_bf16 v[88:91], a[152:155], v[52:55], v[88:91]
    buffer_store_dwordx4 v[104:107], v1, s[8:11], s79 offen offset:0 sc0 sc1
    v_mfma_f32_16x16x32_bf16 v[88:91], a[168:171], v[56:59], v[88:91]
    buffer_load_dwordx4 a[48:51], v1, s[8:11], s80 offen offset:1024
    v_mfma_f32_16x16x32_bf16 v[88:91], a[184:187], v[60:63], v[88:91]
    v_mfma_f32_16x16x32_bf16 v[92:95], a[140:143], v[48:51], v[92:95]
    v_mfma_f32_16x16x32_bf16 v[92:95], a[156:159], v[52:55], v[92:95]
    s_xor_b32 s80, s75, 18432
    ds_read_b64_tr_b16 v[48:49], v31 offset:16384
    v_mfma_f32_16x16x32_bf16 v[92:95], a[172:175], v[56:59], v[92:95]
    ds_read_b64_tr_b16 v[50:51], v31 offset:16896
    v_mfma_f32_16x16x32_bf16 v[92:95], a[188:191], v[60:63], v[92:95]
    s_waitcnt lgkmcnt(2)
    ds_read_b64_tr_b16 v[52:53], v31 offset:20480
    v_mfma_f32_16x16x32_bf16 v[64:67], a[192:195], v[32:35], v[64:67]
    ds_read_b64_tr_b16 v[54:55], v31 offset:20992
    v_mfma_f32_16x16x32_bf16 v[64:67], a[208:211], v[36:39], v[64:67]
    ds_read_b64_tr_b16 v[56:57], v31 offset:24576
    v_mfma_f32_16x16x32_bf16 v[64:67], a[224:227], v[40:43], v[64:67]
    ds_read_b64_tr_b16 v[58:59], v31 offset:25088
    v_mfma_f32_16x16x32_bf16 v[64:67], a[240:243], v[44:47], v[64:67]
    ds_read_b64_tr_b16 v[60:61], v31 offset:28672
    v_mfma_f32_16x16x32_bf16 v[68:71], a[196:199], v[32:35], v[68:71]
    ds_read_b64_tr_b16 v[62:63], v31 offset:29184
    v_mfma_f32_16x16x32_bf16 v[68:71], a[212:215], v[36:39], v[68:71]
    buffer_load_dwordx4 a[52:55], v1, s[8:11], s80 offen offset:1024
    v_mfma_f32_16x16x32_bf16 v[68:71], a[228:231], v[40:43], v[68:71]
    s_xor_b32 s80, s76, 2048
    v_cvt_pk_bf16_f32 v112, v112, v113
    v_cvt_pk_bf16_f32 v113, v114, v115
    v_mfma_f32_16x16x32_bf16 v[68:71], a[244:247], v[44:47], v[68:71]
    v_cvt_pk_bf16_f32 v114, v116, v117
    v_cvt_pk_bf16_f32 v115, v118, v119
    v_mfma_f32_16x16x32_bf16 v[72:75], a[200:203], v[32:35], v[72:75]
    s_xor_b32 s79, s1, 36864
    v_mfma_f32_16x16x32_bf16 v[72:75], a[216:219], v[36:39], v[72:75]
    buffer_store_dwordx4 v[112:115], v1, s[8:11], s79 offen offset:1024 sc0 sc1
    v_mfma_f32_16x16x32_bf16 v[72:75], a[232:235], v[40:43], v[72:75]
    buffer_load_dwordx4 a[56:59], v1, s[8:11], s80 offen offset:1024
    v_mfma_f32_16x16x32_bf16 v[72:75], a[248:251], v[44:47], v[72:75]
    s_xor_b32 s80, s76, 18432
    v_mfma_f32_16x16x32_bf16 v[76:79], a[204:207], v[32:35], v[76:79]
    buffer_load_dwordx4 a[60:63], v1, s[8:11], s80 offen offset:1024
    v_mfma_f32_16x16x32_bf16 v[76:79], a[220:223], v[36:39], v[76:79]
    v_mfma_f32_16x16x32_bf16 v[76:79], a[236:239], v[40:43], v[76:79]
    s_waitcnt lgkmcnt(0)
    s_barrier
    v_mfma_f32_16x16x32_bf16 v[76:79], a[252:255], v[44:47], v[76:79]
    ds_read_b64_tr_b16 v[32:33], v8 offset:32768
    v_mfma_f32_16x16x32_bf16 v[80:83], a[192:195], v[48:51], v[80:83]
    ds_read_b64_tr_b16 v[34:35], v8 offset:33792
    v_mfma_f32_16x16x32_bf16 v[80:83], a[208:211], v[52:55], v[80:83]
    s_xor_b32 s80, s75, 4096
    ds_read_b64_tr_b16 v[36:37], v9 offset:32768
    v_mfma_f32_16x16x32_bf16 v[80:83], a[224:227], v[56:59], v[80:83]
    ds_read_b64_tr_b16 v[38:39], v9 offset:33792
    v_mfma_f32_16x16x32_bf16 v[80:83], a[240:243], v[60:63], v[80:83]
    ds_read_b64_tr_b16 v[40:41], v10 offset:32768
    v_mfma_f32_16x16x32_bf16 v[84:87], a[196:199], v[48:51], v[84:87]
    ds_read_b64_tr_b16 v[42:43], v10 offset:33792
    v_mfma_f32_16x16x32_bf16 v[84:87], a[212:215], v[52:55], v[84:87]
    ds_read_b64_tr_b16 v[44:45], v11 offset:32768
    v_mfma_f32_16x16x32_bf16 v[84:87], a[228:231], v[56:59], v[84:87]
    ds_read_b64_tr_b16 v[46:47], v11 offset:33792
    v_cvt_pk_bf16_f32 v120, v120, v121
    v_mfma_f32_16x16x32_bf16 v[84:87], a[244:247], v[60:63], v[84:87]
    v_cvt_pk_bf16_f32 v121, v122, v123
    v_cvt_pk_bf16_f32 v122, v124, v125
    v_mfma_f32_16x16x32_bf16 v[88:91], a[200:203], v[48:51], v[88:91]
    v_cvt_pk_bf16_f32 v123, v126, v127
    v_mfma_f32_16x16x32_bf16 v[88:91], a[216:219], v[52:55], v[88:91]
    s_xor_b32 s79, s1, 45056
    v_mfma_f32_16x16x32_bf16 v[88:91], a[232:235], v[56:59], v[88:91]
    buffer_store_dwordx4 v[120:123], v1, s[8:11], s79 offen offset:1024 sc0 sc1
    v_mfma_f32_16x16x32_bf16 v[88:91], a[248:251], v[60:63], v[88:91]
    buffer_load_dwordx4 a[64:67], v1, s[8:11], s80 offen offset:0
    v_mfma_f32_16x16x32_bf16 v[92:95], a[204:207], v[48:51], v[92:95]
    v_mfma_f32_16x16x32_bf16 v[92:95], a[220:223], v[52:55], v[92:95]
    s_xor_b32 s80, s75, 20480
    ds_read_b64_tr_b16 v[48:49], v12 offset:32768
    v_mfma_f32_16x16x32_bf16 v[92:95], a[236:239], v[56:59], v[92:95]
    ds_read_b64_tr_b16 v[50:51], v12 offset:33792
    v_mfma_f32_16x16x32_bf16 v[92:95], a[252:255], v[60:63], v[92:95]
    s_waitcnt vmcnt(26) lgkmcnt(3)
    ds_read_b64_tr_b16 v[52:53], v13 offset:32768
    v_mfma_f32_16x16x32_bf16 v[128:131], v[32:35], a[0:3], 0
    s_waitcnt vmcnt(25)
    ds_read_b64_tr_b16 v[54:55], v13 offset:33792
    v_mfma_f32_16x16x32_bf16 v[160:163], v[32:35], a[4:7], 0
    s_waitcnt vmcnt(22)
    ds_read_b64_tr_b16 v[56:57], v14 offset:32768
    v_mfma_f32_16x16x32_bf16 v[192:195], v[32:35], a[8:11], 0
    s_waitcnt vmcnt(21)
    ds_read_b64_tr_b16 v[58:59], v14 offset:33792
    v_mfma_f32_16x16x32_bf16 v[224:227], v[32:35], a[12:15], 0
    ds_read_b64_tr_b16 v[60:61], v15 offset:32768
    v_mfma_f32_16x16x32_bf16 v[132:135], v[36:39], a[0:3], 0
    ds_read_b64_tr_b16 v[62:63], v15 offset:33792
    v_mfma_f32_16x16x32_bf16 v[164:167], v[36:39], a[4:7], 0
    ds_read_b64_tr_b16 v[32:33], v8 offset:40960
    v_mfma_f32_16x16x32_bf16 v[196:199], v[36:39], a[8:11], 0
    ds_read_b64_tr_b16 v[34:35], v8 offset:41984
    v_cvt_pk_bf16_f32 v64, v64, v65
    v_mfma_f32_16x16x32_bf16 v[228:231], v[36:39], a[12:15], 0
    buffer_load_dwordx4 a[68:71], v1, s[8:11], s80 offen offset:0
    v_mfma_f32_16x16x32_bf16 v[136:139], v[40:43], a[0:3], 0
    s_xor_b32 s80, s76, 4096
    ds_read_b64_tr_b16 v[36:37], v9 offset:40960
    v_cvt_pk_bf16_f32 v65, v66, v67
    v_mfma_f32_16x16x32_bf16 v[168:171], v[40:43], a[4:7], 0
    ds_read_b64_tr_b16 v[38:39], v9 offset:41984
    v_cvt_pk_bf16_f32 v66, v68, v69
    v_mfma_f32_16x16x32_bf16 v[200:203], v[40:43], a[8:11], 0
    s_waitcnt lgkmcnt(8)
    v_cvt_pk_bf16_f32 v67, v70, v71
    v_mfma_f32_16x16x32_bf16 v[232:235], v[40:43], a[12:15], 0
    buffer_load_dwordx4 a[72:75], v1, s[8:11], s80 offen offset:0
    v_mfma_f32_16x16x32_bf16 v[140:143], v[44:47], a[0:3], 0
    s_xor_b32 s79, s1, 36864
    s_xor_b32 s80, s76, 20480
    ds_read_b64_tr_b16 v[40:41], v10 offset:40960
    v_mfma_f32_16x16x32_bf16 v[172:175], v[44:47], a[4:7], 0
    ds_read_b64_tr_b16 v[42:43], v10 offset:41984
    v_mfma_f32_16x16x32_bf16 v[204:207], v[44:47], a[8:11], 0
    buffer_store_dwordx4 v[64:67], v1, s[8:11], s79 offen offset:2048 sc0 sc1
    v_mfma_f32_16x16x32_bf16 v[236:239], v[44:47], a[12:15], 0
    buffer_load_dwordx4 a[76:79], v1, s[8:11], s80 offen offset:0
    v_mfma_f32_16x16x32_bf16 v[144:147], v[48:51], a[0:3], 0
    s_xor_b32 s80, s75, 4096
    ds_read_b64_tr_b16 v[44:45], v11 offset:40960
    v_mfma_f32_16x16x32_bf16 v[176:179], v[48:51], a[4:7], 0
    ds_read_b64_tr_b16 v[46:47], v11 offset:41984
    v_mfma_f32_16x16x32_bf16 v[208:211], v[48:51], a[8:11], 0
    buffer_load_dwordx4 a[80:83], v1, s[8:11], s80 offen offset:1024
    v_mfma_f32_16x16x32_bf16 v[240:243], v[48:51], a[12:15], 0
    v_mfma_f32_16x16x32_bf16 v[148:151], v[52:55], a[0:3], 0
    s_xor_b32 s80, s75, 20480
    ds_read_b64_tr_b16 v[48:49], v12 offset:40960
    v_mfma_f32_16x16x32_bf16 v[180:183], v[52:55], a[4:7], 0
    ds_read_b64_tr_b16 v[50:51], v12 offset:41984
    v_mfma_f32_16x16x32_bf16 v[212:215], v[52:55], a[8:11], 0
    buffer_load_dwordx4 a[84:87], v1, s[8:11], s80 offen offset:1024
    v_mfma_f32_16x16x32_bf16 v[244:247], v[52:55], a[12:15], 0
    s_waitcnt lgkmcnt(4)
    v_mfma_f32_16x16x32_bf16 v[152:155], v[56:59], a[0:3], 0
    ds_read_b64_tr_b16 v[52:53], v13 offset:40960
    v_cvt_pk_bf16_f32 v72, v72, v73
    v_mfma_f32_16x16x32_bf16 v[184:187], v[56:59], a[4:7], 0
    ds_read_b64_tr_b16 v[54:55], v13 offset:41984
    v_cvt_pk_bf16_f32 v73, v74, v75
    v_mfma_f32_16x16x32_bf16 v[216:219], v[56:59], a[8:11], 0
    v_cvt_pk_bf16_f32 v74, v76, v77
    v_cvt_pk_bf16_f32 v75, v78, v79
    v_mfma_f32_16x16x32_bf16 v[248:251], v[56:59], a[12:15], 0
    v_mfma_f32_16x16x32_bf16 v[156:159], v[60:63], a[0:3], 0
    s_xor_b32 s79, s1, 45056
    s_xor_b32 s80, s76, 4096
    ds_read_b64_tr_b16 v[56:57], v14 offset:40960
    v_mfma_f32_16x16x32_bf16 v[188:191], v[60:63], a[4:7], 0
    s_waitcnt vmcnt(24)
    ds_read_b64_tr_b16 v[58:59], v14 offset:41984
    v_mfma_f32_16x16x32_bf16 v[220:223], v[60:63], a[8:11], 0
    buffer_store_dwordx4 v[72:75], v1, s[8:11], s79 offen offset:2048 sc0 sc1
    v_mfma_f32_16x16x32_bf16 v[252:255], v[60:63], a[12:15], 0
    buffer_load_dwordx4 a[88:91], v1, s[8:11], s80 offen offset:1024
    v_mfma_f32_16x16x32_bf16 v[128:131], v[32:35], a[16:19], v[128:131]
    s_waitcnt vmcnt(25)
    ds_read_b64_tr_b16 v[60:61], v15 offset:40960
    v_mfma_f32_16x16x32_bf16 v[160:163], v[32:35], a[20:23], v[160:163]
    s_waitcnt vmcnt(22)
    ds_read_b64_tr_b16 v[62:63], v15 offset:41984
    v_mfma_f32_16x16x32_bf16 v[192:195], v[32:35], a[24:27], v[192:195]
    s_waitcnt vmcnt(21)
    v_mfma_f32_16x16x32_bf16 v[224:227], v[32:35], a[28:31], v[224:227]
    v_mfma_f32_16x16x32_bf16 v[132:135], v[36:39], a[16:19], v[132:135]
    s_xor_b32 s80, s76, 20480
    ds_read_b64_tr_b16 v[32:33], v8 offset:0
    v_mfma_f32_16x16x32_bf16 v[164:167], v[36:39], a[20:23], v[164:167]
    ds_read_b64_tr_b16 v[34:35], v8 offset:1024
    v_mfma_f32_16x16x32_bf16 v[196:199], v[36:39], a[24:27], v[196:199]
    buffer_load_dwordx4 a[92:95], v1, s[8:11], s80 offen offset:1024
    v_mfma_f32_16x16x32_bf16 v[228:231], v[36:39], a[28:31], v[228:231]
    v_mfma_f32_16x16x32_bf16 v[136:139], v[40:43], a[16:19], v[136:139]
    ds_read_b64_tr_b16 v[36:37], v9 offset:0
    v_cvt_pk_bf16_f32 v80, v80, v81
    v_mfma_f32_16x16x32_bf16 v[168:171], v[40:43], a[20:23], v[168:171]
    s_xor_b32 s80, s75, 6144
    ds_read_b64_tr_b16 v[38:39], v9 offset:1024
    v_cvt_pk_bf16_f32 v81, v82, v83
    v_mfma_f32_16x16x32_bf16 v[200:203], v[40:43], a[24:27], v[200:203]
    s_waitcnt lgkmcnt(5)
    v_cvt_pk_bf16_f32 v82, v84, v85
    v_cvt_pk_bf16_f32 v83, v86, v87
    v_mfma_f32_16x16x32_bf16 v[232:235], v[40:43], a[28:31], v[232:235]
    buffer_load_dwordx4 a[96:99], v1, s[8:11], s80 offen offset:0
    v_mfma_f32_16x16x32_bf16 v[140:143], v[44:47], a[16:19], v[140:143]
    s_xor_b32 s79, s1, 36864
    ds_read_b64_tr_b16 v[40:41], v10 offset:0
    v_mfma_f32_16x16x32_bf16 v[172:175], v[44:47], a[20:23], v[172:175]
    ds_read_b64_tr_b16 v[42:43], v10 offset:1024
    v_mfma_f32_16x16x32_bf16 v[204:207], v[44:47], a[24:27], v[204:207]
    buffer_store_dwordx4 v[80:83], v1, s[8:11], s79 offen offset:3072 sc0 sc1
    v_mfma_f32_16x16x32_bf16 v[236:239], v[44:47], a[28:31], v[236:239]
    v_mfma_f32_16x16x32_bf16 v[144:147], v[48:51], a[16:19], v[144:147]
    s_xor_b32 s80, s75, 22528
    ds_read_b64_tr_b16 v[44:45], v11 offset:0
    v_mfma_f32_16x16x32_bf16 v[176:179], v[48:51], a[20:23], v[176:179]
    ds_read_b64_tr_b16 v[46:47], v11 offset:1024
    v_mfma_f32_16x16x32_bf16 v[208:211], v[48:51], a[24:27], v[208:211]
    buffer_load_dwordx4 a[100:103], v1, s[8:11], s80 offen offset:0
    v_mfma_f32_16x16x32_bf16 v[240:243], v[48:51], a[28:31], v[240:243]
    v_mfma_f32_16x16x32_bf16 v[148:151], v[52:55], a[16:19], v[148:151]
    ds_read_b64_tr_b16 v[48:49], v12 offset:0
    v_mfma_f32_16x16x32_bf16 v[180:183], v[52:55], a[20:23], v[180:183]
    ds_read_b64_tr_b16 v[50:51], v12 offset:1024
    v_mfma_f32_16x16x32_bf16 v[212:215], v[52:55], a[24:27], v[212:215]
    v_mfma_f32_16x16x32_bf16 v[244:247], v[52:55], a[28:31], v[244:247]
    v_mfma_f32_16x16x32_bf16 v[152:155], v[56:59], a[16:19], v[152:155]
    s_xor_b32 s80, s76, 6144
    ds_read_b64_tr_b16 v[52:53], v13 offset:0
    v_cvt_pk_bf16_f32 v88, v88, v89
    v_mfma_f32_16x16x32_bf16 v[184:187], v[56:59], a[20:23], v[184:187]
    ds_read_b64_tr_b16 v[54:55], v13 offset:1024
    v_cvt_pk_bf16_f32 v89, v90, v91
    v_mfma_f32_16x16x32_bf16 v[216:219], v[56:59], a[24:27], v[216:219]
    s_waitcnt lgkmcnt(5)
    v_cvt_pk_bf16_f32 v90, v92, v93
    v_cvt_pk_bf16_f32 v91, v94, v95
    v_mfma_f32_16x16x32_bf16 v[248:251], v[56:59], a[28:31], v[248:251]
    buffer_load_dwordx4 a[104:107], v1, s[8:11], s80 offen offset:0
    v_mfma_f32_16x16x32_bf16 v[156:159], v[60:63], a[16:19], v[156:159]
    s_xor_b32 s79, s1, 45056
    ds_read_b64_tr_b16 v[56:57], v14 offset:0
    v_mfma_f32_16x16x32_bf16 v[188:191], v[60:63], a[20:23], v[188:191]
    ds_read_b64_tr_b16 v[58:59], v14 offset:1024
    v_mfma_f32_16x16x32_bf16 v[220:223], v[60:63], a[24:27], v[220:223]
    buffer_store_dwordx4 v[88:91], v1, s[8:11], s79 offen offset:3072 sc0 sc1
    v_mfma_f32_16x16x32_bf16 v[252:255], v[60:63], a[28:31], v[252:255]
    s_waitcnt vmcnt(26)
    v_mfma_f32_16x16x32_bf16 v[128:131], v[32:35], a[32:35], v[128:131]
    s_waitcnt vmcnt(25)
    s_xor_b32 s80, s76, 22528
    ds_read_b64_tr_b16 v[60:61], v15 offset:0
    v_mfma_f32_16x16x32_bf16 v[160:163], v[32:35], a[36:39], v[160:163]
    s_waitcnt vmcnt(22)
    ds_read_b64_tr_b16 v[62:63], v15 offset:1024
    v_mfma_f32_16x16x32_bf16 v[192:195], v[32:35], a[40:43], v[192:195]
    buffer_load_dwordx4 a[108:111], v1, s[8:11], s80 offen offset:0
    v_mfma_f32_16x16x32_bf16 v[224:227], v[32:35], a[44:47], v[224:227]
    v_mfma_f32_16x16x32_bf16 v[132:135], v[36:39], a[32:35], v[132:135]
    ds_read_b64_tr_b16 v[32:33], v8 offset:8192
    v_mfma_f32_16x16x32_bf16 v[164:167], v[36:39], a[36:39], v[164:167]
    s_xor_b32 s80, s75, 6144
    ds_read_b64_tr_b16 v[34:35], v8 offset:9216
    v_mfma_f32_16x16x32_bf16 v[196:199], v[36:39], a[40:43], v[196:199]
    buffer_load_dwordx4 a[112:115], v1, s[8:11], s80 offen offset:1024
    v_mfma_f32_16x16x32_bf16 v[228:231], v[36:39], a[44:47], v[228:231]
    v_mfma_f32_16x16x32_bf16 v[136:139], v[40:43], a[32:35], v[136:139]
    ds_read_b64_tr_b16 v[36:37], v9 offset:8192
    v_mfma_f32_16x16x32_bf16 v[168:171], v[40:43], a[36:39], v[168:171]
    ds_read_b64_tr_b16 v[38:39], v9 offset:9216
    v_mfma_f32_16x16x32_bf16 v[200:203], v[40:43], a[40:43], v[200:203]
    v_mfma_f32_16x16x32_bf16 v[232:235], v[40:43], a[44:47], v[232:235]
    s_waitcnt lgkmcnt(4)
    v_mfma_f32_16x16x32_bf16 v[140:143], v[44:47], a[32:35], v[140:143]
    s_xor_b32 s80, s75, 22528
    ds_read_b64_tr_b16 v[40:41], v10 offset:8192
    v_mfma_f32_16x16x32_bf16 v[172:175], v[44:47], a[36:39], v[172:175]
    ds_read_b64_tr_b16 v[42:43], v10 offset:9216
    v_mfma_f32_16x16x32_bf16 v[204:207], v[44:47], a[40:43], v[204:207]
    buffer_load_dwordx4 a[116:119], v1, s[8:11], s80 offen offset:1024
    v_mfma_f32_16x16x32_bf16 v[236:239], v[44:47], a[44:47], v[236:239]
    v_mfma_f32_16x16x32_bf16 v[144:147], v[48:51], a[32:35], v[144:147]
    ds_read_b64_tr_b16 v[44:45], v11 offset:8192
    v_mfma_f32_16x16x32_bf16 v[176:179], v[48:51], a[36:39], v[176:179]
    ds_read_b64_tr_b16 v[46:47], v11 offset:9216
    v_mfma_f32_16x16x32_bf16 v[208:211], v[48:51], a[40:43], v[208:211]
    v_mfma_f32_16x16x32_bf16 v[240:243], v[48:51], a[44:47], v[240:243]
    v_mfma_f32_16x16x32_bf16 v[148:151], v[52:55], a[32:35], v[148:151]
    s_xor_b32 s80, s76, 6144
    ds_read_b64_tr_b16 v[48:49], v12 offset:8192
    v_mfma_f32_16x16x32_bf16 v[180:183], v[52:55], a[36:39], v[180:183]
    ds_read_b64_tr_b16 v[50:51], v12 offset:9216
    v_mfma_f32_16x16x32_bf16 v[212:215], v[52:55], a[40:43], v[212:215]
    buffer_load_dwordx4 a[120:123], v1, s[8:11], s80 offen offset:1024
    v_mfma_f32_16x16x32_bf16 v[244:247], v[52:55], a[44:47], v[244:247]
    v_mfma_f32_16x16x32_bf16 v[152:155], v[56:59], a[32:35], v[152:155]
    ds_read_b64_tr_b16 v[52:53], v13 offset:8192
    v_mfma_f32_16x16x32_bf16 v[184:187], v[56:59], a[36:39], v[184:187]
    ds_read_b64_tr_b16 v[54:55], v13 offset:9216
    v_mfma_f32_16x16x32_bf16 v[216:219], v[56:59], a[40:43], v[216:219]
    v_mfma_f32_16x16x32_bf16 v[248:251], v[56:59], a[44:47], v[248:251]
    v_mfma_f32_16x16x32_bf16 v[156:159], v[60:63], a[32:35], v[156:159]
    s_xor_b32 s80, s76, 22528
    ds_read_b64_tr_b16 v[56:57], v14 offset:8192
    v_mfma_f32_16x16x32_bf16 v[188:191], v[60:63], a[36:39], v[188:191]
    ds_read_b64_tr_b16 v[58:59], v14 offset:9216
    v_mfma_f32_16x16x32_bf16 v[220:223], v[60:63], a[40:43], v[220:223]
    buffer_load_dwordx4 a[124:127], v1, s[8:11], s80 offen offset:1024
    v_mfma_f32_16x16x32_bf16 v[252:255], v[60:63], a[44:47], v[252:255]
    s_waitcnt vmcnt(25) lgkmcnt(4)
    v_mfma_f32_16x16x32_bf16 v[128:131], v[32:35], a[48:51], v[128:131]
    s_waitcnt vmcnt(24)
    ds_read_b64_tr_b16 v[60:61], v15 offset:8192
    v_mfma_f32_16x16x32_bf16 v[160:163], v[32:35], a[52:55], v[160:163]
    s_waitcnt vmcnt(21)
    s_xor_b32 s80, s75, 8192
    ds_read_b64_tr_b16 v[62:63], v15 offset:9216
    v_mfma_f32_16x16x32_bf16 v[192:195], v[32:35], a[56:59], v[192:195]
    buffer_load_dwordx4 a[128:131], v1, s[8:11], s80 offen offset:0
    v_mfma_f32_16x16x32_bf16 v[224:227], v[32:35], a[60:63], v[224:227]
    v_mfma_f32_16x16x32_bf16 v[132:135], v[36:39], a[48:51], v[132:135]
    ds_read_b64_tr_b16 v[32:33], v8 offset:16384
    v_mfma_f32_16x16x32_bf16 v[164:167], v[36:39], a[52:55], v[164:167]
    ds_read_b64_tr_b16 v[34:35], v8 offset:17408
    v_mfma_f32_16x16x32_bf16 v[196:199], v[36:39], a[56:59], v[196:199]
    v_mfma_f32_16x16x32_bf16 v[228:231], v[36:39], a[60:63], v[228:231]
    v_mfma_f32_16x16x32_bf16 v[136:139], v[40:43], a[48:51], v[136:139]
    s_xor_b32 s80, s75, 24576
    ds_read_b64_tr_b16 v[36:37], v9 offset:16384
    v_mfma_f32_16x16x32_bf16 v[168:171], v[40:43], a[52:55], v[168:171]
    ds_read_b64_tr_b16 v[38:39], v9 offset:17408
    v_mfma_f32_16x16x32_bf16 v[200:203], v[40:43], a[56:59], v[200:203]
    buffer_load_dwordx4 a[132:135], v1, s[8:11], s80 offen offset:0
    v_mfma_f32_16x16x32_bf16 v[232:235], v[40:43], a[60:63], v[232:235]
    v_mfma_f32_16x16x32_bf16 v[140:143], v[44:47], a[48:51], v[140:143]
    ds_read_b64_tr_b16 v[40:41], v10 offset:16384
    v_mfma_f32_16x16x32_bf16 v[172:175], v[44:47], a[52:55], v[172:175]
    ds_read_b64_tr_b16 v[42:43], v10 offset:17408
    v_mfma_f32_16x16x32_bf16 v[204:207], v[44:47], a[56:59], v[204:207]
    v_mfma_f32_16x16x32_bf16 v[236:239], v[44:47], a[60:63], v[236:239]
    v_mfma_f32_16x16x32_bf16 v[144:147], v[48:51], a[48:51], v[144:147]
    s_xor_b32 s80, s76, 8192
    ds_read_b64_tr_b16 v[44:45], v11 offset:16384
    v_mfma_f32_16x16x32_bf16 v[176:179], v[48:51], a[52:55], v[176:179]
    ds_read_b64_tr_b16 v[46:47], v11 offset:17408
    v_mfma_f32_16x16x32_bf16 v[208:211], v[48:51], a[56:59], v[208:211]
    buffer_load_dwordx4 a[136:139], v1, s[8:11], s80 offen offset:0
    v_mfma_f32_16x16x32_bf16 v[240:243], v[48:51], a[60:63], v[240:243]
    s_waitcnt lgkmcnt(4)
    v_mfma_f32_16x16x32_bf16 v[148:151], v[52:55], a[48:51], v[148:151]
    ds_read_b64_tr_b16 v[48:49], v12 offset:16384
    v_mfma_f32_16x16x32_bf16 v[180:183], v[52:55], a[52:55], v[180:183]
    ds_read_b64_tr_b16 v[50:51], v12 offset:17408
    v_mfma_f32_16x16x32_bf16 v[212:215], v[52:55], a[56:59], v[212:215]
    v_mfma_f32_16x16x32_bf16 v[244:247], v[52:55], a[60:63], v[244:247]
    v_mfma_f32_16x16x32_bf16 v[152:155], v[56:59], a[48:51], v[152:155]
    s_xor_b32 s80, s76, 24576
    ds_read_b64_tr_b16 v[52:53], v13 offset:16384
    v_mfma_f32_16x16x32_bf16 v[184:187], v[56:59], a[52:55], v[184:187]
    ds_read_b64_tr_b16 v[54:55], v13 offset:17408
    v_mfma_f32_16x16x32_bf16 v[216:219], v[56:59], a[56:59], v[216:219]
    buffer_load_dwordx4 a[140:143], v1, s[8:11], s80 offen offset:0
    s_waitcnt vmcnt(9)
    v_mfma_f32_16x16x32_bf16 v[248:251], v[56:59], a[60:63], v[248:251]
    buffer_store_dword v6, v5, s[8:11], s73 offen sc0 sc1
    v_mfma_f32_16x16x32_bf16 v[156:159], v[60:63], a[48:51], v[156:159]
    ds_read_b64_tr_b16 v[56:57], v14 offset:16384
    v_mfma_f32_16x16x32_bf16 v[188:191], v[60:63], a[52:55], v[188:191]
    s_xor_b32 s80, s75, 8192
    ds_read_b64_tr_b16 v[58:59], v14 offset:17408
    v_mfma_f32_16x16x32_bf16 v[220:223], v[60:63], a[56:59], v[220:223]
    buffer_load_dwordx4 a[144:147], v1, s[8:11], s80 offen offset:1024
    v_mfma_f32_16x16x32_bf16 v[252:255], v[60:63], a[60:63], v[252:255]
    v_mfma_f32_16x16x32_bf16 v[128:131], v[32:35], a[64:67], v[128:131]
    ds_read_b64_tr_b16 v[60:61], v15 offset:16384
    v_mfma_f32_16x16x32_bf16 v[160:163], v[32:35], a[68:71], v[160:163]
    ds_read_b64_tr_b16 v[62:63], v15 offset:17408
    v_mfma_f32_16x16x32_bf16 v[192:195], v[32:35], a[72:75], v[192:195]
    v_mfma_f32_16x16x32_bf16 v[224:227], v[32:35], a[76:79], v[224:227]
    v_mfma_f32_16x16x32_bf16 v[132:135], v[36:39], a[64:67], v[132:135]
    s_xor_b32 s80, s75, 24576
    ds_read_b64_tr_b16 v[32:33], v8 offset:24576
    v_mfma_f32_16x16x32_bf16 v[164:167], v[36:39], a[68:71], v[164:167]
    ds_read_b64_tr_b16 v[34:35], v8 offset:25600
    v_mfma_f32_16x16x32_bf16 v[196:199], v[36:39], a[72:75], v[196:199]
    buffer_load_dwordx4 a[148:151], v1, s[8:11], s80 offen offset:1024
    v_mfma_f32_16x16x32_bf16 v[228:231], v[36:39], a[76:79], v[228:231]
    s_waitcnt lgkmcnt(4)
    v_mfma_f32_16x16x32_bf16 v[136:139], v[40:43], a[64:67], v[136:139]
    ds_read_b64_tr_b16 v[36:37], v9 offset:24576
    v_mfma_f32_16x16x32_bf16 v[168:171], v[40:43], a[68:71], v[168:171]
    ds_read_b64_tr_b16 v[38:39], v9 offset:25600
    v_mfma_f32_16x16x32_bf16 v[200:203], v[40:43], a[72:75], v[200:203]
    v_mfma_f32_16x16x32_bf16 v[232:235], v[40:43], a[76:79], v[232:235]
    v_mfma_f32_16x16x32_bf16 v[140:143], v[44:47], a[64:67], v[140:143]
    s_xor_b32 s80, s76, 8192
    ds_read_b64_tr_b16 v[40:41], v10 offset:24576
    v_mfma_f32_16x16x32_bf16 v[172:175], v[44:47], a[68:71], v[172:175]
    ds_read_b64_tr_b16 v[42:43], v10 offset:25600
    v_mfma_f32_16x16x32_bf16 v[204:207], v[44:47], a[72:75], v[204:207]
    buffer_load_dwordx4 a[152:155], v1, s[8:11], s80 offen offset:1024
    v_mfma_f32_16x16x32_bf16 v[236:239], v[44:47], a[76:79], v[236:239]
    v_mfma_f32_16x16x32_bf16 v[144:147], v[48:51], a[64:67], v[144:147]
    ds_read_b64_tr_b16 v[44:45], v11 offset:24576
    v_mfma_f32_16x16x32_bf16 v[176:179], v[48:51], a[68:71], v[176:179]
    ds_read_b64_tr_b16 v[46:47], v11 offset:25600
    v_mfma_f32_16x16x32_bf16 v[208:211], v[48:51], a[72:75], v[208:211]
    v_mfma_f32_16x16x32_bf16 v[240:243], v[48:51], a[76:79], v[240:243]
    v_mfma_f32_16x16x32_bf16 v[148:151], v[52:55], a[64:67], v[148:151]
    s_xor_b32 s80, s76, 24576
    ds_read_b64_tr_b16 v[48:49], v12 offset:24576
    v_mfma_f32_16x16x32_bf16 v[180:183], v[52:55], a[68:71], v[180:183]
    ds_read_b64_tr_b16 v[50:51], v12 offset:25600
    v_mfma_f32_16x16x32_bf16 v[212:215], v[52:55], a[72:75], v[212:215]
    buffer_load_dwordx4 a[156:159], v1, s[8:11], s80 offen offset:1024
    v_mfma_f32_16x16x32_bf16 v[244:247], v[52:55], a[76:79], v[244:247]
    v_mfma_f32_16x16x32_bf16 v[152:155], v[56:59], a[64:67], v[152:155]
    ds_read_b64_tr_b16 v[52:53], v13 offset:24576
    v_lshlrev_b32 v116, 2, v0
    v_mfma_f32_16x16x32_bf16 v[184:187], v[56:59], a[68:71], v[184:187]
    s_xor_b32 s80, s75, 10240
    ds_read_b64_tr_b16 v[54:55], v13 offset:25600
    v_cmp_gt_u32 vcc, 8, v0
    v_mfma_f32_16x16x32_bf16 v[216:219], v[56:59], a[72:75], v[216:219]
    buffer_load_dwordx4 a[160:163], v1, s[8:11], s80 offen offset:0
    v_mfma_f32_16x16x32_bf16 v[248:251], v[56:59], a[76:79], v[248:251]
    s_waitcnt lgkmcnt(4)
    v_mov_b32 v117, 2147479552
    v_cndmask_b32 v116, v117, v116, vcc
    v_mfma_f32_16x16x32_bf16 v[156:159], v[60:63], a[64:67], v[156:159]
    s_lshl_b32 s70, s2, 5
    s_add_u32 s70, s70, 20480
    ds_read_b64_tr_b16 v[56:57], v14 offset:24576
    v_mfma_f32_16x16x32_bf16 v[188:191], v[60:63], a[68:71], v[188:191]
    ds_read_b64_tr_b16 v[58:59], v14 offset:25600
    v_and_b32 v119, 3, v2
    v_mfma_f32_16x16x32_bf16 v[220:223], v[60:63], a[72:75], v[220:223]
    v_lshlrev_b32 v119, 9, v119
    v_mfma_f32_16x16x32_bf16 v[252:255], v[60:63], a[76:79], v[252:255]
    v_mfma_f32_16x16x32_bf16 v[128:131], v[32:35], a[80:83], v[128:131]
    s_xor_b32 s80, s75, 26624
    s_lshr_b32 s69, s2, 6
    ds_read_b64_tr_b16 v[60:61], v15 offset:24576
    v_mfma_f32_16x16x32_bf16 v[160:163], v[32:35], a[84:87], v[160:163]
    s_add_u32 s69, s69, 4
    s_lshl_b32 s69, s69, 5
    ds_read_b64_tr_b16 v[62:63], v15 offset:25600
    v_mfma_f32_16x16x32_bf16 v[192:195], v[32:35], a[88:91], v[192:195]
    buffer_load_dwordx4 a[164:167], v1, s[8:11], s80 offen offset:0
    v_mfma_f32_16x16x32_bf16 v[224:227], v[32:35], a[92:95], v[224:227]
    s_bfe_u32 s68, s2, 196611
    s_add_u32 s69, s69, s68
    s_lshl_b32 s69, s69, 6
    v_mfma_f32_16x16x32_bf16 v[132:135], v[36:39], a[80:83], v[132:135]
    s_add_u32 s69, s69, 1310720
    s_and_b32 s100, s3, 1
    ds_read_b64_tr_b16 v[32:33], v8 offset:49152
    v_mfma_f32_16x16x32_bf16 v[164:167], v[36:39], a[84:87], v[164:167]
    s_lshr_b32 s101, s3, 1
    s_lshl_b32 s19, s100, 13
    ds_read_b64_tr_b16 v[34:35], v8 offset:50176
    v_mfma_f32_16x16x32_bf16 v[196:199], v[36:39], a[88:91], v[196:199]
    buffer_load_dword v118, v119, s[8:11], s69 offen sc0 sc1
    v_mfma_f32_16x16x32_bf16 v[228:231], v[36:39], a[92:95], v[228:231]
    s_add_u32 s19, s19, 65536
    v_add_u32 v18, s19, v1
    v_mfma_f32_16x16x32_bf16 v[136:139], v[40:43], a[80:83], v[136:139]
    s_xor_b32 s80, s76, 10240
    s_mul_i32 s19, s100, 12288
    ds_read_b64_tr_b16 v[36:37], v9 offset:49152
    v_mfma_f32_16x16x32_bf16 v[168:171], v[40:43], a[84:87], v[168:171]
    s_add_u32 s19, s19, 98304
    ds_read_b64_tr_b16 v[38:39], v9 offset:50176
    v_add_u32 v19, s19, v1
    v_mfma_f32_16x16x32_bf16 v[200:203], v[40:43], a[88:91], v[200:203]
    buffer_load_dwordx4 a[168:171], v1, s[8:11], s80 offen offset:0
    v_mfma_f32_16x16x32_bf16 v[232:235], v[40:43], a[92:95], v[232:235]
    v_mfma_f32_16x16x32_bf16 v[140:143], v[44:47], a[80:83], v[140:143]
    s_lshl_b32 s19, s100, 12
    s_add_u32 s19, s19, 98304
    ds_read_b64_tr_b16 v[40:41], v10 offset:49152
    v_mfma_f32_16x16x32_bf16 v[172:175], v[44:47], a[84:87], v[172:175]
    ds_read_b64_tr_b16 v[42:43], v10 offset:50176
    v_add_u32 v20, s19, v1
    v_mfma_f32_16x16x32_bf16 v[204:207], v[44:47], a[88:91], v[204:207]
    v_and_b32 v23, 15, v2
    v_lshrrev_b32 v24, 4, v2
    v_mfma_f32_16x16x32_bf16 v[236:239], v[44:47], a[92:95], v[236:239]
    s_waitcnt lgkmcnt(4)
    v_mfma_f32_16x16x32_bf16 v[144:147], v[48:51], a[80:83], v[144:147]
    s_xor_b32 s80, s76, 26624
    ds_read_b64_tr_b16 v[44:45], v11 offset:49152
    v_lshlrev_b32 v25, 2, v24
    v_mfma_f32_16x16x32_bf16 v[176:179], v[48:51], a[84:87], v[176:179]
    ds_read_b64_tr_b16 v[46:47], v11 offset:50176
    v_sub_u32 v25, v23, v25
    v_mfma_f32_16x16x32_bf16 v[208:211], v[48:51], a[88:91], v[208:211]
    buffer_load_dwordx4 a[172:175], v1, s[8:11], s80 offen offset:0
    v_mfma_f32_16x16x32_bf16 v[240:243], v[48:51], a[92:95], v[240:243]
    v_mfma_f32_16x16x32_bf16 v[148:151], v[52:55], a[80:83], v[148:151]
    s_sub_i32 s19, s101, s100
    s_lshl_b32 s19, s19, 5
    ds_read_b64_tr_b16 v[48:49], v12 offset:49152
    v_mfma_f32_16x16x32_bf16 v[180:183], v[52:55], a[84:87], v[180:183]
    s_xor_b32 s80, s75, 10240
    ds_read_b64_tr_b16 v[50:51], v12 offset:50176
    v_add_u32 v21, s19, v25
    v_mfma_f32_16x16x32_bf16 v[212:215], v[52:55], a[88:91], v[212:215]
    buffer_load_dwordx4 a[176:179], v1, s[8:11], s80 offen offset:1024
    v_mfma_f32_16x16x32_bf16 v[244:247], v[52:55], a[92:95], v[244:247]
    v_mfma_f32_16x16x32_bf16 v[152:155], v[56:59], a[80:83], v[152:155]
    s_add_u32 s19, s101, s100
    s_sub_i32 s19, 1, s19
    ds_read_b64_tr_b16 v[52:53], v13 offset:49152
    v_mfma_f32_16x16x32_bf16 v[184:187], v[56:59], a[84:87], v[184:187]
    s_lshl_b32 s19, s19, 5
    ds_read_b64_tr_b16 v[54:55], v13 offset:50176
    v_add_u32 v22, s19, v25
    v_mfma_f32_16x16x32_bf16 v[216:219], v[56:59], a[88:91], v[216:219]
    v_cvt_f32_i32 v21, v21
    v_cvt_f32_i32 v22, v22
    v_mfma_f32_16x16x32_bf16 v[248:251], v[56:59], a[92:95], v[248:251]
    v_mfma_f32_16x16x32_bf16 v[156:159], v[60:63], a[80:83], v[156:159]
    s_xor_b32 s80, s75, 26624
    ds_read_b64_tr_b16 v[56:57], v14 offset:49152
    v_add_f32 v21, 0.5, v21
    v_mfma_f32_16x16x32_bf16 v[188:191], v[60:63], a[84:87], v[188:191]
    ds_read_b64_tr_b16 v[58:59], v14 offset:50176
    v_add_f32 v22, 0.5, v22
    v_mfma_f32_16x16x32_bf16 v[220:223], v[60:63], a[88:91], v[220:223]
    buffer_load_dwordx4 a[180:183], v1, s[8:11], s80 offen offset:1024
    v_mfma_f32_16x16x32_bf16 v[252:255], v[60:63], a[92:95], v[252:255]
    v_mul_f32 v21, 0x71800000, v21
    v_mul_f32 v22, 0x71800000, v22
    v_mfma_f32_16x16x32_bf16 v[128:131], v[32:35], a[96:99], v[128:131]
    ds_read_b64_tr_b16 v[60:61], v15 offset:49152
    v_lshrrev_b32 v25, 2, v23
    v_mfma_f32_16x16x32_bf16 v[160:163], v[32:35], a[100:103], v[160:163]
    ds_read_b64_tr_b16 v[62:63], v15 offset:50176
    v_and_b32 v23, 3, v23
    v_mfma_f32_16x16x32_bf16 v[192:195], v[32:35], a[104:107], v[192:195]
    s_waitcnt vmcnt(20)
    v_lshlrev_b32 v23, 6, v23
    v_lshl_add_u32 v23, v25, 15, v23
    v_mfma_f32_16x16x32_bf16 v[224:227], v[32:35], a[108:111], v[224:227]
    s_waitcnt lgkmcnt(4)
    v_mfma_f32_16x16x32_bf16 v[132:135], v[36:39], a[96:99], v[132:135]
    s_xor_b32 s80, s76, 10240
    ds_read_b64_tr_b16 v[32:33], v8 offset:57344
    v_lshl_add_u32 v23, v24, 4, v23
    v_mfma_f32_16x16x32_bf16 v[164:167], v[36:39], a[100:103], v[164:167]
    s_lshl_b32 s18, s6, 20
    s_lshl_b32 s19, s3, 18
    ds_read_b64_tr_b16 v[34:35], v8 offset:58368
    v_mfma_f32_16x16x32_bf16 v[196:199], v[36:39], a[104:107], v[196:199]
    buffer_load_dwordx4 a[184:187], v1, s[8:11], s80 offen offset:1024
    v_mfma_f32_16x16x32_bf16 v[228:231], v[36:39], a[108:111], v[228:231]
    s_add_u32 s18, s18, s19
    s_lshl_b32 s19, s7, 10
    s_add_u32 s18, s18, s19
    v_mfma_f32_16x16x32_bf16 v[136:139], v[40:43], a[96:99], v[136:139]
    s_add_u32 s18, s18, 67108864
    s_mov_b32 s13, s60
    ds_read_b64_tr_b16 v[36:37], v9 offset:57344
    v_mfma_f32_16x16x32_bf16 v[168:171], v[40:43], a[100:103], v[168:171]
    s_mov_b32 s12, 2
    s_mov_b32 s25, 0
    ds_read_b64_tr_b16 v[38:39], v9 offset:58368
    v_mfma_f32_16x16x32_bf16 v[200:203], v[40:43], a[104:107], v[200:203]
    s_mov_b32 s26, 28
    s_mov_b32 s64, 128
    s_lshl_b32 s65, s5, 1
    v_mfma_f32_16x16x32_bf16 v[232:235], v[40:43], a[108:111], v[232:235]
    v_mfma_f32_16x16x32_bf16 v[140:143], v[44:47], a[96:99], v[140:143]
    s_xor_b32 s80, s76, 26624
    s_and_b32 s65, s65, 7
    ds_read_b64_tr_b16 v[40:41], v10 offset:57344
    v_mfma_f32_16x16x32_bf16 v[172:175], v[44:47], a[100:103], v[172:175]
    s_xor_b32 s65, s65, s3
    s_lshl_b32 s65, s65, 16
    ds_read_b64_tr_b16 v[42:43], v10 offset:58368
    v_mfma_f32_16x16x32_bf16 v[204:207], v[44:47], a[104:107], v[204:207]
    buffer_load_dwordx4 a[188:191], v1, s[8:11], s80 offen offset:1024
    v_mfma_f32_16x16x32_bf16 v[236:239], v[44:47], a[108:111], v[236:239]
    s_add_u32 s15, s62, 65536
    s_add_u32 s16, s62, 0
    s_lshl_b32 s20, s7, 13
    v_mfma_f32_16x16x32_bf16 v[144:147], v[48:51], a[96:99], v[144:147]
    s_lshl_b32 s19, s100, 11
    s_add_u32 s20, s20, s19
    ds_read_b64_tr_b16 v[44:45], v11 offset:57344
    v_mfma_f32_16x16x32_bf16 v[176:179], v[48:51], a[100:103], v[176:179]
    s_xor_b32 s80, s75, 12288
    s_add_u32 s20, s20, 50331648
    ds_read_b64_tr_b16 v[46:47], v11 offset:58368
    v_mfma_f32_16x16x32_bf16 v[208:211], v[48:51], a[104:107], v[208:211]
    buffer_load_dwordx4 a[192:195], v1, s[8:11], s80 offen offset:0
    v_mfma_f32_16x16x32_bf16 v[240:243], v[48:51], a[108:111], v[240:243]
    s_sub_u32 s19, 3, s101
    s_lshl_b32 s19, s19, 18
    s_add_u32 s21, s20, s19
    v_mfma_f32_16x16x32_bf16 v[148:151], v[52:55], a[96:99], v[148:151]
    s_lshl_b32 s19, s101, 18
    s_add_u32 s20, s20, s19
    ds_read_b64_tr_b16 v[48:49], v12 offset:57344
    v_mfma_f32_16x16x32_bf16 v[180:183], v[52:55], a[100:103], v[180:183]
    s_add_u32 s22, s72, 131072
    s_and_b32 s23, s2, 231
    ds_read_b64_tr_b16 v[50:51], v12 offset:58368
    v_mfma_f32_16x16x32_bf16 v[212:215], v[52:55], a[104:107], v[212:215]
    s_lshl_b32 s23, s23, 8
    s_sub_u32 s19, 3, s3
    s_min_u32 s19, s19, s3
    v_mfma_f32_16x16x32_bf16 v[244:247], v[52:55], a[108:111], v[244:247]
    s_waitcnt lgkmcnt(4)
    v_mfma_f32_16x16x32_bf16 v[152:155], v[56:59], a[96:99], v[152:155]
    s_xor_b32 s80, s75, 28672
    s_lshl_b32 s19, s19, 7
    ds_read_b64_tr_b16 v[52:53], v13 offset:57344
    s_waitcnt vmcnt(7)
    v_cmp_ne_u32 vcc, 0, v118
    s_cmp_eq_u64 vcc, -1
    s_cbranch_scc0 L_E2_slow_5
L_E2_ok_6:
    v_mfma_f32_16x16x32_bf16 v[184:187], v[56:59], a[100:103], v[184:187]
    s_add_u32 s23, s23, s19
    s_add_u32 s23, s23, 1179648
    ds_read_b64_tr_b16 v[54:55], v13 offset:58368
    v_mfma_f32_16x16x32_bf16 v[216:219], v[56:59], a[104:107], v[216:219]
    buffer_load_dwordx4 a[196:199], v1, s[8:11], s80 offen offset:0
    v_mfma_f32_16x16x32_bf16 v[248:251], v[56:59], a[108:111], v[248:251]
    buffer_load_dword v112, v116, s[8:11], s70 offen
    v_mfma_f32_16x16x32_bf16 v[156:159], v[60:63], a[96:99], v[156:159]
    s_add_u32 s70, s70, 12288
    s_lshl_b32 s71, s2, 2
    ds_read_b64_tr_b16 v[56:57], v14 offset:57344
    v_mfma_f32_16x16x32_bf16 v[188:191], v[60:63], a[100:103], v[188:191]
    s_add_u32 s71, s71, s3
    s_and_b32 s100, s71, 31
    ds_read_b64_tr_b16 v[58:59], v14 offset:58368
    v_mfma_f32_16x16x32_bf16 v[220:223], v[60:63], a[104:107], v[220:223]
    buffer_load_dword v113, v116, s[8:11], s70 offen
    v_mfma_f32_16x16x32_bf16 v[252:255], v[60:63], a[108:111], v[252:255]
    s_lshr_b32 s101, s71, 5
    s_sub_u32 s101, s101, 4
    s_and_b32 s101, s101, 31
    v_mfma_f32_16x16x32_bf16 v[128:131], v[32:35], a[112:115], v[128:131]
    s_xor_b32 s80, s76, 12288
    s_add_u32 s70, s70, 12288
    ds_read_b64_tr_b16 v[60:61], v15 offset:57344
    v_mfma_f32_16x16x32_bf16 v[160:163], v[32:35], a[116:119], v[160:163]
    ds_read_b64_tr_b16 v[62:63], v15 offset:58368
    v_and_b32 v121, 7, v2
    v_mfma_f32_16x16x32_bf16 v[192:195], v[32:35], a[120:123], v[192:195]
    buffer_load_dwordx4 a[200:203], v1, s[8:11], s80 offen offset:0
    v_mfma_f32_16x16x32_bf16 v[224:227], v[32:35], a[124:127], v[224:227]
    buffer_load_dword v114, v116, s[8:11], s70 offen
    v_mfma_f32_16x16x32_bf16 v[132:135], v[36:39], a[112:115], v[132:135]
    s_add_u32 s70, s70, 12288
    v_and_b32 v120, 4, v121
    v_and_b32 v122, 2, v121
    v_mfma_f32_16x16x32_bf16 v[164:167], v[36:39], a[116:119], v[164:167]
    buffer_load_dword v115, v116, s[8:11], s70 offen
    v_mfma_f32_16x16x32_bf16 v[196:199], v[36:39], a[120:123], v[196:199]
    s_add_u32 s70, s70, 12288
    v_lshl_add_u32 v120, v122, 3, v120
    v_and_b32 v122, 1, v121
    v_mfma_f32_16x16x32_bf16 v[228:231], v[36:39], a[124:127], v[228:231]
    v_lshl_add_u32 v120, v122, 1, v120
    v_mul_u32_u24 v120, 3584, v120
    v_mfma_f32_16x16x32_bf16 v[136:139], v[40:43], a[112:115], v[136:139]
    s_xor_b32 s80, s76, 28672
    v_subrev_u32 v8, 98304, v8
    v_subrev_u32 v9, 98304, v9
    s_waitcnt lgkmcnt(0)
    s_barrier
    v_mfma_f32_16x16x32_bf16 v[168:171], v[40:43], a[116:119], v[168:171]
    ds_read_b64_tr_b16 v[32:33], v8 offset:0
    v_lshrrev_b32 v122, 3, v2
    v_mfma_f32_16x16x32_bf16 v[200:203], v[40:43], a[120:123], v[200:203]
    ds_read_b64_tr_b16 v[34:35], v8 offset:1024
    v_lshl_add_u32 v120, v122, 4, v120
    v_mfma_f32_16x16x32_bf16 v[232:235], v[40:43], a[124:127], v[232:235]
    ds_read_b64_tr_b16 v[36:37], v9 offset:0
    v_subrev_u32 v10, 98304, v10
    v_mfma_f32_16x16x32_bf16 v[140:143], v[44:47], a[112:115], v[140:143]
    ds_read_b64_tr_b16 v[38:39], v9 offset:1024
    v_lshlrev_b32 v121, 13, v121
    v_mfma_f32_16x16x32_bf16 v[172:175], v[44:47], a[116:119], v[172:175]
    ds_read_b64_tr_b16 v[40:41], v10 offset:0
    v_lshl_add_u32 v121, v122, 4, v121
    v_mfma_f32_16x16x32_bf16 v[204:207], v[44:47], a[120:123], v[204:207]
    s_lshr_b32 s71, s100, 1
    s_lshl_b32 s71, s71, 2
    ds_read_b64_tr_b16 v[42:43], v10 offset:1024
    v_mfma_f32_16x16x32_bf16 v[236:239], v[44:47], a[124:127], v[236:239]
    s_and_b32 s100, s100, 1
    s_add_u32 s71, s71, s100
    v_subrev_u32 v11, 98304, v11
    v_mfma_f32_16x16x32_bf16 v[144:147], v[48:51], a[112:115], v[144:147]
    s_mul_i32 s71, s71, 28672
    s_lshl_b32 s100, s101, 7
    ds_read_b64_tr_b16 v[44:45], v11 offset:0
    v_mfma_f32_16x16x32_bf16 v[176:179], v[48:51], a[116:119], v[176:179]
    s_add_u32 s71, s71, s100
    s_cmp_lt_u32 s101, 28
    s_cselect_b32 s71, s71, 2147479552
    ds_read_b64_tr_b16 v[46:47], v11 offset:1024
    v_mfma_f32_16x16x32_bf16 v[208:211], v[48:51], a[120:123], v[208:211]
    buffer_load_dwordx4 a[204:207], v1, s[8:11], s80 offen offset:0
    v_mfma_f32_16x16x32_bf16 v[240:243], v[48:51], a[124:127], v[240:243]
    s_xor_b32 s80, s75, 12288
    v_subrev_u32 v12, 98304, v12
    v_mfma_f32_16x16x32_bf16 v[148:151], v[52:55], a[112:115], v[148:151]
    ds_read_b64_tr_b16 v[48:49], v12 offset:0
    v_mfma_f32_16x16x32_bf16 v[180:183], v[52:55], a[116:119], v[180:183]
    ds_read_b64_tr_b16 v[50:51], v12 offset:1024
    v_mfma_f32_16x16x32_bf16 v[212:215], v[52:55], a[120:123], v[212:215]
    buffer_load_dwordx4 a[208:211], v1, s[8:11], s80 offen offset:1024
    v_mfma_f32_16x16x32_bf16 v[244:247], v[52:55], a[124:127], v[244:247]
    s_xor_b32 s80, s75, 28672
    v_subrev_u32 v13, 98304, v13
    v_mfma_f32_16x16x32_bf16 v[152:155], v[56:59], a[112:115], v[152:155]
    ds_read_b64_tr_b16 v[52:53], v13 offset:0
    v_mfma_f32_16x16x32_bf16 v[184:187], v[56:59], a[116:119], v[184:187]
    ds_read_b64_tr_b16 v[54:55], v13 offset:1024
    v_mfma_f32_16x16x32_bf16 v[216:219], v[56:59], a[120:123], v[216:219]
    buffer_load_dwordx4 a[212:215], v1, s[8:11], s80 offen offset:1024
    v_mfma_f32_16x16x32_bf16 v[248:251], v[56:59], a[124:127], v[248:251]
    s_xor_b32 s80, s76, 12288
    v_subrev_u32 v14, 98304, v14
    v_mfma_f32_16x16x32_bf16 v[156:159], v[60:63], a[112:115], v[156:159]
    ds_read_b64_tr_b16 v[56:57], v14 offset:0
    v_mfma_f32_16x16x32_bf16 v[188:191], v[60:63], a[116:119], v[188:191]
    ds_read_b64_tr_b16 v[58:59], v14 offset:1024
    v_mfma_f32_16x16x32_bf16 v[220:223], v[60:63], a[120:123], v[220:223]
    buffer_load_dwordx4 a[216:219], v1, s[8:11], s80 offen offset:1024
    v_mfma_f32_16x16x32_bf16 v[252:255], v[60:63], a[124:127], v[252:255]
    s_waitcnt lgkmcnt(4)
    v_subrev_u32 v15, 98304, v15
    v_mfma_f32_16x16x32_bf16 v[128:131], v[32:35], a[128:131], v[128:131]
    ds_read_b64_tr_b16 v[60:61], v15 offset:0
    v_mfma_f32_16x16x32_bf16 v[160:163], v[32:35], a[132:135], v[160:163]
    ds_read_b64_tr_b16 v[62:63], v15 offset:1024
    v_mfma_f32_16x16x32_bf16 v[192:195], v[32:35], a[136:139], v[192:195]
    buffer_load_dword v3, v17, s[8:11], s74 offen sc0 sc1
    v_mfma_f32_16x16x32_bf16 v[224:227], v[32:35], a[140:143], v[224:227]
    v_mfma_f32_16x16x32_bf16 v[132:135], v[36:39], a[128:131], v[132:135]
    s_xor_b32 s80, s76, 28672
    ds_read_b64_tr_b16 v[32:33], v8 offset:8192
    v_mfma_f32_16x16x32_bf16 v[164:167], v[36:39], a[132:135], v[164:167]
    ds_read_b64_tr_b16 v[34:35], v8 offset:9216
    v_mfma_f32_16x16x32_bf16 v[196:199], v[36:39], a[136:139], v[196:199]
    buffer_load_dwordx4 a[220:223], v1, s[8:11], s80 offen offset:1024
    v_mfma_f32_16x16x32_bf16 v[228:231], v[36:39], a[140:143], v[228:231]
    v_mfma_f32_16x16x32_bf16 v[136:139], v[40:43], a[128:131], v[136:139]
    ds_read_b64_tr_b16 v[36:37], v9 offset:8192
    v_mfma_f32_16x16x32_bf16 v[168:171], v[40:43], a[132:135], v[168:171]
    s_xor_b32 s80, s75, 14336
    ds_read_b64_tr_b16 v[38:39], v9 offset:9216
    v_mfma_f32_16x16x32_bf16 v[200:203], v[40:43], a[136:139], v[200:203]
    buffer_load_dwordx4 a[224:227], v1, s[8:11], s80 offen offset:0
    v_mfma_f32_16x16x32_bf16 v[232:235], v[40:43], a[140:143], v[232:235]
    v_mfma_f32_16x16x32_bf16 v[140:143], v[44:47], a[128:131], v[140:143]
    ds_read_b64_tr_b16 v[40:41], v10 offset:8192
    v_mfma_f32_16x16x32_bf16 v[172:175], v[44:47], a[132:135], v[172:175]
    ds_read_b64_tr_b16 v[42:43], v10 offset:9216
    v_mfma_f32_16x16x32_bf16 v[204:207], v[44:47], a[136:139], v[204:207]
    v_mfma_f32_16x16x32_bf16 v[236:239], v[44:47], a[140:143], v[236:239]
    v_mfma_f32_16x16x32_bf16 v[144:147], v[48:51], a[128:131], v[144:147]
    s_xor_b32 s80, s75, 30720
    ds_read_b64_tr_b16 v[44:45], v11 offset:8192
    v_mfma_f32_16x16x32_bf16 v[176:179], v[48:51], a[132:135], v[176:179]
    ds_read_b64_tr_b16 v[46:47], v11 offset:9216
    v_mfma_f32_16x16x32_bf16 v[208:211], v[48:51], a[136:139], v[208:211]
    buffer_load_dwordx4 a[228:231], v1, s[8:11], s80 offen offset:0
    v_mfma_f32_16x16x32_bf16 v[240:243], v[48:51], a[140:143], v[240:243]
    s_waitcnt lgkmcnt(4)
    v_mfma_f32_16x16x32_bf16 v[148:151], v[52:55], a[128:131], v[148:151]
    ds_read_b64_tr_b16 v[48:49], v12 offset:8192
    v_mfma_f32_16x16x32_bf16 v[180:183], v[52:55], a[132:135], v[180:183]
    ds_read_b64_tr_b16 v[50:51], v12 offset:9216
    v_mfma_f32_16x16x32_bf16 v[212:215], v[52:55], a[136:139], v[212:215]
    v_mfma_f32_16x16x32_bf16 v[244:247], v[52:55], a[140:143], v[244:247]
    v_mfma_f32_16x16x32_bf16 v[152:155], v[56:59], a[128:131], v[152:155]
    s_xor_b32 s80, s76, 14336
    ds_read_b64_tr_b16 v[52:53], v13 offset:8192
    v_mfma_f32_16x16x32_bf16 v[184:187], v[56:59], a[132:135], v[184:187]
    ds_read_b64_tr_b16 v[54:55], v13 offset:9216
    v_mfma_f32_16x16x32_bf16 v[216:219], v[56:59], a[136:139], v[216:219]
    buffer_load_dwordx4 a[232:235], v1, s[8:11], s80 offen offset:0
    s_waitcnt vmcnt(4)
    v_cmp_ne_u32 vcc, 0, v3
    s_cmp_eq_u64 vcc, -1
    s_cbranch_scc0 L_KV_slow_7
L_KV_ok_8:
    v_mfma_f32_16x16x32_bf16 v[248:251], v[56:59], a[140:143], v[248:251]
    v_mfma_f32_16x16x32_bf16 v[156:159], v[60:63], a[128:131], v[156:159]
    s_add_u32 m0, s62, 65536
    s_add_u32 s98, s81, 0
    ds_read_b64_tr_b16 v[56:57], v14 offset:8192
    v_mfma_f32_16x16x32_bf16 v[188:191], v[60:63], a[132:135], v[188:191]
    ds_read_b64_tr_b16 v[58:59], v14 offset:9216
    v_add_u32 v16, s62, v1
    v_mfma_f32_16x16x32_bf16 v[220:223], v[60:63], a[136:139], v[220:223]
    buffer_load_dwordx4 v1, s[8:11], s98 offen offset:0   lds
    v_mfma_f32_16x16x32_bf16 v[252:255], v[60:63], a[140:143], v[252:255]
    v_and_b32 v17, 4294959103, v16
    v_mov_b32 v24, -1
    v_mfma_f32_16x16x32_bf16 v[128:131], v[32:35], a[144:147], v[128:131]
    s_xor_b32 s80, s76, 30720
    ds_read_b64_tr_b16 v[60:61], v15 offset:8192
    v_mov_b32 v28, 0x3f803f80
    v_mfma_f32_16x16x32_bf16 v[160:163], v[32:35], a[148:151], v[160:163]
    ds_read_b64_tr_b16 v[62:63], v15 offset:9216
    v_mov_b32 v25, -1
    v_mfma_f32_16x16x32_bf16 v[192:195], v[32:35], a[152:155], v[192:195]
    buffer_load_dwordx4 a[236:239], v1, s[8:11], s80 offen offset:0
    v_mfma_f32_16x16x32_bf16 v[224:227], v[32:35], a[156:159], v[224:227]
    buffer_load_dwordx4 v1, s[8:11], s98 offen offset:1024   lds
    v_mfma_f32_16x16x32_bf16 v[132:135], v[36:39], a[144:147], v[132:135]
    ds_read_b64_tr_b16 v[32:33], v8 offset:16384
    v_add_f32 v112, v112, v113
    v_mfma_f32_16x16x32_bf16 v[164:167], v[36:39], a[148:151], v[164:167]
    s_xor_b32 s80, s75, 14336
    ds_read_b64_tr_b16 v[34:35], v8 offset:17408
    v_add_f32 v114, v114, v115
    v_mfma_f32_16x16x32_bf16 v[196:199], v[36:39], a[152:155], v[196:199]
    buffer_load_dwordx4 a[240:243], v1, s[8:11], s80 offen offset:1024
    v_mfma_f32_16x16x32_bf16 v[228:231], v[36:39], a[156:159], v[228:231]
    s_waitcnt lgkmcnt(4)
    ds_read_b64_tr_b16 a[24:25], v8 offset:49152
    v_add_f32 v112, v112, v114
    v_mfma_f32_16x16x32_bf16 v[136:139], v[40:43], a[144:147], v[136:139]
    ds_read_b64_tr_b16 v[36:37], v9 offset:16384
    v_cvt_pk_bf16_f32 v112, v112, v112
    v_mfma_f32_16x16x32_bf16 v[168:171], v[40:43], a[148:151], v[168:171]
    ds_read_b64_tr_b16 v[38:39], v9 offset:17408
    v_and_b32 v112, 0xffff0000, v112
    v_mfma_f32_16x16x32_bf16 v[200:203], v[40:43], a[152:155], v[200:203]
    s_lshr_b32 s70, s2, 6
    s_cmp_eq_u32 s70, 2
    s_cselect_b32 s70, 1.0, 0
    ds_read_b64_tr_b16 a[26:27], v8 offset:50176
    v_mfma_f32_16x16x32_bf16 v[232:235], v[40:43], a[156:159], v[232:235]
    buffer_load_dwordx4 v1, s[8:11], s98 offen offset:2048   lds
    v_mfma_f32_16x16x32_bf16 v[140:143], v[44:47], a[144:147], v[140:143]
    s_xor_b32 s80, s75, 30720
    ds_read_b64_tr_b16 v[40:41], v10 offset:16384
    v_add_f32 v112, s70, v112
    v_mfma_f32_16x16x32_bf16 v[172:175], v[44:47], a[148:151], v[172:175]
    ds_read_b64_tr_b16 v[42:43], v10 offset:17408
    v_cvt_pk_bf16_f32 v112, v112, v112
    v_mfma_f32_16x16x32_bf16 v[204:207], v[44:47], a[152:155], v[204:207]
    ds_read_b64_tr_b16 a[28:29], v9 offset:49152
    v_and_b32 v112, 0xffff0000, v112
    v_mfma_f32_16x16x32_bf16 v[236:239], v[44:47], a[156:159], v[236:239]
    buffer_load_dwordx4 a[244:247], v1, s[8:11], s80 offen offset:1024
    v_mfma_f32_16x16x32_bf16 v[144:147], v[48:51], a[144:147], v[144:147]
    s_lshl_b32 s70, s2, 5
    s_add_u32 s70, s70, 4096
    ds_read_b64_tr_b16 v[44:45], v11 offset:16384
    v_mfma_f32_16x16x32_bf16 v[176:179], v[48:51], a[148:151], v[176:179]
    ds_read_b64_tr_b16 v[46:47], v11 offset:17408
    v_mov_b32 v29, 0x3f803f80
    v_mfma_f32_16x16x32_bf16 v[208:211], v[48:51], a[152:155], v[208:211]
    ds_read_b64_tr_b16 a[30:31], v9 offset:50176
    v_mov_b32 v26, -1
    v_mfma_f32_16x16x32_bf16 v[240:243], v[48:51], a[156:159], v[240:243]
    buffer_store_dword v112, v116, s[8:11], s70 offen sc0 sc1
    v_mfma_f32_16x16x32_bf16 v[148:151], v[52:55], a[144:147], v[148:151]
    s_xor_b32 s80, s76, 14336
    ds_read_b64_tr_b16 v[48:49], v12 offset:16384
    v_mov_b32 v30, 0x3f803f80
    v_mfma_f32_16x16x32_bf16 v[180:183], v[52:55], a[148:151], v[180:183]
    ds_read_b64_tr_b16 v[50:51], v12 offset:17408
    v_mov_b32 v27, -1
    v_mfma_f32_16x16x32_bf16 v[212:215], v[52:55], a[152:155], v[212:215]
    ds_read_b64_tr_b16 a[32:33], v10 offset:49152
    v_mov_b32 v31, 0x3f803f80
    v_mfma_f32_16x16x32_bf16 v[244:247], v[52:55], a[156:159], v[244:247]
    buffer_load_dwordx4 a[248:251], v1, s[8:11], s80 offen offset:1024
    v_mfma_f32_16x16x32_bf16 v[152:155], v[56:59], a[144:147], v[152:155]
    ds_read_b64_tr_b16 v[52:53], v13 offset:16384
    v_mov_b32 v64, 0
    v_mfma_f32_16x16x32_bf16 v[184:187], v[56:59], a[148:151], v[184:187]
    ds_read_b64_tr_b16 v[54:55], v13 offset:17408
    v_mov_b32 v65, 0
    v_mfma_f32_16x16x32_bf16 v[216:219], v[56:59], a[152:155], v[216:219]
    s_waitcnt lgkmcnt(7)
    s_xor_b32 s80, s76, 30720
    ds_read_b64_tr_b16 a[34:35], v10 offset:50176
    v_mov_b32 v66, 0
    v_mfma_f32_16x16x32_bf16 v[248:251], v[56:59], a[156:159], v[248:251]
    buffer_load_dwordx4 a[252:255], v1, s[8:11], s80 offen offset:1024
    v_mfma_f32_16x16x32_bf16 v[156:159], v[60:63], a[144:147], v[156:159]
    ds_read_b64_tr_b16 v[56:57], v14 offset:16384
    v_mov_b32 v67, 0
    v_mfma_f32_16x16x32_bf16 v[188:191], v[60:63], a[148:151], v[188:191]
    ds_read_b64_tr_b16 v[58:59], v14 offset:17408
    v_mov_b32 v68, 0
    v_mfma_f32_16x16x32_bf16 v[220:223], v[60:63], a[152:155], v[220:223]
    ds_read_b64_tr_b16 a[36:37], v11 offset:49152
    v_mov_b32 v69, 0
    v_mfma_f32_16x16x32_bf16 v[252:255], v[60:63], a[156:159], v[252:255]
    buffer_load_dwordx4 v1, s[8:11], s98 offen offset:3072   lds
    v_mfma_f32_16x16x32_bf16 v[128:131], v[32:35], a[160:163], v[128:131]
    s_add_u32 m0, s62, 69632
    s_add_u32 s98, s81, 4096
    ds_read_b64_tr_b16 v[60:61], v15 offset:16384
    v_mfma_f32_16x16x32_bf16 v[160:163], v[32:35], a[164:167], v[160:163]
    ds_read_b64_tr_b16 v[62:63], v15 offset:17408
    v_mov_b32 v70, 0
    v_mfma_f32_16x16x32_bf16 v[192:195], v[32:35], a[168:171], v[192:195]
    ds_read_b64_tr_b16 a[38:39], v11 offset:50176
    v_mov_b32 v71, 0
    v_mfma_f32_16x16x32_bf16 v[224:227], v[32:35], a[172:175], v[224:227]
    buffer_load_dwordx4 v1, s[8:11], s98 offen offset:0   lds
    v_mfma_f32_16x16x32_bf16 v[132:135], v[36:39], a[160:163], v[132:135]
    ds_read_b64_tr_b16 v[32:33], v8 offset:24576
    v_mov_b32 v72, 0
    v_mfma_f32_16x16x32_bf16 v[164:167], v[36:39], a[164:167], v[164:167]
    ds_read_b64_tr_b16 v[34:35], v8 offset:25600
    v_mov_b32 v73, 0
    v_mfma_f32_16x16x32_bf16 v[196:199], v[36:39], a[168:171], v[196:199]
    ds_read_b64_tr_b16 a[40:41], v12 offset:49152
    v_mov_b32 v74, 0
    v_mfma_f32_16x16x32_bf16 v[228:231], v[36:39], a[172:175], v[228:231]
    buffer_load_dwordx4 v1, s[8:11], s98 offen offset:1024   lds
    v_mfma_f32_16x16x32_bf16 v[136:139], v[40:43], a[160:163], v[136:139]
    ds_read_b64_tr_b16 v[36:37], v9 offset:24576
    v_mov_b32 v75, 0
    v_mfma_f32_16x16x32_bf16 v[168:171], v[40:43], a[164:167], v[168:171]
    ds_read_b64_tr_b16 v[38:39], v9 offset:25600
    v_mov_b32 v76, 0
    v_mfma_f32_16x16x32_bf16 v[200:203], v[40:43], a[168:171], v[200:203]
    s_waitcnt lgkmcnt(7)
    ds_read_b64_tr_b16 a[42:43], v12 offset:50176
    v_mov_b32 v77, 0
    v_mfma_f32_16x16x32_bf16 v[232:235], v[40:43], a[172:175], v[232:235]
    buffer_load_dwordx4 v1, s[8:11], s98 offen offset:2048   lds
    v_mfma_f32_16x16x32_bf16 v[140:143], v[44:47], a[160:163], v[140:143]
    ds_read_b64_tr_b16 v[40:41], v10 offset:24576
    v_mov_b32 v78, 0
    v_mfma_f32_16x16x32_bf16 v[172:175], v[44:47], a[164:167], v[172:175]
    ds_read_b64_tr_b16 v[42:43], v10 offset:25600
    v_mov_b32 v79, 0
    v_mfma_f32_16x16x32_bf16 v[204:207], v[44:47], a[168:171], v[204:207]
    s_cmp_eq_u32 s60, 0
    s_cselect_b32 s19, 0, 0x76800000
    ds_read_b64_tr_b16 a[44:45], v13 offset:49152
    v_add_f32 v3, s19, v21
    v_mfma_f32_16x16x32_bf16 v[236:239], v[44:47], a[172:175], v[236:239]
    buffer_load_dwordx4 v1, s[8:11], s98 offen offset:3072   lds
    v_mfma_f32_16x16x32_bf16 v[144:147], v[48:51], a[160:163], v[144:147]
    s_add_u32 m0, s62, 98304
    s_add_u32 s98, s81, 32768
    ds_read_b64_tr_b16 v[44:45], v11 offset:24576
    v_mfma_f32_16x16x32_bf16 v[176:179], v[48:51], a[164:167], v[176:179]
    ds_read_b64_tr_b16 v[46:47], v11 offset:25600
    v_add_f32 v96, 0, v3
    v_mfma_f32_16x16x32_bf16 v[208:211], v[48:51], a[168:171], v[208:211]
    ds_read_b64_tr_b16 a[46:47], v13 offset:50176
    v_min_f32 v96, v96, v64
    v_mfma_f32_16x16x32_bf16 v[240:243], v[48:51], a[172:175], v[240:243]
    buffer_load_dwordx4 v1, s[8:11], s98 offen offset:0   lds
    v_mfma_f32_16x16x32_bf16 v[148:151], v[52:55], a[160:163], v[148:151]
    ds_read_b64_tr_b16 v[48:49], v12 offset:24576
    v_add_f32 v97, 0xf1800000, v3
    v_mfma_f32_16x16x32_bf16 v[180:183], v[52:55], a[164:167], v[180:183]
    ds_read_b64_tr_b16 v[50:51], v12 offset:25600
    v_min_f32 v97, v97, v65
    v_mfma_f32_16x16x32_bf16 v[212:215], v[52:55], a[168:171], v[212:215]
    ds_read_b64_tr_b16 a[48:49], v14 offset:49152
    v_add_f32 v98, 0xf2000000, v3
    v_mfma_f32_16x16x32_bf16 v[244:247], v[52:55], a[172:175], v[244:247]
    buffer_load_dwordx4 v1, s[8:11], s98 offen offset:1024   lds
    v_mfma_f32_16x16x32_bf16 v[152:155], v[56:59], a[160:163], v[152:155]
    ds_read_b64_tr_b16 v[52:53], v13 offset:24576
    v_min_f32 v98, v98, v66
    v_mfma_f32_16x16x32_bf16 v[184:187], v[56:59], a[164:167], v[184:187]
    ds_read_b64_tr_b16 v[54:55], v13 offset:25600
    v_add_f32 v99, 0xf2400000, v3
    v_mfma_f32_16x16x32_bf16 v[216:219], v[56:59], a[168:171], v[216:219]
    s_waitcnt lgkmcnt(7)
    ds_read_b64_tr_b16 a[50:51], v14 offset:50176
    v_min_f32 v99, v99, v67
    v_mfma_f32_16x16x32_bf16 v[248:251], v[56:59], a[172:175], v[248:251]
    buffer_load_dwordx4 v1, s[8:11], s98 offen offset:2048   lds
    v_mfma_f32_16x16x32_bf16 v[156:159], v[60:63], a[160:163], v[156:159]
    ds_read_b64_tr_b16 v[56:57], v14 offset:24576
    v_add_f32 v100, 0xf3800000, v3
    v_mfma_f32_16x16x32_bf16 v[188:191], v[60:63], a[164:167], v[188:191]
    ds_read_b64_tr_b16 v[58:59], v14 offset:25600
    v_min_f32 v100, v100, v64
    v_mfma_f32_16x16x32_bf16 v[220:223], v[60:63], a[168:171], v[220:223]
    ds_read_b64_tr_b16 a[52:53], v15 offset:49152
    v_add_f32 v101, 0xf3880000, v3
    v_mfma_f32_16x16x32_bf16 v[252:255], v[60:63], a[172:175], v[252:255]
    buffer_load_dwordx4 v1, s[8:11], s98 offen offset:3072   lds
    v_mfma_f32_16x16x32_bf16 v[128:131], v[32:35], a[176:179], v[128:131]
    s_add_u32 m0, s62, 102400
    s_add_u32 s98, s81, 36864
    ds_read_b64_tr_b16 v[60:61], v15 offset:24576
    v_mfma_f32_16x16x32_bf16 v[160:163], v[32:35], a[180:183], v[160:163]
    ds_read_b64_tr_b16 v[62:63], v15 offset:25600
    v_min_f32 v101, v101, v65
    v_mfma_f32_16x16x32_bf16 v[192:195], v[32:35], a[184:187], v[192:195]
    ds_read_b64_tr_b16 a[54:55], v15 offset:50176
    v_add_f32 v102, 0xf3900000, v3
    v_mfma_f32_16x16x32_bf16 v[224:227], v[32:35], a[188:191], v[224:227]
    buffer_load_dwordx4 v1, s[8:11], s98 offen offset:0   lds
    v_mfma_f32_16x16x32_bf16 v[132:135], v[36:39], a[176:179], v[132:135]
    ds_read_b64_tr_b16 v[32:33], v8 offset:32768
    v_min_f32 v102, v102, v66
    v_mfma_f32_16x16x32_bf16 v[164:167], v[36:39], a[180:183], v[164:167]
    ds_read_b64_tr_b16 v[34:35], v8 offset:33792
    v_add_f32 v103, 0xf3980000, v3
    v_mfma_f32_16x16x32_bf16 v[196:199], v[36:39], a[184:187], v[196:199]
    ds_read_b64_tr_b16 a[64:65], v8 offset:57344
    v_min_f32 v103, v103, v67
    v_mfma_f32_16x16x32_bf16 v[228:231], v[36:39], a[188:191], v[228:231]
    buffer_load_dwordx4 v1, s[8:11], s98 offen offset:1024   lds
    v_mfma_f32_16x16x32_bf16 v[136:139], v[40:43], a[176:179], v[136:139]
    ds_read_b64_tr_b16 v[36:37], v9 offset:32768
    v_add_f32 v104, 0x73800000, v3
    v_mfma_f32_16x16x32_bf16 v[168:171], v[40:43], a[180:183], v[168:171]
    ds_read_b64_tr_b16 v[38:39], v9 offset:33792
    v_min_f32 v104, v104, v68
    v_mfma_f32_16x16x32_bf16 v[200:203], v[40:43], a[184:187], v[200:203]
    s_waitcnt lgkmcnt(7)
    ds_read_b64_tr_b16 a[66:67], v8 offset:58368
    v_add_f32 v105, 0x73700000, v3
    v_mfma_f32_16x16x32_bf16 v[232:235], v[40:43], a[188:191], v[232:235]
    buffer_load_dwordx4 v1, s[8:11], s98 offen offset:2048   lds
    v_mfma_f32_16x16x32_bf16 v[140:143], v[44:47], a[176:179], v[140:143]
    ds_read_b64_tr_b16 v[40:41], v10 offset:32768
    v_min_f32 v105, v105, v69
    v_mfma_f32_16x16x32_bf16 v[172:175], v[44:47], a[180:183], v[172:175]
    ds_read_b64_tr_b16 v[42:43], v10 offset:33792
    v_add_f32 v106, 0x73600000, v3
    v_mfma_f32_16x16x32_bf16 v[204:207], v[44:47], a[184:187], v[204:207]
    ds_read_b64_tr_b16 a[68:69], v9 offset:57344
    v_min_f32 v106, v106, v70
    v_mfma_f32_16x16x32_bf16 v[236:239], v[44:47], a[188:191], v[236:239]
    buffer_load_dwordx4 v1, s[8:11], s98 offen offset:3072   lds
    v_mfma_f32_16x16x32_bf16 v[144:147], v[48:51], a[176:179], v[144:147]
    s_add_u32 m0, s62, 131072
    s_add_u32 s98, s82, 0
    ds_read_b64_tr_b16 v[44:45], v11 offset:32768
    v_mfma_f32_16x16x32_bf16 v[176:179], v[48:51], a[180:183], v[176:179]
    ds_read_b64_tr_b16 v[46:47], v11 offset:33792
    v_add_f32 v107, 0x73500000, v3
    v_mfma_f32_16x16x32_bf16 v[208:211], v[48:51], a[184:187], v[208:211]
    ds_read_b64_tr_b16 a[70:71], v9 offset:58368
    v_min_f32 v107, v107, v71
    v_mfma_f32_16x16x32_bf16 v[240:243], v[48:51], a[188:191], v[240:243]
    buffer_load_dwordx4 v1, s[8:11], s98 offen offset:0   lds
    v_mfma_f32_16x16x32_bf16 v[148:151], v[52:55], a[176:179], v[148:151]
    ds_read_b64_tr_b16 v[48:49], v12 offset:32768
    v_add_f32 v108, 0, v3
    v_mfma_f32_16x16x32_bf16 v[180:183], v[52:55], a[180:183], v[180:183]
    ds_read_b64_tr_b16 v[50:51], v12 offset:33792
    v_min_f32 v108, v108, v68
    v_mfma_f32_16x16x32_bf16 v[212:215], v[52:55], a[184:187], v[212:215]
    ds_read_b64_tr_b16 a[72:73], v10 offset:57344
    v_add_f32 v109, 0xf1800000, v3
    v_mfma_f32_16x16x32_bf16 v[244:247], v[52:55], a[188:191], v[244:247]
    buffer_load_dwordx4 v1, s[8:11], s98 offen offset:1024   lds
    v_mfma_f32_16x16x32_bf16 v[152:155], v[56:59], a[176:179], v[152:155]
    ds_read_b64_tr_b16 v[52:53], v13 offset:32768
    v_min_f32 v109, v109, v69
    v_mfma_f32_16x16x32_bf16 v[184:187], v[56:59], a[180:183], v[184:187]
    ds_read_b64_tr_b16 v[54:55], v13 offset:33792
    v_add_f32 v110, 0xf2000000, v3
    v_mfma_f32_16x16x32_bf16 v[216:219], v[56:59], a[184:187], v[216:219]
    s_waitcnt lgkmcnt(7)
    ds_read_b64_tr_b16 a[74:75], v10 offset:58368
    v_min_f32 v110, v110, v70
    v_mfma_f32_16x16x32_bf16 v[248:251], v[56:59], a[188:191], v[248:251]
    buffer_load_dwordx4 v1, s[8:11], s98 offen offset:2048   lds
    v_mfma_f32_16x16x32_bf16 v[156:159], v[60:63], a[176:179], v[156:159]
    ds_read_b64_tr_b16 v[56:57], v14 offset:32768
    v_add_f32 v111, 0xf2400000, v3
    v_mfma_f32_16x16x32_bf16 v[188:191], v[60:63], a[180:183], v[188:191]
    ds_read_b64_tr_b16 v[58:59], v14 offset:33792
    v_min_f32 v111, v111, v71
    v_mfma_f32_16x16x32_bf16 v[220:223], v[60:63], a[184:187], v[220:223]
    s_cmp_eq_u32 s60, 0
    s_cselect_b32 s19, 1.0, 0
    ds_read_b64_tr_b16 a[76:77], v11 offset:57344
    v_sub_f32 v3, v22, v21
    v_mfma_f32_16x16x32_bf16 v[252:255], v[60:63], a[188:191], v[252:255]
    buffer_load_dwordx4 v1, s[8:11], s98 offen offset:3072   lds
    v_mfma_f32_16x16x32_bf16 v[128:131], v[32:35], a[192:195], v[128:131]
    s_add_u32 m0, s62, 135168
    s_add_u32 s98, s82, 4096
    ds_read_b64_tr_b16 v[60:61], v15 offset:32768
    v_mfma_f32_16x16x32_bf16 v[160:163], v[32:35], a[196:199], v[160:163]
    ds_read_b64_tr_b16 v[62:63], v15 offset:33792
    v_fma_f32 v3, s19, v3, v21
    v_mfma_f32_16x16x32_bf16 v[192:195], v[32:35], a[200:203], v[192:195]
    ds_read_b64_tr_b16 a[78:79], v11 offset:58368
    v_add_f32 v80, 0, v3
    v_mfma_f32_16x16x32_bf16 v[224:227], v[32:35], a[204:207], v[224:227]
    buffer_load_dwordx4 v1, s[8:11], s98 offen offset:0   lds
    v_mfma_f32_16x16x32_bf16 v[132:135], v[36:39], a[192:195], v[132:135]
    ds_read_b64_tr_b16 v[32:33], v8 offset:40960
    v_min_f32 v80, v80, v64
    v_mfma_f32_16x16x32_bf16 v[164:167], v[36:39], a[196:199], v[164:167]
    ds_read_b64_tr_b16 v[34:35], v8 offset:41984
    v_add_f32 v81, 0xf1800000, v3
    v_mfma_f32_16x16x32_bf16 v[196:199], v[36:39], a[200:203], v[196:199]
    ds_read_b64_tr_b16 a[80:81], v12 offset:57344
    v_min_f32 v81, v81, v65
    v_mfma_f32_16x16x32_bf16 v[228:231], v[36:39], a[204:207], v[228:231]
    buffer_load_dwordx4 v1, s[8:11], s98 offen offset:1024   lds
    v_mfma_f32_16x16x32_bf16 v[136:139], v[40:43], a[192:195], v[136:139]
    ds_read_b64_tr_b16 v[36:37], v9 offset:40960
    v_add_f32 v82, 0xf2000000, v3
    v_mfma_f32_16x16x32_bf16 v[168:171], v[40:43], a[196:199], v[168:171]
    ds_read_b64_tr_b16 v[38:39], v9 offset:41984
    v_min_f32 v82, v82, v66
    v_mfma_f32_16x16x32_bf16 v[200:203], v[40:43], a[200:203], v[200:203]
    s_waitcnt lgkmcnt(7)
    ds_read_b64_tr_b16 a[82:83], v12 offset:58368
    v_add_f32 v83, 0xf2400000, v3
    v_mfma_f32_16x16x32_bf16 v[232:235], v[40:43], a[204:207], v[232:235]
    buffer_load_dwordx4 v1, s[8:11], s98 offen offset:2048   lds
    v_mfma_f32_16x16x32_bf16 v[140:143], v[44:47], a[192:195], v[140:143]
    ds_read_b64_tr_b16 v[40:41], v10 offset:40960
    v_min_f32 v83, v83, v67
    v_mfma_f32_16x16x32_bf16 v[172:175], v[44:47], a[196:199], v[172:175]
    ds_read_b64_tr_b16 v[42:43], v10 offset:41984
    v_add_f32 v84, 0xf3800000, v3
    v_mfma_f32_16x16x32_bf16 v[204:207], v[44:47], a[200:203], v[204:207]
    ds_read_b64_tr_b16 a[84:85], v13 offset:57344
    v_min_f32 v84, v84, v64
    v_mfma_f32_16x16x32_bf16 v[236:239], v[44:47], a[204:207], v[236:239]
    buffer_load_dwordx4 v1, s[8:11], s98 offen offset:3072   lds
    v_mfma_f32_16x16x32_bf16 v[144:147], v[48:51], a[192:195], v[144:147]
    ds_read_b64_tr_b16 v[44:45], v11 offset:40960
    v_add_f32 v85, 0xf3880000, v3
    v_mfma_f32_16x16x32_bf16 v[176:179], v[48:51], a[196:199], v[176:179]
    ds_read_b64_tr_b16 v[46:47], v11 offset:41984
    v_min_f32 v85, v85, v65
    v_mfma_f32_16x16x32_bf16 v[208:211], v[48:51], a[200:203], v[208:211]
    ds_read_b64_tr_b16 a[86:87], v13 offset:58368
    v_add_f32 v86, 0xf3900000, v3
    v_mfma_f32_16x16x32_bf16 v[240:243], v[48:51], a[204:207], v[240:243]
    buffer_load_dwordx4 a[0:3], v120, s[40:43], s71 offen
    v_mfma_f32_16x16x32_bf16 v[148:151], v[52:55], a[192:195], v[148:151]
    ds_read_b64_tr_b16 v[48:49], v12 offset:40960
    v_min_f32 v86, v86, v66
    v_mfma_f32_16x16x32_bf16 v[180:183], v[52:55], a[196:199], v[180:183]
    ds_read_b64_tr_b16 v[50:51], v12 offset:41984
    v_add_f32 v87, 0xf3980000, v3
    v_mfma_f32_16x16x32_bf16 v[212:215], v[52:55], a[200:203], v[212:215]
    ds_read_b64_tr_b16 a[88:89], v14 offset:57344
    v_min_f32 v87, v87, v67
    v_mfma_f32_16x16x32_bf16 v[244:247], v[52:55], a[204:207], v[244:247]
    buffer_load_dwordx4 a[4:7], v120, s[40:43], s71 offen offset:3584
    v_mfma_f32_16x16x32_bf16 v[152:155], v[56:59], a[192:195], v[152:155]
    ds_read_b64_tr_b16 v[52:53], v13 offset:40960
    v_add_f32 v88, 0x73800000, v3
    v_mfma_f32_16x16x32_bf16 v[184:187], v[56:59], a[196:199], v[184:187]
    ds_read_b64_tr_b16 v[54:55], v13 offset:41984
    v_min_f32 v88, v88, v68
    v_mfma_f32_16x16x32_bf16 v[216:219], v[56:59], a[200:203], v[216:219]
    s_waitcnt lgkmcnt(7)
    ds_read_b64_tr_b16 a[90:91], v14 offset:58368
    v_add_f32 v89, 0x73700000, v3
    v_mfma_f32_16x16x32_bf16 v[248:251], v[56:59], a[204:207], v[248:251]
    buffer_load_dwordx4 a[8:11], v120, s[44:47], s71 offen
    v_mfma_f32_16x16x32_bf16 v[156:159], v[60:63], a[192:195], v[156:159]
    ds_read_b64_tr_b16 v[56:57], v14 offset:40960
    v_min_f32 v89, v89, v69
    v_mfma_f32_16x16x32_bf16 v[188:191], v[60:63], a[196:199], v[188:191]
    ds_read_b64_tr_b16 v[58:59], v14 offset:41984
    v_add_f32 v90, 0x73600000, v3
    v_mfma_f32_16x16x32_bf16 v[220:223], v[60:63], a[200:203], v[220:223]
    ds_read_b64_tr_b16 a[92:93], v15 offset:57344
    v_min_f32 v90, v90, v70
    v_mfma_f32_16x16x32_bf16 v[252:255], v[60:63], a[204:207], v[252:255]
    buffer_load_dwordx4 a[12:15], v120, s[44:47], s71 offen offset:3584
    v_mfma_f32_16x16x32_bf16 v[192:195], v[32:35], a[216:219], v[192:195]
    s_waitcnt vmcnt(34)
    s_lshl_b32 s71, s101, 16
    ds_read_b64_tr_b16 v[60:61], v15 offset:40960
    v_add_f32 v91, 0x73500000, v3
    v_mfma_f32_16x16x32_bf16 v[192:195], a[24:27], a[232:235], v[192:195]
    s_waitcnt vmcnt(26)
    s_lshl_b32 s100, s3, 11
    ds_read_b64_tr_b16 v[62:63], v15 offset:41984
    v_min_f32 v91, v91, v71
    v_mfma_f32_16x16x32_bf16 v[192:195], a[64:67], a[248:251], v[192:195]
    s_add_u32 s71, s71, s100
    ds_read_b64_tr_b16 a[94:95], v15 offset:58368
    v_add_f32 v92, 0, v3
    v_mfma_f32_16x16x32_bf16 v[196:199], v[36:39], a[216:219], v[196:199]
    s_lshl_b32 s100, s4, 7
    v_min_f32 v92, v92, v68
    v_add_f32 v93, 0xf1800000, v3
    v_mfma_f32_16x16x32_bf16 v[196:199], a[28:31], a[232:235], v[196:199]
    s_add_u32 s71, s71, s100
    v_min_f32 v93, v93, v69
    v_add_f32 v94, 0xf2000000, v3
    v_mfma_f32_16x16x32_bf16 v[196:199], a[68:71], a[248:251], v[196:199]
    v_min_f32 v94, v94, v70
    v_add_f32 v95, 0xf2400000, v3
    v_mfma_f32_16x16x32_bf16 v[224:227], v[32:35], a[220:223], v[224:227]
    buffer_load_dwordx4 a[16:19], v121, s[48:51], s71 offen
    v_mfma_f32_16x16x32_bf16 v[224:227], a[24:27], a[236:239], v[224:227]
    s_waitcnt vmcnt(26)
    v_min_f32 v95, v95, v71
    s_waitcnt lgkmcnt(0)
    s_barrier
    v_mfma_f32_16x16x32_bf16 v[224:227], a[64:67], a[252:255], v[224:227]
    buffer_load_dwordx4 a[20:23], v121, s[48:51], s71 offen offset:1024
    v_mfma_f32_16x16x32_bf16 v[228:231], v[36:39], a[220:223], v[228:231]
    v_cvt_pk_bf16_f32 v192, v192, v193
    v_cvt_pk_bf16_f32 v193, v194, v195
    v_mfma_f32_16x16x32_bf16 v[228:231], a[28:31], a[236:239], v[228:231]
    v_cvt_pk_bf16_f32 v194, v196, v197
    v_cvt_pk_bf16_f32 v195, v198, v199
    v_mfma_f32_16x16x32_bf16 v[228:231], a[68:71], a[252:255], v[228:231]
    ds_write_b128 v16, v[192:195] offset:32768
    v_lshrrev_b32 v121, 1, v2
    v_mfma_f32_16x16x32_bf16 v[128:131], v[32:35], a[208:211], v[128:131]
    v_and_b32 v121, 15, v121
    v_lshlrev_b32 v121, 10, v121
    v_mfma_f32_16x16x32_bf16 v[128:131], a[24:27], a[224:227], v[128:131]
    v_and_b32 v122, 1, v2
    v_lshl_add_u32 v121, v122, 7, v121
    v_mfma_f32_16x16x32_bf16 v[128:131], a[64:67], a[240:243], v[128:131]
    v_mfma_f32_16x16x32_bf16 v[132:135], v[36:39], a[208:211], v[132:135]
    s_lshl_b32 s71, s6, 2
    v_cvt_pk_bf16_f32 v224, v224, v225
    v_cvt_pk_bf16_f32 v225, v226, v227
    v_mfma_f32_16x16x32_bf16 v[132:135], a[28:31], a[224:227], v[132:135]
    s_add_u32 s71, s71, s3
    v_cvt_pk_bf16_f32 v226, v228, v229
    v_cvt_pk_bf16_f32 v227, v230, v231
    v_mfma_f32_16x16x32_bf16 v[132:135], a[68:71], a[240:243], v[132:135]
    s_lshl_b32 s71, s71, 14
    ds_write_b128 v16, v[224:227] offset:36864
    v_mfma_f32_16x16x32_bf16 v[160:163], v[32:35], a[212:215], v[160:163]
    buffer_load_dword a60, v121, s[28:31], s71 offen
    v_mfma_f32_16x16x32_bf16 v[160:163], a[24:27], a[228:231], v[160:163]
    v_mfma_f32_16x16x32_bf16 v[160:163], a[64:67], a[244:247], v[160:163]
    s_getpc_b64 s[100:101]
L_ct2:
    s_lshr_b32 s99, s2, 3
    s_lshl_b32 s99, s99, 2
    s_add_u32 s99, s99, s3
    s_mul_i32 s99, s99, 6
    v_min_u32 v123, 5, v2
    v_add_u32 v123, s99, v123
    v_lshlrev_b32 v123, 7, v123
    v_add_u32 v123, L_attn-L_ct2, v123
    v_min_u32 v123, L_code_end-L_ct2, v123
    global_load_dword a61, v123, s[100:101]
    v_mfma_f32_16x16x32_bf16 v[164:167], v[36:39], a[212:215], v[164:167]
    v_cvt_pk_bf16_f32 v128, v128, v129
    v_cvt_pk_bf16_f32 v129, v130, v131
    v_mfma_f32_16x16x32_bf16 v[164:167], a[28:31], a[228:231], v[164:167]
    v_cvt_pk_bf16_f32 v130, v132, v133
    v_cvt_pk_bf16_f32 v131, v134, v135
    v_mfma_f32_16x16x32_bf16 v[164:167], a[68:71], a[244:247], v[164:167]
    ds_write_b128 v16, v[128:131] offset:0
    v_mfma_f32_16x16x32_bf16 v[200:203], v[40:43], a[216:219], v[200:203]
    v_mfma_f32_16x16x32_bf16 v[200:203], a[32:35], a[232:235], v[200:203]
    v_mfma_f32_16x16x32_bf16 v[200:203], a[72:75], a[248:251], v[200:203]
    v_mfma_f32_16x16x32_bf16 v[204:207], v[44:47], a[216:219], v[204:207]
    v_cvt_pk_bf16_f32 v160, v160, v161
    v_cvt_pk_bf16_f32 v161, v162, v163
    v_mfma_f32_16x16x32_bf16 v[204:207], a[36:39], a[232:235], v[204:207]
    v_cvt_pk_bf16_f32 v162, v164, v165
    v_cvt_pk_bf16_f32 v163, v166, v167
    v_mfma_f32_16x16x32_bf16 v[204:207], a[76:79], a[248:251], v[204:207]
    ds_write_b128 v16, v[160:163] offset:4096
    v_mfma_f32_16x16x32_bf16 v[232:235], v[40:43], a[220:223], v[232:235]
    v_mfma_f32_16x16x32_bf16 v[232:235], a[32:35], a[236:239], v[232:235]
    v_mfma_f32_16x16x32_bf16 v[232:235], a[72:75], a[252:255], v[232:235]
    v_mfma_f32_16x16x32_bf16 v[236:239], v[44:47], a[220:223], v[236:239]
    v_cvt_pk_bf16_f32 v200, v200, v201
    v_cvt_pk_bf16_f32 v201, v202, v203
    v_mfma_f32_16x16x32_bf16 v[236:239], a[36:39], a[236:239], v[236:239]
    v_cvt_pk_bf16_f32 v202, v204, v205
    v_cvt_pk_bf16_f32 v203, v206, v207
    v_mfma_f32_16x16x32_bf16 v[236:239], a[76:79], a[252:255], v[236:239]
    ds_write_b128 v16, v[200:203] offset:33792
    v_mfma_f32_16x16x32_bf16 v[136:139], v[40:43], a[208:211], v[136:139]
    v_mfma_f32_16x16x32_bf16 v[136:139], a[32:35], a[224:227], v[136:139]
    v_mfma_f32_16x16x32_bf16 v[136:139], a[72:75], a[240:243], v[136:139]
    v_mfma_f32_16x16x32_bf16 v[140:143], v[44:47], a[208:211], v[140:143]
    v_cvt_pk_bf16_f32 v232, v232, v233
    v_cvt_pk_bf16_f32 v233, v234, v235
    v_mfma_f32_16x16x32_bf16 v[140:143], a[36:39], a[224:227], v[140:143]
    v_cvt_pk_bf16_f32 v234, v236, v237
    v_cvt_pk_bf16_f32 v235, v238, v239
    v_mfma_f32_16x16x32_bf16 v[140:143], a[76:79], a[240:243], v[140:143]
    ds_write_b128 v16, v[232:235] offset:37888
    v_mfma_f32_16x16x32_bf16 v[168:171], v[40:43], a[212:215], v[168:171]
    v_mfma_f32_16x16x32_bf16 v[168:171], a[32:35], a[228:231], v[168:171]
    v_mfma_f32_16x16x32_bf16 v[168:171], a[72:75], a[244:247], v[168:171]
    v_mfma_f32_16x16x32_bf16 v[172:175], v[44:47], a[212:215], v[172:175]
    v_cvt_pk_bf16_f32 v136, v136, v137
    v_cvt_pk_bf16_f32 v137, v138, v139
    v_mfma_f32_16x16x32_bf16 v[172:175], a[36:39], a[228:231], v[172:175]
    v_cvt_pk_bf16_f32 v138, v140, v141
    v_cvt_pk_bf16_f32 v139, v142, v143
    v_mfma_f32_16x16x32_bf16 v[172:175], a[76:79], a[244:247], v[172:175]
    ds_write_b128 v16, v[136:139] offset:1024
    v_mfma_f32_16x16x32_bf16 v[208:211], v[48:51], a[216:219], v[208:211]
    v_mfma_f32_16x16x32_bf16 v[208:211], a[40:43], a[232:235], v[208:211]
    v_mfma_f32_16x16x32_bf16 v[208:211], a[80:83], a[248:251], v[208:211]
    v_mfma_f32_16x16x32_bf16 v[212:215], v[52:55], a[216:219], v[212:215]
    v_cvt_pk_bf16_f32 v168, v168, v169
    v_cvt_pk_bf16_f32 v169, v170, v171
    v_mfma_f32_16x16x32_bf16 v[212:215], a[44:47], a[232:235], v[212:215]
    v_cvt_pk_bf16_f32 v170, v172, v173
    v_cvt_pk_bf16_f32 v171, v174, v175
    v_mfma_f32_16x16x32_bf16 v[212:215], a[84:87], a[248:251], v[212:215]
    ds_write_b128 v16, v[168:171] offset:5120
    v_mfma_f32_16x16x32_bf16 v[240:243], v[48:51], a[220:223], v[240:243]
    v_mfma_f32_16x16x32_bf16 v[240:243], a[40:43], a[236:239], v[240:243]
    v_mfma_f32_16x16x32_bf16 v[240:243], a[80:83], a[252:255], v[240:243]
    v_mfma_f32_16x16x32_bf16 v[244:247], v[52:55], a[220:223], v[244:247]
    v_cvt_pk_bf16_f32 v208, v208, v209
    v_cvt_pk_bf16_f32 v209, v210, v211
    v_mfma_f32_16x16x32_bf16 v[244:247], a[44:47], a[236:239], v[244:247]
    v_cvt_pk_bf16_f32 v210, v212, v213
    v_cvt_pk_bf16_f32 v211, v214, v215
    v_mfma_f32_16x16x32_bf16 v[244:247], a[84:87], a[252:255], v[244:247]
    ds_write_b128 v16, v[208:211] offset:34816
    v_mfma_f32_16x16x32_bf16 v[144:147], v[48:51], a[208:211], v[144:147]
    v_mfma_f32_16x16x32_bf16 v[144:147], a[40:43], a[224:227], v[144:147]
    v_mfma_f32_16x16x32_bf16 v[144:147], a[80:83], a[240:243], v[144:147]
    v_mfma_f32_16x16x32_bf16 v[148:151], v[52:55], a[208:211], v[148:151]
    v_cvt_pk_bf16_f32 v240, v240, v241
    v_cvt_pk_bf16_f32 v241, v242, v243
    v_mfma_f32_16x16x32_bf16 v[148:151], a[44:47], a[224:227], v[148:151]
    v_cvt_pk_bf16_f32 v242, v244, v245
    v_cvt_pk_bf16_f32 v243, v246, v247
    v_mfma_f32_16x16x32_bf16 v[148:151], a[84:87], a[240:243], v[148:151]
    ds_write_b128 v16, v[240:243] offset:38912
    v_mfma_f32_16x16x32_bf16 v[176:179], v[48:51], a[212:215], v[176:179]
    v_mfma_f32_16x16x32_bf16 v[176:179], a[40:43], a[228:231], v[176:179]
    v_mfma_f32_16x16x32_bf16 v[176:179], a[80:83], a[244:247], v[176:179]
    v_mfma_f32_16x16x32_bf16 v[180:183], v[52:55], a[212:215], v[180:183]
    v_cvt_pk_bf16_f32 v144, v144, v145
    v_cvt_pk_bf16_f32 v145, v146, v147
    v_mfma_f32_16x16x32_bf16 v[180:183], a[44:47], a[228:231], v[180:183]
    v_cvt_pk_bf16_f32 v146, v148, v149
    v_cvt_pk_bf16_f32 v147, v150, v151
    v_mfma_f32_16x16x32_bf16 v[180:183], a[84:87], a[244:247], v[180:183]
    ds_write_b128 v16, v[144:147] offset:2048
    v_mfma_f32_16x16x32_bf16 v[216:219], v[56:59], a[216:219], v[216:219]
    v_mfma_f32_16x16x32_bf16 v[216:219], a[48:51], a[232:235], v[216:219]
    v_mfma_f32_16x16x32_bf16 v[216:219], a[88:91], a[248:251], v[216:219]
    v_mfma_f32_16x16x32_bf16 v[220:223], v[60:63], a[216:219], v[220:223]
    v_cvt_pk_bf16_f32 v176, v176, v177
    v_cvt_pk_bf16_f32 v177, v178, v179
    v_mfma_f32_16x16x32_bf16 v[220:223], a[52:55], a[232:235], v[220:223]
    v_cvt_pk_bf16_f32 v178, v180, v181
    v_cvt_pk_bf16_f32 v179, v182, v183
    v_mfma_f32_16x16x32_bf16 v[220:223], a[92:95], a[248:251], v[220:223]
    ds_write_b128 v16, v[176:179] offset:6144
    v_mfma_f32_16x16x32_bf16 v[248:251], v[56:59], a[220:223], v[248:251]
    v_mfma_f32_16x16x32_bf16 v[248:251], a[48:51], a[236:239], v[248:251]
    v_mfma_f32_16x16x32_bf16 v[248:251], a[88:91], a[252:255], v[248:251]
    v_mfma_f32_16x16x32_bf16 v[252:255], v[60:63], a[220:223], v[252:255]
    v_cvt_pk_bf16_f32 v216, v216, v217
    v_cvt_pk_bf16_f32 v217, v218, v219
    v_mfma_f32_16x16x32_bf16 v[252:255], a[52:55], a[236:239], v[252:255]
    v_cvt_pk_bf16_f32 v218, v220, v221
    v_cvt_pk_bf16_f32 v219, v222, v223
    v_mfma_f32_16x16x32_bf16 v[252:255], a[92:95], a[252:255], v[252:255]
    ds_write_b128 v16, v[216:219] offset:35840
    v_mfma_f32_16x16x32_bf16 v[152:155], v[56:59], a[208:211], v[152:155]
    v_mfma_f32_16x16x32_bf16 v[152:155], a[48:51], a[224:227], v[152:155]
    v_mfma_f32_16x16x32_bf16 v[152:155], a[88:91], a[240:243], v[152:155]
    v_mfma_f32_16x16x32_bf16 v[156:159], v[60:63], a[208:211], v[156:159]
    v_cvt_pk_bf16_f32 v248, v248, v249
    v_cvt_pk_bf16_f32 v249, v250, v251
    v_mfma_f32_16x16x32_bf16 v[156:159], a[52:55], a[224:227], v[156:159]
    v_cvt_pk_bf16_f32 v250, v252, v253
    v_cvt_pk_bf16_f32 v251, v254, v255
    v_mfma_f32_16x16x32_bf16 v[156:159], a[92:95], a[240:243], v[156:159]
    ds_write_b128 v16, v[248:251] offset:39936
    v_mfma_f32_16x16x32_bf16 v[184:187], v[56:59], a[212:215], v[184:187]
    v_mfma_f32_16x16x32_bf16 v[184:187], a[48:51], a[228:231], v[184:187]
    v_mfma_f32_16x16x32_bf16 v[184:187], a[88:91], a[244:247], v[184:187]
    v_mfma_f32_16x16x32_bf16 v[188:191], v[60:63], a[212:215], v[188:191]
    v_cvt_pk_bf16_f32 v152, v152, v153
    v_cvt_pk_bf16_f32 v153, v154, v155
    v_mfma_f32_16x16x32_bf16 v[188:191], a[52:55], a[228:231], v[188:191]
    v_cvt_pk_bf16_f32 v154, v156, v157
    v_cvt_pk_bf16_f32 v155, v158, v159
    v_mfma_f32_16x16x32_bf16 v[188:191], a[92:95], a[244:247], v[188:191]
    ds_write_b128 v16, v[152:155] offset:3072
L_attn:
    v_add_u32 v15, 4096, v1
    v_cvt_pk_bf16_f32 v184, v184, v185
    v_cvt_pk_bf16_f32 v185, v186, v187
    s_nop 3
    v_cvt_pk_bf16_f32 v186, v188, v189
    v_cvt_pk_bf16_f32 v187, v190, v191
    ds_write_b128 v16, v[184:187] offset:7168
    s_waitcnt vmcnt(24) lgkmcnt(0)
    s_barrier
    ds_read_b128 a[64:67], v17 offset:0
    ds_read_b128 a[128:131], v18 offset:0
    ds_read_b128 a[68:71], v17 offset:1024
    ds_read_b128 a[132:135], v18 offset:1024
    ds_read_b128 a[72:75], v17 offset:2048
    ds_read_b128 a[136:139], v18 offset:2048
    ds_read_b128 a[76:79], v17 offset:3072
    ds_read_b128 a[140:143], v18 offset:3072
    ds_read_b128 a[144:147], v18 offset:4096
    ds_read_b128 a[148:151], v18 offset:5120
    ds_read_b128 a[152:155], v18 offset:6144
    ds_read_b128 a[156:159], v18 offset:7168
    ds_read_b128 a[80:83], v17 offset:4096
    ds_read_b128 a[84:87], v17 offset:5120
    ds_read_b128 a[88:91], v17 offset:6144
    ds_read_b128 a[92:95], v17 offset:7168
    s_waitcnt lgkmcnt(14)
    v_mfma_f32_16x16x32_bf16 v[96:99], a[128:131], a[64:67], v[96:99]
    s_waitcnt lgkmcnt(12)
    s_add_u32 s19, s82, 32768
    s_sub_u32 s82, s12, s13
    ds_read_b128 a[96:99], v17 offset:8192
    v_mfma_f32_16x16x32_bf16 v[96:99], a[132:135], a[68:71], v[96:99]
    s_waitcnt lgkmcnt(11)
    s_sub_u32 s82, s82, 1
    s_cmp_gt_u32 s12, s13
    s_cselect_b32 s82, s82, s12
    ds_read_b128 a[100:103], v17 offset:9216
    v_mfma_f32_16x16x32_bf16 v[96:99], a[136:139], a[72:75], v[96:99]
    s_waitcnt lgkmcnt(10)
    s_mul_i32 s82, s82, 65536
    s_add_u32 s82, s82, s81
    ds_read_b128 a[104:107], v17 offset:10240
    v_mfma_f32_16x16x32_bf16 v[96:99], a[140:143], a[76:79], v[96:99]
    s_waitcnt lgkmcnt(10)
    s_cmp_ge_u32 s12, 17
    s_cselect_b32 s82, 2147471360, s82
    s_add_u32 s12, s12, 1
    ds_read_b128 a[108:111], v17 offset:11264
    v_mfma_f32_16x16x32_bf16 v[100:103], a[144:147], a[64:67], v[100:103]
    s_waitcnt lgkmcnt(10)
    s_sub_u32 s14, s60, 1
    ds_read_b128 a[112:115], v17 offset:12288
    v_mfma_f32_16x16x32_bf16 v[100:103], a[148:151], a[68:71], v[100:103]
    s_waitcnt lgkmcnt(10)
    ds_read_b128 a[116:119], v17 offset:13312
    v_mfma_f32_16x16x32_bf16 v[100:103], a[152:155], a[72:75], v[100:103]
    s_waitcnt lgkmcnt(10)
    ds_read_b128 a[120:123], v17 offset:14336
    v_mfma_f32_16x16x32_bf16 v[100:103], a[156:159], a[76:79], v[100:103]
    s_waitcnt lgkmcnt(10)
    ds_read_b128 a[124:127], v17 offset:15360
    v_mfma_f32_16x16x32_bf16 v[104:107], a[128:131], a[80:83], v[104:107]
    s_waitcnt lgkmcnt(10)
    ds_read_b128 a[192:195], v17 offset:32768
    v_exp_f32 v96, v96
    v_mfma_f32_16x16x32_bf16 v[104:107], a[132:135], a[84:87], v[104:107]
    s_waitcnt lgkmcnt(10)
    ds_read_b128 a[196:199], v17 offset:33792
    v_exp_f32 v97, v97
    v_mfma_f32_16x16x32_bf16 v[104:107], a[136:139], a[88:91], v[104:107]
    s_waitcnt lgkmcnt(10)
    ds_read_b128 a[200:203], v17 offset:34816
    v_exp_f32 v98, v98
    v_mfma_f32_16x16x32_bf16 v[104:107], a[140:143], a[92:95], v[104:107]
    ds_read_b128 a[204:207], v17 offset:35840
    v_exp_f32 v99, v99
    v_mfma_f32_16x16x32_bf16 v[108:111], a[144:147], a[80:83], v[108:111]
    ds_read_b128 a[208:211], v17 offset:36864
    v_exp_f32 v100, v100
    v_mfma_f32_16x16x32_bf16 v[108:111], a[148:151], a[84:87], v[108:111]
    ds_read_b128 a[212:215], v17 offset:37888
    v_exp_f32 v101, v101
    v_mfma_f32_16x16x32_bf16 v[108:111], a[152:155], a[88:91], v[108:111]
    ds_read_b128 a[216:219], v17 offset:38912
    v_exp_f32 v102, v102
    v_mfma_f32_16x16x32_bf16 v[108:111], a[156:159], a[92:95], v[108:111]
    s_waitcnt lgkmcnt(14)
    ds_read_b128 a[220:223], v17 offset:39936
    v_exp_f32 v103, v103
    v_mfma_f32_16x16x32_bf16 v[112:115], a[128:131], a[96:99], v[72:75]
    s_waitcnt lgkmcnt(14)
    ds_read_b128 a[224:227], v17 offset:40960
    v_exp_f32 v104, v104
    v_mfma_f32_16x16x32_bf16 v[112:115], a[132:135], a[100:103], v[112:115]
    s_waitcnt lgkmcnt(14)
    ds_read_b128 a[228:231], v17 offset:41984
    v_exp_f32 v105, v105
    v_mfma_f32_16x16x32_bf16 v[112:115], a[136:139], a[104:107], v[112:115]
    s_waitcnt lgkmcnt(14)
    ds_read_b128 a[232:235], v17 offset:43008
    v_exp_f32 v106, v106
    v_mfma_f32_16x16x32_bf16 v[112:115], a[140:143], a[108:111], v[112:115]
    s_waitcnt lgkmcnt(14)
    ds_read_b128 a[236:239], v17 offset:44032
    v_exp_f32 v107, v107
    v_mfma_f32_16x16x32_bf16 v[120:123], a[128:131], a[112:115], v[76:79]
    s_waitcnt lgkmcnt(14)
    ds_read_b128 a[240:243], v17 offset:45056
    v_exp_f32 v108, v108
    v_mfma_f32_16x16x32_bf16 v[120:123], a[132:135], a[116:119], v[120:123]
    s_waitcnt lgkmcnt(14)
    ds_read_b128 a[244:247], v17 offset:46080
    v_exp_f32 v109, v109
    v_mfma_f32_16x16x32_bf16 v[120:123], a[136:139], a[120:123], v[120:123]
    s_waitcnt lgkmcnt(14)
    ds_read_b128 a[248:251], v17 offset:47104
    v_exp_f32 v110, v110
    v_mfma_f32_16x16x32_bf16 v[120:123], a[140:143], a[124:127], v[120:123]
    ds_read_b128 a[252:255], v17 offset:48128
    v_exp_f32 v111, v111
    v_mfma_f32_16x16x32_bf16 v[116:119], a[144:147], a[96:99], v[72:75]
    ds_read_b128 a[128:131], v18 offset:16384
    v_cvt_pk_bf16_f32 v48, v96, v97
    v_mfma_f32_16x16x32_bf16 v[116:119], a[148:151], a[100:103], v[116:119]
    ds_read_b128 a[132:135], v18 offset:17408
    v_cvt_pk_bf16_f32 v49, v98, v99
    v_mfma_f32_16x16x32_bf16 v[116:119], a[152:155], a[104:107], v[116:119]
    ds_read_b128 a[136:139], v18 offset:18432
    v_cvt_pk_bf16_f32 v50, v100, v101
    v_mfma_f32_16x16x32_bf16 v[116:119], a[156:159], a[108:111], v[116:119]
    ds_read_b128 a[140:143], v18 offset:19456
    v_cvt_pk_bf16_f32 v51, v102, v103
    v_mfma_f32_16x16x32_bf16 v[124:127], a[144:147], a[112:115], v[76:79]
    ds_read_b128 a[144:147], v18 offset:20480
    v_cvt_pk_bf16_f32 v52, v104, v105
    v_mfma_f32_16x16x32_bf16 v[124:127], a[148:151], a[116:119], v[124:127]
    ds_read_b128 a[148:151], v18 offset:21504
    v_cvt_pk_bf16_f32 v53, v106, v107
    v_mfma_f32_16x16x32_bf16 v[124:127], a[152:155], a[120:123], v[124:127]
    ds_read_b128 a[152:155], v18 offset:22528
    v_cvt_pk_bf16_f32 v54, v108, v109
    v_mfma_f32_16x16x32_bf16 v[124:127], a[156:159], a[124:127], v[124:127]
    ds_read_b128 a[156:159], v18 offset:23552
    v_cvt_pk_bf16_f32 v55, v110, v111
    v_xor_b32 v18, 196608, v18
    v_lshrrev_b32 v17, 4, v2
    v_lshlrev_b32 v17, 15, v17
    v_and_b32 v14, 255, v1
    v_add_u32 v17, v17, v14
L_t1_p1:
    s_waitcnt vmcnt(8) lgkmcnt(0)
    s_barrier
    s_cmp_eq_u32 s60, 0
    s_cbranch_scc1 L_t1_zero
    v_mfma_f32_16x16x32_bf16 v[96:99], a[128:131], a[64:67], v[64:67]
    s_add_u32 m0, s15, 0
    ds_read_b128 a[160:163], v19 offset:0
    v_mfma_f32_16x16x32_bf16 v[96:99], a[132:135], a[68:71], v[96:99]
    ds_read_b128 a[164:167], v19 offset:1024
    v_mfma_f32_16x16x32_bf16 v[96:99], a[136:139], a[72:75], v[96:99]
    v_exp_f32 v112, v112
    v_mfma_f32_16x16x32_bf16 v[96:99], a[140:143], a[76:79], v[96:99]
    buffer_load_dwordx4 v1, s[8:11], s82 offen offset:0  lds
    v_mfma_f32_16x16x32_bf16 v[104:107], a[128:131], a[80:83], v[68:71]
    v_exp_f32 v113, v113
    v_mfma_f32_16x16x32_bf16 v[104:107], a[132:135], a[84:87], v[104:107]
    ds_read_b128 a[168:171], v19 offset:2048
    v_cvt_pk_bf16_f32 v56, v112, v113
    v_mfma_f32_16x16x32_bf16 v[104:107], a[136:139], a[88:91], v[104:107]
    v_exp_f32 v114, v114
    v_mfma_f32_16x16x32_bf16 v[104:107], a[140:143], a[92:95], v[104:107]
    buffer_load_dwordx4 v1, s[8:11], s82 offen offset:1024  lds
    v_mfma_f32_16x16x32_bf16 v[100:103], a[144:147], a[64:67], v[64:67]
    v_exp_f32 v115, v115
    v_mfma_f32_16x16x32_bf16 v[100:103], a[148:151], a[68:71], v[100:103]
    ds_read_b128 a[172:175], v19 offset:3072
    v_cvt_pk_bf16_f32 v57, v114, v115
    v_mfma_f32_16x16x32_bf16 v[100:103], a[152:155], a[72:75], v[100:103]
    v_exp_f32 v116, v116
    v_mfma_f32_16x16x32_bf16 v[100:103], a[156:159], a[76:79], v[100:103]
    buffer_load_dwordx4 v1, s[8:11], s82 offen offset:2048  lds
    v_mfma_f32_16x16x32_bf16 v[108:111], a[144:147], a[80:83], v[68:71]
    v_exp_f32 v117, v117
    v_mfma_f32_16x16x32_bf16 v[108:111], a[148:151], a[84:87], v[108:111]
    ds_read_b128 a[176:179], v20 offset:4096
    v_cvt_pk_bf16_f32 v58, v116, v117
    v_mfma_f32_16x16x32_bf16 v[108:111], a[152:155], a[88:91], v[108:111]
    v_exp_f32 v118, v118
    v_mfma_f32_16x16x32_bf16 v[108:111], a[156:159], a[92:95], v[108:111]
    buffer_load_dwordx4 v1, s[8:11], s82 offen offset:3072  lds
    v_mfma_f32_16x16x32_bf16 v[32:35], v[28:31], v[48:51], 0
    s_add_u32 m0, s15, 4096
    v_exp_f32 v119, v119
    v_mfma_f32_16x16x32_bf16 v[36:39], v[28:31], v[52:55], 0
    s_waitcnt lgkmcnt(4)
    ds_read_b128 a[180:183], v20 offset:5120
    v_cvt_pk_bf16_f32 v59, v118, v119
    v_mfma_f32_16x16x32_bf16 v[128:131], a[160:163], v[48:51], 0
    v_exp_f32 v120, v120
    v_mfma_f32_16x16x32_bf16 v[160:163], a[160:163], v[52:55], 0
    s_waitcnt lgkmcnt(4)
    v_mfma_f32_16x16x32_bf16 v[132:135], a[164:167], v[48:51], 0
    v_exp_f32 v121, v121
    v_mfma_f32_16x16x32_bf16 v[164:167], a[164:167], v[52:55], 0
    s_waitcnt lgkmcnt(3)
    ds_read_b128 a[184:187], v20 offset:6144
    v_cvt_pk_bf16_f32 v60, v120, v121
    v_mfma_f32_16x16x32_bf16 v[136:139], a[168:171], v[48:51], 0
    s_waitcnt lgkmcnt(3)
    v_exp_f32 v122, v122
    v_mfma_f32_16x16x32_bf16 v[168:171], a[168:171], v[52:55], 0
    buffer_load_dwordx4 v15, s[8:11], s82 offen offset:0  lds
    v_mfma_f32_16x16x32_bf16 v[140:143], a[172:175], v[48:51], 0
    v_exp_f32 v123, v123
    v_mfma_f32_16x16x32_bf16 v[172:175], a[172:175], v[52:55], 0
    s_waitcnt lgkmcnt(2)
    ds_read_b128 a[188:191], v20 offset:7168
    v_cvt_pk_bf16_f32 v61, v122, v123
    v_mfma_f32_16x16x32_bf16 v[144:147], a[176:179], v[48:51], 0
    s_waitcnt lgkmcnt(2)
    v_exp_f32 v124, v124
    v_mfma_f32_16x16x32_bf16 v[176:179], a[176:179], v[52:55], 0
    buffer_load_dwordx4 v15, s[8:11], s82 offen offset:1024  lds
    v_mfma_f32_16x16x32_bf16 v[148:151], a[180:183], v[48:51], 0
    v_exp_f32 v125, v125
    v_mfma_f32_16x16x32_bf16 v[180:183], a[180:183], v[52:55], 0
    s_waitcnt lgkmcnt(1)
    v_cvt_pk_bf16_f32 v62, v124, v125
    v_mfma_f32_16x16x32_bf16 v[152:155], a[184:187], v[48:51], 0
    s_waitcnt lgkmcnt(0)
    v_exp_f32 v126, v126
    v_mfma_f32_16x16x32_bf16 v[184:187], a[184:187], v[52:55], 0
    buffer_load_dwordx4 v15, s[8:11], s82 offen offset:2048  lds
    v_mfma_f32_16x16x32_bf16 v[156:159], a[188:191], v[48:51], 0
    v_exp_f32 v127, v127
    v_mfma_f32_16x16x32_bf16 v[188:191], a[188:191], v[52:55], 0
    v_cvt_pk_bf16_f32 v63, v126, v127
    v_mfma_f32_16x16x32_bf16 v[112:115], a[128:131], a[96:99], v[72:75]
    v_mfma_f32_16x16x32_bf16 v[112:115], a[132:135], a[100:103], v[112:115]
    v_mfma_f32_16x16x32_bf16 v[112:115], a[136:139], a[104:107], v[112:115]
    v_exp_f32 v96, v96
    v_mfma_f32_16x16x32_bf16 v[112:115], a[140:143], a[108:111], v[112:115]
    buffer_load_dwordx4 v15, s[8:11], s82 offen offset:3072  lds
    v_mfma_f32_16x16x32_bf16 v[120:123], a[128:131], a[112:115], v[76:79]
    s_xor_b32 s15, s15, 196608
    v_exp_f32 v97, v97
    v_mfma_f32_16x16x32_bf16 v[120:123], a[132:135], a[116:119], v[120:123]
    s_add_u32 m0, s16, 0
    ds_read_b128 a[128:131], v18 offset:0
    v_cvt_pk_bf16_f32 v48, v96, v97
    v_mfma_f32_16x16x32_bf16 v[120:123], a[136:139], a[120:123], v[120:123]
    v_exp_f32 v98, v98
    v_mfma_f32_16x16x32_bf16 v[120:123], a[140:143], a[124:127], v[120:123]
    buffer_load_dwordx4 v1, s[8:11], s19 offen offset:0  lds
    v_mfma_f32_16x16x32_bf16 v[116:119], a[144:147], a[96:99], v[72:75]
    v_exp_f32 v99, v99
    v_mfma_f32_16x16x32_bf16 v[116:119], a[148:151], a[100:103], v[116:119]
    ds_read_b128 a[132:135], v18 offset:1024
    v_cvt_pk_bf16_f32 v49, v98, v99
    v_mfma_f32_16x16x32_bf16 v[116:119], a[152:155], a[104:107], v[116:119]
    v_exp_f32 v100, v100
    v_mfma_f32_16x16x32_bf16 v[116:119], a[156:159], a[108:111], v[116:119]
    buffer_load_dwordx4 v1, s[8:11], s19 offen offset:1024  lds
    v_mfma_f32_16x16x32_bf16 v[124:127], a[144:147], a[112:115], v[76:79]
    v_exp_f32 v101, v101
    v_mfma_f32_16x16x32_bf16 v[124:127], a[148:151], a[116:119], v[124:127]
    ds_read_b128 a[136:139], v18 offset:2048
    v_cvt_pk_bf16_f32 v50, v100, v101
    v_mfma_f32_16x16x32_bf16 v[124:127], a[152:155], a[120:123], v[124:127]
    v_exp_f32 v102, v102
    v_mfma_f32_16x16x32_bf16 v[124:127], a[156:159], a[124:127], v[124:127]
    buffer_load_dwordx4 v1, s[8:11], s19 offen offset:2048  lds
    v_mfma_f32_16x16x32_bf16 v[40:43], v[28:31], v[56:59], 0
    v_exp_f32 v103, v103
    v_mfma_f32_16x16x32_bf16 v[44:47], v[28:31], v[60:63], 0
    ds_read_b128 a[140:143], v18 offset:3072
    v_cvt_pk_bf16_f32 v51, v102, v103
    v_mfma_f32_16x16x32_bf16 v[192:195], a[160:163], v[56:59], 0
    v_exp_f32 v104, v104
    v_mfma_f32_16x16x32_bf16 v[224:227], a[160:163], v[60:63], 0
    v_mfma_f32_16x16x32_bf16 v[196:199], a[164:167], v[56:59], 0
    v_exp_f32 v105, v105
    v_mfma_f32_16x16x32_bf16 v[228:231], a[164:167], v[60:63], 0
    ds_read_b128 a[144:147], v18 offset:4096
    v_cvt_pk_bf16_f32 v52, v104, v105
    v_mfma_f32_16x16x32_bf16 v[200:203], a[168:171], v[56:59], 0
    v_exp_f32 v106, v106
    v_mfma_f32_16x16x32_bf16 v[232:235], a[168:171], v[60:63], 0
    buffer_load_dwordx4 v1, s[8:11], s19 offen offset:3072  lds
    v_mfma_f32_16x16x32_bf16 v[204:207], a[172:175], v[56:59], 0
    s_add_u32 m0, s16, 4096
    v_exp_f32 v107, v107
    v_mfma_f32_16x16x32_bf16 v[236:239], a[172:175], v[60:63], 0
    ds_read_b128 a[148:151], v18 offset:5120
    v_cvt_pk_bf16_f32 v53, v106, v107
    v_mfma_f32_16x16x32_bf16 v[208:211], a[176:179], v[56:59], 0
    v_exp_f32 v108, v108
    v_mfma_f32_16x16x32_bf16 v[240:243], a[176:179], v[60:63], 0
    buffer_load_dwordx4 v15, s[8:11], s19 offen offset:0  lds
    v_mfma_f32_16x16x32_bf16 v[212:215], a[180:183], v[56:59], 0
    v_exp_f32 v109, v109
    v_mfma_f32_16x16x32_bf16 v[244:247], a[180:183], v[60:63], 0
    ds_read_b128 a[152:155], v18 offset:6144
    v_cvt_pk_bf16_f32 v54, v108, v109
    v_mfma_f32_16x16x32_bf16 v[216:219], a[184:187], v[56:59], 0
    v_exp_f32 v110, v110
    v_mfma_f32_16x16x32_bf16 v[248:251], a[184:187], v[60:63], 0
    buffer_load_dwordx4 v15, s[8:11], s19 offen offset:1024  lds
    v_mfma_f32_16x16x32_bf16 v[220:223], a[188:191], v[56:59], 0
    v_exp_f32 v111, v111
    v_mfma_f32_16x16x32_bf16 v[252:255], a[188:191], v[60:63], 0
    ds_read_b128 a[156:159], v18 offset:7168
    v_cvt_pk_bf16_f32 v55, v110, v111
    s_cmp_eq_u32 s14, 0
    s_cbranch_scc1 L_t1_diag
.p2align 3
L_t1_loop:
    s_waitcnt lgkmcnt(7)
    v_mfma_f32_16x16x32_bf16 v[96:99], a[128:131], a[64:67], v[64:67]
    s_waitcnt lgkmcnt(6)
    ds_read_b128 a[160:163], v19 offset:16384
    v_mfma_f32_16x16x32_bf16 v[96:99], a[132:135], a[68:71], v[96:99]
    s_waitcnt lgkmcnt(6)
    ds_read_b128 a[164:167], v19 offset:17408
    v_mfma_f32_16x16x32_bf16 v[96:99], a[136:139], a[72:75], v[96:99]
    s_waitcnt lgkmcnt(6)
    v_exp_f32 v112, v112
    v_mfma_f32_16x16x32_bf16 v[96:99], a[140:143], a[76:79], v[96:99]
    buffer_load_dwordx4 v15, s[8:11], s19 offen offset:2048  lds
    v_mfma_f32_16x16x32_bf16 v[104:107], a[128:131], a[80:83], v[68:71]
    v_exp_f32 v113, v113
    v_mfma_f32_16x16x32_bf16 v[104:107], a[132:135], a[84:87], v[104:107]
    ds_read_b128 a[168:171], v19 offset:18432
    v_cvt_pk_bf16_f32 v56, v112, v113
    v_mfma_f32_16x16x32_bf16 v[104:107], a[136:139], a[88:91], v[104:107]
    s_waitcnt lgkmcnt(6)
    v_exp_f32 v114, v114
    v_mfma_f32_16x16x32_bf16 v[104:107], a[140:143], a[92:95], v[104:107]
    buffer_load_dwordx4 v15, s[8:11], s19 offen offset:3072  lds
    v_mfma_f32_16x16x32_bf16 v[100:103], a[144:147], a[64:67], v[64:67]
    s_waitcnt lgkmcnt(5)
    s_xor_b32 s16, s16, 98304
    v_exp_f32 v115, v115
    v_mfma_f32_16x16x32_bf16 v[100:103], a[148:151], a[68:71], v[100:103]
    s_waitcnt lgkmcnt(4)
    ds_read_b128 a[172:175], v19 offset:19456
    v_cvt_pk_bf16_f32 v57, v114, v115
    v_mfma_f32_16x16x32_bf16 v[100:103], a[152:155], a[72:75], v[100:103]
    s_waitcnt lgkmcnt(4)
    v_exp_f32 v116, v116
    v_mfma_f32_16x16x32_bf16 v[100:103], a[156:159], a[76:79], v[100:103]
    v_mfma_f32_16x16x32_bf16 v[108:111], a[144:147], a[80:83], v[68:71]
    v_exp_f32 v117, v117
    v_mfma_f32_16x16x32_bf16 v[108:111], a[148:151], a[84:87], v[108:111]
    ds_read_b128 a[176:179], v20 offset:20480
    v_cvt_pk_bf16_f32 v58, v116, v117
    v_mfma_f32_16x16x32_bf16 v[108:111], a[152:155], a[88:91], v[108:111]
    v_exp_f32 v118, v118
    v_mfma_f32_16x16x32_bf16 v[108:111], a[156:159], a[92:95], v[108:111]
    v_mfma_f32_16x16x32_bf16 v[32:35], v[28:31], v[48:51], v[32:35]
    v_exp_f32 v119, v119
    v_mfma_f32_16x16x32_bf16 v[36:39], v[28:31], v[52:55], v[36:39]
    s_waitcnt lgkmcnt(4)
    ds_read_b128 a[180:183], v20 offset:21504
    v_cvt_pk_bf16_f32 v59, v118, v119
    v_mfma_f32_16x16x32_bf16 v[128:131], a[160:163], v[48:51], v[128:131]
    v_exp_f32 v120, v120
    v_mfma_f32_16x16x32_bf16 v[160:163], a[160:163], v[52:55], v[160:163]
    s_waitcnt lgkmcnt(4)
    v_mfma_f32_16x16x32_bf16 v[132:135], a[164:167], v[48:51], v[132:135]
    v_exp_f32 v121, v121
    v_mfma_f32_16x16x32_bf16 v[164:167], a[164:167], v[52:55], v[164:167]
    s_waitcnt lgkmcnt(3)
    ds_read_b128 a[184:187], v20 offset:22528
    v_cvt_pk_bf16_f32 v60, v120, v121
    v_mfma_f32_16x16x32_bf16 v[136:139], a[168:171], v[48:51], v[136:139]
    v_exp_f32 v122, v122
    v_mfma_f32_16x16x32_bf16 v[168:171], a[168:171], v[52:55], v[168:171]
    s_waitcnt lgkmcnt(3)
    v_mfma_f32_16x16x32_bf16 v[140:143], a[172:175], v[48:51], v[140:143]
    v_exp_f32 v123, v123
    v_mfma_f32_16x16x32_bf16 v[172:175], a[172:175], v[52:55], v[172:175]
    s_waitcnt lgkmcnt(2)
    ds_read_b128 a[188:191], v20 offset:23552
    v_cvt_pk_bf16_f32 v61, v122, v123
    v_mfma_f32_16x16x32_bf16 v[144:147], a[176:179], v[48:51], v[144:147]
    v_exp_f32 v124, v124
    v_mfma_f32_16x16x32_bf16 v[176:179], a[176:179], v[52:55], v[176:179]
    s_waitcnt lgkmcnt(2)
    v_mfma_f32_16x16x32_bf16 v[148:151], a[180:183], v[48:51], v[148:151]
    v_exp_f32 v125, v125
    v_mfma_f32_16x16x32_bf16 v[180:183], a[180:183], v[52:55], v[180:183]
    s_waitcnt lgkmcnt(1)
    v_cvt_pk_bf16_f32 v62, v124, v125
    v_xor_b32 v19, 98304, v19
    v_mfma_f32_16x16x32_bf16 v[152:155], a[184:187], v[48:51], v[152:155]
    v_exp_f32 v126, v126
    v_mfma_f32_16x16x32_bf16 v[184:187], a[184:187], v[52:55], v[184:187]
    s_waitcnt lgkmcnt(0)
    v_xor_b32 v20, 98304, v20
    v_mfma_f32_16x16x32_bf16 v[156:159], a[188:191], v[48:51], v[156:159]
    v_exp_f32 v127, v127
    v_mfma_f32_16x16x32_bf16 v[188:191], a[188:191], v[52:55], v[188:191]
    v_cvt_pk_bf16_f32 v63, v126, v127
    v_mfma_f32_16x16x32_bf16 v[112:115], a[128:131], a[96:99], v[72:75]
    v_exp_f32 v96, v96
    v_mfma_f32_16x16x32_bf16 v[112:115], a[132:135], a[100:103], v[112:115]
    v_mfma_f32_16x16x32_bf16 v[112:115], a[136:139], a[104:107], v[112:115]
    v_exp_f32 v97, v97
    v_mfma_f32_16x16x32_bf16 v[112:115], a[140:143], a[108:111], v[112:115]
    v_cvt_pk_bf16_f32 v48, v96, v97
    v_mfma_f32_16x16x32_bf16 v[120:123], a[128:131], a[112:115], v[76:79]
    v_exp_f32 v98, v98
    v_mfma_f32_16x16x32_bf16 v[120:123], a[132:135], a[116:119], v[120:123]
    v_mfma_f32_16x16x32_bf16 v[120:123], a[136:139], a[120:123], v[120:123]
    v_exp_f32 v99, v99
    v_mfma_f32_16x16x32_bf16 v[120:123], a[140:143], a[124:127], v[120:123]
    v_mfma_f32_16x16x32_bf16 v[116:119], a[144:147], a[96:99], v[72:75]
    v_exp_f32 v100, v100
    v_mfma_f32_16x16x32_bf16 v[116:119], a[148:151], a[100:103], v[116:119]
    ds_read_b128 a[128:131], v18 offset:16384
    v_cvt_pk_bf16_f32 v49, v98, v99
    v_mfma_f32_16x16x32_bf16 v[116:119], a[152:155], a[104:107], v[116:119]
    s_add_u32 s19, s82, 32768
    v_exp_f32 v101, v101
    v_mfma_f32_16x16x32_bf16 v[116:119], a[156:159], a[108:111], v[116:119]
    s_sub_u32 s82, s12, s13
    ds_read_b128 a[132:135], v18 offset:17408
    v_cvt_pk_bf16_f32 v50, v100, v101
    v_mfma_f32_16x16x32_bf16 v[124:127], a[144:147], a[112:115], v[76:79]
    s_sub_u32 s82, s82, 1
    v_exp_f32 v102, v102
    v_mfma_f32_16x16x32_bf16 v[124:127], a[148:151], a[116:119], v[124:127]
    s_cmp_gt_u32 s12, s13
    s_cselect_b32 s82, s82, s12
    s_mul_i32 s82, s82, 65536
    ds_read_b128 a[136:139], v18 offset:18432
    v_mfma_f32_16x16x32_bf16 v[124:127], a[152:155], a[120:123], v[124:127]
    s_add_u32 s82, s82, s81
    v_exp_f32 v103, v103
    v_mfma_f32_16x16x32_bf16 v[124:127], a[156:159], a[124:127], v[124:127]
    s_cmp_ge_u32 s12, 17
    s_cselect_b32 s82, 2147471360, s82
    ds_read_b128 a[140:143], v18 offset:19456
    v_cvt_pk_bf16_f32 v51, v102, v103
    v_mfma_f32_16x16x32_bf16 v[40:43], v[28:31], v[56:59], v[40:43]
    s_add_u32 s12, s12, 1
    v_exp_f32 v104, v104
    v_mfma_f32_16x16x32_bf16 v[44:47], v[28:31], v[60:63], v[44:47]
    ds_read_b128 a[144:147], v18 offset:20480
    v_mfma_f32_16x16x32_bf16 v[192:195], a[160:163], v[56:59], v[192:195]
    v_exp_f32 v105, v105
    v_mfma_f32_16x16x32_bf16 v[224:227], a[160:163], v[60:63], v[224:227]
    ds_read_b128 a[148:151], v18 offset:21504
    v_cvt_pk_bf16_f32 v52, v104, v105
    v_mfma_f32_16x16x32_bf16 v[196:199], a[164:167], v[56:59], v[196:199]
    v_exp_f32 v106, v106
    v_mfma_f32_16x16x32_bf16 v[228:231], a[164:167], v[60:63], v[228:231]
    ds_read_b128 a[152:155], v18 offset:22528
    v_mfma_f32_16x16x32_bf16 v[200:203], a[168:171], v[56:59], v[200:203]
    v_exp_f32 v107, v107
    v_mfma_f32_16x16x32_bf16 v[232:235], a[168:171], v[60:63], v[232:235]
    ds_read_b128 a[156:159], v18 offset:23552
    v_cvt_pk_bf16_f32 v53, v106, v107
    v_mfma_f32_16x16x32_bf16 v[204:207], a[172:175], v[56:59], v[204:207]
    v_exp_f32 v108, v108
    v_mfma_f32_16x16x32_bf16 v[236:239], a[172:175], v[60:63], v[236:239]
    v_mfma_f32_16x16x32_bf16 v[208:211], a[176:179], v[56:59], v[208:211]
    v_exp_f32 v109, v109
    v_mfma_f32_16x16x32_bf16 v[240:243], a[176:179], v[60:63], v[240:243]
    v_cvt_pk_bf16_f32 v54, v108, v109
    v_xor_b32 v18, 196608, v18
    v_mfma_f32_16x16x32_bf16 v[212:215], a[180:183], v[56:59], v[212:215]
    v_exp_f32 v110, v110
    v_mfma_f32_16x16x32_bf16 v[244:247], a[180:183], v[60:63], v[244:247]
    v_mfma_f32_16x16x32_bf16 v[216:219], a[184:187], v[56:59], v[216:219]
    v_exp_f32 v111, v111
    v_mfma_f32_16x16x32_bf16 v[248:251], a[184:187], v[60:63], v[248:251]
    v_cvt_pk_bf16_f32 v55, v110, v111
    v_mfma_f32_16x16x32_bf16 v[220:223], a[188:191], v[56:59], v[220:223]
    v_mfma_f32_16x16x32_bf16 v[252:255], a[188:191], v[60:63], v[252:255]
    s_waitcnt vmcnt(0) lgkmcnt(0)
    s_barrier
    v_mfma_f32_16x16x32_bf16 v[96:99], a[128:131], a[64:67], v[64:67]
    s_add_u32 m0, s15, 0
    ds_read_b128 a[160:163], v19 offset:0
    v_mfma_f32_16x16x32_bf16 v[96:99], a[132:135], a[68:71], v[96:99]
    ds_read_b128 a[164:167], v19 offset:1024
    v_mfma_f32_16x16x32_bf16 v[96:99], a[136:139], a[72:75], v[96:99]
    v_exp_f32 v112, v112
    v_mfma_f32_16x16x32_bf16 v[96:99], a[140:143], a[76:79], v[96:99]
    buffer_load_dwordx4 v1, s[8:11], s82 offen offset:0  lds
    v_mfma_f32_16x16x32_bf16 v[104:107], a[128:131], a[80:83], v[68:71]
    v_exp_f32 v113, v113
    v_mfma_f32_16x16x32_bf16 v[104:107], a[132:135], a[84:87], v[104:107]
    ds_read_b128 a[168:171], v19 offset:2048
    v_cvt_pk_bf16_f32 v56, v112, v113
    v_mfma_f32_16x16x32_bf16 v[104:107], a[136:139], a[88:91], v[104:107]
    v_exp_f32 v114, v114
    v_mfma_f32_16x16x32_bf16 v[104:107], a[140:143], a[92:95], v[104:107]
    buffer_load_dwordx4 v1, s[8:11], s82 offen offset:1024  lds
    v_mfma_f32_16x16x32_bf16 v[100:103], a[144:147], a[64:67], v[64:67]
    v_exp_f32 v115, v115
    v_mfma_f32_16x16x32_bf16 v[100:103], a[148:151], a[68:71], v[100:103]
    ds_read_b128 a[172:175], v19 offset:3072
    v_cvt_pk_bf16_f32 v57, v114, v115
    v_mfma_f32_16x16x32_bf16 v[100:103], a[152:155], a[72:75], v[100:103]
    v_exp_f32 v116, v116
    v_mfma_f32_16x16x32_bf16 v[100:103], a[156:159], a[76:79], v[100:103]
    buffer_load_dwordx4 v1, s[8:11], s82 offen offset:2048  lds
    v_mfma_f32_16x16x32_bf16 v[108:111], a[144:147], a[80:83], v[68:71]
    v_exp_f32 v117, v117
    v_mfma_f32_16x16x32_bf16 v[108:111], a[148:151], a[84:87], v[108:111]
    ds_read_b128 a[176:179], v20 offset:4096
    v_cvt_pk_bf16_f32 v58, v116, v117
    v_mfma_f32_16x16x32_bf16 v[108:111], a[152:155], a[88:91], v[108:111]
    v_exp_f32 v118, v118
    v_mfma_f32_16x16x32_bf16 v[108:111], a[156:159], a[92:95], v[108:111]
    buffer_load_dwordx4 v1, s[8:11], s82 offen offset:3072  lds
    v_mfma_f32_16x16x32_bf16 v[32:35], v[28:31], v[48:51], v[32:35]
    s_add_u32 m0, s15, 4096
    v_exp_f32 v119, v119
    v_mfma_f32_16x16x32_bf16 v[36:39], v[28:31], v[52:55], v[36:39]
    s_waitcnt lgkmcnt(4)
    ds_read_b128 a[180:183], v20 offset:5120
    v_cvt_pk_bf16_f32 v59, v118, v119
    v_mfma_f32_16x16x32_bf16 v[128:131], a[160:163], v[48:51], v[128:131]
    v_exp_f32 v120, v120
    v_mfma_f32_16x16x32_bf16 v[160:163], a[160:163], v[52:55], v[160:163]
    s_waitcnt lgkmcnt(4)
    v_mfma_f32_16x16x32_bf16 v[132:135], a[164:167], v[48:51], v[132:135]
    v_exp_f32 v121, v121
    v_mfma_f32_16x16x32_bf16 v[164:167], a[164:167], v[52:55], v[164:167]
    s_waitcnt lgkmcnt(3)
    ds_read_b128 a[184:187], v20 offset:6144
    v_cvt_pk_bf16_f32 v60, v120, v121
    v_mfma_f32_16x16x32_bf16 v[136:139], a[168:171], v[48:51], v[136:139]
    s_waitcnt lgkmcnt(3)
    v_exp_f32 v122, v122
    v_mfma_f32_16x16x32_bf16 v[168:171], a[168:171], v[52:55], v[168:171]
    buffer_load_dwordx4 v15, s[8:11], s82 offen offset:0  lds
    v_mfma_f32_16x16x32_bf16 v[140:143], a[172:175], v[48:51], v[140:143]
    v_exp_f32 v123, v123
    v_mfma_f32_16x16x32_bf16 v[172:175], a[172:175], v[52:55], v[172:175]
    s_waitcnt lgkmcnt(2)
    ds_read_b128 a[188:191], v20 offset:7168
    v_cvt_pk_bf16_f32 v61, v122, v123
    v_mfma_f32_16x16x32_bf16 v[144:147], a[176:179], v[48:51], v[144:147]
    s_waitcnt lgkmcnt(2)
    v_exp_f32 v124, v124
    v_mfma_f32_16x16x32_bf16 v[176:179], a[176:179], v[52:55], v[176:179]
    buffer_load_dwordx4 v15, s[8:11], s82 offen offset:1024  lds
    v_mfma_f32_16x16x32_bf16 v[148:151], a[180:183], v[48:51], v[148:151]
    v_exp_f32 v125, v125
    v_mfma_f32_16x16x32_bf16 v[180:183], a[180:183], v[52:55], v[180:183]
    s_waitcnt lgkmcnt(1)
    v_cvt_pk_bf16_f32 v62, v124, v125
    v_mfma_f32_16x16x32_bf16 v[152:155], a[184:187], v[48:51], v[152:155]
    s_waitcnt lgkmcnt(0)
    v_exp_f32 v126, v126
    v_mfma_f32_16x16x32_bf16 v[184:187], a[184:187], v[52:55], v[184:187]
    buffer_load_dwordx4 v15, s[8:11], s82 offen offset:2048  lds
    v_mfma_f32_16x16x32_bf16 v[156:159], a[188:191], v[48:51], v[156:159]
    v_exp_f32 v127, v127
    v_mfma_f32_16x16x32_bf16 v[188:191], a[188:191], v[52:55], v[188:191]
    v_cvt_pk_bf16_f32 v63, v126, v127
    v_mfma_f32_16x16x32_bf16 v[112:115], a[128:131], a[96:99], v[72:75]
    v_mfma_f32_16x16x32_bf16 v[112:115], a[132:135], a[100:103], v[112:115]
    v_mfma_f32_16x16x32_bf16 v[112:115], a[136:139], a[104:107], v[112:115]
    v_exp_f32 v96, v96
    v_mfma_f32_16x16x32_bf16 v[112:115], a[140:143], a[108:111], v[112:115]
    buffer_load_dwordx4 v15, s[8:11], s82 offen offset:3072  lds
    v_mfma_f32_16x16x32_bf16 v[120:123], a[128:131], a[112:115], v[76:79]
    s_xor_b32 s15, s15, 196608
    v_exp_f32 v97, v97
    v_mfma_f32_16x16x32_bf16 v[120:123], a[132:135], a[116:119], v[120:123]
    s_add_u32 m0, s16, 0
    ds_read_b128 a[128:131], v18 offset:0
    v_cvt_pk_bf16_f32 v48, v96, v97
    v_mfma_f32_16x16x32_bf16 v[120:123], a[136:139], a[120:123], v[120:123]
    v_exp_f32 v98, v98
    v_mfma_f32_16x16x32_bf16 v[120:123], a[140:143], a[124:127], v[120:123]
    buffer_load_dwordx4 v1, s[8:11], s19 offen offset:0  lds
    v_mfma_f32_16x16x32_bf16 v[116:119], a[144:147], a[96:99], v[72:75]
    v_exp_f32 v99, v99
    v_mfma_f32_16x16x32_bf16 v[116:119], a[148:151], a[100:103], v[116:119]
    ds_read_b128 a[132:135], v18 offset:1024
    v_cvt_pk_bf16_f32 v49, v98, v99
    v_mfma_f32_16x16x32_bf16 v[116:119], a[152:155], a[104:107], v[116:119]
    v_exp_f32 v100, v100
    v_mfma_f32_16x16x32_bf16 v[116:119], a[156:159], a[108:111], v[116:119]
    buffer_load_dwordx4 v1, s[8:11], s19 offen offset:1024  lds
    v_mfma_f32_16x16x32_bf16 v[124:127], a[144:147], a[112:115], v[76:79]
    v_exp_f32 v101, v101
    v_mfma_f32_16x16x32_bf16 v[124:127], a[148:151], a[116:119], v[124:127]
    ds_read_b128 a[136:139], v18 offset:2048
    v_cvt_pk_bf16_f32 v50, v100, v101
    v_mfma_f32_16x16x32_bf16 v[124:127], a[152:155], a[120:123], v[124:127]
    v_exp_f32 v102, v102
    v_mfma_f32_16x16x32_bf16 v[124:127], a[156:159], a[124:127], v[124:127]
    buffer_load_dwordx4 v1, s[8:11], s19 offen offset:2048  lds
    v_mfma_f32_16x16x32_bf16 v[40:43], v[28:31], v[56:59], v[40:43]
    v_exp_f32 v103, v103
    v_mfma_f32_16x16x32_bf16 v[44:47], v[28:31], v[60:63], v[44:47]
    ds_read_b128 a[140:143], v18 offset:3072
    v_cvt_pk_bf16_f32 v51, v102, v103
    v_mfma_f32_16x16x32_bf16 v[192:195], a[160:163], v[56:59], v[192:195]
    v_exp_f32 v104, v104
    v_mfma_f32_16x16x32_bf16 v[224:227], a[160:163], v[60:63], v[224:227]
    v_mfma_f32_16x16x32_bf16 v[196:199], a[164:167], v[56:59], v[196:199]
    v_exp_f32 v105, v105
    v_mfma_f32_16x16x32_bf16 v[228:231], a[164:167], v[60:63], v[228:231]
    ds_read_b128 a[144:147], v18 offset:4096
    v_cvt_pk_bf16_f32 v52, v104, v105
    v_mfma_f32_16x16x32_bf16 v[200:203], a[168:171], v[56:59], v[200:203]
    v_exp_f32 v106, v106
    v_mfma_f32_16x16x32_bf16 v[232:235], a[168:171], v[60:63], v[232:235]
    buffer_load_dwordx4 v1, s[8:11], s19 offen offset:3072  lds
    v_mfma_f32_16x16x32_bf16 v[204:207], a[172:175], v[56:59], v[204:207]
    s_add_u32 m0, s16, 4096
    v_exp_f32 v107, v107
    v_mfma_f32_16x16x32_bf16 v[236:239], a[172:175], v[60:63], v[236:239]
    ds_read_b128 a[148:151], v18 offset:5120
    v_cvt_pk_bf16_f32 v53, v106, v107
    v_mfma_f32_16x16x32_bf16 v[208:211], a[176:179], v[56:59], v[208:211]
    s_sub_u32 s14, s14, 1
    v_exp_f32 v108, v108
    v_mfma_f32_16x16x32_bf16 v[240:243], a[176:179], v[60:63], v[240:243]
    buffer_load_dwordx4 v15, s[8:11], s19 offen offset:0  lds
    v_mfma_f32_16x16x32_bf16 v[212:215], a[180:183], v[56:59], v[212:215]
    v_exp_f32 v109, v109
    v_mfma_f32_16x16x32_bf16 v[244:247], a[180:183], v[60:63], v[244:247]
    ds_read_b128 a[152:155], v18 offset:6144
    v_cvt_pk_bf16_f32 v54, v108, v109
    v_mfma_f32_16x16x32_bf16 v[216:219], a[184:187], v[56:59], v[216:219]
    v_exp_f32 v110, v110
    v_mfma_f32_16x16x32_bf16 v[248:251], a[184:187], v[60:63], v[248:251]
    buffer_load_dwordx4 v15, s[8:11], s19 offen offset:1024  lds
    v_mfma_f32_16x16x32_bf16 v[220:223], a[188:191], v[56:59], v[220:223]
    v_exp_f32 v111, v111
    v_mfma_f32_16x16x32_bf16 v[252:255], a[188:191], v[60:63], v[252:255]
    ds_read_b128 a[156:159], v18 offset:7168
    v_cvt_pk_bf16_f32 v55, v110, v111
    s_cmp_lg_u32 s14, 0
    s_cbranch_scc1 L_t1_loop
L_t1_diag:
    s_waitcnt lgkmcnt(7)
    v_mfma_f32_16x16x32_bf16 v[96:99], a[128:131], a[64:67], v[80:83]
    s_waitcnt lgkmcnt(6)
    ds_read_b128 a[160:163], v19 offset:16384
    v_mfma_f32_16x16x32_bf16 v[96:99], a[132:135], a[68:71], v[96:99]
    s_waitcnt lgkmcnt(6)
    ds_read_b128 a[164:167], v19 offset:17408
    v_mfma_f32_16x16x32_bf16 v[96:99], a[136:139], a[72:75], v[96:99]
    s_waitcnt lgkmcnt(6)
    v_exp_f32 v112, v112
    v_mfma_f32_16x16x32_bf16 v[96:99], a[140:143], a[76:79], v[96:99]
    buffer_load_dwordx4 v15, s[8:11], s19 offen offset:2048  lds
    v_mfma_f32_16x16x32_bf16 v[104:107], a[128:131], a[80:83], v[88:91]
    v_exp_f32 v113, v113
    v_mfma_f32_16x16x32_bf16 v[104:107], a[132:135], a[84:87], v[104:107]
    ds_read_b128 a[168:171], v19 offset:18432
    v_cvt_pk_bf16_f32 v56, v112, v113
    v_mfma_f32_16x16x32_bf16 v[104:107], a[136:139], a[88:91], v[104:107]
    s_waitcnt lgkmcnt(6)
    v_exp_f32 v114, v114
    v_mfma_f32_16x16x32_bf16 v[104:107], a[140:143], a[92:95], v[104:107]
    buffer_load_dwordx4 v15, s[8:11], s19 offen offset:3072  lds
    v_mfma_f32_16x16x32_bf16 v[100:103], a[144:147], a[64:67], v[84:87]
    s_waitcnt lgkmcnt(5)
    s_xor_b32 s16, s16, 98304
    v_exp_f32 v115, v115
    v_mfma_f32_16x16x32_bf16 v[100:103], a[148:151], a[68:71], v[100:103]
    s_waitcnt lgkmcnt(4)
    ds_read_b128 a[172:175], v19 offset:19456
    v_cvt_pk_bf16_f32 v57, v114, v115
    v_mfma_f32_16x16x32_bf16 v[100:103], a[152:155], a[72:75], v[100:103]
    s_waitcnt lgkmcnt(4)
    v_exp_f32 v116, v116
    v_mfma_f32_16x16x32_bf16 v[100:103], a[156:159], a[76:79], v[100:103]
    v_mfma_f32_16x16x32_bf16 v[108:111], a[144:147], a[80:83], v[92:95]
    v_exp_f32 v117, v117
    v_mfma_f32_16x16x32_bf16 v[108:111], a[148:151], a[84:87], v[108:111]
    ds_read_b128 a[176:179], v20 offset:20480
    v_cvt_pk_bf16_f32 v58, v116, v117
    v_mfma_f32_16x16x32_bf16 v[108:111], a[152:155], a[88:91], v[108:111]
    v_exp_f32 v118, v118
    v_mfma_f32_16x16x32_bf16 v[108:111], a[156:159], a[92:95], v[108:111]
    v_mfma_f32_16x16x32_bf16 v[32:35], v[28:31], v[48:51], v[32:35]
    v_exp_f32 v119, v119
    v_mfma_f32_16x16x32_bf16 v[36:39], v[28:31], v[52:55], v[36:39]
    s_waitcnt lgkmcnt(4)
    ds_read_b128 a[180:183], v20 offset:21504
    v_cvt_pk_bf16_f32 v59, v118, v119
    v_mfma_f32_16x16x32_bf16 v[128:131], a[160:163], v[48:51], v[128:131]
    v_exp_f32 v120, v120
    v_mfma_f32_16x16x32_bf16 v[160:163], a[160:163], v[52:55], v[160:163]
    s_waitcnt lgkmcnt(4)
    v_add_f32 v80, 0, v22
    v_min_f32 v80, v80, v72
    v_mfma_f32_16x16x32_bf16 v[132:135], a[164:167], v[48:51], v[132:135]
    v_exp_f32 v121, v121
    v_mfma_f32_16x16x32_bf16 v[164:167], a[164:167], v[52:55], v[164:167]
    s_waitcnt lgkmcnt(3)
    ds_read_b128 a[184:187], v20 offset:22528
    v_cvt_pk_bf16_f32 v60, v120, v121
    v_mfma_f32_16x16x32_bf16 v[136:139], a[168:171], v[48:51], v[136:139]
    v_exp_f32 v122, v122
    v_mfma_f32_16x16x32_bf16 v[168:171], a[168:171], v[52:55], v[168:171]
    s_waitcnt lgkmcnt(3)
    v_add_f32 v81, 0xf1800000, v22
    v_min_f32 v81, v81, v73
    v_mfma_f32_16x16x32_bf16 v[140:143], a[172:175], v[48:51], v[140:143]
    v_exp_f32 v123, v123
    v_mfma_f32_16x16x32_bf16 v[172:175], a[172:175], v[52:55], v[172:175]
    s_waitcnt lgkmcnt(2)
    ds_read_b128 a[188:191], v20 offset:23552
    v_cvt_pk_bf16_f32 v61, v122, v123
    v_mfma_f32_16x16x32_bf16 v[144:147], a[176:179], v[48:51], v[144:147]
    v_exp_f32 v124, v124
    v_mfma_f32_16x16x32_bf16 v[176:179], a[176:179], v[52:55], v[176:179]
    s_waitcnt lgkmcnt(2)
    v_add_f32 v82, 0xf2000000, v22
    v_min_f32 v82, v82, v74
    v_mfma_f32_16x16x32_bf16 v[148:151], a[180:183], v[48:51], v[148:151]
    v_exp_f32 v125, v125
    v_mfma_f32_16x16x32_bf16 v[180:183], a[180:183], v[52:55], v[180:183]
    s_waitcnt lgkmcnt(1)
    v_cvt_pk_bf16_f32 v62, v124, v125
    v_xor_b32 v19, 98304, v19
    v_mfma_f32_16x16x32_bf16 v[152:155], a[184:187], v[48:51], v[152:155]
    v_exp_f32 v126, v126
    v_mfma_f32_16x16x32_bf16 v[184:187], a[184:187], v[52:55], v[184:187]
    s_waitcnt lgkmcnt(0)
    v_xor_b32 v20, 98304, v20
    v_add_f32 v83, 0xf2400000, v22
    v_mfma_f32_16x16x32_bf16 v[156:159], a[188:191], v[48:51], v[156:159]
    v_exp_f32 v127, v127
    v_mfma_f32_16x16x32_bf16 v[188:191], a[188:191], v[52:55], v[188:191]
    v_cvt_pk_bf16_f32 v63, v126, v127
    v_min_f32 v83, v83, v75
    v_add_f32 v84, 0xf3800000, v22
    v_min_f32 v84, v84, v72
    v_mfma_f32_16x16x32_bf16 v[112:115], a[128:131], a[96:99], v[72:75]
    v_exp_f32 v96, v96
    v_mfma_f32_16x16x32_bf16 v[112:115], a[132:135], a[100:103], v[112:115]
    v_mfma_f32_16x16x32_bf16 v[112:115], a[136:139], a[104:107], v[112:115]
    v_exp_f32 v97, v97
    v_mfma_f32_16x16x32_bf16 v[112:115], a[140:143], a[108:111], v[112:115]
    v_cvt_pk_bf16_f32 v48, v96, v97
    v_add_f32 v85, 0xf3880000, v22
    v_mfma_f32_16x16x32_bf16 v[120:123], a[128:131], a[112:115], v[76:79]
    v_exp_f32 v98, v98
    v_mfma_f32_16x16x32_bf16 v[120:123], a[132:135], a[116:119], v[120:123]
    v_min_f32 v85, v85, v73
    v_add_f32 v86, 0xf3900000, v22
    v_mfma_f32_16x16x32_bf16 v[120:123], a[136:139], a[120:123], v[120:123]
    v_exp_f32 v99, v99
    v_mfma_f32_16x16x32_bf16 v[120:123], a[140:143], a[124:127], v[120:123]
    v_min_f32 v86, v86, v74
    v_add_f32 v87, 0xf3980000, v22
    v_mfma_f32_16x16x32_bf16 v[116:119], a[144:147], a[96:99], v[72:75]
    v_exp_f32 v100, v100
    v_mfma_f32_16x16x32_bf16 v[116:119], a[148:151], a[100:103], v[116:119]
    ds_read_b128 a[128:131], v18 offset:16384
    v_cvt_pk_bf16_f32 v49, v98, v99
    v_mfma_f32_16x16x32_bf16 v[116:119], a[152:155], a[104:107], v[116:119]
    s_add_u32 s19, s82, 32768
    v_exp_f32 v101, v101
    v_mfma_f32_16x16x32_bf16 v[116:119], a[156:159], a[108:111], v[116:119]
    s_sub_u32 s82, s12, s13
    ds_read_b128 a[132:135], v18 offset:17408
    v_cvt_pk_bf16_f32 v50, v100, v101
    v_mfma_f32_16x16x32_bf16 v[124:127], a[144:147], a[112:115], v[76:79]
    s_sub_u32 s82, s82, 1
    v_exp_f32 v102, v102
    v_mfma_f32_16x16x32_bf16 v[124:127], a[148:151], a[116:119], v[124:127]
    s_cmp_gt_u32 s12, s13
    s_cselect_b32 s82, s82, s12
    s_mul_i32 s82, s82, 65536
    ds_read_b128 a[136:139], v18 offset:18432
    v_mfma_f32_16x16x32_bf16 v[124:127], a[152:155], a[120:123], v[124:127]
    s_add_u32 s82, s82, s81
    v_exp_f32 v103, v103
    v_mfma_f32_16x16x32_bf16 v[124:127], a[156:159], a[124:127], v[124:127]
    s_cmp_ge_u32 s12, 17
    s_cselect_b32 s82, 2147471360, s82
    ds_read_b128 a[140:143], v18 offset:19456
    v_cvt_pk_bf16_f32 v51, v102, v103
    v_mfma_f32_16x16x32_bf16 v[40:43], v[28:31], v[56:59], v[40:43]
    s_add_u32 s12, s12, 1
    v_exp_f32 v104, v104
    v_mfma_f32_16x16x32_bf16 v[44:47], v[28:31], v[60:63], v[44:47]
    ds_read_b128 a[144:147], v18 offset:20480
    v_min_f32 v87, v87, v75
    v_mfma_f32_16x16x32_bf16 v[192:195], a[160:163], v[56:59], v[192:195]
    v_exp_f32 v105, v105
    v_mfma_f32_16x16x32_bf16 v[224:227], a[160:163], v[60:63], v[224:227]
    ds_read_b128 a[148:151], v18 offset:21504
    v_cvt_pk_bf16_f32 v52, v104, v105
    v_mfma_f32_16x16x32_bf16 v[196:199], a[164:167], v[56:59], v[196:199]
    v_exp_f32 v106, v106
    v_mfma_f32_16x16x32_bf16 v[228:231], a[164:167], v[60:63], v[228:231]
    ds_read_b128 a[152:155], v18 offset:22528
    v_add_f32 v88, 0x73800000, v22
    v_mfma_f32_16x16x32_bf16 v[200:203], a[168:171], v[56:59], v[200:203]
    v_exp_f32 v107, v107
    v_mfma_f32_16x16x32_bf16 v[232:235], a[168:171], v[60:63], v[232:235]
    ds_read_b128 a[156:159], v18 offset:23552
    v_cvt_pk_bf16_f32 v53, v106, v107
    v_mfma_f32_16x16x32_bf16 v[204:207], a[172:175], v[56:59], v[204:207]
    v_exp_f32 v108, v108
    v_mfma_f32_16x16x32_bf16 v[236:239], a[172:175], v[60:63], v[236:239]
    v_min_f32 v88, v88, v76
    v_add_f32 v89, 0x73700000, v22
    v_mfma_f32_16x16x32_bf16 v[208:211], a[176:179], v[56:59], v[208:211]
    v_exp_f32 v109, v109
    v_mfma_f32_16x16x32_bf16 v[240:243], a[176:179], v[60:63], v[240:243]
    v_cvt_pk_bf16_f32 v54, v108, v109
    v_xor_b32 v18, 196608, v18
    v_mfma_f32_16x16x32_bf16 v[212:215], a[180:183], v[56:59], v[212:215]
    v_exp_f32 v110, v110
    v_mfma_f32_16x16x32_bf16 v[244:247], a[180:183], v[60:63], v[244:247]
    v_min_f32 v89, v89, v77
    v_add_f32 v90, 0x73600000, v22
    v_mfma_f32_16x16x32_bf16 v[216:219], a[184:187], v[56:59], v[216:219]
    v_exp_f32 v111, v111
    v_mfma_f32_16x16x32_bf16 v[248:251], a[184:187], v[60:63], v[248:251]
    v_cvt_pk_bf16_f32 v55, v110, v111
    v_min_f32 v90, v90, v78
    v_mfma_f32_16x16x32_bf16 v[220:223], a[188:191], v[56:59], v[220:223]
    v_add_f32 v91, 0x73500000, v22
    v_min_f32 v91, v91, v79
    v_mfma_f32_16x16x32_bf16 v[252:255], a[188:191], v[60:63], v[252:255]
    v_add_f32 v92, 0, v22
    v_min_f32 v92, v92, v76
    v_add_f32 v93, 0xf1800000, v22
    v_min_f32 v93, v93, v77
    v_add_f32 v94, 0xf2000000, v22
    v_min_f32 v94, v94, v78
    v_add_f32 v95, 0xf2400000, v22
    v_min_f32 v95, v95, v79
    s_waitcnt vmcnt(0) lgkmcnt(0)
    s_barrier
    v_mfma_f32_16x16x32_bf16 v[96:99], a[128:131], a[96:99], v[80:83]
    s_xor_b32 s100, s16, 8192
    ds_read_b128 a[176:179], v20 offset:4096
    v_lshrrev_b32 v13, 1, v1
    v_mfma_f32_16x16x32_bf16 v[96:99], a[132:135], a[100:103], v[96:99]
    s_add_u32 m0, s15, 0
    ds_read_b128 a[180:183], v20 offset:5120
    v_add_u32 v12, s100, v13
    v_mfma_f32_16x16x32_bf16 v[96:99], a[136:139], a[104:107], v[96:99]
    buffer_load_dwordx4 v1, s[8:11], s82 offen offset:0  lds
    v_exp_f32 v112, v112
    v_mfma_f32_16x16x32_bf16 v[96:99], a[140:143], a[108:111], v[96:99]
    v_exp_f32 v113, v113
    v_mfma_f32_16x16x32_bf16 v[100:103], a[144:147], a[96:99], v[84:87]
    ds_read_b128 a[184:187], v20 offset:6144
    v_cvt_pk_bf16_f32 v56, v112, v113
    v_mfma_f32_16x16x32_bf16 v[100:103], a[148:151], a[100:103], v[100:103]
    v_exp_f32 v114, v114
    v_mfma_f32_16x16x32_bf16 v[100:103], a[152:155], a[104:107], v[100:103]
    buffer_load_dwordx4 v1, s[8:11], s82 offen offset:1024  lds
    v_exp_f32 v115, v115
    v_mfma_f32_16x16x32_bf16 v[100:103], a[156:159], a[108:111], v[100:103]
    ds_read_b128 a[188:191], v20 offset:7168
    v_cvt_pk_bf16_f32 v57, v114, v115
    v_mfma_f32_16x16x32_bf16 v[104:107], a[128:131], a[112:115], v[88:91]
    v_exp_f32 v116, v116
    v_mfma_f32_16x16x32_bf16 v[104:107], a[132:135], a[116:119], v[104:107]
    v_exp_f32 v117, v117
    v_mfma_f32_16x16x32_bf16 v[104:107], a[136:139], a[120:123], v[104:107]
    ds_read_b128 a[160:163], v19 offset:0
    v_cvt_pk_bf16_f32 v58, v116, v117
    v_mfma_f32_16x16x32_bf16 v[104:107], a[140:143], a[124:127], v[104:107]
    buffer_load_dwordx4 v1, s[8:11], s82 offen offset:2048  lds
    v_exp_f32 v118, v118
    v_mfma_f32_16x16x32_bf16 v[108:111], a[144:147], a[112:115], v[92:95]
    v_exp_f32 v119, v119
    v_mfma_f32_16x16x32_bf16 v[108:111], a[148:151], a[116:119], v[108:111]
    ds_read_b128 a[164:167], v19 offset:1024
    v_cvt_pk_bf16_f32 v59, v118, v119
    v_mfma_f32_16x16x32_bf16 v[108:111], a[152:155], a[120:123], v[108:111]
    v_exp_f32 v120, v120
    v_mfma_f32_16x16x32_bf16 v[108:111], a[156:159], a[124:127], v[108:111]
    buffer_load_dwordx4 v1, s[8:11], s82 offen offset:3072  lds
    v_exp_f32 v121, v121
    v_mfma_f32_16x16x32_bf16 v[32:35], v[28:31], v[48:51], v[32:35]
    s_add_u32 m0, s15, 4096
    ds_read_b128 a[168:171], v19 offset:2048
    v_cvt_pk_bf16_f32 v60, v120, v121
    v_mfma_f32_16x16x32_bf16 v[36:39], v[28:31], v[52:55], v[36:39]
    s_waitcnt lgkmcnt(6)
    v_exp_f32 v122, v122
    v_mfma_f32_16x16x32_bf16 v[144:147], a[176:179], v[48:51], v[144:147]
    v_exp_f32 v123, v123
    v_mfma_f32_16x16x32_bf16 v[176:179], a[176:179], v[52:55], v[176:179]
    s_waitcnt lgkmcnt(5)
    ds_read_b128 a[172:175], v19 offset:3072
    v_cvt_pk_bf16_f32 v61, v122, v123
    v_mfma_f32_16x16x32_bf16 v[148:151], a[180:183], v[48:51], v[148:151]
    buffer_load_dwordx4 v15, s[8:11], s82 offen offset:0  lds
    v_exp_f32 v124, v124
    v_mfma_f32_16x16x32_bf16 v[180:183], a[180:183], v[52:55], v[180:183]
    s_waitcnt lgkmcnt(5)
    v_exp_f32 v125, v125
    v_mfma_f32_16x16x32_bf16 v[152:155], a[184:187], v[48:51], v[152:155]
    s_waitcnt lgkmcnt(4)
    v_exp_f32 v126, v126
    v_mfma_f32_16x16x32_bf16 v[184:187], a[184:187], v[52:55], v[184:187]
    buffer_load_dwordx4 v15, s[8:11], s82 offen offset:1024  lds
    v_exp_f32 v127, v127
    v_mfma_f32_16x16x32_bf16 v[156:159], a[188:191], v[48:51], v[156:159]
    ds_write_b128 v16, v[144:147] offset:32768
    v_cvt_pk_bf16_f32 v62, v124, v125
    v_mfma_f32_16x16x32_bf16 v[188:191], a[188:191], v[52:55], v[188:191]
    s_waitcnt lgkmcnt(4)
    v_exp_f32 v96, v96
    v_mfma_f32_16x16x32_bf16 v[128:131], a[160:163], v[48:51], v[128:131]
    v_exp_f32 v97, v97
    v_mfma_f32_16x16x32_bf16 v[160:163], a[160:163], v[52:55], v[160:163]
    s_waitcnt lgkmcnt(3)
    ds_write_b128 v16, v[176:179] offset:33792
    v_cvt_pk_bf16_f32 v63, v126, v127
    v_mfma_f32_16x16x32_bf16 v[132:135], a[164:167], v[48:51], v[132:135]
    s_waitcnt lgkmcnt(3)
    v_exp_f32 v98, v98
    v_mfma_f32_16x16x32_bf16 v[164:167], a[164:167], v[52:55], v[164:167]
    buffer_load_dwordx4 v15, s[8:11], s82 offen offset:2048  lds
    v_exp_f32 v99, v99
    v_mfma_f32_16x16x32_bf16 v[136:139], a[168:171], v[48:51], v[136:139]
    ds_write_b128 v16, v[148:151] offset:34816
    v_mfma_f32_16x16x32_bf16 v[168:171], a[168:171], v[52:55], v[168:171]
    s_waitcnt lgkmcnt(3)
    v_exp_f32 v100, v100
    v_mfma_f32_16x16x32_bf16 v[140:143], a[172:175], v[48:51], v[140:143]
    v_exp_f32 v101, v101
    v_mfma_f32_16x16x32_bf16 v[172:175], a[172:175], v[52:55], v[172:175]
    ds_write_b128 v16, v[180:183] offset:35840
    v_mov_b32 v33, v36
    v_mfma_f32_16x16x32_bf16 v[40:43], v[28:31], v[56:59], v[40:43]
    buffer_load_dwordx4 v15, s[8:11], s82 offen offset:3072  lds
    v_exp_f32 v102, v102
    v_mfma_f32_16x16x32_bf16 v[44:47], v[28:31], v[60:63], v[44:47]
    s_xor_b32 s15, s15, 196608
    v_exp_f32 v103, v103
    v_mfma_f32_16x16x32_bf16 v[208:211], a[176:179], v[56:59], v[208:211]
    ds_write_b128 v16, v[152:155] offset:36864
    v_cvt_pk_bf16_f32 v48, v96, v97
    v_mfma_f32_16x16x32_bf16 v[240:243], a[176:179], v[60:63], v[240:243]
    ds_read_b128 a[176:179], v20 offset:20480
    v_exp_f32 v104, v104
    v_mfma_f32_16x16x32_bf16 v[212:215], a[180:183], v[56:59], v[212:215]
    v_exp_f32 v105, v105
    v_mfma_f32_16x16x32_bf16 v[244:247], a[180:183], v[60:63], v[244:247]
    ds_read_b128 a[180:183], v20 offset:21504
    v_exp_f32 v106, v106
    v_mfma_f32_16x16x32_bf16 v[216:219], a[184:187], v[56:59], v[216:219]
    ds_write_b128 v16, v[184:187] offset:37888
    v_cvt_pk_bf16_f32 v49, v98, v99
    v_mfma_f32_16x16x32_bf16 v[248:251], a[184:187], v[60:63], v[248:251]
    ds_read_b128 a[184:187], v20 offset:22528
    v_exp_f32 v107, v107
    v_mfma_f32_16x16x32_bf16 v[220:223], a[188:191], v[56:59], v[220:223]
    v_exp_f32 v108, v108
    v_mfma_f32_16x16x32_bf16 v[252:255], a[188:191], v[60:63], v[252:255]
    ds_read_b128 a[188:191], v20 offset:23552
    v_exp_f32 v109, v109
    v_mfma_f32_16x16x32_bf16 v[192:195], a[160:163], v[56:59], v[192:195]
    ds_write_b128 v16, v[156:159] offset:38912
    v_cvt_pk_bf16_f32 v50, v100, v101
    v_mfma_f32_16x16x32_bf16 v[224:227], a[160:163], v[60:63], v[224:227]
    ds_read_b128 a[160:163], v19 offset:16384
    v_exp_f32 v110, v110
    v_mfma_f32_16x16x32_bf16 v[196:199], a[164:167], v[56:59], v[196:199]
    v_exp_f32 v111, v111
    v_mfma_f32_16x16x32_bf16 v[228:231], a[164:167], v[60:63], v[228:231]
    ds_read_b128 a[164:167], v19 offset:17408
    v_cvt_pk_bf16_f32 v51, v102, v103
    v_mfma_f32_16x16x32_bf16 v[200:203], a[168:171], v[56:59], v[200:203]
    ds_write_b128 v16, v[188:191] offset:39936
    v_cvt_pk_bf16_f32 v52, v104, v105
    v_mfma_f32_16x16x32_bf16 v[232:235], a[168:171], v[60:63], v[232:235]
    ds_read_b128 a[168:171], v19 offset:18432
    v_cvt_pk_bf16_f32 v53, v106, v107
    v_mfma_f32_16x16x32_bf16 v[204:207], a[172:175], v[56:59], v[204:207]
    v_cvt_pk_bf16_f32 v54, v108, v109
    v_cvt_pk_bf16_f32 v55, v110, v111
    v_mfma_f32_16x16x32_bf16 v[236:239], a[172:175], v[60:63], v[236:239]
    ds_read_b128 a[172:175], v19 offset:19456
    ds_write_b64 v12, v[32:33]
    s_xor_b32 s101, s16, 98304
    v_xor_b32 v12, 8192, v12
    v_add_u32 v9, s101, v1
    v_xor_b32 v8, 8192, v16
    v_xor_b32 v10, 8192, v9
L_t1_join:
    v_xor_b32 v19, 98304, v19
    v_xor_b32 v20, 98304, v20
    s_waitcnt lgkmcnt(0)
    s_barrier
    v_mfma_f32_16x16x32_bf16 v[40:43], v[28:31], v[48:51], v[40:43]
    s_lshl_b32 s100, s60, 20
    s_add_u32 s101, s100, s21
    ds_read_b64 v[120:121], v12
    v_mfma_f32_16x16x32_bf16 v[44:47], v[28:31], v[52:55], v[44:47]
    s_add_u32 s100, s100, s20
    ds_read_b128 v[144:147], v8 offset:32768
    v_lshrrev_b32 v11, 4, v2
    v_mfma_f32_16x16x32_bf16 v[208:211], a[176:179], v[48:51], v[208:211]
    ds_read_b128 v[176:179], v8 offset:33792
    v_lshrrev_b32 v13, 2, v1
    v_mfma_f32_16x16x32_bf16 v[240:243], a[176:179], v[52:55], v[240:243]
    ds_read_b128 v[148:151], v8 offset:34816
    v_add_u32 v13, 32768, v13
    v_mfma_f32_16x16x32_bf16 v[212:215], a[180:183], v[48:51], v[212:215]
    s_xor_b32 s99, s62, 8192
    ds_read_b128 v[180:183], v8 offset:35840
    v_add_u32 v14, s99, v13
    v_mfma_f32_16x16x32_bf16 v[244:247], a[180:183], v[52:55], v[244:247]
    ds_read_b128 v[152:155], v8 offset:36864
    v_cmp_eq_u32 vcc, 1, v11
    v_mfma_f32_16x16x32_bf16 v[216:219], a[184:187], v[48:51], v[216:219]
    ds_read_b128 v[184:187], v8 offset:37888
    s_waitcnt lgkmcnt(6)
    v_add_f32 v112, v120, v32
    v_mfma_f32_16x16x32_bf16 v[248:251], a[184:187], v[52:55], v[248:251]
    ds_read_b128 v[156:159], v8 offset:38912
    v_add_f32 v114, v121, v36
    v_mfma_f32_16x16x32_bf16 v[220:223], a[188:191], v[48:51], v[220:223]
    ds_read_b128 v[188:191], v8 offset:39936
    v_cndmask_b32 v12, v32, v36, vcc
    v_mfma_f32_16x16x32_bf16 v[252:255], a[188:191], v[52:55], v[252:255]
    v_rcp_f32 v112, v112
    v_mfma_f32_16x16x32_bf16 v[192:195], a[160:163], v[48:51], v[192:195]
    v_rcp_f32 v114, v114
    v_mfma_f32_16x16x32_bf16 v[224:227], a[160:163], v[52:55], v[224:227]
    v_cmp_eq_u32 vcc, 2, v11
    v_cmp_eq_u32 s[96:97], 3, v11
    v_mfma_f32_16x16x32_bf16 v[196:199], a[164:167], v[48:51], v[196:199]
    ds_write_b128 v9, v[208:211] offset:0
    v_mfma_f32_16x16x32_bf16 v[228:231], a[164:167], v[52:55], v[228:231]
    v_mfma_f32_16x16x32_bf16 v[200:203], a[168:171], v[48:51], v[200:203]
    ds_write_b128 v9, v[240:243] offset:1024
    v_mfma_f32_16x16x32_bf16 v[232:235], a[168:171], v[52:55], v[232:235]
    v_mfma_f32_16x16x32_bf16 v[204:207], a[172:175], v[48:51], v[204:207]
    ds_write_b128 v9, v[212:215] offset:2048
    v_mfma_f32_16x16x32_bf16 v[236:239], a[172:175], v[52:55], v[236:239]
    v_cndmask_b32 v12, v12, v40, vcc
    v_cndmask_b32 v12, v12, v44, s[96:97]
    ds_write_b128 v9, v[244:247] offset:3072
    s_waitcnt lgkmcnt(11)
    v_pk_add_f32 v[128:129], v[128:129], v[144:145]
    v_pk_add_f32 v[130:131], v[130:131], v[146:147]
    s_waitcnt lgkmcnt(9)
    v_pk_add_f32 v[132:133], v[132:133], v[148:149]
    v_pk_add_f32 v[134:135], v[134:135], v[150:151]
    v_pk_mul_f32 v[128:129], v[128:129], v[112:113] op_sel_hi:[1,0]
    v_pk_mul_f32 v[130:131], v[130:131], v[112:113] op_sel_hi:[1,0]
    v_pk_mul_f32 v[132:133], v[132:133], v[112:113] op_sel_hi:[1,0]
    v_pk_mul_f32 v[134:135], v[134:135], v[112:113] op_sel_hi:[1,0]
    v_cvt_pk_bf16_f32 v128, v128, v129
    v_cvt_pk_bf16_f32 v129, v130, v131
    v_cvt_pk_bf16_f32 v130, v132, v133
    s_add_u32 m0, s16, 0
    ds_write_b128 v9, v[216:219] offset:4096
    v_cvt_pk_bf16_f32 v131, v134, v135
    buffer_store_dwordx4 v[128:131], v1, s[8:11], s100 offen offset:0 sc0 sc1
    s_waitcnt lgkmcnt(8)
    v_pk_add_f32 v[136:137], v[136:137], v[152:153]
    v_pk_add_f32 v[138:139], v[138:139], v[154:155]
    s_waitcnt lgkmcnt(6)
    v_pk_add_f32 v[140:141], v[140:141], v[156:157]
    v_pk_add_f32 v[142:143], v[142:143], v[158:159]
    v_pk_mul_f32 v[136:137], v[136:137], v[112:113] op_sel_hi:[1,0]
    v_pk_mul_f32 v[138:139], v[138:139], v[112:113] op_sel_hi:[1,0]
    v_pk_mul_f32 v[140:141], v[140:141], v[112:113] op_sel_hi:[1,0]
    v_pk_mul_f32 v[142:143], v[142:143], v[112:113] op_sel_hi:[1,0]
    v_cvt_pk_bf16_f32 v136, v136, v137
    buffer_load_dwordx4 v1, s[8:11], s19 offen offset:0  lds
    ds_write_b128 v9, v[248:251] offset:5120
    v_cvt_pk_bf16_f32 v137, v138, v139
    v_cvt_pk_bf16_f32 v138, v140, v141
    v_cvt_pk_bf16_f32 v139, v142, v143
    buffer_store_dwordx4 v[136:139], v1, s[8:11], s100 offen offset:1024 sc0 sc1
    v_pk_add_f32 v[160:161], v[160:161], v[176:177]
    v_pk_add_f32 v[162:163], v[162:163], v[178:179]
    v_pk_add_f32 v[164:165], v[164:165], v[180:181]
    v_pk_add_f32 v[166:167], v[166:167], v[182:183]
    v_pk_mul_f32 v[160:161], v[160:161], v[114:115] op_sel_hi:[1,0]
    v_pk_mul_f32 v[162:163], v[162:163], v[114:115] op_sel_hi:[1,0]
    v_pk_mul_f32 v[164:165], v[164:165], v[114:115] op_sel_hi:[1,0]
    buffer_load_dwordx4 v1, s[8:11], s19 offen offset:1024  lds
    ds_write_b128 v9, v[220:223] offset:6144
    v_pk_mul_f32 v[166:167], v[166:167], v[114:115] op_sel_hi:[1,0]
    v_cvt_pk_bf16_f32 v160, v160, v161
    v_cvt_pk_bf16_f32 v161, v162, v163
    v_cvt_pk_bf16_f32 v162, v164, v165
    v_cvt_pk_bf16_f32 v163, v166, v167
    buffer_store_dwordx4 v[160:163], v15, s[8:11], s100 offen offset:0 sc0 sc1
    v_pk_add_f32 v[168:169], v[168:169], v[184:185]
    v_pk_add_f32 v[170:171], v[170:171], v[186:187]
    s_waitcnt lgkmcnt(7)
    v_pk_add_f32 v[172:173], v[172:173], v[188:189]
    v_pk_add_f32 v[174:175], v[174:175], v[190:191]
    v_pk_mul_f32 v[168:169], v[168:169], v[114:115] op_sel_hi:[1,0]
    buffer_load_dwordx4 v1, s[8:11], s19 offen offset:2048  lds
    ds_write_b128 v9, v[252:255] offset:7168
    v_pk_mul_f32 v[170:171], v[170:171], v[114:115] op_sel_hi:[1,0]
    v_pk_mul_f32 v[172:173], v[172:173], v[114:115] op_sel_hi:[1,0]
    v_pk_mul_f32 v[174:175], v[174:175], v[114:115] op_sel_hi:[1,0]
    v_cvt_pk_bf16_f32 v168, v168, v169
    v_cvt_pk_bf16_f32 v169, v170, v171
    v_cvt_pk_bf16_f32 v170, v172, v173
    v_cvt_pk_bf16_f32 v171, v174, v175
    buffer_store_dwordx4 v[168:171], v15, s[8:11], s100 offen offset:1024 sc0 sc1
    buffer_load_dwordx4 v1, s[8:11], s19 offen offset:3072  lds
    ds_write_b32 v14, v12
    v_and_b32 v14, 4294967103, v13
    v_add_u32 v14, s62, v14
    s_waitcnt lgkmcnt(0)
    s_barrier
    ds_read_b32 v116, v14 offset:128
    ds_read_b32 v118, v14 offset:192
    ds_read_b128 v[208:211], v10 offset:0
    ds_read_b128 v[212:215], v10 offset:2048
    ds_read_b128 v[216:219], v10 offset:4096
    ds_read_b128 v[220:223], v10 offset:6144
    ds_read_b128 v[240:243], v10 offset:1024
    ds_read_b128 v[244:247], v10 offset:3072
    ds_read_b128 v[248:251], v10 offset:5120
    ds_read_b128 v[252:255], v10 offset:7168
    ds_read_b32 v120, v13 offset:0
    ds_read_b32 v121, v13 offset:8192
    ds_read_b32 v122, v13 offset:16384
    ds_read_b32 v123, v13 offset:24576
    s_waitcnt lgkmcnt(13)
    v_add_f32 v116, v116, v40
    s_waitcnt lgkmcnt(12)
    v_add_f32 v118, v118, v44
    v_rcp_f32 v116, v116
    v_rcp_f32 v118, v118
    s_waitcnt lgkmcnt(11)
    v_pk_add_f32 v[192:193], v[192:193], v[208:209]
    v_pk_add_f32 v[194:195], v[194:195], v[210:211]
    s_waitcnt lgkmcnt(10)
    v_pk_add_f32 v[196:197], v[196:197], v[212:213]
    v_pk_add_f32 v[198:199], v[198:199], v[214:215]
    v_pk_mul_f32 v[192:193], v[192:193], v[116:117] op_sel_hi:[1,0]
    v_pk_mul_f32 v[194:195], v[194:195], v[116:117] op_sel_hi:[1,0]
    v_pk_mul_f32 v[196:197], v[196:197], v[116:117] op_sel_hi:[1,0]
    v_pk_mul_f32 v[198:199], v[198:199], v[116:117] op_sel_hi:[1,0]
    v_cvt_pk_bf16_f32 v192, v192, v193
    v_cvt_pk_bf16_f32 v193, v194, v195
    v_cvt_pk_bf16_f32 v194, v196, v197
    v_cvt_pk_bf16_f32 v195, v198, v199
    buffer_store_dwordx4 v[192:195], v1, s[8:11], s101 offen offset:0 sc0 sc1
    s_add_u32 m0, s16, 4096
    s_waitcnt lgkmcnt(9)
    v_pk_add_f32 v[200:201], v[200:201], v[216:217]
    v_pk_add_f32 v[202:203], v[202:203], v[218:219]
    s_waitcnt lgkmcnt(8)
    v_pk_add_f32 v[204:205], v[204:205], v[220:221]
    v_pk_add_f32 v[206:207], v[206:207], v[222:223]
    v_pk_mul_f32 v[200:201], v[200:201], v[116:117] op_sel_hi:[1,0]
    v_pk_mul_f32 v[202:203], v[202:203], v[116:117] op_sel_hi:[1,0]
    v_pk_mul_f32 v[204:205], v[204:205], v[116:117] op_sel_hi:[1,0]
    v_pk_mul_f32 v[206:207], v[206:207], v[116:117] op_sel_hi:[1,0]
    v_cvt_pk_bf16_f32 v200, v200, v201
    v_cvt_pk_bf16_f32 v201, v202, v203
    v_cvt_pk_bf16_f32 v202, v204, v205
    v_cvt_pk_bf16_f32 v203, v206, v207
    buffer_store_dwordx4 v[200:203], v1, s[8:11], s101 offen offset:1024 sc0 sc1
    buffer_load_dwordx4 v15, s[8:11], s19 offen offset:0  lds
    buffer_load_dwordx4 v15, s[8:11], s19 offen offset:1024  lds
    s_waitcnt lgkmcnt(2)
    v_add_f32 v120, v120, v121
    s_waitcnt lgkmcnt(0)
    v_add_f32 v122, v122, v123
    v_min_f32 v124, v120, v122
    v_add_f32 v120, v120, v122
    v_cmp_le_f32 vcc, 0x1f800000, v124
    s_mov_b64 s[96:97], vcc
    v_cmp_ge_f32 vcc, 0x67800000, v120
    s_and_b64 s[96:97], s[96:97], vcc
    s_cmp_eq_u64 s[96:97], -1
    s_cselect_b32 s96, s25, 1
    s_cmp_lg_u32 s96, 0
    s_cbranch_scc1 L_t1_redo
L_t1_safe:
    v_pk_add_f32 v[224:225], v[224:225], v[240:241]
    v_pk_add_f32 v[226:227], v[226:227], v[242:243]
    v_pk_add_f32 v[228:229], v[228:229], v[244:245]
    v_pk_add_f32 v[230:231], v[230:231], v[246:247]
    v_pk_mul_f32 v[224:225], v[224:225], v[118:119] op_sel_hi:[1,0]
    v_pk_mul_f32 v[226:227], v[226:227], v[118:119] op_sel_hi:[1,0]
    v_pk_mul_f32 v[228:229], v[228:229], v[118:119] op_sel_hi:[1,0]
    v_pk_mul_f32 v[230:231], v[230:231], v[118:119] op_sel_hi:[1,0]
    v_cvt_pk_bf16_f32 v224, v224, v225
    v_cvt_pk_bf16_f32 v225, v226, v227
    v_cvt_pk_bf16_f32 v226, v228, v229
    v_cvt_pk_bf16_f32 v227, v230, v231
    buffer_store_dwordx4 v[224:227], v15, s[8:11], s101 offen offset:0 sc0 sc1
    buffer_load_dwordx4 v15, s[8:11], s19 offen offset:2048  lds
    ds_read_b128 a[128:131], v18 offset:0
    ds_read_b128 a[132:135], v18 offset:1024
    ds_read_b128 a[136:139], v18 offset:2048
    ds_read_b128 a[140:143], v18 offset:3072
    v_pk_add_f32 v[232:233], v[232:233], v[248:249]
    v_pk_add_f32 v[234:235], v[234:235], v[250:251]
    v_pk_add_f32 v[236:237], v[236:237], v[252:253]
    v_pk_add_f32 v[238:239], v[238:239], v[254:255]
    v_pk_mul_f32 v[232:233], v[232:233], v[118:119] op_sel_hi:[1,0]
    v_pk_mul_f32 v[234:235], v[234:235], v[118:119] op_sel_hi:[1,0]
    v_pk_mul_f32 v[236:237], v[236:237], v[118:119] op_sel_hi:[1,0]
    v_pk_mul_f32 v[238:239], v[238:239], v[118:119] op_sel_hi:[1,0]
    v_cvt_pk_bf16_f32 v232, v232, v233
    v_cvt_pk_bf16_f32 v233, v234, v235
    v_cvt_pk_bf16_f32 v234, v236, v237
    v_cvt_pk_bf16_f32 v235, v238, v239
    buffer_store_dwordx4 v[232:235], v15, s[8:11], s101 offen offset:1024 sc0 sc1
    buffer_load_dwordx4 v15, s[8:11], s19 offen offset:3072  lds
    s_xor_b32 s16, s16, 98304
    ds_read_b128 a[144:147], v18 offset:4096
    ds_read_b128 a[148:151], v18 offset:5120
    ds_read_b128 a[152:155], v18 offset:6144
    ds_read_b128 a[156:159], v18 offset:7168
L_t2_start:
    s_waitcnt lgkmcnt(7)
    v_mfma_f32_16x16x32_bf16 v[96:99], a[128:131], a[192:195], v[64:67]
    s_waitcnt lgkmcnt(6)
    s_add_u32 s19, s82, 32768
    s_sub_u32 s82, s12, s13
    s_sub_u32 s82, s82, 1
    v_mfma_f32_16x16x32_bf16 v[96:99], a[132:135], a[196:199], v[96:99]
    s_waitcnt lgkmcnt(5)
    s_cmp_gt_u32 s12, s13
    s_cselect_b32 s82, s82, s12
    s_mul_i32 s82, s82, 65536
    s_add_u32 s82, s82, s81
    v_mfma_f32_16x16x32_bf16 v[96:99], a[136:139], a[200:203], v[96:99]
    s_waitcnt lgkmcnt(4)
    s_cmp_ge_u32 s12, 17
    s_cselect_b32 s82, 2147471360, s82
    s_add_u32 s12, s12, 1
    s_sub_u32 s14, s61, 8
    v_mfma_f32_16x16x32_bf16 v[96:99], a[140:143], a[204:207], v[96:99]
    s_waitcnt lgkmcnt(3)
    v_mfma_f32_16x16x32_bf16 v[100:103], a[144:147], a[192:195], v[64:67]
    s_waitcnt lgkmcnt(2)
    v_mfma_f32_16x16x32_bf16 v[100:103], a[148:151], a[196:199], v[100:103]
    s_waitcnt lgkmcnt(1)
    v_mfma_f32_16x16x32_bf16 v[100:103], a[152:155], a[200:203], v[100:103]
    s_waitcnt lgkmcnt(0)
    v_mfma_f32_16x16x32_bf16 v[100:103], a[156:159], a[204:207], v[100:103]
    v_mfma_f32_16x16x32_bf16 v[104:107], a[128:131], a[208:211], v[68:71]
    v_exp_f32 v96, v96
    v_mfma_f32_16x16x32_bf16 v[104:107], a[132:135], a[212:215], v[104:107]
    v_exp_f32 v97, v97
    v_mfma_f32_16x16x32_bf16 v[104:107], a[136:139], a[216:219], v[104:107]
    v_exp_f32 v98, v98
    v_mfma_f32_16x16x32_bf16 v[104:107], a[140:143], a[220:223], v[104:107]
    v_exp_f32 v99, v99
    v_mfma_f32_16x16x32_bf16 v[108:111], a[144:147], a[208:211], v[68:71]
    v_exp_f32 v100, v100
    v_mfma_f32_16x16x32_bf16 v[108:111], a[148:151], a[212:215], v[108:111]
    v_exp_f32 v101, v101
    v_mfma_f32_16x16x32_bf16 v[108:111], a[152:155], a[216:219], v[108:111]
    v_exp_f32 v102, v102
    v_mfma_f32_16x16x32_bf16 v[108:111], a[156:159], a[220:223], v[108:111]
    v_exp_f32 v103, v103
    v_mfma_f32_16x16x32_bf16 v[112:115], a[128:131], a[224:227], v[72:75]
    v_exp_f32 v104, v104
    v_mfma_f32_16x16x32_bf16 v[112:115], a[132:135], a[228:231], v[112:115]
    v_exp_f32 v105, v105
    v_mfma_f32_16x16x32_bf16 v[112:115], a[136:139], a[232:235], v[112:115]
    v_exp_f32 v106, v106
    v_mfma_f32_16x16x32_bf16 v[112:115], a[140:143], a[236:239], v[112:115]
    v_exp_f32 v107, v107
    v_mfma_f32_16x16x32_bf16 v[120:123], a[128:131], a[240:243], v[76:79]
    v_exp_f32 v108, v108
    v_mfma_f32_16x16x32_bf16 v[120:123], a[132:135], a[244:247], v[120:123]
    v_exp_f32 v109, v109
    v_mfma_f32_16x16x32_bf16 v[120:123], a[136:139], a[248:251], v[120:123]
    v_exp_f32 v110, v110
    v_mfma_f32_16x16x32_bf16 v[120:123], a[140:143], a[252:255], v[120:123]
    v_exp_f32 v111, v111
    v_mfma_f32_16x16x32_bf16 v[116:119], a[144:147], a[224:227], v[72:75]
    ds_read_b128 a[128:131], v18 offset:16384
    v_cvt_pk_bf16_f32 v48, v96, v97
    v_mfma_f32_16x16x32_bf16 v[116:119], a[148:151], a[228:231], v[116:119]
    ds_read_b128 a[132:135], v18 offset:17408
    v_cvt_pk_bf16_f32 v49, v98, v99
    v_mfma_f32_16x16x32_bf16 v[116:119], a[152:155], a[232:235], v[116:119]
    ds_read_b128 a[136:139], v18 offset:18432
    v_cvt_pk_bf16_f32 v50, v100, v101
    v_mfma_f32_16x16x32_bf16 v[116:119], a[156:159], a[236:239], v[116:119]
    ds_read_b128 a[140:143], v18 offset:19456
    v_cvt_pk_bf16_f32 v51, v102, v103
    v_mfma_f32_16x16x32_bf16 v[124:127], a[144:147], a[240:243], v[76:79]
    ds_read_b128 a[144:147], v18 offset:20480
    v_cvt_pk_bf16_f32 v52, v104, v105
    v_mfma_f32_16x16x32_bf16 v[124:127], a[148:151], a[244:247], v[124:127]
    ds_read_b128 a[148:151], v18 offset:21504
    v_cvt_pk_bf16_f32 v53, v106, v107
    v_mfma_f32_16x16x32_bf16 v[124:127], a[152:155], a[248:251], v[124:127]
    ds_read_b128 a[152:155], v18 offset:22528
    v_cvt_pk_bf16_f32 v54, v108, v109
    v_mfma_f32_16x16x32_bf16 v[124:127], a[156:159], a[252:255], v[124:127]
    ds_read_b128 a[156:159], v18 offset:23552
    v_cvt_pk_bf16_f32 v55, v110, v111
    v_xor_b32 v18, 196608, v18
    s_waitcnt vmcnt(0) lgkmcnt(0)
    s_barrier
    v_mfma_f32_16x16x32_bf16 v[96:99], a[128:131], a[192:195], v[64:67]
    s_add_u32 m0, s15, 0
    ds_read_b128 a[160:163], v19 offset:0
    v_mfma_f32_16x16x32_bf16 v[96:99], a[132:135], a[196:199], v[96:99]
    ds_read_b128 a[164:167], v19 offset:1024
    v_mfma_f32_16x16x32_bf16 v[96:99], a[136:139], a[200:203], v[96:99]
    v_exp_f32 v112, v112
    v_mfma_f32_16x16x32_bf16 v[96:99], a[140:143], a[204:207], v[96:99]
    buffer_load_dwordx4 v1, s[8:11], s82 offen offset:0  lds
    v_mfma_f32_16x16x32_bf16 v[104:107], a[128:131], a[208:211], v[68:71]
    v_exp_f32 v113, v113
    v_mfma_f32_16x16x32_bf16 v[104:107], a[132:135], a[212:215], v[104:107]
    ds_read_b128 a[168:171], v19 offset:2048
    v_cvt_pk_bf16_f32 v56, v112, v113
    v_mfma_f32_16x16x32_bf16 v[104:107], a[136:139], a[216:219], v[104:107]
    v_exp_f32 v114, v114
    v_mfma_f32_16x16x32_bf16 v[104:107], a[140:143], a[220:223], v[104:107]
    buffer_load_dwordx4 v1, s[8:11], s82 offen offset:1024  lds
    v_mfma_f32_16x16x32_bf16 v[100:103], a[144:147], a[192:195], v[64:67]
    v_exp_f32 v115, v115
    v_mfma_f32_16x16x32_bf16 v[100:103], a[148:151], a[196:199], v[100:103]
    ds_read_b128 a[172:175], v19 offset:3072
    v_cvt_pk_bf16_f32 v57, v114, v115
    v_mfma_f32_16x16x32_bf16 v[100:103], a[152:155], a[200:203], v[100:103]
    v_exp_f32 v116, v116
    v_mfma_f32_16x16x32_bf16 v[100:103], a[156:159], a[204:207], v[100:103]
    buffer_load_dwordx4 v1, s[8:11], s82 offen offset:2048  lds
    v_mfma_f32_16x16x32_bf16 v[108:111], a[144:147], a[208:211], v[68:71]
    v_exp_f32 v117, v117
    v_mfma_f32_16x16x32_bf16 v[108:111], a[148:151], a[212:215], v[108:111]
    ds_read_b128 a[176:179], v20 offset:4096
    v_cvt_pk_bf16_f32 v58, v116, v117
    v_mfma_f32_16x16x32_bf16 v[108:111], a[152:155], a[216:219], v[108:111]
    v_exp_f32 v118, v118
    v_mfma_f32_16x16x32_bf16 v[108:111], a[156:159], a[220:223], v[108:111]
    buffer_load_dwordx4 v1, s[8:11], s82 offen offset:3072  lds
    v_mfma_f32_16x16x32_bf16 v[32:35], v[28:31], v[48:51], 0
    s_add_u32 m0, s15, 4096
    v_exp_f32 v119, v119
    v_mfma_f32_16x16x32_bf16 v[36:39], v[28:31], v[52:55], 0
    s_waitcnt lgkmcnt(4)
    ds_read_b128 a[180:183], v20 offset:5120
    v_cvt_pk_bf16_f32 v59, v118, v119
    v_mfma_f32_16x16x32_bf16 v[128:131], a[160:163], v[48:51], 0
    v_exp_f32 v120, v120
    v_mfma_f32_16x16x32_bf16 v[160:163], a[160:163], v[52:55], 0
    s_waitcnt lgkmcnt(4)
    v_mfma_f32_16x16x32_bf16 v[132:135], a[164:167], v[48:51], 0
    v_exp_f32 v121, v121
    v_mfma_f32_16x16x32_bf16 v[164:167], a[164:167], v[52:55], 0
    s_waitcnt lgkmcnt(3)
    ds_read_b128 a[184:187], v20 offset:6144
    v_cvt_pk_bf16_f32 v60, v120, v121
    v_mfma_f32_16x16x32_bf16 v[136:139], a[168:171], v[48:51], 0
    s_waitcnt lgkmcnt(3)
    v_exp_f32 v122, v122
    v_mfma_f32_16x16x32_bf16 v[168:171], a[168:171], v[52:55], 0
    buffer_load_dwordx4 v15, s[8:11], s82 offen offset:0  lds
    v_mfma_f32_16x16x32_bf16 v[140:143], a[172:175], v[48:51], 0
    v_exp_f32 v123, v123
    v_mfma_f32_16x16x32_bf16 v[172:175], a[172:175], v[52:55], 0
    s_waitcnt lgkmcnt(2)
    ds_read_b128 a[188:191], v20 offset:7168
    v_cvt_pk_bf16_f32 v61, v122, v123
    v_mfma_f32_16x16x32_bf16 v[144:147], a[176:179], v[48:51], 0
    s_waitcnt lgkmcnt(2)
    v_exp_f32 v124, v124
    v_mfma_f32_16x16x32_bf16 v[176:179], a[176:179], v[52:55], 0
    buffer_load_dwordx4 v15, s[8:11], s82 offen offset:1024  lds
    v_mfma_f32_16x16x32_bf16 v[148:151], a[180:183], v[48:51], 0
    v_exp_f32 v125, v125
    v_mfma_f32_16x16x32_bf16 v[180:183], a[180:183], v[52:55], 0
    s_waitcnt lgkmcnt(1)
    v_cvt_pk_bf16_f32 v62, v124, v125
    v_mfma_f32_16x16x32_bf16 v[152:155], a[184:187], v[48:51], 0
    s_waitcnt lgkmcnt(0)
    v_exp_f32 v126, v126
    v_mfma_f32_16x16x32_bf16 v[184:187], a[184:187], v[52:55], 0
    buffer_load_dwordx4 v15, s[8:11], s82 offen offset:2048  lds
    v_mfma_f32_16x16x32_bf16 v[156:159], a[188:191], v[48:51], 0
    v_exp_f32 v127, v127
    v_mfma_f32_16x16x32_bf16 v[188:191], a[188:191], v[52:55], 0
    v_cvt_pk_bf16_f32 v63, v126, v127
    v_mfma_f32_16x16x32_bf16 v[112:115], a[128:131], a[224:227], v[72:75]
    v_mfma_f32_16x16x32_bf16 v[112:115], a[132:135], a[228:231], v[112:115]
    v_mfma_f32_16x16x32_bf16 v[112:115], a[136:139], a[232:235], v[112:115]
    v_exp_f32 v96, v96
    v_mfma_f32_16x16x32_bf16 v[112:115], a[140:143], a[236:239], v[112:115]
    buffer_load_dwordx4 v15, s[8:11], s82 offen offset:3072  lds
    v_mfma_f32_16x16x32_bf16 v[120:123], a[128:131], a[240:243], v[76:79]
    s_xor_b32 s15, s15, 196608
    v_exp_f32 v97, v97
    v_mfma_f32_16x16x32_bf16 v[120:123], a[132:135], a[244:247], v[120:123]
    s_add_u32 m0, s16, 0
    ds_read_b128 a[128:131], v18 offset:0
    v_cvt_pk_bf16_f32 v48, v96, v97
    v_mfma_f32_16x16x32_bf16 v[120:123], a[136:139], a[248:251], v[120:123]
    v_exp_f32 v98, v98
    v_mfma_f32_16x16x32_bf16 v[120:123], a[140:143], a[252:255], v[120:123]
    buffer_load_dwordx4 v1, s[8:11], s19 offen offset:0  lds
    v_mfma_f32_16x16x32_bf16 v[116:119], a[144:147], a[224:227], v[72:75]
    v_exp_f32 v99, v99
    v_mfma_f32_16x16x32_bf16 v[116:119], a[148:151], a[228:231], v[116:119]
    ds_read_b128 a[132:135], v18 offset:1024
    v_cvt_pk_bf16_f32 v49, v98, v99
    v_mfma_f32_16x16x32_bf16 v[116:119], a[152:155], a[232:235], v[116:119]
    v_exp_f32 v100, v100
    v_mfma_f32_16x16x32_bf16 v[116:119], a[156:159], a[236:239], v[116:119]
    buffer_load_dwordx4 v1, s[8:11], s19 offen offset:1024  lds
    v_mfma_f32_16x16x32_bf16 v[124:127], a[144:147], a[240:243], v[76:79]
    v_exp_f32 v101, v101
    v_mfma_f32_16x16x32_bf16 v[124:127], a[148:151], a[244:247], v[124:127]
    ds_read_b128 a[136:139], v18 offset:2048
    v_cvt_pk_bf16_f32 v50, v100, v101
    v_mfma_f32_16x16x32_bf16 v[124:127], a[152:155], a[248:251], v[124:127]
    v_exp_f32 v102, v102
    v_mfma_f32_16x16x32_bf16 v[124:127], a[156:159], a[252:255], v[124:127]
    buffer_load_dwordx4 v1, s[8:11], s19 offen offset:2048  lds
    v_mfma_f32_16x16x32_bf16 v[40:43], v[28:31], v[56:59], 0
    v_exp_f32 v103, v103
    v_mfma_f32_16x16x32_bf16 v[44:47], v[28:31], v[60:63], 0
    ds_read_b128 a[140:143], v18 offset:3072
    v_cvt_pk_bf16_f32 v51, v102, v103
    v_mfma_f32_16x16x32_bf16 v[192:195], a[160:163], v[56:59], 0
    v_exp_f32 v104, v104
    v_mfma_f32_16x16x32_bf16 v[224:227], a[160:163], v[60:63], 0
    v_mfma_f32_16x16x32_bf16 v[196:199], a[164:167], v[56:59], 0
    v_exp_f32 v105, v105
    v_mfma_f32_16x16x32_bf16 v[228:231], a[164:167], v[60:63], 0
    ds_read_b128 a[144:147], v18 offset:4096
    v_cvt_pk_bf16_f32 v52, v104, v105
    v_mfma_f32_16x16x32_bf16 v[200:203], a[168:171], v[56:59], 0
    v_exp_f32 v106, v106
    v_mfma_f32_16x16x32_bf16 v[232:235], a[168:171], v[60:63], 0
    buffer_load_dwordx4 v1, s[8:11], s19 offen offset:3072  lds
    v_mfma_f32_16x16x32_bf16 v[204:207], a[172:175], v[56:59], 0
    s_add_u32 m0, s16, 4096
    v_exp_f32 v107, v107
    v_mfma_f32_16x16x32_bf16 v[236:239], a[172:175], v[60:63], 0
    ds_read_b128 a[148:151], v18 offset:5120
    v_cvt_pk_bf16_f32 v53, v106, v107
    v_mfma_f32_16x16x32_bf16 v[208:211], a[176:179], v[56:59], 0
    v_exp_f32 v108, v108
    v_mfma_f32_16x16x32_bf16 v[240:243], a[176:179], v[60:63], 0
    buffer_load_dwordx4 v15, s[8:11], s19 offen offset:0  lds
    v_mfma_f32_16x16x32_bf16 v[212:215], a[180:183], v[56:59], 0
    v_exp_f32 v109, v109
    v_mfma_f32_16x16x32_bf16 v[244:247], a[180:183], v[60:63], 0
    ds_read_b128 a[152:155], v18 offset:6144
    v_cvt_pk_bf16_f32 v54, v108, v109
    v_mfma_f32_16x16x32_bf16 v[216:219], a[184:187], v[56:59], 0
    v_exp_f32 v110, v110
    v_mfma_f32_16x16x32_bf16 v[248:251], a[184:187], v[60:63], 0
    buffer_load_dwordx4 v15, s[8:11], s19 offen offset:1024  lds
    v_mfma_f32_16x16x32_bf16 v[220:223], a[188:191], v[56:59], 0
    v_exp_f32 v111, v111
    v_mfma_f32_16x16x32_bf16 v[252:255], a[188:191], v[60:63], 0
    ds_read_b128 a[156:159], v18 offset:7168
    v_cvt_pk_bf16_f32 v55, v110, v111
    s_waitcnt lgkmcnt(7)
    v_mfma_f32_16x16x32_bf16 v[96:99], a[128:131], a[192:195], v[64:67]
    s_waitcnt lgkmcnt(6)
    s_lshr_b32 s101, s2, 3
    s_sub_u32 s101, s101, 4
    ds_read_b128 a[160:163], v19 offset:16384
    v_mfma_f32_16x16x32_bf16 v[96:99], a[132:135], a[196:199], v[96:99]
    s_waitcnt lgkmcnt(6)
    s_and_b32 s101, s101, 31
    ds_read_b128 a[164:167], v19 offset:17408
    v_and_b32 v14, 7, v2
    v_mfma_f32_16x16x32_bf16 v[96:99], a[136:139], a[200:203], v[96:99]
    s_waitcnt lgkmcnt(6)
    v_exp_f32 v112, v112
    v_mfma_f32_16x16x32_bf16 v[96:99], a[140:143], a[204:207], v[96:99]
    buffer_load_dwordx4 v15, s[8:11], s19 offen offset:2048  lds
    v_mfma_f32_16x16x32_bf16 v[104:107], a[128:131], a[208:211], v[68:71]
    v_exp_f32 v113, v113
    v_mfma_f32_16x16x32_bf16 v[104:107], a[132:135], a[212:215], v[104:107]
    ds_read_b128 a[168:171], v19 offset:18432
    v_cvt_pk_bf16_f32 v56, v112, v113
    v_mfma_f32_16x16x32_bf16 v[104:107], a[136:139], a[216:219], v[104:107]
    s_waitcnt lgkmcnt(6)
    v_exp_f32 v114, v114
    v_mfma_f32_16x16x32_bf16 v[104:107], a[140:143], a[220:223], v[104:107]
    buffer_load_dwordx4 v15, s[8:11], s19 offen offset:3072  lds
    v_mfma_f32_16x16x32_bf16 v[100:103], a[144:147], a[192:195], v[64:67]
    s_waitcnt lgkmcnt(5)
    s_xor_b32 s16, s16, 98304
    v_exp_f32 v115, v115
    v_mfma_f32_16x16x32_bf16 v[100:103], a[148:151], a[196:199], v[100:103]
    s_waitcnt lgkmcnt(4)
    s_add_u32 s27, s18, 0
    ds_read_b128 a[172:175], v19 offset:19456
    v_cvt_pk_bf16_f32 v57, v114, v115
    v_mfma_f32_16x16x32_bf16 v[100:103], a[152:155], a[200:203], v[100:103]
    s_waitcnt lgkmcnt(4)
    v_exp_f32 v116, v116
    v_mfma_f32_16x16x32_bf16 v[100:103], a[156:159], a[204:207], v[100:103]
    buffer_store_dwordx4 v[24:27], v17, s[8:11], s27 offen offset:0 sc0 sc1
    v_mfma_f32_16x16x32_bf16 v[108:111], a[144:147], a[208:211], v[68:71]
    s_add_u32 s27, s18, 131072
    v_exp_f32 v117, v117
    v_mfma_f32_16x16x32_bf16 v[108:111], a[148:151], a[212:215], v[108:111]
    ds_read_b128 a[176:179], v20 offset:20480
    v_cvt_pk_bf16_f32 v58, v116, v117
    v_mfma_f32_16x16x32_bf16 v[108:111], a[152:155], a[216:219], v[108:111]
    v_exp_f32 v118, v118
    v_mfma_f32_16x16x32_bf16 v[108:111], a[156:159], a[220:223], v[108:111]
    buffer_store_dwordx4 v[24:27], v17, s[8:11], s27 offen offset:0 sc0 sc1
    v_mfma_f32_16x16x32_bf16 v[32:35], v[28:31], v[48:51], v[32:35]
    v_exp_f32 v119, v119
    v_mfma_f32_16x16x32_bf16 v[36:39], v[28:31], v[52:55], v[36:39]
    s_waitcnt lgkmcnt(4)
    ds_read_b128 a[180:183], v20 offset:21504
    v_cvt_pk_bf16_f32 v59, v118, v119
    v_mfma_f32_16x16x32_bf16 v[128:131], a[160:163], v[48:51], v[128:131]
    v_exp_f32 v120, v120
    v_mfma_f32_16x16x32_bf16 v[160:163], a[160:163], v[52:55], v[160:163]
    s_waitcnt lgkmcnt(4)
    v_lshlrev_b32 v14, 4, v14
    v_lshrrev_b32 v13, 3, v2
    v_mfma_f32_16x16x32_bf16 v[132:135], a[164:167], v[48:51], v[132:135]
    v_exp_f32 v121, v121
    v_mfma_f32_16x16x32_bf16 v[164:167], a[164:167], v[52:55], v[164:167]
    s_waitcnt lgkmcnt(3)
    ds_read_b128 a[184:187], v20 offset:22528
    v_cvt_pk_bf16_f32 v60, v120, v121
    v_mfma_f32_16x16x32_bf16 v[136:139], a[168:171], v[48:51], v[136:139]
    v_exp_f32 v122, v122
    v_mfma_f32_16x16x32_bf16 v[168:171], a[168:171], v[52:55], v[168:171]
    s_waitcnt lgkmcnt(3)
    v_lshl_add_u32 v12, v13, 13, v14
    v_mul_u32_u24 v13, 28672, v13
    v_mfma_f32_16x16x32_bf16 v[140:143], a[172:175], v[48:51], v[140:143]
    v_exp_f32 v123, v123
    v_mfma_f32_16x16x32_bf16 v[172:175], a[172:175], v[52:55], v[172:175]
    s_waitcnt lgkmcnt(2)
    ds_read_b128 a[188:191], v20 offset:23552
    v_cvt_pk_bf16_f32 v61, v122, v123
    v_mfma_f32_16x16x32_bf16 v[144:147], a[176:179], v[48:51], v[144:147]
    v_exp_f32 v124, v124
    v_mfma_f32_16x16x32_bf16 v[176:179], a[176:179], v[52:55], v[176:179]
    s_waitcnt lgkmcnt(2)
    v_add_u32 v13, v13, v14
    v_mfma_f32_16x16x32_bf16 v[148:151], a[180:183], v[48:51], v[148:151]
    s_lshl_b32 s17, s4, 2
    v_exp_f32 v125, v125
    v_mfma_f32_16x16x32_bf16 v[180:183], a[180:183], v[52:55], v[180:183]
    s_waitcnt lgkmcnt(1)
    s_add_u32 s17, s17, s3
    v_cvt_pk_bf16_f32 v62, v124, v125
    v_xor_b32 v19, 98304, v19
    v_mfma_f32_16x16x32_bf16 v[152:155], a[184:187], v[48:51], v[152:155]
    s_lshl_b32 s17, s17, 7
    v_exp_f32 v126, v126
    v_mfma_f32_16x16x32_bf16 v[184:187], a[184:187], v[52:55], v[184:187]
    s_waitcnt lgkmcnt(0)
    s_lshl_b32 s100, s101, 16
    s_add_u32 s17, s17, s100
    v_xor_b32 v20, 98304, v20
    v_mfma_f32_16x16x32_bf16 v[156:159], a[188:191], v[48:51], v[156:159]
    s_add_u32 s17, s17, 4194304
    v_exp_f32 v127, v127
    v_mfma_f32_16x16x32_bf16 v[188:191], a[188:191], v[52:55], v[188:191]
    s_cmp_lt_u32 s101, s26
    s_cselect_b32 s17, s17, 2143285248
    v_cvt_pk_bf16_f32 v63, v126, v127
    buffer_store_dwordx4 a[0:3], v12, s[8:11], s17 offen sc0 sc1
    v_mfma_f32_16x16x32_bf16 v[112:115], a[128:131], a[224:227], v[72:75]
    s_add_u32 s17, s17, 4096
    v_exp_f32 v96, v96
    v_mfma_f32_16x16x32_bf16 v[112:115], a[132:135], a[228:231], v[112:115]
    buffer_store_dwordx4 a[4:7], v12, s[8:11], s17 offen sc0 sc1
    v_mfma_f32_16x16x32_bf16 v[112:115], a[136:139], a[232:235], v[112:115]
    s_add_u32 s27, s18, 0
    v_exp_f32 v97, v97
    v_mfma_f32_16x16x32_bf16 v[112:115], a[140:143], a[236:239], v[112:115]
    v_cvt_pk_bf16_f32 v48, v96, v97
    v_lshrrev_b32 v9, 1, v2
    v_mfma_f32_16x16x32_bf16 v[120:123], a[128:131], a[240:243], v[76:79]
    v_exp_f32 v98, v98
    v_mfma_f32_16x16x32_bf16 v[120:123], a[132:135], a[244:247], v[120:123]
    buffer_store_dwordx4 v[24:27], v17, s[8:11], s27 offen offset:256 sc0 sc1
    v_mfma_f32_16x16x32_bf16 v[120:123], a[136:139], a[248:251], v[120:123]
    s_add_u32 s27, s18, 131072
    v_exp_f32 v99, v99
    v_mfma_f32_16x16x32_bf16 v[120:123], a[140:143], a[252:255], v[120:123]
    buffer_store_dwordx4 v[24:27], v17, s[8:11], s27 offen offset:256 sc0 sc1
    v_mfma_f32_16x16x32_bf16 v[116:119], a[144:147], a[224:227], v[72:75]
    s_add_u32 s27, s18, 0
    v_exp_f32 v100, v100
    v_mfma_f32_16x16x32_bf16 v[116:119], a[148:151], a[228:231], v[116:119]
    ds_read_b128 a[128:131], v18 offset:16384
    v_cvt_pk_bf16_f32 v49, v98, v99
    v_mfma_f32_16x16x32_bf16 v[116:119], a[152:155], a[232:235], v[116:119]
    s_add_u32 s19, s82, 32768
    v_exp_f32 v101, v101
    v_mfma_f32_16x16x32_bf16 v[116:119], a[156:159], a[236:239], v[116:119]
    s_sub_u32 s82, s12, s13
    ds_read_b128 a[132:135], v18 offset:17408
    v_cvt_pk_bf16_f32 v50, v100, v101
    v_mfma_f32_16x16x32_bf16 v[124:127], a[144:147], a[240:243], v[76:79]
    s_sub_u32 s82, s82, 1
    v_exp_f32 v102, v102
    v_mfma_f32_16x16x32_bf16 v[124:127], a[148:151], a[244:247], v[124:127]
    s_cmp_gt_u32 s12, s13
    s_cselect_b32 s82, s82, s12
    s_mul_i32 s82, s82, 65536
    ds_read_b128 a[136:139], v18 offset:18432
    v_mfma_f32_16x16x32_bf16 v[124:127], a[152:155], a[248:251], v[124:127]
    s_add_u32 s82, s82, s81
    v_exp_f32 v103, v103
    v_mfma_f32_16x16x32_bf16 v[124:127], a[156:159], a[252:255], v[124:127]
    s_cmp_ge_u32 s12, 17
    s_cselect_b32 s82, 2147471360, s82
    ds_read_b128 a[140:143], v18 offset:19456
    v_cvt_pk_bf16_f32 v51, v102, v103
    v_mfma_f32_16x16x32_bf16 v[40:43], v[28:31], v[56:59], v[40:43]
    s_add_u32 s12, s12, 1
    v_exp_f32 v104, v104
    v_mfma_f32_16x16x32_bf16 v[44:47], v[28:31], v[60:63], v[44:47]
    ds_read_b128 a[144:147], v18 offset:20480
    v_lshrrev_b32 v10, 4, v2
    v_mfma_f32_16x16x32_bf16 v[192:195], a[160:163], v[56:59], v[192:195]
    v_exp_f32 v105, v105
    v_mfma_f32_16x16x32_bf16 v[224:227], a[160:163], v[60:63], v[224:227]
    ds_read_b128 a[148:151], v18 offset:21504
    v_cvt_pk_bf16_f32 v52, v104, v105
    v_mfma_f32_16x16x32_bf16 v[196:199], a[164:167], v[56:59], v[196:199]
    v_exp_f32 v106, v106
    v_mfma_f32_16x16x32_bf16 v[228:231], a[164:167], v[60:63], v[228:231]
    ds_read_b128 a[152:155], v18 offset:22528
    v_xor_b32 v9, v9, v10
    v_mfma_f32_16x16x32_bf16 v[200:203], a[168:171], v[56:59], v[200:203]
    v_exp_f32 v107, v107
    v_mfma_f32_16x16x32_bf16 v[232:235], a[168:171], v[60:63], v[232:235]
    ds_read_b128 a[156:159], v18 offset:23552
    v_cvt_pk_bf16_f32 v53, v106, v107
    v_mfma_f32_16x16x32_bf16 v[204:207], a[172:175], v[56:59], v[204:207]
    v_exp_f32 v108, v108
    v_mfma_f32_16x16x32_bf16 v[236:239], a[172:175], v[60:63], v[236:239]
    buffer_store_dwordx4 v[24:27], v17, s[8:11], s27 offen offset:512 sc0 sc1
    v_mfma_f32_16x16x32_bf16 v[208:211], a[176:179], v[56:59], v[208:211]
    s_add_u32 s27, s18, 131072
    v_exp_f32 v109, v109
    v_mfma_f32_16x16x32_bf16 v[240:243], a[176:179], v[60:63], v[240:243]
    v_cvt_pk_bf16_f32 v54, v108, v109
    v_xor_b32 v18, 196608, v18
    v_mfma_f32_16x16x32_bf16 v[212:215], a[180:183], v[56:59], v[212:215]
    v_exp_f32 v110, v110
    v_mfma_f32_16x16x32_bf16 v[244:247], a[180:183], v[60:63], v[244:247]
    buffer_store_dwordx4 v[24:27], v17, s[8:11], s27 offen offset:512 sc0 sc1
    v_mfma_f32_16x16x32_bf16 v[216:219], a[184:187], v[56:59], v[216:219]
    s_add_u32 s27, s18, 0
    v_exp_f32 v111, v111
    v_mfma_f32_16x16x32_bf16 v[248:251], a[184:187], v[60:63], v[248:251]
    v_cvt_pk_bf16_f32 v55, v110, v111
    v_and_b32 v9, 3, v9
    v_mfma_f32_16x16x32_bf16 v[220:223], a[188:191], v[56:59], v[220:223]
    buffer_store_dwordx4 v[24:27], v17, s[8:11], s27 offen offset:768 sc0 sc1
    v_mfma_f32_16x16x32_bf16 v[252:255], a[188:191], v[60:63], v[252:255]
    v_lshlrev_b32 v9, 5, v9
    v_and_b32 v10, 1, v2
    v_lshl_add_u32 v9, v10, 4, v9
    v_lshrrev_b32 v8, 3, v2
    s_waitcnt vmcnt(9) lgkmcnt(0)
    s_barrier
    buffer_store_dword v6, v5, s[8:11], s22 offen sc0 sc1
    v_mfma_f32_16x16x32_bf16 v[96:99], a[128:131], a[192:195], v[64:67]
    s_add_u32 m0, s15, 0
    ds_read_b128 a[160:163], v19 offset:0
    v_mfma_f32_16x16x32_bf16 v[96:99], a[132:135], a[196:199], v[96:99]
    ds_read_b128 a[164:167], v19 offset:1024
    v_mfma_f32_16x16x32_bf16 v[96:99], a[136:139], a[200:203], v[96:99]
    v_exp_f32 v112, v112
    v_mfma_f32_16x16x32_bf16 v[96:99], a[140:143], a[204:207], v[96:99]
    buffer_load_dwordx4 v1, s[8:11], s82 offen offset:0  lds
    v_mfma_f32_16x16x32_bf16 v[104:107], a[128:131], a[208:211], v[68:71]
    v_exp_f32 v113, v113
    v_mfma_f32_16x16x32_bf16 v[104:107], a[132:135], a[212:215], v[104:107]
    ds_read_b128 a[168:171], v19 offset:2048
    v_cvt_pk_bf16_f32 v56, v112, v113
    v_mfma_f32_16x16x32_bf16 v[104:107], a[136:139], a[216:219], v[104:107]
    v_exp_f32 v114, v114
    v_mfma_f32_16x16x32_bf16 v[104:107], a[140:143], a[220:223], v[104:107]
    buffer_load_dwordx4 v1, s[8:11], s82 offen offset:1024  lds
    v_mfma_f32_16x16x32_bf16 v[100:103], a[144:147], a[192:195], v[64:67]
    v_exp_f32 v115, v115
    v_mfma_f32_16x16x32_bf16 v[100:103], a[148:151], a[196:199], v[100:103]
    ds_read_b128 a[172:175], v19 offset:3072
    v_cvt_pk_bf16_f32 v57, v114, v115
    v_mfma_f32_16x16x32_bf16 v[100:103], a[152:155], a[200:203], v[100:103]
    v_exp_f32 v116, v116
    v_mfma_f32_16x16x32_bf16 v[100:103], a[156:159], a[204:207], v[100:103]
    buffer_load_dwordx4 v1, s[8:11], s82 offen offset:2048  lds
    v_mfma_f32_16x16x32_bf16 v[108:111], a[144:147], a[208:211], v[68:71]
    v_exp_f32 v117, v117
    v_mfma_f32_16x16x32_bf16 v[108:111], a[148:151], a[212:215], v[108:111]
    ds_read_b128 a[176:179], v20 offset:4096
    v_cvt_pk_bf16_f32 v58, v116, v117
    v_mfma_f32_16x16x32_bf16 v[108:111], a[152:155], a[216:219], v[108:111]
    v_exp_f32 v118, v118
    v_mfma_f32_16x16x32_bf16 v[108:111], a[156:159], a[220:223], v[108:111]
    buffer_load_dwordx4 v1, s[8:11], s82 offen offset:3072  lds
    v_mfma_f32_16x16x32_bf16 v[32:35], v[28:31], v[48:51], v[32:35]
    s_add_u32 m0, s15, 4096
    v_exp_f32 v119, v119
    v_mfma_f32_16x16x32_bf16 v[36:39], v[28:31], v[52:55], v[36:39]
    s_waitcnt lgkmcnt(4)
    ds_read_b128 a[180:183], v20 offset:5120
    v_cvt_pk_bf16_f32 v59, v118, v119
    v_mfma_f32_16x16x32_bf16 v[128:131], a[160:163], v[48:51], v[128:131]
    v_exp_f32 v120, v120
    v_mfma_f32_16x16x32_bf16 v[160:163], a[160:163], v[52:55], v[160:163]
    s_waitcnt lgkmcnt(4)
    v_mfma_f32_16x16x32_bf16 v[132:135], a[164:167], v[48:51], v[132:135]
    v_exp_f32 v121, v121
    v_mfma_f32_16x16x32_bf16 v[164:167], a[164:167], v[52:55], v[164:167]
    s_waitcnt lgkmcnt(3)
    ds_read_b128 a[184:187], v20 offset:6144
    v_cvt_pk_bf16_f32 v60, v120, v121
    v_mfma_f32_16x16x32_bf16 v[136:139], a[168:171], v[48:51], v[136:139]
    s_waitcnt lgkmcnt(3)
    v_exp_f32 v122, v122
    v_mfma_f32_16x16x32_bf16 v[168:171], a[168:171], v[52:55], v[168:171]
    buffer_load_dwordx4 v15, s[8:11], s82 offen offset:0  lds
    v_mfma_f32_16x16x32_bf16 v[140:143], a[172:175], v[48:51], v[140:143]
    v_exp_f32 v123, v123
    v_mfma_f32_16x16x32_bf16 v[172:175], a[172:175], v[52:55], v[172:175]
    s_waitcnt lgkmcnt(2)
    ds_read_b128 a[188:191], v20 offset:7168
    v_cvt_pk_bf16_f32 v61, v122, v123
    v_mfma_f32_16x16x32_bf16 v[144:147], a[176:179], v[48:51], v[144:147]
    s_waitcnt lgkmcnt(2)
    v_exp_f32 v124, v124
    v_mfma_f32_16x16x32_bf16 v[176:179], a[176:179], v[52:55], v[176:179]
    buffer_load_dwordx4 v15, s[8:11], s82 offen offset:1024  lds
    v_mfma_f32_16x16x32_bf16 v[148:151], a[180:183], v[48:51], v[148:151]
    v_exp_f32 v125, v125
    v_mfma_f32_16x16x32_bf16 v[180:183], a[180:183], v[52:55], v[180:183]
    s_waitcnt lgkmcnt(1)
    v_cvt_pk_bf16_f32 v62, v124, v125
    v_mfma_f32_16x16x32_bf16 v[152:155], a[184:187], v[48:51], v[152:155]
    s_waitcnt lgkmcnt(0)
    v_exp_f32 v126, v126
    v_mfma_f32_16x16x32_bf16 v[184:187], a[184:187], v[52:55], v[184:187]
    buffer_load_dwordx4 v15, s[8:11], s82 offen offset:2048  lds
    v_mfma_f32_16x16x32_bf16 v[156:159], a[188:191], v[48:51], v[156:159]
    v_exp_f32 v127, v127
    v_mfma_f32_16x16x32_bf16 v[188:191], a[188:191], v[52:55], v[188:191]
    v_cvt_pk_bf16_f32 v63, v126, v127
    v_mfma_f32_16x16x32_bf16 v[112:115], a[128:131], a[224:227], v[72:75]
    v_mfma_f32_16x16x32_bf16 v[112:115], a[132:135], a[228:231], v[112:115]
    v_mfma_f32_16x16x32_bf16 v[112:115], a[136:139], a[232:235], v[112:115]
    v_exp_f32 v96, v96
    v_mfma_f32_16x16x32_bf16 v[112:115], a[140:143], a[236:239], v[112:115]
    buffer_load_dwordx4 v15, s[8:11], s82 offen offset:3072  lds
    v_mfma_f32_16x16x32_bf16 v[120:123], a[128:131], a[240:243], v[76:79]
    s_xor_b32 s15, s15, 196608
    v_exp_f32 v97, v97
    v_mfma_f32_16x16x32_bf16 v[120:123], a[132:135], a[244:247], v[120:123]
    s_add_u32 m0, s16, 0
    ds_read_b128 a[128:131], v18 offset:0
    v_cvt_pk_bf16_f32 v48, v96, v97
    v_mfma_f32_16x16x32_bf16 v[120:123], a[136:139], a[248:251], v[120:123]
    v_exp_f32 v98, v98
    v_mfma_f32_16x16x32_bf16 v[120:123], a[140:143], a[252:255], v[120:123]
    buffer_load_dwordx4 v1, s[8:11], s19 offen offset:0  lds
    v_mfma_f32_16x16x32_bf16 v[116:119], a[144:147], a[224:227], v[72:75]
    v_exp_f32 v99, v99
    v_mfma_f32_16x16x32_bf16 v[116:119], a[148:151], a[228:231], v[116:119]
    ds_read_b128 a[132:135], v18 offset:1024
    v_cvt_pk_bf16_f32 v49, v98, v99
    v_mfma_f32_16x16x32_bf16 v[116:119], a[152:155], a[232:235], v[116:119]
    v_exp_f32 v100, v100
    v_mfma_f32_16x16x32_bf16 v[116:119], a[156:159], a[236:239], v[116:119]
    buffer_load_dwordx4 v1, s[8:11], s19 offen offset:1024  lds
    v_mfma_f32_16x16x32_bf16 v[124:127], a[144:147], a[240:243], v[76:79]
    v_exp_f32 v101, v101
    v_mfma_f32_16x16x32_bf16 v[124:127], a[148:151], a[244:247], v[124:127]
    ds_read_b128 a[136:139], v18 offset:2048
    v_cvt_pk_bf16_f32 v50, v100, v101
    v_mfma_f32_16x16x32_bf16 v[124:127], a[152:155], a[248:251], v[124:127]
    v_exp_f32 v102, v102
    v_mfma_f32_16x16x32_bf16 v[124:127], a[156:159], a[252:255], v[124:127]
    buffer_load_dwordx4 v1, s[8:11], s19 offen offset:2048  lds
    v_mfma_f32_16x16x32_bf16 v[40:43], v[28:31], v[56:59], v[40:43]
    v_exp_f32 v103, v103
    v_mfma_f32_16x16x32_bf16 v[44:47], v[28:31], v[60:63], v[44:47]
    ds_read_b128 a[140:143], v18 offset:3072
    v_cvt_pk_bf16_f32 v51, v102, v103
    v_mfma_f32_16x16x32_bf16 v[192:195], a[160:163], v[56:59], v[192:195]
    v_exp_f32 v104, v104
    v_mfma_f32_16x16x32_bf16 v[224:227], a[160:163], v[60:63], v[224:227]
    v_mfma_f32_16x16x32_bf16 v[196:199], a[164:167], v[56:59], v[196:199]
    v_exp_f32 v105, v105
    v_mfma_f32_16x16x32_bf16 v[228:231], a[164:167], v[60:63], v[228:231]
    ds_read_b128 a[144:147], v18 offset:4096
    v_cvt_pk_bf16_f32 v52, v104, v105
    v_mfma_f32_16x16x32_bf16 v[200:203], a[168:171], v[56:59], v[200:203]
    v_exp_f32 v106, v106
    v_mfma_f32_16x16x32_bf16 v[232:235], a[168:171], v[60:63], v[232:235]
    buffer_load_dwordx4 v1, s[8:11], s19 offen offset:3072  lds
    v_mfma_f32_16x16x32_bf16 v[204:207], a[172:175], v[56:59], v[204:207]
    s_add_u32 m0, s16, 4096
    v_exp_f32 v107, v107
    v_mfma_f32_16x16x32_bf16 v[236:239], a[172:175], v[60:63], v[236:239]
    ds_read_b128 a[148:151], v18 offset:5120
    v_cvt_pk_bf16_f32 v53, v106, v107
    v_mfma_f32_16x16x32_bf16 v[208:211], a[176:179], v[56:59], v[208:211]
    v_exp_f32 v108, v108
    v_mfma_f32_16x16x32_bf16 v[240:243], a[176:179], v[60:63], v[240:243]
    buffer_load_dwordx4 v15, s[8:11], s19 offen offset:0  lds
    v_mfma_f32_16x16x32_bf16 v[212:215], a[180:183], v[56:59], v[212:215]
    v_exp_f32 v109, v109
    v_mfma_f32_16x16x32_bf16 v[244:247], a[180:183], v[60:63], v[244:247]
    ds_read_b128 a[152:155], v18 offset:6144
    v_cvt_pk_bf16_f32 v54, v108, v109
    v_mfma_f32_16x16x32_bf16 v[216:219], a[184:187], v[56:59], v[216:219]
    v_exp_f32 v110, v110
    v_mfma_f32_16x16x32_bf16 v[248:251], a[184:187], v[60:63], v[248:251]
    buffer_load_dwordx4 v15, s[8:11], s19 offen offset:1024  lds
    v_mfma_f32_16x16x32_bf16 v[220:223], a[188:191], v[56:59], v[220:223]
    v_exp_f32 v111, v111
    v_mfma_f32_16x16x32_bf16 v[252:255], a[188:191], v[60:63], v[252:255]
    ds_read_b128 a[156:159], v18 offset:7168
    v_cvt_pk_bf16_f32 v55, v110, v111
    s_waitcnt lgkmcnt(7)
    v_mfma_f32_16x16x32_bf16 v[96:99], a[128:131], a[192:195], v[64:67]
    s_waitcnt lgkmcnt(6)
    ds_read_b128 a[160:163], v19 offset:16384
    v_mfma_f32_16x16x32_bf16 v[96:99], a[132:135], a[196:199], v[96:99]
    s_waitcnt lgkmcnt(6)
    ds_read_b128 a[164:167], v19 offset:17408
    v_mfma_f32_16x16x32_bf16 v[96:99], a[136:139], a[200:203], v[96:99]
    s_waitcnt lgkmcnt(6)
    v_exp_f32 v112, v112
    v_mfma_f32_16x16x32_bf16 v[96:99], a[140:143], a[204:207], v[96:99]
    buffer_load_dwordx4 v15, s[8:11], s19 offen offset:2048  lds
    v_mfma_f32_16x16x32_bf16 v[104:107], a[128:131], a[208:211], v[68:71]
    v_exp_f32 v113, v113
    v_mfma_f32_16x16x32_bf16 v[104:107], a[132:135], a[212:215], v[104:107]
    ds_read_b128 a[168:171], v19 offset:18432
    v_cvt_pk_bf16_f32 v56, v112, v113
    v_mfma_f32_16x16x32_bf16 v[104:107], a[136:139], a[216:219], v[104:107]
    s_waitcnt lgkmcnt(6)
    v_exp_f32 v114, v114
    v_mfma_f32_16x16x32_bf16 v[104:107], a[140:143], a[220:223], v[104:107]
    buffer_load_dwordx4 v15, s[8:11], s19 offen offset:3072  lds
    v_mfma_f32_16x16x32_bf16 v[100:103], a[144:147], a[192:195], v[64:67]
    s_waitcnt lgkmcnt(5)
    s_xor_b32 s16, s16, 98304
    v_exp_f32 v115, v115
    v_mfma_f32_16x16x32_bf16 v[100:103], a[148:151], a[196:199], v[100:103]
    s_waitcnt lgkmcnt(4)
    s_add_u32 s17, s17, 2093056
    ds_read_b128 a[172:175], v19 offset:19456
    v_cvt_pk_bf16_f32 v57, v114, v115
    v_mfma_f32_16x16x32_bf16 v[100:103], a[152:155], a[200:203], v[100:103]
    s_waitcnt lgkmcnt(4)
    v_exp_f32 v116, v116
    v_mfma_f32_16x16x32_bf16 v[100:103], a[156:159], a[204:207], v[100:103]
    buffer_store_dwordx4 a[8:11], v12, s[8:11], s17 offen sc0 sc1
    v_mfma_f32_16x16x32_bf16 v[108:111], a[144:147], a[208:211], v[68:71]
    s_add_u32 s27, s18, 131072
    v_exp_f32 v117, v117
    v_mfma_f32_16x16x32_bf16 v[108:111], a[148:151], a[212:215], v[108:111]
    ds_read_b128 a[176:179], v20 offset:20480
    v_cvt_pk_bf16_f32 v58, v116, v117
    v_mfma_f32_16x16x32_bf16 v[108:111], a[152:155], a[216:219], v[108:111]
    v_exp_f32 v118, v118
    v_mfma_f32_16x16x32_bf16 v[108:111], a[156:159], a[220:223], v[108:111]
    buffer_store_dwordx4 v[24:27], v17, s[8:11], s27 offen offset:768 sc0 sc1
    v_mfma_f32_16x16x32_bf16 v[32:35], v[28:31], v[48:51], v[32:35]
    s_add_u32 s27, s18, 8388608
    v_exp_f32 v119, v119
    v_mfma_f32_16x16x32_bf16 v[36:39], v[28:31], v[52:55], v[36:39]
    s_waitcnt lgkmcnt(4)
    ds_read_b128 a[180:183], v20 offset:21504
    v_cvt_pk_bf16_f32 v59, v118, v119
    v_mfma_f32_16x16x32_bf16 v[128:131], a[160:163], v[48:51], v[128:131]
    s_waitcnt lgkmcnt(4)
    v_exp_f32 v120, v120
    v_mfma_f32_16x16x32_bf16 v[160:163], a[160:163], v[52:55], v[160:163]
    buffer_store_dwordx4 v[24:27], v17, s[8:11], s27 offen offset:0 sc0 sc1
    v_mfma_f32_16x16x32_bf16 v[132:135], a[164:167], v[48:51], v[132:135]
    s_add_u32 s27, s18, 8519680
    v_exp_f32 v121, v121
    v_mfma_f32_16x16x32_bf16 v[164:167], a[164:167], v[52:55], v[164:167]
    s_waitcnt lgkmcnt(3)
    ds_read_b128 a[184:187], v20 offset:22528
    v_cvt_pk_bf16_f32 v60, v120, v121
    v_mfma_f32_16x16x32_bf16 v[136:139], a[168:171], v[48:51], v[136:139]
    s_waitcnt lgkmcnt(3)
    v_exp_f32 v122, v122
    v_mfma_f32_16x16x32_bf16 v[168:171], a[168:171], v[52:55], v[168:171]
    buffer_store_dwordx4 v[24:27], v17, s[8:11], s27 offen offset:0 sc0 sc1
    v_mfma_f32_16x16x32_bf16 v[140:143], a[172:175], v[48:51], v[140:143]
    v_exp_f32 v123, v123
    v_mfma_f32_16x16x32_bf16 v[172:175], a[172:175], v[52:55], v[172:175]
    s_waitcnt lgkmcnt(2)
    ds_read_b128 a[188:191], v20 offset:23552
    v_cvt_pk_bf16_f32 v61, v122, v123
    v_mfma_f32_16x16x32_bf16 v[144:147], a[176:179], v[48:51], v[144:147]
    v_exp_f32 v124, v124
    v_mfma_f32_16x16x32_bf16 v[176:179], a[176:179], v[52:55], v[176:179]
    s_waitcnt lgkmcnt(2)
    v_mfma_f32_16x16x32_bf16 v[148:151], a[180:183], v[48:51], v[148:151]
    v_exp_f32 v125, v125
    v_mfma_f32_16x16x32_bf16 v[180:183], a[180:183], v[52:55], v[180:183]
    s_waitcnt lgkmcnt(1)
    v_cvt_pk_bf16_f32 v62, v124, v125
    v_xor_b32 v19, 98304, v19
    v_mfma_f32_16x16x32_bf16 v[152:155], a[184:187], v[48:51], v[152:155]
    v_exp_f32 v126, v126
    v_mfma_f32_16x16x32_bf16 v[184:187], a[184:187], v[52:55], v[184:187]
    s_waitcnt lgkmcnt(0)
    v_xor_b32 v20, 98304, v20
    v_mfma_f32_16x16x32_bf16 v[156:159], a[188:191], v[48:51], v[156:159]
    v_exp_f32 v127, v127
    v_mfma_f32_16x16x32_bf16 v[188:191], a[188:191], v[52:55], v[188:191]
    v_cvt_pk_bf16_f32 v63, v126, v127
    v_mfma_f32_16x16x32_bf16 v[112:115], a[128:131], a[224:227], v[72:75]
    s_add_u32 s17, s17, 4096
    v_exp_f32 v96, v96
    v_mfma_f32_16x16x32_bf16 v[112:115], a[132:135], a[228:231], v[112:115]
    buffer_store_dwordx4 a[12:15], v12, s[8:11], s17 offen sc0 sc1
    v_mfma_f32_16x16x32_bf16 v[112:115], a[136:139], a[232:235], v[112:115]
    s_add_u32 s27, s18, 8388608
    v_exp_f32 v97, v97
    v_mfma_f32_16x16x32_bf16 v[112:115], a[140:143], a[236:239], v[112:115]
    v_cvt_pk_bf16_f32 v48, v96, v97
    v_lshl_add_u32 v8, v8, 10, v9
    v_mfma_f32_16x16x32_bf16 v[120:123], a[128:131], a[240:243], v[76:79]
    v_exp_f32 v98, v98
    v_mfma_f32_16x16x32_bf16 v[120:123], a[132:135], a[244:247], v[120:123]
    buffer_store_dwordx4 v[24:27], v17, s[8:11], s27 offen offset:256 sc0 sc1
    v_mfma_f32_16x16x32_bf16 v[120:123], a[136:139], a[248:251], v[120:123]
    s_add_u32 s27, s18, 8519680
    v_exp_f32 v99, v99
    v_mfma_f32_16x16x32_bf16 v[120:123], a[140:143], a[252:255], v[120:123]
    buffer_store_dwordx4 v[24:27], v17, s[8:11], s27 offen offset:256 sc0 sc1
    v_mfma_f32_16x16x32_bf16 v[116:119], a[144:147], a[224:227], v[72:75]
    s_add_u32 s27, s18, 8388608
    v_exp_f32 v100, v100
    v_mfma_f32_16x16x32_bf16 v[116:119], a[148:151], a[228:231], v[116:119]
    ds_read_b128 a[128:131], v18 offset:16384
    v_cvt_pk_bf16_f32 v49, v98, v99
    v_mfma_f32_16x16x32_bf16 v[116:119], a[152:155], a[232:235], v[116:119]
    s_add_u32 s19, s82, 32768
    v_exp_f32 v101, v101
    v_mfma_f32_16x16x32_bf16 v[116:119], a[156:159], a[236:239], v[116:119]
    s_sub_u32 s82, s12, s13
    ds_read_b128 a[132:135], v18 offset:17408
    v_cvt_pk_bf16_f32 v50, v100, v101
    v_mfma_f32_16x16x32_bf16 v[124:127], a[144:147], a[240:243], v[76:79]
    s_sub_u32 s82, s82, 1
    v_exp_f32 v102, v102
    v_mfma_f32_16x16x32_bf16 v[124:127], a[148:151], a[244:247], v[124:127]
    s_cmp_gt_u32 s12, s13
    s_cselect_b32 s82, s82, s12
    s_mul_i32 s82, s82, 65536
    ds_read_b128 a[136:139], v18 offset:18432
    v_mfma_f32_16x16x32_bf16 v[124:127], a[152:155], a[248:251], v[124:127]
    s_add_u32 s82, s82, s81
    v_exp_f32 v103, v103
    v_mfma_f32_16x16x32_bf16 v[124:127], a[156:159], a[252:255], v[124:127]
    s_cmp_ge_u32 s12, 17
    s_cselect_b32 s82, 2147471360, s82
    ds_read_b128 a[140:143], v18 offset:19456
    v_cvt_pk_bf16_f32 v51, v102, v103
    v_mfma_f32_16x16x32_bf16 v[40:43], v[28:31], v[56:59], v[40:43]
    s_add_u32 s12, s12, 1
    v_exp_f32 v104, v104
    v_mfma_f32_16x16x32_bf16 v[44:47], v[28:31], v[60:63], v[44:47]
    ds_read_b128 a[144:147], v18 offset:20480
    v_bfe_u32 v4, v2, 1, 2
    v_mfma_f32_16x16x32_bf16 v[192:195], a[160:163], v[56:59], v[192:195]
    v_exp_f32 v105, v105
    v_mfma_f32_16x16x32_bf16 v[224:227], a[160:163], v[60:63], v[224:227]
    ds_read_b128 a[148:151], v18 offset:21504
    v_cvt_pk_bf16_f32 v52, v104, v105
    v_mfma_f32_16x16x32_bf16 v[196:199], a[164:167], v[56:59], v[196:199]
    v_exp_f32 v106, v106
    v_mfma_f32_16x16x32_bf16 v[228:231], a[164:167], v[60:63], v[228:231]
    ds_read_b128 a[152:155], v18 offset:22528
    v_lshlrev_b32 v4, 11, v4
    v_mfma_f32_16x16x32_bf16 v[200:203], a[168:171], v[56:59], v[200:203]
    v_exp_f32 v107, v107
    v_mfma_f32_16x16x32_bf16 v[232:235], a[168:171], v[60:63], v[232:235]
    ds_read_b128 a[156:159], v18 offset:23552
    v_cvt_pk_bf16_f32 v53, v106, v107
    v_mfma_f32_16x16x32_bf16 v[204:207], a[172:175], v[56:59], v[204:207]
    v_exp_f32 v108, v108
    v_mfma_f32_16x16x32_bf16 v[236:239], a[172:175], v[60:63], v[236:239]
    buffer_store_dwordx4 v[24:27], v17, s[8:11], s27 offen offset:512 sc0 sc1
    v_mfma_f32_16x16x32_bf16 v[208:211], a[176:179], v[56:59], v[208:211]
    s_add_u32 s27, s18, 8519680
    v_exp_f32 v109, v109
    v_mfma_f32_16x16x32_bf16 v[240:243], a[176:179], v[60:63], v[240:243]
    v_cvt_pk_bf16_f32 v54, v108, v109
    v_xor_b32 v18, 196608, v18
    v_mfma_f32_16x16x32_bf16 v[212:215], a[180:183], v[56:59], v[212:215]
    v_exp_f32 v110, v110
    v_mfma_f32_16x16x32_bf16 v[244:247], a[180:183], v[60:63], v[244:247]
    buffer_store_dwordx4 v[24:27], v17, s[8:11], s27 offen offset:512 sc0 sc1
    v_mfma_f32_16x16x32_bf16 v[216:219], a[184:187], v[56:59], v[216:219]
    v_exp_f32 v111, v111
    v_mfma_f32_16x16x32_bf16 v[248:251], a[184:187], v[60:63], v[248:251]
    v_cvt_pk_bf16_f32 v55, v110, v111
    v_lshl_add_u32 v4, v10, 6, v4
    v_mfma_f32_16x16x32_bf16 v[220:223], a[188:191], v[56:59], v[220:223]
    v_add_u32 v9, 7168, v8
    v_add_u32 v10, 14336, v8
    v_mfma_f32_16x16x32_bf16 v[252:255], a[188:191], v[60:63], v[252:255]
    v_add_u32 v11, 21504, v8
    s_waitcnt vmcnt(9) lgkmcnt(0)
    s_barrier
    v_mfma_f32_16x16x32_bf16 v[96:99], a[128:131], a[192:195], v[64:67]
    s_add_u32 m0, s15, 0
    ds_read_b128 a[160:163], v19 offset:0
    v_mfma_f32_16x16x32_bf16 v[96:99], a[132:135], a[196:199], v[96:99]
    ds_read_b128 a[164:167], v19 offset:1024
    v_mfma_f32_16x16x32_bf16 v[96:99], a[136:139], a[200:203], v[96:99]
    v_exp_f32 v112, v112
    v_mfma_f32_16x16x32_bf16 v[96:99], a[140:143], a[204:207], v[96:99]
    buffer_load_dwordx4 v1, s[8:11], s82 offen offset:0  lds
    v_mfma_f32_16x16x32_bf16 v[104:107], a[128:131], a[208:211], v[68:71]
    v_exp_f32 v113, v113
    v_mfma_f32_16x16x32_bf16 v[104:107], a[132:135], a[212:215], v[104:107]
    ds_read_b128 a[168:171], v19 offset:2048
    v_cvt_pk_bf16_f32 v56, v112, v113
    v_mfma_f32_16x16x32_bf16 v[104:107], a[136:139], a[216:219], v[104:107]
    v_exp_f32 v114, v114
    v_mfma_f32_16x16x32_bf16 v[104:107], a[140:143], a[220:223], v[104:107]
    buffer_load_dwordx4 v1, s[8:11], s82 offen offset:1024  lds
    v_mfma_f32_16x16x32_bf16 v[100:103], a[144:147], a[192:195], v[64:67]
    v_exp_f32 v115, v115
    v_mfma_f32_16x16x32_bf16 v[100:103], a[148:151], a[196:199], v[100:103]
    ds_read_b128 a[172:175], v19 offset:3072
    v_cvt_pk_bf16_f32 v57, v114, v115
    v_mfma_f32_16x16x32_bf16 v[100:103], a[152:155], a[200:203], v[100:103]
    v_exp_f32 v116, v116
    v_mfma_f32_16x16x32_bf16 v[100:103], a[156:159], a[204:207], v[100:103]
    buffer_load_dwordx4 v1, s[8:11], s82 offen offset:2048  lds
    v_mfma_f32_16x16x32_bf16 v[108:111], a[144:147], a[208:211], v[68:71]
    v_exp_f32 v117, v117
    v_mfma_f32_16x16x32_bf16 v[108:111], a[148:151], a[212:215], v[108:111]
    ds_read_b128 a[176:179], v20 offset:4096
    v_cvt_pk_bf16_f32 v58, v116, v117
    v_mfma_f32_16x16x32_bf16 v[108:111], a[152:155], a[216:219], v[108:111]
    v_exp_f32 v118, v118
    v_mfma_f32_16x16x32_bf16 v[108:111], a[156:159], a[220:223], v[108:111]
    buffer_load_dwordx4 v1, s[8:11], s82 offen offset:3072  lds
    v_mfma_f32_16x16x32_bf16 v[32:35], v[28:31], v[48:51], v[32:35]
    s_add_u32 m0, s15, 4096
    v_exp_f32 v119, v119
    v_mfma_f32_16x16x32_bf16 v[36:39], v[28:31], v[52:55], v[36:39]
    s_waitcnt lgkmcnt(4)
    ds_read_b128 a[180:183], v20 offset:5120
    v_cvt_pk_bf16_f32 v59, v118, v119
    v_mfma_f32_16x16x32_bf16 v[128:131], a[160:163], v[48:51], v[128:131]
    v_exp_f32 v120, v120
    v_mfma_f32_16x16x32_bf16 v[160:163], a[160:163], v[52:55], v[160:163]
    s_waitcnt lgkmcnt(4)
    v_mfma_f32_16x16x32_bf16 v[132:135], a[164:167], v[48:51], v[132:135]
    v_exp_f32 v121, v121
    v_mfma_f32_16x16x32_bf16 v[164:167], a[164:167], v[52:55], v[164:167]
    s_waitcnt lgkmcnt(3)
    ds_read_b128 a[184:187], v20 offset:6144
    v_cvt_pk_bf16_f32 v60, v120, v121
    v_mfma_f32_16x16x32_bf16 v[136:139], a[168:171], v[48:51], v[136:139]
    s_waitcnt lgkmcnt(3)
    v_exp_f32 v122, v122
    v_mfma_f32_16x16x32_bf16 v[168:171], a[168:171], v[52:55], v[168:171]
    buffer_load_dwordx4 v15, s[8:11], s82 offen offset:0  lds
    v_mfma_f32_16x16x32_bf16 v[140:143], a[172:175], v[48:51], v[140:143]
    v_exp_f32 v123, v123
    v_mfma_f32_16x16x32_bf16 v[172:175], a[172:175], v[52:55], v[172:175]
    s_waitcnt lgkmcnt(2)
    ds_read_b128 a[188:191], v20 offset:7168
    v_cvt_pk_bf16_f32 v61, v122, v123
    v_mfma_f32_16x16x32_bf16 v[144:147], a[176:179], v[48:51], v[144:147]
    s_waitcnt lgkmcnt(2)
    v_exp_f32 v124, v124
    v_mfma_f32_16x16x32_bf16 v[176:179], a[176:179], v[52:55], v[176:179]
    buffer_load_dwordx4 v15, s[8:11], s82 offen offset:1024  lds
    v_mfma_f32_16x16x32_bf16 v[148:151], a[180:183], v[48:51], v[148:151]
    v_exp_f32 v125, v125
    v_mfma_f32_16x16x32_bf16 v[180:183], a[180:183], v[52:55], v[180:183]
    s_waitcnt lgkmcnt(1)
    v_cvt_pk_bf16_f32 v62, v124, v125
    v_mfma_f32_16x16x32_bf16 v[152:155], a[184:187], v[48:51], v[152:155]
    s_waitcnt lgkmcnt(0)
    v_exp_f32 v126, v126
    v_mfma_f32_16x16x32_bf16 v[184:187], a[184:187], v[52:55], v[184:187]
    buffer_load_dwordx4 v15, s[8:11], s82 offen offset:2048  lds
    v_mfma_f32_16x16x32_bf16 v[156:159], a[188:191], v[48:51], v[156:159]
    v_exp_f32 v127, v127
    v_mfma_f32_16x16x32_bf16 v[188:191], a[188:191], v[52:55], v[188:191]
    v_cvt_pk_bf16_f32 v63, v126, v127
    v_mfma_f32_16x16x32_bf16 v[112:115], a[128:131], a[224:227], v[72:75]
    v_mfma_f32_16x16x32_bf16 v[112:115], a[132:135], a[228:231], v[112:115]
    v_mfma_f32_16x16x32_bf16 v[112:115], a[136:139], a[232:235], v[112:115]
    v_exp_f32 v96, v96
    v_mfma_f32_16x16x32_bf16 v[112:115], a[140:143], a[236:239], v[112:115]
    buffer_load_dwordx4 v15, s[8:11], s82 offen offset:3072  lds
    v_mfma_f32_16x16x32_bf16 v[120:123], a[128:131], a[240:243], v[76:79]
    s_xor_b32 s15, s15, 196608
    v_exp_f32 v97, v97
    v_mfma_f32_16x16x32_bf16 v[120:123], a[132:135], a[244:247], v[120:123]
    s_add_u32 m0, s16, 0
    ds_read_b128 a[128:131], v18 offset:0
    v_cvt_pk_bf16_f32 v48, v96, v97
    v_mfma_f32_16x16x32_bf16 v[120:123], a[136:139], a[248:251], v[120:123]
    v_exp_f32 v98, v98
    v_mfma_f32_16x16x32_bf16 v[120:123], a[140:143], a[252:255], v[120:123]
    buffer_load_dwordx4 v1, s[8:11], s19 offen offset:0  lds
    v_mfma_f32_16x16x32_bf16 v[116:119], a[144:147], a[224:227], v[72:75]
    v_exp_f32 v99, v99
    v_mfma_f32_16x16x32_bf16 v[116:119], a[148:151], a[228:231], v[116:119]
    ds_read_b128 a[132:135], v18 offset:1024
    v_cvt_pk_bf16_f32 v49, v98, v99
    v_mfma_f32_16x16x32_bf16 v[116:119], a[152:155], a[232:235], v[116:119]
    v_exp_f32 v100, v100
    v_mfma_f32_16x16x32_bf16 v[116:119], a[156:159], a[236:239], v[116:119]
    buffer_load_dwordx4 v1, s[8:11], s19 offen offset:1024  lds
    v_mfma_f32_16x16x32_bf16 v[124:127], a[144:147], a[240:243], v[76:79]
    v_exp_f32 v101, v101
    v_mfma_f32_16x16x32_bf16 v[124:127], a[148:151], a[244:247], v[124:127]
    ds_read_b128 a[136:139], v18 offset:2048
    v_cvt_pk_bf16_f32 v50, v100, v101
    v_mfma_f32_16x16x32_bf16 v[124:127], a[152:155], a[248:251], v[124:127]
    v_exp_f32 v102, v102
    v_mfma_f32_16x16x32_bf16 v[124:127], a[156:159], a[252:255], v[124:127]
    buffer_load_dwordx4 v1, s[8:11], s19 offen offset:2048  lds
    v_mfma_f32_16x16x32_bf16 v[40:43], v[28:31], v[56:59], v[40:43]
    v_exp_f32 v103, v103
    v_mfma_f32_16x16x32_bf16 v[44:47], v[28:31], v[60:63], v[44:47]
    ds_read_b128 a[140:143], v18 offset:3072
    v_cvt_pk_bf16_f32 v51, v102, v103
    v_mfma_f32_16x16x32_bf16 v[192:195], a[160:163], v[56:59], v[192:195]
    v_exp_f32 v104, v104
    v_mfma_f32_16x16x32_bf16 v[224:227], a[160:163], v[60:63], v[224:227]
    v_mfma_f32_16x16x32_bf16 v[196:199], a[164:167], v[56:59], v[196:199]
    v_exp_f32 v105, v105
    v_mfma_f32_16x16x32_bf16 v[228:231], a[164:167], v[60:63], v[228:231]
    ds_read_b128 a[144:147], v18 offset:4096
    v_cvt_pk_bf16_f32 v52, v104, v105
    v_mfma_f32_16x16x32_bf16 v[200:203], a[168:171], v[56:59], v[200:203]
    v_exp_f32 v106, v106
    v_mfma_f32_16x16x32_bf16 v[232:235], a[168:171], v[60:63], v[232:235]
    buffer_load_dwordx4 v1, s[8:11], s19 offen offset:3072  lds
    v_mfma_f32_16x16x32_bf16 v[204:207], a[172:175], v[56:59], v[204:207]
    s_add_u32 m0, s16, 4096
    v_exp_f32 v107, v107
    v_mfma_f32_16x16x32_bf16 v[236:239], a[172:175], v[60:63], v[236:239]
    ds_read_b128 a[148:151], v18 offset:5120
    v_cvt_pk_bf16_f32 v53, v106, v107
    v_mfma_f32_16x16x32_bf16 v[208:211], a[176:179], v[56:59], v[208:211]
    v_exp_f32 v108, v108
    v_mfma_f32_16x16x32_bf16 v[240:243], a[176:179], v[60:63], v[240:243]
    buffer_load_dwordx4 v15, s[8:11], s19 offen offset:0  lds
    v_mfma_f32_16x16x32_bf16 v[212:215], a[180:183], v[56:59], v[212:215]
    v_exp_f32 v109, v109
    v_mfma_f32_16x16x32_bf16 v[244:247], a[180:183], v[60:63], v[244:247]
    ds_read_b128 a[152:155], v18 offset:6144
    v_cvt_pk_bf16_f32 v54, v108, v109
    v_mfma_f32_16x16x32_bf16 v[216:219], a[184:187], v[56:59], v[216:219]
    v_exp_f32 v110, v110
    v_mfma_f32_16x16x32_bf16 v[248:251], a[184:187], v[60:63], v[248:251]
    buffer_load_dwordx4 v15, s[8:11], s19 offen offset:1024  lds
    v_mfma_f32_16x16x32_bf16 v[220:223], a[188:191], v[56:59], v[220:223]
    v_exp_f32 v111, v111
    v_mfma_f32_16x16x32_bf16 v[252:255], a[188:191], v[60:63], v[252:255]
    ds_read_b128 a[156:159], v18 offset:7168
    v_cvt_pk_bf16_f32 v55, v110, v111
    s_waitcnt lgkmcnt(7)
    v_mfma_f32_16x16x32_bf16 v[96:99], a[128:131], a[192:195], v[64:67]
    s_waitcnt lgkmcnt(6)
    s_mul_i32 s17, s4, 229376
    s_mul_i32 s100, s3, 7168
    ds_read_b128 a[160:163], v19 offset:16384
    v_mfma_f32_16x16x32_bf16 v[96:99], a[132:135], a[196:199], v[96:99]
    s_waitcnt lgkmcnt(6)
    s_add_u32 s17, s17, s100
    s_lshl_b32 s100, s101, 7
    ds_read_b128 a[164:167], v19 offset:17408
    v_mfma_f32_16x16x32_bf16 v[96:99], a[136:139], a[200:203], v[96:99]
    s_waitcnt lgkmcnt(6)
    s_add_u32 s17, s17, s100
    v_exp_f32 v112, v112
    v_mfma_f32_16x16x32_bf16 v[96:99], a[140:143], a[204:207], v[96:99]
    buffer_load_dwordx4 v15, s[8:11], s19 offen offset:2048  lds
    v_mfma_f32_16x16x32_bf16 v[104:107], a[128:131], a[208:211], v[68:71]
    s_add_u32 s17, s17, 8388608
    v_exp_f32 v113, v113
    v_mfma_f32_16x16x32_bf16 v[104:107], a[132:135], a[212:215], v[104:107]
    s_cmp_lt_u32 s101, s26
    s_cselect_b32 s17, s17, 2147479552
    ds_read_b128 a[168:171], v19 offset:18432
    v_cvt_pk_bf16_f32 v56, v112, v113
    v_mfma_f32_16x16x32_bf16 v[104:107], a[136:139], a[216:219], v[104:107]
    s_waitcnt lgkmcnt(6)
    v_exp_f32 v114, v114
    v_mfma_f32_16x16x32_bf16 v[104:107], a[140:143], a[220:223], v[104:107]
    buffer_load_dwordx4 v15, s[8:11], s19 offen offset:3072  lds
    v_mfma_f32_16x16x32_bf16 v[100:103], a[144:147], a[192:195], v[64:67]
    s_waitcnt lgkmcnt(5)
    s_xor_b32 s16, s16, 98304
    v_exp_f32 v115, v115
    v_mfma_f32_16x16x32_bf16 v[100:103], a[148:151], a[196:199], v[100:103]
    s_waitcnt lgkmcnt(4)
    ds_read_b128 a[172:175], v19 offset:19456
    v_cvt_pk_bf16_f32 v57, v114, v115
    v_mfma_f32_16x16x32_bf16 v[100:103], a[152:155], a[200:203], v[100:103]
    s_waitcnt lgkmcnt(4)
    v_exp_f32 v116, v116
    v_mfma_f32_16x16x32_bf16 v[100:103], a[156:159], a[204:207], v[100:103]
    buffer_store_dwordx4 a[16:19], v13, s[8:11], s17 offen sc0 sc1
    v_mfma_f32_16x16x32_bf16 v[108:111], a[144:147], a[208:211], v[68:71]
    s_add_u32 s27, s18, 8388608
    v_exp_f32 v117, v117
    v_mfma_f32_16x16x32_bf16 v[108:111], a[148:151], a[212:215], v[108:111]
    ds_read_b128 a[176:179], v20 offset:20480
    v_cvt_pk_bf16_f32 v58, v116, v117
    v_mfma_f32_16x16x32_bf16 v[108:111], a[152:155], a[216:219], v[108:111]
    v_exp_f32 v118, v118
    v_mfma_f32_16x16x32_bf16 v[108:111], a[156:159], a[220:223], v[108:111]
    buffer_store_dwordx4 v[24:27], v17, s[8:11], s27 offen offset:768 sc0 sc1
    v_mfma_f32_16x16x32_bf16 v[32:35], v[28:31], v[48:51], v[32:35]
    s_add_u32 s27, s18, 8519680
    v_exp_f32 v119, v119
    v_mfma_f32_16x16x32_bf16 v[36:39], v[28:31], v[52:55], v[36:39]
    s_waitcnt lgkmcnt(4)
    ds_read_b128 a[180:183], v20 offset:21504
    v_cvt_pk_bf16_f32 v59, v118, v119
    v_mfma_f32_16x16x32_bf16 v[128:131], a[160:163], v[48:51], v[128:131]
    s_waitcnt lgkmcnt(4)
    v_exp_f32 v120, v120
    v_mfma_f32_16x16x32_bf16 v[160:163], a[160:163], v[52:55], v[160:163]
    buffer_store_dwordx4 v[24:27], v17, s[8:11], s27 offen offset:768 sc0 sc1
    v_mfma_f32_16x16x32_bf16 v[132:135], a[164:167], v[48:51], v[132:135]
    v_exp_f32 v121, v121
    v_mfma_f32_16x16x32_bf16 v[164:167], a[164:167], v[52:55], v[164:167]
    s_waitcnt lgkmcnt(3)
    ds_read_b128 a[184:187], v20 offset:22528
    v_cvt_pk_bf16_f32 v60, v120, v121
    v_mfma_f32_16x16x32_bf16 v[136:139], a[168:171], v[48:51], v[136:139]
    s_waitcnt lgkmcnt(3)
    v_exp_f32 v122, v122
    v_mfma_f32_16x16x32_bf16 v[168:171], a[168:171], v[52:55], v[168:171]
    buffer_load_dword v3, v4, s[8:11], s23 offen sc0 sc1
    v_mfma_f32_16x16x32_bf16 v[140:143], a[172:175], v[48:51], v[140:143]
    v_exp_f32 v123, v123
    v_mfma_f32_16x16x32_bf16 v[172:175], a[172:175], v[52:55], v[172:175]
    s_waitcnt lgkmcnt(2)
    ds_read_b128 a[188:191], v20 offset:23552
    v_cvt_pk_bf16_f32 v61, v122, v123
    v_mfma_f32_16x16x32_bf16 v[144:147], a[176:179], v[48:51], v[144:147]
    v_exp_f32 v124, v124
    v_mfma_f32_16x16x32_bf16 v[176:179], a[176:179], v[52:55], v[176:179]
    s_waitcnt lgkmcnt(2)
    v_mfma_f32_16x16x32_bf16 v[148:151], a[180:183], v[48:51], v[148:151]
    v_exp_f32 v125, v125
    v_mfma_f32_16x16x32_bf16 v[180:183], a[180:183], v[52:55], v[180:183]
    s_waitcnt lgkmcnt(1)
    v_cvt_pk_bf16_f32 v62, v124, v125
    v_xor_b32 v19, 98304, v19
    v_mfma_f32_16x16x32_bf16 v[152:155], a[184:187], v[48:51], v[152:155]
    v_exp_f32 v126, v126
    v_mfma_f32_16x16x32_bf16 v[184:187], a[184:187], v[52:55], v[184:187]
    s_waitcnt lgkmcnt(0)
    v_xor_b32 v20, 98304, v20
    v_mfma_f32_16x16x32_bf16 v[156:159], a[188:191], v[48:51], v[156:159]
    v_exp_f32 v127, v127
    v_mfma_f32_16x16x32_bf16 v[188:191], a[188:191], v[52:55], v[188:191]
    v_cvt_pk_bf16_f32 v63, v126, v127
    v_mfma_f32_16x16x32_bf16 v[112:115], a[128:131], a[224:227], v[72:75]
    v_exp_f32 v96, v96
    v_mfma_f32_16x16x32_bf16 v[112:115], a[132:135], a[228:231], v[112:115]
    buffer_store_dwordx4 a[20:23], v13, s[8:11], s17 offen offset:3584 sc0 sc1
    v_mfma_f32_16x16x32_bf16 v[112:115], a[136:139], a[232:235], v[112:115]
    v_exp_f32 v97, v97
    v_mfma_f32_16x16x32_bf16 v[112:115], a[140:143], a[236:239], v[112:115]
    v_cvt_pk_bf16_f32 v48, v96, v97
    v_lshlrev_b32 v12, 3, v0
    v_mfma_f32_16x16x32_bf16 v[120:123], a[128:131], a[240:243], v[76:79]
    s_lshl_b32 s101, s2, 11
    v_exp_f32 v98, v98
    v_mfma_f32_16x16x32_bf16 v[120:123], a[132:135], a[244:247], v[120:123]
    v_add_f32 v80, 0, v21
    v_min_f32 v80, v80, v64
    v_mfma_f32_16x16x32_bf16 v[120:123], a[136:139], a[248:251], v[120:123]
    s_add_u32 s101, s101, 524288
    v_exp_f32 v99, v99
    v_mfma_f32_16x16x32_bf16 v[120:123], a[140:143], a[252:255], v[120:123]
    buffer_store_dwordx2 v[24:25], v12, s[8:11], s101 offen sc0 sc1
    v_mfma_f32_16x16x32_bf16 v[116:119], a[144:147], a[224:227], v[72:75]
    s_lshl_b32 s101, s2, 6
    v_exp_f32 v100, v100
    v_mfma_f32_16x16x32_bf16 v[116:119], a[148:151], a[228:231], v[116:119]
    s_add_u32 s101, s101, 65536
    ds_read_b128 a[128:131], v18 offset:16384
    v_cvt_pk_bf16_f32 v49, v98, v99
    v_mfma_f32_16x16x32_bf16 v[116:119], a[152:155], a[232:235], v[116:119]
    s_add_u32 s19, s82, 32768
    v_exp_f32 v101, v101
    v_mfma_f32_16x16x32_bf16 v[116:119], a[156:159], a[236:239], v[116:119]
    s_sub_u32 s82, s12, s13
    ds_read_b128 a[132:135], v18 offset:17408
    v_cvt_pk_bf16_f32 v50, v100, v101
    v_mfma_f32_16x16x32_bf16 v[124:127], a[144:147], a[240:243], v[76:79]
    s_sub_u32 s82, s82, 1
    v_exp_f32 v102, v102
    v_mfma_f32_16x16x32_bf16 v[124:127], a[148:151], a[244:247], v[124:127]
    s_cmp_gt_u32 s12, s13
    s_cselect_b32 s82, s82, s12
    s_mul_i32 s82, s82, 65536
    ds_read_b128 a[136:139], v18 offset:18432
    v_mfma_f32_16x16x32_bf16 v[124:127], a[152:155], a[248:251], v[124:127]
    s_add_u32 s82, s82, s81
    v_exp_f32 v103, v103
    v_mfma_f32_16x16x32_bf16 v[124:127], a[156:159], a[252:255], v[124:127]
    s_cmp_ge_u32 s12, 17
    s_cselect_b32 s82, 2147471360, s82
    ds_read_b128 a[140:143], v18 offset:19456
    v_cvt_pk_bf16_f32 v51, v102, v103
    v_mfma_f32_16x16x32_bf16 v[40:43], v[28:31], v[56:59], v[40:43]
    s_add_u32 s12, s12, 1
    v_exp_f32 v104, v104
    v_mfma_f32_16x16x32_bf16 v[44:47], v[28:31], v[60:63], v[44:47]
    ds_read_b128 a[144:147], v18 offset:20480
    v_mov_b32 v13, 0
    v_mfma_f32_16x16x32_bf16 v[192:195], a[160:163], v[56:59], v[192:195]
    v_exp_f32 v105, v105
    v_mfma_f32_16x16x32_bf16 v[224:227], a[160:163], v[60:63], v[224:227]
    ds_read_b128 a[148:151], v18 offset:21504
    v_cvt_pk_bf16_f32 v52, v104, v105
    v_mfma_f32_16x16x32_bf16 v[196:199], a[164:167], v[56:59], v[196:199]
    v_exp_f32 v106, v106
    v_mfma_f32_16x16x32_bf16 v[228:231], a[164:167], v[60:63], v[228:231]
    ds_read_b128 a[152:155], v18 offset:22528
    v_add_f32 v81, 0xf1800000, v21
    v_mfma_f32_16x16x32_bf16 v[200:203], a[168:171], v[56:59], v[200:203]
    v_exp_f32 v107, v107
    v_mfma_f32_16x16x32_bf16 v[232:235], a[168:171], v[60:63], v[232:235]
    ds_read_b128 a[156:159], v18 offset:23552
    v_cvt_pk_bf16_f32 v53, v106, v107
    v_mfma_f32_16x16x32_bf16 v[204:207], a[172:175], v[56:59], v[204:207]
    v_exp_f32 v108, v108
    v_mfma_f32_16x16x32_bf16 v[236:239], a[172:175], v[60:63], v[236:239]
    buffer_store_dword v13, v7, s[8:11], s101 offen sc0 sc1
    v_mfma_f32_16x16x32_bf16 v[208:211], a[176:179], v[56:59], v[208:211]
    s_lshl_b32 s101, s66, 6
    v_exp_f32 v109, v109
    v_mfma_f32_16x16x32_bf16 v[240:243], a[176:179], v[60:63], v[240:243]
    s_add_u32 s101, s101, 81920
    v_cvt_pk_bf16_f32 v54, v108, v109
    v_xor_b32 v18, 196608, v18
    v_mfma_f32_16x16x32_bf16 v[212:215], a[180:183], v[56:59], v[212:215]
    v_exp_f32 v110, v110
    v_mfma_f32_16x16x32_bf16 v[244:247], a[180:183], v[60:63], v[244:247]
    buffer_store_dwordx4 v[24:27], v7, s[8:11], s101 offen sc0 sc1
    v_mfma_f32_16x16x32_bf16 v[216:219], a[184:187], v[56:59], v[216:219]
    v_exp_f32 v111, v111
    v_mfma_f32_16x16x32_bf16 v[248:251], a[184:187], v[60:63], v[248:251]
    v_cvt_pk_bf16_f32 v55, v110, v111
    v_min_f32 v81, v81, v65
    v_mfma_f32_16x16x32_bf16 v[220:223], a[188:191], v[56:59], v[220:223]
    buffer_store_dwordx4 v[24:27], v7, s[8:11], s101 offen offset:16 sc0 sc1
    v_mfma_f32_16x16x32_bf16 v[252:255], a[188:191], v[60:63], v[252:255]
    v_add_f32 v82, 0xf2000000, v21
    v_min_f32 v82, v82, v66
    s_waitcnt vmcnt(9) lgkmcnt(0)
    s_barrier
    v_mfma_f32_16x16x32_bf16 v[96:99], a[128:131], a[192:195], v[64:67]
    s_add_u32 m0, s15, 0
    ds_read_b128 a[160:163], v19 offset:0
    v_mfma_f32_16x16x32_bf16 v[96:99], a[132:135], a[196:199], v[96:99]
    ds_read_b128 a[164:167], v19 offset:1024
    v_mfma_f32_16x16x32_bf16 v[96:99], a[136:139], a[200:203], v[96:99]
    v_exp_f32 v112, v112
    v_mfma_f32_16x16x32_bf16 v[96:99], a[140:143], a[204:207], v[96:99]
    buffer_load_dwordx4 v1, s[8:11], s82 offen offset:0  lds
    v_mfma_f32_16x16x32_bf16 v[104:107], a[128:131], a[208:211], v[68:71]
    v_exp_f32 v113, v113
    v_mfma_f32_16x16x32_bf16 v[104:107], a[132:135], a[212:215], v[104:107]
    ds_read_b128 a[168:171], v19 offset:2048
    v_cvt_pk_bf16_f32 v56, v112, v113
    v_mfma_f32_16x16x32_bf16 v[104:107], a[136:139], a[216:219], v[104:107]
    v_exp_f32 v114, v114
    v_mfma_f32_16x16x32_bf16 v[104:107], a[140:143], a[220:223], v[104:107]
    buffer_load_dwordx4 v1, s[8:11], s82 offen offset:1024  lds
    v_mfma_f32_16x16x32_bf16 v[100:103], a[144:147], a[192:195], v[64:67]
    v_exp_f32 v115, v115
    v_mfma_f32_16x16x32_bf16 v[100:103], a[148:151], a[196:199], v[100:103]
    ds_read_b128 a[172:175], v19 offset:3072
    v_cvt_pk_bf16_f32 v57, v114, v115
    v_mfma_f32_16x16x32_bf16 v[100:103], a[152:155], a[200:203], v[100:103]
    v_exp_f32 v116, v116
    v_mfma_f32_16x16x32_bf16 v[100:103], a[156:159], a[204:207], v[100:103]
    buffer_load_dwordx4 v1, s[8:11], s82 offen offset:2048  lds
    v_mfma_f32_16x16x32_bf16 v[108:111], a[144:147], a[208:211], v[68:71]
    v_exp_f32 v117, v117
    v_mfma_f32_16x16x32_bf16 v[108:111], a[148:151], a[212:215], v[108:111]
    ds_read_b128 a[176:179], v20 offset:4096
    v_cvt_pk_bf16_f32 v58, v116, v117
    v_mfma_f32_16x16x32_bf16 v[108:111], a[152:155], a[216:219], v[108:111]
    v_exp_f32 v118, v118
    v_mfma_f32_16x16x32_bf16 v[108:111], a[156:159], a[220:223], v[108:111]
    buffer_load_dwordx4 v1, s[8:11], s82 offen offset:3072  lds
    v_mfma_f32_16x16x32_bf16 v[32:35], v[28:31], v[48:51], v[32:35]
    s_add_u32 m0, s15, 4096
    v_exp_f32 v119, v119
    v_mfma_f32_16x16x32_bf16 v[36:39], v[28:31], v[52:55], v[36:39]
    s_waitcnt lgkmcnt(4)
    ds_read_b128 a[180:183], v20 offset:5120
    v_cvt_pk_bf16_f32 v59, v118, v119
    v_mfma_f32_16x16x32_bf16 v[128:131], a[160:163], v[48:51], v[128:131]
    v_exp_f32 v120, v120
    v_mfma_f32_16x16x32_bf16 v[160:163], a[160:163], v[52:55], v[160:163]
    s_waitcnt lgkmcnt(4)
    v_mfma_f32_16x16x32_bf16 v[132:135], a[164:167], v[48:51], v[132:135]
    v_exp_f32 v121, v121
    v_mfma_f32_16x16x32_bf16 v[164:167], a[164:167], v[52:55], v[164:167]
    s_waitcnt lgkmcnt(3)
    ds_read_b128 a[184:187], v20 offset:6144
    v_cvt_pk_bf16_f32 v60, v120, v121
    v_mfma_f32_16x16x32_bf16 v[136:139], a[168:171], v[48:51], v[136:139]
    s_waitcnt lgkmcnt(3)
    v_exp_f32 v122, v122
    v_mfma_f32_16x16x32_bf16 v[168:171], a[168:171], v[52:55], v[168:171]
    buffer_load_dwordx4 v15, s[8:11], s82 offen offset:0  lds
    v_mfma_f32_16x16x32_bf16 v[140:143], a[172:175], v[48:51], v[140:143]
    v_exp_f32 v123, v123
    v_mfma_f32_16x16x32_bf16 v[172:175], a[172:175], v[52:55], v[172:175]
    s_waitcnt lgkmcnt(2)
    ds_read_b128 a[188:191], v20 offset:7168
    v_cvt_pk_bf16_f32 v61, v122, v123
    v_mfma_f32_16x16x32_bf16 v[144:147], a[176:179], v[48:51], v[144:147]
    s_waitcnt lgkmcnt(2)
    v_exp_f32 v124, v124
    v_mfma_f32_16x16x32_bf16 v[176:179], a[176:179], v[52:55], v[176:179]
    buffer_load_dwordx4 v15, s[8:11], s82 offen offset:1024  lds
    v_mfma_f32_16x16x32_bf16 v[148:151], a[180:183], v[48:51], v[148:151]
    v_exp_f32 v125, v125
    v_mfma_f32_16x16x32_bf16 v[180:183], a[180:183], v[52:55], v[180:183]
    s_waitcnt lgkmcnt(1)
    v_cvt_pk_bf16_f32 v62, v124, v125
    v_mfma_f32_16x16x32_bf16 v[152:155], a[184:187], v[48:51], v[152:155]
    s_waitcnt lgkmcnt(0)
    v_exp_f32 v126, v126
    v_mfma_f32_16x16x32_bf16 v[184:187], a[184:187], v[52:55], v[184:187]
    buffer_load_dwordx4 v15, s[8:11], s82 offen offset:2048  lds
    v_mfma_f32_16x16x32_bf16 v[156:159], a[188:191], v[48:51], v[156:159]
    v_exp_f32 v127, v127
    v_mfma_f32_16x16x32_bf16 v[188:191], a[188:191], v[52:55], v[188:191]
    v_cvt_pk_bf16_f32 v63, v126, v127
    v_mfma_f32_16x16x32_bf16 v[112:115], a[128:131], a[224:227], v[72:75]
    v_mfma_f32_16x16x32_bf16 v[112:115], a[132:135], a[228:231], v[112:115]
    v_mfma_f32_16x16x32_bf16 v[112:115], a[136:139], a[232:235], v[112:115]
    v_exp_f32 v96, v96
    v_mfma_f32_16x16x32_bf16 v[112:115], a[140:143], a[236:239], v[112:115]
    buffer_load_dwordx4 v15, s[8:11], s82 offen offset:3072  lds
    v_mfma_f32_16x16x32_bf16 v[120:123], a[128:131], a[240:243], v[76:79]
    s_xor_b32 s15, s15, 196608
    v_exp_f32 v97, v97
    v_mfma_f32_16x16x32_bf16 v[120:123], a[132:135], a[244:247], v[120:123]
    s_add_u32 m0, s16, 0
    ds_read_b128 a[128:131], v18 offset:0
    v_cvt_pk_bf16_f32 v48, v96, v97
    v_mfma_f32_16x16x32_bf16 v[120:123], a[136:139], a[248:251], v[120:123]
    v_exp_f32 v98, v98
    v_mfma_f32_16x16x32_bf16 v[120:123], a[140:143], a[252:255], v[120:123]
    buffer_load_dwordx4 v1, s[8:11], s19 offen offset:0  lds
    v_mfma_f32_16x16x32_bf16 v[116:119], a[144:147], a[224:227], v[72:75]
    v_exp_f32 v99, v99
    v_mfma_f32_16x16x32_bf16 v[116:119], a[148:151], a[228:231], v[116:119]
    ds_read_b128 a[132:135], v18 offset:1024
    v_cvt_pk_bf16_f32 v49, v98, v99
    v_mfma_f32_16x16x32_bf16 v[116:119], a[152:155], a[232:235], v[116:119]
    v_exp_f32 v100, v100
    v_mfma_f32_16x16x32_bf16 v[116:119], a[156:159], a[236:239], v[116:119]
    buffer_load_dwordx4 v1, s[8:11], s19 offen offset:1024  lds
    v_mfma_f32_16x16x32_bf16 v[124:127], a[144:147], a[240:243], v[76:79]
    v_exp_f32 v101, v101
    v_mfma_f32_16x16x32_bf16 v[124:127], a[148:151], a[244:247], v[124:127]
    ds_read_b128 a[136:139], v18 offset:2048
    v_cvt_pk_bf16_f32 v50, v100, v101
    v_mfma_f32_16x16x32_bf16 v[124:127], a[152:155], a[248:251], v[124:127]
    v_exp_f32 v102, v102
    v_mfma_f32_16x16x32_bf16 v[124:127], a[156:159], a[252:255], v[124:127]
    buffer_load_dwordx4 v1, s[8:11], s19 offen offset:2048  lds
    v_mfma_f32_16x16x32_bf16 v[40:43], v[28:31], v[56:59], v[40:43]
    v_exp_f32 v103, v103
    v_mfma_f32_16x16x32_bf16 v[44:47], v[28:31], v[60:63], v[44:47]
    ds_read_b128 a[140:143], v18 offset:3072
    v_cvt_pk_bf16_f32 v51, v102, v103
    v_mfma_f32_16x16x32_bf16 v[192:195], a[160:163], v[56:59], v[192:195]
    v_exp_f32 v104, v104
    v_mfma_f32_16x16x32_bf16 v[224:227], a[160:163], v[60:63], v[224:227]
    v_mfma_f32_16x16x32_bf16 v[196:199], a[164:167], v[56:59], v[196:199]
    v_exp_f32 v105, v105
    v_mfma_f32_16x16x32_bf16 v[228:231], a[164:167], v[60:63], v[228:231]
    ds_read_b128 a[144:147], v18 offset:4096
    v_cvt_pk_bf16_f32 v52, v104, v105
    v_mfma_f32_16x16x32_bf16 v[200:203], a[168:171], v[56:59], v[200:203]
    v_exp_f32 v106, v106
    v_mfma_f32_16x16x32_bf16 v[232:235], a[168:171], v[60:63], v[232:235]
    buffer_load_dwordx4 v1, s[8:11], s19 offen offset:3072  lds
    v_mfma_f32_16x16x32_bf16 v[204:207], a[172:175], v[56:59], v[204:207]
    s_add_u32 m0, s16, 4096
    v_exp_f32 v107, v107
    v_mfma_f32_16x16x32_bf16 v[236:239], a[172:175], v[60:63], v[236:239]
    ds_read_b128 a[148:151], v18 offset:5120
    v_cvt_pk_bf16_f32 v53, v106, v107
    v_mfma_f32_16x16x32_bf16 v[208:211], a[176:179], v[56:59], v[208:211]
    v_exp_f32 v108, v108
    v_mfma_f32_16x16x32_bf16 v[240:243], a[176:179], v[60:63], v[240:243]
    buffer_load_dwordx4 v15, s[8:11], s19 offen offset:0  lds
    v_mfma_f32_16x16x32_bf16 v[212:215], a[180:183], v[56:59], v[212:215]
    v_exp_f32 v109, v109
    v_mfma_f32_16x16x32_bf16 v[244:247], a[180:183], v[60:63], v[244:247]
    ds_read_b128 a[152:155], v18 offset:6144
    v_cvt_pk_bf16_f32 v54, v108, v109
    v_mfma_f32_16x16x32_bf16 v[216:219], a[184:187], v[56:59], v[216:219]
    v_exp_f32 v110, v110
    v_mfma_f32_16x16x32_bf16 v[248:251], a[184:187], v[60:63], v[248:251]
    buffer_load_dwordx4 v15, s[8:11], s19 offen offset:1024  lds
    v_mfma_f32_16x16x32_bf16 v[220:223], a[188:191], v[56:59], v[220:223]
    v_exp_f32 v111, v111
    v_mfma_f32_16x16x32_bf16 v[252:255], a[188:191], v[60:63], v[252:255]
    ds_read_b128 a[156:159], v18 offset:7168
    v_cvt_pk_bf16_f32 v55, v110, v111
    s_waitcnt lgkmcnt(7)
    v_mfma_f32_16x16x32_bf16 v[96:99], a[128:131], a[192:195], v[64:67]
    s_waitcnt lgkmcnt(6)
    s_lshl_b32 s24, s60, 2
    s_add_u32 s24, s24, s3
    ds_read_b128 a[160:163], v19 offset:16384
    v_mfma_f32_16x16x32_bf16 v[96:99], a[132:135], a[196:199], v[96:99]
    s_waitcnt lgkmcnt(6)
    s_lshl_b32 s24, s24, 3
    s_add_u32 s24, s24, s4
    ds_read_b128 a[164:167], v19 offset:17408
    v_mfma_f32_16x16x32_bf16 v[96:99], a[136:139], a[200:203], v[96:99]
    s_waitcnt lgkmcnt(6)
    s_lshl_b32 s24, s24, 2
    v_exp_f32 v112, v112
    v_mfma_f32_16x16x32_bf16 v[96:99], a[140:143], a[204:207], v[96:99]
    buffer_load_dwordx4 v15, s[8:11], s19 offen offset:2048  lds
    v_mfma_f32_16x16x32_bf16 v[104:107], a[128:131], a[208:211], v[68:71]
    s_add_u32 s24, s24, s5
    v_exp_f32 v113, v113
    v_mfma_f32_16x16x32_bf16 v[104:107], a[132:135], a[212:215], v[104:107]
    s_lshl_b32 s24, s24, 13
    ds_read_b128 a[168:171], v19 offset:18432
    v_cvt_pk_bf16_f32 v56, v112, v113
    v_mfma_f32_16x16x32_bf16 v[104:107], a[136:139], a[216:219], v[104:107]
    s_waitcnt lgkmcnt(6)
    s_add_u32 s24, s24, 50331648
    v_exp_f32 v114, v114
    s_waitcnt vmcnt(20)
    v_cmp_ne_u32 vcc, 0, v3
    s_cmp_eq_u64 vcc, -1
    s_cbranch_scc0 L_C1_slow_9
L_C1_ok_10:
    v_mfma_f32_16x16x32_bf16 v[104:107], a[140:143], a[220:223], v[104:107]
    buffer_load_dwordx4 v15, s[8:11], s19 offen offset:3072  lds
    v_mfma_f32_16x16x32_bf16 v[100:103], a[144:147], a[192:195], v[64:67]
    s_waitcnt lgkmcnt(5)
    s_xor_b32 s16, s16, 98304
    v_exp_f32 v115, v115
    v_mfma_f32_16x16x32_bf16 v[100:103], a[148:151], a[196:199], v[100:103]
    s_waitcnt lgkmcnt(4)
    s_xor_b32 s74, s24, 0
    ds_read_b128 a[172:175], v19 offset:19456
    v_cvt_pk_bf16_f32 v57, v114, v115
    v_mfma_f32_16x16x32_bf16 v[100:103], a[152:155], a[200:203], v[100:103]
    s_waitcnt lgkmcnt(4)
    v_exp_f32 v116, v116
    v_mfma_f32_16x16x32_bf16 v[100:103], a[156:159], a[204:207], v[100:103]
    buffer_load_dwordx4 a[64:67], v1, s[8:11], s74 offen offset:0
    v_mfma_f32_16x16x32_bf16 v[108:111], a[144:147], a[208:211], v[68:71]
    s_xor_b32 s74, s24, 0
    v_exp_f32 v117, v117
    v_mfma_f32_16x16x32_bf16 v[108:111], a[148:151], a[212:215], v[108:111]
    ds_read_b128 a[176:179], v20 offset:20480
    v_cvt_pk_bf16_f32 v58, v116, v117
    v_mfma_f32_16x16x32_bf16 v[108:111], a[152:155], a[216:219], v[108:111]
    v_exp_f32 v118, v118
    v_mfma_f32_16x16x32_bf16 v[108:111], a[156:159], a[220:223], v[108:111]
    buffer_load_dwordx4 a[68:71], v1, s[8:11], s74 offen offset:1024
    v_mfma_f32_16x16x32_bf16 v[32:35], v[28:31], v[48:51], v[32:35]
    s_xor_b32 s74, s24, 0
    v_exp_f32 v119, v119
    v_mfma_f32_16x16x32_bf16 v[36:39], v[28:31], v[52:55], v[36:39]
    s_waitcnt lgkmcnt(4)
    ds_read_b128 a[180:183], v20 offset:21504
    v_cvt_pk_bf16_f32 v59, v118, v119
    v_mfma_f32_16x16x32_bf16 v[128:131], a[160:163], v[48:51], v[128:131]
    s_waitcnt lgkmcnt(4)
    v_exp_f32 v120, v120
    v_mfma_f32_16x16x32_bf16 v[160:163], a[160:163], v[52:55], v[160:163]
    buffer_load_dwordx4 a[72:75], v1, s[8:11], s74 offen offset:2048
    v_mfma_f32_16x16x32_bf16 v[132:135], a[164:167], v[48:51], v[132:135]
    s_xor_b32 s74, s24, 0
    v_exp_f32 v121, v121
    v_mfma_f32_16x16x32_bf16 v[164:167], a[164:167], v[52:55], v[164:167]
    s_waitcnt lgkmcnt(3)
    ds_read_b128 a[184:187], v20 offset:22528
    v_cvt_pk_bf16_f32 v60, v120, v121
    v_mfma_f32_16x16x32_bf16 v[136:139], a[168:171], v[48:51], v[136:139]
    s_waitcnt lgkmcnt(3)
    v_exp_f32 v122, v122
    v_mfma_f32_16x16x32_bf16 v[168:171], a[168:171], v[52:55], v[168:171]
    buffer_load_dwordx4 a[76:79], v1, s[8:11], s74 offen offset:3072
    v_mfma_f32_16x16x32_bf16 v[140:143], a[172:175], v[48:51], v[140:143]
    s_xor_b32 s74, s24, 4096
    v_exp_f32 v123, v123
    v_mfma_f32_16x16x32_bf16 v[172:175], a[172:175], v[52:55], v[172:175]
    s_waitcnt lgkmcnt(2)
    ds_read_b128 a[188:191], v20 offset:23552
    v_cvt_pk_bf16_f32 v61, v122, v123
    v_mfma_f32_16x16x32_bf16 v[144:147], a[176:179], v[48:51], v[144:147]
    s_waitcnt lgkmcnt(2)
    v_exp_f32 v124, v124
    v_mfma_f32_16x16x32_bf16 v[176:179], a[176:179], v[52:55], v[176:179]
    buffer_load_dwordx4 a[80:83], v1, s[8:11], s74 offen offset:0
    v_mfma_f32_16x16x32_bf16 v[148:151], a[180:183], v[48:51], v[148:151]
    v_exp_f32 v125, v125
    v_mfma_f32_16x16x32_bf16 v[180:183], a[180:183], v[52:55], v[180:183]
    s_waitcnt lgkmcnt(1)
    v_cvt_pk_bf16_f32 v62, v124, v125
    v_xor_b32 v19, 98304, v19
    v_mfma_f32_16x16x32_bf16 v[152:155], a[184:187], v[48:51], v[152:155]
    v_exp_f32 v126, v126
    v_mfma_f32_16x16x32_bf16 v[184:187], a[184:187], v[52:55], v[184:187]
    s_waitcnt lgkmcnt(0)
    v_xor_b32 v20, 98304, v20
    v_mfma_f32_16x16x32_bf16 v[156:159], a[188:191], v[48:51], v[156:159]
    v_exp_f32 v127, v127
    v_mfma_f32_16x16x32_bf16 v[188:191], a[188:191], v[52:55], v[188:191]
    v_cvt_pk_bf16_f32 v63, v126, v127
    v_mfma_f32_16x16x32_bf16 v[112:115], a[128:131], a[224:227], v[72:75]
    s_add_u32 m0, s62, 32768
    v_exp_f32 v96, v96
    v_mfma_f32_16x16x32_bf16 v[112:115], a[132:135], a[228:231], v[112:115]
    v_add_f32 v83, 0xf2400000, v21
    v_min_f32 v83, v83, v67
    v_mfma_f32_16x16x32_bf16 v[112:115], a[136:139], a[232:235], v[112:115]
    s_xor_b32 s98, s65, 0
    v_exp_f32 v97, v97
    v_mfma_f32_16x16x32_bf16 v[112:115], a[140:143], a[236:239], v[112:115]
    v_cvt_pk_bf16_f32 v48, v96, v97
    v_add_f32 v84, 0xf3800000, v21
    v_mfma_f32_16x16x32_bf16 v[120:123], a[128:131], a[240:243], v[76:79]
    v_exp_f32 v98, v98
    v_mfma_f32_16x16x32_bf16 v[120:123], a[132:135], a[244:247], v[120:123]
    buffer_load_dwordx4 v8, s[28:31], s98 offen offset:0   lds
    v_mfma_f32_16x16x32_bf16 v[120:123], a[136:139], a[248:251], v[120:123]
    v_exp_f32 v99, v99
    v_mfma_f32_16x16x32_bf16 v[120:123], a[140:143], a[252:255], v[120:123]
    buffer_load_dwordx4 v9, s[28:31], s98 offen offset:1024   lds
    v_mfma_f32_16x16x32_bf16 v[116:119], a[144:147], a[224:227], v[72:75]
    v_exp_f32 v100, v100
    v_mfma_f32_16x16x32_bf16 v[116:119], a[148:151], a[228:231], v[116:119]
    ds_read_b128 a[128:131], v18 offset:16384
    v_cvt_pk_bf16_f32 v49, v98, v99
    v_mfma_f32_16x16x32_bf16 v[116:119], a[152:155], a[232:235], v[116:119]
    s_add_u32 s19, s82, 32768
    v_exp_f32 v101, v101
    v_mfma_f32_16x16x32_bf16 v[116:119], a[156:159], a[236:239], v[116:119]
    s_sub_u32 s82, s12, s13
    ds_read_b128 a[132:135], v18 offset:17408
    v_cvt_pk_bf16_f32 v50, v100, v101
    v_mfma_f32_16x16x32_bf16 v[124:127], a[144:147], a[240:243], v[76:79]
    s_sub_u32 s82, s82, 1
    v_exp_f32 v102, v102
    v_mfma_f32_16x16x32_bf16 v[124:127], a[148:151], a[244:247], v[124:127]
    s_cmp_gt_u32 s12, s13
    s_cselect_b32 s82, s82, s12
    s_mul_i32 s82, s82, 65536
    ds_read_b128 a[136:139], v18 offset:18432
    v_mfma_f32_16x16x32_bf16 v[124:127], a[152:155], a[248:251], v[124:127]
    s_add_u32 s82, s82, s81
    v_exp_f32 v103, v103
    v_mfma_f32_16x16x32_bf16 v[124:127], a[156:159], a[252:255], v[124:127]
    s_cmp_ge_u32 s12, 17
    s_cselect_b32 s82, 2147471360, s82
    ds_read_b128 a[140:143], v18 offset:19456
    v_cvt_pk_bf16_f32 v51, v102, v103
    v_mfma_f32_16x16x32_bf16 v[40:43], v[28:31], v[56:59], v[40:43]
    s_add_u32 s12, s12, 1
    v_exp_f32 v104, v104
    v_mfma_f32_16x16x32_bf16 v[44:47], v[28:31], v[60:63], v[44:47]
    ds_read_b128 a[144:147], v18 offset:20480
    v_min_f32 v84, v84, v64
    v_mfma_f32_16x16x32_bf16 v[192:195], a[160:163], v[56:59], v[192:195]
    v_exp_f32 v105, v105
    v_mfma_f32_16x16x32_bf16 v[224:227], a[160:163], v[60:63], v[224:227]
    ds_read_b128 a[148:151], v18 offset:21504
    v_cvt_pk_bf16_f32 v52, v104, v105
    v_mfma_f32_16x16x32_bf16 v[196:199], a[164:167], v[56:59], v[196:199]
    v_exp_f32 v106, v106
    v_mfma_f32_16x16x32_bf16 v[228:231], a[164:167], v[60:63], v[228:231]
    ds_read_b128 a[152:155], v18 offset:22528
    v_add_f32 v85, 0xf3880000, v21
    v_mfma_f32_16x16x32_bf16 v[200:203], a[168:171], v[56:59], v[200:203]
    v_exp_f32 v107, v107
    v_mfma_f32_16x16x32_bf16 v[232:235], a[168:171], v[60:63], v[232:235]
    ds_read_b128 a[156:159], v18 offset:23552
    v_cvt_pk_bf16_f32 v53, v106, v107
    v_mfma_f32_16x16x32_bf16 v[204:207], a[172:175], v[56:59], v[204:207]
    v_exp_f32 v108, v108
    v_mfma_f32_16x16x32_bf16 v[236:239], a[172:175], v[60:63], v[236:239]
    buffer_load_dwordx4 v10, s[28:31], s98 offen offset:2048   lds
    v_mfma_f32_16x16x32_bf16 v[208:211], a[176:179], v[56:59], v[208:211]
    v_exp_f32 v109, v109
    v_mfma_f32_16x16x32_bf16 v[240:243], a[176:179], v[60:63], v[240:243]
    v_cvt_pk_bf16_f32 v54, v108, v109
    v_xor_b32 v18, 196608, v18
    v_mfma_f32_16x16x32_bf16 v[212:215], a[180:183], v[56:59], v[212:215]
    v_exp_f32 v110, v110
    v_mfma_f32_16x16x32_bf16 v[244:247], a[180:183], v[60:63], v[244:247]
    buffer_load_dwordx4 v11, s[28:31], s98 offen offset:3072   lds
    v_mfma_f32_16x16x32_bf16 v[216:219], a[184:187], v[56:59], v[216:219]
    s_xor_b32 s74, s24, 4096
    v_exp_f32 v111, v111
    v_mfma_f32_16x16x32_bf16 v[248:251], a[184:187], v[60:63], v[248:251]
    v_cvt_pk_bf16_f32 v55, v110, v111
    v_min_f32 v85, v85, v65
    v_mfma_f32_16x16x32_bf16 v[220:223], a[188:191], v[56:59], v[220:223]
    buffer_load_dwordx4 a[84:87], v1, s[8:11], s74 offen offset:1024
    v_mfma_f32_16x16x32_bf16 v[252:255], a[188:191], v[60:63], v[252:255]
    s_xor_b32 s74, s24, 4096
    buffer_load_dwordx4 a[88:91], v1, s[8:11], s74 offen offset:2048
    s_xor_b32 s74, s24, 4096
    buffer_load_dwordx4 a[92:95], v1, s[8:11], s74 offen offset:3072
    s_waitcnt vmcnt(12) lgkmcnt(0)
    s_barrier
    v_mfma_f32_16x16x32_bf16 v[96:99], a[128:131], a[192:195], v[64:67]
    s_add_u32 m0, s15, 0
    ds_read_b128 a[160:163], v19 offset:0
    v_mfma_f32_16x16x32_bf16 v[96:99], a[132:135], a[196:199], v[96:99]
    ds_read_b128 a[164:167], v19 offset:1024
    v_mfma_f32_16x16x32_bf16 v[96:99], a[136:139], a[200:203], v[96:99]
    v_exp_f32 v112, v112
    v_mfma_f32_16x16x32_bf16 v[96:99], a[140:143], a[204:207], v[96:99]
    buffer_load_dwordx4 v1, s[8:11], s82 offen offset:0  lds
    v_mfma_f32_16x16x32_bf16 v[104:107], a[128:131], a[208:211], v[68:71]
    v_exp_f32 v113, v113
    v_mfma_f32_16x16x32_bf16 v[104:107], a[132:135], a[212:215], v[104:107]
    ds_read_b128 a[168:171], v19 offset:2048
    v_cvt_pk_bf16_f32 v56, v112, v113
    v_mfma_f32_16x16x32_bf16 v[104:107], a[136:139], a[216:219], v[104:107]
    v_exp_f32 v114, v114
    v_mfma_f32_16x16x32_bf16 v[104:107], a[140:143], a[220:223], v[104:107]
    buffer_load_dwordx4 v1, s[8:11], s82 offen offset:1024  lds
    v_mfma_f32_16x16x32_bf16 v[100:103], a[144:147], a[192:195], v[64:67]
    v_exp_f32 v115, v115
    v_mfma_f32_16x16x32_bf16 v[100:103], a[148:151], a[196:199], v[100:103]
    ds_read_b128 a[172:175], v19 offset:3072
    v_cvt_pk_bf16_f32 v57, v114, v115
    v_mfma_f32_16x16x32_bf16 v[100:103], a[152:155], a[200:203], v[100:103]
    v_exp_f32 v116, v116
    v_mfma_f32_16x16x32_bf16 v[100:103], a[156:159], a[204:207], v[100:103]
    buffer_load_dwordx4 v1, s[8:11], s82 offen offset:2048  lds
    v_mfma_f32_16x16x32_bf16 v[108:111], a[144:147], a[208:211], v[68:71]
    v_exp_f32 v117, v117
    v_mfma_f32_16x16x32_bf16 v[108:111], a[148:151], a[212:215], v[108:111]
    ds_read_b128 a[176:179], v20 offset:4096
    v_cvt_pk_bf16_f32 v58, v116, v117
    v_mfma_f32_16x16x32_bf16 v[108:111], a[152:155], a[216:219], v[108:111]
    v_exp_f32 v118, v118
    v_mfma_f32_16x16x32_bf16 v[108:111], a[156:159], a[220:223], v[108:111]
    buffer_load_dwordx4 v1, s[8:11], s82 offen offset:3072  lds
    v_mfma_f32_16x16x32_bf16 v[32:35], v[28:31], v[48:51], v[32:35]
    s_add_u32 m0, s15, 4096
    v_exp_f32 v119, v119
    v_mfma_f32_16x16x32_bf16 v[36:39], v[28:31], v[52:55], v[36:39]
    s_waitcnt lgkmcnt(4)
    ds_read_b128 a[180:183], v20 offset:5120
    v_cvt_pk_bf16_f32 v59, v118, v119
    v_mfma_f32_16x16x32_bf16 v[128:131], a[160:163], v[48:51], v[128:131]
    v_exp_f32 v120, v120
    v_mfma_f32_16x16x32_bf16 v[160:163], a[160:163], v[52:55], v[160:163]
    s_waitcnt lgkmcnt(4)
    v_mfma_f32_16x16x32_bf16 v[132:135], a[164:167], v[48:51], v[132:135]
    v_exp_f32 v121, v121
    v_mfma_f32_16x16x32_bf16 v[164:167], a[164:167], v[52:55], v[164:167]
    s_waitcnt lgkmcnt(3)
    ds_read_b128 a[184:187], v20 offset:6144
    v_cvt_pk_bf16_f32 v60, v120, v121
    v_mfma_f32_16x16x32_bf16 v[136:139], a[168:171], v[48:51], v[136:139]
    s_waitcnt lgkmcnt(3)
    v_exp_f32 v122, v122
    v_mfma_f32_16x16x32_bf16 v[168:171], a[168:171], v[52:55], v[168:171]
    buffer_load_dwordx4 v15, s[8:11], s82 offen offset:0  lds
    v_mfma_f32_16x16x32_bf16 v[140:143], a[172:175], v[48:51], v[140:143]
    v_exp_f32 v123, v123
    v_mfma_f32_16x16x32_bf16 v[172:175], a[172:175], v[52:55], v[172:175]
    s_waitcnt lgkmcnt(2)
    ds_read_b128 a[188:191], v20 offset:7168
    v_cvt_pk_bf16_f32 v61, v122, v123
    v_mfma_f32_16x16x32_bf16 v[144:147], a[176:179], v[48:51], v[144:147]
    s_waitcnt lgkmcnt(2)
    v_exp_f32 v124, v124
    v_mfma_f32_16x16x32_bf16 v[176:179], a[176:179], v[52:55], v[176:179]
    buffer_load_dwordx4 v15, s[8:11], s82 offen offset:1024  lds
    v_mfma_f32_16x16x32_bf16 v[148:151], a[180:183], v[48:51], v[148:151]
    v_exp_f32 v125, v125
    v_mfma_f32_16x16x32_bf16 v[180:183], a[180:183], v[52:55], v[180:183]
    s_waitcnt lgkmcnt(1)
    v_cvt_pk_bf16_f32 v62, v124, v125
    v_mfma_f32_16x16x32_bf16 v[152:155], a[184:187], v[48:51], v[152:155]
    s_waitcnt lgkmcnt(0)
    v_exp_f32 v126, v126
    v_mfma_f32_16x16x32_bf16 v[184:187], a[184:187], v[52:55], v[184:187]
    buffer_load_dwordx4 v15, s[8:11], s82 offen offset:2048  lds
    v_mfma_f32_16x16x32_bf16 v[156:159], a[188:191], v[48:51], v[156:159]
    v_exp_f32 v127, v127
    v_mfma_f32_16x16x32_bf16 v[188:191], a[188:191], v[52:55], v[188:191]
    v_cvt_pk_bf16_f32 v63, v126, v127
    v_mfma_f32_16x16x32_bf16 v[112:115], a[128:131], a[224:227], v[72:75]
    v_mfma_f32_16x16x32_bf16 v[112:115], a[132:135], a[228:231], v[112:115]
    v_mfma_f32_16x16x32_bf16 v[112:115], a[136:139], a[232:235], v[112:115]
    v_exp_f32 v96, v96
    v_mfma_f32_16x16x32_bf16 v[112:115], a[140:143], a[236:239], v[112:115]
    buffer_load_dwordx4 v15, s[8:11], s82 offen offset:3072  lds
    v_mfma_f32_16x16x32_bf16 v[120:123], a[128:131], a[240:243], v[76:79]
    s_xor_b32 s15, s15, 196608
    v_exp_f32 v97, v97
    v_mfma_f32_16x16x32_bf16 v[120:123], a[132:135], a[244:247], v[120:123]
    s_add_u32 m0, s16, 0
    ds_read_b128 a[128:131], v18 offset:0
    v_cvt_pk_bf16_f32 v48, v96, v97
    v_mfma_f32_16x16x32_bf16 v[120:123], a[136:139], a[248:251], v[120:123]
    v_exp_f32 v98, v98
    v_mfma_f32_16x16x32_bf16 v[120:123], a[140:143], a[252:255], v[120:123]
    buffer_load_dwordx4 v1, s[8:11], s19 offen offset:0  lds
    v_mfma_f32_16x16x32_bf16 v[116:119], a[144:147], a[224:227], v[72:75]
    v_exp_f32 v99, v99
    v_mfma_f32_16x16x32_bf16 v[116:119], a[148:151], a[228:231], v[116:119]
    ds_read_b128 a[132:135], v18 offset:1024
    v_cvt_pk_bf16_f32 v49, v98, v99
    v_mfma_f32_16x16x32_bf16 v[116:119], a[152:155], a[232:235], v[116:119]
    v_exp_f32 v100, v100
    v_mfma_f32_16x16x32_bf16 v[116:119], a[156:159], a[236:239], v[116:119]
    buffer_load_dwordx4 v1, s[8:11], s19 offen offset:1024  lds
    v_mfma_f32_16x16x32_bf16 v[124:127], a[144:147], a[240:243], v[76:79]
    v_exp_f32 v101, v101
    v_mfma_f32_16x16x32_bf16 v[124:127], a[148:151], a[244:247], v[124:127]
    ds_read_b128 a[136:139], v18 offset:2048
    v_cvt_pk_bf16_f32 v50, v100, v101
    v_mfma_f32_16x16x32_bf16 v[124:127], a[152:155], a[248:251], v[124:127]
    v_exp_f32 v102, v102
    v_mfma_f32_16x16x32_bf16 v[124:127], a[156:159], a[252:255], v[124:127]
    buffer_load_dwordx4 v1, s[8:11], s19 offen offset:2048  lds
    v_mfma_f32_16x16x32_bf16 v[40:43], v[28:31], v[56:59], v[40:43]
    v_exp_f32 v103, v103
    v_mfma_f32_16x16x32_bf16 v[44:47], v[28:31], v[60:63], v[44:47]
    ds_read_b128 a[140:143], v18 offset:3072
    v_cvt_pk_bf16_f32 v51, v102, v103
    v_mfma_f32_16x16x32_bf16 v[192:195], a[160:163], v[56:59], v[192:195]
    v_exp_f32 v104, v104
    v_mfma_f32_16x16x32_bf16 v[224:227], a[160:163], v[60:63], v[224:227]
    v_mfma_f32_16x16x32_bf16 v[196:199], a[164:167], v[56:59], v[196:199]
    v_exp_f32 v105, v105
    v_mfma_f32_16x16x32_bf16 v[228:231], a[164:167], v[60:63], v[228:231]
    ds_read_b128 a[144:147], v18 offset:4096
    v_cvt_pk_bf16_f32 v52, v104, v105
    v_mfma_f32_16x16x32_bf16 v[200:203], a[168:171], v[56:59], v[200:203]
    v_exp_f32 v106, v106
    v_mfma_f32_16x16x32_bf16 v[232:235], a[168:171], v[60:63], v[232:235]
    buffer_load_dwordx4 v1, s[8:11], s19 offen offset:3072  lds
    v_mfma_f32_16x16x32_bf16 v[204:207], a[172:175], v[56:59], v[204:207]
    s_add_u32 m0, s16, 4096
    v_exp_f32 v107, v107
    v_mfma_f32_16x16x32_bf16 v[236:239], a[172:175], v[60:63], v[236:239]
    ds_read_b128 a[148:151], v18 offset:5120
    v_cvt_pk_bf16_f32 v53, v106, v107
    v_mfma_f32_16x16x32_bf16 v[208:211], a[176:179], v[56:59], v[208:211]
    v_exp_f32 v108, v108
    v_mfma_f32_16x16x32_bf16 v[240:243], a[176:179], v[60:63], v[240:243]
    buffer_load_dwordx4 v15, s[8:11], s19 offen offset:0  lds
    v_mfma_f32_16x16x32_bf16 v[212:215], a[180:183], v[56:59], v[212:215]
    v_exp_f32 v109, v109
    v_mfma_f32_16x16x32_bf16 v[244:247], a[180:183], v[60:63], v[244:247]
    ds_read_b128 a[152:155], v18 offset:6144
    v_cvt_pk_bf16_f32 v54, v108, v109
    v_mfma_f32_16x16x32_bf16 v[216:219], a[184:187], v[56:59], v[216:219]
    v_exp_f32 v110, v110
    v_mfma_f32_16x16x32_bf16 v[248:251], a[184:187], v[60:63], v[248:251]
    buffer_load_dwordx4 v15, s[8:11], s19 offen offset:1024  lds
    v_mfma_f32_16x16x32_bf16 v[220:223], a[188:191], v[56:59], v[220:223]
    v_exp_f32 v111, v111
    v_mfma_f32_16x16x32_bf16 v[252:255], a[188:191], v[60:63], v[252:255]
    ds_read_b128 a[156:159], v18 offset:7168
    v_cvt_pk_bf16_f32 v55, v110, v111
    s_waitcnt lgkmcnt(7)
    v_mfma_f32_16x16x32_bf16 v[96:99], a[128:131], a[192:195], v[64:67]
    s_waitcnt lgkmcnt(6)
    ds_read_b128 a[160:163], v19 offset:16384
    v_mfma_f32_16x16x32_bf16 v[96:99], a[132:135], a[196:199], v[96:99]
    s_waitcnt lgkmcnt(6)
    ds_read_b128 a[164:167], v19 offset:17408
    v_mfma_f32_16x16x32_bf16 v[96:99], a[136:139], a[200:203], v[96:99]
    s_waitcnt lgkmcnt(6)
    v_exp_f32 v112, v112
    v_mfma_f32_16x16x32_bf16 v[96:99], a[140:143], a[204:207], v[96:99]
    buffer_load_dwordx4 v15, s[8:11], s19 offen offset:2048  lds
    v_mfma_f32_16x16x32_bf16 v[104:107], a[128:131], a[208:211], v[68:71]
    v_exp_f32 v113, v113
    v_mfma_f32_16x16x32_bf16 v[104:107], a[132:135], a[212:215], v[104:107]
    ds_read_b128 a[168:171], v19 offset:18432
    v_cvt_pk_bf16_f32 v56, v112, v113
    v_mfma_f32_16x16x32_bf16 v[104:107], a[136:139], a[216:219], v[104:107]
    s_waitcnt lgkmcnt(6)
    v_exp_f32 v114, v114
    v_mfma_f32_16x16x32_bf16 v[104:107], a[140:143], a[220:223], v[104:107]
    buffer_load_dwordx4 v15, s[8:11], s19 offen offset:3072  lds
    v_mfma_f32_16x16x32_bf16 v[100:103], a[144:147], a[192:195], v[64:67]
    s_waitcnt lgkmcnt(5)
    s_xor_b32 s16, s16, 98304
    v_exp_f32 v115, v115
    v_mfma_f32_16x16x32_bf16 v[100:103], a[148:151], a[196:199], v[100:103]
    s_waitcnt lgkmcnt(4)
    s_lshl_b32 s64, s2, 6
    ds_read_b128 a[172:175], v19 offset:19456
    v_cvt_pk_bf16_f32 v57, v114, v115
    v_mfma_f32_16x16x32_bf16 v[100:103], a[152:155], a[200:203], v[100:103]
    s_waitcnt lgkmcnt(4)
    s_add_u32 s64, s64, 1327104
    v_exp_f32 v116, v116
    v_mfma_f32_16x16x32_bf16 v[100:103], a[156:159], a[204:207], v[100:103]
    buffer_store_dword v6, v7, s[8:11], s64 offen sc0 sc1
    v_mfma_f32_16x16x32_bf16 v[108:111], a[144:147], a[208:211], v[68:71]
    s_xor_b32 s74, s24, 8192
    v_exp_f32 v117, v117
    v_mfma_f32_16x16x32_bf16 v[108:111], a[148:151], a[212:215], v[108:111]
    ds_read_b128 a[176:179], v20 offset:20480
    v_cvt_pk_bf16_f32 v58, v116, v117
    v_mfma_f32_16x16x32_bf16 v[108:111], a[152:155], a[216:219], v[108:111]
    v_exp_f32 v118, v118
    v_mfma_f32_16x16x32_bf16 v[108:111], a[156:159], a[220:223], v[108:111]
    buffer_load_dwordx4 a[96:99], v1, s[8:11], s74 offen offset:0
    v_mfma_f32_16x16x32_bf16 v[32:35], v[28:31], v[48:51], v[32:35]
    s_xor_b32 s74, s24, 8192
    v_exp_f32 v119, v119
    v_mfma_f32_16x16x32_bf16 v[36:39], v[28:31], v[52:55], v[36:39]
    s_waitcnt lgkmcnt(4)
    ds_read_b128 a[180:183], v20 offset:21504
    v_cvt_pk_bf16_f32 v59, v118, v119
    v_mfma_f32_16x16x32_bf16 v[128:131], a[160:163], v[48:51], v[128:131]
    s_waitcnt lgkmcnt(4)
    v_exp_f32 v120, v120
    v_mfma_f32_16x16x32_bf16 v[160:163], a[160:163], v[52:55], v[160:163]
    buffer_load_dwordx4 a[100:103], v1, s[8:11], s74 offen offset:1024
    v_mfma_f32_16x16x32_bf16 v[132:135], a[164:167], v[48:51], v[132:135]
    s_xor_b32 s74, s24, 8192
    v_exp_f32 v121, v121
    v_mfma_f32_16x16x32_bf16 v[164:167], a[164:167], v[52:55], v[164:167]
    s_waitcnt lgkmcnt(3)
    ds_read_b128 a[184:187], v20 offset:22528
    v_cvt_pk_bf16_f32 v60, v120, v121
    v_mfma_f32_16x16x32_bf16 v[136:139], a[168:171], v[48:51], v[136:139]
    s_waitcnt lgkmcnt(3)
    v_exp_f32 v122, v122
    v_mfma_f32_16x16x32_bf16 v[168:171], a[168:171], v[52:55], v[168:171]
    buffer_load_dwordx4 a[104:107], v1, s[8:11], s74 offen offset:2048
    v_mfma_f32_16x16x32_bf16 v[140:143], a[172:175], v[48:51], v[140:143]
    s_xor_b32 s74, s24, 8192
    v_exp_f32 v123, v123
    v_mfma_f32_16x16x32_bf16 v[172:175], a[172:175], v[52:55], v[172:175]
    s_waitcnt lgkmcnt(2)
    ds_read_b128 a[188:191], v20 offset:23552
    v_cvt_pk_bf16_f32 v61, v122, v123
    v_mfma_f32_16x16x32_bf16 v[144:147], a[176:179], v[48:51], v[144:147]
    s_waitcnt lgkmcnt(2)
    v_exp_f32 v124, v124
    v_mfma_f32_16x16x32_bf16 v[176:179], a[176:179], v[52:55], v[176:179]
    buffer_load_dwordx4 a[108:111], v1, s[8:11], s74 offen offset:3072
    v_mfma_f32_16x16x32_bf16 v[148:151], a[180:183], v[48:51], v[148:151]
    s_xor_b32 s74, s24, 12288
    v_exp_f32 v125, v125
    v_mfma_f32_16x16x32_bf16 v[180:183], a[180:183], v[52:55], v[180:183]
    s_waitcnt lgkmcnt(1)
    v_cvt_pk_bf16_f32 v62, v124, v125
    v_xor_b32 v19, 98304, v19
    v_mfma_f32_16x16x32_bf16 v[152:155], a[184:187], v[48:51], v[152:155]
    buffer_load_dwordx4 a[112:115], v1, s[8:11], s74 offen offset:0
    v_exp_f32 v126, v126
    v_mfma_f32_16x16x32_bf16 v[184:187], a[184:187], v[52:55], v[184:187]
    s_waitcnt lgkmcnt(0)
    v_xor_b32 v20, 98304, v20
    v_mfma_f32_16x16x32_bf16 v[156:159], a[188:191], v[48:51], v[156:159]
    v_exp_f32 v127, v127
    v_mfma_f32_16x16x32_bf16 v[188:191], a[188:191], v[52:55], v[188:191]
    v_cvt_pk_bf16_f32 v63, v126, v127
    v_mfma_f32_16x16x32_bf16 v[112:115], a[128:131], a[224:227], v[72:75]
    s_add_u32 m0, s62, 36864
    v_exp_f32 v96, v96
    v_mfma_f32_16x16x32_bf16 v[112:115], a[132:135], a[228:231], v[112:115]
    v_add_f32 v86, 0xf3900000, v21
    v_min_f32 v86, v86, v66
    v_mfma_f32_16x16x32_bf16 v[112:115], a[136:139], a[232:235], v[112:115]
    s_xor_b32 s98, s65, 32768
    v_exp_f32 v97, v97
    v_mfma_f32_16x16x32_bf16 v[112:115], a[140:143], a[236:239], v[112:115]
    v_cvt_pk_bf16_f32 v48, v96, v97
    v_add_f32 v87, 0xf3980000, v21
    v_mfma_f32_16x16x32_bf16 v[120:123], a[128:131], a[240:243], v[76:79]
    v_exp_f32 v98, v98
    v_mfma_f32_16x16x32_bf16 v[120:123], a[132:135], a[244:247], v[120:123]
    buffer_load_dwordx4 v8, s[28:31], s98 offen offset:0   lds
    v_mfma_f32_16x16x32_bf16 v[120:123], a[136:139], a[248:251], v[120:123]
    v_exp_f32 v99, v99
    v_mfma_f32_16x16x32_bf16 v[120:123], a[140:143], a[252:255], v[120:123]
    buffer_load_dwordx4 v9, s[28:31], s98 offen offset:1024   lds
    v_mfma_f32_16x16x32_bf16 v[116:119], a[144:147], a[224:227], v[72:75]
    v_exp_f32 v100, v100
    v_mfma_f32_16x16x32_bf16 v[116:119], a[148:151], a[228:231], v[116:119]
    ds_read_b128 a[128:131], v18 offset:16384
    v_cvt_pk_bf16_f32 v49, v98, v99
    v_mfma_f32_16x16x32_bf16 v[116:119], a[152:155], a[232:235], v[116:119]
    s_add_u32 s19, s82, 32768
    v_exp_f32 v101, v101
    v_mfma_f32_16x16x32_bf16 v[116:119], a[156:159], a[236:239], v[116:119]
    s_sub_u32 s82, s12, s13
    ds_read_b128 a[132:135], v18 offset:17408
    v_cvt_pk_bf16_f32 v50, v100, v101
    v_mfma_f32_16x16x32_bf16 v[124:127], a[144:147], a[240:243], v[76:79]
    s_sub_u32 s82, s82, 1
    v_exp_f32 v102, v102
    v_mfma_f32_16x16x32_bf16 v[124:127], a[148:151], a[244:247], v[124:127]
    s_cmp_gt_u32 s12, s13
    s_cselect_b32 s82, s82, s12
    s_mul_i32 s82, s82, 65536
    ds_read_b128 a[136:139], v18 offset:18432
    v_mfma_f32_16x16x32_bf16 v[124:127], a[152:155], a[248:251], v[124:127]
    s_add_u32 s82, s82, s81
    v_exp_f32 v103, v103
    v_mfma_f32_16x16x32_bf16 v[124:127], a[156:159], a[252:255], v[124:127]
    s_cmp_ge_u32 s12, 17
    s_cselect_b32 s82, 2147471360, s82
    ds_read_b128 a[140:143], v18 offset:19456
    v_cvt_pk_bf16_f32 v51, v102, v103
    v_mfma_f32_16x16x32_bf16 v[40:43], v[28:31], v[56:59], v[40:43]
    s_add_u32 s12, s12, 1
    v_exp_f32 v104, v104
    v_mfma_f32_16x16x32_bf16 v[44:47], v[28:31], v[60:63], v[44:47]
    ds_read_b128 a[144:147], v18 offset:20480
    v_min_f32 v87, v87, v67
    v_mfma_f32_16x16x32_bf16 v[192:195], a[160:163], v[56:59], v[192:195]
    v_exp_f32 v105, v105
    v_mfma_f32_16x16x32_bf16 v[224:227], a[160:163], v[60:63], v[224:227]
    ds_read_b128 a[148:151], v18 offset:21504
    v_cvt_pk_bf16_f32 v52, v104, v105
    v_mfma_f32_16x16x32_bf16 v[196:199], a[164:167], v[56:59], v[196:199]
    v_exp_f32 v106, v106
    v_mfma_f32_16x16x32_bf16 v[228:231], a[164:167], v[60:63], v[228:231]
    ds_read_b128 a[152:155], v18 offset:22528
    v_add_f32 v88, 0x73800000, v21
    v_mfma_f32_16x16x32_bf16 v[200:203], a[168:171], v[56:59], v[200:203]
    v_exp_f32 v107, v107
    v_mfma_f32_16x16x32_bf16 v[232:235], a[168:171], v[60:63], v[232:235]
    ds_read_b128 a[156:159], v18 offset:23552
    v_cvt_pk_bf16_f32 v53, v106, v107
    v_mfma_f32_16x16x32_bf16 v[204:207], a[172:175], v[56:59], v[204:207]
    v_exp_f32 v108, v108
    v_mfma_f32_16x16x32_bf16 v[236:239], a[172:175], v[60:63], v[236:239]
    buffer_load_dwordx4 v10, s[28:31], s98 offen offset:2048   lds
    v_mfma_f32_16x16x32_bf16 v[208:211], a[176:179], v[56:59], v[208:211]
    v_exp_f32 v109, v109
    v_mfma_f32_16x16x32_bf16 v[240:243], a[176:179], v[60:63], v[240:243]
    v_cvt_pk_bf16_f32 v54, v108, v109
    v_xor_b32 v18, 196608, v18
    v_mfma_f32_16x16x32_bf16 v[212:215], a[180:183], v[56:59], v[212:215]
    v_exp_f32 v110, v110
    v_mfma_f32_16x16x32_bf16 v[244:247], a[180:183], v[60:63], v[244:247]
    buffer_load_dwordx4 v11, s[28:31], s98 offen offset:3072   lds
    v_mfma_f32_16x16x32_bf16 v[216:219], a[184:187], v[56:59], v[216:219]
    s_xor_b32 s74, s24, 12288
    v_exp_f32 v111, v111
    v_mfma_f32_16x16x32_bf16 v[248:251], a[184:187], v[60:63], v[248:251]
    v_cvt_pk_bf16_f32 v55, v110, v111
    v_min_f32 v88, v88, v68
    v_mfma_f32_16x16x32_bf16 v[220:223], a[188:191], v[56:59], v[220:223]
    buffer_load_dwordx4 a[116:119], v1, s[8:11], s74 offen offset:1024
    v_mfma_f32_16x16x32_bf16 v[252:255], a[188:191], v[60:63], v[252:255]
    s_xor_b32 s74, s24, 12288
    buffer_load_dwordx4 a[120:123], v1, s[8:11], s74 offen offset:2048
    s_xor_b32 s74, s24, 12288
    buffer_load_dwordx4 a[124:127], v1, s[8:11], s74 offen offset:3072
    s_waitcnt vmcnt(13) lgkmcnt(0)
    s_barrier
    v_mfma_f32_16x16x32_bf16 v[96:99], a[128:131], a[192:195], v[64:67]
    s_add_u32 m0, s15, 0
    ds_read_b128 a[160:163], v19 offset:0
    v_mfma_f32_16x16x32_bf16 v[96:99], a[132:135], a[196:199], v[96:99]
    ds_read_b128 a[164:167], v19 offset:1024
    v_mfma_f32_16x16x32_bf16 v[96:99], a[136:139], a[200:203], v[96:99]
    v_exp_f32 v112, v112
    v_mfma_f32_16x16x32_bf16 v[96:99], a[140:143], a[204:207], v[96:99]
    buffer_load_dwordx4 v1, s[8:11], s82 offen offset:0  lds
    v_mfma_f32_16x16x32_bf16 v[104:107], a[128:131], a[208:211], v[68:71]
    v_exp_f32 v113, v113
    v_mfma_f32_16x16x32_bf16 v[104:107], a[132:135], a[212:215], v[104:107]
    ds_read_b128 a[168:171], v19 offset:2048
    v_cvt_pk_bf16_f32 v56, v112, v113
    v_mfma_f32_16x16x32_bf16 v[104:107], a[136:139], a[216:219], v[104:107]
    v_exp_f32 v114, v114
    v_mfma_f32_16x16x32_bf16 v[104:107], a[140:143], a[220:223], v[104:107]
    buffer_load_dwordx4 v1, s[8:11], s82 offen offset:1024  lds
    v_mfma_f32_16x16x32_bf16 v[100:103], a[144:147], a[192:195], v[64:67]
    v_exp_f32 v115, v115
    v_mfma_f32_16x16x32_bf16 v[100:103], a[148:151], a[196:199], v[100:103]
    ds_read_b128 a[172:175], v19 offset:3072
    v_cvt_pk_bf16_f32 v57, v114, v115
    v_mfma_f32_16x16x32_bf16 v[100:103], a[152:155], a[200:203], v[100:103]
    v_exp_f32 v116, v116
    v_mfma_f32_16x16x32_bf16 v[100:103], a[156:159], a[204:207], v[100:103]
    buffer_load_dwordx4 v1, s[8:11], s82 offen offset:2048  lds
    v_mfma_f32_16x16x32_bf16 v[108:111], a[144:147], a[208:211], v[68:71]
    v_exp_f32 v117, v117
    v_mfma_f32_16x16x32_bf16 v[108:111], a[148:151], a[212:215], v[108:111]
    ds_read_b128 a[176:179], v20 offset:4096
    v_cvt_pk_bf16_f32 v58, v116, v117
    v_mfma_f32_16x16x32_bf16 v[108:111], a[152:155], a[216:219], v[108:111]
    v_exp_f32 v118, v118
    v_mfma_f32_16x16x32_bf16 v[108:111], a[156:159], a[220:223], v[108:111]
    buffer_load_dwordx4 v1, s[8:11], s82 offen offset:3072  lds
    v_mfma_f32_16x16x32_bf16 v[32:35], v[28:31], v[48:51], v[32:35]
    s_add_u32 m0, s15, 4096
    v_exp_f32 v119, v119
    v_mfma_f32_16x16x32_bf16 v[36:39], v[28:31], v[52:55], v[36:39]
    s_waitcnt lgkmcnt(4)
    ds_read_b128 a[180:183], v20 offset:5120
    v_cvt_pk_bf16_f32 v59, v118, v119
    v_mfma_f32_16x16x32_bf16 v[128:131], a[160:163], v[48:51], v[128:131]
    v_exp_f32 v120, v120
    v_mfma_f32_16x16x32_bf16 v[160:163], a[160:163], v[52:55], v[160:163]
    s_waitcnt lgkmcnt(4)
    v_mfma_f32_16x16x32_bf16 v[132:135], a[164:167], v[48:51], v[132:135]
    v_exp_f32 v121, v121
    v_mfma_f32_16x16x32_bf16 v[164:167], a[164:167], v[52:55], v[164:167]
    s_waitcnt lgkmcnt(3)
    ds_read_b128 a[184:187], v20 offset:6144
    v_cvt_pk_bf16_f32 v60, v120, v121
    v_mfma_f32_16x16x32_bf16 v[136:139], a[168:171], v[48:51], v[136:139]
    s_waitcnt lgkmcnt(3)
    v_exp_f32 v122, v122
    v_mfma_f32_16x16x32_bf16 v[168:171], a[168:171], v[52:55], v[168:171]
    buffer_load_dwordx4 v15, s[8:11], s82 offen offset:0  lds
    v_mfma_f32_16x16x32_bf16 v[140:143], a[172:175], v[48:51], v[140:143]
    v_exp_f32 v123, v123
    v_mfma_f32_16x16x32_bf16 v[172:175], a[172:175], v[52:55], v[172:175]
    s_waitcnt lgkmcnt(2)
    ds_read_b128 a[188:191], v20 offset:7168
    v_cvt_pk_bf16_f32 v61, v122, v123
    v_mfma_f32_16x16x32_bf16 v[144:147], a[176:179], v[48:51], v[144:147]
    s_waitcnt lgkmcnt(2)
    v_exp_f32 v124, v124
    v_mfma_f32_16x16x32_bf16 v[176:179], a[176:179], v[52:55], v[176:179]
    buffer_load_dwordx4 v15, s[8:11], s82 offen offset:1024  lds
    v_mfma_f32_16x16x32_bf16 v[148:151], a[180:183], v[48:51], v[148:151]
    v_exp_f32 v125, v125
    v_mfma_f32_16x16x32_bf16 v[180:183], a[180:183], v[52:55], v[180:183]
    s_waitcnt lgkmcnt(1)
    v_cvt_pk_bf16_f32 v62, v124, v125
    v_mfma_f32_16x16x32_bf16 v[152:155], a[184:187], v[48:51], v[152:155]
    s_waitcnt lgkmcnt(0)
    v_exp_f32 v126, v126
    v_mfma_f32_16x16x32_bf16 v[184:187], a[184:187], v[52:55], v[184:187]
    buffer_load_dwordx4 v15, s[8:11], s82 offen offset:2048  lds
    v_mfma_f32_16x16x32_bf16 v[156:159], a[188:191], v[48:51], v[156:159]
    v_exp_f32 v127, v127
    v_mfma_f32_16x16x32_bf16 v[188:191], a[188:191], v[52:55], v[188:191]
    v_cvt_pk_bf16_f32 v63, v126, v127
    v_mfma_f32_16x16x32_bf16 v[112:115], a[128:131], a[224:227], v[72:75]
    v_mfma_f32_16x16x32_bf16 v[112:115], a[132:135], a[228:231], v[112:115]
    v_mfma_f32_16x16x32_bf16 v[112:115], a[136:139], a[232:235], v[112:115]
    v_exp_f32 v96, v96
    v_mfma_f32_16x16x32_bf16 v[112:115], a[140:143], a[236:239], v[112:115]
    buffer_load_dwordx4 v15, s[8:11], s82 offen offset:3072  lds
    v_mfma_f32_16x16x32_bf16 v[120:123], a[128:131], a[240:243], v[76:79]
    s_xor_b32 s15, s15, 196608
    v_exp_f32 v97, v97
    v_mfma_f32_16x16x32_bf16 v[120:123], a[132:135], a[244:247], v[120:123]
    s_add_u32 m0, s16, 0
    ds_read_b128 a[128:131], v18 offset:0
    v_cvt_pk_bf16_f32 v48, v96, v97
    v_mfma_f32_16x16x32_bf16 v[120:123], a[136:139], a[248:251], v[120:123]
    v_exp_f32 v98, v98
    v_mfma_f32_16x16x32_bf16 v[120:123], a[140:143], a[252:255], v[120:123]
    buffer_load_dwordx4 v1, s[8:11], s19 offen offset:0  lds
    v_mfma_f32_16x16x32_bf16 v[116:119], a[144:147], a[224:227], v[72:75]
    v_exp_f32 v99, v99
    v_mfma_f32_16x16x32_bf16 v[116:119], a[148:151], a[228:231], v[116:119]
    ds_read_b128 a[132:135], v18 offset:1024
    v_cvt_pk_bf16_f32 v49, v98, v99
    v_mfma_f32_16x16x32_bf16 v[116:119], a[152:155], a[232:235], v[116:119]
    v_exp_f32 v100, v100
    v_mfma_f32_16x16x32_bf16 v[116:119], a[156:159], a[236:239], v[116:119]
    buffer_load_dwordx4 v1, s[8:11], s19 offen offset:1024  lds
    v_mfma_f32_16x16x32_bf16 v[124:127], a[144:147], a[240:243], v[76:79]
    v_exp_f32 v101, v101
    v_mfma_f32_16x16x32_bf16 v[124:127], a[148:151], a[244:247], v[124:127]
    ds_read_b128 a[136:139], v18 offset:2048
    v_cvt_pk_bf16_f32 v50, v100, v101
    v_mfma_f32_16x16x32_bf16 v[124:127], a[152:155], a[248:251], v[124:127]
    v_exp_f32 v102, v102
    v_mfma_f32_16x16x32_bf16 v[124:127], a[156:159], a[252:255], v[124:127]
    buffer_load_dwordx4 v1, s[8:11], s19 offen offset:2048  lds
    v_mfma_f32_16x16x32_bf16 v[40:43], v[28:31], v[56:59], v[40:43]
    v_exp_f32 v103, v103
    v_mfma_f32_16x16x32_bf16 v[44:47], v[28:31], v[60:63], v[44:47]
    ds_read_b128 a[140:143], v18 offset:3072
    v_cvt_pk_bf16_f32 v51, v102, v103
    v_mfma_f32_16x16x32_bf16 v[192:195], a[160:163], v[56:59], v[192:195]
    v_exp_f32 v104, v104
    v_mfma_f32_16x16x32_bf16 v[224:227], a[160:163], v[60:63], v[224:227]
    v_mfma_f32_16x16x32_bf16 v[196:199], a[164:167], v[56:59], v[196:199]
    v_exp_f32 v105, v105
    v_mfma_f32_16x16x32_bf16 v[228:231], a[164:167], v[60:63], v[228:231]
    ds_read_b128 a[144:147], v18 offset:4096
    v_cvt_pk_bf16_f32 v52, v104, v105
    v_mfma_f32_16x16x32_bf16 v[200:203], a[168:171], v[56:59], v[200:203]
    v_exp_f32 v106, v106
    v_mfma_f32_16x16x32_bf16 v[232:235], a[168:171], v[60:63], v[232:235]
    buffer_load_dwordx4 v1, s[8:11], s19 offen offset:3072  lds
    v_mfma_f32_16x16x32_bf16 v[204:207], a[172:175], v[56:59], v[204:207]
    s_add_u32 m0, s16, 4096
    v_exp_f32 v107, v107
    v_mfma_f32_16x16x32_bf16 v[236:239], a[172:175], v[60:63], v[236:239]
    ds_read_b128 a[148:151], v18 offset:5120
    v_cvt_pk_bf16_f32 v53, v106, v107
    v_mfma_f32_16x16x32_bf16 v[208:211], a[176:179], v[56:59], v[208:211]
    v_exp_f32 v108, v108
    v_mfma_f32_16x16x32_bf16 v[240:243], a[176:179], v[60:63], v[240:243]
    buffer_load_dwordx4 v15, s[8:11], s19 offen offset:0  lds
    v_mfma_f32_16x16x32_bf16 v[212:215], a[180:183], v[56:59], v[212:215]
    v_exp_f32 v109, v109
    v_mfma_f32_16x16x32_bf16 v[244:247], a[180:183], v[60:63], v[244:247]
    ds_read_b128 a[152:155], v18 offset:6144
    v_cvt_pk_bf16_f32 v54, v108, v109
    v_mfma_f32_16x16x32_bf16 v[216:219], a[184:187], v[56:59], v[216:219]
    v_exp_f32 v110, v110
    v_mfma_f32_16x16x32_bf16 v[248:251], a[184:187], v[60:63], v[248:251]
    buffer_load_dwordx4 v15, s[8:11], s19 offen offset:1024  lds
    v_mfma_f32_16x16x32_bf16 v[220:223], a[188:191], v[56:59], v[220:223]
    v_exp_f32 v111, v111
    v_mfma_f32_16x16x32_bf16 v[252:255], a[188:191], v[60:63], v[252:255]
    ds_read_b128 a[156:159], v18 offset:7168
    v_cvt_pk_bf16_f32 v55, v110, v111
    s_waitcnt lgkmcnt(7)
    v_mfma_f32_16x16x32_bf16 v[96:99], a[128:131], a[192:195], v[64:67]
    s_waitcnt lgkmcnt(6)
    ds_read_b128 a[160:163], v19 offset:16384
    v_mfma_f32_16x16x32_bf16 v[96:99], a[132:135], a[196:199], v[96:99]
    s_waitcnt lgkmcnt(6)
    ds_read_b128 a[164:167], v19 offset:17408
    v_mfma_f32_16x16x32_bf16 v[96:99], a[136:139], a[200:203], v[96:99]
    s_waitcnt lgkmcnt(6)
    v_exp_f32 v112, v112
    v_mfma_f32_16x16x32_bf16 v[96:99], a[140:143], a[204:207], v[96:99]
    buffer_load_dwordx4 v15, s[8:11], s19 offen offset:2048  lds
    v_mfma_f32_16x16x32_bf16 v[104:107], a[128:131], a[208:211], v[68:71]
    v_exp_f32 v113, v113
    v_mfma_f32_16x16x32_bf16 v[104:107], a[132:135], a[212:215], v[104:107]
    ds_read_b128 a[168:171], v19 offset:18432
    v_cvt_pk_bf16_f32 v56, v112, v113
    v_mfma_f32_16x16x32_bf16 v[104:107], a[136:139], a[216:219], v[104:107]
    s_waitcnt lgkmcnt(6)
    v_exp_f32 v114, v114
    v_mfma_f32_16x16x32_bf16 v[104:107], a[140:143], a[220:223], v[104:107]
    buffer_load_dwordx4 v15, s[8:11], s19 offen offset:3072  lds
    v_mfma_f32_16x16x32_bf16 v[100:103], a[144:147], a[192:195], v[64:67]
    s_waitcnt lgkmcnt(5)
    s_xor_b32 s16, s16, 98304
    v_exp_f32 v115, v115
    v_mfma_f32_16x16x32_bf16 v[100:103], a[148:151], a[196:199], v[100:103]
    s_waitcnt lgkmcnt(4)
    s_xor_b32 s74, s24, 16384
    ds_read_b128 a[172:175], v19 offset:19456
    v_cvt_pk_bf16_f32 v57, v114, v115
    v_mfma_f32_16x16x32_bf16 v[100:103], a[152:155], a[200:203], v[100:103]
    s_waitcnt lgkmcnt(4)
    v_exp_f32 v116, v116
    v_mfma_f32_16x16x32_bf16 v[100:103], a[156:159], a[204:207], v[100:103]
    buffer_load_dwordx4 a[0:3], v1, s[8:11], s74 offen offset:0
    v_mfma_f32_16x16x32_bf16 v[108:111], a[144:147], a[208:211], v[68:71]
    s_xor_b32 s74, s24, 16384
    v_exp_f32 v117, v117
    v_mfma_f32_16x16x32_bf16 v[108:111], a[148:151], a[212:215], v[108:111]
    ds_read_b128 a[176:179], v20 offset:20480
    v_cvt_pk_bf16_f32 v58, v116, v117
    v_mfma_f32_16x16x32_bf16 v[108:111], a[152:155], a[216:219], v[108:111]
    v_exp_f32 v118, v118
    v_mfma_f32_16x16x32_bf16 v[108:111], a[156:159], a[220:223], v[108:111]
    buffer_load_dwordx4 a[4:7], v1, s[8:11], s74 offen offset:1024
    v_mfma_f32_16x16x32_bf16 v[32:35], v[28:31], v[48:51], v[32:35]
    s_xor_b32 s74, s24, 16384
    v_exp_f32 v119, v119
    v_mfma_f32_16x16x32_bf16 v[36:39], v[28:31], v[52:55], v[36:39]
    s_waitcnt lgkmcnt(4)
    ds_read_b128 a[180:183], v20 offset:21504
    v_cvt_pk_bf16_f32 v59, v118, v119
    v_mfma_f32_16x16x32_bf16 v[128:131], a[160:163], v[48:51], v[128:131]
    s_waitcnt lgkmcnt(4)
    v_exp_f32 v120, v120
    v_mfma_f32_16x16x32_bf16 v[160:163], a[160:163], v[52:55], v[160:163]
    buffer_load_dwordx4 a[8:11], v1, s[8:11], s74 offen offset:2048
    v_mfma_f32_16x16x32_bf16 v[132:135], a[164:167], v[48:51], v[132:135]
    s_xor_b32 s74, s24, 16384
    v_exp_f32 v121, v121
    v_mfma_f32_16x16x32_bf16 v[164:167], a[164:167], v[52:55], v[164:167]
    s_waitcnt lgkmcnt(3)
    ds_read_b128 a[184:187], v20 offset:22528
    v_cvt_pk_bf16_f32 v60, v120, v121
    v_mfma_f32_16x16x32_bf16 v[136:139], a[168:171], v[48:51], v[136:139]
    s_waitcnt lgkmcnt(3)
    v_exp_f32 v122, v122
    v_mfma_f32_16x16x32_bf16 v[168:171], a[168:171], v[52:55], v[168:171]
    buffer_load_dwordx4 a[12:15], v1, s[8:11], s74 offen offset:3072
    v_mfma_f32_16x16x32_bf16 v[140:143], a[172:175], v[48:51], v[140:143]
    s_xor_b32 s74, s24, 20480
    v_exp_f32 v123, v123
    v_mfma_f32_16x16x32_bf16 v[172:175], a[172:175], v[52:55], v[172:175]
    s_waitcnt lgkmcnt(2)
    ds_read_b128 a[188:191], v20 offset:23552
    v_cvt_pk_bf16_f32 v61, v122, v123
    v_mfma_f32_16x16x32_bf16 v[144:147], a[176:179], v[48:51], v[144:147]
    s_waitcnt lgkmcnt(2)
    v_exp_f32 v124, v124
    v_mfma_f32_16x16x32_bf16 v[176:179], a[176:179], v[52:55], v[176:179]
    buffer_load_dwordx4 a[16:19], v1, s[8:11], s74 offen offset:0
    v_mfma_f32_16x16x32_bf16 v[148:151], a[180:183], v[48:51], v[148:151]
    s_xor_b32 s74, s24, 20480
    v_exp_f32 v125, v125
    v_mfma_f32_16x16x32_bf16 v[180:183], a[180:183], v[52:55], v[180:183]
    s_waitcnt lgkmcnt(1)
    v_cvt_pk_bf16_f32 v62, v124, v125
    v_xor_b32 v19, 98304, v19
    v_mfma_f32_16x16x32_bf16 v[152:155], a[184:187], v[48:51], v[152:155]
    buffer_load_dwordx4 a[20:23], v1, s[8:11], s74 offen offset:1024
    v_exp_f32 v126, v126
    v_mfma_f32_16x16x32_bf16 v[184:187], a[184:187], v[52:55], v[184:187]
    s_waitcnt lgkmcnt(0)
    v_xor_b32 v20, 98304, v20
    v_mfma_f32_16x16x32_bf16 v[156:159], a[188:191], v[48:51], v[156:159]
    v_exp_f32 v127, v127
    v_mfma_f32_16x16x32_bf16 v[188:191], a[188:191], v[52:55], v[188:191]
    v_cvt_pk_bf16_f32 v63, v126, v127
    v_mfma_f32_16x16x32_bf16 v[112:115], a[128:131], a[224:227], v[72:75]
    s_xor_b32 s74, s24, 20480
    v_exp_f32 v96, v96
    v_mfma_f32_16x16x32_bf16 v[112:115], a[132:135], a[228:231], v[112:115]
    buffer_load_dwordx4 a[24:27], v1, s[8:11], s74 offen offset:2048
    v_mfma_f32_16x16x32_bf16 v[112:115], a[136:139], a[232:235], v[112:115]
    s_xor_b32 s74, s24, 20480
    v_exp_f32 v97, v97
    v_mfma_f32_16x16x32_bf16 v[112:115], a[140:143], a[236:239], v[112:115]
    v_cvt_pk_bf16_f32 v48, v96, v97
    v_add_f32 v89, 0x73700000, v21
    v_mfma_f32_16x16x32_bf16 v[120:123], a[128:131], a[240:243], v[76:79]
    v_exp_f32 v98, v98
    v_mfma_f32_16x16x32_bf16 v[120:123], a[132:135], a[244:247], v[120:123]
    buffer_load_dwordx4 a[28:31], v1, s[8:11], s74 offen offset:3072
    v_mfma_f32_16x16x32_bf16 v[120:123], a[136:139], a[248:251], v[120:123]
    s_xor_b32 s74, s24, 24576
    v_exp_f32 v99, v99
    v_mfma_f32_16x16x32_bf16 v[120:123], a[140:143], a[252:255], v[120:123]
    buffer_load_dwordx4 a[32:35], v1, s[8:11], s74 offen offset:0
    v_mfma_f32_16x16x32_bf16 v[116:119], a[144:147], a[224:227], v[72:75]
    s_xor_b32 s74, s24, 24576
    v_exp_f32 v100, v100
    v_mfma_f32_16x16x32_bf16 v[116:119], a[148:151], a[228:231], v[116:119]
    ds_read_b128 a[128:131], v18 offset:16384
    v_cvt_pk_bf16_f32 v49, v98, v99
    v_mfma_f32_16x16x32_bf16 v[116:119], a[152:155], a[232:235], v[116:119]
    s_add_u32 s19, s82, 32768
    v_exp_f32 v101, v101
    v_mfma_f32_16x16x32_bf16 v[116:119], a[156:159], a[236:239], v[116:119]
    s_sub_u32 s82, s12, s13
    ds_read_b128 a[132:135], v18 offset:17408
    v_cvt_pk_bf16_f32 v50, v100, v101
    v_mfma_f32_16x16x32_bf16 v[124:127], a[144:147], a[240:243], v[76:79]
    s_sub_u32 s82, s82, 1
    v_exp_f32 v102, v102
    v_mfma_f32_16x16x32_bf16 v[124:127], a[148:151], a[244:247], v[124:127]
    s_cmp_gt_u32 s12, s13
    s_cselect_b32 s82, s82, s12
    s_mul_i32 s82, s82, 65536
    ds_read_b128 a[136:139], v18 offset:18432
    v_mfma_f32_16x16x32_bf16 v[124:127], a[152:155], a[248:251], v[124:127]
    s_add_u32 s82, s82, s81
    v_exp_f32 v103, v103
    v_mfma_f32_16x16x32_bf16 v[124:127], a[156:159], a[252:255], v[124:127]
    s_cmp_ge_u32 s12, 17
    s_cselect_b32 s82, 2147471360, s82
    ds_read_b128 a[140:143], v18 offset:19456
    v_cvt_pk_bf16_f32 v51, v102, v103
    v_mfma_f32_16x16x32_bf16 v[40:43], v[28:31], v[56:59], v[40:43]
    s_add_u32 s12, s12, 1
    v_exp_f32 v104, v104
    v_mfma_f32_16x16x32_bf16 v[44:47], v[28:31], v[60:63], v[44:47]
    ds_read_b128 a[144:147], v18 offset:20480
    v_min_f32 v89, v89, v69
    v_mfma_f32_16x16x32_bf16 v[192:195], a[160:163], v[56:59], v[192:195]
    v_exp_f32 v105, v105
    v_mfma_f32_16x16x32_bf16 v[224:227], a[160:163], v[60:63], v[224:227]
    ds_read_b128 a[148:151], v18 offset:21504
    v_cvt_pk_bf16_f32 v52, v104, v105
    v_mfma_f32_16x16x32_bf16 v[196:199], a[164:167], v[56:59], v[196:199]
    v_exp_f32 v106, v106
    v_mfma_f32_16x16x32_bf16 v[228:231], a[164:167], v[60:63], v[228:231]
    ds_read_b128 a[152:155], v18 offset:22528
    v_add_f32 v90, 0x73600000, v21
    v_mfma_f32_16x16x32_bf16 v[200:203], a[168:171], v[56:59], v[200:203]
    v_exp_f32 v107, v107
    v_mfma_f32_16x16x32_bf16 v[232:235], a[168:171], v[60:63], v[232:235]
    ds_read_b128 a[156:159], v18 offset:23552
    v_cvt_pk_bf16_f32 v53, v106, v107
    v_mfma_f32_16x16x32_bf16 v[204:207], a[172:175], v[56:59], v[204:207]
    v_exp_f32 v108, v108
    v_mfma_f32_16x16x32_bf16 v[236:239], a[172:175], v[60:63], v[236:239]
    buffer_load_dwordx4 a[36:39], v1, s[8:11], s74 offen offset:1024
    v_mfma_f32_16x16x32_bf16 v[208:211], a[176:179], v[56:59], v[208:211]
    s_xor_b32 s74, s24, 24576
    v_exp_f32 v109, v109
    v_mfma_f32_16x16x32_bf16 v[240:243], a[176:179], v[60:63], v[240:243]
    v_cvt_pk_bf16_f32 v54, v108, v109
    v_xor_b32 v18, 196608, v18
    v_mfma_f32_16x16x32_bf16 v[212:215], a[180:183], v[56:59], v[212:215]
    v_exp_f32 v110, v110
    v_mfma_f32_16x16x32_bf16 v[244:247], a[180:183], v[60:63], v[244:247]
    buffer_load_dwordx4 a[40:43], v1, s[8:11], s74 offen offset:2048
    v_mfma_f32_16x16x32_bf16 v[216:219], a[184:187], v[56:59], v[216:219]
    s_xor_b32 s74, s24, 24576
    v_exp_f32 v111, v111
    v_mfma_f32_16x16x32_bf16 v[248:251], a[184:187], v[60:63], v[248:251]
    v_cvt_pk_bf16_f32 v55, v110, v111
    v_min_f32 v90, v90, v70
    v_mfma_f32_16x16x32_bf16 v[220:223], a[188:191], v[56:59], v[220:223]
    buffer_load_dwordx4 a[44:47], v1, s[8:11], s74 offen offset:3072
    v_mfma_f32_16x16x32_bf16 v[252:255], a[188:191], v[60:63], v[252:255]
    v_add_f32 v91, 0x73500000, v21
    v_min_f32 v91, v91, v71
    v_add_f32 v92, 0, v21
    v_min_f32 v92, v92, v68
    s_waitcnt vmcnt(12) lgkmcnt(0)
    s_barrier
    v_mfma_f32_16x16x32_bf16 v[96:99], a[128:131], a[192:195], v[64:67]
    s_add_u32 m0, s15, 0
    ds_read_b128 a[160:163], v19 offset:0
    v_mfma_f32_16x16x32_bf16 v[96:99], a[132:135], a[196:199], v[96:99]
    ds_read_b128 a[164:167], v19 offset:1024
    v_mfma_f32_16x16x32_bf16 v[96:99], a[136:139], a[200:203], v[96:99]
    v_exp_f32 v112, v112
    v_mfma_f32_16x16x32_bf16 v[96:99], a[140:143], a[204:207], v[96:99]
    buffer_load_dwordx4 v1, s[8:11], s82 offen offset:0  lds
    v_mfma_f32_16x16x32_bf16 v[104:107], a[128:131], a[208:211], v[68:71]
    v_exp_f32 v113, v113
    v_mfma_f32_16x16x32_bf16 v[104:107], a[132:135], a[212:215], v[104:107]
    ds_read_b128 a[168:171], v19 offset:2048
    v_cvt_pk_bf16_f32 v56, v112, v113
    v_mfma_f32_16x16x32_bf16 v[104:107], a[136:139], a[216:219], v[104:107]
    v_exp_f32 v114, v114
    v_mfma_f32_16x16x32_bf16 v[104:107], a[140:143], a[220:223], v[104:107]
    buffer_load_dwordx4 v1, s[8:11], s82 offen offset:1024  lds
    v_mfma_f32_16x16x32_bf16 v[100:103], a[144:147], a[192:195], v[64:67]
    v_exp_f32 v115, v115
    v_mfma_f32_16x16x32_bf16 v[100:103], a[148:151], a[196:199], v[100:103]
    ds_read_b128 a[172:175], v19 offset:3072
    v_cvt_pk_bf16_f32 v57, v114, v115
    v_mfma_f32_16x16x32_bf16 v[100:103], a[152:155], a[200:203], v[100:103]
    v_exp_f32 v116, v116
    v_mfma_f32_16x16x32_bf16 v[100:103], a[156:159], a[204:207], v[100:103]
    buffer_load_dwordx4 v1, s[8:11], s82 offen offset:2048  lds
    v_mfma_f32_16x16x32_bf16 v[108:111], a[144:147], a[208:211], v[68:71]
    v_exp_f32 v117, v117
    v_mfma_f32_16x16x32_bf16 v[108:111], a[148:151], a[212:215], v[108:111]
    ds_read_b128 a[176:179], v20 offset:4096
    v_cvt_pk_bf16_f32 v58, v116, v117
    v_mfma_f32_16x16x32_bf16 v[108:111], a[152:155], a[216:219], v[108:111]
    v_exp_f32 v118, v118
    v_mfma_f32_16x16x32_bf16 v[108:111], a[156:159], a[220:223], v[108:111]
    buffer_load_dwordx4 v1, s[8:11], s82 offen offset:3072  lds
    v_mfma_f32_16x16x32_bf16 v[32:35], v[28:31], v[48:51], v[32:35]
    s_add_u32 m0, s15, 4096
    v_exp_f32 v119, v119
    v_mfma_f32_16x16x32_bf16 v[36:39], v[28:31], v[52:55], v[36:39]
    s_waitcnt lgkmcnt(4)
    ds_read_b128 a[180:183], v20 offset:5120
    v_cvt_pk_bf16_f32 v59, v118, v119
    v_mfma_f32_16x16x32_bf16 v[128:131], a[160:163], v[48:51], v[128:131]
    v_exp_f32 v120, v120
    v_mfma_f32_16x16x32_bf16 v[160:163], a[160:163], v[52:55], v[160:163]
    s_waitcnt lgkmcnt(4)
    v_mfma_f32_16x16x32_bf16 v[132:135], a[164:167], v[48:51], v[132:135]
    v_exp_f32 v121, v121
    v_mfma_f32_16x16x32_bf16 v[164:167], a[164:167], v[52:55], v[164:167]
    s_waitcnt lgkmcnt(3)
    ds_read_b128 a[184:187], v20 offset:6144
    v_cvt_pk_bf16_f32 v60, v120, v121
    v_mfma_f32_16x16x32_bf16 v[136:139], a[168:171], v[48:51], v[136:139]
    s_waitcnt lgkmcnt(3)
    v_exp_f32 v122, v122
    v_mfma_f32_16x16x32_bf16 v[168:171], a[168:171], v[52:55], v[168:171]
    buffer_load_dwordx4 v15, s[8:11], s82 offen offset:0  lds
    v_mfma_f32_16x16x32_bf16 v[140:143], a[172:175], v[48:51], v[140:143]
    v_exp_f32 v123, v123
    v_mfma_f32_16x16x32_bf16 v[172:175], a[172:175], v[52:55], v[172:175]
    s_waitcnt lgkmcnt(2)
    ds_read_b128 a[188:191], v20 offset:7168
    v_cvt_pk_bf16_f32 v61, v122, v123
    v_mfma_f32_16x16x32_bf16 v[144:147], a[176:179], v[48:51], v[144:147]
    s_waitcnt lgkmcnt(2)
    v_exp_f32 v124, v124
    v_mfma_f32_16x16x32_bf16 v[176:179], a[176:179], v[52:55], v[176:179]
    buffer_load_dwordx4 v15, s[8:11], s82 offen offset:1024  lds
    v_mfma_f32_16x16x32_bf16 v[148:151], a[180:183], v[48:51], v[148:151]
    v_exp_f32 v125, v125
    v_mfma_f32_16x16x32_bf16 v[180:183], a[180:183], v[52:55], v[180:183]
    s_waitcnt lgkmcnt(1)
    v_cvt_pk_bf16_f32 v62, v124, v125
    v_mfma_f32_16x16x32_bf16 v[152:155], a[184:187], v[48:51], v[152:155]
    s_waitcnt lgkmcnt(0)
    v_exp_f32 v126, v126
    v_mfma_f32_16x16x32_bf16 v[184:187], a[184:187], v[52:55], v[184:187]
    buffer_load_dwordx4 v15, s[8:11], s82 offen offset:2048  lds
    v_mfma_f32_16x16x32_bf16 v[156:159], a[188:191], v[48:51], v[156:159]
    v_exp_f32 v127, v127
    v_mfma_f32_16x16x32_bf16 v[188:191], a[188:191], v[52:55], v[188:191]
    v_cvt_pk_bf16_f32 v63, v126, v127
    v_mfma_f32_16x16x32_bf16 v[112:115], a[128:131], a[224:227], v[72:75]
    v_mfma_f32_16x16x32_bf16 v[112:115], a[132:135], a[228:231], v[112:115]
    v_mfma_f32_16x16x32_bf16 v[112:115], a[136:139], a[232:235], v[112:115]
    v_exp_f32 v96, v96
    v_mfma_f32_16x16x32_bf16 v[112:115], a[140:143], a[236:239], v[112:115]
    buffer_load_dwordx4 v15, s[8:11], s82 offen offset:3072  lds
    v_mfma_f32_16x16x32_bf16 v[120:123], a[128:131], a[240:243], v[76:79]
    s_xor_b32 s15, s15, 196608
    v_exp_f32 v97, v97
    v_mfma_f32_16x16x32_bf16 v[120:123], a[132:135], a[244:247], v[120:123]
    s_add_u32 m0, s16, 0
    ds_read_b128 a[128:131], v18 offset:0
    v_cvt_pk_bf16_f32 v48, v96, v97
    v_mfma_f32_16x16x32_bf16 v[120:123], a[136:139], a[248:251], v[120:123]
    v_exp_f32 v98, v98
    v_mfma_f32_16x16x32_bf16 v[120:123], a[140:143], a[252:255], v[120:123]
    buffer_load_dwordx4 v1, s[8:11], s19 offen offset:0  lds
    v_mfma_f32_16x16x32_bf16 v[116:119], a[144:147], a[224:227], v[72:75]
    v_exp_f32 v99, v99
    v_mfma_f32_16x16x32_bf16 v[116:119], a[148:151], a[228:231], v[116:119]
    ds_read_b128 a[132:135], v18 offset:1024
    v_cvt_pk_bf16_f32 v49, v98, v99
    v_mfma_f32_16x16x32_bf16 v[116:119], a[152:155], a[232:235], v[116:119]
    v_exp_f32 v100, v100
    v_mfma_f32_16x16x32_bf16 v[116:119], a[156:159], a[236:239], v[116:119]
    buffer_load_dwordx4 v1, s[8:11], s19 offen offset:1024  lds
    v_mfma_f32_16x16x32_bf16 v[124:127], a[144:147], a[240:243], v[76:79]
    v_exp_f32 v101, v101
    v_mfma_f32_16x16x32_bf16 v[124:127], a[148:151], a[244:247], v[124:127]
    ds_read_b128 a[136:139], v18 offset:2048
    v_cvt_pk_bf16_f32 v50, v100, v101
    v_mfma_f32_16x16x32_bf16 v[124:127], a[152:155], a[248:251], v[124:127]
    v_exp_f32 v102, v102
    v_mfma_f32_16x16x32_bf16 v[124:127], a[156:159], a[252:255], v[124:127]
    buffer_load_dwordx4 v1, s[8:11], s19 offen offset:2048  lds
    v_mfma_f32_16x16x32_bf16 v[40:43], v[28:31], v[56:59], v[40:43]
    v_exp_f32 v103, v103
    v_mfma_f32_16x16x32_bf16 v[44:47], v[28:31], v[60:63], v[44:47]
    ds_read_b128 a[140:143], v18 offset:3072
    v_cvt_pk_bf16_f32 v51, v102, v103
    v_mfma_f32_16x16x32_bf16 v[192:195], a[160:163], v[56:59], v[192:195]
    v_exp_f32 v104, v104
    v_mfma_f32_16x16x32_bf16 v[224:227], a[160:163], v[60:63], v[224:227]
    v_mfma_f32_16x16x32_bf16 v[196:199], a[164:167], v[56:59], v[196:199]
    v_exp_f32 v105, v105
    v_mfma_f32_16x16x32_bf16 v[228:231], a[164:167], v[60:63], v[228:231]
    ds_read_b128 a[144:147], v18 offset:4096
    v_cvt_pk_bf16_f32 v52, v104, v105
    v_mfma_f32_16x16x32_bf16 v[200:203], a[168:171], v[56:59], v[200:203]
    v_exp_f32 v106, v106
    v_mfma_f32_16x16x32_bf16 v[232:235], a[168:171], v[60:63], v[232:235]
    buffer_load_dwordx4 v1, s[8:11], s19 offen offset:3072  lds
    v_mfma_f32_16x16x32_bf16 v[204:207], a[172:175], v[56:59], v[204:207]
    s_add_u32 m0, s16, 4096
    v_exp_f32 v107, v107
    v_mfma_f32_16x16x32_bf16 v[236:239], a[172:175], v[60:63], v[236:239]
    ds_read_b128 a[148:151], v18 offset:5120
    v_cvt_pk_bf16_f32 v53, v106, v107
    v_mfma_f32_16x16x32_bf16 v[208:211], a[176:179], v[56:59], v[208:211]
    v_exp_f32 v108, v108
    v_mfma_f32_16x16x32_bf16 v[240:243], a[176:179], v[60:63], v[240:243]
    buffer_load_dwordx4 v15, s[8:11], s19 offen offset:0  lds
    v_mfma_f32_16x16x32_bf16 v[212:215], a[180:183], v[56:59], v[212:215]
    v_exp_f32 v109, v109
    v_mfma_f32_16x16x32_bf16 v[244:247], a[180:183], v[60:63], v[244:247]
    ds_read_b128 a[152:155], v18 offset:6144
    v_cvt_pk_bf16_f32 v54, v108, v109
    v_mfma_f32_16x16x32_bf16 v[216:219], a[184:187], v[56:59], v[216:219]
    v_exp_f32 v110, v110
    v_mfma_f32_16x16x32_bf16 v[248:251], a[184:187], v[60:63], v[248:251]
    buffer_load_dwordx4 v15, s[8:11], s19 offen offset:1024  lds
    v_mfma_f32_16x16x32_bf16 v[220:223], a[188:191], v[56:59], v[220:223]
    v_exp_f32 v111, v111
    v_mfma_f32_16x16x32_bf16 v[252:255], a[188:191], v[60:63], v[252:255]
    ds_read_b128 a[156:159], v18 offset:7168
    v_cvt_pk_bf16_f32 v55, v110, v111
    s_waitcnt lgkmcnt(7)
    v_mfma_f32_16x16x32_bf16 v[96:99], a[128:131], a[192:195], v[64:67]
    s_waitcnt lgkmcnt(6)
    ds_read_b128 a[160:163], v19 offset:16384
    v_add_f32 v93, 0xf1800000, v21
    v_mfma_f32_16x16x32_bf16 v[96:99], a[132:135], a[196:199], v[96:99]
    s_waitcnt lgkmcnt(6)
    ds_read_b128 a[164:167], v19 offset:17408
    v_min_f32 v93, v93, v69
    v_mfma_f32_16x16x32_bf16 v[96:99], a[136:139], a[200:203], v[96:99]
    s_waitcnt lgkmcnt(6)
    v_exp_f32 v112, v112
    v_mfma_f32_16x16x32_bf16 v[96:99], a[140:143], a[204:207], v[96:99]
    buffer_load_dwordx4 v15, s[8:11], s19 offen offset:2048  lds
    v_mfma_f32_16x16x32_bf16 v[104:107], a[128:131], a[208:211], v[68:71]
    v_exp_f32 v113, v113
    v_mfma_f32_16x16x32_bf16 v[104:107], a[132:135], a[212:215], v[104:107]
    ds_read_b128 a[168:171], v19 offset:18432
    v_cvt_pk_bf16_f32 v56, v112, v113
    v_mfma_f32_16x16x32_bf16 v[104:107], a[136:139], a[216:219], v[104:107]
    s_waitcnt lgkmcnt(6)
    v_exp_f32 v114, v114
    v_mfma_f32_16x16x32_bf16 v[104:107], a[140:143], a[220:223], v[104:107]
    buffer_load_dwordx4 v15, s[8:11], s19 offen offset:3072  lds
    v_mfma_f32_16x16x32_bf16 v[100:103], a[144:147], a[192:195], v[64:67]
    s_waitcnt lgkmcnt(5)
    s_xor_b32 s16, s16, 98304
    v_exp_f32 v115, v115
    v_mfma_f32_16x16x32_bf16 v[100:103], a[148:151], a[196:199], v[100:103]
    s_waitcnt lgkmcnt(4)
    s_xor_b32 s74, s24, 28672
    ds_read_b128 a[172:175], v19 offset:19456
    v_cvt_pk_bf16_f32 v57, v114, v115
    v_mfma_f32_16x16x32_bf16 v[100:103], a[152:155], a[200:203], v[100:103]
    s_waitcnt lgkmcnt(4)
    v_exp_f32 v116, v116
    v_mfma_f32_16x16x32_bf16 v[100:103], a[156:159], a[204:207], v[100:103]
    buffer_load_dwordx4 a[48:51], v1, s[8:11], s74 offen offset:0
    v_mfma_f32_16x16x32_bf16 v[108:111], a[144:147], a[208:211], v[68:71]
    s_xor_b32 s74, s24, 28672
    v_exp_f32 v117, v117
    v_mfma_f32_16x16x32_bf16 v[108:111], a[148:151], a[212:215], v[108:111]
    ds_read_b128 a[176:179], v20 offset:20480
    v_cvt_pk_bf16_f32 v58, v116, v117
    v_mfma_f32_16x16x32_bf16 v[108:111], a[152:155], a[216:219], v[108:111]
    v_exp_f32 v118, v118
    v_mfma_f32_16x16x32_bf16 v[108:111], a[156:159], a[220:223], v[108:111]
    buffer_load_dwordx4 a[52:55], v1, s[8:11], s74 offen offset:1024
    v_mfma_f32_16x16x32_bf16 v[32:35], v[28:31], v[48:51], v[32:35]
    s_xor_b32 s74, s24, 28672
    v_exp_f32 v119, v119
    v_mfma_f32_16x16x32_bf16 v[36:39], v[28:31], v[52:55], v[36:39]
    s_waitcnt lgkmcnt(4)
    ds_read_b128 a[180:183], v20 offset:21504
    v_cvt_pk_bf16_f32 v59, v118, v119
    v_mfma_f32_16x16x32_bf16 v[128:131], a[160:163], v[48:51], v[128:131]
    s_waitcnt lgkmcnt(4)
    v_exp_f32 v120, v120
    v_mfma_f32_16x16x32_bf16 v[160:163], a[160:163], v[52:55], v[160:163]
    buffer_load_dwordx4 a[56:59], v1, s[8:11], s74 offen offset:2048
    v_mfma_f32_16x16x32_bf16 v[132:135], a[164:167], v[48:51], v[132:135]
    s_xor_b32 s74, s24, 28672
    v_exp_f32 v121, v121
    v_mfma_f32_16x16x32_bf16 v[164:167], a[164:167], v[52:55], v[164:167]
    s_waitcnt lgkmcnt(3)
    ds_read_b128 a[184:187], v20 offset:22528
    v_cvt_pk_bf16_f32 v60, v120, v121
    v_mfma_f32_16x16x32_bf16 v[136:139], a[168:171], v[48:51], v[136:139]
    s_waitcnt lgkmcnt(3)
    v_exp_f32 v122, v122
    v_mfma_f32_16x16x32_bf16 v[168:171], a[168:171], v[52:55], v[168:171]
    buffer_load_dwordx4 a[60:63], v1, s[8:11], s74 offen offset:3072
    v_mfma_f32_16x16x32_bf16 v[140:143], a[172:175], v[48:51], v[140:143]
    v_exp_f32 v123, v123
    v_mfma_f32_16x16x32_bf16 v[172:175], a[172:175], v[52:55], v[172:175]
    s_waitcnt lgkmcnt(2)
    ds_read_b128 a[188:191], v20 offset:23552
    v_cvt_pk_bf16_f32 v61, v122, v123
    v_mfma_f32_16x16x32_bf16 v[144:147], a[176:179], v[48:51], v[144:147]
    v_exp_f32 v124, v124
    v_mfma_f32_16x16x32_bf16 v[176:179], a[176:179], v[52:55], v[176:179]
    s_waitcnt lgkmcnt(2)
    v_add_f32 v94, 0xf2000000, v21
    v_min_f32 v94, v94, v70
    v_mfma_f32_16x16x32_bf16 v[148:151], a[180:183], v[48:51], v[148:151]
    v_exp_f32 v125, v125
    v_mfma_f32_16x16x32_bf16 v[180:183], a[180:183], v[52:55], v[180:183]
    s_waitcnt lgkmcnt(1)
    v_cvt_pk_bf16_f32 v62, v124, v125
    v_xor_b32 v19, 98304, v19
    v_mfma_f32_16x16x32_bf16 v[152:155], a[184:187], v[48:51], v[152:155]
    v_exp_f32 v126, v126
    v_mfma_f32_16x16x32_bf16 v[184:187], a[184:187], v[52:55], v[184:187]
    s_waitcnt lgkmcnt(0)
    v_xor_b32 v20, 98304, v20
    v_add_f32 v95, 0xf2400000, v21
    v_mfma_f32_16x16x32_bf16 v[156:159], a[188:191], v[48:51], v[156:159]
    v_exp_f32 v127, v127
    v_mfma_f32_16x16x32_bf16 v[188:191], a[188:191], v[52:55], v[188:191]
    v_cvt_pk_bf16_f32 v63, v126, v127
    v_min_f32 v95, v95, v71
    v_mfma_f32_16x16x32_bf16 v[112:115], a[128:131], a[224:227], v[72:75]
    v_exp_f32 v96, v96
    v_mfma_f32_16x16x32_bf16 v[112:115], a[132:135], a[228:231], v[112:115]
    v_mfma_f32_16x16x32_bf16 v[112:115], a[136:139], a[232:235], v[112:115]
    v_exp_f32 v97, v97
    v_mfma_f32_16x16x32_bf16 v[112:115], a[140:143], a[236:239], v[112:115]
    v_cvt_pk_bf16_f32 v48, v96, v97
    v_mfma_f32_16x16x32_bf16 v[120:123], a[128:131], a[240:243], v[76:79]
    v_exp_f32 v98, v98
    v_mfma_f32_16x16x32_bf16 v[120:123], a[132:135], a[244:247], v[120:123]
    v_mfma_f32_16x16x32_bf16 v[120:123], a[136:139], a[248:251], v[120:123]
    v_exp_f32 v99, v99
    v_mfma_f32_16x16x32_bf16 v[120:123], a[140:143], a[252:255], v[120:123]
    v_mfma_f32_16x16x32_bf16 v[116:119], a[144:147], a[224:227], v[72:75]
    v_exp_f32 v100, v100
    v_mfma_f32_16x16x32_bf16 v[116:119], a[148:151], a[228:231], v[116:119]
    ds_read_b128 a[128:131], v18 offset:16384
    v_cvt_pk_bf16_f32 v49, v98, v99
    v_mfma_f32_16x16x32_bf16 v[116:119], a[152:155], a[232:235], v[116:119]
    s_add_u32 s19, s82, 32768
    v_exp_f32 v101, v101
    v_mfma_f32_16x16x32_bf16 v[116:119], a[156:159], a[236:239], v[116:119]
    s_sub_u32 s82, s12, s13
    ds_read_b128 a[132:135], v18 offset:17408
    v_cvt_pk_bf16_f32 v50, v100, v101
    v_mfma_f32_16x16x32_bf16 v[124:127], a[144:147], a[240:243], v[76:79]
    s_sub_u32 s82, s82, 1
    v_exp_f32 v102, v102
    v_mfma_f32_16x16x32_bf16 v[124:127], a[148:151], a[244:247], v[124:127]
    s_cmp_gt_u32 s12, s13
    s_cselect_b32 s82, s82, s12
    s_mul_i32 s82, s82, 65536
    ds_read_b128 a[136:139], v18 offset:18432
    v_mfma_f32_16x16x32_bf16 v[124:127], a[152:155], a[248:251], v[124:127]
    s_add_u32 s82, s82, s81
    v_exp_f32 v103, v103
    v_mfma_f32_16x16x32_bf16 v[124:127], a[156:159], a[252:255], v[124:127]
    s_cmp_ge_u32 s12, 17
    s_cselect_b32 s82, 2147471360, s82
    ds_read_b128 a[140:143], v18 offset:19456
    v_cvt_pk_bf16_f32 v51, v102, v103
    v_mfma_f32_16x16x32_bf16 v[40:43], v[28:31], v[56:59], v[40:43]
    s_add_u32 s12, s12, 1
    v_exp_f32 v104, v104
    v_mfma_f32_16x16x32_bf16 v[44:47], v[28:31], v[60:63], v[44:47]
    ds_read_b128 a[144:147], v18 offset:20480
    v_mfma_f32_16x16x32_bf16 v[192:195], a[160:163], v[56:59], v[192:195]
    v_exp_f32 v105, v105
    v_mfma_f32_16x16x32_bf16 v[224:227], a[160:163], v[60:63], v[224:227]
    ds_read_b128 a[148:151], v18 offset:21504
    v_cvt_pk_bf16_f32 v52, v104, v105
    v_mfma_f32_16x16x32_bf16 v[196:199], a[164:167], v[56:59], v[196:199]
    v_exp_f32 v106, v106
    v_mfma_f32_16x16x32_bf16 v[228:231], a[164:167], v[60:63], v[228:231]
    ds_read_b128 a[152:155], v18 offset:22528
    v_mfma_f32_16x16x32_bf16 v[200:203], a[168:171], v[56:59], v[200:203]
    v_exp_f32 v107, v107
    v_mfma_f32_16x16x32_bf16 v[232:235], a[168:171], v[60:63], v[232:235]
    ds_read_b128 a[156:159], v18 offset:23552
    v_cvt_pk_bf16_f32 v53, v106, v107
    v_mfma_f32_16x16x32_bf16 v[204:207], a[172:175], v[56:59], v[204:207]
    v_exp_f32 v108, v108
    v_mfma_f32_16x16x32_bf16 v[236:239], a[172:175], v[60:63], v[236:239]
    v_mfma_f32_16x16x32_bf16 v[208:211], a[176:179], v[56:59], v[208:211]
    v_exp_f32 v109, v109
    v_mfma_f32_16x16x32_bf16 v[240:243], a[176:179], v[60:63], v[240:243]
    v_cvt_pk_bf16_f32 v54, v108, v109
    v_xor_b32 v18, 196608, v18
    v_mfma_f32_16x16x32_bf16 v[212:215], a[180:183], v[56:59], v[212:215]
    v_exp_f32 v110, v110
    v_mfma_f32_16x16x32_bf16 v[244:247], a[180:183], v[60:63], v[244:247]
    v_mfma_f32_16x16x32_bf16 v[216:219], a[184:187], v[56:59], v[216:219]
    v_exp_f32 v111, v111
    v_mfma_f32_16x16x32_bf16 v[248:251], a[184:187], v[60:63], v[248:251]
    v_cvt_pk_bf16_f32 v55, v110, v111
    v_mfma_f32_16x16x32_bf16 v[220:223], a[188:191], v[56:59], v[220:223]
    v_mfma_f32_16x16x32_bf16 v[252:255], a[188:191], v[60:63], v[252:255]
    s_waitcnt vmcnt(4) lgkmcnt(0)
    s_barrier
    v_mfma_f32_16x16x32_bf16 v[96:99], a[128:131], a[192:195], v[64:67]
    s_add_u32 m0, s15, 0
    ds_read_b128 a[160:163], v19 offset:0
    v_mfma_f32_16x16x32_bf16 v[96:99], a[132:135], a[196:199], v[96:99]
    ds_read_b128 a[164:167], v19 offset:1024
    v_mfma_f32_16x16x32_bf16 v[96:99], a[136:139], a[200:203], v[96:99]
    v_exp_f32 v112, v112
    v_mfma_f32_16x16x32_bf16 v[96:99], a[140:143], a[204:207], v[96:99]
    buffer_load_dwordx4 v1, s[8:11], s82 offen offset:0  lds
    v_mfma_f32_16x16x32_bf16 v[104:107], a[128:131], a[208:211], v[68:71]
    v_exp_f32 v113, v113
    v_mfma_f32_16x16x32_bf16 v[104:107], a[132:135], a[212:215], v[104:107]
    ds_read_b128 a[168:171], v19 offset:2048
    v_cvt_pk_bf16_f32 v56, v112, v113
    v_mfma_f32_16x16x32_bf16 v[104:107], a[136:139], a[216:219], v[104:107]
    v_exp_f32 v114, v114
    v_mfma_f32_16x16x32_bf16 v[104:107], a[140:143], a[220:223], v[104:107]
    buffer_load_dwordx4 v1, s[8:11], s82 offen offset:1024  lds
    v_mfma_f32_16x16x32_bf16 v[100:103], a[144:147], a[192:195], v[64:67]
    v_exp_f32 v115, v115
    v_mfma_f32_16x16x32_bf16 v[100:103], a[148:151], a[196:199], v[100:103]
    ds_read_b128 a[172:175], v19 offset:3072
    v_cvt_pk_bf16_f32 v57, v114, v115
    v_mfma_f32_16x16x32_bf16 v[100:103], a[152:155], a[200:203], v[100:103]
    v_exp_f32 v116, v116
    v_mfma_f32_16x16x32_bf16 v[100:103], a[156:159], a[204:207], v[100:103]
    buffer_load_dwordx4 v1, s[8:11], s82 offen offset:2048  lds
    v_mfma_f32_16x16x32_bf16 v[108:111], a[144:147], a[208:211], v[68:71]
    v_exp_f32 v117, v117
    v_mfma_f32_16x16x32_bf16 v[108:111], a[148:151], a[212:215], v[108:111]
    ds_read_b128 a[176:179], v20 offset:4096
    v_cvt_pk_bf16_f32 v58, v116, v117
    v_mfma_f32_16x16x32_bf16 v[108:111], a[152:155], a[216:219], v[108:111]
    v_exp_f32 v118, v118
    v_mfma_f32_16x16x32_bf16 v[108:111], a[156:159], a[220:223], v[108:111]
    buffer_load_dwordx4 v1, s[8:11], s82 offen offset:3072  lds
    v_mfma_f32_16x16x32_bf16 v[32:35], v[28:31], v[48:51], v[32:35]
    s_add_u32 m0, s15, 4096
    v_exp_f32 v119, v119
    v_mfma_f32_16x16x32_bf16 v[36:39], v[28:31], v[52:55], v[36:39]
    s_waitcnt lgkmcnt(4)
    ds_read_b128 a[180:183], v20 offset:5120
    v_cvt_pk_bf16_f32 v59, v118, v119
    v_mfma_f32_16x16x32_bf16 v[128:131], a[160:163], v[48:51], v[128:131]
    v_exp_f32 v120, v120
    v_mfma_f32_16x16x32_bf16 v[160:163], a[160:163], v[52:55], v[160:163]
    s_waitcnt lgkmcnt(4)
    v_mfma_f32_16x16x32_bf16 v[132:135], a[164:167], v[48:51], v[132:135]
    v_exp_f32 v121, v121
    v_mfma_f32_16x16x32_bf16 v[164:167], a[164:167], v[52:55], v[164:167]
    s_waitcnt lgkmcnt(3)
    ds_read_b128 a[184:187], v20 offset:6144
    v_cvt_pk_bf16_f32 v60, v120, v121
    v_mfma_f32_16x16x32_bf16 v[136:139], a[168:171], v[48:51], v[136:139]
    s_waitcnt lgkmcnt(3)
    v_exp_f32 v122, v122
    v_mfma_f32_16x16x32_bf16 v[168:171], a[168:171], v[52:55], v[168:171]
    buffer_load_dwordx4 v15, s[8:11], s82 offen offset:0  lds
    v_mfma_f32_16x16x32_bf16 v[140:143], a[172:175], v[48:51], v[140:143]
    v_exp_f32 v123, v123
    v_mfma_f32_16x16x32_bf16 v[172:175], a[172:175], v[52:55], v[172:175]
    s_waitcnt lgkmcnt(2)
    ds_read_b128 a[188:191], v20 offset:7168
    v_cvt_pk_bf16_f32 v61, v122, v123
    v_mfma_f32_16x16x32_bf16 v[144:147], a[176:179], v[48:51], v[144:147]
    s_waitcnt lgkmcnt(2)
    v_exp_f32 v124, v124
    v_mfma_f32_16x16x32_bf16 v[176:179], a[176:179], v[52:55], v[176:179]
    buffer_load_dwordx4 v15, s[8:11], s82 offen offset:1024  lds
    v_mfma_f32_16x16x32_bf16 v[148:151], a[180:183], v[48:51], v[148:151]
    v_exp_f32 v125, v125
    v_mfma_f32_16x16x32_bf16 v[180:183], a[180:183], v[52:55], v[180:183]
    s_waitcnt lgkmcnt(1)
    v_cvt_pk_bf16_f32 v62, v124, v125
    v_mfma_f32_16x16x32_bf16 v[152:155], a[184:187], v[48:51], v[152:155]
    s_waitcnt lgkmcnt(0)
    v_exp_f32 v126, v126
    v_mfma_f32_16x16x32_bf16 v[184:187], a[184:187], v[52:55], v[184:187]
    buffer_load_dwordx4 v15, s[8:11], s82 offen offset:2048  lds
    v_mfma_f32_16x16x32_bf16 v[156:159], a[188:191], v[48:51], v[156:159]
    v_exp_f32 v127, v127
    v_mfma_f32_16x16x32_bf16 v[188:191], a[188:191], v[52:55], v[188:191]
    v_cvt_pk_bf16_f32 v63, v126, v127
    v_mfma_f32_16x16x32_bf16 v[112:115], a[128:131], a[224:227], v[72:75]
    v_mfma_f32_16x16x32_bf16 v[112:115], a[132:135], a[228:231], v[112:115]
    v_mfma_f32_16x16x32_bf16 v[112:115], a[136:139], a[232:235], v[112:115]
    v_exp_f32 v96, v96
    v_mfma_f32_16x16x32_bf16 v[112:115], a[140:143], a[236:239], v[112:115]
    buffer_load_dwordx4 v15, s[8:11], s82 offen offset:3072  lds
    v_mfma_f32_16x16x32_bf16 v[120:123], a[128:131], a[240:243], v[76:79]
    s_xor_b32 s15, s15, 196608
    v_exp_f32 v97, v97
    v_mfma_f32_16x16x32_bf16 v[120:123], a[132:135], a[244:247], v[120:123]
    s_add_u32 m0, s16, 0
    ds_read_b128 a[128:131], v18 offset:0
    v_cvt_pk_bf16_f32 v48, v96, v97
    v_mfma_f32_16x16x32_bf16 v[120:123], a[136:139], a[248:251], v[120:123]
    v_exp_f32 v98, v98
    v_mfma_f32_16x16x32_bf16 v[120:123], a[140:143], a[252:255], v[120:123]
    buffer_load_dwordx4 v1, s[8:11], s19 offen offset:0  lds
    v_mfma_f32_16x16x32_bf16 v[116:119], a[144:147], a[224:227], v[72:75]
    v_exp_f32 v99, v99
    v_mfma_f32_16x16x32_bf16 v[116:119], a[148:151], a[228:231], v[116:119]
    ds_read_b128 a[132:135], v18 offset:1024
    v_cvt_pk_bf16_f32 v49, v98, v99
    v_mfma_f32_16x16x32_bf16 v[116:119], a[152:155], a[232:235], v[116:119]
    v_exp_f32 v100, v100
    v_mfma_f32_16x16x32_bf16 v[116:119], a[156:159], a[236:239], v[116:119]
    buffer_load_dwordx4 v1, s[8:11], s19 offen offset:1024  lds
    v_mfma_f32_16x16x32_bf16 v[124:127], a[144:147], a[240:243], v[76:79]
    v_exp_f32 v101, v101
    v_mfma_f32_16x16x32_bf16 v[124:127], a[148:151], a[244:247], v[124:127]
    ds_read_b128 a[136:139], v18 offset:2048
    v_cvt_pk_bf16_f32 v50, v100, v101
    v_mfma_f32_16x16x32_bf16 v[124:127], a[152:155], a[248:251], v[124:127]
    v_exp_f32 v102, v102
    v_mfma_f32_16x16x32_bf16 v[124:127], a[156:159], a[252:255], v[124:127]
    buffer_load_dwordx4 v1, s[8:11], s19 offen offset:2048  lds
    v_mfma_f32_16x16x32_bf16 v[40:43], v[28:31], v[56:59], v[40:43]
    v_exp_f32 v103, v103
    v_mfma_f32_16x16x32_bf16 v[44:47], v[28:31], v[60:63], v[44:47]
    ds_read_b128 a[140:143], v18 offset:3072
    v_cvt_pk_bf16_f32 v51, v102, v103
    v_mfma_f32_16x16x32_bf16 v[192:195], a[160:163], v[56:59], v[192:195]
    v_exp_f32 v104, v104
    v_mfma_f32_16x16x32_bf16 v[224:227], a[160:163], v[60:63], v[224:227]
    v_mfma_f32_16x16x32_bf16 v[196:199], a[164:167], v[56:59], v[196:199]
    v_exp_f32 v105, v105
    v_mfma_f32_16x16x32_bf16 v[228:231], a[164:167], v[60:63], v[228:231]
    ds_read_b128 a[144:147], v18 offset:4096
    v_cvt_pk_bf16_f32 v52, v104, v105
    v_mfma_f32_16x16x32_bf16 v[200:203], a[168:171], v[56:59], v[200:203]
    v_exp_f32 v106, v106
    v_mfma_f32_16x16x32_bf16 v[232:235], a[168:171], v[60:63], v[232:235]
    buffer_load_dwordx4 v1, s[8:11], s19 offen offset:3072  lds
    v_mfma_f32_16x16x32_bf16 v[204:207], a[172:175], v[56:59], v[204:207]
    s_add_u32 m0, s16, 4096
    v_exp_f32 v107, v107
    v_mfma_f32_16x16x32_bf16 v[236:239], a[172:175], v[60:63], v[236:239]
    ds_read_b128 a[148:151], v18 offset:5120
    v_cvt_pk_bf16_f32 v53, v106, v107
    v_mfma_f32_16x16x32_bf16 v[208:211], a[176:179], v[56:59], v[208:211]
    v_exp_f32 v108, v108
    v_mfma_f32_16x16x32_bf16 v[240:243], a[176:179], v[60:63], v[240:243]
    buffer_load_dwordx4 v15, s[8:11], s19 offen offset:0  lds
    v_mfma_f32_16x16x32_bf16 v[212:215], a[180:183], v[56:59], v[212:215]
    v_exp_f32 v109, v109
    v_mfma_f32_16x16x32_bf16 v[244:247], a[180:183], v[60:63], v[244:247]
    ds_read_b128 a[152:155], v18 offset:6144
    v_cvt_pk_bf16_f32 v54, v108, v109
    v_mfma_f32_16x16x32_bf16 v[216:219], a[184:187], v[56:59], v[216:219]
    v_exp_f32 v110, v110
    v_mfma_f32_16x16x32_bf16 v[248:251], a[184:187], v[60:63], v[248:251]
    buffer_load_dwordx4 v15, s[8:11], s19 offen offset:1024  lds
    v_mfma_f32_16x16x32_bf16 v[220:223], a[188:191], v[56:59], v[220:223]
    v_exp_f32 v111, v111
    v_mfma_f32_16x16x32_bf16 v[252:255], a[188:191], v[60:63], v[252:255]
    ds_read_b128 a[156:159], v18 offset:7168
    v_cvt_pk_bf16_f32 v55, v110, v111
    s_cmp_eq_u32 s14, 0
    s_cbranch_scc1 L_t2_diag
.p2align 3
L_t2_loop:
    s_waitcnt lgkmcnt(7)
    v_mfma_f32_16x16x32_bf16 v[96:99], a[128:131], a[192:195], v[64:67]
    s_waitcnt lgkmcnt(6)
    ds_read_b128 a[160:163], v19 offset:16384
    v_mfma_f32_16x16x32_bf16 v[96:99], a[132:135], a[196:199], v[96:99]
    s_waitcnt lgkmcnt(6)
    ds_read_b128 a[164:167], v19 offset:17408
    v_mfma_f32_16x16x32_bf16 v[96:99], a[136:139], a[200:203], v[96:99]
    s_waitcnt lgkmcnt(6)
    v_exp_f32 v112, v112
    v_mfma_f32_16x16x32_bf16 v[96:99], a[140:143], a[204:207], v[96:99]
    buffer_load_dwordx4 v15, s[8:11], s19 offen offset:2048  lds
    v_mfma_f32_16x16x32_bf16 v[104:107], a[128:131], a[208:211], v[68:71]
    v_exp_f32 v113, v113
    v_mfma_f32_16x16x32_bf16 v[104:107], a[132:135], a[212:215], v[104:107]
    ds_read_b128 a[168:171], v19 offset:18432
    v_cvt_pk_bf16_f32 v56, v112, v113
    v_mfma_f32_16x16x32_bf16 v[104:107], a[136:139], a[216:219], v[104:107]
    s_waitcnt lgkmcnt(6)
    v_exp_f32 v114, v114
    v_mfma_f32_16x16x32_bf16 v[104:107], a[140:143], a[220:223], v[104:107]
    buffer_load_dwordx4 v15, s[8:11], s19 offen offset:3072  lds
    v_mfma_f32_16x16x32_bf16 v[100:103], a[144:147], a[192:195], v[64:67]
    s_waitcnt lgkmcnt(5)
    s_xor_b32 s16, s16, 98304
    v_exp_f32 v115, v115
    v_mfma_f32_16x16x32_bf16 v[100:103], a[148:151], a[196:199], v[100:103]
    s_waitcnt lgkmcnt(4)
    ds_read_b128 a[172:175], v19 offset:19456
    v_cvt_pk_bf16_f32 v57, v114, v115
    v_mfma_f32_16x16x32_bf16 v[100:103], a[152:155], a[200:203], v[100:103]
    s_waitcnt lgkmcnt(4)
    v_exp_f32 v116, v116
    v_mfma_f32_16x16x32_bf16 v[100:103], a[156:159], a[204:207], v[100:103]
    v_mfma_f32_16x16x32_bf16 v[108:111], a[144:147], a[208:211], v[68:71]
    v_exp_f32 v117, v117
    v_mfma_f32_16x16x32_bf16 v[108:111], a[148:151], a[212:215], v[108:111]
    ds_read_b128 a[176:179], v20 offset:20480
    v_cvt_pk_bf16_f32 v58, v116, v117
    v_mfma_f32_16x16x32_bf16 v[108:111], a[152:155], a[216:219], v[108:111]
    v_exp_f32 v118, v118
    v_mfma_f32_16x16x32_bf16 v[108:111], a[156:159], a[220:223], v[108:111]
    v_mfma_f32_16x16x32_bf16 v[32:35], v[28:31], v[48:51], v[32:35]
    v_exp_f32 v119, v119
    v_mfma_f32_16x16x32_bf16 v[36:39], v[28:31], v[52:55], v[36:39]
    s_waitcnt lgkmcnt(4)
    ds_read_b128 a[180:183], v20 offset:21504
    v_cvt_pk_bf16_f32 v59, v118, v119
    v_mfma_f32_16x16x32_bf16 v[128:131], a[160:163], v[48:51], v[128:131]
    v_exp_f32 v120, v120
    v_mfma_f32_16x16x32_bf16 v[160:163], a[160:163], v[52:55], v[160:163]
    s_waitcnt lgkmcnt(4)
    v_mfma_f32_16x16x32_bf16 v[132:135], a[164:167], v[48:51], v[132:135]
    v_exp_f32 v121, v121
    v_mfma_f32_16x16x32_bf16 v[164:167], a[164:167], v[52:55], v[164:167]
    s_waitcnt lgkmcnt(3)
    ds_read_b128 a[184:187], v20 offset:22528
    v_cvt_pk_bf16_f32 v60, v120, v121
    v_mfma_f32_16x16x32_bf16 v[136:139], a[168:171], v[48:51], v[136:139]
    v_exp_f32 v122, v122
    v_mfma_f32_16x16x32_bf16 v[168:171], a[168:171], v[52:55], v[168:171]
    s_waitcnt lgkmcnt(3)
    v_mfma_f32_16x16x32_bf16 v[140:143], a[172:175], v[48:51], v[140:143]
    v_exp_f32 v123, v123
    v_mfma_f32_16x16x32_bf16 v[172:175], a[172:175], v[52:55], v[172:175]
    s_waitcnt lgkmcnt(2)
    ds_read_b128 a[188:191], v20 offset:23552
    v_cvt_pk_bf16_f32 v61, v122, v123
    v_mfma_f32_16x16x32_bf16 v[144:147], a[176:179], v[48:51], v[144:147]
    v_exp_f32 v124, v124
    v_mfma_f32_16x16x32_bf16 v[176:179], a[176:179], v[52:55], v[176:179]
    s_waitcnt lgkmcnt(2)
    v_mfma_f32_16x16x32_bf16 v[148:151], a[180:183], v[48:51], v[148:151]
    v_exp_f32 v125, v125
    v_mfma_f32_16x16x32_bf16 v[180:183], a[180:183], v[52:55], v[180:183]
    s_waitcnt lgkmcnt(1)
    v_cvt_pk_bf16_f32 v62, v124, v125
    v_xor_b32 v19, 98304, v19
    v_mfma_f32_16x16x32_bf16 v[152:155], a[184:187], v[48:51], v[152:155]
    v_exp_f32 v126, v126
    v_mfma_f32_16x16x32_bf16 v[184:187], a[184:187], v[52:55], v[184:187]
    s_waitcnt lgkmcnt(0)
    v_xor_b32 v20, 98304, v20
    v_mfma_f32_16x16x32_bf16 v[156:159], a[188:191], v[48:51], v[156:159]
    v_exp_f32 v127, v127
    v_mfma_f32_16x16x32_bf16 v[188:191], a[188:191], v[52:55], v[188:191]
    v_cvt_pk_bf16_f32 v63, v126, v127
    v_mfma_f32_16x16x32_bf16 v[112:115], a[128:131], a[224:227], v[72:75]
    v_exp_f32 v96, v96
    v_mfma_f32_16x16x32_bf16 v[112:115], a[132:135], a[228:231], v[112:115]
    v_mfma_f32_16x16x32_bf16 v[112:115], a[136:139], a[232:235], v[112:115]
    v_exp_f32 v97, v97
    v_mfma_f32_16x16x32_bf16 v[112:115], a[140:143], a[236:239], v[112:115]
    v_cvt_pk_bf16_f32 v48, v96, v97
    v_mfma_f32_16x16x32_bf16 v[120:123], a[128:131], a[240:243], v[76:79]
    v_exp_f32 v98, v98
    v_mfma_f32_16x16x32_bf16 v[120:123], a[132:135], a[244:247], v[120:123]
    v_mfma_f32_16x16x32_bf16 v[120:123], a[136:139], a[248:251], v[120:123]
    v_exp_f32 v99, v99
    v_mfma_f32_16x16x32_bf16 v[120:123], a[140:143], a[252:255], v[120:123]
    v_mfma_f32_16x16x32_bf16 v[116:119], a[144:147], a[224:227], v[72:75]
    v_exp_f32 v100, v100
    v_mfma_f32_16x16x32_bf16 v[116:119], a[148:151], a[228:231], v[116:119]
    ds_read_b128 a[128:131], v18 offset:16384
    v_cvt_pk_bf16_f32 v49, v98, v99
    v_mfma_f32_16x16x32_bf16 v[116:119], a[152:155], a[232:235], v[116:119]
    s_add_u32 s19, s82, 32768
    v_exp_f32 v101, v101
    v_mfma_f32_16x16x32_bf16 v[116:119], a[156:159], a[236:239], v[116:119]
    s_sub_u32 s82, s12, s13
    ds_read_b128 a[132:135], v18 offset:17408
    v_cvt_pk_bf16_f32 v50, v100, v101
    v_mfma_f32_16x16x32_bf16 v[124:127], a[144:147], a[240:243], v[76:79]
    s_sub_u32 s82, s82, 1
    v_exp_f32 v102, v102
    v_mfma_f32_16x16x32_bf16 v[124:127], a[148:151], a[244:247], v[124:127]
    s_cmp_gt_u32 s12, s13
    s_cselect_b32 s82, s82, s12
    s_mul_i32 s82, s82, 65536
    ds_read_b128 a[136:139], v18 offset:18432
    v_mfma_f32_16x16x32_bf16 v[124:127], a[152:155], a[248:251], v[124:127]
    s_add_u32 s82, s82, s81
    v_exp_f32 v103, v103
    v_mfma_f32_16x16x32_bf16 v[124:127], a[156:159], a[252:255], v[124:127]
    s_cmp_ge_u32 s12, 17
    s_cselect_b32 s82, 2147471360, s82
    ds_read_b128 a[140:143], v18 offset:19456
    v_cvt_pk_bf16_f32 v51, v102, v103
    v_mfma_f32_16x16x32_bf16 v[40:43], v[28:31], v[56:59], v[40:43]
    s_add_u32 s12, s12, 1
    v_exp_f32 v104, v104
    v_mfma_f32_16x16x32_bf16 v[44:47], v[28:31], v[60:63], v[44:47]
    ds_read_b128 a[144:147], v18 offset:20480
    v_mfma_f32_16x16x32_bf16 v[192:195], a[160:163], v[56:59], v[192:195]
    v_exp_f32 v105, v105
    v_mfma_f32_16x16x32_bf16 v[224:227], a[160:163], v[60:63], v[224:227]
    ds_read_b128 a[148:151], v18 offset:21504
    v_cvt_pk_bf16_f32 v52, v104, v105
    v_mfma_f32_16x16x32_bf16 v[196:199], a[164:167], v[56:59], v[196:199]
    v_exp_f32 v106, v106
    v_mfma_f32_16x16x32_bf16 v[228:231], a[164:167], v[60:63], v[228:231]
    ds_read_b128 a[152:155], v18 offset:22528
    v_mfma_f32_16x16x32_bf16 v[200:203], a[168:171], v[56:59], v[200:203]
    v_exp_f32 v107, v107
    v_mfma_f32_16x16x32_bf16 v[232:235], a[168:171], v[60:63], v[232:235]
    ds_read_b128 a[156:159], v18 offset:23552
    v_cvt_pk_bf16_f32 v53, v106, v107
    v_mfma_f32_16x16x32_bf16 v[204:207], a[172:175], v[56:59], v[204:207]
    v_exp_f32 v108, v108
    v_mfma_f32_16x16x32_bf16 v[236:239], a[172:175], v[60:63], v[236:239]
    v_mfma_f32_16x16x32_bf16 v[208:211], a[176:179], v[56:59], v[208:211]
    v_exp_f32 v109, v109
    v_mfma_f32_16x16x32_bf16 v[240:243], a[176:179], v[60:63], v[240:243]
    v_cvt_pk_bf16_f32 v54, v108, v109
    v_xor_b32 v18, 196608, v18
    v_mfma_f32_16x16x32_bf16 v[212:215], a[180:183], v[56:59], v[212:215]
    v_exp_f32 v110, v110
    v_mfma_f32_16x16x32_bf16 v[244:247], a[180:183], v[60:63], v[244:247]
    v_mfma_f32_16x16x32_bf16 v[216:219], a[184:187], v[56:59], v[216:219]
    v_exp_f32 v111, v111
    v_mfma_f32_16x16x32_bf16 v[248:251], a[184:187], v[60:63], v[248:251]
    v_cvt_pk_bf16_f32 v55, v110, v111
    v_mfma_f32_16x16x32_bf16 v[220:223], a[188:191], v[56:59], v[220:223]
    v_mfma_f32_16x16x32_bf16 v[252:255], a[188:191], v[60:63], v[252:255]
    s_waitcnt vmcnt(0) lgkmcnt(0)
    s_barrier
    v_mfma_f32_16x16x32_bf16 v[96:99], a[128:131], a[192:195], v[64:67]
    s_add_u32 m0, s15, 0
    ds_read_b128 a[160:163], v19 offset:0
    v_mfma_f32_16x16x32_bf16 v[96:99], a[132:135], a[196:199], v[96:99]
    ds_read_b128 a[164:167], v19 offset:1024
    v_mfma_f32_16x16x32_bf16 v[96:99], a[136:139], a[200:203], v[96:99]
    v_exp_f32 v112, v112
    v_mfma_f32_16x16x32_bf16 v[96:99], a[140:143], a[204:207], v[96:99]
    buffer_load_dwordx4 v1, s[8:11], s82 offen offset:0  lds
    v_mfma_f32_16x16x32_bf16 v[104:107], a[128:131], a[208:211], v[68:71]
    v_exp_f32 v113, v113
    v_mfma_f32_16x16x32_bf16 v[104:107], a[132:135], a[212:215], v[104:107]
    ds_read_b128 a[168:171], v19 offset:2048
    v_cvt_pk_bf16_f32 v56, v112, v113
    v_mfma_f32_16x16x32_bf16 v[104:107], a[136:139], a[216:219], v[104:107]
    v_exp_f32 v114, v114
    v_mfma_f32_16x16x32_bf16 v[104:107], a[140:143], a[220:223], v[104:107]
    buffer_load_dwordx4 v1, s[8:11], s82 offen offset:1024  lds
    v_mfma_f32_16x16x32_bf16 v[100:103], a[144:147], a[192:195], v[64:67]
    v_exp_f32 v115, v115
    v_mfma_f32_16x16x32_bf16 v[100:103], a[148:151], a[196:199], v[100:103]
    ds_read_b128 a[172:175], v19 offset:3072
    v_cvt_pk_bf16_f32 v57, v114, v115
    v_mfma_f32_16x16x32_bf16 v[100:103], a[152:155], a[200:203], v[100:103]
    v_exp_f32 v116, v116
    v_mfma_f32_16x16x32_bf16 v[100:103], a[156:159], a[204:207], v[100:103]
    buffer_load_dwordx4 v1, s[8:11], s82 offen offset:2048  lds
    v_mfma_f32_16x16x32_bf16 v[108:111], a[144:147], a[208:211], v[68:71]
    v_exp_f32 v117, v117
    v_mfma_f32_16x16x32_bf16 v[108:111], a[148:151], a[212:215], v[108:111]
    ds_read_b128 a[176:179], v20 offset:4096
    v_cvt_pk_bf16_f32 v58, v116, v117
    v_mfma_f32_16x16x32_bf16 v[108:111], a[152:155], a[216:219], v[108:111]
    v_exp_f32 v118, v118
    v_mfma_f32_16x16x32_bf16 v[108:111], a[156:159], a[220:223], v[108:111]
    buffer_load_dwordx4 v1, s[8:11], s82 offen offset:3072  lds
    v_mfma_f32_16x16x32_bf16 v[32:35], v[28:31], v[48:51], v[32:35]
    s_add_u32 m0, s15, 4096
    v_exp_f32 v119, v119
    v_mfma_f32_16x16x32_bf16 v[36:39], v[28:31], v[52:55], v[36:39]
    s_waitcnt lgkmcnt(4)
    ds_read_b128 a[180:183], v20 offset:5120
    v_cvt_pk_bf16_f32 v59, v118, v119
    v_mfma_f32_16x16x32_bf16 v[128:131], a[160:163], v[48:51], v[128:131]
    v_exp_f32 v120, v120
    v_mfma_f32_16x16x32_bf16 v[160:163], a[160:163], v[52:55], v[160:163]
    s_waitcnt lgkmcnt(4)
    v_mfma_f32_16x16x32_bf16 v[132:135], a[164:167], v[48:51], v[132:135]
    v_exp_f32 v121, v121
    v_mfma_f32_16x16x32_bf16 v[164:167], a[164:167], v[52:55], v[164:167]
    s_waitcnt lgkmcnt(3)
    ds_read_b128 a[184:187], v20 offset:6144
    v_cvt_pk_bf16_f32 v60, v120, v121
    v_mfma_f32_16x16x32_bf16 v[136:139], a[168:171], v[48:51], v[136:139]
    s_waitcnt lgkmcnt(3)
    v_exp_f32 v122, v122
    v_mfma_f32_16x16x32_bf16 v[168:171], a[168:171], v[52:55], v[168:171]
    buffer_load_dwordx4 v15, s[8:11], s82 offen offset:0  lds
    v_mfma_f32_16x16x32_bf16 v[140:143], a[172:175], v[48:51], v[140:143]
    v_exp_f32 v123, v123
    v_mfma_f32_16x16x32_bf16 v[172:175], a[172:175], v[52:55], v[172:175]
    s_waitcnt lgkmcnt(2)
    ds_read_b128 a[188:191], v20 offset:7168
    v_cvt_pk_bf16_f32 v61, v122, v123
    v_mfma_f32_16x16x32_bf16 v[144:147], a[176:179], v[48:51], v[144:147]
    s_waitcnt lgkmcnt(2)
    v_exp_f32 v124, v124
    v_mfma_f32_16x16x32_bf16 v[176:179], a[176:179], v[52:55], v[176:179]
    buffer_load_dwordx4 v15, s[8:11], s82 offen offset:1024  lds
    v_mfma_f32_16x16x32_bf16 v[148:151], a[180:183], v[48:51], v[148:151]
    v_exp_f32 v125, v125
    v_mfma_f32_16x16x32_bf16 v[180:183], a[180:183], v[52:55], v[180:183]
    s_waitcnt lgkmcnt(1)
    v_cvt_pk_bf16_f32 v62, v124, v125
    v_mfma_f32_16x16x32_bf16 v[152:155], a[184:187], v[48:51], v[152:155]
    s_waitcnt lgkmcnt(0)
    v_exp_f32 v126, v126
    v_mfma_f32_16x16x32_bf16 v[184:187], a[184:187], v[52:55], v[184:187]
    buffer_load_dwordx4 v15, s[8:11], s82 offen offset:2048  lds
    v_mfma_f32_16x16x32_bf16 v[156:159], a[188:191], v[48:51], v[156:159]
    v_exp_f32 v127, v127
    v_mfma_f32_16x16x32_bf16 v[188:191], a[188:191], v[52:55], v[188:191]
    v_cvt_pk_bf16_f32 v63, v126, v127
    v_mfma_f32_16x16x32_bf16 v[112:115], a[128:131], a[224:227], v[72:75]
    v_mfma_f32_16x16x32_bf16 v[112:115], a[132:135], a[228:231], v[112:115]
    v_mfma_f32_16x16x32_bf16 v[112:115], a[136:139], a[232:235], v[112:115]
    v_exp_f32 v96, v96
    v_mfma_f32_16x16x32_bf16 v[112:115], a[140:143], a[236:239], v[112:115]
    buffer_load_dwordx4 v15, s[8:11], s82 offen offset:3072  lds
    v_mfma_f32_16x16x32_bf16 v[120:123], a[128:131], a[240:243], v[76:79]
    s_xor_b32 s15, s15, 196608
    v_exp_f32 v97, v97
    v_mfma_f32_16x16x32_bf16 v[120:123], a[132:135], a[244:247], v[120:123]
    s_add_u32 m0, s16, 0
    ds_read_b128 a[128:131], v18 offset:0
    v_cvt_pk_bf16_f32 v48, v96, v97
    v_mfma_f32_16x16x32_bf16 v[120:123], a[136:139], a[248:251], v[120:123]
    v_exp_f32 v98, v98
    v_mfma_f32_16x16x32_bf16 v[120:123], a[140:143], a[252:255], v[120:123]
    buffer_load_dwordx4 v1, s[8:11], s19 offen offset:0  lds
    v_mfma_f32_16x16x32_bf16 v[116:119], a[144:147], a[224:227], v[72:75]
    v_exp_f32 v99, v99
    v_mfma_f32_16x16x32_bf16 v[116:119], a[148:151], a[228:231], v[116:119]
    ds_read_b128 a[132:135], v18 offset:1024
    v_cvt_pk_bf16_f32 v49, v98, v99
    v_mfma_f32_16x16x32_bf16 v[116:119], a[152:155], a[232:235], v[116:119]
    v_exp_f32 v100, v100
    v_mfma_f32_16x16x32_bf16 v[116:119], a[156:159], a[236:239], v[116:119]
    buffer_load_dwordx4 v1, s[8:11], s19 offen offset:1024  lds
    v_mfma_f32_16x16x32_bf16 v[124:127], a[144:147], a[240:243], v[76:79]
    v_exp_f32 v101, v101
    v_mfma_f32_16x16x32_bf16 v[124:127], a[148:151], a[244:247], v[124:127]
    ds_read_b128 a[136:139], v18 offset:2048
    v_cvt_pk_bf16_f32 v50, v100, v101
    v_mfma_f32_16x16x32_bf16 v[124:127], a[152:155], a[248:251], v[124:127]
    v_exp_f32 v102, v102
    v_mfma_f32_16x16x32_bf16 v[124:127], a[156:159], a[252:255], v[124:127]
    buffer_load_dwordx4 v1, s[8:11], s19 offen offset:2048  lds
    v_mfma_f32_16x16x32_bf16 v[40:43], v[28:31], v[56:59], v[40:43]
    v_exp_f32 v103, v103
    v_mfma_f32_16x16x32_bf16 v[44:47], v[28:31], v[60:63], v[44:47]
    ds_read_b128 a[140:143], v18 offset:3072
    v_cvt_pk_bf16_f32 v51, v102, v103
    v_mfma_f32_16x16x32_bf16 v[192:195], a[160:163], v[56:59], v[192:195]
    v_exp_f32 v104, v104
    v_mfma_f32_16x16x32_bf16 v[224:227], a[160:163], v[60:63], v[224:227]
    v_mfma_f32_16x16x32_bf16 v[196:199], a[164:167], v[56:59], v[196:199]
    v_exp_f32 v105, v105
    v_mfma_f32_16x16x32_bf16 v[228:231], a[164:167], v[60:63], v[228:231]
    ds_read_b128 a[144:147], v18 offset:4096
    v_cvt_pk_bf16_f32 v52, v104, v105
    v_mfma_f32_16x16x32_bf16 v[200:203], a[168:171], v[56:59], v[200:203]
    v_exp_f32 v106, v106
    v_mfma_f32_16x16x32_bf16 v[232:235], a[168:171], v[60:63], v[232:235]
    buffer_load_dwordx4 v1, s[8:11], s19 offen offset:3072  lds
    v_mfma_f32_16x16x32_bf16 v[204:207], a[172:175], v[56:59], v[204:207]
    s_add_u32 m0, s16, 4096
    v_exp_f32 v107, v107
    v_mfma_f32_16x16x32_bf16 v[236:239], a[172:175], v[60:63], v[236:239]
    ds_read_b128 a[148:151], v18 offset:5120
    v_cvt_pk_bf16_f32 v53, v106, v107
    v_mfma_f32_16x16x32_bf16 v[208:211], a[176:179], v[56:59], v[208:211]
    s_sub_u32 s14, s14, 1
    v_exp_f32 v108, v108
    v_mfma_f32_16x16x32_bf16 v[240:243], a[176:179], v[60:63], v[240:243]
    buffer_load_dwordx4 v15, s[8:11], s19 offen offset:0  lds
    v_mfma_f32_16x16x32_bf16 v[212:215], a[180:183], v[56:59], v[212:215]
    v_exp_f32 v109, v109
    v_mfma_f32_16x16x32_bf16 v[244:247], a[180:183], v[60:63], v[244:247]
    ds_read_b128 a[152:155], v18 offset:6144
    v_cvt_pk_bf16_f32 v54, v108, v109
    v_mfma_f32_16x16x32_bf16 v[216:219], a[184:187], v[56:59], v[216:219]
    v_exp_f32 v110, v110
    v_mfma_f32_16x16x32_bf16 v[248:251], a[184:187], v[60:63], v[248:251]
    buffer_load_dwordx4 v15, s[8:11], s19 offen offset:1024  lds
    v_mfma_f32_16x16x32_bf16 v[220:223], a[188:191], v[56:59], v[220:223]
    v_exp_f32 v111, v111
    v_mfma_f32_16x16x32_bf16 v[252:255], a[188:191], v[60:63], v[252:255]
    ds_read_b128 a[156:159], v18 offset:7168
    v_cvt_pk_bf16_f32 v55, v110, v111
    s_cmp_lg_u32 s14, 0
    s_cbranch_scc1 L_t2_loop
L_t2_diag:
    s_waitcnt lgkmcnt(7)
    v_mfma_f32_16x16x32_bf16 v[96:99], a[128:131], a[192:195], v[80:83]
    s_waitcnt lgkmcnt(6)
    ds_read_b128 a[160:163], v19 offset:16384
    v_mov_b32 v24, v8
    v_mov_b32 v25, v9
    v_mfma_f32_16x16x32_bf16 v[96:99], a[132:135], a[196:199], v[96:99]
    s_waitcnt lgkmcnt(6)
    ds_read_b128 a[164:167], v19 offset:17408
    v_mov_b32 v26, v10
    v_mov_b32 v27, v11
    v_mfma_f32_16x16x32_bf16 v[96:99], a[136:139], a[200:203], v[96:99]
    s_waitcnt lgkmcnt(6)
    v_exp_f32 v112, v112
    v_add_u32 v11, 131072, v16
    v_mfma_f32_16x16x32_bf16 v[96:99], a[140:143], a[204:207], v[96:99]
    buffer_load_dwordx4 v15, s[8:11], s19 offen offset:2048  lds
    v_lshlrev_b32 v12, 6, v0
    v_mfma_f32_16x16x32_bf16 v[104:107], a[128:131], a[208:211], v[88:91]
    s_mov_b32 s71, 1327104
    v_exp_f32 v113, v113
    v_mfma_f32_16x16x32_bf16 v[104:107], a[132:135], a[212:215], v[104:107]
    ds_read_b128 a[168:171], v19 offset:18432
    v_cvt_pk_bf16_f32 v56, v112, v113
    v_mfma_f32_16x16x32_bf16 v[104:107], a[136:139], a[216:219], v[104:107]
    s_waitcnt lgkmcnt(6)
    v_exp_f32 v114, v114
    v_mfma_f32_16x16x32_bf16 v[104:107], a[140:143], a[220:223], v[104:107]
    buffer_load_dwordx4 v15, s[8:11], s19 offen offset:3072  lds
    v_mfma_f32_16x16x32_bf16 v[100:103], a[144:147], a[192:195], v[84:87]
    s_waitcnt lgkmcnt(5)
    s_xor_b32 s16, s16, 98304
    v_exp_f32 v115, v115
    v_mfma_f32_16x16x32_bf16 v[100:103], a[148:151], a[196:199], v[100:103]
    s_waitcnt lgkmcnt(4)
    ds_read_b128 a[172:175], v19 offset:19456
    v_cvt_pk_bf16_f32 v57, v114, v115
    v_mfma_f32_16x16x32_bf16 v[100:103], a[152:155], a[200:203], v[100:103]
    s_waitcnt lgkmcnt(4)
    v_exp_f32 v116, v116
    v_mfma_f32_16x16x32_bf16 v[100:103], a[156:159], a[204:207], v[100:103]
    buffer_load_dword v3, v12, s[8:11], s71 offen sc0 sc1
    v_bfe_u32 v13, v2, 1, 4
    v_mfma_f32_16x16x32_bf16 v[108:111], a[144:147], a[208:211], v[92:95]
    v_exp_f32 v117, v117
    v_lshlrev_b32 v13, 10, v13
    v_mfma_f32_16x16x32_bf16 v[108:111], a[148:151], a[212:215], v[108:111]
    ds_read_b128 a[176:179], v20 offset:20480
    v_cvt_pk_bf16_f32 v58, v116, v117
    v_and_b32 v14, 1, v2
    v_mfma_f32_16x16x32_bf16 v[108:111], a[152:155], a[216:219], v[108:111]
    v_exp_f32 v118, v118
    v_lshl_add_u32 v13, v14, 7, v13
    v_mfma_f32_16x16x32_bf16 v[108:111], a[156:159], a[220:223], v[108:111]
    s_lshl_b32 s74, s6, 2
    s_add_u32 s74, s74, s3
    s_lshl_b32 s74, s74, 14
    v_mfma_f32_16x16x32_bf16 v[32:35], v[28:31], v[48:51], v[32:35]
    v_exp_f32 v119, v119
    v_mfma_f32_16x16x32_bf16 v[36:39], v[28:31], v[52:55], v[36:39]
    s_waitcnt lgkmcnt(4)
    ds_read_b128 a[180:183], v20 offset:21504
    v_cvt_pk_bf16_f32 v59, v118, v119
    v_mfma_f32_16x16x32_bf16 v[128:131], a[160:163], v[48:51], v[128:131]
    s_waitcnt lgkmcnt(4)
    v_exp_f32 v120, v120
    v_mfma_f32_16x16x32_bf16 v[160:163], a[160:163], v[52:55], v[160:163]
    buffer_load_dword v14, v13, s[28:31], s74 offen
    v_mfma_f32_16x16x32_bf16 v[132:135], a[164:167], v[48:51], v[132:135]
    v_exp_f32 v121, v121
    v_mfma_f32_16x16x32_bf16 v[164:167], a[164:167], v[52:55], v[164:167]
    s_waitcnt lgkmcnt(3)
    ds_read_b128 a[184:187], v20 offset:22528
    v_cvt_pk_bf16_f32 v60, v120, v121
    v_mfma_f32_16x16x32_bf16 v[136:139], a[168:171], v[48:51], v[136:139]
    v_exp_f32 v122, v122
    v_mfma_f32_16x16x32_bf16 v[168:171], a[168:171], v[52:55], v[168:171]
    s_waitcnt lgkmcnt(3)
    v_add_f32 v80, 0, v22
    v_min_f32 v80, v80, v72
    v_mfma_f32_16x16x32_bf16 v[140:143], a[172:175], v[48:51], v[140:143]
    v_exp_f32 v123, v123
    v_mfma_f32_16x16x32_bf16 v[172:175], a[172:175], v[52:55], v[172:175]
    s_waitcnt lgkmcnt(2)
    ds_read_b128 a[188:191], v20 offset:23552
    v_cvt_pk_bf16_f32 v61, v122, v123
    v_mfma_f32_16x16x32_bf16 v[144:147], a[176:179], v[48:51], v[144:147]
    v_exp_f32 v124, v124
    v_mfma_f32_16x16x32_bf16 v[176:179], a[176:179], v[52:55], v[176:179]
    s_waitcnt lgkmcnt(2)
    v_add_f32 v81, 0xf1800000, v22
    v_min_f32 v81, v81, v73
    v_mfma_f32_16x16x32_bf16 v[148:151], a[180:183], v[48:51], v[148:151]
    v_exp_f32 v125, v125
    v_mfma_f32_16x16x32_bf16 v[180:183], a[180:183], v[52:55], v[180:183]
    s_waitcnt lgkmcnt(1)
    v_cvt_pk_bf16_f32 v62, v124, v125
    v_xor_b32 v19, 98304, v19
    v_mfma_f32_16x16x32_bf16 v[152:155], a[184:187], v[48:51], v[152:155]
    v_exp_f32 v126, v126
    v_mfma_f32_16x16x32_bf16 v[184:187], a[184:187], v[52:55], v[184:187]
    s_waitcnt lgkmcnt(0)
    v_xor_b32 v20, 98304, v20
    v_add_f32 v82, 0xf2000000, v22
    v_mfma_f32_16x16x32_bf16 v[156:159], a[188:191], v[48:51], v[156:159]
    v_exp_f32 v127, v127
    v_mfma_f32_16x16x32_bf16 v[188:191], a[188:191], v[52:55], v[188:191]
    v_cvt_pk_bf16_f32 v63, v126, v127
    v_min_f32 v82, v82, v74
    v_add_f32 v83, 0xf2400000, v22
    v_min_f32 v83, v83, v75
    v_add_f32 v84, 0xf3800000, v22
    v_min_f32 v84, v84, v72
    v_mfma_f32_16x16x32_bf16 v[112:115], a[128:131], a[224:227], v[72:75]
    v_exp_f32 v96, v96
    v_mfma_f32_16x16x32_bf16 v[112:115], a[132:135], a[228:231], v[112:115]
    v_add_f32 v85, 0xf3880000, v22
    v_min_f32 v85, v85, v73
    s_getpc_b64 s[100:101]
L_ct3:
    s_lshr_b32 s99, s2, 3
    s_lshl_b32 s99, s99, 2
    s_add_u32 s99, s99, s3
    s_mul_i32 s99, s99, 4
    v_min_u32 v13, 3, v2
    v_add_u32 v13, s99, v13
    v_lshlrev_b32 v13, 7, v13
    v_add_u32 v13, L_ct3-L_ct3, v13
    v_min_u32 v13, L_end-L_ct3, v13
    global_load_dword v13, v13, s[100:101]
    v_mfma_f32_16x16x32_bf16 v[112:115], a[136:139], a[232:235], v[112:115]
    s_and_b32 s68, s2, 31
    v_exp_f32 v97, v97
    v_mfma_f32_16x16x32_bf16 v[112:115], a[140:143], a[236:239], v[112:115]
    s_lshl_b32 s68, s68, 2
    s_add_u32 s68, s68, s3
    v_cvt_pk_bf16_f32 v48, v96, v97
    v_mfma_f32_16x16x32_bf16 v[120:123], a[128:131], a[240:243], v[76:79]
    s_lshl_b32 s69, s60, 7
    v_exp_f32 v98, v98
    v_mfma_f32_16x16x32_bf16 v[120:123], a[132:135], a[244:247], v[120:123]
    v_add_f32 v86, 0xf3900000, v22
    v_min_f32 v86, v86, v74
    v_mfma_f32_16x16x32_bf16 v[120:123], a[136:139], a[248:251], v[120:123]
    s_add_u32 s68, s68, s69
    v_exp_f32 v99, v99
    v_mfma_f32_16x16x32_bf16 v[120:123], a[140:143], a[252:255], v[120:123]
    v_add_f32 v87, 0xf3980000, v22
    v_min_f32 v87, v87, v75
    v_mfma_f32_16x16x32_bf16 v[116:119], a[144:147], a[224:227], v[72:75]
    s_lshl_b32 s68, s68, 10
    v_exp_f32 v100, v100
    v_mfma_f32_16x16x32_bf16 v[116:119], a[148:151], a[228:231], v[116:119]
    s_sub_u32 s69, s61, s60
    ds_read_b128 a[128:131], v18 offset:16384
    v_cvt_pk_bf16_f32 v49, v98, v99
    v_mfma_f32_16x16x32_bf16 v[116:119], a[152:155], a[232:235], v[116:119]
    s_lshl_b32 s69, s69, 17
    v_exp_f32 v101, v101
    v_mfma_f32_16x16x32_bf16 v[116:119], a[156:159], a[236:239], v[116:119]
    ds_read_b128 a[132:135], v18 offset:17408
    v_cvt_pk_bf16_f32 v50, v100, v101
    v_mfma_f32_16x16x32_bf16 v[124:127], a[144:147], a[240:243], v[76:79]
    v_exp_f32 v102, v102
    v_mfma_f32_16x16x32_bf16 v[124:127], a[148:151], a[244:247], v[124:127]
    ds_read_b128 a[136:139], v18 offset:18432
    v_bfe_u32 v9, v2, 3, 1
    v_mfma_f32_16x16x32_bf16 v[124:127], a[152:155], a[248:251], v[124:127]
    v_exp_f32 v103, v103
    v_mfma_f32_16x16x32_bf16 v[124:127], a[156:159], a[252:255], v[124:127]
    ds_read_b128 a[140:143], v18 offset:19456
    v_cvt_pk_bf16_f32 v51, v102, v103
    v_mfma_f32_16x16x32_bf16 v[40:43], v[28:31], v[56:59], v[40:43]
    v_exp_f32 v104, v104
    v_mfma_f32_16x16x32_bf16 v[44:47], v[28:31], v[60:63], v[44:47]
    ds_read_b128 a[144:147], v18 offset:20480
    v_mul_lo_u32 v9, v9, s69
    v_mfma_f32_16x16x32_bf16 v[192:195], a[160:163], v[56:59], v[192:195]
    v_exp_f32 v105, v105
    v_mfma_f32_16x16x32_bf16 v[224:227], a[160:163], v[60:63], v[224:227]
    ds_read_b128 a[148:151], v18 offset:21504
    v_cvt_pk_bf16_f32 v52, v104, v105
    v_mfma_f32_16x16x32_bf16 v[196:199], a[164:167], v[56:59], v[196:199]
    v_exp_f32 v106, v106
    v_mfma_f32_16x16x32_bf16 v[228:231], a[164:167], v[60:63], v[228:231]
    ds_read_b128 a[152:155], v18 offset:22528
    v_and_b32 v8, 7, v2
    v_mfma_f32_16x16x32_bf16 v[200:203], a[168:171], v[56:59], v[200:203]
    v_exp_f32 v107, v107
    v_mfma_f32_16x16x32_bf16 v[232:235], a[168:171], v[60:63], v[232:235]
    ds_read_b128 a[156:159], v18 offset:23552
    v_cvt_pk_bf16_f32 v53, v106, v107
    v_mfma_f32_16x16x32_bf16 v[204:207], a[172:175], v[56:59], v[204:207]
    v_exp_f32 v108, v108
    v_mfma_f32_16x16x32_bf16 v[236:239], a[172:175], v[60:63], v[236:239]
    v_lshl_add_u32 v9, v8, 7, v9
    v_add_f32 v88, 0x73800000, v22
    v_mfma_f32_16x16x32_bf16 v[208:211], a[176:179], v[56:59], v[208:211]
    v_exp_f32 v109, v109
    v_mfma_f32_16x16x32_bf16 v[240:243], a[176:179], v[60:63], v[240:243]
    v_cvt_pk_bf16_f32 v54, v108, v109
    v_xor_b32 v18, 196608, v18
    v_mfma_f32_16x16x32_bf16 v[212:215], a[180:183], v[56:59], v[212:215]
    v_exp_f32 v110, v110
    v_mfma_f32_16x16x32_bf16 v[244:247], a[180:183], v[60:63], v[244:247]
    buffer_load_dword v8, v9, s[32:35], s68 offen
    v_mfma_f32_16x16x32_bf16 v[216:219], a[184:187], v[56:59], v[216:219]
    v_exp_f32 v111, v111
    v_mfma_f32_16x16x32_bf16 v[248:251], a[184:187], v[60:63], v[248:251]
    v_cvt_pk_bf16_f32 v55, v110, v111
    v_min_f32 v88, v88, v76
    s_waitcnt vmcnt(3)
    v_cmp_ne_u32 vcc, 0, v3
    s_cmp_eq_u64 vcc, -1
    s_cbranch_scc0 L_F_slow_11
L_F_ok_12:
    v_mfma_f32_16x16x32_bf16 v[220:223], a[188:191], v[56:59], v[220:223]
    v_add_f32 v89, 0x73700000, v22
    v_min_f32 v89, v89, v77
    v_mfma_f32_16x16x32_bf16 v[252:255], a[188:191], v[60:63], v[252:255]
    v_add_f32 v90, 0x73600000, v22
    v_min_f32 v90, v90, v78
    v_add_f32 v91, 0x73500000, v22
    v_min_f32 v91, v91, v79
    v_add_f32 v92, 0, v22
    v_min_f32 v92, v92, v76
    v_add_f32 v93, 0xf1800000, v22
    v_min_f32 v93, v93, v77
    v_add_f32 v94, 0xf2000000, v22
    v_min_f32 v94, v94, v78
    v_add_f32 v95, 0xf2400000, v22
    v_min_f32 v95, v95, v79
    s_waitcnt lgkmcnt(0)
    s_barrier
    v_mfma_f32_16x16x32_bf16 v[96:99], a[128:131], a[224:227], v[80:83]
    s_xor_b32 s100, s62, 8192
    s_xor_b32 s98, s65, 262144
    ds_read_b128 a[176:179], v20 offset:4096
    s_waitcnt vmcnt(1)
    v_lshrrev_b32 v13, 1, v1
    v_mfma_f32_16x16x32_bf16 v[96:99], a[132:135], a[228:231], v[96:99]
    s_add_u32 m0, s62, 65536
    ds_read_b128 a[180:183], v20 offset:5120
    v_add_u32 v12, s100, v13
    v_mfma_f32_16x16x32_bf16 v[96:99], a[136:139], a[232:235], v[96:99]
    buffer_load_dwordx4 v24, s[28:31], s98 offen offset:0   lds
    v_exp_f32 v112, v112
    v_mfma_f32_16x16x32_bf16 v[96:99], a[140:143], a[236:239], v[96:99]
    v_exp_f32 v113, v113
    v_mfma_f32_16x16x32_bf16 v[100:103], a[144:147], a[224:227], v[84:87]
    ds_read_b128 a[184:187], v20 offset:6144
    v_cvt_pk_bf16_f32 v56, v112, v113
    v_mfma_f32_16x16x32_bf16 v[100:103], a[148:151], a[228:231], v[100:103]
    v_exp_f32 v114, v114
    v_mfma_f32_16x16x32_bf16 v[100:103], a[152:155], a[232:235], v[100:103]
    buffer_load_dwordx4 v25, s[28:31], s98 offen offset:1024   lds
    v_exp_f32 v115, v115
    v_mfma_f32_16x16x32_bf16 v[100:103], a[156:159], a[236:239], v[100:103]
    ds_read_b128 a[188:191], v20 offset:7168
    v_cvt_pk_bf16_f32 v57, v114, v115
    v_mfma_f32_16x16x32_bf16 v[104:107], a[128:131], a[240:243], v[88:91]
    v_exp_f32 v116, v116
    v_mfma_f32_16x16x32_bf16 v[104:107], a[132:135], a[244:247], v[104:107]
    v_exp_f32 v117, v117
    v_mfma_f32_16x16x32_bf16 v[104:107], a[136:139], a[248:251], v[104:107]
    ds_read_b128 a[160:163], v19 offset:0
    v_cvt_pk_bf16_f32 v58, v116, v117
    v_mfma_f32_16x16x32_bf16 v[104:107], a[140:143], a[252:255], v[104:107]
    buffer_load_dwordx4 v26, s[28:31], s98 offen offset:2048   lds
    v_exp_f32 v118, v118
    v_mfma_f32_16x16x32_bf16 v[108:111], a[144:147], a[240:243], v[92:95]
    v_exp_f32 v119, v119
    v_mfma_f32_16x16x32_bf16 v[108:111], a[148:151], a[244:247], v[108:111]
    ds_read_b128 a[164:167], v19 offset:1024
    v_cvt_pk_bf16_f32 v59, v118, v119
    v_mfma_f32_16x16x32_bf16 v[108:111], a[152:155], a[248:251], v[108:111]
    v_exp_f32 v120, v120
    v_mfma_f32_16x16x32_bf16 v[108:111], a[156:159], a[252:255], v[108:111]
    buffer_load_dwordx4 v27, s[28:31], s98 offen offset:3072   lds
    v_exp_f32 v121, v121
    v_mfma_f32_16x16x32_bf16 v[32:35], v[28:31], v[48:51], v[32:35]
    s_add_u32 m0, s62, 69632
    ds_read_b128 a[168:171], v19 offset:2048
    v_cvt_pk_bf16_f32 v60, v120, v121
    v_mfma_f32_16x16x32_bf16 v[36:39], v[28:31], v[52:55], v[36:39]
    s_waitcnt lgkmcnt(6)
    s_xor_b32 s98, s65, 294912
    v_exp_f32 v122, v122
    v_mfma_f32_16x16x32_bf16 v[144:147], a[176:179], v[48:51], v[144:147]
    v_exp_f32 v123, v123
    v_mfma_f32_16x16x32_bf16 v[176:179], a[176:179], v[52:55], v[176:179]
    s_waitcnt lgkmcnt(5)
    ds_read_b128 a[172:175], v19 offset:3072
    v_cvt_pk_bf16_f32 v61, v122, v123
    v_mfma_f32_16x16x32_bf16 v[148:151], a[180:183], v[48:51], v[148:151]
    buffer_load_dwordx4 v24, s[28:31], s98 offen offset:0   lds
    v_exp_f32 v124, v124
    v_mfma_f32_16x16x32_bf16 v[180:183], a[180:183], v[52:55], v[180:183]
    s_waitcnt lgkmcnt(5)
    v_exp_f32 v125, v125
    v_mfma_f32_16x16x32_bf16 v[152:155], a[184:187], v[48:51], v[152:155]
    s_waitcnt lgkmcnt(4)
    v_exp_f32 v126, v126
    v_mfma_f32_16x16x32_bf16 v[184:187], a[184:187], v[52:55], v[184:187]
    buffer_load_dwordx4 v25, s[28:31], s98 offen offset:1024   lds
    v_exp_f32 v127, v127
    v_mfma_f32_16x16x32_bf16 v[156:159], a[188:191], v[48:51], v[156:159]
    ds_write_b128 v11, v[144:147] offset:0
    v_cvt_pk_bf16_f32 v62, v124, v125
    v_mfma_f32_16x16x32_bf16 v[188:191], a[188:191], v[52:55], v[188:191]
    s_waitcnt lgkmcnt(4)
    v_exp_f32 v96, v96
    v_mfma_f32_16x16x32_bf16 v[128:131], a[160:163], v[48:51], v[128:131]
    v_exp_f32 v97, v97
    v_mfma_f32_16x16x32_bf16 v[160:163], a[160:163], v[52:55], v[160:163]
    s_waitcnt lgkmcnt(3)
    ds_write_b128 v11, v[176:179] offset:1024
    v_cvt_pk_bf16_f32 v63, v126, v127
    v_mfma_f32_16x16x32_bf16 v[132:135], a[164:167], v[48:51], v[132:135]
    s_waitcnt lgkmcnt(3)
    v_exp_f32 v98, v98
    v_mfma_f32_16x16x32_bf16 v[164:167], a[164:167], v[52:55], v[164:167]
    buffer_load_dwordx4 v26, s[28:31], s98 offen offset:2048   lds
    v_exp_f32 v99, v99
    v_mfma_f32_16x16x32_bf16 v[136:139], a[168:171], v[48:51], v[136:139]
    ds_write_b128 v11, v[148:151] offset:2048
    v_mfma_f32_16x16x32_bf16 v[168:171], a[168:171], v[52:55], v[168:171]
    s_waitcnt lgkmcnt(3)
    v_exp_f32 v100, v100
    v_mfma_f32_16x16x32_bf16 v[140:143], a[172:175], v[48:51], v[140:143]
    v_exp_f32 v101, v101
    v_mfma_f32_16x16x32_bf16 v[172:175], a[172:175], v[52:55], v[172:175]
    ds_write_b128 v11, v[180:183] offset:3072
    v_mov_b32 v33, v36
    v_mfma_f32_16x16x32_bf16 v[40:43], v[28:31], v[56:59], v[40:43]
    buffer_load_dwordx4 v27, s[28:31], s98 offen offset:3072   lds
    v_exp_f32 v102, v102
    v_mfma_f32_16x16x32_bf16 v[44:47], v[28:31], v[60:63], v[44:47]
    v_exp_f32 v103, v103
    v_mfma_f32_16x16x32_bf16 v[208:211], a[176:179], v[56:59], v[208:211]
    ds_write_b128 v11, v[152:155] offset:4096
    v_cvt_pk_bf16_f32 v48, v96, v97
    v_mfma_f32_16x16x32_bf16 v[240:243], a[176:179], v[60:63], v[240:243]
    ds_read_b128 a[176:179], v20 offset:20480
    v_exp_f32 v104, v104
    v_mfma_f32_16x16x32_bf16 v[212:215], a[180:183], v[56:59], v[212:215]
    v_exp_f32 v105, v105
    v_mfma_f32_16x16x32_bf16 v[244:247], a[180:183], v[60:63], v[244:247]
    ds_read_b128 a[180:183], v20 offset:21504
    v_exp_f32 v106, v106
    v_mfma_f32_16x16x32_bf16 v[216:219], a[184:187], v[56:59], v[216:219]
    ds_write_b128 v11, v[184:187] offset:5120
    v_cvt_pk_bf16_f32 v49, v98, v99
    v_mfma_f32_16x16x32_bf16 v[248:251], a[184:187], v[60:63], v[248:251]
    ds_read_b128 a[184:187], v20 offset:22528
    v_exp_f32 v107, v107
    v_mfma_f32_16x16x32_bf16 v[220:223], a[188:191], v[56:59], v[220:223]
    v_exp_f32 v108, v108
    v_mfma_f32_16x16x32_bf16 v[252:255], a[188:191], v[60:63], v[252:255]
    ds_read_b128 a[188:191], v20 offset:23552
    v_exp_f32 v109, v109
    v_mfma_f32_16x16x32_bf16 v[192:195], a[160:163], v[56:59], v[192:195]
    ds_write_b128 v11, v[156:159] offset:6144
    v_cvt_pk_bf16_f32 v50, v100, v101
    v_mfma_f32_16x16x32_bf16 v[224:227], a[160:163], v[60:63], v[224:227]
    ds_read_b128 a[160:163], v19 offset:16384
    v_exp_f32 v110, v110
    v_mfma_f32_16x16x32_bf16 v[196:199], a[164:167], v[56:59], v[196:199]
    v_exp_f32 v111, v111
    v_mfma_f32_16x16x32_bf16 v[228:231], a[164:167], v[60:63], v[228:231]
    ds_read_b128 a[164:167], v19 offset:17408
    v_cvt_pk_bf16_f32 v51, v102, v103
    v_mfma_f32_16x16x32_bf16 v[200:203], a[168:171], v[56:59], v[200:203]
    ds_write_b128 v11, v[188:191] offset:7168
    v_cvt_pk_bf16_f32 v52, v104, v105
    v_mfma_f32_16x16x32_bf16 v[232:235], a[168:171], v[60:63], v[232:235]
    ds_read_b128 a[168:171], v19 offset:18432
    v_cvt_pk_bf16_f32 v53, v106, v107
    v_mfma_f32_16x16x32_bf16 v[204:207], a[172:175], v[56:59], v[204:207]
    v_cvt_pk_bf16_f32 v54, v108, v109
    v_cvt_pk_bf16_f32 v55, v110, v111
    v_mfma_f32_16x16x32_bf16 v[236:239], a[172:175], v[60:63], v[236:239]
    ds_read_b128 a[172:175], v19 offset:19456
    ds_write_b64 v12, v[32:33]
    s_add_u32 s101, s62, 98304
    v_xor_b32 v12, 8192, v12
    v_add_u32 v9, s101, v1
    s_waitcnt vmcnt(8)
    v_xor_b32 v8, 8192, v11
    v_xor_b32 v10, 8192, v9
L_t2_join:
    v_xor_b32 v19, 98304, v19
    v_xor_b32 v20, 98304, v20
    s_waitcnt lgkmcnt(0)
    s_barrier
    v_mfma_f32_16x16x32_bf16 v[40:43], v[28:31], v[48:51], v[40:43]
    s_lshl_b32 s100, s61, 20
    s_add_u32 s101, s100, s21
    ds_read_b64 v[120:121], v12
    v_mfma_f32_16x16x32_bf16 v[44:47], v[28:31], v[52:55], v[44:47]
    s_add_u32 s100, s100, s20
    ds_read_b128 v[144:147], v8 offset:0
    v_lshrrev_b32 v11, 4, v2
    v_mfma_f32_16x16x32_bf16 v[208:211], a[176:179], v[48:51], v[208:211]
    ds_read_b128 v[176:179], v8 offset:1024
    v_lshrrev_b32 v13, 2, v1
    v_mfma_f32_16x16x32_bf16 v[240:243], a[176:179], v[52:55], v[240:243]
    ds_read_b128 v[148:151], v8 offset:2048
    v_add_u32 v13, 131072, v13
    v_mfma_f32_16x16x32_bf16 v[212:215], a[180:183], v[48:51], v[212:215]
    s_xor_b32 s99, s62, 8192
    ds_read_b128 v[180:183], v8 offset:3072
    v_add_u32 v14, s99, v13
    v_mfma_f32_16x16x32_bf16 v[244:247], a[180:183], v[52:55], v[244:247]
    ds_read_b128 v[152:155], v8 offset:4096
    v_cmp_eq_u32 vcc, 1, v11
    v_mfma_f32_16x16x32_bf16 v[216:219], a[184:187], v[48:51], v[216:219]
    ds_read_b128 v[184:187], v8 offset:5120
    s_waitcnt lgkmcnt(6)
    v_add_f32 v112, v120, v32
    v_mfma_f32_16x16x32_bf16 v[248:251], a[184:187], v[52:55], v[248:251]
    ds_read_b128 v[156:159], v8 offset:6144
    v_add_f32 v114, v121, v36
    v_mfma_f32_16x16x32_bf16 v[220:223], a[188:191], v[48:51], v[220:223]
    ds_read_b128 v[188:191], v8 offset:7168
    v_cndmask_b32 v12, v32, v36, vcc
    v_mfma_f32_16x16x32_bf16 v[252:255], a[188:191], v[52:55], v[252:255]
    v_rcp_f32 v112, v112
    v_mfma_f32_16x16x32_bf16 v[192:195], a[160:163], v[48:51], v[192:195]
    v_rcp_f32 v114, v114
    v_mfma_f32_16x16x32_bf16 v[224:227], a[160:163], v[52:55], v[224:227]
    v_cmp_eq_u32 vcc, 2, v11
    v_cmp_eq_u32 s[96:97], 3, v11
    v_mfma_f32_16x16x32_bf16 v[196:199], a[164:167], v[48:51], v[196:199]
    ds_write_b128 v9, v[208:211] offset:0
    v_mfma_f32_16x16x32_bf16 v[228:231], a[164:167], v[52:55], v[228:231]
    v_mfma_f32_16x16x32_bf16 v[200:203], a[168:171], v[48:51], v[200:203]
    ds_write_b128 v9, v[240:243] offset:1024
    v_mfma_f32_16x16x32_bf16 v[232:235], a[168:171], v[52:55], v[232:235]
    v_mfma_f32_16x16x32_bf16 v[204:207], a[172:175], v[48:51], v[204:207]
    ds_write_b128 v9, v[212:215] offset:2048
    v_mfma_f32_16x16x32_bf16 v[236:239], a[172:175], v[52:55], v[236:239]
    v_cndmask_b32 v12, v12, v40, vcc
    v_cndmask_b32 v12, v12, v44, s[96:97]
    ds_write_b128 v9, v[244:247] offset:3072
    s_waitcnt lgkmcnt(11)
    v_pk_add_f32 v[128:129], v[128:129], v[144:145]
    v_pk_add_f32 v[130:131], v[130:131], v[146:147]
    s_waitcnt lgkmcnt(9)
    v_pk_add_f32 v[132:133], v[132:133], v[148:149]
    v_pk_add_f32 v[134:135], v[134:135], v[150:151]
    v_pk_mul_f32 v[128:129], v[128:129], v[112:113] op_sel_hi:[1,0]
    v_pk_mul_f32 v[130:131], v[130:131], v[112:113] op_sel_hi:[1,0]
    v_pk_mul_f32 v[132:133], v[132:133], v[112:113] op_sel_hi:[1,0]
    v_pk_mul_f32 v[134:135], v[134:135], v[112:113] op_sel_hi:[1,0]
    v_cvt_pk_bf16_f32 v128, v128, v129
    v_cvt_pk_bf16_f32 v129, v130, v131
    v_cvt_pk_bf16_f32 v130, v132, v133
    v_lshrrev_b32 v58, 2, v2
    v_and_b32 v57, 3, v2
    ds_write_b128 v9, v[216:219] offset:4096
    v_cvt_pk_bf16_f32 v131, v134, v135
    buffer_store_dwordx4 v[128:131], v1, s[8:11], s100 offen offset:0 sc0 sc1
    s_waitcnt lgkmcnt(8)
    v_pk_add_f32 v[136:137], v[136:137], v[152:153]
    v_pk_add_f32 v[138:139], v[138:139], v[154:155]
    s_waitcnt lgkmcnt(6)
    v_pk_add_f32 v[140:141], v[140:141], v[156:157]
    v_pk_add_f32 v[142:143], v[142:143], v[158:159]
    v_pk_mul_f32 v[136:137], v[136:137], v[112:113] op_sel_hi:[1,0]
    v_pk_mul_f32 v[138:139], v[138:139], v[112:113] op_sel_hi:[1,0]
    v_pk_mul_f32 v[140:141], v[140:141], v[112:113] op_sel_hi:[1,0]
    v_pk_mul_f32 v[142:143], v[142:143], v[112:113] op_sel_hi:[1,0]
    v_cvt_pk_bf16_f32 v136, v136, v137
    v_lshlrev_b32 v56, 7, v58
    v_lshl_add_u32 v56, v57, 3, v56
    v_bfe_u32 v57, v2, 3, 2
    ds_write_b128 v9, v[248:251] offset:5120
    v_cvt_pk_bf16_f32 v137, v138, v139
    v_cvt_pk_bf16_f32 v138, v140, v141
    v_cvt_pk_bf16_f32 v139, v142, v143
    buffer_store_dwordx4 v[136:139], v1, s[8:11], s100 offen offset:1024 sc0 sc1
    v_pk_add_f32 v[160:161], v[160:161], v[176:177]
    v_pk_add_f32 v[162:163], v[162:163], v[178:179]
    v_pk_add_f32 v[164:165], v[164:165], v[180:181]
    v_pk_add_f32 v[166:167], v[166:167], v[182:183]
    v_pk_mul_f32 v[160:161], v[160:161], v[114:115] op_sel_hi:[1,0]
    v_pk_mul_f32 v[162:163], v[162:163], v[114:115] op_sel_hi:[1,0]
    v_pk_mul_f32 v[164:165], v[164:165], v[114:115] op_sel_hi:[1,0]
    v_lshl_add_u32 v56, v57, 5, v56
    v_xor_b32 v57, 32, v56
    ds_write_b128 v9, v[220:223] offset:6144
    v_pk_mul_f32 v[166:167], v[166:167], v[114:115] op_sel_hi:[1,0]
    v_cvt_pk_bf16_f32 v160, v160, v161
    v_cvt_pk_bf16_f32 v161, v162, v163
    v_cvt_pk_bf16_f32 v162, v164, v165
    v_cvt_pk_bf16_f32 v163, v166, v167
    buffer_store_dwordx4 v[160:163], v15, s[8:11], s100 offen offset:0 sc0 sc1
    v_pk_add_f32 v[168:169], v[168:169], v[184:185]
    v_pk_add_f32 v[170:171], v[170:171], v[186:187]
    s_waitcnt lgkmcnt(7)
    v_pk_add_f32 v[172:173], v[172:173], v[188:189]
    v_pk_add_f32 v[174:175], v[174:175], v[190:191]
    v_pk_mul_f32 v[168:169], v[168:169], v[114:115] op_sel_hi:[1,0]
    v_xor_b32 v58, 64, v56
    v_xor_b32 v59, 96, v56
    v_add_u32 v60, 65536, v56
    ds_write_b128 v9, v[252:255] offset:7168
    v_pk_mul_f32 v[170:171], v[170:171], v[114:115] op_sel_hi:[1,0]
    v_pk_mul_f32 v[172:173], v[172:173], v[114:115] op_sel_hi:[1,0]
    v_pk_mul_f32 v[174:175], v[174:175], v[114:115] op_sel_hi:[1,0]
    v_cvt_pk_bf16_f32 v168, v168, v169
    v_cvt_pk_bf16_f32 v169, v170, v171
    v_cvt_pk_bf16_f32 v170, v172, v173
    v_cvt_pk_bf16_f32 v171, v174, v175
    buffer_store_dwordx4 v[168:171], v15, s[8:11], s100 offen offset:1024 sc0 sc1
    v_add_u32 v61, 65536, v57
    v_add_u32 v62, 65536, v58
    v_add_u32 v63, 65536, v59
    ds_write_b32 v14, v12
    v_and_b32 v14, 4294967103, v13
    v_add_u32 v14, s62, v14
    s_waitcnt lgkmcnt(0)
    s_barrier
    ds_read_b32 v116, v14 offset:128
    ds_read_b32 v118, v14 offset:192
    ds_read_b128 v[208:211], v10 offset:0
    ds_read_b128 v[212:215], v10 offset:2048
    ds_read_b128 v[216:219], v10 offset:4096
    ds_read_b128 v[220:223], v10 offset:6144
    ds_read_b128 v[240:243], v10 offset:1024
    ds_read_b128 v[244:247], v10 offset:3072
    ds_read_b128 v[248:251], v10 offset:5120
    ds_read_b128 v[252:255], v10 offset:7168
    ds_read_b32 v120, v13 offset:0
    ds_read_b32 v121, v13 offset:8192
    ds_read_b32 v122, v13 offset:16384
    ds_read_b32 v123, v13 offset:24576
    s_waitcnt lgkmcnt(13)
    v_add_f32 v116, v116, v40
    s_waitcnt lgkmcnt(12)
    v_add_f32 v118, v118, v44
    v_rcp_f32 v116, v116
    v_rcp_f32 v118, v118
    s_waitcnt lgkmcnt(11)
    v_pk_add_f32 v[192:193], v[192:193], v[208:209]
    v_pk_add_f32 v[194:195], v[194:195], v[210:211]
    s_waitcnt lgkmcnt(10)
    v_pk_add_f32 v[196:197], v[196:197], v[212:213]
    v_pk_add_f32 v[198:199], v[198:199], v[214:215]
    v_pk_mul_f32 v[192:193], v[192:193], v[116:117] op_sel_hi:[1,0]
    v_pk_mul_f32 v[194:195], v[194:195], v[116:117] op_sel_hi:[1,0]
    v_pk_mul_f32 v[196:197], v[196:197], v[116:117] op_sel_hi:[1,0]
    v_pk_mul_f32 v[198:199], v[198:199], v[116:117] op_sel_hi:[1,0]
    v_cvt_pk_bf16_f32 v192, v192, v193
    v_cvt_pk_bf16_f32 v193, v194, v195
    v_cvt_pk_bf16_f32 v194, v196, v197
    v_cvt_pk_bf16_f32 v195, v198, v199
    buffer_store_dwordx4 v[192:195], v1, s[8:11], s101 offen offset:0 sc0 sc1
    s_waitcnt lgkmcnt(9)
    v_pk_add_f32 v[200:201], v[200:201], v[216:217]
    v_pk_add_f32 v[202:203], v[202:203], v[218:219]
    s_waitcnt lgkmcnt(8)
    v_pk_add_f32 v[204:205], v[204:205], v[220:221]
    v_pk_add_f32 v[206:207], v[206:207], v[222:223]
    v_pk_mul_f32 v[200:201], v[200:201], v[116:117] op_sel_hi:[1,0]
    v_pk_mul_f32 v[202:203], v[202:203], v[116:117] op_sel_hi:[1,0]
    v_pk_mul_f32 v[204:205], v[204:205], v[116:117] op_sel_hi:[1,0]
    v_pk_mul_f32 v[206:207], v[206:207], v[116:117] op_sel_hi:[1,0]
    v_cvt_pk_bf16_f32 v200, v200, v201
    v_cvt_pk_bf16_f32 v201, v202, v203
    v_cvt_pk_bf16_f32 v202, v204, v205
    v_cvt_pk_bf16_f32 v203, v206, v207
    buffer_store_dwordx4 v[200:203], v1, s[8:11], s101 offen offset:1024 sc0 sc1
    s_waitcnt lgkmcnt(2)
    v_add_f32 v120, v120, v121
    s_waitcnt lgkmcnt(0)
    v_add_f32 v122, v122, v123
    v_min_f32 v124, v120, v122
    v_add_f32 v120, v120, v122
    v_cmp_le_f32 vcc, 0x1f800000, v124
    s_mov_b64 s[96:97], vcc
    v_cmp_ge_f32 vcc, 0x67800000, v120
    s_and_b64 s[96:97], s[96:97], vcc
    s_cmp_eq_u64 s[96:97], -1
    s_cselect_b32 s96, s25, 1
    s_cmp_lg_u32 s96, 0
    s_cbranch_scc1 L_t2_redo
L_t2_safe:
    v_pk_add_f32 v[224:225], v[224:225], v[240:241]
    v_pk_add_f32 v[226:227], v[226:227], v[242:243]
    v_pk_add_f32 v[228:229], v[228:229], v[244:245]
    v_pk_add_f32 v[230:231], v[230:231], v[246:247]
    v_pk_mul_f32 v[224:225], v[224:225], v[118:119] op_sel_hi:[1,0]
    v_pk_mul_f32 v[226:227], v[226:227], v[118:119] op_sel_hi:[1,0]
    v_pk_mul_f32 v[228:229], v[228:229], v[118:119] op_sel_hi:[1,0]
    v_pk_mul_f32 v[230:231], v[230:231], v[118:119] op_sel_hi:[1,0]
    v_cvt_pk_bf16_f32 v224, v224, v225
    v_cvt_pk_bf16_f32 v225, v226, v227
    v_cvt_pk_bf16_f32 v226, v228, v229
    v_cvt_pk_bf16_f32 v227, v230, v231
    buffer_store_dwordx4 v[224:227], v15, s[8:11], s101 offen offset:0 sc0 sc1
    ds_read_b64_tr_b16 a[192:193], v56 offset:32768
    ds_read_b64_tr_b16 a[194:195], v56 offset:34816
    ds_read_b64_tr_b16 a[196:197], v56 offset:36864
    ds_read_b64_tr_b16 a[198:199], v56 offset:38912
    ds_read_b64_tr_b16 a[200:201], v57 offset:32768
    ds_read_b64_tr_b16 a[202:203], v57 offset:34816
    ds_read_b64_tr_b16 a[204:205], v57 offset:36864
    ds_read_b64_tr_b16 a[206:207], v57 offset:38912
    v_pk_add_f32 v[232:233], v[232:233], v[248:249]
    v_pk_add_f32 v[234:235], v[234:235], v[250:251]
    v_pk_add_f32 v[236:237], v[236:237], v[252:253]
    v_pk_add_f32 v[238:239], v[238:239], v[254:255]
    v_pk_mul_f32 v[232:233], v[232:233], v[118:119] op_sel_hi:[1,0]
    v_pk_mul_f32 v[234:235], v[234:235], v[118:119] op_sel_hi:[1,0]
    v_pk_mul_f32 v[236:237], v[236:237], v[118:119] op_sel_hi:[1,0]
    v_pk_mul_f32 v[238:239], v[238:239], v[118:119] op_sel_hi:[1,0]
    v_cvt_pk_bf16_f32 v232, v232, v233
    v_cvt_pk_bf16_f32 v233, v234, v235
    v_cvt_pk_bf16_f32 v234, v236, v237
    v_cvt_pk_bf16_f32 v235, v238, v239
    buffer_store_dwordx4 v[232:235], v15, s[8:11], s101 offen offset:1024 sc0 sc1
    ds_read_b64_tr_b16 a[208:209], v56 offset:40960
    ds_read_b64_tr_b16 a[210:211], v56 offset:43008
    ds_read_b64_tr_b16 a[212:213], v56 offset:45056
    ds_read_b64_tr_b16 a[214:215], v56 offset:47104
    ds_read_b64_tr_b16 a[216:217], v57 offset:40960
    ds_read_b64_tr_b16 a[218:219], v57 offset:43008
    ds_read_b64_tr_b16 a[220:221], v57 offset:45056
    ds_read_b64_tr_b16 a[222:223], v57 offset:47104
    s_waitcnt lgkmcnt(14)
    v_mfma_f32_16x16x32_bf16 v[64:67], a[192:195], a[64:67], 0
    s_waitcnt lgkmcnt(12)
    s_add_u32 m0, s62, 0
    ds_read_b64_tr_b16 a[224:225], v56 offset:49152
    v_mfma_f32_16x16x32_bf16 v[64:67], a[196:199], a[68:71], v[64:67]
    s_xor_b32 s98, s65, 128
    ds_read_b64_tr_b16 a[226:227], v56 offset:51200
    v_mfma_f32_16x16x32_bf16 v[72:75], a[192:195], a[80:83], 0
    buffer_load_dwordx4 v24, s[28:31], s98 offen offset:0   lds
    v_mfma_f32_16x16x32_bf16 v[72:75], a[196:199], a[84:87], v[72:75]
    s_waitcnt lgkmcnt(12)
    ds_read_b64_tr_b16 a[228:229], v56 offset:53248
    v_mfma_f32_16x16x32_bf16 v[68:71], a[200:203], a[64:67], 0
    s_waitcnt lgkmcnt(11)
    ds_read_b64_tr_b16 a[230:231], v56 offset:55296
    v_mfma_f32_16x16x32_bf16 v[68:71], a[204:207], a[68:71], v[68:71]
    s_add_u32 s22, s22, 65536
    ds_read_b64_tr_b16 a[232:233], v57 offset:49152
    v_mfma_f32_16x16x32_bf16 v[76:79], a[200:203], a[80:83], 0
    buffer_load_dwordx4 v25, s[28:31], s98 offen offset:1024   lds
    ds_read_b64_tr_b16 a[234:235], v57 offset:51200
    v_mfma_f32_16x16x32_bf16 v[76:79], a[204:207], a[84:87], v[76:79]
    s_waitcnt lgkmcnt(12)
    s_add_u32 s23, s23, 65536
    ds_read_b64_tr_b16 a[236:237], v57 offset:53248
    v_mfma_f32_16x16x32_bf16 v[64:67], a[208:211], a[72:75], v[64:67]
    s_waitcnt lgkmcnt(11)
    s_lshl_b32 s24, s61, 2
    ds_read_b64_tr_b16 a[238:239], v57 offset:55296
    v_mfma_f32_16x16x32_bf16 v[64:67], a[212:215], a[76:79], v[64:67]
    s_add_u32 s24, s24, s3
    ds_read_b64_tr_b16 a[240:241], v56 offset:57344
    v_mfma_f32_16x16x32_bf16 v[72:75], a[208:211], a[88:91], v[72:75]
    buffer_load_dwordx4 v26, s[28:31], s98 offen offset:2048   lds
    v_mfma_f32_16x16x32_bf16 v[72:75], a[212:215], a[92:95], v[72:75]
    s_waitcnt lgkmcnt(7)
    s_lshl_b32 s24, s24, 3
    ds_read_b64_tr_b16 a[242:243], v56 offset:59392
    v_mfma_f32_16x16x32_bf16 v[68:71], a[216:219], a[72:75], v[68:71]
    s_add_u32 s24, s24, s4
    ds_read_b64_tr_b16 a[244:245], v56 offset:61440
    v_mfma_f32_16x16x32_bf16 v[68:71], a[220:223], a[76:79], v[68:71]
    s_lshl_b32 s24, s24, 2
    ds_read_b64_tr_b16 a[246:247], v56 offset:63488
    v_mfma_f32_16x16x32_bf16 v[76:79], a[216:219], a[88:91], v[76:79]
    buffer_load_dwordx4 v27, s[28:31], s98 offen offset:3072   lds
    ds_read_b64_tr_b16 a[248:249], v57 offset:57344
    v_mfma_f32_16x16x32_bf16 v[76:79], a[220:223], a[92:95], v[76:79]
    s_add_u32 m0, s62, 4096
    ds_read_b64_tr_b16 a[250:251], v57 offset:59392
    v_mfma_f32_16x16x32_bf16 v[64:67], a[224:227], a[96:99], v[64:67]
    s_waitcnt lgkmcnt(8)
    s_xor_b32 s98, s65, 32896
    ds_read_b64_tr_b16 a[252:253], v57 offset:61440
    v_mfma_f32_16x16x32_bf16 v[64:67], a[228:231], a[100:103], v[64:67]
    s_add_u32 s24, s24, s5
    ds_read_b64_tr_b16 a[254:255], v57 offset:63488
    v_mfma_f32_16x16x32_bf16 v[72:75], a[224:227], a[112:115], v[72:75]
    buffer_load_dwordx4 v24, s[28:31], s98 offen offset:0   lds
    v_mfma_f32_16x16x32_bf16 v[72:75], a[228:231], a[116:119], v[72:75]
    s_lshl_b32 s24, s24, 13
    ds_read_b64_tr_b16 a[192:193], v58 offset:32768
    v_mfma_f32_16x16x32_bf16 v[68:71], a[232:235], a[96:99], v[68:71]
    s_waitcnt lgkmcnt(8)
    s_add_u32 s24, s24, 50331648
    ds_read_b64_tr_b16 a[194:195], v58 offset:34816
    v_mfma_f32_16x16x32_bf16 v[68:71], a[236:239], a[100:103], v[68:71]
    ds_read_b64_tr_b16 a[196:197], v58 offset:36864
    v_mfma_f32_16x16x32_bf16 v[76:79], a[232:235], a[112:115], v[76:79]
    buffer_load_dwordx4 v25, s[28:31], s98 offen offset:1024   lds
    ds_read_b64_tr_b16 a[198:199], v58 offset:38912
    v_mfma_f32_16x16x32_bf16 v[76:79], a[236:239], a[116:119], v[76:79]
    s_waitcnt lgkmcnt(8)
    ds_read_b64_tr_b16 a[200:201], v59 offset:32768
    v_mfma_f32_16x16x32_bf16 v[64:67], a[240:243], a[104:107], v[64:67]
    ds_read_b64_tr_b16 a[202:203], v59 offset:34816
    v_mfma_f32_16x16x32_bf16 v[64:67], a[244:247], a[108:111], v[64:67]
    ds_read_b64_tr_b16 a[204:205], v59 offset:36864
    v_mfma_f32_16x16x32_bf16 v[72:75], a[240:243], a[120:123], v[72:75]
    buffer_load_dwordx4 v26, s[28:31], s98 offen offset:2048   lds
    ds_read_b64_tr_b16 a[206:207], v59 offset:38912
    v_mfma_f32_16x16x32_bf16 v[72:75], a[244:247], a[124:127], v[72:75]
    s_waitcnt lgkmcnt(8)
    ds_read_b64_tr_b16 a[208:209], v58 offset:40960
    v_mfma_f32_16x16x32_bf16 v[68:71], a[248:251], a[104:107], v[68:71]
    ds_read_b64_tr_b16 a[210:211], v58 offset:43008
    v_mfma_f32_16x16x32_bf16 v[68:71], a[252:255], a[108:111], v[68:71]
    ds_read_b64_tr_b16 a[212:213], v58 offset:45056
    v_mfma_f32_16x16x32_bf16 v[76:79], a[248:251], a[120:123], v[76:79]
    buffer_load_dwordx4 v27, s[28:31], s98 offen offset:3072   lds
    ds_read_b64_tr_b16 a[214:215], v58 offset:47104
    v_mfma_f32_16x16x32_bf16 v[76:79], a[252:255], a[124:127], v[76:79]
    s_waitcnt lgkmcnt(9)
    ds_read_b64_tr_b16 a[216:217], v59 offset:40960
    v_mfma_f32_16x16x32_bf16 v[80:83], a[192:195], a[64:67], 0
    s_waitcnt lgkmcnt(9)
    ds_read_b64_tr_b16 a[218:219], v59 offset:43008
    v_mfma_f32_16x16x32_bf16 v[80:83], a[196:199], a[68:71], v[80:83]
    ds_read_b64_tr_b16 a[220:221], v59 offset:45056
    v_mfma_f32_16x16x32_bf16 v[88:91], a[192:195], a[80:83], 0
    ds_read_b64_tr_b16 a[222:223], v59 offset:47104
    s_waitcnt vmcnt(16)
    s_barrier
    v_mfma_f32_16x16x32_bf16 v[88:91], a[196:199], a[84:87], v[88:91]
    s_waitcnt lgkmcnt(9)
    s_add_u32 m0, s62, 98304
    ds_read_b64_tr_b16 a[224:225], v58 offset:49152
    v_mfma_f32_16x16x32_bf16 v[84:87], a[200:203], a[64:67], 0
    s_waitcnt lgkmcnt(9)
    s_xor_b32 s98, s65, 262272
    ds_read_b64_tr_b16 a[226:227], v58 offset:51200
    v_mfma_f32_16x16x32_bf16 v[84:87], a[204:207], a[68:71], v[84:87]
    buffer_load_dwordx4 v24, s[28:31], s98 offen offset:0   lds
    ds_read_b64_tr_b16 a[228:229], v58 offset:53248
    v_mfma_f32_16x16x32_bf16 v[92:95], a[200:203], a[80:83], 0
    ds_read_b64_tr_b16 a[230:231], v58 offset:55296
    v_mfma_f32_16x16x32_bf16 v[92:95], a[204:207], a[84:87], v[92:95]
    s_waitcnt lgkmcnt(9)
    ds_read_b64_tr_b16 a[232:233], v59 offset:49152
    v_mfma_f32_16x16x32_bf16 v[80:83], a[208:211], a[72:75], v[80:83]
    s_waitcnt lgkmcnt(9)
    ds_read_b64_tr_b16 a[234:235], v59 offset:51200
    v_mfma_f32_16x16x32_bf16 v[80:83], a[212:215], a[76:79], v[80:83]
    buffer_load_dwordx4 v25, s[28:31], s98 offen offset:1024   lds
    ds_read_b64_tr_b16 a[236:237], v59 offset:53248
    v_mfma_f32_16x16x32_bf16 v[88:91], a[208:211], a[88:91], v[88:91]
    ds_read_b64_tr_b16 a[238:239], v59 offset:55296
    v_mfma_f32_16x16x32_bf16 v[88:91], a[212:215], a[92:95], v[88:91]
    s_waitcnt lgkmcnt(9)
    ds_read_b64_tr_b16 a[240:241], v58 offset:57344
    v_mfma_f32_16x16x32_bf16 v[84:87], a[216:219], a[72:75], v[84:87]
    s_waitcnt lgkmcnt(9)
    ds_read_b64_tr_b16 a[242:243], v58 offset:59392
    v_mfma_f32_16x16x32_bf16 v[84:87], a[220:223], a[76:79], v[84:87]
    buffer_load_dwordx4 v26, s[28:31], s98 offen offset:2048   lds
    ds_read_b64_tr_b16 a[244:245], v58 offset:61440
    v_mfma_f32_16x16x32_bf16 v[92:95], a[216:219], a[88:91], v[92:95]
    ds_read_b64_tr_b16 a[246:247], v58 offset:63488
    v_mfma_f32_16x16x32_bf16 v[92:95], a[220:223], a[92:95], v[92:95]
    s_waitcnt lgkmcnt(9)
    ds_read_b64_tr_b16 a[248:249], v59 offset:57344
    v_mfma_f32_16x16x32_bf16 v[80:83], a[224:227], a[96:99], v[80:83]
    s_waitcnt lgkmcnt(9)
    ds_read_b64_tr_b16 a[250:251], v59 offset:59392
    v_mfma_f32_16x16x32_bf16 v[80:83], a[228:231], a[100:103], v[80:83]
    buffer_load_dwordx4 v27, s[28:31], s98 offen offset:3072   lds
    ds_read_b64_tr_b16 a[252:253], v59 offset:61440
    v_mfma_f32_16x16x32_bf16 v[88:91], a[224:227], a[112:115], v[88:91]
    s_add_u32 m0, s62, 102400
    ds_read_b64_tr_b16 a[254:255], v59 offset:63488
    v_mfma_f32_16x16x32_bf16 v[88:91], a[228:231], a[116:119], v[88:91]
    s_waitcnt lgkmcnt(9)
    s_xor_b32 s98, s65, 295040
    ds_read_b64_tr_b16 a[192:193], v60 offset:0
    v_mfma_f32_16x16x32_bf16 v[84:87], a[232:235], a[96:99], v[84:87]
    s_waitcnt lgkmcnt(9)
    ds_read_b64_tr_b16 a[194:195], v60 offset:2048
    v_mfma_f32_16x16x32_bf16 v[84:87], a[236:239], a[100:103], v[84:87]
    buffer_load_dwordx4 v24, s[28:31], s98 offen offset:0   lds
    ds_read_b64_tr_b16 a[196:197], v60 offset:4096
    v_mfma_f32_16x16x32_bf16 v[92:95], a[232:235], a[112:115], v[92:95]
    ds_read_b64_tr_b16 a[198:199], v60 offset:6144
    v_mfma_f32_16x16x32_bf16 v[92:95], a[236:239], a[116:119], v[92:95]
    s_waitcnt lgkmcnt(9)
    ds_read_b64_tr_b16 a[200:201], v61 offset:0
    v_mfma_f32_16x16x32_bf16 v[80:83], a[240:243], a[104:107], v[80:83]
    s_waitcnt lgkmcnt(9)
    ds_read_b64_tr_b16 a[202:203], v61 offset:2048
    v_mfma_f32_16x16x32_bf16 v[80:83], a[244:247], a[108:111], v[80:83]
    buffer_load_dwordx4 v25, s[28:31], s98 offen offset:1024   lds
    ds_read_b64_tr_b16 a[204:205], v61 offset:4096
    v_mfma_f32_16x16x32_bf16 v[88:91], a[240:243], a[120:123], v[88:91]
    ds_read_b64_tr_b16 a[206:207], v61 offset:6144
    v_mfma_f32_16x16x32_bf16 v[88:91], a[244:247], a[124:127], v[88:91]
    s_waitcnt lgkmcnt(9)
    ds_read_b64_tr_b16 a[208:209], v60 offset:8192
    v_mfma_f32_16x16x32_bf16 v[84:87], a[248:251], a[104:107], v[84:87]
    s_waitcnt lgkmcnt(9)
    ds_read_b64_tr_b16 a[210:211], v60 offset:10240
    v_lshrrev_b32 v46, 2, v2
    v_mfma_f32_16x16x32_bf16 v[84:87], a[252:255], a[108:111], v[84:87]
    buffer_load_dwordx4 v26, s[28:31], s98 offen offset:2048   lds
    ds_read_b64_tr_b16 a[212:213], v60 offset:12288
    v_mfma_f32_16x16x32_bf16 v[92:95], a[248:251], a[120:123], v[92:95]
    ds_read_b64_tr_b16 a[214:215], v60 offset:14336
    v_and_b32 v45, 3, v2
    v_mfma_f32_16x16x32_bf16 v[92:95], a[252:255], a[124:127], v[92:95]
    s_waitcnt lgkmcnt(9)
    ds_read_b64_tr_b16 a[216:217], v61 offset:8192
    v_lshlrev_b32 v44, 8, v46
    v_mfma_f32_16x16x32_bf16 v[64:67], a[192:195], a[0:3], v[64:67]
    s_waitcnt lgkmcnt(9)
    ds_read_b64_tr_b16 a[218:219], v61 offset:10240
    v_lshl_add_u32 v44, v45, 4, v44
    v_mfma_f32_16x16x32_bf16 v[64:67], a[196:199], a[4:7], v[64:67]
    buffer_load_dwordx4 v27, s[28:31], s98 offen offset:3072   lds
    ds_read_b64_tr_b16 a[220:221], v61 offset:12288
    v_mfma_f32_16x16x32_bf16 v[72:75], a[192:195], a[16:19], v[72:75]
    ds_read_b64_tr_b16 a[222:223], v61 offset:14336
    v_lshlrev_b32 v45, 3, v45
    v_mfma_f32_16x16x32_bf16 v[72:75], a[196:199], a[20:23], v[72:75]
    s_waitcnt lgkmcnt(9)
    ds_read_b64_tr_b16 a[224:225], v60 offset:16384
    v_lshl_add_u32 v45, v46, 6, v45
    v_mfma_f32_16x16x32_bf16 v[68:71], a[200:203], a[0:3], v[68:71]
    s_waitcnt lgkmcnt(9)
    ds_read_b64_tr_b16 a[226:227], v60 offset:18432
    v_lshlrev_b32 v46, 1, v45
    v_mfma_f32_16x16x32_bf16 v[68:71], a[204:207], a[4:7], v[68:71]
    s_lshl_b32 s70, s2, 15
    ds_read_b64_tr_b16 a[228:229], v60 offset:20480
    v_mfma_f32_16x16x32_bf16 v[76:79], a[200:203], a[16:19], v[76:79]
    s_lshl_b32 s100, s3, 6
    ds_read_b64_tr_b16 a[230:231], v60 offset:22528
    v_mfma_f32_16x16x32_bf16 v[76:79], a[204:207], a[20:23], v[76:79]
    s_waitcnt lgkmcnt(9)
    s_add_u32 s70, s70, s100
    ds_read_b64_tr_b16 a[232:233], v61 offset:16384
    v_mfma_f32_16x16x32_bf16 v[64:67], a[208:211], a[8:11], v[64:67]
    s_waitcnt lgkmcnt(9)
    s_add_u32 s70, s70, 67108864
    ds_read_b64_tr_b16 a[234:235], v61 offset:18432
    v_mfma_f32_16x16x32_bf16 v[64:67], a[212:215], a[12:15], v[64:67]
    s_and_b32 s68, s2, 31
    ds_read_b64_tr_b16 a[236:237], v61 offset:20480
    v_mfma_f32_16x16x32_bf16 v[72:75], a[208:211], a[24:27], v[72:75]
    s_lshl_b32 s68, s68, 2
    ds_read_b64_tr_b16 a[238:239], v61 offset:22528
    v_mfma_f32_16x16x32_bf16 v[72:75], a[212:215], a[28:31], v[72:75]
    s_waitcnt lgkmcnt(9)
    s_add_u32 s68, s68, s3
    ds_read_b64_tr_b16 a[240:241], v60 offset:24576
    v_mfma_f32_16x16x32_bf16 v[68:71], a[216:219], a[8:11], v[68:71]
    s_waitcnt lgkmcnt(9)
    s_lshl_b32 s69, s61, 7
    ds_read_b64_tr_b16 a[242:243], v60 offset:26624
    v_mfma_f32_16x16x32_bf16 v[68:71], a[220:223], a[12:15], v[68:71]
    s_add_u32 s69, s69, s68
    ds_read_b64_tr_b16 a[244:245], v60 offset:28672
    v_mfma_f32_16x16x32_bf16 v[76:79], a[216:219], a[24:27], v[76:79]
    s_lshl_b32 s100, s60, 7
    ds_read_b64_tr_b16 a[246:247], v60 offset:30720
    v_mfma_f32_16x16x32_bf16 v[76:79], a[220:223], a[28:31], v[76:79]
    s_waitcnt lgkmcnt(9)
    s_add_u32 s68, s68, s100
    ds_read_b64_tr_b16 a[248:249], v61 offset:24576
    v_mfma_f32_16x16x32_bf16 v[64:67], a[224:227], a[32:35], v[64:67]
    s_waitcnt lgkmcnt(9)
    s_lshl_b32 s100, s68, 10
    ds_read_b64_tr_b16 a[250:251], v61 offset:26624
    v_mfma_f32_16x16x32_bf16 v[64:67], a[228:231], a[36:39], v[64:67]
    s_lshl_b32 s101, s69, 10
    ds_read_b64_tr_b16 a[252:253], v61 offset:28672
    v_mfma_f32_16x16x32_bf16 v[72:75], a[224:227], a[48:51], v[72:75]
    ds_read_b64_tr_b16 a[254:255], v61 offset:30720
    ds_read_b64_tr_b16 a[208:209], v62 offset:8192
    v_mfma_f32_16x16x32_bf16 v[72:75], a[228:231], a[52:55], v[72:75]
    s_waitcnt lgkmcnt(10)
    ds_read_b64_tr_b16 a[192:193], v62 offset:0
    ds_read_b64_tr_b16 a[210:211], v62 offset:10240
    v_mfma_f32_16x16x32_bf16 v[68:71], a[232:235], a[32:35], v[68:71]
    s_waitcnt lgkmcnt(11)
    ds_read_b64_tr_b16 a[194:195], v62 offset:2048
    ds_read_b64_tr_b16 a[212:213], v62 offset:12288
    v_mfma_f32_16x16x32_bf16 v[68:71], a[236:239], a[36:39], v[68:71]
    ds_read_b64_tr_b16 a[196:197], v62 offset:4096
    ds_read_b64_tr_b16 a[214:215], v62 offset:14336
    v_mfma_f32_16x16x32_bf16 v[76:79], a[232:235], a[48:51], v[76:79]
    ds_read_b64_tr_b16 a[198:199], v62 offset:6144
    ds_read_b64_tr_b16 a[216:217], v63 offset:8192
    v_mfma_f32_16x16x32_bf16 v[76:79], a[236:239], a[52:55], v[76:79]
    s_waitcnt lgkmcnt(14)
    ds_read_b64_tr_b16 a[200:201], v63 offset:0
    ds_read_b64_tr_b16 a[218:219], v63 offset:10240
    v_mfma_f32_16x16x32_bf16 v[64:67], a[240:243], a[40:43], v[64:67]
    s_waitcnt lgkmcnt(15)
    ds_read_b64_tr_b16 a[202:203], v63 offset:2048
    ds_read_b64_tr_b16 a[220:221], v63 offset:12288
    v_mfma_f32_16x16x32_bf16 v[64:67], a[244:247], a[44:47], v[64:67]
    ds_read_b64_tr_b16 a[204:205], v63 offset:4096
    ds_read_b64_tr_b16 a[222:223], v63 offset:14336
    v_mfma_f32_16x16x32_bf16 v[72:75], a[240:243], a[56:59], v[72:75]
    s_waitcnt lgkmcnt(15)
    ds_read_b64_tr_b16 a[206:207], v63 offset:6144
    s_waitcnt vmcnt(16)
    v_mfma_f32_16x16x32_bf16 v[72:75], a[244:247], a[60:63], v[72:75]
    buffer_store_dword v6, v5, s[8:11], s22 offen sc0 sc1
    v_mfma_f32_16x16x32_bf16 v[68:71], a[248:251], a[40:43], v[68:71]
    ds_read_b64_tr_b16 a[224:225], v62 offset:16384
    v_mfma_f32_16x16x32_bf16 v[68:71], a[252:255], a[44:47], v[68:71]
    ds_read_b64_tr_b16 a[226:227], v62 offset:18432
    v_mfma_f32_16x16x32_bf16 v[76:79], a[248:251], a[56:59], v[76:79]
    ds_read_b64_tr_b16 a[228:229], v62 offset:20480
    v_mfma_f32_16x16x32_bf16 v[76:79], a[252:255], a[60:63], v[76:79]
    s_waitcnt lgkmcnt(12)
    ds_read_b64_tr_b16 a[230:231], v62 offset:22528
    v_mfma_f32_16x16x32_bf16 v[80:83], a[192:195], a[0:3], v[80:83]
    s_waitcnt lgkmcnt(11)
    ds_read_b64_tr_b16 a[232:233], v63 offset:16384
    v_mfma_f32_16x16x32_bf16 v[80:83], a[196:199], a[4:7], v[80:83]
    ds_read_b64_tr_b16 a[234:235], v63 offset:18432
    v_mfma_f32_16x16x32_bf16 v[88:91], a[192:195], a[16:19], v[88:91]
    ds_read_b64_tr_b16 a[236:237], v63 offset:20480
    v_mfma_f32_16x16x32_bf16 v[88:91], a[196:199], a[20:23], v[88:91]
    s_waitcnt lgkmcnt(8)
    ds_read_b64_tr_b16 a[238:239], v63 offset:22528
    v_mfma_f32_16x16x32_bf16 v[84:87], a[200:203], a[0:3], v[84:87]
    s_waitcnt lgkmcnt(8)
    ds_read_b64_tr_b16 a[240:241], v62 offset:24576
    v_mfma_f32_16x16x32_bf16 v[84:87], a[204:207], a[4:7], v[84:87]
    ds_read_b64_tr_b16 a[242:243], v62 offset:26624
    v_mfma_f32_16x16x32_bf16 v[92:95], a[200:203], a[16:19], v[92:95]
    ds_read_b64_tr_b16 a[244:245], v62 offset:28672
    v_cvt_pk_bf16_f32 v64, v64, v65
    s_waitcnt vmcnt(1)
    s_barrier
    v_mfma_f32_16x16x32_bf16 v[92:95], a[204:207], a[20:23], v[92:95]
    s_xor_b32 s74, s24, 0
    ds_read_b64_tr_b16 a[246:247], v62 offset:30720
    v_cvt_pk_bf16_f32 v65, v66, v67
    v_mfma_f32_16x16x32_bf16 v[80:83], a[208:211], a[8:11], v[80:83]
    buffer_load_dwordx4 v[128:131], v1, s[8:11], s74 offen offset:0
    v_mfma_f32_16x16x32_bf16 v[80:83], a[212:215], a[12:15], v[80:83]
    s_xor_b32 s74, s24, 4096
    ds_read_b64_tr_b16 a[248:249], v63 offset:24576
    v_cvt_pk_bf16_f32 v66, v68, v69
    v_mfma_f32_16x16x32_bf16 v[88:91], a[208:211], a[24:27], v[88:91]
    ds_read_b64_tr_b16 a[250:251], v63 offset:26624
    v_cvt_pk_bf16_f32 v67, v70, v71
    v_mfma_f32_16x16x32_bf16 v[88:91], a[212:215], a[28:31], v[88:91]
    buffer_load_dwordx4 v[144:147], v1, s[8:11], s74 offen offset:0
    ds_read_b64_tr_b16 a[252:253], v63 offset:28672
    v_mfma_f32_16x16x32_bf16 v[84:87], a[216:219], a[8:11], v[84:87]
    s_xor_b32 s74, s24, 0
    ds_read_b64_tr_b16 a[254:255], v63 offset:30720
    v_min_u32 v64, -2, v64
    v_mfma_f32_16x16x32_bf16 v[84:87], a[220:223], a[12:15], v[84:87]
    ds_read_b64_tr_b16 a[192:193], v56 offset:0
    v_min_u32 v65, -2, v65
    v_mfma_f32_16x16x32_bf16 v[92:95], a[216:219], a[24:27], v[92:95]
    buffer_load_dwordx4 v[132:135], v1, s[8:11], s74 offen offset:1024
    v_mfma_f32_16x16x32_bf16 v[92:95], a[220:223], a[28:31], v[92:95]
    s_waitcnt lgkmcnt(7)
    s_xor_b32 s74, s24, 4096
    ds_read_b64_tr_b16 a[194:195], v56 offset:2048
    v_min_u32 v66, -2, v66
    v_mfma_f32_16x16x32_bf16 v[80:83], a[224:227], a[32:35], v[80:83]
    ds_read_b64_tr_b16 a[196:197], v56 offset:4096
    v_min_u32 v67, -2, v67
    v_mfma_f32_16x16x32_bf16 v[80:83], a[228:231], a[36:39], v[80:83]
    buffer_load_dwordx4 v[148:151], v1, s[8:11], s74 offen offset:1024
    v_mfma_f32_16x16x32_bf16 v[88:91], a[224:227], a[48:51], v[88:91]
    s_xor_b32 s74, s24, 0
    ds_read_b64_tr_b16 a[198:199], v56 offset:6144
    v_mfma_f32_16x16x32_bf16 v[88:91], a[228:231], a[52:55], v[88:91]
    s_add_u32 s75, s18, 0
    ds_read_b64_tr_b16 a[200:201], v57 offset:0
    v_mfma_f32_16x16x32_bf16 v[84:87], a[232:235], a[32:35], v[84:87]
    buffer_load_dwordx4 v[136:139], v1, s[8:11], s74 offen offset:2048
    ds_read_b64_tr_b16 a[202:203], v57 offset:2048
    v_mfma_f32_16x16x32_bf16 v[84:87], a[236:239], a[36:39], v[84:87]
    s_xor_b32 s74, s24, 4096
    ds_read_b64_tr_b16 a[204:205], v57 offset:4096
    v_mfma_f32_16x16x32_bf16 v[92:95], a[232:235], a[48:51], v[92:95]
    buffer_store_dwordx4 v[64:67], v23, s[8:11], s75 offen offset:0 sc0 sc1
    ds_read_b64_tr_b16 a[206:207], v57 offset:6144
    v_mfma_f32_16x16x32_bf16 v[92:95], a[236:239], a[52:55], v[92:95]
    buffer_load_dwordx4 v[152:155], v1, s[8:11], s74 offen offset:2048
    v_mfma_f32_16x16x32_bf16 v[80:83], a[240:243], a[40:43], v[80:83]
    s_waitcnt lgkmcnt(7)
    s_xor_b32 s74, s24, 0
    ds_read_b64_tr_b16 a[208:209], v56 offset:8192
    v_cvt_pk_bf16_f32 v72, v72, v73
    v_mfma_f32_16x16x32_bf16 v[80:83], a[244:247], a[44:47], v[80:83]
    ds_read_b64_tr_b16 a[210:211], v56 offset:10240
    v_cvt_pk_bf16_f32 v73, v74, v75
    v_mfma_f32_16x16x32_bf16 v[88:91], a[240:243], a[56:59], v[88:91]
    buffer_load_dwordx4 v[140:143], v1, s[8:11], s74 offen offset:3072
    v_mfma_f32_16x16x32_bf16 v[88:91], a[244:247], a[60:63], v[88:91]
    s_xor_b32 s74, s24, 4096
    ds_read_b64_tr_b16 a[212:213], v56 offset:12288
    v_cvt_pk_bf16_f32 v74, v76, v77
    v_mfma_f32_16x16x32_bf16 v[84:87], a[248:251], a[40:43], v[84:87]
    ds_read_b64_tr_b16 a[214:215], v56 offset:14336
    v_cvt_pk_bf16_f32 v75, v78, v79
    v_mfma_f32_16x16x32_bf16 v[84:87], a[252:255], a[44:47], v[84:87]
    buffer_load_dwordx4 v[156:159], v1, s[8:11], s74 offen offset:3072
    ds_read_b64_tr_b16 a[216:217], v57 offset:8192
    v_mfma_f32_16x16x32_bf16 v[92:95], a[248:251], a[56:59], v[92:95]
    ds_read_b64_tr_b16 a[218:219], v57 offset:10240
    v_min_u32 v72, -2, v72
    v_mfma_f32_16x16x32_bf16 v[92:95], a[252:255], a[60:63], v[92:95]
    s_waitcnt lgkmcnt(7)
    ds_read_b64_tr_b16 a[220:221], v57 offset:12288
    v_min_u32 v73, -2, v73
    v_mfma_f32_16x16x32_bf16 v[96:99], a[192:195], a[64:67], 0
    ds_read_b64_tr_b16 a[222:223], v57 offset:14336
    v_min_u32 v74, -2, v74
    v_mfma_f32_16x16x32_bf16 v[96:99], a[196:199], a[68:71], v[96:99]
    ds_read_b64_tr_b16 a[224:225], v56 offset:16384
    v_min_u32 v75, -2, v75
    v_mfma_f32_16x16x32_bf16 v[104:107], a[192:195], a[80:83], 0
    s_add_u32 s75, s18, 131072
    ds_read_b64_tr_b16 a[226:227], v56 offset:18432
    v_mfma_f32_16x16x32_bf16 v[104:107], a[196:199], a[84:87], v[104:107]
    buffer_store_dwordx4 v[72:75], v23, s[8:11], s75 offen offset:0 sc0 sc1
    ds_read_b64_tr_b16 a[228:229], v56 offset:20480
    v_mfma_f32_16x16x32_bf16 v[100:103], a[200:203], a[64:67], 0
    s_waitcnt lgkmcnt(9)
    ds_read_b64_tr_b16 a[230:231], v56 offset:22528
    v_mfma_f32_16x16x32_bf16 v[100:103], a[204:207], a[68:71], v[100:103]
    ds_read_b64_tr_b16 a[232:233], v57 offset:16384
    v_mfma_f32_16x16x32_bf16 v[108:111], a[200:203], a[80:83], 0
    ds_read_b64_tr_b16 a[234:235], v57 offset:18432
    v_mfma_f32_16x16x32_bf16 v[108:111], a[204:207], a[84:87], v[108:111]
    ds_read_b64_tr_b16 a[236:237], v57 offset:20480
    v_mfma_f32_16x16x32_bf16 v[96:99], a[208:211], a[72:75], v[96:99]
    s_waitcnt lgkmcnt(9)
    ds_read_b64_tr_b16 a[238:239], v57 offset:22528
    v_mfma_f32_16x16x32_bf16 v[96:99], a[212:215], a[76:79], v[96:99]
    ds_read_b64_tr_b16 a[240:241], v56 offset:24576
    v_mfma_f32_16x16x32_bf16 v[104:107], a[208:211], a[88:91], v[104:107]
    ds_read_b64_tr_b16 a[242:243], v56 offset:26624
    v_mfma_f32_16x16x32_bf16 v[104:107], a[212:215], a[92:95], v[104:107]
    ds_read_b64_tr_b16 a[244:245], v56 offset:28672
    v_mfma_f32_16x16x32_bf16 v[100:103], a[216:219], a[72:75], v[100:103]
    s_waitcnt lgkmcnt(9)
    ds_read_b64_tr_b16 a[246:247], v56 offset:30720
    v_mfma_f32_16x16x32_bf16 v[100:103], a[220:223], a[76:79], v[100:103]
    ds_read_b64_tr_b16 a[248:249], v57 offset:24576
    v_mfma_f32_16x16x32_bf16 v[108:111], a[216:219], a[88:91], v[108:111]
    ds_read_b64_tr_b16 a[250:251], v57 offset:26624
    v_mfma_f32_16x16x32_bf16 v[108:111], a[220:223], a[92:95], v[108:111]
    ds_read_b64_tr_b16 a[252:253], v57 offset:28672
    v_mfma_f32_16x16x32_bf16 v[96:99], a[224:227], a[96:99], v[96:99]
    s_waitcnt lgkmcnt(9)
    ds_read_b64_tr_b16 a[254:255], v57 offset:30720
    v_mfma_f32_16x16x32_bf16 v[96:99], a[228:231], a[100:103], v[96:99]
    ds_read_b64_tr_b16 a[192:193], v60 offset:32768
    v_mfma_f32_16x16x32_bf16 v[104:107], a[224:227], a[112:115], v[104:107]
    ds_read_b64_tr_b16 a[194:195], v60 offset:34816
    v_mfma_f32_16x16x32_bf16 v[104:107], a[228:231], a[116:119], v[104:107]
    ds_read_b64_tr_b16 a[196:197], v60 offset:36864
    v_mfma_f32_16x16x32_bf16 v[100:103], a[232:235], a[96:99], v[100:103]
    s_waitcnt lgkmcnt(9)
    ds_read_b64_tr_b16 a[198:199], v60 offset:38912
    v_cvt_pk_bf16_f32 v80, v80, v81
    v_mfma_f32_16x16x32_bf16 v[100:103], a[236:239], a[100:103], v[100:103]
    ds_read_b64_tr_b16 a[200:201], v61 offset:32768
    v_cvt_pk_bf16_f32 v81, v82, v83
    v_mfma_f32_16x16x32_bf16 v[108:111], a[232:235], a[112:115], v[108:111]
    ds_read_b64_tr_b16 a[202:203], v61 offset:34816
    v_cvt_pk_bf16_f32 v82, v84, v85
    v_mfma_f32_16x16x32_bf16 v[108:111], a[236:239], a[116:119], v[108:111]
    ds_read_b64_tr_b16 a[204:205], v61 offset:36864
    v_cvt_pk_bf16_f32 v83, v86, v87
    v_mfma_f32_16x16x32_bf16 v[96:99], a[240:243], a[104:107], v[96:99]
    s_waitcnt lgkmcnt(9)
    ds_read_b64_tr_b16 a[206:207], v61 offset:38912
    v_min_u32 v80, -2, v80
    v_mfma_f32_16x16x32_bf16 v[96:99], a[244:247], a[108:111], v[96:99]
    ds_read_b64_tr_b16 a[208:209], v60 offset:40960
    v_min_u32 v81, -2, v81
    v_mfma_f32_16x16x32_bf16 v[104:107], a[240:243], a[120:123], v[104:107]
    ds_read_b64_tr_b16 a[210:211], v60 offset:43008
    v_min_u32 v82, -2, v82
    v_mfma_f32_16x16x32_bf16 v[104:107], a[244:247], a[124:127], v[104:107]
    buffer_load_dword v3, v4, s[8:11], s23 offen sc0 sc1
    ds_read_b64_tr_b16 a[212:213], v60 offset:45056
    v_mfma_f32_16x16x32_bf16 v[100:103], a[248:251], a[104:107], v[100:103]
    s_waitcnt lgkmcnt(9)
    ds_read_b64_tr_b16 a[214:215], v60 offset:47104
    v_min_u32 v83, -2, v83
    v_mfma_f32_16x16x32_bf16 v[100:103], a[252:255], a[108:111], v[100:103]
    s_add_u32 s75, s18, 0
    ds_read_b64_tr_b16 a[216:217], v61 offset:40960
    v_mfma_f32_16x16x32_bf16 v[108:111], a[248:251], a[120:123], v[108:111]
    buffer_store_dwordx4 v[80:83], v23, s[8:11], s75 offen offset:256 sc0 sc1
    ds_read_b64_tr_b16 a[218:219], v61 offset:43008
    v_mfma_f32_16x16x32_bf16 v[108:111], a[252:255], a[124:127], v[108:111]
    ds_read_b64_tr_b16 a[220:221], v61 offset:45056
    v_cvt_pk_bf16_f32 v88, v88, v89
    v_mfma_f32_16x16x32_bf16 v[96:99], a[192:195], a[0:3], v[96:99]
    s_waitcnt lgkmcnt(9)
    ds_read_b64_tr_b16 a[222:223], v61 offset:47104
    v_cvt_pk_bf16_f32 v89, v90, v91
    v_mfma_f32_16x16x32_bf16 v[96:99], a[196:199], a[4:7], v[96:99]
    ds_read_b64_tr_b16 a[224:225], v60 offset:49152
    v_cvt_pk_bf16_f32 v90, v92, v93
    v_mfma_f32_16x16x32_bf16 v[104:107], a[192:195], a[16:19], v[104:107]
    ds_read_b64_tr_b16 a[226:227], v60 offset:51200
    v_cvt_pk_bf16_f32 v91, v94, v95
    v_mfma_f32_16x16x32_bf16 v[104:107], a[196:199], a[20:23], v[104:107]
    ds_read_b64_tr_b16 a[228:229], v60 offset:53248
    v_min_u32 v88, -2, v88
    v_mfma_f32_16x16x32_bf16 v[100:103], a[200:203], a[0:3], v[100:103]
    s_waitcnt lgkmcnt(9)
    ds_read_b64_tr_b16 a[230:231], v60 offset:55296
    v_min_u32 v89, -2, v89
    v_mfma_f32_16x16x32_bf16 v[100:103], a[204:207], a[4:7], v[100:103]
    ds_read_b64_tr_b16 a[232:233], v61 offset:49152
    v_min_u32 v90, -2, v90
    v_mfma_f32_16x16x32_bf16 v[108:111], a[200:203], a[16:19], v[108:111]
    ds_read_b64_tr_b16 a[234:235], v61 offset:51200
    v_min_u32 v91, -2, v91
    v_mfma_f32_16x16x32_bf16 v[108:111], a[204:207], a[20:23], v[108:111]
    s_waitcnt lgkmcnt(9)
    s_add_u32 s75, s18, 131072
    ds_read_b64_tr_b16 a[236:237], v61 offset:53248
    v_mfma_f32_16x16x32_bf16 v[96:99], a[208:211], a[8:11], v[96:99]
    buffer_store_dwordx4 v[88:91], v23, s[8:11], s75 offen offset:256 sc0 sc1
    ds_read_b64_tr_b16 a[238:239], v61 offset:55296
    v_mfma_f32_16x16x32_bf16 v[96:99], a[212:215], a[12:15], v[96:99]
    ds_read_b64_tr_b16 a[240:241], v60 offset:57344
    v_mfma_f32_16x16x32_bf16 v[104:107], a[208:211], a[24:27], v[104:107]
    ds_read_b64_tr_b16 a[242:243], v60 offset:59392
    v_mfma_f32_16x16x32_bf16 v[104:107], a[212:215], a[28:31], v[104:107]
    s_waitcnt lgkmcnt(9)
    ds_read_b64_tr_b16 a[244:245], v60 offset:61440
    v_mfma_f32_16x16x32_bf16 v[100:103], a[216:219], a[8:11], v[100:103]
    ds_read_b64_tr_b16 a[246:247], v60 offset:63488
    v_mfma_f32_16x16x32_bf16 v[100:103], a[220:223], a[12:15], v[100:103]
    ds_read_b64_tr_b16 a[248:249], v61 offset:57344
    v_mfma_f32_16x16x32_bf16 v[108:111], a[216:219], a[24:27], v[108:111]
    ds_read_b64_tr_b16 a[250:251], v61 offset:59392
    v_mfma_f32_16x16x32_bf16 v[108:111], a[220:223], a[28:31], v[108:111]
    s_waitcnt lgkmcnt(9)
    ds_read_b64_tr_b16 a[252:253], v61 offset:61440
    v_mfma_f32_16x16x32_bf16 v[96:99], a[224:227], a[32:35], v[96:99]
    ds_read_b64_tr_b16 a[254:255], v61 offset:63488
    v_mfma_f32_16x16x32_bf16 v[96:99], a[228:231], a[36:39], v[96:99]
    ds_read_b64_tr_b16 a[192:193], v58 offset:0
    v_mfma_f32_16x16x32_bf16 v[104:107], a[224:227], a[48:51], v[104:107]
    ds_read_b64_tr_b16 a[194:195], v58 offset:2048
    v_mfma_f32_16x16x32_bf16 v[104:107], a[228:231], a[52:55], v[104:107]
    s_waitcnt lgkmcnt(9)
    ds_read_b64_tr_b16 a[196:197], v58 offset:4096
    v_mfma_f32_16x16x32_bf16 v[100:103], a[232:235], a[32:35], v[100:103]
    ds_read_b64_tr_b16 a[198:199], v58 offset:6144
    v_mfma_f32_16x16x32_bf16 v[100:103], a[236:239], a[36:39], v[100:103]
    ds_read_b64_tr_b16 a[200:201], v59 offset:0
    v_mfma_f32_16x16x32_bf16 v[108:111], a[232:235], a[48:51], v[108:111]
    ds_read_b64_tr_b16 a[202:203], v59 offset:2048
    v_mfma_f32_16x16x32_bf16 v[108:111], a[236:239], a[52:55], v[108:111]
    s_waitcnt lgkmcnt(9)
    ds_read_b64_tr_b16 a[204:205], v59 offset:4096
    v_mfma_f32_16x16x32_bf16 v[96:99], a[240:243], a[40:43], v[96:99]
    ds_read_b64_tr_b16 a[206:207], v59 offset:6144
    v_mfma_f32_16x16x32_bf16 v[96:99], a[244:247], a[44:47], v[96:99]
    ds_read_b64_tr_b16 a[208:209], v58 offset:8192
    v_mfma_f32_16x16x32_bf16 v[104:107], a[240:243], a[56:59], v[104:107]
    ds_read_b64_tr_b16 a[210:211], v58 offset:10240
    v_mfma_f32_16x16x32_bf16 v[104:107], a[244:247], a[60:63], v[104:107]
    s_waitcnt lgkmcnt(9)
    ds_read_b64_tr_b16 a[212:213], v58 offset:12288
    v_mfma_f32_16x16x32_bf16 v[100:103], a[248:251], a[40:43], v[100:103]
    ds_read_b64_tr_b16 a[214:215], v58 offset:14336
    v_mfma_f32_16x16x32_bf16 v[100:103], a[252:255], a[44:47], v[100:103]
    ds_read_b64_tr_b16 a[216:217], v59 offset:8192
    v_mfma_f32_16x16x32_bf16 v[108:111], a[248:251], a[56:59], v[108:111]
    ds_read_b64_tr_b16 a[218:219], v59 offset:10240
    v_mfma_f32_16x16x32_bf16 v[108:111], a[252:255], a[60:63], v[108:111]
    s_waitcnt lgkmcnt(9)
    ds_read_b64_tr_b16 a[220:221], v59 offset:12288
    v_mfma_f32_16x16x32_bf16 v[112:115], a[192:195], a[64:67], 0
    ds_read_b64_tr_b16 a[222:223], v59 offset:14336
    v_mfma_f32_16x16x32_bf16 v[112:115], a[196:199], a[68:71], v[112:115]
    ds_read_b64_tr_b16 a[224:225], v58 offset:16384
    v_mfma_f32_16x16x32_bf16 v[120:123], a[192:195], a[80:83], 0
    ds_read_b64_tr_b16 a[226:227], v58 offset:18432
    v_mfma_f32_16x16x32_bf16 v[120:123], a[196:199], a[84:87], v[120:123]
    s_waitcnt lgkmcnt(9)
    ds_read_b64_tr_b16 a[228:229], v58 offset:20480
    v_mfma_f32_16x16x32_bf16 v[116:119], a[200:203], a[64:67], 0
    ds_read_b64_tr_b16 a[230:231], v58 offset:22528
    v_mfma_f32_16x16x32_bf16 v[116:119], a[204:207], a[68:71], v[116:119]
    ds_read_b64_tr_b16 a[232:233], v59 offset:16384
    v_mfma_f32_16x16x32_bf16 v[124:127], a[200:203], a[80:83], 0
    ds_read_b64_tr_b16 a[234:235], v59 offset:18432
    v_mfma_f32_16x16x32_bf16 v[124:127], a[204:207], a[84:87], v[124:127]
    s_waitcnt lgkmcnt(9)
    ds_read_b64_tr_b16 a[236:237], v59 offset:20480
    v_mfma_f32_16x16x32_bf16 v[112:115], a[208:211], a[72:75], v[112:115]
    ds_read_b64_tr_b16 a[238:239], v59 offset:22528
    v_cvt_pk_bf16_f32 v96, v96, v97
    s_waitcnt vmcnt(2)
    v_cmp_ne_u32 vcc, 0, v3
    s_cmp_eq_u64 vcc, -1
    s_cbranch_scc0 L_C2_slow_13
L_C2_ok_14:
    v_mfma_f32_16x16x32_bf16 v[112:115], a[212:215], a[76:79], v[112:115]
    s_xor_b32 s74, s24, 8192
    ds_read_b64_tr_b16 a[240:241], v58 offset:24576
    v_cvt_pk_bf16_f32 v97, v98, v99
    v_mfma_f32_16x16x32_bf16 v[120:123], a[208:211], a[88:91], v[120:123]
    buffer_load_dwordx4 v[160:163], v1, s[8:11], s74 offen offset:0
    v_mfma_f32_16x16x32_bf16 v[120:123], a[212:215], a[92:95], v[120:123]
    s_waitcnt lgkmcnt(8)
    s_xor_b32 s74, s24, 12288
    ds_read_b64_tr_b16 a[242:243], v58 offset:26624
    v_cvt_pk_bf16_f32 v98, v100, v101
    v_mfma_f32_16x16x32_bf16 v[116:119], a[216:219], a[72:75], v[116:119]
    ds_read_b64_tr_b16 a[244:245], v58 offset:28672
    v_cvt_pk_bf16_f32 v99, v102, v103
    v_mfma_f32_16x16x32_bf16 v[116:119], a[220:223], a[76:79], v[116:119]
    ds_read_b64_tr_b16 a[246:247], v58 offset:30720
    v_min_u32 v96, -2, v96
    v_mfma_f32_16x16x32_bf16 v[124:127], a[216:219], a[88:91], v[124:127]
    buffer_load_dwordx4 v[176:179], v1, s[8:11], s74 offen offset:0
    ds_read_b64_tr_b16 a[248:249], v59 offset:24576
    v_mfma_f32_16x16x32_bf16 v[124:127], a[220:223], a[92:95], v[124:127]
    s_waitcnt lgkmcnt(8)
    s_xor_b32 s74, s24, 8192
    ds_read_b64_tr_b16 a[250:251], v59 offset:26624
    v_min_u32 v97, -2, v97
    v_mfma_f32_16x16x32_bf16 v[112:115], a[224:227], a[96:99], v[112:115]
    ds_read_b64_tr_b16 a[252:253], v59 offset:28672
    v_min_u32 v98, -2, v98
    v_mfma_f32_16x16x32_bf16 v[112:115], a[228:231], a[100:103], v[112:115]
    ds_read_b64_tr_b16 a[254:255], v59 offset:30720
    v_min_u32 v99, -2, v99
    v_mfma_f32_16x16x32_bf16 v[120:123], a[224:227], a[112:115], v[120:123]
    buffer_load_dwordx4 v[164:167], v1, s[8:11], s74 offen offset:1024
    v_mfma_f32_16x16x32_bf16 v[120:123], a[228:231], a[116:119], v[120:123]
    s_waitcnt lgkmcnt(7)
    s_xor_b32 s74, s24, 12288
    ds_read_b64_tr_b16 a[192:193], v62 offset:32768
    v_mfma_f32_16x16x32_bf16 v[116:119], a[232:235], a[96:99], v[116:119]
    s_add_u32 s75, s18, 0
    ds_read_b64_tr_b16 a[194:195], v62 offset:34816
    v_mfma_f32_16x16x32_bf16 v[116:119], a[236:239], a[100:103], v[116:119]
    buffer_store_dwordx4 v[96:99], v23, s[8:11], s75 offen offset:512 sc0 sc1
    ds_read_b64_tr_b16 a[196:197], v62 offset:36864
    v_mfma_f32_16x16x32_bf16 v[124:127], a[232:235], a[112:115], v[124:127]
    buffer_load_dwordx4 v[180:183], v1, s[8:11], s74 offen offset:1024
    ds_read_b64_tr_b16 a[198:199], v62 offset:38912
    v_mfma_f32_16x16x32_bf16 v[124:127], a[236:239], a[116:119], v[124:127]
    s_waitcnt lgkmcnt(8)
    s_xor_b32 s74, s24, 8192
    ds_read_b64_tr_b16 a[200:201], v63 offset:32768
    v_cvt_pk_bf16_f32 v104, v104, v105
    v_mfma_f32_16x16x32_bf16 v[112:115], a[240:243], a[104:107], v[112:115]
    ds_read_b64_tr_b16 a[202:203], v63 offset:34816
    v_cvt_pk_bf16_f32 v105, v106, v107
    v_mfma_f32_16x16x32_bf16 v[112:115], a[244:247], a[108:111], v[112:115]
    ds_read_b64_tr_b16 a[204:205], v63 offset:36864
    v_cvt_pk_bf16_f32 v106, v108, v109
    v_mfma_f32_16x16x32_bf16 v[120:123], a[240:243], a[120:123], v[120:123]
    buffer_load_dwordx4 v[168:171], v1, s[8:11], s74 offen offset:2048
    ds_read_b64_tr_b16 a[206:207], v63 offset:38912
    v_mfma_f32_16x16x32_bf16 v[120:123], a[244:247], a[124:127], v[120:123]
    s_waitcnt lgkmcnt(8)
    s_xor_b32 s74, s24, 12288
    ds_read_b64_tr_b16 a[208:209], v62 offset:40960
    v_cvt_pk_bf16_f32 v107, v110, v111
    v_mfma_f32_16x16x32_bf16 v[116:119], a[248:251], a[104:107], v[116:119]
    ds_read_b64_tr_b16 a[210:211], v62 offset:43008
    v_min_u32 v104, -2, v104
    v_mfma_f32_16x16x32_bf16 v[116:119], a[252:255], a[108:111], v[116:119]
    ds_read_b64_tr_b16 a[212:213], v62 offset:45056
    v_min_u32 v105, -2, v105
    v_mfma_f32_16x16x32_bf16 v[124:127], a[248:251], a[120:123], v[124:127]
    buffer_load_dwordx4 v[184:187], v1, s[8:11], s74 offen offset:2048
    ds_read_b64_tr_b16 a[214:215], v62 offset:47104
    v_mfma_f32_16x16x32_bf16 v[124:127], a[252:255], a[124:127], v[124:127]
    s_waitcnt lgkmcnt(9)
    s_xor_b32 s74, s24, 8192
    ds_read_b64_tr_b16 a[216:217], v63 offset:40960
    v_min_u32 v106, -2, v106
    v_mfma_f32_16x16x32_bf16 v[112:115], a[192:195], a[0:3], v[112:115]
    s_waitcnt lgkmcnt(9)
    ds_read_b64_tr_b16 a[218:219], v63 offset:43008
    v_min_u32 v107, -2, v107
    v_mfma_f32_16x16x32_bf16 v[112:115], a[196:199], a[4:7], v[112:115]
    s_add_u32 s75, s18, 131072
    ds_read_b64_tr_b16 a[220:221], v63 offset:45056
    v_mfma_f32_16x16x32_bf16 v[120:123], a[192:195], a[16:19], v[120:123]
    buffer_load_dwordx4 v[172:175], v1, s[8:11], s74 offen offset:3072
    ds_read_b64_tr_b16 a[222:223], v63 offset:47104
    v_mfma_f32_16x16x32_bf16 v[120:123], a[196:199], a[20:23], v[120:123]
    s_waitcnt lgkmcnt(8)
    s_xor_b32 s74, s24, 12288
    ds_read_b64_tr_b16 a[224:225], v62 offset:49152
    v_mfma_f32_16x16x32_bf16 v[116:119], a[200:203], a[0:3], v[116:119]
    buffer_store_dwordx4 v[104:107], v23, s[8:11], s75 offen offset:512 sc0 sc1
    ds_read_b64_tr_b16 a[226:227], v62 offset:51200
    v_mfma_f32_16x16x32_bf16 v[116:119], a[204:207], a[4:7], v[116:119]
    ds_read_b64_tr_b16 a[228:229], v62 offset:53248
    v_mfma_f32_16x16x32_bf16 v[124:127], a[200:203], a[16:19], v[124:127]
    buffer_load_dwordx4 v[188:191], v1, s[8:11], s74 offen offset:3072
    ds_read_b64_tr_b16 a[230:231], v62 offset:55296
    v_mfma_f32_16x16x32_bf16 v[124:127], a[204:207], a[20:23], v[124:127]
    s_waitcnt lgkmcnt(9)
    ds_read_b64_tr_b16 a[232:233], v63 offset:49152
    v_mfma_f32_16x16x32_bf16 v[112:115], a[208:211], a[8:11], v[112:115]
    s_waitcnt lgkmcnt(9)
    ds_read_b64_tr_b16 a[234:235], v63 offset:51200
    v_mfma_f32_16x16x32_bf16 v[112:115], a[212:215], a[12:15], v[112:115]
    ds_read_b64_tr_b16 a[236:237], v63 offset:53248
    v_mfma_f32_16x16x32_bf16 v[120:123], a[208:211], a[24:27], v[120:123]
    ds_read_b64_tr_b16 a[238:239], v63 offset:55296
    v_mfma_f32_16x16x32_bf16 v[120:123], a[212:215], a[28:31], v[120:123]
    s_waitcnt lgkmcnt(9)
    ds_read_b64_tr_b16 a[240:241], v62 offset:57344
    v_mfma_f32_16x16x32_bf16 v[116:119], a[216:219], a[8:11], v[116:119]
    s_waitcnt lgkmcnt(9)
    ds_read_b64_tr_b16 a[242:243], v62 offset:59392
    v_mfma_f32_16x16x32_bf16 v[116:119], a[220:223], a[12:15], v[116:119]
    ds_read_b64_tr_b16 a[244:245], v62 offset:61440
    v_mfma_f32_16x16x32_bf16 v[124:127], a[216:219], a[24:27], v[124:127]
    ds_read_b64_tr_b16 a[246:247], v62 offset:63488
    v_mfma_f32_16x16x32_bf16 v[124:127], a[220:223], a[28:31], v[124:127]
    s_waitcnt lgkmcnt(9)
    ds_read_b64_tr_b16 a[248:249], v63 offset:57344
    v_mfma_f32_16x16x32_bf16 v[112:115], a[224:227], a[32:35], v[112:115]
    s_waitcnt lgkmcnt(9)
    ds_read_b64_tr_b16 a[250:251], v63 offset:59392
    ds_read_b64_tr_b16 a[208:209], v56 offset:40960
    v_mfma_f32_16x16x32_bf16 v[112:115], a[228:231], a[36:39], v[112:115]
    ds_read_b64_tr_b16 a[252:253], v63 offset:61440
    ds_read_b64_tr_b16 a[210:211], v56 offset:43008
    v_mfma_f32_16x16x32_bf16 v[120:123], a[224:227], a[48:51], v[120:123]
    ds_read_b64_tr_b16 a[254:255], v63 offset:63488
    ds_read_b64_tr_b16 a[212:213], v56 offset:45056
    v_mfma_f32_16x16x32_bf16 v[120:123], a[228:231], a[52:55], v[120:123]
    s_waitcnt lgkmcnt(12)
    ds_read_b64_tr_b16 a[192:193], v56 offset:32768
    ds_read_b64_tr_b16 a[214:215], v56 offset:47104
    v_mfma_f32_16x16x32_bf16 v[116:119], a[232:235], a[32:35], v[116:119]
    s_waitcnt lgkmcnt(13)
    ds_read_b64_tr_b16 a[194:195], v56 offset:34816
    ds_read_b64_tr_b16 a[216:217], v57 offset:40960
    v_mfma_f32_16x16x32_bf16 v[116:119], a[236:239], a[36:39], v[116:119]
    ds_read_b64_tr_b16 a[196:197], v56 offset:36864
    ds_read_b64_tr_b16 a[218:219], v57 offset:43008
    v_mfma_f32_16x16x32_bf16 v[124:127], a[232:235], a[48:51], v[124:127]
    ds_read_b64_tr_b16 a[198:199], v56 offset:38912
    ds_read_b64_tr_b16 a[220:221], v57 offset:45056
    v_mfma_f32_16x16x32_bf16 v[124:127], a[236:239], a[52:55], v[124:127]
    s_waitcnt lgkmcnt(15)
    ds_read_b64_tr_b16 a[200:201], v57 offset:32768
    ds_read_b64_tr_b16 a[222:223], v57 offset:47104
    v_mfma_f32_16x16x32_bf16 v[112:115], a[240:243], a[40:43], v[112:115]
    ds_read_b64_tr_b16 a[202:203], v57 offset:34816
    v_mfma_f32_16x16x32_bf16 v[112:115], a[244:247], a[44:47], v[112:115]
    ds_read_b64_tr_b16 a[204:205], v57 offset:36864
    v_mfma_f32_16x16x32_bf16 v[120:123], a[240:243], a[56:59], v[120:123]
    s_waitcnt lgkmcnt(15)
    s_xor_b32 s74, s24, 16384
    ds_read_b64_tr_b16 a[206:207], v57 offset:38912
    v_mfma_f32_16x16x32_bf16 v[120:123], a[244:247], a[60:63], v[120:123]
    buffer_load_dwordx4 v[192:195], v1, s[8:11], s74 offen offset:0
    v_mfma_f32_16x16x32_bf16 v[116:119], a[248:251], a[40:43], v[116:119]
    s_waitcnt lgkmcnt(13)
    s_xor_b32 s74, s24, 20480
    ds_read_b64_tr_b16 a[224:225], v56 offset:49152
    v_mfma_f32_16x16x32_bf16 v[116:119], a[252:255], a[44:47], v[116:119]
    ds_read_b64_tr_b16 a[226:227], v56 offset:51200
    v_mfma_f32_16x16x32_bf16 v[124:127], a[248:251], a[56:59], v[124:127]
    ds_read_b64_tr_b16 a[228:229], v56 offset:53248
    v_mfma_f32_16x16x32_bf16 v[124:127], a[252:255], a[60:63], v[124:127]
    s_waitcnt lgkmcnt(9)
    ds_read_b64_tr_b16 a[230:231], v56 offset:55296
    v_mfma_f32_16x16x32_bf16 v[64:67], a[192:195], v[128:131], 0
    buffer_load_dwordx4 v[208:211], v1, s[8:11], s74 offen offset:0
    v_mfma_f32_16x16x32_bf16 v[64:67], a[196:199], v[132:135], v[64:67]
    s_xor_b32 s74, s24, 16384
    ds_read_b64_tr_b16 a[232:233], v57 offset:49152
    v_mfma_f32_16x16x32_bf16 v[72:75], a[192:195], v[144:147], 0
    ds_read_b64_tr_b16 a[234:235], v57 offset:51200
    v_mfma_f32_16x16x32_bf16 v[72:75], a[196:199], v[148:151], v[72:75]
    s_waitcnt lgkmcnt(7)
    ds_read_b64_tr_b16 a[236:237], v57 offset:53248
    v_mfma_f32_16x16x32_bf16 v[68:71], a[200:203], v[128:131], 0
    s_waitcnt lgkmcnt(7)
    ds_read_b64_tr_b16 a[238:239], v57 offset:55296
    v_mfma_f32_16x16x32_bf16 v[68:71], a[204:207], v[132:135], v[68:71]
    buffer_load_dwordx4 v[196:199], v1, s[8:11], s74 offen offset:1024
    v_mfma_f32_16x16x32_bf16 v[76:79], a[200:203], v[144:147], 0
    s_xor_b32 s74, s24, 20480
    ds_read_b64_tr_b16 a[240:241], v56 offset:57344
    v_cvt_pk_bf16_f32 v112, v112, v113
    v_mfma_f32_16x16x32_bf16 v[76:79], a[204:207], v[148:151], v[76:79]
    ds_read_b64_tr_b16 a[242:243], v56 offset:59392
    v_cvt_pk_bf16_f32 v113, v114, v115
    v_mfma_f32_16x16x32_bf16 v[64:67], a[208:211], v[136:139], v[64:67]
    ds_read_b64_tr_b16 a[244:245], v56 offset:61440
    v_cvt_pk_bf16_f32 v114, v116, v117
    v_mfma_f32_16x16x32_bf16 v[64:67], a[212:215], v[140:143], v[64:67]
    ds_read_b64_tr_b16 a[246:247], v56 offset:63488
    v_cvt_pk_bf16_f32 v115, v118, v119
    v_mfma_f32_16x16x32_bf16 v[72:75], a[208:211], v[152:155], v[72:75]
    buffer_load_dwordx4 v[212:215], v1, s[8:11], s74 offen offset:1024
    v_mfma_f32_16x16x32_bf16 v[72:75], a[212:215], v[156:159], v[72:75]
    s_xor_b32 s74, s24, 16384
    ds_read_b64_tr_b16 a[248:249], v57 offset:57344
    v_min_u32 v112, -2, v112
    v_mfma_f32_16x16x32_bf16 v[68:71], a[216:219], v[136:139], v[68:71]
    ds_read_b64_tr_b16 a[250:251], v57 offset:59392
    v_min_u32 v113, -2, v113
    v_mfma_f32_16x16x32_bf16 v[68:71], a[220:223], v[140:143], v[68:71]
    ds_read_b64_tr_b16 a[252:253], v57 offset:61440
    v_min_u32 v114, -2, v114
    v_mfma_f32_16x16x32_bf16 v[76:79], a[216:219], v[152:155], v[76:79]
    s_waitcnt vmcnt(13) lgkmcnt(7)
    ds_read_b64_tr_b16 a[254:255], v57 offset:63488
    v_min_u32 v115, -2, v115
    v_mfma_f32_16x16x32_bf16 v[76:79], a[220:223], v[156:159], v[76:79]
    buffer_load_dwordx4 v[200:203], v1, s[8:11], s74 offen offset:2048
    v_mfma_f32_16x16x32_bf16 v[64:67], a[224:227], v[160:163], v[64:67]
    s_waitcnt vmcnt(12)
    s_xor_b32 s74, s24, 20480
    ds_read_b64_tr_b16 a[192:193], v58 offset:32768
    v_mfma_f32_16x16x32_bf16 v[64:67], a[228:231], v[164:167], v[64:67]
    s_waitcnt vmcnt(10)
    s_add_u32 s75, s18, 0
    ds_read_b64_tr_b16 a[194:195], v58 offset:34816
    v_mfma_f32_16x16x32_bf16 v[72:75], a[224:227], v[176:179], v[72:75]
    buffer_store_dwordx4 v[112:115], v23, s[8:11], s75 offen offset:768 sc0 sc1
    v_mfma_f32_16x16x32_bf16 v[72:75], a[228:231], v[180:183], v[72:75]
    ds_read_b64_tr_b16 a[196:197], v58 offset:36864
    v_cvt_pk_bf16_f32 v120, v120, v121
    v_mfma_f32_16x16x32_bf16 v[68:71], a[232:235], v[160:163], v[68:71]
    buffer_load_dwordx4 v[216:219], v1, s[8:11], s74 offen offset:2048
    ds_read_b64_tr_b16 a[198:199], v58 offset:38912
    v_mfma_f32_16x16x32_bf16 v[68:71], a[236:239], v[164:167], v[68:71]
    s_xor_b32 s74, s24, 16384
    ds_read_b64_tr_b16 a[200:201], v59 offset:32768
    v_cvt_pk_bf16_f32 v121, v122, v123
    v_mfma_f32_16x16x32_bf16 v[76:79], a[232:235], v[176:179], v[76:79]
    ds_read_b64_tr_b16 a[202:203], v59 offset:34816
    v_cvt_pk_bf16_f32 v122, v124, v125
    v_mfma_f32_16x16x32_bf16 v[76:79], a[236:239], v[180:183], v[76:79]
    s_waitcnt vmcnt(11) lgkmcnt(7)
    ds_read_b64_tr_b16 a[204:205], v59 offset:36864
    v_cvt_pk_bf16_f32 v123, v126, v127
    v_mfma_f32_16x16x32_bf16 v[64:67], a[240:243], v[168:171], v[64:67]
    s_waitcnt vmcnt(9)
    ds_read_b64_tr_b16 a[206:207], v59 offset:38912
    v_min_u32 v120, -2, v120
    v_mfma_f32_16x16x32_bf16 v[64:67], a[244:247], v[172:175], v[64:67]
    buffer_load_dwordx4 v[204:207], v1, s[8:11], s74 offen offset:3072
    v_mfma_f32_16x16x32_bf16 v[72:75], a[240:243], v[184:187], v[72:75]
    s_waitcnt vmcnt(8)
    s_xor_b32 s74, s24, 20480
    ds_read_b64_tr_b16 a[208:209], v58 offset:40960
    v_min_u32 v121, -2, v121
    v_mfma_f32_16x16x32_bf16 v[72:75], a[244:247], v[188:191], v[72:75]
    ds_read_b64_tr_b16 a[210:211], v58 offset:43008
    v_min_u32 v122, -2, v122
    v_mfma_f32_16x16x32_bf16 v[68:71], a[248:251], v[168:171], v[68:71]
    s_waitcnt lgkmcnt(8)
    ds_read_b64_tr_b16 a[212:213], v58 offset:45056
    v_min_u32 v123, -2, v123
    v_mfma_f32_16x16x32_bf16 v[68:71], a[252:255], v[172:175], v[68:71]
    s_add_u32 s75, s18, 131072
    ds_read_b64_tr_b16 a[214:215], v58 offset:47104
    v_mfma_f32_16x16x32_bf16 v[76:79], a[248:251], v[184:187], v[76:79]
    buffer_load_dwordx4 v[220:223], v1, s[8:11], s74 offen offset:3072
    ds_read_b64_tr_b16 a[216:217], v59 offset:40960
    v_mfma_f32_16x16x32_bf16 v[76:79], a[252:255], v[188:191], v[76:79]
    s_waitcnt lgkmcnt(8)
    s_xor_b32 s74, s24, 24576
    ds_read_b64_tr_b16 a[218:219], v59 offset:43008
    v_mfma_f32_16x16x32_bf16 v[80:83], a[192:195], v[128:131], 0
    buffer_store_dwordx4 v[120:123], v23, s[8:11], s75 offen offset:768 sc0 sc1
    ds_read_b64_tr_b16 a[220:221], v59 offset:45056
    v_mfma_f32_16x16x32_bf16 v[80:83], a[196:199], v[132:135], v[80:83]
    ds_read_b64_tr_b16 a[222:223], v59 offset:47104
    v_mfma_f32_16x16x32_bf16 v[88:91], a[192:195], v[144:147], 0
    s_waitcnt lgkmcnt(8)
    ds_read_b64_tr_b16 a[224:225], v58 offset:49152
    v_mfma_f32_16x16x32_bf16 v[88:91], a[196:199], v[148:151], v[88:91]
    buffer_load_dwordx4 v[224:227], v1, s[8:11], s74 offen offset:0
    ds_read_b64_tr_b16 a[226:227], v58 offset:51200
    v_mfma_f32_16x16x32_bf16 v[84:87], a[200:203], v[128:131], 0
    s_xor_b32 s74, s24, 28672
    ds_read_b64_tr_b16 a[228:229], v58 offset:53248
    v_mfma_f32_16x16x32_bf16 v[84:87], a[204:207], v[132:135], v[84:87]
    ds_read_b64_tr_b16 a[230:231], v58 offset:55296
    v_mfma_f32_16x16x32_bf16 v[92:95], a[200:203], v[144:147], 0
    ds_read_b64_tr_b16 a[232:233], v59 offset:49152
    v_mfma_f32_16x16x32_bf16 v[92:95], a[204:207], v[148:151], v[92:95]
    s_waitcnt lgkmcnt(9)
    ds_read_b64_tr_b16 a[234:235], v59 offset:51200
    v_mfma_f32_16x16x32_bf16 v[80:83], a[208:211], v[136:139], v[80:83]
    buffer_load_dwordx4 v[240:243], v1, s[8:11], s74 offen offset:0
    ds_read_b64_tr_b16 a[236:237], v59 offset:53248
    v_mfma_f32_16x16x32_bf16 v[80:83], a[212:215], v[140:143], v[80:83]
    s_xor_b32 s74, s24, 24576
    ds_read_b64_tr_b16 a[238:239], v59 offset:55296
    v_mfma_f32_16x16x32_bf16 v[88:91], a[208:211], v[152:155], v[88:91]
    ds_read_b64_tr_b16 a[240:241], v58 offset:57344
    v_mfma_f32_16x16x32_bf16 v[88:91], a[212:215], v[156:159], v[88:91]
    s_waitcnt lgkmcnt(9)
    ds_read_b64_tr_b16 a[242:243], v58 offset:59392
    v_mfma_f32_16x16x32_bf16 v[84:87], a[216:219], v[136:139], v[84:87]
    ds_read_b64_tr_b16 a[244:245], v58 offset:61440
    v_mfma_f32_16x16x32_bf16 v[84:87], a[220:223], v[140:143], v[84:87]
    buffer_load_dwordx4 v[228:231], v1, s[8:11], s74 offen offset:1024
    ds_read_b64_tr_b16 a[246:247], v58 offset:63488
    v_mfma_f32_16x16x32_bf16 v[92:95], a[216:219], v[152:155], v[92:95]
    s_xor_b32 s74, s24, 28672
    ds_read_b64_tr_b16 a[248:249], v59 offset:57344
    v_mfma_f32_16x16x32_bf16 v[92:95], a[220:223], v[156:159], v[92:95]
    s_waitcnt lgkmcnt(9)
    ds_read_b64_tr_b16 a[250:251], v59 offset:59392
    v_mfma_f32_16x16x32_bf16 v[80:83], a[224:227], v[160:163], v[80:83]
    ds_read_b64_tr_b16 a[252:253], v59 offset:61440
    v_mfma_f32_16x16x32_bf16 v[80:83], a[228:231], v[164:167], v[80:83]
    ds_read_b64_tr_b16 a[254:255], v59 offset:63488
    v_mfma_f32_16x16x32_bf16 v[88:91], a[224:227], v[176:179], v[88:91]
    buffer_load_dwordx4 v[244:247], v1, s[8:11], s74 offen offset:1024
    v_mfma_f32_16x16x32_bf16 v[88:91], a[228:231], v[180:183], v[88:91]
    s_waitcnt lgkmcnt(8)
    s_xor_b32 s74, s24, 24576
    ds_read_b64_tr_b16 a[192:193], v56 offset:0
    v_mfma_f32_16x16x32_bf16 v[84:87], a[232:235], v[160:163], v[84:87]
    ds_read_b64_tr_b16 a[194:195], v56 offset:2048
    v_mfma_f32_16x16x32_bf16 v[84:87], a[236:239], v[164:167], v[84:87]
    ds_read_b64_tr_b16 a[196:197], v56 offset:4096
    v_mfma_f32_16x16x32_bf16 v[92:95], a[232:235], v[176:179], v[92:95]
    s_waitcnt lgkmcnt(8)
    ds_read_b64_tr_b16 a[198:199], v56 offset:6144
    v_mfma_f32_16x16x32_bf16 v[92:95], a[236:239], v[180:183], v[92:95]
    buffer_load_dwordx4 v[232:235], v1, s[8:11], s74 offen offset:2048
    ds_read_b64_tr_b16 a[200:201], v57 offset:0
    v_mfma_f32_16x16x32_bf16 v[80:83], a[240:243], v[168:171], v[80:83]
    s_waitcnt lgkmcnt(8)
    s_xor_b32 s74, s24, 28672
    ds_read_b64_tr_b16 a[202:203], v57 offset:2048
    v_mfma_f32_16x16x32_bf16 v[80:83], a[244:247], v[172:175], v[80:83]
    ds_read_b64_tr_b16 a[204:205], v57 offset:4096
    v_mfma_f32_16x16x32_bf16 v[88:91], a[240:243], v[184:187], v[88:91]
    ds_read_b64_tr_b16 a[206:207], v57 offset:6144
    v_mfma_f32_16x16x32_bf16 v[88:91], a[244:247], v[188:191], v[88:91]
    s_waitcnt lgkmcnt(8)
    ds_read_b64_tr_b16 a[208:209], v56 offset:8192
    v_mfma_f32_16x16x32_bf16 v[84:87], a[248:251], v[168:171], v[84:87]
    buffer_load_dwordx4 v[248:251], v1, s[8:11], s74 offen offset:2048
    ds_read_b64_tr_b16 a[210:211], v56 offset:10240
    v_mfma_f32_16x16x32_bf16 v[84:87], a[252:255], v[172:175], v[84:87]
    s_xor_b32 s74, s24, 24576
    ds_read_b64_tr_b16 a[212:213], v56 offset:12288
    v_mfma_f32_16x16x32_bf16 v[92:95], a[248:251], v[184:187], v[92:95]
    ds_read_b64_tr_b16 a[214:215], v56 offset:14336
    v_mfma_f32_16x16x32_bf16 v[92:95], a[252:255], v[188:191], v[92:95]
    s_waitcnt lgkmcnt(9)
    ds_read_b64_tr_b16 a[216:217], v57 offset:8192
    v_mfma_f32_16x16x32_bf16 v[96:99], a[192:195], v[128:131], 0
    s_waitcnt lgkmcnt(9)
    ds_read_b64_tr_b16 a[218:219], v57 offset:10240
    v_mfma_f32_16x16x32_bf16 v[96:99], a[196:199], v[132:135], v[96:99]
    buffer_load_dwordx4 v[236:239], v1, s[8:11], s74 offen offset:3072
    ds_read_b64_tr_b16 a[220:221], v57 offset:12288
    v_mfma_f32_16x16x32_bf16 v[104:107], a[192:195], v[144:147], 0
    s_xor_b32 s74, s24, 28672
    ds_read_b64_tr_b16 a[222:223], v57 offset:14336
    v_mfma_f32_16x16x32_bf16 v[104:107], a[196:199], v[148:151], v[104:107]
    s_waitcnt lgkmcnt(9)
    ds_read_b64_tr_b16 a[224:225], v56 offset:16384
    v_mfma_f32_16x16x32_bf16 v[100:103], a[200:203], v[128:131], 0
    s_waitcnt lgkmcnt(9)
    ds_read_b64_tr_b16 a[226:227], v56 offset:18432
    v_mfma_f32_16x16x32_bf16 v[100:103], a[204:207], v[132:135], v[100:103]
    ds_read_b64_tr_b16 a[228:229], v56 offset:20480
    v_mfma_f32_16x16x32_bf16 v[108:111], a[200:203], v[144:147], 0
    buffer_load_dwordx4 v[252:255], v1, s[8:11], s74 offen offset:3072
    ds_read_b64_tr_b16 a[230:231], v56 offset:22528
    v_mfma_f32_16x16x32_bf16 v[108:111], a[204:207], v[148:151], v[108:111]
    s_waitcnt lgkmcnt(9)
    ds_read_b64_tr_b16 a[232:233], v57 offset:16384
    v_mfma_f32_16x16x32_bf16 v[96:99], a[208:211], v[136:139], v[96:99]
    s_waitcnt lgkmcnt(9)
    ds_read_b64_tr_b16 a[234:235], v57 offset:18432
    v_mfma_f32_16x16x32_bf16 v[96:99], a[212:215], v[140:143], v[96:99]
    ds_read_b64_tr_b16 a[236:237], v57 offset:20480
    v_mfma_f32_16x16x32_bf16 v[104:107], a[208:211], v[152:155], v[104:107]
    ds_read_b64_tr_b16 a[238:239], v57 offset:22528
    v_mfma_f32_16x16x32_bf16 v[104:107], a[212:215], v[156:159], v[104:107]
    s_waitcnt lgkmcnt(9)
    ds_read_b64_tr_b16 a[240:241], v56 offset:24576
    v_mfma_f32_16x16x32_bf16 v[100:103], a[216:219], v[136:139], v[100:103]
    s_waitcnt lgkmcnt(9)
    ds_read_b64_tr_b16 a[242:243], v56 offset:26624
    v_mfma_f32_16x16x32_bf16 v[100:103], a[220:223], v[140:143], v[100:103]
    ds_read_b64_tr_b16 a[244:245], v56 offset:28672
    v_mfma_f32_16x16x32_bf16 v[108:111], a[216:219], v[152:155], v[108:111]
    ds_read_b64_tr_b16 a[246:247], v56 offset:30720
    v_mfma_f32_16x16x32_bf16 v[108:111], a[220:223], v[156:159], v[108:111]
    s_waitcnt lgkmcnt(9)
    ds_read_b64_tr_b16 a[248:249], v57 offset:24576
    v_mfma_f32_16x16x32_bf16 v[96:99], a[224:227], v[160:163], v[96:99]
    s_waitcnt lgkmcnt(9)
    ds_read_b64_tr_b16 a[250:251], v57 offset:26624
    v_mfma_f32_16x16x32_bf16 v[96:99], a[228:231], v[164:167], v[96:99]
    ds_read_b64_tr_b16 a[252:253], v57 offset:28672
    v_mfma_f32_16x16x32_bf16 v[104:107], a[224:227], v[176:179], v[104:107]
    ds_read_b64_tr_b16 a[254:255], v57 offset:30720
    v_mfma_f32_16x16x32_bf16 v[104:107], a[228:231], v[180:183], v[104:107]
    s_waitcnt lgkmcnt(8)
    ds_read_b64_tr_b16 a[192:193], v58 offset:0
    v_mfma_f32_16x16x32_bf16 v[100:103], a[232:235], v[160:163], v[100:103]
    buffer_load_dwordx2 v[32:33], v45, s[32:35], s100 offen
    ds_read_b64_tr_b16 a[194:195], v58 offset:2048
    v_mfma_f32_16x16x32_bf16 v[100:103], a[236:239], v[164:167], v[100:103]
    ds_read_b64_tr_b16 a[196:197], v58 offset:4096
    v_mfma_f32_16x16x32_bf16 v[108:111], a[232:235], v[176:179], v[108:111]
    ds_read_b64_tr_b16 a[198:199], v58 offset:6144
    v_mfma_f32_16x16x32_bf16 v[108:111], a[236:239], v[180:183], v[108:111]
    s_waitcnt lgkmcnt(8)
    ds_read_b64_tr_b16 a[200:201], v59 offset:0
    v_mfma_f32_16x16x32_bf16 v[96:99], a[240:243], v[168:171], v[96:99]
    buffer_load_dwordx2 v[34:35], v45, s[32:35], s100 offen offset:32
    ds_read_b64_tr_b16 a[202:203], v59 offset:2048
    v_mfma_f32_16x16x32_bf16 v[96:99], a[244:247], v[172:175], v[96:99]
    ds_read_b64_tr_b16 a[204:205], v59 offset:4096
    v_mfma_f32_16x16x32_bf16 v[104:107], a[240:243], v[184:187], v[104:107]
    ds_read_b64_tr_b16 a[206:207], v59 offset:6144
    v_mfma_f32_16x16x32_bf16 v[104:107], a[244:247], v[188:191], v[104:107]
    s_waitcnt lgkmcnt(8)
    ds_read_b64_tr_b16 a[208:209], v58 offset:8192
    v_mfma_f32_16x16x32_bf16 v[100:103], a[248:251], v[168:171], v[100:103]
    buffer_load_dwordx2 v[36:37], v45, s[32:35], s101 offen
    ds_read_b64_tr_b16 a[210:211], v58 offset:10240
    v_mfma_f32_16x16x32_bf16 v[100:103], a[252:255], v[172:175], v[100:103]
    ds_read_b64_tr_b16 a[212:213], v58 offset:12288
    v_mfma_f32_16x16x32_bf16 v[108:111], a[248:251], v[184:187], v[108:111]
    ds_read_b64_tr_b16 a[214:215], v58 offset:14336
    v_mfma_f32_16x16x32_bf16 v[108:111], a[252:255], v[188:191], v[108:111]
    s_waitcnt lgkmcnt(8)
    ds_read_b64_tr_b16 a[216:217], v59 offset:8192
    v_mfma_f32_16x16x32_bf16 v[112:115], a[192:195], v[128:131], 0
    buffer_load_dwordx2 v[38:39], v45, s[32:35], s101 offen offset:32
    ds_read_b64_tr_b16 a[218:219], v59 offset:10240
    v_mfma_f32_16x16x32_bf16 v[112:115], a[196:199], v[132:135], v[112:115]
    ds_read_b64_tr_b16 a[220:221], v59 offset:12288
    v_mfma_f32_16x16x32_bf16 v[120:123], a[192:195], v[144:147], 0
    ds_read_b64_tr_b16 a[222:223], v59 offset:14336
    v_mfma_f32_16x16x32_bf16 v[120:123], a[196:199], v[148:151], v[120:123]
    s_waitcnt lgkmcnt(8)
    ds_read_b64_tr_b16 a[224:225], v58 offset:16384
    v_mfma_f32_16x16x32_bf16 v[116:119], a[200:203], v[128:131], 0
    buffer_load_dwordx2 v[40:41], v45, s[56:59], 0 offen
    ds_read_b64_tr_b16 a[226:227], v58 offset:18432
    v_mfma_f32_16x16x32_bf16 v[116:119], a[204:207], v[132:135], v[116:119]
    ds_read_b64_tr_b16 a[228:229], v58 offset:20480
    v_mfma_f32_16x16x32_bf16 v[124:127], a[200:203], v[144:147], 0
    ds_read_b64_tr_b16 a[230:231], v58 offset:22528
    v_mfma_f32_16x16x32_bf16 v[124:127], a[204:207], v[148:151], v[124:127]
    s_waitcnt lgkmcnt(8)
    ds_read_b64_tr_b16 a[232:233], v59 offset:16384
    v_mfma_f32_16x16x32_bf16 v[112:115], a[208:211], v[136:139], v[112:115]
    buffer_load_dwordx2 v[42:43], v45, s[56:59], 0 offen offset:32
    ds_read_b64_tr_b16 a[234:235], v59 offset:18432
    v_mfma_f32_16x16x32_bf16 v[112:115], a[212:215], v[140:143], v[112:115]
    ds_read_b64_tr_b16 a[236:237], v59 offset:20480
    v_mfma_f32_16x16x32_bf16 v[120:123], a[208:211], v[152:155], v[120:123]
    ds_read_b64_tr_b16 a[238:239], v59 offset:22528
    v_mfma_f32_16x16x32_bf16 v[120:123], a[212:215], v[156:159], v[120:123]
    s_waitcnt lgkmcnt(9)
    ds_read_b64_tr_b16 a[240:241], v58 offset:24576
    v_mfma_f32_16x16x32_bf16 v[116:119], a[216:219], v[136:139], v[116:119]
    s_waitcnt lgkmcnt(9)
    ds_read_b64_tr_b16 a[242:243], v58 offset:26624
    v_mfma_f32_16x16x32_bf16 v[116:119], a[220:223], v[140:143], v[116:119]
    ds_read_b64_tr_b16 a[244:245], v58 offset:28672
    v_mfma_f32_16x16x32_bf16 v[124:127], a[216:219], v[152:155], v[124:127]
    ds_read_b64_tr_b16 a[246:247], v58 offset:30720
    v_mfma_f32_16x16x32_bf16 v[124:127], a[220:223], v[156:159], v[124:127]
    s_waitcnt lgkmcnt(9)
    ds_read_b64_tr_b16 a[248:249], v59 offset:24576
    v_mfma_f32_16x16x32_bf16 v[112:115], a[224:227], v[160:163], v[112:115]
    s_waitcnt lgkmcnt(9)
    ds_read_b64_tr_b16 a[250:251], v59 offset:26624
    v_mfma_f32_16x16x32_bf16 v[112:115], a[228:231], v[164:167], v[112:115]
    ds_read_b64_tr_b16 a[252:253], v59 offset:28672
    v_mfma_f32_16x16x32_bf16 v[120:123], a[224:227], v[176:179], v[120:123]
    ds_read_b64_tr_b16 a[254:255], v59 offset:30720
    v_mfma_f32_16x16x32_bf16 v[120:123], a[228:231], v[180:183], v[120:123]
    s_waitcnt lgkmcnt(9)
    ds_read_b64_tr_b16 a[192:193], v60 offset:0
    v_mfma_f32_16x16x32_bf16 v[116:119], a[232:235], v[160:163], v[116:119]
    s_waitcnt lgkmcnt(9)
    ds_read_b64_tr_b16 a[194:195], v60 offset:2048
    v_mfma_f32_16x16x32_bf16 v[116:119], a[236:239], v[164:167], v[116:119]
    ds_read_b64_tr_b16 a[196:197], v60 offset:4096
    v_mfma_f32_16x16x32_bf16 v[124:127], a[232:235], v[176:179], v[124:127]
    ds_read_b64_tr_b16 a[198:199], v60 offset:6144
    v_mfma_f32_16x16x32_bf16 v[124:127], a[236:239], v[180:183], v[124:127]
    s_waitcnt lgkmcnt(9)
    ds_read_b64_tr_b16 a[200:201], v61 offset:0
    v_mfma_f32_16x16x32_bf16 v[112:115], a[240:243], v[168:171], v[112:115]
    s_waitcnt lgkmcnt(9)
    ds_read_b64_tr_b16 a[202:203], v61 offset:2048
    ds_read_b64_tr_b16 a[224:225], v60 offset:16384
    v_mfma_f32_16x16x32_bf16 v[112:115], a[244:247], v[172:175], v[112:115]
    ds_read_b64_tr_b16 a[204:205], v61 offset:4096
    ds_read_b64_tr_b16 a[226:227], v60 offset:18432
    v_mfma_f32_16x16x32_bf16 v[120:123], a[240:243], v[184:187], v[120:123]
    ds_read_b64_tr_b16 a[206:207], v61 offset:6144
    ds_read_b64_tr_b16 a[228:229], v60 offset:20480
    v_mfma_f32_16x16x32_bf16 v[120:123], a[244:247], v[188:191], v[120:123]
    s_waitcnt lgkmcnt(12)
    ds_read_b64_tr_b16 a[208:209], v60 offset:8192
    ds_read_b64_tr_b16 a[230:231], v60 offset:22528
    v_mfma_f32_16x16x32_bf16 v[116:119], a[248:251], v[168:171], v[116:119]
    s_waitcnt lgkmcnt(13)
    ds_read_b64_tr_b16 a[210:211], v60 offset:10240
    ds_read_b64_tr_b16 a[232:233], v61 offset:16384
    v_mfma_f32_16x16x32_bf16 v[116:119], a[252:255], v[172:175], v[116:119]
    ds_read_b64_tr_b16 a[212:213], v60 offset:12288
    ds_read_b64_tr_b16 a[234:235], v61 offset:18432
    v_mfma_f32_16x16x32_bf16 v[124:127], a[248:251], v[184:187], v[124:127]
    ds_read_b64_tr_b16 a[214:215], v60 offset:14336
    ds_read_b64_tr_b16 a[236:237], v61 offset:20480
    v_mfma_f32_16x16x32_bf16 v[124:127], a[252:255], v[188:191], v[124:127]
    s_waitcnt vmcnt(23) lgkmcnt(15)
    ds_read_b64_tr_b16 a[216:217], v61 offset:8192
    ds_read_b64_tr_b16 a[238:239], v61 offset:22528
    v_mfma_f32_16x16x32_bf16 v[64:67], a[192:195], v[192:195], v[64:67]
    s_waitcnt vmcnt(21)
    ds_read_b64_tr_b16 a[218:219], v61 offset:10240
    v_mfma_f32_16x16x32_bf16 v[64:67], a[196:199], v[196:199], v[64:67]
    ds_read_b64_tr_b16 a[220:221], v61 offset:12288
    v_mfma_f32_16x16x32_bf16 v[72:75], a[192:195], v[208:211], v[72:75]
    s_waitcnt vmcnt(20) lgkmcnt(15)
    s_mov_b32 s74, 8192
    ds_read_b64_tr_b16 a[222:223], v61 offset:14336
    v_mfma_f32_16x16x32_bf16 v[72:75], a[196:199], v[212:215], v[72:75]
    buffer_load_dwordx4 v[168:171], v46, s[8:11], s74 offen
    v_mfma_f32_16x16x32_bf16 v[68:71], a[200:203], v[192:195], v[68:71]
    s_waitcnt lgkmcnt(13)
    ds_read_b64_tr_b16 a[240:241], v60 offset:24576
    v_mfma_f32_16x16x32_bf16 v[68:71], a[204:207], v[196:199], v[68:71]
    ds_read_b64_tr_b16 a[242:243], v60 offset:26624
    v_mfma_f32_16x16x32_bf16 v[76:79], a[200:203], v[208:211], v[76:79]
    buffer_load_dwordx4 v[172:175], v46, s[8:11], s74 offen offset:64
    v_mfma_f32_16x16x32_bf16 v[76:79], a[204:207], v[212:215], v[76:79]
    s_waitcnt vmcnt(21) lgkmcnt(9)
    s_mov_b32 s74, 6144
    ds_read_b64_tr_b16 a[244:245], v60 offset:28672
    v_mfma_f32_16x16x32_bf16 v[64:67], a[208:211], v[200:203], v[64:67]
    s_waitcnt vmcnt(18) lgkmcnt(8)
    ds_read_b64_tr_b16 a[246:247], v60 offset:30720
    v_mfma_f32_16x16x32_bf16 v[64:67], a[212:215], v[204:207], v[64:67]
    buffer_load_dwordx4 v[176:179], v46, s[8:11], s74 offen
    v_mfma_f32_16x16x32_bf16 v[72:75], a[208:211], v[216:219], v[72:75]
    s_waitcnt vmcnt(18)
    ds_read_b64_tr_b16 a[248:249], v61 offset:24576
    v_mfma_f32_16x16x32_bf16 v[72:75], a[212:215], v[220:223], v[72:75]
    s_waitcnt lgkmcnt(5)
    ds_read_b64_tr_b16 a[250:251], v61 offset:26624
    v_mfma_f32_16x16x32_bf16 v[68:71], a[216:219], v[200:203], v[68:71]
    buffer_load_dwordx4 v[180:183], v46, s[8:11], s74 offen offset:64
    ds_read_b64_tr_b16 a[252:253], v61 offset:28672
    v_mfma_f32_16x16x32_bf16 v[68:71], a[220:223], v[204:207], v[68:71]
    s_mov_b32 s74, 4096
    ds_read_b64_tr_b16 a[254:255], v61 offset:30720
    v_mfma_f32_16x16x32_bf16 v[76:79], a[216:219], v[216:219], v[76:79]
    s_waitcnt vmcnt(17)
    ds_read_b64_tr_b16 a[192:193], v62 offset:0
    v_mfma_f32_16x16x32_bf16 v[76:79], a[220:223], v[220:223], v[76:79]
    buffer_load_dwordx4 v[160:163], v46, s[8:11], s74 offen
    v_mfma_f32_16x16x32_bf16 v[64:67], a[224:227], v[224:227], v[64:67]
    s_waitcnt vmcnt(16)
    ds_read_b64_tr_b16 a[194:195], v62 offset:2048
    s_waitcnt vmcnt(6)
    v_lshlrev_b32 v48, 16, v40
    v_mfma_f32_16x16x32_bf16 v[64:67], a[228:231], v[228:231], v[64:67]
    ds_read_b64_tr_b16 a[196:197], v62 offset:4096
    v_and_b32 v49, 0xffff0000, v40
    v_mfma_f32_16x16x32_bf16 v[72:75], a[224:227], v[240:243], v[72:75]
    buffer_load_dwordx4 v[164:167], v46, s[8:11], s74 offen offset:64
    v_mfma_f32_16x16x32_bf16 v[72:75], a[228:231], v[244:247], v[72:75]
    s_mov_b32 s74, 10240
    ds_read_b64_tr_b16 a[198:199], v62 offset:6144
    v_lshlrev_b32 v50, 16, v41
    v_mfma_f32_16x16x32_bf16 v[68:71], a[232:235], v[224:227], v[68:71]
    ds_read_b64_tr_b16 a[200:201], v63 offset:0
    v_and_b32 v51, 0xffff0000, v41
    v_mfma_f32_16x16x32_bf16 v[68:71], a[236:239], v[228:231], v[68:71]
    buffer_load_dwordx4 v[184:187], v46, s[8:11], s74 offen
    ds_read_b64_tr_b16 a[202:203], v63 offset:2048
    v_mfma_f32_16x16x32_bf16 v[76:79], a[232:235], v[240:243], v[76:79]
    ds_read_b64_tr_b16 a[204:205], v63 offset:4096
    s_waitcnt vmcnt(7)
    v_lshlrev_b32 v52, 16, v42
    v_mfma_f32_16x16x32_bf16 v[76:79], a[236:239], v[244:247], v[76:79]
    s_waitcnt lgkmcnt(7)
    ds_read_b64_tr_b16 a[206:207], v63 offset:6144
    v_and_b32 v53, 0xffff0000, v42
    v_mfma_f32_16x16x32_bf16 v[64:67], a[240:243], v[232:235], v[64:67]
    buffer_load_dwordx4 v[188:191], v46, s[8:11], s74 offen offset:64
    v_mfma_f32_16x16x32_bf16 v[64:67], a[244:247], v[236:239], v[64:67]
    ds_read_b64_tr_b16 a[208:209], v62 offset:8192
    v_lshlrev_b32 v54, 16, v43
    v_mfma_f32_16x16x32_bf16 v[72:75], a[240:243], v[248:251], v[72:75]
    ds_read_b64_tr_b16 a[210:211], v62 offset:10240
    v_and_b32 v55, 0xffff0000, v43
    v_mfma_f32_16x16x32_bf16 v[72:75], a[244:247], v[252:255], v[72:75]
    ds_read_b64_tr_b16 a[212:213], v62 offset:12288
    v_mfma_f32_16x16x32_bf16 v[68:71], a[248:251], v[232:235], v[68:71]
    ds_read_b64_tr_b16 a[214:215], v62 offset:14336
    v_mfma_f32_16x16x32_bf16 v[68:71], a[252:255], v[236:239], v[68:71]
    ds_read_b64_tr_b16 a[216:217], v63 offset:8192
    v_mfma_f32_16x16x32_bf16 v[76:79], a[248:251], v[248:251], v[76:79]
    ds_read_b64_tr_b16 a[218:219], v63 offset:10240
    v_mfma_f32_16x16x32_bf16 v[76:79], a[252:255], v[252:255], v[76:79]
    s_waitcnt lgkmcnt(8)
    ds_read_b64_tr_b16 a[220:221], v63 offset:12288
    v_mfma_f32_16x16x32_bf16 v[80:83], a[192:195], v[192:195], v[80:83]
    ds_read_b64_tr_b16 a[222:223], v63 offset:14336
    v_mfma_f32_16x16x32_bf16 v[80:83], a[196:199], v[196:199], v[80:83]
    ds_read_b64_tr_b16 a[224:225], v62 offset:16384
    v_mfma_f32_16x16x32_bf16 v[88:91], a[192:195], v[208:211], v[88:91]
    ds_read_b64_tr_b16 a[226:227], v62 offset:18432
    v_mfma_f32_16x16x32_bf16 v[88:91], a[196:199], v[212:215], v[88:91]
    ds_read_b64_tr_b16 a[228:229], v62 offset:20480
    v_mfma_f32_16x16x32_bf16 v[84:87], a[200:203], v[192:195], v[84:87]
    s_waitcnt lgkmcnt(9)
    ds_read_b64_tr_b16 a[230:231], v62 offset:22528
    v_mfma_f32_16x16x32_bf16 v[84:87], a[204:207], v[196:199], v[84:87]
    ds_read_b64_tr_b16 a[232:233], v63 offset:16384
    v_mfma_f32_16x16x32_bf16 v[92:95], a[200:203], v[208:211], v[92:95]
    ds_read_b64_tr_b16 a[234:235], v63 offset:18432
    v_cvt_pk_bf16_f32 v64, v64, v65
    v_mfma_f32_16x16x32_bf16 v[92:95], a[204:207], v[212:215], v[92:95]
    ds_read_b64_tr_b16 a[236:237], v63 offset:20480
    v_cvt_pk_bf16_f32 v65, v66, v67
    v_mfma_f32_16x16x32_bf16 v[80:83], a[208:211], v[200:203], v[80:83]
    s_waitcnt lgkmcnt(9)
    ds_read_b64_tr_b16 a[238:239], v63 offset:22528
    v_cvt_pk_bf16_f32 v66, v68, v69
    v_mfma_f32_16x16x32_bf16 v[80:83], a[212:215], v[204:207], v[80:83]
    ds_read_b64_tr_b16 a[240:241], v62 offset:24576
    v_cvt_pk_bf16_f32 v67, v70, v71
    v_mfma_f32_16x16x32_bf16 v[88:91], a[208:211], v[216:219], v[88:91]
    ds_read_b64_tr_b16 a[242:243], v62 offset:26624
    v_min_u32 v64, -2, v64
    v_mfma_f32_16x16x32_bf16 v[88:91], a[212:215], v[220:223], v[88:91]
    ds_read_b64_tr_b16 a[244:245], v62 offset:28672
    v_min_u32 v65, -2, v65
    v_mfma_f32_16x16x32_bf16 v[84:87], a[216:219], v[200:203], v[84:87]
    s_waitcnt lgkmcnt(9)
    ds_read_b64_tr_b16 a[246:247], v62 offset:30720
    v_min_u32 v66, -2, v66
    v_mfma_f32_16x16x32_bf16 v[84:87], a[220:223], v[204:207], v[84:87]
    ds_read_b64_tr_b16 a[248:249], v63 offset:24576
    v_min_u32 v67, -2, v67
    v_mfma_f32_16x16x32_bf16 v[92:95], a[216:219], v[216:219], v[92:95]
    s_add_u32 s75, s18, 8388608
    ds_read_b64_tr_b16 a[250:251], v63 offset:26624
    v_mfma_f32_16x16x32_bf16 v[92:95], a[220:223], v[220:223], v[92:95]
    buffer_store_dwordx4 v[64:67], v23, s[8:11], s75 offen offset:0 sc0 sc1
    ds_read_b64_tr_b16 a[252:253], v63 offset:28672
    v_mfma_f32_16x16x32_bf16 v[80:83], a[224:227], v[224:227], v[80:83]
    s_waitcnt lgkmcnt(9)
    ds_read_b64_tr_b16 a[254:255], v63 offset:30720
    v_cvt_pk_bf16_f32 v72, v72, v73
    v_mfma_f32_16x16x32_bf16 v[80:83], a[228:231], v[228:231], v[80:83]
    ds_read_b64_tr_b16 a[192:193], v60 offset:32768
    v_cvt_pk_bf16_f32 v73, v74, v75
    v_mfma_f32_16x16x32_bf16 v[88:91], a[224:227], v[240:243], v[88:91]
    ds_read_b64_tr_b16 a[194:195], v60 offset:34816
    v_cvt_pk_bf16_f32 v74, v76, v77
    v_mfma_f32_16x16x32_bf16 v[88:91], a[228:231], v[244:247], v[88:91]
    ds_read_b64_tr_b16 a[196:197], v60 offset:36864
    v_cvt_pk_bf16_f32 v75, v78, v79
    v_mfma_f32_16x16x32_bf16 v[84:87], a[232:235], v[224:227], v[84:87]
    s_waitcnt lgkmcnt(9)
    ds_read_b64_tr_b16 a[198:199], v60 offset:38912
    v_min_u32 v72, -2, v72
    v_mfma_f32_16x16x32_bf16 v[84:87], a[236:239], v[228:231], v[84:87]
    ds_read_b64_tr_b16 a[200:201], v61 offset:32768
    v_min_u32 v73, -2, v73
    v_mfma_f32_16x16x32_bf16 v[92:95], a[232:235], v[240:243], v[92:95]
    ds_read_b64_tr_b16 a[202:203], v61 offset:34816
    v_min_u32 v74, -2, v74
    v_mfma_f32_16x16x32_bf16 v[92:95], a[236:239], v[244:247], v[92:95]
    ds_read_b64_tr_b16 a[204:205], v61 offset:36864
    v_min_u32 v75, -2, v75
    v_mfma_f32_16x16x32_bf16 v[80:83], a[240:243], v[232:235], v[80:83]
    s_waitcnt lgkmcnt(9)
    s_add_u32 s75, s18, 8519680
    ds_read_b64_tr_b16 a[206:207], v61 offset:38912
    s_waitcnt vmcnt(8)
    v_mul_f32 v8, v48, v168
    v_mfma_f32_16x16x32_bf16 v[80:83], a[244:247], v[236:239], v[80:83]
    buffer_store_dwordx4 v[72:75], v23, s[8:11], s75 offen offset:0 sc0 sc1
    v_mfma_f32_16x16x32_bf16 v[88:91], a[240:243], v[248:251], v[88:91]
    ds_read_b64_tr_b16 a[208:209], v60 offset:40960
    v_mul_f32 v9, v49, v169
    v_mfma_f32_16x16x32_bf16 v[88:91], a[244:247], v[252:255], v[88:91]
    ds_read_b64_tr_b16 a[210:211], v60 offset:43008
    v_mul_f32 v10, v50, v170
    v_mfma_f32_16x16x32_bf16 v[84:87], a[248:251], v[232:235], v[84:87]
    s_waitcnt lgkmcnt(8)
    ds_read_b64_tr_b16 a[212:213], v60 offset:45056
    v_mul_f32 v11, v51, v171
    v_mfma_f32_16x16x32_bf16 v[84:87], a[252:255], v[236:239], v[84:87]
    ds_read_b64_tr_b16 a[214:215], v60 offset:47104
    s_waitcnt vmcnt(8)
    v_mul_f32 v12, v52, v172
    v_mfma_f32_16x16x32_bf16 v[92:95], a[248:251], v[248:251], v[92:95]
    ds_read_b64_tr_b16 a[216:217], v61 offset:40960
    v_mul_f32 v13, v53, v173
    v_mfma_f32_16x16x32_bf16 v[92:95], a[252:255], v[252:255], v[92:95]
    ds_read_b64_tr_b16 a[218:219], v61 offset:43008
    v_mul_f32 v14, v54, v174
    v_mfma_f32_16x16x32_bf16 v[96:99], a[192:195], v[192:195], v[96:99]
    s_waitcnt lgkmcnt(8)
    ds_read_b64_tr_b16 a[220:221], v61 offset:45056
    v_mul_f32 v15, v55, v175
    v_mfma_f32_16x16x32_bf16 v[96:99], a[196:199], v[196:199], v[96:99]
    ds_read_b64_tr_b16 a[222:223], v61 offset:47104
    s_waitcnt vmcnt(7)
    v_mul_f32 v16, v48, v176
    v_mfma_f32_16x16x32_bf16 v[104:107], a[192:195], v[208:211], v[104:107]
    ds_read_b64_tr_b16 a[224:225], v60 offset:49152
    v_fmac_f32 v16, v49, v177
    v_mfma_f32_16x16x32_bf16 v[104:107], a[196:199], v[212:215], v[104:107]
    ds_read_b64_tr_b16 a[226:227], v60 offset:51200
    v_fmac_f32 v16, v50, v178
    v_mfma_f32_16x16x32_bf16 v[100:103], a[200:203], v[192:195], v[100:103]
    s_waitcnt lgkmcnt(9)
    ds_read_b64_tr_b16 a[228:229], v60 offset:53248
    v_fmac_f32 v16, v51, v179
    v_mfma_f32_16x16x32_bf16 v[100:103], a[204:207], v[196:199], v[100:103]
    ds_read_b64_tr_b16 a[230:231], v60 offset:55296
    s_waitcnt vmcnt(6)
    v_fmac_f32 v16, v52, v180
    v_mfma_f32_16x16x32_bf16 v[108:111], a[200:203], v[208:211], v[108:111]
    ds_read_b64_tr_b16 a[232:233], v61 offset:49152
    v_cvt_pk_bf16_f32 v80, v80, v81
    v_mfma_f32_16x16x32_bf16 v[108:111], a[204:207], v[212:215], v[108:111]
    s_waitcnt lgkmcnt(9)
    ds_read_b64_tr_b16 a[234:235], v61 offset:51200
    v_cvt_pk_bf16_f32 v81, v82, v83
    v_mfma_f32_16x16x32_bf16 v[96:99], a[208:211], v[200:203], v[96:99]
    ds_read_b64_tr_b16 a[236:237], v61 offset:53248
    v_cvt_pk_bf16_f32 v82, v84, v85
    v_mfma_f32_16x16x32_bf16 v[96:99], a[212:215], v[204:207], v[96:99]
    ds_read_b64_tr_b16 a[238:239], v61 offset:55296
    v_cvt_pk_bf16_f32 v83, v86, v87
    v_mfma_f32_16x16x32_bf16 v[104:107], a[208:211], v[216:219], v[104:107]
    ds_read_b64_tr_b16 a[240:241], v60 offset:57344
    v_min_u32 v80, -2, v80
    v_mfma_f32_16x16x32_bf16 v[104:107], a[212:215], v[220:223], v[104:107]
    s_waitcnt lgkmcnt(9)
    ds_read_b64_tr_b16 a[242:243], v60 offset:59392
    v_min_u32 v81, -2, v81
    v_mfma_f32_16x16x32_bf16 v[100:103], a[216:219], v[200:203], v[100:103]
    ds_read_b64_tr_b16 a[244:245], v60 offset:61440
    v_min_u32 v82, -2, v82
    v_mfma_f32_16x16x32_bf16 v[100:103], a[220:223], v[204:207], v[100:103]
    ds_read_b64_tr_b16 a[246:247], v60 offset:63488
    v_min_u32 v83, -2, v83
    v_mfma_f32_16x16x32_bf16 v[108:111], a[216:219], v[216:219], v[108:111]
    s_waitcnt lgkmcnt(9)
    s_add_u32 s75, s18, 8388608
    ds_read_b64_tr_b16 a[248:249], v61 offset:57344
    v_fmac_f32 v16, v53, v181
    v_mfma_f32_16x16x32_bf16 v[108:111], a[220:223], v[220:223], v[108:111]
    buffer_store_dwordx4 v[80:83], v23, s[8:11], s75 offen offset:256 sc0 sc1
    ds_read_b64_tr_b16 a[250:251], v61 offset:59392
    v_mfma_f32_16x16x32_bf16 v[96:99], a[224:227], v[224:227], v[96:99]
    s_waitcnt lgkmcnt(9)
    ds_read_b64_tr_b16 a[252:253], v61 offset:61440
    v_cvt_pk_bf16_f32 v88, v88, v89
    v_mfma_f32_16x16x32_bf16 v[96:99], a[228:231], v[228:231], v[96:99]
    ds_read_b64_tr_b16 a[254:255], v61 offset:63488
    v_cvt_pk_bf16_f32 v89, v90, v91
    v_mfma_f32_16x16x32_bf16 v[104:107], a[224:227], v[240:243], v[104:107]
    ds_read_b64_tr_b16 a[192:193], v62 offset:32768
    v_cvt_pk_bf16_f32 v90, v92, v93
    v_mfma_f32_16x16x32_bf16 v[104:107], a[228:231], v[244:247], v[104:107]
    s_waitcnt lgkmcnt(9)
    ds_read_b64_tr_b16 a[194:195], v62 offset:34816
    v_cvt_pk_bf16_f32 v91, v94, v95
    v_mfma_f32_16x16x32_bf16 v[100:103], a[232:235], v[224:227], v[100:103]
    ds_read_b64_tr_b16 a[196:197], v62 offset:36864
    v_min_u32 v88, -2, v88
    v_mfma_f32_16x16x32_bf16 v[100:103], a[236:239], v[228:231], v[100:103]
    ds_read_b64_tr_b16 a[198:199], v62 offset:38912
    v_min_u32 v89, -2, v89
    v_mfma_f32_16x16x32_bf16 v[108:111], a[232:235], v[240:243], v[108:111]
    ds_read_b64_tr_b16 a[200:201], v63 offset:32768
    v_min_u32 v90, -2, v90
    v_mfma_f32_16x16x32_bf16 v[108:111], a[236:239], v[244:247], v[108:111]
    s_waitcnt lgkmcnt(9)
    ds_read_b64_tr_b16 a[202:203], v63 offset:34816
    v_fmac_f32 v16, v54, v182
    v_mfma_f32_16x16x32_bf16 v[96:99], a[240:243], v[232:235], v[96:99]
    s_add_u32 s74, s70, 0
    ds_read_b64_tr_b16 a[204:205], v63 offset:36864
    v_min_u32 v91, -2, v91
    v_mfma_f32_16x16x32_bf16 v[96:99], a[244:247], v[236:239], v[96:99]
    buffer_load_dwordx4 v[128:131], v44, s[8:11], s74 offen sc0 sc1
    ds_read_b64_tr_b16 a[206:207], v63 offset:38912
    v_mfma_f32_16x16x32_bf16 v[104:107], a[240:243], v[248:251], v[104:107]
    s_add_u32 s74, s70, 4096
    ds_read_b64_tr_b16 a[208:209], v62 offset:40960
    v_fmac_f32 v16, v55, v183
    v_mfma_f32_16x16x32_bf16 v[104:107], a[244:247], v[252:255], v[104:107]
    s_waitcnt lgkmcnt(9)
    s_add_u32 s75, s18, 8519680
    ds_read_b64_tr_b16 a[210:211], v62 offset:43008
    v_add_f32_dpp v16, v16, v16 quad_perm:[1,0,3,2] row_mask:0xf bank_mask:0xf
    v_mfma_f32_16x16x32_bf16 v[100:103], a[248:251], v[232:235], v[100:103]
    buffer_store_dwordx4 v[88:91], v23, s[8:11], s75 offen offset:256 sc0 sc1
    ds_read_b64_tr_b16 a[212:213], v62 offset:45056
    v_mfma_f32_16x16x32_bf16 v[100:103], a[252:255], v[236:239], v[100:103]
    buffer_load_dwordx4 v[132:135], v44, s[8:11], s74 offen sc0 sc1
    ds_read_b64_tr_b16 a[214:215], v62 offset:47104
    v_mfma_f32_16x16x32_bf16 v[108:111], a[248:251], v[248:251], v[108:111]
    s_add_u32 s74, s70, 8192
    ds_read_b64_tr_b16 a[216:217], v63 offset:40960
    v_add_f32_dpp v16, v16, v16 quad_perm:[2,3,0,1] row_mask:0xf bank_mask:0xf
    v_mfma_f32_16x16x32_bf16 v[108:111], a[252:255], v[252:255], v[108:111]
    s_waitcnt lgkmcnt(9)
    ds_read_b64_tr_b16 a[218:219], v63 offset:43008
    v_add_f32_dpp v16, v16, v16 row_half_mirror row_mask:0xf bank_mask:0xf
    v_mfma_f32_16x16x32_bf16 v[112:115], a[192:195], v[192:195], v[112:115]
    ds_read_b64_tr_b16 a[220:221], v63 offset:45056
    v_add_f32_dpp v16, v16, v16 row_mirror row_mask:0xf bank_mask:0xf
    v_mfma_f32_16x16x32_bf16 v[112:115], a[196:199], v[196:199], v[112:115]
    buffer_load_dwordx4 v[136:139], v44, s[8:11], s74 offen sc0 sc1
    ds_read_b64_tr_b16 a[222:223], v63 offset:47104
    v_mfma_f32_16x16x32_bf16 v[120:123], a[192:195], v[208:211], v[120:123]
    s_add_u32 s74, s70, 12288
    ds_read_b64_tr_b16 a[224:225], v62 offset:49152
    v_mov_b32 v19, v16
    v_mfma_f32_16x16x32_bf16 v[120:123], a[196:199], v[212:215], v[120:123]
    s_waitcnt lgkmcnt(9)
    ds_read_b64_tr_b16 a[226:227], v62 offset:51200
    v_permlane16_swap_b32 v16, v19
    v_mfma_f32_16x16x32_bf16 v[116:119], a[200:203], v[192:195], v[116:119]
    ds_read_b64_tr_b16 a[228:229], v62 offset:53248
    v_add_f32 v16, v16, v19
    v_mfma_f32_16x16x32_bf16 v[116:119], a[204:207], v[196:199], v[116:119]
    buffer_load_dwordx4 v[140:143], v44, s[8:11], s74 offen sc0 sc1
    ds_read_b64_tr_b16 a[230:231], v62 offset:55296
    v_mfma_f32_16x16x32_bf16 v[124:127], a[200:203], v[208:211], v[124:127]
    s_add_u32 s74, s70, 16384
    ds_read_b64_tr_b16 a[232:233], v63 offset:49152
    v_cvt_pk_bf16_f32 v96, v96, v97
    v_mfma_f32_16x16x32_bf16 v[124:127], a[204:207], v[212:215], v[124:127]
    s_waitcnt lgkmcnt(9)
    ds_read_b64_tr_b16 a[234:235], v63 offset:51200
    v_cvt_pk_bf16_f32 v97, v98, v99
    v_mfma_f32_16x16x32_bf16 v[112:115], a[208:211], v[200:203], v[112:115]
    ds_read_b64_tr_b16 a[236:237], v63 offset:53248
    v_cvt_pk_bf16_f32 v98, v100, v101
    v_mfma_f32_16x16x32_bf16 v[112:115], a[212:215], v[204:207], v[112:115]
    buffer_load_dwordx4 v[144:147], v44, s[8:11], s74 offen sc0 sc1
    ds_read_b64_tr_b16 a[238:239], v63 offset:55296
    v_mfma_f32_16x16x32_bf16 v[120:123], a[208:211], v[216:219], v[120:123]
    s_add_u32 s74, s70, 20480
    ds_read_b64_tr_b16 a[240:241], v62 offset:57344
    v_cvt_pk_bf16_f32 v99, v102, v103
    v_mfma_f32_16x16x32_bf16 v[120:123], a[212:215], v[220:223], v[120:123]
    s_waitcnt lgkmcnt(9)
    ds_read_b64_tr_b16 a[242:243], v62 offset:59392
    v_min_u32 v96, -2, v96
    v_mfma_f32_16x16x32_bf16 v[116:119], a[216:219], v[200:203], v[116:119]
    ds_read_b64_tr_b16 a[244:245], v62 offset:61440
    v_min_u32 v97, -2, v97
    v_mfma_f32_16x16x32_bf16 v[116:119], a[220:223], v[204:207], v[116:119]
    buffer_load_dwordx4 v[148:151], v44, s[8:11], s74 offen sc0 sc1
    ds_read_b64_tr_b16 a[246:247], v62 offset:63488
    v_mfma_f32_16x16x32_bf16 v[124:127], a[216:219], v[216:219], v[124:127]
    s_add_u32 s74, s70, 24576
    ds_read_b64_tr_b16 a[248:249], v63 offset:57344
    v_min_u32 v98, -2, v98
    v_mfma_f32_16x16x32_bf16 v[124:127], a[220:223], v[220:223], v[124:127]
    s_waitcnt lgkmcnt(9)
    ds_read_b64_tr_b16 a[250:251], v63 offset:59392
    v_min_u32 v99, -2, v99
    v_mfma_f32_16x16x32_bf16 v[112:115], a[224:227], v[224:227], v[112:115]
    s_add_u32 s75, s18, 8388608
    ds_read_b64_tr_b16 a[252:253], v63 offset:61440
    v_mov_b32 v19, v16
    v_mfma_f32_16x16x32_bf16 v[112:115], a[228:231], v[228:231], v[112:115]
    buffer_load_dwordx4 v[152:155], v44, s[8:11], s74 offen sc0 sc1
    ds_read_b64_tr_b16 a[254:255], v63 offset:63488
    v_mfma_f32_16x16x32_bf16 v[120:123], a[224:227], v[240:243], v[120:123]
    s_waitcnt lgkmcnt(9)
    s_add_u32 s74, s70, 28672
    v_permlane32_swap_b32 v16, v19
    v_mfma_f32_16x16x32_bf16 v[120:123], a[228:231], v[244:247], v[120:123]
    buffer_store_dwordx4 v[96:99], v23, s[8:11], s75 offen offset:512 sc0 sc1
    v_add_f32 v16, v16, v19
    v_mfma_f32_16x16x32_bf16 v[116:119], a[232:235], v[224:227], v[116:119]
    s_waitcnt lgkmcnt(7)
    v_cvt_pk_bf16_f32 v104, v104, v105
    v_mfma_f32_16x16x32_bf16 v[116:119], a[236:239], v[228:231], v[116:119]
    buffer_load_dwordx4 v[156:159], v44, s[8:11], s74 offen sc0 sc1
    v_mfma_f32_16x16x32_bf16 v[124:127], a[232:235], v[240:243], v[124:127]
    v_cvt_pk_bf16_f32 v105, v106, v107
    v_mfma_f32_16x16x32_bf16 v[124:127], a[236:239], v[244:247], v[124:127]
    s_waitcnt lgkmcnt(4)
    v_cvt_pk_bf16_f32 v106, v108, v109
    v_mfma_f32_16x16x32_bf16 v[112:115], a[240:243], v[232:235], v[112:115]
    v_cvt_pk_bf16_f32 v107, v110, v111
    v_mfma_f32_16x16x32_bf16 v[112:115], a[244:247], v[236:239], v[112:115]
    v_min_u32 v104, -2, v104
    v_mfma_f32_16x16x32_bf16 v[120:123], a[240:243], v[248:251], v[120:123]
    v_min_u32 v105, -2, v105
    v_mfma_f32_16x16x32_bf16 v[120:123], a[244:247], v[252:255], v[120:123]
    s_waitcnt lgkmcnt(0)
    v_min_u32 v106, -2, v106
    v_mfma_f32_16x16x32_bf16 v[116:119], a[248:251], v[232:235], v[116:119]
    v_min_u32 v107, -2, v107
    v_mfma_f32_16x16x32_bf16 v[116:119], a[252:255], v[236:239], v[116:119]
    s_add_u32 s75, s18, 8519680
    v_mfma_f32_16x16x32_bf16 v[124:127], a[248:251], v[248:251], v[124:127]
    buffer_store_dwordx4 v[104:107], v23, s[8:11], s75 offen offset:512 sc0 sc1
    v_mfma_f32_16x16x32_bf16 v[124:127], a[252:255], v[252:255], v[124:127]
    v_cvt_pk_bf16_f32 v112, v112, v113
    v_cvt_pk_bf16_f32 v113, v114, v115
    s_nop 1
    v_cvt_pk_bf16_f32 v114, v116, v117
    v_cvt_pk_bf16_f32 v115, v118, v119
    v_min_u32 v112, -2, v112
    v_min_u32 v113, -2, v113
    v_min_u32 v114, -2, v114
    v_min_u32 v115, -2, v115
    s_add_u32 s75, s18, 8388608
    buffer_store_dwordx4 v[112:115], v23, s[8:11], s75 offen offset:768 sc0 sc1
    v_cvt_pk_bf16_f32 v120, v120, v121
    v_cvt_pk_bf16_f32 v121, v122, v123
    v_cvt_pk_bf16_f32 v122, v124, v125
    v_cvt_pk_bf16_f32 v123, v126, v127
    v_min_u32 v120, -2, v120
    v_min_u32 v121, -2, v121
    v_min_u32 v122, -2, v122
    v_min_u32 v123, -2, v123
    s_add_u32 s75, s18, 8519680
    buffer_store_dwordx4 v[120:123], v23, s[8:11], s75 offen offset:768 sc0 sc1
    s_mov_b32 s12, 0xf000f0
    s_mov_b32 s13, 0xf000f0
    v_mov_b64 v[192:193], -1
    v_mov_b64 v[194:195], -1
    v_mov_b64 v[196:197], -1
    v_mov_b64 v[198:199], -1
    v_mov_b64 v[200:201], -1
    v_mov_b64 v[202:203], -1
    v_mov_b64 v[204:205], -1
    v_mov_b64 v[206:207], -1
    v_mov_b64 v[208:209], -1
    v_mov_b64 v[210:211], -1
    v_mov_b64 v[212:213], -1
    v_mov_b64 v[214:215], -1
    v_mov_b64 v[216:217], -1
    v_mov_b64 v[218:219], -1
    v_mov_b64 v[220:221], -1
    v_mov_b64 v[222:223], -1
    s_mov_b64 exec, s[12:13]
    s_add_u32 s74, s70, 8388608
    buffer_load_dwordx4 v[192:195], v44, s[8:11], s74 offen sc0 sc1
    s_add_u32 s74, s70, 8392704
    buffer_load_dwordx4 v[196:199], v44, s[8:11], s74 offen sc0 sc1
    s_add_u32 s74, s70, 8396800
    buffer_load_dwordx4 v[200:203], v44, s[8:11], s74 offen sc0 sc1
    s_add_u32 s74, s70, 8400896
    buffer_load_dwordx4 v[204:207], v44, s[8:11], s74 offen sc0 sc1
    s_add_u32 s74, s70, 8404992
    buffer_load_dwordx4 v[208:211], v44, s[8:11], s74 offen sc0 sc1
    s_add_u32 s74, s70, 8409088
    buffer_load_dwordx4 v[212:215], v44, s[8:11], s74 offen sc0 sc1
    s_add_u32 s74, s70, 8413184
    buffer_load_dwordx4 v[216:219], v44, s[8:11], s74 offen sc0 sc1
    s_add_u32 s74, s70, 8417280
    buffer_load_dwordx4 v[220:223], v44, s[8:11], s74 offen sc0 sc1
    s_mov_b64 exec, -1
    v_mov_b32 v100, 0x3f80
    v_mov_b32 v101, 0x3f800000
    v_lshlrev_b32 v88, 16, v36
    v_and_b32 v89, 0xffff0000, v36
    v_lshlrev_b32 v90, 16, v37
    v_and_b32 v91, 0xffff0000, v37
    v_lshlrev_b32 v92, 16, v38
    v_and_b32 v93, 0xffff0000, v38
    v_lshlrev_b32 v94, 16, v39
    v_and_b32 v95, 0xffff0000, v39
    v_lshlrev_b32 v72, 16, v32
    v_and_b32 v73, 0xffff0000, v32
    v_lshlrev_b32 v74, 16, v33
    v_and_b32 v75, 0xffff0000, v33
    v_lshlrev_b32 v76, 16, v34
    v_and_b32 v77, 0xffff0000, v34
    v_lshlrev_b32 v78, 16, v35
    v_and_b32 v79, 0xffff0000, v35
    s_waitcnt vmcnt(20)
    v_max_u32 v3, v128, v129
    v_max3_u32 v3, v3, v130, v131
    s_waitcnt vmcnt(18)
    v_max3_u32 v3, v3, v132, v133
    v_max3_u32 v3, v3, v134, v135
    s_waitcnt vmcnt(17)
    v_max3_u32 v3, v3, v136, v137
    v_max3_u32 v3, v3, v138, v139
    s_waitcnt vmcnt(16)
    v_max3_u32 v3, v3, v140, v141
    v_max3_u32 v3, v3, v142, v143
    s_waitcnt vmcnt(15)
    v_max3_u32 v3, v3, v144, v145
    v_max3_u32 v3, v3, v146, v147
    s_waitcnt vmcnt(14)
    v_max3_u32 v3, v3, v148, v149
    v_max3_u32 v3, v3, v150, v151
    s_waitcnt vmcnt(13)
    v_max3_u32 v3, v3, v152, v153
    v_max3_u32 v3, v3, v154, v155
    s_waitcnt vmcnt(11)
    v_max3_u32 v3, v3, v156, v157
    v_max3_u32 v3, v3, v158, v159
    v_cmp_eq_u32 vcc, -1, v3
    s_cbranch_vccnz L_P1_slow_15
L_P1_ok_16:
    v_lshlrev_b32 v64, 16, v128
    v_and_b32 v65, 0xffff0000, v128
    v_lshlrev_b32 v66, 16, v129
    v_and_b32 v67, 0xffff0000, v129
    v_lshlrev_b32 v68, 16, v130
    v_and_b32 v69, 0xffff0000, v130
    v_lshlrev_b32 v70, 16, v131
    v_and_b32 v71, 0xffff0000, v131
    v_dot2c_f32_bf16 v64, v132, v100
    v_dot2c_f32_bf16 v65, v132, v101
    v_dot2c_f32_bf16 v66, v133, v100
    v_dot2c_f32_bf16 v67, v133, v101
    v_dot2c_f32_bf16 v68, v134, v100
    v_dot2c_f32_bf16 v69, v134, v101
    v_dot2c_f32_bf16 v70, v135, v100
    v_dot2c_f32_bf16 v71, v135, v101
    v_dot2c_f32_bf16 v64, v136, v100
    v_dot2c_f32_bf16 v65, v136, v101
    v_dot2c_f32_bf16 v66, v137, v100
    v_dot2c_f32_bf16 v67, v137, v101
    v_dot2c_f32_bf16 v68, v138, v100
    v_dot2c_f32_bf16 v69, v138, v101
    v_dot2c_f32_bf16 v70, v139, v100
    v_dot2c_f32_bf16 v71, v139, v101
    v_dot2c_f32_bf16 v64, v140, v100
    v_dot2c_f32_bf16 v65, v140, v101
    v_dot2c_f32_bf16 v66, v141, v100
    v_dot2c_f32_bf16 v67, v141, v101
    v_dot2c_f32_bf16 v68, v142, v100
    v_dot2c_f32_bf16 v69, v142, v101
    v_dot2c_f32_bf16 v70, v143, v100
    v_dot2c_f32_bf16 v71, v143, v101
    v_dot2c_f32_bf16 v64, v144, v100
    v_dot2c_f32_bf16 v65, v144, v101
    v_dot2c_f32_bf16 v66, v145, v100
    v_dot2c_f32_bf16 v67, v145, v101
    v_dot2c_f32_bf16 v68, v146, v100
    v_dot2c_f32_bf16 v69, v146, v101
    v_dot2c_f32_bf16 v70, v147, v100
    v_dot2c_f32_bf16 v71, v147, v101
    v_dot2c_f32_bf16 v64, v148, v100
    v_dot2c_f32_bf16 v65, v148, v101
    v_dot2c_f32_bf16 v66, v149, v100
    v_dot2c_f32_bf16 v67, v149, v101
    v_dot2c_f32_bf16 v68, v150, v100
    v_dot2c_f32_bf16 v69, v150, v101
    v_dot2c_f32_bf16 v70, v151, v100
    v_dot2c_f32_bf16 v71, v151, v101
    v_dot2c_f32_bf16 v64, v152, v100
    v_dot2c_f32_bf16 v65, v152, v101
    v_dot2c_f32_bf16 v66, v153, v100
    v_dot2c_f32_bf16 v67, v153, v101
    v_dot2c_f32_bf16 v68, v154, v100
    v_dot2c_f32_bf16 v69, v154, v101
    v_dot2c_f32_bf16 v70, v155, v100
    v_dot2c_f32_bf16 v71, v155, v101
    v_dot2c_f32_bf16 v64, v156, v100
    v_dot2c_f32_bf16 v65, v156, v101
    v_dot2c_f32_bf16 v66, v157, v100
    v_dot2c_f32_bf16 v67, v157, v101
    v_dot2c_f32_bf16 v68, v158, v100
    v_dot2c_f32_bf16 v69, v158, v101
    v_dot2c_f32_bf16 v70, v159, v100
    v_dot2c_f32_bf16 v71, v159, v101
    v_pk_fma_f32 v[64:65], v[64:65], v[160:161], v[72:73]
    v_pk_fma_f32 v[66:67], v[66:67], v[162:163], v[74:75]
    v_pk_fma_f32 v[68:69], v[68:69], v[164:165], v[76:77]
    v_pk_fma_f32 v[70:71], v[70:71], v[166:167], v[78:79]
    v_cvt_pk_bf16_f32 v32, v64, v65
    v_cvt_pk_bf16_f32 v33, v66, v67
    v_cvt_pk_bf16_f32 v34, v68, v69
    v_cvt_pk_bf16_f32 v35, v70, v71
    v_lshlrev_b32 v64, 16, v32
    v_and_b32 v65, 0xffff0000, v32
    v_lshlrev_b32 v66, 16, v33
    v_and_b32 v67, 0xffff0000, v33
    v_lshlrev_b32 v68, 16, v34
    v_and_b32 v69, 0xffff0000, v34
    v_lshlrev_b32 v70, 16, v35
    v_and_b32 v71, 0xffff0000, v35
    v_pk_add_f32 v[48:49], v[64:65], v[66:67]
    v_pk_add_f32 v[50:51], v[68:69], v[70:71]
    v_pk_add_f32 v[48:49], v[48:49], v[50:51]
    v_add_f32 v48, v48, v49
    s_nop 1
    v_add_f32_dpp v48, v48, v48 quad_perm:[1,0,3,2] row_mask:0xf bank_mask:0xf
    s_nop 1
    v_add_f32_dpp v48, v48, v48 quad_perm:[2,3,0,1] row_mask:0xf bank_mask:0xf
    s_nop 1
    v_add_f32_dpp v48, v48, v48 row_half_mirror row_mask:0xf bank_mask:0xf
    s_nop 1
    v_add_f32_dpp v48, v48, v48 row_mirror row_mask:0xf bank_mask:0xf
    v_mov_b32 v49, v48
    s_nop 1
    v_permlane16_swap_b32 v48, v49
    v_add_f32 v48, v48, v49
    v_mov_b32 v49, v48
    s_nop 1
    v_permlane32_swap_b32 v48, v49
    v_add_f32 v48, v48, v49
    v_mul_f32 v48, 0xbb000000, v48
    v_pk_add_f32 v[72:73], v[64:65], v[48:49] op_sel_hi:[1,0]
    v_pk_add_f32 v[74:75], v[66:67], v[48:49] op_sel_hi:[1,0]
    v_pk_add_f32 v[76:77], v[68:69], v[48:49] op_sel_hi:[1,0]
    v_pk_add_f32 v[78:79], v[70:71], v[48:49] op_sel_hi:[1,0]
    v_pk_mul_f32 v[50:51], v[72:73], v[72:73]
    v_pk_mul_f32 v[52:53], v[72:73], v[8:9]
    v_pk_fma_f32 v[50:51], v[74:75], v[74:75], v[50:51]
    v_pk_fma_f32 v[52:53], v[74:75], v[10:11], v[52:53]
    v_pk_fma_f32 v[50:51], v[76:77], v[76:77], v[50:51]
    v_pk_fma_f32 v[52:53], v[76:77], v[12:13], v[52:53]
    v_pk_fma_f32 v[50:51], v[78:79], v[78:79], v[50:51]
    v_pk_fma_f32 v[52:53], v[78:79], v[14:15], v[52:53]
    v_add_f32 v50, v50, v51
    v_add_f32 v52, v52, v53
    s_nop 0
    v_add_f32_dpp v50, v50, v50 quad_perm:[1,0,3,2] row_mask:0xf bank_mask:0xf
    v_add_f32_dpp v52, v52, v52 quad_perm:[1,0,3,2] row_mask:0xf bank_mask:0xf
    s_nop 0
    v_add_f32_dpp v50, v50, v50 quad_perm:[2,3,0,1] row_mask:0xf bank_mask:0xf
    v_add_f32_dpp v52, v52, v52 quad_perm:[2,3,0,1] row_mask:0xf bank_mask:0xf
    s_nop 0
    v_add_f32_dpp v50, v50, v50 row_half_mirror row_mask:0xf bank_mask:0xf
    v_add_f32_dpp v52, v52, v52 row_half_mirror row_mask:0xf bank_mask:0xf
    s_nop 0
    v_add_f32_dpp v50, v50, v50 row_mirror row_mask:0xf bank_mask:0xf
    v_add_f32_dpp v52, v52, v52 row_mirror row_mask:0xf bank_mask:0xf
    v_mov_b32 v51, v50
    v_mov_b32 v53, v52
    s_nop 0
    v_permlane16_swap_b32 v50, v51
    v_permlane16_swap_b32 v52, v53
    v_add_f32 v50, v50, v51
    v_add_f32 v52, v52, v53
    v_mov_b32 v51, v50
    v_mov_b32 v53, v52
    s_nop 0
    v_permlane32_swap_b32 v50, v51
    v_permlane32_swap_b32 v52, v53
    v_add_f32 v50, v50, v51
    v_add_f32 v52, v52, v53
    v_mov_b32 v48, 0x3727c5ac
    v_fmac_f32 v48, 0x3b000000, v50
    v_rsq_f32 v48, v48
    s_nop 0
    v_fma_f32 v52, v52, v48, v16
    v_ashrrev_i32 v53, 31, v52
    v_or_b32 v53, 0x80000000, v53
    v_xor_b32 v53, v53, v52
    v_and_b32 v53, 0xfffff800, v53
    v_or_b32 v17, s68, v53
    v_pk_mul_f32 v[72:73], v[72:73], v[48:49] op_sel_hi:[1,0]
    v_pk_mul_f32 v[74:75], v[74:75], v[48:49] op_sel_hi:[1,0]
    v_pk_mul_f32 v[76:77], v[76:77], v[48:49] op_sel_hi:[1,0]
    v_pk_mul_f32 v[78:79], v[78:79], v[48:49] op_sel_hi:[1,0]
    v_pk_fma_f32 v[72:73], v[72:73], v[168:169], v[176:177]
    v_pk_fma_f32 v[74:75], v[74:75], v[170:171], v[178:179]
    v_pk_fma_f32 v[76:77], v[76:77], v[172:173], v[180:181]
    v_pk_fma_f32 v[78:79], v[78:79], v[174:175], v[182:183]
    v_cvt_pk_bf16_f32 v20, v72, v73
    v_cvt_pk_bf16_f32 v21, v74, v75
    v_cvt_pk_bf16_f32 v22, v76, v77
    v_cvt_pk_bf16_f32 v23, v78, v79
    v_lshlrev_b32 v98, 4, v0
    v_cmp_gt_u32 vcc, 224, v0
    v_mov_b32 v99, 2147479552
    s_nop 0
    v_cndmask_b32 v99, v99, v98, vcc
    s_lshl_b32 s17, s66, 13
    s_add_u32 s17, s17, 4194304
    s_cmp_lt_u32 s66, 224
    s_cselect_b32 s17, s17, 2143285248
    s_lshl_b32 s100, s3, 2
    v_mov_b32 v47, s100
    v_mov_b32 v102, 0
    s_lshl_b32 s100, s2, 6
    s_add_u32 s100, s100, 65536
    s_lshl_b32 s101, s2, 11
    s_add_u32 s101, s101, 524288
    s_branch L_pg_17
.p2align 12
L_pg_17:
    s_mov_b32 s99, 0
L_P2_l_18:
    s_waitcnt vmcnt(0)
    v_max_u32 v48, v192, v193
    v_max3_u32 v48, v48, v194, v195
    v_max_u32 v49, v196, v197
    v_max3_u32 v49, v49, v198, v199
    v_max_u32 v50, v200, v201
    v_max3_u32 v50, v50, v202, v203
    v_max_u32 v51, v204, v205
    v_max3_u32 v51, v51, v206, v207
    v_max_u32 v52, v208, v209
    v_max3_u32 v52, v52, v210, v211
    v_max_u32 v53, v212, v213
    v_max3_u32 v53, v53, v214, v215
    v_max_u32 v54, v216, v217
    v_max3_u32 v54, v54, v218, v219
    v_max_u32 v55, v220, v221
    v_max3_u32 v55, v55, v222, v223
    v_max3_u32 v3, v48, v49, v50
    v_max3_u32 v3, v3, v51, v52
    v_max3_u32 v3, v3, v53, v54
    v_max_u32 v3, v3, v55
    v_cmp_eq_u32 vcc, -1, v3
    s_add_u32 s99, s99, 1
    s_cbranch_vccz L_P2_ok_19
    s_cmp_ge_u32 s99, 200000
    s_cbranch_scc1 L_P2_ok_19
    s_sleep 1
    v_cmp_eq_u32 vcc, -1, v48
    s_cbranch_vccz L_P2_s_20
    s_and_b64 s[96:97], vcc, s[12:13]
    s_cselect_b64 exec, s[96:97], vcc
    s_add_u32 s74, s70, 8388608
    buffer_load_dwordx4 v[192:195], v44, s[8:11], s74 offen sc0 sc1
    s_mov_b64 exec, -1
L_P2_s_20:
    v_cmp_eq_u32 vcc, -1, v49
    s_cbranch_vccz L_P2_s_21
    s_and_b64 s[96:97], vcc, s[12:13]
    s_cselect_b64 exec, s[96:97], vcc
    s_add_u32 s74, s70, 8392704
    buffer_load_dwordx4 v[196:199], v44, s[8:11], s74 offen sc0 sc1
    s_mov_b64 exec, -1
L_P2_s_21:
    v_cmp_eq_u32 vcc, -1, v50
    s_cbranch_vccz L_P2_s_22
    s_and_b64 s[96:97], vcc, s[12:13]
    s_cselect_b64 exec, s[96:97], vcc
    s_add_u32 s74, s70, 8396800
    buffer_load_dwordx4 v[200:203], v44, s[8:11], s74 offen sc0 sc1
    s_mov_b64 exec, -1
L_P2_s_22:
    v_cmp_eq_u32 vcc, -1, v51
    s_cbranch_vccz L_P2_s_23
    s_and_b64 s[96:97], vcc, s[12:13]
    s_cselect_b64 exec, s[96:97], vcc
    s_add_u32 s74, s70, 8400896
    buffer_load_dwordx4 v[204:207], v44, s[8:11], s74 offen sc0 sc1
    s_mov_b64 exec, -1
L_P2_s_23:
    v_cmp_eq_u32 vcc, -1, v52
    s_cbranch_vccz L_P2_s_24
    s_and_b64 s[96:97], vcc, s[12:13]
    s_cselect_b64 exec, s[96:97], vcc
    s_add_u32 s74, s70, 8404992
    buffer_load_dwordx4 v[208:211], v44, s[8:11], s74 offen sc0 sc1
    s_mov_b64 exec, -1
L_P2_s_24:
    v_cmp_eq_u32 vcc, -1, v53
    s_cbranch_vccz L_P2_s_25
    s_and_b64 s[96:97], vcc, s[12:13]
    s_cselect_b64 exec, s[96:97], vcc
    s_add_u32 s74, s70, 8409088
    buffer_load_dwordx4 v[212:215], v44, s[8:11], s74 offen sc0 sc1
    s_mov_b64 exec, -1
L_P2_s_25:
    v_cmp_eq_u32 vcc, -1, v54
    s_cbranch_vccz L_P2_s_26
    s_and_b64 s[96:97], vcc, s[12:13]
    s_cselect_b64 exec, s[96:97], vcc
    s_add_u32 s74, s70, 8413184
    buffer_load_dwordx4 v[216:219], v44, s[8:11], s74 offen sc0 sc1
    s_mov_b64 exec, -1
L_P2_s_26:
    v_cmp_eq_u32 vcc, -1, v55
    s_cbranch_vccz L_P2_s_27
    s_and_b64 s[96:97], vcc, s[12:13]
    s_cselect_b64 exec, s[96:97], vcc
    s_add_u32 s74, s70, 8417280
    buffer_load_dwordx4 v[220:223], v44, s[8:11], s74 offen sc0 sc1
    s_mov_b64 exec, -1
L_P2_s_27:
    s_branch L_P2_l_18
L_P2_ok_19:
    v_lshlrev_b32 v80, 16, v192
    v_and_b32 v81, 0xffff0000, v192
    v_lshlrev_b32 v82, 16, v193
    v_and_b32 v83, 0xffff0000, v193
    v_lshlrev_b32 v84, 16, v194
    v_and_b32 v85, 0xffff0000, v194
    v_lshlrev_b32 v86, 16, v195
    v_and_b32 v87, 0xffff0000, v195
    v_dot2c_f32_bf16 v80, v196, v100
    v_dot2c_f32_bf16 v81, v196, v101
    v_dot2c_f32_bf16 v82, v197, v100
    v_dot2c_f32_bf16 v83, v197, v101
    v_dot2c_f32_bf16 v84, v198, v100
    v_dot2c_f32_bf16 v85, v198, v101
    v_dot2c_f32_bf16 v86, v199, v100
    v_dot2c_f32_bf16 v87, v199, v101
    v_dot2c_f32_bf16 v80, v200, v100
    v_dot2c_f32_bf16 v81, v200, v101
    v_dot2c_f32_bf16 v82, v201, v100
    v_dot2c_f32_bf16 v83, v201, v101
    v_dot2c_f32_bf16 v84, v202, v100
    v_dot2c_f32_bf16 v85, v202, v101
    v_dot2c_f32_bf16 v86, v203, v100
    v_dot2c_f32_bf16 v87, v203, v101
    v_dot2c_f32_bf16 v80, v204, v100
    v_dot2c_f32_bf16 v81, v204, v101
    v_dot2c_f32_bf16 v82, v205, v100
    v_dot2c_f32_bf16 v83, v205, v101
    v_dot2c_f32_bf16 v84, v206, v100
    v_dot2c_f32_bf16 v85, v206, v101
    v_dot2c_f32_bf16 v86, v207, v100
    v_dot2c_f32_bf16 v87, v207, v101
    v_dot2c_f32_bf16 v80, v208, v100
    v_dot2c_f32_bf16 v81, v208, v101
    v_dot2c_f32_bf16 v82, v209, v100
    v_dot2c_f32_bf16 v83, v209, v101
    v_dot2c_f32_bf16 v84, v210, v100
    v_dot2c_f32_bf16 v85, v210, v101
    v_dot2c_f32_bf16 v86, v211, v100
    v_dot2c_f32_bf16 v87, v211, v101
    v_dot2c_f32_bf16 v80, v212, v100
    v_dot2c_f32_bf16 v81, v212, v101
    v_dot2c_f32_bf16 v82, v213, v100
    v_dot2c_f32_bf16 v83, v213, v101
    v_dot2c_f32_bf16 v84, v214, v100
    v_dot2c_f32_bf16 v85, v214, v101
    v_dot2c_f32_bf16 v86, v215, v100
    v_dot2c_f32_bf16 v87, v215, v101
    v_dot2c_f32_bf16 v80, v216, v100
    v_dot2c_f32_bf16 v81, v216, v101
    v_dot2c_f32_bf16 v82, v217, v100
    v_dot2c_f32_bf16 v83, v217, v101
    v_dot2c_f32_bf16 v84, v218, v100
    v_dot2c_f32_bf16 v85, v218, v101
    v_dot2c_f32_bf16 v86, v219, v100
    v_dot2c_f32_bf16 v87, v219, v101
    v_dot2c_f32_bf16 v80, v220, v100
    v_dot2c_f32_bf16 v81, v220, v101
    v_dot2c_f32_bf16 v82, v221, v100
    v_dot2c_f32_bf16 v83, v221, v101
    v_dot2c_f32_bf16 v84, v222, v100
    v_dot2c_f32_bf16 v85, v222, v101
    v_dot2c_f32_bf16 v86, v223, v100
    v_dot2c_f32_bf16 v87, v223, v101
    v_pk_fma_f32 v[80:81], v[80:81], v[160:161], v[88:89]
    v_pk_fma_f32 v[82:83], v[82:83], v[162:163], v[90:91]
    v_pk_fma_f32 v[84:85], v[84:85], v[164:165], v[92:93]
    v_pk_fma_f32 v[86:87], v[86:87], v[166:167], v[94:95]
    v_cvt_pk_bf16_f32 v36, v80, v81
    v_cvt_pk_bf16_f32 v37, v82, v83
    v_cvt_pk_bf16_f32 v38, v84, v85
    v_cvt_pk_bf16_f32 v39, v86, v87
    v_lshlrev_b32 v80, 16, v36
    v_and_b32 v81, 0xffff0000, v36
    v_lshlrev_b32 v82, 16, v37
    v_and_b32 v83, 0xffff0000, v37
    v_lshlrev_b32 v84, 16, v38
    v_and_b32 v85, 0xffff0000, v38
    v_lshlrev_b32 v86, 16, v39
    v_and_b32 v87, 0xffff0000, v39
    v_pk_add_f32 v[48:49], v[80:81], v[82:83]
    v_pk_add_f32 v[50:51], v[84:85], v[86:87]
    v_pk_add_f32 v[48:49], v[48:49], v[50:51]
    v_add_f32 v48, v48, v49
    s_nop 1
    v_add_f32_dpp v48, v48, v48 quad_perm:[1,0,3,2] row_mask:0xf bank_mask:0xf
    s_nop 1
    v_add_f32_dpp v48, v48, v48 quad_perm:[2,3,0,1] row_mask:0xf bank_mask:0xf
    s_nop 1
    v_add_f32_dpp v48, v48, v48 row_half_mirror row_mask:0xf bank_mask:0xf
    s_nop 1
    v_add_f32_dpp v48, v48, v48 row_mirror row_mask:0xf bank_mask:0xf
    v_mov_b32 v49, v48
    s_nop 1
    v_permlane16_swap_b32 v48, v49
    v_add_f32 v48, v48, v49
    v_mov_b32 v49, v48
    s_nop 1
    v_permlane32_swap_b32 v48, v49
    v_add_f32 v48, v48, v49
    v_mul_f32 v48, 0xbb000000, v48
    v_pk_add_f32 v[88:89], v[80:81], v[48:49] op_sel_hi:[1,0]
    v_pk_add_f32 v[90:91], v[82:83], v[48:49] op_sel_hi:[1,0]
    v_pk_add_f32 v[92:93], v[84:85], v[48:49] op_sel_hi:[1,0]
    v_pk_add_f32 v[94:95], v[86:87], v[48:49] op_sel_hi:[1,0]
    v_pk_mul_f32 v[50:51], v[88:89], v[88:89]
    v_pk_mul_f32 v[52:53], v[88:89], v[8:9]
    v_pk_fma_f32 v[50:51], v[90:91], v[90:91], v[50:51]
    v_pk_fma_f32 v[52:53], v[90:91], v[10:11], v[52:53]
    v_pk_fma_f32 v[50:51], v[92:93], v[92:93], v[50:51]
    v_pk_fma_f32 v[52:53], v[92:93], v[12:13], v[52:53]
    v_pk_fma_f32 v[50:51], v[94:95], v[94:95], v[50:51]
    v_pk_fma_f32 v[52:53], v[94:95], v[14:15], v[52:53]
    v_add_f32 v50, v50, v51
    v_add_f32 v52, v52, v53
    s_nop 0
    v_add_f32_dpp v50, v50, v50 quad_perm:[1,0,3,2] row_mask:0xf bank_mask:0xf
    v_add_f32_dpp v52, v52, v52 quad_perm:[1,0,3,2] row_mask:0xf bank_mask:0xf
    s_nop 0
    v_add_f32_dpp v50, v50, v50 quad_perm:[2,3,0,1] row_mask:0xf bank_mask:0xf
    v_add_f32_dpp v52, v52, v52 quad_perm:[2,3,0,1] row_mask:0xf bank_mask:0xf
    s_nop 0
    v_add_f32_dpp v50, v50, v50 row_half_mirror row_mask:0xf bank_mask:0xf
    v_add_f32_dpp v52, v52, v52 row_half_mirror row_mask:0xf bank_mask:0xf
    s_nop 0
    v_add_f32_dpp v50, v50, v50 row_mirror row_mask:0xf bank_mask:0xf
    v_add_f32_dpp v52, v52, v52 row_mirror row_mask:0xf bank_mask:0xf
    v_mov_b32 v51, v50
    v_mov_b32 v53, v52
    s_nop 0
    v_permlane16_swap_b32 v50, v51
    v_permlane16_swap_b32 v52, v53
    v_add_f32 v50, v50, v51
    v_add_f32 v52, v52, v53
    v_mov_b32 v51, v50
    v_mov_b32 v53, v52
    s_nop 0
    v_permlane32_swap_b32 v50, v51
    v_permlane32_swap_b32 v52, v53
    v_add_f32 v50, v50, v51
    v_add_f32 v52, v52, v53
    v_mov_b32 v48, 0x3727c5ac
    v_fmac_f32 v48, 0x3b000000, v50
    v_rsq_f32 v48, v48
    s_nop 0
    v_fma_f32 v52, v52, v48, v16
    v_ashrrev_i32 v53, 31, v52
    v_or_b32 v53, 0x80000000, v53
    v_xor_b32 v53, v53, v52
    v_and_b32 v53, 0xfffff800, v53
    v_or_b32 v18, s69, v53
    v_max3_u32 v19, v17, v18, 1
    ds_write_b32 v47, v19
    s_waitcnt lgkmcnt(0)
    s_barrier
    ds_read_b128 v[52:55], v102
    v_pk_mul_f32 v[88:89], v[88:89], v[48:49] op_sel_hi:[1,0]
    v_pk_mul_f32 v[90:91], v[90:91], v[48:49] op_sel_hi:[1,0]
    v_pk_mul_f32 v[92:93], v[92:93], v[48:49] op_sel_hi:[1,0]
    v_pk_mul_f32 v[94:95], v[94:95], v[48:49] op_sel_hi:[1,0]
    v_pk_fma_f32 v[88:89], v[88:89], v[168:169], v[176:177]
    v_pk_fma_f32 v[90:91], v[90:91], v[170:171], v[178:179]
    v_pk_fma_f32 v[92:93], v[92:93], v[172:173], v[180:181]
    v_pk_fma_f32 v[94:95], v[94:95], v[174:175], v[182:183]
    v_cvt_pk_bf16_f32 v24, v88, v89
    v_cvt_pk_bf16_f32 v25, v90, v91
    v_cvt_pk_bf16_f32 v26, v92, v93
    v_cvt_pk_bf16_f32 v27, v94, v95
    s_waitcnt lgkmcnt(0)
    v_max_u32 v52, v52, v53
    v_max3_u32 v52, v52, v54, v55
    v_cmp_eq_u32 vcc, v52, v19
    s_cbranch_vccz L_notbest
    buffer_store_dword v19, v5, s[8:11], s100 offen sc0 sc1
    v_cmp_gt_u32 vcc, v17, v18
    s_nop 1
    v_cndmask_b32 v28, v24, v20, vcc
    v_cndmask_b32 v40, v36, v32, vcc
    v_cndmask_b32 v29, v25, v21, vcc
    v_cndmask_b32 v41, v37, v33, vcc
    v_cndmask_b32 v30, v26, v22, vcc
    v_cndmask_b32 v42, v38, v34, vcc
    v_cndmask_b32 v31, v27, v23, vcc
    v_cndmask_b32 v43, v39, v35, vcc
    v_min_u32 v28, -2, v28
    v_min_u32 v40, -2, v40
    v_min_u32 v29, -2, v29
    v_min_u32 v41, -2, v41
    v_min_u32 v30, -2, v30
    v_min_u32 v42, -2, v42
    v_min_u32 v31, -2, v31
    v_min_u32 v43, -2, v43
    buffer_store_dwordx4 v[28:31], v1, s[8:11], s101 offen sc0 sc1
    buffer_store_dwordx4 v[40:43], v1, s[8:11], s101 offen offset:1024 sc0 sc1
L_notbest:
    buffer_load_dwordx4 v[112:115], v98, s[8:11], s17 offen
    s_add_u32 s17, s17, 4096
    buffer_load_dwordx4 v[116:119], v98, s[8:11], s17 offen
    s_add_u32 s17, s17, 2093056
    buffer_load_dwordx4 v[120:123], v98, s[8:11], s17 offen
    s_add_u32 s17, s17, 4096
    buffer_load_dwordx4 v[124:127], v98, s[8:11], s17 offen
    s_mul_i32 s17, s67, 28672
    s_add_u32 s17, s17, 8388608
    s_cmp_lt_u32 s67, 64
    s_cselect_b32 s17, s17, 2143285248
    buffer_load_dwordx4 v[128:131], v99, s[8:11], s17 offen offset:0
    buffer_load_dwordx4 v[132:135], v99, s[8:11], s17 offen offset:3584
    s_add_u32 s17, s17, 7168
    buffer_load_dwordx4 v[136:139], v99, s[8:11], s17 offen offset:0
    buffer_load_dwordx4 v[140:143], v99, s[8:11], s17 offen offset:3584
    s_add_u32 s17, s17, 7168
    buffer_load_dwordx4 v[144:147], v99, s[8:11], s17 offen offset:0
    buffer_load_dwordx4 v[148:151], v99, s[8:11], s17 offen offset:3584
    s_add_u32 s17, s17, 7168
    buffer_load_dwordx4 v[152:155], v99, s[8:11], s17 offen offset:0
    buffer_load_dwordx4 v[156:159], v99, s[8:11], s17 offen offset:3584
    v_lshlrev_b32 v72, 16, v20
    v_and_b32 v73, 0xffff0000, v20
    v_lshlrev_b32 v74, 16, v21
    v_and_b32 v75, 0xffff0000, v21
    v_lshlrev_b32 v76, 16, v22
    v_and_b32 v77, 0xffff0000, v22
    v_lshlrev_b32 v78, 16, v23
    v_and_b32 v79, 0xffff0000, v23
    v_pk_mul_f32 v[72:73], v[72:73], v[184:185]
    v_pk_mul_f32 v[74:75], v[74:75], v[186:187]
    v_pk_mul_f32 v[76:77], v[76:77], v[188:189]
    v_pk_mul_f32 v[78:79], v[78:79], v[190:191]
    v_cvt_pk_bf16_f32 v56, v72, v73
    v_cvt_pk_bf16_f32 v57, v74, v75
    v_cvt_pk_bf16_f32 v58, v76, v77
    v_cvt_pk_bf16_f32 v59, v78, v79
    v_lshlrev_b32 v72, 16, v56
    v_and_b32 v73, 0xffff0000, v56
    v_lshlrev_b32 v74, 16, v57
    v_and_b32 v75, 0xffff0000, v57
    v_lshlrev_b32 v76, 16, v58
    v_and_b32 v77, 0xffff0000, v58
    v_lshlrev_b32 v78, 16, v59
    v_and_b32 v79, 0xffff0000, v59
    v_pk_add_f32 v[72:73], v[72:73], v[64:65]
    v_pk_add_f32 v[74:75], v[74:75], v[66:67]
    v_pk_add_f32 v[76:77], v[76:77], v[68:69]
    v_pk_add_f32 v[78:79], v[78:79], v[70:71]
    v_cvt_pk_bf16_f32 v56, v72, v73
    v_cvt_pk_bf16_f32 v57, v74, v75
    v_cvt_pk_bf16_f32 v58, v76, v77
    v_cvt_pk_bf16_f32 v59, v78, v79
    v_lshlrev_b32 v88, 16, v24
    v_and_b32 v89, 0xffff0000, v24
    v_lshlrev_b32 v90, 16, v25
    v_and_b32 v91, 0xffff0000, v25
    v_lshlrev_b32 v92, 16, v26
    v_and_b32 v93, 0xffff0000, v26
    v_lshlrev_b32 v94, 16, v27
    v_and_b32 v95, 0xffff0000, v27
    v_pk_mul_f32 v[88:89], v[88:89], v[184:185]
    v_pk_mul_f32 v[90:91], v[90:91], v[186:187]
    v_pk_mul_f32 v[92:93], v[92:93], v[188:189]
    v_pk_mul_f32 v[94:95], v[94:95], v[190:191]
    v_cvt_pk_bf16_f32 v60, v88, v89
    v_cvt_pk_bf16_f32 v61, v90, v91
    v_cvt_pk_bf16_f32 v62, v92, v93
    v_cvt_pk_bf16_f32 v63, v94, v95
    v_lshlrev_b32 v88, 16, v60
    v_and_b32 v89, 0xffff0000, v60
    v_lshlrev_b32 v90, 16, v61
    v_and_b32 v91, 0xffff0000, v61
    v_lshlrev_b32 v92, 16, v62
    v_and_b32 v93, 0xffff0000, v62
    v_lshlrev_b32 v94, 16, v63
    v_and_b32 v95, 0xffff0000, v63
    v_pk_add_f32 v[88:89], v[88:89], v[80:81]
    v_pk_add_f32 v[90:91], v[90:91], v[82:83]
    v_pk_add_f32 v[92:93], v[92:93], v[84:85]
    v_pk_add_f32 v[94:95], v[94:95], v[86:87]
    v_cvt_pk_bf16_f32 v60, v88, v89
    v_cvt_pk_bf16_f32 v61, v90, v91
    v_cvt_pk_bf16_f32 v62, v92, v93
    v_cvt_pk_bf16_f32 v63, v94, v95
    v_lshlrev_b32 v4, 6, v0
    s_mov_b32 s71, 65536
    s_mov_b32 s99, 0
    s_branch L_pg_28
.p2align 12
L_pg_28:
L_kl:
    buffer_load_dword v3, v4, s[8:11], s71 offen sc0 sc1
    s_add_u32 s99, s99, 1
    s_waitcnt vmcnt(0)
    v_cmp_eq_u32 vcc, 0, v3
    s_cbranch_vccz L_kd
    s_cmp_ge_u32 s99, 200000
    s_cbranch_scc1 L_kd
    s_mov_b64 exec, vcc
    s_sleep 2
    s_branch L_kl
L_kd:
    s_mov_b64 exec, -1
    v_max_u32_dpp v3, v3, v3 quad_perm:[1,0,3,2] row_mask:0xf bank_mask:0xf
    s_nop 1
    v_max_u32_dpp v3, v3, v3 quad_perm:[2,3,0,1] row_mask:0xf bank_mask:0xf
    s_nop 1
    v_max_u32_dpp v3, v3, v3 row_half_mirror row_mask:0xf bank_mask:0xf
    s_nop 1
    v_max_u32_dpp v3, v3, v3 row_mirror row_mask:0xf bank_mask:0xf
    v_mov_b32 v19, v3
    s_nop 1
    v_permlane16_swap_b32 v3, v19
    v_max_u32 v3, v3, v19
    v_mov_b32 v19, v3
    s_nop 1
    v_permlane32_swap_b32 v3, v19
    v_max_u32 v3, v3, v19
    ds_write_b32 v47, v3 offset:64
    s_waitcnt lgkmcnt(0)
    s_barrier
    ds_read_b128 v[52:55], v102 offset:64
    v_lshlrev_b32 v4, 2, v0
    s_waitcnt lgkmcnt(0)
    v_max_u32 v52, v52, v53
    v_max3_u32 v52, v52, v54, v55
    s_nop 0
    v_readfirstlane_b32 s71, v52
    s_and_b32 s72, s71, 2047
    s_lshr_b32 s100, s72, 7
    s_sub_u32 s101, 15, s100
    s_min_u32 s100, s100, s101
    s_lshl_b32 s100, s100, 16
    s_and_b32 s101, s72, 1024
    s_cmp_eq_u32 s101, 0
    s_cselect_b32 s73, 31, 31
    s_lshr_b32 s101, s72, 2
    s_and_b32 s73, s73, s101
    s_lshl_b32 s73, s73, 2
    s_lshl_b32 s73, s73, 9
    s_add_u32 s73, s73, s100
    s_add_u32 s73, s73, 524288
    buffer_load_dword v19, v4, s[8:11], s73 offen sc0 sc1
    s_lshl_b32 s100, s68, 10
    s_cmp_eq_u32 s68, s72
    s_cselect_b32 s100, 2147479552, s100
    buffer_store_dwordx2 v[56:57], v45, s[52:55], s100 offen
    buffer_store_dwordx2 v[58:59], v45, s[52:55], s100 offen offset:32
    s_lshl_b32 s100, s69, 10
    s_cmp_eq_u32 s69, s72
    s_cselect_b32 s100, 2147479552, s100
    buffer_store_dwordx2 v[60:61], v45, s[52:55], s100 offen
    buffer_store_dwordx2 v[62:63], v45, s[52:55], s100 offen offset:32
    s_cmp_ge_u32 s66, 224
    s_cbranch_scc1 L_nprod
    v_lshlrev_b32 v160, 16, v112
    v_and_b32 v161, 0xffff0000, v112
    v_lshlrev_b32 v162, 16, v113
    v_and_b32 v163, 0xffff0000, v113
    v_lshlrev_b32 v164, 16, v114
    v_and_b32 v165, 0xffff0000, v114
    v_lshlrev_b32 v166, 16, v115
    v_and_b32 v167, 0xffff0000, v115
    v_lshlrev_b32 v168, 16, v116
    v_and_b32 v169, 0xffff0000, v116
    v_lshlrev_b32 v170, 16, v117
    v_and_b32 v171, 0xffff0000, v117
    v_lshlrev_b32 v172, 16, v118
    v_and_b32 v173, 0xffff0000, v118
    v_lshlrev_b32 v174, 16, v119
    v_and_b32 v175, 0xffff0000, v119
    v_lshlrev_b32 v176, 16, v120
    v_and_b32 v177, 0xffff0000, v120
    v_lshlrev_b32 v178, 16, v121
    v_and_b32 v179, 0xffff0000, v121
    v_lshlrev_b32 v180, 16, v122
    v_and_b32 v181, 0xffff0000, v122
    v_lshlrev_b32 v182, 16, v123
    v_and_b32 v183, 0xffff0000, v123
    v_lshlrev_b32 v184, 16, v124
    v_and_b32 v185, 0xffff0000, v124
    v_lshlrev_b32 v186, 16, v125
    v_and_b32 v187, 0xffff0000, v125
    v_lshlrev_b32 v188, 16, v126
    v_and_b32 v189, 0xffff0000, v126
    v_lshlrev_b32 v190, 16, v127
    v_and_b32 v191, 0xffff0000, v127
    s_mov_b32 s99, 0
    s_waitcnt vmcnt(4)
L_hl:
    v_cmp_eq_u32 vcc, -1, v19
    s_add_u32 s99, s99, 1
    s_cbranch_vccz L_hok
    s_cmp_ge_u32 s99, 200000
    s_cbranch_scc1 L_hok
    buffer_load_dword v19, v4, s[8:11], s73 offen sc0 sc1
    s_waitcnt vmcnt(0)
    s_branch L_hl
L_hok:
    v_lshlrev_b32 v48, 16, v19
    v_and_b32 v50, 0xffff0000, v19
    v_pk_mul_f32 v[64:65], v[160:161], v[48:49] op_sel_hi:[1,0]
    v_pk_mul_f32 v[66:67], v[162:163], v[48:49] op_sel_hi:[1,0]
    v_pk_mul_f32 v[68:69], v[164:165], v[48:49] op_sel_hi:[1,0]
    v_pk_mul_f32 v[70:71], v[166:167], v[48:49] op_sel_hi:[1,0]
    v_pk_mul_f32 v[72:73], v[176:177], v[48:49] op_sel_hi:[1,0]
    v_pk_mul_f32 v[74:75], v[178:179], v[48:49] op_sel_hi:[1,0]
    v_pk_mul_f32 v[76:77], v[180:181], v[48:49] op_sel_hi:[1,0]
    v_pk_mul_f32 v[78:79], v[182:183], v[48:49] op_sel_hi:[1,0]
    v_pk_fma_f32 v[64:65], v[168:169], v[50:51], v[64:65] op_sel_hi:[1,0,1]
    v_pk_fma_f32 v[66:67], v[170:171], v[50:51], v[66:67] op_sel_hi:[1,0,1]
    v_pk_fma_f32 v[68:69], v[172:173], v[50:51], v[68:69] op_sel_hi:[1,0,1]
    v_pk_fma_f32 v[70:71], v[174:175], v[50:51], v[70:71] op_sel_hi:[1,0,1]
    v_pk_fma_f32 v[72:73], v[184:185], v[50:51], v[72:73] op_sel_hi:[1,0,1]
    v_pk_fma_f32 v[74:75], v[186:187], v[50:51], v[74:75] op_sel_hi:[1,0,1]
    v_pk_fma_f32 v[76:77], v[188:189], v[50:51], v[76:77] op_sel_hi:[1,0,1]
    v_pk_fma_f32 v[78:79], v[190:191], v[50:51], v[78:79] op_sel_hi:[1,0,1]
    v_permlane32_swap_b32 v64, v72
    v_permlane32_swap_b32 v65, v73
    v_permlane32_swap_b32 v66, v74
    v_permlane32_swap_b32 v67, v75
    v_permlane32_swap_b32 v68, v76
    v_permlane32_swap_b32 v69, v77
    v_permlane32_swap_b32 v70, v78
    v_permlane32_swap_b32 v71, v79
    v_add_f32 v64, v64, v72
    v_add_f32 v65, v65, v73
    v_add_f32 v66, v66, v74
    v_add_f32 v67, v67, v75
    v_add_f32 v68, v68, v76
    v_add_f32 v69, v69, v77
    v_add_f32 v70, v70, v78
    v_add_f32 v71, v71, v79
    v_permlane16_swap_b32 v64, v68
    v_permlane16_swap_b32 v65, v69
    v_permlane16_swap_b32 v66, v70
    v_permlane16_swap_b32 v67, v71
    v_add_f32 v64, v64, v68
    v_add_f32 v65, v65, v69
    v_add_f32 v66, v66, v70
    v_add_f32 v67, v67, v71
    v_add_f32_dpp v64, v64, v64 quad_perm:[1,0,3,2] row_mask:0xf bank_mask:0xf
    v_add_f32_dpp v65, v65, v65 quad_perm:[1,0,3,2] row_mask:0xf bank_mask:0xf
    v_add_f32_dpp v66, v66, v66 quad_perm:[1,0,3,2] row_mask:0xf bank_mask:0xf
    v_add_f32_dpp v67, v67, v67 quad_perm:[1,0,3,2] row_mask:0xf bank_mask:0xf
    v_add_f32_dpp v64, v64, v64 quad_perm:[2,3,0,1] row_mask:0xf bank_mask:0xf
    v_add_f32_dpp v65, v65, v65 quad_perm:[2,3,0,1] row_mask:0xf bank_mask:0xf
    v_add_f32_dpp v66, v66, v66 quad_perm:[2,3,0,1] row_mask:0xf bank_mask:0xf
    v_add_f32_dpp v67, v67, v67 quad_perm:[2,3,0,1] row_mask:0xf bank_mask:0xf
    v_add_f32_dpp v64, v64, v64 row_half_mirror row_mask:0xf bank_mask:0xf
    v_add_f32_dpp v65, v65, v65 row_half_mirror row_mask:0xf bank_mask:0xf
    v_add_f32_dpp v66, v66, v66 row_half_mirror row_mask:0xf bank_mask:0xf
    v_add_f32_dpp v67, v67, v67 row_half_mirror row_mask:0xf bank_mask:0xf
    v_add_f32_dpp v64, v64, v64 row_mirror row_mask:0xf bank_mask:0xf
    v_add_f32_dpp v65, v65, v65 row_mirror row_mask:0xf bank_mask:0xf
    v_add_f32_dpp v66, v66, v66 row_mirror row_mask:0xf bank_mask:0xf
    v_add_f32_dpp v67, v67, v67 row_mirror row_mask:0xf bank_mask:0xf
    v_and_b32 v50, 15, v2
    v_cmp_eq_u32 vcc, 0, v50
    v_mov_b32 v51, 1024
    s_nop 0
    v_cndmask_b32 v51, v51, v0, vcc
    ds_write_b128 v51, v[64:67] offset:256
    v_lshlrev_b32 v50, 2, v50
    s_waitcnt lgkmcnt(0)
    s_barrier
    s_cmp_lg_u32 s3, 0
    s_cbranch_scc1 L_nprod
    ds_read_b32 v64, v50 offset:256
    ds_read_b32 v65, v50 offset:320
    ds_read_b32 v66, v50 offset:384
    ds_read_b32 v67, v50 offset:448
    v_cmp_gt_u32 vcc, 8, v2
    v_mov_b32 v51, 2147479552
    s_nop 0
    v_cndmask_b32 v51, v51, v50, vcc
    s_lshl_b32 s100, s66, 6
    s_add_u32 s100, s100, 81920
    s_waitcnt lgkmcnt(2)
    v_add_f32 v64, v64, v65
    s_waitcnt lgkmcnt(0)
    v_add_f32 v66, v66, v67
    v_add_f32 v64, v64, v66
    v_cvt_pk_bf16_f32 v64, v64, v64
    v_and_b32 v64, 0xffff0000, v64
    s_nop 1
    v_mov_b32_dpp v65, v64 row_ror:8 row_mask:0xf bank_mask:0xf
    v_mul_f32 v66, 0xbfb8aa3b, v64
    v_exp_f32 v66, v66
    s_nop 0
    v_add_f32 v66, 1.0, v66
    v_rcp_f32 v66, v66
    s_nop 0
    v_mul_f32 v64, v64, v66
    v_cvt_pk_bf16_f32 v64, v64, v64
    v_and_b32 v64, 0xffff0000, v64
    v_mul_f32 v64, v64, v65
    v_cvt_pk_bf16_f32 v64, v64, v64
    v_and_b32 v64, 0xffff0000, v64
    buffer_store_dword v64, v51, s[8:11], s100 offen sc0 sc1
L_nprod:
    s_cmp_ge_u32 s67, 64
    s_cbranch_scc1 L_fin
    v_lshlrev_b32 v4, 6, v0
    v_cmp_gt_u32 vcc, 224, v0
    v_mov_b32 v51, 2147479552
    s_nop 0
    v_cndmask_b32 v4, v51, v4, vcc
    s_mov_b32 s100, 81920
    v_and_b32 v52, 7, v2
    s_lshl_b32 s101, s67, 3
    v_add_u32 v52, s101, v52
    v_lshrrev_b32 v53, 5, v52
    v_lshlrev_b32 v53, 6, v53
    v_and_b32 v54, 12, v52
    v_lshl_add_u32 v53, v54, 2, v53
    v_bfe_u32 v54, v52, 4, 1
    v_lshl_add_u32 v53, v54, 3, v53
    v_and_b32 v54, 2, v52
    v_lshl_add_u32 v53, v54, 1, v53
    v_lshlrev_b32 v54, 2, v52
    s_mov_b32 s101, 10240
    buffer_load_dword v55, v54, s[8:11], s101 offen
    buffer_load_dword v88, v53, s[8:11], s73 offen sc0 sc1
    buffer_load_dword v89, v53, s[8:11], s73 offen offset:1024 sc0 sc1
    v_lshlrev_b32 v192, 16, v128
    v_and_b32 v193, 0xffff0000, v128
    v_lshlrev_b32 v194, 16, v129
    v_and_b32 v195, 0xffff0000, v129
    v_lshlrev_b32 v196, 16, v130
    v_and_b32 v197, 0xffff0000, v130
    v_lshlrev_b32 v198, 16, v131
    v_and_b32 v199, 0xffff0000, v131
    v_lshlrev_b32 v200, 16, v132
    v_and_b32 v201, 0xffff0000, v132
    v_lshlrev_b32 v202, 16, v133
    v_and_b32 v203, 0xffff0000, v133
    v_lshlrev_b32 v204, 16, v134
    v_and_b32 v205, 0xffff0000, v134
    v_lshlrev_b32 v206, 16, v135
    v_and_b32 v207, 0xffff0000, v135
    v_lshlrev_b32 v208, 16, v136
    v_and_b32 v209, 0xffff0000, v136
    v_lshlrev_b32 v210, 16, v137
    v_and_b32 v211, 0xffff0000, v137
    v_lshlrev_b32 v212, 16, v138
    v_and_b32 v213, 0xffff0000, v138
    v_lshlrev_b32 v214, 16, v139
    v_and_b32 v215, 0xffff0000, v139
    v_lshlrev_b32 v216, 16, v140
    v_and_b32 v217, 0xffff0000, v140
    v_lshlrev_b32 v218, 16, v141
    v_and_b32 v219, 0xffff0000, v141
    v_lshlrev_b32 v220, 16, v142
    v_and_b32 v221, 0xffff0000, v142
    v_lshlrev_b32 v222, 16, v143
    v_and_b32 v223, 0xffff0000, v143
    v_lshlrev_b32 v224, 16, v144
    v_and_b32 v225, 0xffff0000, v144
    v_lshlrev_b32 v226, 16, v145
    v_and_b32 v227, 0xffff0000, v145
    v_lshlrev_b32 v228, 16, v146
    v_and_b32 v229, 0xffff0000, v146
    v_lshlrev_b32 v230, 16, v147
    v_and_b32 v231, 0xffff0000, v147
    v_lshlrev_b32 v232, 16, v148
    v_and_b32 v233, 0xffff0000, v148
    v_lshlrev_b32 v234, 16, v149
    v_and_b32 v235, 0xffff0000, v149
    v_lshlrev_b32 v236, 16, v150
    v_and_b32 v237, 0xffff0000, v150
    v_lshlrev_b32 v238, 16, v151
    v_and_b32 v239, 0xffff0000, v151
    v_lshlrev_b32 v240, 16, v152
    v_and_b32 v241, 0xffff0000, v152
    v_lshlrev_b32 v242, 16, v153
    v_and_b32 v243, 0xffff0000, v153
    v_lshlrev_b32 v244, 16, v154
    v_and_b32 v245, 0xffff0000, v154
    v_lshlrev_b32 v246, 16, v155
    v_and_b32 v247, 0xffff0000, v155
    v_lshlrev_b32 v248, 16, v156
    v_and_b32 v249, 0xffff0000, v156
    v_lshlrev_b32 v250, 16, v157
    v_and_b32 v251, 0xffff0000, v157
    v_lshlrev_b32 v252, 16, v158
    v_and_b32 v253, 0xffff0000, v158
    v_lshlrev_b32 v254, 16, v159
    v_and_b32 v255, 0xffff0000, v159
    s_and_b32 s101, s71, 0xfffff800
    s_or_b32 s101, s101, 0x400
    v_mov_b32 v90, s101
    v_not_b32 v91, v90
    v_ashrrev_i32 v91, 31, v91
    v_or_b32 v91, 0x80000000, v91
    v_xor_b32 v90, v90, v91
    v_cvt_pk_bf16_f32 v90, v90, v90
    v_and_b32 v90, 0xffff0000, v90
    v_mul_f32 v90, 0xbfb8aa3b, v90
    v_exp_f32 v90, v90
    s_nop 0
    v_add_f32 v90, 1.0, v90
    v_rcp_f32 v90, v90
    s_nop 0
    v_cvt_pk_bf16_f32 v90, v90, v90
    v_and_b32 v90, 0xffff0000, v90
    s_mov_b32 s99, 0
L_CND_l_29:
    s_waitcnt vmcnt(0)
    v_max_u32 v3, v88, v89
    v_cmp_eq_u32 vcc, -1, v3
    s_add_u32 s99, s99, 1
    s_cbranch_vccz L_CND_ok_30
    s_cmp_ge_u32 s99, 200000
    s_cbranch_scc1 L_CND_ok_30
    s_mov_b64 exec, vcc
    s_sleep 1
    buffer_load_dword v88, v53, s[8:11], s73 offen sc0 sc1
    buffer_load_dword v89, v53, s[8:11], s73 offen offset:1024 sc0 sc1
    s_branch L_CND_l_29
L_CND_ok_30:
    s_mov_b64 exec, -1
    v_and_b32 v51, 1, v52
    v_cmp_eq_u32 vcc, 0, v51
    v_lshlrev_b32 v91, 16, v88
    v_and_b32 v88, 0xffff0000, v88
    v_cndmask_b32 v88, v88, v91, vcc
    v_lshlrev_b32 v91, 16, v89
    v_and_b32 v89, 0xffff0000, v89
    v_cndmask_b32 v89, v89, v91, vcc
    v_and_b32 v50, 15, v2
    v_cmp_eq_u32 vcc, 0, v50
    v_lshrrev_b32 v51, 1, v0
    v_mov_b32 v50, 1024
    v_cndmask_b32 v51, v50, v51, vcc
    v_and_b32 v50, 7, v2
    v_lshlrev_b32 v50, 2, v50
    v_cmp_gt_u32 vcc, 8, v2
    v_lshlrev_b32 v52, 1, v52
    v_mov_b32 v53, 2147479552
    v_cndmask_b32 v52, v53, v52, vcc
    s_cmp_lt_u32 s66, 224
    s_cbranch_scc1 L_asl
    s_sleep 16
L_asl:
    s_sleep 7
    buffer_load_dwordx4 v[80:83], v4, s[8:11], s100 offen sc0 sc1
    buffer_load_dwordx4 v[84:87], v4, s[8:11], s100 offen offset:16 sc0 sc1
    s_mov_b32 s99, 0
L_ACT_l_31:
    s_waitcnt vmcnt(0)
    v_max_u32 v3, v80, v81
    v_max3_u32 v3, v3, v82, v83
    v_max3_u32 v3, v3, v84, v85
    v_max3_u32 v3, v3, v86, v87
    v_cmp_eq_u32 vcc, -1, v3
    s_add_u32 s99, s99, 1
    s_cbranch_vccz L_ACT_ok_32
    s_cmp_ge_u32 s99, 200000
    s_cbranch_scc1 L_ACT_ok_32
    s_mov_b64 exec, vcc
    s_sleep 2
    buffer_load_dwordx4 v[80:83], v4, s[8:11], s100 offen sc0 sc1
    buffer_load_dwordx4 v[84:87], v4, s[8:11], s100 offen offset:16 sc0 sc1
    s_branch L_ACT_l_31
L_ACT_ok_32:
    s_mov_b64 exec, -1
    v_pk_mul_f32 v[64:65], v[192:193], v[80:81] op_sel_hi:[1,0]
    v_pk_mul_f32 v[66:67], v[194:195], v[80:81] op_sel_hi:[1,0]
    v_pk_mul_f32 v[68:69], v[196:197], v[80:81] op_sel_hi:[1,0]
    v_pk_mul_f32 v[70:71], v[198:199], v[80:81] op_sel_hi:[1,0]
    v_pk_fma_f32 v[64:65], v[200:201], v[80:81], v[64:65] op_sel:[0,1,0] op_sel_hi:[1,1,1]
    v_pk_fma_f32 v[66:67], v[202:203], v[80:81], v[66:67] op_sel:[0,1,0] op_sel_hi:[1,1,1]
    v_pk_fma_f32 v[68:69], v[204:205], v[80:81], v[68:69] op_sel:[0,1,0] op_sel_hi:[1,1,1]
    v_pk_fma_f32 v[70:71], v[206:207], v[80:81], v[70:71] op_sel:[0,1,0] op_sel_hi:[1,1,1]
    v_pk_fma_f32 v[64:65], v[208:209], v[82:83], v[64:65] op_sel:[0,0,0] op_sel_hi:[1,0,1]
    v_pk_fma_f32 v[66:67], v[210:211], v[82:83], v[66:67] op_sel:[0,0,0] op_sel_hi:[1,0,1]
    v_pk_fma_f32 v[68:69], v[212:213], v[82:83], v[68:69] op_sel:[0,0,0] op_sel_hi:[1,0,1]
    v_pk_fma_f32 v[70:71], v[214:215], v[82:83], v[70:71] op_sel:[0,0,0] op_sel_hi:[1,0,1]
    v_pk_fma_f32 v[64:65], v[216:217], v[82:83], v[64:65] op_sel:[0,1,0] op_sel_hi:[1,1,1]
    v_pk_fma_f32 v[66:67], v[218:219], v[82:83], v[66:67] op_sel:[0,1,0] op_sel_hi:[1,1,1]
    v_pk_fma_f32 v[68:69], v[220:221], v[82:83], v[68:69] op_sel:[0,1,0] op_sel_hi:[1,1,1]
    v_pk_fma_f32 v[70:71], v[222:223], v[82:83], v[70:71] op_sel:[0,1,0] op_sel_hi:[1,1,1]
    v_pk_fma_f32 v[64:65], v[224:225], v[84:85], v[64:65] op_sel:[0,0,0] op_sel_hi:[1,0,1]
    v_pk_fma_f32 v[66:67], v[226:227], v[84:85], v[66:67] op_sel:[0,0,0] op_sel_hi:[1,0,1]
    v_pk_fma_f32 v[68:69], v[228:229], v[84:85], v[68:69] op_sel:[0,0,0] op_sel_hi:[1,0,1]
    v_pk_fma_f32 v[70:71], v[230:231], v[84:85], v[70:71] op_sel:[0,0,0] op_sel_hi:[1,0,1]
    v_pk_fma_f32 v[64:65], v[232:233], v[84:85], v[64:65] op_sel:[0,1,0] op_sel_hi:[1,1,1]
    v_pk_fma_f32 v[66:67], v[234:235], v[84:85], v[66:67] op_sel:[0,1,0] op_sel_hi:[1,1,1]
    v_pk_fma_f32 v[68:69], v[236:237], v[84:85], v[68:69] op_sel:[0,1,0] op_sel_hi:[1,1,1]
    v_pk_fma_f32 v[70:71], v[238:239], v[84:85], v[70:71] op_sel:[0,1,0] op_sel_hi:[1,1,1]
    v_pk_fma_f32 v[64:65], v[240:241], v[86:87], v[64:65] op_sel:[0,0,0] op_sel_hi:[1,0,1]
    v_pk_fma_f32 v[66:67], v[242:243], v[86:87], v[66:67] op_sel:[0,0,0] op_sel_hi:[1,0,1]
    v_pk_fma_f32 v[68:69], v[244:245], v[86:87], v[68:69] op_sel:[0,0,0] op_sel_hi:[1,0,1]
    v_pk_fma_f32 v[70:71], v[246:247], v[86:87], v[70:71] op_sel:[0,0,0] op_sel_hi:[1,0,1]
    v_pk_fma_f32 v[64:65], v[248:249], v[86:87], v[64:65] op_sel:[0,1,0] op_sel_hi:[1,1,1]
    v_pk_fma_f32 v[66:67], v[250:251], v[86:87], v[66:67] op_sel:[0,1,0] op_sel_hi:[1,1,1]
    v_pk_fma_f32 v[68:69], v[252:253], v[86:87], v[68:69] op_sel:[0,1,0] op_sel_hi:[1,1,1]
    v_pk_fma_f32 v[70:71], v[254:255], v[86:87], v[70:71] op_sel:[0,1,0] op_sel_hi:[1,1,1]
    s_nop 0
    v_permlane32_swap_b32 v64, v68
    v_permlane32_swap_b32 v65, v69
    v_permlane32_swap_b32 v66, v70
    v_permlane32_swap_b32 v67, v71
    v_add_f32 v64, v64, v68
    v_add_f32 v65, v65, v69
    v_add_f32 v66, v66, v70
    v_add_f32 v67, v67, v71
    s_nop 0
    v_permlane16_swap_b32 v64, v66
    v_permlane16_swap_b32 v65, v67
    v_add_f32 v64, v64, v66
    v_add_f32 v65, v65, v67
    s_nop 0
    v_add_f32_dpp v64, v64, v64 quad_perm:[1,0,3,2] row_mask:0xf bank_mask:0xf
    v_add_f32_dpp v65, v65, v65 quad_perm:[1,0,3,2] row_mask:0xf bank_mask:0xf
    s_nop 0
    v_add_f32_dpp v64, v64, v64 quad_perm:[2,3,0,1] row_mask:0xf bank_mask:0xf
    v_add_f32_dpp v65, v65, v65 quad_perm:[2,3,0,1] row_mask:0xf bank_mask:0xf
    s_nop 0
    v_add_f32_dpp v64, v64, v64 row_half_mirror row_mask:0xf bank_mask:0xf
    v_add_f32_dpp v65, v65, v65 row_half_mirror row_mask:0xf bank_mask:0xf
    s_nop 0
    v_add_f32_dpp v64, v64, v64 row_mirror row_mask:0xf bank_mask:0xf
    v_add_f32_dpp v65, v65, v65 row_mirror row_mask:0xf bank_mask:0xf
    ds_write_b64 v51, v[64:65] offset:2048
    s_waitcnt lgkmcnt(0)
    s_barrier
    s_cmp_lg_u32 s3, 0
    s_cbranch_scc1 L_fin
    ds_read_b32 v64, v50 offset:2048
    ds_read_b32 v65, v50 offset:2080
    ds_read_b32 v66, v50 offset:2112
    ds_read_b32 v67, v50 offset:2144
    s_lshl_b32 s100, s72, 10
    s_waitcnt lgkmcnt(2)
    v_add_f32 v64, v64, v65
    s_waitcnt lgkmcnt(0)
    v_add_f32 v66, v66, v67
    v_add_f32 v64, v64, v66
    v_cvt_pk_bf16_f32 v64, v64, v64
    v_and_b32 v64, 0xffff0000, v64
    v_mul_f32 v64, v64, v90
    v_cvt_pk_bf16_f32 v64, v64, v64
    v_and_b32 v64, 0xffff0000, v64
    v_add_f32 v64, v64, v88
    v_cvt_pk_bf16_f32 v64, v64, v64
    v_and_b32 v64, 0xffff0000, v64
    v_mul_f32 v64, v64, v55
    v_cvt_pk_bf16_f32 v64, v64, v64
    v_and_b32 v64, 0xffff0000, v64
    v_add_f32 v64, v64, v89
    v_cvt_pk_bf16_f32 v64, v64, v64
    buffer_store_short v64, v52, s[52:55], s100 offen
L_fin:
L_end:
    s_endpgm
L_E_slow_1:
    s_mov_b32 s99, 0
L_E_slow_1_l:
    s_sleep 20
    buffer_load_dword v3, v4, s[36:39], s67 offen sc0 sc1
    s_add_u32 s99, s99, 1
    s_waitcnt vmcnt(0)
    v_cmp_le_u32 vcc, s68, v3
    s_cmp_eq_u64 vcc, -1
    s_cbranch_scc1 L_E_ok_2
    s_cmp_lt_u32 s99, 200000
    s_cbranch_scc1 L_E_slow_1_l
    s_branch L_E_ok_2
L_H_slow_3:
    s_mov_b32 s99, 0
L_H_slow_3_l:
    s_sleep 4
    buffer_load_dword v3, v16, s[8:11], s78 offen sc0 sc1
    s_add_u32 s99, s99, 1
    s_waitcnt vmcnt(0)
    v_cmp_ne_u32 vcc, 0, v3
    s_cmp_eq_u64 vcc, -1
    s_cbranch_scc1 L_H_ok_4
    s_cmp_lt_u32 s99, 200000
    s_cbranch_scc1 L_H_slow_3_l
    s_branch L_H_ok_4
L_E2_slow_5:
    s_mov_b32 s99, 0
L_E2_slow_5_l:
    s_sleep 4
    buffer_load_dword v118, v119, s[8:11], s69 offen sc0 sc1
    s_add_u32 s99, s99, 1
    s_waitcnt vmcnt(0)
    v_cmp_ne_u32 vcc, 0, v118
    s_cmp_eq_u64 vcc, -1
    s_cbranch_scc1 L_E2_ok_6
    s_cmp_lt_u32 s99, 200000
    s_cbranch_scc1 L_E2_slow_5_l
    s_branch L_E2_ok_6
L_KV_slow_7:
    s_mov_b32 s99, 0
L_KV_slow_7_l:
    s_sleep 4
    buffer_load_dword v3, v17, s[8:11], s74 offen sc0 sc1
    s_add_u32 s99, s99, 1
    s_waitcnt vmcnt(0)
    v_cmp_ne_u32 vcc, 0, v3
    s_cmp_eq_u64 vcc, -1
    s_cbranch_scc1 L_KV_ok_8
    s_cmp_lt_u32 s99, 200000
    s_cbranch_scc1 L_KV_slow_7_l
    s_branch L_KV_ok_8
L_t1_start:
    v_mfma_f32_16x16x32_bf16 v[96:99], a[128:131], a[64:67], v[96:99]
    s_add_u32 s19, s82, 32768
    s_sub_u32 s82, s12, s13
    s_sub_u32 s82, s82, 1
    v_mfma_f32_16x16x32_bf16 v[96:99], a[132:135], a[68:71], v[96:99]
    s_cmp_gt_u32 s12, s13
    s_cselect_b32 s82, s82, s12
    s_mul_i32 s82, s82, 65536
    s_add_u32 s82, s82, s81
    v_mfma_f32_16x16x32_bf16 v[96:99], a[136:139], a[72:75], v[96:99]
    s_cmp_ge_u32 s12, 17
    s_cselect_b32 s82, 2147471360, s82
    s_add_u32 s12, s12, 1
    s_sub_u32 s14, s60, 1
    v_mfma_f32_16x16x32_bf16 v[96:99], a[140:143], a[76:79], v[96:99]
    v_mfma_f32_16x16x32_bf16 v[100:103], a[144:147], a[64:67], v[100:103]
    v_mfma_f32_16x16x32_bf16 v[100:103], a[148:151], a[68:71], v[100:103]
    v_mfma_f32_16x16x32_bf16 v[100:103], a[152:155], a[72:75], v[100:103]
    v_mfma_f32_16x16x32_bf16 v[100:103], a[156:159], a[76:79], v[100:103]
    v_mfma_f32_16x16x32_bf16 v[104:107], a[128:131], a[80:83], v[104:107]
    s_nop 2
    v_exp_f32 v96, v96
    v_mfma_f32_16x16x32_bf16 v[104:107], a[132:135], a[84:87], v[104:107]
    v_exp_f32 v97, v97
    v_mfma_f32_16x16x32_bf16 v[104:107], a[136:139], a[88:91], v[104:107]
    v_exp_f32 v98, v98
    v_mfma_f32_16x16x32_bf16 v[104:107], a[140:143], a[92:95], v[104:107]
    v_exp_f32 v99, v99
    v_mfma_f32_16x16x32_bf16 v[108:111], a[144:147], a[80:83], v[108:111]
    v_exp_f32 v100, v100
    v_mfma_f32_16x16x32_bf16 v[108:111], a[148:151], a[84:87], v[108:111]
    v_exp_f32 v101, v101
    v_mfma_f32_16x16x32_bf16 v[108:111], a[152:155], a[88:91], v[108:111]
    v_exp_f32 v102, v102
    v_mfma_f32_16x16x32_bf16 v[108:111], a[156:159], a[92:95], v[108:111]
    v_exp_f32 v103, v103
    v_mfma_f32_16x16x32_bf16 v[112:115], a[128:131], a[96:99], v[72:75]
    v_exp_f32 v104, v104
    v_mfma_f32_16x16x32_bf16 v[112:115], a[132:135], a[100:103], v[112:115]
    v_exp_f32 v105, v105
    v_mfma_f32_16x16x32_bf16 v[112:115], a[136:139], a[104:107], v[112:115]
    v_exp_f32 v106, v106
    v_mfma_f32_16x16x32_bf16 v[112:115], a[140:143], a[108:111], v[112:115]
    v_exp_f32 v107, v107
    v_mfma_f32_16x16x32_bf16 v[120:123], a[128:131], a[112:115], v[76:79]
    v_exp_f32 v108, v108
    v_mfma_f32_16x16x32_bf16 v[120:123], a[132:135], a[116:119], v[120:123]
    v_exp_f32 v109, v109
    v_mfma_f32_16x16x32_bf16 v[120:123], a[136:139], a[120:123], v[120:123]
    v_exp_f32 v110, v110
    v_mfma_f32_16x16x32_bf16 v[120:123], a[140:143], a[124:127], v[120:123]
    v_exp_f32 v111, v111
    v_mfma_f32_16x16x32_bf16 v[116:119], a[144:147], a[96:99], v[72:75]
    ds_read_b128 a[128:131], v18 offset:16384
    v_cvt_pk_bf16_f32 v48, v96, v97
    v_mfma_f32_16x16x32_bf16 v[116:119], a[148:151], a[100:103], v[116:119]
    ds_read_b128 a[132:135], v18 offset:17408
    v_cvt_pk_bf16_f32 v49, v98, v99
    v_mfma_f32_16x16x32_bf16 v[116:119], a[152:155], a[104:107], v[116:119]
    ds_read_b128 a[136:139], v18 offset:18432
    v_cvt_pk_bf16_f32 v50, v100, v101
    v_mfma_f32_16x16x32_bf16 v[116:119], a[156:159], a[108:111], v[116:119]
    ds_read_b128 a[140:143], v18 offset:19456
    v_cvt_pk_bf16_f32 v51, v102, v103
    v_mfma_f32_16x16x32_bf16 v[124:127], a[144:147], a[112:115], v[76:79]
    ds_read_b128 a[144:147], v18 offset:20480
    v_cvt_pk_bf16_f32 v52, v104, v105
    v_mfma_f32_16x16x32_bf16 v[124:127], a[148:151], a[116:119], v[124:127]
    ds_read_b128 a[148:151], v18 offset:21504
    v_cvt_pk_bf16_f32 v53, v106, v107
    v_mfma_f32_16x16x32_bf16 v[124:127], a[152:155], a[120:123], v[124:127]
    ds_read_b128 a[152:155], v18 offset:22528
    v_cvt_pk_bf16_f32 v54, v108, v109
    v_mfma_f32_16x16x32_bf16 v[124:127], a[156:159], a[124:127], v[124:127]
    ds_read_b128 a[156:159], v18 offset:23552
    v_cvt_pk_bf16_f32 v55, v110, v111
    v_xor_b32 v18, 196608, v18
    s_branch L_t1_p1
L_t1_zero:
    v_mfma_f32_16x16x32_bf16 v[96:99], a[128:131], a[96:99], v[80:83]
    s_xor_b32 s100, s16, 8192
    ds_read_b128 a[176:179], v20 offset:4096
    v_lshrrev_b32 v13, 1, v1
    v_mfma_f32_16x16x32_bf16 v[96:99], a[132:135], a[100:103], v[96:99]
    s_add_u32 m0, s15, 0
    ds_read_b128 a[180:183], v20 offset:5120
    v_add_u32 v12, s100, v13
    v_mfma_f32_16x16x32_bf16 v[96:99], a[136:139], a[104:107], v[96:99]
    buffer_load_dwordx4 v1, s[8:11], s82 offen offset:0  lds
    v_exp_f32 v112, v112
    v_mfma_f32_16x16x32_bf16 v[96:99], a[140:143], a[108:111], v[96:99]
    v_exp_f32 v113, v113
    v_mfma_f32_16x16x32_bf16 v[100:103], a[144:147], a[96:99], v[84:87]
    ds_read_b128 a[184:187], v20 offset:6144
    v_cvt_pk_bf16_f32 v56, v112, v113
    v_mfma_f32_16x16x32_bf16 v[100:103], a[148:151], a[100:103], v[100:103]
    v_exp_f32 v114, v114
    v_mfma_f32_16x16x32_bf16 v[100:103], a[152:155], a[104:107], v[100:103]
    buffer_load_dwordx4 v1, s[8:11], s82 offen offset:1024  lds
    v_exp_f32 v115, v115
    v_mfma_f32_16x16x32_bf16 v[100:103], a[156:159], a[108:111], v[100:103]
    ds_read_b128 a[188:191], v20 offset:7168
    v_cvt_pk_bf16_f32 v57, v114, v115
    v_mfma_f32_16x16x32_bf16 v[104:107], a[128:131], a[112:115], v[88:91]
    v_exp_f32 v116, v116
    v_mfma_f32_16x16x32_bf16 v[104:107], a[132:135], a[116:119], v[104:107]
    v_exp_f32 v117, v117
    v_mfma_f32_16x16x32_bf16 v[104:107], a[136:139], a[120:123], v[104:107]
    ds_read_b128 a[160:163], v19 offset:0
    v_cvt_pk_bf16_f32 v58, v116, v117
    v_mfma_f32_16x16x32_bf16 v[104:107], a[140:143], a[124:127], v[104:107]
    buffer_load_dwordx4 v1, s[8:11], s82 offen offset:2048  lds
    v_exp_f32 v118, v118
    v_mfma_f32_16x16x32_bf16 v[108:111], a[144:147], a[112:115], v[92:95]
    v_exp_f32 v119, v119
    v_mfma_f32_16x16x32_bf16 v[108:111], a[148:151], a[116:119], v[108:111]
    ds_read_b128 a[164:167], v19 offset:1024
    v_cvt_pk_bf16_f32 v59, v118, v119
    v_mfma_f32_16x16x32_bf16 v[108:111], a[152:155], a[120:123], v[108:111]
    v_exp_f32 v120, v120
    v_mfma_f32_16x16x32_bf16 v[108:111], a[156:159], a[124:127], v[108:111]
    buffer_load_dwordx4 v1, s[8:11], s82 offen offset:3072  lds
    v_exp_f32 v121, v121
    v_mfma_f32_16x16x32_bf16 v[32:35], v[28:31], v[48:51], 0
    s_add_u32 m0, s15, 4096
    ds_read_b128 a[168:171], v19 offset:2048
    v_cvt_pk_bf16_f32 v60, v120, v121
    v_mfma_f32_16x16x32_bf16 v[36:39], v[28:31], v[52:55], 0
    s_waitcnt lgkmcnt(6)
    v_exp_f32 v122, v122
    v_mfma_f32_16x16x32_bf16 v[144:147], a[176:179], v[48:51], 0
    v_exp_f32 v123, v123
    v_mfma_f32_16x16x32_bf16 v[176:179], a[176:179], v[52:55], 0
    s_waitcnt lgkmcnt(5)
    ds_read_b128 a[172:175], v19 offset:3072
    v_cvt_pk_bf16_f32 v61, v122, v123
    v_mfma_f32_16x16x32_bf16 v[148:151], a[180:183], v[48:51], 0
    buffer_load_dwordx4 v15, s[8:11], s82 offen offset:0  lds
    v_exp_f32 v124, v124
    v_mfma_f32_16x16x32_bf16 v[180:183], a[180:183], v[52:55], 0
    s_waitcnt lgkmcnt(5)
    v_exp_f32 v125, v125
    v_mfma_f32_16x16x32_bf16 v[152:155], a[184:187], v[48:51], 0
    s_waitcnt lgkmcnt(4)
    v_exp_f32 v126, v126
    v_mfma_f32_16x16x32_bf16 v[184:187], a[184:187], v[52:55], 0
    buffer_load_dwordx4 v15, s[8:11], s82 offen offset:1024  lds
    v_exp_f32 v127, v127
    v_mfma_f32_16x16x32_bf16 v[156:159], a[188:191], v[48:51], 0
    ds_write_b128 v16, v[144:147] offset:32768
    v_cvt_pk_bf16_f32 v62, v124, v125
    v_mfma_f32_16x16x32_bf16 v[188:191], a[188:191], v[52:55], 0
    s_waitcnt lgkmcnt(4)
    v_exp_f32 v96, v96
    v_mfma_f32_16x16x32_bf16 v[128:131], a[160:163], v[48:51], 0
    v_exp_f32 v97, v97
    v_mfma_f32_16x16x32_bf16 v[160:163], a[160:163], v[52:55], 0
    s_waitcnt lgkmcnt(3)
    ds_write_b128 v16, v[176:179] offset:33792
    v_cvt_pk_bf16_f32 v63, v126, v127
    v_mfma_f32_16x16x32_bf16 v[132:135], a[164:167], v[48:51], 0
    s_waitcnt lgkmcnt(3)
    v_exp_f32 v98, v98
    v_mfma_f32_16x16x32_bf16 v[164:167], a[164:167], v[52:55], 0
    buffer_load_dwordx4 v15, s[8:11], s82 offen offset:2048  lds
    v_exp_f32 v99, v99
    v_mfma_f32_16x16x32_bf16 v[136:139], a[168:171], v[48:51], 0
    ds_write_b128 v16, v[148:151] offset:34816
    v_mfma_f32_16x16x32_bf16 v[168:171], a[168:171], v[52:55], 0
    s_waitcnt lgkmcnt(3)
    v_exp_f32 v100, v100
    v_mfma_f32_16x16x32_bf16 v[140:143], a[172:175], v[48:51], 0
    v_exp_f32 v101, v101
    v_mfma_f32_16x16x32_bf16 v[172:175], a[172:175], v[52:55], 0
    ds_write_b128 v16, v[180:183] offset:35840
    v_mov_b32 v33, v36
    v_mfma_f32_16x16x32_bf16 v[40:43], v[28:31], v[56:59], 0
    buffer_load_dwordx4 v15, s[8:11], s82 offen offset:3072  lds
    v_exp_f32 v102, v102
    v_mfma_f32_16x16x32_bf16 v[44:47], v[28:31], v[60:63], 0
    s_xor_b32 s15, s15, 196608
    v_exp_f32 v103, v103
    v_mfma_f32_16x16x32_bf16 v[208:211], a[176:179], v[56:59], 0
    ds_write_b128 v16, v[152:155] offset:36864
    v_cvt_pk_bf16_f32 v48, v96, v97
    v_mfma_f32_16x16x32_bf16 v[240:243], a[176:179], v[60:63], 0
    ds_read_b128 a[176:179], v20 offset:20480
    v_exp_f32 v104, v104
    v_mfma_f32_16x16x32_bf16 v[212:215], a[180:183], v[56:59], 0
    v_exp_f32 v105, v105
    v_mfma_f32_16x16x32_bf16 v[244:247], a[180:183], v[60:63], 0
    ds_read_b128 a[180:183], v20 offset:21504
    v_exp_f32 v106, v106
    v_mfma_f32_16x16x32_bf16 v[216:219], a[184:187], v[56:59], 0
    ds_write_b128 v16, v[184:187] offset:37888
    v_cvt_pk_bf16_f32 v49, v98, v99
    v_mfma_f32_16x16x32_bf16 v[248:251], a[184:187], v[60:63], 0
    ds_read_b128 a[184:187], v20 offset:22528
    v_exp_f32 v107, v107
    v_mfma_f32_16x16x32_bf16 v[220:223], a[188:191], v[56:59], 0
    v_exp_f32 v108, v108
    v_mfma_f32_16x16x32_bf16 v[252:255], a[188:191], v[60:63], 0
    ds_read_b128 a[188:191], v20 offset:23552
    v_exp_f32 v109, v109
    v_mfma_f32_16x16x32_bf16 v[192:195], a[160:163], v[56:59], 0
    ds_write_b128 v16, v[156:159] offset:38912
    v_cvt_pk_bf16_f32 v50, v100, v101
    v_mfma_f32_16x16x32_bf16 v[224:227], a[160:163], v[60:63], 0
    ds_read_b128 a[160:163], v19 offset:16384
    v_exp_f32 v110, v110
    v_mfma_f32_16x16x32_bf16 v[196:199], a[164:167], v[56:59], 0
    v_exp_f32 v111, v111
    v_mfma_f32_16x16x32_bf16 v[228:231], a[164:167], v[60:63], 0
    ds_read_b128 a[164:167], v19 offset:17408
    v_cvt_pk_bf16_f32 v51, v102, v103
    v_mfma_f32_16x16x32_bf16 v[200:203], a[168:171], v[56:59], 0
    ds_write_b128 v16, v[188:191] offset:39936
    v_cvt_pk_bf16_f32 v52, v104, v105
    v_mfma_f32_16x16x32_bf16 v[232:235], a[168:171], v[60:63], 0
    ds_read_b128 a[168:171], v19 offset:18432
    v_cvt_pk_bf16_f32 v53, v106, v107
    v_mfma_f32_16x16x32_bf16 v[204:207], a[172:175], v[56:59], 0
    v_cvt_pk_bf16_f32 v54, v108, v109
    v_cvt_pk_bf16_f32 v55, v110, v111
    v_mfma_f32_16x16x32_bf16 v[236:239], a[172:175], v[60:63], 0
    ds_read_b128 a[172:175], v19 offset:19456
    ds_write_b64 v12, v[32:33]
    s_xor_b32 s101, s16, 98304
    v_xor_b32 v12, 8192, v12
    v_add_u32 v9, s101, v1
    v_xor_b32 v8, 8192, v16
    v_xor_b32 v10, 8192, v9
    s_branch L_t1_join
L_t1_redo:
    s_cmp_eq_u32 s25, 0
    s_cbranch_scc1 L_t1_max
    s_mov_b32 s25, 0
    v_mov_b32 v64, 0
    v_mov_b32 v65, 0
    v_mov_b32 v66, 0
    v_mov_b32 v67, 0
    v_mov_b32 v68, 0
    v_mov_b32 v69, 0
    v_mov_b32 v70, 0
    v_mov_b32 v71, 0
    v_mov_b32 v72, 0
    v_mov_b32 v73, 0
    v_mov_b32 v74, 0
    v_mov_b32 v75, 0
    v_mov_b32 v76, 0
    v_mov_b32 v77, 0
    v_mov_b32 v78, 0
    v_mov_b32 v79, 0
    s_nop 1
    s_branch L_t1_safe
L_t1_max:
    s_waitcnt vmcnt(0) lgkmcnt(0)
    s_barrier
    s_mov_b32 s25, 1
    s_and_b32 s100, s3, 1
    s_lshl_b32 s100, s100, 13
    s_sub_u32 s101, s81, s62
    s_add_u32 s101, s101, s100
    s_mov_b32 s14, s60
    v_mov_b32 v48, 0xff800000
    v_mov_b32 v49, 0xff800000
    v_mov_b32 v50, 0xff800000
    v_mov_b32 v51, 0xff800000
L_t1_maxl:
    s_cmp_eq_u32 s14, 0
    s_cbranch_scc1 L_t1_maxd
    s_add_u32 s100, s101, 0
    buffer_load_dwordx4 a[128:131], v1, s[8:11], s100 offen offset:0
    buffer_load_dwordx4 a[132:135], v1, s[8:11], s100 offen offset:1024
    buffer_load_dwordx4 a[136:139], v1, s[8:11], s100 offen offset:2048
    buffer_load_dwordx4 a[140:143], v1, s[8:11], s100 offen offset:3072
    buffer_load_dwordx4 a[144:147], v15, s[8:11], s100 offen offset:0
    buffer_load_dwordx4 a[148:151], v15, s[8:11], s100 offen offset:1024
    buffer_load_dwordx4 a[152:155], v15, s[8:11], s100 offen offset:2048
    buffer_load_dwordx4 a[156:159], v15, s[8:11], s100 offen offset:3072
    s_waitcnt vmcnt(7)
    v_mfma_f32_16x16x32_bf16 v[96:99], a[128:131], a[64:67], v[64:67]
    s_waitcnt vmcnt(6)
    v_mfma_f32_16x16x32_bf16 v[96:99], a[132:135], a[68:71], v[96:99]
    s_waitcnt vmcnt(5)
    v_mfma_f32_16x16x32_bf16 v[96:99], a[136:139], a[72:75], v[96:99]
    s_waitcnt vmcnt(4)
    v_mfma_f32_16x16x32_bf16 v[96:99], a[140:143], a[76:79], v[96:99]
    v_mfma_f32_16x16x32_bf16 v[104:107], a[128:131], a[80:83], v[68:71]
    v_mfma_f32_16x16x32_bf16 v[104:107], a[132:135], a[84:87], v[104:107]
    v_mfma_f32_16x16x32_bf16 v[104:107], a[136:139], a[88:91], v[104:107]
    v_mfma_f32_16x16x32_bf16 v[104:107], a[140:143], a[92:95], v[104:107]
    s_waitcnt vmcnt(3)
    v_mfma_f32_16x16x32_bf16 v[100:103], a[144:147], a[64:67], v[64:67]
    s_waitcnt vmcnt(2)
    v_mfma_f32_16x16x32_bf16 v[100:103], a[148:151], a[68:71], v[100:103]
    s_waitcnt vmcnt(1)
    v_mfma_f32_16x16x32_bf16 v[100:103], a[152:155], a[72:75], v[100:103]
    s_waitcnt vmcnt(0)
    v_mfma_f32_16x16x32_bf16 v[100:103], a[156:159], a[76:79], v[100:103]
    v_mfma_f32_16x16x32_bf16 v[108:111], a[144:147], a[80:83], v[68:71]
    v_mfma_f32_16x16x32_bf16 v[108:111], a[148:151], a[84:87], v[108:111]
    v_mfma_f32_16x16x32_bf16 v[108:111], a[152:155], a[88:91], v[108:111]
    v_mfma_f32_16x16x32_bf16 v[108:111], a[156:159], a[92:95], v[108:111]
    v_mfma_f32_16x16x32_bf16 v[112:115], a[128:131], a[96:99], v[72:75]
    v_mfma_f32_16x16x32_bf16 v[112:115], a[132:135], a[100:103], v[112:115]
    v_mfma_f32_16x16x32_bf16 v[112:115], a[136:139], a[104:107], v[112:115]
    v_mfma_f32_16x16x32_bf16 v[112:115], a[140:143], a[108:111], v[112:115]
    v_mfma_f32_16x16x32_bf16 v[120:123], a[128:131], a[112:115], v[76:79]
    v_mfma_f32_16x16x32_bf16 v[120:123], a[132:135], a[116:119], v[120:123]
    v_mfma_f32_16x16x32_bf16 v[120:123], a[136:139], a[120:123], v[120:123]
    v_mfma_f32_16x16x32_bf16 v[120:123], a[140:143], a[124:127], v[120:123]
    v_mfma_f32_16x16x32_bf16 v[116:119], a[144:147], a[96:99], v[72:75]
    v_mfma_f32_16x16x32_bf16 v[116:119], a[148:151], a[100:103], v[116:119]
    v_mfma_f32_16x16x32_bf16 v[116:119], a[152:155], a[104:107], v[116:119]
    v_mfma_f32_16x16x32_bf16 v[116:119], a[156:159], a[108:111], v[116:119]
    v_mfma_f32_16x16x32_bf16 v[124:127], a[144:147], a[112:115], v[76:79]
    v_mfma_f32_16x16x32_bf16 v[124:127], a[148:151], a[116:119], v[124:127]
    v_mfma_f32_16x16x32_bf16 v[124:127], a[152:155], a[120:123], v[124:127]
    v_mfma_f32_16x16x32_bf16 v[124:127], a[156:159], a[124:127], v[124:127]
    v_max3_f32 v48, v48, v96, v97
    v_max3_f32 v48, v48, v98, v99
    v_max3_f32 v48, v48, v100, v101
    v_max3_f32 v48, v48, v102, v103
    v_max3_f32 v49, v49, v104, v105
    v_max3_f32 v49, v49, v106, v107
    v_max3_f32 v49, v49, v108, v109
    v_max3_f32 v49, v49, v110, v111
    v_max3_f32 v50, v50, v112, v113
    v_max3_f32 v50, v50, v114, v115
    v_max3_f32 v50, v50, v116, v117
    v_max3_f32 v50, v50, v118, v119
    v_max3_f32 v51, v51, v120, v121
    v_max3_f32 v51, v51, v122, v123
    v_max3_f32 v51, v51, v124, v125
    v_max3_f32 v51, v51, v126, v127
    s_add_u32 s100, s101, 16384
    buffer_load_dwordx4 a[128:131], v1, s[8:11], s100 offen offset:0
    buffer_load_dwordx4 a[132:135], v1, s[8:11], s100 offen offset:1024
    buffer_load_dwordx4 a[136:139], v1, s[8:11], s100 offen offset:2048
    buffer_load_dwordx4 a[140:143], v1, s[8:11], s100 offen offset:3072
    buffer_load_dwordx4 a[144:147], v15, s[8:11], s100 offen offset:0
    buffer_load_dwordx4 a[148:151], v15, s[8:11], s100 offen offset:1024
    buffer_load_dwordx4 a[152:155], v15, s[8:11], s100 offen offset:2048
    buffer_load_dwordx4 a[156:159], v15, s[8:11], s100 offen offset:3072
    s_waitcnt vmcnt(7)
    v_mfma_f32_16x16x32_bf16 v[96:99], a[128:131], a[64:67], v[64:67]
    s_waitcnt vmcnt(6)
    v_mfma_f32_16x16x32_bf16 v[96:99], a[132:135], a[68:71], v[96:99]
    s_waitcnt vmcnt(5)
    v_mfma_f32_16x16x32_bf16 v[96:99], a[136:139], a[72:75], v[96:99]
    s_waitcnt vmcnt(4)
    v_mfma_f32_16x16x32_bf16 v[96:99], a[140:143], a[76:79], v[96:99]
    v_mfma_f32_16x16x32_bf16 v[104:107], a[128:131], a[80:83], v[68:71]
    v_mfma_f32_16x16x32_bf16 v[104:107], a[132:135], a[84:87], v[104:107]
    v_mfma_f32_16x16x32_bf16 v[104:107], a[136:139], a[88:91], v[104:107]
    v_mfma_f32_16x16x32_bf16 v[104:107], a[140:143], a[92:95], v[104:107]
    s_waitcnt vmcnt(3)
    v_mfma_f32_16x16x32_bf16 v[100:103], a[144:147], a[64:67], v[64:67]
    s_waitcnt vmcnt(2)
    v_mfma_f32_16x16x32_bf16 v[100:103], a[148:151], a[68:71], v[100:103]
    s_waitcnt vmcnt(1)
    v_mfma_f32_16x16x32_bf16 v[100:103], a[152:155], a[72:75], v[100:103]
    s_waitcnt vmcnt(0)
    v_mfma_f32_16x16x32_bf16 v[100:103], a[156:159], a[76:79], v[100:103]
    v_mfma_f32_16x16x32_bf16 v[108:111], a[144:147], a[80:83], v[68:71]
    v_mfma_f32_16x16x32_bf16 v[108:111], a[148:151], a[84:87], v[108:111]
    v_mfma_f32_16x16x32_bf16 v[108:111], a[152:155], a[88:91], v[108:111]
    v_mfma_f32_16x16x32_bf16 v[108:111], a[156:159], a[92:95], v[108:111]
    v_mfma_f32_16x16x32_bf16 v[112:115], a[128:131], a[96:99], v[72:75]
    v_mfma_f32_16x16x32_bf16 v[112:115], a[132:135], a[100:103], v[112:115]
    v_mfma_f32_16x16x32_bf16 v[112:115], a[136:139], a[104:107], v[112:115]
    v_mfma_f32_16x16x32_bf16 v[112:115], a[140:143], a[108:111], v[112:115]
    v_mfma_f32_16x16x32_bf16 v[120:123], a[128:131], a[112:115], v[76:79]
    v_mfma_f32_16x16x32_bf16 v[120:123], a[132:135], a[116:119], v[120:123]
    v_mfma_f32_16x16x32_bf16 v[120:123], a[136:139], a[120:123], v[120:123]
    v_mfma_f32_16x16x32_bf16 v[120:123], a[140:143], a[124:127], v[120:123]
    v_mfma_f32_16x16x32_bf16 v[116:119], a[144:147], a[96:99], v[72:75]
    v_mfma_f32_16x16x32_bf16 v[116:119], a[148:151], a[100:103], v[116:119]
    v_mfma_f32_16x16x32_bf16 v[116:119], a[152:155], a[104:107], v[116:119]
    v_mfma_f32_16x16x32_bf16 v[116:119], a[156:159], a[108:111], v[116:119]
    v_mfma_f32_16x16x32_bf16 v[124:127], a[144:147], a[112:115], v[76:79]
    v_mfma_f32_16x16x32_bf16 v[124:127], a[148:151], a[116:119], v[124:127]
    v_mfma_f32_16x16x32_bf16 v[124:127], a[152:155], a[120:123], v[124:127]
    v_mfma_f32_16x16x32_bf16 v[124:127], a[156:159], a[124:127], v[124:127]
    v_max3_f32 v48, v48, v96, v97
    v_max3_f32 v48, v48, v98, v99
    v_max3_f32 v48, v48, v100, v101
    v_max3_f32 v48, v48, v102, v103
    v_max3_f32 v49, v49, v104, v105
    v_max3_f32 v49, v49, v106, v107
    v_max3_f32 v49, v49, v108, v109
    v_max3_f32 v49, v49, v110, v111
    v_max3_f32 v50, v50, v112, v113
    v_max3_f32 v50, v50, v114, v115
    v_max3_f32 v50, v50, v116, v117
    v_max3_f32 v50, v50, v118, v119
    v_max3_f32 v51, v51, v120, v121
    v_max3_f32 v51, v51, v122, v123
    v_max3_f32 v51, v51, v124, v125
    v_max3_f32 v51, v51, v126, v127
    s_add_u32 s101, s101, 65536
    s_sub_u32 s14, s14, 1
    s_nop 7
    s_branch L_t1_maxl
L_t1_maxd:
    s_add_u32 s100, s101, 0
    buffer_load_dwordx4 a[128:131], v1, s[8:11], s100 offen offset:0
    buffer_load_dwordx4 a[132:135], v1, s[8:11], s100 offen offset:1024
    buffer_load_dwordx4 a[136:139], v1, s[8:11], s100 offen offset:2048
    buffer_load_dwordx4 a[140:143], v1, s[8:11], s100 offen offset:3072
    buffer_load_dwordx4 a[144:147], v15, s[8:11], s100 offen offset:0
    buffer_load_dwordx4 a[148:151], v15, s[8:11], s100 offen offset:1024
    buffer_load_dwordx4 a[152:155], v15, s[8:11], s100 offen offset:2048
    buffer_load_dwordx4 a[156:159], v15, s[8:11], s100 offen offset:3072
    v_add_f32 v80, 0, v21
    v_min_f32 v80, v80, v64
    v_add_f32 v81, 0xf1800000, v21
    v_min_f32 v81, v81, v65
    v_add_f32 v82, 0xf2000000, v21
    v_min_f32 v82, v82, v66
    v_add_f32 v83, 0xf2400000, v21
    v_min_f32 v83, v83, v67
    v_add_f32 v84, 0xf3800000, v21
    v_min_f32 v84, v84, v64
    v_add_f32 v85, 0xf3880000, v21
    v_min_f32 v85, v85, v65
    v_add_f32 v86, 0xf3900000, v21
    v_min_f32 v86, v86, v66
    v_add_f32 v87, 0xf3980000, v21
    v_min_f32 v87, v87, v67
    v_add_f32 v88, 0x73800000, v21
    v_min_f32 v88, v88, v68
    v_add_f32 v89, 0x73700000, v21
    v_min_f32 v89, v89, v69
    v_add_f32 v90, 0x73600000, v21
    v_min_f32 v90, v90, v70
    v_add_f32 v91, 0x73500000, v21
    v_min_f32 v91, v91, v71
    v_add_f32 v92, 0, v21
    v_min_f32 v92, v92, v68
    v_add_f32 v93, 0xf1800000, v21
    v_min_f32 v93, v93, v69
    v_add_f32 v94, 0xf2000000, v21
    v_min_f32 v94, v94, v70
    v_add_f32 v95, 0xf2400000, v21
    v_min_f32 v95, v95, v71
    s_waitcnt vmcnt(7)
    v_mfma_f32_16x16x32_bf16 v[96:99], a[128:131], a[64:67], v[80:83]
    s_waitcnt vmcnt(6)
    v_mfma_f32_16x16x32_bf16 v[96:99], a[132:135], a[68:71], v[96:99]
    s_waitcnt vmcnt(5)
    v_mfma_f32_16x16x32_bf16 v[96:99], a[136:139], a[72:75], v[96:99]
    s_waitcnt vmcnt(4)
    v_mfma_f32_16x16x32_bf16 v[96:99], a[140:143], a[76:79], v[96:99]
    v_mfma_f32_16x16x32_bf16 v[104:107], a[128:131], a[80:83], v[88:91]
    v_mfma_f32_16x16x32_bf16 v[104:107], a[132:135], a[84:87], v[104:107]
    v_mfma_f32_16x16x32_bf16 v[104:107], a[136:139], a[88:91], v[104:107]
    v_mfma_f32_16x16x32_bf16 v[104:107], a[140:143], a[92:95], v[104:107]
    s_waitcnt vmcnt(3)
    v_mfma_f32_16x16x32_bf16 v[100:103], a[144:147], a[64:67], v[84:87]
    s_waitcnt vmcnt(2)
    v_mfma_f32_16x16x32_bf16 v[100:103], a[148:151], a[68:71], v[100:103]
    s_waitcnt vmcnt(1)
    v_mfma_f32_16x16x32_bf16 v[100:103], a[152:155], a[72:75], v[100:103]
    s_waitcnt vmcnt(0)
    v_mfma_f32_16x16x32_bf16 v[100:103], a[156:159], a[76:79], v[100:103]
    v_mfma_f32_16x16x32_bf16 v[108:111], a[144:147], a[80:83], v[92:95]
    v_mfma_f32_16x16x32_bf16 v[108:111], a[148:151], a[84:87], v[108:111]
    v_mfma_f32_16x16x32_bf16 v[108:111], a[152:155], a[88:91], v[108:111]
    v_mfma_f32_16x16x32_bf16 v[108:111], a[156:159], a[92:95], v[108:111]
    v_mfma_f32_16x16x32_bf16 v[112:115], a[128:131], a[96:99], v[72:75]
    v_mfma_f32_16x16x32_bf16 v[112:115], a[132:135], a[100:103], v[112:115]
    v_mfma_f32_16x16x32_bf16 v[112:115], a[136:139], a[104:107], v[112:115]
    v_mfma_f32_16x16x32_bf16 v[112:115], a[140:143], a[108:111], v[112:115]
    v_mfma_f32_16x16x32_bf16 v[120:123], a[128:131], a[112:115], v[76:79]
    v_mfma_f32_16x16x32_bf16 v[120:123], a[132:135], a[116:119], v[120:123]
    v_mfma_f32_16x16x32_bf16 v[120:123], a[136:139], a[120:123], v[120:123]
    v_mfma_f32_16x16x32_bf16 v[120:123], a[140:143], a[124:127], v[120:123]
    v_mfma_f32_16x16x32_bf16 v[116:119], a[144:147], a[96:99], v[72:75]
    v_mfma_f32_16x16x32_bf16 v[116:119], a[148:151], a[100:103], v[116:119]
    v_mfma_f32_16x16x32_bf16 v[116:119], a[152:155], a[104:107], v[116:119]
    v_mfma_f32_16x16x32_bf16 v[116:119], a[156:159], a[108:111], v[116:119]
    v_mfma_f32_16x16x32_bf16 v[124:127], a[144:147], a[112:115], v[76:79]
    v_mfma_f32_16x16x32_bf16 v[124:127], a[148:151], a[116:119], v[124:127]
    v_mfma_f32_16x16x32_bf16 v[124:127], a[152:155], a[120:123], v[124:127]
    v_mfma_f32_16x16x32_bf16 v[124:127], a[156:159], a[124:127], v[124:127]
    v_max3_f32 v48, v48, v96, v97
    v_max3_f32 v48, v48, v98, v99
    v_max3_f32 v48, v48, v100, v101
    v_max3_f32 v48, v48, v102, v103
    v_max3_f32 v49, v49, v104, v105
    v_max3_f32 v49, v49, v106, v107
    v_max3_f32 v49, v49, v108, v109
    v_max3_f32 v49, v49, v110, v111
    v_max3_f32 v50, v50, v112, v113
    v_max3_f32 v50, v50, v114, v115
    v_max3_f32 v50, v50, v116, v117
    v_max3_f32 v50, v50, v118, v119
    v_max3_f32 v51, v51, v120, v121
    v_max3_f32 v51, v51, v122, v123
    v_max3_f32 v51, v51, v124, v125
    v_max3_f32 v51, v51, v126, v127
    s_add_u32 s100, s101, 16384
    buffer_load_dwordx4 a[128:131], v1, s[8:11], s100 offen offset:0
    buffer_load_dwordx4 a[132:135], v1, s[8:11], s100 offen offset:1024
    buffer_load_dwordx4 a[136:139], v1, s[8:11], s100 offen offset:2048
    buffer_load_dwordx4 a[140:143], v1, s[8:11], s100 offen offset:3072
    buffer_load_dwordx4 a[144:147], v15, s[8:11], s100 offen offset:0
    buffer_load_dwordx4 a[148:151], v15, s[8:11], s100 offen offset:1024
    buffer_load_dwordx4 a[152:155], v15, s[8:11], s100 offen offset:2048
    buffer_load_dwordx4 a[156:159], v15, s[8:11], s100 offen offset:3072
    v_add_f32 v80, 0, v22
    v_min_f32 v80, v80, v72
    v_add_f32 v81, 0xf1800000, v22
    v_min_f32 v81, v81, v73
    v_add_f32 v82, 0xf2000000, v22
    v_min_f32 v82, v82, v74
    v_add_f32 v83, 0xf2400000, v22
    v_min_f32 v83, v83, v75
    v_add_f32 v84, 0xf3800000, v22
    v_min_f32 v84, v84, v72
    v_add_f32 v85, 0xf3880000, v22
    v_min_f32 v85, v85, v73
    v_add_f32 v86, 0xf3900000, v22
    v_min_f32 v86, v86, v74
    v_add_f32 v87, 0xf3980000, v22
    v_min_f32 v87, v87, v75
    v_add_f32 v88, 0x73800000, v22
    v_min_f32 v88, v88, v76
    v_add_f32 v89, 0x73700000, v22
    v_min_f32 v89, v89, v77
    v_add_f32 v90, 0x73600000, v22
    v_min_f32 v90, v90, v78
    v_add_f32 v91, 0x73500000, v22
    v_min_f32 v91, v91, v79
    v_add_f32 v92, 0, v22
    v_min_f32 v92, v92, v76
    v_add_f32 v93, 0xf1800000, v22
    v_min_f32 v93, v93, v77
    v_add_f32 v94, 0xf2000000, v22
    v_min_f32 v94, v94, v78
    v_add_f32 v95, 0xf2400000, v22
    v_min_f32 v95, v95, v79
    s_waitcnt vmcnt(7)
    v_mfma_f32_16x16x32_bf16 v[96:99], a[128:131], a[96:99], v[80:83]
    s_waitcnt vmcnt(6)
    v_mfma_f32_16x16x32_bf16 v[96:99], a[132:135], a[100:103], v[96:99]
    s_waitcnt vmcnt(5)
    v_mfma_f32_16x16x32_bf16 v[96:99], a[136:139], a[104:107], v[96:99]
    s_waitcnt vmcnt(4)
    v_mfma_f32_16x16x32_bf16 v[96:99], a[140:143], a[108:111], v[96:99]
    v_mfma_f32_16x16x32_bf16 v[104:107], a[128:131], a[112:115], v[88:91]
    v_mfma_f32_16x16x32_bf16 v[104:107], a[132:135], a[116:119], v[104:107]
    v_mfma_f32_16x16x32_bf16 v[104:107], a[136:139], a[120:123], v[104:107]
    v_mfma_f32_16x16x32_bf16 v[104:107], a[140:143], a[124:127], v[104:107]
    s_waitcnt vmcnt(3)
    v_mfma_f32_16x16x32_bf16 v[100:103], a[144:147], a[96:99], v[84:87]
    s_waitcnt vmcnt(2)
    v_mfma_f32_16x16x32_bf16 v[100:103], a[148:151], a[100:103], v[100:103]
    s_waitcnt vmcnt(1)
    v_mfma_f32_16x16x32_bf16 v[100:103], a[152:155], a[104:107], v[100:103]
    s_waitcnt vmcnt(0)
    v_mfma_f32_16x16x32_bf16 v[100:103], a[156:159], a[108:111], v[100:103]
    v_mfma_f32_16x16x32_bf16 v[108:111], a[144:147], a[112:115], v[92:95]
    v_mfma_f32_16x16x32_bf16 v[108:111], a[148:151], a[116:119], v[108:111]
    v_mfma_f32_16x16x32_bf16 v[108:111], a[152:155], a[120:123], v[108:111]
    v_mfma_f32_16x16x32_bf16 v[108:111], a[156:159], a[124:127], v[108:111]
    v_max3_f32 v50, v50, v96, v97
    v_max3_f32 v50, v50, v98, v99
    s_nop 1
    v_max3_f32 v50, v50, v100, v101
    v_max3_f32 v50, v50, v102, v103
    v_max3_f32 v51, v51, v104, v105
    v_max3_f32 v51, v51, v106, v107
    v_max3_f32 v51, v51, v108, v109
    v_max3_f32 v51, v51, v110, v111
    v_mov_b32 v52, v48
    v_mov_b32 v53, v49
    v_mov_b32 v54, v50
    v_mov_b32 v55, v51
    v_permlane16_swap_b32 v48, v52
    v_permlane16_swap_b32 v49, v53
    v_permlane16_swap_b32 v50, v54
    v_permlane16_swap_b32 v51, v55
    v_max_f32 v48, v48, v52
    v_max_f32 v49, v49, v53
    v_max_f32 v50, v50, v54
    v_max_f32 v51, v51, v55
    v_mov_b32 v52, v48
    v_mov_b32 v53, v49
    v_mov_b32 v54, v50
    v_mov_b32 v55, v51
    v_permlane32_swap_b32 v48, v52
    v_permlane32_swap_b32 v49, v53
    v_permlane32_swap_b32 v50, v54
    v_permlane32_swap_b32 v51, v55
    v_max_f32 v48, v48, v52
    v_max_f32 v49, v49, v53
    v_max_f32 v50, v50, v54
    v_max_f32 v51, v51, v55
    ds_write_b128 v16, v[48:51] offset:32768
    v_xor_b32 v8, 8192, v16
    s_waitcnt lgkmcnt(0)
    s_barrier
    ds_read_b128 v[52:55], v8 offset:32768
    s_waitcnt lgkmcnt(0)
    v_max_f32 v48, v48, v52
    v_max_f32 v49, v49, v53
    v_max_f32 v50, v50, v54
    v_max_f32 v51, v51, v55
    v_sub_f32 v64, 0, v48
    v_sub_f32 v65, 0, v48
    v_sub_f32 v66, 0, v48
    v_sub_f32 v67, 0, v48
    v_sub_f32 v68, 0, v49
    v_sub_f32 v69, 0, v49
    v_sub_f32 v70, 0, v49
    v_sub_f32 v71, 0, v49
    v_sub_f32 v72, 0, v50
    v_sub_f32 v73, 0, v50
    v_sub_f32 v74, 0, v50
    v_sub_f32 v75, 0, v50
    v_sub_f32 v76, 0, v51
    v_sub_f32 v77, 0, v51
    v_sub_f32 v78, 0, v51
    v_sub_f32 v79, 0, v51
    s_mov_b32 s12, 0
    s_and_b32 s100, s12, 1
    s_mul_i32 s15, s100, 196608
    s_xor_b32 s15, s15, 65536
    s_mul_i32 s16, s100, 98304
    s_xor_b32 s16, s16, 98304
    v_and_b32 v18, 0x7fff, v18
    v_or_b32 v18, s15, v18
    v_and_b32 v19, 0x7fff, v19
    v_or_b32 v19, s16, v19
    v_and_b32 v20, 0x7fff, v20
    v_or_b32 v20, s16, v20
    s_add_u32 s15, s15, s62
    s_add_u32 s16, s16, s62
    s_add_u32 s12, s12, 2
    s_mov_b32 s82, s81
    s_add_u32 s19, s82, 32768
    s_add_u32 m0, s15, 0
    s_nop 0
    buffer_load_dwordx4 v1, s[8:11], s82 offen offset:0  lds
    buffer_load_dwordx4 v1, s[8:11], s82 offen offset:1024  lds
    buffer_load_dwordx4 v1, s[8:11], s82 offen offset:2048  lds
    buffer_load_dwordx4 v1, s[8:11], s82 offen offset:3072  lds
    s_add_u32 m0, s15, 4096
    s_nop 0
    buffer_load_dwordx4 v15, s[8:11], s82 offen offset:0  lds
    buffer_load_dwordx4 v15, s[8:11], s82 offen offset:1024  lds
    buffer_load_dwordx4 v15, s[8:11], s82 offen offset:2048  lds
    buffer_load_dwordx4 v15, s[8:11], s82 offen offset:3072  lds
    s_xor_b32 s15, s15, 196608
    s_add_u32 m0, s16, 0
    s_nop 0
    buffer_load_dwordx4 v1, s[8:11], s19 offen offset:0  lds
    buffer_load_dwordx4 v1, s[8:11], s19 offen offset:1024  lds
    buffer_load_dwordx4 v1, s[8:11], s19 offen offset:2048  lds
    buffer_load_dwordx4 v1, s[8:11], s19 offen offset:3072  lds
    s_add_u32 m0, s16, 4096
    s_nop 0
    buffer_load_dwordx4 v15, s[8:11], s19 offen offset:0  lds
    buffer_load_dwordx4 v15, s[8:11], s19 offen offset:1024  lds
    buffer_load_dwordx4 v15, s[8:11], s19 offen offset:2048  lds
    buffer_load_dwordx4 v15, s[8:11], s19 offen offset:3072  lds
    s_xor_b32 s16, s16, 98304
    s_cmp_eq_u32 s60, 0
    s_cselect_b32 s82, 0, 1
    s_mul_i32 s82, s82, 65536
    s_add_u32 s82, s82, s81
    s_add_u32 m0, s15, 0
    s_nop 0
    buffer_load_dwordx4 v1, s[8:11], s82 offen offset:0  lds
    buffer_load_dwordx4 v1, s[8:11], s82 offen offset:1024  lds
    buffer_load_dwordx4 v1, s[8:11], s82 offen offset:2048  lds
    buffer_load_dwordx4 v1, s[8:11], s82 offen offset:3072  lds
    s_add_u32 m0, s15, 4096
    s_nop 0
    buffer_load_dwordx4 v15, s[8:11], s82 offen offset:0  lds
    buffer_load_dwordx4 v15, s[8:11], s82 offen offset:1024  lds
    buffer_load_dwordx4 v15, s[8:11], s82 offen offset:2048  lds
    buffer_load_dwordx4 v15, s[8:11], s82 offen offset:3072  lds
    s_xor_b32 s15, s15, 196608
    s_cmp_eq_u32 s60, 0
    s_cselect_b32 s19, 0, 0x76800000
    v_add_f32 v3, s19, v21
    v_add_f32 v96, 0, v3
    v_min_f32 v96, v96, v64
    v_add_f32 v97, 0xf1800000, v3
    v_min_f32 v97, v97, v65
    v_add_f32 v98, 0xf2000000, v3
    v_min_f32 v98, v98, v66
    v_add_f32 v99, 0xf2400000, v3
    v_min_f32 v99, v99, v67
    v_add_f32 v100, 0xf3800000, v3
    v_min_f32 v100, v100, v64
    v_add_f32 v101, 0xf3880000, v3
    v_min_f32 v101, v101, v65
    v_add_f32 v102, 0xf3900000, v3
    v_min_f32 v102, v102, v66
    v_add_f32 v103, 0xf3980000, v3
    v_min_f32 v103, v103, v67
    v_add_f32 v104, 0x73800000, v3
    v_min_f32 v104, v104, v68
    v_add_f32 v105, 0x73700000, v3
    v_min_f32 v105, v105, v69
    v_add_f32 v106, 0x73600000, v3
    v_min_f32 v106, v106, v70
    v_add_f32 v107, 0x73500000, v3
    v_min_f32 v107, v107, v71
    v_add_f32 v108, 0, v3
    v_min_f32 v108, v108, v68
    v_add_f32 v109, 0xf1800000, v3
    v_min_f32 v109, v109, v69
    v_add_f32 v110, 0xf2000000, v3
    v_min_f32 v110, v110, v70
    v_add_f32 v111, 0xf2400000, v3
    v_min_f32 v111, v111, v71
    v_add_f32 v80, 0, v22
    v_min_f32 v80, v80, v72
    v_add_f32 v81, 0xf1800000, v22
    v_min_f32 v81, v81, v73
    v_add_f32 v82, 0xf2000000, v22
    v_min_f32 v82, v82, v74
    v_add_f32 v83, 0xf2400000, v22
    v_min_f32 v83, v83, v75
    v_add_f32 v84, 0xf3800000, v22
    v_min_f32 v84, v84, v72
    v_add_f32 v85, 0xf3880000, v22
    v_min_f32 v85, v85, v73
    v_add_f32 v86, 0xf3900000, v22
    v_min_f32 v86, v86, v74
    v_add_f32 v87, 0xf3980000, v22
    v_min_f32 v87, v87, v75
    v_add_f32 v88, 0x73800000, v22
    v_min_f32 v88, v88, v76
    v_add_f32 v89, 0x73700000, v22
    v_min_f32 v89, v89, v77
    v_add_f32 v90, 0x73600000, v22
    v_min_f32 v90, v90, v78
    v_add_f32 v91, 0x73500000, v22
    v_min_f32 v91, v91, v79
    v_add_f32 v92, 0, v22
    v_min_f32 v92, v92, v76
    v_add_f32 v93, 0xf1800000, v22
    v_min_f32 v93, v93, v77
    v_add_f32 v94, 0xf2000000, v22
    v_min_f32 v94, v94, v78
    v_add_f32 v95, 0xf2400000, v22
    v_min_f32 v95, v95, v79
    s_cmp_eq_u32 s60, 0
    s_cbranch_scc1 L_t1_mk
    v_add_f32 v80, 0, v21
    v_min_f32 v80, v80, v64
    v_add_f32 v81, 0xf1800000, v21
    v_min_f32 v81, v81, v65
    v_add_f32 v82, 0xf2000000, v21
    v_min_f32 v82, v82, v66
    v_add_f32 v83, 0xf2400000, v21
    v_min_f32 v83, v83, v67
    v_add_f32 v84, 0xf3800000, v21
    v_min_f32 v84, v84, v64
    v_add_f32 v85, 0xf3880000, v21
    v_min_f32 v85, v85, v65
    v_add_f32 v86, 0xf3900000, v21
    v_min_f32 v86, v86, v66
    v_add_f32 v87, 0xf3980000, v21
    v_min_f32 v87, v87, v67
    v_add_f32 v88, 0x73800000, v21
    v_min_f32 v88, v88, v68
    v_add_f32 v89, 0x73700000, v21
    v_min_f32 v89, v89, v69
    v_add_f32 v90, 0x73600000, v21
    v_min_f32 v90, v90, v70
    v_add_f32 v91, 0x73500000, v21
    v_min_f32 v91, v91, v71
    v_add_f32 v92, 0, v21
    v_min_f32 v92, v92, v68
    v_add_f32 v93, 0xf1800000, v21
    v_min_f32 v93, v93, v69
    v_add_f32 v94, 0xf2000000, v21
    v_min_f32 v94, v94, v70
    v_add_f32 v95, 0xf2400000, v21
    v_min_f32 v95, v95, v71
L_t1_mk:
    s_waitcnt vmcnt(0) lgkmcnt(0)
    s_barrier
    ds_read_b128 a[128:131], v18 offset:0
    ds_read_b128 a[132:135], v18 offset:1024
    ds_read_b128 a[136:139], v18 offset:2048
    ds_read_b128 a[140:143], v18 offset:3072
    ds_read_b128 a[144:147], v18 offset:4096
    ds_read_b128 a[148:151], v18 offset:5120
    ds_read_b128 a[152:155], v18 offset:6144
    ds_read_b128 a[156:159], v18 offset:7168
    s_waitcnt lgkmcnt(0)
    s_branch L_t1_start
L_C1_slow_9:
    s_mov_b32 s99, 0
L_C1_slow_9_l:
    s_sleep 4
    buffer_load_dword v3, v4, s[8:11], s23 offen sc0 sc1
    s_add_u32 s99, s99, 1
    s_waitcnt vmcnt(0)
    v_cmp_ne_u32 vcc, 0, v3
    s_cmp_eq_u64 vcc, -1
    s_cbranch_scc1 L_C1_ok_10
    s_cmp_lt_u32 s99, 200000
    s_cbranch_scc1 L_C1_slow_9_l
    s_branch L_C1_ok_10
L_F_slow_11:
    s_mov_b32 s99, 0
L_F_slow_11_l:
    s_sleep 4
    buffer_load_dword v3, v12, s[8:11], s71 offen sc0 sc1
    s_add_u32 s99, s99, 1
    s_waitcnt vmcnt(0)
    v_cmp_ne_u32 vcc, 0, v3
    s_cmp_eq_u64 vcc, -1
    s_cbranch_scc1 L_F_ok_12
    s_cmp_lt_u32 s99, 200000
    s_cbranch_scc1 L_F_slow_11_l
    s_branch L_F_ok_12
L_t2_redo:
    s_cmp_eq_u32 s25, 0
    s_cbranch_scc1 L_t2_max
    s_mov_b32 s25, 0
    v_mov_b32 v64, 0
    v_mov_b32 v65, 0
    v_mov_b32 v66, 0
    v_mov_b32 v67, 0
    v_mov_b32 v68, 0
    v_mov_b32 v69, 0
    v_mov_b32 v70, 0
    v_mov_b32 v71, 0
    v_mov_b32 v72, 0
    v_mov_b32 v73, 0
    v_mov_b32 v74, 0
    v_mov_b32 v75, 0
    v_mov_b32 v76, 0
    v_mov_b32 v77, 0
    v_mov_b32 v78, 0
    v_mov_b32 v79, 0
    s_nop 1
    s_branch L_t2_safe
L_t2_max:
    s_waitcnt vmcnt(0) lgkmcnt(0)
    s_barrier
    s_mov_b32 s25, 1
    s_and_b32 s100, s3, 1
    s_lshl_b32 s100, s100, 13
    s_sub_u32 s101, s81, s62
    s_add_u32 s101, s101, s100
    s_mov_b32 s14, s61
    s_mov_b32 s26, 0
    v_mov_b32 v24, -1
    v_mov_b32 v25, -1
    v_mov_b32 v26, -1
    v_mov_b32 v27, -1
    v_mov_b32 v48, 0xff800000
    v_mov_b32 v49, 0xff800000
    v_mov_b32 v50, 0xff800000
    v_mov_b32 v51, 0xff800000
L_t2_maxl:
    s_cmp_eq_u32 s14, 0
    s_cbranch_scc1 L_t2_maxd
    s_add_u32 s100, s101, 0
    buffer_load_dwordx4 a[128:131], v1, s[8:11], s100 offen offset:0
    buffer_load_dwordx4 a[132:135], v1, s[8:11], s100 offen offset:1024
    buffer_load_dwordx4 a[136:139], v1, s[8:11], s100 offen offset:2048
    buffer_load_dwordx4 a[140:143], v1, s[8:11], s100 offen offset:3072
    buffer_load_dwordx4 a[144:147], v15, s[8:11], s100 offen offset:0
    buffer_load_dwordx4 a[148:151], v15, s[8:11], s100 offen offset:1024
    buffer_load_dwordx4 a[152:155], v15, s[8:11], s100 offen offset:2048
    buffer_load_dwordx4 a[156:159], v15, s[8:11], s100 offen offset:3072
    s_waitcnt vmcnt(7)
    v_mfma_f32_16x16x32_bf16 v[96:99], a[128:131], a[192:195], v[64:67]
    s_waitcnt vmcnt(6)
    v_mfma_f32_16x16x32_bf16 v[96:99], a[132:135], a[196:199], v[96:99]
    s_waitcnt vmcnt(5)
    v_mfma_f32_16x16x32_bf16 v[96:99], a[136:139], a[200:203], v[96:99]
    s_waitcnt vmcnt(4)
    v_mfma_f32_16x16x32_bf16 v[96:99], a[140:143], a[204:207], v[96:99]
    v_mfma_f32_16x16x32_bf16 v[104:107], a[128:131], a[208:211], v[68:71]
    v_mfma_f32_16x16x32_bf16 v[104:107], a[132:135], a[212:215], v[104:107]
    v_mfma_f32_16x16x32_bf16 v[104:107], a[136:139], a[216:219], v[104:107]
    v_mfma_f32_16x16x32_bf16 v[104:107], a[140:143], a[220:223], v[104:107]
    s_waitcnt vmcnt(3)
    v_mfma_f32_16x16x32_bf16 v[100:103], a[144:147], a[192:195], v[64:67]
    s_waitcnt vmcnt(2)
    v_mfma_f32_16x16x32_bf16 v[100:103], a[148:151], a[196:199], v[100:103]
    s_waitcnt vmcnt(1)
    v_mfma_f32_16x16x32_bf16 v[100:103], a[152:155], a[200:203], v[100:103]
    s_waitcnt vmcnt(0)
    v_mfma_f32_16x16x32_bf16 v[100:103], a[156:159], a[204:207], v[100:103]
    v_mfma_f32_16x16x32_bf16 v[108:111], a[144:147], a[208:211], v[68:71]
    v_mfma_f32_16x16x32_bf16 v[108:111], a[148:151], a[212:215], v[108:111]
    v_mfma_f32_16x16x32_bf16 v[108:111], a[152:155], a[216:219], v[108:111]
    v_mfma_f32_16x16x32_bf16 v[108:111], a[156:159], a[220:223], v[108:111]
    v_mfma_f32_16x16x32_bf16 v[112:115], a[128:131], a[224:227], v[72:75]
    v_mfma_f32_16x16x32_bf16 v[112:115], a[132:135], a[228:231], v[112:115]
    v_mfma_f32_16x16x32_bf16 v[112:115], a[136:139], a[232:235], v[112:115]
    v_mfma_f32_16x16x32_bf16 v[112:115], a[140:143], a[236:239], v[112:115]
    v_mfma_f32_16x16x32_bf16 v[120:123], a[128:131], a[240:243], v[76:79]
    v_mfma_f32_16x16x32_bf16 v[120:123], a[132:135], a[244:247], v[120:123]
    v_mfma_f32_16x16x32_bf16 v[120:123], a[136:139], a[248:251], v[120:123]
    v_mfma_f32_16x16x32_bf16 v[120:123], a[140:143], a[252:255], v[120:123]
    v_mfma_f32_16x16x32_bf16 v[116:119], a[144:147], a[224:227], v[72:75]
    v_mfma_f32_16x16x32_bf16 v[116:119], a[148:151], a[228:231], v[116:119]
    v_mfma_f32_16x16x32_bf16 v[116:119], a[152:155], a[232:235], v[116:119]
    v_mfma_f32_16x16x32_bf16 v[116:119], a[156:159], a[236:239], v[116:119]
    v_mfma_f32_16x16x32_bf16 v[124:127], a[144:147], a[240:243], v[76:79]
    v_mfma_f32_16x16x32_bf16 v[124:127], a[148:151], a[244:247], v[124:127]
    v_mfma_f32_16x16x32_bf16 v[124:127], a[152:155], a[248:251], v[124:127]
    v_mfma_f32_16x16x32_bf16 v[124:127], a[156:159], a[252:255], v[124:127]
    v_max3_f32 v48, v48, v96, v97
    v_max3_f32 v48, v48, v98, v99
    v_max3_f32 v48, v48, v100, v101
    v_max3_f32 v48, v48, v102, v103
    v_max3_f32 v49, v49, v104, v105
    v_max3_f32 v49, v49, v106, v107
    v_max3_f32 v49, v49, v108, v109
    v_max3_f32 v49, v49, v110, v111
    v_max3_f32 v50, v50, v112, v113
    v_max3_f32 v50, v50, v114, v115
    v_max3_f32 v50, v50, v116, v117
    v_max3_f32 v50, v50, v118, v119
    v_max3_f32 v51, v51, v120, v121
    v_max3_f32 v51, v51, v122, v123
    v_max3_f32 v51, v51, v124, v125
    v_max3_f32 v51, v51, v126, v127
    s_add_u32 s100, s101, 16384
    buffer_load_dwordx4 a[128:131], v1, s[8:11], s100 offen offset:0
    buffer_load_dwordx4 a[132:135], v1, s[8:11], s100 offen offset:1024
    buffer_load_dwordx4 a[136:139], v1, s[8:11], s100 offen offset:2048
    buffer_load_dwordx4 a[140:143], v1, s[8:11], s100 offen offset:3072
    buffer_load_dwordx4 a[144:147], v15, s[8:11], s100 offen offset:0
    buffer_load_dwordx4 a[148:151], v15, s[8:11], s100 offen offset:1024
    buffer_load_dwordx4 a[152:155], v15, s[8:11], s100 offen offset:2048
    buffer_load_dwordx4 a[156:159], v15, s[8:11], s100 offen offset:3072
    s_waitcnt vmcnt(7)
    v_mfma_f32_16x16x32_bf16 v[96:99], a[128:131], a[192:195], v[64:67]
    s_waitcnt vmcnt(6)
    v_mfma_f32_16x16x32_bf16 v[96:99], a[132:135], a[196:199], v[96:99]
    s_waitcnt vmcnt(5)
    v_mfma_f32_16x16x32_bf16 v[96:99], a[136:139], a[200:203], v[96:99]
    s_waitcnt vmcnt(4)
    v_mfma_f32_16x16x32_bf16 v[96:99], a[140:143], a[204:207], v[96:99]
    v_mfma_f32_16x16x32_bf16 v[104:107], a[128:131], a[208:211], v[68:71]
    v_mfma_f32_16x16x32_bf16 v[104:107], a[132:135], a[212:215], v[104:107]
    v_mfma_f32_16x16x32_bf16 v[104:107], a[136:139], a[216:219], v[104:107]
    v_mfma_f32_16x16x32_bf16 v[104:107], a[140:143], a[220:223], v[104:107]
    s_waitcnt vmcnt(3)
    v_mfma_f32_16x16x32_bf16 v[100:103], a[144:147], a[192:195], v[64:67]
    s_waitcnt vmcnt(2)
    v_mfma_f32_16x16x32_bf16 v[100:103], a[148:151], a[196:199], v[100:103]
    s_waitcnt vmcnt(1)
    v_mfma_f32_16x16x32_bf16 v[100:103], a[152:155], a[200:203], v[100:103]
    s_waitcnt vmcnt(0)
    v_mfma_f32_16x16x32_bf16 v[100:103], a[156:159], a[204:207], v[100:103]
    v_mfma_f32_16x16x32_bf16 v[108:111], a[144:147], a[208:211], v[68:71]
    v_mfma_f32_16x16x32_bf16 v[108:111], a[148:151], a[212:215], v[108:111]
    v_mfma_f32_16x16x32_bf16 v[108:111], a[152:155], a[216:219], v[108:111]
    v_mfma_f32_16x16x32_bf16 v[108:111], a[156:159], a[220:223], v[108:111]
    v_mfma_f32_16x16x32_bf16 v[112:115], a[128:131], a[224:227], v[72:75]
    v_mfma_f32_16x16x32_bf16 v[112:115], a[132:135], a[228:231], v[112:115]
    v_mfma_f32_16x16x32_bf16 v[112:115], a[136:139], a[232:235], v[112:115]
    v_mfma_f32_16x16x32_bf16 v[112:115], a[140:143], a[236:239], v[112:115]
    v_mfma_f32_16x16x32_bf16 v[120:123], a[128:131], a[240:243], v[76:79]
    v_mfma_f32_16x16x32_bf16 v[120:123], a[132:135], a[244:247], v[120:123]
    v_mfma_f32_16x16x32_bf16 v[120:123], a[136:139], a[248:251], v[120:123]
    v_mfma_f32_16x16x32_bf16 v[120:123], a[140:143], a[252:255], v[120:123]
    v_mfma_f32_16x16x32_bf16 v[116:119], a[144:147], a[224:227], v[72:75]
    v_mfma_f32_16x16x32_bf16 v[116:119], a[148:151], a[228:231], v[116:119]
    v_mfma_f32_16x16x32_bf16 v[116:119], a[152:155], a[232:235], v[116:119]
    v_mfma_f32_16x16x32_bf16 v[116:119], a[156:159], a[236:239], v[116:119]
    v_mfma_f32_16x16x32_bf16 v[124:127], a[144:147], a[240:243], v[76:79]
    v_mfma_f32_16x16x32_bf16 v[124:127], a[148:151], a[244:247], v[124:127]
    v_mfma_f32_16x16x32_bf16 v[124:127], a[152:155], a[248:251], v[124:127]
    v_mfma_f32_16x16x32_bf16 v[124:127], a[156:159], a[252:255], v[124:127]
    v_max3_f32 v48, v48, v96, v97
    v_max3_f32 v48, v48, v98, v99
    v_max3_f32 v48, v48, v100, v101
    v_max3_f32 v48, v48, v102, v103
    v_max3_f32 v49, v49, v104, v105
    v_max3_f32 v49, v49, v106, v107
    v_max3_f32 v49, v49, v108, v109
    v_max3_f32 v49, v49, v110, v111
    v_max3_f32 v50, v50, v112, v113
    v_max3_f32 v50, v50, v114, v115
    v_max3_f32 v50, v50, v116, v117
    v_max3_f32 v50, v50, v118, v119
    v_max3_f32 v51, v51, v120, v121
    v_max3_f32 v51, v51, v122, v123
    v_max3_f32 v51, v51, v124, v125
    v_max3_f32 v51, v51, v126, v127
    s_add_u32 s101, s101, 65536
    s_sub_u32 s14, s14, 1
    s_nop 7
    s_branch L_t2_maxl
L_t2_maxd:
    s_add_u32 s100, s101, 0
    buffer_load_dwordx4 a[128:131], v1, s[8:11], s100 offen offset:0
    buffer_load_dwordx4 a[132:135], v1, s[8:11], s100 offen offset:1024
    buffer_load_dwordx4 a[136:139], v1, s[8:11], s100 offen offset:2048
    buffer_load_dwordx4 a[140:143], v1, s[8:11], s100 offen offset:3072
    buffer_load_dwordx4 a[144:147], v15, s[8:11], s100 offen offset:0
    buffer_load_dwordx4 a[148:151], v15, s[8:11], s100 offen offset:1024
    buffer_load_dwordx4 a[152:155], v15, s[8:11], s100 offen offset:2048
    buffer_load_dwordx4 a[156:159], v15, s[8:11], s100 offen offset:3072
    v_add_f32 v80, 0, v21
    v_min_f32 v80, v80, v64
    v_add_f32 v81, 0xf1800000, v21
    v_min_f32 v81, v81, v65
    v_add_f32 v82, 0xf2000000, v21
    v_min_f32 v82, v82, v66
    v_add_f32 v83, 0xf2400000, v21
    v_min_f32 v83, v83, v67
    v_add_f32 v84, 0xf3800000, v21
    v_min_f32 v84, v84, v64
    v_add_f32 v85, 0xf3880000, v21
    v_min_f32 v85, v85, v65
    v_add_f32 v86, 0xf3900000, v21
    v_min_f32 v86, v86, v66
    v_add_f32 v87, 0xf3980000, v21
    v_min_f32 v87, v87, v67
    v_add_f32 v88, 0x73800000, v21
    v_min_f32 v88, v88, v68
    v_add_f32 v89, 0x73700000, v21
    v_min_f32 v89, v89, v69
    v_add_f32 v90, 0x73600000, v21
    v_min_f32 v90, v90, v70
    v_add_f32 v91, 0x73500000, v21
    v_min_f32 v91, v91, v71
    v_add_f32 v92, 0, v21
    v_min_f32 v92, v92, v68
    v_add_f32 v93, 0xf1800000, v21
    v_min_f32 v93, v93, v69
    v_add_f32 v94, 0xf2000000, v21
    v_min_f32 v94, v94, v70
    v_add_f32 v95, 0xf2400000, v21
    v_min_f32 v95, v95, v71
    s_waitcnt vmcnt(7)
    v_mfma_f32_16x16x32_bf16 v[96:99], a[128:131], a[192:195], v[80:83]
    s_waitcnt vmcnt(6)
    v_mfma_f32_16x16x32_bf16 v[96:99], a[132:135], a[196:199], v[96:99]
    s_waitcnt vmcnt(5)
    v_mfma_f32_16x16x32_bf16 v[96:99], a[136:139], a[200:203], v[96:99]
    s_waitcnt vmcnt(4)
    v_mfma_f32_16x16x32_bf16 v[96:99], a[140:143], a[204:207], v[96:99]
    v_mfma_f32_16x16x32_bf16 v[104:107], a[128:131], a[208:211], v[88:91]
    v_mfma_f32_16x16x32_bf16 v[104:107], a[132:135], a[212:215], v[104:107]
    v_mfma_f32_16x16x32_bf16 v[104:107], a[136:139], a[216:219], v[104:107]
    v_mfma_f32_16x16x32_bf16 v[104:107], a[140:143], a[220:223], v[104:107]
    s_waitcnt vmcnt(3)
    v_mfma_f32_16x16x32_bf16 v[100:103], a[144:147], a[192:195], v[84:87]
    s_waitcnt vmcnt(2)
    v_mfma_f32_16x16x32_bf16 v[100:103], a[148:151], a[196:199], v[100:103]
    s_waitcnt vmcnt(1)
    v_mfma_f32_16x16x32_bf16 v[100:103], a[152:155], a[200:203], v[100:103]
    s_waitcnt vmcnt(0)
    v_mfma_f32_16x16x32_bf16 v[100:103], a[156:159], a[204:207], v[100:103]
    v_mfma_f32_16x16x32_bf16 v[108:111], a[144:147], a[208:211], v[92:95]
    v_mfma_f32_16x16x32_bf16 v[108:111], a[148:151], a[212:215], v[108:111]
    v_mfma_f32_16x16x32_bf16 v[108:111], a[152:155], a[216:219], v[108:111]
    v_mfma_f32_16x16x32_bf16 v[108:111], a[156:159], a[220:223], v[108:111]
    v_mfma_f32_16x16x32_bf16 v[112:115], a[128:131], a[224:227], v[72:75]
    v_mfma_f32_16x16x32_bf16 v[112:115], a[132:135], a[228:231], v[112:115]
    v_mfma_f32_16x16x32_bf16 v[112:115], a[136:139], a[232:235], v[112:115]
    v_mfma_f32_16x16x32_bf16 v[112:115], a[140:143], a[236:239], v[112:115]
    v_mfma_f32_16x16x32_bf16 v[120:123], a[128:131], a[240:243], v[76:79]
    v_mfma_f32_16x16x32_bf16 v[120:123], a[132:135], a[244:247], v[120:123]
    v_mfma_f32_16x16x32_bf16 v[120:123], a[136:139], a[248:251], v[120:123]
    v_mfma_f32_16x16x32_bf16 v[120:123], a[140:143], a[252:255], v[120:123]
    v_mfma_f32_16x16x32_bf16 v[116:119], a[144:147], a[224:227], v[72:75]
    v_mfma_f32_16x16x32_bf16 v[116:119], a[148:151], a[228:231], v[116:119]
    v_mfma_f32_16x16x32_bf16 v[116:119], a[152:155], a[232:235], v[116:119]
    v_mfma_f32_16x16x32_bf16 v[116:119], a[156:159], a[236:239], v[116:119]
    v_mfma_f32_16x16x32_bf16 v[124:127], a[144:147], a[240:243], v[76:79]
    v_mfma_f32_16x16x32_bf16 v[124:127], a[148:151], a[244:247], v[124:127]
    v_mfma_f32_16x16x32_bf16 v[124:127], a[152:155], a[248:251], v[124:127]
    v_mfma_f32_16x16x32_bf16 v[124:127], a[156:159], a[252:255], v[124:127]
    v_max3_f32 v48, v48, v96, v97
    v_max3_f32 v48, v48, v98, v99
    v_max3_f32 v48, v48, v100, v101
    v_max3_f32 v48, v48, v102, v103
    v_max3_f32 v49, v49, v104, v105
    v_max3_f32 v49, v49, v106, v107
    v_max3_f32 v49, v49, v108, v109
    v_max3_f32 v49, v49, v110, v111
    v_max3_f32 v50, v50, v112, v113
    v_max3_f32 v50, v50, v114, v115
    v_max3_f32 v50, v50, v116, v117
    v_max3_f32 v50, v50, v118, v119
    v_max3_f32 v51, v51, v120, v121
    v_max3_f32 v51, v51, v122, v123
    v_max3_f32 v51, v51, v124, v125
    v_max3_f32 v51, v51, v126, v127
    s_add_u32 s100, s101, 16384
    buffer_load_dwordx4 a[128:131], v1, s[8:11], s100 offen offset:0
    buffer_load_dwordx4 a[132:135], v1, s[8:11], s100 offen offset:1024
    buffer_load_dwordx4 a[136:139], v1, s[8:11], s100 offen offset:2048
    buffer_load_dwordx4 a[140:143], v1, s[8:11], s100 offen offset:3072
    buffer_load_dwordx4 a[144:147], v15, s[8:11], s100 offen offset:0
    buffer_load_dwordx4 a[148:151], v15, s[8:11], s100 offen offset:1024
    buffer_load_dwordx4 a[152:155], v15, s[8:11], s100 offen offset:2048
    buffer_load_dwordx4 a[156:159], v15, s[8:11], s100 offen offset:3072
    v_add_f32 v80, 0, v22
    v_min_f32 v80, v80, v72
    v_add_f32 v81, 0xf1800000, v22
    v_min_f32 v81, v81, v73
    v_add_f32 v82, 0xf2000000, v22
    v_min_f32 v82, v82, v74
    v_add_f32 v83, 0xf2400000, v22
    v_min_f32 v83, v83, v75
    v_add_f32 v84, 0xf3800000, v22
    v_min_f32 v84, v84, v72
    v_add_f32 v85, 0xf3880000, v22
    v_min_f32 v85, v85, v73
    v_add_f32 v86, 0xf3900000, v22
    v_min_f32 v86, v86, v74
    v_add_f32 v87, 0xf3980000, v22
    v_min_f32 v87, v87, v75
    v_add_f32 v88, 0x73800000, v22
    v_min_f32 v88, v88, v76
    v_add_f32 v89, 0x73700000, v22
    v_min_f32 v89, v89, v77
    v_add_f32 v90, 0x73600000, v22
    v_min_f32 v90, v90, v78
    v_add_f32 v91, 0x73500000, v22
    v_min_f32 v91, v91, v79
    v_add_f32 v92, 0, v22
    v_min_f32 v92, v92, v76
    v_add_f32 v93, 0xf1800000, v22
    v_min_f32 v93, v93, v77
    v_add_f32 v94, 0xf2000000, v22
    v_min_f32 v94, v94, v78
    v_add_f32 v95, 0xf2400000, v22
    v_min_f32 v95, v95, v79
    s_waitcnt vmcnt(7)
    v_mfma_f32_16x16x32_bf16 v[96:99], a[128:131], a[224:227], v[80:83]
    s_waitcnt vmcnt(6)
    v_mfma_f32_16x16x32_bf16 v[96:99], a[132:135], a[228:231], v[96:99]
    s_waitcnt vmcnt(5)
    v_mfma_f32_16x16x32_bf16 v[96:99], a[136:139], a[232:235], v[96:99]
    s_waitcnt vmcnt(4)
    v_mfma_f32_16x16x32_bf16 v[96:99], a[140:143], a[236:239], v[96:99]
    v_mfma_f32_16x16x32_bf16 v[104:107], a[128:131], a[240:243], v[88:91]
    v_mfma_f32_16x16x32_bf16 v[104:107], a[132:135], a[244:247], v[104:107]
    v_mfma_f32_16x16x32_bf16 v[104:107], a[136:139], a[248:251], v[104:107]
    v_mfma_f32_16x16x32_bf16 v[104:107], a[140:143], a[252:255], v[104:107]
    s_waitcnt vmcnt(3)
    v_mfma_f32_16x16x32_bf16 v[100:103], a[144:147], a[224:227], v[84:87]
    s_waitcnt vmcnt(2)
    v_mfma_f32_16x16x32_bf16 v[100:103], a[148:151], a[228:231], v[100:103]
    s_waitcnt vmcnt(1)
    v_mfma_f32_16x16x32_bf16 v[100:103], a[152:155], a[232:235], v[100:103]
    s_waitcnt vmcnt(0)
    v_mfma_f32_16x16x32_bf16 v[100:103], a[156:159], a[236:239], v[100:103]
    v_mfma_f32_16x16x32_bf16 v[108:111], a[144:147], a[240:243], v[92:95]
    v_mfma_f32_16x16x32_bf16 v[108:111], a[148:151], a[244:247], v[108:111]
    v_mfma_f32_16x16x32_bf16 v[108:111], a[152:155], a[248:251], v[108:111]
    v_mfma_f32_16x16x32_bf16 v[108:111], a[156:159], a[252:255], v[108:111]
    v_max3_f32 v50, v50, v96, v97
    v_max3_f32 v50, v50, v98, v99
    s_nop 1
    v_max3_f32 v50, v50, v100, v101
    v_max3_f32 v50, v50, v102, v103
    v_max3_f32 v51, v51, v104, v105
    v_max3_f32 v51, v51, v106, v107
    v_max3_f32 v51, v51, v108, v109
    v_max3_f32 v51, v51, v110, v111
    v_mov_b32 v52, v48
    v_mov_b32 v53, v49
    v_mov_b32 v54, v50
    v_mov_b32 v55, v51
    v_permlane16_swap_b32 v48, v52
    v_permlane16_swap_b32 v49, v53
    v_permlane16_swap_b32 v50, v54
    v_permlane16_swap_b32 v51, v55
    v_max_f32 v48, v48, v52
    v_max_f32 v49, v49, v53
    v_max_f32 v50, v50, v54
    v_max_f32 v51, v51, v55
    v_mov_b32 v52, v48
    v_mov_b32 v53, v49
    v_mov_b32 v54, v50
    v_mov_b32 v55, v51
    v_permlane32_swap_b32 v48, v52
    v_permlane32_swap_b32 v49, v53
    v_permlane32_swap_b32 v50, v54
    v_permlane32_swap_b32 v51, v55
    v_max_f32 v48, v48, v52
    v_max_f32 v49, v49, v53
    v_max_f32 v50, v50, v54
    v_max_f32 v51, v51, v55
    ds_write_b128 v16, v[48:51] offset:32768
    v_xor_b32 v8, 8192, v16
    s_waitcnt lgkmcnt(0)
    s_barrier
    ds_read_b128 v[52:55], v8 offset:32768
    s_waitcnt lgkmcnt(0)
    v_max_f32 v48, v48, v52
    v_max_f32 v49, v49, v53
    v_max_f32 v50, v50, v54
    v_max_f32 v51, v51, v55
    v_sub_f32 v64, 0, v48
    v_sub_f32 v65, 0, v48
    v_sub_f32 v66, 0, v48
    v_sub_f32 v67, 0, v48
    v_sub_f32 v68, 0, v49
    v_sub_f32 v69, 0, v49
    v_sub_f32 v70, 0, v49
    v_sub_f32 v71, 0, v49
    v_sub_f32 v72, 0, v50
    v_sub_f32 v73, 0, v50
    v_sub_f32 v74, 0, v50
    v_sub_f32 v75, 0, v50
    v_sub_f32 v76, 0, v51
    v_sub_f32 v77, 0, v51
    v_sub_f32 v78, 0, v51
    v_sub_f32 v79, 0, v51
    s_add_u32 s12, s13, 1
    s_and_b32 s100, s12, 1
    s_mul_i32 s15, s100, 196608
    s_xor_b32 s15, s15, 65536
    s_mul_i32 s16, s100, 98304
    s_xor_b32 s16, s16, 98304
    v_and_b32 v18, 0x7fff, v18
    v_or_b32 v18, s15, v18
    v_and_b32 v19, 0x7fff, v19
    v_or_b32 v19, s16, v19
    v_and_b32 v20, 0x7fff, v20
    v_or_b32 v20, s16, v20
    s_add_u32 s15, s15, s62
    s_add_u32 s16, s16, s62
    s_add_u32 s12, s12, 2
    s_mov_b32 s82, s81
    s_add_u32 s19, s82, 32768
    s_add_u32 m0, s15, 0
    s_nop 0
    buffer_load_dwordx4 v1, s[8:11], s82 offen offset:0  lds
    buffer_load_dwordx4 v1, s[8:11], s82 offen offset:1024  lds
    buffer_load_dwordx4 v1, s[8:11], s82 offen offset:2048  lds
    buffer_load_dwordx4 v1, s[8:11], s82 offen offset:3072  lds
    s_add_u32 m0, s15, 4096
    s_nop 0
    buffer_load_dwordx4 v15, s[8:11], s82 offen offset:0  lds
    buffer_load_dwordx4 v15, s[8:11], s82 offen offset:1024  lds
    buffer_load_dwordx4 v15, s[8:11], s82 offen offset:2048  lds
    buffer_load_dwordx4 v15, s[8:11], s82 offen offset:3072  lds
    s_xor_b32 s15, s15, 196608
    s_add_u32 m0, s16, 0
    s_nop 0
    buffer_load_dwordx4 v1, s[8:11], s19 offen offset:0  lds
    buffer_load_dwordx4 v1, s[8:11], s19 offen offset:1024  lds
    buffer_load_dwordx4 v1, s[8:11], s19 offen offset:2048  lds
    buffer_load_dwordx4 v1, s[8:11], s19 offen offset:3072  lds
    s_add_u32 m0, s16, 4096
    s_nop 0
    buffer_load_dwordx4 v15, s[8:11], s19 offen offset:0  lds
    buffer_load_dwordx4 v15, s[8:11], s19 offen offset:1024  lds
    buffer_load_dwordx4 v15, s[8:11], s19 offen offset:2048  lds
    buffer_load_dwordx4 v15, s[8:11], s19 offen offset:3072  lds
    s_xor_b32 s16, s16, 98304
    s_cmp_eq_u32 s61, 0
    s_cselect_b32 s82, 0, 1
    s_mul_i32 s82, s82, 65536
    s_add_u32 s82, s82, s81
    s_add_u32 m0, s15, 0
    s_nop 0
    buffer_load_dwordx4 v1, s[8:11], s82 offen offset:0  lds
    buffer_load_dwordx4 v1, s[8:11], s82 offen offset:1024  lds
    buffer_load_dwordx4 v1, s[8:11], s82 offen offset:2048  lds
    buffer_load_dwordx4 v1, s[8:11], s82 offen offset:3072  lds
    s_add_u32 m0, s15, 4096
    s_nop 0
    buffer_load_dwordx4 v15, s[8:11], s82 offen offset:0  lds
    buffer_load_dwordx4 v15, s[8:11], s82 offen offset:1024  lds
    buffer_load_dwordx4 v15, s[8:11], s82 offen offset:2048  lds
    buffer_load_dwordx4 v15, s[8:11], s82 offen offset:3072  lds
    s_xor_b32 s15, s15, 196608
    s_waitcnt vmcnt(0) lgkmcnt(0)
    s_barrier
    ds_read_b128 a[128:131], v18 offset:0
    ds_read_b128 a[132:135], v18 offset:1024
    ds_read_b128 a[136:139], v18 offset:2048
    ds_read_b128 a[140:143], v18 offset:3072
    ds_read_b128 a[144:147], v18 offset:4096
    ds_read_b128 a[148:151], v18 offset:5120
    ds_read_b128 a[152:155], v18 offset:6144
    ds_read_b128 a[156:159], v18 offset:7168
    s_waitcnt lgkmcnt(0)
    s_branch L_t2_start
L_C2_slow_13:
    s_mov_b32 s99, 0
L_C2_slow_13_l:
    s_sleep 4
    buffer_load_dword v3, v4, s[8:11], s23 offen sc0 sc1
    s_add_u32 s99, s99, 1
    s_waitcnt vmcnt(0)
    v_cmp_ne_u32 vcc, 0, v3
    s_cmp_eq_u64 vcc, -1
    s_cbranch_scc1 L_C2_ok_14
    s_cmp_lt_u32 s99, 200000
    s_cbranch_scc1 L_C2_slow_13_l
    s_branch L_C2_ok_14
L_P1_slow_15:
    s_mov_b32 s14, 0xf000f000
    s_mov_b32 s15, 0xf000f000
    s_mov_b32 s99, 0
L_P2_l_5321:
    s_waitcnt vmcnt(0)
    v_max_u32 v48, v128, v129
    v_max3_u32 v48, v48, v130, v131
    v_max_u32 v49, v132, v133
    v_max3_u32 v49, v49, v134, v135
    v_max_u32 v50, v136, v137
    v_max3_u32 v50, v50, v138, v139
    v_max_u32 v51, v140, v141
    v_max3_u32 v51, v51, v142, v143
    v_max_u32 v52, v144, v145
    v_max3_u32 v52, v52, v146, v147
    v_max_u32 v53, v148, v149
    v_max3_u32 v53, v53, v150, v151
    v_max_u32 v54, v152, v153
    v_max3_u32 v54, v54, v154, v155
    v_max_u32 v55, v156, v157
    v_max3_u32 v55, v55, v158, v159
    v_max3_u32 v3, v48, v49, v50
    v_max3_u32 v3, v3, v51, v52
    v_max3_u32 v3, v3, v53, v54
    v_max_u32 v3, v3, v55
    v_cmp_eq_u32 vcc, -1, v3
    s_add_u32 s99, s99, 1
    s_cbranch_vccz L_P2_ok_5322
    s_cmp_ge_u32 s99, 200000
    s_cbranch_scc1 L_P2_ok_5322
    s_sleep 1
    v_cmp_eq_u32 vcc, -1, v48
    s_cbranch_vccz L_P2_s_5323
    s_and_b64 s[96:97], vcc, s[14:15]
    s_cselect_b64 exec, s[96:97], vcc
    s_add_u32 s74, s70, 0
    buffer_load_dwordx4 v[128:131], v44, s[8:11], s74 offen sc0 sc1
    s_mov_b64 exec, -1
L_P2_s_5323:
    v_cmp_eq_u32 vcc, -1, v49
    s_cbranch_vccz L_P2_s_5324
    s_and_b64 s[96:97], vcc, s[14:15]
    s_cselect_b64 exec, s[96:97], vcc
    s_add_u32 s74, s70, 4096
    buffer_load_dwordx4 v[132:135], v44, s[8:11], s74 offen sc0 sc1
    s_mov_b64 exec, -1
L_P2_s_5324:
    v_cmp_eq_u32 vcc, -1, v50
    s_cbranch_vccz L_P2_s_5325
    s_and_b64 s[96:97], vcc, s[14:15]
    s_cselect_b64 exec, s[96:97], vcc
    s_add_u32 s74, s70, 8192
    buffer_load_dwordx4 v[136:139], v44, s[8:11], s74 offen sc0 sc1
    s_mov_b64 exec, -1
L_P2_s_5325:
    v_cmp_eq_u32 vcc, -1, v51
    s_cbranch_vccz L_P2_s_5326
    s_and_b64 s[96:97], vcc, s[14:15]
    s_cselect_b64 exec, s[96:97], vcc
    s_add_u32 s74, s70, 12288
    buffer_load_dwordx4 v[140:143], v44, s[8:11], s74 offen sc0 sc1
    s_mov_b64 exec, -1
L_P2_s_5326:
    v_cmp_eq_u32 vcc, -1, v52
    s_cbranch_vccz L_P2_s_5327
    s_and_b64 s[96:97], vcc, s[14:15]
    s_cselect_b64 exec, s[96:97], vcc
    s_add_u32 s74, s70, 16384
    buffer_load_dwordx4 v[144:147], v44, s[8:11], s74 offen sc0 sc1
    s_mov_b64 exec, -1
L_P2_s_5327:
    v_cmp_eq_u32 vcc, -1, v53
    s_cbranch_vccz L_P2_s_5328
    s_and_b64 s[96:97], vcc, s[14:15]
    s_cselect_b64 exec, s[96:97], vcc
    s_add_u32 s74, s70, 20480
    buffer_load_dwordx4 v[148:151], v44, s[8:11], s74 offen sc0 sc1
    s_mov_b64 exec, -1
L_P2_s_5328:
    v_cmp_eq_u32 vcc, -1, v54
    s_cbranch_vccz L_P2_s_5329
    s_and_b64 s[96:97], vcc, s[14:15]
    s_cselect_b64 exec, s[96:97], vcc
    s_add_u32 s74, s70, 24576
    buffer_load_dwordx4 v[152:155], v44, s[8:11], s74 offen sc0 sc1
    s_mov_b64 exec, -1
L_P2_s_5329:
    v_cmp_eq_u32 vcc, -1, v55
    s_cbranch_vccz L_P2_s_5330
    s_and_b64 s[96:97], vcc, s[14:15]
    s_cselect_b64 exec, s[96:97], vcc
    s_add_u32 s74, s70, 28672
    buffer_load_dwordx4 v[156:159], v44, s[8:11], s74 offen sc0 sc1
    s_mov_b64 exec, -1
L_P2_s_5330:
    s_branch L_P2_l_5321
L_P2_ok_5322:
    s_branch L_P1_ok_16
L_code_end:
    s_endpgm
.section .rodata,"a"
.p2align 6
.amdhsa_kernel adaLN_cond__compressed_kv_cla__moe_arch_mod__prompt_kernel
  .amdhsa_next_free_vgpr 512
  .amdhsa_next_free_sgpr 102
  .amdhsa_accum_offset 256
  .amdhsa_group_segment_fixed_size 0
  .amdhsa_kernarg_size 128
  .amdhsa_user_sgpr_count 2
  .amdhsa_user_sgpr_kernarg_segment_ptr 1
  .amdhsa_system_sgpr_workgroup_id_x 1
.end_amdhsa_kernel
```

```asm
; @launch grid=(256,1,1) block=(256,1,1) lds=163840
.amdgcn_target "amdgcn-amd-amdhsa--gfx950"
.text
.globl adaLN_cond__compressed_kv_cla__moe_arch_mod__prompt_kernel
.p2align 8
.type adaLN_cond__compressed_kv_cla__moe_arch_mod__prompt_kernel,@function
adaLN_cond__compressed_kv_cla__moe_arch_mod__prompt_kernel:
    s_cmp_ge_u32 s2, 256
    s_cbranch_scc1 L_end
    s_load_dwordx16 s[64:79], s[0:1], 0
    s_load_dwordx16 s[80:95], s[0:1], 64
    s_getpc_b64 s[100:101]
L_pf1:
    v_lshrrev_b32 v3, 6, v0
    v_and_b32 v2, 63, v0
    s_lshr_b32 s5, s2, 3
    s_mul_i32 s98, s5, 24
    v_min_u32 v5, 5, v2
    v_mad_u32_u24 v5, v3, 6, v5
    v_add_u32 v5, s98, v5
    v_lshlrev_b32 v5, 7, v5
    v_min_u32 v5, L_code_end-L_pf1, v5
    global_load_dword a255, v5, s[100:101]
    v_readfirstlane_b32 s3, v3
    v_lshlrev_b32 v1, 4, v2
    s_and_b32 s4, s2, 7
    s_and_b32 s5, s5, 3
    s_lshr_b32 s6, s2, 5
    s_lshl_b32 s7, s4, 2
    s_add_u32 s7, s7, s5
    s_mov_b32 s60, s6
    s_sub_u32 s61, 15, s6
    v_lshrrev_b32 v3, 3, v2
    v_lshrrev_b32 v4, 4, v2
    v_and_b32 v5, 7, v2
    v_xor_b32 v5, v5, v4
    v_lshlrev_b32 v5, 4, v5
    v_lshl_add_u32 v16, v3, 10, v5
    v_xor_b32 v17, 64, v16
    v_add_u32 v17, 7168, v17
    v_add_u32 v18, 14336, v16
    v_add_u32 v19, 14336, v17
    v_bfe_u32 v5, v2, 1, 3
    v_xor_b32 v5, v5, v4
    v_lshlrev_b32 v5, 5, v5
    v_and_b32 v6, 1, v2
    v_lshl_add_u32 v5, v6, 4, v5
    v_lshl_add_u32 v20, v4, 13, v5
    v_add_u32 v21, 31744, v20
    v_xor_b32 v22, 128, v20
    v_add_u32 v22, 63488, v22
    v_add_u32 v23, 31744, v22
    s_lshl_b32 s62, s3, 13
    s_lshl_b32 s63, s3, 12
    s_lshl_b32 s96, s6, 18
    s_lshl_b32 s98, s3, 16
    s_add_u32 s96, s96, s98
    s_lshl_b32 s97, s3, 17
    s_lshl_b32 s99, s5, 0
    s_xor_b32 s99, s99, s6
    s_lshl_b32 s99, s99, 3
    s_and_b32 s99, s99, 7
    s_lshl_b32 s98, s99, 7
    s_add_u32 s96, s96, s98
    s_lshl_b32 s98, s99, 19
    s_add_u32 s97, s97, s98
    v_and_b32 v84, 7, v2
    v_lshrrev_b32 v65, 3, v0
    v_mul_u32_u24 v64, 24576, v65
    v_lshl_add_u32 v64, v84, 4, v64
    v_lshlrev_b32 v65, 3, v65
    v_lshrrev_b32 v85, 3, v2
    v_lshlrev_b32 v86, 10, v84
    v_lshl_add_u32 v86, v85, 4, v86
    s_lshl_b32 s100, s7, 8
    s_waitcnt lgkmcnt(0)
    s_add_u32 s16, s70, s100
    s_addc_u32 s17, s71, 0
    s_sub_u32 s18, 4194304, s100
    s_mov_b32 s19, 0x00020000
    s_mov_b32 s12, s66
    s_mov_b32 s13, s67
    s_mov_b32 s14, 2097152
    s_mov_b32 s15, 0x00020000
    s_add_u32 m0, s63, 98304
    s_xor_b32 s98, s97, 0
    buffer_load_dwordx4 v20, s[16:19], s98 offen offset:0   lds
    buffer_load_dwordx4 v21, s[16:19], s98 offen offset:1024   lds
    buffer_load_dwordx4 v22, s[16:19], s98 offen offset:2048   lds
    buffer_load_dwordx4 v23, s[16:19], s98 offen offset:3072   lds
    s_add_u32 m0, s62, 0
    s_xor_b32 s98, s96, 0
    buffer_load_dwordx4 v16, s[12:15], s98 offen offset:0   lds
    buffer_load_dwordx4 v17, s[12:15], s98 offen offset:1024   lds
    buffer_load_dwordx4 v18, s[12:15], s98 offen offset:2048   lds
    buffer_load_dwordx4 v19, s[12:15], s98 offen offset:3072   lds
    s_add_u32 m0, s62, 4096
    s_xor_b32 s98, s96, 32768
    buffer_load_dwordx4 v16, s[12:15], s98 offen offset:0   lds
    buffer_load_dwordx4 v17, s[12:15], s98 offen offset:1024   lds
    buffer_load_dwordx4 v18, s[12:15], s98 offen offset:2048   lds
    buffer_load_dwordx4 v19, s[12:15], s98 offen offset:3072   lds
    s_mov_b32 s40, s88
    s_mov_b32 s41, s89
    s_mov_b32 s42, 3145728
    s_mov_b32 s43, 0x00020000
    s_mov_b32 s44, s86
    s_mov_b32 s45, s87
    s_mov_b32 s46, 1024
    s_mov_b32 s47, 0x00020000
    s_mov_b32 s32, s64
    s_mov_b32 s33, s65
    s_mov_b32 s34, 2097152
    s_mov_b32 s35, 0x00020000
    s_mov_b32 s8, s94
    s_mov_b32 s9, s95
    s_mov_b32 s10, 268435456
    s_mov_b32 s11, 0x00020000
    s_add_u32 s20, s72, s100
    s_addc_u32 s21, s73, 0
    s_sub_u32 s22, 4194304, s100
    s_mov_b32 s23, 0x00020000
    s_add_u32 s24, s68, s100
    s_addc_u32 s25, s69, 0
    s_sub_u32 s26, 4194304, s100
    s_mov_b32 s27, 0x00020000
    s_mov_b32 s36, s92
    s_mov_b32 s37, s93
    s_mov_b32 s38, 256
    s_mov_b32 s39, 0x00020000
    s_lshl_b32 s100, s4, 19
    s_lshl_b32 s99, s5, 8
    s_add_u32 s100, s100, s99
    s_add_u32 s28, s74, s100
    s_addc_u32 s29, s75, 0
    s_sub_u32 s30, 4194304, s100
    s_mov_b32 s31, 0x00020000
    s_mov_b32 s48, s84
    s_mov_b32 s49, s85
    s_mov_b32 s50, 1835008
    s_mov_b32 s51, 0x00020000
    s_mov_b32 s52, s90
    s_mov_b32 s53, s91
    s_mov_b32 s54, 2097152
    s_mov_b32 s55, 0x00020000
    s_mov_b64 s[92:93], s[80:81]
    s_mov_b64 s[94:95], s[82:83]
    s_mov_b32 s56, s78
    s_mov_b32 s57, s79
    s_mov_b32 s58, 1024
    s_mov_b32 s59, 0x00020000
    s_load_dword s90, s[36:37], 64
    s_load_dword s91, s[8:9], 0x3f00
    s_lshl_b32 s64, s3, 19
    s_and_b32 s100, s97, 3670016
    s_xor_b32 s64, s64, s100
    s_lshr_b32 s100, s6, 1
    s_and_b32 s100, s100, 0
    s_lshl_b32 s1, s100, 12
    s_lshl_b32 s100, s100, 7
    s_add_u32 s64, s64, s100
    s_lshl_b32 s100, s5, 1
    s_xor_b32 s100, s100, s6
    s_and_b32 s100, s100, 0
    s_lshl_b32 s68, s100, 11
    s_lshl_b32 s100, s100, 19
    s_lshl_b32 s0, s3, 17
    s_add_u32 s0, s0, s100
    s_mul_i32 s81, s7, 1048576
    s_add_u32 s81, s81, 16777216
    s_mul_i32 s100, s6, 131072
    s_add_u32 s65, s81, s100
    s_lshr_b32 s100, s3, 1
    s_mul_i32 s100, s100, 65536
    s_add_u32 s65, s65, s100
    s_and_b32 s100, s3, 1
    s_lshl_b32 s100, s100, 14
    s_add_u32 s65, s65, s100
    s_add_u32 s81, s81, s62
    s_cmp_eq_u32 s60, 0
    s_cselect_b32 s82, 0, 1
    s_mul_i32 s82, s82, 65536
    s_add_u32 s82, s82, s81
    s_sub_u32 s100, s6, 2
    s_lshl_b32 s69, s100, 7
    s_lshl_b32 s100, s100, 3
    s_add_u32 s100, s100, s4
    s_lshl_b32 s100, s100, 8
    s_mul_i32 s101, s5, 12288
    s_add_u32 s100, s100, s101
    s_add_u32 s100, s100, 16384
    s_cmp_ge_u32 s6, 2
    s_cselect_b32 s66, s100, 2147479552
    s_cselect_b32 s69, s69, 2147479552
    s_cmp_eq_u32 s3, 0
    s_cselect_b32 s66, s66, 2147479552
    s_lshl_b32 s70, s3, 9
    s_add_u32 s70, s70, 16384
    s_lshr_b32 s71, s2, 1
    s_lshl_b32 s71, s71, 14
    s_and_b32 s100, s2, 1
    s_lshl_b32 s100, s100, 7
    s_add_u32 s71, s71, s100
    s_add_u32 s71, s71, s63
    s_add_u32 s71, s71, 2097152
    s_lshl_b32 s72, s2, 2
    s_add_u32 s72, s72, s3
    s_lshl_b32 s72, s72, 6
    s_add_u32 s72, s72, 1048576
    s_lshl_b32 s74, s7, 11
    s_add_u32 s74, s74, 1114112
    s_lshl_b32 s73, s6, 2
    s_add_u32 s73, s73, s3
    s_lshl_b32 s73, s73, 6
    s_add_u32 s73, s73, s74
    s_lshr_b32 s100, s3, 1
    s_sub_u32 s101, 3, s100
    s_and_b32 s98, s3, 1
    s_cselect_b32 s100, s101, s100
    s_lshl_b32 s75, s60, 2
    s_add_u32 s75, s75, s100
    s_lshl_b32 s76, s61, 2
    s_add_u32 s76, s76, s100
    s_sub_u32 s77, s76, s75
    s_lshl_b32 s77, s77, 10
    s_lshl_b32 s78, s75, 10
    s_add_u32 s78, s78, 983040
    s_lshl_b32 s75, s75, 15
    s_add_u32 s75, s75, 2097152
    s_add_u32 s75, s75, s68
    s_lshl_b32 s76, s76, 15
    s_add_u32 s76, s76, 2097152
    s_add_u32 s76, s76, s68
    s_add_u32 s1, s1, s65
    s_cmp_eq_u32 s3, 0
    s_cselect_b32 s68, 32, 0
    s_cselect_b32 s67, 0, 2147479552
    v_and_b32 v48, 15, v2
    v_lshrrev_b32 v49, 4, v2
    v_lshrrev_b32 v50, 1, v48
    v_xor_b32 v50, v50, v49
    v_lshlrev_b32 v50, 4, v50
    v_lshl_add_u32 v28, v48, 7, v50
    v_add_u32 v28, s62, v28
    v_xor_b32 v29, 64, v28
    v_add_u32 v30, 65536, v28
    v_add_u32 v31, 65536, v29
    v_lshrrev_b32 v50, 2, v48
    v_and_b32 v51, 3, v48
    v_lshl_add_u32 v52, v49, 3, v50
    v_lshlrev_b32 v53, 8, v52
    v_lshl_add_u32 v53, v51, 3, v53
    v_add_u32 v53, 98304, v53
    v_and_b32 v54, 1, v49
    v_lshl_add_u32 v54, v54, 2, v50
    v_xor_b32 v55, 0, v54
    v_lshl_add_u32 v8, v55, 5, v53
    v_xor_b32 v55, 1, v54
    v_lshl_add_u32 v9, v55, 5, v53
    v_xor_b32 v55, 2, v54
    v_lshl_add_u32 v10, v55, 5, v53
    v_xor_b32 v55, 3, v54
    v_lshl_add_u32 v11, v55, 5, v53
    v_xor_b32 v55, 4, v54
    v_lshl_add_u32 v12, v55, 5, v53
    v_xor_b32 v55, 5, v54
    v_lshl_add_u32 v13, v55, 5, v53
    v_xor_b32 v55, 6, v54
    v_lshl_add_u32 v14, v55, 5, v53
    v_xor_b32 v55, 7, v54
    v_lshl_add_u32 v15, v55, 5, v53
    v_bfe_u32 v49, v2, 1, 2
    v_bfe_u32 v50, v2, 4, 1
    v_xor_b32 v49, v49, v50
    v_lshlrev_b32 v49, 5, v49
    v_and_b32 v50, 1, v2
    v_lshl_add_u32 v49, v50, 4, v49
    v_lshl_add_u32 v24, v85, 13, v49
    v_xor_b32 v25, 64, v24
    v_add_u32 v25, 64512, v25
    v_add_u32 v26, 129024, v24
    v_add_u32 v27, 129024, v25
    v_cmp_eq_u32 vcc, 0, v2
    v_mov_b32 v6, 2147479552
    s_nop 0
    v_cndmask_b32 v5, v6, v2, vcc
    v_cmp_eq_u32 vcc, 0, v0
    s_nop 1
    v_cndmask_b32 v7, v6, v0, vcc
    v_and_b32 v48, 8, v2
    v_cmp_eq_u32 vcc, 0, v48
    v_lshlrev_b32 v48, 5, v84
    v_lshrrev_b32 v49, 1, v2
    v_and_b32 v49, 24, v49
    v_add_u32 v48, v48, v49
    s_lshl_b32 s100, s3, 8
    s_add_u32 s100, s100, 147456
    v_add_u32 v48, s100, v48
    v_mov_b32 v49, 148480
    v_cndmask_b32 v98, v49, v48, vcc
    v_lshlrev_b32 v99, 5, v84
    v_add_u32 v99, 149504, v99
    s_lshl_b32 s100, s3, 3
    v_add_u32 v100, s100, v99
    v_lshlrev_b32 v106, 5, v85
    v_lshlrev_b32 v107, 8, v85
    v_lshl_add_u32 v107, v84, 4, v107
    s_sub_u32 s100, s2, 64
    s_lshl_b32 s80, s100, 12
    s_add_u32 s80, s80, 1048576
    s_cmp_lt_u32 s100, 64
    s_cselect_b32 s80, s80, 2147479552
    s_mul_i32 s99, s5, 786432
    s_sub_u32 s79, s6, 2
    s_lshl_b32 s79, s79, 3
    s_add_u32 s79, s79, s4
    s_lshl_b32 s79, s79, 7
    s_add_u32 s79, s79, s99
    s_cmp_ge_u32 s6, 2
    s_cselect_b32 s79, s79, 2147414016
    s_lshl_b32 s100, s5, 8
    v_add_u32 v65, s100, v65
    v_mov_b32 v6, 1
    v_and_b32 v4, 1, v2
    v_lshlrev_b32 v4, 7, v4
    buffer_load_dwordx2 v[66:67], v65, s[44:47], 0 offen
    buffer_load_dwordx4 v[68:71], v64, s[40:43], s79 offen
    s_add_u32 s79, s79, 6144
    buffer_load_dwordx4 v[72:75], v64, s[40:43], s79 offen
    s_add_u32 s79, s79, 6144
    buffer_load_dwordx4 v[76:79], v64, s[40:43], s79 offen
    s_add_u32 s79, s79, 6144
    buffer_load_dwordx4 v[80:83], v64, s[40:43], s79 offen
    s_lshl_b32 s79, s2, 5
    s_add_u32 s79, s79, s3
    s_lshl_b32 s79, s79, 8
    buffer_load_dwordx4 v[88:91], v86, s[32:35], s79 offen
    buffer_load_dwordx4 v[92:95], v86, s[32:35], s79 offen offset:128
    s_add_u32 m0, s63, 114688
    s_xor_b32 s98, s97, 524288
    buffer_load_dwordx4 v20, s[16:19], s98 offen offset:0   lds
    buffer_load_dwordx4 v21, s[16:19], s98 offen offset:1024   lds
    buffer_load_dwordx4 v22, s[16:19], s98 offen offset:2048   lds
    buffer_load_dwordx4 v23, s[16:19], s98 offen offset:3072   lds
    s_add_u32 m0, s62, 32768
    s_xor_b32 s98, s96, 128
    buffer_load_dwordx4 v16, s[12:15], s98 offen offset:0   lds
    buffer_load_dwordx4 v17, s[12:15], s98 offen offset:1024   lds
    buffer_load_dwordx4 v18, s[12:15], s98 offen offset:2048   lds
    buffer_load_dwordx4 v19, s[12:15], s98 offen offset:3072   lds
    s_add_u32 m0, s62, 36864
    s_xor_b32 s98, s96, 32896
    buffer_load_dwordx4 v16, s[12:15], s98 offen offset:0   lds
    buffer_load_dwordx4 v17, s[12:15], s98 offen offset:1024   lds
    buffer_load_dwordx4 v18, s[12:15], s98 offen offset:2048   lds
    buffer_load_dwordx4 v19, s[12:15], s98 offen offset:3072   lds
    s_waitcnt vmcnt(19) lgkmcnt(0)
    s_barrier
    ds_read_b64_tr_b16 v[32:33], v8 offset:0
    ds_read_b64_tr_b16 v[34:35], v8 offset:1024
    ds_read_b128 a[0:3], v28 offset:0
    ds_read_b128 a[4:7], v28 offset:2048
    ds_read_b128 a[8:11], v28 offset:4096
    ds_read_b128 a[12:15], v28 offset:6144
    ds_read_b64_tr_b16 v[36:37], v9 offset:0
    ds_read_b64_tr_b16 v[38:39], v9 offset:1024
    ds_read_b64_tr_b16 v[40:41], v10 offset:0
    ds_read_b64_tr_b16 v[42:43], v10 offset:1024
    ds_read_b64_tr_b16 v[44:45], v11 offset:0
    ds_read_b64_tr_b16 v[46:47], v11 offset:1024
    ds_read_b64_tr_b16 v[48:49], v12 offset:0
    ds_read_b64_tr_b16 v[50:51], v12 offset:1024
    ds_read_b64_tr_b16 v[52:53], v13 offset:0
    ds_read_b64_tr_b16 v[54:55], v13 offset:1024
    ds_read_b64_tr_b16 v[56:57], v14 offset:0
    ds_read_b64_tr_b16 v[58:59], v14 offset:1024
    ds_read_b64_tr_b16 v[60:61], v15 offset:0
    ds_read_b64_tr_b16 v[62:63], v15 offset:1024
    s_waitcnt lgkmcnt(15)
    v_mfma_f32_16x16x32_bf16 v[128:131], v[32:35], a[0:3], 0
    v_mfma_f32_16x16x32_bf16 v[160:163], v[32:35], a[4:7], 0
    v_mfma_f32_16x16x32_bf16 v[192:195], v[32:35], a[8:11], 0
    s_waitcnt lgkmcnt(14)
    s_add_u32 m0, s63, 131072
    s_xor_b32 s98, s97, 1048576
    ds_read_b128 a[16:19], v29 offset:0
    v_mfma_f32_16x16x32_bf16 v[224:227], v[32:35], a[12:15], 0
    s_waitcnt lgkmcnt(13)
    ds_read_b128 a[20:23], v29 offset:2048
    v_mfma_f32_16x16x32_bf16 v[132:135], v[36:39], a[0:3], 0
    ds_read_b64_tr_b16 v[32:33], v8 offset:8192
    v_mfma_f32_16x16x32_bf16 v[164:167], v[36:39], a[4:7], 0
    ds_read_b64_tr_b16 v[34:35], v8 offset:9216
    v_mfma_f32_16x16x32_bf16 v[196:199], v[36:39], a[8:11], 0
    ds_read_b128 a[24:27], v29 offset:4096
    v_mfma_f32_16x16x32_bf16 v[228:231], v[36:39], a[12:15], 0
    s_waitcnt lgkmcnt(15)
    ds_read_b128 a[28:31], v29 offset:6144
    v_mfma_f32_16x16x32_bf16 v[136:139], v[40:43], a[0:3], 0
    ds_read_b64_tr_b16 v[36:37], v9 offset:8192
    v_mfma_f32_16x16x32_bf16 v[168:171], v[40:43], a[4:7], 0
    s_waitcnt lgkmcnt(7)
    ds_read_b64_tr_b16 v[38:39], v9 offset:9216
    v_mfma_f32_16x16x32_bf16 v[200:203], v[40:43], a[8:11], 0
    buffer_load_dwordx4 v20, s[16:19], s98 offen offset:0   lds
    v_mfma_f32_16x16x32_bf16 v[232:235], v[40:43], a[12:15], 0
    buffer_load_dwordx4 v21, s[16:19], s98 offen offset:1024   lds
    v_mfma_f32_16x16x32_bf16 v[140:143], v[44:47], a[0:3], 0
    ds_read_b64_tr_b16 v[40:41], v10 offset:8192
    v_mfma_f32_16x16x32_bf16 v[172:175], v[44:47], a[4:7], 0
    ds_read_b64_tr_b16 v[42:43], v10 offset:9216
    v_mfma_f32_16x16x32_bf16 v[204:207], v[44:47], a[8:11], 0
    buffer_load_dwordx4 v22, s[16:19], s98 offen offset:2048   lds
    v_mfma_f32_16x16x32_bf16 v[236:239], v[44:47], a[12:15], 0
    buffer_load_dwordx4 v23, s[16:19], s98 offen offset:3072   lds
    v_mfma_f32_16x16x32_bf16 v[144:147], v[48:51], a[0:3], 0
    s_add_u32 m0, s62, 65536
    s_xor_b32 s98, s96, 256
    ds_read_b64_tr_b16 v[44:45], v11 offset:8192
    v_mfma_f32_16x16x32_bf16 v[176:179], v[48:51], a[4:7], 0
    ds_read_b64_tr_b16 v[46:47], v11 offset:9216
    v_mfma_f32_16x16x32_bf16 v[208:211], v[48:51], a[8:11], 0
    buffer_load_dwordx4 v16, s[12:15], s98 offen offset:0   lds
    v_mfma_f32_16x16x32_bf16 v[240:243], v[48:51], a[12:15], 0
    buffer_load_dwordx4 v17, s[12:15], s98 offen offset:1024   lds
    v_mfma_f32_16x16x32_bf16 v[148:151], v[52:55], a[0:3], 0
    ds_read_b64_tr_b16 v[48:49], v12 offset:8192
    v_mfma_f32_16x16x32_bf16 v[180:183], v[52:55], a[4:7], 0
    ds_read_b64_tr_b16 v[50:51], v12 offset:9216
    v_mfma_f32_16x16x32_bf16 v[212:215], v[52:55], a[8:11], 0
    buffer_load_dwordx4 v18, s[12:15], s98 offen offset:2048   lds
    v_mfma_f32_16x16x32_bf16 v[244:247], v[52:55], a[12:15], 0
    buffer_load_dwordx4 v19, s[12:15], s98 offen offset:3072   lds
    v_mfma_f32_16x16x32_bf16 v[152:155], v[56:59], a[0:3], 0
    s_add_u32 m0, s62, 69632
    s_xor_b32 s98, s96, 33024
    ds_read_b64_tr_b16 v[52:53], v13 offset:8192
    v_mfma_f32_16x16x32_bf16 v[184:187], v[56:59], a[4:7], 0
    ds_read_b64_tr_b16 v[54:55], v13 offset:9216
    v_mfma_f32_16x16x32_bf16 v[216:219], v[56:59], a[8:11], 0
    buffer_load_dwordx4 v16, s[12:15], s98 offen offset:0   lds
    v_mfma_f32_16x16x32_bf16 v[248:251], v[56:59], a[12:15], 0
    buffer_load_dwordx4 v17, s[12:15], s98 offen offset:1024   lds
    v_mfma_f32_16x16x32_bf16 v[156:159], v[60:63], a[0:3], 0
    ds_read_b64_tr_b16 v[56:57], v14 offset:8192
    v_mfma_f32_16x16x32_bf16 v[188:191], v[60:63], a[4:7], 0
    s_waitcnt lgkmcnt(5)
    ds_read_b64_tr_b16 v[58:59], v14 offset:9216
    v_mfma_f32_16x16x32_bf16 v[220:223], v[60:63], a[8:11], 0
    buffer_load_dwordx4 v18, s[12:15], s98 offen offset:2048   lds
    v_mfma_f32_16x16x32_bf16 v[252:255], v[60:63], a[12:15], 0
    buffer_load_dwordx4 v19, s[12:15], s98 offen offset:3072   lds
    v_mfma_f32_16x16x32_bf16 v[128:131], v[32:35], a[16:19], v[128:131]
    ds_read_b64_tr_b16 v[60:61], v15 offset:8192
    v_mfma_f32_16x16x32_bf16 v[160:163], v[32:35], a[20:23], v[160:163]
    ds_read_b64_tr_b16 v[62:63], v15 offset:9216
    v_mfma_f32_16x16x32_bf16 v[192:195], v[32:35], a[24:27], v[192:195]
    v_mfma_f32_16x16x32_bf16 v[224:227], v[32:35], a[28:31], v[224:227]
    v_mfma_f32_16x16x32_bf16 v[132:135], v[36:39], a[16:19], v[132:135]
    v_mfma_f32_16x16x32_bf16 v[164:167], v[36:39], a[20:23], v[164:167]
    v_mfma_f32_16x16x32_bf16 v[196:199], v[36:39], a[24:27], v[196:199]
    v_mfma_f32_16x16x32_bf16 v[228:231], v[36:39], a[28:31], v[228:231]
    v_mfma_f32_16x16x32_bf16 v[136:139], v[40:43], a[16:19], v[136:139]
    s_waitcnt vmcnt(12) lgkmcnt(0)
    s_barrier
    v_mfma_f32_16x16x32_bf16 v[168:171], v[40:43], a[20:23], v[168:171]
    s_add_u32 m0, s63, 98304
    s_xor_b32 s98, s97, 1572864
    ds_read_b64_tr_b16 v[32:33], v8 offset:16384
    v_lshlrev_b32 v102, 16, v66
    v_and_b32 v103, 0xffff0000, v66
    v_lshlrev_b32 v104, 16, v67
    v_mfma_f32_16x16x32_bf16 v[200:203], v[40:43], a[24:27], v[200:203]
    ds_read_b64_tr_b16 v[34:35], v8 offset:17408
    v_and_b32 v105, 0xffff0000, v67
    v_mul_f32 v108, 0xbfb8aa3b, v102
    v_mul_f32 v109, 0xbfb8aa3b, v103
    v_mfma_f32_16x16x32_bf16 v[232:235], v[40:43], a[28:31], v[232:235]
    ds_read_b64_tr_b16 v[36:37], v9 offset:16384
    v_mul_f32 v110, 0xbfb8aa3b, v104
    v_mul_f32 v111, 0xbfb8aa3b, v105
    v_mfma_f32_16x16x32_bf16 v[140:143], v[44:47], a[16:19], v[140:143]
    ds_read_b64_tr_b16 v[38:39], v9 offset:17408
    v_exp_f32 v108, v108
    v_mfma_f32_16x16x32_bf16 v[172:175], v[44:47], a[20:23], v[172:175]
    ds_read_b64_tr_b16 v[40:41], v10 offset:16384
    v_exp_f32 v109, v109
    v_mfma_f32_16x16x32_bf16 v[204:207], v[44:47], a[24:27], v[204:207]
    ds_read_b64_tr_b16 v[42:43], v10 offset:17408
    v_exp_f32 v110, v110
    v_mfma_f32_16x16x32_bf16 v[236:239], v[44:47], a[28:31], v[236:239]
    ds_read_b128 a[32:35], v28 offset:32768
    v_exp_f32 v111, v111
    v_add_f32 v108, 1.0, v108
    v_mfma_f32_16x16x32_bf16 v[144:147], v[48:51], a[16:19], v[144:147]
    ds_read_b64_tr_b16 v[44:45], v11 offset:16384
    v_add_f32 v109, 1.0, v109
    v_add_f32 v110, 1.0, v110
    v_add_f32 v111, 1.0, v111
    v_mfma_f32_16x16x32_bf16 v[176:179], v[48:51], a[20:23], v[176:179]
    ds_read_b64_tr_b16 v[46:47], v11 offset:17408
    v_rcp_f32 v108, v108
    v_mfma_f32_16x16x32_bf16 v[208:211], v[48:51], a[24:27], v[208:211]
    ds_read_b128 a[36:39], v28 offset:34816
    v_mov_b32 v112, 0
    v_rcp_f32 v109, v109
    v_mfma_f32_16x16x32_bf16 v[240:243], v[48:51], a[28:31], v[240:243]
    ds_read_b128 a[40:43], v28 offset:36864
    v_mov_b32 v113, 0
    v_rcp_f32 v110, v110
    v_mfma_f32_16x16x32_bf16 v[148:151], v[52:55], a[16:19], v[148:151]
    ds_read_b64_tr_b16 v[48:49], v12 offset:16384
    v_mov_b32 v114, 0
    v_rcp_f32 v111, v111
    v_mfma_f32_16x16x32_bf16 v[180:183], v[52:55], a[20:23], v[180:183]
    ds_read_b64_tr_b16 v[50:51], v12 offset:17408
    v_mov_b32 v115, 0
    v_mul_f32 v102, v102, v108
    v_mul_f32 v103, v103, v109
    v_mfma_f32_16x16x32_bf16 v[212:215], v[52:55], a[24:27], v[212:215]
    ds_read_b128 a[44:47], v28 offset:38912
    v_lshlrev_b32 v116, 4, v0
    v_mul_f32 v104, v104, v110
    v_mul_f32 v105, v105, v111
    v_mfma_f32_16x16x32_bf16 v[244:247], v[52:55], a[28:31], v[244:247]
    buffer_load_dwordx4 v20, s[16:19], s98 offen offset:0   lds
    v_cvt_pk_bf16_f32 v108, v102, v103
    v_cvt_pk_bf16_f32 v109, v104, v105
    v_mfma_f32_16x16x32_bf16 v[152:155], v[56:59], a[16:19], v[152:155]
    ds_read_b64_tr_b16 v[52:53], v13 offset:16384
    v_lshlrev_b32 v102, 16, v108
    v_and_b32 v103, 0xffff0000, v108
    v_lshlrev_b32 v104, 16, v109
    v_mfma_f32_16x16x32_bf16 v[184:187], v[56:59], a[20:23], v[184:187]
    ds_read_b64_tr_b16 v[54:55], v13 offset:17408
    v_and_b32 v105, 0xffff0000, v109
    v_lshlrev_b32 v108, 16, v68
    v_and_b32 v109, 0xffff0000, v68
    v_mfma_f32_16x16x32_bf16 v[216:219], v[56:59], a[24:27], v[216:219]
    buffer_load_dwordx4 v21, s[16:19], s98 offen offset:1024   lds
    v_mul_f32 v120, v108, v102
    v_mul_f32 v121, v109, v102
    v_mfma_f32_16x16x32_bf16 v[248:251], v[56:59], a[28:31], v[248:251]
    buffer_store_dwordx4 v[112:115], v116, s[8:11], s80 offen sc0 sc1
    v_lshlrev_b32 v110, 16, v69
    v_and_b32 v111, 0xffff0000, v69
    v_mfma_f32_16x16x32_bf16 v[156:159], v[60:63], a[16:19], v[156:159]
    ds_read_b64_tr_b16 v[56:57], v14 offset:16384
    v_lshlrev_b32 v117, 13, v2
    v_mul_f32 v122, v110, v102
    v_mul_f32 v123, v111, v102
    v_mfma_f32_16x16x32_bf16 v[188:191], v[60:63], a[20:23], v[188:191]
    s_lshl_b32 s100, s6, 19
    s_and_b32 s101, s3, 1
    ds_read_b64_tr_b16 v[58:59], v14 offset:17408
    v_lshlrev_b32 v108, 16, v70
    v_and_b32 v109, 0xffff0000, v70
    v_mul_f32 v124, v108, v102
    v_mfma_f32_16x16x32_bf16 v[220:223], v[60:63], a[24:27], v[220:223]
    buffer_load_dwordx4 v22, s[16:19], s98 offen offset:2048   lds
    v_mul_f32 v125, v109, v102
    v_lshlrev_b32 v110, 16, v71
    v_mfma_f32_16x16x32_bf16 v[252:255], v[60:63], a[28:31], v[252:255]
    s_waitcnt lgkmcnt(5)
    s_lshl_b32 s101, s101, 7
    s_add_u32 s100, s100, s101
    v_min_u32 v116, 496, v116
    v_and_b32 v111, 0xffff0000, v71
    v_mul_f32 v126, v110, v102
    v_mul_f32 v127, v111, v102
    v_mfma_f32_16x16x32_bf16 v[128:131], v[32:35], a[32:35], v[128:131]
    s_sub_u32 s80, s80, 1048576
    s_lshr_b32 s80, s80, 3
    ds_read_b64_tr_b16 v[60:61], v15 offset:16384
    v_lshlrev_b32 v108, 16, v72
    v_and_b32 v109, 0xffff0000, v72
    v_fmac_f32 v120, v108, v103
    v_mfma_f32_16x16x32_bf16 v[160:163], v[32:35], a[36:39], v[160:163]
    s_add_u32 s80, s80, 1310720
    s_cmp_lt_u32 s80, 1343488
    s_cselect_b32 s80, s80, 2147479552
    ds_read_b64_tr_b16 v[62:63], v15 offset:17408
    v_fmac_f32 v121, v109, v103
    v_lshlrev_b32 v110, 16, v73
    v_and_b32 v111, 0xffff0000, v73
    v_mfma_f32_16x16x32_bf16 v[192:195], v[32:35], a[40:43], v[192:195]
    s_waitcnt lgkmcnt(5)
    ds_read_b128 a[48:51], v29 offset:32768
    v_fmac_f32 v122, v110, v103
    v_fmac_f32 v123, v111, v103
    v_lshlrev_b32 v108, 16, v74
    v_mfma_f32_16x16x32_bf16 v[224:227], v[32:35], a[44:47], v[224:227]
    ds_read_b128 a[52:55], v29 offset:34816
    v_and_b32 v109, 0xffff0000, v74
    v_fmac_f32 v124, v108, v103
    v_fmac_f32 v125, v109, v103
    v_mfma_f32_16x16x32_bf16 v[132:135], v[36:39], a[32:35], v[132:135]
    ds_read_b64_tr_b16 v[32:33], v8 offset:24576
    v_lshlrev_b32 v110, 16, v75
    v_and_b32 v111, 0xffff0000, v75
    v_fmac_f32 v126, v110, v103
    v_mfma_f32_16x16x32_bf16 v[164:167], v[36:39], a[36:39], v[164:167]
    ds_read_b64_tr_b16 v[34:35], v8 offset:25600
    v_fmac_f32 v127, v111, v103
    v_lshlrev_b32 v108, 16, v76
    v_and_b32 v109, 0xffff0000, v76
    v_mfma_f32_16x16x32_bf16 v[196:199], v[36:39], a[40:43], v[196:199]
    ds_read_b128 a[56:59], v29 offset:36864
    v_fmac_f32 v120, v108, v104
    v_fmac_f32 v121, v109, v104
    v_lshlrev_b32 v110, 16, v77
    v_mfma_f32_16x16x32_bf16 v[228:231], v[36:39], a[44:47], v[228:231]
    ds_read_b128 a[60:63], v29 offset:38912
    v_and_b32 v111, 0xffff0000, v77
    v_fmac_f32 v122, v110, v104
    v_fmac_f32 v123, v111, v104
    v_mfma_f32_16x16x32_bf16 v[136:139], v[40:43], a[32:35], v[136:139]
    ds_read_b64_tr_b16 v[36:37], v9 offset:24576
    v_lshlrev_b32 v108, 16, v78
    v_and_b32 v109, 0xffff0000, v78
    v_fmac_f32 v124, v108, v104
    v_mfma_f32_16x16x32_bf16 v[168:171], v[40:43], a[36:39], v[168:171]
    ds_read_b64_tr_b16 v[38:39], v9 offset:25600
    v_fmac_f32 v125, v109, v104
    v_lshlrev_b32 v110, 16, v79
    v_and_b32 v111, 0xffff0000, v79
    v_mfma_f32_16x16x32_bf16 v[200:203], v[40:43], a[40:43], v[200:203]
    buffer_load_dwordx4 v23, s[16:19], s98 offen offset:3072   lds
    v_fmac_f32 v126, v110, v104
    v_fmac_f32 v127, v111, v104
    v_mfma_f32_16x16x32_bf16 v[232:235], v[40:43], a[44:47], v[232:235]
    buffer_store_dwordx4 v[112:115], v116, s[8:11], s80 offen sc0 sc1
    v_lshlrev_b32 v108, 16, v80
    v_and_b32 v109, 0xffff0000, v80
    v_mfma_f32_16x16x32_bf16 v[140:143], v[44:47], a[32:35], v[140:143]
    s_add_u32 m0, s62, 0
    s_xor_b32 s98, s96, 384
    ds_read_b64_tr_b16 v[40:41], v10 offset:24576
    v_fmac_f32 v120, v108, v105
    v_fmac_f32 v121, v109, v105
    v_lshlrev_b32 v110, 16, v81
    v_mfma_f32_16x16x32_bf16 v[172:175], v[44:47], a[36:39], v[172:175]
    ds_read_b64_tr_b16 v[42:43], v10 offset:25600
    v_and_b32 v111, 0xffff0000, v81
    v_fmac_f32 v122, v110, v105
    v_fmac_f32 v123, v111, v105
    v_mfma_f32_16x16x32_bf16 v[204:207], v[44:47], a[40:43], v[204:207]
    buffer_load_dwordx4 v16, s[12:15], s98 offen offset:0   lds
    v_lshlrev_b32 v108, 16, v82
    v_and_b32 v109, 0xffff0000, v82
    v_mfma_f32_16x16x32_bf16 v[236:239], v[44:47], a[44:47], v[236:239]
    v_fmac_f32 v124, v108, v105
    v_fmac_f32 v125, v109, v105
    v_lshlrev_b32 v110, 16, v83
    v_and_b32 v111, 0xffff0000, v83
    v_mfma_f32_16x16x32_bf16 v[144:147], v[48:51], a[32:35], v[144:147]
    ds_read_b64_tr_b16 v[44:45], v11 offset:24576
    v_fmac_f32 v126, v110, v105
    v_fmac_f32 v127, v111, v105
    v_permlane32_swap_b32 v120, v124
    v_mfma_f32_16x16x32_bf16 v[176:179], v[48:51], a[36:39], v[176:179]
    ds_read_b64_tr_b16 v[46:47], v11 offset:25600
    v_permlane32_swap_b32 v121, v125
    v_permlane32_swap_b32 v122, v126
    v_permlane32_swap_b32 v123, v127
    v_mfma_f32_16x16x32_bf16 v[208:211], v[48:51], a[40:43], v[208:211]
    buffer_load_dwordx4 v17, s[12:15], s98 offen offset:1024   lds
    v_add_f32 v120, v120, v124
    v_add_f32 v121, v121, v125
    v_mfma_f32_16x16x32_bf16 v[240:243], v[48:51], a[44:47], v[240:243]
    s_waitcnt lgkmcnt(4)
    v_add_f32 v122, v122, v126
    v_add_f32 v123, v123, v127
    s_nop 0
    v_permlane16_swap_b32 v120, v122
    v_permlane16_swap_b32 v121, v123
    v_mfma_f32_16x16x32_bf16 v[148:151], v[52:55], a[32:35], v[148:151]
    ds_read_b64_tr_b16 v[48:49], v12 offset:24576
    v_add_f32 v120, v120, v122
    v_add_f32 v121, v121, v123
    s_nop 0
    v_add_f32_dpp v120, v120, v120 row_ror:8 row_mask:0xf bank_mask:0xf
    v_mfma_f32_16x16x32_bf16 v[180:183], v[52:55], a[36:39], v[180:183]
    ds_read_b64_tr_b16 v[50:51], v12 offset:25600
    v_add_f32_dpp v121, v121, v121 row_ror:8 row_mask:0xf bank_mask:0xf
    v_mfma_f32_16x16x32_bf16 v[212:215], v[52:55], a[40:43], v[212:215]
    buffer_load_dwordx4 v18, s[12:15], s98 offen offset:2048   lds
    ds_write_b64 v98, v[120:121]
    v_mfma_f32_16x16x32_bf16 v[244:247], v[52:55], a[44:47], v[244:247]
    v_mfma_f32_16x16x32_bf16 v[152:155], v[56:59], a[32:35], v[152:155]
    ds_read_b64_tr_b16 v[52:53], v13 offset:24576
    v_lshlrev_b32 v64, 16, v88
    v_mfma_f32_16x16x32_bf16 v[184:187], v[56:59], a[36:39], v[184:187]
    ds_read_b64_tr_b16 v[54:55], v13 offset:25600
    v_and_b32 v65, 0xffff0000, v88
    v_mfma_f32_16x16x32_bf16 v[216:219], v[56:59], a[40:43], v[216:219]
    buffer_load_dwordx4 v19, s[12:15], s98 offen offset:3072   lds
    v_mfma_f32_16x16x32_bf16 v[248:251], v[56:59], a[44:47], v[248:251]
    v_lshlrev_b32 v66, 16, v89
    v_and_b32 v67, 0xffff0000, v89
    v_mfma_f32_16x16x32_bf16 v[156:159], v[60:63], a[32:35], v[156:159]
    s_add_u32 m0, s62, 4096
    s_xor_b32 s98, s96, 33152
    ds_read_b64_tr_b16 v[56:57], v14 offset:24576
    v_mfma_f32_16x16x32_bf16 v[188:191], v[60:63], a[36:39], v[188:191]
    ds_read_b64_tr_b16 v[58:59], v14 offset:25600
    v_lshlrev_b32 v68, 16, v90
    v_mfma_f32_16x16x32_bf16 v[220:223], v[60:63], a[40:43], v[220:223]
    buffer_load_dwordx4 v16, s[12:15], s98 offen offset:0   lds
    v_mfma_f32_16x16x32_bf16 v[252:255], v[60:63], a[44:47], v[252:255]
    v_and_b32 v69, 0xffff0000, v90
    v_lshlrev_b32 v70, 16, v91
    v_mfma_f32_16x16x32_bf16 v[128:131], v[32:35], a[48:51], v[128:131]
    ds_read_b64_tr_b16 v[60:61], v15 offset:24576
    v_and_b32 v71, 0xffff0000, v91
    v_mfma_f32_16x16x32_bf16 v[160:163], v[32:35], a[52:55], v[160:163]
    ds_read_b64_tr_b16 v[62:63], v15 offset:25600
    v_lshlrev_b32 v72, 16, v92
    v_mfma_f32_16x16x32_bf16 v[192:195], v[32:35], a[56:59], v[192:195]
    buffer_load_dwordx4 v17, s[12:15], s98 offen offset:1024   lds
    v_mfma_f32_16x16x32_bf16 v[224:227], v[32:35], a[60:63], v[224:227]
    v_and_b32 v73, 0xffff0000, v92
    v_lshlrev_b32 v74, 16, v93
    v_mfma_f32_16x16x32_bf16 v[132:135], v[36:39], a[48:51], v[132:135]
    buffer_load_dwordx4 v18, s[12:15], s98 offen offset:2048   lds
    v_mfma_f32_16x16x32_bf16 v[164:167], v[36:39], a[52:55], v[164:167]
    v_and_b32 v75, 0xffff0000, v93
    v_lshlrev_b32 v76, 16, v94
    v_mfma_f32_16x16x32_bf16 v[196:199], v[36:39], a[56:59], v[196:199]
    buffer_load_dwordx4 v19, s[12:15], s98 offen offset:3072   lds
    s_cmp_eq_u32 s3, 0
    s_cselect_b32 s101, s100, 2147479552
    buffer_load_dword a241, v117, s[20:23], s101 offen offset:4
    v_mfma_f32_16x16x32_bf16 v[228:231], v[36:39], a[60:63], v[228:231]
    s_waitcnt lgkmcnt(2)
    v_and_b32 v77, 0xffff0000, v94
    v_lshlrev_b32 v78, 16, v95
    s_waitcnt vmcnt(9)
    v_mfma_f32_16x16x32_bf16 v[136:139], v[40:43], a[48:51], v[136:139]
    v_and_b32 v79, 0xffff0000, v95
    v_add_f32 v108, v64, v65
    s_waitcnt lgkmcnt(0)
    s_barrier
    v_mfma_f32_16x16x32_bf16 v[168:171], v[40:43], a[52:55], v[168:171]
    s_add_u32 m0, s63, 114688
    s_xor_b32 s98, s97, 2097152
    ds_read_b64_tr_b16 v[32:33], v8 offset:32768
    v_lshrrev_b32 v87, 2, v1
    v_add_u32 v101, 147456, v87
    v_mfma_f32_16x16x32_bf16 v[200:203], v[40:43], a[56:59], v[200:203]
    ds_read_b64_tr_b16 v[34:35], v8 offset:33792
    ds_read_b32 v102, v101
    v_mfma_f32_16x16x32_bf16 v[232:235], v[40:43], a[60:63], v[232:235]
    ds_read_b64_tr_b16 v[36:37], v9 offset:32768
    ds_read_b32 v103, v101 offset:256
    v_mfma_f32_16x16x32_bf16 v[140:143], v[44:47], a[48:51], v[140:143]
    ds_read_b64_tr_b16 v[38:39], v9 offset:33792
    ds_read_b32 v104, v101 offset:512
    v_mfma_f32_16x16x32_bf16 v[172:175], v[44:47], a[52:55], v[172:175]
    ds_read_b64_tr_b16 v[40:41], v10 offset:32768
    ds_read_b32 v105, v101 offset:768
    v_mfma_f32_16x16x32_bf16 v[204:207], v[44:47], a[56:59], v[204:207]
    ds_read_b64_tr_b16 v[42:43], v10 offset:33792
    v_add_f32 v109, v66, v67
    v_mfma_f32_16x16x32_bf16 v[236:239], v[44:47], a[60:63], v[236:239]
    ds_read_b128 a[64:67], v30 offset:0
    v_add_f32 v108, v108, v68
    v_mfma_f32_16x16x32_bf16 v[144:147], v[48:51], a[48:51], v[144:147]
    ds_read_b64_tr_b16 v[44:45], v11 offset:32768
    v_add_f32 v109, v109, v69
    v_mfma_f32_16x16x32_bf16 v[176:179], v[48:51], a[52:55], v[176:179]
    ds_read_b64_tr_b16 v[46:47], v11 offset:33792
    v_add_f32 v108, v108, v70
    v_mfma_f32_16x16x32_bf16 v[208:211], v[48:51], a[56:59], v[208:211]
    ds_read_b128 a[68:71], v30 offset:2048
    v_add_f32 v109, v109, v71
    v_mfma_f32_16x16x32_bf16 v[240:243], v[48:51], a[60:63], v[240:243]
    ds_read_b128 a[72:75], v30 offset:4096
    s_waitcnt lgkmcnt(10)
    v_add_f32 v102, v102, v103
    v_mfma_f32_16x16x32_bf16 v[148:151], v[52:55], a[48:51], v[148:151]
    ds_read_b64_tr_b16 v[48:49], v12 offset:32768
    s_waitcnt lgkmcnt(7)
    v_add_f32 v104, v104, v105
    v_mfma_f32_16x16x32_bf16 v[180:183], v[52:55], a[52:55], v[180:183]
    ds_read_b64_tr_b16 v[50:51], v12 offset:33792
    v_add_f32 v102, v102, v104
    buffer_store_dword v102, v87, s[8:11], s66 offen sc0 sc1
    v_mfma_f32_16x16x32_bf16 v[212:215], v[52:55], a[56:59], v[212:215]
    ds_read_b128 a[76:79], v30 offset:6144
    v_add_f32 v108, v108, v72
    v_mfma_f32_16x16x32_bf16 v[244:247], v[52:55], a[60:63], v[244:247]
    buffer_load_dwordx4 v20, s[16:19], s98 offen offset:0   lds
    v_mfma_f32_16x16x32_bf16 v[152:155], v[56:59], a[48:51], v[152:155]
    s_mov_b32 s40, s92
    s_mov_b32 s41, s93
    ds_read_b64_tr_b16 v[52:53], v13 offset:32768
    v_mfma_f32_16x16x32_bf16 v[184:187], v[56:59], a[52:55], v[184:187]
    s_mov_b32 s42, 1835008
    s_mov_b32 s44, s94
    ds_read_b64_tr_b16 v[54:55], v13 offset:33792
    v_mfma_f32_16x16x32_bf16 v[216:219], v[56:59], a[56:59], v[216:219]
    s_mov_b32 s45, s95
    s_mov_b32 s46, 1835008
    v_add_f32 v109, v109, v73
    v_mfma_f32_16x16x32_bf16 v[248:251], v[56:59], a[60:63], v[248:251]
    buffer_load_dwordx4 v21, s[16:19], s98 offen offset:1024   lds
    v_mfma_f32_16x16x32_bf16 v[156:159], v[60:63], a[48:51], v[156:159]
    ds_read_b64_tr_b16 v[56:57], v14 offset:32768
    v_add_f32 v108, v108, v74
    v_mfma_f32_16x16x32_bf16 v[188:191], v[60:63], a[52:55], v[188:191]
    ds_read_b64_tr_b16 v[58:59], v14 offset:33792
    v_add_f32 v109, v109, v75
    v_mfma_f32_16x16x32_bf16 v[220:223], v[60:63], a[56:59], v[220:223]
    buffer_load_dwordx4 v22, s[16:19], s98 offen offset:2048   lds
    v_mfma_f32_16x16x32_bf16 v[252:255], v[60:63], a[60:63], v[252:255]
    s_waitcnt lgkmcnt(5)
    v_add_f32 v108, v108, v76
    v_add_f32 v109, v109, v77
    v_mfma_f32_16x16x32_bf16 v[128:131], v[32:35], a[64:67], v[128:131]
    ds_read_b64_tr_b16 v[60:61], v15 offset:32768
    v_add_f32 v108, v108, v78
    v_mfma_f32_16x16x32_bf16 v[160:163], v[32:35], a[68:71], v[160:163]
    ds_read_b64_tr_b16 v[62:63], v15 offset:33792
    v_add_f32 v109, v109, v79
    v_mfma_f32_16x16x32_bf16 v[192:195], v[32:35], a[72:75], v[192:195]
    s_waitcnt lgkmcnt(5)
    ds_read_b128 a[80:83], v31 offset:0
    v_add_f32 v108, v108, v109
    v_mfma_f32_16x16x32_bf16 v[224:227], v[32:35], a[76:79], v[224:227]
    ds_read_b128 a[84:87], v31 offset:2048
    v_add_f32_dpp v108, v108, v108 row_ror:8 row_mask:0xf bank_mask:0xf
    v_mfma_f32_16x16x32_bf16 v[132:135], v[36:39], a[64:67], v[132:135]
    ds_read_b64_tr_b16 v[32:33], v8 offset:40960
    v_mov_b32 v110, v108
    v_mfma_f32_16x16x32_bf16 v[164:167], v[36:39], a[68:71], v[164:167]
    ds_read_b64_tr_b16 v[34:35], v8 offset:41984
    v_permlane16_swap_b32 v108, v110
    v_mfma_f32_16x16x32_bf16 v[196:199], v[36:39], a[72:75], v[196:199]
    ds_read_b128 a[88:91], v31 offset:4096
    v_add_f32 v108, v108, v110
    v_mfma_f32_16x16x32_bf16 v[228:231], v[36:39], a[76:79], v[228:231]
    ds_read_b128 a[92:95], v31 offset:6144
    v_mov_b32 v110, v108
    v_mfma_f32_16x16x32_bf16 v[136:139], v[40:43], a[64:67], v[136:139]
    ds_read_b64_tr_b16 v[36:37], v9 offset:40960
    v_permlane32_swap_b32 v108, v110
    v_mfma_f32_16x16x32_bf16 v[168:171], v[40:43], a[68:71], v[168:171]
    ds_read_b64_tr_b16 v[38:39], v9 offset:41984
    v_add_f32 v108, v108, v110
    v_mfma_f32_16x16x32_bf16 v[200:203], v[40:43], a[72:75], v[200:203]
    buffer_load_dwordx4 v23, s[16:19], s98 offen offset:3072   lds
    v_mfma_f32_16x16x32_bf16 v[232:235], v[40:43], a[76:79], v[232:235]
    v_mul_f32 v108, 0x3c000000, v108
    v_sub_f32 v110, v64, v108
    v_mfma_f32_16x16x32_bf16 v[140:143], v[44:47], a[64:67], v[140:143]
    s_add_u32 m0, s62, 32768
    s_xor_b32 s98, s96, 512
    ds_read_b64_tr_b16 v[40:41], v10 offset:40960
    v_mfma_f32_16x16x32_bf16 v[172:175], v[44:47], a[68:71], v[172:175]
    ds_read_b64_tr_b16 v[42:43], v10 offset:41984
    v_mul_f32 v109, v110, v110
    v_mfma_f32_16x16x32_bf16 v[204:207], v[44:47], a[72:75], v[204:207]
    buffer_load_dwordx4 v16, s[12:15], s98 offen offset:0   lds
    v_mfma_f32_16x16x32_bf16 v[236:239], v[44:47], a[76:79], v[236:239]
    v_sub_f32 v111, v65, v108
    v_fmac_f32 v109, v111, v111
    v_mfma_f32_16x16x32_bf16 v[144:147], v[48:51], a[64:67], v[144:147]
    ds_read_b64_tr_b16 v[44:45], v11 offset:40960
    v_sub_f32 v110, v66, v108
    v_mfma_f32_16x16x32_bf16 v[176:179], v[48:51], a[68:71], v[176:179]
    ds_read_b64_tr_b16 v[46:47], v11 offset:41984
    v_fmac_f32 v109, v110, v110
    v_mfma_f32_16x16x32_bf16 v[208:211], v[48:51], a[72:75], v[208:211]
    buffer_load_dwordx4 v17, s[12:15], s98 offen offset:1024   lds
    v_mfma_f32_16x16x32_bf16 v[240:243], v[48:51], a[76:79], v[240:243]
    s_waitcnt lgkmcnt(4)
    v_sub_f32 v111, v67, v108
    v_fmac_f32 v109, v111, v111
    v_mfma_f32_16x16x32_bf16 v[148:151], v[52:55], a[64:67], v[148:151]
    ds_read_b64_tr_b16 v[48:49], v12 offset:40960
    v_sub_f32 v110, v68, v108
    v_mfma_f32_16x16x32_bf16 v[180:183], v[52:55], a[68:71], v[180:183]
    ds_read_b64_tr_b16 v[50:51], v12 offset:41984
    v_fmac_f32 v109, v110, v110
    v_mfma_f32_16x16x32_bf16 v[212:215], v[52:55], a[72:75], v[212:215]
    buffer_load_dwordx4 v18, s[12:15], s98 offen offset:2048   lds
    v_mfma_f32_16x16x32_bf16 v[244:247], v[52:55], a[76:79], v[244:247]
    v_sub_f32 v111, v69, v108
    v_fmac_f32 v109, v111, v111
    v_mfma_f32_16x16x32_bf16 v[152:155], v[56:59], a[64:67], v[152:155]
    ds_read_b64_tr_b16 v[52:53], v13 offset:40960
    v_sub_f32 v110, v70, v108
    v_mfma_f32_16x16x32_bf16 v[184:187], v[56:59], a[68:71], v[184:187]
    ds_read_b64_tr_b16 v[54:55], v13 offset:41984
    v_fmac_f32 v109, v110, v110
    v_mfma_f32_16x16x32_bf16 v[216:219], v[56:59], a[72:75], v[216:219]
    buffer_load_dwordx4 v19, s[12:15], s98 offen offset:3072   lds
    v_mfma_f32_16x16x32_bf16 v[248:251], v[56:59], a[76:79], v[248:251]
    v_sub_f32 v111, v71, v108
    v_fmac_f32 v109, v111, v111
    v_mfma_f32_16x16x32_bf16 v[156:159], v[60:63], a[64:67], v[156:159]
    s_add_u32 m0, s62, 36864
    s_xor_b32 s98, s96, 33280
    ds_read_b64_tr_b16 v[56:57], v14 offset:40960
    v_mfma_f32_16x16x32_bf16 v[188:191], v[60:63], a[68:71], v[188:191]
    ds_read_b64_tr_b16 v[58:59], v14 offset:41984
    v_sub_f32 v110, v72, v108
    v_mfma_f32_16x16x32_bf16 v[220:223], v[60:63], a[72:75], v[220:223]
    buffer_load_dwordx4 v16, s[12:15], s98 offen offset:0   lds
    v_mfma_f32_16x16x32_bf16 v[252:255], v[60:63], a[76:79], v[252:255]
    v_fmac_f32 v109, v110, v110
    v_sub_f32 v111, v73, v108
    v_mfma_f32_16x16x32_bf16 v[128:131], v[32:35], a[80:83], v[128:131]
    ds_read_b64_tr_b16 v[60:61], v15 offset:40960
    v_fmac_f32 v109, v111, v111
    v_mfma_f32_16x16x32_bf16 v[160:163], v[32:35], a[84:87], v[160:163]
    ds_read_b64_tr_b16 v[62:63], v15 offset:41984
    v_sub_f32 v110, v74, v108
    v_mfma_f32_16x16x32_bf16 v[192:195], v[32:35], a[88:91], v[192:195]
    buffer_load_dwordx4 v17, s[12:15], s98 offen offset:1024   lds
    v_mfma_f32_16x16x32_bf16 v[224:227], v[32:35], a[92:95], v[224:227]
    v_fmac_f32 v109, v110, v110
    v_sub_f32 v111, v75, v108
    v_mfma_f32_16x16x32_bf16 v[132:135], v[36:39], a[80:83], v[132:135]
    buffer_load_dwordx4 v18, s[12:15], s98 offen offset:2048   lds
    v_mfma_f32_16x16x32_bf16 v[164:167], v[36:39], a[84:87], v[164:167]
    v_fmac_f32 v109, v111, v111
    v_sub_f32 v110, v76, v108
    v_mfma_f32_16x16x32_bf16 v[196:199], v[36:39], a[88:91], v[196:199]
    buffer_load_dwordx4 v19, s[12:15], s98 offen offset:3072   lds
    s_cmp_eq_u32 s3, 1
    s_cselect_b32 s101, s100, 2147479552
    buffer_load_dword a243, v117, s[20:23], s101 offen offset:4
    v_mfma_f32_16x16x32_bf16 v[228:231], v[36:39], a[92:95], v[228:231]
    s_waitcnt lgkmcnt(2)
    v_fmac_f32 v109, v110, v110
    v_sub_f32 v111, v77, v108
    v_mfma_f32_16x16x32_bf16 v[136:139], v[40:43], a[80:83], v[136:139]
    v_fmac_f32 v109, v111, v111
    v_sub_f32 v110, v78, v108
    s_waitcnt vmcnt(15) lgkmcnt(0)
    s_barrier
    v_mfma_f32_16x16x32_bf16 v[168:171], v[40:43], a[84:87], v[168:171]
    s_add_u32 m0, s63, 131072
    s_xor_b32 s98, s97, 2621440
    ds_read_b64_tr_b16 v[32:33], v8 offset:0
    v_mfma_f32_16x16x32_bf16 v[200:203], v[40:43], a[88:91], v[200:203]
    ds_read_b64_tr_b16 v[34:35], v8 offset:1024
    v_fmac_f32 v109, v110, v110
    v_mfma_f32_16x16x32_bf16 v[232:235], v[40:43], a[92:95], v[232:235]
    ds_read_b64_tr_b16 v[36:37], v9 offset:0
    v_sub_f32 v111, v79, v108
    v_mfma_f32_16x16x32_bf16 v[140:143], v[44:47], a[80:83], v[140:143]
    ds_read_b64_tr_b16 v[38:39], v9 offset:1024
    v_fmac_f32 v109, v111, v111
    v_mfma_f32_16x16x32_bf16 v[172:175], v[44:47], a[84:87], v[172:175]
    ds_read_b64_tr_b16 v[40:41], v10 offset:0
    v_add_f32_dpp v109, v109, v109 row_ror:8 row_mask:0xf bank_mask:0xf
    v_mfma_f32_16x16x32_bf16 v[204:207], v[44:47], a[88:91], v[204:207]
    ds_read_b64_tr_b16 v[42:43], v10 offset:1024
    v_mov_b32 v110, v109
    v_mfma_f32_16x16x32_bf16 v[236:239], v[44:47], a[92:95], v[236:239]
    ds_read_b128 a[96:99], v28 offset:0
    v_permlane16_swap_b32 v109, v110
    v_mfma_f32_16x16x32_bf16 v[144:147], v[48:51], a[80:83], v[144:147]
    ds_read_b64_tr_b16 v[44:45], v11 offset:0
    v_add_f32 v109, v109, v110
    v_mfma_f32_16x16x32_bf16 v[176:179], v[48:51], a[84:87], v[176:179]
    ds_read_b64_tr_b16 v[46:47], v11 offset:1024
    v_mov_b32 v110, v109
    s_waitcnt vmcnt(13)
    buffer_atomic_add v6, v7, s[36:39], s69 offen sc1
    v_mfma_f32_16x16x32_bf16 v[208:211], v[48:51], a[88:91], v[208:211]
    ds_read_b128 a[100:103], v28 offset:2048
    v_permlane32_swap_b32 v109, v110
    v_mfma_f32_16x16x32_bf16 v[240:243], v[48:51], a[92:95], v[240:243]
    ds_read_b128 a[104:107], v28 offset:4096
    v_add_f32 v109, v109, v110
    v_mfma_f32_16x16x32_bf16 v[148:151], v[52:55], a[80:83], v[148:151]
    ds_read_b64_tr_b16 v[48:49], v12 offset:0
    v_mfma_f32_16x16x32_bf16 v[180:183], v[52:55], a[84:87], v[180:183]
    ds_read_b64_tr_b16 v[50:51], v12 offset:1024
    v_mfma_f32_16x16x32_bf16 v[212:215], v[52:55], a[88:91], v[212:215]
    ds_read_b128 a[108:111], v28 offset:6144
    v_mfma_f32_16x16x32_bf16 v[244:247], v[52:55], a[92:95], v[244:247]
    buffer_load_dwordx4 v20, s[16:19], s98 offen offset:0   lds
    v_mfma_f32_16x16x32_bf16 v[152:155], v[56:59], a[80:83], v[152:155]
    ds_read_b64_tr_b16 v[52:53], v13 offset:0
    v_mfma_f32_16x16x32_bf16 v[184:187], v[56:59], a[84:87], v[184:187]
    ds_read_b64_tr_b16 v[54:55], v13 offset:1024
    v_mfma_f32_16x16x32_bf16 v[216:219], v[56:59], a[88:91], v[216:219]
    buffer_load_dwordx4 v21, s[16:19], s98 offen offset:1024   lds
    v_mfma_f32_16x16x32_bf16 v[248:251], v[56:59], a[92:95], v[248:251]
    ds_write_b64 v100, v[108:109]
    v_mfma_f32_16x16x32_bf16 v[156:159], v[60:63], a[80:83], v[156:159]
    ds_read_b64_tr_b16 v[56:57], v14 offset:0
    v_mfma_f32_16x16x32_bf16 v[188:191], v[60:63], a[84:87], v[188:191]
    ds_read_b64_tr_b16 v[58:59], v14 offset:1024
    v_mfma_f32_16x16x32_bf16 v[220:223], v[60:63], a[88:91], v[220:223]
    buffer_load_dwordx4 v22, s[16:19], s98 offen offset:2048   lds
    v_mfma_f32_16x16x32_bf16 v[252:255], v[60:63], a[92:95], v[252:255]
    s_waitcnt lgkmcnt(6)
    v_mfma_f32_16x16x32_bf16 v[128:131], v[32:35], a[96:99], v[128:131]
    ds_read_b64_tr_b16 v[60:61], v15 offset:0
    v_mfma_f32_16x16x32_bf16 v[160:163], v[32:35], a[100:103], v[160:163]
    ds_read_b64_tr_b16 v[62:63], v15 offset:1024
    v_mfma_f32_16x16x32_bf16 v[192:195], v[32:35], a[104:107], v[192:195]
    s_waitcnt lgkmcnt(6)
    ds_read_b128 a[112:115], v29 offset:0
    v_mfma_f32_16x16x32_bf16 v[224:227], v[32:35], a[108:111], v[224:227]
    ds_read_b128 a[116:119], v29 offset:2048
    v_mfma_f32_16x16x32_bf16 v[132:135], v[36:39], a[96:99], v[132:135]
    ds_read_b64_tr_b16 v[32:33], v8 offset:8192
    v_mfma_f32_16x16x32_bf16 v[164:167], v[36:39], a[100:103], v[164:167]
    ds_read_b64_tr_b16 v[34:35], v8 offset:9216
    v_mfma_f32_16x16x32_bf16 v[196:199], v[36:39], a[104:107], v[196:199]
    ds_read_b128 a[120:123], v29 offset:4096
    v_mfma_f32_16x16x32_bf16 v[228:231], v[36:39], a[108:111], v[228:231]
    ds_read_b128 a[124:127], v29 offset:6144
    v_mfma_f32_16x16x32_bf16 v[136:139], v[40:43], a[96:99], v[136:139]
    ds_read_b64_tr_b16 v[36:37], v9 offset:8192
    v_mfma_f32_16x16x32_bf16 v[168:171], v[40:43], a[100:103], v[168:171]
    ds_read_b64_tr_b16 v[38:39], v9 offset:9216
    v_mfma_f32_16x16x32_bf16 v[200:203], v[40:43], a[104:107], v[200:203]
    buffer_load_dwordx4 v23, s[16:19], s98 offen offset:3072   lds
    v_mfma_f32_16x16x32_bf16 v[232:235], v[40:43], a[108:111], v[232:235]
    v_mfma_f32_16x16x32_bf16 v[140:143], v[44:47], a[96:99], v[140:143]
    s_add_u32 m0, s62, 65536
    s_xor_b32 s98, s96, 640
    ds_read_b64_tr_b16 v[40:41], v10 offset:8192
    v_mfma_f32_16x16x32_bf16 v[172:175], v[44:47], a[100:103], v[172:175]
    ds_read_b64_tr_b16 v[42:43], v10 offset:9216
    v_mfma_f32_16x16x32_bf16 v[204:207], v[44:47], a[104:107], v[204:207]
    buffer_load_dwordx4 v16, s[12:15], s98 offen offset:0   lds
    v_mfma_f32_16x16x32_bf16 v[236:239], v[44:47], a[108:111], v[236:239]
    v_mfma_f32_16x16x32_bf16 v[144:147], v[48:51], a[96:99], v[144:147]
    ds_read_b64_tr_b16 v[44:45], v11 offset:8192
    v_mfma_f32_16x16x32_bf16 v[176:179], v[48:51], a[100:103], v[176:179]
    ds_read_b64_tr_b16 v[46:47], v11 offset:9216
    v_mfma_f32_16x16x32_bf16 v[208:211], v[48:51], a[104:107], v[208:211]
    buffer_load_dwordx4 v17, s[12:15], s98 offen offset:1024   lds
    v_mfma_f32_16x16x32_bf16 v[240:243], v[48:51], a[108:111], v[240:243]
    s_waitcnt lgkmcnt(4)
    v_mfma_f32_16x16x32_bf16 v[148:151], v[52:55], a[96:99], v[148:151]
    ds_read_b64_tr_b16 v[48:49], v12 offset:8192
    v_mfma_f32_16x16x32_bf16 v[180:183], v[52:55], a[100:103], v[180:183]
    ds_read_b64_tr_b16 v[50:51], v12 offset:9216
    v_mfma_f32_16x16x32_bf16 v[212:215], v[52:55], a[104:107], v[212:215]
    buffer_load_dwordx4 v18, s[12:15], s98 offen offset:2048   lds
    v_mfma_f32_16x16x32_bf16 v[244:247], v[52:55], a[108:111], v[244:247]
    v_mfma_f32_16x16x32_bf16 v[152:155], v[56:59], a[96:99], v[152:155]
    ds_read_b64_tr_b16 v[52:53], v13 offset:8192
    v_mfma_f32_16x16x32_bf16 v[184:187], v[56:59], a[100:103], v[184:187]
    ds_read_b64_tr_b16 v[54:55], v13 offset:9216
    v_mfma_f32_16x16x32_bf16 v[216:219], v[56:59], a[104:107], v[216:219]
    buffer_load_dwordx4 v19, s[12:15], s98 offen offset:3072   lds
    v_mfma_f32_16x16x32_bf16 v[248:251], v[56:59], a[108:111], v[248:251]
    v_mfma_f32_16x16x32_bf16 v[156:159], v[60:63], a[96:99], v[156:159]
    s_add_u32 m0, s62, 69632
    s_xor_b32 s98, s96, 33408
    ds_read_b64_tr_b16 v[56:57], v14 offset:8192
    v_mfma_f32_16x16x32_bf16 v[188:191], v[60:63], a[100:103], v[188:191]
    ds_read_b64_tr_b16 v[58:59], v14 offset:9216
    v_mfma_f32_16x16x32_bf16 v[220:223], v[60:63], a[104:107], v[220:223]
    buffer_load_dwordx4 v16, s[12:15], s98 offen offset:0   lds
    v_mfma_f32_16x16x32_bf16 v[252:255], v[60:63], a[108:111], v[252:255]
    v_mfma_f32_16x16x32_bf16 v[128:131], v[32:35], a[112:115], v[128:131]
    ds_read_b64_tr_b16 v[60:61], v15 offset:8192
    v_mfma_f32_16x16x32_bf16 v[160:163], v[32:35], a[116:119], v[160:163]
    ds_read_b64_tr_b16 v[62:63], v15 offset:9216
    v_mfma_f32_16x16x32_bf16 v[192:195], v[32:35], a[120:123], v[192:195]
    buffer_load_dwordx4 v17, s[12:15], s98 offen offset:1024   lds
    v_mfma_f32_16x16x32_bf16 v[224:227], v[32:35], a[124:127], v[224:227]
    v_mfma_f32_16x16x32_bf16 v[132:135], v[36:39], a[112:115], v[132:135]
    buffer_load_dwordx4 v18, s[12:15], s98 offen offset:2048   lds
    v_mfma_f32_16x16x32_bf16 v[164:167], v[36:39], a[116:119], v[164:167]
    v_mfma_f32_16x16x32_bf16 v[196:199], v[36:39], a[120:123], v[196:199]
    buffer_load_dwordx4 v19, s[12:15], s98 offen offset:3072   lds
    s_cmp_eq_u32 s3, 2
    s_cselect_b32 s101, s100, 2147479552
    buffer_load_dword a245, v117, s[24:27], s101 offen offset:4
    v_mfma_f32_16x16x32_bf16 v[228:231], v[36:39], a[124:127], v[228:231]
    s_waitcnt lgkmcnt(2)
    v_mfma_f32_16x16x32_bf16 v[136:139], v[40:43], a[112:115], v[136:139]
    s_waitcnt vmcnt(15) lgkmcnt(0)
    s_barrier
    v_mfma_f32_16x16x32_bf16 v[168:171], v[40:43], a[116:119], v[168:171]
    s_add_u32 m0, s63, 98304
    s_xor_b32 s98, s97, 3145728
    ds_read_b64_tr_b16 v[32:33], v8 offset:16384
    v_mfma_f32_16x16x32_bf16 v[200:203], v[40:43], a[120:123], v[200:203]
    ds_read_b64_tr_b16 v[34:35], v8 offset:17408
    v_mfma_f32_16x16x32_bf16 v[232:235], v[40:43], a[124:127], v[232:235]
    ds_read_b64_tr_b16 v[36:37], v9 offset:16384
    v_mfma_f32_16x16x32_bf16 v[140:143], v[44:47], a[112:115], v[140:143]
    ds_read_b64_tr_b16 v[38:39], v9 offset:17408
    v_mfma_f32_16x16x32_bf16 v[172:175], v[44:47], a[116:119], v[172:175]
    ds_read_b64_tr_b16 v[40:41], v10 offset:16384
    v_mfma_f32_16x16x32_bf16 v[204:207], v[44:47], a[120:123], v[204:207]
    ds_read_b64_tr_b16 v[42:43], v10 offset:17408
    v_mfma_f32_16x16x32_bf16 v[236:239], v[44:47], a[124:127], v[236:239]
    ds_read_b128 a[128:131], v28 offset:32768
    v_mfma_f32_16x16x32_bf16 v[144:147], v[48:51], a[112:115], v[144:147]
    ds_read_b64_tr_b16 v[44:45], v11 offset:16384
    v_mfma_f32_16x16x32_bf16 v[176:179], v[48:51], a[116:119], v[176:179]
    ds_read_b64_tr_b16 v[46:47], v11 offset:17408
    v_mfma_f32_16x16x32_bf16 v[208:211], v[48:51], a[120:123], v[208:211]
    ds_read_b128 a[132:135], v28 offset:34816
    v_mfma_f32_16x16x32_bf16 v[240:243], v[48:51], a[124:127], v[240:243]
    ds_read_b128 a[136:139], v28 offset:36864
    v_mfma_f32_16x16x32_bf16 v[148:151], v[52:55], a[112:115], v[148:151]
    ds_read_b64_tr_b16 v[48:49], v12 offset:16384
    v_mfma_f32_16x16x32_bf16 v[180:183], v[52:55], a[116:119], v[180:183]
    ds_read_b64_tr_b16 v[50:51], v12 offset:17408
    v_mfma_f32_16x16x32_bf16 v[212:215], v[52:55], a[120:123], v[212:215]
    ds_read_b128 a[140:143], v28 offset:38912
    v_mfma_f32_16x16x32_bf16 v[244:247], v[52:55], a[124:127], v[244:247]
    buffer_load_dwordx4 v20, s[16:19], s98 offen offset:0   lds
    v_mfma_f32_16x16x32_bf16 v[152:155], v[56:59], a[112:115], v[152:155]
    ds_read_b64_tr_b16 v[52:53], v13 offset:16384
    v_mfma_f32_16x16x32_bf16 v[184:187], v[56:59], a[116:119], v[184:187]
    ds_read_b64_tr_b16 v[54:55], v13 offset:17408
    v_mfma_f32_16x16x32_bf16 v[216:219], v[56:59], a[120:123], v[216:219]
    buffer_load_dwordx4 v21, s[16:19], s98 offen offset:1024   lds
    v_mfma_f32_16x16x32_bf16 v[248:251], v[56:59], a[124:127], v[248:251]
    ds_read_b128 v[88:91], v99
    v_mfma_f32_16x16x32_bf16 v[156:159], v[60:63], a[112:115], v[156:159]
    ds_read_b64_tr_b16 v[56:57], v14 offset:16384
    v_mfma_f32_16x16x32_bf16 v[188:191], v[60:63], a[116:119], v[188:191]
    ds_read_b64_tr_b16 v[58:59], v14 offset:17408
    v_mfma_f32_16x16x32_bf16 v[220:223], v[60:63], a[120:123], v[220:223]
    buffer_load_dwordx4 v22, s[16:19], s98 offen offset:2048   lds
    v_mfma_f32_16x16x32_bf16 v[252:255], v[60:63], a[124:127], v[252:255]
    s_waitcnt lgkmcnt(6)
    ds_read_b128 v[92:95], v99 offset:16
    v_mfma_f32_16x16x32_bf16 v[128:131], v[32:35], a[128:131], v[128:131]
    ds_read_b64_tr_b16 v[60:61], v15 offset:16384
    v_mfma_f32_16x16x32_bf16 v[160:163], v[32:35], a[132:135], v[160:163]
    ds_read_b64_tr_b16 v[62:63], v15 offset:17408
    v_mfma_f32_16x16x32_bf16 v[192:195], v[32:35], a[136:139], v[192:195]
    s_waitcnt lgkmcnt(7)
    ds_read_b128 a[144:147], v29 offset:32768
    v_mfma_f32_16x16x32_bf16 v[224:227], v[32:35], a[140:143], v[224:227]
    ds_read_b128 a[148:151], v29 offset:34816
    v_mfma_f32_16x16x32_bf16 v[132:135], v[36:39], a[128:131], v[132:135]
    ds_read_b64_tr_b16 v[32:33], v8 offset:24576
    v_mfma_f32_16x16x32_bf16 v[164:167], v[36:39], a[132:135], v[164:167]
    ds_read_b64_tr_b16 v[34:35], v8 offset:25600
    v_mfma_f32_16x16x32_bf16 v[196:199], v[36:39], a[136:139], v[196:199]
    ds_read_b128 a[152:155], v29 offset:36864
    v_mfma_f32_16x16x32_bf16 v[228:231], v[36:39], a[140:143], v[228:231]
    ds_read_b128 a[156:159], v29 offset:38912
    s_waitcnt lgkmcnt(11)
    v_add_f32 v108, v88, v90
    v_mfma_f32_16x16x32_bf16 v[136:139], v[40:43], a[128:131], v[136:139]
    ds_read_b64_tr_b16 v[36:37], v9 offset:24576
    s_waitcnt lgkmcnt(9)
    v_add_f32 v109, v92, v94
    v_mfma_f32_16x16x32_bf16 v[168:171], v[40:43], a[132:135], v[168:171]
    ds_read_b64_tr_b16 v[38:39], v9 offset:25600
    v_add_f32 v108, v108, v109
    v_mfma_f32_16x16x32_bf16 v[200:203], v[40:43], a[136:139], v[200:203]
    buffer_load_dwordx4 v23, s[16:19], s98 offen offset:3072   lds
    v_mfma_f32_16x16x32_bf16 v[232:235], v[40:43], a[140:143], v[232:235]
    v_mul_f32 v108, 0x3e800000, v108
    v_add_f32 v109, v89, v91
    v_mfma_f32_16x16x32_bf16 v[140:143], v[44:47], a[128:131], v[140:143]
    s_add_u32 m0, s62, 0
    s_xor_b32 s98, s96, 768
    ds_read_b64_tr_b16 v[40:41], v10 offset:24576
    v_mfma_f32_16x16x32_bf16 v[172:175], v[44:47], a[132:135], v[172:175]
    ds_read_b64_tr_b16 v[42:43], v10 offset:25600
    v_add_f32 v110, v93, v95
    v_mfma_f32_16x16x32_bf16 v[204:207], v[44:47], a[136:139], v[204:207]
    buffer_load_dwordx4 v16, s[12:15], s98 offen offset:0   lds
    v_mfma_f32_16x16x32_bf16 v[236:239], v[44:47], a[140:143], v[236:239]
    v_add_f32 v109, v109, v110
    v_sub_f32 v88, v88, v108
    v_mfma_f32_16x16x32_bf16 v[144:147], v[48:51], a[128:131], v[144:147]
    ds_read_b64_tr_b16 v[44:45], v11 offset:24576
    v_sub_f32 v90, v90, v108
    v_mfma_f32_16x16x32_bf16 v[176:179], v[48:51], a[132:135], v[176:179]
    ds_read_b64_tr_b16 v[46:47], v11 offset:25600
    v_sub_f32 v92, v92, v108
    v_mfma_f32_16x16x32_bf16 v[208:211], v[48:51], a[136:139], v[208:211]
    buffer_load_dwordx4 v17, s[12:15], s98 offen offset:1024   lds
    v_mfma_f32_16x16x32_bf16 v[240:243], v[48:51], a[140:143], v[240:243]
    v_sub_f32 v94, v94, v108
    v_mul_f32 v110, v88, v88
    v_mfma_f32_16x16x32_bf16 v[148:151], v[52:55], a[128:131], v[148:151]
    ds_read_b64_tr_b16 v[48:49], v12 offset:24576
    v_fmac_f32 v110, v90, v90
    v_mfma_f32_16x16x32_bf16 v[180:183], v[52:55], a[132:135], v[180:183]
    ds_read_b64_tr_b16 v[50:51], v12 offset:25600
    v_fmac_f32 v110, v92, v92
    v_mfma_f32_16x16x32_bf16 v[212:215], v[52:55], a[136:139], v[212:215]
    buffer_load_dwordx4 v18, s[12:15], s98 offen offset:2048   lds
    v_mfma_f32_16x16x32_bf16 v[244:247], v[52:55], a[140:143], v[244:247]
    v_fmac_f32 v110, v94, v94
    v_fmac_f32 v109, 0x43000000, v110
    v_mfma_f32_16x16x32_bf16 v[152:155], v[56:59], a[128:131], v[152:155]
    ds_read_b64_tr_b16 v[52:53], v13 offset:24576
    v_mov_b32 v110, 0x3727c5ac
    v_mfma_f32_16x16x32_bf16 v[184:187], v[56:59], a[132:135], v[184:187]
    ds_read_b64_tr_b16 v[54:55], v13 offset:25600
    v_fmac_f32 v110, 0x3b000000, v109
    v_mfma_f32_16x16x32_bf16 v[216:219], v[56:59], a[136:139], v[216:219]
    buffer_load_dwordx4 v19, s[12:15], s98 offen offset:3072   lds
    v_mfma_f32_16x16x32_bf16 v[248:251], v[56:59], a[140:143], v[248:251]
    s_waitcnt lgkmcnt(4)
    v_rsq_f32 v110, v110
    v_mfma_f32_16x16x32_bf16 v[156:159], v[60:63], a[128:131], v[156:159]
    s_add_u32 m0, s62, 4096
    s_xor_b32 s98, s96, 33536
    ds_read_b64_tr_b16 v[56:57], v14 offset:24576
    v_mfma_f32_16x16x32_bf16 v[188:191], v[60:63], a[132:135], v[188:191]
    ds_read_b64_tr_b16 v[58:59], v14 offset:25600
    v_sub_f32 v64, v64, v108
    v_mfma_f32_16x16x32_bf16 v[220:223], v[60:63], a[136:139], v[220:223]
    buffer_load_dwordx4 v16, s[12:15], s98 offen offset:0   lds
    v_mfma_f32_16x16x32_bf16 v[252:255], v[60:63], a[140:143], v[252:255]
    v_sub_f32 v65, v65, v108
    v_sub_f32 v66, v66, v108
    v_mfma_f32_16x16x32_bf16 v[128:131], v[32:35], a[144:147], v[128:131]
    ds_read_b64_tr_b16 v[60:61], v15 offset:24576
    v_sub_f32 v67, v67, v108
    v_mfma_f32_16x16x32_bf16 v[160:163], v[32:35], a[148:151], v[160:163]
    ds_read_b64_tr_b16 v[62:63], v15 offset:25600
    v_sub_f32 v68, v68, v108
    v_mfma_f32_16x16x32_bf16 v[192:195], v[32:35], a[152:155], v[192:195]
    buffer_load_dwordx4 v17, s[12:15], s98 offen offset:1024   lds
    v_mfma_f32_16x16x32_bf16 v[224:227], v[32:35], a[156:159], v[224:227]
    v_sub_f32 v69, v69, v108
    v_sub_f32 v70, v70, v108
    v_mfma_f32_16x16x32_bf16 v[132:135], v[36:39], a[144:147], v[132:135]
    buffer_load_dwordx4 v18, s[12:15], s98 offen offset:2048   lds
    v_mfma_f32_16x16x32_bf16 v[164:167], v[36:39], a[148:151], v[164:167]
    v_sub_f32 v71, v71, v108
    v_sub_f32 v72, v72, v108
    v_mfma_f32_16x16x32_bf16 v[196:199], v[36:39], a[152:155], v[196:199]
    buffer_load_dwordx4 v19, s[12:15], s98 offen offset:3072   lds
    s_cmp_eq_u32 s3, 3
    s_cselect_b32 s101, s100, 2147479552
    buffer_load_dword a247, v117, s[24:27], s101 offen offset:4
    v_mfma_f32_16x16x32_bf16 v[228:231], v[36:39], a[156:159], v[228:231]
    v_sub_f32 v73, v73, v108
    v_sub_f32 v74, v74, v108
    v_mfma_f32_16x16x32_bf16 v[136:139], v[40:43], a[144:147], v[136:139]
    v_sub_f32 v75, v75, v108
    v_sub_f32 v76, v76, v108
    s_waitcnt vmcnt(14) lgkmcnt(0)
    s_barrier
    v_mfma_f32_16x16x32_bf16 v[168:171], v[40:43], a[148:151], v[168:171]
    s_add_u32 m0, s63, 114688
    s_xor_b32 s98, s97, 3670016
    ds_read_b64_tr_b16 v[32:33], v8 offset:32768
    v_mfma_f32_16x16x32_bf16 v[200:203], v[40:43], a[152:155], v[200:203]
    ds_read_b64_tr_b16 v[34:35], v8 offset:33792
    v_sub_f32 v77, v77, v108
    v_mfma_f32_16x16x32_bf16 v[232:235], v[40:43], a[156:159], v[232:235]
    ds_read_b64_tr_b16 v[36:37], v9 offset:32768
    v_sub_f32 v78, v78, v108
    v_mfma_f32_16x16x32_bf16 v[140:143], v[44:47], a[144:147], v[140:143]
    ds_read_b64_tr_b16 v[38:39], v9 offset:33792
    v_sub_f32 v79, v79, v108
    v_mfma_f32_16x16x32_bf16 v[172:175], v[44:47], a[148:151], v[172:175]
    ds_read_b64_tr_b16 v[40:41], v10 offset:32768
    v_mul_f32 v64, v64, v110
    v_mfma_f32_16x16x32_bf16 v[204:207], v[44:47], a[152:155], v[204:207]
    ds_read_b64_tr_b16 v[42:43], v10 offset:33792
    v_mul_f32 v65, v65, v110
    v_mfma_f32_16x16x32_bf16 v[236:239], v[44:47], a[156:159], v[236:239]
    ds_read_b128 a[160:163], v30 offset:0
    v_mul_f32 v66, v66, v110
    v_mfma_f32_16x16x32_bf16 v[144:147], v[48:51], a[144:147], v[144:147]
    ds_read_b64_tr_b16 v[44:45], v11 offset:32768
    v_mul_f32 v67, v67, v110
    v_mfma_f32_16x16x32_bf16 v[176:179], v[48:51], a[148:151], v[176:179]
    ds_read_b64_tr_b16 v[46:47], v11 offset:33792
    v_mul_f32 v68, v68, v110
    v_mfma_f32_16x16x32_bf16 v[208:211], v[48:51], a[152:155], v[208:211]
    ds_read_b128 a[164:167], v30 offset:2048
    v_mul_f32 v69, v69, v110
    v_mfma_f32_16x16x32_bf16 v[240:243], v[48:51], a[156:159], v[240:243]
    ds_read_b128 a[168:171], v30 offset:4096
    v_mul_f32 v70, v70, v110
    v_mfma_f32_16x16x32_bf16 v[148:151], v[52:55], a[144:147], v[148:151]
    ds_read_b64_tr_b16 v[48:49], v12 offset:32768
    v_mul_f32 v71, v71, v110
    v_mfma_f32_16x16x32_bf16 v[180:183], v[52:55], a[148:151], v[180:183]
    ds_read_b64_tr_b16 v[50:51], v12 offset:33792
    v_mul_f32 v72, v72, v110
    v_mfma_f32_16x16x32_bf16 v[212:215], v[52:55], a[152:155], v[212:215]
    ds_read_b128 a[172:175], v30 offset:6144
    v_mul_f32 v73, v73, v110
    buffer_load_dword v3, v4, s[36:39], s67 offen sc0 sc1
    v_mfma_f32_16x16x32_bf16 v[244:247], v[52:55], a[156:159], v[244:247]
    buffer_load_dwordx4 v20, s[16:19], s98 offen offset:0   lds
    v_mfma_f32_16x16x32_bf16 v[152:155], v[56:59], a[144:147], v[152:155]
    ds_read_b64_tr_b16 v[52:53], v13 offset:32768
    v_mul_f32 v74, v74, v110
    v_mfma_f32_16x16x32_bf16 v[184:187], v[56:59], a[148:151], v[184:187]
    ds_read_b64_tr_b16 v[54:55], v13 offset:33792
    v_mul_f32 v75, v75, v110
    v_mfma_f32_16x16x32_bf16 v[216:219], v[56:59], a[152:155], v[216:219]
    buffer_load_dwordx4 v21, s[16:19], s98 offen offset:1024   lds
    v_mfma_f32_16x16x32_bf16 v[248:251], v[56:59], a[156:159], v[248:251]
    v_mul_f32 v76, v76, v110
    v_mul_f32 v77, v77, v110
    v_mfma_f32_16x16x32_bf16 v[156:159], v[60:63], a[144:147], v[156:159]
    ds_read_b64_tr_b16 v[56:57], v14 offset:32768
    v_mul_f32 v78, v78, v110
    v_mfma_f32_16x16x32_bf16 v[188:191], v[60:63], a[148:151], v[188:191]
    ds_read_b64_tr_b16 v[58:59], v14 offset:33792
    v_mul_f32 v79, v79, v110
    v_mfma_f32_16x16x32_bf16 v[220:223], v[60:63], a[152:155], v[220:223]
    buffer_load_dwordx4 v22, s[16:19], s98 offen offset:2048   lds
    v_mfma_f32_16x16x32_bf16 v[252:255], v[60:63], a[156:159], v[252:255]
    s_waitcnt lgkmcnt(5)
    v_mfma_f32_16x16x32_bf16 v[128:131], v[32:35], a[160:163], v[128:131]
    ds_read_b64_tr_b16 v[60:61], v15 offset:32768
    v_and_b32 v96, 31, v2
    v_mfma_f32_16x16x32_bf16 v[160:163], v[32:35], a[164:167], v[160:163]
    ds_read_b64_tr_b16 v[62:63], v15 offset:33792
    v_lshlrev_b32 v96, 4, v96
    v_mfma_f32_16x16x32_bf16 v[192:195], v[32:35], a[168:171], v[192:195]
    s_waitcnt lgkmcnt(5)
    ds_read_b128 a[176:179], v31 offset:0
    v_lshrrev_b32 v97, 5, v2
    v_mfma_f32_16x16x32_bf16 v[224:227], v[32:35], a[172:175], v[224:227]
    ds_read_b128 a[180:183], v31 offset:2048
    v_lshl_add_u32 v96, v97, 11, v96
    v_mfma_f32_16x16x32_bf16 v[132:135], v[36:39], a[160:163], v[132:135]
    ds_read_b64_tr_b16 v[32:33], v8 offset:40960
    v_mfma_f32_16x16x32_bf16 v[164:167], v[36:39], a[164:167], v[164:167]
    ds_read_b64_tr_b16 v[34:35], v8 offset:41984
    v_mfma_f32_16x16x32_bf16 v[196:199], v[36:39], a[168:171], v[196:199]
    ds_read_b128 a[184:187], v31 offset:4096
    v_mfma_f32_16x16x32_bf16 v[228:231], v[36:39], a[172:175], v[228:231]
    ds_read_b128 a[188:191], v31 offset:6144
    v_mfma_f32_16x16x32_bf16 v[136:139], v[40:43], a[160:163], v[136:139]
    ds_read_b64_tr_b16 v[36:37], v9 offset:40960
    v_mfma_f32_16x16x32_bf16 v[168:171], v[40:43], a[164:167], v[168:171]
    ds_read_b64_tr_b16 v[38:39], v9 offset:41984
    v_mfma_f32_16x16x32_bf16 v[200:203], v[40:43], a[168:171], v[200:203]
    buffer_load_dwordx4 v23, s[16:19], s98 offen offset:3072   lds
    v_mfma_f32_16x16x32_bf16 v[232:235], v[40:43], a[172:175], v[232:235]
    v_mfma_f32_16x16x32_bf16 v[140:143], v[44:47], a[160:163], v[140:143]
    s_add_u32 m0, s62, 32768
    s_xor_b32 s98, s96, 896
    ds_read_b64_tr_b16 v[40:41], v10 offset:40960
    v_mfma_f32_16x16x32_bf16 v[172:175], v[44:47], a[164:167], v[172:175]
    ds_read_b64_tr_b16 v[42:43], v10 offset:41984
    v_mfma_f32_16x16x32_bf16 v[204:207], v[44:47], a[168:171], v[204:207]
    buffer_load_dwordx4 v16, s[12:15], s98 offen offset:0   lds
    v_mfma_f32_16x16x32_bf16 v[236:239], v[44:47], a[172:175], v[236:239]
    v_mfma_f32_16x16x32_bf16 v[144:147], v[48:51], a[160:163], v[144:147]
    ds_read_b64_tr_b16 v[44:45], v11 offset:40960
    v_mfma_f32_16x16x32_bf16 v[176:179], v[48:51], a[164:167], v[176:179]
    ds_read_b64_tr_b16 v[46:47], v11 offset:41984
    v_mfma_f32_16x16x32_bf16 v[208:211], v[48:51], a[168:171], v[208:211]
    buffer_load_dwordx4 v17, s[12:15], s98 offen offset:1024   lds
    v_mfma_f32_16x16x32_bf16 v[240:243], v[48:51], a[172:175], v[240:243]
    s_waitcnt lgkmcnt(4)
    v_mfma_f32_16x16x32_bf16 v[148:151], v[52:55], a[160:163], v[148:151]
    ds_read_b64_tr_b16 v[48:49], v12 offset:40960
    v_mfma_f32_16x16x32_bf16 v[180:183], v[52:55], a[164:167], v[180:183]
    ds_read_b64_tr_b16 v[50:51], v12 offset:41984
    v_mfma_f32_16x16x32_bf16 v[212:215], v[52:55], a[168:171], v[212:215]
    buffer_load_dwordx4 v18, s[12:15], s98 offen offset:2048   lds
    v_mfma_f32_16x16x32_bf16 v[244:247], v[52:55], a[172:175], v[244:247]
    v_mfma_f32_16x16x32_bf16 v[152:155], v[56:59], a[160:163], v[152:155]
    ds_read_b64_tr_b16 v[52:53], v13 offset:40960
    v_mfma_f32_16x16x32_bf16 v[184:187], v[56:59], a[164:167], v[184:187]
    ds_read_b64_tr_b16 v[54:55], v13 offset:41984
    v_mfma_f32_16x16x32_bf16 v[216:219], v[56:59], a[168:171], v[216:219]
    buffer_load_dwordx4 v19, s[12:15], s98 offen offset:3072   lds
    v_mfma_f32_16x16x32_bf16 v[248:251], v[56:59], a[172:175], v[248:251]
    v_mfma_f32_16x16x32_bf16 v[156:159], v[60:63], a[160:163], v[156:159]
    s_add_u32 m0, s62, 36864
    s_xor_b32 s98, s96, 33664
    ds_read_b64_tr_b16 v[56:57], v14 offset:40960
    v_mfma_f32_16x16x32_bf16 v[188:191], v[60:63], a[164:167], v[188:191]
    ds_read_b64_tr_b16 v[58:59], v14 offset:41984
    v_mfma_f32_16x16x32_bf16 v[220:223], v[60:63], a[168:171], v[220:223]
    buffer_load_dwordx4 v16, s[12:15], s98 offen offset:0   lds
    v_mfma_f32_16x16x32_bf16 v[252:255], v[60:63], a[172:175], v[252:255]
    v_mfma_f32_16x16x32_bf16 v[128:131], v[32:35], a[176:179], v[128:131]
    ds_read_b64_tr_b16 v[60:61], v15 offset:40960
    v_mfma_f32_16x16x32_bf16 v[160:163], v[32:35], a[180:183], v[160:163]
    ds_read_b64_tr_b16 v[62:63], v15 offset:41984
    v_mfma_f32_16x16x32_bf16 v[192:195], v[32:35], a[184:187], v[192:195]
    buffer_load_dwordx4 v17, s[12:15], s98 offen offset:1024   lds
    v_mfma_f32_16x16x32_bf16 v[224:227], v[32:35], a[188:191], v[224:227]
    v_mfma_f32_16x16x32_bf16 v[132:135], v[36:39], a[176:179], v[132:135]
    buffer_load_dwordx4 v18, s[12:15], s98 offen offset:2048   lds
    v_mfma_f32_16x16x32_bf16 v[164:167], v[36:39], a[180:183], v[164:167]
    v_mfma_f32_16x16x32_bf16 v[196:199], v[36:39], a[184:187], v[196:199]
    buffer_load_dwordx4 v19, s[12:15], s98 offen offset:3072   lds
    v_mfma_f32_16x16x32_bf16 v[228:231], v[36:39], a[188:191], v[228:231]
    s_waitcnt lgkmcnt(2)
    s_waitcnt vmcnt(12)
    v_cmp_le_u32 vcc, s68, v3
    s_cmp_eq_u64 vcc, -1
    s_cbranch_scc0 L_E_slow_1
L_E_ok_2:
    v_mfma_f32_16x16x32_bf16 v[136:139], v[40:43], a[176:179], v[136:139]
    s_waitcnt lgkmcnt(0)
    s_barrier
    v_mfma_f32_16x16x32_bf16 v[168:171], v[40:43], a[180:183], v[168:171]
    s_add_u32 m0, s62, 65536
    s_xor_b32 s98, s64, 0
    ds_read_b64_tr_b16 v[32:33], v8 offset:0
    v_mfma_f32_16x16x32_bf16 v[200:203], v[40:43], a[184:187], v[200:203]
    ds_read_b64_tr_b16 v[34:35], v8 offset:1024
    v_mov_b32 v18, v106
    v_mfma_f32_16x16x32_bf16 v[232:235], v[40:43], a[188:191], v[232:235]
    ds_read_b64_tr_b16 v[36:37], v9 offset:0
    v_mov_b32 v19, v107
    v_mfma_f32_16x16x32_bf16 v[140:143], v[44:47], a[176:179], v[140:143]
    ds_read_b64_tr_b16 v[38:39], v9 offset:1024
    v_mfma_f32_16x16x32_bf16 v[172:175], v[44:47], a[180:183], v[172:175]
    ds_read_b64_tr_b16 v[40:41], v10 offset:0
    v_mfma_f32_16x16x32_bf16 v[204:207], v[44:47], a[184:187], v[204:207]
    ds_read_b64_tr_b16 v[42:43], v10 offset:1024
    v_mfma_f32_16x16x32_bf16 v[236:239], v[44:47], a[188:191], v[236:239]
    ds_read_b128 a[192:195], v28 offset:0
    v_mfma_f32_16x16x32_bf16 v[144:147], v[48:51], a[176:179], v[144:147]
    ds_read_b64_tr_b16 v[44:45], v11 offset:0
    v_mfma_f32_16x16x32_bf16 v[176:179], v[48:51], a[180:183], v[176:179]
    ds_read_b64_tr_b16 v[46:47], v11 offset:1024
    v_mfma_f32_16x16x32_bf16 v[208:211], v[48:51], a[184:187], v[208:211]
    ds_read_b128 a[196:199], v28 offset:2048
    v_mfma_f32_16x16x32_bf16 v[240:243], v[48:51], a[188:191], v[240:243]
    ds_read_b128 a[200:203], v28 offset:4096
    v_mfma_f32_16x16x32_bf16 v[148:151], v[52:55], a[176:179], v[148:151]
    ds_read_b64_tr_b16 v[48:49], v12 offset:0
    v_mfma_f32_16x16x32_bf16 v[180:183], v[52:55], a[180:183], v[180:183]
    ds_read_b64_tr_b16 v[50:51], v12 offset:1024
    v_mfma_f32_16x16x32_bf16 v[212:215], v[52:55], a[184:187], v[212:215]
    ds_read_b128 a[204:207], v28 offset:6144
    v_mfma_f32_16x16x32_bf16 v[244:247], v[52:55], a[188:191], v[244:247]
    buffer_load_dwordx4 v24, s[20:23], s98 offen offset:0   lds
    v_mfma_f32_16x16x32_bf16 v[152:155], v[56:59], a[176:179], v[152:155]
    ds_read_b64_tr_b16 v[52:53], v13 offset:0
    v_mfma_f32_16x16x32_bf16 v[184:187], v[56:59], a[180:183], v[184:187]
    ds_read_b64_tr_b16 v[54:55], v13 offset:1024
    v_mfma_f32_16x16x32_bf16 v[216:219], v[56:59], a[184:187], v[216:219]
    buffer_load_dwordx4 v[80:83], v96, s[8:11], s70 offen
    v_mfma_f32_16x16x32_bf16 v[248:251], v[56:59], a[188:191], v[248:251]
    buffer_load_dwordx4 v25, s[20:23], s98 offen offset:1024   lds
    v_mfma_f32_16x16x32_bf16 v[156:159], v[60:63], a[176:179], v[156:159]
    s_lshl_b32 s80, s2, 6
    s_add_u32 s80, s80, 1310720
    ds_read_b64_tr_b16 v[56:57], v14 offset:0
    v_mfma_f32_16x16x32_bf16 v[188:191], v[60:63], a[180:183], v[188:191]
    s_waitcnt lgkmcnt(6)
    s_add_u32 s70, s70, 12288
    ds_read_b64_tr_b16 v[58:59], v14 offset:1024
    v_mfma_f32_16x16x32_bf16 v[220:223], v[60:63], a[184:187], v[220:223]
    buffer_store_dword v6, v7, s[8:11], s80 offen sc0 sc1
    v_mfma_f32_16x16x32_bf16 v[252:255], v[60:63], a[188:191], v[252:255]
    buffer_load_dwordx4 v26, s[20:23], s98 offen offset:2048   lds
    v_mfma_f32_16x16x32_bf16 v[128:131], v[32:35], a[192:195], v[128:131]
    ds_read_b64_tr_b16 v[60:61], v15 offset:0
    v_mfma_f32_16x16x32_bf16 v[160:163], v[32:35], a[196:199], v[160:163]
    ds_read_b64_tr_b16 v[62:63], v15 offset:1024
    v_mfma_f32_16x16x32_bf16 v[192:195], v[32:35], a[200:203], v[192:195]
    s_waitcnt lgkmcnt(5)
    ds_read_b128 a[208:211], v29 offset:0
    v_mfma_f32_16x16x32_bf16 v[224:227], v[32:35], a[204:207], v[224:227]
    ds_read_b128 a[212:215], v29 offset:2048
    v_mfma_f32_16x16x32_bf16 v[132:135], v[36:39], a[192:195], v[132:135]
    ds_read_b64_tr_b16 v[32:33], v8 offset:8192
    v_mfma_f32_16x16x32_bf16 v[164:167], v[36:39], a[196:199], v[164:167]
    ds_read_b64_tr_b16 v[34:35], v8 offset:9216
    v_mfma_f32_16x16x32_bf16 v[196:199], v[36:39], a[200:203], v[196:199]
    ds_read_b128 a[216:219], v29 offset:4096
    v_mfma_f32_16x16x32_bf16 v[228:231], v[36:39], a[204:207], v[228:231]
    ds_read_b128 a[220:223], v29 offset:6144
    v_mfma_f32_16x16x32_bf16 v[136:139], v[40:43], a[192:195], v[136:139]
    ds_read_b64_tr_b16 v[36:37], v9 offset:8192
    v_mfma_f32_16x16x32_bf16 v[168:171], v[40:43], a[196:199], v[168:171]
    ds_read_b64_tr_b16 v[38:39], v9 offset:9216
    v_mfma_f32_16x16x32_bf16 v[200:203], v[40:43], a[200:203], v[200:203]
    buffer_load_dwordx4 v27, s[20:23], s98 offen offset:3072   lds
    v_mfma_f32_16x16x32_bf16 v[232:235], v[40:43], a[204:207], v[232:235]
    buffer_load_dwordx4 v[84:87], v96, s[8:11], s70 offen
    v_mfma_f32_16x16x32_bf16 v[140:143], v[44:47], a[192:195], v[140:143]
    s_add_u32 m0, s62, 69632
    s_xor_b32 s98, s64, 262144
    ds_read_b64_tr_b16 v[40:41], v10 offset:8192
    v_mfma_f32_16x16x32_bf16 v[172:175], v[44:47], a[196:199], v[172:175]
    s_add_u32 s70, s70, 12288
    ds_read_b64_tr_b16 v[42:43], v10 offset:9216
    v_mfma_f32_16x16x32_bf16 v[204:207], v[44:47], a[200:203], v[204:207]
    buffer_load_dwordx4 v24, s[20:23], s98 offen offset:0   lds
    v_mfma_f32_16x16x32_bf16 v[236:239], v[44:47], a[204:207], v[236:239]
    buffer_load_dwordx4 v[88:91], v96, s[8:11], s70 offen
    v_mfma_f32_16x16x32_bf16 v[144:147], v[48:51], a[192:195], v[144:147]
    s_add_u32 s70, s70, 12288
    ds_read_b64_tr_b16 v[44:45], v11 offset:8192
    v_mfma_f32_16x16x32_bf16 v[176:179], v[48:51], a[196:199], v[176:179]
    s_waitcnt lgkmcnt(5)
    ds_read_b64_tr_b16 v[46:47], v11 offset:9216
    v_mfma_f32_16x16x32_bf16 v[208:211], v[48:51], a[200:203], v[208:211]
    buffer_load_dwordx4 v25, s[20:23], s98 offen offset:1024   lds
    v_mfma_f32_16x16x32_bf16 v[240:243], v[48:51], a[204:207], v[240:243]
    buffer_load_dwordx4 v[92:95], v96, s[8:11], s70 offen
    v_mfma_f32_16x16x32_bf16 v[148:151], v[52:55], a[192:195], v[148:151]
    ds_read_b64_tr_b16 v[48:49], v12 offset:8192
    v_mfma_f32_16x16x32_bf16 v[180:183], v[52:55], a[196:199], v[180:183]
    ds_read_b64_tr_b16 v[50:51], v12 offset:9216
    v_mfma_f32_16x16x32_bf16 v[212:215], v[52:55], a[200:203], v[212:215]
    buffer_load_dwordx4 v26, s[20:23], s98 offen offset:2048   lds
    v_mfma_f32_16x16x32_bf16 v[244:247], v[52:55], a[204:207], v[244:247]
    v_mfma_f32_16x16x32_bf16 v[152:155], v[56:59], a[192:195], v[152:155]
    ds_read_b64_tr_b16 v[52:53], v13 offset:8192
    v_mfma_f32_16x16x32_bf16 v[184:187], v[56:59], a[196:199], v[184:187]
    ds_read_b64_tr_b16 v[54:55], v13 offset:9216
    v_mfma_f32_16x16x32_bf16 v[216:219], v[56:59], a[200:203], v[216:219]
    buffer_load_dwordx4 v27, s[20:23], s98 offen offset:3072   lds
    v_mfma_f32_16x16x32_bf16 v[248:251], v[56:59], a[204:207], v[248:251]
    v_mfma_f32_16x16x32_bf16 v[156:159], v[60:63], a[192:195], v[156:159]
    ds_read_b64_tr_b16 v[56:57], v14 offset:8192
    v_mfma_f32_16x16x32_bf16 v[188:191], v[60:63], a[196:199], v[188:191]
    ds_read_b64_tr_b16 v[58:59], v14 offset:9216
    v_mfma_f32_16x16x32_bf16 v[220:223], v[60:63], a[200:203], v[220:223]
    v_mfma_f32_16x16x32_bf16 v[252:255], v[60:63], a[204:207], v[252:255]
    v_mfma_f32_16x16x32_bf16 v[128:131], v[32:35], a[208:211], v[128:131]
    ds_read_b64_tr_b16 v[60:61], v15 offset:8192
    v_mfma_f32_16x16x32_bf16 v[160:163], v[32:35], a[212:215], v[160:163]
    ds_read_b64_tr_b16 v[62:63], v15 offset:9216
    v_mfma_f32_16x16x32_bf16 v[192:195], v[32:35], a[216:219], v[192:195]
    s_getpc_b64 s[100:101]
L_ct1:
    s_lshr_b32 s99, s2, 3
    s_lshl_b32 s99, s99, 2
    s_add_u32 s99, s99, s3
    s_mul_i32 s99, s99, 2
    v_min_u32 v3, 1, v2
    v_add_u32 v3, s99, v3
    v_lshlrev_b32 v3, 7, v3
    v_add_u32 v3, L_ct1-L_ct1, v3
    v_min_u32 v3, L_attn-L_ct1, v3
    global_load_dword v3, v3, s[100:101]
    v_mfma_f32_16x16x32_bf16 v[224:227], v[32:35], a[220:223], v[224:227]
    s_waitcnt lgkmcnt(4)
    v_mfma_f32_16x16x32_bf16 v[132:135], v[36:39], a[208:211], v[132:135]
    v_mfma_f32_16x16x32_bf16 v[164:167], v[36:39], a[212:215], v[164:167]
    v_mfma_f32_16x16x32_bf16 v[196:199], v[36:39], a[216:219], v[196:199]
    v_mfma_f32_16x16x32_bf16 v[228:231], v[36:39], a[220:223], v[228:231]
    v_mfma_f32_16x16x32_bf16 v[136:139], v[40:43], a[208:211], v[136:139]
    s_waitcnt vmcnt(14) lgkmcnt(0)
    s_barrier
    v_mfma_f32_16x16x32_bf16 v[168:171], v[40:43], a[212:215], v[168:171]
    s_add_u32 m0, s62, 0
    s_xor_b32 s98, s64, 2097152
    ds_read_b64_tr_b16 v[32:33], v8 offset:16384
    v_mfma_f32_16x16x32_bf16 v[200:203], v[40:43], a[216:219], v[200:203]
    ds_read_b64_tr_b16 v[34:35], v8 offset:17408
    v_mfma_f32_16x16x32_bf16 v[232:235], v[40:43], a[220:223], v[232:235]
    ds_read_b64_tr_b16 v[96:97], v8 offset:24576
    v_mfma_f32_16x16x32_bf16 v[140:143], v[44:47], a[208:211], v[140:143]
    ds_read_b64_tr_b16 v[98:99], v8 offset:25600
    v_mfma_f32_16x16x32_bf16 v[172:175], v[44:47], a[212:215], v[172:175]
    ds_read_b128 a[224:227], v28 offset:32768
    v_mfma_f32_16x16x32_bf16 v[204:207], v[44:47], a[216:219], v[204:207]
    ds_read_b128 a[240:243], v29 offset:32768
    v_mfma_f32_16x16x32_bf16 v[236:239], v[44:47], a[220:223], v[236:239]
    ds_read_b64_tr_b16 v[36:37], v9 offset:16384
    v_mfma_f32_16x16x32_bf16 v[144:147], v[48:51], a[208:211], v[144:147]
    ds_read_b64_tr_b16 v[38:39], v9 offset:17408
    v_mfma_f32_16x16x32_bf16 v[176:179], v[48:51], a[212:215], v[176:179]
    ds_read_b64_tr_b16 v[100:101], v9 offset:24576
    v_mfma_f32_16x16x32_bf16 v[208:211], v[48:51], a[216:219], v[208:211]
    ds_read_b64_tr_b16 v[102:103], v9 offset:25600
    v_mfma_f32_16x16x32_bf16 v[240:243], v[48:51], a[220:223], v[240:243]
    ds_read_b128 a[228:231], v28 offset:34816
    v_mfma_f32_16x16x32_bf16 v[148:151], v[52:55], a[208:211], v[148:151]
    ds_read_b128 a[244:247], v29 offset:34816
    v_mfma_f32_16x16x32_bf16 v[180:183], v[52:55], a[212:215], v[180:183]
    ds_read_b128 a[232:235], v28 offset:36864
    v_mfma_f32_16x16x32_bf16 v[212:215], v[52:55], a[216:219], v[212:215]
    ds_read_b128 a[248:251], v29 offset:36864
    v_mfma_f32_16x16x32_bf16 v[244:247], v[52:55], a[220:223], v[244:247]
    ds_read_b128 a[236:239], v28 offset:38912
    v_mfma_f32_16x16x32_bf16 v[152:155], v[56:59], a[208:211], v[152:155]
    ds_read_b128 a[252:255], v29 offset:38912
    v_mfma_f32_16x16x32_bf16 v[184:187], v[56:59], a[212:215], v[184:187]
    ds_read_b64_tr_b16 v[40:41], v10 offset:16384
    v_and_b32 v16, 15, v2
    v_mfma_f32_16x16x32_bf16 v[216:219], v[56:59], a[216:219], v[216:219]
    ds_read_b64_tr_b16 v[42:43], v10 offset:17408
    v_lshrrev_b32 v17, 4, v2
    v_mfma_f32_16x16x32_bf16 v[248:251], v[56:59], a[220:223], v[248:251]
    ds_read_b64_tr_b16 v[104:105], v10 offset:24576
    v_lshrrev_b32 v29, 2, v16
    v_mfma_f32_16x16x32_bf16 v[156:159], v[60:63], a[208:211], v[156:159]
    ds_read_b64_tr_b16 v[106:107], v10 offset:25600
    v_and_b32 v16, 3, v16
    v_mfma_f32_16x16x32_bf16 v[188:191], v[60:63], a[212:215], v[188:191]
    ds_read_b64_tr_b16 v[44:45], v11 offset:16384
    v_lshl_add_u32 v28, v17, 3, v29
    v_mfma_f32_16x16x32_bf16 v[220:223], v[60:63], a[216:219], v[220:223]
    ds_read_b64_tr_b16 v[46:47], v11 offset:17408
    v_lshlrev_b32 v28, 7, v28
    v_mfma_f32_16x16x32_bf16 v[252:255], v[60:63], a[220:223], v[252:255]
    s_waitcnt lgkmcnt(9)
    ds_read_b64_tr_b16 v[108:109], v11 offset:24576
    v_lshl_add_u32 v28, v16, 3, v28
    v_mfma_f32_16x16x32_bf16 v[128:131], v[32:35], a[224:227], v[128:131]
    ds_read_b64_tr_b16 v[110:111], v11 offset:25600
    v_and_b32 v17, 1, v17
    v_mfma_f32_16x16x32_bf16 v[128:131], v[96:99], a[240:243], v[128:131]
    v_lshrrev_b32 v29, 1, v29
    v_lshl_add_u32 v29, v17, 1, v29
    v_mfma_f32_16x16x32_bf16 v[132:135], v[36:39], a[224:227], v[132:135]
    v_lshl_add_u32 v28, v29, 5, v28
    v_add_u32 v28, 65536, v28
    v_mfma_f32_16x16x32_bf16 v[132:135], v[100:103], a[240:243], v[132:135]
    v_xor_b32 v29, 32, v28
    v_xor_b32 v30, 64, v28
    v_mfma_f32_16x16x32_bf16 v[160:163], v[32:35], a[228:231], v[160:163]
    v_xor_b32 v31, 96, v28
    v_and_b32 v16, 15, v2
    v_mfma_f32_16x16x32_bf16 v[160:163], v[96:99], a[244:247], v[160:163]
    v_lshlrev_b32 v16, 6, v16
    v_add_u32 v16, 65536, v16
    s_waitcnt vmcnt(7)
    v_add_f32 v80, v80, v84
    v_mfma_f32_16x16x32_bf16 v[164:167], v[36:39], a[228:231], v[164:167]
    v_mad_i32_i24 v16, v17, s77, v16
    v_and_b32 v17, 31, v2
    s_waitcnt vmcnt(3)
    v_add_f32 v88, v88, v92
    v_mfma_f32_16x16x32_bf16 v[164:167], v[100:103], a[244:247], v[164:167]
    buffer_load_dwordx4 v24, s[20:23], s98 offen offset:0   lds
    v_add_f32 v81, v81, v85
    v_mfma_f32_16x16x32_bf16 v[192:195], v[32:35], a[232:235], v[192:195]
    s_waitcnt lgkmcnt(2)
    ds_read_b64_tr_b16 v[48:49], v12 offset:16384
    v_lshlrev_b32 v17, 6, v17
    v_add_f32 v89, v89, v93
    v_mfma_f32_16x16x32_bf16 v[192:195], v[96:99], a[248:251], v[192:195]
    ds_read_b64_tr_b16 v[50:51], v12 offset:17408
    v_add_f32 v82, v82, v86
    v_add_f32 v90, v90, v94
    v_mfma_f32_16x16x32_bf16 v[196:199], v[36:39], a[232:235], v[196:199]
    ds_read_b64_tr_b16 v[112:113], v12 offset:24576
    v_add_f32 v83, v83, v87
    v_add_f32 v91, v91, v95
    v_mfma_f32_16x16x32_bf16 v[196:199], v[100:103], a[248:251], v[196:199]
    ds_read_b64_tr_b16 v[114:115], v12 offset:25600
    v_add_f32 v80, v80, v88
    v_add_f32 v81, v81, v89
    v_mfma_f32_16x16x32_bf16 v[224:227], v[32:35], a[236:239], v[224:227]
    ds_read_b64_tr_b16 v[52:53], v13 offset:16384
    v_add_f32 v82, v82, v90
    v_add_f32 v83, v83, v91
    v_mfma_f32_16x16x32_bf16 v[224:227], v[96:99], a[252:255], v[224:227]
    ds_read_b64_tr_b16 v[54:55], v13 offset:17408
    v_lshrrev_b32 v88, 5, v2
    v_cvt_f32_u32 v88, v88
    v_mfma_f32_16x16x32_bf16 v[228:231], v[36:39], a[236:239], v[228:231]
    ds_read_b64_tr_b16 v[116:117], v13 offset:24576
    v_cvt_pk_bf16_f32 v84, v80, v81
    v_cvt_pk_bf16_f32 v85, v82, v83
    v_mfma_f32_16x16x32_bf16 v[228:231], v[100:103], a[252:255], v[228:231]
    ds_read_b64_tr_b16 v[118:119], v13 offset:25600
    v_lshlrev_b32 v80, 16, v84
    v_and_b32 v81, 0xffff0000, v84
    v_mfma_f32_16x16x32_bf16 v[136:139], v[40:43], a[224:227], v[136:139]
    buffer_load_dwordx4 v25, s[20:23], s98 offen offset:1024   lds
    v_lshlrev_b32 v82, 16, v85
    v_mfma_f32_16x16x32_bf16 v[136:139], v[104:107], a[240:243], v[136:139]
    s_waitcnt lgkmcnt(8)
    v_and_b32 v83, 0xffff0000, v85
    v_add_f32 v80, v80, v88
    v_add_f32 v81, v81, v88
    v_mfma_f32_16x16x32_bf16 v[140:143], v[44:47], a[224:227], v[140:143]
    buffer_load_dwordx4 v26, s[20:23], s98 offen offset:2048   lds
    v_add_f32 v82, v82, v88
    v_mfma_f32_16x16x32_bf16 v[140:143], v[108:111], a[240:243], v[140:143]
    v_add_f32 v83, v83, v88
    v_cvt_pk_bf16_f32 v84, v80, v81
    v_cvt_pk_bf16_f32 v85, v82, v83
    v_mfma_f32_16x16x32_bf16 v[168:171], v[40:43], a[228:231], v[168:171]
    buffer_load_dwordx4 v27, s[20:23], s98 offen offset:3072   lds
    v_lshlrev_b32 v80, 16, v84
    v_mfma_f32_16x16x32_bf16 v[168:171], v[104:107], a[244:247], v[168:171]
    s_add_u32 m0, s62, 4096
    s_xor_b32 s98, s64, 2359296
    v_and_b32 v81, 0xffff0000, v84
    v_lshlrev_b32 v82, 16, v85
    v_and_b32 v83, 0xffff0000, v85
    v_mfma_f32_16x16x32_bf16 v[172:175], v[44:47], a[228:231], v[172:175]
    buffer_load_dwordx4 v24, s[20:23], s98 offen offset:0   lds
    v_mul_f32 v80, 0x3e0293ee, v80
    v_mfma_f32_16x16x32_bf16 v[172:175], v[108:111], a[244:247], v[172:175]
    v_mul_f32 v81, 0x3e0293ee, v81
    v_mul_f32 v82, 0x3e0293ee, v82
    v_mul_f32 v83, 0x3e0293ee, v83
    v_mfma_f32_16x16x32_bf16 v[200:203], v[40:43], a[232:235], v[200:203]
    s_lshl_b32 s70, s3, 10
    s_add_u32 s70, s70, 151552
    ds_read_b64_tr_b16 v[56:57], v14 offset:16384
    v_add_u32 v88, s70, v1
    v_add_u32 v18, s70, v18
    v_mfma_f32_16x16x32_bf16 v[200:203], v[104:107], a[248:251], v[200:203]
    ds_read_b64_tr_b16 v[58:59], v14 offset:17408
    ds_write_b128 v88, v[80:83]
    v_mfma_f32_16x16x32_bf16 v[204:207], v[44:47], a[232:235], v[204:207]
    ds_read_b64_tr_b16 v[120:121], v14 offset:24576
    v_cvt_pk_bf16_f32 v128, v128, v129
    v_mfma_f32_16x16x32_bf16 v[204:207], v[108:111], a[248:251], v[204:207]
    ds_read_b64_tr_b16 v[122:123], v14 offset:25600
    v_cvt_pk_bf16_f32 v129, v130, v131
    v_mfma_f32_16x16x32_bf16 v[232:235], v[40:43], a[236:239], v[232:235]
    ds_read_b64_tr_b16 v[60:61], v15 offset:16384
    v_cvt_pk_bf16_f32 v130, v132, v133
    v_mfma_f32_16x16x32_bf16 v[232:235], v[104:107], a[252:255], v[232:235]
    ds_read_b64_tr_b16 v[62:63], v15 offset:17408
    v_cvt_pk_bf16_f32 v131, v134, v135
    v_mfma_f32_16x16x32_bf16 v[236:239], v[44:47], a[236:239], v[236:239]
    s_xor_b32 s79, s65, 0
    ds_read_b64_tr_b16 v[124:125], v15 offset:24576
    v_mfma_f32_16x16x32_bf16 v[236:239], v[108:111], a[252:255], v[236:239]
    s_waitcnt lgkmcnt(8)
    ds_read_b64_tr_b16 v[126:127], v15 offset:25600
    v_mfma_f32_16x16x32_bf16 v[144:147], v[48:51], a[224:227], v[144:147]
    buffer_load_dwordx4 v25, s[20:23], s98 offen offset:1024   lds
    v_mfma_f32_16x16x32_bf16 v[144:147], v[112:115], a[240:243], v[144:147]
    ds_read_b128 v[80:83], v18 offset:0
    v_mfma_f32_16x16x32_bf16 v[148:151], v[52:55], a[224:227], v[148:151]
    buffer_load_dwordx4 v26, s[20:23], s98 offen offset:2048   lds
    v_mfma_f32_16x16x32_bf16 v[148:151], v[116:119], a[240:243], v[148:151]
    ds_read_b128 v[84:87], v18 offset:16
    v_mfma_f32_16x16x32_bf16 v[176:179], v[48:51], a[228:231], v[176:179]
    buffer_load_dwordx4 v27, s[20:23], s98 offen offset:3072   lds
    v_mfma_f32_16x16x32_bf16 v[176:179], v[112:115], a[244:247], v[176:179]
    ds_read_b128 v[88:91], v18 offset:512
    v_mfma_f32_16x16x32_bf16 v[180:183], v[52:55], a[228:231], v[180:183]
    ds_read_b128 v[92:95], v18 offset:528
    v_mfma_f32_16x16x32_bf16 v[180:183], v[116:119], a[244:247], v[180:183]
    buffer_store_dwordx4 v[128:131], v1, s[8:11], s79 offen offset:0 sc0 sc1
    v_mfma_f32_16x16x32_bf16 v[208:211], v[48:51], a[232:235], v[208:211]
    v_cvt_pk_bf16_f32 v160, v160, v161
    v_cvt_pk_bf16_f32 v161, v162, v163
    s_waitcnt vmcnt(10) lgkmcnt(0)
    s_barrier
    v_mfma_f32_16x16x32_bf16 v[208:211], v[112:115], a[248:251], v[208:211]
    s_add_u32 m0, s62, 32768
    s_xor_b32 s98, s64, 128
    ds_read_b64_tr_b16 v[32:33], v28 offset:0
    v_mfma_f32_16x16x32_bf16 v[212:215], v[52:55], a[232:235], v[212:215]
    ds_read_b64_tr_b16 v[34:35], v28 offset:512
    v_cvt_pk_bf16_f32 v162, v164, v165
    v_mfma_f32_16x16x32_bf16 v[212:215], v[116:119], a[248:251], v[212:215]
    ds_read_b64_tr_b16 v[36:37], v28 offset:4096
    v_cvt_pk_bf16_f32 v163, v166, v167
    v_mfma_f32_16x16x32_bf16 v[240:243], v[48:51], a[236:239], v[240:243]
    s_xor_b32 s79, s65, 4096
    ds_read_b64_tr_b16 v[38:39], v28 offset:4608
    v_fma_f32 v64, v64, v88, v80
    v_mfma_f32_16x16x32_bf16 v[240:243], v[112:115], a[252:255], v[240:243]
    ds_read_b64_tr_b16 v[40:41], v28 offset:8192
    v_fma_f32 v65, v65, v89, v81
    v_mfma_f32_16x16x32_bf16 v[244:247], v[52:55], a[236:239], v[244:247]
    ds_read_b64_tr_b16 v[42:43], v28 offset:8704
    v_fma_f32 v66, v66, v90, v82
    v_mfma_f32_16x16x32_bf16 v[244:247], v[116:119], a[252:255], v[244:247]
    ds_read_b64_tr_b16 v[44:45], v28 offset:12288
    v_fma_f32 v67, v67, v91, v83
    v_mfma_f32_16x16x32_bf16 v[152:155], v[56:59], a[224:227], v[152:155]
    ds_read_b64_tr_b16 v[46:47], v28 offset:12800
    v_fma_f32 v68, v68, v92, v84
    v_mfma_f32_16x16x32_bf16 v[152:155], v[120:123], a[240:243], v[152:155]
    ds_read_b64_tr_b16 v[48:49], v29 offset:0
    v_fma_f32 v69, v69, v93, v85
    v_mfma_f32_16x16x32_bf16 v[156:159], v[60:63], a[224:227], v[156:159]
    ds_read_b64_tr_b16 v[50:51], v29 offset:512
    v_fma_f32 v70, v70, v94, v86
    v_mfma_f32_16x16x32_bf16 v[156:159], v[124:127], a[240:243], v[156:159]
    ds_read_b64_tr_b16 v[52:53], v29 offset:4096
    v_fma_f32 v71, v71, v95, v87
    v_mfma_f32_16x16x32_bf16 v[184:187], v[56:59], a[228:231], v[184:187]
    ds_read_b64_tr_b16 v[54:55], v29 offset:4608
    v_cvt_pk_bf16_f32 v64, v64, v65
    v_mfma_f32_16x16x32_bf16 v[184:187], v[120:123], a[244:247], v[184:187]
    buffer_load_dwordx4 v24, s[20:23], s98 offen offset:0   lds
    v_mfma_f32_16x16x32_bf16 v[188:191], v[60:63], a[228:231], v[188:191]
    v_cvt_pk_bf16_f32 v65, v66, v67
    v_cvt_pk_bf16_f32 v66, v68, v69
    v_mfma_f32_16x16x32_bf16 v[188:191], v[124:127], a[244:247], v[188:191]
    ds_read_b128 v[80:83], v18 offset:256
    v_cvt_pk_bf16_f32 v67, v70, v71
    v_mfma_f32_16x16x32_bf16 v[216:219], v[56:59], a[232:235], v[216:219]
    buffer_store_dwordx4 v[64:67], v19, s[8:11], s71 offen offset:0 sc0 sc1
    v_mfma_f32_16x16x32_bf16 v[216:219], v[120:123], a[248:251], v[216:219]
    buffer_load_dwordx4 v25, s[20:23], s98 offen offset:1024   lds
    v_mfma_f32_16x16x32_bf16 v[220:223], v[60:63], a[232:235], v[220:223]
    ds_read_b128 v[84:87], v18 offset:272
    v_mfma_f32_16x16x32_bf16 v[220:223], v[124:127], a[248:251], v[220:223]
    ds_read_b128 v[88:91], v18 offset:768
    v_mfma_f32_16x16x32_bf16 v[248:251], v[56:59], a[236:239], v[248:251]
    ds_read_b128 v[92:95], v18 offset:784
    v_mfma_f32_16x16x32_bf16 v[248:251], v[120:123], a[252:255], v[248:251]
    buffer_load_dwordx4 v26, s[20:23], s98 offen offset:2048   lds
    v_mfma_f32_16x16x32_bf16 v[252:255], v[60:63], a[236:239], v[252:255]
    buffer_store_dwordx4 v[160:163], v1, s[8:11], s79 offen offset:0 sc0 sc1
    v_mfma_f32_16x16x32_bf16 v[252:255], v[124:127], a[252:255], v[252:255]
    s_waitcnt lgkmcnt(4)
    v_mfma_f32_16x16x32_bf16 v[96:99], a[0:3], v[32:35], 0
    ds_read_b64_tr_b16 v[56:57], v29 offset:8192
    v_cvt_pk_bf16_f32 v192, v192, v193
    v_mfma_f32_16x16x32_bf16 v[96:99], a[16:19], v[36:39], v[96:99]
    ds_read_b64_tr_b16 v[58:59], v29 offset:8704
    v_cvt_pk_bf16_f32 v193, v194, v195
    v_mfma_f32_16x16x32_bf16 v[96:99], a[32:35], v[40:43], v[96:99]
    ds_read_b64_tr_b16 v[60:61], v29 offset:12288
    s_waitcnt lgkmcnt(4)
    v_fma_f32 v72, v72, v88, v80
    v_mfma_f32_16x16x32_bf16 v[96:99], a[48:51], v[44:47], v[96:99]
    ds_read_b64_tr_b16 v[62:63], v29 offset:12800
    v_fma_f32 v73, v73, v89, v81
    v_mfma_f32_16x16x32_bf16 v[100:103], a[4:7], v[32:35], 0
    buffer_load_dwordx4 v27, s[20:23], s98 offen offset:3072   lds
    v_mfma_f32_16x16x32_bf16 v[100:103], a[20:23], v[36:39], v[100:103]
    s_add_u32 m0, s62, 36864
    s_xor_b32 s98, s64, 262272
    v_fma_f32 v74, v74, v90, v82
    v_mfma_f32_16x16x32_bf16 v[100:103], a[36:39], v[40:43], v[100:103]
    v_fma_f32 v75, v75, v91, v83
    s_waitcnt lgkmcnt(4)
    v_fma_f32 v76, v76, v92, v84
    v_mfma_f32_16x16x32_bf16 v[100:103], a[52:55], v[44:47], v[100:103]
    v_fma_f32 v77, v77, v93, v85
    v_fma_f32 v78, v78, v94, v86
    v_mfma_f32_16x16x32_bf16 v[104:107], a[8:11], v[32:35], 0
    buffer_load_dwordx4 v24, s[20:23], s98 offen offset:0   lds
    v_mfma_f32_16x16x32_bf16 v[104:107], a[24:27], v[36:39], v[104:107]
    v_fma_f32 v79, v79, v95, v87
    v_cvt_pk_bf16_f32 v194, v196, v197
    v_mfma_f32_16x16x32_bf16 v[104:107], a[40:43], v[40:43], v[104:107]
    v_cvt_pk_bf16_f32 v72, v72, v73
    v_cvt_pk_bf16_f32 v73, v74, v75
    v_mfma_f32_16x16x32_bf16 v[104:107], a[56:59], v[44:47], v[104:107]
    v_cvt_pk_bf16_f32 v74, v76, v77
    v_cvt_pk_bf16_f32 v75, v78, v79
    v_mfma_f32_16x16x32_bf16 v[108:111], a[12:15], v[32:35], 0
    buffer_load_dwordx4 v25, s[20:23], s98 offen offset:1024   lds
    v_mfma_f32_16x16x32_bf16 v[108:111], a[28:31], v[36:39], v[108:111]
    ds_read_b64_tr_b16 v[32:33], v28 offset:16384
    v_cvt_pk_bf16_f32 v195, v198, v199
    v_mfma_f32_16x16x32_bf16 v[108:111], a[44:47], v[40:43], v[108:111]
    s_xor_b32 s79, s65, 8192
    ds_read_b64_tr_b16 v[34:35], v28 offset:16896
    v_mfma_f32_16x16x32_bf16 v[108:111], a[60:63], v[44:47], v[108:111]
    ds_read_b64_tr_b16 v[36:37], v28 offset:20480
    v_mfma_f32_16x16x32_bf16 v[112:115], a[0:3], v[48:51], 0
    ds_read_b64_tr_b16 v[38:39], v28 offset:20992
    v_mfma_f32_16x16x32_bf16 v[112:115], a[16:19], v[52:55], v[112:115]
    s_waitcnt lgkmcnt(4)
    ds_read_b64_tr_b16 v[40:41], v28 offset:24576
    v_mfma_f32_16x16x32_bf16 v[112:115], a[32:35], v[56:59], v[112:115]
    ds_read_b64_tr_b16 v[42:43], v28 offset:25088
    v_mfma_f32_16x16x32_bf16 v[112:115], a[48:51], v[60:63], v[112:115]
    ds_read_b64_tr_b16 v[44:45], v28 offset:28672
    v_mfma_f32_16x16x32_bf16 v[116:119], a[4:7], v[48:51], 0
    s_lshr_b32 s100, s2, 3
    s_mul_i32 s66, s4, 28
    ds_read_b64_tr_b16 v[46:47], v28 offset:29184
    v_mfma_f32_16x16x32_bf16 v[116:119], a[20:23], v[52:55], v[116:119]
    buffer_load_dwordx4 v26, s[20:23], s98 offen offset:2048   lds
    v_mfma_f32_16x16x32_bf16 v[116:119], a[36:39], v[56:59], v[116:119]
    buffer_store_dwordx4 v[72:75], v19, s[8:11], s71 offen offset:2048 sc0 sc1
    v_mfma_f32_16x16x32_bf16 v[116:119], a[52:55], v[60:63], v[116:119]
    buffer_store_dwordx4 v[192:195], v1, s[8:11], s79 offen offset:0 sc0 sc1
    v_mfma_f32_16x16x32_bf16 v[120:123], a[8:11], v[48:51], 0
    s_add_u32 s66, s66, s100
    s_cmp_lt_u32 s100, 28
    s_cselect_b32 s66, s66, 255
    s_lshl_b32 s67, s4, 3
    v_mfma_f32_16x16x32_bf16 v[120:123], a[24:27], v[52:55], v[120:123]
    buffer_load_dwordx4 v27, s[20:23], s98 offen offset:3072   lds
    v_mfma_f32_16x16x32_bf16 v[120:123], a[40:43], v[56:59], v[120:123]
    s_add_u32 m0, s63, 131072
    s_xor_b32 s98, s0, 0
    v_cvt_pk_bf16_f32 v224, v224, v225
    v_mfma_f32_16x16x32_bf16 v[120:123], a[56:59], v[60:63], v[120:123]
    s_add_u32 s67, s67, s100
    v_cvt_pk_bf16_f32 v225, v226, v227
    v_cvt_pk_bf16_f32 v226, v228, v229
    v_mfma_f32_16x16x32_bf16 v[124:127], a[12:15], v[48:51], 0
    v_mfma_f32_16x16x32_bf16 v[124:127], a[28:31], v[52:55], v[124:127]
    s_sub_u32 s67, s67, 24
    ds_read_b64_tr_b16 v[48:49], v29 offset:16384
    v_cvt_pk_bf16_f32 v227, v230, v231
    v_mfma_f32_16x16x32_bf16 v[124:127], a[44:47], v[56:59], v[124:127]
    s_xor_b32 s79, s65, 12288
    s_cmp_ge_u32 s100, 24
    s_cselect_b32 s67, s67, 255
    ds_read_b64_tr_b16 v[50:51], v29 offset:16896
    v_mfma_f32_16x16x32_bf16 v[124:127], a[60:63], v[60:63], v[124:127]
    s_waitcnt lgkmcnt(2)
    ds_read_b64_tr_b16 v[52:53], v29 offset:20480
    v_mfma_f32_16x16x32_bf16 v[96:99], a[64:67], v[32:35], v[96:99]
    ds_read_b64_tr_b16 v[54:55], v29 offset:20992
    v_mfma_f32_16x16x32_bf16 v[96:99], a[80:83], v[36:39], v[96:99]
    ds_read_b64_tr_b16 v[56:57], v29 offset:24576
    v_mfma_f32_16x16x32_bf16 v[96:99], a[96:99], v[40:43], v[96:99]
    ds_read_b64_tr_b16 v[58:59], v29 offset:25088
    v_mfma_f32_16x16x32_bf16 v[96:99], a[112:115], v[44:47], v[96:99]
    ds_read_b64_tr_b16 v[60:61], v29 offset:28672
    v_mfma_f32_16x16x32_bf16 v[100:103], a[68:71], v[32:35], v[100:103]
    ds_read_b64_tr_b16 v[62:63], v29 offset:29184
    v_mfma_f32_16x16x32_bf16 v[100:103], a[84:87], v[36:39], v[100:103]
    buffer_load_dwordx4 v20, s[24:27], s98 offen offset:0   lds
    v_mfma_f32_16x16x32_bf16 v[100:103], a[100:103], v[40:43], v[100:103]
    buffer_store_dwordx4 v[224:227], v1, s[8:11], s79 offen offset:0 sc0 sc1
    v_mfma_f32_16x16x32_bf16 v[100:103], a[116:119], v[44:47], v[100:103]
    v_cvt_pk_bf16_f32 v136, v136, v137
    v_cvt_pk_bf16_f32 v137, v138, v139
    v_mfma_f32_16x16x32_bf16 v[104:107], a[72:75], v[32:35], v[104:107]
    v_cvt_pk_bf16_f32 v138, v140, v141
    v_cvt_pk_bf16_f32 v139, v142, v143
    v_mfma_f32_16x16x32_bf16 v[104:107], a[88:91], v[36:39], v[104:107]
    buffer_load_dwordx4 v21, s[24:27], s98 offen offset:1024   lds
    v_mfma_f32_16x16x32_bf16 v[104:107], a[104:107], v[40:43], v[104:107]
    s_xor_b32 s79, s65, 0
    v_mfma_f32_16x16x32_bf16 v[104:107], a[120:123], v[44:47], v[104:107]
    buffer_store_dwordx4 v[136:139], v1, s[8:11], s79 offen offset:1024 sc0 sc1
    v_mfma_f32_16x16x32_bf16 v[108:111], a[76:79], v[32:35], v[108:111]
    v_mfma_f32_16x16x32_bf16 v[108:111], a[92:95], v[36:39], v[108:111]
    ds_read_b64_tr_b16 v[32:33], v30 offset:0
    v_cvt_pk_bf16_f32 v168, v168, v169
    v_mfma_f32_16x16x32_bf16 v[108:111], a[108:111], v[40:43], v[108:111]
    ds_read_b64_tr_b16 v[34:35], v30 offset:512
    v_cvt_pk_bf16_f32 v169, v170, v171
    v_mfma_f32_16x16x32_bf16 v[108:111], a[124:127], v[44:47], v[108:111]
    s_waitcnt lgkmcnt(2)
    ds_read_b64_tr_b16 v[36:37], v30 offset:4096
    v_cvt_pk_bf16_f32 v170, v172, v173
    v_mfma_f32_16x16x32_bf16 v[112:115], a[64:67], v[48:51], v[112:115]
    ds_read_b64_tr_b16 v[38:39], v30 offset:4608
    v_cvt_pk_bf16_f32 v171, v174, v175
    v_mfma_f32_16x16x32_bf16 v[112:115], a[80:83], v[52:55], v[112:115]
    s_xor_b32 s79, s65, 4096
    ds_read_b64_tr_b16 v[40:41], v30 offset:8192
    v_mfma_f32_16x16x32_bf16 v[112:115], a[96:99], v[56:59], v[112:115]
    ds_read_b64_tr_b16 v[42:43], v30 offset:8704
    v_mfma_f32_16x16x32_bf16 v[112:115], a[112:115], v[60:63], v[112:115]
    ds_read_b64_tr_b16 v[44:45], v30 offset:12288
    v_mfma_f32_16x16x32_bf16 v[116:119], a[68:71], v[48:51], v[116:119]
    ds_read_b64_tr_b16 v[46:47], v30 offset:12800
    v_mfma_f32_16x16x32_bf16 v[116:119], a[84:87], v[52:55], v[116:119]
    buffer_load_dwordx4 v22, s[24:27], s98 offen offset:2048   lds
    v_mfma_f32_16x16x32_bf16 v[116:119], a[100:103], v[56:59], v[116:119]
    buffer_store_dwordx4 v[168:171], v1, s[8:11], s79 offen offset:1024 sc0 sc1
    v_mfma_f32_16x16x32_bf16 v[116:119], a[116:119], v[60:63], v[116:119]
    v_cvt_pk_bf16_f32 v200, v200, v201
    v_cvt_pk_bf16_f32 v201, v202, v203
    v_mfma_f32_16x16x32_bf16 v[120:123], a[72:75], v[48:51], v[120:123]
    v_cvt_pk_bf16_f32 v202, v204, v205
    v_cvt_pk_bf16_f32 v203, v206, v207
    v_mfma_f32_16x16x32_bf16 v[120:123], a[88:91], v[52:55], v[120:123]
    buffer_load_dwordx4 v23, s[24:27], s98 offen offset:3072   lds
    v_mfma_f32_16x16x32_bf16 v[120:123], a[104:107], v[56:59], v[120:123]
    s_add_u32 m0, s63, 98304
    s_xor_b32 s98, s0, 524288
    s_xor_b32 s79, s65, 8192
    v_mfma_f32_16x16x32_bf16 v[120:123], a[120:123], v[60:63], v[120:123]
    buffer_store_dwordx4 v[200:203], v1, s[8:11], s79 offen offset:1024 sc0 sc1
    v_mfma_f32_16x16x32_bf16 v[124:127], a[76:79], v[48:51], v[124:127]
    v_mfma_f32_16x16x32_bf16 v[124:127], a[92:95], v[52:55], v[124:127]
    ds_read_b64_tr_b16 v[48:49], v31 offset:0
    v_cvt_pk_bf16_f32 v232, v232, v233
    v_mfma_f32_16x16x32_bf16 v[124:127], a[108:111], v[56:59], v[124:127]
    ds_read_b64_tr_b16 v[50:51], v31 offset:512
    v_cvt_pk_bf16_f32 v233, v234, v235
    v_mfma_f32_16x16x32_bf16 v[124:127], a[124:127], v[60:63], v[124:127]
    s_waitcnt lgkmcnt(2)
    ds_read_b64_tr_b16 v[52:53], v31 offset:4096
    v_cvt_pk_bf16_f32 v234, v236, v237
    v_mfma_f32_16x16x32_bf16 v[64:67], a[0:3], v[32:35], 0
    ds_read_b64_tr_b16 v[54:55], v31 offset:4608
    v_cvt_pk_bf16_f32 v235, v238, v239
    v_mfma_f32_16x16x32_bf16 v[64:67], a[16:19], v[36:39], v[64:67]
    s_xor_b32 s79, s65, 12288
    ds_read_b64_tr_b16 v[56:57], v31 offset:8192
    v_mfma_f32_16x16x32_bf16 v[64:67], a[32:35], v[40:43], v[64:67]
    ds_read_b64_tr_b16 v[58:59], v31 offset:8704
    v_mfma_f32_16x16x32_bf16 v[64:67], a[48:51], v[44:47], v[64:67]
    ds_read_b64_tr_b16 v[60:61], v31 offset:12288
    v_mfma_f32_16x16x32_bf16 v[68:71], a[4:7], v[32:35], 0
    ds_read_b64_tr_b16 v[62:63], v31 offset:12800
    v_mfma_f32_16x16x32_bf16 v[68:71], a[20:23], v[36:39], v[68:71]
    buffer_load_dwordx4 v20, s[24:27], s98 offen offset:0   lds
    v_mfma_f32_16x16x32_bf16 v[68:71], a[36:39], v[40:43], v[68:71]
    buffer_store_dwordx4 v[232:235], v1, s[8:11], s79 offen offset:1024 sc0 sc1
    v_mfma_f32_16x16x32_bf16 v[68:71], a[52:55], v[44:47], v[68:71]
    v_mfma_f32_16x16x32_bf16 v[72:75], a[8:11], v[32:35], 0
    v_mfma_f32_16x16x32_bf16 v[72:75], a[24:27], v[36:39], v[72:75]
    buffer_load_dwordx4 v21, s[24:27], s98 offen offset:1024   lds
    v_mfma_f32_16x16x32_bf16 v[72:75], a[40:43], v[40:43], v[72:75]
    v_cvt_pk_bf16_f32 v144, v144, v145
    v_cvt_pk_bf16_f32 v145, v146, v147
    v_mfma_f32_16x16x32_bf16 v[72:75], a[56:59], v[44:47], v[72:75]
    v_cvt_pk_bf16_f32 v146, v148, v149
    v_cvt_pk_bf16_f32 v147, v150, v151
    v_mfma_f32_16x16x32_bf16 v[76:79], a[12:15], v[32:35], 0
    v_mfma_f32_16x16x32_bf16 v[76:79], a[28:31], v[36:39], v[76:79]
    s_xor_b32 s79, s65, 0
    ds_read_b64_tr_b16 v[32:33], v30 offset:16384
    v_mfma_f32_16x16x32_bf16 v[76:79], a[44:47], v[40:43], v[76:79]
    ds_read_b64_tr_b16 v[34:35], v30 offset:16896
    v_mfma_f32_16x16x32_bf16 v[76:79], a[60:63], v[44:47], v[76:79]
    s_waitcnt lgkmcnt(2)
    ds_read_b64_tr_b16 v[36:37], v30 offset:20480
    v_mfma_f32_16x16x32_bf16 v[80:83], a[0:3], v[48:51], 0
    ds_read_b64_tr_b16 v[38:39], v30 offset:20992
    v_mfma_f32_16x16x32_bf16 v[80:83], a[16:19], v[52:55], v[80:83]
    ds_read_b64_tr_b16 v[40:41], v30 offset:24576
    v_mfma_f32_16x16x32_bf16 v[80:83], a[32:35], v[56:59], v[80:83]
    ds_read_b64_tr_b16 v[42:43], v30 offset:25088
    v_mfma_f32_16x16x32_bf16 v[80:83], a[48:51], v[60:63], v[80:83]
    ds_read_b64_tr_b16 v[44:45], v30 offset:28672
    v_mfma_f32_16x16x32_bf16 v[84:87], a[4:7], v[48:51], 0
    ds_read_b64_tr_b16 v[46:47], v30 offset:29184
    v_mfma_f32_16x16x32_bf16 v[84:87], a[20:23], v[52:55], v[84:87]
    buffer_load_dwordx4 v22, s[24:27], s98 offen offset:2048   lds
    v_mfma_f32_16x16x32_bf16 v[84:87], a[36:39], v[56:59], v[84:87]
    buffer_store_dwordx4 v[144:147], v1, s[8:11], s79 offen offset:2048 sc0 sc1
    v_mfma_f32_16x16x32_bf16 v[84:87], a[52:55], v[60:63], v[84:87]
    v_mfma_f32_16x16x32_bf16 v[88:91], a[8:11], v[48:51], 0
    v_mfma_f32_16x16x32_bf16 v[88:91], a[24:27], v[52:55], v[88:91]
    buffer_load_dwordx4 v23, s[24:27], s98 offen offset:3072   lds
    v_mfma_f32_16x16x32_bf16 v[88:91], a[40:43], v[56:59], v[88:91]
    v_mfma_f32_16x16x32_bf16 v[88:91], a[56:59], v[60:63], v[88:91]
    v_mfma_f32_16x16x32_bf16 v[92:95], a[12:15], v[48:51], 0
    v_cvt_pk_bf16_f32 v176, v176, v177
    v_cvt_pk_bf16_f32 v177, v178, v179
    s_waitcnt vmcnt(16)
    v_mfma_f32_16x16x32_bf16 v[92:95], a[28:31], v[52:55], v[92:95]
    ds_read_b64_tr_b16 v[48:49], v31 offset:16384
    v_cvt_pk_bf16_f32 v178, v180, v181
    v_mfma_f32_16x16x32_bf16 v[92:95], a[44:47], v[56:59], v[92:95]
    ds_read_b64_tr_b16 v[50:51], v31 offset:16896
    v_cvt_pk_bf16_f32 v179, v182, v183
    v_mfma_f32_16x16x32_bf16 v[92:95], a[60:63], v[60:63], v[92:95]
    s_waitcnt lgkmcnt(2)
    s_xor_b32 s79, s65, 4096
    ds_read_b64_tr_b16 v[52:53], v31 offset:20480
    v_mfma_f32_16x16x32_bf16 v[64:67], a[64:67], v[32:35], v[64:67]
    ds_read_b64_tr_b16 v[54:55], v31 offset:20992
    v_mfma_f32_16x16x32_bf16 v[64:67], a[80:83], v[36:39], v[64:67]
    ds_read_b64_tr_b16 v[56:57], v31 offset:24576
    v_mfma_f32_16x16x32_bf16 v[64:67], a[96:99], v[40:43], v[64:67]
    ds_read_b64_tr_b16 v[58:59], v31 offset:25088
    v_mfma_f32_16x16x32_bf16 v[64:67], a[112:115], v[44:47], v[64:67]
    ds_read_b64_tr_b16 v[60:61], v31 offset:28672
    v_mfma_f32_16x16x32_bf16 v[68:71], a[68:71], v[32:35], v[68:71]
    ds_read_b64_tr_b16 v[62:63], v31 offset:29184
    v_mfma_f32_16x16x32_bf16 v[68:71], a[84:87], v[36:39], v[68:71]
    buffer_store_dword v6, v5, s[8:11], s72 offen sc0 sc1
    v_mfma_f32_16x16x32_bf16 v[68:71], a[100:103], v[40:43], v[68:71]
    buffer_store_dwordx4 v[176:179], v1, s[8:11], s79 offen offset:2048 sc0 sc1
    v_mfma_f32_16x16x32_bf16 v[68:71], a[116:119], v[44:47], v[68:71]
    v_mfma_f32_16x16x32_bf16 v[72:75], a[72:75], v[32:35], v[72:75]
    v_mfma_f32_16x16x32_bf16 v[72:75], a[88:91], v[36:39], v[72:75]
    v_mfma_f32_16x16x32_bf16 v[72:75], a[104:107], v[40:43], v[72:75]
    v_cvt_pk_bf16_f32 v208, v208, v209
    v_cvt_pk_bf16_f32 v209, v210, v211
    v_mfma_f32_16x16x32_bf16 v[72:75], a[120:123], v[44:47], v[72:75]
    v_cvt_pk_bf16_f32 v210, v212, v213
    v_cvt_pk_bf16_f32 v211, v214, v215
    v_mfma_f32_16x16x32_bf16 v[76:79], a[76:79], v[32:35], v[76:79]
    v_mfma_f32_16x16x32_bf16 v[76:79], a[92:95], v[36:39], v[76:79]
    v_mfma_f32_16x16x32_bf16 v[76:79], a[108:111], v[40:43], v[76:79]
    s_xor_b32 s79, s65, 8192
    v_xor_b32 v28, 65536, v28
    s_waitcnt lgkmcnt(0)
    s_barrier
    v_mfma_f32_16x16x32_bf16 v[76:79], a[124:127], v[44:47], v[76:79]
    s_add_u32 m0, s62, 65536
    s_xor_b32 s98, s64, 2097280
    ds_read_b64_tr_b16 v[32:33], v28 offset:0
    v_mfma_f32_16x16x32_bf16 v[80:83], a[64:67], v[48:51], v[80:83]
    ds_read_b64_tr_b16 v[34:35], v28 offset:512
    v_mfma_f32_16x16x32_bf16 v[80:83], a[80:83], v[52:55], v[80:83]
    ds_read_b64_tr_b16 v[36:37], v28 offset:4096
    v_mfma_f32_16x16x32_bf16 v[80:83], a[96:99], v[56:59], v[80:83]
    ds_read_b64_tr_b16 v[38:39], v28 offset:4608
    v_mfma_f32_16x16x32_bf16 v[80:83], a[112:115], v[60:63], v[80:83]
    ds_read_b64_tr_b16 v[40:41], v28 offset:8192
    v_mfma_f32_16x16x32_bf16 v[84:87], a[68:71], v[48:51], v[84:87]
    ds_read_b64_tr_b16 v[42:43], v28 offset:8704
    v_mfma_f32_16x16x32_bf16 v[84:87], a[84:87], v[52:55], v[84:87]
    ds_read_b64_tr_b16 v[44:45], v28 offset:12288
    v_mfma_f32_16x16x32_bf16 v[84:87], a[100:103], v[56:59], v[84:87]
    ds_read_b64_tr_b16 v[46:47], v28 offset:12800
    v_mfma_f32_16x16x32_bf16 v[84:87], a[116:119], v[60:63], v[84:87]
    buffer_load_dwordx4 v24, s[20:23], s98 offen offset:0   lds
    v_mfma_f32_16x16x32_bf16 v[88:91], a[72:75], v[48:51], v[88:91]
    buffer_store_dwordx4 v[208:211], v1, s[8:11], s79 offen offset:2048 sc0 sc1
    v_mfma_f32_16x16x32_bf16 v[88:91], a[88:91], v[52:55], v[88:91]
    v_mfma_f32_16x16x32_bf16 v[88:91], a[104:107], v[56:59], v[88:91]
    buffer_load_dwordx4 v25, s[20:23], s98 offen offset:1024   lds
    v_mfma_f32_16x16x32_bf16 v[88:91], a[120:123], v[60:63], v[88:91]
    v_mfma_f32_16x16x32_bf16 v[92:95], a[76:79], v[48:51], v[92:95]
    v_xor_b32 v29, 65536, v29
    v_cvt_pk_bf16_f32 v240, v240, v241
    v_mfma_f32_16x16x32_bf16 v[92:95], a[92:95], v[52:55], v[92:95]
    ds_read_b64_tr_b16 v[48:49], v29 offset:0
    v_cvt_pk_bf16_f32 v241, v242, v243
    v_mfma_f32_16x16x32_bf16 v[92:95], a[108:111], v[56:59], v[92:95]
    ds_read_b64_tr_b16 v[50:51], v29 offset:512
    v_cvt_pk_bf16_f32 v242, v244, v245
    v_mfma_f32_16x16x32_bf16 v[92:95], a[124:127], v[60:63], v[92:95]
    s_waitcnt lgkmcnt(3)
    ds_read_b64_tr_b16 v[52:53], v29 offset:4096
    v_cvt_pk_bf16_f32 v243, v246, v247
    v_mfma_f32_16x16x32_bf16 v[96:99], a[128:131], v[32:35], v[96:99]
    s_xor_b32 s79, s65, 12288
    ds_read_b64_tr_b16 v[54:55], v29 offset:4608
    v_mfma_f32_16x16x32_bf16 v[96:99], a[144:147], v[36:39], v[96:99]
    ds_read_b64_tr_b16 v[56:57], v29 offset:8192
    v_mfma_f32_16x16x32_bf16 v[96:99], a[160:163], v[40:43], v[96:99]
    s_waitcnt lgkmcnt(5)
    ds_read_b64_tr_b16 v[58:59], v29 offset:8704
    v_mfma_f32_16x16x32_bf16 v[96:99], a[176:179], v[44:47], v[96:99]
    ds_read_b64_tr_b16 v[60:61], v29 offset:12288
    v_mfma_f32_16x16x32_bf16 v[100:103], a[132:135], v[32:35], v[100:103]
    ds_read_b64_tr_b16 v[62:63], v29 offset:12800
    v_mfma_f32_16x16x32_bf16 v[100:103], a[148:151], v[36:39], v[100:103]
    buffer_load_dwordx4 v26, s[20:23], s98 offen offset:2048   lds
    v_mfma_f32_16x16x32_bf16 v[100:103], a[164:167], v[40:43], v[100:103]
    buffer_store_dwordx4 v[240:243], v1, s[8:11], s79 offen offset:2048 sc0 sc1
    v_mfma_f32_16x16x32_bf16 v[100:103], a[180:183], v[44:47], v[100:103]
    v_mfma_f32_16x16x32_bf16 v[104:107], a[136:139], v[32:35], v[104:107]
    buffer_load_dwordx4 v27, s[20:23], s98 offen offset:3072   lds
    v_mfma_f32_16x16x32_bf16 v[104:107], a[152:155], v[36:39], v[104:107]
    s_add_u32 m0, s62, 69632
    s_xor_b32 s98, s64, 2359424
    v_mfma_f32_16x16x32_bf16 v[104:107], a[168:171], v[40:43], v[104:107]
    v_cvt_pk_bf16_f32 v152, v152, v153
    v_cvt_pk_bf16_f32 v153, v154, v155
    v_mfma_f32_16x16x32_bf16 v[104:107], a[184:187], v[44:47], v[104:107]
    buffer_load_dwordx4 v24, s[20:23], s98 offen offset:0   lds
    v_mfma_f32_16x16x32_bf16 v[108:111], a[140:143], v[32:35], v[108:111]
    v_cvt_pk_bf16_f32 v154, v156, v157
    v_cvt_pk_bf16_f32 v155, v158, v159
    v_mfma_f32_16x16x32_bf16 v[108:111], a[156:159], v[36:39], v[108:111]
    s_xor_b32 s79, s65, 0
    ds_read_b64_tr_b16 v[32:33], v28 offset:16384
    v_mfma_f32_16x16x32_bf16 v[108:111], a[172:175], v[40:43], v[108:111]
    ds_read_b64_tr_b16 v[34:35], v28 offset:16896
    v_mfma_f32_16x16x32_bf16 v[108:111], a[188:191], v[44:47], v[108:111]
    s_waitcnt lgkmcnt(2)
    ds_read_b64_tr_b16 v[36:37], v28 offset:20480
    v_mfma_f32_16x16x32_bf16 v[112:115], a[128:131], v[48:51], v[112:115]
    ds_read_b64_tr_b16 v[38:39], v28 offset:20992
    v_mfma_f32_16x16x32_bf16 v[112:115], a[144:147], v[52:55], v[112:115]
    ds_read_b64_tr_b16 v[40:41], v28 offset:24576
    v_mfma_f32_16x16x32_bf16 v[112:115], a[160:163], v[56:59], v[112:115]
    ds_read_b64_tr_b16 v[42:43], v28 offset:25088
    v_mfma_f32_16x16x32_bf16 v[112:115], a[176:179], v[60:63], v[112:115]
    ds_read_b64_tr_b16 v[44:45], v28 offset:28672
    v_mfma_f32_16x16x32_bf16 v[116:119], a[132:135], v[48:51], v[116:119]
    ds_read_b64_tr_b16 v[46:47], v28 offset:29184
    v_mfma_f32_16x16x32_bf16 v[116:119], a[148:151], v[52:55], v[116:119]
    buffer_load_dwordx4 v25, s[20:23], s98 offen offset:1024   lds
    v_mfma_f32_16x16x32_bf16 v[116:119], a[164:167], v[56:59], v[116:119]
    buffer_store_dwordx4 v[152:155], v1, s[8:11], s79 offen offset:3072 sc0 sc1
    v_mfma_f32_16x16x32_bf16 v[116:119], a[180:183], v[60:63], v[116:119]
    v_mfma_f32_16x16x32_bf16 v[120:123], a[136:139], v[48:51], v[120:123]
    buffer_load_dwordx4 v26, s[20:23], s98 offen offset:2048   lds
    v_mfma_f32_16x16x32_bf16 v[120:123], a[152:155], v[52:55], v[120:123]
    v_mfma_f32_16x16x32_bf16 v[120:123], a[168:171], v[56:59], v[120:123]
    v_cvt_pk_bf16_f32 v184, v184, v185
    v_cvt_pk_bf16_f32 v185, v186, v187
    v_mfma_f32_16x16x32_bf16 v[120:123], a[184:187], v[60:63], v[120:123]
    buffer_load_dwordx4 v27, s[20:23], s98 offen offset:3072   lds
    v_mfma_f32_16x16x32_bf16 v[124:127], a[140:143], v[48:51], v[124:127]
    v_cvt_pk_bf16_f32 v186, v188, v189
    v_cvt_pk_bf16_f32 v187, v190, v191
    v_mfma_f32_16x16x32_bf16 v[124:127], a[156:159], v[52:55], v[124:127]
    s_add_u32 m0, s63, 114688
    s_xor_b32 s98, s0, 1048576
    ds_read_b64_tr_b16 v[48:49], v29 offset:16384
    v_mfma_f32_16x16x32_bf16 v[124:127], a[172:175], v[56:59], v[124:127]
    s_xor_b32 s79, s65, 4096
    ds_read_b64_tr_b16 v[50:51], v29 offset:16896
    v_mfma_f32_16x16x32_bf16 v[124:127], a[188:191], v[60:63], v[124:127]
    s_waitcnt lgkmcnt(2)
    ds_read_b64_tr_b16 v[52:53], v29 offset:20480
    v_mfma_f32_16x16x32_bf16 v[96:99], a[192:195], v[32:35], v[96:99]
    ds_read_b64_tr_b16 v[54:55], v29 offset:20992
    v_mfma_f32_16x16x32_bf16 v[96:99], a[208:211], v[36:39], v[96:99]
    ds_read_b64_tr_b16 v[56:57], v29 offset:24576
    v_mfma_f32_16x16x32_bf16 v[96:99], a[224:227], v[40:43], v[96:99]
    ds_read_b64_tr_b16 v[58:59], v29 offset:25088
    v_mfma_f32_16x16x32_bf16 v[96:99], a[240:243], v[44:47], v[96:99]
    ds_read_b64_tr_b16 v[60:61], v29 offset:28672
    v_mfma_f32_16x16x32_bf16 v[100:103], a[196:199], v[32:35], v[100:103]
    ds_read_b64_tr_b16 v[62:63], v29 offset:29184
    v_mfma_f32_16x16x32_bf16 v[100:103], a[212:215], v[36:39], v[100:103]
    buffer_load_dwordx4 v20, s[24:27], s98 offen offset:0   lds
    v_mfma_f32_16x16x32_bf16 v[100:103], a[228:231], v[40:43], v[100:103]
    buffer_store_dwordx4 v[184:187], v1, s[8:11], s79 offen offset:3072 sc0 sc1
    v_mfma_f32_16x16x32_bf16 v[100:103], a[244:247], v[44:47], v[100:103]
    v_mfma_f32_16x16x32_bf16 v[104:107], a[200:203], v[32:35], v[104:107]
    buffer_load_dwordx4 v21, s[24:27], s98 offen offset:1024   lds
    v_mfma_f32_16x16x32_bf16 v[104:107], a[216:219], v[36:39], v[104:107]
    v_mfma_f32_16x16x32_bf16 v[104:107], a[232:235], v[40:43], v[104:107]
    v_mfma_f32_16x16x32_bf16 v[104:107], a[248:251], v[44:47], v[104:107]
    buffer_load_dwordx4 v22, s[24:27], s98 offen offset:2048   lds
    v_mfma_f32_16x16x32_bf16 v[108:111], a[204:207], v[32:35], v[108:111]
    v_xor_b32 v30, 65536, v30
    v_cvt_pk_bf16_f32 v216, v216, v217
    v_mfma_f32_16x16x32_bf16 v[108:111], a[220:223], v[36:39], v[108:111]
    ds_read_b64_tr_b16 v[32:33], v30 offset:0
    v_cvt_pk_bf16_f32 v217, v218, v219
    v_mfma_f32_16x16x32_bf16 v[108:111], a[236:239], v[40:43], v[108:111]
    ds_read_b64_tr_b16 v[34:35], v30 offset:512
    v_cvt_pk_bf16_f32 v218, v220, v221
    v_mfma_f32_16x16x32_bf16 v[108:111], a[252:255], v[44:47], v[108:111]
    s_waitcnt lgkmcnt(2)
    ds_read_b64_tr_b16 v[36:37], v30 offset:4096
    v_cvt_pk_bf16_f32 v219, v222, v223
    v_mfma_f32_16x16x32_bf16 v[112:115], a[192:195], v[48:51], v[112:115]
    s_xor_b32 s79, s65, 8192
    ds_read_b64_tr_b16 v[38:39], v30 offset:4608
    v_mfma_f32_16x16x32_bf16 v[112:115], a[208:211], v[52:55], v[112:115]
    ds_read_b64_tr_b16 v[40:41], v30 offset:8192
    v_mfma_f32_16x16x32_bf16 v[112:115], a[224:227], v[56:59], v[112:115]
    ds_read_b64_tr_b16 v[42:43], v30 offset:8704
    v_mfma_f32_16x16x32_bf16 v[112:115], a[240:243], v[60:63], v[112:115]
    ds_read_b64_tr_b16 v[44:45], v30 offset:12288
    v_mfma_f32_16x16x32_bf16 v[116:119], a[196:199], v[48:51], v[116:119]
    ds_read_b64_tr_b16 v[46:47], v30 offset:12800
    v_mfma_f32_16x16x32_bf16 v[116:119], a[212:215], v[52:55], v[116:119]
    buffer_load_dwordx4 v23, s[24:27], s98 offen offset:3072   lds
    v_mfma_f32_16x16x32_bf16 v[116:119], a[228:231], v[56:59], v[116:119]
    s_add_u32 m0, s63, 147456
    s_xor_b32 s98, s0, 1572864
    v_mfma_f32_16x16x32_bf16 v[116:119], a[244:247], v[60:63], v[116:119]
    buffer_store_dwordx4 v[216:219], v1, s[8:11], s79 offen offset:3072 sc0 sc1
    v_mfma_f32_16x16x32_bf16 v[120:123], a[200:203], v[48:51], v[120:123]
    buffer_load_dwordx4 v20, s[24:27], s98 offen offset:0   lds
    v_mfma_f32_16x16x32_bf16 v[120:123], a[216:219], v[52:55], v[120:123]
    v_mfma_f32_16x16x32_bf16 v[120:123], a[232:235], v[56:59], v[120:123]
    v_mfma_f32_16x16x32_bf16 v[120:123], a[248:251], v[60:63], v[120:123]
    buffer_load_dwordx4 v21, s[24:27], s98 offen offset:1024   lds
    v_mfma_f32_16x16x32_bf16 v[124:127], a[204:207], v[48:51], v[124:127]
    v_xor_b32 v31, 65536, v31
    v_mfma_f32_16x16x32_bf16 v[124:127], a[220:223], v[52:55], v[124:127]
    ds_read_b64_tr_b16 v[48:49], v31 offset:0
    v_mfma_f32_16x16x32_bf16 v[124:127], a[236:239], v[56:59], v[124:127]
    ds_read_b64_tr_b16 v[50:51], v31 offset:512
    v_mfma_f32_16x16x32_bf16 v[124:127], a[252:255], v[60:63], v[124:127]
    s_waitcnt lgkmcnt(2)
    ds_read_b64_tr_b16 v[52:53], v31 offset:4096
    v_mfma_f32_16x16x32_bf16 v[64:67], a[128:131], v[32:35], v[64:67]
    ds_read_b64_tr_b16 v[54:55], v31 offset:4608
    v_mfma_f32_16x16x32_bf16 v[64:67], a[144:147], v[36:39], v[64:67]
    ds_read_b64_tr_b16 v[56:57], v31 offset:8192
    v_mfma_f32_16x16x32_bf16 v[64:67], a[160:163], v[40:43], v[64:67]
    ds_read_b64_tr_b16 v[58:59], v31 offset:8704
    v_mfma_f32_16x16x32_bf16 v[64:67], a[176:179], v[44:47], v[64:67]
    ds_read_b64_tr_b16 v[60:61], v31 offset:12288
    v_mfma_f32_16x16x32_bf16 v[68:71], a[132:135], v[32:35], v[68:71]
    ds_read_b64_tr_b16 v[62:63], v31 offset:12800
    v_mfma_f32_16x16x32_bf16 v[68:71], a[148:151], v[36:39], v[68:71]
    buffer_load_dwordx4 v22, s[24:27], s98 offen offset:2048   lds
    v_mfma_f32_16x16x32_bf16 v[68:71], a[164:167], v[40:43], v[68:71]
    v_cvt_pk_bf16_f32 v96, v96, v97
    v_cvt_pk_bf16_f32 v97, v98, v99
    v_mfma_f32_16x16x32_bf16 v[68:71], a[180:183], v[44:47], v[68:71]
    v_cvt_pk_bf16_f32 v98, v100, v101
    v_cvt_pk_bf16_f32 v99, v102, v103
    v_mfma_f32_16x16x32_bf16 v[72:75], a[136:139], v[32:35], v[72:75]
    buffer_load_dwordx4 v23, s[24:27], s98 offen offset:3072   lds
    v_mfma_f32_16x16x32_bf16 v[72:75], a[152:155], v[36:39], v[72:75]
    s_xor_b32 s79, s1, 32768
    v_mfma_f32_16x16x32_bf16 v[72:75], a[168:171], v[40:43], v[72:75]
    buffer_store_dwordx4 v[96:99], v1, s[8:11], s79 offen offset:0 sc0 sc1
    v_mfma_f32_16x16x32_bf16 v[72:75], a[184:187], v[44:47], v[72:75]
    v_mfma_f32_16x16x32_bf16 v[76:79], a[140:143], v[32:35], v[76:79]
    v_mfma_f32_16x16x32_bf16 v[76:79], a[156:159], v[36:39], v[76:79]
    ds_read_b64_tr_b16 v[32:33], v30 offset:16384
    v_mfma_f32_16x16x32_bf16 v[76:79], a[172:175], v[40:43], v[76:79]
    ds_read_b64_tr_b16 v[34:35], v30 offset:16896
    v_mfma_f32_16x16x32_bf16 v[76:79], a[188:191], v[44:47], v[76:79]
    s_waitcnt lgkmcnt(2)
    ds_read_b64_tr_b16 v[36:37], v30 offset:20480
    v_mfma_f32_16x16x32_bf16 v[80:83], a[128:131], v[48:51], v[80:83]
    ds_read_b64_tr_b16 v[38:39], v30 offset:20992
    v_mfma_f32_16x16x32_bf16 v[80:83], a[144:147], v[52:55], v[80:83]
    ds_read_b64_tr_b16 v[40:41], v30 offset:24576
    v_mfma_f32_16x16x32_bf16 v[80:83], a[160:163], v[56:59], v[80:83]
    ds_read_b64_tr_b16 v[42:43], v30 offset:25088
    v_mfma_f32_16x16x32_bf16 v[80:83], a[176:179], v[60:63], v[80:83]
    ds_read_b64_tr_b16 v[44:45], v30 offset:28672
    v_mfma_f32_16x16x32_bf16 v[84:87], a[132:135], v[48:51], v[84:87]
    ds_read_b64_tr_b16 v[46:47], v30 offset:29184
    v_cvt_pk_bf16_f32 v104, v104, v105
    v_mfma_f32_16x16x32_bf16 v[84:87], a[148:151], v[52:55], v[84:87]
    v_cvt_pk_bf16_f32 v105, v106, v107
    v_cvt_pk_bf16_f32 v106, v108, v109
    v_mfma_f32_16x16x32_bf16 v[84:87], a[164:167], v[56:59], v[84:87]
    v_cvt_pk_bf16_f32 v107, v110, v111
    v_mfma_f32_16x16x32_bf16 v[84:87], a[180:183], v[60:63], v[84:87]
    s_xor_b32 s79, s1, 40960
    v_mfma_f32_16x16x32_bf16 v[88:91], a[136:139], v[48:51], v[88:91]
    buffer_store_dwordx4 v[104:107], v1, s[8:11], s79 offen offset:0 sc0 sc1
    v_mfma_f32_16x16x32_bf16 v[88:91], a[152:155], v[52:55], v[88:91]
    v_mfma_f32_16x16x32_bf16 v[88:91], a[168:171], v[56:59], v[88:91]
    v_mfma_f32_16x16x32_bf16 v[88:91], a[184:187], v[60:63], v[88:91]
    v_mfma_f32_16x16x32_bf16 v[92:95], a[140:143], v[48:51], v[92:95]
    v_mfma_f32_16x16x32_bf16 v[92:95], a[156:159], v[52:55], v[92:95]
    ds_read_b64_tr_b16 v[48:49], v31 offset:16384
    v_mfma_f32_16x16x32_bf16 v[92:95], a[172:175], v[56:59], v[92:95]
    ds_read_b64_tr_b16 v[50:51], v31 offset:16896
    v_mfma_f32_16x16x32_bf16 v[92:95], a[188:191], v[60:63], v[92:95]
    s_waitcnt lgkmcnt(2)
    ds_read_b64_tr_b16 v[52:53], v31 offset:20480
    v_mfma_f32_16x16x32_bf16 v[64:67], a[192:195], v[32:35], v[64:67]
    ds_read_b64_tr_b16 v[54:55], v31 offset:20992
    v_mfma_f32_16x16x32_bf16 v[64:67], a[208:211], v[36:39], v[64:67]
    ds_read_b64_tr_b16 v[56:57], v31 offset:24576
    v_mfma_f32_16x16x32_bf16 v[64:67], a[224:227], v[40:43], v[64:67]
    ds_read_b64_tr_b16 v[58:59], v31 offset:25088
    v_cvt_pk_bf16_f32 v112, v112, v113
    v_mfma_f32_16x16x32_bf16 v[64:67], a[240:243], v[44:47], v[64:67]
    ds_read_b64_tr_b16 v[60:61], v31 offset:28672
    v_cvt_pk_bf16_f32 v113, v114, v115
    v_mfma_f32_16x16x32_bf16 v[68:71], a[196:199], v[32:35], v[68:71]
    ds_read_b64_tr_b16 v[62:63], v31 offset:29184
    v_cvt_pk_bf16_f32 v114, v116, v117
    v_mfma_f32_16x16x32_bf16 v[68:71], a[212:215], v[36:39], v[68:71]
    v_cvt_pk_bf16_f32 v115, v118, v119
    v_mfma_f32_16x16x32_bf16 v[68:71], a[228:231], v[40:43], v[68:71]
    s_xor_b32 s79, s1, 32768
    v_mfma_f32_16x16x32_bf16 v[68:71], a[244:247], v[44:47], v[68:71]
    buffer_store_dwordx4 v[112:115], v1, s[8:11], s79 offen offset:1024 sc0 sc1
    v_mfma_f32_16x16x32_bf16 v[72:75], a[200:203], v[32:35], v[72:75]
    v_mfma_f32_16x16x32_bf16 v[72:75], a[216:219], v[36:39], v[72:75]
    v_mfma_f32_16x16x32_bf16 v[72:75], a[232:235], v[40:43], v[72:75]
    v_mfma_f32_16x16x32_bf16 v[72:75], a[248:251], v[44:47], v[72:75]
    v_mfma_f32_16x16x32_bf16 v[76:79], a[204:207], v[32:35], v[76:79]
    v_mfma_f32_16x16x32_bf16 v[76:79], a[220:223], v[36:39], v[76:79]
    v_mfma_f32_16x16x32_bf16 v[76:79], a[236:239], v[40:43], v[76:79]
    s_waitcnt vmcnt(40) lgkmcnt(0)
    s_barrier
    v_mfma_f32_16x16x32_bf16 v[76:79], a[252:255], v[44:47], v[76:79]
    s_add_u32 m0, s63, 0
    s_xor_b32 s98, s0, 2097152
    ds_read_b64_tr_b16 v[32:33], v28 offset:32768
    v_mfma_f32_16x16x32_bf16 v[80:83], a[192:195], v[48:51], v[80:83]
    ds_read_b64_tr_b16 v[34:35], v28 offset:33280
    v_cvt_pk_bf16_f32 v120, v120, v121
    v_mfma_f32_16x16x32_bf16 v[80:83], a[208:211], v[52:55], v[80:83]
    ds_read_b64_tr_b16 v[36:37], v28 offset:36864
    v_cvt_pk_bf16_f32 v121, v122, v123
    v_mfma_f32_16x16x32_bf16 v[80:83], a[224:227], v[56:59], v[80:83]
    ds_read_b64_tr_b16 v[38:39], v28 offset:37376
    v_cvt_pk_bf16_f32 v122, v124, v125
    v_mfma_f32_16x16x32_bf16 v[80:83], a[240:243], v[60:63], v[80:83]
    ds_read_b64_tr_b16 v[40:41], v28 offset:40960
    v_cvt_pk_bf16_f32 v123, v126, v127
    v_mfma_f32_16x16x32_bf16 v[84:87], a[196:199], v[48:51], v[84:87]
    s_xor_b32 s79, s1, 40960
    ds_read_b64_tr_b16 v[42:43], v28 offset:41472
    v_mfma_f32_16x16x32_bf16 v[84:87], a[212:215], v[52:55], v[84:87]
    ds_read_b64_tr_b16 v[44:45], v28 offset:45056
    v_mfma_f32_16x16x32_bf16 v[84:87], a[228:231], v[56:59], v[84:87]
    ds_read_b64_tr_b16 v[46:47], v28 offset:45568
    v_mfma_f32_16x16x32_bf16 v[84:87], a[244:247], v[60:63], v[84:87]
    buffer_load_dwordx4 v20, s[24:27], s98 offen offset:0   lds
    v_mfma_f32_16x16x32_bf16 v[88:91], a[200:203], v[48:51], v[88:91]
    buffer_store_dwordx4 v[120:123], v1, s[8:11], s79 offen offset:1024 sc0 sc1
    v_mfma_f32_16x16x32_bf16 v[88:91], a[216:219], v[52:55], v[88:91]
    v_mfma_f32_16x16x32_bf16 v[88:91], a[232:235], v[56:59], v[88:91]
    v_mfma_f32_16x16x32_bf16 v[88:91], a[248:251], v[60:63], v[88:91]
    v_mfma_f32_16x16x32_bf16 v[92:95], a[204:207], v[48:51], v[92:95]
    v_mfma_f32_16x16x32_bf16 v[92:95], a[220:223], v[52:55], v[92:95]
    ds_read_b64_tr_b16 v[48:49], v29 offset:32768
    v_mfma_f32_16x16x32_bf16 v[92:95], a[236:239], v[56:59], v[92:95]
    ds_read_b64_tr_b16 v[50:51], v29 offset:33280
    v_mfma_f32_16x16x32_bf16 v[92:95], a[252:255], v[60:63], v[92:95]
    s_waitcnt lgkmcnt(3)
    ds_read_b64_tr_b16 v[52:53], v29 offset:36864
    v_mfma_f32_16x16x32_bf16 v[96:99], a[0:3], v[32:35], 0
    ds_read_b64_tr_b16 v[54:55], v29 offset:37376
    v_mfma_f32_16x16x32_bf16 v[96:99], a[16:19], v[36:39], v[96:99]
    ds_read_b64_tr_b16 v[56:57], v29 offset:40960
    v_mfma_f32_16x16x32_bf16 v[96:99], a[32:35], v[40:43], v[96:99]
    s_waitcnt lgkmcnt(5)
    ds_read_b64_tr_b16 v[58:59], v29 offset:41472
    v_mfma_f32_16x16x32_bf16 v[96:99], a[48:51], v[44:47], v[96:99]
    ds_read_b64_tr_b16 v[60:61], v29 offset:45056
    v_mfma_f32_16x16x32_bf16 v[100:103], a[4:7], v[32:35], 0
    ds_read_b64_tr_b16 v[62:63], v29 offset:45568
    v_mfma_f32_16x16x32_bf16 v[100:103], a[20:23], v[36:39], v[100:103]
    buffer_load_dwordx4 v21, s[24:27], s98 offen offset:1024   lds
    v_mfma_f32_16x16x32_bf16 v[100:103], a[36:39], v[40:43], v[100:103]
    v_cvt_pk_bf16_f32 v64, v64, v65
    v_cvt_pk_bf16_f32 v65, v66, v67
    v_mfma_f32_16x16x32_bf16 v[100:103], a[52:55], v[44:47], v[100:103]
    v_cvt_pk_bf16_f32 v66, v68, v69
    v_cvt_pk_bf16_f32 v67, v70, v71
    v_mfma_f32_16x16x32_bf16 v[104:107], a[8:11], v[32:35], 0
    s_xor_b32 s79, s1, 32768
    v_mfma_f32_16x16x32_bf16 v[104:107], a[24:27], v[36:39], v[104:107]
    buffer_store_dwordx4 v[64:67], v1, s[8:11], s79 offen offset:2048 sc0 sc1
    v_mfma_f32_16x16x32_bf16 v[104:107], a[40:43], v[40:43], v[104:107]
    v_mfma_f32_16x16x32_bf16 v[104:107], a[56:59], v[44:47], v[104:107]
    buffer_load_dwordx4 v22, s[24:27], s98 offen offset:2048   lds
    v_mfma_f32_16x16x32_bf16 v[108:111], a[12:15], v[32:35], 0
    v_mfma_f32_16x16x32_bf16 v[108:111], a[28:31], v[36:39], v[108:111]
    ds_read_b64_tr_b16 v[32:33], v28 offset:49152
    v_mfma_f32_16x16x32_bf16 v[108:111], a[44:47], v[40:43], v[108:111]
    ds_read_b64_tr_b16 v[34:35], v28 offset:49664
    v_mfma_f32_16x16x32_bf16 v[108:111], a[60:63], v[44:47], v[108:111]
    s_waitcnt lgkmcnt(2)
    ds_read_b64_tr_b16 v[36:37], v28 offset:53248
    v_mfma_f32_16x16x32_bf16 v[112:115], a[0:3], v[48:51], 0
    ds_read_b64_tr_b16 v[38:39], v28 offset:53760
    v_mfma_f32_16x16x32_bf16 v[112:115], a[16:19], v[52:55], v[112:115]
    ds_read_b64_tr_b16 v[40:41], v28 offset:57344
    v_mfma_f32_16x16x32_bf16 v[112:115], a[32:35], v[56:59], v[112:115]
    ds_read_b64_tr_b16 v[42:43], v28 offset:57856
    v_mfma_f32_16x16x32_bf16 v[112:115], a[48:51], v[60:63], v[112:115]
    ds_read_b64_tr_b16 v[44:45], v28 offset:61440
    v_mfma_f32_16x16x32_bf16 v[116:119], a[4:7], v[48:51], 0
    ds_read_b64_tr_b16 v[46:47], v28 offset:61952
    v_cvt_pk_bf16_f32 v72, v72, v73
    v_mfma_f32_16x16x32_bf16 v[116:119], a[20:23], v[52:55], v[116:119]
    buffer_load_dwordx4 v23, s[24:27], s98 offen offset:3072   lds
    v_mfma_f32_16x16x32_bf16 v[116:119], a[36:39], v[56:59], v[116:119]
    s_add_u32 m0, s63, 16384
    s_xor_b32 s98, s0, 2621440
    v_cvt_pk_bf16_f32 v73, v74, v75
    v_mfma_f32_16x16x32_bf16 v[116:119], a[52:55], v[60:63], v[116:119]
    v_cvt_pk_bf16_f32 v74, v76, v77
    v_cvt_pk_bf16_f32 v75, v78, v79
    v_mfma_f32_16x16x32_bf16 v[120:123], a[8:11], v[48:51], 0
    s_xor_b32 s79, s1, 40960
    v_mfma_f32_16x16x32_bf16 v[120:123], a[24:27], v[52:55], v[120:123]
    buffer_store_dwordx4 v[72:75], v1, s[8:11], s79 offen offset:2048 sc0 sc1
    v_mfma_f32_16x16x32_bf16 v[120:123], a[40:43], v[56:59], v[120:123]
    v_mfma_f32_16x16x32_bf16 v[120:123], a[56:59], v[60:63], v[120:123]
    buffer_load_dwordx4 v20, s[24:27], s98 offen offset:0   lds
    v_mfma_f32_16x16x32_bf16 v[124:127], a[12:15], v[48:51], 0
    v_mfma_f32_16x16x32_bf16 v[124:127], a[28:31], v[52:55], v[124:127]
    ds_read_b64_tr_b16 v[48:49], v29 offset:49152
    v_mfma_f32_16x16x32_bf16 v[124:127], a[44:47], v[56:59], v[124:127]
    ds_read_b64_tr_b16 v[50:51], v29 offset:49664
    v_mfma_f32_16x16x32_bf16 v[124:127], a[60:63], v[60:63], v[124:127]
    s_waitcnt lgkmcnt(2)
    ds_read_b64_tr_b16 v[52:53], v29 offset:53248
    v_mfma_f32_16x16x32_bf16 v[96:99], a[64:67], v[32:35], v[96:99]
    ds_read_b64_tr_b16 v[54:55], v29 offset:53760
    v_mfma_f32_16x16x32_bf16 v[96:99], a[80:83], v[36:39], v[96:99]
    ds_read_b64_tr_b16 v[56:57], v29 offset:57344
    v_mfma_f32_16x16x32_bf16 v[96:99], a[96:99], v[40:43], v[96:99]
    ds_read_b64_tr_b16 v[58:59], v29 offset:57856
    v_cvt_pk_bf16_f32 v80, v80, v81
    v_mfma_f32_16x16x32_bf16 v[96:99], a[112:115], v[44:47], v[96:99]
    ds_read_b64_tr_b16 v[60:61], v29 offset:61440
    v_cvt_pk_bf16_f32 v81, v82, v83
    v_mfma_f32_16x16x32_bf16 v[100:103], a[68:71], v[32:35], v[100:103]
    ds_read_b64_tr_b16 v[62:63], v29 offset:61952
    v_cvt_pk_bf16_f32 v82, v84, v85
    v_mfma_f32_16x16x32_bf16 v[100:103], a[84:87], v[36:39], v[100:103]
    buffer_load_dwordx4 v21, s[24:27], s98 offen offset:1024   lds
    v_mfma_f32_16x16x32_bf16 v[100:103], a[100:103], v[40:43], v[100:103]
    v_cvt_pk_bf16_f32 v83, v86, v87
    v_mfma_f32_16x16x32_bf16 v[100:103], a[116:119], v[44:47], v[100:103]
    s_xor_b32 s79, s1, 32768
    v_mfma_f32_16x16x32_bf16 v[104:107], a[72:75], v[32:35], v[104:107]
    buffer_store_dwordx4 v[80:83], v1, s[8:11], s79 offen offset:3072 sc0 sc1
    v_mfma_f32_16x16x32_bf16 v[104:107], a[88:91], v[36:39], v[104:107]
    v_mfma_f32_16x16x32_bf16 v[104:107], a[104:107], v[40:43], v[104:107]
    v_mfma_f32_16x16x32_bf16 v[104:107], a[120:123], v[44:47], v[104:107]
    buffer_load_dwordx4 v22, s[24:27], s98 offen offset:2048   lds
    v_mfma_f32_16x16x32_bf16 v[108:111], a[76:79], v[32:35], v[108:111]
    v_mfma_f32_16x16x32_bf16 v[108:111], a[92:95], v[36:39], v[108:111]
    ds_read_b64_tr_b16 v[32:33], v30 offset:32768
    v_mfma_f32_16x16x32_bf16 v[108:111], a[108:111], v[40:43], v[108:111]
    ds_read_b64_tr_b16 v[34:35], v30 offset:33280
    v_mfma_f32_16x16x32_bf16 v[108:111], a[124:127], v[44:47], v[108:111]
    s_waitcnt lgkmcnt(2)
    ds_read_b64_tr_b16 v[36:37], v30 offset:36864
    v_mfma_f32_16x16x32_bf16 v[112:115], a[64:67], v[48:51], v[112:115]
    ds_read_b64_tr_b16 v[38:39], v30 offset:37376
    v_cvt_pk_bf16_f32 v88, v88, v89
    v_mfma_f32_16x16x32_bf16 v[112:115], a[80:83], v[52:55], v[112:115]
    ds_read_b64_tr_b16 v[40:41], v30 offset:40960
    v_cvt_pk_bf16_f32 v89, v90, v91
    v_mfma_f32_16x16x32_bf16 v[112:115], a[96:99], v[56:59], v[112:115]
    ds_read_b64_tr_b16 v[42:43], v30 offset:41472
    v_cvt_pk_bf16_f32 v90, v92, v93
    v_mfma_f32_16x16x32_bf16 v[112:115], a[112:115], v[60:63], v[112:115]
    ds_read_b64_tr_b16 v[44:45], v30 offset:45056
    v_cvt_pk_bf16_f32 v91, v94, v95
    v_mfma_f32_16x16x32_bf16 v[116:119], a[68:71], v[48:51], v[116:119]
    s_xor_b32 s79, s1, 40960
    ds_read_b64_tr_b16 v[46:47], v30 offset:45568
    v_mfma_f32_16x16x32_bf16 v[116:119], a[84:87], v[52:55], v[116:119]
    buffer_load_dwordx4 v23, s[24:27], s98 offen offset:3072   lds
    v_mfma_f32_16x16x32_bf16 v[116:119], a[100:103], v[56:59], v[116:119]
    buffer_store_dwordx4 v[88:91], v1, s[8:11], s79 offen offset:3072 sc0 sc1
    v_mfma_f32_16x16x32_bf16 v[116:119], a[116:119], v[60:63], v[116:119]
    v_mfma_f32_16x16x32_bf16 v[120:123], a[72:75], v[48:51], v[120:123]
    v_mfma_f32_16x16x32_bf16 v[120:123], a[88:91], v[52:55], v[120:123]
    v_mfma_f32_16x16x32_bf16 v[120:123], a[104:107], v[56:59], v[120:123]
    v_mfma_f32_16x16x32_bf16 v[120:123], a[120:123], v[60:63], v[120:123]
    v_mfma_f32_16x16x32_bf16 v[124:127], a[76:79], v[48:51], v[124:127]
    v_mfma_f32_16x16x32_bf16 v[124:127], a[92:95], v[52:55], v[124:127]
    ds_read_b64_tr_b16 v[48:49], v31 offset:32768
    v_mfma_f32_16x16x32_bf16 v[124:127], a[108:111], v[56:59], v[124:127]
    ds_read_b64_tr_b16 v[50:51], v31 offset:33280
    v_mfma_f32_16x16x32_bf16 v[124:127], a[124:127], v[60:63], v[124:127]
    s_waitcnt lgkmcnt(2)
    ds_read_b64_tr_b16 v[52:53], v31 offset:36864
    v_mfma_f32_16x16x32_bf16 v[64:67], a[0:3], v[32:35], 0
    ds_read_b64_tr_b16 v[54:55], v31 offset:37376
    v_mfma_f32_16x16x32_bf16 v[64:67], a[16:19], v[36:39], v[64:67]
    ds_read_b64_tr_b16 v[56:57], v31 offset:40960
    v_mfma_f32_16x16x32_bf16 v[64:67], a[32:35], v[40:43], v[64:67]
    ds_read_b64_tr_b16 v[58:59], v31 offset:41472
    v_mfma_f32_16x16x32_bf16 v[64:67], a[48:51], v[44:47], v[64:67]
    ds_read_b64_tr_b16 v[60:61], v31 offset:45056
    v_mfma_f32_16x16x32_bf16 v[68:71], a[4:7], v[32:35], 0
    ds_read_b64_tr_b16 v[62:63], v31 offset:45568
    v_mfma_f32_16x16x32_bf16 v[68:71], a[20:23], v[36:39], v[68:71]
    v_mfma_f32_16x16x32_bf16 v[68:71], a[36:39], v[40:43], v[68:71]
    v_mfma_f32_16x16x32_bf16 v[68:71], a[52:55], v[44:47], v[68:71]
    v_mfma_f32_16x16x32_bf16 v[72:75], a[8:11], v[32:35], 0
    v_mfma_f32_16x16x32_bf16 v[72:75], a[24:27], v[36:39], v[72:75]
    v_mfma_f32_16x16x32_bf16 v[72:75], a[40:43], v[40:43], v[72:75]
    v_cvt_pk_bf16_f32 v248, v248, v249
    v_cvt_pk_bf16_f32 v249, v250, v251
    v_mfma_f32_16x16x32_bf16 v[72:75], a[56:59], v[44:47], v[72:75]
    v_cvt_pk_bf16_f32 v250, v252, v253
    v_cvt_pk_bf16_f32 v251, v254, v255
    v_mfma_f32_16x16x32_bf16 v[76:79], a[12:15], v[32:35], 0
    v_mfma_f32_16x16x32_bf16 v[76:79], a[28:31], v[36:39], v[76:79]
    s_xor_b32 s79, s65, 12288
    ds_read_b64_tr_b16 v[32:33], v30 offset:49152
    v_mfma_f32_16x16x32_bf16 v[76:79], a[44:47], v[40:43], v[76:79]
    ds_read_b64_tr_b16 v[34:35], v30 offset:49664
    v_mfma_f32_16x16x32_bf16 v[76:79], a[60:63], v[44:47], v[76:79]
    s_waitcnt lgkmcnt(2)
    ds_read_b64_tr_b16 v[36:37], v30 offset:53248
    v_mfma_f32_16x16x32_bf16 v[80:83], a[0:3], v[48:51], 0
    ds_read_b64_tr_b16 v[38:39], v30 offset:53760
    v_mfma_f32_16x16x32_bf16 v[80:83], a[16:19], v[52:55], v[80:83]
    ds_read_b64_tr_b16 v[40:41], v30 offset:57344
    v_mfma_f32_16x16x32_bf16 v[80:83], a[32:35], v[56:59], v[80:83]
    ds_read_b64_tr_b16 v[42:43], v30 offset:57856
    v_mfma_f32_16x16x32_bf16 v[80:83], a[48:51], v[60:63], v[80:83]
    ds_read_b64_tr_b16 v[44:45], v30 offset:61440
    v_mfma_f32_16x16x32_bf16 v[84:87], a[4:7], v[48:51], 0
    ds_read_b64_tr_b16 v[46:47], v30 offset:61952
    v_mfma_f32_16x16x32_bf16 v[84:87], a[20:23], v[52:55], v[84:87]
    buffer_store_dwordx4 v[248:251], v1, s[8:11], s79 offen offset:3072 sc0 sc1
    v_mfma_f32_16x16x32_bf16 v[84:87], a[36:39], v[56:59], v[84:87]
    buffer_load_dword v3, v16, s[8:11], s78 offen sc0 sc1
    v_mfma_f32_16x16x32_bf16 v[84:87], a[52:55], v[60:63], v[84:87]
    v_mfma_f32_16x16x32_bf16 v[88:91], a[8:11], v[48:51], 0
    v_mfma_f32_16x16x32_bf16 v[88:91], a[24:27], v[52:55], v[88:91]
    v_mfma_f32_16x16x32_bf16 v[88:91], a[40:43], v[56:59], v[88:91]
    v_mfma_f32_16x16x32_bf16 v[88:91], a[56:59], v[60:63], v[88:91]
    v_mfma_f32_16x16x32_bf16 v[92:95], a[12:15], v[48:51], 0
    v_mfma_f32_16x16x32_bf16 v[92:95], a[28:31], v[52:55], v[92:95]
    ds_read_b64_tr_b16 v[48:49], v31 offset:49152
    v_mfma_f32_16x16x32_bf16 v[92:95], a[44:47], v[56:59], v[92:95]
    ds_read_b64_tr_b16 v[50:51], v31 offset:49664
    v_mfma_f32_16x16x32_bf16 v[92:95], a[60:63], v[60:63], v[92:95]
    s_waitcnt lgkmcnt(2)
    ds_read_b64_tr_b16 v[52:53], v31 offset:53248
    v_mfma_f32_16x16x32_bf16 v[64:67], a[64:67], v[32:35], v[64:67]
    ds_read_b64_tr_b16 v[54:55], v31 offset:53760
    v_mfma_f32_16x16x32_bf16 v[64:67], a[80:83], v[36:39], v[64:67]
    ds_read_b64_tr_b16 v[56:57], v31 offset:57344
    v_mfma_f32_16x16x32_bf16 v[64:67], a[96:99], v[40:43], v[64:67]
    ds_read_b64_tr_b16 v[58:59], v31 offset:57856
    v_mfma_f32_16x16x32_bf16 v[64:67], a[112:115], v[44:47], v[64:67]
    ds_read_b64_tr_b16 v[60:61], v31 offset:61440
    v_mfma_f32_16x16x32_bf16 v[68:71], a[68:71], v[32:35], v[68:71]
    ds_read_b64_tr_b16 v[62:63], v31 offset:61952
    v_mfma_f32_16x16x32_bf16 v[68:71], a[84:87], v[36:39], v[68:71]
    v_mfma_f32_16x16x32_bf16 v[68:71], a[100:103], v[40:43], v[68:71]
    v_mfma_f32_16x16x32_bf16 v[68:71], a[116:119], v[44:47], v[68:71]
    v_mfma_f32_16x16x32_bf16 v[72:75], a[72:75], v[32:35], v[72:75]
    v_mfma_f32_16x16x32_bf16 v[72:75], a[88:91], v[36:39], v[72:75]
    v_mfma_f32_16x16x32_bf16 v[72:75], a[104:107], v[40:43], v[72:75]
    v_mfma_f32_16x16x32_bf16 v[72:75], a[120:123], v[44:47], v[72:75]
    v_mfma_f32_16x16x32_bf16 v[76:79], a[76:79], v[32:35], v[76:79]
    v_mfma_f32_16x16x32_bf16 v[76:79], a[92:95], v[36:39], v[76:79]
    v_mfma_f32_16x16x32_bf16 v[76:79], a[108:111], v[40:43], v[76:79]
    v_xor_b32 v28, 65536, v28
    s_waitcnt vmcnt(28) lgkmcnt(0)
    s_barrier
    v_mfma_f32_16x16x32_bf16 v[76:79], a[124:127], v[44:47], v[76:79]
    s_add_u32 m0, s63, 32768
    s_xor_b32 s98, s0, 3145728
    ds_read_b64_tr_b16 v[32:33], v28 offset:0
    v_mfma_f32_16x16x32_bf16 v[80:83], a[64:67], v[48:51], v[80:83]
    ds_read_b64_tr_b16 v[34:35], v28 offset:512
    v_mfma_f32_16x16x32_bf16 v[80:83], a[80:83], v[52:55], v[80:83]
    ds_read_b64_tr_b16 v[36:37], v28 offset:4096
    v_mfma_f32_16x16x32_bf16 v[80:83], a[96:99], v[56:59], v[80:83]
    ds_read_b64_tr_b16 v[38:39], v28 offset:4608
    v_mfma_f32_16x16x32_bf16 v[80:83], a[112:115], v[60:63], v[80:83]
    ds_read_b64_tr_b16 v[40:41], v28 offset:8192
    v_mfma_f32_16x16x32_bf16 v[84:87], a[68:71], v[48:51], v[84:87]
    ds_read_b64_tr_b16 v[42:43], v28 offset:8704
    v_mfma_f32_16x16x32_bf16 v[84:87], a[84:87], v[52:55], v[84:87]
    ds_read_b64_tr_b16 v[44:45], v28 offset:12288
    v_mfma_f32_16x16x32_bf16 v[84:87], a[100:103], v[56:59], v[84:87]
    ds_read_b64_tr_b16 v[46:47], v28 offset:12800
    v_mfma_f32_16x16x32_bf16 v[84:87], a[116:119], v[60:63], v[84:87]
    buffer_load_dwordx4 v20, s[24:27], s98 offen offset:0   lds
    v_mfma_f32_16x16x32_bf16 v[88:91], a[72:75], v[48:51], v[88:91]
    v_mfma_f32_16x16x32_bf16 v[88:91], a[88:91], v[52:55], v[88:91]
    v_mfma_f32_16x16x32_bf16 v[88:91], a[104:107], v[56:59], v[88:91]
    v_mfma_f32_16x16x32_bf16 v[88:91], a[120:123], v[60:63], v[88:91]
    v_mfma_f32_16x16x32_bf16 v[92:95], a[76:79], v[48:51], v[92:95]
    v_xor_b32 v29, 65536, v29
    v_mfma_f32_16x16x32_bf16 v[92:95], a[92:95], v[52:55], v[92:95]
    ds_read_b64_tr_b16 v[48:49], v29 offset:0
    v_mfma_f32_16x16x32_bf16 v[92:95], a[108:111], v[56:59], v[92:95]
    ds_read_b64_tr_b16 v[50:51], v29 offset:512
    v_mfma_f32_16x16x32_bf16 v[92:95], a[124:127], v[60:63], v[92:95]
    s_waitcnt lgkmcnt(3)
    ds_read_b64_tr_b16 v[52:53], v29 offset:4096
    v_mfma_f32_16x16x32_bf16 v[96:99], a[128:131], v[32:35], v[96:99]
    ds_read_b64_tr_b16 v[54:55], v29 offset:4608
    s_waitcnt vmcnt(1)
    v_cmp_ne_u32 vcc, 0, v3
    s_cmp_eq_u64 vcc, -1
    s_cbranch_scc0 L_H_slow_3
L_H_ok_4:
    v_mfma_f32_16x16x32_bf16 v[96:99], a[144:147], v[36:39], v[96:99]
    ds_read_b64_tr_b16 v[56:57], v29 offset:8192
    v_mfma_f32_16x16x32_bf16 v[96:99], a[160:163], v[40:43], v[96:99]
    s_waitcnt lgkmcnt(5)
    s_xor_b32 s80, s75, 0
    ds_read_b64_tr_b16 v[58:59], v29 offset:8704
    v_mfma_f32_16x16x32_bf16 v[96:99], a[176:179], v[44:47], v[96:99]
    ds_read_b64_tr_b16 v[60:61], v29 offset:12288
    v_mfma_f32_16x16x32_bf16 v[100:103], a[132:135], v[32:35], v[100:103]
    ds_read_b64_tr_b16 v[62:63], v29 offset:12800
    v_mfma_f32_16x16x32_bf16 v[100:103], a[148:151], v[36:39], v[100:103]
    buffer_load_dwordx4 v21, s[24:27], s98 offen offset:1024   lds
    v_mfma_f32_16x16x32_bf16 v[100:103], a[164:167], v[40:43], v[100:103]
    buffer_load_dwordx4 a[0:3], v1, s[8:11], s80 offen offset:0
    v_mfma_f32_16x16x32_bf16 v[100:103], a[180:183], v[44:47], v[100:103]
    v_mfma_f32_16x16x32_bf16 v[104:107], a[136:139], v[32:35], v[104:107]
    s_xor_b32 s80, s75, 16384
    v_mfma_f32_16x16x32_bf16 v[104:107], a[152:155], v[36:39], v[104:107]
    buffer_load_dwordx4 a[4:7], v1, s[8:11], s80 offen offset:0
    v_mfma_f32_16x16x32_bf16 v[104:107], a[168:171], v[40:43], v[104:107]
    v_mfma_f32_16x16x32_bf16 v[104:107], a[184:187], v[44:47], v[104:107]
    buffer_load_dwordx4 v22, s[24:27], s98 offen offset:2048   lds
    v_mfma_f32_16x16x32_bf16 v[108:111], a[140:143], v[32:35], v[108:111]
    v_mfma_f32_16x16x32_bf16 v[108:111], a[156:159], v[36:39], v[108:111]
    ds_read_b64_tr_b16 v[32:33], v28 offset:16384
    v_mfma_f32_16x16x32_bf16 v[108:111], a[172:175], v[40:43], v[108:111]
    ds_read_b64_tr_b16 v[34:35], v28 offset:16896
    v_mfma_f32_16x16x32_bf16 v[108:111], a[188:191], v[44:47], v[108:111]
    s_waitcnt lgkmcnt(2)
    s_xor_b32 s80, s76, 0
    ds_read_b64_tr_b16 v[36:37], v28 offset:20480
    v_mfma_f32_16x16x32_bf16 v[112:115], a[128:131], v[48:51], v[112:115]
    ds_read_b64_tr_b16 v[38:39], v28 offset:20992
    v_mfma_f32_16x16x32_bf16 v[112:115], a[144:147], v[52:55], v[112:115]
    ds_read_b64_tr_b16 v[40:41], v28 offset:24576
    v_mfma_f32_16x16x32_bf16 v[112:115], a[160:163], v[56:59], v[112:115]
    ds_read_b64_tr_b16 v[42:43], v28 offset:25088
    v_mfma_f32_16x16x32_bf16 v[112:115], a[176:179], v[60:63], v[112:115]
    ds_read_b64_tr_b16 v[44:45], v28 offset:28672
    v_mfma_f32_16x16x32_bf16 v[116:119], a[132:135], v[48:51], v[116:119]
    ds_read_b64_tr_b16 v[46:47], v28 offset:29184
    v_mfma_f32_16x16x32_bf16 v[116:119], a[148:151], v[52:55], v[116:119]
    buffer_load_dwordx4 v23, s[24:27], s98 offen offset:3072   lds
    v_mfma_f32_16x16x32_bf16 v[116:119], a[164:167], v[56:59], v[116:119]
    s_add_u32 m0, s63, 49152
    s_xor_b32 s98, s0, 3670016
    v_mfma_f32_16x16x32_bf16 v[116:119], a[180:183], v[60:63], v[116:119]
    buffer_load_dwordx4 a[8:11], v1, s[8:11], s80 offen offset:0
    v_mfma_f32_16x16x32_bf16 v[120:123], a[136:139], v[48:51], v[120:123]
    s_xor_b32 s80, s76, 16384
    v_mfma_f32_16x16x32_bf16 v[120:123], a[152:155], v[52:55], v[120:123]
    buffer_load_dwordx4 a[12:15], v1, s[8:11], s80 offen offset:0
    v_mfma_f32_16x16x32_bf16 v[120:123], a[168:171], v[56:59], v[120:123]
    v_mfma_f32_16x16x32_bf16 v[120:123], a[184:187], v[60:63], v[120:123]
    buffer_load_dwordx4 v20, s[24:27], s98 offen offset:0   lds
    v_mfma_f32_16x16x32_bf16 v[124:127], a[140:143], v[48:51], v[124:127]
    v_mfma_f32_16x16x32_bf16 v[124:127], a[156:159], v[52:55], v[124:127]
    s_xor_b32 s80, s75, 0
    ds_read_b64_tr_b16 v[48:49], v29 offset:16384
    v_mfma_f32_16x16x32_bf16 v[124:127], a[172:175], v[56:59], v[124:127]
    ds_read_b64_tr_b16 v[50:51], v29 offset:16896
    v_mfma_f32_16x16x32_bf16 v[124:127], a[188:191], v[60:63], v[124:127]
    s_waitcnt lgkmcnt(2)
    ds_read_b64_tr_b16 v[52:53], v29 offset:20480
    v_mfma_f32_16x16x32_bf16 v[96:99], a[192:195], v[32:35], v[96:99]
    ds_read_b64_tr_b16 v[54:55], v29 offset:20992
    v_mfma_f32_16x16x32_bf16 v[96:99], a[208:211], v[36:39], v[96:99]
    ds_read_b64_tr_b16 v[56:57], v29 offset:24576
    v_mfma_f32_16x16x32_bf16 v[96:99], a[224:227], v[40:43], v[96:99]
    ds_read_b64_tr_b16 v[58:59], v29 offset:25088
    v_mfma_f32_16x16x32_bf16 v[96:99], a[240:243], v[44:47], v[96:99]
    ds_read_b64_tr_b16 v[60:61], v29 offset:28672
    v_mfma_f32_16x16x32_bf16 v[100:103], a[196:199], v[32:35], v[100:103]
    ds_read_b64_tr_b16 v[62:63], v29 offset:29184
    v_mfma_f32_16x16x32_bf16 v[100:103], a[212:215], v[36:39], v[100:103]
    buffer_load_dwordx4 v21, s[24:27], s98 offen offset:1024   lds
    v_mfma_f32_16x16x32_bf16 v[100:103], a[228:231], v[40:43], v[100:103]
    buffer_load_dwordx4 a[16:19], v1, s[8:11], s80 offen offset:1024
    v_mfma_f32_16x16x32_bf16 v[100:103], a[244:247], v[44:47], v[100:103]
    s_xor_b32 s80, s75, 16384
    v_mfma_f32_16x16x32_bf16 v[104:107], a[200:203], v[32:35], v[104:107]
    buffer_load_dwordx4 a[20:23], v1, s[8:11], s80 offen offset:1024
    v_mfma_f32_16x16x32_bf16 v[104:107], a[216:219], v[36:39], v[104:107]
    v_mfma_f32_16x16x32_bf16 v[104:107], a[232:235], v[40:43], v[104:107]
    v_mfma_f32_16x16x32_bf16 v[104:107], a[248:251], v[44:47], v[104:107]
    buffer_load_dwordx4 v22, s[24:27], s98 offen offset:2048   lds
    v_mfma_f32_16x16x32_bf16 v[108:111], a[204:207], v[32:35], v[108:111]
    s_xor_b32 s80, s76, 0
    v_xor_b32 v30, 65536, v30
    v_mfma_f32_16x16x32_bf16 v[108:111], a[220:223], v[36:39], v[108:111]
    ds_read_b64_tr_b16 v[32:33], v30 offset:0
    v_mfma_f32_16x16x32_bf16 v[108:111], a[236:239], v[40:43], v[108:111]
    ds_read_b64_tr_b16 v[34:35], v30 offset:512
    v_mfma_f32_16x16x32_bf16 v[108:111], a[252:255], v[44:47], v[108:111]
    s_waitcnt lgkmcnt(2)
    ds_read_b64_tr_b16 v[36:37], v30 offset:4096
    v_mfma_f32_16x16x32_bf16 v[112:115], a[192:195], v[48:51], v[112:115]
    ds_read_b64_tr_b16 v[38:39], v30 offset:4608
    v_mfma_f32_16x16x32_bf16 v[112:115], a[208:211], v[52:55], v[112:115]
    ds_read_b64_tr_b16 v[40:41], v30 offset:8192
    v_mfma_f32_16x16x32_bf16 v[112:115], a[224:227], v[56:59], v[112:115]
    ds_read_b64_tr_b16 v[42:43], v30 offset:8704
    v_mfma_f32_16x16x32_bf16 v[112:115], a[240:243], v[60:63], v[112:115]
    ds_read_b64_tr_b16 v[44:45], v30 offset:12288
    v_mfma_f32_16x16x32_bf16 v[116:119], a[196:199], v[48:51], v[116:119]
    ds_read_b64_tr_b16 v[46:47], v30 offset:12800
    v_mfma_f32_16x16x32_bf16 v[116:119], a[212:215], v[52:55], v[116:119]
    buffer_load_dwordx4 v23, s[24:27], s98 offen offset:3072   lds
    v_mfma_f32_16x16x32_bf16 v[116:119], a[228:231], v[56:59], v[116:119]
    buffer_load_dwordx4 a[24:27], v1, s[8:11], s80 offen offset:1024
    v_mfma_f32_16x16x32_bf16 v[116:119], a[244:247], v[60:63], v[116:119]
    s_xor_b32 s80, s76, 16384
    v_mfma_f32_16x16x32_bf16 v[120:123], a[200:203], v[48:51], v[120:123]
    buffer_load_dwordx4 a[28:31], v1, s[8:11], s80 offen offset:1024
    v_mfma_f32_16x16x32_bf16 v[120:123], a[216:219], v[52:55], v[120:123]
    s_xor_b32 s80, s75, 2048
    v_mfma_f32_16x16x32_bf16 v[120:123], a[232:235], v[56:59], v[120:123]
    buffer_load_dwordx4 a[32:35], v1, s[8:11], s80 offen offset:0
    v_mfma_f32_16x16x32_bf16 v[120:123], a[248:251], v[60:63], v[120:123]
    v_mfma_f32_16x16x32_bf16 v[124:127], a[204:207], v[48:51], v[124:127]
    v_xor_b32 v31, 65536, v31
    v_mfma_f32_16x16x32_bf16 v[124:127], a[220:223], v[52:55], v[124:127]
    ds_read_b64_tr_b16 v[48:49], v31 offset:0
    v_mfma_f32_16x16x32_bf16 v[124:127], a[236:239], v[56:59], v[124:127]
    ds_read_b64_tr_b16 v[50:51], v31 offset:512
    v_mfma_f32_16x16x32_bf16 v[124:127], a[252:255], v[60:63], v[124:127]
    s_waitcnt lgkmcnt(2)
    ds_read_b64_tr_b16 v[52:53], v31 offset:4096
    v_mfma_f32_16x16x32_bf16 v[64:67], a[128:131], v[32:35], v[64:67]
    s_xor_b32 s80, s75, 18432
    ds_read_b64_tr_b16 v[54:55], v31 offset:4608
    v_mfma_f32_16x16x32_bf16 v[64:67], a[144:147], v[36:39], v[64:67]
    ds_read_b64_tr_b16 v[56:57], v31 offset:8192
    v_mfma_f32_16x16x32_bf16 v[64:67], a[160:163], v[40:43], v[64:67]
    ds_read_b64_tr_b16 v[58:59], v31 offset:8704
    v_mfma_f32_16x16x32_bf16 v[64:67], a[176:179], v[44:47], v[64:67]
    ds_read_b64_tr_b16 v[60:61], v31 offset:12288
    v_mfma_f32_16x16x32_bf16 v[68:71], a[132:135], v[32:35], v[68:71]
    ds_read_b64_tr_b16 v[62:63], v31 offset:12800
    v_mfma_f32_16x16x32_bf16 v[68:71], a[148:151], v[36:39], v[68:71]
    buffer_load_dwordx4 a[36:39], v1, s[8:11], s80 offen offset:0
    v_mfma_f32_16x16x32_bf16 v[68:71], a[164:167], v[40:43], v[68:71]
    v_cvt_pk_bf16_f32 v96, v96, v97
    v_cvt_pk_bf16_f32 v97, v98, v99
    v_mfma_f32_16x16x32_bf16 v[68:71], a[180:183], v[44:47], v[68:71]
    s_xor_b32 s80, s76, 2048
    v_cvt_pk_bf16_f32 v98, v100, v101
    v_cvt_pk_bf16_f32 v99, v102, v103
    v_mfma_f32_16x16x32_bf16 v[72:75], a[136:139], v[32:35], v[72:75]
    s_xor_b32 s79, s1, 36864
    v_mfma_f32_16x16x32_bf16 v[72:75], a[152:155], v[36:39], v[72:75]
    buffer_store_dwordx4 v[96:99], v1, s[8:11], s79 offen offset:0 sc0 sc1
    v_mfma_f32_16x16x32_bf16 v[72:75], a[168:171], v[40:43], v[72:75]
    buffer_load_dwordx4 a[40:43], v1, s[8:11], s80 offen offset:0
    v_mfma_f32_16x16x32_bf16 v[72:75], a[184:187], v[44:47], v[72:75]
    v_mfma_f32_16x16x32_bf16 v[76:79], a[140:143], v[32:35], v[76:79]
    v_mfma_f32_16x16x32_bf16 v[76:79], a[156:159], v[36:39], v[76:79]
    ds_read_b64_tr_b16 v[32:33], v30 offset:16384
    v_mfma_f32_16x16x32_bf16 v[76:79], a[172:175], v[40:43], v[76:79]
    s_xor_b32 s80, s76, 18432
    ds_read_b64_tr_b16 v[34:35], v30 offset:16896
    v_mfma_f32_16x16x32_bf16 v[76:79], a[188:191], v[44:47], v[76:79]
    s_waitcnt lgkmcnt(2)
    ds_read_b64_tr_b16 v[36:37], v30 offset:20480
    v_mfma_f32_16x16x32_bf16 v[80:83], a[128:131], v[48:51], v[80:83]
    ds_read_b64_tr_b16 v[38:39], v30 offset:20992
    v_mfma_f32_16x16x32_bf16 v[80:83], a[144:147], v[52:55], v[80:83]
    ds_read_b64_tr_b16 v[40:41], v30 offset:24576
    v_mfma_f32_16x16x32_bf16 v[80:83], a[160:163], v[56:59], v[80:83]
    ds_read_b64_tr_b16 v[42:43], v30 offset:25088
    v_mfma_f32_16x16x32_bf16 v[80:83], a[176:179], v[60:63], v[80:83]
    ds_read_b64_tr_b16 v[44:45], v30 offset:28672
    v_mfma_f32_16x16x32_bf16 v[84:87], a[132:135], v[48:51], v[84:87]
    ds_read_b64_tr_b16 v[46:47], v30 offset:29184
    v_mfma_f32_16x16x32_bf16 v[84:87], a[148:151], v[52:55], v[84:87]
    buffer_load_dwordx4 a[44:47], v1, s[8:11], s80 offen offset:0
    v_mfma_f32_16x16x32_bf16 v[84:87], a[164:167], v[56:59], v[84:87]
    s_xor_b32 s80, s75, 2048
    v_cvt_pk_bf16_f32 v104, v104, v105
    v_cvt_pk_bf16_f32 v105, v106, v107
    v_mfma_f32_16x16x32_bf16 v[84:87], a[180:183], v[60:63], v[84:87]
    v_cvt_pk_bf16_f32 v106, v108, v109
    v_cvt_pk_bf16_f32 v107, v110, v111
    v_mfma_f32_16x16x32_bf16 v[88:91], a[136:139], v[48:51], v[88:91]
    s_xor_b32 s79, s1, 45056
    v_mfma_f32_16x16x32_bf16 v[88:91], a[152:155], v[52:55], v[88:91]
    buffer_store_dwordx4 v[104:107], v1, s[8:11], s79 offen offset:0 sc0 sc1
    v_mfma_f32_16x16x32_bf16 v[88:91], a[168:171], v[56:59], v[88:91]
    buffer_load_dwordx4 a[48:51], v1, s[8:11], s80 offen offset:1024
    v_mfma_f32_16x16x32_bf16 v[88:91], a[184:187], v[60:63], v[88:91]
    v_mfma_f32_16x16x32_bf16 v[92:95], a[140:143], v[48:51], v[92:95]
    v_mfma_f32_16x16x32_bf16 v[92:95], a[156:159], v[52:55], v[92:95]
    s_xor_b32 s80, s75, 18432
    ds_read_b64_tr_b16 v[48:49], v31 offset:16384
    v_mfma_f32_16x16x32_bf16 v[92:95], a[172:175], v[56:59], v[92:95]
    ds_read_b64_tr_b16 v[50:51], v31 offset:16896
    v_mfma_f32_16x16x32_bf16 v[92:95], a[188:191], v[60:63], v[92:95]
    s_waitcnt lgkmcnt(2)
    ds_read_b64_tr_b16 v[52:53], v31 offset:20480
    v_mfma_f32_16x16x32_bf16 v[64:67], a[192:195], v[32:35], v[64:67]
    ds_read_b64_tr_b16 v[54:55], v31 offset:20992
    v_mfma_f32_16x16x32_bf16 v[64:67], a[208:211], v[36:39], v[64:67]
    ds_read_b64_tr_b16 v[56:57], v31 offset:24576
    v_mfma_f32_16x16x32_bf16 v[64:67], a[224:227], v[40:43], v[64:67]
    ds_read_b64_tr_b16 v[58:59], v31 offset:25088
    v_mfma_f32_16x16x32_bf16 v[64:67], a[240:243], v[44:47], v[64:67]
    ds_read_b64_tr_b16 v[60:61], v31 offset:28672
    v_mfma_f32_16x16x32_bf16 v[68:71], a[196:199], v[32:35], v[68:71]
    ds_read_b64_tr_b16 v[62:63], v31 offset:29184
    v_mfma_f32_16x16x32_bf16 v[68:71], a[212:215], v[36:39], v[68:71]
    buffer_load_dwordx4 a[52:55], v1, s[8:11], s80 offen offset:1024
    v_mfma_f32_16x16x32_bf16 v[68:71], a[228:231], v[40:43], v[68:71]
    s_xor_b32 s80, s76, 2048
    v_cvt_pk_bf16_f32 v112, v112, v113
    v_cvt_pk_bf16_f32 v113, v114, v115
    v_mfma_f32_16x16x32_bf16 v[68:71], a[244:247], v[44:47], v[68:71]
    v_cvt_pk_bf16_f32 v114, v116, v117
    v_cvt_pk_bf16_f32 v115, v118, v119
    v_mfma_f32_16x16x32_bf16 v[72:75], a[200:203], v[32:35], v[72:75]
    s_xor_b32 s79, s1, 36864
    v_mfma_f32_16x16x32_bf16 v[72:75], a[216:219], v[36:39], v[72:75]
    buffer_store_dwordx4 v[112:115], v1, s[8:11], s79 offen offset:1024 sc0 sc1
    v_mfma_f32_16x16x32_bf16 v[72:75], a[232:235], v[40:43], v[72:75]
    buffer_load_dwordx4 a[56:59], v1, s[8:11], s80 offen offset:1024
    v_mfma_f32_16x16x32_bf16 v[72:75], a[248:251], v[44:47], v[72:75]
    s_xor_b32 s80, s76, 18432
    v_mfma_f32_16x16x32_bf16 v[76:79], a[204:207], v[32:35], v[76:79]
    buffer_load_dwordx4 a[60:63], v1, s[8:11], s80 offen offset:1024
    v_mfma_f32_16x16x32_bf16 v[76:79], a[220:223], v[36:39], v[76:79]
    v_mfma_f32_16x16x32_bf16 v[76:79], a[236:239], v[40:43], v[76:79]
    s_waitcnt lgkmcnt(0)
    s_barrier
    v_mfma_f32_16x16x32_bf16 v[76:79], a[252:255], v[44:47], v[76:79]
    ds_read_b64_tr_b16 v[32:33], v8 offset:32768
    v_mfma_f32_16x16x32_bf16 v[80:83], a[192:195], v[48:51], v[80:83]
    ds_read_b64_tr_b16 v[34:35], v8 offset:33792
    v_mfma_f32_16x16x32_bf16 v[80:83], a[208:211], v[52:55], v[80:83]
    s_xor_b32 s80, s75, 4096
    ds_read_b64_tr_b16 v[36:37], v9 offset:32768
    v_mfma_f32_16x16x32_bf16 v[80:83], a[224:227], v[56:59], v[80:83]
    ds_read_b64_tr_b16 v[38:39], v9 offset:33792
    v_mfma_f32_16x16x32_bf16 v[80:83], a[240:243], v[60:63], v[80:83]
    ds_read_b64_tr_b16 v[40:41], v10 offset:32768
    v_mfma_f32_16x16x32_bf16 v[84:87], a[196:199], v[48:51], v[84:87]
    ds_read_b64_tr_b16 v[42:43], v10 offset:33792
    v_mfma_f32_16x16x32_bf16 v[84:87], a[212:215], v[52:55], v[84:87]
    ds_read_b64_tr_b16 v[44:45], v11 offset:32768
    v_mfma_f32_16x16x32_bf16 v[84:87], a[228:231], v[56:59], v[84:87]
    ds_read_b64_tr_b16 v[46:47], v11 offset:33792
    v_cvt_pk_bf16_f32 v120, v120, v121
    v_mfma_f32_16x16x32_bf16 v[84:87], a[244:247], v[60:63], v[84:87]
    v_cvt_pk_bf16_f32 v121, v122, v123
    v_cvt_pk_bf16_f32 v122, v124, v125
    v_mfma_f32_16x16x32_bf16 v[88:91], a[200:203], v[48:51], v[88:91]
    v_cvt_pk_bf16_f32 v123, v126, v127
    v_mfma_f32_16x16x32_bf16 v[88:91], a[216:219], v[52:55], v[88:91]
    s_xor_b32 s79, s1, 45056
    v_mfma_f32_16x16x32_bf16 v[88:91], a[232:235], v[56:59], v[88:91]
    buffer_store_dwordx4 v[120:123], v1, s[8:11], s79 offen offset:1024 sc0 sc1
    v_mfma_f32_16x16x32_bf16 v[88:91], a[248:251], v[60:63], v[88:91]
    buffer_load_dwordx4 a[64:67], v1, s[8:11], s80 offen offset:0
    v_mfma_f32_16x16x32_bf16 v[92:95], a[204:207], v[48:51], v[92:95]
    v_mfma_f32_16x16x32_bf16 v[92:95], a[220:223], v[52:55], v[92:95]
    s_xor_b32 s80, s75, 20480
    ds_read_b64_tr_b16 v[48:49], v12 offset:32768
    v_mfma_f32_16x16x32_bf16 v[92:95], a[236:239], v[56:59], v[92:95]
    ds_read_b64_tr_b16 v[50:51], v12 offset:33792
    v_mfma_f32_16x16x32_bf16 v[92:95], a[252:255], v[60:63], v[92:95]
    s_waitcnt vmcnt(26) lgkmcnt(3)
    ds_read_b64_tr_b16 v[52:53], v13 offset:32768
    v_mfma_f32_16x16x32_bf16 v[128:131], v[32:35], a[0:3], 0
    s_waitcnt vmcnt(25)
    ds_read_b64_tr_b16 v[54:55], v13 offset:33792
    v_mfma_f32_16x16x32_bf16 v[160:163], v[32:35], a[4:7], 0
    s_waitcnt vmcnt(22)
    ds_read_b64_tr_b16 v[56:57], v14 offset:32768
    v_mfma_f32_16x16x32_bf16 v[192:195], v[32:35], a[8:11], 0
    s_waitcnt vmcnt(21)
    ds_read_b64_tr_b16 v[58:59], v14 offset:33792
    v_mfma_f32_16x16x32_bf16 v[224:227], v[32:35], a[12:15], 0
    ds_read_b64_tr_b16 v[60:61], v15 offset:32768
    v_mfma_f32_16x16x32_bf16 v[132:135], v[36:39], a[0:3], 0
    ds_read_b64_tr_b16 v[62:63], v15 offset:33792
    v_mfma_f32_16x16x32_bf16 v[164:167], v[36:39], a[4:7], 0
    ds_read_b64_tr_b16 v[32:33], v8 offset:40960
    v_mfma_f32_16x16x32_bf16 v[196:199], v[36:39], a[8:11], 0
    ds_read_b64_tr_b16 v[34:35], v8 offset:41984
    v_cvt_pk_bf16_f32 v64, v64, v65
    v_mfma_f32_16x16x32_bf16 v[228:231], v[36:39], a[12:15], 0
    buffer_load_dwordx4 a[68:71], v1, s[8:11], s80 offen offset:0
    v_mfma_f32_16x16x32_bf16 v[136:139], v[40:43], a[0:3], 0
    s_xor_b32 s80, s76, 4096
    ds_read_b64_tr_b16 v[36:37], v9 offset:40960
    v_cvt_pk_bf16_f32 v65, v66, v67
    v_mfma_f32_16x16x32_bf16 v[168:171], v[40:43], a[4:7], 0
    ds_read_b64_tr_b16 v[38:39], v9 offset:41984
    v_cvt_pk_bf16_f32 v66, v68, v69
    v_mfma_f32_16x16x32_bf16 v[200:203], v[40:43], a[8:11], 0
    s_waitcnt lgkmcnt(8)
    v_cvt_pk_bf16_f32 v67, v70, v71
    v_mfma_f32_16x16x32_bf16 v[232:235], v[40:43], a[12:15], 0
    buffer_load_dwordx4 a[72:75], v1, s[8:11], s80 offen offset:0
    v_mfma_f32_16x16x32_bf16 v[140:143], v[44:47], a[0:3], 0
    s_xor_b32 s79, s1, 36864
    s_xor_b32 s80, s76, 20480
    ds_read_b64_tr_b16 v[40:41], v10 offset:40960
    v_mfma_f32_16x16x32_bf16 v[172:175], v[44:47], a[4:7], 0
    ds_read_b64_tr_b16 v[42:43], v10 offset:41984
    v_mfma_f32_16x16x32_bf16 v[204:207], v[44:47], a[8:11], 0
    buffer_store_dwordx4 v[64:67], v1, s[8:11], s79 offen offset:2048 sc0 sc1
    v_mfma_f32_16x16x32_bf16 v[236:239], v[44:47], a[12:15], 0
    buffer_load_dwordx4 a[76:79], v1, s[8:11], s80 offen offset:0
    v_mfma_f32_16x16x32_bf16 v[144:147], v[48:51], a[0:3], 0
    s_xor_b32 s80, s75, 4096
    ds_read_b64_tr_b16 v[44:45], v11 offset:40960
    v_mfma_f32_16x16x32_bf16 v[176:179], v[48:51], a[4:7], 0
    ds_read_b64_tr_b16 v[46:47], v11 offset:41984
    v_mfma_f32_16x16x32_bf16 v[208:211], v[48:51], a[8:11], 0
    buffer_load_dwordx4 a[80:83], v1, s[8:11], s80 offen offset:1024
    v_mfma_f32_16x16x32_bf16 v[240:243], v[48:51], a[12:15], 0
    v_mfma_f32_16x16x32_bf16 v[148:151], v[52:55], a[0:3], 0
    s_xor_b32 s80, s75, 20480
    ds_read_b64_tr_b16 v[48:49], v12 offset:40960
    v_mfma_f32_16x16x32_bf16 v[180:183], v[52:55], a[4:7], 0
    ds_read_b64_tr_b16 v[50:51], v12 offset:41984
    v_mfma_f32_16x16x32_bf16 v[212:215], v[52:55], a[8:11], 0
    buffer_load_dwordx4 a[84:87], v1, s[8:11], s80 offen offset:1024
    v_mfma_f32_16x16x32_bf16 v[244:247], v[52:55], a[12:15], 0
    s_waitcnt lgkmcnt(4)
    v_mfma_f32_16x16x32_bf16 v[152:155], v[56:59], a[0:3], 0
    ds_read_b64_tr_b16 v[52:53], v13 offset:40960
    v_cvt_pk_bf16_f32 v72, v72, v73
    v_mfma_f32_16x16x32_bf16 v[184:187], v[56:59], a[4:7], 0
    ds_read_b64_tr_b16 v[54:55], v13 offset:41984
    v_cvt_pk_bf16_f32 v73, v74, v75
    v_mfma_f32_16x16x32_bf16 v[216:219], v[56:59], a[8:11], 0
    v_cvt_pk_bf16_f32 v74, v76, v77
    v_cvt_pk_bf16_f32 v75, v78, v79
    v_mfma_f32_16x16x32_bf16 v[248:251], v[56:59], a[12:15], 0
    v_mfma_f32_16x16x32_bf16 v[156:159], v[60:63], a[0:3], 0
    s_xor_b32 s79, s1, 45056
    s_xor_b32 s80, s76, 4096
    ds_read_b64_tr_b16 v[56:57], v14 offset:40960
    v_mfma_f32_16x16x32_bf16 v[188:191], v[60:63], a[4:7], 0
    s_waitcnt vmcnt(24)
    ds_read_b64_tr_b16 v[58:59], v14 offset:41984
    v_mfma_f32_16x16x32_bf16 v[220:223], v[60:63], a[8:11], 0
    buffer_store_dwordx4 v[72:75], v1, s[8:11], s79 offen offset:2048 sc0 sc1
    v_mfma_f32_16x16x32_bf16 v[252:255], v[60:63], a[12:15], 0
    buffer_load_dwordx4 a[88:91], v1, s[8:11], s80 offen offset:1024
    v_mfma_f32_16x16x32_bf16 v[128:131], v[32:35], a[16:19], v[128:131]
    s_waitcnt vmcnt(25)
    ds_read_b64_tr_b16 v[60:61], v15 offset:40960
    v_mfma_f32_16x16x32_bf16 v[160:163], v[32:35], a[20:23], v[160:163]
    s_waitcnt vmcnt(22)
    ds_read_b64_tr_b16 v[62:63], v15 offset:41984
    v_mfma_f32_16x16x32_bf16 v[192:195], v[32:35], a[24:27], v[192:195]
    s_waitcnt vmcnt(21)
    v_mfma_f32_16x16x32_bf16 v[224:227], v[32:35], a[28:31], v[224:227]
    v_mfma_f32_16x16x32_bf16 v[132:135], v[36:39], a[16:19], v[132:135]
    s_xor_b32 s80, s76, 20480
    ds_read_b64_tr_b16 v[32:33], v8 offset:0
    v_mfma_f32_16x16x32_bf16 v[164:167], v[36:39], a[20:23], v[164:167]
    ds_read_b64_tr_b16 v[34:35], v8 offset:1024
    v_mfma_f32_16x16x32_bf16 v[196:199], v[36:39], a[24:27], v[196:199]
    buffer_load_dwordx4 a[92:95], v1, s[8:11], s80 offen offset:1024
    v_mfma_f32_16x16x32_bf16 v[228:231], v[36:39], a[28:31], v[228:231]
    v_mfma_f32_16x16x32_bf16 v[136:139], v[40:43], a[16:19], v[136:139]
    ds_read_b64_tr_b16 v[36:37], v9 offset:0
    v_cvt_pk_bf16_f32 v80, v80, v81
    v_mfma_f32_16x16x32_bf16 v[168:171], v[40:43], a[20:23], v[168:171]
    s_xor_b32 s80, s75, 6144
    ds_read_b64_tr_b16 v[38:39], v9 offset:1024
    v_cvt_pk_bf16_f32 v81, v82, v83
    v_mfma_f32_16x16x32_bf16 v[200:203], v[40:43], a[24:27], v[200:203]
    s_waitcnt lgkmcnt(5)
    v_cvt_pk_bf16_f32 v82, v84, v85
    v_cvt_pk_bf16_f32 v83, v86, v87
    v_mfma_f32_16x16x32_bf16 v[232:235], v[40:43], a[28:31], v[232:235]
    buffer_load_dwordx4 a[96:99], v1, s[8:11], s80 offen offset:0
    v_mfma_f32_16x16x32_bf16 v[140:143], v[44:47], a[16:19], v[140:143]
    s_xor_b32 s79, s1, 36864
    ds_read_b64_tr_b16 v[40:41], v10 offset:0
    v_mfma_f32_16x16x32_bf16 v[172:175], v[44:47], a[20:23], v[172:175]
    ds_read_b64_tr_b16 v[42:43], v10 offset:1024
    v_mfma_f32_16x16x32_bf16 v[204:207], v[44:47], a[24:27], v[204:207]
    buffer_store_dwordx4 v[80:83], v1, s[8:11], s79 offen offset:3072 sc0 sc1
    v_mfma_f32_16x16x32_bf16 v[236:239], v[44:47], a[28:31], v[236:239]
    v_mfma_f32_16x16x32_bf16 v[144:147], v[48:51], a[16:19], v[144:147]
    s_xor_b32 s80, s75, 22528
    ds_read_b64_tr_b16 v[44:45], v11 offset:0
    v_mfma_f32_16x16x32_bf16 v[176:179], v[48:51], a[20:23], v[176:179]
    ds_read_b64_tr_b16 v[46:47], v11 offset:1024
    v_mfma_f32_16x16x32_bf16 v[208:211], v[48:51], a[24:27], v[208:211]
    buffer_load_dwordx4 a[100:103], v1, s[8:11], s80 offen offset:0
    v_mfma_f32_16x16x32_bf16 v[240:243], v[48:51], a[28:31], v[240:243]
    v_mfma_f32_16x16x32_bf16 v[148:151], v[52:55], a[16:19], v[148:151]
    ds_read_b64_tr_b16 v[48:49], v12 offset:0
    v_mfma_f32_16x16x32_bf16 v[180:183], v[52:55], a[20:23], v[180:183]
    ds_read_b64_tr_b16 v[50:51], v12 offset:1024
    v_mfma_f32_16x16x32_bf16 v[212:215], v[52:55], a[24:27], v[212:215]
    v_mfma_f32_16x16x32_bf16 v[244:247], v[52:55], a[28:31], v[244:247]
    v_mfma_f32_16x16x32_bf16 v[152:155], v[56:59], a[16:19], v[152:155]
    s_xor_b32 s80, s76, 6144
    ds_read_b64_tr_b16 v[52:53], v13 offset:0
    v_cvt_pk_bf16_f32 v88, v88, v89
    v_mfma_f32_16x16x32_bf16 v[184:187], v[56:59], a[20:23], v[184:187]
    ds_read_b64_tr_b16 v[54:55], v13 offset:1024
    v_cvt_pk_bf16_f32 v89, v90, v91
    v_mfma_f32_16x16x32_bf16 v[216:219], v[56:59], a[24:27], v[216:219]
    s_waitcnt lgkmcnt(5)
    v_cvt_pk_bf16_f32 v90, v92, v93
    v_cvt_pk_bf16_f32 v91, v94, v95
    v_mfma_f32_16x16x32_bf16 v[248:251], v[56:59], a[28:31], v[248:251]
    buffer_load_dwordx4 a[104:107], v1, s[8:11], s80 offen offset:0
    v_mfma_f32_16x16x32_bf16 v[156:159], v[60:63], a[16:19], v[156:159]
    s_xor_b32 s79, s1, 45056
    ds_read_b64_tr_b16 v[56:57], v14 offset:0
    v_mfma_f32_16x16x32_bf16 v[188:191], v[60:63], a[20:23], v[188:191]
    ds_read_b64_tr_b16 v[58:59], v14 offset:1024
    v_mfma_f32_16x16x32_bf16 v[220:223], v[60:63], a[24:27], v[220:223]
    buffer_store_dwordx4 v[88:91], v1, s[8:11], s79 offen offset:3072 sc0 sc1
    v_mfma_f32_16x16x32_bf16 v[252:255], v[60:63], a[28:31], v[252:255]
    s_waitcnt vmcnt(26)
    v_mfma_f32_16x16x32_bf16 v[128:131], v[32:35], a[32:35], v[128:131]
    s_waitcnt vmcnt(25)
    s_xor_b32 s80, s76, 22528
    ds_read_b64_tr_b16 v[60:61], v15 offset:0
    v_mfma_f32_16x16x32_bf16 v[160:163], v[32:35], a[36:39], v[160:163]
    s_waitcnt vmcnt(22)
    ds_read_b64_tr_b16 v[62:63], v15 offset:1024
    v_mfma_f32_16x16x32_bf16 v[192:195], v[32:35], a[40:43], v[192:195]
    buffer_load_dwordx4 a[108:111], v1, s[8:11], s80 offen offset:0
    v_mfma_f32_16x16x32_bf16 v[224:227], v[32:35], a[44:47], v[224:227]
    v_mfma_f32_16x16x32_bf16 v[132:135], v[36:39], a[32:35], v[132:135]
    ds_read_b64_tr_b16 v[32:33], v8 offset:8192
    v_mfma_f32_16x16x32_bf16 v[164:167], v[36:39], a[36:39], v[164:167]
    s_xor_b32 s80, s75, 6144
    ds_read_b64_tr_b16 v[34:35], v8 offset:9216
    v_mfma_f32_16x16x32_bf16 v[196:199], v[36:39], a[40:43], v[196:199]
    buffer_load_dwordx4 a[112:115], v1, s[8:11], s80 offen offset:1024
    v_mfma_f32_16x16x32_bf16 v[228:231], v[36:39], a[44:47], v[228:231]
    v_mfma_f32_16x16x32_bf16 v[136:139], v[40:43], a[32:35], v[136:139]
    ds_read_b64_tr_b16 v[36:37], v9 offset:8192
    v_mfma_f32_16x16x32_bf16 v[168:171], v[40:43], a[36:39], v[168:171]
    ds_read_b64_tr_b16 v[38:39], v9 offset:9216
    v_mfma_f32_16x16x32_bf16 v[200:203], v[40:43], a[40:43], v[200:203]
    v_mfma_f32_16x16x32_bf16 v[232:235], v[40:43], a[44:47], v[232:235]
    s_waitcnt lgkmcnt(4)
    v_mfma_f32_16x16x32_bf16 v[140:143], v[44:47], a[32:35], v[140:143]
    s_xor_b32 s80, s75, 22528
    ds_read_b64_tr_b16 v[40:41], v10 offset:8192
    v_mfma_f32_16x16x32_bf16 v[172:175], v[44:47], a[36:39], v[172:175]
    ds_read_b64_tr_b16 v[42:43], v10 offset:9216
    v_mfma_f32_16x16x32_bf16 v[204:207], v[44:47], a[40:43], v[204:207]
    buffer_load_dwordx4 a[116:119], v1, s[8:11], s80 offen offset:1024
    v_mfma_f32_16x16x32_bf16 v[236:239], v[44:47], a[44:47], v[236:239]
    v_mfma_f32_16x16x32_bf16 v[144:147], v[48:51], a[32:35], v[144:147]
    ds_read_b64_tr_b16 v[44:45], v11 offset:8192
    v_mfma_f32_16x16x32_bf16 v[176:179], v[48:51], a[36:39], v[176:179]
    ds_read_b64_tr_b16 v[46:47], v11 offset:9216
    v_mfma_f32_16x16x32_bf16 v[208:211], v[48:51], a[40:43], v[208:211]
    v_mfma_f32_16x16x32_bf16 v[240:243], v[48:51], a[44:47], v[240:243]
    v_mfma_f32_16x16x32_bf16 v[148:151], v[52:55], a[32:35], v[148:151]
    s_xor_b32 s80, s76, 6144
    ds_read_b64_tr_b16 v[48:49], v12 offset:8192
    v_mfma_f32_16x16x32_bf16 v[180:183], v[52:55], a[36:39], v[180:183]
    ds_read_b64_tr_b16 v[50:51], v12 offset:9216
    v_mfma_f32_16x16x32_bf16 v[212:215], v[52:55], a[40:43], v[212:215]
    buffer_load_dwordx4 a[120:123], v1, s[8:11], s80 offen offset:1024
    v_mfma_f32_16x16x32_bf16 v[244:247], v[52:55], a[44:47], v[244:247]
    v_mfma_f32_16x16x32_bf16 v[152:155], v[56:59], a[32:35], v[152:155]
    ds_read_b64_tr_b16 v[52:53], v13 offset:8192
    v_mfma_f32_16x16x32_bf16 v[184:187], v[56:59], a[36:39], v[184:187]
    ds_read_b64_tr_b16 v[54:55], v13 offset:9216
    v_mfma_f32_16x16x32_bf16 v[216:219], v[56:59], a[40:43], v[216:219]
    v_mfma_f32_16x16x32_bf16 v[248:251], v[56:59], a[44:47], v[248:251]
    v_mfma_f32_16x16x32_bf16 v[156:159], v[60:63], a[32:35], v[156:159]
    s_xor_b32 s80, s76, 22528
    ds_read_b64_tr_b16 v[56:57], v14 offset:8192
    v_mfma_f32_16x16x32_bf16 v[188:191], v[60:63], a[36:39], v[188:191]
    ds_read_b64_tr_b16 v[58:59], v14 offset:9216
    v_mfma_f32_16x16x32_bf16 v[220:223], v[60:63], a[40:43], v[220:223]
    buffer_load_dwordx4 a[124:127], v1, s[8:11], s80 offen offset:1024
    v_mfma_f32_16x16x32_bf16 v[252:255], v[60:63], a[44:47], v[252:255]
    s_waitcnt vmcnt(25) lgkmcnt(4)
    v_mfma_f32_16x16x32_bf16 v[128:131], v[32:35], a[48:51], v[128:131]
    s_waitcnt vmcnt(24)
    ds_read_b64_tr_b16 v[60:61], v15 offset:8192
    v_mfma_f32_16x16x32_bf16 v[160:163], v[32:35], a[52:55], v[160:163]
    s_waitcnt vmcnt(21)
    s_xor_b32 s80, s75, 8192
    ds_read_b64_tr_b16 v[62:63], v15 offset:9216
    v_mfma_f32_16x16x32_bf16 v[192:195], v[32:35], a[56:59], v[192:195]
    buffer_load_dwordx4 a[128:131], v1, s[8:11], s80 offen offset:0
    v_mfma_f32_16x16x32_bf16 v[224:227], v[32:35], a[60:63], v[224:227]
    v_mfma_f32_16x16x32_bf16 v[132:135], v[36:39], a[48:51], v[132:135]
    ds_read_b64_tr_b16 v[32:33], v8 offset:16384
    v_mfma_f32_16x16x32_bf16 v[164:167], v[36:39], a[52:55], v[164:167]
    ds_read_b64_tr_b16 v[34:35], v8 offset:17408
    v_mfma_f32_16x16x32_bf16 v[196:199], v[36:39], a[56:59], v[196:199]
    v_mfma_f32_16x16x32_bf16 v[228:231], v[36:39], a[60:63], v[228:231]
    v_mfma_f32_16x16x32_bf16 v[136:139], v[40:43], a[48:51], v[136:139]
    s_xor_b32 s80, s75, 24576
    ds_read_b64_tr_b16 v[36:37], v9 offset:16384
    v_mfma_f32_16x16x32_bf16 v[168:171], v[40:43], a[52:55], v[168:171]
    ds_read_b64_tr_b16 v[38:39], v9 offset:17408
    v_mfma_f32_16x16x32_bf16 v[200:203], v[40:43], a[56:59], v[200:203]
    buffer_load_dwordx4 a[132:135], v1, s[8:11], s80 offen offset:0
    v_mfma_f32_16x16x32_bf16 v[232:235], v[40:43], a[60:63], v[232:235]
    v_mfma_f32_16x16x32_bf16 v[140:143], v[44:47], a[48:51], v[140:143]
    ds_read_b64_tr_b16 v[40:41], v10 offset:16384
    v_mfma_f32_16x16x32_bf16 v[172:175], v[44:47], a[52:55], v[172:175]
    ds_read_b64_tr_b16 v[42:43], v10 offset:17408
    v_mfma_f32_16x16x32_bf16 v[204:207], v[44:47], a[56:59], v[204:207]
    v_mfma_f32_16x16x32_bf16 v[236:239], v[44:47], a[60:63], v[236:239]
    v_mfma_f32_16x16x32_bf16 v[144:147], v[48:51], a[48:51], v[144:147]
    s_xor_b32 s80, s76, 8192
    ds_read_b64_tr_b16 v[44:45], v11 offset:16384
    v_mfma_f32_16x16x32_bf16 v[176:179], v[48:51], a[52:55], v[176:179]
    ds_read_b64_tr_b16 v[46:47], v11 offset:17408
    v_mfma_f32_16x16x32_bf16 v[208:211], v[48:51], a[56:59], v[208:211]
    buffer_load_dwordx4 a[136:139], v1, s[8:11], s80 offen offset:0
    v_mfma_f32_16x16x32_bf16 v[240:243], v[48:51], a[60:63], v[240:243]
    s_waitcnt lgkmcnt(4)
    v_mfma_f32_16x16x32_bf16 v[148:151], v[52:55], a[48:51], v[148:151]
    ds_read_b64_tr_b16 v[48:49], v12 offset:16384
    v_mfma_f32_16x16x32_bf16 v[180:183], v[52:55], a[52:55], v[180:183]
    ds_read_b64_tr_b16 v[50:51], v12 offset:17408
    v_mfma_f32_16x16x32_bf16 v[212:215], v[52:55], a[56:59], v[212:215]
    v_mfma_f32_16x16x32_bf16 v[244:247], v[52:55], a[60:63], v[244:247]
    v_mfma_f32_16x16x32_bf16 v[152:155], v[56:59], a[48:51], v[152:155]
    s_xor_b32 s80, s76, 24576
    ds_read_b64_tr_b16 v[52:53], v13 offset:16384
    v_mfma_f32_16x16x32_bf16 v[184:187], v[56:59], a[52:55], v[184:187]
    ds_read_b64_tr_b16 v[54:55], v13 offset:17408
    v_mfma_f32_16x16x32_bf16 v[216:219], v[56:59], a[56:59], v[216:219]
    buffer_load_dwordx4 a[140:143], v1, s[8:11], s80 offen offset:0
    s_waitcnt vmcnt(9)
    v_mfma_f32_16x16x32_bf16 v[248:251], v[56:59], a[60:63], v[248:251]
    buffer_store_dword v6, v5, s[8:11], s73 offen sc0 sc1
    v_mfma_f32_16x16x32_bf16 v[156:159], v[60:63], a[48:51], v[156:159]
    ds_read_b64_tr_b16 v[56:57], v14 offset:16384
    v_mfma_f32_16x16x32_bf16 v[188:191], v[60:63], a[52:55], v[188:191]
    s_xor_b32 s80, s75, 8192
    ds_read_b64_tr_b16 v[58:59], v14 offset:17408
    v_mfma_f32_16x16x32_bf16 v[220:223], v[60:63], a[56:59], v[220:223]
    buffer_load_dwordx4 a[144:147], v1, s[8:11], s80 offen offset:1024
    v_mfma_f32_16x16x32_bf16 v[252:255], v[60:63], a[60:63], v[252:255]
    v_mfma_f32_16x16x32_bf16 v[128:131], v[32:35], a[64:67], v[128:131]
    ds_read_b64_tr_b16 v[60:61], v15 offset:16384
    v_mfma_f32_16x16x32_bf16 v[160:163], v[32:35], a[68:71], v[160:163]
    ds_read_b64_tr_b16 v[62:63], v15 offset:17408
    v_mfma_f32_16x16x32_bf16 v[192:195], v[32:35], a[72:75], v[192:195]
    v_mfma_f32_16x16x32_bf16 v[224:227], v[32:35], a[76:79], v[224:227]
    v_mfma_f32_16x16x32_bf16 v[132:135], v[36:39], a[64:67], v[132:135]
    s_xor_b32 s80, s75, 24576
    ds_read_b64_tr_b16 v[32:33], v8 offset:24576
    v_mfma_f32_16x16x32_bf16 v[164:167], v[36:39], a[68:71], v[164:167]
    ds_read_b64_tr_b16 v[34:35], v8 offset:25600
    v_mfma_f32_16x16x32_bf16 v[196:199], v[36:39], a[72:75], v[196:199]
    buffer_load_dwordx4 a[148:151], v1, s[8:11], s80 offen offset:1024
    v_mfma_f32_16x16x32_bf16 v[228:231], v[36:39], a[76:79], v[228:231]
    s_waitcnt lgkmcnt(4)
    v_mfma_f32_16x16x32_bf16 v[136:139], v[40:43], a[64:67], v[136:139]
    ds_read_b64_tr_b16 v[36:37], v9 offset:24576
    v_mfma_f32_16x16x32_bf16 v[168:171], v[40:43], a[68:71], v[168:171]
    ds_read_b64_tr_b16 v[38:39], v9 offset:25600
    v_mfma_f32_16x16x32_bf16 v[200:203], v[40:43], a[72:75], v[200:203]
    v_mfma_f32_16x16x32_bf16 v[232:235], v[40:43], a[76:79], v[232:235]
    v_mfma_f32_16x16x32_bf16 v[140:143], v[44:47], a[64:67], v[140:143]
    s_xor_b32 s80, s76, 8192
    ds_read_b64_tr_b16 v[40:41], v10 offset:24576
    v_mfma_f32_16x16x32_bf16 v[172:175], v[44:47], a[68:71], v[172:175]
    ds_read_b64_tr_b16 v[42:43], v10 offset:25600
    v_mfma_f32_16x16x32_bf16 v[204:207], v[44:47], a[72:75], v[204:207]
    buffer_load_dwordx4 a[152:155], v1, s[8:11], s80 offen offset:1024
    v_mfma_f32_16x16x32_bf16 v[236:239], v[44:47], a[76:79], v[236:239]
    v_mfma_f32_16x16x32_bf16 v[144:147], v[48:51], a[64:67], v[144:147]
    ds_read_b64_tr_b16 v[44:45], v11 offset:24576
    v_mfma_f32_16x16x32_bf16 v[176:179], v[48:51], a[68:71], v[176:179]
    ds_read_b64_tr_b16 v[46:47], v11 offset:25600
    v_mfma_f32_16x16x32_bf16 v[208:211], v[48:51], a[72:75], v[208:211]
    v_mfma_f32_16x16x32_bf16 v[240:243], v[48:51], a[76:79], v[240:243]
    v_mfma_f32_16x16x32_bf16 v[148:151], v[52:55], a[64:67], v[148:151]
    s_xor_b32 s80, s76, 24576
    ds_read_b64_tr_b16 v[48:49], v12 offset:24576
    v_mfma_f32_16x16x32_bf16 v[180:183], v[52:55], a[68:71], v[180:183]
    ds_read_b64_tr_b16 v[50:51], v12 offset:25600
    v_mfma_f32_16x16x32_bf16 v[212:215], v[52:55], a[72:75], v[212:215]
    buffer_load_dwordx4 a[156:159], v1, s[8:11], s80 offen offset:1024
    v_mfma_f32_16x16x32_bf16 v[244:247], v[52:55], a[76:79], v[244:247]
    v_mfma_f32_16x16x32_bf16 v[152:155], v[56:59], a[64:67], v[152:155]
    ds_read_b64_tr_b16 v[52:53], v13 offset:24576
    v_lshlrev_b32 v116, 2, v0
    v_mfma_f32_16x16x32_bf16 v[184:187], v[56:59], a[68:71], v[184:187]
    s_xor_b32 s80, s75, 10240
    ds_read_b64_tr_b16 v[54:55], v13 offset:25600
    v_cmp_gt_u32 vcc, 8, v0
    v_mfma_f32_16x16x32_bf16 v[216:219], v[56:59], a[72:75], v[216:219]
    buffer_load_dwordx4 a[160:163], v1, s[8:11], s80 offen offset:0
    v_mfma_f32_16x16x32_bf16 v[248:251], v[56:59], a[76:79], v[248:251]
    s_waitcnt lgkmcnt(4)
    v_mov_b32 v117, 2147479552
    v_cndmask_b32 v116, v117, v116, vcc
    v_mfma_f32_16x16x32_bf16 v[156:159], v[60:63], a[64:67], v[156:159]
    s_lshl_b32 s70, s2, 5
    s_add_u32 s70, s70, 20480
    ds_read_b64_tr_b16 v[56:57], v14 offset:24576
    v_mfma_f32_16x16x32_bf16 v[188:191], v[60:63], a[68:71], v[188:191]
    ds_read_b64_tr_b16 v[58:59], v14 offset:25600
    v_and_b32 v119, 3, v2
    v_mfma_f32_16x16x32_bf16 v[220:223], v[60:63], a[72:75], v[220:223]
    v_lshlrev_b32 v119, 9, v119
    v_mfma_f32_16x16x32_bf16 v[252:255], v[60:63], a[76:79], v[252:255]
    v_mfma_f32_16x16x32_bf16 v[128:131], v[32:35], a[80:83], v[128:131]
    s_xor_b32 s80, s75, 26624
    s_lshr_b32 s69, s2, 6
    ds_read_b64_tr_b16 v[60:61], v15 offset:24576
    v_mfma_f32_16x16x32_bf16 v[160:163], v[32:35], a[84:87], v[160:163]
    s_add_u32 s69, s69, 4
    s_lshl_b32 s69, s69, 5
    ds_read_b64_tr_b16 v[62:63], v15 offset:25600
    v_mfma_f32_16x16x32_bf16 v[192:195], v[32:35], a[88:91], v[192:195]
    buffer_load_dwordx4 a[164:167], v1, s[8:11], s80 offen offset:0
    v_mfma_f32_16x16x32_bf16 v[224:227], v[32:35], a[92:95], v[224:227]
    s_bfe_u32 s68, s2, 196611
    s_add_u32 s69, s69, s68
    s_lshl_b32 s69, s69, 6
    v_mfma_f32_16x16x32_bf16 v[132:135], v[36:39], a[80:83], v[132:135]
    s_add_u32 s69, s69, 1310720
    s_and_b32 s100, s3, 1
    ds_read_b64_tr_b16 v[32:33], v8 offset:49152
    v_mfma_f32_16x16x32_bf16 v[164:167], v[36:39], a[84:87], v[164:167]
    s_lshr_b32 s101, s3, 1
    s_lshl_b32 s19, s100, 13
    ds_read_b64_tr_b16 v[34:35], v8 offset:50176
    v_mfma_f32_16x16x32_bf16 v[196:199], v[36:39], a[88:91], v[196:199]
    buffer_load_dword v118, v119, s[8:11], s69 offen sc0 sc1
    v_mfma_f32_16x16x32_bf16 v[228:231], v[36:39], a[92:95], v[228:231]
    s_add_u32 s19, s19, 65536
    v_add_u32 v18, s19, v1
    v_mfma_f32_16x16x32_bf16 v[136:139], v[40:43], a[80:83], v[136:139]
    s_xor_b32 s80, s76, 10240
    s_mul_i32 s19, s100, 12288
    ds_read_b64_tr_b16 v[36:37], v9 offset:49152
    v_mfma_f32_16x16x32_bf16 v[168:171], v[40:43], a[84:87], v[168:171]
    s_add_u32 s19, s19, 98304
    ds_read_b64_tr_b16 v[38:39], v9 offset:50176
    v_add_u32 v19, s19, v1
    v_mfma_f32_16x16x32_bf16 v[200:203], v[40:43], a[88:91], v[200:203]
    buffer_load_dwordx4 a[168:171], v1, s[8:11], s80 offen offset:0
    v_mfma_f32_16x16x32_bf16 v[232:235], v[40:43], a[92:95], v[232:235]
    v_mfma_f32_16x16x32_bf16 v[140:143], v[44:47], a[80:83], v[140:143]
    s_lshl_b32 s19, s100, 12
    s_add_u32 s19, s19, 98304
    ds_read_b64_tr_b16 v[40:41], v10 offset:49152
    v_mfma_f32_16x16x32_bf16 v[172:175], v[44:47], a[84:87], v[172:175]
    ds_read_b64_tr_b16 v[42:43], v10 offset:50176
    v_add_u32 v20, s19, v1
    v_mfma_f32_16x16x32_bf16 v[204:207], v[44:47], a[88:91], v[204:207]
    v_and_b32 v23, 15, v2
    v_lshrrev_b32 v24, 4, v2
    v_mfma_f32_16x16x32_bf16 v[236:239], v[44:47], a[92:95], v[236:239]
    s_waitcnt lgkmcnt(4)
    v_mfma_f32_16x16x32_bf16 v[144:147], v[48:51], a[80:83], v[144:147]
    s_xor_b32 s80, s76, 26624
    ds_read_b64_tr_b16 v[44:45], v11 offset:49152
    v_lshlrev_b32 v25, 2, v24
    v_mfma_f32_16x16x32_bf16 v[176:179], v[48:51], a[84:87], v[176:179]
    ds_read_b64_tr_b16 v[46:47], v11 offset:50176
    v_sub_u32 v25, v23, v25
    v_mfma_f32_16x16x32_bf16 v[208:211], v[48:51], a[88:91], v[208:211]
    buffer_load_dwordx4 a[172:175], v1, s[8:11], s80 offen offset:0
    v_mfma_f32_16x16x32_bf16 v[240:243], v[48:51], a[92:95], v[240:243]
    v_mfma_f32_16x16x32_bf16 v[148:151], v[52:55], a[80:83], v[148:151]
    s_sub_i32 s19, s101, s100
    s_lshl_b32 s19, s19, 5
    ds_read_b64_tr_b16 v[48:49], v12 offset:49152
    v_mfma_f32_16x16x32_bf16 v[180:183], v[52:55], a[84:87], v[180:183]
    s_xor_b32 s80, s75, 10240
    ds_read_b64_tr_b16 v[50:51], v12 offset:50176
    v_add_u32 v21, s19, v25
    v_mfma_f32_16x16x32_bf16 v[212:215], v[52:55], a[88:91], v[212:215]
    buffer_load_dwordx4 a[176:179], v1, s[8:11], s80 offen offset:1024
    v_mfma_f32_16x16x32_bf16 v[244:247], v[52:55], a[92:95], v[244:247]
    v_mfma_f32_16x16x32_bf16 v[152:155], v[56:59], a[80:83], v[152:155]
    s_add_u32 s19, s101, s100
    s_sub_i32 s19, 1, s19
    ds_read_b64_tr_b16 v[52:53], v13 offset:49152
    v_mfma_f32_16x16x32_bf16 v[184:187], v[56:59], a[84:87], v[184:187]
    s_lshl_b32 s19, s19, 5
    ds_read_b64_tr_b16 v[54:55], v13 offset:50176
    v_add_u32 v22, s19, v25
    v_mfma_f32_16x16x32_bf16 v[216:219], v[56:59], a[88:91], v[216:219]
    v_cvt_f32_i32 v21, v21
    v_cvt_f32_i32 v22, v22
    v_mfma_f32_16x16x32_bf16 v[248:251], v[56:59], a[92:95], v[248:251]
    v_mfma_f32_16x16x32_bf16 v[156:159], v[60:63], a[80:83], v[156:159]
    s_xor_b32 s80, s75, 26624
    ds_read_b64_tr_b16 v[56:57], v14 offset:49152
    v_add_f32 v21, 0.5, v21
    v_mfma_f32_16x16x32_bf16 v[188:191], v[60:63], a[84:87], v[188:191]
    ds_read_b64_tr_b16 v[58:59], v14 offset:50176
    v_add_f32 v22, 0.5, v22
    v_mfma_f32_16x16x32_bf16 v[220:223], v[60:63], a[88:91], v[220:223]
    buffer_load_dwordx4 a[180:183], v1, s[8:11], s80 offen offset:1024
    v_mfma_f32_16x16x32_bf16 v[252:255], v[60:63], a[92:95], v[252:255]
    v_mul_f32 v21, 0x71800000, v21
    v_mul_f32 v22, 0x71800000, v22
    v_mfma_f32_16x16x32_bf16 v[128:131], v[32:35], a[96:99], v[128:131]
    ds_read_b64_tr_b16 v[60:61], v15 offset:49152
    v_lshrrev_b32 v25, 2, v23
    v_mfma_f32_16x16x32_bf16 v[160:163], v[32:35], a[100:103], v[160:163]
    ds_read_b64_tr_b16 v[62:63], v15 offset:50176
    v_and_b32 v23, 3, v23
    v_mfma_f32_16x16x32_bf16 v[192:195], v[32:35], a[104:107], v[192:195]
    s_waitcnt vmcnt(20)
    v_lshlrev_b32 v23, 6, v23
    v_lshl_add_u32 v23, v25, 15, v23
    v_mfma_f32_16x16x32_bf16 v[224:227], v[32:35], a[108:111], v[224:227]
    s_waitcnt lgkmcnt(4)
    v_mfma_f32_16x16x32_bf16 v[132:135], v[36:39], a[96:99], v[132:135]
    s_xor_b32 s80, s76, 10240
    ds_read_b64_tr_b16 v[32:33], v8 offset:57344
    v_lshl_add_u32 v23, v24, 4, v23
    v_mfma_f32_16x16x32_bf16 v[164:167], v[36:39], a[100:103], v[164:167]
    s_lshl_b32 s18, s6, 20
    s_lshl_b32 s19, s3, 18
    ds_read_b64_tr_b16 v[34:35], v8 offset:58368
    v_mfma_f32_16x16x32_bf16 v[196:199], v[36:39], a[104:107], v[196:199]
    buffer_load_dwordx4 a[184:187], v1, s[8:11], s80 offen offset:1024
    v_mfma_f32_16x16x32_bf16 v[228:231], v[36:39], a[108:111], v[228:231]
    s_add_u32 s18, s18, s19
    s_lshl_b32 s19, s7, 10
    s_add_u32 s18, s18, s19
    v_mfma_f32_16x16x32_bf16 v[136:139], v[40:43], a[96:99], v[136:139]
    s_add_u32 s18, s18, 67108864
    s_mov_b32 s13, s60
    ds_read_b64_tr_b16 v[36:37], v9 offset:57344
    v_mfma_f32_16x16x32_bf16 v[168:171], v[40:43], a[100:103], v[168:171]
    s_mov_b32 s12, 2
    s_mov_b32 s25, 0
    ds_read_b64_tr_b16 v[38:39], v9 offset:58368
    v_mfma_f32_16x16x32_bf16 v[200:203], v[40:43], a[104:107], v[200:203]
    s_mov_b32 s26, 28
    s_mov_b32 s64, 128
    s_lshl_b32 s65, s5, 1
    v_mfma_f32_16x16x32_bf16 v[232:235], v[40:43], a[108:111], v[232:235]
    v_mfma_f32_16x16x32_bf16 v[140:143], v[44:47], a[96:99], v[140:143]
    s_xor_b32 s80, s76, 26624
    s_and_b32 s65, s65, 7
    ds_read_b64_tr_b16 v[40:41], v10 offset:57344
    v_mfma_f32_16x16x32_bf16 v[172:175], v[44:47], a[100:103], v[172:175]
    s_xor_b32 s65, s65, s3
    s_lshl_b32 s65, s65, 16
    ds_read_b64_tr_b16 v[42:43], v10 offset:58368
    v_mfma_f32_16x16x32_bf16 v[204:207], v[44:47], a[104:107], v[204:207]
    buffer_load_dwordx4 a[188:191], v1, s[8:11], s80 offen offset:1024
    v_mfma_f32_16x16x32_bf16 v[236:239], v[44:47], a[108:111], v[236:239]
    s_add_u32 s15, s62, 65536
    s_add_u32 s16, s62, 0
    s_lshl_b32 s20, s7, 13
    v_mfma_f32_16x16x32_bf16 v[144:147], v[48:51], a[96:99], v[144:147]
    s_lshl_b32 s19, s100, 11
    s_add_u32 s20, s20, s19
    ds_read_b64_tr_b16 v[44:45], v11 offset:57344
    v_mfma_f32_16x16x32_bf16 v[176:179], v[48:51], a[100:103], v[176:179]
    s_xor_b32 s80, s75, 12288
    s_add_u32 s20, s20, 50331648
    ds_read_b64_tr_b16 v[46:47], v11 offset:58368
    v_mfma_f32_16x16x32_bf16 v[208:211], v[48:51], a[104:107], v[208:211]
    buffer_load_dwordx4 a[192:195], v1, s[8:11], s80 offen offset:0
    v_mfma_f32_16x16x32_bf16 v[240:243], v[48:51], a[108:111], v[240:243]
    s_sub_u32 s19, 3, s101
    s_lshl_b32 s19, s19, 18
    s_add_u32 s21, s20, s19
    v_mfma_f32_16x16x32_bf16 v[148:151], v[52:55], a[96:99], v[148:151]
    s_lshl_b32 s19, s101, 18
    s_add_u32 s20, s20, s19
    ds_read_b64_tr_b16 v[48:49], v12 offset:57344
    v_mfma_f32_16x16x32_bf16 v[180:183], v[52:55], a[100:103], v[180:183]
    s_add_u32 s22, s72, 131072
    s_and_b32 s23, s2, 231
    ds_read_b64_tr_b16 v[50:51], v12 offset:58368
    v_mfma_f32_16x16x32_bf16 v[212:215], v[52:55], a[104:107], v[212:215]
    s_lshl_b32 s23, s23, 8
    s_sub_u32 s19, 3, s3
    s_min_u32 s19, s19, s3
    v_mfma_f32_16x16x32_bf16 v[244:247], v[52:55], a[108:111], v[244:247]
    s_waitcnt lgkmcnt(4)
    v_mfma_f32_16x16x32_bf16 v[152:155], v[56:59], a[96:99], v[152:155]
    s_xor_b32 s80, s75, 28672
    s_lshl_b32 s19, s19, 7
    ds_read_b64_tr_b16 v[52:53], v13 offset:57344
    s_waitcnt vmcnt(7)
    v_cmp_ne_u32 vcc, 0, v118
    s_cmp_eq_u64 vcc, -1
    s_cbranch_scc0 L_E2_slow_5
L_E2_ok_6:
    v_mfma_f32_16x16x32_bf16 v[184:187], v[56:59], a[100:103], v[184:187]
    s_add_u32 s23, s23, s19
    s_add_u32 s23, s23, 1179648
    ds_read_b64_tr_b16 v[54:55], v13 offset:58368
    v_mfma_f32_16x16x32_bf16 v[216:219], v[56:59], a[104:107], v[216:219]
    buffer_load_dwordx4 a[196:199], v1, s[8:11], s80 offen offset:0
    v_mfma_f32_16x16x32_bf16 v[248:251], v[56:59], a[108:111], v[248:251]
    buffer_load_dword v112, v116, s[8:11], s70 offen
    v_mfma_f32_16x16x32_bf16 v[156:159], v[60:63], a[96:99], v[156:159]
    s_add_u32 s70, s70, 12288
    s_lshl_b32 s71, s2, 2
    ds_read_b64_tr_b16 v[56:57], v14 offset:57344
    v_mfma_f32_16x16x32_bf16 v[188:191], v[60:63], a[100:103], v[188:191]
    s_add_u32 s71, s71, s3
    s_and_b32 s100, s71, 31
    ds_read_b64_tr_b16 v[58:59], v14 offset:58368
    v_mfma_f32_16x16x32_bf16 v[220:223], v[60:63], a[104:107], v[220:223]
    buffer_load_dword v113, v116, s[8:11], s70 offen
    v_mfma_f32_16x16x32_bf16 v[252:255], v[60:63], a[108:111], v[252:255]
    s_lshr_b32 s101, s71, 5
    s_sub_u32 s101, s101, 4
    s_and_b32 s101, s101, 31
    v_mfma_f32_16x16x32_bf16 v[128:131], v[32:35], a[112:115], v[128:131]
    s_xor_b32 s80, s76, 12288
    s_add_u32 s70, s70, 12288
    ds_read_b64_tr_b16 v[60:61], v15 offset:57344
    v_mfma_f32_16x16x32_bf16 v[160:163], v[32:35], a[116:119], v[160:163]
    ds_read_b64_tr_b16 v[62:63], v15 offset:58368
    v_and_b32 v121, 7, v2
    v_mfma_f32_16x16x32_bf16 v[192:195], v[32:35], a[120:123], v[192:195]
    buffer_load_dwordx4 a[200:203], v1, s[8:11], s80 offen offset:0
    v_mfma_f32_16x16x32_bf16 v[224:227], v[32:35], a[124:127], v[224:227]
    buffer_load_dword v114, v116, s[8:11], s70 offen
    v_mfma_f32_16x16x32_bf16 v[132:135], v[36:39], a[112:115], v[132:135]
    s_add_u32 s70, s70, 12288
    v_and_b32 v120, 4, v121
    v_and_b32 v122, 2, v121
    v_mfma_f32_16x16x32_bf16 v[164:167], v[36:39], a[116:119], v[164:167]
    buffer_load_dword v115, v116, s[8:11], s70 offen
    v_mfma_f32_16x16x32_bf16 v[196:199], v[36:39], a[120:123], v[196:199]
    s_add_u32 s70, s70, 12288
    v_lshl_add_u32 v120, v122, 3, v120
    v_and_b32 v122, 1, v121
    v_mfma_f32_16x16x32_bf16 v[228:231], v[36:39], a[124:127], v[228:231]
    v_lshl_add_u32 v120, v122, 1, v120
    v_mul_u32_u24 v120, 3584, v120
    v_mfma_f32_16x16x32_bf16 v[136:139], v[40:43], a[112:115], v[136:139]
    s_xor_b32 s80, s76, 28672
    v_subrev_u32 v8, 98304, v8
    v_subrev_u32 v9, 98304, v9
    s_waitcnt lgkmcnt(0)
    s_barrier
    v_mfma_f32_16x16x32_bf16 v[168:171], v[40:43], a[116:119], v[168:171]
    ds_read_b64_tr_b16 v[32:33], v8 offset:0
    v_lshrrev_b32 v122, 3, v2
    v_mfma_f32_16x16x32_bf16 v[200:203], v[40:43], a[120:123], v[200:203]
    ds_read_b64_tr_b16 v[34:35], v8 offset:1024
    v_lshl_add_u32 v120, v122, 4, v120
    v_mfma_f32_16x16x32_bf16 v[232:235], v[40:43], a[124:127], v[232:235]
    ds_read_b64_tr_b16 v[36:37], v9 offset:0
    v_subrev_u32 v10, 98304, v10
    v_mfma_f32_16x16x32_bf16 v[140:143], v[44:47], a[112:115], v[140:143]
    ds_read_b64_tr_b16 v[38:39], v9 offset:1024
    v_lshlrev_b32 v121, 13, v121
    v_mfma_f32_16x16x32_bf16 v[172:175], v[44:47], a[116:119], v[172:175]
    ds_read_b64_tr_b16 v[40:41], v10 offset:0
    v_lshl_add_u32 v121, v122, 4, v121
    v_mfma_f32_16x16x32_bf16 v[204:207], v[44:47], a[120:123], v[204:207]
    s_lshr_b32 s71, s100, 1
    s_lshl_b32 s71, s71, 2
    ds_read_b64_tr_b16 v[42:43], v10 offset:1024
    v_mfma_f32_16x16x32_bf16 v[236:239], v[44:47], a[124:127], v[236:239]
    s_and_b32 s100, s100, 1
    s_add_u32 s71, s71, s100
    v_subrev_u32 v11, 98304, v11
    v_mfma_f32_16x16x32_bf16 v[144:147], v[48:51], a[112:115], v[144:147]
    s_mul_i32 s71, s71, 28672
    s_lshl_b32 s100, s101, 7
    ds_read_b64_tr_b16 v[44:45], v11 offset:0
    v_mfma_f32_16x16x32_bf16 v[176:179], v[48:51], a[116:119], v[176:179]
    s_add_u32 s71, s71, s100
    s_cmp_lt_u32 s101, 28
    s_cselect_b32 s71, s71, 2147479552
    ds_read_b64_tr_b16 v[46:47], v11 offset:1024
    v_mfma_f32_16x16x32_bf16 v[208:211], v[48:51], a[120:123], v[208:211]
    buffer_load_dwordx4 a[204:207], v1, s[8:11], s80 offen offset:0
    v_mfma_f32_16x16x32_bf16 v[240:243], v[48:51], a[124:127], v[240:243]
    s_xor_b32 s80, s75, 12288
    v_subrev_u32 v12, 98304, v12
    v_mfma_f32_16x16x32_bf16 v[148:151], v[52:55], a[112:115], v[148:151]
    ds_read_b64_tr_b16 v[48:49], v12 offset:0
    v_mfma_f32_16x16x32_bf16 v[180:183], v[52:55], a[116:119], v[180:183]
    ds_read_b64_tr_b16 v[50:51], v12 offset:1024
    v_mfma_f32_16x16x32_bf16 v[212:215], v[52:55], a[120:123], v[212:215]
    buffer_load_dwordx4 a[208:211], v1, s[8:11], s80 offen offset:1024
    v_mfma_f32_16x16x32_bf16 v[244:247], v[52:55], a[124:127], v[244:247]
    s_xor_b32 s80, s75, 28672
    v_subrev_u32 v13, 98304, v13
    v_mfma_f32_16x16x32_bf16 v[152:155], v[56:59], a[112:115], v[152:155]
    ds_read_b64_tr_b16 v[52:53], v13 offset:0
    v_mfma_f32_16x16x32_bf16 v[184:187], v[56:59], a[116:119], v[184:187]
    ds_read_b64_tr_b16 v[54:55], v13 offset:1024
    v_mfma_f32_16x16x32_bf16 v[216:219], v[56:59], a[120:123], v[216:219]
    buffer_load_dwordx4 a[212:215], v1, s[8:11], s80 offen offset:1024
    v_mfma_f32_16x16x32_bf16 v[248:251], v[56:59], a[124:127], v[248:251]
    s_xor_b32 s80, s76, 12288
    v_subrev_u32 v14, 98304, v14
    v_mfma_f32_16x16x32_bf16 v[156:159], v[60:63], a[112:115], v[156:159]
    ds_read_b64_tr_b16 v[56:57], v14 offset:0
    v_mfma_f32_16x16x32_bf16 v[188:191], v[60:63], a[116:119], v[188:191]
    ds_read_b64_tr_b16 v[58:59], v14 offset:1024
    v_mfma_f32_16x16x32_bf16 v[220:223], v[60:63], a[120:123], v[220:223]
    buffer_load_dwordx4 a[216:219], v1, s[8:11], s80 offen offset:1024
    v_mfma_f32_16x16x32_bf16 v[252:255], v[60:63], a[124:127], v[252:255]
    s_waitcnt lgkmcnt(4)
    v_subrev_u32 v15, 98304, v15
    v_mfma_f32_16x16x32_bf16 v[128:131], v[32:35], a[128:131], v[128:131]
    ds_read_b64_tr_b16 v[60:61], v15 offset:0
    v_mfma_f32_16x16x32_bf16 v[160:163], v[32:35], a[132:135], v[160:163]
    ds_read_b64_tr_b16 v[62:63], v15 offset:1024
    v_mfma_f32_16x16x32_bf16 v[192:195], v[32:35], a[136:139], v[192:195]
    buffer_load_dword v3, v17, s[8:11], s74 offen sc0 sc1
    v_mfma_f32_16x16x32_bf16 v[224:227], v[32:35], a[140:143], v[224:227]
    v_mfma_f32_16x16x32_bf16 v[132:135], v[36:39], a[128:131], v[132:135]
    s_xor_b32 s80, s76, 28672
    ds_read_b64_tr_b16 v[32:33], v8 offset:8192
    v_mfma_f32_16x16x32_bf16 v[164:167], v[36:39], a[132:135], v[164:167]
    ds_read_b64_tr_b16 v[34:35], v8 offset:9216
    v_mfma_f32_16x16x32_bf16 v[196:199], v[36:39], a[136:139], v[196:199]
    buffer_load_dwordx4 a[220:223], v1, s[8:11], s80 offen offset:1024
    v_mfma_f32_16x16x32_bf16 v[228:231], v[36:39], a[140:143], v[228:231]
    v_mfma_f32_16x16x32_bf16 v[136:139], v[40:43], a[128:131], v[136:139]
    ds_read_b64_tr_b16 v[36:37], v9 offset:8192
    v_mfma_f32_16x16x32_bf16 v[168:171], v[40:43], a[132:135], v[168:171]
    s_xor_b32 s80, s75, 14336
    ds_read_b64_tr_b16 v[38:39], v9 offset:9216
    v_mfma_f32_16x16x32_bf16 v[200:203], v[40:43], a[136:139], v[200:203]
    buffer_load_dwordx4 a[224:227], v1, s[8:11], s80 offen offset:0
    v_mfma_f32_16x16x32_bf16 v[232:235], v[40:43], a[140:143], v[232:235]
    v_mfma_f32_16x16x32_bf16 v[140:143], v[44:47], a[128:131], v[140:143]
    ds_read_b64_tr_b16 v[40:41], v10 offset:8192
    v_mfma_f32_16x16x32_bf16 v[172:175], v[44:47], a[132:135], v[172:175]
    ds_read_b64_tr_b16 v[42:43], v10 offset:9216
    v_mfma_f32_16x16x32_bf16 v[204:207], v[44:47], a[136:139], v[204:207]
    v_mfma_f32_16x16x32_bf16 v[236:239], v[44:47], a[140:143], v[236:239]
    v_mfma_f32_16x16x32_bf16 v[144:147], v[48:51], a[128:131], v[144:147]
    s_xor_b32 s80, s75, 30720
    ds_read_b64_tr_b16 v[44:45], v11 offset:8192
    v_mfma_f32_16x16x32_bf16 v[176:179], v[48:51], a[132:135], v[176:179]
    ds_read_b64_tr_b16 v[46:47], v11 offset:9216
    v_mfma_f32_16x16x32_bf16 v[208:211], v[48:51], a[136:139], v[208:211]
    buffer_load_dwordx4 a[228:231], v1, s[8:11], s80 offen offset:0
    v_mfma_f32_16x16x32_bf16 v[240:243], v[48:51], a[140:143], v[240:243]
    s_waitcnt lgkmcnt(4)
    v_mfma_f32_16x16x32_bf16 v[148:151], v[52:55], a[128:131], v[148:151]
    ds_read_b64_tr_b16 v[48:49], v12 offset:8192
    v_mfma_f32_16x16x32_bf16 v[180:183], v[52:55], a[132:135], v[180:183]
    ds_read_b64_tr_b16 v[50:51], v12 offset:9216
    v_mfma_f32_16x16x32_bf16 v[212:215], v[52:55], a[136:139], v[212:215]
    v_mfma_f32_16x16x32_bf16 v[244:247], v[52:55], a[140:143], v[244:247]
    v_mfma_f32_16x16x32_bf16 v[152:155], v[56:59], a[128:131], v[152:155]
    s_xor_b32 s80, s76, 14336
    ds_read_b64_tr_b16 v[52:53], v13 offset:8192
    v_mfma_f32_16x16x32_bf16 v[184:187], v[56:59], a[132:135], v[184:187]
    ds_read_b64_tr_b16 v[54:55], v13 offset:9216
    v_mfma_f32_16x16x32_bf16 v[216:219], v[56:59], a[136:139], v[216:219]
    buffer_load_dwordx4 a[232:235], v1, s[8:11], s80 offen offset:0
    s_waitcnt vmcnt(4)
    v_cmp_ne_u32 vcc, 0, v3
    s_cmp_eq_u64 vcc, -1
    s_cbranch_scc0 L_KV_slow_7
L_KV_ok_8:
    v_mfma_f32_16x16x32_bf16 v[248:251], v[56:59], a[140:143], v[248:251]
    v_mfma_f32_16x16x32_bf16 v[156:159], v[60:63], a[128:131], v[156:159]
    s_add_u32 m0, s62, 65536
    s_add_u32 s98, s81, 0
    ds_read_b64_tr_b16 v[56:57], v14 offset:8192
    v_mfma_f32_16x16x32_bf16 v[188:191], v[60:63], a[132:135], v[188:191]
    ds_read_b64_tr_b16 v[58:59], v14 offset:9216
    v_add_u32 v16, s62, v1
    v_mfma_f32_16x16x32_bf16 v[220:223], v[60:63], a[136:139], v[220:223]
    buffer_load_dwordx4 v1, s[8:11], s98 offen offset:0   lds
    v_mfma_f32_16x16x32_bf16 v[252:255], v[60:63], a[140:143], v[252:255]
    v_and_b32 v17, 4294959103, v16
    v_mov_b32 v24, -1
    v_mfma_f32_16x16x32_bf16 v[128:131], v[32:35], a[144:147], v[128:131]
    s_xor_b32 s80, s76, 30720
    ds_read_b64_tr_b16 v[60:61], v15 offset:8192
    v_mov_b32 v28, 0x3f803f80
    v_mfma_f32_16x16x32_bf16 v[160:163], v[32:35], a[148:151], v[160:163]
    ds_read_b64_tr_b16 v[62:63], v15 offset:9216
    v_mov_b32 v25, -1
    v_mfma_f32_16x16x32_bf16 v[192:195], v[32:35], a[152:155], v[192:195]
    buffer_load_dwordx4 a[236:239], v1, s[8:11], s80 offen offset:0
    v_mfma_f32_16x16x32_bf16 v[224:227], v[32:35], a[156:159], v[224:227]
    buffer_load_dwordx4 v1, s[8:11], s98 offen offset:1024   lds
    v_mfma_f32_16x16x32_bf16 v[132:135], v[36:39], a[144:147], v[132:135]
    ds_read_b64_tr_b16 v[32:33], v8 offset:16384
    v_add_f32 v112, v112, v113
    v_mfma_f32_16x16x32_bf16 v[164:167], v[36:39], a[148:151], v[164:167]
    s_xor_b32 s80, s75, 14336
    ds_read_b64_tr_b16 v[34:35], v8 offset:17408
    v_add_f32 v114, v114, v115
    v_mfma_f32_16x16x32_bf16 v[196:199], v[36:39], a[152:155], v[196:199]
    buffer_load_dwordx4 a[240:243], v1, s[8:11], s80 offen offset:1024
    v_mfma_f32_16x16x32_bf16 v[228:231], v[36:39], a[156:159], v[228:231]
    s_waitcnt lgkmcnt(4)
    ds_read_b64_tr_b16 a[24:25], v8 offset:49152
    v_add_f32 v112, v112, v114
    v_mfma_f32_16x16x32_bf16 v[136:139], v[40:43], a[144:147], v[136:139]
    ds_read_b64_tr_b16 v[36:37], v9 offset:16384
    v_cvt_pk_bf16_f32 v112, v112, v112
    v_mfma_f32_16x16x32_bf16 v[168:171], v[40:43], a[148:151], v[168:171]
    ds_read_b64_tr_b16 v[38:39], v9 offset:17408
    v_and_b32 v112, 0xffff0000, v112
    v_mfma_f32_16x16x32_bf16 v[200:203], v[40:43], a[152:155], v[200:203]
    s_lshr_b32 s70, s2, 6
    s_cmp_eq_u32 s70, 2
    s_cselect_b32 s70, 1.0, 0
    ds_read_b64_tr_b16 a[26:27], v8 offset:50176
    v_mfma_f32_16x16x32_bf16 v[232:235], v[40:43], a[156:159], v[232:235]
    buffer_load_dwordx4 v1, s[8:11], s98 offen offset:2048   lds
    v_mfma_f32_16x16x32_bf16 v[140:143], v[44:47], a[144:147], v[140:143]
    s_xor_b32 s80, s75, 30720
    ds_read_b64_tr_b16 v[40:41], v10 offset:16384
    v_add_f32 v112, s70, v112
    v_mfma_f32_16x16x32_bf16 v[172:175], v[44:47], a[148:151], v[172:175]
    ds_read_b64_tr_b16 v[42:43], v10 offset:17408
    v_cvt_pk_bf16_f32 v112, v112, v112
    v_mfma_f32_16x16x32_bf16 v[204:207], v[44:47], a[152:155], v[204:207]
    ds_read_b64_tr_b16 a[28:29], v9 offset:49152
    v_and_b32 v112, 0xffff0000, v112
    v_mfma_f32_16x16x32_bf16 v[236:239], v[44:47], a[156:159], v[236:239]
    buffer_load_dwordx4 a[244:247], v1, s[8:11], s80 offen offset:1024
    v_mfma_f32_16x16x32_bf16 v[144:147], v[48:51], a[144:147], v[144:147]
    s_lshl_b32 s70, s2, 5
    s_add_u32 s70, s70, 4096
    ds_read_b64_tr_b16 v[44:45], v11 offset:16384
    v_mfma_f32_16x16x32_bf16 v[176:179], v[48:51], a[148:151], v[176:179]
    ds_read_b64_tr_b16 v[46:47], v11 offset:17408
    v_mov_b32 v29, 0x3f803f80
    v_mfma_f32_16x16x32_bf16 v[208:211], v[48:51], a[152:155], v[208:211]
    ds_read_b64_tr_b16 a[30:31], v9 offset:50176
    v_mov_b32 v26, -1
    v_mfma_f32_16x16x32_bf16 v[240:243], v[48:51], a[156:159], v[240:243]
    buffer_store_dword v112, v116, s[8:11], s70 offen sc0 sc1
    v_mfma_f32_16x16x32_bf16 v[148:151], v[52:55], a[144:147], v[148:151]
    s_xor_b32 s80, s76, 14336
    ds_read_b64_tr_b16 v[48:49], v12 offset:16384
    v_mov_b32 v30, 0x3f803f80
    v_mfma_f32_16x16x32_bf16 v[180:183], v[52:55], a[148:151], v[180:183]
    ds_read_b64_tr_b16 v[50:51], v12 offset:17408
    v_mov_b32 v27, -1
    v_mfma_f32_16x16x32_bf16 v[212:215], v[52:55], a[152:155], v[212:215]
    ds_read_b64_tr_b16 a[32:33], v10 offset:49152
    v_mov_b32 v31, 0x3f803f80
    v_mfma_f32_16x16x32_bf16 v[244:247], v[52:55], a[156:159], v[244:247]
    buffer_load_dwordx4 a[248:251], v1, s[8:11], s80 offen offset:1024
    v_mfma_f32_16x16x32_bf16 v[152:155], v[56:59], a[144:147], v[152:155]
    ds_read_b64_tr_b16 v[52:53], v13 offset:16384
    v_mov_b32 v64, 0
    v_mfma_f32_16x16x32_bf16 v[184:187], v[56:59], a[148:151], v[184:187]
    ds_read_b64_tr_b16 v[54:55], v13 offset:17408
    v_mov_b32 v65, 0
    v_mfma_f32_16x16x32_bf16 v[216:219], v[56:59], a[152:155], v[216:219]
    s_waitcnt lgkmcnt(7)
    s_xor_b32 s80, s76, 30720
    ds_read_b64_tr_b16 a[34:35], v10 offset:50176
    v_mov_b32 v66, 0
    v_mfma_f32_16x16x32_bf16 v[248:251], v[56:59], a[156:159], v[248:251]
    buffer_load_dwordx4 a[252:255], v1, s[8:11], s80 offen offset:1024
    v_mfma_f32_16x16x32_bf16 v[156:159], v[60:63], a[144:147], v[156:159]
    ds_read_b64_tr_b16 v[56:57], v14 offset:16384
    v_mov_b32 v67, 0
    v_mfma_f32_16x16x32_bf16 v[188:191], v[60:63], a[148:151], v[188:191]
    ds_read_b64_tr_b16 v[58:59], v14 offset:17408
    v_mov_b32 v68, 0
    v_mfma_f32_16x16x32_bf16 v[220:223], v[60:63], a[152:155], v[220:223]
    ds_read_b64_tr_b16 a[36:37], v11 offset:49152
    v_mov_b32 v69, 0
    v_mfma_f32_16x16x32_bf16 v[252:255], v[60:63], a[156:159], v[252:255]
    buffer_load_dwordx4 v1, s[8:11], s98 offen offset:3072   lds
    v_mfma_f32_16x16x32_bf16 v[128:131], v[32:35], a[160:163], v[128:131]
    s_add_u32 m0, s62, 69632
    s_add_u32 s98, s81, 4096
    ds_read_b64_tr_b16 v[60:61], v15 offset:16384
    v_mfma_f32_16x16x32_bf16 v[160:163], v[32:35], a[164:167], v[160:163]
    ds_read_b64_tr_b16 v[62:63], v15 offset:17408
    v_mov_b32 v70, 0
    v_mfma_f32_16x16x32_bf16 v[192:195], v[32:35], a[168:171], v[192:195]
    ds_read_b64_tr_b16 a[38:39], v11 offset:50176
    v_mov_b32 v71, 0
    v_mfma_f32_16x16x32_bf16 v[224:227], v[32:35], a[172:175], v[224:227]
    buffer_load_dwordx4 v1, s[8:11], s98 offen offset:0   lds
    v_mfma_f32_16x16x32_bf16 v[132:135], v[36:39], a[160:163], v[132:135]
    ds_read_b64_tr_b16 v[32:33], v8 offset:24576
    v_mov_b32 v72, 0
    v_mfma_f32_16x16x32_bf16 v[164:167], v[36:39], a[164:167], v[164:167]
    ds_read_b64_tr_b16 v[34:35], v8 offset:25600
    v_mov_b32 v73, 0
    v_mfma_f32_16x16x32_bf16 v[196:199], v[36:39], a[168:171], v[196:199]
    ds_read_b64_tr_b16 a[40:41], v12 offset:49152
    v_mov_b32 v74, 0
    v_mfma_f32_16x16x32_bf16 v[228:231], v[36:39], a[172:175], v[228:231]
    buffer_load_dwordx4 v1, s[8:11], s98 offen offset:1024   lds
    v_mfma_f32_16x16x32_bf16 v[136:139], v[40:43], a[160:163], v[136:139]
    ds_read_b64_tr_b16 v[36:37], v9 offset:24576
    v_mov_b32 v75, 0
    v_mfma_f32_16x16x32_bf16 v[168:171], v[40:43], a[164:167], v[168:171]
    ds_read_b64_tr_b16 v[38:39], v9 offset:25600
    v_mov_b32 v76, 0
    v_mfma_f32_16x16x32_bf16 v[200:203], v[40:43], a[168:171], v[200:203]
    s_waitcnt lgkmcnt(7)
    ds_read_b64_tr_b16 a[42:43], v12 offset:50176
    v_mov_b32 v77, 0
    v_mfma_f32_16x16x32_bf16 v[232:235], v[40:43], a[172:175], v[232:235]
    buffer_load_dwordx4 v1, s[8:11], s98 offen offset:2048   lds
    v_mfma_f32_16x16x32_bf16 v[140:143], v[44:47], a[160:163], v[140:143]
    ds_read_b64_tr_b16 v[40:41], v10 offset:24576
    v_mov_b32 v78, 0
    v_mfma_f32_16x16x32_bf16 v[172:175], v[44:47], a[164:167], v[172:175]
    ds_read_b64_tr_b16 v[42:43], v10 offset:25600
    v_mov_b32 v79, 0
    v_mfma_f32_16x16x32_bf16 v[204:207], v[44:47], a[168:171], v[204:207]
    s_cmp_eq_u32 s60, 0
    s_cselect_b32 s19, 0, 0x76800000
    ds_read_b64_tr_b16 a[44:45], v13 offset:49152
    v_add_f32 v3, s19, v21
    v_mfma_f32_16x16x32_bf16 v[236:239], v[44:47], a[172:175], v[236:239]
    buffer_load_dwordx4 v1, s[8:11], s98 offen offset:3072   lds
    v_mfma_f32_16x16x32_bf16 v[144:147], v[48:51], a[160:163], v[144:147]
    s_add_u32 m0, s62, 98304
    s_add_u32 s98, s81, 32768
    ds_read_b64_tr_b16 v[44:45], v11 offset:24576
    v_mfma_f32_16x16x32_bf16 v[176:179], v[48:51], a[164:167], v[176:179]
    ds_read_b64_tr_b16 v[46:47], v11 offset:25600
    v_add_f32 v96, 0, v3
    v_mfma_f32_16x16x32_bf16 v[208:211], v[48:51], a[168:171], v[208:211]
    ds_read_b64_tr_b16 a[46:47], v13 offset:50176
    v_min_f32 v96, v96, v64
    v_mfma_f32_16x16x32_bf16 v[240:243], v[48:51], a[172:175], v[240:243]
    buffer_load_dwordx4 v1, s[8:11], s98 offen offset:0   lds
    v_mfma_f32_16x16x32_bf16 v[148:151], v[52:55], a[160:163], v[148:151]
    ds_read_b64_tr_b16 v[48:49], v12 offset:24576
    v_add_f32 v97, 0xf1800000, v3
    v_mfma_f32_16x16x32_bf16 v[180:183], v[52:55], a[164:167], v[180:183]
    ds_read_b64_tr_b16 v[50:51], v12 offset:25600
    v_min_f32 v97, v97, v65
    v_mfma_f32_16x16x32_bf16 v[212:215], v[52:55], a[168:171], v[212:215]
    ds_read_b64_tr_b16 a[48:49], v14 offset:49152
    v_add_f32 v98, 0xf2000000, v3
    v_mfma_f32_16x16x32_bf16 v[244:247], v[52:55], a[172:175], v[244:247]
    buffer_load_dwordx4 v1, s[8:11], s98 offen offset:1024   lds
    v_mfma_f32_16x16x32_bf16 v[152:155], v[56:59], a[160:163], v[152:155]
    ds_read_b64_tr_b16 v[52:53], v13 offset:24576
    v_min_f32 v98, v98, v66
    v_mfma_f32_16x16x32_bf16 v[184:187], v[56:59], a[164:167], v[184:187]
    ds_read_b64_tr_b16 v[54:55], v13 offset:25600
    v_add_f32 v99, 0xf2400000, v3
    v_mfma_f32_16x16x32_bf16 v[216:219], v[56:59], a[168:171], v[216:219]
    s_waitcnt lgkmcnt(7)
    ds_read_b64_tr_b16 a[50:51], v14 offset:50176
    v_min_f32 v99, v99, v67
    v_mfma_f32_16x16x32_bf16 v[248:251], v[56:59], a[172:175], v[248:251]
    buffer_load_dwordx4 v1, s[8:11], s98 offen offset:2048   lds
    v_mfma_f32_16x16x32_bf16 v[156:159], v[60:63], a[160:163], v[156:159]
    ds_read_b64_tr_b16 v[56:57], v14 offset:24576
    v_add_f32 v100, 0xf3800000, v3
    v_mfma_f32_16x16x32_bf16 v[188:191], v[60:63], a[164:167], v[188:191]
    ds_read_b64_tr_b16 v[58:59], v14 offset:25600
    v_min_f32 v100, v100, v64
    v_mfma_f32_16x16x32_bf16 v[220:223], v[60:63], a[168:171], v[220:223]
    ds_read_b64_tr_b16 a[52:53], v15 offset:49152
    v_add_f32 v101, 0xf3880000, v3
    v_mfma_f32_16x16x32_bf16 v[252:255], v[60:63], a[172:175], v[252:255]
    buffer_load_dwordx4 v1, s[8:11], s98 offen offset:3072   lds
    v_mfma_f32_16x16x32_bf16 v[128:131], v[32:35], a[176:179], v[128:131]
    s_add_u32 m0, s62, 102400
    s_add_u32 s98, s81, 36864
    ds_read_b64_tr_b16 v[60:61], v15 offset:24576
    v_mfma_f32_16x16x32_bf16 v[160:163], v[32:35], a[180:183], v[160:163]
    ds_read_b64_tr_b16 v[62:63], v15 offset:25600
    v_min_f32 v101, v101, v65
    v_mfma_f32_16x16x32_bf16 v[192:195], v[32:35], a[184:187], v[192:195]
    ds_read_b64_tr_b16 a[54:55], v15 offset:50176
    v_add_f32 v102, 0xf3900000, v3
    v_mfma_f32_16x16x32_bf16 v[224:227], v[32:35], a[188:191], v[224:227]
    buffer_load_dwordx4 v1, s[8:11], s98 offen offset:0   lds
    v_mfma_f32_16x16x32_bf16 v[132:135], v[36:39], a[176:179], v[132:135]
    ds_read_b64_tr_b16 v[32:33], v8 offset:32768
    v_min_f32 v102, v102, v66
    v_mfma_f32_16x16x32_bf16 v[164:167], v[36:39], a[180:183], v[164:167]
    ds_read_b64_tr_b16 v[34:35], v8 offset:33792
    v_add_f32 v103, 0xf3980000, v3
    v_mfma_f32_16x16x32_bf16 v[196:199], v[36:39], a[184:187], v[196:199]
    ds_read_b64_tr_b16 a[64:65], v8 offset:57344
    v_min_f32 v103, v103, v67
    v_mfma_f32_16x16x32_bf16 v[228:231], v[36:39], a[188:191], v[228:231]
    buffer_load_dwordx4 v1, s[8:11], s98 offen offset:1024   lds
    v_mfma_f32_16x16x32_bf16 v[136:139], v[40:43], a[176:179], v[136:139]
    ds_read_b64_tr_b16 v[36:37], v9 offset:32768
    v_add_f32 v104, 0x73800000, v3
    v_mfma_f32_16x16x32_bf16 v[168:171], v[40:43], a[180:183], v[168:171]
    ds_read_b64_tr_b16 v[38:39], v9 offset:33792
    v_min_f32 v104, v104, v68
    v_mfma_f32_16x16x32_bf16 v[200:203], v[40:43], a[184:187], v[200:203]
    s_waitcnt lgkmcnt(7)
    ds_read_b64_tr_b16 a[66:67], v8 offset:58368
    v_add_f32 v105, 0x73700000, v3
    v_mfma_f32_16x16x32_bf16 v[232:235], v[40:43], a[188:191], v[232:235]
    buffer_load_dwordx4 v1, s[8:11], s98 offen offset:2048   lds
    v_mfma_f32_16x16x32_bf16 v[140:143], v[44:47], a[176:179], v[140:143]
    ds_read_b64_tr_b16 v[40:41], v10 offset:32768
    v_min_f32 v105, v105, v69
    v_mfma_f32_16x16x32_bf16 v[172:175], v[44:47], a[180:183], v[172:175]
    ds_read_b64_tr_b16 v[42:43], v10 offset:33792
    v_add_f32 v106, 0x73600000, v3
    v_mfma_f32_16x16x32_bf16 v[204:207], v[44:47], a[184:187], v[204:207]
    ds_read_b64_tr_b16 a[68:69], v9 offset:57344
    v_min_f32 v106, v106, v70
    v_mfma_f32_16x16x32_bf16 v[236:239], v[44:47], a[188:191], v[236:239]
    buffer_load_dwordx4 v1, s[8:11], s98 offen offset:3072   lds
    v_mfma_f32_16x16x32_bf16 v[144:147], v[48:51], a[176:179], v[144:147]
    s_add_u32 m0, s62, 131072
    s_add_u32 s98, s82, 0
    ds_read_b64_tr_b16 v[44:45], v11 offset:32768
    v_mfma_f32_16x16x32_bf16 v[176:179], v[48:51], a[180:183], v[176:179]
    ds_read_b64_tr_b16 v[46:47], v11 offset:33792
    v_add_f32 v107, 0x73500000, v3
    v_mfma_f32_16x16x32_bf16 v[208:211], v[48:51], a[184:187], v[208:211]
    ds_read_b64_tr_b16 a[70:71], v9 offset:58368
    v_min_f32 v107, v107, v71
    v_mfma_f32_16x16x32_bf16 v[240:243], v[48:51], a[188:191], v[240:243]
    buffer_load_dwordx4 v1, s[8:11], s98 offen offset:0   lds
    v_mfma_f32_16x16x32_bf16 v[148:151], v[52:55], a[176:179], v[148:151]
    ds_read_b64_tr_b16 v[48:49], v12 offset:32768
    v_add_f32 v108, 0, v3
    v_mfma_f32_16x16x32_bf16 v[180:183], v[52:55], a[180:183], v[180:183]
    ds_read_b64_tr_b16 v[50:51], v12 offset:33792
    v_min_f32 v108, v108, v68
    v_mfma_f32_16x16x32_bf16 v[212:215], v[52:55], a[184:187], v[212:215]
    ds_read_b64_tr_b16 a[72:73], v10 offset:57344
    v_add_f32 v109, 0xf1800000, v3
    v_mfma_f32_16x16x32_bf16 v[244:247], v[52:55], a[188:191], v[244:247]
    buffer_load_dwordx4 v1, s[8:11], s98 offen offset:1024   lds
    v_mfma_f32_16x16x32_bf16 v[152:155], v[56:59], a[176:179], v[152:155]
    ds_read_b64_tr_b16 v[52:53], v13 offset:32768
    v_min_f32 v109, v109, v69
    v_mfma_f32_16x16x32_bf16 v[184:187], v[56:59], a[180:183], v[184:187]
    ds_read_b64_tr_b16 v[54:55], v13 offset:33792
    v_add_f32 v110, 0xf2000000, v3
    v_mfma_f32_16x16x32_bf16 v[216:219], v[56:59], a[184:187], v[216:219]
    s_waitcnt lgkmcnt(7)
    ds_read_b64_tr_b16 a[74:75], v10 offset:58368
    v_min_f32 v110, v110, v70
    v_mfma_f32_16x16x32_bf16 v[248:251], v[56:59], a[188:191], v[248:251]
    buffer_load_dwordx4 v1, s[8:11], s98 offen offset:2048   lds
    v_mfma_f32_16x16x32_bf16 v[156:159], v[60:63], a[176:179], v[156:159]
    ds_read_b64_tr_b16 v[56:57], v14 offset:32768
    v_add_f32 v111, 0xf2400000, v3
    v_mfma_f32_16x16x32_bf16 v[188:191], v[60:63], a[180:183], v[188:191]
    ds_read_b64_tr_b16 v[58:59], v14 offset:33792
    v_min_f32 v111, v111, v71
    v_mfma_f32_16x16x32_bf16 v[220:223], v[60:63], a[184:187], v[220:223]
    s_cmp_eq_u32 s60, 0
    s_cselect_b32 s19, 1.0, 0
    ds_read_b64_tr_b16 a[76:77], v11 offset:57344
    v_sub_f32 v3, v22, v21
    v_mfma_f32_16x16x32_bf16 v[252:255], v[60:63], a[188:191], v[252:255]
    buffer_load_dwordx4 v1, s[8:11], s98 offen offset:3072   lds
    v_mfma_f32_16x16x32_bf16 v[128:131], v[32:35], a[192:195], v[128:131]
    s_add_u32 m0, s62, 135168
    s_add_u32 s98, s82, 4096
    ds_read_b64_tr_b16 v[60:61], v15 offset:32768
    v_mfma_f32_16x16x32_bf16 v[160:163], v[32:35], a[196:199], v[160:163]
    ds_read_b64_tr_b16 v[62:63], v15 offset:33792
    v_fma_f32 v3, s19, v3, v21
    v_mfma_f32_16x16x32_bf16 v[192:195], v[32:35], a[200:203], v[192:195]
    ds_read_b64_tr_b16 a[78:79], v11 offset:58368
    v_add_f32 v80, 0, v3
    v_mfma_f32_16x16x32_bf16 v[224:227], v[32:35], a[204:207], v[224:227]
    buffer_load_dwordx4 v1, s[8:11], s98 offen offset:0   lds
    v_mfma_f32_16x16x32_bf16 v[132:135], v[36:39], a[192:195], v[132:135]
    ds_read_b64_tr_b16 v[32:33], v8 offset:40960
    v_min_f32 v80, v80, v64
    v_mfma_f32_16x16x32_bf16 v[164:167], v[36:39], a[196:199], v[164:167]
    ds_read_b64_tr_b16 v[34:35], v8 offset:41984
    v_add_f32 v81, 0xf1800000, v3
    v_mfma_f32_16x16x32_bf16 v[196:199], v[36:39], a[200:203], v[196:199]
    ds_read_b64_tr_b16 a[80:81], v12 offset:57344
    v_min_f32 v81, v81, v65
    v_mfma_f32_16x16x32_bf16 v[228:231], v[36:39], a[204:207], v[228:231]
    buffer_load_dwordx4 v1, s[8:11], s98 offen offset:1024   lds
    v_mfma_f32_16x16x32_bf16 v[136:139], v[40:43], a[192:195], v[136:139]
    ds_read_b64_tr_b16 v[36:37], v9 offset:40960
    v_add_f32 v82, 0xf2000000, v3
    v_mfma_f32_16x16x32_bf16 v[168:171], v[40:43], a[196:199], v[168:171]
    ds_read_b64_tr_b16 v[38:39], v9 offset:41984
    v_min_f32 v82, v82, v66
    v_mfma_f32_16x16x32_bf16 v[200:203], v[40:43], a[200:203], v[200:203]
    s_waitcnt lgkmcnt(7)
    ds_read_b64_tr_b16 a[82:83], v12 offset:58368
    v_add_f32 v83, 0xf2400000, v3
    v_mfma_f32_16x16x32_bf16 v[232:235], v[40:43], a[204:207], v[232:235]
    buffer_load_dwordx4 v1, s[8:11], s98 offen offset:2048   lds
    v_mfma_f32_16x16x32_bf16 v[140:143], v[44:47], a[192:195], v[140:143]
    ds_read_b64_tr_b16 v[40:41], v10 offset:40960
    v_min_f32 v83, v83, v67
    v_mfma_f32_16x16x32_bf16 v[172:175], v[44:47], a[196:199], v[172:175]
    ds_read_b64_tr_b16 v[42:43], v10 offset:41984
    v_add_f32 v84, 0xf3800000, v3
    v_mfma_f32_16x16x32_bf16 v[204:207], v[44:47], a[200:203], v[204:207]
    ds_read_b64_tr_b16 a[84:85], v13 offset:57344
    v_min_f32 v84, v84, v64
    v_mfma_f32_16x16x32_bf16 v[236:239], v[44:47], a[204:207], v[236:239]
    buffer_load_dwordx4 v1, s[8:11], s98 offen offset:3072   lds
    v_mfma_f32_16x16x32_bf16 v[144:147], v[48:51], a[192:195], v[144:147]
    ds_read_b64_tr_b16 v[44:45], v11 offset:40960
    v_add_f32 v85, 0xf3880000, v3
    v_mfma_f32_16x16x32_bf16 v[176:179], v[48:51], a[196:199], v[176:179]
    ds_read_b64_tr_b16 v[46:47], v11 offset:41984
    v_min_f32 v85, v85, v65
    v_mfma_f32_16x16x32_bf16 v[208:211], v[48:51], a[200:203], v[208:211]
    ds_read_b64_tr_b16 a[86:87], v13 offset:58368
    v_add_f32 v86, 0xf3900000, v3
    v_mfma_f32_16x16x32_bf16 v[240:243], v[48:51], a[204:207], v[240:243]
    buffer_load_dwordx4 a[0:3], v120, s[40:43], s71 offen
    v_mfma_f32_16x16x32_bf16 v[148:151], v[52:55], a[192:195], v[148:151]
    ds_read_b64_tr_b16 v[48:49], v12 offset:40960
    v_min_f32 v86, v86, v66
    v_mfma_f32_16x16x32_bf16 v[180:183], v[52:55], a[196:199], v[180:183]
    ds_read_b64_tr_b16 v[50:51], v12 offset:41984
    v_add_f32 v87, 0xf3980000, v3
    v_mfma_f32_16x16x32_bf16 v[212:215], v[52:55], a[200:203], v[212:215]
    ds_read_b64_tr_b16 a[88:89], v14 offset:57344
    v_min_f32 v87, v87, v67
    v_mfma_f32_16x16x32_bf16 v[244:247], v[52:55], a[204:207], v[244:247]
    buffer_load_dwordx4 a[4:7], v120, s[40:43], s71 offen offset:3584
    v_mfma_f32_16x16x32_bf16 v[152:155], v[56:59], a[192:195], v[152:155]
    ds_read_b64_tr_b16 v[52:53], v13 offset:40960
    v_add_f32 v88, 0x73800000, v3
    v_mfma_f32_16x16x32_bf16 v[184:187], v[56:59], a[196:199], v[184:187]
    ds_read_b64_tr_b16 v[54:55], v13 offset:41984
    v_min_f32 v88, v88, v68
    v_mfma_f32_16x16x32_bf16 v[216:219], v[56:59], a[200:203], v[216:219]
    s_waitcnt lgkmcnt(7)
    ds_read_b64_tr_b16 a[90:91], v14 offset:58368
    v_add_f32 v89, 0x73700000, v3
    v_mfma_f32_16x16x32_bf16 v[248:251], v[56:59], a[204:207], v[248:251]
    buffer_load_dwordx4 a[8:11], v120, s[44:47], s71 offen
    v_mfma_f32_16x16x32_bf16 v[156:159], v[60:63], a[192:195], v[156:159]
    ds_read_b64_tr_b16 v[56:57], v14 offset:40960
    v_min_f32 v89, v89, v69
    v_mfma_f32_16x16x32_bf16 v[188:191], v[60:63], a[196:199], v[188:191]
    ds_read_b64_tr_b16 v[58:59], v14 offset:41984
    v_add_f32 v90, 0x73600000, v3
    v_mfma_f32_16x16x32_bf16 v[220:223], v[60:63], a[200:203], v[220:223]
    ds_read_b64_tr_b16 a[92:93], v15 offset:57344
    v_min_f32 v90, v90, v70
    v_mfma_f32_16x16x32_bf16 v[252:255], v[60:63], a[204:207], v[252:255]
    buffer_load_dwordx4 a[12:15], v120, s[44:47], s71 offen offset:3584
    v_mfma_f32_16x16x32_bf16 v[192:195], v[32:35], a[216:219], v[192:195]
    s_waitcnt vmcnt(34)
    s_lshl_b32 s71, s101, 16
    ds_read_b64_tr_b16 v[60:61], v15 offset:40960
    v_add_f32 v91, 0x73500000, v3
    v_mfma_f32_16x16x32_bf16 v[192:195], a[24:27], a[232:235], v[192:195]
    s_waitcnt vmcnt(26)
    s_lshl_b32 s100, s3, 11
    ds_read_b64_tr_b16 v[62:63], v15 offset:41984
    v_min_f32 v91, v91, v71
    v_mfma_f32_16x16x32_bf16 v[192:195], a[64:67], a[248:251], v[192:195]
    s_add_u32 s71, s71, s100
    ds_read_b64_tr_b16 a[94:95], v15 offset:58368
    v_add_f32 v92, 0, v3
    v_mfma_f32_16x16x32_bf16 v[196:199], v[36:39], a[216:219], v[196:199]
    s_lshl_b32 s100, s4, 7
    v_min_f32 v92, v92, v68
    v_add_f32 v93, 0xf1800000, v3
    v_mfma_f32_16x16x32_bf16 v[196:199], a[28:31], a[232:235], v[196:199]
    s_add_u32 s71, s71, s100
    v_min_f32 v93, v93, v69
    v_add_f32 v94, 0xf2000000, v3
    v_mfma_f32_16x16x32_bf16 v[196:199], a[68:71], a[248:251], v[196:199]
    v_min_f32 v94, v94, v70
    v_add_f32 v95, 0xf2400000, v3
    v_mfma_f32_16x16x32_bf16 v[224:227], v[32:35], a[220:223], v[224:227]
    buffer_load_dwordx4 a[16:19], v121, s[48:51], s71 offen
    v_mfma_f32_16x16x32_bf16 v[224:227], a[24:27], a[236:239], v[224:227]
    s_waitcnt vmcnt(26)
    v_min_f32 v95, v95, v71
    s_waitcnt lgkmcnt(0)
    s_barrier
    v_mfma_f32_16x16x32_bf16 v[224:227], a[64:67], a[252:255], v[224:227]
    buffer_load_dwordx4 a[20:23], v121, s[48:51], s71 offen offset:1024
    v_mfma_f32_16x16x32_bf16 v[228:231], v[36:39], a[220:223], v[228:231]
    v_cvt_pk_bf16_f32 v192, v192, v193
    v_cvt_pk_bf16_f32 v193, v194, v195
    v_mfma_f32_16x16x32_bf16 v[228:231], a[28:31], a[236:239], v[228:231]
    v_cvt_pk_bf16_f32 v194, v196, v197
    v_cvt_pk_bf16_f32 v195, v198, v199
    v_mfma_f32_16x16x32_bf16 v[228:231], a[68:71], a[252:255], v[228:231]
    ds_write_b128 v16, v[192:195] offset:32768
    v_lshrrev_b32 v121, 1, v2
    v_mfma_f32_16x16x32_bf16 v[128:131], v[32:35], a[208:211], v[128:131]
    v_and_b32 v121, 15, v121
    v_lshlrev_b32 v121, 10, v121
    v_mfma_f32_16x16x32_bf16 v[128:131], a[24:27], a[224:227], v[128:131]
    v_and_b32 v122, 1, v2
    v_lshl_add_u32 v121, v122, 7, v121
    v_mfma_f32_16x16x32_bf16 v[128:131], a[64:67], a[240:243], v[128:131]
    v_mfma_f32_16x16x32_bf16 v[132:135], v[36:39], a[208:211], v[132:135]
    s_lshl_b32 s71, s6, 2
    v_cvt_pk_bf16_f32 v224, v224, v225
    v_cvt_pk_bf16_f32 v225, v226, v227
    v_mfma_f32_16x16x32_bf16 v[132:135], a[28:31], a[224:227], v[132:135]
    s_add_u32 s71, s71, s3
    v_cvt_pk_bf16_f32 v226, v228, v229
    v_cvt_pk_bf16_f32 v227, v230, v231
    v_mfma_f32_16x16x32_bf16 v[132:135], a[68:71], a[240:243], v[132:135]
    s_lshl_b32 s71, s71, 14
    ds_write_b128 v16, v[224:227] offset:36864
    v_mfma_f32_16x16x32_bf16 v[160:163], v[32:35], a[212:215], v[160:163]
    buffer_load_dword a60, v121, s[28:31], s71 offen
    v_mfma_f32_16x16x32_bf16 v[160:163], a[24:27], a[228:231], v[160:163]
    v_mfma_f32_16x16x32_bf16 v[160:163], a[64:67], a[244:247], v[160:163]
    s_getpc_b64 s[100:101]
L_ct2:
    s_lshr_b32 s99, s2, 3
    s_lshl_b32 s99, s99, 2
    s_add_u32 s99, s99, s3
    s_mul_i32 s99, s99, 6
    v_min_u32 v123, 5, v2
    v_add_u32 v123, s99, v123
    v_lshlrev_b32 v123, 7, v123
    v_add_u32 v123, L_attn-L_ct2, v123
    v_min_u32 v123, L_code_end-L_ct2, v123
    global_load_dword a61, v123, s[100:101]
    v_mfma_f32_16x16x32_bf16 v[164:167], v[36:39], a[212:215], v[164:167]
    v_cvt_pk_bf16_f32 v128, v128, v129
    v_cvt_pk_bf16_f32 v129, v130, v131
    v_mfma_f32_16x16x32_bf16 v[164:167], a[28:31], a[228:231], v[164:167]
    v_cvt_pk_bf16_f32 v130, v132, v133
    v_cvt_pk_bf16_f32 v131, v134, v135
    v_mfma_f32_16x16x32_bf16 v[164:167], a[68:71], a[244:247], v[164:167]
    ds_write_b128 v16, v[128:131] offset:0
    v_mfma_f32_16x16x32_bf16 v[200:203], v[40:43], a[216:219], v[200:203]
    v_mfma_f32_16x16x32_bf16 v[200:203], a[32:35], a[232:235], v[200:203]
    v_mfma_f32_16x16x32_bf16 v[200:203], a[72:75], a[248:251], v[200:203]
    v_mfma_f32_16x16x32_bf16 v[204:207], v[44:47], a[216:219], v[204:207]
    v_cvt_pk_bf16_f32 v160, v160, v161
    v_cvt_pk_bf16_f32 v161, v162, v163
    v_mfma_f32_16x16x32_bf16 v[204:207], a[36:39], a[232:235], v[204:207]
    v_cvt_pk_bf16_f32 v162, v164, v165
    v_cvt_pk_bf16_f32 v163, v166, v167
    v_mfma_f32_16x16x32_bf16 v[204:207], a[76:79], a[248:251], v[204:207]
    ds_write_b128 v16, v[160:163] offset:4096
    v_mfma_f32_16x16x32_bf16 v[232:235], v[40:43], a[220:223], v[232:235]
    v_mfma_f32_16x16x32_bf16 v[232:235], a[32:35], a[236:239], v[232:235]
    v_mfma_f32_16x16x32_bf16 v[232:235], a[72:75], a[252:255], v[232:235]
    v_mfma_f32_16x16x32_bf16 v[236:239], v[44:47], a[220:223], v[236:239]
    v_cvt_pk_bf16_f32 v200, v200, v201
    v_cvt_pk_bf16_f32 v201, v202, v203
    v_mfma_f32_16x16x32_bf16 v[236:239], a[36:39], a[236:239], v[236:239]
    v_cvt_pk_bf16_f32 v202, v204, v205
    v_cvt_pk_bf16_f32 v203, v206, v207
    v_mfma_f32_16x16x32_bf16 v[236:239], a[76:79], a[252:255], v[236:239]
    ds_write_b128 v16, v[200:203] offset:33792
    v_mfma_f32_16x16x32_bf16 v[136:139], v[40:43], a[208:211], v[136:139]
    v_mfma_f32_16x16x32_bf16 v[136:139], a[32:35], a[224:227], v[136:139]
    v_mfma_f32_16x16x32_bf16 v[136:139], a[72:75], a[240:243], v[136:139]
    v_mfma_f32_16x16x32_bf16 v[140:143], v[44:47], a[208:211], v[140:143]
    v_cvt_pk_bf16_f32 v232, v232, v233
    v_cvt_pk_bf16_f32 v233, v234, v235
    v_mfma_f32_16x16x32_bf16 v[140:143], a[36:39], a[224:227], v[140:143]
    v_cvt_pk_bf16_f32 v234, v236, v237
    v_cvt_pk_bf16_f32 v235, v238, v239
    v_mfma_f32_16x16x32_bf16 v[140:143], a[76:79], a[240:243], v[140:143]
    ds_write_b128 v16, v[232:235] offset:37888
    v_mfma_f32_16x16x32_bf16 v[168:171], v[40:43], a[212:215], v[168:171]
    v_mfma_f32_16x16x32_bf16 v[168:171], a[32:35], a[228:231], v[168:171]
    v_mfma_f32_16x16x32_bf16 v[168:171], a[72:75], a[244:247], v[168:171]
    v_mfma_f32_16x16x32_bf16 v[172:175], v[44:47], a[212:215], v[172:175]
    v_cvt_pk_bf16_f32 v136, v136, v137
    v_cvt_pk_bf16_f32 v137, v138, v139
    v_mfma_f32_16x16x32_bf16 v[172:175], a[36:39], a[228:231], v[172:175]
    v_cvt_pk_bf16_f32 v138, v140, v141
    v_cvt_pk_bf16_f32 v139, v142, v143
    v_mfma_f32_16x16x32_bf16 v[172:175], a[76:79], a[244:247], v[172:175]
    ds_write_b128 v16, v[136:139] offset:1024
    v_mfma_f32_16x16x32_bf16 v[208:211], v[48:51], a[216:219], v[208:211]
    v_mfma_f32_16x16x32_bf16 v[208:211], a[40:43], a[232:235], v[208:211]
    v_mfma_f32_16x16x32_bf16 v[208:211], a[80:83], a[248:251], v[208:211]
    v_mfma_f32_16x16x32_bf16 v[212:215], v[52:55], a[216:219], v[212:215]
    v_cvt_pk_bf16_f32 v168, v168, v169
    v_cvt_pk_bf16_f32 v169, v170, v171
    v_mfma_f32_16x16x32_bf16 v[212:215], a[44:47], a[232:235], v[212:215]
    v_cvt_pk_bf16_f32 v170, v172, v173
    v_cvt_pk_bf16_f32 v171, v174, v175
    v_mfma_f32_16x16x32_bf16 v[212:215], a[84:87], a[248:251], v[212:215]
    ds_write_b128 v16, v[168:171] offset:5120
    v_mfma_f32_16x16x32_bf16 v[240:243], v[48:51], a[220:223], v[240:243]
    v_mfma_f32_16x16x32_bf16 v[240:243], a[40:43], a[236:239], v[240:243]
    v_mfma_f32_16x16x32_bf16 v[240:243], a[80:83], a[252:255], v[240:243]
    v_mfma_f32_16x16x32_bf16 v[244:247], v[52:55], a[220:223], v[244:247]
    v_cvt_pk_bf16_f32 v208, v208, v209
    v_cvt_pk_bf16_f32 v209, v210, v211
    v_mfma_f32_16x16x32_bf16 v[244:247], a[44:47], a[236:239], v[244:247]
    v_cvt_pk_bf16_f32 v210, v212, v213
    v_cvt_pk_bf16_f32 v211, v214, v215
    v_mfma_f32_16x16x32_bf16 v[244:247], a[84:87], a[252:255], v[244:247]
    ds_write_b128 v16, v[208:211] offset:34816
    v_mfma_f32_16x16x32_bf16 v[144:147], v[48:51], a[208:211], v[144:147]
    v_mfma_f32_16x16x32_bf16 v[144:147], a[40:43], a[224:227], v[144:147]
    v_mfma_f32_16x16x32_bf16 v[144:147], a[80:83], a[240:243], v[144:147]
    v_mfma_f32_16x16x32_bf16 v[148:151], v[52:55], a[208:211], v[148:151]
    v_cvt_pk_bf16_f32 v240, v240, v241
    v_cvt_pk_bf16_f32 v241, v242, v243
    v_mfma_f32_16x16x32_bf16 v[148:151], a[44:47], a[224:227], v[148:151]
    v_cvt_pk_bf16_f32 v242, v244, v245
    v_cvt_pk_bf16_f32 v243, v246, v247
    v_mfma_f32_16x16x32_bf16 v[148:151], a[84:87], a[240:243], v[148:151]
    ds_write_b128 v16, v[240:243] offset:38912
    v_mfma_f32_16x16x32_bf16 v[176:179], v[48:51], a[212:215], v[176:179]
    v_mfma_f32_16x16x32_bf16 v[176:179], a[40:43], a[228:231], v[176:179]
    v_mfma_f32_16x16x32_bf16 v[176:179], a[80:83], a[244:247], v[176:179]
    v_mfma_f32_16x16x32_bf16 v[180:183], v[52:55], a[212:215], v[180:183]
    v_cvt_pk_bf16_f32 v144, v144, v145
    v_cvt_pk_bf16_f32 v145, v146, v147
    v_mfma_f32_16x16x32_bf16 v[180:183], a[44:47], a[228:231], v[180:183]
    v_cvt_pk_bf16_f32 v146, v148, v149
    v_cvt_pk_bf16_f32 v147, v150, v151
    v_mfma_f32_16x16x32_bf16 v[180:183], a[84:87], a[244:247], v[180:183]
    ds_write_b128 v16, v[144:147] offset:2048
    v_mfma_f32_16x16x32_bf16 v[216:219], v[56:59], a[216:219], v[216:219]
    v_mfma_f32_16x16x32_bf16 v[216:219], a[48:51], a[232:235], v[216:219]
    v_mfma_f32_16x16x32_bf16 v[216:219], a[88:91], a[248:251], v[216:219]
    v_mfma_f32_16x16x32_bf16 v[220:223], v[60:63], a[216:219], v[220:223]
    v_cvt_pk_bf16_f32 v176, v176, v177
    v_cvt_pk_bf16_f32 v177, v178, v179
    v_mfma_f32_16x16x32_bf16 v[220:223], a[52:55], a[232:235], v[220:223]
    v_cvt_pk_bf16_f32 v178, v180, v181
    v_cvt_pk_bf16_f32 v179, v182, v183
    v_mfma_f32_16x16x32_bf16 v[220:223], a[92:95], a[248:251], v[220:223]
    ds_write_b128 v16, v[176:179] offset:6144
    v_mfma_f32_16x16x32_bf16 v[248:251], v[56:59], a[220:223], v[248:251]
    v_mfma_f32_16x16x32_bf16 v[248:251], a[48:51], a[236:239], v[248:251]
    v_mfma_f32_16x16x32_bf16 v[248:251], a[88:91], a[252:255], v[248:251]
    v_mfma_f32_16x16x32_bf16 v[252:255], v[60:63], a[220:223], v[252:255]
    v_cvt_pk_bf16_f32 v216, v216, v217
    v_cvt_pk_bf16_f32 v217, v218, v219
    v_mfma_f32_16x16x32_bf16 v[252:255], a[52:55], a[236:239], v[252:255]
    v_cvt_pk_bf16_f32 v218, v220, v221
    v_cvt_pk_bf16_f32 v219, v222, v223
    v_mfma_f32_16x16x32_bf16 v[252:255], a[92:95], a[252:255], v[252:255]
    ds_write_b128 v16, v[216:219] offset:35840
    v_mfma_f32_16x16x32_bf16 v[152:155], v[56:59], a[208:211], v[152:155]
    v_mfma_f32_16x16x32_bf16 v[152:155], a[48:51], a[224:227], v[152:155]
    v_mfma_f32_16x16x32_bf16 v[152:155], a[88:91], a[240:243], v[152:155]
    v_mfma_f32_16x16x32_bf16 v[156:159], v[60:63], a[208:211], v[156:159]
    v_cvt_pk_bf16_f32 v248, v248, v249
    v_cvt_pk_bf16_f32 v249, v250, v251
    v_mfma_f32_16x16x32_bf16 v[156:159], a[52:55], a[224:227], v[156:159]
    v_cvt_pk_bf16_f32 v250, v252, v253
    v_cvt_pk_bf16_f32 v251, v254, v255
    v_mfma_f32_16x16x32_bf16 v[156:159], a[92:95], a[240:243], v[156:159]
    ds_write_b128 v16, v[248:251] offset:39936
    v_mfma_f32_16x16x32_bf16 v[184:187], v[56:59], a[212:215], v[184:187]
    v_mfma_f32_16x16x32_bf16 v[184:187], a[48:51], a[228:231], v[184:187]
    v_mfma_f32_16x16x32_bf16 v[184:187], a[88:91], a[244:247], v[184:187]
    v_mfma_f32_16x16x32_bf16 v[188:191], v[60:63], a[212:215], v[188:191]
    v_cvt_pk_bf16_f32 v152, v152, v153
    v_cvt_pk_bf16_f32 v153, v154, v155
    v_mfma_f32_16x16x32_bf16 v[188:191], a[52:55], a[228:231], v[188:191]
    v_cvt_pk_bf16_f32 v154, v156, v157
    v_cvt_pk_bf16_f32 v155, v158, v159
    v_mfma_f32_16x16x32_bf16 v[188:191], a[92:95], a[244:247], v[188:191]
    ds_write_b128 v16, v[152:155] offset:3072
L_attn:
    v_add_u32 v15, 4096, v1
    v_cvt_pk_bf16_f32 v184, v184, v185
    v_cvt_pk_bf16_f32 v185, v186, v187
    s_nop 3
    v_cvt_pk_bf16_f32 v186, v188, v189
    v_cvt_pk_bf16_f32 v187, v190, v191
    ds_write_b128 v16, v[184:187] offset:7168
    s_waitcnt vmcnt(24) lgkmcnt(0)
    s_barrier
    ds_read_b128 a[64:67], v17 offset:0
    ds_read_b128 a[128:131], v18 offset:0
    ds_read_b128 a[68:71], v17 offset:1024
    ds_read_b128 a[132:135], v18 offset:1024
    ds_read_b128 a[72:75], v17 offset:2048
    ds_read_b128 a[136:139], v18 offset:2048
    ds_read_b128 a[76:79], v17 offset:3072
    ds_read_b128 a[140:143], v18 offset:3072
    ds_read_b128 a[144:147], v18 offset:4096
    ds_read_b128 a[148:151], v18 offset:5120
    ds_read_b128 a[152:155], v18 offset:6144
    ds_read_b128 a[156:159], v18 offset:7168
    ds_read_b128 a[80:83], v17 offset:4096
    ds_read_b128 a[84:87], v17 offset:5120
    ds_read_b128 a[88:91], v17 offset:6144
    ds_read_b128 a[92:95], v17 offset:7168
    s_waitcnt lgkmcnt(14)
    v_mfma_f32_16x16x32_bf16 v[96:99], a[128:131], a[64:67], v[96:99]
    s_waitcnt lgkmcnt(12)
    s_add_u32 s19, s82, 32768
    s_sub_u32 s82, s12, s13
    ds_read_b128 a[96:99], v17 offset:8192
    v_mfma_f32_16x16x32_bf16 v[96:99], a[132:135], a[68:71], v[96:99]
    s_waitcnt lgkmcnt(11)
    s_sub_u32 s82, s82, 1
    s_cmp_gt_u32 s12, s13
    s_cselect_b32 s82, s82, s12
    ds_read_b128 a[100:103], v17 offset:9216
    v_mfma_f32_16x16x32_bf16 v[96:99], a[136:139], a[72:75], v[96:99]
    s_waitcnt lgkmcnt(10)
    s_mul_i32 s82, s82, 65536
    s_add_u32 s82, s82, s81
    ds_read_b128 a[104:107], v17 offset:10240
    v_mfma_f32_16x16x32_bf16 v[96:99], a[140:143], a[76:79], v[96:99]
    s_waitcnt lgkmcnt(10)
    s_cmp_ge_u32 s12, 17
    s_cselect_b32 s82, 2147471360, s82
    s_add_u32 s12, s12, 1
    ds_read_b128 a[108:111], v17 offset:11264
    v_mfma_f32_16x16x32_bf16 v[100:103], a[144:147], a[64:67], v[100:103]
    s_waitcnt lgkmcnt(10)
    s_sub_u32 s14, s60, 1
    ds_read_b128 a[112:115], v17 offset:12288
    v_mfma_f32_16x16x32_bf16 v[100:103], a[148:151], a[68:71], v[100:103]
    s_waitcnt lgkmcnt(10)
    ds_read_b128 a[116:119], v17 offset:13312
    v_mfma_f32_16x16x32_bf16 v[100:103], a[152:155], a[72:75], v[100:103]
    s_waitcnt lgkmcnt(10)
    ds_read_b128 a[120:123], v17 offset:14336
    v_mfma_f32_16x16x32_bf16 v[100:103], a[156:159], a[76:79], v[100:103]
    s_waitcnt lgkmcnt(10)
    ds_read_b128 a[124:127], v17 offset:15360
    v_mfma_f32_16x16x32_bf16 v[104:107], a[128:131], a[80:83], v[104:107]
    s_waitcnt lgkmcnt(10)
    ds_read_b128 a[192:195], v17 offset:32768
    v_exp_f32 v96, v96
    v_mfma_f32_16x16x32_bf16 v[104:107], a[132:135], a[84:87], v[104:107]
    s_waitcnt lgkmcnt(10)
    ds_read_b128 a[196:199], v17 offset:33792
    v_exp_f32 v97, v97
    v_mfma_f32_16x16x32_bf16 v[104:107], a[136:139], a[88:91], v[104:107]
    s_waitcnt lgkmcnt(10)
    ds_read_b128 a[200:203], v17 offset:34816
    v_exp_f32 v98, v98
    v_mfma_f32_16x16x32_bf16 v[104:107], a[140:143], a[92:95], v[104:107]
    ds_read_b128 a[204:207], v17 offset:35840
    v_exp_f32 v99, v99
    v_mfma_f32_16x16x32_bf16 v[108:111], a[144:147], a[80:83], v[108:111]
    ds_read_b128 a[208:211], v17 offset:36864
    v_exp_f32 v100, v100
    v_mfma_f32_16x16x32_bf16 v[108:111], a[148:151], a[84:87], v[108:111]
    ds_read_b128 a[212:215], v17 offset:37888
    v_exp_f32 v101, v101
    v_mfma_f32_16x16x32_bf16 v[108:111], a[152:155], a[88:91], v[108:111]
    ds_read_b128 a[216:219], v17 offset:38912
    v_exp_f32 v102, v102
    v_mfma_f32_16x16x32_bf16 v[108:111], a[156:159], a[92:95], v[108:111]
    s_waitcnt lgkmcnt(14)
    ds_read_b128 a[220:223], v17 offset:39936
    v_exp_f32 v103, v103
    v_mfma_f32_16x16x32_bf16 v[112:115], a[128:131], a[96:99], v[72:75]
    s_waitcnt lgkmcnt(14)
    ds_read_b128 a[224:227], v17 offset:40960
    v_exp_f32 v104, v104
    v_mfma_f32_16x16x32_bf16 v[112:115], a[132:135], a[100:103], v[112:115]
    s_waitcnt lgkmcnt(14)
    ds_read_b128 a[228:231], v17 offset:41984
    v_exp_f32 v105, v105
    v_mfma_f32_16x16x32_bf16 v[112:115], a[136:139], a[104:107], v[112:115]
    s_waitcnt lgkmcnt(14)
    ds_read_b128 a[232:235], v17 offset:43008
    v_exp_f32 v106, v106
    v_mfma_f32_16x16x32_bf16 v[112:115], a[140:143], a[108:111], v[112:115]
    s_waitcnt lgkmcnt(14)
    ds_read_b128 a[236:239], v17 offset:44032
    v_exp_f32 v107, v107
    v_mfma_f32_16x16x32_bf16 v[120:123], a[128:131], a[112:115], v[76:79]
    s_waitcnt lgkmcnt(14)
    ds_read_b128 a[240:243], v17 offset:45056
    v_exp_f32 v108, v108
    v_mfma_f32_16x16x32_bf16 v[120:123], a[132:135], a[116:119], v[120:123]
    s_waitcnt lgkmcnt(14)
    ds_read_b128 a[244:247], v17 offset:46080
    v_exp_f32 v109, v109
    v_mfma_f32_16x16x32_bf16 v[120:123], a[136:139], a[120:123], v[120:123]
    s_waitcnt lgkmcnt(14)
    ds_read_b128 a[248:251], v17 offset:47104
    v_exp_f32 v110, v110
    v_mfma_f32_16x16x32_bf16 v[120:123], a[140:143], a[124:127], v[120:123]
    ds_read_b128 a[252:255], v17 offset:48128
    v_exp_f32 v111, v111
    v_mfma_f32_16x16x32_bf16 v[116:119], a[144:147], a[96:99], v[72:75]
    ds_read_b128 a[128:131], v18 offset:16384
    v_cvt_pk_bf16_f32 v48, v96, v97
    v_mfma_f32_16x16x32_bf16 v[116:119], a[148:151], a[100:103], v[116:119]
    ds_read_b128 a[132:135], v18 offset:17408
    v_cvt_pk_bf16_f32 v49, v98, v99
    v_mfma_f32_16x16x32_bf16 v[116:119], a[152:155], a[104:107], v[116:119]
    ds_read_b128 a[136:139], v18 offset:18432
    v_cvt_pk_bf16_f32 v50, v100, v101
    v_mfma_f32_16x16x32_bf16 v[116:119], a[156:159], a[108:111], v[116:119]
    ds_read_b128 a[140:143], v18 offset:19456
    v_cvt_pk_bf16_f32 v51, v102, v103
    v_mfma_f32_16x16x32_bf16 v[124:127], a[144:147], a[112:115], v[76:79]
    ds_read_b128 a[144:147], v18 offset:20480
    v_cvt_pk_bf16_f32 v52, v104, v105
    v_mfma_f32_16x16x32_bf16 v[124:127], a[148:151], a[116:119], v[124:127]
    ds_read_b128 a[148:151], v18 offset:21504
    v_cvt_pk_bf16_f32 v53, v106, v107
    v_mfma_f32_16x16x32_bf16 v[124:127], a[152:155], a[120:123], v[124:127]
    ds_read_b128 a[152:155], v18 offset:22528
    v_cvt_pk_bf16_f32 v54, v108, v109
    v_mfma_f32_16x16x32_bf16 v[124:127], a[156:159], a[124:127], v[124:127]
    ds_read_b128 a[156:159], v18 offset:23552
    v_cvt_pk_bf16_f32 v55, v110, v111
    v_xor_b32 v18, 196608, v18
    v_lshrrev_b32 v17, 4, v2
    v_lshlrev_b32 v17, 15, v17
    v_and_b32 v14, 255, v1
    v_add_u32 v17, v17, v14
L_t1_p1:
    s_waitcnt vmcnt(8) lgkmcnt(0)
    s_barrier
    s_cmp_eq_u32 s60, 0
    s_cbranch_scc1 L_t1_zero
    v_mfma_f32_16x16x32_bf16 v[96:99], a[128:131], a[64:67], v[64:67]
    s_add_u32 m0, s15, 0
    ds_read_b128 a[160:163], v19 offset:0
    v_mfma_f32_16x16x32_bf16 v[96:99], a[132:135], a[68:71], v[96:99]
    ds_read_b128 a[164:167], v19 offset:1024
    v_mfma_f32_16x16x32_bf16 v[96:99], a[136:139], a[72:75], v[96:99]
    v_exp_f32 v112, v112
    v_mfma_f32_16x16x32_bf16 v[96:99], a[140:143], a[76:79], v[96:99]
    buffer_load_dwordx4 v1, s[8:11], s82 offen offset:0  lds
    v_mfma_f32_16x16x32_bf16 v[104:107], a[128:131], a[80:83], v[68:71]
    v_exp_f32 v113, v113
    v_mfma_f32_16x16x32_bf16 v[104:107], a[132:135], a[84:87], v[104:107]
    ds_read_b128 a[168:171], v19 offset:2048
    v_cvt_pk_bf16_f32 v56, v112, v113
    v_mfma_f32_16x16x32_bf16 v[104:107], a[136:139], a[88:91], v[104:107]
    v_exp_f32 v114, v114
    v_mfma_f32_16x16x32_bf16 v[104:107], a[140:143], a[92:95], v[104:107]
    buffer_load_dwordx4 v1, s[8:11], s82 offen offset:1024  lds
    v_mfma_f32_16x16x32_bf16 v[100:103], a[144:147], a[64:67], v[64:67]
    v_exp_f32 v115, v115
    v_mfma_f32_16x16x32_bf16 v[100:103], a[148:151], a[68:71], v[100:103]
    ds_read_b128 a[172:175], v19 offset:3072
    v_cvt_pk_bf16_f32 v57, v114, v115
    v_mfma_f32_16x16x32_bf16 v[100:103], a[152:155], a[72:75], v[100:103]
    v_exp_f32 v116, v116
    v_mfma_f32_16x16x32_bf16 v[100:103], a[156:159], a[76:79], v[100:103]
    buffer_load_dwordx4 v1, s[8:11], s82 offen offset:2048  lds
    v_mfma_f32_16x16x32_bf16 v[108:111], a[144:147], a[80:83], v[68:71]
    v_exp_f32 v117, v117
    v_mfma_f32_16x16x32_bf16 v[108:111], a[148:151], a[84:87], v[108:111]
    ds_read_b128 a[176:179], v20 offset:4096
    v_cvt_pk_bf16_f32 v58, v116, v117
    v_mfma_f32_16x16x32_bf16 v[108:111], a[152:155], a[88:91], v[108:111]
    v_exp_f32 v118, v118
    v_mfma_f32_16x16x32_bf16 v[108:111], a[156:159], a[92:95], v[108:111]
    buffer_load_dwordx4 v1, s[8:11], s82 offen offset:3072  lds
    v_mfma_f32_16x16x32_bf16 v[32:35], v[28:31], v[48:51], 0
    s_add_u32 m0, s15, 4096
    v_exp_f32 v119, v119
    v_mfma_f32_16x16x32_bf16 v[36:39], v[28:31], v[52:55], 0
    s_waitcnt lgkmcnt(4)
    ds_read_b128 a[180:183], v20 offset:5120
    v_cvt_pk_bf16_f32 v59, v118, v119
    v_mfma_f32_16x16x32_bf16 v[128:131], a[160:163], v[48:51], 0
    s_waitcnt lgkmcnt(4)
    v_exp_f32 v120, v120
    v_mfma_f32_16x16x32_bf16 v[160:163], a[160:163], v[52:55], 0
    buffer_load_dwordx4 v15, s[8:11], s82 offen offset:0  lds
    v_mfma_f32_16x16x32_bf16 v[132:135], a[164:167], v[48:51], 0
    v_exp_f32 v121, v121
    v_mfma_f32_16x16x32_bf16 v[164:167], a[164:167], v[52:55], 0
    s_waitcnt lgkmcnt(3)
    ds_read_b128 a[184:187], v20 offset:6144
    v_cvt_pk_bf16_f32 v60, v120, v121
    v_mfma_f32_16x16x32_bf16 v[136:139], a[168:171], v[48:51], 0
    s_waitcnt lgkmcnt(3)
    v_exp_f32 v122, v122
    v_mfma_f32_16x16x32_bf16 v[168:171], a[168:171], v[52:55], 0
    buffer_load_dwordx4 v15, s[8:11], s82 offen offset:1024  lds
    v_mfma_f32_16x16x32_bf16 v[140:143], a[172:175], v[48:51], 0
    v_exp_f32 v123, v123
    v_mfma_f32_16x16x32_bf16 v[172:175], a[172:175], v[52:55], 0
    s_waitcnt lgkmcnt(2)
    ds_read_b128 a[188:191], v20 offset:7168
    v_cvt_pk_bf16_f32 v61, v122, v123
    v_mfma_f32_16x16x32_bf16 v[144:147], a[176:179], v[48:51], 0
    s_waitcnt lgkmcnt(2)
    v_exp_f32 v124, v124
    v_mfma_f32_16x16x32_bf16 v[176:179], a[176:179], v[52:55], 0
    buffer_load_dwordx4 v15, s[8:11], s82 offen offset:2048  lds
    v_mfma_f32_16x16x32_bf16 v[148:151], a[180:183], v[48:51], 0
    v_exp_f32 v125, v125
    v_mfma_f32_16x16x32_bf16 v[180:183], a[180:183], v[52:55], 0
    s_waitcnt lgkmcnt(1)
    v_cvt_pk_bf16_f32 v62, v124, v125
    v_mfma_f32_16x16x32_bf16 v[152:155], a[184:187], v[48:51], 0
    s_waitcnt lgkmcnt(0)
    v_exp_f32 v126, v126
    v_mfma_f32_16x16x32_bf16 v[184:187], a[184:187], v[52:55], 0
    buffer_load_dwordx4 v15, s[8:11], s82 offen offset:3072  lds
    v_mfma_f32_16x16x32_bf16 v[156:159], a[188:191], v[48:51], 0
    s_xor_b32 s15, s15, 196608
    v_exp_f32 v127, v127
    v_mfma_f32_16x16x32_bf16 v[188:191], a[188:191], v[52:55], 0
    s_add_u32 m0, s16, 0
    v_cvt_pk_bf16_f32 v63, v126, v127
    v_mfma_f32_16x16x32_bf16 v[112:115], a[128:131], a[96:99], v[72:75]
    v_mfma_f32_16x16x32_bf16 v[112:115], a[132:135], a[100:103], v[112:115]
    v_mfma_f32_16x16x32_bf16 v[112:115], a[136:139], a[104:107], v[112:115]
    v_exp_f32 v96, v96
    v_mfma_f32_16x16x32_bf16 v[112:115], a[140:143], a[108:111], v[112:115]
    buffer_load_dwordx4 v1, s[8:11], s19 offen offset:0  lds
    v_mfma_f32_16x16x32_bf16 v[120:123], a[128:131], a[112:115], v[76:79]
    v_exp_f32 v97, v97
    v_mfma_f32_16x16x32_bf16 v[120:123], a[132:135], a[116:119], v[120:123]
    ds_read_b128 a[128:131], v18 offset:0
    v_cvt_pk_bf16_f32 v48, v96, v97
    v_mfma_f32_16x16x32_bf16 v[120:123], a[136:139], a[120:123], v[120:123]
    v_exp_f32 v98, v98
    v_mfma_f32_16x16x32_bf16 v[120:123], a[140:143], a[124:127], v[120:123]
    buffer_load_dwordx4 v1, s[8:11], s19 offen offset:1024  lds
    v_mfma_f32_16x16x32_bf16 v[116:119], a[144:147], a[96:99], v[72:75]
    v_exp_f32 v99, v99
    v_mfma_f32_16x16x32_bf16 v[116:119], a[148:151], a[100:103], v[116:119]
    ds_read_b128 a[132:135], v18 offset:1024
    v_cvt_pk_bf16_f32 v49, v98, v99
    v_mfma_f32_16x16x32_bf16 v[116:119], a[152:155], a[104:107], v[116:119]
    v_exp_f32 v100, v100
    v_mfma_f32_16x16x32_bf16 v[116:119], a[156:159], a[108:111], v[116:119]
    buffer_load_dwordx4 v1, s[8:11], s19 offen offset:2048  lds
    v_mfma_f32_16x16x32_bf16 v[124:127], a[144:147], a[112:115], v[76:79]
    v_exp_f32 v101, v101
    v_mfma_f32_16x16x32_bf16 v[124:127], a[148:151], a[116:119], v[124:127]
    ds_read_b128 a[136:139], v18 offset:2048
    v_cvt_pk_bf16_f32 v50, v100, v101
    v_mfma_f32_16x16x32_bf16 v[124:127], a[152:155], a[120:123], v[124:127]
    v_exp_f32 v102, v102
    v_mfma_f32_16x16x32_bf16 v[124:127], a[156:159], a[124:127], v[124:127]
    buffer_load_dwordx4 v1, s[8:11], s19 offen offset:3072  lds
    v_mfma_f32_16x16x32_bf16 v[40:43], v[28:31], v[56:59], 0
    s_add_u32 m0, s16, 4096
    v_exp_f32 v103, v103
    v_mfma_f32_16x16x32_bf16 v[44:47], v[28:31], v[60:63], 0
    ds_read_b128 a[140:143], v18 offset:3072
    v_cvt_pk_bf16_f32 v51, v102, v103
    v_mfma_f32_16x16x32_bf16 v[192:195], a[160:163], v[56:59], 0
    v_exp_f32 v104, v104
    v_mfma_f32_16x16x32_bf16 v[224:227], a[160:163], v[60:63], 0
    buffer_load_dwordx4 v15, s[8:11], s19 offen offset:0  lds
    v_mfma_f32_16x16x32_bf16 v[196:199], a[164:167], v[56:59], 0
    v_exp_f32 v105, v105
    v_mfma_f32_16x16x32_bf16 v[228:231], a[164:167], v[60:63], 0
    ds_read_b128 a[144:147], v18 offset:4096
    v_cvt_pk_bf16_f32 v52, v104, v105
    v_mfma_f32_16x16x32_bf16 v[200:203], a[168:171], v[56:59], 0
    v_exp_f32 v106, v106
    v_mfma_f32_16x16x32_bf16 v[232:235], a[168:171], v[60:63], 0
    buffer_load_dwordx4 v15, s[8:11], s19 offen offset:1024  lds
    v_mfma_f32_16x16x32_bf16 v[204:207], a[172:175], v[56:59], 0
    v_exp_f32 v107, v107
    v_mfma_f32_16x16x32_bf16 v[236:239], a[172:175], v[60:63], 0
    ds_read_b128 a[148:151], v18 offset:5120
    v_cvt_pk_bf16_f32 v53, v106, v107
    v_mfma_f32_16x16x32_bf16 v[208:211], a[176:179], v[56:59], 0
    v_exp_f32 v108, v108
    v_mfma_f32_16x16x32_bf16 v[240:243], a[176:179], v[60:63], 0
    buffer_load_dwordx4 v15, s[8:11], s19 offen offset:2048  lds
    v_mfma_f32_16x16x32_bf16 v[212:215], a[180:183], v[56:59], 0
    v_exp_f32 v109, v109
    v_mfma_f32_16x16x32_bf16 v[244:247], a[180:183], v[60:63], 0
    ds_read_b128 a[152:155], v18 offset:6144
    v_cvt_pk_bf16_f32 v54, v108, v109
    v_mfma_f32_16x16x32_bf16 v[216:219], a[184:187], v[56:59], 0
    v_exp_f32 v110, v110
    v_mfma_f32_16x16x32_bf16 v[248:251], a[184:187], v[60:63], 0
    buffer_load_dwordx4 v15, s[8:11], s19 offen offset:3072  lds
    v_mfma_f32_16x16x32_bf16 v[220:223], a[188:191], v[56:59], 0
    s_xor_b32 s16, s16, 98304
    v_exp_f32 v111, v111
    v_mfma_f32_16x16x32_bf16 v[252:255], a[188:191], v[60:63], 0
    ds_read_b128 a[156:159], v18 offset:7168
    v_cvt_pk_bf16_f32 v55, v110, v111
    s_cmp_eq_u32 s14, 0
    s_cbranch_scc1 L_t1_diag
.p2align 3
L_t1_loop:
    s_waitcnt lgkmcnt(7)
    v_mfma_f32_16x16x32_bf16 v[96:99], a[128:131], a[64:67], v[64:67]
    s_waitcnt lgkmcnt(6)
    ds_read_b128 a[160:163], v19 offset:16384
    v_mfma_f32_16x16x32_bf16 v[96:99], a[132:135], a[68:71], v[96:99]
    s_waitcnt lgkmcnt(6)
    ds_read_b128 a[164:167], v19 offset:17408
    v_mfma_f32_16x16x32_bf16 v[96:99], a[136:139], a[72:75], v[96:99]
    s_waitcnt lgkmcnt(6)
    v_exp_f32 v112, v112
    v_mfma_f32_16x16x32_bf16 v[96:99], a[140:143], a[76:79], v[96:99]
    v_mfma_f32_16x16x32_bf16 v[104:107], a[128:131], a[80:83], v[68:71]
    v_exp_f32 v113, v113
    v_mfma_f32_16x16x32_bf16 v[104:107], a[132:135], a[84:87], v[104:107]
    ds_read_b128 a[168:171], v19 offset:18432
    v_cvt_pk_bf16_f32 v56, v112, v113
    v_mfma_f32_16x16x32_bf16 v[104:107], a[136:139], a[88:91], v[104:107]
    v_exp_f32 v114, v114
    v_mfma_f32_16x16x32_bf16 v[104:107], a[140:143], a[92:95], v[104:107]
    s_waitcnt lgkmcnt(6)
    v_mfma_f32_16x16x32_bf16 v[100:103], a[144:147], a[64:67], v[64:67]
    s_waitcnt lgkmcnt(5)
    v_exp_f32 v115, v115
    v_mfma_f32_16x16x32_bf16 v[100:103], a[148:151], a[68:71], v[100:103]
    s_waitcnt lgkmcnt(4)
    ds_read_b128 a[172:175], v19 offset:19456
    v_cvt_pk_bf16_f32 v57, v114, v115
    v_mfma_f32_16x16x32_bf16 v[100:103], a[152:155], a[72:75], v[100:103]
    s_waitcnt lgkmcnt(4)
    v_exp_f32 v116, v116
    v_mfma_f32_16x16x32_bf16 v[100:103], a[156:159], a[76:79], v[100:103]
    v_mfma_f32_16x16x32_bf16 v[108:111], a[144:147], a[80:83], v[68:71]
    v_exp_f32 v117, v117
    v_mfma_f32_16x16x32_bf16 v[108:111], a[148:151], a[84:87], v[108:111]
    ds_read_b128 a[176:179], v20 offset:20480
    v_cvt_pk_bf16_f32 v58, v116, v117
    v_mfma_f32_16x16x32_bf16 v[108:111], a[152:155], a[88:91], v[108:111]
    v_exp_f32 v118, v118
    v_mfma_f32_16x16x32_bf16 v[108:111], a[156:159], a[92:95], v[108:111]
    v_mfma_f32_16x16x32_bf16 v[32:35], v[28:31], v[48:51], v[32:35]
    v_exp_f32 v119, v119
    v_mfma_f32_16x16x32_bf16 v[36:39], v[28:31], v[52:55], v[36:39]
    s_waitcnt lgkmcnt(4)
    ds_read_b128 a[180:183], v20 offset:21504
    v_cvt_pk_bf16_f32 v59, v118, v119
    v_mfma_f32_16x16x32_bf16 v[128:131], a[160:163], v[48:51], v[128:131]
    v_exp_f32 v120, v120
    v_mfma_f32_16x16x32_bf16 v[160:163], a[160:163], v[52:55], v[160:163]
    s_waitcnt lgkmcnt(4)
    v_mfma_f32_16x16x32_bf16 v[132:135], a[164:167], v[48:51], v[132:135]
    v_exp_f32 v121, v121
    v_mfma_f32_16x16x32_bf16 v[164:167], a[164:167], v[52:55], v[164:167]
    s_waitcnt lgkmcnt(3)
    ds_read_b128 a[184:187], v20 offset:22528
    v_cvt_pk_bf16_f32 v60, v120, v121
    v_mfma_f32_16x16x32_bf16 v[136:139], a[168:171], v[48:51], v[136:139]
    v_exp_f32 v122, v122
    v_mfma_f32_16x16x32_bf16 v[168:171], a[168:171], v[52:55], v[168:171]
    s_waitcnt lgkmcnt(3)
    v_mfma_f32_16x16x32_bf16 v[140:143], a[172:175], v[48:51], v[140:143]
    v_exp_f32 v123, v123
    v_mfma_f32_16x16x32_bf16 v[172:175], a[172:175], v[52:55], v[172:175]
    s_waitcnt lgkmcnt(2)
    ds_read_b128 a[188:191], v20 offset:23552
    v_cvt_pk_bf16_f32 v61, v122, v123
    v_mfma_f32_16x16x32_bf16 v[144:147], a[176:179], v[48:51], v[144:147]
    v_exp_f32 v124, v124
    v_mfma_f32_16x16x32_bf16 v[176:179], a[176:179], v[52:55], v[176:179]
    s_waitcnt lgkmcnt(2)
    v_mfma_f32_16x16x32_bf16 v[148:151], a[180:183], v[48:51], v[148:151]
    v_exp_f32 v125, v125
    v_mfma_f32_16x16x32_bf16 v[180:183], a[180:183], v[52:55], v[180:183]
    s_waitcnt lgkmcnt(1)
    v_cvt_pk_bf16_f32 v62, v124, v125
    v_xor_b32 v19, 98304, v19
    v_mfma_f32_16x16x32_bf16 v[152:155], a[184:187], v[48:51], v[152:155]
    v_exp_f32 v126, v126
    v_mfma_f32_16x16x32_bf16 v[184:187], a[184:187], v[52:55], v[184:187]
    s_waitcnt lgkmcnt(0)
    v_xor_b32 v20, 98304, v20
    v_mfma_f32_16x16x32_bf16 v[156:159], a[188:191], v[48:51], v[156:159]
    v_exp_f32 v127, v127
    v_mfma_f32_16x16x32_bf16 v[188:191], a[188:191], v[52:55], v[188:191]
    v_cvt_pk_bf16_f32 v63, v126, v127
    v_mfma_f32_16x16x32_bf16 v[112:115], a[128:131], a[96:99], v[72:75]
    v_exp_f32 v96, v96
    v_mfma_f32_16x16x32_bf16 v[112:115], a[132:135], a[100:103], v[112:115]
    v_mfma_f32_16x16x32_bf16 v[112:115], a[136:139], a[104:107], v[112:115]
    v_exp_f32 v97, v97
    v_mfma_f32_16x16x32_bf16 v[112:115], a[140:143], a[108:111], v[112:115]
    v_cvt_pk_bf16_f32 v48, v96, v97
    v_mfma_f32_16x16x32_bf16 v[120:123], a[128:131], a[112:115], v[76:79]
    v_exp_f32 v98, v98
    v_mfma_f32_16x16x32_bf16 v[120:123], a[132:135], a[116:119], v[120:123]
    v_mfma_f32_16x16x32_bf16 v[120:123], a[136:139], a[120:123], v[120:123]
    v_exp_f32 v99, v99
    v_mfma_f32_16x16x32_bf16 v[120:123], a[140:143], a[124:127], v[120:123]
    v_mfma_f32_16x16x32_bf16 v[116:119], a[144:147], a[96:99], v[72:75]
    v_exp_f32 v100, v100
    v_mfma_f32_16x16x32_bf16 v[116:119], a[148:151], a[100:103], v[116:119]
    ds_read_b128 a[128:131], v18 offset:16384
    v_cvt_pk_bf16_f32 v49, v98, v99
    v_mfma_f32_16x16x32_bf16 v[116:119], a[152:155], a[104:107], v[116:119]
    s_add_u32 s19, s82, 32768
    v_exp_f32 v101, v101
    v_mfma_f32_16x16x32_bf16 v[116:119], a[156:159], a[108:111], v[116:119]
    s_sub_u32 s82, s12, s13
    ds_read_b128 a[132:135], v18 offset:17408
    v_cvt_pk_bf16_f32 v50, v100, v101
    v_mfma_f32_16x16x32_bf16 v[124:127], a[144:147], a[112:115], v[76:79]
    s_sub_u32 s82, s82, 1
    v_exp_f32 v102, v102
    v_mfma_f32_16x16x32_bf16 v[124:127], a[148:151], a[116:119], v[124:127]
    s_cmp_gt_u32 s12, s13
    s_cselect_b32 s82, s82, s12
    s_mul_i32 s82, s82, 65536
    ds_read_b128 a[136:139], v18 offset:18432
    v_mfma_f32_16x16x32_bf16 v[124:127], a[152:155], a[120:123], v[124:127]
    s_add_u32 s82, s82, s81
    v_exp_f32 v103, v103
    v_mfma_f32_16x16x32_bf16 v[124:127], a[156:159], a[124:127], v[124:127]
    s_cmp_ge_u32 s12, 17
    s_cselect_b32 s82, 2147471360, s82
    ds_read_b128 a[140:143], v18 offset:19456
    v_cvt_pk_bf16_f32 v51, v102, v103
    v_mfma_f32_16x16x32_bf16 v[40:43], v[28:31], v[56:59], v[40:43]
    s_add_u32 s12, s12, 1
    v_exp_f32 v104, v104
    v_mfma_f32_16x16x32_bf16 v[44:47], v[28:31], v[60:63], v[44:47]
    ds_read_b128 a[144:147], v18 offset:20480
    v_mfma_f32_16x16x32_bf16 v[192:195], a[160:163], v[56:59], v[192:195]
    v_exp_f32 v105, v105
    v_mfma_f32_16x16x32_bf16 v[224:227], a[160:163], v[60:63], v[224:227]
    ds_read_b128 a[148:151], v18 offset:21504
    v_cvt_pk_bf16_f32 v52, v104, v105
    v_mfma_f32_16x16x32_bf16 v[196:199], a[164:167], v[56:59], v[196:199]
    v_exp_f32 v106, v106
    v_mfma_f32_16x16x32_bf16 v[228:231], a[164:167], v[60:63], v[228:231]
    ds_read_b128 a[152:155], v18 offset:22528
    v_mfma_f32_16x16x32_bf16 v[200:203], a[168:171], v[56:59], v[200:203]
    v_exp_f32 v107, v107
    v_mfma_f32_16x16x32_bf16 v[232:235], a[168:171], v[60:63], v[232:235]
    ds_read_b128 a[156:159], v18 offset:23552
    v_cvt_pk_bf16_f32 v53, v106, v107
    v_mfma_f32_16x16x32_bf16 v[204:207], a[172:175], v[56:59], v[204:207]
    v_exp_f32 v108, v108
    v_mfma_f32_16x16x32_bf16 v[236:239], a[172:175], v[60:63], v[236:239]
    v_mfma_f32_16x16x32_bf16 v[208:211], a[176:179], v[56:59], v[208:211]
    v_exp_f32 v109, v109
    v_mfma_f32_16x16x32_bf16 v[240:243], a[176:179], v[60:63], v[240:243]
    v_cvt_pk_bf16_f32 v54, v108, v109
    v_xor_b32 v18, 196608, v18
    v_mfma_f32_16x16x32_bf16 v[212:215], a[180:183], v[56:59], v[212:215]
    v_exp_f32 v110, v110
    v_mfma_f32_16x16x32_bf16 v[244:247], a[180:183], v[60:63], v[244:247]
    v_mfma_f32_16x16x32_bf16 v[216:219], a[184:187], v[56:59], v[216:219]
    v_exp_f32 v111, v111
    v_mfma_f32_16x16x32_bf16 v[248:251], a[184:187], v[60:63], v[248:251]
    v_cvt_pk_bf16_f32 v55, v110, v111
    v_mfma_f32_16x16x32_bf16 v[220:223], a[188:191], v[56:59], v[220:223]
    v_mfma_f32_16x16x32_bf16 v[252:255], a[188:191], v[60:63], v[252:255]
    s_waitcnt vmcnt(0) lgkmcnt(0)
    s_barrier
    v_mfma_f32_16x16x32_bf16 v[96:99], a[128:131], a[64:67], v[64:67]
    s_add_u32 m0, s15, 0
    ds_read_b128 a[160:163], v19 offset:0
    v_mfma_f32_16x16x32_bf16 v[96:99], a[132:135], a[68:71], v[96:99]
    ds_read_b128 a[164:167], v19 offset:1024
    v_mfma_f32_16x16x32_bf16 v[96:99], a[136:139], a[72:75], v[96:99]
    v_exp_f32 v112, v112
    v_mfma_f32_16x16x32_bf16 v[96:99], a[140:143], a[76:79], v[96:99]
    buffer_load_dwordx4 v1, s[8:11], s82 offen offset:0  lds
    v_mfma_f32_16x16x32_bf16 v[104:107], a[128:131], a[80:83], v[68:71]
    v_exp_f32 v113, v113
    v_mfma_f32_16x16x32_bf16 v[104:107], a[132:135], a[84:87], v[104:107]
    ds_read_b128 a[168:171], v19 offset:2048
    v_cvt_pk_bf16_f32 v56, v112, v113
    v_mfma_f32_16x16x32_bf16 v[104:107], a[136:139], a[88:91], v[104:107]
    v_exp_f32 v114, v114
    v_mfma_f32_16x16x32_bf16 v[104:107], a[140:143], a[92:95], v[104:107]
    buffer_load_dwordx4 v1, s[8:11], s82 offen offset:1024  lds
    v_mfma_f32_16x16x32_bf16 v[100:103], a[144:147], a[64:67], v[64:67]
    v_exp_f32 v115, v115
    v_mfma_f32_16x16x32_bf16 v[100:103], a[148:151], a[68:71], v[100:103]
    ds_read_b128 a[172:175], v19 offset:3072
    v_cvt_pk_bf16_f32 v57, v114, v115
    v_mfma_f32_16x16x32_bf16 v[100:103], a[152:155], a[72:75], v[100:103]
    v_exp_f32 v116, v116
    v_mfma_f32_16x16x32_bf16 v[100:103], a[156:159], a[76:79], v[100:103]
    buffer_load_dwordx4 v1, s[8:11], s82 offen offset:2048  lds
    v_mfma_f32_16x16x32_bf16 v[108:111], a[144:147], a[80:83], v[68:71]
    v_exp_f32 v117, v117
    v_mfma_f32_16x16x32_bf16 v[108:111], a[148:151], a[84:87], v[108:111]
    ds_read_b128 a[176:179], v20 offset:4096
    v_cvt_pk_bf16_f32 v58, v116, v117
    v_mfma_f32_16x16x32_bf16 v[108:111], a[152:155], a[88:91], v[108:111]
    v_exp_f32 v118, v118
    v_mfma_f32_16x16x32_bf16 v[108:111], a[156:159], a[92:95], v[108:111]
    buffer_load_dwordx4 v1, s[8:11], s82 offen offset:3072  lds
    v_mfma_f32_16x16x32_bf16 v[32:35], v[28:31], v[48:51], v[32:35]
    s_add_u32 m0, s15, 4096
    v_exp_f32 v119, v119
    v_mfma_f32_16x16x32_bf16 v[36:39], v[28:31], v[52:55], v[36:39]
    s_waitcnt lgkmcnt(4)
    ds_read_b128 a[180:183], v20 offset:5120
    v_cvt_pk_bf16_f32 v59, v118, v119
    v_mfma_f32_16x16x32_bf16 v[128:131], a[160:163], v[48:51], v[128:131]
    s_waitcnt lgkmcnt(4)
    v_exp_f32 v120, v120
    v_mfma_f32_16x16x32_bf16 v[160:163], a[160:163], v[52:55], v[160:163]
    buffer_load_dwordx4 v15, s[8:11], s82 offen offset:0  lds
    v_mfma_f32_16x16x32_bf16 v[132:135], a[164:167], v[48:51], v[132:135]
    v_exp_f32 v121, v121
    v_mfma_f32_16x16x32_bf16 v[164:167], a[164:167], v[52:55], v[164:167]
    s_waitcnt lgkmcnt(3)
    ds_read_b128 a[184:187], v20 offset:6144
    v_cvt_pk_bf16_f32 v60, v120, v121
    v_mfma_f32_16x16x32_bf16 v[136:139], a[168:171], v[48:51], v[136:139]
    s_waitcnt lgkmcnt(3)
    v_exp_f32 v122, v122
    v_mfma_f32_16x16x32_bf16 v[168:171], a[168:171], v[52:55], v[168:171]
    buffer_load_dwordx4 v15, s[8:11], s82 offen offset:1024  lds
    v_mfma_f32_16x16x32_bf16 v[140:143], a[172:175], v[48:51], v[140:143]
    v_exp_f32 v123, v123
    v_mfma_f32_16x16x32_bf16 v[172:175], a[172:175], v[52:55], v[172:175]
    s_waitcnt lgkmcnt(2)
    ds_read_b128 a[188:191], v20 offset:7168
    v_cvt_pk_bf16_f32 v61, v122, v123
    v_mfma_f32_16x16x32_bf16 v[144:147], a[176:179], v[48:51], v[144:147]
    s_waitcnt lgkmcnt(2)
    v_exp_f32 v124, v124
    v_mfma_f32_16x16x32_bf16 v[176:179], a[176:179], v[52:55], v[176:179]
    buffer_load_dwordx4 v15, s[8:11], s82 offen offset:2048  lds
    v_mfma_f32_16x16x32_bf16 v[148:151], a[180:183], v[48:51], v[148:151]
    v_exp_f32 v125, v125
    v_mfma_f32_16x16x32_bf16 v[180:183], a[180:183], v[52:55], v[180:183]
    s_waitcnt lgkmcnt(1)
    v_cvt_pk_bf16_f32 v62, v124, v125
    v_mfma_f32_16x16x32_bf16 v[152:155], a[184:187], v[48:51], v[152:155]
    s_waitcnt lgkmcnt(0)
    v_exp_f32 v126, v126
    v_mfma_f32_16x16x32_bf16 v[184:187], a[184:187], v[52:55], v[184:187]
    buffer_load_dwordx4 v15, s[8:11], s82 offen offset:3072  lds
    v_mfma_f32_16x16x32_bf16 v[156:159], a[188:191], v[48:51], v[156:159]
    s_xor_b32 s15, s15, 196608
    v_exp_f32 v127, v127
    v_mfma_f32_16x16x32_bf16 v[188:191], a[188:191], v[52:55], v[188:191]
    s_add_u32 m0, s16, 0
    v_cvt_pk_bf16_f32 v63, v126, v127
    v_mfma_f32_16x16x32_bf16 v[112:115], a[128:131], a[96:99], v[72:75]
    v_mfma_f32_16x16x32_bf16 v[112:115], a[132:135], a[100:103], v[112:115]
    v_mfma_f32_16x16x32_bf16 v[112:115], a[136:139], a[104:107], v[112:115]
    v_exp_f32 v96, v96
    v_mfma_f32_16x16x32_bf16 v[112:115], a[140:143], a[108:111], v[112:115]
    buffer_load_dwordx4 v1, s[8:11], s19 offen offset:0  lds
    v_mfma_f32_16x16x32_bf16 v[120:123], a[128:131], a[112:115], v[76:79]
    v_exp_f32 v97, v97
    v_mfma_f32_16x16x32_bf16 v[120:123], a[132:135], a[116:119], v[120:123]
    ds_read_b128 a[128:131], v18 offset:0
    v_cvt_pk_bf16_f32 v48, v96, v97
    v_mfma_f32_16x16x32_bf16 v[120:123], a[136:139], a[120:123], v[120:123]
    v_exp_f32 v98, v98
    v_mfma_f32_16x16x32_bf16 v[120:123], a[140:143], a[124:127], v[120:123]
    buffer_load_dwordx4 v1, s[8:11], s19 offen offset:1024  lds
    v_mfma_f32_16x16x32_bf16 v[116:119], a[144:147], a[96:99], v[72:75]
    v_exp_f32 v99, v99
    v_mfma_f32_16x16x32_bf16 v[116:119], a[148:151], a[100:103], v[116:119]
    ds_read_b128 a[132:135], v18 offset:1024
    v_cvt_pk_bf16_f32 v49, v98, v99
    v_mfma_f32_16x16x32_bf16 v[116:119], a[152:155], a[104:107], v[116:119]
    v_exp_f32 v100, v100
    v_mfma_f32_16x16x32_bf16 v[116:119], a[156:159], a[108:111], v[116:119]
    buffer_load_dwordx4 v1, s[8:11], s19 offen offset:2048  lds
    v_mfma_f32_16x16x32_bf16 v[124:127], a[144:147], a[112:115], v[76:79]
    v_exp_f32 v101, v101
    v_mfma_f32_16x16x32_bf16 v[124:127], a[148:151], a[116:119], v[124:127]
    ds_read_b128 a[136:139], v18 offset:2048
    v_cvt_pk_bf16_f32 v50, v100, v101
    v_mfma_f32_16x16x32_bf16 v[124:127], a[152:155], a[120:123], v[124:127]
    v_exp_f32 v102, v102
    v_mfma_f32_16x16x32_bf16 v[124:127], a[156:159], a[124:127], v[124:127]
    buffer_load_dwordx4 v1, s[8:11], s19 offen offset:3072  lds
    v_mfma_f32_16x16x32_bf16 v[40:43], v[28:31], v[56:59], v[40:43]
    s_add_u32 m0, s16, 4096
    v_exp_f32 v103, v103
    v_mfma_f32_16x16x32_bf16 v[44:47], v[28:31], v[60:63], v[44:47]
    ds_read_b128 a[140:143], v18 offset:3072
    v_cvt_pk_bf16_f32 v51, v102, v103
    v_mfma_f32_16x16x32_bf16 v[192:195], a[160:163], v[56:59], v[192:195]
    v_exp_f32 v104, v104
    v_mfma_f32_16x16x32_bf16 v[224:227], a[160:163], v[60:63], v[224:227]
    buffer_load_dwordx4 v15, s[8:11], s19 offen offset:0  lds
    v_mfma_f32_16x16x32_bf16 v[196:199], a[164:167], v[56:59], v[196:199]
    v_exp_f32 v105, v105
    v_mfma_f32_16x16x32_bf16 v[228:231], a[164:167], v[60:63], v[228:231]
    ds_read_b128 a[144:147], v18 offset:4096
    v_cvt_pk_bf16_f32 v52, v104, v105
    v_mfma_f32_16x16x32_bf16 v[200:203], a[168:171], v[56:59], v[200:203]
    v_exp_f32 v106, v106
    v_mfma_f32_16x16x32_bf16 v[232:235], a[168:171], v[60:63], v[232:235]
    buffer_load_dwordx4 v15, s[8:11], s19 offen offset:1024  lds
    v_mfma_f32_16x16x32_bf16 v[204:207], a[172:175], v[56:59], v[204:207]
    v_exp_f32 v107, v107
    v_mfma_f32_16x16x32_bf16 v[236:239], a[172:175], v[60:63], v[236:239]
    ds_read_b128 a[148:151], v18 offset:5120
    v_cvt_pk_bf16_f32 v53, v106, v107
    v_mfma_f32_16x16x32_bf16 v[208:211], a[176:179], v[56:59], v[208:211]
    s_sub_u32 s14, s14, 1
    v_exp_f32 v108, v108
    v_mfma_f32_16x16x32_bf16 v[240:243], a[176:179], v[60:63], v[240:243]
    buffer_load_dwordx4 v15, s[8:11], s19 offen offset:2048  lds
    v_mfma_f32_16x16x32_bf16 v[212:215], a[180:183], v[56:59], v[212:215]
    v_exp_f32 v109, v109
    v_mfma_f32_16x16x32_bf16 v[244:247], a[180:183], v[60:63], v[244:247]
    ds_read_b128 a[152:155], v18 offset:6144
    v_cvt_pk_bf16_f32 v54, v108, v109
    v_mfma_f32_16x16x32_bf16 v[216:219], a[184:187], v[56:59], v[216:219]
    v_exp_f32 v110, v110
    v_mfma_f32_16x16x32_bf16 v[248:251], a[184:187], v[60:63], v[248:251]
    buffer_load_dwordx4 v15, s[8:11], s19 offen offset:3072  lds
    v_mfma_f32_16x16x32_bf16 v[220:223], a[188:191], v[56:59], v[220:223]
    s_xor_b32 s16, s16, 98304
    v_exp_f32 v111, v111
    v_mfma_f32_16x16x32_bf16 v[252:255], a[188:191], v[60:63], v[252:255]
    ds_read_b128 a[156:159], v18 offset:7168
    v_cvt_pk_bf16_f32 v55, v110, v111
    s_cmp_lg_u32 s14, 0
    s_cbranch_scc1 L_t1_loop
L_t1_diag:
    s_waitcnt lgkmcnt(7)
    v_mfma_f32_16x16x32_bf16 v[96:99], a[128:131], a[64:67], v[80:83]
    s_waitcnt lgkmcnt(6)
    ds_read_b128 a[160:163], v19 offset:16384
    v_mfma_f32_16x16x32_bf16 v[96:99], a[132:135], a[68:71], v[96:99]
    s_waitcnt lgkmcnt(6)
    ds_read_b128 a[164:167], v19 offset:17408
    v_mfma_f32_16x16x32_bf16 v[96:99], a[136:139], a[72:75], v[96:99]
    s_waitcnt lgkmcnt(6)
    v_exp_f32 v112, v112
    v_mfma_f32_16x16x32_bf16 v[96:99], a[140:143], a[76:79], v[96:99]
    v_mfma_f32_16x16x32_bf16 v[104:107], a[128:131], a[80:83], v[88:91]
    v_exp_f32 v113, v113
    v_mfma_f32_16x16x32_bf16 v[104:107], a[132:135], a[84:87], v[104:107]
    ds_read_b128 a[168:171], v19 offset:18432
    v_cvt_pk_bf16_f32 v56, v112, v113
    v_mfma_f32_16x16x32_bf16 v[104:107], a[136:139], a[88:91], v[104:107]
    v_exp_f32 v114, v114
    v_mfma_f32_16x16x32_bf16 v[104:107], a[140:143], a[92:95], v[104:107]
    s_waitcnt lgkmcnt(6)
    v_mfma_f32_16x16x32_bf16 v[100:103], a[144:147], a[64:67], v[84:87]
    s_waitcnt lgkmcnt(5)
    v_exp_f32 v115, v115
    v_mfma_f32_16x16x32_bf16 v[100:103], a[148:151], a[68:71], v[100:103]
    s_waitcnt lgkmcnt(4)
    ds_read_b128 a[172:175], v19 offset:19456
    v_cvt_pk_bf16_f32 v57, v114, v115
    v_mfma_f32_16x16x32_bf16 v[100:103], a[152:155], a[72:75], v[100:103]
    s_waitcnt lgkmcnt(4)
    v_exp_f32 v116, v116
    v_mfma_f32_16x16x32_bf16 v[100:103], a[156:159], a[76:79], v[100:103]
    v_mfma_f32_16x16x32_bf16 v[108:111], a[144:147], a[80:83], v[92:95]
    v_exp_f32 v117, v117
    v_mfma_f32_16x16x32_bf16 v[108:111], a[148:151], a[84:87], v[108:111]
    ds_read_b128 a[176:179], v20 offset:20480
    v_cvt_pk_bf16_f32 v58, v116, v117
    v_mfma_f32_16x16x32_bf16 v[108:111], a[152:155], a[88:91], v[108:111]
    v_exp_f32 v118, v118
    v_mfma_f32_16x16x32_bf16 v[108:111], a[156:159], a[92:95], v[108:111]
    v_mfma_f32_16x16x32_bf16 v[32:35], v[28:31], v[48:51], v[32:35]
    v_exp_f32 v119, v119
    v_mfma_f32_16x16x32_bf16 v[36:39], v[28:31], v[52:55], v[36:39]
    s_waitcnt lgkmcnt(4)
    ds_read_b128 a[180:183], v20 offset:21504
    v_cvt_pk_bf16_f32 v59, v118, v119
    v_mfma_f32_16x16x32_bf16 v[128:131], a[160:163], v[48:51], v[128:131]
    v_exp_f32 v120, v120
    v_mfma_f32_16x16x32_bf16 v[160:163], a[160:163], v[52:55], v[160:163]
    s_waitcnt lgkmcnt(4)
    v_add_f32 v80, 0, v22
    v_min_f32 v80, v80, v72
    v_mfma_f32_16x16x32_bf16 v[132:135], a[164:167], v[48:51], v[132:135]
    v_exp_f32 v121, v121
    v_mfma_f32_16x16x32_bf16 v[164:167], a[164:167], v[52:55], v[164:167]
    s_waitcnt lgkmcnt(3)
    ds_read_b128 a[184:187], v20 offset:22528
    v_cvt_pk_bf16_f32 v60, v120, v121
    v_mfma_f32_16x16x32_bf16 v[136:139], a[168:171], v[48:51], v[136:139]
    v_exp_f32 v122, v122
    v_mfma_f32_16x16x32_bf16 v[168:171], a[168:171], v[52:55], v[168:171]
    s_waitcnt lgkmcnt(3)
    v_add_f32 v81, 0xf1800000, v22
    v_min_f32 v81, v81, v73
    v_mfma_f32_16x16x32_bf16 v[140:143], a[172:175], v[48:51], v[140:143]
    v_exp_f32 v123, v123
    v_mfma_f32_16x16x32_bf16 v[172:175], a[172:175], v[52:55], v[172:175]
    s_waitcnt lgkmcnt(2)
    ds_read_b128 a[188:191], v20 offset:23552
    v_cvt_pk_bf16_f32 v61, v122, v123
    v_mfma_f32_16x16x32_bf16 v[144:147], a[176:179], v[48:51], v[144:147]
    v_exp_f32 v124, v124
    v_mfma_f32_16x16x32_bf16 v[176:179], a[176:179], v[52:55], v[176:179]
    s_waitcnt lgkmcnt(2)
    v_add_f32 v82, 0xf2000000, v22
    v_min_f32 v82, v82, v74
    v_mfma_f32_16x16x32_bf16 v[148:151], a[180:183], v[48:51], v[148:151]
    v_exp_f32 v125, v125
    v_mfma_f32_16x16x32_bf16 v[180:183], a[180:183], v[52:55], v[180:183]
    s_waitcnt lgkmcnt(1)
    v_cvt_pk_bf16_f32 v62, v124, v125
    v_xor_b32 v19, 98304, v19
    v_mfma_f32_16x16x32_bf16 v[152:155], a[184:187], v[48:51], v[152:155]
    v_exp_f32 v126, v126
    v_mfma_f32_16x16x32_bf16 v[184:187], a[184:187], v[52:55], v[184:187]
    s_waitcnt lgkmcnt(0)
    v_xor_b32 v20, 98304, v20
    v_add_f32 v83, 0xf2400000, v22
    v_mfma_f32_16x16x32_bf16 v[156:159], a[188:191], v[48:51], v[156:159]
    v_exp_f32 v127, v127
    v_mfma_f32_16x16x32_bf16 v[188:191], a[188:191], v[52:55], v[188:191]
    v_cvt_pk_bf16_f32 v63, v126, v127
    v_min_f32 v83, v83, v75
    v_add_f32 v84, 0xf3800000, v22
    v_min_f32 v84, v84, v72
    v_mfma_f32_16x16x32_bf16 v[112:115], a[128:131], a[96:99], v[72:75]
    v_exp_f32 v96, v96
    v_mfma_f32_16x16x32_bf16 v[112:115], a[132:135], a[100:103], v[112:115]
    v_mfma_f32_16x16x32_bf16 v[112:115], a[136:139], a[104:107], v[112:115]
    v_exp_f32 v97, v97
    v_mfma_f32_16x16x32_bf16 v[112:115], a[140:143], a[108:111], v[112:115]
    v_cvt_pk_bf16_f32 v48, v96, v97
    v_add_f32 v85, 0xf3880000, v22
    v_mfma_f32_16x16x32_bf16 v[120:123], a[128:131], a[112:115], v[76:79]
    v_exp_f32 v98, v98
    v_mfma_f32_16x16x32_bf16 v[120:123], a[132:135], a[116:119], v[120:123]
    v_min_f32 v85, v85, v73
    v_add_f32 v86, 0xf3900000, v22
    v_mfma_f32_16x16x32_bf16 v[120:123], a[136:139], a[120:123], v[120:123]
    v_exp_f32 v99, v99
    v_mfma_f32_16x16x32_bf16 v[120:123], a[140:143], a[124:127], v[120:123]
    v_min_f32 v86, v86, v74
    v_add_f32 v87, 0xf3980000, v22
    v_mfma_f32_16x16x32_bf16 v[116:119], a[144:147], a[96:99], v[72:75]
    v_exp_f32 v100, v100
    v_mfma_f32_16x16x32_bf16 v[116:119], a[148:151], a[100:103], v[116:119]
    ds_read_b128 a[128:131], v18 offset:16384
    v_cvt_pk_bf16_f32 v49, v98, v99
    v_mfma_f32_16x16x32_bf16 v[116:119], a[152:155], a[104:107], v[116:119]
    s_add_u32 s19, s82, 32768
    v_exp_f32 v101, v101
    v_mfma_f32_16x16x32_bf16 v[116:119], a[156:159], a[108:111], v[116:119]
    s_sub_u32 s82, s12, s13
    ds_read_b128 a[132:135], v18 offset:17408
    v_cvt_pk_bf16_f32 v50, v100, v101
    v_mfma_f32_16x16x32_bf16 v[124:127], a[144:147], a[112:115], v[76:79]
    s_sub_u32 s82, s82, 1
    v_exp_f32 v102, v102
    v_mfma_f32_16x16x32_bf16 v[124:127], a[148:151], a[116:119], v[124:127]
    s_cmp_gt_u32 s12, s13
    s_cselect_b32 s82, s82, s12
    s_mul_i32 s82, s82, 65536
    ds_read_b128 a[136:139], v18 offset:18432
    v_mfma_f32_16x16x32_bf16 v[124:127], a[152:155], a[120:123], v[124:127]
    s_add_u32 s82, s82, s81
    v_exp_f32 v103, v103
    v_mfma_f32_16x16x32_bf16 v[124:127], a[156:159], a[124:127], v[124:127]
    s_cmp_ge_u32 s12, 17
    s_cselect_b32 s82, 2147471360, s82
    ds_read_b128 a[140:143], v18 offset:19456
    v_cvt_pk_bf16_f32 v51, v102, v103
    v_mfma_f32_16x16x32_bf16 v[40:43], v[28:31], v[56:59], v[40:43]
    s_add_u32 s12, s12, 1
    v_exp_f32 v104, v104
    v_mfma_f32_16x16x32_bf16 v[44:47], v[28:31], v[60:63], v[44:47]
    ds_read_b128 a[144:147], v18 offset:20480
    v_min_f32 v87, v87, v75
    v_mfma_f32_16x16x32_bf16 v[192:195], a[160:163], v[56:59], v[192:195]
    v_exp_f32 v105, v105
    v_mfma_f32_16x16x32_bf16 v[224:227], a[160:163], v[60:63], v[224:227]
    ds_read_b128 a[148:151], v18 offset:21504
    v_cvt_pk_bf16_f32 v52, v104, v105
    v_mfma_f32_16x16x32_bf16 v[196:199], a[164:167], v[56:59], v[196:199]
    v_exp_f32 v106, v106
    v_mfma_f32_16x16x32_bf16 v[228:231], a[164:167], v[60:63], v[228:231]
    ds_read_b128 a[152:155], v18 offset:22528
    v_add_f32 v88, 0x73800000, v22
    v_mfma_f32_16x16x32_bf16 v[200:203], a[168:171], v[56:59], v[200:203]
    v_exp_f32 v107, v107
    v_mfma_f32_16x16x32_bf16 v[232:235], a[168:171], v[60:63], v[232:235]
    ds_read_b128 a[156:159], v18 offset:23552
    v_cvt_pk_bf16_f32 v53, v106, v107
    v_mfma_f32_16x16x32_bf16 v[204:207], a[172:175], v[56:59], v[204:207]
    v_exp_f32 v108, v108
    v_mfma_f32_16x16x32_bf16 v[236:239], a[172:175], v[60:63], v[236:239]
    v_min_f32 v88, v88, v76
    v_add_f32 v89, 0x73700000, v22
    v_mfma_f32_16x16x32_bf16 v[208:211], a[176:179], v[56:59], v[208:211]
    v_exp_f32 v109, v109
    v_mfma_f32_16x16x32_bf16 v[240:243], a[176:179], v[60:63], v[240:243]
    v_cvt_pk_bf16_f32 v54, v108, v109
    v_xor_b32 v18, 196608, v18
    v_mfma_f32_16x16x32_bf16 v[212:215], a[180:183], v[56:59], v[212:215]
    v_exp_f32 v110, v110
    v_mfma_f32_16x16x32_bf16 v[244:247], a[180:183], v[60:63], v[244:247]
    v_min_f32 v89, v89, v77
    v_add_f32 v90, 0x73600000, v22
    v_mfma_f32_16x16x32_bf16 v[216:219], a[184:187], v[56:59], v[216:219]
    v_exp_f32 v111, v111
    v_mfma_f32_16x16x32_bf16 v[248:251], a[184:187], v[60:63], v[248:251]
    v_cvt_pk_bf16_f32 v55, v110, v111
    v_min_f32 v90, v90, v78
    v_mfma_f32_16x16x32_bf16 v[220:223], a[188:191], v[56:59], v[220:223]
    v_add_f32 v91, 0x73500000, v22
    v_min_f32 v91, v91, v79
    v_mfma_f32_16x16x32_bf16 v[252:255], a[188:191], v[60:63], v[252:255]
    v_add_f32 v92, 0, v22
    v_min_f32 v92, v92, v76
    v_add_f32 v93, 0xf1800000, v22
    v_min_f32 v93, v93, v77
    v_add_f32 v94, 0xf2000000, v22
    v_min_f32 v94, v94, v78
    v_add_f32 v95, 0xf2400000, v22
    v_min_f32 v95, v95, v79
    s_waitcnt vmcnt(0) lgkmcnt(0)
    s_barrier
    v_mfma_f32_16x16x32_bf16 v[96:99], a[128:131], a[96:99], v[80:83]
    s_xor_b32 s100, s16, 8192
    ds_read_b128 a[176:179], v20 offset:4096
    v_lshrrev_b32 v13, 1, v1
    v_mfma_f32_16x16x32_bf16 v[96:99], a[132:135], a[100:103], v[96:99]
    s_add_u32 m0, s15, 0
    ds_read_b128 a[180:183], v20 offset:5120
    v_add_u32 v12, s100, v13
    v_mfma_f32_16x16x32_bf16 v[96:99], a[136:139], a[104:107], v[96:99]
    buffer_load_dwordx4 v1, s[8:11], s82 offen offset:0  lds
    v_exp_f32 v112, v112
    v_mfma_f32_16x16x32_bf16 v[96:99], a[140:143], a[108:111], v[96:99]
    v_exp_f32 v113, v113
    v_mfma_f32_16x16x32_bf16 v[100:103], a[144:147], a[96:99], v[84:87]
    ds_read_b128 a[184:187], v20 offset:6144
    v_cvt_pk_bf16_f32 v56, v112, v113
    v_mfma_f32_16x16x32_bf16 v[100:103], a[148:151], a[100:103], v[100:103]
    v_exp_f32 v114, v114
    v_mfma_f32_16x16x32_bf16 v[100:103], a[152:155], a[104:107], v[100:103]
    buffer_load_dwordx4 v1, s[8:11], s82 offen offset:1024  lds
    v_exp_f32 v115, v115
    v_mfma_f32_16x16x32_bf16 v[100:103], a[156:159], a[108:111], v[100:103]
    ds_read_b128 a[188:191], v20 offset:7168
    v_cvt_pk_bf16_f32 v57, v114, v115
    v_mfma_f32_16x16x32_bf16 v[104:107], a[128:131], a[112:115], v[88:91]
    v_exp_f32 v116, v116
    v_mfma_f32_16x16x32_bf16 v[104:107], a[132:135], a[116:119], v[104:107]
    v_exp_f32 v117, v117
    v_mfma_f32_16x16x32_bf16 v[104:107], a[136:139], a[120:123], v[104:107]
    ds_read_b128 a[160:163], v19 offset:0
    v_cvt_pk_bf16_f32 v58, v116, v117
    v_mfma_f32_16x16x32_bf16 v[104:107], a[140:143], a[124:127], v[104:107]
    buffer_load_dwordx4 v1, s[8:11], s82 offen offset:2048  lds
    v_exp_f32 v118, v118
    v_mfma_f32_16x16x32_bf16 v[108:111], a[144:147], a[112:115], v[92:95]
    v_exp_f32 v119, v119
    v_mfma_f32_16x16x32_bf16 v[108:111], a[148:151], a[116:119], v[108:111]
    ds_read_b128 a[164:167], v19 offset:1024
    v_cvt_pk_bf16_f32 v59, v118, v119
    v_mfma_f32_16x16x32_bf16 v[108:111], a[152:155], a[120:123], v[108:111]
    v_exp_f32 v120, v120
    v_mfma_f32_16x16x32_bf16 v[108:111], a[156:159], a[124:127], v[108:111]
    buffer_load_dwordx4 v1, s[8:11], s82 offen offset:3072  lds
    v_exp_f32 v121, v121
    v_mfma_f32_16x16x32_bf16 v[32:35], v[28:31], v[48:51], v[32:35]
    s_add_u32 m0, s15, 4096
    ds_read_b128 a[168:171], v19 offset:2048
    v_cvt_pk_bf16_f32 v60, v120, v121
    v_mfma_f32_16x16x32_bf16 v[36:39], v[28:31], v[52:55], v[36:39]
    s_waitcnt lgkmcnt(6)
    v_exp_f32 v122, v122
    v_mfma_f32_16x16x32_bf16 v[144:147], a[176:179], v[48:51], v[144:147]
    v_exp_f32 v123, v123
    v_mfma_f32_16x16x32_bf16 v[176:179], a[176:179], v[52:55], v[176:179]
    s_waitcnt lgkmcnt(5)
    ds_read_b128 a[172:175], v19 offset:3072
    v_cvt_pk_bf16_f32 v61, v122, v123
    v_mfma_f32_16x16x32_bf16 v[148:151], a[180:183], v[48:51], v[148:151]
    buffer_load_dwordx4 v15, s[8:11], s82 offen offset:0  lds
    v_exp_f32 v124, v124
    v_mfma_f32_16x16x32_bf16 v[180:183], a[180:183], v[52:55], v[180:183]
    s_waitcnt lgkmcnt(5)
    v_exp_f32 v125, v125
    v_mfma_f32_16x16x32_bf16 v[152:155], a[184:187], v[48:51], v[152:155]
    s_waitcnt lgkmcnt(4)
    v_exp_f32 v126, v126
    v_mfma_f32_16x16x32_bf16 v[184:187], a[184:187], v[52:55], v[184:187]
    buffer_load_dwordx4 v15, s[8:11], s82 offen offset:1024  lds
    v_exp_f32 v127, v127
    v_mfma_f32_16x16x32_bf16 v[156:159], a[188:191], v[48:51], v[156:159]
    ds_write_b128 v16, v[144:147] offset:32768
    v_cvt_pk_bf16_f32 v62, v124, v125
    v_mfma_f32_16x16x32_bf16 v[188:191], a[188:191], v[52:55], v[188:191]
    s_waitcnt lgkmcnt(4)
    v_exp_f32 v96, v96
    v_mfma_f32_16x16x32_bf16 v[128:131], a[160:163], v[48:51], v[128:131]
    v_exp_f32 v97, v97
    v_mfma_f32_16x16x32_bf16 v[160:163], a[160:163], v[52:55], v[160:163]
    s_waitcnt lgkmcnt(3)
    ds_write_b128 v16, v[176:179] offset:33792
    v_cvt_pk_bf16_f32 v63, v126, v127
    v_mfma_f32_16x16x32_bf16 v[132:135], a[164:167], v[48:51], v[132:135]
    s_waitcnt lgkmcnt(3)
    v_exp_f32 v98, v98
    v_mfma_f32_16x16x32_bf16 v[164:167], a[164:167], v[52:55], v[164:167]
    buffer_load_dwordx4 v15, s[8:11], s82 offen offset:2048  lds
    v_exp_f32 v99, v99
    v_mfma_f32_16x16x32_bf16 v[136:139], a[168:171], v[48:51], v[136:139]
    ds_write_b128 v16, v[148:151] offset:34816
    v_mfma_f32_16x16x32_bf16 v[168:171], a[168:171], v[52:55], v[168:171]
    s_waitcnt lgkmcnt(3)
    v_exp_f32 v100, v100
    v_mfma_f32_16x16x32_bf16 v[140:143], a[172:175], v[48:51], v[140:143]
    v_exp_f32 v101, v101
    v_mfma_f32_16x16x32_bf16 v[172:175], a[172:175], v[52:55], v[172:175]
    ds_write_b128 v16, v[180:183] offset:35840
    v_mov_b32 v33, v36
    v_mfma_f32_16x16x32_bf16 v[40:43], v[28:31], v[56:59], v[40:43]
    buffer_load_dwordx4 v15, s[8:11], s82 offen offset:3072  lds
    v_exp_f32 v102, v102
    v_mfma_f32_16x16x32_bf16 v[44:47], v[28:31], v[60:63], v[44:47]
    s_xor_b32 s15, s15, 196608
    v_exp_f32 v103, v103
    v_mfma_f32_16x16x32_bf16 v[208:211], a[176:179], v[56:59], v[208:211]
    ds_write_b128 v16, v[152:155] offset:36864
    v_cvt_pk_bf16_f32 v48, v96, v97
    v_mfma_f32_16x16x32_bf16 v[240:243], a[176:179], v[60:63], v[240:243]
    ds_read_b128 a[176:179], v20 offset:20480
    v_exp_f32 v104, v104
    v_mfma_f32_16x16x32_bf16 v[212:215], a[180:183], v[56:59], v[212:215]
    v_exp_f32 v105, v105
    v_mfma_f32_16x16x32_bf16 v[244:247], a[180:183], v[60:63], v[244:247]
    ds_read_b128 a[180:183], v20 offset:21504
    v_exp_f32 v106, v106
    v_mfma_f32_16x16x32_bf16 v[216:219], a[184:187], v[56:59], v[216:219]
    ds_write_b128 v16, v[184:187] offset:37888
    v_cvt_pk_bf16_f32 v49, v98, v99
    v_mfma_f32_16x16x32_bf16 v[248:251], a[184:187], v[60:63], v[248:251]
    ds_read_b128 a[184:187], v20 offset:22528
    v_exp_f32 v107, v107
    v_mfma_f32_16x16x32_bf16 v[220:223], a[188:191], v[56:59], v[220:223]
    v_exp_f32 v108, v108
    v_mfma_f32_16x16x32_bf16 v[252:255], a[188:191], v[60:63], v[252:255]
    ds_read_b128 a[188:191], v20 offset:23552
    v_exp_f32 v109, v109
    v_mfma_f32_16x16x32_bf16 v[192:195], a[160:163], v[56:59], v[192:195]
    ds_write_b128 v16, v[156:159] offset:38912
    v_cvt_pk_bf16_f32 v50, v100, v101
    v_mfma_f32_16x16x32_bf16 v[224:227], a[160:163], v[60:63], v[224:227]
    ds_read_b128 a[160:163], v19 offset:16384
    v_exp_f32 v110, v110
    v_mfma_f32_16x16x32_bf16 v[196:199], a[164:167], v[56:59], v[196:199]
    v_exp_f32 v111, v111
    v_mfma_f32_16x16x32_bf16 v[228:231], a[164:167], v[60:63], v[228:231]
    ds_read_b128 a[164:167], v19 offset:17408
    v_cvt_pk_bf16_f32 v51, v102, v103
    v_mfma_f32_16x16x32_bf16 v[200:203], a[168:171], v[56:59], v[200:203]
    ds_write_b128 v16, v[188:191] offset:39936
    v_cvt_pk_bf16_f32 v52, v104, v105
    v_mfma_f32_16x16x32_bf16 v[232:235], a[168:171], v[60:63], v[232:235]
    ds_read_b128 a[168:171], v19 offset:18432
    v_cvt_pk_bf16_f32 v53, v106, v107
    v_mfma_f32_16x16x32_bf16 v[204:207], a[172:175], v[56:59], v[204:207]
    v_cvt_pk_bf16_f32 v54, v108, v109
    v_cvt_pk_bf16_f32 v55, v110, v111
    v_mfma_f32_16x16x32_bf16 v[236:239], a[172:175], v[60:63], v[236:239]
    ds_read_b128 a[172:175], v19 offset:19456
    ds_write_b64 v12, v[32:33]
    s_xor_b32 s101, s16, 98304
    v_xor_b32 v12, 8192, v12
    v_add_u32 v9, s101, v1
    v_xor_b32 v8, 8192, v16
    v_xor_b32 v10, 8192, v9
L_t1_join:
    v_xor_b32 v19, 98304, v19
    v_xor_b32 v20, 98304, v20
    s_waitcnt lgkmcnt(0)
    s_barrier
    v_mfma_f32_16x16x32_bf16 v[40:43], v[28:31], v[48:51], v[40:43]
    s_lshl_b32 s100, s60, 20
    s_add_u32 s101, s100, s21
    ds_read_b64 v[120:121], v12
    v_mfma_f32_16x16x32_bf16 v[44:47], v[28:31], v[52:55], v[44:47]
    s_add_u32 s100, s100, s20
    ds_read_b128 v[144:147], v8 offset:32768
    v_lshrrev_b32 v11, 4, v2
    v_mfma_f32_16x16x32_bf16 v[208:211], a[176:179], v[48:51], v[208:211]
    ds_read_b128 v[176:179], v8 offset:33792
    v_lshrrev_b32 v13, 2, v1
    v_mfma_f32_16x16x32_bf16 v[240:243], a[176:179], v[52:55], v[240:243]
    ds_read_b128 v[148:151], v8 offset:34816
    v_add_u32 v13, 32768, v13
    v_mfma_f32_16x16x32_bf16 v[212:215], a[180:183], v[48:51], v[212:215]
    s_xor_b32 s99, s62, 8192
    ds_read_b128 v[180:183], v8 offset:35840
    v_add_u32 v14, s99, v13
    v_mfma_f32_16x16x32_bf16 v[244:247], a[180:183], v[52:55], v[244:247]
    ds_read_b128 v[152:155], v8 offset:36864
    v_cmp_eq_u32 vcc, 1, v11
    v_mfma_f32_16x16x32_bf16 v[216:219], a[184:187], v[48:51], v[216:219]
    ds_read_b128 v[184:187], v8 offset:37888
    s_waitcnt lgkmcnt(6)
    v_add_f32 v112, v120, v32
    v_mfma_f32_16x16x32_bf16 v[248:251], a[184:187], v[52:55], v[248:251]
    ds_read_b128 v[156:159], v8 offset:38912
    v_add_f32 v114, v121, v36
    v_mfma_f32_16x16x32_bf16 v[220:223], a[188:191], v[48:51], v[220:223]
    ds_read_b128 v[188:191], v8 offset:39936
    v_cndmask_b32 v12, v32, v36, vcc
    v_mfma_f32_16x16x32_bf16 v[252:255], a[188:191], v[52:55], v[252:255]
    v_rcp_f32 v112, v112
    v_mfma_f32_16x16x32_bf16 v[192:195], a[160:163], v[48:51], v[192:195]
    v_rcp_f32 v114, v114
    v_mfma_f32_16x16x32_bf16 v[224:227], a[160:163], v[52:55], v[224:227]
    v_cmp_eq_u32 vcc, 2, v11
    v_cmp_eq_u32 s[96:97], 3, v11
    v_mfma_f32_16x16x32_bf16 v[196:199], a[164:167], v[48:51], v[196:199]
    ds_write_b128 v9, v[208:211] offset:0
    v_mfma_f32_16x16x32_bf16 v[228:231], a[164:167], v[52:55], v[228:231]
    v_mfma_f32_16x16x32_bf16 v[200:203], a[168:171], v[48:51], v[200:203]
    ds_write_b128 v9, v[240:243] offset:1024
    v_mfma_f32_16x16x32_bf16 v[232:235], a[168:171], v[52:55], v[232:235]
    v_mfma_f32_16x16x32_bf16 v[204:207], a[172:175], v[48:51], v[204:207]
    ds_write_b128 v9, v[212:215] offset:2048
    v_mfma_f32_16x16x32_bf16 v[236:239], a[172:175], v[52:55], v[236:239]
    v_cndmask_b32 v12, v12, v40, vcc
    v_cndmask_b32 v12, v12, v44, s[96:97]
    ds_write_b128 v9, v[244:247] offset:3072
    s_waitcnt lgkmcnt(11)
    v_pk_add_f32 v[128:129], v[128:129], v[144:145]
    v_pk_add_f32 v[130:131], v[130:131], v[146:147]
    s_waitcnt lgkmcnt(9)
    v_pk_add_f32 v[132:133], v[132:133], v[148:149]
    v_pk_add_f32 v[134:135], v[134:135], v[150:151]
    v_pk_mul_f32 v[128:129], v[128:129], v[112:113] op_sel_hi:[1,0]
    v_pk_mul_f32 v[130:131], v[130:131], v[112:113] op_sel_hi:[1,0]
    v_pk_mul_f32 v[132:133], v[132:133], v[112:113] op_sel_hi:[1,0]
    v_pk_mul_f32 v[134:135], v[134:135], v[112:113] op_sel_hi:[1,0]
    v_cvt_pk_bf16_f32 v128, v128, v129
    v_cvt_pk_bf16_f32 v129, v130, v131
    v_cvt_pk_bf16_f32 v130, v132, v133
    s_add_u32 m0, s16, 0
    ds_write_b128 v9, v[216:219] offset:4096
    v_cvt_pk_bf16_f32 v131, v134, v135
    buffer_store_dwordx4 v[128:131], v1, s[8:11], s100 offen offset:0 sc0 sc1
    s_waitcnt lgkmcnt(8)
    v_pk_add_f32 v[136:137], v[136:137], v[152:153]
    v_pk_add_f32 v[138:139], v[138:139], v[154:155]
    s_waitcnt lgkmcnt(6)
    v_pk_add_f32 v[140:141], v[140:141], v[156:157]
    v_pk_add_f32 v[142:143], v[142:143], v[158:159]
    v_pk_mul_f32 v[136:137], v[136:137], v[112:113] op_sel_hi:[1,0]
    v_pk_mul_f32 v[138:139], v[138:139], v[112:113] op_sel_hi:[1,0]
    v_pk_mul_f32 v[140:141], v[140:141], v[112:113] op_sel_hi:[1,0]
    v_pk_mul_f32 v[142:143], v[142:143], v[112:113] op_sel_hi:[1,0]
    v_cvt_pk_bf16_f32 v136, v136, v137
    buffer_load_dwordx4 v1, s[8:11], s19 offen offset:0  lds
    ds_write_b128 v9, v[248:251] offset:5120
    v_cvt_pk_bf16_f32 v137, v138, v139
    v_cvt_pk_bf16_f32 v138, v140, v141
    v_cvt_pk_bf16_f32 v139, v142, v143
    buffer_store_dwordx4 v[136:139], v1, s[8:11], s100 offen offset:1024 sc0 sc1
    v_pk_add_f32 v[160:161], v[160:161], v[176:177]
    v_pk_add_f32 v[162:163], v[162:163], v[178:179]
    v_pk_add_f32 v[164:165], v[164:165], v[180:181]
    v_pk_add_f32 v[166:167], v[166:167], v[182:183]
    v_pk_mul_f32 v[160:161], v[160:161], v[114:115] op_sel_hi:[1,0]
    v_pk_mul_f32 v[162:163], v[162:163], v[114:115] op_sel_hi:[1,0]
    v_pk_mul_f32 v[164:165], v[164:165], v[114:115] op_sel_hi:[1,0]
    buffer_load_dwordx4 v1, s[8:11], s19 offen offset:1024  lds
    ds_write_b128 v9, v[220:223] offset:6144
    v_pk_mul_f32 v[166:167], v[166:167], v[114:115] op_sel_hi:[1,0]
    v_cvt_pk_bf16_f32 v160, v160, v161
    v_cvt_pk_bf16_f32 v161, v162, v163
    v_cvt_pk_bf16_f32 v162, v164, v165
    v_cvt_pk_bf16_f32 v163, v166, v167
    buffer_store_dwordx4 v[160:163], v15, s[8:11], s100 offen offset:0 sc0 sc1
    v_pk_add_f32 v[168:169], v[168:169], v[184:185]
    v_pk_add_f32 v[170:171], v[170:171], v[186:187]
    s_waitcnt lgkmcnt(7)
    v_pk_add_f32 v[172:173], v[172:173], v[188:189]
    v_pk_add_f32 v[174:175], v[174:175], v[190:191]
    v_pk_mul_f32 v[168:169], v[168:169], v[114:115] op_sel_hi:[1,0]
    buffer_load_dwordx4 v1, s[8:11], s19 offen offset:2048  lds
    ds_write_b128 v9, v[252:255] offset:7168
    v_pk_mul_f32 v[170:171], v[170:171], v[114:115] op_sel_hi:[1,0]
    v_pk_mul_f32 v[172:173], v[172:173], v[114:115] op_sel_hi:[1,0]
    v_pk_mul_f32 v[174:175], v[174:175], v[114:115] op_sel_hi:[1,0]
    v_cvt_pk_bf16_f32 v168, v168, v169
    v_cvt_pk_bf16_f32 v169, v170, v171
    v_cvt_pk_bf16_f32 v170, v172, v173
    v_cvt_pk_bf16_f32 v171, v174, v175
    buffer_store_dwordx4 v[168:171], v15, s[8:11], s100 offen offset:1024 sc0 sc1
    buffer_load_dwordx4 v1, s[8:11], s19 offen offset:3072  lds
    ds_write_b32 v14, v12
    v_and_b32 v14, 4294967103, v13
    v_add_u32 v14, s62, v14
    s_waitcnt lgkmcnt(0)
    s_barrier
    ds_read_b32 v116, v14 offset:128
    ds_read_b32 v118, v14 offset:192
    ds_read_b128 v[208:211], v10 offset:0
    ds_read_b128 v[212:215], v10 offset:2048
    ds_read_b128 v[216:219], v10 offset:4096
    ds_read_b128 v[220:223], v10 offset:6144
    ds_read_b128 v[240:243], v10 offset:1024
    ds_read_b128 v[244:247], v10 offset:3072
    ds_read_b128 v[248:251], v10 offset:5120
    ds_read_b128 v[252:255], v10 offset:7168
    ds_read_b32 v120, v13 offset:0
    ds_read_b32 v121, v13 offset:8192
    ds_read_b32 v122, v13 offset:16384
    ds_read_b32 v123, v13 offset:24576
    s_waitcnt lgkmcnt(13)
    v_add_f32 v116, v116, v40
    s_waitcnt lgkmcnt(12)
    v_add_f32 v118, v118, v44
    v_rcp_f32 v116, v116
    v_rcp_f32 v118, v118
    s_waitcnt lgkmcnt(11)
    v_pk_add_f32 v[192:193], v[192:193], v[208:209]
    v_pk_add_f32 v[194:195], v[194:195], v[210:211]
    s_waitcnt lgkmcnt(10)
    v_pk_add_f32 v[196:197], v[196:197], v[212:213]
    v_pk_add_f32 v[198:199], v[198:199], v[214:215]
    v_pk_mul_f32 v[192:193], v[192:193], v[116:117] op_sel_hi:[1,0]
    v_pk_mul_f32 v[194:195], v[194:195], v[116:117] op_sel_hi:[1,0]
    v_pk_mul_f32 v[196:197], v[196:197], v[116:117] op_sel_hi:[1,0]
    v_pk_mul_f32 v[198:199], v[198:199], v[116:117] op_sel_hi:[1,0]
    v_cvt_pk_bf16_f32 v192, v192, v193
    v_cvt_pk_bf16_f32 v193, v194, v195
    v_cvt_pk_bf16_f32 v194, v196, v197
    v_cvt_pk_bf16_f32 v195, v198, v199
    buffer_store_dwordx4 v[192:195], v1, s[8:11], s101 offen offset:0 sc0 sc1
    s_add_u32 m0, s16, 4096
    s_waitcnt lgkmcnt(9)
    v_pk_add_f32 v[200:201], v[200:201], v[216:217]
    v_pk_add_f32 v[202:203], v[202:203], v[218:219]
    s_waitcnt lgkmcnt(8)
    v_pk_add_f32 v[204:205], v[204:205], v[220:221]
    v_pk_add_f32 v[206:207], v[206:207], v[222:223]
    v_pk_mul_f32 v[200:201], v[200:201], v[116:117] op_sel_hi:[1,0]
    v_pk_mul_f32 v[202:203], v[202:203], v[116:117] op_sel_hi:[1,0]
    v_pk_mul_f32 v[204:205], v[204:205], v[116:117] op_sel_hi:[1,0]
    v_pk_mul_f32 v[206:207], v[206:207], v[116:117] op_sel_hi:[1,0]
    v_cvt_pk_bf16_f32 v200, v200, v201
    v_cvt_pk_bf16_f32 v201, v202, v203
    v_cvt_pk_bf16_f32 v202, v204, v205
    v_cvt_pk_bf16_f32 v203, v206, v207
    buffer_store_dwordx4 v[200:203], v1, s[8:11], s101 offen offset:1024 sc0 sc1
    buffer_load_dwordx4 v15, s[8:11], s19 offen offset:0  lds
    buffer_load_dwordx4 v15, s[8:11], s19 offen offset:1024  lds
    s_waitcnt lgkmcnt(2)
    v_add_f32 v120, v120, v121
    s_waitcnt lgkmcnt(0)
    v_add_f32 v122, v122, v123
    v_min_f32 v124, v120, v122
    v_add_f32 v120, v120, v122
    v_cmp_le_f32 vcc, 0x1f800000, v124
    s_mov_b64 s[96:97], vcc
    v_cmp_ge_f32 vcc, 0x67800000, v120
    s_and_b64 s[96:97], s[96:97], vcc
    s_cmp_eq_u64 s[96:97], -1
    s_cselect_b32 s96, s25, 1
    s_cmp_lg_u32 s96, 0
    s_cbranch_scc1 L_t1_redo
L_t1_safe:
    v_pk_add_f32 v[224:225], v[224:225], v[240:241]
    v_pk_add_f32 v[226:227], v[226:227], v[242:243]
    v_pk_add_f32 v[228:229], v[228:229], v[244:245]
    v_pk_add_f32 v[230:231], v[230:231], v[246:247]
    v_pk_mul_f32 v[224:225], v[224:225], v[118:119] op_sel_hi:[1,0]
    v_pk_mul_f32 v[226:227], v[226:227], v[118:119] op_sel_hi:[1,0]
    v_pk_mul_f32 v[228:229], v[228:229], v[118:119] op_sel_hi:[1,0]
    v_pk_mul_f32 v[230:231], v[230:231], v[118:119] op_sel_hi:[1,0]
    v_cvt_pk_bf16_f32 v224, v224, v225
    v_cvt_pk_bf16_f32 v225, v226, v227
    v_cvt_pk_bf16_f32 v226, v228, v229
    v_cvt_pk_bf16_f32 v227, v230, v231
    buffer_store_dwordx4 v[224:227], v15, s[8:11], s101 offen offset:0 sc0 sc1
    buffer_load_dwordx4 v15, s[8:11], s19 offen offset:2048  lds
    ds_read_b128 a[128:131], v18 offset:0
    ds_read_b128 a[132:135], v18 offset:1024
    ds_read_b128 a[136:139], v18 offset:2048
    ds_read_b128 a[140:143], v18 offset:3072
    v_pk_add_f32 v[232:233], v[232:233], v[248:249]
    v_pk_add_f32 v[234:235], v[234:235], v[250:251]
    v_pk_add_f32 v[236:237], v[236:237], v[252:253]
    v_pk_add_f32 v[238:239], v[238:239], v[254:255]
    v_pk_mul_f32 v[232:233], v[232:233], v[118:119] op_sel_hi:[1,0]
    v_pk_mul_f32 v[234:235], v[234:235], v[118:119] op_sel_hi:[1,0]
    v_pk_mul_f32 v[236:237], v[236:237], v[118:119] op_sel_hi:[1,0]
    v_pk_mul_f32 v[238:239], v[238:239], v[118:119] op_sel_hi:[1,0]
    v_cvt_pk_bf16_f32 v232, v232, v233
    v_cvt_pk_bf16_f32 v233, v234, v235
    v_cvt_pk_bf16_f32 v234, v236, v237
    v_cvt_pk_bf16_f32 v235, v238, v239
    buffer_store_dwordx4 v[232:235], v15, s[8:11], s101 offen offset:1024 sc0 sc1
    buffer_load_dwordx4 v15, s[8:11], s19 offen offset:3072  lds
    s_xor_b32 s16, s16, 98304
    ds_read_b128 a[144:147], v18 offset:4096
    ds_read_b128 a[148:151], v18 offset:5120
    ds_read_b128 a[152:155], v18 offset:6144
    ds_read_b128 a[156:159], v18 offset:7168
L_t2_start:
    s_waitcnt lgkmcnt(7)
    v_mfma_f32_16x16x32_bf16 v[96:99], a[128:131], a[192:195], v[64:67]
    s_waitcnt lgkmcnt(6)
    s_add_u32 s19, s82, 32768
    s_sub_u32 s82, s12, s13
    s_sub_u32 s82, s82, 1
    v_mfma_f32_16x16x32_bf16 v[96:99], a[132:135], a[196:199], v[96:99]
    s_waitcnt lgkmcnt(5)
    s_cmp_gt_u32 s12, s13
    s_cselect_b32 s82, s82, s12
    s_mul_i32 s82, s82, 65536
    s_add_u32 s82, s82, s81
    v_mfma_f32_16x16x32_bf16 v[96:99], a[136:139], a[200:203], v[96:99]
    s_waitcnt lgkmcnt(4)
    s_cmp_ge_u32 s12, 17
    s_cselect_b32 s82, 2147471360, s82
    s_add_u32 s12, s12, 1
    s_sub_u32 s14, s61, 8
    v_mfma_f32_16x16x32_bf16 v[96:99], a[140:143], a[204:207], v[96:99]
    s_waitcnt lgkmcnt(3)
    v_mfma_f32_16x16x32_bf16 v[100:103], a[144:147], a[192:195], v[64:67]
    s_waitcnt lgkmcnt(2)
    v_mfma_f32_16x16x32_bf16 v[100:103], a[148:151], a[196:199], v[100:103]
    s_waitcnt lgkmcnt(1)
    v_mfma_f32_16x16x32_bf16 v[100:103], a[152:155], a[200:203], v[100:103]
    s_waitcnt lgkmcnt(0)
    v_mfma_f32_16x16x32_bf16 v[100:103], a[156:159], a[204:207], v[100:103]
    v_mfma_f32_16x16x32_bf16 v[104:107], a[128:131], a[208:211], v[68:71]
    v_exp_f32 v96, v96
    v_mfma_f32_16x16x32_bf16 v[104:107], a[132:135], a[212:215], v[104:107]
    v_exp_f32 v97, v97
    v_mfma_f32_16x16x32_bf16 v[104:107], a[136:139], a[216:219], v[104:107]
    v_exp_f32 v98, v98
    v_mfma_f32_16x16x32_bf16 v[104:107], a[140:143], a[220:223], v[104:107]
    v_exp_f32 v99, v99
    v_mfma_f32_16x16x32_bf16 v[108:111], a[144:147], a[208:211], v[68:71]
    v_exp_f32 v100, v100
    v_mfma_f32_16x16x32_bf16 v[108:111], a[148:151], a[212:215], v[108:111]
    v_exp_f32 v101, v101
    v_mfma_f32_16x16x32_bf16 v[108:111], a[152:155], a[216:219], v[108:111]
    v_exp_f32 v102, v102
    v_mfma_f32_16x16x32_bf16 v[108:111], a[156:159], a[220:223], v[108:111]
    v_exp_f32 v103, v103
    v_mfma_f32_16x16x32_bf16 v[112:115], a[128:131], a[224:227], v[72:75]
    v_exp_f32 v104, v104
    v_mfma_f32_16x16x32_bf16 v[112:115], a[132:135], a[228:231], v[112:115]
    v_exp_f32 v105, v105
    v_mfma_f32_16x16x32_bf16 v[112:115], a[136:139], a[232:235], v[112:115]
    v_exp_f32 v106, v106
    v_mfma_f32_16x16x32_bf16 v[112:115], a[140:143], a[236:239], v[112:115]
    v_exp_f32 v107, v107
    v_mfma_f32_16x16x32_bf16 v[120:123], a[128:131], a[240:243], v[76:79]
    v_exp_f32 v108, v108
    v_mfma_f32_16x16x32_bf16 v[120:123], a[132:135], a[244:247], v[120:123]
    v_exp_f32 v109, v109
    v_mfma_f32_16x16x32_bf16 v[120:123], a[136:139], a[248:251], v[120:123]
    v_exp_f32 v110, v110
    v_mfma_f32_16x16x32_bf16 v[120:123], a[140:143], a[252:255], v[120:123]
    v_exp_f32 v111, v111
    v_mfma_f32_16x16x32_bf16 v[116:119], a[144:147], a[224:227], v[72:75]
    ds_read_b128 a[128:131], v18 offset:16384
    v_cvt_pk_bf16_f32 v48, v96, v97
    v_mfma_f32_16x16x32_bf16 v[116:119], a[148:151], a[228:231], v[116:119]
    ds_read_b128 a[132:135], v18 offset:17408
    v_cvt_pk_bf16_f32 v49, v98, v99
    v_mfma_f32_16x16x32_bf16 v[116:119], a[152:155], a[232:235], v[116:119]
    ds_read_b128 a[136:139], v18 offset:18432
    v_cvt_pk_bf16_f32 v50, v100, v101
    v_mfma_f32_16x16x32_bf16 v[116:119], a[156:159], a[236:239], v[116:119]
    ds_read_b128 a[140:143], v18 offset:19456
    v_cvt_pk_bf16_f32 v51, v102, v103
    v_mfma_f32_16x16x32_bf16 v[124:127], a[144:147], a[240:243], v[76:79]
    ds_read_b128 a[144:147], v18 offset:20480
    v_cvt_pk_bf16_f32 v52, v104, v105
    v_mfma_f32_16x16x32_bf16 v[124:127], a[148:151], a[244:247], v[124:127]
    ds_read_b128 a[148:151], v18 offset:21504
    v_cvt_pk_bf16_f32 v53, v106, v107
    v_mfma_f32_16x16x32_bf16 v[124:127], a[152:155], a[248:251], v[124:127]
    ds_read_b128 a[152:155], v18 offset:22528
    v_cvt_pk_bf16_f32 v54, v108, v109
    v_mfma_f32_16x16x32_bf16 v[124:127], a[156:159], a[252:255], v[124:127]
    ds_read_b128 a[156:159], v18 offset:23552
    v_cvt_pk_bf16_f32 v55, v110, v111
    v_xor_b32 v18, 196608, v18
    s_waitcnt vmcnt(0) lgkmcnt(0)
    s_barrier
    v_mfma_f32_16x16x32_bf16 v[96:99], a[128:131], a[192:195], v[64:67]
    s_add_u32 m0, s15, 0
    ds_read_b128 a[160:163], v19 offset:0
    v_mfma_f32_16x16x32_bf16 v[96:99], a[132:135], a[196:199], v[96:99]
    ds_read_b128 a[164:167], v19 offset:1024
    v_mfma_f32_16x16x32_bf16 v[96:99], a[136:139], a[200:203], v[96:99]
    v_exp_f32 v112, v112
    v_mfma_f32_16x16x32_bf16 v[96:99], a[140:143], a[204:207], v[96:99]
    buffer_load_dwordx4 v1, s[8:11], s82 offen offset:0  lds
    v_mfma_f32_16x16x32_bf16 v[104:107], a[128:131], a[208:211], v[68:71]
    v_exp_f32 v113, v113
    v_mfma_f32_16x16x32_bf16 v[104:107], a[132:135], a[212:215], v[104:107]
    ds_read_b128 a[168:171], v19 offset:2048
    v_cvt_pk_bf16_f32 v56, v112, v113
    v_mfma_f32_16x16x32_bf16 v[104:107], a[136:139], a[216:219], v[104:107]
    v_exp_f32 v114, v114
    v_mfma_f32_16x16x32_bf16 v[104:107], a[140:143], a[220:223], v[104:107]
    buffer_load_dwordx4 v1, s[8:11], s82 offen offset:1024  lds
    v_mfma_f32_16x16x32_bf16 v[100:103], a[144:147], a[192:195], v[64:67]
    v_exp_f32 v115, v115
    v_mfma_f32_16x16x32_bf16 v[100:103], a[148:151], a[196:199], v[100:103]
    ds_read_b128 a[172:175], v19 offset:3072
    v_cvt_pk_bf16_f32 v57, v114, v115
    v_mfma_f32_16x16x32_bf16 v[100:103], a[152:155], a[200:203], v[100:103]
    v_exp_f32 v116, v116
    v_mfma_f32_16x16x32_bf16 v[100:103], a[156:159], a[204:207], v[100:103]
    buffer_load_dwordx4 v1, s[8:11], s82 offen offset:2048  lds
    v_mfma_f32_16x16x32_bf16 v[108:111], a[144:147], a[208:211], v[68:71]
    v_exp_f32 v117, v117
    v_mfma_f32_16x16x32_bf16 v[108:111], a[148:151], a[212:215], v[108:111]
    ds_read_b128 a[176:179], v20 offset:4096
    v_cvt_pk_bf16_f32 v58, v116, v117
    v_mfma_f32_16x16x32_bf16 v[108:111], a[152:155], a[216:219], v[108:111]
    v_exp_f32 v118, v118
    v_mfma_f32_16x16x32_bf16 v[108:111], a[156:159], a[220:223], v[108:111]
    buffer_load_dwordx4 v1, s[8:11], s82 offen offset:3072  lds
    v_mfma_f32_16x16x32_bf16 v[32:35], v[28:31], v[48:51], 0
    s_add_u32 m0, s15, 4096
    v_exp_f32 v119, v119
    v_mfma_f32_16x16x32_bf16 v[36:39], v[28:31], v[52:55], 0
    s_waitcnt lgkmcnt(4)
    ds_read_b128 a[180:183], v20 offset:5120
    v_cvt_pk_bf16_f32 v59, v118, v119
    v_mfma_f32_16x16x32_bf16 v[128:131], a[160:163], v[48:51], 0
    s_waitcnt lgkmcnt(4)
    v_exp_f32 v120, v120
    v_mfma_f32_16x16x32_bf16 v[160:163], a[160:163], v[52:55], 0
    buffer_load_dwordx4 v15, s[8:11], s82 offen offset:0  lds
    v_mfma_f32_16x16x32_bf16 v[132:135], a[164:167], v[48:51], 0
    v_exp_f32 v121, v121
    v_mfma_f32_16x16x32_bf16 v[164:167], a[164:167], v[52:55], 0
    s_waitcnt lgkmcnt(3)
    ds_read_b128 a[184:187], v20 offset:6144
    v_cvt_pk_bf16_f32 v60, v120, v121
    v_mfma_f32_16x16x32_bf16 v[136:139], a[168:171], v[48:51], 0
    s_waitcnt lgkmcnt(3)
    v_exp_f32 v122, v122
    v_mfma_f32_16x16x32_bf16 v[168:171], a[168:171], v[52:55], 0
    buffer_load_dwordx4 v15, s[8:11], s82 offen offset:1024  lds
    v_mfma_f32_16x16x32_bf16 v[140:143], a[172:175], v[48:51], 0
    v_exp_f32 v123, v123
    v_mfma_f32_16x16x32_bf16 v[172:175], a[172:175], v[52:55], 0
    s_waitcnt lgkmcnt(2)
    ds_read_b128 a[188:191], v20 offset:7168
    v_cvt_pk_bf16_f32 v61, v122, v123
    v_mfma_f32_16x16x32_bf16 v[144:147], a[176:179], v[48:51], 0
    s_waitcnt lgkmcnt(2)
    v_exp_f32 v124, v124
    v_mfma_f32_16x16x32_bf16 v[176:179], a[176:179], v[52:55], 0
    buffer_load_dwordx4 v15, s[8:11], s82 offen offset:2048  lds
    v_mfma_f32_16x16x32_bf16 v[148:151], a[180:183], v[48:51], 0
    v_exp_f32 v125, v125
    v_mfma_f32_16x16x32_bf16 v[180:183], a[180:183], v[52:55], 0
    s_waitcnt lgkmcnt(1)
    v_cvt_pk_bf16_f32 v62, v124, v125
    v_mfma_f32_16x16x32_bf16 v[152:155], a[184:187], v[48:51], 0
    s_waitcnt lgkmcnt(0)
    v_exp_f32 v126, v126
    v_mfma_f32_16x16x32_bf16 v[184:187], a[184:187], v[52:55], 0
    buffer_load_dwordx4 v15, s[8:11], s82 offen offset:3072  lds
    v_mfma_f32_16x16x32_bf16 v[156:159], a[188:191], v[48:51], 0
    s_xor_b32 s15, s15, 196608
    v_exp_f32 v127, v127
    v_mfma_f32_16x16x32_bf16 v[188:191], a[188:191], v[52:55], 0
    s_add_u32 m0, s16, 0
    v_cvt_pk_bf16_f32 v63, v126, v127
    v_mfma_f32_16x16x32_bf16 v[112:115], a[128:131], a[224:227], v[72:75]
    v_mfma_f32_16x16x32_bf16 v[112:115], a[132:135], a[228:231], v[112:115]
    v_mfma_f32_16x16x32_bf16 v[112:115], a[136:139], a[232:235], v[112:115]
    v_exp_f32 v96, v96
    v_mfma_f32_16x16x32_bf16 v[112:115], a[140:143], a[236:239], v[112:115]
    buffer_load_dwordx4 v1, s[8:11], s19 offen offset:0  lds
    v_mfma_f32_16x16x32_bf16 v[120:123], a[128:131], a[240:243], v[76:79]
    v_exp_f32 v97, v97
    v_mfma_f32_16x16x32_bf16 v[120:123], a[132:135], a[244:247], v[120:123]
    ds_read_b128 a[128:131], v18 offset:0
    v_cvt_pk_bf16_f32 v48, v96, v97
    v_mfma_f32_16x16x32_bf16 v[120:123], a[136:139], a[248:251], v[120:123]
    v_exp_f32 v98, v98
    v_mfma_f32_16x16x32_bf16 v[120:123], a[140:143], a[252:255], v[120:123]
    buffer_load_dwordx4 v1, s[8:11], s19 offen offset:1024  lds
    v_mfma_f32_16x16x32_bf16 v[116:119], a[144:147], a[224:227], v[72:75]
    v_exp_f32 v99, v99
    v_mfma_f32_16x16x32_bf16 v[116:119], a[148:151], a[228:231], v[116:119]
    ds_read_b128 a[132:135], v18 offset:1024
    v_cvt_pk_bf16_f32 v49, v98, v99
    v_mfma_f32_16x16x32_bf16 v[116:119], a[152:155], a[232:235], v[116:119]
    v_exp_f32 v100, v100
    v_mfma_f32_16x16x32_bf16 v[116:119], a[156:159], a[236:239], v[116:119]
    buffer_load_dwordx4 v1, s[8:11], s19 offen offset:2048  lds
    v_mfma_f32_16x16x32_bf16 v[124:127], a[144:147], a[240:243], v[76:79]
    v_exp_f32 v101, v101
    v_mfma_f32_16x16x32_bf16 v[124:127], a[148:151], a[244:247], v[124:127]
    ds_read_b128 a[136:139], v18 offset:2048
    v_cvt_pk_bf16_f32 v50, v100, v101
    v_mfma_f32_16x16x32_bf16 v[124:127], a[152:155], a[248:251], v[124:127]
    v_exp_f32 v102, v102
    v_mfma_f32_16x16x32_bf16 v[124:127], a[156:159], a[252:255], v[124:127]
    buffer_load_dwordx4 v1, s[8:11], s19 offen offset:3072  lds
    v_mfma_f32_16x16x32_bf16 v[40:43], v[28:31], v[56:59], 0
    s_add_u32 m0, s16, 4096
    v_exp_f32 v103, v103
    v_mfma_f32_16x16x32_bf16 v[44:47], v[28:31], v[60:63], 0
    ds_read_b128 a[140:143], v18 offset:3072
    v_cvt_pk_bf16_f32 v51, v102, v103
    v_mfma_f32_16x16x32_bf16 v[192:195], a[160:163], v[56:59], 0
    v_exp_f32 v104, v104
    v_mfma_f32_16x16x32_bf16 v[224:227], a[160:163], v[60:63], 0
    buffer_load_dwordx4 v15, s[8:11], s19 offen offset:0  lds
    v_mfma_f32_16x16x32_bf16 v[196:199], a[164:167], v[56:59], 0
    v_exp_f32 v105, v105
    v_mfma_f32_16x16x32_bf16 v[228:231], a[164:167], v[60:63], 0
    ds_read_b128 a[144:147], v18 offset:4096
    v_cvt_pk_bf16_f32 v52, v104, v105
    v_mfma_f32_16x16x32_bf16 v[200:203], a[168:171], v[56:59], 0
    v_exp_f32 v106, v106
    v_mfma_f32_16x16x32_bf16 v[232:235], a[168:171], v[60:63], 0
    buffer_load_dwordx4 v15, s[8:11], s19 offen offset:1024  lds
    v_mfma_f32_16x16x32_bf16 v[204:207], a[172:175], v[56:59], 0
    v_exp_f32 v107, v107
    v_mfma_f32_16x16x32_bf16 v[236:239], a[172:175], v[60:63], 0
    ds_read_b128 a[148:151], v18 offset:5120
    v_cvt_pk_bf16_f32 v53, v106, v107
    v_mfma_f32_16x16x32_bf16 v[208:211], a[176:179], v[56:59], 0
    v_exp_f32 v108, v108
    v_mfma_f32_16x16x32_bf16 v[240:243], a[176:179], v[60:63], 0
    buffer_load_dwordx4 v15, s[8:11], s19 offen offset:2048  lds
    v_mfma_f32_16x16x32_bf16 v[212:215], a[180:183], v[56:59], 0
    v_exp_f32 v109, v109
    v_mfma_f32_16x16x32_bf16 v[244:247], a[180:183], v[60:63], 0
    ds_read_b128 a[152:155], v18 offset:6144
    v_cvt_pk_bf16_f32 v54, v108, v109
    v_mfma_f32_16x16x32_bf16 v[216:219], a[184:187], v[56:59], 0
    v_exp_f32 v110, v110
    v_mfma_f32_16x16x32_bf16 v[248:251], a[184:187], v[60:63], 0
    buffer_load_dwordx4 v15, s[8:11], s19 offen offset:3072  lds
    v_mfma_f32_16x16x32_bf16 v[220:223], a[188:191], v[56:59], 0
    s_xor_b32 s16, s16, 98304
    v_exp_f32 v111, v111
    v_mfma_f32_16x16x32_bf16 v[252:255], a[188:191], v[60:63], 0
    ds_read_b128 a[156:159], v18 offset:7168
    v_cvt_pk_bf16_f32 v55, v110, v111
    s_waitcnt lgkmcnt(7)
    v_mfma_f32_16x16x32_bf16 v[96:99], a[128:131], a[192:195], v[64:67]
    s_waitcnt lgkmcnt(6)
    s_lshr_b32 s101, s2, 3
    s_sub_u32 s101, s101, 4
    ds_read_b128 a[160:163], v19 offset:16384
    v_mfma_f32_16x16x32_bf16 v[96:99], a[132:135], a[196:199], v[96:99]
    s_waitcnt lgkmcnt(6)
    s_and_b32 s101, s101, 31
    ds_read_b128 a[164:167], v19 offset:17408
    v_and_b32 v14, 7, v2
    v_mfma_f32_16x16x32_bf16 v[96:99], a[136:139], a[200:203], v[96:99]
    s_waitcnt lgkmcnt(6)
    v_exp_f32 v112, v112
    v_mfma_f32_16x16x32_bf16 v[96:99], a[140:143], a[204:207], v[96:99]
    v_lshlrev_b32 v14, 4, v14
    v_lshrrev_b32 v13, 3, v2
    v_mfma_f32_16x16x32_bf16 v[104:107], a[128:131], a[208:211], v[68:71]
    v_exp_f32 v113, v113
    v_mfma_f32_16x16x32_bf16 v[104:107], a[132:135], a[212:215], v[104:107]
    ds_read_b128 a[168:171], v19 offset:18432
    v_cvt_pk_bf16_f32 v56, v112, v113
    v_mfma_f32_16x16x32_bf16 v[104:107], a[136:139], a[216:219], v[104:107]
    v_exp_f32 v114, v114
    v_mfma_f32_16x16x32_bf16 v[104:107], a[140:143], a[220:223], v[104:107]
    s_waitcnt lgkmcnt(6)
    v_lshl_add_u32 v12, v13, 13, v14
    v_mul_u32_u24 v13, 28672, v13
    v_mfma_f32_16x16x32_bf16 v[100:103], a[144:147], a[192:195], v[64:67]
    s_waitcnt lgkmcnt(5)
    s_add_u32 s27, s18, 0
    v_exp_f32 v115, v115
    v_mfma_f32_16x16x32_bf16 v[100:103], a[148:151], a[196:199], v[100:103]
    s_waitcnt lgkmcnt(4)
    ds_read_b128 a[172:175], v19 offset:19456
    v_cvt_pk_bf16_f32 v57, v114, v115
    v_mfma_f32_16x16x32_bf16 v[100:103], a[152:155], a[200:203], v[100:103]
    s_waitcnt lgkmcnt(4)
    v_exp_f32 v116, v116
    v_mfma_f32_16x16x32_bf16 v[100:103], a[156:159], a[204:207], v[100:103]
    buffer_store_dwordx4 v[24:27], v17, s[8:11], s27 offen offset:0 sc0 sc1
    v_mfma_f32_16x16x32_bf16 v[108:111], a[144:147], a[208:211], v[68:71]
    s_add_u32 s27, s18, 131072
    v_exp_f32 v117, v117
    v_mfma_f32_16x16x32_bf16 v[108:111], a[148:151], a[212:215], v[108:111]
    ds_read_b128 a[176:179], v20 offset:20480
    v_cvt_pk_bf16_f32 v58, v116, v117
    v_mfma_f32_16x16x32_bf16 v[108:111], a[152:155], a[216:219], v[108:111]
    v_exp_f32 v118, v118
    v_mfma_f32_16x16x32_bf16 v[108:111], a[156:159], a[220:223], v[108:111]
    buffer_store_dwordx4 v[24:27], v17, s[8:11], s27 offen offset:0 sc0 sc1
    v_mfma_f32_16x16x32_bf16 v[32:35], v[28:31], v[48:51], v[32:35]
    v_exp_f32 v119, v119
    v_mfma_f32_16x16x32_bf16 v[36:39], v[28:31], v[52:55], v[36:39]
    s_waitcnt lgkmcnt(4)
    ds_read_b128 a[180:183], v20 offset:21504
    v_cvt_pk_bf16_f32 v59, v118, v119
    v_mfma_f32_16x16x32_bf16 v[128:131], a[160:163], v[48:51], v[128:131]
    v_exp_f32 v120, v120
    v_mfma_f32_16x16x32_bf16 v[160:163], a[160:163], v[52:55], v[160:163]
    s_waitcnt lgkmcnt(4)
    v_add_u32 v13, v13, v14
    v_mfma_f32_16x16x32_bf16 v[132:135], a[164:167], v[48:51], v[132:135]
    s_lshl_b32 s17, s4, 2
    v_exp_f32 v121, v121
    v_mfma_f32_16x16x32_bf16 v[164:167], a[164:167], v[52:55], v[164:167]
    s_waitcnt lgkmcnt(3)
    s_add_u32 s17, s17, s3
    ds_read_b128 a[184:187], v20 offset:22528
    v_cvt_pk_bf16_f32 v60, v120, v121
    v_mfma_f32_16x16x32_bf16 v[136:139], a[168:171], v[48:51], v[136:139]
    s_lshl_b32 s17, s17, 7
    v_exp_f32 v122, v122
    v_mfma_f32_16x16x32_bf16 v[168:171], a[168:171], v[52:55], v[168:171]
    s_waitcnt lgkmcnt(3)
    v_mfma_f32_16x16x32_bf16 v[140:143], a[172:175], v[48:51], v[140:143]
    s_lshl_b32 s100, s101, 16
    v_exp_f32 v123, v123
    v_mfma_f32_16x16x32_bf16 v[172:175], a[172:175], v[52:55], v[172:175]
    s_waitcnt lgkmcnt(2)
    s_add_u32 s17, s17, s100
    ds_read_b128 a[188:191], v20 offset:23552
    v_cvt_pk_bf16_f32 v61, v122, v123
    v_mfma_f32_16x16x32_bf16 v[144:147], a[176:179], v[48:51], v[144:147]
    s_add_u32 s17, s17, 4194304
    v_exp_f32 v124, v124
    v_mfma_f32_16x16x32_bf16 v[176:179], a[176:179], v[52:55], v[176:179]
    s_waitcnt lgkmcnt(2)
    v_mfma_f32_16x16x32_bf16 v[148:151], a[180:183], v[48:51], v[148:151]
    s_cmp_lt_u32 s101, s26
    s_cselect_b32 s17, s17, 2143285248
    v_exp_f32 v125, v125
    v_mfma_f32_16x16x32_bf16 v[180:183], a[180:183], v[52:55], v[180:183]
    s_waitcnt lgkmcnt(1)
    v_cvt_pk_bf16_f32 v62, v124, v125
    v_xor_b32 v19, 98304, v19
    v_mfma_f32_16x16x32_bf16 v[152:155], a[184:187], v[48:51], v[152:155]
    buffer_store_dwordx4 a[0:3], v12, s[8:11], s17 offen sc0 sc1
    v_exp_f32 v126, v126
    v_mfma_f32_16x16x32_bf16 v[184:187], a[184:187], v[52:55], v[184:187]
    s_waitcnt lgkmcnt(0)
    v_xor_b32 v20, 98304, v20
    v_mfma_f32_16x16x32_bf16 v[156:159], a[188:191], v[48:51], v[156:159]
    v_exp_f32 v127, v127
    v_mfma_f32_16x16x32_bf16 v[188:191], a[188:191], v[52:55], v[188:191]
    v_cvt_pk_bf16_f32 v63, v126, v127
    v_mfma_f32_16x16x32_bf16 v[112:115], a[128:131], a[224:227], v[72:75]
    s_add_u32 s17, s17, 4096
    v_exp_f32 v96, v96
    v_mfma_f32_16x16x32_bf16 v[112:115], a[132:135], a[228:231], v[112:115]
    buffer_store_dwordx4 a[4:7], v12, s[8:11], s17 offen sc0 sc1
    v_mfma_f32_16x16x32_bf16 v[112:115], a[136:139], a[232:235], v[112:115]
    s_add_u32 s27, s18, 0
    v_exp_f32 v97, v97
    v_mfma_f32_16x16x32_bf16 v[112:115], a[140:143], a[236:239], v[112:115]
    v_cvt_pk_bf16_f32 v48, v96, v97
    v_lshrrev_b32 v9, 1, v2
    v_mfma_f32_16x16x32_bf16 v[120:123], a[128:131], a[240:243], v[76:79]
    v_exp_f32 v98, v98
    v_mfma_f32_16x16x32_bf16 v[120:123], a[132:135], a[244:247], v[120:123]
    buffer_store_dwordx4 v[24:27], v17, s[8:11], s27 offen offset:256 sc0 sc1
    v_mfma_f32_16x16x32_bf16 v[120:123], a[136:139], a[248:251], v[120:123]
    s_add_u32 s27, s18, 131072
    v_exp_f32 v99, v99
    v_mfma_f32_16x16x32_bf16 v[120:123], a[140:143], a[252:255], v[120:123]
    buffer_store_dwordx4 v[24:27], v17, s[8:11], s27 offen offset:256 sc0 sc1
    v_mfma_f32_16x16x32_bf16 v[116:119], a[144:147], a[224:227], v[72:75]
    s_add_u32 s27, s18, 0
    v_exp_f32 v100, v100
    v_mfma_f32_16x16x32_bf16 v[116:119], a[148:151], a[228:231], v[116:119]
    ds_read_b128 a[128:131], v18 offset:16384
    v_cvt_pk_bf16_f32 v49, v98, v99
    v_mfma_f32_16x16x32_bf16 v[116:119], a[152:155], a[232:235], v[116:119]
    s_add_u32 s19, s82, 32768
    v_exp_f32 v101, v101
    v_mfma_f32_16x16x32_bf16 v[116:119], a[156:159], a[236:239], v[116:119]
    s_sub_u32 s82, s12, s13
    ds_read_b128 a[132:135], v18 offset:17408
    v_cvt_pk_bf16_f32 v50, v100, v101
    v_mfma_f32_16x16x32_bf16 v[124:127], a[144:147], a[240:243], v[76:79]
    s_sub_u32 s82, s82, 1
    v_exp_f32 v102, v102
    v_mfma_f32_16x16x32_bf16 v[124:127], a[148:151], a[244:247], v[124:127]
    s_cmp_gt_u32 s12, s13
    s_cselect_b32 s82, s82, s12
    s_mul_i32 s82, s82, 65536
    ds_read_b128 a[136:139], v18 offset:18432
    v_mfma_f32_16x16x32_bf16 v[124:127], a[152:155], a[248:251], v[124:127]
    s_add_u32 s82, s82, s81
    v_exp_f32 v103, v103
    v_mfma_f32_16x16x32_bf16 v[124:127], a[156:159], a[252:255], v[124:127]
    s_cmp_ge_u32 s12, 17
    s_cselect_b32 s82, 2147471360, s82
    ds_read_b128 a[140:143], v18 offset:19456
    v_cvt_pk_bf16_f32 v51, v102, v103
    v_mfma_f32_16x16x32_bf16 v[40:43], v[28:31], v[56:59], v[40:43]
    s_add_u32 s12, s12, 1
    v_exp_f32 v104, v104
    v_mfma_f32_16x16x32_bf16 v[44:47], v[28:31], v[60:63], v[44:47]
    ds_read_b128 a[144:147], v18 offset:20480
    v_lshrrev_b32 v10, 4, v2
    v_mfma_f32_16x16x32_bf16 v[192:195], a[160:163], v[56:59], v[192:195]
    v_exp_f32 v105, v105
    v_mfma_f32_16x16x32_bf16 v[224:227], a[160:163], v[60:63], v[224:227]
    ds_read_b128 a[148:151], v18 offset:21504
    v_cvt_pk_bf16_f32 v52, v104, v105
    v_mfma_f32_16x16x32_bf16 v[196:199], a[164:167], v[56:59], v[196:199]
    v_exp_f32 v106, v106
    v_mfma_f32_16x16x32_bf16 v[228:231], a[164:167], v[60:63], v[228:231]
    ds_read_b128 a[152:155], v18 offset:22528
    v_xor_b32 v9, v9, v10
    v_mfma_f32_16x16x32_bf16 v[200:203], a[168:171], v[56:59], v[200:203]
    v_exp_f32 v107, v107
    v_mfma_f32_16x16x32_bf16 v[232:235], a[168:171], v[60:63], v[232:235]
    ds_read_b128 a[156:159], v18 offset:23552
    v_cvt_pk_bf16_f32 v53, v106, v107
    v_mfma_f32_16x16x32_bf16 v[204:207], a[172:175], v[56:59], v[204:207]
    v_exp_f32 v108, v108
    v_mfma_f32_16x16x32_bf16 v[236:239], a[172:175], v[60:63], v[236:239]
    buffer_store_dwordx4 v[24:27], v17, s[8:11], s27 offen offset:512 sc0 sc1
    v_mfma_f32_16x16x32_bf16 v[208:211], a[176:179], v[56:59], v[208:211]
    s_add_u32 s27, s18, 131072
    v_exp_f32 v109, v109
    v_mfma_f32_16x16x32_bf16 v[240:243], a[176:179], v[60:63], v[240:243]
    v_cvt_pk_bf16_f32 v54, v108, v109
    v_xor_b32 v18, 196608, v18
    v_mfma_f32_16x16x32_bf16 v[212:215], a[180:183], v[56:59], v[212:215]
    v_exp_f32 v110, v110
    v_mfma_f32_16x16x32_bf16 v[244:247], a[180:183], v[60:63], v[244:247]
    buffer_store_dwordx4 v[24:27], v17, s[8:11], s27 offen offset:512 sc0 sc1
    v_mfma_f32_16x16x32_bf16 v[216:219], a[184:187], v[56:59], v[216:219]
    s_add_u32 s27, s18, 0
    v_exp_f32 v111, v111
    v_mfma_f32_16x16x32_bf16 v[248:251], a[184:187], v[60:63], v[248:251]
    v_cvt_pk_bf16_f32 v55, v110, v111
    v_and_b32 v9, 3, v9
    v_mfma_f32_16x16x32_bf16 v[220:223], a[188:191], v[56:59], v[220:223]
    buffer_store_dwordx4 v[24:27], v17, s[8:11], s27 offen offset:768 sc0 sc1
    v_mfma_f32_16x16x32_bf16 v[252:255], a[188:191], v[60:63], v[252:255]
    v_lshlrev_b32 v9, 5, v9
    v_and_b32 v10, 1, v2
    v_lshl_add_u32 v9, v10, 4, v9
    v_lshrrev_b32 v8, 3, v2
    s_waitcnt vmcnt(9) lgkmcnt(0)
    s_barrier
    buffer_store_dword v6, v5, s[8:11], s22 offen sc0 sc1
    v_mfma_f32_16x16x32_bf16 v[96:99], a[128:131], a[192:195], v[64:67]
    s_add_u32 m0, s15, 0
    ds_read_b128 a[160:163], v19 offset:0
    v_mfma_f32_16x16x32_bf16 v[96:99], a[132:135], a[196:199], v[96:99]
    ds_read_b128 a[164:167], v19 offset:1024
    v_mfma_f32_16x16x32_bf16 v[96:99], a[136:139], a[200:203], v[96:99]
    v_exp_f32 v112, v112
    v_mfma_f32_16x16x32_bf16 v[96:99], a[140:143], a[204:207], v[96:99]
    buffer_load_dwordx4 v1, s[8:11], s82 offen offset:0  lds
    v_mfma_f32_16x16x32_bf16 v[104:107], a[128:131], a[208:211], v[68:71]
    v_exp_f32 v113, v113
    v_mfma_f32_16x16x32_bf16 v[104:107], a[132:135], a[212:215], v[104:107]
    ds_read_b128 a[168:171], v19 offset:2048
    v_cvt_pk_bf16_f32 v56, v112, v113
    v_mfma_f32_16x16x32_bf16 v[104:107], a[136:139], a[216:219], v[104:107]
    v_exp_f32 v114, v114
    v_mfma_f32_16x16x32_bf16 v[104:107], a[140:143], a[220:223], v[104:107]
    buffer_load_dwordx4 v1, s[8:11], s82 offen offset:1024  lds
    v_mfma_f32_16x16x32_bf16 v[100:103], a[144:147], a[192:195], v[64:67]
    v_exp_f32 v115, v115
    v_mfma_f32_16x16x32_bf16 v[100:103], a[148:151], a[196:199], v[100:103]
    ds_read_b128 a[172:175], v19 offset:3072
    v_cvt_pk_bf16_f32 v57, v114, v115
    v_mfma_f32_16x16x32_bf16 v[100:103], a[152:155], a[200:203], v[100:103]
    v_exp_f32 v116, v116
    v_mfma_f32_16x16x32_bf16 v[100:103], a[156:159], a[204:207], v[100:103]
    buffer_load_dwordx4 v1, s[8:11], s82 offen offset:2048  lds
    v_mfma_f32_16x16x32_bf16 v[108:111], a[144:147], a[208:211], v[68:71]
    v_exp_f32 v117, v117
    v_mfma_f32_16x16x32_bf16 v[108:111], a[148:151], a[212:215], v[108:111]
    ds_read_b128 a[176:179], v20 offset:4096
    v_cvt_pk_bf16_f32 v58, v116, v117
    v_mfma_f32_16x16x32_bf16 v[108:111], a[152:155], a[216:219], v[108:111]
    v_exp_f32 v118, v118
    v_mfma_f32_16x16x32_bf16 v[108:111], a[156:159], a[220:223], v[108:111]
    buffer_load_dwordx4 v1, s[8:11], s82 offen offset:3072  lds
    v_mfma_f32_16x16x32_bf16 v[32:35], v[28:31], v[48:51], v[32:35]
    s_add_u32 m0, s15, 4096
    v_exp_f32 v119, v119
    v_mfma_f32_16x16x32_bf16 v[36:39], v[28:31], v[52:55], v[36:39]
    s_waitcnt lgkmcnt(4)
    ds_read_b128 a[180:183], v20 offset:5120
    v_cvt_pk_bf16_f32 v59, v118, v119
    v_mfma_f32_16x16x32_bf16 v[128:131], a[160:163], v[48:51], v[128:131]
    s_waitcnt lgkmcnt(4)
    v_exp_f32 v120, v120
    v_mfma_f32_16x16x32_bf16 v[160:163], a[160:163], v[52:55], v[160:163]
    buffer_load_dwordx4 v15, s[8:11], s82 offen offset:0  lds
    v_mfma_f32_16x16x32_bf16 v[132:135], a[164:167], v[48:51], v[132:135]
    v_exp_f32 v121, v121
    v_mfma_f32_16x16x32_bf16 v[164:167], a[164:167], v[52:55], v[164:167]
    s_waitcnt lgkmcnt(3)
    ds_read_b128 a[184:187], v20 offset:6144
    v_cvt_pk_bf16_f32 v60, v120, v121
    v_mfma_f32_16x16x32_bf16 v[136:139], a[168:171], v[48:51], v[136:139]
    s_waitcnt lgkmcnt(3)
    v_exp_f32 v122, v122
    v_mfma_f32_16x16x32_bf16 v[168:171], a[168:171], v[52:55], v[168:171]
    buffer_load_dwordx4 v15, s[8:11], s82 offen offset:1024  lds
    v_mfma_f32_16x16x32_bf16 v[140:143], a[172:175], v[48:51], v[140:143]
    v_exp_f32 v123, v123
    v_mfma_f32_16x16x32_bf16 v[172:175], a[172:175], v[52:55], v[172:175]
    s_waitcnt lgkmcnt(2)
    ds_read_b128 a[188:191], v20 offset:7168
    v_cvt_pk_bf16_f32 v61, v122, v123
    v_mfma_f32_16x16x32_bf16 v[144:147], a[176:179], v[48:51], v[144:147]
    s_waitcnt lgkmcnt(2)
    v_exp_f32 v124, v124
    v_mfma_f32_16x16x32_bf16 v[176:179], a[176:179], v[52:55], v[176:179]
    buffer_load_dwordx4 v15, s[8:11], s82 offen offset:2048  lds
    v_mfma_f32_16x16x32_bf16 v[148:151], a[180:183], v[48:51], v[148:151]
    v_exp_f32 v125, v125
    v_mfma_f32_16x16x32_bf16 v[180:183], a[180:183], v[52:55], v[180:183]
    s_waitcnt lgkmcnt(1)
    v_cvt_pk_bf16_f32 v62, v124, v125
    v_mfma_f32_16x16x32_bf16 v[152:155], a[184:187], v[48:51], v[152:155]
    s_waitcnt lgkmcnt(0)
    v_exp_f32 v126, v126
    v_mfma_f32_16x16x32_bf16 v[184:187], a[184:187], v[52:55], v[184:187]
    buffer_load_dwordx4 v15, s[8:11], s82 offen offset:3072  lds
    v_mfma_f32_16x16x32_bf16 v[156:159], a[188:191], v[48:51], v[156:159]
    s_xor_b32 s15, s15, 196608
    v_exp_f32 v127, v127
    v_mfma_f32_16x16x32_bf16 v[188:191], a[188:191], v[52:55], v[188:191]
    s_add_u32 m0, s16, 0
    v_cvt_pk_bf16_f32 v63, v126, v127
    v_mfma_f32_16x16x32_bf16 v[112:115], a[128:131], a[224:227], v[72:75]
    v_mfma_f32_16x16x32_bf16 v[112:115], a[132:135], a[228:231], v[112:115]
    v_mfma_f32_16x16x32_bf16 v[112:115], a[136:139], a[232:235], v[112:115]
    v_exp_f32 v96, v96
    v_mfma_f32_16x16x32_bf16 v[112:115], a[140:143], a[236:239], v[112:115]
    buffer_load_dwordx4 v1, s[8:11], s19 offen offset:0  lds
    v_mfma_f32_16x16x32_bf16 v[120:123], a[128:131], a[240:243], v[76:79]
    v_exp_f32 v97, v97
    v_mfma_f32_16x16x32_bf16 v[120:123], a[132:135], a[244:247], v[120:123]
    ds_read_b128 a[128:131], v18 offset:0
    v_cvt_pk_bf16_f32 v48, v96, v97
    v_mfma_f32_16x16x32_bf16 v[120:123], a[136:139], a[248:251], v[120:123]
    v_exp_f32 v98, v98
    v_mfma_f32_16x16x32_bf16 v[120:123], a[140:143], a[252:255], v[120:123]
    buffer_load_dwordx4 v1, s[8:11], s19 offen offset:1024  lds
    v_mfma_f32_16x16x32_bf16 v[116:119], a[144:147], a[224:227], v[72:75]
    v_exp_f32 v99, v99
    v_mfma_f32_16x16x32_bf16 v[116:119], a[148:151], a[228:231], v[116:119]
    ds_read_b128 a[132:135], v18 offset:1024
    v_cvt_pk_bf16_f32 v49, v98, v99
    v_mfma_f32_16x16x32_bf16 v[116:119], a[152:155], a[232:235], v[116:119]
    v_exp_f32 v100, v100
    v_mfma_f32_16x16x32_bf16 v[116:119], a[156:159], a[236:239], v[116:119]
    buffer_load_dwordx4 v1, s[8:11], s19 offen offset:2048  lds
    v_mfma_f32_16x16x32_bf16 v[124:127], a[144:147], a[240:243], v[76:79]
    v_exp_f32 v101, v101
    v_mfma_f32_16x16x32_bf16 v[124:127], a[148:151], a[244:247], v[124:127]
    ds_read_b128 a[136:139], v18 offset:2048
    v_cvt_pk_bf16_f32 v50, v100, v101
    v_mfma_f32_16x16x32_bf16 v[124:127], a[152:155], a[248:251], v[124:127]
    v_exp_f32 v102, v102
    v_mfma_f32_16x16x32_bf16 v[124:127], a[156:159], a[252:255], v[124:127]
    buffer_load_dwordx4 v1, s[8:11], s19 offen offset:3072  lds
    v_mfma_f32_16x16x32_bf16 v[40:43], v[28:31], v[56:59], v[40:43]
    s_add_u32 m0, s16, 4096
    v_exp_f32 v103, v103
    v_mfma_f32_16x16x32_bf16 v[44:47], v[28:31], v[60:63], v[44:47]
    ds_read_b128 a[140:143], v18 offset:3072
    v_cvt_pk_bf16_f32 v51, v102, v103
    v_mfma_f32_16x16x32_bf16 v[192:195], a[160:163], v[56:59], v[192:195]
    v_exp_f32 v104, v104
    v_mfma_f32_16x16x32_bf16 v[224:227], a[160:163], v[60:63], v[224:227]
    buffer_load_dwordx4 v15, s[8:11], s19 offen offset:0  lds
    v_mfma_f32_16x16x32_bf16 v[196:199], a[164:167], v[56:59], v[196:199]
    v_exp_f32 v105, v105
    v_mfma_f32_16x16x32_bf16 v[228:231], a[164:167], v[60:63], v[228:231]
    ds_read_b128 a[144:147], v18 offset:4096
    v_cvt_pk_bf16_f32 v52, v104, v105
    v_mfma_f32_16x16x32_bf16 v[200:203], a[168:171], v[56:59], v[200:203]
    v_exp_f32 v106, v106
    v_mfma_f32_16x16x32_bf16 v[232:235], a[168:171], v[60:63], v[232:235]
    buffer_load_dwordx4 v15, s[8:11], s19 offen offset:1024  lds
    v_mfma_f32_16x16x32_bf16 v[204:207], a[172:175], v[56:59], v[204:207]
    v_exp_f32 v107, v107
    v_mfma_f32_16x16x32_bf16 v[236:239], a[172:175], v[60:63], v[236:239]
    ds_read_b128 a[148:151], v18 offset:5120
    v_cvt_pk_bf16_f32 v53, v106, v107
    v_mfma_f32_16x16x32_bf16 v[208:211], a[176:179], v[56:59], v[208:211]
    v_exp_f32 v108, v108
    v_mfma_f32_16x16x32_bf16 v[240:243], a[176:179], v[60:63], v[240:243]
    buffer_load_dwordx4 v15, s[8:11], s19 offen offset:2048  lds
    v_mfma_f32_16x16x32_bf16 v[212:215], a[180:183], v[56:59], v[212:215]
    v_exp_f32 v109, v109
    v_mfma_f32_16x16x32_bf16 v[244:247], a[180:183], v[60:63], v[244:247]
    ds_read_b128 a[152:155], v18 offset:6144
    v_cvt_pk_bf16_f32 v54, v108, v109
    v_mfma_f32_16x16x32_bf16 v[216:219], a[184:187], v[56:59], v[216:219]
    v_exp_f32 v110, v110
    v_mfma_f32_16x16x32_bf16 v[248:251], a[184:187], v[60:63], v[248:251]
    buffer_load_dwordx4 v15, s[8:11], s19 offen offset:3072  lds
    v_mfma_f32_16x16x32_bf16 v[220:223], a[188:191], v[56:59], v[220:223]
    s_xor_b32 s16, s16, 98304
    v_exp_f32 v111, v111
    v_mfma_f32_16x16x32_bf16 v[252:255], a[188:191], v[60:63], v[252:255]
    ds_read_b128 a[156:159], v18 offset:7168
    v_cvt_pk_bf16_f32 v55, v110, v111
    s_waitcnt lgkmcnt(7)
    v_mfma_f32_16x16x32_bf16 v[96:99], a[128:131], a[192:195], v[64:67]
    s_waitcnt lgkmcnt(6)
    ds_read_b128 a[160:163], v19 offset:16384
    v_mfma_f32_16x16x32_bf16 v[96:99], a[132:135], a[196:199], v[96:99]
    s_waitcnt lgkmcnt(6)
    ds_read_b128 a[164:167], v19 offset:17408
    v_mfma_f32_16x16x32_bf16 v[96:99], a[136:139], a[200:203], v[96:99]
    s_waitcnt lgkmcnt(6)
    v_exp_f32 v112, v112
    v_mfma_f32_16x16x32_bf16 v[96:99], a[140:143], a[204:207], v[96:99]
    v_mfma_f32_16x16x32_bf16 v[104:107], a[128:131], a[208:211], v[68:71]
    v_exp_f32 v113, v113
    v_mfma_f32_16x16x32_bf16 v[104:107], a[132:135], a[212:215], v[104:107]
    ds_read_b128 a[168:171], v19 offset:18432
    v_cvt_pk_bf16_f32 v56, v112, v113
    v_mfma_f32_16x16x32_bf16 v[104:107], a[136:139], a[216:219], v[104:107]
    v_exp_f32 v114, v114
    v_mfma_f32_16x16x32_bf16 v[104:107], a[140:143], a[220:223], v[104:107]
    s_waitcnt lgkmcnt(6)
    v_mfma_f32_16x16x32_bf16 v[100:103], a[144:147], a[192:195], v[64:67]
    s_waitcnt lgkmcnt(5)
    s_add_u32 s17, s17, 2093056
    v_exp_f32 v115, v115
    v_mfma_f32_16x16x32_bf16 v[100:103], a[148:151], a[196:199], v[100:103]
    s_waitcnt lgkmcnt(4)
    ds_read_b128 a[172:175], v19 offset:19456
    v_cvt_pk_bf16_f32 v57, v114, v115
    v_mfma_f32_16x16x32_bf16 v[100:103], a[152:155], a[200:203], v[100:103]
    s_waitcnt lgkmcnt(4)
    v_exp_f32 v116, v116
    v_mfma_f32_16x16x32_bf16 v[100:103], a[156:159], a[204:207], v[100:103]
    buffer_store_dwordx4 a[8:11], v12, s[8:11], s17 offen sc0 sc1
    v_mfma_f32_16x16x32_bf16 v[108:111], a[144:147], a[208:211], v[68:71]
    s_add_u32 s27, s18, 131072
    v_exp_f32 v117, v117
    v_mfma_f32_16x16x32_bf16 v[108:111], a[148:151], a[212:215], v[108:111]
    ds_read_b128 a[176:179], v20 offset:20480
    v_cvt_pk_bf16_f32 v58, v116, v117
    v_mfma_f32_16x16x32_bf16 v[108:111], a[152:155], a[216:219], v[108:111]
    v_exp_f32 v118, v118
    v_mfma_f32_16x16x32_bf16 v[108:111], a[156:159], a[220:223], v[108:111]
    buffer_store_dwordx4 v[24:27], v17, s[8:11], s27 offen offset:768 sc0 sc1
    v_mfma_f32_16x16x32_bf16 v[32:35], v[28:31], v[48:51], v[32:35]
    s_add_u32 s27, s18, 8388608
    v_exp_f32 v119, v119
    v_mfma_f32_16x16x32_bf16 v[36:39], v[28:31], v[52:55], v[36:39]
    s_waitcnt lgkmcnt(4)
    ds_read_b128 a[180:183], v20 offset:21504
    v_cvt_pk_bf16_f32 v59, v118, v119
    v_mfma_f32_16x16x32_bf16 v[128:131], a[160:163], v[48:51], v[128:131]
    s_waitcnt lgkmcnt(4)
    v_exp_f32 v120, v120
    v_mfma_f32_16x16x32_bf16 v[160:163], a[160:163], v[52:55], v[160:163]
    buffer_store_dwordx4 v[24:27], v17, s[8:11], s27 offen offset:0 sc0 sc1
    v_mfma_f32_16x16x32_bf16 v[132:135], a[164:167], v[48:51], v[132:135]
    s_add_u32 s27, s18, 8519680
    v_exp_f32 v121, v121
    v_mfma_f32_16x16x32_bf16 v[164:167], a[164:167], v[52:55], v[164:167]
    s_waitcnt lgkmcnt(3)
    ds_read_b128 a[184:187], v20 offset:22528
    v_cvt_pk_bf16_f32 v60, v120, v121
    v_mfma_f32_16x16x32_bf16 v[136:139], a[168:171], v[48:51], v[136:139]
    s_waitcnt lgkmcnt(3)
    v_exp_f32 v122, v122
    v_mfma_f32_16x16x32_bf16 v[168:171], a[168:171], v[52:55], v[168:171]
    buffer_store_dwordx4 v[24:27], v17, s[8:11], s27 offen offset:0 sc0 sc1
    v_mfma_f32_16x16x32_bf16 v[140:143], a[172:175], v[48:51], v[140:143]
    v_exp_f32 v123, v123
    v_mfma_f32_16x16x32_bf16 v[172:175], a[172:175], v[52:55], v[172:175]
    s_waitcnt lgkmcnt(2)
    ds_read_b128 a[188:191], v20 offset:23552
    v_cvt_pk_bf16_f32 v61, v122, v123
    v_mfma_f32_16x16x32_bf16 v[144:147], a[176:179], v[48:51], v[144:147]
    v_exp_f32 v124, v124
    v_mfma_f32_16x16x32_bf16 v[176:179], a[176:179], v[52:55], v[176:179]
    s_waitcnt lgkmcnt(2)
    v_mfma_f32_16x16x32_bf16 v[148:151], a[180:183], v[48:51], v[148:151]
    v_exp_f32 v125, v125
    v_mfma_f32_16x16x32_bf16 v[180:183], a[180:183], v[52:55], v[180:183]
    s_waitcnt lgkmcnt(1)
    v_cvt_pk_bf16_f32 v62, v124, v125
    v_xor_b32 v19, 98304, v19
    v_mfma_f32_16x16x32_bf16 v[152:155], a[184:187], v[48:51], v[152:155]
    v_exp_f32 v126, v126
    v_mfma_f32_16x16x32_bf16 v[184:187], a[184:187], v[52:55], v[184:187]
    s_waitcnt lgkmcnt(0)
    v_xor_b32 v20, 98304, v20
    v_mfma_f32_16x16x32_bf16 v[156:159], a[188:191], v[48:51], v[156:159]
    v_exp_f32 v127, v127
    v_mfma_f32_16x16x32_bf16 v[188:191], a[188:191], v[52:55], v[188:191]
    v_cvt_pk_bf16_f32 v63, v126, v127
    v_mfma_f32_16x16x32_bf16 v[112:115], a[128:131], a[224:227], v[72:75]
    s_add_u32 s17, s17, 4096
    v_exp_f32 v96, v96
    v_mfma_f32_16x16x32_bf16 v[112:115], a[132:135], a[228:231], v[112:115]
    buffer_store_dwordx4 a[12:15], v12, s[8:11], s17 offen sc0 sc1
    v_mfma_f32_16x16x32_bf16 v[112:115], a[136:139], a[232:235], v[112:115]
    s_add_u32 s27, s18, 8388608
    v_exp_f32 v97, v97
    v_mfma_f32_16x16x32_bf16 v[112:115], a[140:143], a[236:239], v[112:115]
    v_cvt_pk_bf16_f32 v48, v96, v97
    v_lshl_add_u32 v8, v8, 10, v9
    v_mfma_f32_16x16x32_bf16 v[120:123], a[128:131], a[240:243], v[76:79]
    v_exp_f32 v98, v98
    v_mfma_f32_16x16x32_bf16 v[120:123], a[132:135], a[244:247], v[120:123]
    buffer_store_dwordx4 v[24:27], v17, s[8:11], s27 offen offset:256 sc0 sc1
    v_mfma_f32_16x16x32_bf16 v[120:123], a[136:139], a[248:251], v[120:123]
    s_add_u32 s27, s18, 8519680
    v_exp_f32 v99, v99
    v_mfma_f32_16x16x32_bf16 v[120:123], a[140:143], a[252:255], v[120:123]
    buffer_store_dwordx4 v[24:27], v17, s[8:11], s27 offen offset:256 sc0 sc1
    v_mfma_f32_16x16x32_bf16 v[116:119], a[144:147], a[224:227], v[72:75]
    s_add_u32 s27, s18, 8388608
    v_exp_f32 v100, v100
    v_mfma_f32_16x16x32_bf16 v[116:119], a[148:151], a[228:231], v[116:119]
    ds_read_b128 a[128:131], v18 offset:16384
    v_cvt_pk_bf16_f32 v49, v98, v99
    v_mfma_f32_16x16x32_bf16 v[116:119], a[152:155], a[232:235], v[116:119]
    s_add_u32 s19, s82, 32768
    v_exp_f32 v101, v101
    v_mfma_f32_16x16x32_bf16 v[116:119], a[156:159], a[236:239], v[116:119]
    s_sub_u32 s82, s12, s13
    ds_read_b128 a[132:135], v18 offset:17408
    v_cvt_pk_bf16_f32 v50, v100, v101
    v_mfma_f32_16x16x32_bf16 v[124:127], a[144:147], a[240:243], v[76:79]
    s_sub_u32 s82, s82, 1
    v_exp_f32 v102, v102
    v_mfma_f32_16x16x32_bf16 v[124:127], a[148:151], a[244:247], v[124:127]
    s_cmp_gt_u32 s12, s13
    s_cselect_b32 s82, s82, s12
    s_mul_i32 s82, s82, 65536
    ds_read_b128 a[136:139], v18 offset:18432
    v_mfma_f32_16x16x32_bf16 v[124:127], a[152:155], a[248:251], v[124:127]
    s_add_u32 s82, s82, s81
    v_exp_f32 v103, v103
    v_mfma_f32_16x16x32_bf16 v[124:127], a[156:159], a[252:255], v[124:127]
    s_cmp_ge_u32 s12, 17
    s_cselect_b32 s82, 2147471360, s82
    ds_read_b128 a[140:143], v18 offset:19456
    v_cvt_pk_bf16_f32 v51, v102, v103
    v_mfma_f32_16x16x32_bf16 v[40:43], v[28:31], v[56:59], v[40:43]
    s_add_u32 s12, s12, 1
    v_exp_f32 v104, v104
    v_mfma_f32_16x16x32_bf16 v[44:47], v[28:31], v[60:63], v[44:47]
    ds_read_b128 a[144:147], v18 offset:20480
    v_bfe_u32 v4, v2, 1, 2
    v_mfma_f32_16x16x32_bf16 v[192:195], a[160:163], v[56:59], v[192:195]
    v_exp_f32 v105, v105
    v_mfma_f32_16x16x32_bf16 v[224:227], a[160:163], v[60:63], v[224:227]
    ds_read_b128 a[148:151], v18 offset:21504
    v_cvt_pk_bf16_f32 v52, v104, v105
    v_mfma_f32_16x16x32_bf16 v[196:199], a[164:167], v[56:59], v[196:199]
    v_exp_f32 v106, v106
    v_mfma_f32_16x16x32_bf16 v[228:231], a[164:167], v[60:63], v[228:231]
    ds_read_b128 a[152:155], v18 offset:22528
    v_lshlrev_b32 v4, 11, v4
    v_mfma_f32_16x16x32_bf16 v[200:203], a[168:171], v[56:59], v[200:203]
    v_exp_f32 v107, v107
    v_mfma_f32_16x16x32_bf16 v[232:235], a[168:171], v[60:63], v[232:235]
    ds_read_b128 a[156:159], v18 offset:23552
    v_cvt_pk_bf16_f32 v53, v106, v107
    v_mfma_f32_16x16x32_bf16 v[204:207], a[172:175], v[56:59], v[204:207]
    v_exp_f32 v108, v108
    v_mfma_f32_16x16x32_bf16 v[236:239], a[172:175], v[60:63], v[236:239]
    buffer_store_dwordx4 v[24:27], v17, s[8:11], s27 offen offset:512 sc0 sc1
    v_mfma_f32_16x16x32_bf16 v[208:211], a[176:179], v[56:59], v[208:211]
    s_add_u32 s27, s18, 8519680
    v_exp_f32 v109, v109
    v_mfma_f32_16x16x32_bf16 v[240:243], a[176:179], v[60:63], v[240:243]
    v_cvt_pk_bf16_f32 v54, v108, v109
    v_xor_b32 v18, 196608, v18
    v_mfma_f32_16x16x32_bf16 v[212:215], a[180:183], v[56:59], v[212:215]
    v_exp_f32 v110, v110
    v_mfma_f32_16x16x32_bf16 v[244:247], a[180:183], v[60:63], v[244:247]
    buffer_store_dwordx4 v[24:27], v17, s[8:11], s27 offen offset:512 sc0 sc1
    v_mfma_f32_16x16x32_bf16 v[216:219], a[184:187], v[56:59], v[216:219]
    v_exp_f32 v111, v111
    v_mfma_f32_16x16x32_bf16 v[248:251], a[184:187], v[60:63], v[248:251]
    v_cvt_pk_bf16_f32 v55, v110, v111
    v_lshl_add_u32 v4, v10, 6, v4
    v_mfma_f32_16x16x32_bf16 v[220:223], a[188:191], v[56:59], v[220:223]
    v_add_u32 v9, 7168, v8
    v_add_u32 v10, 14336, v8
    v_mfma_f32_16x16x32_bf16 v[252:255], a[188:191], v[60:63], v[252:255]
    v_add_u32 v11, 21504, v8
    s_waitcnt vmcnt(9) lgkmcnt(0)
    s_barrier
    v_mfma_f32_16x16x32_bf16 v[96:99], a[128:131], a[192:195], v[64:67]
    s_add_u32 m0, s15, 0
    ds_read_b128 a[160:163], v19 offset:0
    v_mfma_f32_16x16x32_bf16 v[96:99], a[132:135], a[196:199], v[96:99]
    ds_read_b128 a[164:167], v19 offset:1024
    v_mfma_f32_16x16x32_bf16 v[96:99], a[136:139], a[200:203], v[96:99]
    v_exp_f32 v112, v112
    v_mfma_f32_16x16x32_bf16 v[96:99], a[140:143], a[204:207], v[96:99]
    buffer_load_dwordx4 v1, s[8:11], s82 offen offset:0  lds
    v_mfma_f32_16x16x32_bf16 v[104:107], a[128:131], a[208:211], v[68:71]
    v_exp_f32 v113, v113
    v_mfma_f32_16x16x32_bf16 v[104:107], a[132:135], a[212:215], v[104:107]
    ds_read_b128 a[168:171], v19 offset:2048
    v_cvt_pk_bf16_f32 v56, v112, v113
    v_mfma_f32_16x16x32_bf16 v[104:107], a[136:139], a[216:219], v[104:107]
    v_exp_f32 v114, v114
    v_mfma_f32_16x16x32_bf16 v[104:107], a[140:143], a[220:223], v[104:107]
    buffer_load_dwordx4 v1, s[8:11], s82 offen offset:1024  lds
    v_mfma_f32_16x16x32_bf16 v[100:103], a[144:147], a[192:195], v[64:67]
    v_exp_f32 v115, v115
    v_mfma_f32_16x16x32_bf16 v[100:103], a[148:151], a[196:199], v[100:103]
    ds_read_b128 a[172:175], v19 offset:3072
    v_cvt_pk_bf16_f32 v57, v114, v115
    v_mfma_f32_16x16x32_bf16 v[100:103], a[152:155], a[200:203], v[100:103]
    v_exp_f32 v116, v116
    v_mfma_f32_16x16x32_bf16 v[100:103], a[156:159], a[204:207], v[100:103]
    buffer_load_dwordx4 v1, s[8:11], s82 offen offset:2048  lds
    v_mfma_f32_16x16x32_bf16 v[108:111], a[144:147], a[208:211], v[68:71]
    v_exp_f32 v117, v117
    v_mfma_f32_16x16x32_bf16 v[108:111], a[148:151], a[212:215], v[108:111]
    ds_read_b128 a[176:179], v20 offset:4096
    v_cvt_pk_bf16_f32 v58, v116, v117
    v_mfma_f32_16x16x32_bf16 v[108:111], a[152:155], a[216:219], v[108:111]
    v_exp_f32 v118, v118
    v_mfma_f32_16x16x32_bf16 v[108:111], a[156:159], a[220:223], v[108:111]
    buffer_load_dwordx4 v1, s[8:11], s82 offen offset:3072  lds
    v_mfma_f32_16x16x32_bf16 v[32:35], v[28:31], v[48:51], v[32:35]
    s_add_u32 m0, s15, 4096
    v_exp_f32 v119, v119
    v_mfma_f32_16x16x32_bf16 v[36:39], v[28:31], v[52:55], v[36:39]
    s_waitcnt lgkmcnt(4)
    ds_read_b128 a[180:183], v20 offset:5120
    v_cvt_pk_bf16_f32 v59, v118, v119
    v_mfma_f32_16x16x32_bf16 v[128:131], a[160:163], v[48:51], v[128:131]
    s_waitcnt lgkmcnt(4)
    v_exp_f32 v120, v120
    v_mfma_f32_16x16x32_bf16 v[160:163], a[160:163], v[52:55], v[160:163]
    buffer_load_dwordx4 v15, s[8:11], s82 offen offset:0  lds
    v_mfma_f32_16x16x32_bf16 v[132:135], a[164:167], v[48:51], v[132:135]
    v_exp_f32 v121, v121
    v_mfma_f32_16x16x32_bf16 v[164:167], a[164:167], v[52:55], v[164:167]
    s_waitcnt lgkmcnt(3)
    ds_read_b128 a[184:187], v20 offset:6144
    v_cvt_pk_bf16_f32 v60, v120, v121
    v_mfma_f32_16x16x32_bf16 v[136:139], a[168:171], v[48:51], v[136:139]
    s_waitcnt lgkmcnt(3)
    v_exp_f32 v122, v122
    v_mfma_f32_16x16x32_bf16 v[168:171], a[168:171], v[52:55], v[168:171]
    buffer_load_dwordx4 v15, s[8:11], s82 offen offset:1024  lds
    v_mfma_f32_16x16x32_bf16 v[140:143], a[172:175], v[48:51], v[140:143]
    v_exp_f32 v123, v123
    v_mfma_f32_16x16x32_bf16 v[172:175], a[172:175], v[52:55], v[172:175]
    s_waitcnt lgkmcnt(2)
    ds_read_b128 a[188:191], v20 offset:7168
    v_cvt_pk_bf16_f32 v61, v122, v123
    v_mfma_f32_16x16x32_bf16 v[144:147], a[176:179], v[48:51], v[144:147]
    s_waitcnt lgkmcnt(2)
    v_exp_f32 v124, v124
    v_mfma_f32_16x16x32_bf16 v[176:179], a[176:179], v[52:55], v[176:179]
    buffer_load_dwordx4 v15, s[8:11], s82 offen offset:2048  lds
    v_mfma_f32_16x16x32_bf16 v[148:151], a[180:183], v[48:51], v[148:151]
    v_exp_f32 v125, v125
    v_mfma_f32_16x16x32_bf16 v[180:183], a[180:183], v[52:55], v[180:183]
    s_waitcnt lgkmcnt(1)
    v_cvt_pk_bf16_f32 v62, v124, v125
    v_mfma_f32_16x16x32_bf16 v[152:155], a[184:187], v[48:51], v[152:155]
    s_waitcnt lgkmcnt(0)
    v_exp_f32 v126, v126
    v_mfma_f32_16x16x32_bf16 v[184:187], a[184:187], v[52:55], v[184:187]
    buffer_load_dwordx4 v15, s[8:11], s82 offen offset:3072  lds
    v_mfma_f32_16x16x32_bf16 v[156:159], a[188:191], v[48:51], v[156:159]
    s_xor_b32 s15, s15, 196608
    v_exp_f32 v127, v127
    v_mfma_f32_16x16x32_bf16 v[188:191], a[188:191], v[52:55], v[188:191]
    s_add_u32 m0, s16, 0
    v_cvt_pk_bf16_f32 v63, v126, v127
    v_mfma_f32_16x16x32_bf16 v[112:115], a[128:131], a[224:227], v[72:75]
    v_mfma_f32_16x16x32_bf16 v[112:115], a[132:135], a[228:231], v[112:115]
    v_mfma_f32_16x16x32_bf16 v[112:115], a[136:139], a[232:235], v[112:115]
    v_exp_f32 v96, v96
    v_mfma_f32_16x16x32_bf16 v[112:115], a[140:143], a[236:239], v[112:115]
    buffer_load_dwordx4 v1, s[8:11], s19 offen offset:0  lds
    v_mfma_f32_16x16x32_bf16 v[120:123], a[128:131], a[240:243], v[76:79]
    v_exp_f32 v97, v97
    v_mfma_f32_16x16x32_bf16 v[120:123], a[132:135], a[244:247], v[120:123]
    ds_read_b128 a[128:131], v18 offset:0
    v_cvt_pk_bf16_f32 v48, v96, v97
    v_mfma_f32_16x16x32_bf16 v[120:123], a[136:139], a[248:251], v[120:123]
    v_exp_f32 v98, v98
    v_mfma_f32_16x16x32_bf16 v[120:123], a[140:143], a[252:255], v[120:123]
    buffer_load_dwordx4 v1, s[8:11], s19 offen offset:1024  lds
    v_mfma_f32_16x16x32_bf16 v[116:119], a[144:147], a[224:227], v[72:75]
    v_exp_f32 v99, v99
    v_mfma_f32_16x16x32_bf16 v[116:119], a[148:151], a[228:231], v[116:119]
    ds_read_b128 a[132:135], v18 offset:1024
    v_cvt_pk_bf16_f32 v49, v98, v99
    v_mfma_f32_16x16x32_bf16 v[116:119], a[152:155], a[232:235], v[116:119]
    v_exp_f32 v100, v100
    v_mfma_f32_16x16x32_bf16 v[116:119], a[156:159], a[236:239], v[116:119]
    buffer_load_dwordx4 v1, s[8:11], s19 offen offset:2048  lds
    v_mfma_f32_16x16x32_bf16 v[124:127], a[144:147], a[240:243], v[76:79]
    v_exp_f32 v101, v101
    v_mfma_f32_16x16x32_bf16 v[124:127], a[148:151], a[244:247], v[124:127]
    ds_read_b128 a[136:139], v18 offset:2048
    v_cvt_pk_bf16_f32 v50, v100, v101
    v_mfma_f32_16x16x32_bf16 v[124:127], a[152:155], a[248:251], v[124:127]
    v_exp_f32 v102, v102
    v_mfma_f32_16x16x32_bf16 v[124:127], a[156:159], a[252:255], v[124:127]
    buffer_load_dwordx4 v1, s[8:11], s19 offen offset:3072  lds
    v_mfma_f32_16x16x32_bf16 v[40:43], v[28:31], v[56:59], v[40:43]
    s_add_u32 m0, s16, 4096
    v_exp_f32 v103, v103
    v_mfma_f32_16x16x32_bf16 v[44:47], v[28:31], v[60:63], v[44:47]
    ds_read_b128 a[140:143], v18 offset:3072
    v_cvt_pk_bf16_f32 v51, v102, v103
    v_mfma_f32_16x16x32_bf16 v[192:195], a[160:163], v[56:59], v[192:195]
    v_exp_f32 v104, v104
    v_mfma_f32_16x16x32_bf16 v[224:227], a[160:163], v[60:63], v[224:227]
    buffer_load_dwordx4 v15, s[8:11], s19 offen offset:0  lds
    v_mfma_f32_16x16x32_bf16 v[196:199], a[164:167], v[56:59], v[196:199]
    v_exp_f32 v105, v105
    v_mfma_f32_16x16x32_bf16 v[228:231], a[164:167], v[60:63], v[228:231]
    ds_read_b128 a[144:147], v18 offset:4096
    v_cvt_pk_bf16_f32 v52, v104, v105
    v_mfma_f32_16x16x32_bf16 v[200:203], a[168:171], v[56:59], v[200:203]
    v_exp_f32 v106, v106
    v_mfma_f32_16x16x32_bf16 v[232:235], a[168:171], v[60:63], v[232:235]
    buffer_load_dwordx4 v15, s[8:11], s19 offen offset:1024  lds
    v_mfma_f32_16x16x32_bf16 v[204:207], a[172:175], v[56:59], v[204:207]
    v_exp_f32 v107, v107
    v_mfma_f32_16x16x32_bf16 v[236:239], a[172:175], v[60:63], v[236:239]
    ds_read_b128 a[148:151], v18 offset:5120
    v_cvt_pk_bf16_f32 v53, v106, v107
    v_mfma_f32_16x16x32_bf16 v[208:211], a[176:179], v[56:59], v[208:211]
    v_exp_f32 v108, v108
    v_mfma_f32_16x16x32_bf16 v[240:243], a[176:179], v[60:63], v[240:243]
    buffer_load_dwordx4 v15, s[8:11], s19 offen offset:2048  lds
    v_mfma_f32_16x16x32_bf16 v[212:215], a[180:183], v[56:59], v[212:215]
    v_exp_f32 v109, v109
    v_mfma_f32_16x16x32_bf16 v[244:247], a[180:183], v[60:63], v[244:247]
    ds_read_b128 a[152:155], v18 offset:6144
    v_cvt_pk_bf16_f32 v54, v108, v109
    v_mfma_f32_16x16x32_bf16 v[216:219], a[184:187], v[56:59], v[216:219]
    v_exp_f32 v110, v110
    v_mfma_f32_16x16x32_bf16 v[248:251], a[184:187], v[60:63], v[248:251]
    buffer_load_dwordx4 v15, s[8:11], s19 offen offset:3072  lds
    v_mfma_f32_16x16x32_bf16 v[220:223], a[188:191], v[56:59], v[220:223]
    s_xor_b32 s16, s16, 98304
    v_exp_f32 v111, v111
    v_mfma_f32_16x16x32_bf16 v[252:255], a[188:191], v[60:63], v[252:255]
    ds_read_b128 a[156:159], v18 offset:7168
    v_cvt_pk_bf16_f32 v55, v110, v111
    s_waitcnt lgkmcnt(7)
    v_mfma_f32_16x16x32_bf16 v[96:99], a[128:131], a[192:195], v[64:67]
    s_waitcnt lgkmcnt(6)
    s_mul_i32 s17, s4, 229376
    s_mul_i32 s100, s3, 7168
    ds_read_b128 a[160:163], v19 offset:16384
    v_mfma_f32_16x16x32_bf16 v[96:99], a[132:135], a[196:199], v[96:99]
    s_waitcnt lgkmcnt(6)
    s_add_u32 s17, s17, s100
    s_lshl_b32 s100, s101, 7
    ds_read_b128 a[164:167], v19 offset:17408
    v_mfma_f32_16x16x32_bf16 v[96:99], a[136:139], a[200:203], v[96:99]
    s_waitcnt lgkmcnt(6)
    s_add_u32 s17, s17, s100
    v_exp_f32 v112, v112
    v_mfma_f32_16x16x32_bf16 v[96:99], a[140:143], a[204:207], v[96:99]
    v_mfma_f32_16x16x32_bf16 v[104:107], a[128:131], a[208:211], v[68:71]
    s_add_u32 s17, s17, 8388608
    v_exp_f32 v113, v113
    v_mfma_f32_16x16x32_bf16 v[104:107], a[132:135], a[212:215], v[104:107]
    s_cmp_lt_u32 s101, s26
    s_cselect_b32 s17, s17, 2147479552
    ds_read_b128 a[168:171], v19 offset:18432
    v_cvt_pk_bf16_f32 v56, v112, v113
    v_mfma_f32_16x16x32_bf16 v[104:107], a[136:139], a[216:219], v[104:107]
    s_waitcnt lgkmcnt(6)
    v_exp_f32 v114, v114
    v_mfma_f32_16x16x32_bf16 v[104:107], a[140:143], a[220:223], v[104:107]
    buffer_store_dwordx4 a[16:19], v13, s[8:11], s17 offen sc0 sc1
    v_mfma_f32_16x16x32_bf16 v[100:103], a[144:147], a[192:195], v[64:67]
    s_waitcnt lgkmcnt(5)
    s_add_u32 s27, s18, 8388608
    v_exp_f32 v115, v115
    v_mfma_f32_16x16x32_bf16 v[100:103], a[148:151], a[196:199], v[100:103]
    s_waitcnt lgkmcnt(4)
    ds_read_b128 a[172:175], v19 offset:19456
    v_cvt_pk_bf16_f32 v57, v114, v115
    v_mfma_f32_16x16x32_bf16 v[100:103], a[152:155], a[200:203], v[100:103]
    s_waitcnt lgkmcnt(4)
    v_exp_f32 v116, v116
    v_mfma_f32_16x16x32_bf16 v[100:103], a[156:159], a[204:207], v[100:103]
    buffer_store_dwordx4 v[24:27], v17, s[8:11], s27 offen offset:768 sc0 sc1
    v_mfma_f32_16x16x32_bf16 v[108:111], a[144:147], a[208:211], v[68:71]
    s_add_u32 s27, s18, 8519680
    v_exp_f32 v117, v117
    v_mfma_f32_16x16x32_bf16 v[108:111], a[148:151], a[212:215], v[108:111]
    ds_read_b128 a[176:179], v20 offset:20480
    v_cvt_pk_bf16_f32 v58, v116, v117
    v_mfma_f32_16x16x32_bf16 v[108:111], a[152:155], a[216:219], v[108:111]
    v_exp_f32 v118, v118
    v_mfma_f32_16x16x32_bf16 v[108:111], a[156:159], a[220:223], v[108:111]
    buffer_store_dwordx4 v[24:27], v17, s[8:11], s27 offen offset:768 sc0 sc1
    v_mfma_f32_16x16x32_bf16 v[32:35], v[28:31], v[48:51], v[32:35]
    v_exp_f32 v119, v119
    v_mfma_f32_16x16x32_bf16 v[36:39], v[28:31], v[52:55], v[36:39]
    s_waitcnt lgkmcnt(4)
    ds_read_b128 a[180:183], v20 offset:21504
    v_cvt_pk_bf16_f32 v59, v118, v119
    v_mfma_f32_16x16x32_bf16 v[128:131], a[160:163], v[48:51], v[128:131]
    s_waitcnt lgkmcnt(4)
    v_exp_f32 v120, v120
    v_mfma_f32_16x16x32_bf16 v[160:163], a[160:163], v[52:55], v[160:163]
    buffer_load_dword v3, v4, s[8:11], s23 offen sc0 sc1
    v_mfma_f32_16x16x32_bf16 v[132:135], a[164:167], v[48:51], v[132:135]
    v_exp_f32 v121, v121
    v_mfma_f32_16x16x32_bf16 v[164:167], a[164:167], v[52:55], v[164:167]
    s_waitcnt lgkmcnt(3)
    ds_read_b128 a[184:187], v20 offset:22528
    v_cvt_pk_bf16_f32 v60, v120, v121
    v_mfma_f32_16x16x32_bf16 v[136:139], a[168:171], v[48:51], v[136:139]
    v_exp_f32 v122, v122
    v_mfma_f32_16x16x32_bf16 v[168:171], a[168:171], v[52:55], v[168:171]
    s_waitcnt lgkmcnt(3)
    v_mfma_f32_16x16x32_bf16 v[140:143], a[172:175], v[48:51], v[140:143]
    v_exp_f32 v123, v123
    v_mfma_f32_16x16x32_bf16 v[172:175], a[172:175], v[52:55], v[172:175]
    s_waitcnt lgkmcnt(2)
    ds_read_b128 a[188:191], v20 offset:23552
    v_cvt_pk_bf16_f32 v61, v122, v123
    v_mfma_f32_16x16x32_bf16 v[144:147], a[176:179], v[48:51], v[144:147]
    v_exp_f32 v124, v124
    v_mfma_f32_16x16x32_bf16 v[176:179], a[176:179], v[52:55], v[176:179]
    s_waitcnt lgkmcnt(2)
    v_mfma_f32_16x16x32_bf16 v[148:151], a[180:183], v[48:51], v[148:151]
    v_exp_f32 v125, v125
    v_mfma_f32_16x16x32_bf16 v[180:183], a[180:183], v[52:55], v[180:183]
    s_waitcnt lgkmcnt(1)
    v_cvt_pk_bf16_f32 v62, v124, v125
    v_xor_b32 v19, 98304, v19
    v_mfma_f32_16x16x32_bf16 v[152:155], a[184:187], v[48:51], v[152:155]
    v_exp_f32 v126, v126
    v_mfma_f32_16x16x32_bf16 v[184:187], a[184:187], v[52:55], v[184:187]
    s_waitcnt lgkmcnt(0)
    v_xor_b32 v20, 98304, v20
    v_mfma_f32_16x16x32_bf16 v[156:159], a[188:191], v[48:51], v[156:159]
    v_exp_f32 v127, v127
    v_mfma_f32_16x16x32_bf16 v[188:191], a[188:191], v[52:55], v[188:191]
    v_cvt_pk_bf16_f32 v63, v126, v127
    v_mfma_f32_16x16x32_bf16 v[112:115], a[128:131], a[224:227], v[72:75]
    v_exp_f32 v96, v96
    v_mfma_f32_16x16x32_bf16 v[112:115], a[132:135], a[228:231], v[112:115]
    buffer_store_dwordx4 a[20:23], v13, s[8:11], s17 offen offset:3584 sc0 sc1
    v_mfma_f32_16x16x32_bf16 v[112:115], a[136:139], a[232:235], v[112:115]
    v_exp_f32 v97, v97
    v_mfma_f32_16x16x32_bf16 v[112:115], a[140:143], a[236:239], v[112:115]
    v_cvt_pk_bf16_f32 v48, v96, v97
    v_lshlrev_b32 v12, 3, v0
    v_mfma_f32_16x16x32_bf16 v[120:123], a[128:131], a[240:243], v[76:79]
    s_lshl_b32 s101, s2, 11
    v_exp_f32 v98, v98
    v_mfma_f32_16x16x32_bf16 v[120:123], a[132:135], a[244:247], v[120:123]
    v_add_f32 v80, 0, v21
    v_min_f32 v80, v80, v64
    v_mfma_f32_16x16x32_bf16 v[120:123], a[136:139], a[248:251], v[120:123]
    s_add_u32 s101, s101, 524288
    v_exp_f32 v99, v99
    v_mfma_f32_16x16x32_bf16 v[120:123], a[140:143], a[252:255], v[120:123]
    buffer_store_dwordx2 v[24:25], v12, s[8:11], s101 offen sc0 sc1
    v_mfma_f32_16x16x32_bf16 v[116:119], a[144:147], a[224:227], v[72:75]
    s_lshl_b32 s101, s2, 6
    v_exp_f32 v100, v100
    v_mfma_f32_16x16x32_bf16 v[116:119], a[148:151], a[228:231], v[116:119]
    s_add_u32 s101, s101, 65536
    ds_read_b128 a[128:131], v18 offset:16384
    v_cvt_pk_bf16_f32 v49, v98, v99
    v_mfma_f32_16x16x32_bf16 v[116:119], a[152:155], a[232:235], v[116:119]
    s_add_u32 s19, s82, 32768
    v_exp_f32 v101, v101
    v_mfma_f32_16x16x32_bf16 v[116:119], a[156:159], a[236:239], v[116:119]
    s_sub_u32 s82, s12, s13
    ds_read_b128 a[132:135], v18 offset:17408
    v_cvt_pk_bf16_f32 v50, v100, v101
    v_mfma_f32_16x16x32_bf16 v[124:127], a[144:147], a[240:243], v[76:79]
    s_sub_u32 s82, s82, 1
    v_exp_f32 v102, v102
    v_mfma_f32_16x16x32_bf16 v[124:127], a[148:151], a[244:247], v[124:127]
    s_cmp_gt_u32 s12, s13
    s_cselect_b32 s82, s82, s12
    s_mul_i32 s82, s82, 65536
    ds_read_b128 a[136:139], v18 offset:18432
    v_mfma_f32_16x16x32_bf16 v[124:127], a[152:155], a[248:251], v[124:127]
    s_add_u32 s82, s82, s81
    v_exp_f32 v103, v103
    v_mfma_f32_16x16x32_bf16 v[124:127], a[156:159], a[252:255], v[124:127]
    s_cmp_ge_u32 s12, 17
    s_cselect_b32 s82, 2147471360, s82
    ds_read_b128 a[140:143], v18 offset:19456
    v_cvt_pk_bf16_f32 v51, v102, v103
    v_mfma_f32_16x16x32_bf16 v[40:43], v[28:31], v[56:59], v[40:43]
    s_add_u32 s12, s12, 1
    v_exp_f32 v104, v104
    v_mfma_f32_16x16x32_bf16 v[44:47], v[28:31], v[60:63], v[44:47]
    ds_read_b128 a[144:147], v18 offset:20480
    v_mov_b32 v13, 0
    v_mfma_f32_16x16x32_bf16 v[192:195], a[160:163], v[56:59], v[192:195]
    v_exp_f32 v105, v105
    v_mfma_f32_16x16x32_bf16 v[224:227], a[160:163], v[60:63], v[224:227]
    ds_read_b128 a[148:151], v18 offset:21504
    v_cvt_pk_bf16_f32 v52, v104, v105
    v_mfma_f32_16x16x32_bf16 v[196:199], a[164:167], v[56:59], v[196:199]
    v_exp_f32 v106, v106
    v_mfma_f32_16x16x32_bf16 v[228:231], a[164:167], v[60:63], v[228:231]
    ds_read_b128 a[152:155], v18 offset:22528
    v_add_f32 v81, 0xf1800000, v21
    v_mfma_f32_16x16x32_bf16 v[200:203], a[168:171], v[56:59], v[200:203]
    v_exp_f32 v107, v107
    v_mfma_f32_16x16x32_bf16 v[232:235], a[168:171], v[60:63], v[232:235]
    ds_read_b128 a[156:159], v18 offset:23552
    v_cvt_pk_bf16_f32 v53, v106, v107
    v_mfma_f32_16x16x32_bf16 v[204:207], a[172:175], v[56:59], v[204:207]
    v_exp_f32 v108, v108
    v_mfma_f32_16x16x32_bf16 v[236:239], a[172:175], v[60:63], v[236:239]
    buffer_store_dword v13, v7, s[8:11], s101 offen sc0 sc1
    v_mfma_f32_16x16x32_bf16 v[208:211], a[176:179], v[56:59], v[208:211]
    s_lshl_b32 s101, s66, 6
    v_exp_f32 v109, v109
    v_mfma_f32_16x16x32_bf16 v[240:243], a[176:179], v[60:63], v[240:243]
    s_add_u32 s101, s101, 81920
    v_cvt_pk_bf16_f32 v54, v108, v109
    v_xor_b32 v18, 196608, v18
    v_mfma_f32_16x16x32_bf16 v[212:215], a[180:183], v[56:59], v[212:215]
    v_exp_f32 v110, v110
    v_mfma_f32_16x16x32_bf16 v[244:247], a[180:183], v[60:63], v[244:247]
    buffer_store_dwordx4 v[24:27], v7, s[8:11], s101 offen sc0 sc1
    v_mfma_f32_16x16x32_bf16 v[216:219], a[184:187], v[56:59], v[216:219]
    v_exp_f32 v111, v111
    v_mfma_f32_16x16x32_bf16 v[248:251], a[184:187], v[60:63], v[248:251]
    v_cvt_pk_bf16_f32 v55, v110, v111
    v_min_f32 v81, v81, v65
    v_mfma_f32_16x16x32_bf16 v[220:223], a[188:191], v[56:59], v[220:223]
    buffer_store_dwordx4 v[24:27], v7, s[8:11], s101 offen offset:16 sc0 sc1
    v_mfma_f32_16x16x32_bf16 v[252:255], a[188:191], v[60:63], v[252:255]
    v_add_f32 v82, 0xf2000000, v21
    v_min_f32 v82, v82, v66
    s_waitcnt vmcnt(9) lgkmcnt(0)
    s_barrier
    v_mfma_f32_16x16x32_bf16 v[96:99], a[128:131], a[192:195], v[64:67]
    s_add_u32 m0, s15, 0
    ds_read_b128 a[160:163], v19 offset:0
    v_mfma_f32_16x16x32_bf16 v[96:99], a[132:135], a[196:199], v[96:99]
    ds_read_b128 a[164:167], v19 offset:1024
    v_mfma_f32_16x16x32_bf16 v[96:99], a[136:139], a[200:203], v[96:99]
    v_exp_f32 v112, v112
    v_mfma_f32_16x16x32_bf16 v[96:99], a[140:143], a[204:207], v[96:99]
    buffer_load_dwordx4 v1, s[8:11], s82 offen offset:0  lds
    v_mfma_f32_16x16x32_bf16 v[104:107], a[128:131], a[208:211], v[68:71]
    v_exp_f32 v113, v113
    v_mfma_f32_16x16x32_bf16 v[104:107], a[132:135], a[212:215], v[104:107]
    ds_read_b128 a[168:171], v19 offset:2048
    v_cvt_pk_bf16_f32 v56, v112, v113
    v_mfma_f32_16x16x32_bf16 v[104:107], a[136:139], a[216:219], v[104:107]
    v_exp_f32 v114, v114
    v_mfma_f32_16x16x32_bf16 v[104:107], a[140:143], a[220:223], v[104:107]
    buffer_load_dwordx4 v1, s[8:11], s82 offen offset:1024  lds
    v_mfma_f32_16x16x32_bf16 v[100:103], a[144:147], a[192:195], v[64:67]
    v_exp_f32 v115, v115
    v_mfma_f32_16x16x32_bf16 v[100:103], a[148:151], a[196:199], v[100:103]
    ds_read_b128 a[172:175], v19 offset:3072
    v_cvt_pk_bf16_f32 v57, v114, v115
    v_mfma_f32_16x16x32_bf16 v[100:103], a[152:155], a[200:203], v[100:103]
    v_exp_f32 v116, v116
    v_mfma_f32_16x16x32_bf16 v[100:103], a[156:159], a[204:207], v[100:103]
    buffer_load_dwordx4 v1, s[8:11], s82 offen offset:2048  lds
    v_mfma_f32_16x16x32_bf16 v[108:111], a[144:147], a[208:211], v[68:71]
    v_exp_f32 v117, v117
    v_mfma_f32_16x16x32_bf16 v[108:111], a[148:151], a[212:215], v[108:111]
    ds_read_b128 a[176:179], v20 offset:4096
    v_cvt_pk_bf16_f32 v58, v116, v117
    v_mfma_f32_16x16x32_bf16 v[108:111], a[152:155], a[216:219], v[108:111]
    v_exp_f32 v118, v118
    v_mfma_f32_16x16x32_bf16 v[108:111], a[156:159], a[220:223], v[108:111]
    buffer_load_dwordx4 v1, s[8:11], s82 offen offset:3072  lds
    v_mfma_f32_16x16x32_bf16 v[32:35], v[28:31], v[48:51], v[32:35]
    s_add_u32 m0, s15, 4096
    v_exp_f32 v119, v119
    v_mfma_f32_16x16x32_bf16 v[36:39], v[28:31], v[52:55], v[36:39]
    s_waitcnt lgkmcnt(4)
    ds_read_b128 a[180:183], v20 offset:5120
    v_cvt_pk_bf16_f32 v59, v118, v119
    v_mfma_f32_16x16x32_bf16 v[128:131], a[160:163], v[48:51], v[128:131]
    s_waitcnt lgkmcnt(4)
    v_exp_f32 v120, v120
    v_mfma_f32_16x16x32_bf16 v[160:163], a[160:163], v[52:55], v[160:163]
    buffer_load_dwordx4 v15, s[8:11], s82 offen offset:0  lds
    v_mfma_f32_16x16x32_bf16 v[132:135], a[164:167], v[48:51], v[132:135]
    v_exp_f32 v121, v121
    v_mfma_f32_16x16x32_bf16 v[164:167], a[164:167], v[52:55], v[164:167]
    s_waitcnt lgkmcnt(3)
    ds_read_b128 a[184:187], v20 offset:6144
    v_cvt_pk_bf16_f32 v60, v120, v121
    v_mfma_f32_16x16x32_bf16 v[136:139], a[168:171], v[48:51], v[136:139]
    s_waitcnt lgkmcnt(3)
    v_exp_f32 v122, v122
    v_mfma_f32_16x16x32_bf16 v[168:171], a[168:171], v[52:55], v[168:171]
    buffer_load_dwordx4 v15, s[8:11], s82 offen offset:1024  lds
    v_mfma_f32_16x16x32_bf16 v[140:143], a[172:175], v[48:51], v[140:143]
    v_exp_f32 v123, v123
    v_mfma_f32_16x16x32_bf16 v[172:175], a[172:175], v[52:55], v[172:175]
    s_waitcnt lgkmcnt(2)
    ds_read_b128 a[188:191], v20 offset:7168
    v_cvt_pk_bf16_f32 v61, v122, v123
    v_mfma_f32_16x16x32_bf16 v[144:147], a[176:179], v[48:51], v[144:147]
    s_waitcnt lgkmcnt(2)
    v_exp_f32 v124, v124
    v_mfma_f32_16x16x32_bf16 v[176:179], a[176:179], v[52:55], v[176:179]
    buffer_load_dwordx4 v15, s[8:11], s82 offen offset:2048  lds
    v_mfma_f32_16x16x32_bf16 v[148:151], a[180:183], v[48:51], v[148:151]
    v_exp_f32 v125, v125
    v_mfma_f32_16x16x32_bf16 v[180:183], a[180:183], v[52:55], v[180:183]
    s_waitcnt lgkmcnt(1)
    v_cvt_pk_bf16_f32 v62, v124, v125
    v_mfma_f32_16x16x32_bf16 v[152:155], a[184:187], v[48:51], v[152:155]
    s_waitcnt lgkmcnt(0)
    v_exp_f32 v126, v126
    v_mfma_f32_16x16x32_bf16 v[184:187], a[184:187], v[52:55], v[184:187]
    buffer_load_dwordx4 v15, s[8:11], s82 offen offset:3072  lds
    v_mfma_f32_16x16x32_bf16 v[156:159], a[188:191], v[48:51], v[156:159]
    s_xor_b32 s15, s15, 196608
    v_exp_f32 v127, v127
    v_mfma_f32_16x16x32_bf16 v[188:191], a[188:191], v[52:55], v[188:191]
    s_add_u32 m0, s16, 0
    v_cvt_pk_bf16_f32 v63, v126, v127
    v_mfma_f32_16x16x32_bf16 v[112:115], a[128:131], a[224:227], v[72:75]
    v_mfma_f32_16x16x32_bf16 v[112:115], a[132:135], a[228:231], v[112:115]
    v_mfma_f32_16x16x32_bf16 v[112:115], a[136:139], a[232:235], v[112:115]
    v_exp_f32 v96, v96
    v_mfma_f32_16x16x32_bf16 v[112:115], a[140:143], a[236:239], v[112:115]
    buffer_load_dwordx4 v1, s[8:11], s19 offen offset:0  lds
    v_mfma_f32_16x16x32_bf16 v[120:123], a[128:131], a[240:243], v[76:79]
    v_exp_f32 v97, v97
    v_mfma_f32_16x16x32_bf16 v[120:123], a[132:135], a[244:247], v[120:123]
    ds_read_b128 a[128:131], v18 offset:0
    v_cvt_pk_bf16_f32 v48, v96, v97
    v_mfma_f32_16x16x32_bf16 v[120:123], a[136:139], a[248:251], v[120:123]
    v_exp_f32 v98, v98
    v_mfma_f32_16x16x32_bf16 v[120:123], a[140:143], a[252:255], v[120:123]
    buffer_load_dwordx4 v1, s[8:11], s19 offen offset:1024  lds
    v_mfma_f32_16x16x32_bf16 v[116:119], a[144:147], a[224:227], v[72:75]
    v_exp_f32 v99, v99
    v_mfma_f32_16x16x32_bf16 v[116:119], a[148:151], a[228:231], v[116:119]
    ds_read_b128 a[132:135], v18 offset:1024
    v_cvt_pk_bf16_f32 v49, v98, v99
    v_mfma_f32_16x16x32_bf16 v[116:119], a[152:155], a[232:235], v[116:119]
    v_exp_f32 v100, v100
    v_mfma_f32_16x16x32_bf16 v[116:119], a[156:159], a[236:239], v[116:119]
    buffer_load_dwordx4 v1, s[8:11], s19 offen offset:2048  lds
    v_mfma_f32_16x16x32_bf16 v[124:127], a[144:147], a[240:243], v[76:79]
    v_exp_f32 v101, v101
    v_mfma_f32_16x16x32_bf16 v[124:127], a[148:151], a[244:247], v[124:127]
    ds_read_b128 a[136:139], v18 offset:2048
    v_cvt_pk_bf16_f32 v50, v100, v101
    v_mfma_f32_16x16x32_bf16 v[124:127], a[152:155], a[248:251], v[124:127]
    v_exp_f32 v102, v102
    v_mfma_f32_16x16x32_bf16 v[124:127], a[156:159], a[252:255], v[124:127]
    buffer_load_dwordx4 v1, s[8:11], s19 offen offset:3072  lds
    v_mfma_f32_16x16x32_bf16 v[40:43], v[28:31], v[56:59], v[40:43]
    s_add_u32 m0, s16, 4096
    v_exp_f32 v103, v103
    v_mfma_f32_16x16x32_bf16 v[44:47], v[28:31], v[60:63], v[44:47]
    ds_read_b128 a[140:143], v18 offset:3072
    v_cvt_pk_bf16_f32 v51, v102, v103
    v_mfma_f32_16x16x32_bf16 v[192:195], a[160:163], v[56:59], v[192:195]
    v_exp_f32 v104, v104
    v_mfma_f32_16x16x32_bf16 v[224:227], a[160:163], v[60:63], v[224:227]
    buffer_load_dwordx4 v15, s[8:11], s19 offen offset:0  lds
    v_mfma_f32_16x16x32_bf16 v[196:199], a[164:167], v[56:59], v[196:199]
    v_exp_f32 v105, v105
    v_mfma_f32_16x16x32_bf16 v[228:231], a[164:167], v[60:63], v[228:231]
    ds_read_b128 a[144:147], v18 offset:4096
    v_cvt_pk_bf16_f32 v52, v104, v105
    v_mfma_f32_16x16x32_bf16 v[200:203], a[168:171], v[56:59], v[200:203]
    v_exp_f32 v106, v106
    v_mfma_f32_16x16x32_bf16 v[232:235], a[168:171], v[60:63], v[232:235]
    buffer_load_dwordx4 v15, s[8:11], s19 offen offset:1024  lds
    v_mfma_f32_16x16x32_bf16 v[204:207], a[172:175], v[56:59], v[204:207]
    v_exp_f32 v107, v107
    v_mfma_f32_16x16x32_bf16 v[236:239], a[172:175], v[60:63], v[236:239]
    ds_read_b128 a[148:151], v18 offset:5120
    v_cvt_pk_bf16_f32 v53, v106, v107
    v_mfma_f32_16x16x32_bf16 v[208:211], a[176:179], v[56:59], v[208:211]
    v_exp_f32 v108, v108
    v_mfma_f32_16x16x32_bf16 v[240:243], a[176:179], v[60:63], v[240:243]
    buffer_load_dwordx4 v15, s[8:11], s19 offen offset:2048  lds
    v_mfma_f32_16x16x32_bf16 v[212:215], a[180:183], v[56:59], v[212:215]
    v_exp_f32 v109, v109
    v_mfma_f32_16x16x32_bf16 v[244:247], a[180:183], v[60:63], v[244:247]
    ds_read_b128 a[152:155], v18 offset:6144
    v_cvt_pk_bf16_f32 v54, v108, v109
    v_mfma_f32_16x16x32_bf16 v[216:219], a[184:187], v[56:59], v[216:219]
    v_exp_f32 v110, v110
    v_mfma_f32_16x16x32_bf16 v[248:251], a[184:187], v[60:63], v[248:251]
    buffer_load_dwordx4 v15, s[8:11], s19 offen offset:3072  lds
    v_mfma_f32_16x16x32_bf16 v[220:223], a[188:191], v[56:59], v[220:223]
    s_xor_b32 s16, s16, 98304
    v_exp_f32 v111, v111
    v_mfma_f32_16x16x32_bf16 v[252:255], a[188:191], v[60:63], v[252:255]
    ds_read_b128 a[156:159], v18 offset:7168
    v_cvt_pk_bf16_f32 v55, v110, v111
    s_waitcnt lgkmcnt(7)
    v_mfma_f32_16x16x32_bf16 v[96:99], a[128:131], a[192:195], v[64:67]
    s_waitcnt lgkmcnt(6)
    s_lshl_b32 s24, s60, 2
    s_add_u32 s24, s24, s3
    ds_read_b128 a[160:163], v19 offset:16384
    v_mfma_f32_16x16x32_bf16 v[96:99], a[132:135], a[196:199], v[96:99]
    s_waitcnt lgkmcnt(6)
    s_lshl_b32 s24, s24, 3
    s_add_u32 s24, s24, s4
    ds_read_b128 a[164:167], v19 offset:17408
    v_mfma_f32_16x16x32_bf16 v[96:99], a[136:139], a[200:203], v[96:99]
    s_waitcnt lgkmcnt(6)
    s_lshl_b32 s24, s24, 2
    v_exp_f32 v112, v112
    v_mfma_f32_16x16x32_bf16 v[96:99], a[140:143], a[204:207], v[96:99]
    v_mfma_f32_16x16x32_bf16 v[104:107], a[128:131], a[208:211], v[68:71]
    s_add_u32 s24, s24, s5
    v_exp_f32 v113, v113
    v_mfma_f32_16x16x32_bf16 v[104:107], a[132:135], a[212:215], v[104:107]
    s_lshl_b32 s24, s24, 13
    ds_read_b128 a[168:171], v19 offset:18432
    v_cvt_pk_bf16_f32 v56, v112, v113
    v_mfma_f32_16x16x32_bf16 v[104:107], a[136:139], a[216:219], v[104:107]
    s_add_u32 s24, s24, 50331648
    v_exp_f32 v114, v114
    s_waitcnt vmcnt(21)
    v_cmp_ne_u32 vcc, 0, v3
    s_cmp_eq_u64 vcc, -1
    s_cbranch_scc0 L_C1_slow_9
L_C1_ok_10:
    v_mfma_f32_16x16x32_bf16 v[104:107], a[140:143], a[220:223], v[104:107]
    s_waitcnt lgkmcnt(6)
    v_mfma_f32_16x16x32_bf16 v[100:103], a[144:147], a[192:195], v[64:67]
    s_waitcnt lgkmcnt(5)
    s_xor_b32 s74, s24, 0
    v_exp_f32 v115, v115
    v_mfma_f32_16x16x32_bf16 v[100:103], a[148:151], a[196:199], v[100:103]
    s_waitcnt lgkmcnt(4)
    ds_read_b128 a[172:175], v19 offset:19456
    v_cvt_pk_bf16_f32 v57, v114, v115
    v_mfma_f32_16x16x32_bf16 v[100:103], a[152:155], a[200:203], v[100:103]
    s_waitcnt lgkmcnt(4)
    v_exp_f32 v116, v116
    v_mfma_f32_16x16x32_bf16 v[100:103], a[156:159], a[204:207], v[100:103]
    buffer_load_dwordx4 a[64:67], v1, s[8:11], s74 offen offset:0
    v_mfma_f32_16x16x32_bf16 v[108:111], a[144:147], a[208:211], v[68:71]
    s_xor_b32 s74, s24, 0
    v_exp_f32 v117, v117
    v_mfma_f32_16x16x32_bf16 v[108:111], a[148:151], a[212:215], v[108:111]
    ds_read_b128 a[176:179], v20 offset:20480
    v_cvt_pk_bf16_f32 v58, v116, v117
    v_mfma_f32_16x16x32_bf16 v[108:111], a[152:155], a[216:219], v[108:111]
    v_exp_f32 v118, v118
    v_mfma_f32_16x16x32_bf16 v[108:111], a[156:159], a[220:223], v[108:111]
    buffer_load_dwordx4 a[68:71], v1, s[8:11], s74 offen offset:1024
    v_mfma_f32_16x16x32_bf16 v[32:35], v[28:31], v[48:51], v[32:35]
    s_xor_b32 s74, s24, 0
    v_exp_f32 v119, v119
    v_mfma_f32_16x16x32_bf16 v[36:39], v[28:31], v[52:55], v[36:39]
    s_waitcnt lgkmcnt(4)
    ds_read_b128 a[180:183], v20 offset:21504
    v_cvt_pk_bf16_f32 v59, v118, v119
    v_mfma_f32_16x16x32_bf16 v[128:131], a[160:163], v[48:51], v[128:131]
    s_waitcnt lgkmcnt(4)
    v_exp_f32 v120, v120
    v_mfma_f32_16x16x32_bf16 v[160:163], a[160:163], v[52:55], v[160:163]
    buffer_load_dwordx4 a[72:75], v1, s[8:11], s74 offen offset:2048
    v_mfma_f32_16x16x32_bf16 v[132:135], a[164:167], v[48:51], v[132:135]
    s_xor_b32 s74, s24, 0
    v_exp_f32 v121, v121
    v_mfma_f32_16x16x32_bf16 v[164:167], a[164:167], v[52:55], v[164:167]
    s_waitcnt lgkmcnt(3)
    ds_read_b128 a[184:187], v20 offset:22528
    v_cvt_pk_bf16_f32 v60, v120, v121
    v_mfma_f32_16x16x32_bf16 v[136:139], a[168:171], v[48:51], v[136:139]
    s_waitcnt lgkmcnt(3)
    v_exp_f32 v122, v122
    v_mfma_f32_16x16x32_bf16 v[168:171], a[168:171], v[52:55], v[168:171]
    buffer_load_dwordx4 a[76:79], v1, s[8:11], s74 offen offset:3072
    v_mfma_f32_16x16x32_bf16 v[140:143], a[172:175], v[48:51], v[140:143]
    s_xor_b32 s74, s24, 4096
    v_exp_f32 v123, v123
    v_mfma_f32_16x16x32_bf16 v[172:175], a[172:175], v[52:55], v[172:175]
    s_waitcnt lgkmcnt(2)
    ds_read_b128 a[188:191], v20 offset:23552
    v_cvt_pk_bf16_f32 v61, v122, v123
    v_mfma_f32_16x16x32_bf16 v[144:147], a[176:179], v[48:51], v[144:147]
    s_waitcnt lgkmcnt(2)
    v_exp_f32 v124, v124
    v_mfma_f32_16x16x32_bf16 v[176:179], a[176:179], v[52:55], v[176:179]
    buffer_load_dwordx4 a[80:83], v1, s[8:11], s74 offen offset:0
    v_mfma_f32_16x16x32_bf16 v[148:151], a[180:183], v[48:51], v[148:151]
    v_exp_f32 v125, v125
    v_mfma_f32_16x16x32_bf16 v[180:183], a[180:183], v[52:55], v[180:183]
    s_waitcnt lgkmcnt(1)
    v_cvt_pk_bf16_f32 v62, v124, v125
    v_xor_b32 v19, 98304, v19
    v_mfma_f32_16x16x32_bf16 v[152:155], a[184:187], v[48:51], v[152:155]
    v_exp_f32 v126, v126
    v_mfma_f32_16x16x32_bf16 v[184:187], a[184:187], v[52:55], v[184:187]
    s_waitcnt lgkmcnt(0)
    v_xor_b32 v20, 98304, v20
    v_mfma_f32_16x16x32_bf16 v[156:159], a[188:191], v[48:51], v[156:159]
    v_exp_f32 v127, v127
    v_mfma_f32_16x16x32_bf16 v[188:191], a[188:191], v[52:55], v[188:191]
    v_cvt_pk_bf16_f32 v63, v126, v127
    v_mfma_f32_16x16x32_bf16 v[112:115], a[128:131], a[224:227], v[72:75]
    s_add_u32 m0, s62, 32768
    v_exp_f32 v96, v96
    v_mfma_f32_16x16x32_bf16 v[112:115], a[132:135], a[228:231], v[112:115]
    v_add_f32 v83, 0xf2400000, v21
    v_min_f32 v83, v83, v67
    v_mfma_f32_16x16x32_bf16 v[112:115], a[136:139], a[232:235], v[112:115]
    s_xor_b32 s98, s65, 0
    v_exp_f32 v97, v97
    v_mfma_f32_16x16x32_bf16 v[112:115], a[140:143], a[236:239], v[112:115]
    v_cvt_pk_bf16_f32 v48, v96, v97
    v_add_f32 v84, 0xf3800000, v21
    v_mfma_f32_16x16x32_bf16 v[120:123], a[128:131], a[240:243], v[76:79]
    v_exp_f32 v98, v98
    v_mfma_f32_16x16x32_bf16 v[120:123], a[132:135], a[244:247], v[120:123]
    buffer_load_dwordx4 v8, s[28:31], s98 offen offset:0   lds
    v_mfma_f32_16x16x32_bf16 v[120:123], a[136:139], a[248:251], v[120:123]
    v_exp_f32 v99, v99
    v_mfma_f32_16x16x32_bf16 v[120:123], a[140:143], a[252:255], v[120:123]
    buffer_load_dwordx4 v9, s[28:31], s98 offen offset:1024   lds
    v_mfma_f32_16x16x32_bf16 v[116:119], a[144:147], a[224:227], v[72:75]
    v_exp_f32 v100, v100
    v_mfma_f32_16x16x32_bf16 v[116:119], a[148:151], a[228:231], v[116:119]
    ds_read_b128 a[128:131], v18 offset:16384
    v_cvt_pk_bf16_f32 v49, v98, v99
    v_mfma_f32_16x16x32_bf16 v[116:119], a[152:155], a[232:235], v[116:119]
    s_add_u32 s19, s82, 32768
    v_exp_f32 v101, v101
    v_mfma_f32_16x16x32_bf16 v[116:119], a[156:159], a[236:239], v[116:119]
    s_sub_u32 s82, s12, s13
    ds_read_b128 a[132:135], v18 offset:17408
    v_cvt_pk_bf16_f32 v50, v100, v101
    v_mfma_f32_16x16x32_bf16 v[124:127], a[144:147], a[240:243], v[76:79]
    s_sub_u32 s82, s82, 1
    v_exp_f32 v102, v102
    v_mfma_f32_16x16x32_bf16 v[124:127], a[148:151], a[244:247], v[124:127]
    s_cmp_gt_u32 s12, s13
    s_cselect_b32 s82, s82, s12
    s_mul_i32 s82, s82, 65536
    ds_read_b128 a[136:139], v18 offset:18432
    v_mfma_f32_16x16x32_bf16 v[124:127], a[152:155], a[248:251], v[124:127]
    s_add_u32 s82, s82, s81
    v_exp_f32 v103, v103
    v_mfma_f32_16x16x32_bf16 v[124:127], a[156:159], a[252:255], v[124:127]
    s_cmp_ge_u32 s12, 17
    s_cselect_b32 s82, 2147471360, s82
    ds_read_b128 a[140:143], v18 offset:19456
    v_cvt_pk_bf16_f32 v51, v102, v103
    v_mfma_f32_16x16x32_bf16 v[40:43], v[28:31], v[56:59], v[40:43]
    s_add_u32 s12, s12, 1
    v_exp_f32 v104, v104
    v_mfma_f32_16x16x32_bf16 v[44:47], v[28:31], v[60:63], v[44:47]
    ds_read_b128 a[144:147], v18 offset:20480
    v_min_f32 v84, v84, v64
    v_mfma_f32_16x16x32_bf16 v[192:195], a[160:163], v[56:59], v[192:195]
    v_exp_f32 v105, v105
    v_mfma_f32_16x16x32_bf16 v[224:227], a[160:163], v[60:63], v[224:227]
    ds_read_b128 a[148:151], v18 offset:21504
    v_cvt_pk_bf16_f32 v52, v104, v105
    v_mfma_f32_16x16x32_bf16 v[196:199], a[164:167], v[56:59], v[196:199]
    v_exp_f32 v106, v106
    v_mfma_f32_16x16x32_bf16 v[228:231], a[164:167], v[60:63], v[228:231]
    ds_read_b128 a[152:155], v18 offset:22528
    v_add_f32 v85, 0xf3880000, v21
    v_mfma_f32_16x16x32_bf16 v[200:203], a[168:171], v[56:59], v[200:203]
    v_exp_f32 v107, v107
    v_mfma_f32_16x16x32_bf16 v[232:235], a[168:171], v[60:63], v[232:235]
    ds_read_b128 a[156:159], v18 offset:23552
    v_cvt_pk_bf16_f32 v53, v106, v107
    v_mfma_f32_16x16x32_bf16 v[204:207], a[172:175], v[56:59], v[204:207]
    v_exp_f32 v108, v108
    v_mfma_f32_16x16x32_bf16 v[236:239], a[172:175], v[60:63], v[236:239]
    buffer_load_dwordx4 v10, s[28:31], s98 offen offset:2048   lds
    v_mfma_f32_16x16x32_bf16 v[208:211], a[176:179], v[56:59], v[208:211]
    v_exp_f32 v109, v109
    v_mfma_f32_16x16x32_bf16 v[240:243], a[176:179], v[60:63], v[240:243]
    v_cvt_pk_bf16_f32 v54, v108, v109
    v_xor_b32 v18, 196608, v18
    v_mfma_f32_16x16x32_bf16 v[212:215], a[180:183], v[56:59], v[212:215]
    v_exp_f32 v110, v110
    v_mfma_f32_16x16x32_bf16 v[244:247], a[180:183], v[60:63], v[244:247]
    buffer_load_dwordx4 v11, s[28:31], s98 offen offset:3072   lds
    v_mfma_f32_16x16x32_bf16 v[216:219], a[184:187], v[56:59], v[216:219]
    s_xor_b32 s74, s24, 4096
    v_exp_f32 v111, v111
    v_mfma_f32_16x16x32_bf16 v[248:251], a[184:187], v[60:63], v[248:251]
    v_cvt_pk_bf16_f32 v55, v110, v111
    v_min_f32 v85, v85, v65
    v_mfma_f32_16x16x32_bf16 v[220:223], a[188:191], v[56:59], v[220:223]
    buffer_load_dwordx4 a[84:87], v1, s[8:11], s74 offen offset:1024
    v_mfma_f32_16x16x32_bf16 v[252:255], a[188:191], v[60:63], v[252:255]
    s_xor_b32 s74, s24, 4096
    buffer_load_dwordx4 a[88:91], v1, s[8:11], s74 offen offset:2048
    s_xor_b32 s74, s24, 4096
    buffer_load_dwordx4 a[92:95], v1, s[8:11], s74 offen offset:3072
    s_waitcnt vmcnt(12) lgkmcnt(0)
    s_barrier
    v_mfma_f32_16x16x32_bf16 v[96:99], a[128:131], a[192:195], v[64:67]
    s_add_u32 m0, s15, 0
    ds_read_b128 a[160:163], v19 offset:0
    v_mfma_f32_16x16x32_bf16 v[96:99], a[132:135], a[196:199], v[96:99]
    ds_read_b128 a[164:167], v19 offset:1024
    v_mfma_f32_16x16x32_bf16 v[96:99], a[136:139], a[200:203], v[96:99]
    v_exp_f32 v112, v112
    v_mfma_f32_16x16x32_bf16 v[96:99], a[140:143], a[204:207], v[96:99]
    buffer_load_dwordx4 v1, s[8:11], s82 offen offset:0  lds
    v_mfma_f32_16x16x32_bf16 v[104:107], a[128:131], a[208:211], v[68:71]
    v_exp_f32 v113, v113
    v_mfma_f32_16x16x32_bf16 v[104:107], a[132:135], a[212:215], v[104:107]
    ds_read_b128 a[168:171], v19 offset:2048
    v_cvt_pk_bf16_f32 v56, v112, v113
    v_mfma_f32_16x16x32_bf16 v[104:107], a[136:139], a[216:219], v[104:107]
    v_exp_f32 v114, v114
    v_mfma_f32_16x16x32_bf16 v[104:107], a[140:143], a[220:223], v[104:107]
    buffer_load_dwordx4 v1, s[8:11], s82 offen offset:1024  lds
    v_mfma_f32_16x16x32_bf16 v[100:103], a[144:147], a[192:195], v[64:67]
    v_exp_f32 v115, v115
    v_mfma_f32_16x16x32_bf16 v[100:103], a[148:151], a[196:199], v[100:103]
    ds_read_b128 a[172:175], v19 offset:3072
    v_cvt_pk_bf16_f32 v57, v114, v115
    v_mfma_f32_16x16x32_bf16 v[100:103], a[152:155], a[200:203], v[100:103]
    v_exp_f32 v116, v116
    v_mfma_f32_16x16x32_bf16 v[100:103], a[156:159], a[204:207], v[100:103]
    buffer_load_dwordx4 v1, s[8:11], s82 offen offset:2048  lds
    v_mfma_f32_16x16x32_bf16 v[108:111], a[144:147], a[208:211], v[68:71]
    v_exp_f32 v117, v117
    v_mfma_f32_16x16x32_bf16 v[108:111], a[148:151], a[212:215], v[108:111]
    ds_read_b128 a[176:179], v20 offset:4096
    v_cvt_pk_bf16_f32 v58, v116, v117
    v_mfma_f32_16x16x32_bf16 v[108:111], a[152:155], a[216:219], v[108:111]
    v_exp_f32 v118, v118
    v_mfma_f32_16x16x32_bf16 v[108:111], a[156:159], a[220:223], v[108:111]
    buffer_load_dwordx4 v1, s[8:11], s82 offen offset:3072  lds
    v_mfma_f32_16x16x32_bf16 v[32:35], v[28:31], v[48:51], v[32:35]
    s_add_u32 m0, s15, 4096
    v_exp_f32 v119, v119
    v_mfma_f32_16x16x32_bf16 v[36:39], v[28:31], v[52:55], v[36:39]
    s_waitcnt lgkmcnt(4)
    ds_read_b128 a[180:183], v20 offset:5120
    v_cvt_pk_bf16_f32 v59, v118, v119
    v_mfma_f32_16x16x32_bf16 v[128:131], a[160:163], v[48:51], v[128:131]
    s_waitcnt lgkmcnt(4)
    v_exp_f32 v120, v120
    v_mfma_f32_16x16x32_bf16 v[160:163], a[160:163], v[52:55], v[160:163]
    buffer_load_dwordx4 v15, s[8:11], s82 offen offset:0  lds
    v_mfma_f32_16x16x32_bf16 v[132:135], a[164:167], v[48:51], v[132:135]
    v_exp_f32 v121, v121
    v_mfma_f32_16x16x32_bf16 v[164:167], a[164:167], v[52:55], v[164:167]
    s_waitcnt lgkmcnt(3)
    ds_read_b128 a[184:187], v20 offset:6144
    v_cvt_pk_bf16_f32 v60, v120, v121
    v_mfma_f32_16x16x32_bf16 v[136:139], a[168:171], v[48:51], v[136:139]
    s_waitcnt lgkmcnt(3)
    v_exp_f32 v122, v122
    v_mfma_f32_16x16x32_bf16 v[168:171], a[168:171], v[52:55], v[168:171]
    buffer_load_dwordx4 v15, s[8:11], s82 offen offset:1024  lds
    v_mfma_f32_16x16x32_bf16 v[140:143], a[172:175], v[48:51], v[140:143]
    v_exp_f32 v123, v123
    v_mfma_f32_16x16x32_bf16 v[172:175], a[172:175], v[52:55], v[172:175]
    s_waitcnt lgkmcnt(2)
    ds_read_b128 a[188:191], v20 offset:7168
    v_cvt_pk_bf16_f32 v61, v122, v123
    v_mfma_f32_16x16x32_bf16 v[144:147], a[176:179], v[48:51], v[144:147]
    s_waitcnt lgkmcnt(2)
    v_exp_f32 v124, v124
    v_mfma_f32_16x16x32_bf16 v[176:179], a[176:179], v[52:55], v[176:179]
    buffer_load_dwordx4 v15, s[8:11], s82 offen offset:2048  lds
    v_mfma_f32_16x16x32_bf16 v[148:151], a[180:183], v[48:51], v[148:151]
    v_exp_f32 v125, v125
    v_mfma_f32_16x16x32_bf16 v[180:183], a[180:183], v[52:55], v[180:183]
    s_waitcnt lgkmcnt(1)
    v_cvt_pk_bf16_f32 v62, v124, v125
    v_mfma_f32_16x16x32_bf16 v[152:155], a[184:187], v[48:51], v[152:155]
    s_waitcnt lgkmcnt(0)
    v_exp_f32 v126, v126
    v_mfma_f32_16x16x32_bf16 v[184:187], a[184:187], v[52:55], v[184:187]
    buffer_load_dwordx4 v15, s[8:11], s82 offen offset:3072  lds
    v_mfma_f32_16x16x32_bf16 v[156:159], a[188:191], v[48:51], v[156:159]
    s_xor_b32 s15, s15, 196608
    v_exp_f32 v127, v127
    v_mfma_f32_16x16x32_bf16 v[188:191], a[188:191], v[52:55], v[188:191]
    s_add_u32 m0, s16, 0
    v_cvt_pk_bf16_f32 v63, v126, v127
    v_mfma_f32_16x16x32_bf16 v[112:115], a[128:131], a[224:227], v[72:75]
    v_mfma_f32_16x16x32_bf16 v[112:115], a[132:135], a[228:231], v[112:115]
    v_mfma_f32_16x16x32_bf16 v[112:115], a[136:139], a[232:235], v[112:115]
    v_exp_f32 v96, v96
    v_mfma_f32_16x16x32_bf16 v[112:115], a[140:143], a[236:239], v[112:115]
    buffer_load_dwordx4 v1, s[8:11], s19 offen offset:0  lds
    v_mfma_f32_16x16x32_bf16 v[120:123], a[128:131], a[240:243], v[76:79]
    v_exp_f32 v97, v97
    v_mfma_f32_16x16x32_bf16 v[120:123], a[132:135], a[244:247], v[120:123]
    ds_read_b128 a[128:131], v18 offset:0
    v_cvt_pk_bf16_f32 v48, v96, v97
    v_mfma_f32_16x16x32_bf16 v[120:123], a[136:139], a[248:251], v[120:123]
    v_exp_f32 v98, v98
    v_mfma_f32_16x16x32_bf16 v[120:123], a[140:143], a[252:255], v[120:123]
    buffer_load_dwordx4 v1, s[8:11], s19 offen offset:1024  lds
    v_mfma_f32_16x16x32_bf16 v[116:119], a[144:147], a[224:227], v[72:75]
    v_exp_f32 v99, v99
    v_mfma_f32_16x16x32_bf16 v[116:119], a[148:151], a[228:231], v[116:119]
    ds_read_b128 a[132:135], v18 offset:1024
    v_cvt_pk_bf16_f32 v49, v98, v99
    v_mfma_f32_16x16x32_bf16 v[116:119], a[152:155], a[232:235], v[116:119]
    v_exp_f32 v100, v100
    v_mfma_f32_16x16x32_bf16 v[116:119], a[156:159], a[236:239], v[116:119]
    buffer_load_dwordx4 v1, s[8:11], s19 offen offset:2048  lds
    v_mfma_f32_16x16x32_bf16 v[124:127], a[144:147], a[240:243], v[76:79]
    v_exp_f32 v101, v101
    v_mfma_f32_16x16x32_bf16 v[124:127], a[148:151], a[244:247], v[124:127]
    ds_read_b128 a[136:139], v18 offset:2048
    v_cvt_pk_bf16_f32 v50, v100, v101
    v_mfma_f32_16x16x32_bf16 v[124:127], a[152:155], a[248:251], v[124:127]
    v_exp_f32 v102, v102
    v_mfma_f32_16x16x32_bf16 v[124:127], a[156:159], a[252:255], v[124:127]
    buffer_load_dwordx4 v1, s[8:11], s19 offen offset:3072  lds
    v_mfma_f32_16x16x32_bf16 v[40:43], v[28:31], v[56:59], v[40:43]
    s_add_u32 m0, s16, 4096
    v_exp_f32 v103, v103
    v_mfma_f32_16x16x32_bf16 v[44:47], v[28:31], v[60:63], v[44:47]
    ds_read_b128 a[140:143], v18 offset:3072
    v_cvt_pk_bf16_f32 v51, v102, v103
    v_mfma_f32_16x16x32_bf16 v[192:195], a[160:163], v[56:59], v[192:195]
    v_exp_f32 v104, v104
    v_mfma_f32_16x16x32_bf16 v[224:227], a[160:163], v[60:63], v[224:227]
    buffer_load_dwordx4 v15, s[8:11], s19 offen offset:0  lds
    v_mfma_f32_16x16x32_bf16 v[196:199], a[164:167], v[56:59], v[196:199]
    v_exp_f32 v105, v105
    v_mfma_f32_16x16x32_bf16 v[228:231], a[164:167], v[60:63], v[228:231]
    ds_read_b128 a[144:147], v18 offset:4096
    v_cvt_pk_bf16_f32 v52, v104, v105
    v_mfma_f32_16x16x32_bf16 v[200:203], a[168:171], v[56:59], v[200:203]
    v_exp_f32 v106, v106
    v_mfma_f32_16x16x32_bf16 v[232:235], a[168:171], v[60:63], v[232:235]
    buffer_load_dwordx4 v15, s[8:11], s19 offen offset:1024  lds
    v_mfma_f32_16x16x32_bf16 v[204:207], a[172:175], v[56:59], v[204:207]
    v_exp_f32 v107, v107
    v_mfma_f32_16x16x32_bf16 v[236:239], a[172:175], v[60:63], v[236:239]
    ds_read_b128 a[148:151], v18 offset:5120
    v_cvt_pk_bf16_f32 v53, v106, v107
    v_mfma_f32_16x16x32_bf16 v[208:211], a[176:179], v[56:59], v[208:211]
    v_exp_f32 v108, v108
    v_mfma_f32_16x16x32_bf16 v[240:243], a[176:179], v[60:63], v[240:243]
    buffer_load_dwordx4 v15, s[8:11], s19 offen offset:2048  lds
    v_mfma_f32_16x16x32_bf16 v[212:215], a[180:183], v[56:59], v[212:215]
    v_exp_f32 v109, v109
    v_mfma_f32_16x16x32_bf16 v[244:247], a[180:183], v[60:63], v[244:247]
    ds_read_b128 a[152:155], v18 offset:6144
    v_cvt_pk_bf16_f32 v54, v108, v109
    v_mfma_f32_16x16x32_bf16 v[216:219], a[184:187], v[56:59], v[216:219]
    v_exp_f32 v110, v110
    v_mfma_f32_16x16x32_bf16 v[248:251], a[184:187], v[60:63], v[248:251]
    buffer_load_dwordx4 v15, s[8:11], s19 offen offset:3072  lds
    v_mfma_f32_16x16x32_bf16 v[220:223], a[188:191], v[56:59], v[220:223]
    s_xor_b32 s16, s16, 98304
    v_exp_f32 v111, v111
    v_mfma_f32_16x16x32_bf16 v[252:255], a[188:191], v[60:63], v[252:255]
    ds_read_b128 a[156:159], v18 offset:7168
    v_cvt_pk_bf16_f32 v55, v110, v111
    s_waitcnt lgkmcnt(7)
    v_mfma_f32_16x16x32_bf16 v[96:99], a[128:131], a[192:195], v[64:67]
    s_waitcnt lgkmcnt(6)
    ds_read_b128 a[160:163], v19 offset:16384
    v_mfma_f32_16x16x32_bf16 v[96:99], a[132:135], a[196:199], v[96:99]
    s_waitcnt lgkmcnt(6)
    ds_read_b128 a[164:167], v19 offset:17408
    v_mfma_f32_16x16x32_bf16 v[96:99], a[136:139], a[200:203], v[96:99]
    s_waitcnt lgkmcnt(6)
    v_exp_f32 v112, v112
    v_mfma_f32_16x16x32_bf16 v[96:99], a[140:143], a[204:207], v[96:99]
    v_mfma_f32_16x16x32_bf16 v[104:107], a[128:131], a[208:211], v[68:71]
    v_exp_f32 v113, v113
    v_mfma_f32_16x16x32_bf16 v[104:107], a[132:135], a[212:215], v[104:107]
    ds_read_b128 a[168:171], v19 offset:18432
    v_cvt_pk_bf16_f32 v56, v112, v113
    v_mfma_f32_16x16x32_bf16 v[104:107], a[136:139], a[216:219], v[104:107]
    v_exp_f32 v114, v114
    v_mfma_f32_16x16x32_bf16 v[104:107], a[140:143], a[220:223], v[104:107]
    s_waitcnt lgkmcnt(6)
    v_mfma_f32_16x16x32_bf16 v[100:103], a[144:147], a[192:195], v[64:67]
    s_waitcnt lgkmcnt(5)
    s_lshl_b32 s64, s2, 6
    v_exp_f32 v115, v115
    v_mfma_f32_16x16x32_bf16 v[100:103], a[148:151], a[196:199], v[100:103]
    s_waitcnt lgkmcnt(4)
    s_add_u32 s64, s64, 1327104
    ds_read_b128 a[172:175], v19 offset:19456
    v_cvt_pk_bf16_f32 v57, v114, v115
    v_mfma_f32_16x16x32_bf16 v[100:103], a[152:155], a[200:203], v[100:103]
    s_waitcnt lgkmcnt(4)
    v_exp_f32 v116, v116
    v_mfma_f32_16x16x32_bf16 v[100:103], a[156:159], a[204:207], v[100:103]
    buffer_store_dword v6, v7, s[8:11], s64 offen sc0 sc1
    v_mfma_f32_16x16x32_bf16 v[108:111], a[144:147], a[208:211], v[68:71]
    s_xor_b32 s74, s24, 8192
    v_exp_f32 v117, v117
    v_mfma_f32_16x16x32_bf16 v[108:111], a[148:151], a[212:215], v[108:111]
    ds_read_b128 a[176:179], v20 offset:20480
    v_cvt_pk_bf16_f32 v58, v116, v117
    v_mfma_f32_16x16x32_bf16 v[108:111], a[152:155], a[216:219], v[108:111]
    v_exp_f32 v118, v118
    v_mfma_f32_16x16x32_bf16 v[108:111], a[156:159], a[220:223], v[108:111]
    buffer_load_dwordx4 a[96:99], v1, s[8:11], s74 offen offset:0
    v_mfma_f32_16x16x32_bf16 v[32:35], v[28:31], v[48:51], v[32:35]
    s_xor_b32 s74, s24, 8192
    v_exp_f32 v119, v119
    v_mfma_f32_16x16x32_bf16 v[36:39], v[28:31], v[52:55], v[36:39]
    s_waitcnt lgkmcnt(4)
    ds_read_b128 a[180:183], v20 offset:21504
    v_cvt_pk_bf16_f32 v59, v118, v119
    v_mfma_f32_16x16x32_bf16 v[128:131], a[160:163], v[48:51], v[128:131]
    s_waitcnt lgkmcnt(4)
    v_exp_f32 v120, v120
    v_mfma_f32_16x16x32_bf16 v[160:163], a[160:163], v[52:55], v[160:163]
    buffer_load_dwordx4 a[100:103], v1, s[8:11], s74 offen offset:1024
    v_mfma_f32_16x16x32_bf16 v[132:135], a[164:167], v[48:51], v[132:135]
    s_xor_b32 s74, s24, 8192
    v_exp_f32 v121, v121
    v_mfma_f32_16x16x32_bf16 v[164:167], a[164:167], v[52:55], v[164:167]
    s_waitcnt lgkmcnt(3)
    ds_read_b128 a[184:187], v20 offset:22528
    v_cvt_pk_bf16_f32 v60, v120, v121
    v_mfma_f32_16x16x32_bf16 v[136:139], a[168:171], v[48:51], v[136:139]
    s_waitcnt lgkmcnt(3)
    v_exp_f32 v122, v122
    v_mfma_f32_16x16x32_bf16 v[168:171], a[168:171], v[52:55], v[168:171]
    buffer_load_dwordx4 a[104:107], v1, s[8:11], s74 offen offset:2048
    v_mfma_f32_16x16x32_bf16 v[140:143], a[172:175], v[48:51], v[140:143]
    s_xor_b32 s74, s24, 8192
    v_exp_f32 v123, v123
    v_mfma_f32_16x16x32_bf16 v[172:175], a[172:175], v[52:55], v[172:175]
    s_waitcnt lgkmcnt(2)
    ds_read_b128 a[188:191], v20 offset:23552
    v_cvt_pk_bf16_f32 v61, v122, v123
    v_mfma_f32_16x16x32_bf16 v[144:147], a[176:179], v[48:51], v[144:147]
    s_waitcnt lgkmcnt(2)
    v_exp_f32 v124, v124
    v_mfma_f32_16x16x32_bf16 v[176:179], a[176:179], v[52:55], v[176:179]
    buffer_load_dwordx4 a[108:111], v1, s[8:11], s74 offen offset:3072
    v_mfma_f32_16x16x32_bf16 v[148:151], a[180:183], v[48:51], v[148:151]
    s_xor_b32 s74, s24, 12288
    v_exp_f32 v125, v125
    v_mfma_f32_16x16x32_bf16 v[180:183], a[180:183], v[52:55], v[180:183]
    s_waitcnt lgkmcnt(1)
    v_cvt_pk_bf16_f32 v62, v124, v125
    v_xor_b32 v19, 98304, v19
    v_mfma_f32_16x16x32_bf16 v[152:155], a[184:187], v[48:51], v[152:155]
    buffer_load_dwordx4 a[112:115], v1, s[8:11], s74 offen offset:0
    v_exp_f32 v126, v126
    v_mfma_f32_16x16x32_bf16 v[184:187], a[184:187], v[52:55], v[184:187]
    s_waitcnt lgkmcnt(0)
    v_xor_b32 v20, 98304, v20
    v_mfma_f32_16x16x32_bf16 v[156:159], a[188:191], v[48:51], v[156:159]
    v_exp_f32 v127, v127
    v_mfma_f32_16x16x32_bf16 v[188:191], a[188:191], v[52:55], v[188:191]
    v_cvt_pk_bf16_f32 v63, v126, v127
    v_mfma_f32_16x16x32_bf16 v[112:115], a[128:131], a[224:227], v[72:75]
    s_add_u32 m0, s62, 36864
    v_exp_f32 v96, v96
    v_mfma_f32_16x16x32_bf16 v[112:115], a[132:135], a[228:231], v[112:115]
    v_add_f32 v86, 0xf3900000, v21
    v_min_f32 v86, v86, v66
    v_mfma_f32_16x16x32_bf16 v[112:115], a[136:139], a[232:235], v[112:115]
    s_xor_b32 s98, s65, 32768
    v_exp_f32 v97, v97
    v_mfma_f32_16x16x32_bf16 v[112:115], a[140:143], a[236:239], v[112:115]
    v_cvt_pk_bf16_f32 v48, v96, v97
    v_add_f32 v87, 0xf3980000, v21
    v_mfma_f32_16x16x32_bf16 v[120:123], a[128:131], a[240:243], v[76:79]
    v_exp_f32 v98, v98
    v_mfma_f32_16x16x32_bf16 v[120:123], a[132:135], a[244:247], v[120:123]
    buffer_load_dwordx4 v8, s[28:31], s98 offen offset:0   lds
    v_mfma_f32_16x16x32_bf16 v[120:123], a[136:139], a[248:251], v[120:123]
    v_exp_f32 v99, v99
    v_mfma_f32_16x16x32_bf16 v[120:123], a[140:143], a[252:255], v[120:123]
    buffer_load_dwordx4 v9, s[28:31], s98 offen offset:1024   lds
    v_mfma_f32_16x16x32_bf16 v[116:119], a[144:147], a[224:227], v[72:75]
    v_exp_f32 v100, v100
    v_mfma_f32_16x16x32_bf16 v[116:119], a[148:151], a[228:231], v[116:119]
    ds_read_b128 a[128:131], v18 offset:16384
    v_cvt_pk_bf16_f32 v49, v98, v99
    v_mfma_f32_16x16x32_bf16 v[116:119], a[152:155], a[232:235], v[116:119]
    s_add_u32 s19, s82, 32768
    v_exp_f32 v101, v101
    v_mfma_f32_16x16x32_bf16 v[116:119], a[156:159], a[236:239], v[116:119]
    s_sub_u32 s82, s12, s13
    ds_read_b128 a[132:135], v18 offset:17408
    v_cvt_pk_bf16_f32 v50, v100, v101
    v_mfma_f32_16x16x32_bf16 v[124:127], a[144:147], a[240:243], v[76:79]
    s_sub_u32 s82, s82, 1
    v_exp_f32 v102, v102
    v_mfma_f32_16x16x32_bf16 v[124:127], a[148:151], a[244:247], v[124:127]
    s_cmp_gt_u32 s12, s13
    s_cselect_b32 s82, s82, s12
    s_mul_i32 s82, s82, 65536
    ds_read_b128 a[136:139], v18 offset:18432
    v_mfma_f32_16x16x32_bf16 v[124:127], a[152:155], a[248:251], v[124:127]
    s_add_u32 s82, s82, s81
    v_exp_f32 v103, v103
    v_mfma_f32_16x16x32_bf16 v[124:127], a[156:159], a[252:255], v[124:127]
    s_cmp_ge_u32 s12, 17
    s_cselect_b32 s82, 2147471360, s82
    ds_read_b128 a[140:143], v18 offset:19456
    v_cvt_pk_bf16_f32 v51, v102, v103
    v_mfma_f32_16x16x32_bf16 v[40:43], v[28:31], v[56:59], v[40:43]
    s_add_u32 s12, s12, 1
    v_exp_f32 v104, v104
    v_mfma_f32_16x16x32_bf16 v[44:47], v[28:31], v[60:63], v[44:47]
    ds_read_b128 a[144:147], v18 offset:20480
    v_min_f32 v87, v87, v67
    v_mfma_f32_16x16x32_bf16 v[192:195], a[160:163], v[56:59], v[192:195]
    v_exp_f32 v105, v105
    v_mfma_f32_16x16x32_bf16 v[224:227], a[160:163], v[60:63], v[224:227]
    ds_read_b128 a[148:151], v18 offset:21504
    v_cvt_pk_bf16_f32 v52, v104, v105
    v_mfma_f32_16x16x32_bf16 v[196:199], a[164:167], v[56:59], v[196:199]
    v_exp_f32 v106, v106
    v_mfma_f32_16x16x32_bf16 v[228:231], a[164:167], v[60:63], v[228:231]
    ds_read_b128 a[152:155], v18 offset:22528
    v_add_f32 v88, 0x73800000, v21
    v_mfma_f32_16x16x32_bf16 v[200:203], a[168:171], v[56:59], v[200:203]
    v_exp_f32 v107, v107
    v_mfma_f32_16x16x32_bf16 v[232:235], a[168:171], v[60:63], v[232:235]
    ds_read_b128 a[156:159], v18 offset:23552
    v_cvt_pk_bf16_f32 v53, v106, v107
    v_mfma_f32_16x16x32_bf16 v[204:207], a[172:175], v[56:59], v[204:207]
    v_exp_f32 v108, v108
    v_mfma_f32_16x16x32_bf16 v[236:239], a[172:175], v[60:63], v[236:239]
    buffer_load_dwordx4 v10, s[28:31], s98 offen offset:2048   lds
    v_mfma_f32_16x16x32_bf16 v[208:211], a[176:179], v[56:59], v[208:211]
    v_exp_f32 v109, v109
    v_mfma_f32_16x16x32_bf16 v[240:243], a[176:179], v[60:63], v[240:243]
    v_cvt_pk_bf16_f32 v54, v108, v109
    v_xor_b32 v18, 196608, v18
    v_mfma_f32_16x16x32_bf16 v[212:215], a[180:183], v[56:59], v[212:215]
    v_exp_f32 v110, v110
    v_mfma_f32_16x16x32_bf16 v[244:247], a[180:183], v[60:63], v[244:247]
    buffer_load_dwordx4 v11, s[28:31], s98 offen offset:3072   lds
    v_mfma_f32_16x16x32_bf16 v[216:219], a[184:187], v[56:59], v[216:219]
    s_xor_b32 s74, s24, 12288
    v_exp_f32 v111, v111
    v_mfma_f32_16x16x32_bf16 v[248:251], a[184:187], v[60:63], v[248:251]
    v_cvt_pk_bf16_f32 v55, v110, v111
    v_min_f32 v88, v88, v68
    v_mfma_f32_16x16x32_bf16 v[220:223], a[188:191], v[56:59], v[220:223]
    buffer_load_dwordx4 a[116:119], v1, s[8:11], s74 offen offset:1024
    v_mfma_f32_16x16x32_bf16 v[252:255], a[188:191], v[60:63], v[252:255]
    s_xor_b32 s74, s24, 12288
    buffer_load_dwordx4 a[120:123], v1, s[8:11], s74 offen offset:2048
    s_xor_b32 s74, s24, 12288
    buffer_load_dwordx4 a[124:127], v1, s[8:11], s74 offen offset:3072
    s_waitcnt vmcnt(13) lgkmcnt(0)
    s_barrier
    v_mfma_f32_16x16x32_bf16 v[96:99], a[128:131], a[192:195], v[64:67]
    s_add_u32 m0, s15, 0
    ds_read_b128 a[160:163], v19 offset:0
    v_mfma_f32_16x16x32_bf16 v[96:99], a[132:135], a[196:199], v[96:99]
    ds_read_b128 a[164:167], v19 offset:1024
    v_mfma_f32_16x16x32_bf16 v[96:99], a[136:139], a[200:203], v[96:99]
    v_exp_f32 v112, v112
    v_mfma_f32_16x16x32_bf16 v[96:99], a[140:143], a[204:207], v[96:99]
    buffer_load_dwordx4 v1, s[8:11], s82 offen offset:0  lds
    v_mfma_f32_16x16x32_bf16 v[104:107], a[128:131], a[208:211], v[68:71]
    v_exp_f32 v113, v113
    v_mfma_f32_16x16x32_bf16 v[104:107], a[132:135], a[212:215], v[104:107]
    ds_read_b128 a[168:171], v19 offset:2048
    v_cvt_pk_bf16_f32 v56, v112, v113
    v_mfma_f32_16x16x32_bf16 v[104:107], a[136:139], a[216:219], v[104:107]
    v_exp_f32 v114, v114
    v_mfma_f32_16x16x32_bf16 v[104:107], a[140:143], a[220:223], v[104:107]
    buffer_load_dwordx4 v1, s[8:11], s82 offen offset:1024  lds
    v_mfma_f32_16x16x32_bf16 v[100:103], a[144:147], a[192:195], v[64:67]
    v_exp_f32 v115, v115
    v_mfma_f32_16x16x32_bf16 v[100:103], a[148:151], a[196:199], v[100:103]
    ds_read_b128 a[172:175], v19 offset:3072
    v_cvt_pk_bf16_f32 v57, v114, v115
    v_mfma_f32_16x16x32_bf16 v[100:103], a[152:155], a[200:203], v[100:103]
    v_exp_f32 v116, v116
    v_mfma_f32_16x16x32_bf16 v[100:103], a[156:159], a[204:207], v[100:103]
    buffer_load_dwordx4 v1, s[8:11], s82 offen offset:2048  lds
    v_mfma_f32_16x16x32_bf16 v[108:111], a[144:147], a[208:211], v[68:71]
    v_exp_f32 v117, v117
    v_mfma_f32_16x16x32_bf16 v[108:111], a[148:151], a[212:215], v[108:111]
    ds_read_b128 a[176:179], v20 offset:4096
    v_cvt_pk_bf16_f32 v58, v116, v117
    v_mfma_f32_16x16x32_bf16 v[108:111], a[152:155], a[216:219], v[108:111]
    v_exp_f32 v118, v118
    v_mfma_f32_16x16x32_bf16 v[108:111], a[156:159], a[220:223], v[108:111]
    buffer_load_dwordx4 v1, s[8:11], s82 offen offset:3072  lds
    v_mfma_f32_16x16x32_bf16 v[32:35], v[28:31], v[48:51], v[32:35]
    s_add_u32 m0, s15, 4096
    v_exp_f32 v119, v119
    v_mfma_f32_16x16x32_bf16 v[36:39], v[28:31], v[52:55], v[36:39]
    s_waitcnt lgkmcnt(4)
    ds_read_b128 a[180:183], v20 offset:5120
    v_cvt_pk_bf16_f32 v59, v118, v119
    v_mfma_f32_16x16x32_bf16 v[128:131], a[160:163], v[48:51], v[128:131]
    s_waitcnt lgkmcnt(4)
    v_exp_f32 v120, v120
    v_mfma_f32_16x16x32_bf16 v[160:163], a[160:163], v[52:55], v[160:163]
    buffer_load_dwordx4 v15, s[8:11], s82 offen offset:0  lds
    v_mfma_f32_16x16x32_bf16 v[132:135], a[164:167], v[48:51], v[132:135]
    v_exp_f32 v121, v121
    v_mfma_f32_16x16x32_bf16 v[164:167], a[164:167], v[52:55], v[164:167]
    s_waitcnt lgkmcnt(3)
    ds_read_b128 a[184:187], v20 offset:6144
    v_cvt_pk_bf16_f32 v60, v120, v121
    v_mfma_f32_16x16x32_bf16 v[136:139], a[168:171], v[48:51], v[136:139]
    s_waitcnt lgkmcnt(3)
    v_exp_f32 v122, v122
    v_mfma_f32_16x16x32_bf16 v[168:171], a[168:171], v[52:55], v[168:171]
    buffer_load_dwordx4 v15, s[8:11], s82 offen offset:1024  lds
    v_mfma_f32_16x16x32_bf16 v[140:143], a[172:175], v[48:51], v[140:143]
    v_exp_f32 v123, v123
    v_mfma_f32_16x16x32_bf16 v[172:175], a[172:175], v[52:55], v[172:175]
    s_waitcnt lgkmcnt(2)
    ds_read_b128 a[188:191], v20 offset:7168
    v_cvt_pk_bf16_f32 v61, v122, v123
    v_mfma_f32_16x16x32_bf16 v[144:147], a[176:179], v[48:51], v[144:147]
    s_waitcnt lgkmcnt(2)
    v_exp_f32 v124, v124
    v_mfma_f32_16x16x32_bf16 v[176:179], a[176:179], v[52:55], v[176:179]
    buffer_load_dwordx4 v15, s[8:11], s82 offen offset:2048  lds
    v_mfma_f32_16x16x32_bf16 v[148:151], a[180:183], v[48:51], v[148:151]
    v_exp_f32 v125, v125
    v_mfma_f32_16x16x32_bf16 v[180:183], a[180:183], v[52:55], v[180:183]
    s_waitcnt lgkmcnt(1)
    v_cvt_pk_bf16_f32 v62, v124, v125
    v_mfma_f32_16x16x32_bf16 v[152:155], a[184:187], v[48:51], v[152:155]
    s_waitcnt lgkmcnt(0)
    v_exp_f32 v126, v126
    v_mfma_f32_16x16x32_bf16 v[184:187], a[184:187], v[52:55], v[184:187]
    buffer_load_dwordx4 v15, s[8:11], s82 offen offset:3072  lds
    v_mfma_f32_16x16x32_bf16 v[156:159], a[188:191], v[48:51], v[156:159]
    s_xor_b32 s15, s15, 196608
    v_exp_f32 v127, v127
    v_mfma_f32_16x16x32_bf16 v[188:191], a[188:191], v[52:55], v[188:191]
    s_add_u32 m0, s16, 0
    v_cvt_pk_bf16_f32 v63, v126, v127
    v_mfma_f32_16x16x32_bf16 v[112:115], a[128:131], a[224:227], v[72:75]
    v_mfma_f32_16x16x32_bf16 v[112:115], a[132:135], a[228:231], v[112:115]
    v_mfma_f32_16x16x32_bf16 v[112:115], a[136:139], a[232:235], v[112:115]
    v_exp_f32 v96, v96
    v_mfma_f32_16x16x32_bf16 v[112:115], a[140:143], a[236:239], v[112:115]
    buffer_load_dwordx4 v1, s[8:11], s19 offen offset:0  lds
    v_mfma_f32_16x16x32_bf16 v[120:123], a[128:131], a[240:243], v[76:79]
    v_exp_f32 v97, v97
    v_mfma_f32_16x16x32_bf16 v[120:123], a[132:135], a[244:247], v[120:123]
    ds_read_b128 a[128:131], v18 offset:0
    v_cvt_pk_bf16_f32 v48, v96, v97
    v_mfma_f32_16x16x32_bf16 v[120:123], a[136:139], a[248:251], v[120:123]
    v_exp_f32 v98, v98
    v_mfma_f32_16x16x32_bf16 v[120:123], a[140:143], a[252:255], v[120:123]
    buffer_load_dwordx4 v1, s[8:11], s19 offen offset:1024  lds
    v_mfma_f32_16x16x32_bf16 v[116:119], a[144:147], a[224:227], v[72:75]
    v_exp_f32 v99, v99
    v_mfma_f32_16x16x32_bf16 v[116:119], a[148:151], a[228:231], v[116:119]
    ds_read_b128 a[132:135], v18 offset:1024
    v_cvt_pk_bf16_f32 v49, v98, v99
    v_mfma_f32_16x16x32_bf16 v[116:119], a[152:155], a[232:235], v[116:119]
    v_exp_f32 v100, v100
    v_mfma_f32_16x16x32_bf16 v[116:119], a[156:159], a[236:239], v[116:119]
    buffer_load_dwordx4 v1, s[8:11], s19 offen offset:2048  lds
    v_mfma_f32_16x16x32_bf16 v[124:127], a[144:147], a[240:243], v[76:79]
    v_exp_f32 v101, v101
    v_mfma_f32_16x16x32_bf16 v[124:127], a[148:151], a[244:247], v[124:127]
    ds_read_b128 a[136:139], v18 offset:2048
    v_cvt_pk_bf16_f32 v50, v100, v101
    v_mfma_f32_16x16x32_bf16 v[124:127], a[152:155], a[248:251], v[124:127]
    v_exp_f32 v102, v102
    v_mfma_f32_16x16x32_bf16 v[124:127], a[156:159], a[252:255], v[124:127]
    buffer_load_dwordx4 v1, s[8:11], s19 offen offset:3072  lds
    v_mfma_f32_16x16x32_bf16 v[40:43], v[28:31], v[56:59], v[40:43]
    s_add_u32 m0, s16, 4096
    v_exp_f32 v103, v103
    v_mfma_f32_16x16x32_bf16 v[44:47], v[28:31], v[60:63], v[44:47]
    ds_read_b128 a[140:143], v18 offset:3072
    v_cvt_pk_bf16_f32 v51, v102, v103
    v_mfma_f32_16x16x32_bf16 v[192:195], a[160:163], v[56:59], v[192:195]
    v_exp_f32 v104, v104
    v_mfma_f32_16x16x32_bf16 v[224:227], a[160:163], v[60:63], v[224:227]
    buffer_load_dwordx4 v15, s[8:11], s19 offen offset:0  lds
    v_mfma_f32_16x16x32_bf16 v[196:199], a[164:167], v[56:59], v[196:199]
    v_exp_f32 v105, v105
    v_mfma_f32_16x16x32_bf16 v[228:231], a[164:167], v[60:63], v[228:231]
    ds_read_b128 a[144:147], v18 offset:4096
    v_cvt_pk_bf16_f32 v52, v104, v105
    v_mfma_f32_16x16x32_bf16 v[200:203], a[168:171], v[56:59], v[200:203]
    v_exp_f32 v106, v106
    v_mfma_f32_16x16x32_bf16 v[232:235], a[168:171], v[60:63], v[232:235]
    buffer_load_dwordx4 v15, s[8:11], s19 offen offset:1024  lds
    v_mfma_f32_16x16x32_bf16 v[204:207], a[172:175], v[56:59], v[204:207]
    v_exp_f32 v107, v107
    v_mfma_f32_16x16x32_bf16 v[236:239], a[172:175], v[60:63], v[236:239]
    ds_read_b128 a[148:151], v18 offset:5120
    v_cvt_pk_bf16_f32 v53, v106, v107
    v_mfma_f32_16x16x32_bf16 v[208:211], a[176:179], v[56:59], v[208:211]
    v_exp_f32 v108, v108
    v_mfma_f32_16x16x32_bf16 v[240:243], a[176:179], v[60:63], v[240:243]
    buffer_load_dwordx4 v15, s[8:11], s19 offen offset:2048  lds
    v_mfma_f32_16x16x32_bf16 v[212:215], a[180:183], v[56:59], v[212:215]
    v_exp_f32 v109, v109
    v_mfma_f32_16x16x32_bf16 v[244:247], a[180:183], v[60:63], v[244:247]
    ds_read_b128 a[152:155], v18 offset:6144
    v_cvt_pk_bf16_f32 v54, v108, v109
    v_mfma_f32_16x16x32_bf16 v[216:219], a[184:187], v[56:59], v[216:219]
    v_exp_f32 v110, v110
    v_mfma_f32_16x16x32_bf16 v[248:251], a[184:187], v[60:63], v[248:251]
    buffer_load_dwordx4 v15, s[8:11], s19 offen offset:3072  lds
    v_mfma_f32_16x16x32_bf16 v[220:223], a[188:191], v[56:59], v[220:223]
    s_xor_b32 s16, s16, 98304
    v_exp_f32 v111, v111
    v_mfma_f32_16x16x32_bf16 v[252:255], a[188:191], v[60:63], v[252:255]
    ds_read_b128 a[156:159], v18 offset:7168
    v_cvt_pk_bf16_f32 v55, v110, v111
    s_waitcnt lgkmcnt(7)
    v_mfma_f32_16x16x32_bf16 v[96:99], a[128:131], a[192:195], v[64:67]
    s_waitcnt lgkmcnt(6)
    ds_read_b128 a[160:163], v19 offset:16384
    v_mfma_f32_16x16x32_bf16 v[96:99], a[132:135], a[196:199], v[96:99]
    s_waitcnt lgkmcnt(6)
    ds_read_b128 a[164:167], v19 offset:17408
    v_mfma_f32_16x16x32_bf16 v[96:99], a[136:139], a[200:203], v[96:99]
    s_waitcnt lgkmcnt(6)
    v_exp_f32 v112, v112
    v_mfma_f32_16x16x32_bf16 v[96:99], a[140:143], a[204:207], v[96:99]
    v_mfma_f32_16x16x32_bf16 v[104:107], a[128:131], a[208:211], v[68:71]
    v_exp_f32 v113, v113
    v_mfma_f32_16x16x32_bf16 v[104:107], a[132:135], a[212:215], v[104:107]
    ds_read_b128 a[168:171], v19 offset:18432
    v_cvt_pk_bf16_f32 v56, v112, v113
    v_mfma_f32_16x16x32_bf16 v[104:107], a[136:139], a[216:219], v[104:107]
    v_exp_f32 v114, v114
    v_mfma_f32_16x16x32_bf16 v[104:107], a[140:143], a[220:223], v[104:107]
    s_waitcnt lgkmcnt(6)
    v_mfma_f32_16x16x32_bf16 v[100:103], a[144:147], a[192:195], v[64:67]
    s_waitcnt lgkmcnt(5)
    s_xor_b32 s74, s24, 16384
    v_exp_f32 v115, v115
    v_mfma_f32_16x16x32_bf16 v[100:103], a[148:151], a[196:199], v[100:103]
    s_waitcnt lgkmcnt(4)
    ds_read_b128 a[172:175], v19 offset:19456
    v_cvt_pk_bf16_f32 v57, v114, v115
    v_mfma_f32_16x16x32_bf16 v[100:103], a[152:155], a[200:203], v[100:103]
    s_waitcnt lgkmcnt(4)
    v_exp_f32 v116, v116
    v_mfma_f32_16x16x32_bf16 v[100:103], a[156:159], a[204:207], v[100:103]
    buffer_load_dwordx4 a[0:3], v1, s[8:11], s74 offen offset:0
    v_mfma_f32_16x16x32_bf16 v[108:111], a[144:147], a[208:211], v[68:71]
    s_xor_b32 s74, s24, 16384
    v_exp_f32 v117, v117
    v_mfma_f32_16x16x32_bf16 v[108:111], a[148:151], a[212:215], v[108:111]
    ds_read_b128 a[176:179], v20 offset:20480
    v_cvt_pk_bf16_f32 v58, v116, v117
    v_mfma_f32_16x16x32_bf16 v[108:111], a[152:155], a[216:219], v[108:111]
    v_exp_f32 v118, v118
    v_mfma_f32_16x16x32_bf16 v[108:111], a[156:159], a[220:223], v[108:111]
    buffer_load_dwordx4 a[4:7], v1, s[8:11], s74 offen offset:1024
    v_mfma_f32_16x16x32_bf16 v[32:35], v[28:31], v[48:51], v[32:35]
    s_xor_b32 s74, s24, 16384
    v_exp_f32 v119, v119
    v_mfma_f32_16x16x32_bf16 v[36:39], v[28:31], v[52:55], v[36:39]
    s_waitcnt lgkmcnt(4)
    ds_read_b128 a[180:183], v20 offset:21504
    v_cvt_pk_bf16_f32 v59, v118, v119
    v_mfma_f32_16x16x32_bf16 v[128:131], a[160:163], v[48:51], v[128:131]
    s_waitcnt lgkmcnt(4)
    v_exp_f32 v120, v120
    v_mfma_f32_16x16x32_bf16 v[160:163], a[160:163], v[52:55], v[160:163]
    buffer_load_dwordx4 a[8:11], v1, s[8:11], s74 offen offset:2048
    v_mfma_f32_16x16x32_bf16 v[132:135], a[164:167], v[48:51], v[132:135]
    s_xor_b32 s74, s24, 16384
    v_exp_f32 v121, v121
    v_mfma_f32_16x16x32_bf16 v[164:167], a[164:167], v[52:55], v[164:167]
    s_waitcnt lgkmcnt(3)
    ds_read_b128 a[184:187], v20 offset:22528
    v_cvt_pk_bf16_f32 v60, v120, v121
    v_mfma_f32_16x16x32_bf16 v[136:139], a[168:171], v[48:51], v[136:139]
    s_waitcnt lgkmcnt(3)
    v_exp_f32 v122, v122
    v_mfma_f32_16x16x32_bf16 v[168:171], a[168:171], v[52:55], v[168:171]
    buffer_load_dwordx4 a[12:15], v1, s[8:11], s74 offen offset:3072
    v_mfma_f32_16x16x32_bf16 v[140:143], a[172:175], v[48:51], v[140:143]
    s_xor_b32 s74, s24, 20480
    v_exp_f32 v123, v123
    v_mfma_f32_16x16x32_bf16 v[172:175], a[172:175], v[52:55], v[172:175]
    s_waitcnt lgkmcnt(2)
    ds_read_b128 a[188:191], v20 offset:23552
    v_cvt_pk_bf16_f32 v61, v122, v123
    v_mfma_f32_16x16x32_bf16 v[144:147], a[176:179], v[48:51], v[144:147]
    s_waitcnt lgkmcnt(2)
    v_exp_f32 v124, v124
    v_mfma_f32_16x16x32_bf16 v[176:179], a[176:179], v[52:55], v[176:179]
    buffer_load_dwordx4 a[16:19], v1, s[8:11], s74 offen offset:0
    v_mfma_f32_16x16x32_bf16 v[148:151], a[180:183], v[48:51], v[148:151]
    s_xor_b32 s74, s24, 20480
    v_exp_f32 v125, v125
    v_mfma_f32_16x16x32_bf16 v[180:183], a[180:183], v[52:55], v[180:183]
    s_waitcnt lgkmcnt(1)
    v_cvt_pk_bf16_f32 v62, v124, v125
    v_xor_b32 v19, 98304, v19
    v_mfma_f32_16x16x32_bf16 v[152:155], a[184:187], v[48:51], v[152:155]
    buffer_load_dwordx4 a[20:23], v1, s[8:11], s74 offen offset:1024
    v_exp_f32 v126, v126
    v_mfma_f32_16x16x32_bf16 v[184:187], a[184:187], v[52:55], v[184:187]
    s_waitcnt lgkmcnt(0)
    v_xor_b32 v20, 98304, v20
    v_mfma_f32_16x16x32_bf16 v[156:159], a[188:191], v[48:51], v[156:159]
    v_exp_f32 v127, v127
    v_mfma_f32_16x16x32_bf16 v[188:191], a[188:191], v[52:55], v[188:191]
    v_cvt_pk_bf16_f32 v63, v126, v127
    v_mfma_f32_16x16x32_bf16 v[112:115], a[128:131], a[224:227], v[72:75]
    s_xor_b32 s74, s24, 20480
    v_exp_f32 v96, v96
    v_mfma_f32_16x16x32_bf16 v[112:115], a[132:135], a[228:231], v[112:115]
    buffer_load_dwordx4 a[24:27], v1, s[8:11], s74 offen offset:2048
    v_mfma_f32_16x16x32_bf16 v[112:115], a[136:139], a[232:235], v[112:115]
    s_xor_b32 s74, s24, 20480
    v_exp_f32 v97, v97
    v_mfma_f32_16x16x32_bf16 v[112:115], a[140:143], a[236:239], v[112:115]
    v_cvt_pk_bf16_f32 v48, v96, v97
    v_add_f32 v89, 0x73700000, v21
    v_mfma_f32_16x16x32_bf16 v[120:123], a[128:131], a[240:243], v[76:79]
    v_exp_f32 v98, v98
    v_mfma_f32_16x16x32_bf16 v[120:123], a[132:135], a[244:247], v[120:123]
    buffer_load_dwordx4 a[28:31], v1, s[8:11], s74 offen offset:3072
    v_mfma_f32_16x16x32_bf16 v[120:123], a[136:139], a[248:251], v[120:123]
    s_xor_b32 s74, s24, 24576
    v_exp_f32 v99, v99
    v_mfma_f32_16x16x32_bf16 v[120:123], a[140:143], a[252:255], v[120:123]
    buffer_load_dwordx4 a[32:35], v1, s[8:11], s74 offen offset:0
    v_mfma_f32_16x16x32_bf16 v[116:119], a[144:147], a[224:227], v[72:75]
    s_xor_b32 s74, s24, 24576
    v_exp_f32 v100, v100
    v_mfma_f32_16x16x32_bf16 v[116:119], a[148:151], a[228:231], v[116:119]
    ds_read_b128 a[128:131], v18 offset:16384
    v_cvt_pk_bf16_f32 v49, v98, v99
    v_mfma_f32_16x16x32_bf16 v[116:119], a[152:155], a[232:235], v[116:119]
    s_add_u32 s19, s82, 32768
    v_exp_f32 v101, v101
    v_mfma_f32_16x16x32_bf16 v[116:119], a[156:159], a[236:239], v[116:119]
    s_sub_u32 s82, s12, s13
    ds_read_b128 a[132:135], v18 offset:17408
    v_cvt_pk_bf16_f32 v50, v100, v101
    v_mfma_f32_16x16x32_bf16 v[124:127], a[144:147], a[240:243], v[76:79]
    s_sub_u32 s82, s82, 1
    v_exp_f32 v102, v102
    v_mfma_f32_16x16x32_bf16 v[124:127], a[148:151], a[244:247], v[124:127]
    s_cmp_gt_u32 s12, s13
    s_cselect_b32 s82, s82, s12
    s_mul_i32 s82, s82, 65536
    ds_read_b128 a[136:139], v18 offset:18432
    v_mfma_f32_16x16x32_bf16 v[124:127], a[152:155], a[248:251], v[124:127]
    s_add_u32 s82, s82, s81
    v_exp_f32 v103, v103
    v_mfma_f32_16x16x32_bf16 v[124:127], a[156:159], a[252:255], v[124:127]
    s_cmp_ge_u32 s12, 17
    s_cselect_b32 s82, 2147471360, s82
    ds_read_b128 a[140:143], v18 offset:19456
    v_cvt_pk_bf16_f32 v51, v102, v103
    v_mfma_f32_16x16x32_bf16 v[40:43], v[28:31], v[56:59], v[40:43]
    s_add_u32 s12, s12, 1
    v_exp_f32 v104, v104
    v_mfma_f32_16x16x32_bf16 v[44:47], v[28:31], v[60:63], v[44:47]
    ds_read_b128 a[144:147], v18 offset:20480
    v_min_f32 v89, v89, v69
    v_mfma_f32_16x16x32_bf16 v[192:195], a[160:163], v[56:59], v[192:195]
    v_exp_f32 v105, v105
    v_mfma_f32_16x16x32_bf16 v[224:227], a[160:163], v[60:63], v[224:227]
    ds_read_b128 a[148:151], v18 offset:21504
    v_cvt_pk_bf16_f32 v52, v104, v105
    v_mfma_f32_16x16x32_bf16 v[196:199], a[164:167], v[56:59], v[196:199]
    v_exp_f32 v106, v106
    v_mfma_f32_16x16x32_bf16 v[228:231], a[164:167], v[60:63], v[228:231]
    ds_read_b128 a[152:155], v18 offset:22528
    v_add_f32 v90, 0x73600000, v21
    v_mfma_f32_16x16x32_bf16 v[200:203], a[168:171], v[56:59], v[200:203]
    v_exp_f32 v107, v107
    v_mfma_f32_16x16x32_bf16 v[232:235], a[168:171], v[60:63], v[232:235]
    ds_read_b128 a[156:159], v18 offset:23552
    v_cvt_pk_bf16_f32 v53, v106, v107
    v_mfma_f32_16x16x32_bf16 v[204:207], a[172:175], v[56:59], v[204:207]
    v_exp_f32 v108, v108
    v_mfma_f32_16x16x32_bf16 v[236:239], a[172:175], v[60:63], v[236:239]
    buffer_load_dwordx4 a[36:39], v1, s[8:11], s74 offen offset:1024
    v_mfma_f32_16x16x32_bf16 v[208:211], a[176:179], v[56:59], v[208:211]
    s_xor_b32 s74, s24, 24576
    v_exp_f32 v109, v109
    v_mfma_f32_16x16x32_bf16 v[240:243], a[176:179], v[60:63], v[240:243]
    v_cvt_pk_bf16_f32 v54, v108, v109
    v_xor_b32 v18, 196608, v18
    v_mfma_f32_16x16x32_bf16 v[212:215], a[180:183], v[56:59], v[212:215]
    v_exp_f32 v110, v110
    v_mfma_f32_16x16x32_bf16 v[244:247], a[180:183], v[60:63], v[244:247]
    buffer_load_dwordx4 a[40:43], v1, s[8:11], s74 offen offset:2048
    v_mfma_f32_16x16x32_bf16 v[216:219], a[184:187], v[56:59], v[216:219]
    s_xor_b32 s74, s24, 24576
    v_exp_f32 v111, v111
    v_mfma_f32_16x16x32_bf16 v[248:251], a[184:187], v[60:63], v[248:251]
    v_cvt_pk_bf16_f32 v55, v110, v111
    v_min_f32 v90, v90, v70
    v_mfma_f32_16x16x32_bf16 v[220:223], a[188:191], v[56:59], v[220:223]
    buffer_load_dwordx4 a[44:47], v1, s[8:11], s74 offen offset:3072
    v_mfma_f32_16x16x32_bf16 v[252:255], a[188:191], v[60:63], v[252:255]
    v_add_f32 v91, 0x73500000, v21
    v_min_f32 v91, v91, v71
    v_add_f32 v92, 0, v21
    v_min_f32 v92, v92, v68
    s_waitcnt vmcnt(12) lgkmcnt(0)
    s_barrier
    v_mfma_f32_16x16x32_bf16 v[96:99], a[128:131], a[192:195], v[64:67]
    s_add_u32 m0, s15, 0
    ds_read_b128 a[160:163], v19 offset:0
    v_mfma_f32_16x16x32_bf16 v[96:99], a[132:135], a[196:199], v[96:99]
    ds_read_b128 a[164:167], v19 offset:1024
    v_mfma_f32_16x16x32_bf16 v[96:99], a[136:139], a[200:203], v[96:99]
    v_exp_f32 v112, v112
    v_mfma_f32_16x16x32_bf16 v[96:99], a[140:143], a[204:207], v[96:99]
    buffer_load_dwordx4 v1, s[8:11], s82 offen offset:0  lds
    v_mfma_f32_16x16x32_bf16 v[104:107], a[128:131], a[208:211], v[68:71]
    v_exp_f32 v113, v113
    v_mfma_f32_16x16x32_bf16 v[104:107], a[132:135], a[212:215], v[104:107]
    ds_read_b128 a[168:171], v19 offset:2048
    v_cvt_pk_bf16_f32 v56, v112, v113
    v_mfma_f32_16x16x32_bf16 v[104:107], a[136:139], a[216:219], v[104:107]
    v_exp_f32 v114, v114
    v_mfma_f32_16x16x32_bf16 v[104:107], a[140:143], a[220:223], v[104:107]
    buffer_load_dwordx4 v1, s[8:11], s82 offen offset:1024  lds
    v_mfma_f32_16x16x32_bf16 v[100:103], a[144:147], a[192:195], v[64:67]
    v_exp_f32 v115, v115
    v_mfma_f32_16x16x32_bf16 v[100:103], a[148:151], a[196:199], v[100:103]
    ds_read_b128 a[172:175], v19 offset:3072
    v_cvt_pk_bf16_f32 v57, v114, v115
    v_mfma_f32_16x16x32_bf16 v[100:103], a[152:155], a[200:203], v[100:103]
    v_exp_f32 v116, v116
    v_mfma_f32_16x16x32_bf16 v[100:103], a[156:159], a[204:207], v[100:103]
    buffer_load_dwordx4 v1, s[8:11], s82 offen offset:2048  lds
    v_mfma_f32_16x16x32_bf16 v[108:111], a[144:147], a[208:211], v[68:71]
    v_exp_f32 v117, v117
    v_mfma_f32_16x16x32_bf16 v[108:111], a[148:151], a[212:215], v[108:111]
    ds_read_b128 a[176:179], v20 offset:4096
    v_cvt_pk_bf16_f32 v58, v116, v117
    v_mfma_f32_16x16x32_bf16 v[108:111], a[152:155], a[216:219], v[108:111]
    v_exp_f32 v118, v118
    v_mfma_f32_16x16x32_bf16 v[108:111], a[156:159], a[220:223], v[108:111]
    buffer_load_dwordx4 v1, s[8:11], s82 offen offset:3072  lds
    v_mfma_f32_16x16x32_bf16 v[32:35], v[28:31], v[48:51], v[32:35]
    s_add_u32 m0, s15, 4096
    v_exp_f32 v119, v119
    v_mfma_f32_16x16x32_bf16 v[36:39], v[28:31], v[52:55], v[36:39]
    s_waitcnt lgkmcnt(4)
    ds_read_b128 a[180:183], v20 offset:5120
    v_cvt_pk_bf16_f32 v59, v118, v119
    v_mfma_f32_16x16x32_bf16 v[128:131], a[160:163], v[48:51], v[128:131]
    s_waitcnt lgkmcnt(4)
    v_exp_f32 v120, v120
    v_mfma_f32_16x16x32_bf16 v[160:163], a[160:163], v[52:55], v[160:163]
    buffer_load_dwordx4 v15, s[8:11], s82 offen offset:0  lds
    v_mfma_f32_16x16x32_bf16 v[132:135], a[164:167], v[48:51], v[132:135]
    v_exp_f32 v121, v121
    v_mfma_f32_16x16x32_bf16 v[164:167], a[164:167], v[52:55], v[164:167]
    s_waitcnt lgkmcnt(3)
    ds_read_b128 a[184:187], v20 offset:6144
    v_cvt_pk_bf16_f32 v60, v120, v121
    v_mfma_f32_16x16x32_bf16 v[136:139], a[168:171], v[48:51], v[136:139]
    s_waitcnt lgkmcnt(3)
    v_exp_f32 v122, v122
    v_mfma_f32_16x16x32_bf16 v[168:171], a[168:171], v[52:55], v[168:171]
    buffer_load_dwordx4 v15, s[8:11], s82 offen offset:1024  lds
    v_mfma_f32_16x16x32_bf16 v[140:143], a[172:175], v[48:51], v[140:143]
    v_exp_f32 v123, v123
    v_mfma_f32_16x16x32_bf16 v[172:175], a[172:175], v[52:55], v[172:175]
    s_waitcnt lgkmcnt(2)
    ds_read_b128 a[188:191], v20 offset:7168
    v_cvt_pk_bf16_f32 v61, v122, v123
    v_mfma_f32_16x16x32_bf16 v[144:147], a[176:179], v[48:51], v[144:147]
    s_waitcnt lgkmcnt(2)
    v_exp_f32 v124, v124
    v_mfma_f32_16x16x32_bf16 v[176:179], a[176:179], v[52:55], v[176:179]
    buffer_load_dwordx4 v15, s[8:11], s82 offen offset:2048  lds
    v_mfma_f32_16x16x32_bf16 v[148:151], a[180:183], v[48:51], v[148:151]
    v_exp_f32 v125, v125
    v_mfma_f32_16x16x32_bf16 v[180:183], a[180:183], v[52:55], v[180:183]
    s_waitcnt lgkmcnt(1)
    v_cvt_pk_bf16_f32 v62, v124, v125
    v_mfma_f32_16x16x32_bf16 v[152:155], a[184:187], v[48:51], v[152:155]
    s_waitcnt lgkmcnt(0)
    v_exp_f32 v126, v126
    v_mfma_f32_16x16x32_bf16 v[184:187], a[184:187], v[52:55], v[184:187]
    buffer_load_dwordx4 v15, s[8:11], s82 offen offset:3072  lds
    v_mfma_f32_16x16x32_bf16 v[156:159], a[188:191], v[48:51], v[156:159]
    s_xor_b32 s15, s15, 196608
    v_exp_f32 v127, v127
    v_mfma_f32_16x16x32_bf16 v[188:191], a[188:191], v[52:55], v[188:191]
    s_add_u32 m0, s16, 0
    v_cvt_pk_bf16_f32 v63, v126, v127
    v_mfma_f32_16x16x32_bf16 v[112:115], a[128:131], a[224:227], v[72:75]
    v_mfma_f32_16x16x32_bf16 v[112:115], a[132:135], a[228:231], v[112:115]
    v_mfma_f32_16x16x32_bf16 v[112:115], a[136:139], a[232:235], v[112:115]
    v_exp_f32 v96, v96
    v_mfma_f32_16x16x32_bf16 v[112:115], a[140:143], a[236:239], v[112:115]
    buffer_load_dwordx4 v1, s[8:11], s19 offen offset:0  lds
    v_mfma_f32_16x16x32_bf16 v[120:123], a[128:131], a[240:243], v[76:79]
    v_exp_f32 v97, v97
    v_mfma_f32_16x16x32_bf16 v[120:123], a[132:135], a[244:247], v[120:123]
    ds_read_b128 a[128:131], v18 offset:0
    v_cvt_pk_bf16_f32 v48, v96, v97
    v_mfma_f32_16x16x32_bf16 v[120:123], a[136:139], a[248:251], v[120:123]
    v_exp_f32 v98, v98
    v_mfma_f32_16x16x32_bf16 v[120:123], a[140:143], a[252:255], v[120:123]
    buffer_load_dwordx4 v1, s[8:11], s19 offen offset:1024  lds
    v_mfma_f32_16x16x32_bf16 v[116:119], a[144:147], a[224:227], v[72:75]
    v_exp_f32 v99, v99
    v_mfma_f32_16x16x32_bf16 v[116:119], a[148:151], a[228:231], v[116:119]
    ds_read_b128 a[132:135], v18 offset:1024
    v_cvt_pk_bf16_f32 v49, v98, v99
    v_mfma_f32_16x16x32_bf16 v[116:119], a[152:155], a[232:235], v[116:119]
    v_exp_f32 v100, v100
    v_mfma_f32_16x16x32_bf16 v[116:119], a[156:159], a[236:239], v[116:119]
    buffer_load_dwordx4 v1, s[8:11], s19 offen offset:2048  lds
    v_mfma_f32_16x16x32_bf16 v[124:127], a[144:147], a[240:243], v[76:79]
    v_exp_f32 v101, v101
    v_mfma_f32_16x16x32_bf16 v[124:127], a[148:151], a[244:247], v[124:127]
    ds_read_b128 a[136:139], v18 offset:2048
    v_cvt_pk_bf16_f32 v50, v100, v101
    v_mfma_f32_16x16x32_bf16 v[124:127], a[152:155], a[248:251], v[124:127]
    v_exp_f32 v102, v102
    v_mfma_f32_16x16x32_bf16 v[124:127], a[156:159], a[252:255], v[124:127]
    buffer_load_dwordx4 v1, s[8:11], s19 offen offset:3072  lds
    v_mfma_f32_16x16x32_bf16 v[40:43], v[28:31], v[56:59], v[40:43]
    s_add_u32 m0, s16, 4096
    v_exp_f32 v103, v103
    v_mfma_f32_16x16x32_bf16 v[44:47], v[28:31], v[60:63], v[44:47]
    ds_read_b128 a[140:143], v18 offset:3072
    v_cvt_pk_bf16_f32 v51, v102, v103
    v_mfma_f32_16x16x32_bf16 v[192:195], a[160:163], v[56:59], v[192:195]
    v_exp_f32 v104, v104
    v_mfma_f32_16x16x32_bf16 v[224:227], a[160:163], v[60:63], v[224:227]
    buffer_load_dwordx4 v15, s[8:11], s19 offen offset:0  lds
    v_mfma_f32_16x16x32_bf16 v[196:199], a[164:167], v[56:59], v[196:199]
    v_exp_f32 v105, v105
    v_mfma_f32_16x16x32_bf16 v[228:231], a[164:167], v[60:63], v[228:231]
    ds_read_b128 a[144:147], v18 offset:4096
    v_cvt_pk_bf16_f32 v52, v104, v105
    v_mfma_f32_16x16x32_bf16 v[200:203], a[168:171], v[56:59], v[200:203]
    v_exp_f32 v106, v106
    v_mfma_f32_16x16x32_bf16 v[232:235], a[168:171], v[60:63], v[232:235]
    buffer_load_dwordx4 v15, s[8:11], s19 offen offset:1024  lds
    v_mfma_f32_16x16x32_bf16 v[204:207], a[172:175], v[56:59], v[204:207]
    v_exp_f32 v107, v107
    v_mfma_f32_16x16x32_bf16 v[236:239], a[172:175], v[60:63], v[236:239]
    ds_read_b128 a[148:151], v18 offset:5120
    v_cvt_pk_bf16_f32 v53, v106, v107
    v_mfma_f32_16x16x32_bf16 v[208:211], a[176:179], v[56:59], v[208:211]
    v_exp_f32 v108, v108
    v_mfma_f32_16x16x32_bf16 v[240:243], a[176:179], v[60:63], v[240:243]
    buffer_load_dwordx4 v15, s[8:11], s19 offen offset:2048  lds
    v_mfma_f32_16x16x32_bf16 v[212:215], a[180:183], v[56:59], v[212:215]
    v_exp_f32 v109, v109
    v_mfma_f32_16x16x32_bf16 v[244:247], a[180:183], v[60:63], v[244:247]
    ds_read_b128 a[152:155], v18 offset:6144
    v_cvt_pk_bf16_f32 v54, v108, v109
    v_mfma_f32_16x16x32_bf16 v[216:219], a[184:187], v[56:59], v[216:219]
    v_exp_f32 v110, v110
    v_mfma_f32_16x16x32_bf16 v[248:251], a[184:187], v[60:63], v[248:251]
    buffer_load_dwordx4 v15, s[8:11], s19 offen offset:3072  lds
    v_mfma_f32_16x16x32_bf16 v[220:223], a[188:191], v[56:59], v[220:223]
    s_xor_b32 s16, s16, 98304
    v_exp_f32 v111, v111
    v_mfma_f32_16x16x32_bf16 v[252:255], a[188:191], v[60:63], v[252:255]
    ds_read_b128 a[156:159], v18 offset:7168
    v_cvt_pk_bf16_f32 v55, v110, v111
    s_waitcnt lgkmcnt(7)
    v_mfma_f32_16x16x32_bf16 v[96:99], a[128:131], a[192:195], v[64:67]
    s_waitcnt lgkmcnt(6)
    ds_read_b128 a[160:163], v19 offset:16384
    v_add_f32 v93, 0xf1800000, v21
    v_mfma_f32_16x16x32_bf16 v[96:99], a[132:135], a[196:199], v[96:99]
    s_waitcnt lgkmcnt(6)
    ds_read_b128 a[164:167], v19 offset:17408
    v_min_f32 v93, v93, v69
    v_mfma_f32_16x16x32_bf16 v[96:99], a[136:139], a[200:203], v[96:99]
    s_waitcnt lgkmcnt(6)
    v_exp_f32 v112, v112
    v_mfma_f32_16x16x32_bf16 v[96:99], a[140:143], a[204:207], v[96:99]
    v_add_f32 v94, 0xf2000000, v21
    v_min_f32 v94, v94, v70
    v_mfma_f32_16x16x32_bf16 v[104:107], a[128:131], a[208:211], v[68:71]
    v_exp_f32 v113, v113
    v_mfma_f32_16x16x32_bf16 v[104:107], a[132:135], a[212:215], v[104:107]
    ds_read_b128 a[168:171], v19 offset:18432
    v_cvt_pk_bf16_f32 v56, v112, v113
    v_mfma_f32_16x16x32_bf16 v[104:107], a[136:139], a[216:219], v[104:107]
    v_exp_f32 v114, v114
    v_mfma_f32_16x16x32_bf16 v[104:107], a[140:143], a[220:223], v[104:107]
    s_waitcnt lgkmcnt(6)
    v_add_f32 v95, 0xf2400000, v21
    v_min_f32 v95, v95, v71
    v_mfma_f32_16x16x32_bf16 v[100:103], a[144:147], a[192:195], v[64:67]
    s_waitcnt lgkmcnt(5)
    s_xor_b32 s74, s24, 28672
    v_exp_f32 v115, v115
    v_mfma_f32_16x16x32_bf16 v[100:103], a[148:151], a[196:199], v[100:103]
    s_waitcnt lgkmcnt(4)
    ds_read_b128 a[172:175], v19 offset:19456
    v_cvt_pk_bf16_f32 v57, v114, v115
    v_mfma_f32_16x16x32_bf16 v[100:103], a[152:155], a[200:203], v[100:103]
    s_waitcnt lgkmcnt(4)
    v_exp_f32 v116, v116
    v_mfma_f32_16x16x32_bf16 v[100:103], a[156:159], a[204:207], v[100:103]
    buffer_load_dwordx4 a[48:51], v1, s[8:11], s74 offen offset:0
    v_mfma_f32_16x16x32_bf16 v[108:111], a[144:147], a[208:211], v[68:71]
    s_xor_b32 s74, s24, 28672
    v_exp_f32 v117, v117
    v_mfma_f32_16x16x32_bf16 v[108:111], a[148:151], a[212:215], v[108:111]
    ds_read_b128 a[176:179], v20 offset:20480
    v_cvt_pk_bf16_f32 v58, v116, v117
    v_mfma_f32_16x16x32_bf16 v[108:111], a[152:155], a[216:219], v[108:111]
    v_exp_f32 v118, v118
    v_mfma_f32_16x16x32_bf16 v[108:111], a[156:159], a[220:223], v[108:111]
    buffer_load_dwordx4 a[52:55], v1, s[8:11], s74 offen offset:1024
    v_mfma_f32_16x16x32_bf16 v[32:35], v[28:31], v[48:51], v[32:35]
    s_xor_b32 s74, s24, 28672
    v_exp_f32 v119, v119
    v_mfma_f32_16x16x32_bf16 v[36:39], v[28:31], v[52:55], v[36:39]
    s_waitcnt lgkmcnt(4)
    ds_read_b128 a[180:183], v20 offset:21504
    v_cvt_pk_bf16_f32 v59, v118, v119
    v_mfma_f32_16x16x32_bf16 v[128:131], a[160:163], v[48:51], v[128:131]
    s_waitcnt lgkmcnt(4)
    v_exp_f32 v120, v120
    v_mfma_f32_16x16x32_bf16 v[160:163], a[160:163], v[52:55], v[160:163]
    buffer_load_dwordx4 a[56:59], v1, s[8:11], s74 offen offset:2048
    v_mfma_f32_16x16x32_bf16 v[132:135], a[164:167], v[48:51], v[132:135]
    s_xor_b32 s74, s24, 28672
    v_exp_f32 v121, v121
    v_mfma_f32_16x16x32_bf16 v[164:167], a[164:167], v[52:55], v[164:167]
    s_waitcnt lgkmcnt(3)
    ds_read_b128 a[184:187], v20 offset:22528
    v_cvt_pk_bf16_f32 v60, v120, v121
    v_mfma_f32_16x16x32_bf16 v[136:139], a[168:171], v[48:51], v[136:139]
    s_waitcnt lgkmcnt(3)
    v_exp_f32 v122, v122
    v_mfma_f32_16x16x32_bf16 v[168:171], a[168:171], v[52:55], v[168:171]
    buffer_load_dwordx4 a[60:63], v1, s[8:11], s74 offen offset:3072
    v_mfma_f32_16x16x32_bf16 v[140:143], a[172:175], v[48:51], v[140:143]
    v_exp_f32 v123, v123
    v_mfma_f32_16x16x32_bf16 v[172:175], a[172:175], v[52:55], v[172:175]
    s_waitcnt lgkmcnt(2)
    ds_read_b128 a[188:191], v20 offset:23552
    v_cvt_pk_bf16_f32 v61, v122, v123
    v_mfma_f32_16x16x32_bf16 v[144:147], a[176:179], v[48:51], v[144:147]
    v_exp_f32 v124, v124
    v_mfma_f32_16x16x32_bf16 v[176:179], a[176:179], v[52:55], v[176:179]
    s_waitcnt lgkmcnt(2)
    v_mfma_f32_16x16x32_bf16 v[148:151], a[180:183], v[48:51], v[148:151]
    v_exp_f32 v125, v125
    v_mfma_f32_16x16x32_bf16 v[180:183], a[180:183], v[52:55], v[180:183]
    s_waitcnt lgkmcnt(1)
    v_cvt_pk_bf16_f32 v62, v124, v125
    v_xor_b32 v19, 98304, v19
    v_mfma_f32_16x16x32_bf16 v[152:155], a[184:187], v[48:51], v[152:155]
    v_exp_f32 v126, v126
    v_mfma_f32_16x16x32_bf16 v[184:187], a[184:187], v[52:55], v[184:187]
    s_waitcnt lgkmcnt(0)
    v_xor_b32 v20, 98304, v20
    v_mfma_f32_16x16x32_bf16 v[156:159], a[188:191], v[48:51], v[156:159]
    v_exp_f32 v127, v127
    v_mfma_f32_16x16x32_bf16 v[188:191], a[188:191], v[52:55], v[188:191]
    v_cvt_pk_bf16_f32 v63, v126, v127
    v_mfma_f32_16x16x32_bf16 v[112:115], a[128:131], a[224:227], v[72:75]
    v_exp_f32 v96, v96
    v_mfma_f32_16x16x32_bf16 v[112:115], a[132:135], a[228:231], v[112:115]
    v_mfma_f32_16x16x32_bf16 v[112:115], a[136:139], a[232:235], v[112:115]
    v_exp_f32 v97, v97
    v_mfma_f32_16x16x32_bf16 v[112:115], a[140:143], a[236:239], v[112:115]
    v_cvt_pk_bf16_f32 v48, v96, v97
    v_mfma_f32_16x16x32_bf16 v[120:123], a[128:131], a[240:243], v[76:79]
    v_exp_f32 v98, v98
    v_mfma_f32_16x16x32_bf16 v[120:123], a[132:135], a[244:247], v[120:123]
    v_mfma_f32_16x16x32_bf16 v[120:123], a[136:139], a[248:251], v[120:123]
    v_exp_f32 v99, v99
    v_mfma_f32_16x16x32_bf16 v[120:123], a[140:143], a[252:255], v[120:123]
    v_mfma_f32_16x16x32_bf16 v[116:119], a[144:147], a[224:227], v[72:75]
    v_exp_f32 v100, v100
    v_mfma_f32_16x16x32_bf16 v[116:119], a[148:151], a[228:231], v[116:119]
    ds_read_b128 a[128:131], v18 offset:16384
    v_cvt_pk_bf16_f32 v49, v98, v99
    v_mfma_f32_16x16x32_bf16 v[116:119], a[152:155], a[232:235], v[116:119]
    s_add_u32 s19, s82, 32768
    v_exp_f32 v101, v101
    v_mfma_f32_16x16x32_bf16 v[116:119], a[156:159], a[236:239], v[116:119]
    s_sub_u32 s82, s12, s13
    ds_read_b128 a[132:135], v18 offset:17408
    v_cvt_pk_bf16_f32 v50, v100, v101
    v_mfma_f32_16x16x32_bf16 v[124:127], a[144:147], a[240:243], v[76:79]
    s_sub_u32 s82, s82, 1
    v_exp_f32 v102, v102
    v_mfma_f32_16x16x32_bf16 v[124:127], a[148:151], a[244:247], v[124:127]
    s_cmp_gt_u32 s12, s13
    s_cselect_b32 s82, s82, s12
    s_mul_i32 s82, s82, 65536
    ds_read_b128 a[136:139], v18 offset:18432
    v_mfma_f32_16x16x32_bf16 v[124:127], a[152:155], a[248:251], v[124:127]
    s_add_u32 s82, s82, s81
    v_exp_f32 v103, v103
    v_mfma_f32_16x16x32_bf16 v[124:127], a[156:159], a[252:255], v[124:127]
    s_cmp_ge_u32 s12, 17
    s_cselect_b32 s82, 2147471360, s82
    ds_read_b128 a[140:143], v18 offset:19456
    v_cvt_pk_bf16_f32 v51, v102, v103
    v_mfma_f32_16x16x32_bf16 v[40:43], v[28:31], v[56:59], v[40:43]
    s_add_u32 s12, s12, 1
    v_exp_f32 v104, v104
    v_mfma_f32_16x16x32_bf16 v[44:47], v[28:31], v[60:63], v[44:47]
    ds_read_b128 a[144:147], v18 offset:20480
    v_mfma_f32_16x16x32_bf16 v[192:195], a[160:163], v[56:59], v[192:195]
    v_exp_f32 v105, v105
    v_mfma_f32_16x16x32_bf16 v[224:227], a[160:163], v[60:63], v[224:227]
    ds_read_b128 a[148:151], v18 offset:21504
    v_cvt_pk_bf16_f32 v52, v104, v105
    v_mfma_f32_16x16x32_bf16 v[196:199], a[164:167], v[56:59], v[196:199]
    v_exp_f32 v106, v106
    v_mfma_f32_16x16x32_bf16 v[228:231], a[164:167], v[60:63], v[228:231]
    ds_read_b128 a[152:155], v18 offset:22528
    v_mfma_f32_16x16x32_bf16 v[200:203], a[168:171], v[56:59], v[200:203]
    v_exp_f32 v107, v107
    v_mfma_f32_16x16x32_bf16 v[232:235], a[168:171], v[60:63], v[232:235]
    ds_read_b128 a[156:159], v18 offset:23552
    v_cvt_pk_bf16_f32 v53, v106, v107
    v_mfma_f32_16x16x32_bf16 v[204:207], a[172:175], v[56:59], v[204:207]
    v_exp_f32 v108, v108
    v_mfma_f32_16x16x32_bf16 v[236:239], a[172:175], v[60:63], v[236:239]
    v_mfma_f32_16x16x32_bf16 v[208:211], a[176:179], v[56:59], v[208:211]
    v_exp_f32 v109, v109
    v_mfma_f32_16x16x32_bf16 v[240:243], a[176:179], v[60:63], v[240:243]
    v_cvt_pk_bf16_f32 v54, v108, v109
    v_xor_b32 v18, 196608, v18
    v_mfma_f32_16x16x32_bf16 v[212:215], a[180:183], v[56:59], v[212:215]
    v_exp_f32 v110, v110
    v_mfma_f32_16x16x32_bf16 v[244:247], a[180:183], v[60:63], v[244:247]
    v_mfma_f32_16x16x32_bf16 v[216:219], a[184:187], v[56:59], v[216:219]
    v_exp_f32 v111, v111
    v_mfma_f32_16x16x32_bf16 v[248:251], a[184:187], v[60:63], v[248:251]
    v_cvt_pk_bf16_f32 v55, v110, v111
    v_mfma_f32_16x16x32_bf16 v[220:223], a[188:191], v[56:59], v[220:223]
    v_mfma_f32_16x16x32_bf16 v[252:255], a[188:191], v[60:63], v[252:255]
    s_waitcnt vmcnt(4) lgkmcnt(0)
    s_barrier
    v_mfma_f32_16x16x32_bf16 v[96:99], a[128:131], a[192:195], v[64:67]
    s_add_u32 m0, s15, 0
    ds_read_b128 a[160:163], v19 offset:0
    v_mfma_f32_16x16x32_bf16 v[96:99], a[132:135], a[196:199], v[96:99]
    ds_read_b128 a[164:167], v19 offset:1024
    v_mfma_f32_16x16x32_bf16 v[96:99], a[136:139], a[200:203], v[96:99]
    v_exp_f32 v112, v112
    v_mfma_f32_16x16x32_bf16 v[96:99], a[140:143], a[204:207], v[96:99]
    buffer_load_dwordx4 v1, s[8:11], s82 offen offset:0  lds
    v_mfma_f32_16x16x32_bf16 v[104:107], a[128:131], a[208:211], v[68:71]
    v_exp_f32 v113, v113
    v_mfma_f32_16x16x32_bf16 v[104:107], a[132:135], a[212:215], v[104:107]
    ds_read_b128 a[168:171], v19 offset:2048
    v_cvt_pk_bf16_f32 v56, v112, v113
    v_mfma_f32_16x16x32_bf16 v[104:107], a[136:139], a[216:219], v[104:107]
    v_exp_f32 v114, v114
    v_mfma_f32_16x16x32_bf16 v[104:107], a[140:143], a[220:223], v[104:107]
    buffer_load_dwordx4 v1, s[8:11], s82 offen offset:1024  lds
    v_mfma_f32_16x16x32_bf16 v[100:103], a[144:147], a[192:195], v[64:67]
    v_exp_f32 v115, v115
    v_mfma_f32_16x16x32_bf16 v[100:103], a[148:151], a[196:199], v[100:103]
    ds_read_b128 a[172:175], v19 offset:3072
    v_cvt_pk_bf16_f32 v57, v114, v115
    v_mfma_f32_16x16x32_bf16 v[100:103], a[152:155], a[200:203], v[100:103]
    v_exp_f32 v116, v116
    v_mfma_f32_16x16x32_bf16 v[100:103], a[156:159], a[204:207], v[100:103]
    buffer_load_dwordx4 v1, s[8:11], s82 offen offset:2048  lds
    v_mfma_f32_16x16x32_bf16 v[108:111], a[144:147], a[208:211], v[68:71]
    v_exp_f32 v117, v117
    v_mfma_f32_16x16x32_bf16 v[108:111], a[148:151], a[212:215], v[108:111]
    ds_read_b128 a[176:179], v20 offset:4096
    v_cvt_pk_bf16_f32 v58, v116, v117
    v_mfma_f32_16x16x32_bf16 v[108:111], a[152:155], a[216:219], v[108:111]
    v_exp_f32 v118, v118
    v_mfma_f32_16x16x32_bf16 v[108:111], a[156:159], a[220:223], v[108:111]
    buffer_load_dwordx4 v1, s[8:11], s82 offen offset:3072  lds
    v_mfma_f32_16x16x32_bf16 v[32:35], v[28:31], v[48:51], v[32:35]
    s_add_u32 m0, s15, 4096
    v_exp_f32 v119, v119
    v_mfma_f32_16x16x32_bf16 v[36:39], v[28:31], v[52:55], v[36:39]
    s_waitcnt lgkmcnt(4)
    ds_read_b128 a[180:183], v20 offset:5120
    v_cvt_pk_bf16_f32 v59, v118, v119
    v_mfma_f32_16x16x32_bf16 v[128:131], a[160:163], v[48:51], v[128:131]
    s_waitcnt lgkmcnt(4)
    v_exp_f32 v120, v120
    v_mfma_f32_16x16x32_bf16 v[160:163], a[160:163], v[52:55], v[160:163]
    buffer_load_dwordx4 v15, s[8:11], s82 offen offset:0  lds
    v_mfma_f32_16x16x32_bf16 v[132:135], a[164:167], v[48:51], v[132:135]
    v_exp_f32 v121, v121
    v_mfma_f32_16x16x32_bf16 v[164:167], a[164:167], v[52:55], v[164:167]
    s_waitcnt lgkmcnt(3)
    ds_read_b128 a[184:187], v20 offset:6144
    v_cvt_pk_bf16_f32 v60, v120, v121
    v_mfma_f32_16x16x32_bf16 v[136:139], a[168:171], v[48:51], v[136:139]
    s_waitcnt lgkmcnt(3)
    v_exp_f32 v122, v122
    v_mfma_f32_16x16x32_bf16 v[168:171], a[168:171], v[52:55], v[168:171]
    buffer_load_dwordx4 v15, s[8:11], s82 offen offset:1024  lds
    v_mfma_f32_16x16x32_bf16 v[140:143], a[172:175], v[48:51], v[140:143]
    v_exp_f32 v123, v123
    v_mfma_f32_16x16x32_bf16 v[172:175], a[172:175], v[52:55], v[172:175]
    s_waitcnt lgkmcnt(2)
    ds_read_b128 a[188:191], v20 offset:7168
    v_cvt_pk_bf16_f32 v61, v122, v123
    v_mfma_f32_16x16x32_bf16 v[144:147], a[176:179], v[48:51], v[144:147]
    s_waitcnt lgkmcnt(2)
    v_exp_f32 v124, v124
    v_mfma_f32_16x16x32_bf16 v[176:179], a[176:179], v[52:55], v[176:179]
    buffer_load_dwordx4 v15, s[8:11], s82 offen offset:2048  lds
    v_mfma_f32_16x16x32_bf16 v[148:151], a[180:183], v[48:51], v[148:151]
    v_exp_f32 v125, v125
    v_mfma_f32_16x16x32_bf16 v[180:183], a[180:183], v[52:55], v[180:183]
    s_waitcnt lgkmcnt(1)
    v_cvt_pk_bf16_f32 v62, v124, v125
    v_mfma_f32_16x16x32_bf16 v[152:155], a[184:187], v[48:51], v[152:155]
    s_waitcnt lgkmcnt(0)
    v_exp_f32 v126, v126
    v_mfma_f32_16x16x32_bf16 v[184:187], a[184:187], v[52:55], v[184:187]
    buffer_load_dwordx4 v15, s[8:11], s82 offen offset:3072  lds
    v_mfma_f32_16x16x32_bf16 v[156:159], a[188:191], v[48:51], v[156:159]
    s_xor_b32 s15, s15, 196608
    v_exp_f32 v127, v127
    v_mfma_f32_16x16x32_bf16 v[188:191], a[188:191], v[52:55], v[188:191]
    s_add_u32 m0, s16, 0
    v_cvt_pk_bf16_f32 v63, v126, v127
    v_mfma_f32_16x16x32_bf16 v[112:115], a[128:131], a[224:227], v[72:75]
    v_mfma_f32_16x16x32_bf16 v[112:115], a[132:135], a[228:231], v[112:115]
    v_mfma_f32_16x16x32_bf16 v[112:115], a[136:139], a[232:235], v[112:115]
    v_exp_f32 v96, v96
    v_mfma_f32_16x16x32_bf16 v[112:115], a[140:143], a[236:239], v[112:115]
    buffer_load_dwordx4 v1, s[8:11], s19 offen offset:0  lds
    v_mfma_f32_16x16x32_bf16 v[120:123], a[128:131], a[240:243], v[76:79]
    v_exp_f32 v97, v97
    v_mfma_f32_16x16x32_bf16 v[120:123], a[132:135], a[244:247], v[120:123]
    ds_read_b128 a[128:131], v18 offset:0
    v_cvt_pk_bf16_f32 v48, v96, v97
    v_mfma_f32_16x16x32_bf16 v[120:123], a[136:139], a[248:251], v[120:123]
    v_exp_f32 v98, v98
    v_mfma_f32_16x16x32_bf16 v[120:123], a[140:143], a[252:255], v[120:123]
    buffer_load_dwordx4 v1, s[8:11], s19 offen offset:1024  lds
    v_mfma_f32_16x16x32_bf16 v[116:119], a[144:147], a[224:227], v[72:75]
    v_exp_f32 v99, v99
    v_mfma_f32_16x16x32_bf16 v[116:119], a[148:151], a[228:231], v[116:119]
    ds_read_b128 a[132:135], v18 offset:1024
    v_cvt_pk_bf16_f32 v49, v98, v99
    v_mfma_f32_16x16x32_bf16 v[116:119], a[152:155], a[232:235], v[116:119]
    v_exp_f32 v100, v100
    v_mfma_f32_16x16x32_bf16 v[116:119], a[156:159], a[236:239], v[116:119]
    buffer_load_dwordx4 v1, s[8:11], s19 offen offset:2048  lds
    v_mfma_f32_16x16x32_bf16 v[124:127], a[144:147], a[240:243], v[76:79]
    v_exp_f32 v101, v101
    v_mfma_f32_16x16x32_bf16 v[124:127], a[148:151], a[244:247], v[124:127]
    ds_read_b128 a[136:139], v18 offset:2048
    v_cvt_pk_bf16_f32 v50, v100, v101
    v_mfma_f32_16x16x32_bf16 v[124:127], a[152:155], a[248:251], v[124:127]
    v_exp_f32 v102, v102
    v_mfma_f32_16x16x32_bf16 v[124:127], a[156:159], a[252:255], v[124:127]
    buffer_load_dwordx4 v1, s[8:11], s19 offen offset:3072  lds
    v_mfma_f32_16x16x32_bf16 v[40:43], v[28:31], v[56:59], v[40:43]
    s_add_u32 m0, s16, 4096
    v_exp_f32 v103, v103
    v_mfma_f32_16x16x32_bf16 v[44:47], v[28:31], v[60:63], v[44:47]
    ds_read_b128 a[140:143], v18 offset:3072
    v_cvt_pk_bf16_f32 v51, v102, v103
    v_mfma_f32_16x16x32_bf16 v[192:195], a[160:163], v[56:59], v[192:195]
    v_exp_f32 v104, v104
    v_mfma_f32_16x16x32_bf16 v[224:227], a[160:163], v[60:63], v[224:227]
    buffer_load_dwordx4 v15, s[8:11], s19 offen offset:0  lds
    v_mfma_f32_16x16x32_bf16 v[196:199], a[164:167], v[56:59], v[196:199]
    v_exp_f32 v105, v105
    v_mfma_f32_16x16x32_bf16 v[228:231], a[164:167], v[60:63], v[228:231]
    ds_read_b128 a[144:147], v18 offset:4096
    v_cvt_pk_bf16_f32 v52, v104, v105
    v_mfma_f32_16x16x32_bf16 v[200:203], a[168:171], v[56:59], v[200:203]
    v_exp_f32 v106, v106
    v_mfma_f32_16x16x32_bf16 v[232:235], a[168:171], v[60:63], v[232:235]
    buffer_load_dwordx4 v15, s[8:11], s19 offen offset:1024  lds
    v_mfma_f32_16x16x32_bf16 v[204:207], a[172:175], v[56:59], v[204:207]
    v_exp_f32 v107, v107
    v_mfma_f32_16x16x32_bf16 v[236:239], a[172:175], v[60:63], v[236:239]
    ds_read_b128 a[148:151], v18 offset:5120
    v_cvt_pk_bf16_f32 v53, v106, v107
    v_mfma_f32_16x16x32_bf16 v[208:211], a[176:179], v[56:59], v[208:211]
    v_exp_f32 v108, v108
    v_mfma_f32_16x16x32_bf16 v[240:243], a[176:179], v[60:63], v[240:243]
    buffer_load_dwordx4 v15, s[8:11], s19 offen offset:2048  lds
    v_mfma_f32_16x16x32_bf16 v[212:215], a[180:183], v[56:59], v[212:215]
    v_exp_f32 v109, v109
    v_mfma_f32_16x16x32_bf16 v[244:247], a[180:183], v[60:63], v[244:247]
    ds_read_b128 a[152:155], v18 offset:6144
    v_cvt_pk_bf16_f32 v54, v108, v109
    v_mfma_f32_16x16x32_bf16 v[216:219], a[184:187], v[56:59], v[216:219]
    v_exp_f32 v110, v110
    v_mfma_f32_16x16x32_bf16 v[248:251], a[184:187], v[60:63], v[248:251]
    buffer_load_dwordx4 v15, s[8:11], s19 offen offset:3072  lds
    v_mfma_f32_16x16x32_bf16 v[220:223], a[188:191], v[56:59], v[220:223]
    s_xor_b32 s16, s16, 98304
    v_exp_f32 v111, v111
    v_mfma_f32_16x16x32_bf16 v[252:255], a[188:191], v[60:63], v[252:255]
    ds_read_b128 a[156:159], v18 offset:7168
    v_cvt_pk_bf16_f32 v55, v110, v111
    s_cmp_eq_u32 s14, 0
    s_cbranch_scc1 L_t2_diag
.p2align 3
L_t2_loop:
    s_waitcnt lgkmcnt(7)
    v_mfma_f32_16x16x32_bf16 v[96:99], a[128:131], a[192:195], v[64:67]
    s_waitcnt lgkmcnt(6)
    ds_read_b128 a[160:163], v19 offset:16384
    v_mfma_f32_16x16x32_bf16 v[96:99], a[132:135], a[196:199], v[96:99]
    s_waitcnt lgkmcnt(6)
    ds_read_b128 a[164:167], v19 offset:17408
    v_mfma_f32_16x16x32_bf16 v[96:99], a[136:139], a[200:203], v[96:99]
    s_waitcnt lgkmcnt(6)
    v_exp_f32 v112, v112
    v_mfma_f32_16x16x32_bf16 v[96:99], a[140:143], a[204:207], v[96:99]
    v_mfma_f32_16x16x32_bf16 v[104:107], a[128:131], a[208:211], v[68:71]
    v_exp_f32 v113, v113
    v_mfma_f32_16x16x32_bf16 v[104:107], a[132:135], a[212:215], v[104:107]
    ds_read_b128 a[168:171], v19 offset:18432
    v_cvt_pk_bf16_f32 v56, v112, v113
    v_mfma_f32_16x16x32_bf16 v[104:107], a[136:139], a[216:219], v[104:107]
    v_exp_f32 v114, v114
    v_mfma_f32_16x16x32_bf16 v[104:107], a[140:143], a[220:223], v[104:107]
    s_waitcnt lgkmcnt(6)
    v_mfma_f32_16x16x32_bf16 v[100:103], a[144:147], a[192:195], v[64:67]
    s_waitcnt lgkmcnt(5)
    v_exp_f32 v115, v115
    v_mfma_f32_16x16x32_bf16 v[100:103], a[148:151], a[196:199], v[100:103]
    s_waitcnt lgkmcnt(4)
    ds_read_b128 a[172:175], v19 offset:19456
    v_cvt_pk_bf16_f32 v57, v114, v115
    v_mfma_f32_16x16x32_bf16 v[100:103], a[152:155], a[200:203], v[100:103]
    s_waitcnt lgkmcnt(4)
    v_exp_f32 v116, v116
    v_mfma_f32_16x16x32_bf16 v[100:103], a[156:159], a[204:207], v[100:103]
    v_mfma_f32_16x16x32_bf16 v[108:111], a[144:147], a[208:211], v[68:71]
    v_exp_f32 v117, v117
    v_mfma_f32_16x16x32_bf16 v[108:111], a[148:151], a[212:215], v[108:111]
    ds_read_b128 a[176:179], v20 offset:20480
    v_cvt_pk_bf16_f32 v58, v116, v117
    v_mfma_f32_16x16x32_bf16 v[108:111], a[152:155], a[216:219], v[108:111]
    v_exp_f32 v118, v118
    v_mfma_f32_16x16x32_bf16 v[108:111], a[156:159], a[220:223], v[108:111]
    v_mfma_f32_16x16x32_bf16 v[32:35], v[28:31], v[48:51], v[32:35]
    v_exp_f32 v119, v119
    v_mfma_f32_16x16x32_bf16 v[36:39], v[28:31], v[52:55], v[36:39]
    s_waitcnt lgkmcnt(4)
    ds_read_b128 a[180:183], v20 offset:21504
    v_cvt_pk_bf16_f32 v59, v118, v119
    v_mfma_f32_16x16x32_bf16 v[128:131], a[160:163], v[48:51], v[128:131]
    v_exp_f32 v120, v120
    v_mfma_f32_16x16x32_bf16 v[160:163], a[160:163], v[52:55], v[160:163]
    s_waitcnt lgkmcnt(4)
    v_mfma_f32_16x16x32_bf16 v[132:135], a[164:167], v[48:51], v[132:135]
    v_exp_f32 v121, v121
    v_mfma_f32_16x16x32_bf16 v[164:167], a[164:167], v[52:55], v[164:167]
    s_waitcnt lgkmcnt(3)
    ds_read_b128 a[184:187], v20 offset:22528
    v_cvt_pk_bf16_f32 v60, v120, v121
    v_mfma_f32_16x16x32_bf16 v[136:139], a[168:171], v[48:51], v[136:139]
    v_exp_f32 v122, v122
    v_mfma_f32_16x16x32_bf16 v[168:171], a[168:171], v[52:55], v[168:171]
    s_waitcnt lgkmcnt(3)
    v_mfma_f32_16x16x32_bf16 v[140:143], a[172:175], v[48:51], v[140:143]
    v_exp_f32 v123, v123
    v_mfma_f32_16x16x32_bf16 v[172:175], a[172:175], v[52:55], v[172:175]
    s_waitcnt lgkmcnt(2)
    ds_read_b128 a[188:191], v20 offset:23552
    v_cvt_pk_bf16_f32 v61, v122, v123
    v_mfma_f32_16x16x32_bf16 v[144:147], a[176:179], v[48:51], v[144:147]
    v_exp_f32 v124, v124
    v_mfma_f32_16x16x32_bf16 v[176:179], a[176:179], v[52:55], v[176:179]
    s_waitcnt lgkmcnt(2)
    v_mfma_f32_16x16x32_bf16 v[148:151], a[180:183], v[48:51], v[148:151]
    v_exp_f32 v125, v125
    v_mfma_f32_16x16x32_bf16 v[180:183], a[180:183], v[52:55], v[180:183]
    s_waitcnt lgkmcnt(1)
    v_cvt_pk_bf16_f32 v62, v124, v125
    v_xor_b32 v19, 98304, v19
    v_mfma_f32_16x16x32_bf16 v[152:155], a[184:187], v[48:51], v[152:155]
    v_exp_f32 v126, v126
    v_mfma_f32_16x16x32_bf16 v[184:187], a[184:187], v[52:55], v[184:187]
    s_waitcnt lgkmcnt(0)
    v_xor_b32 v20, 98304, v20
    v_mfma_f32_16x16x32_bf16 v[156:159], a[188:191], v[48:51], v[156:159]
    v_exp_f32 v127, v127
    v_mfma_f32_16x16x32_bf16 v[188:191], a[188:191], v[52:55], v[188:191]
    v_cvt_pk_bf16_f32 v63, v126, v127
    v_mfma_f32_16x16x32_bf16 v[112:115], a[128:131], a[224:227], v[72:75]
    v_exp_f32 v96, v96
    v_mfma_f32_16x16x32_bf16 v[112:115], a[132:135], a[228:231], v[112:115]
    v_mfma_f32_16x16x32_bf16 v[112:115], a[136:139], a[232:235], v[112:115]
    v_exp_f32 v97, v97
    v_mfma_f32_16x16x32_bf16 v[112:115], a[140:143], a[236:239], v[112:115]
    v_cvt_pk_bf16_f32 v48, v96, v97
    v_mfma_f32_16x16x32_bf16 v[120:123], a[128:131], a[240:243], v[76:79]
    v_exp_f32 v98, v98
    v_mfma_f32_16x16x32_bf16 v[120:123], a[132:135], a[244:247], v[120:123]
    v_mfma_f32_16x16x32_bf16 v[120:123], a[136:139], a[248:251], v[120:123]
    v_exp_f32 v99, v99
    v_mfma_f32_16x16x32_bf16 v[120:123], a[140:143], a[252:255], v[120:123]
    v_mfma_f32_16x16x32_bf16 v[116:119], a[144:147], a[224:227], v[72:75]
    v_exp_f32 v100, v100
    v_mfma_f32_16x16x32_bf16 v[116:119], a[148:151], a[228:231], v[116:119]
    ds_read_b128 a[128:131], v18 offset:16384
    v_cvt_pk_bf16_f32 v49, v98, v99
    v_mfma_f32_16x16x32_bf16 v[116:119], a[152:155], a[232:235], v[116:119]
    s_add_u32 s19, s82, 32768
    v_exp_f32 v101, v101
    v_mfma_f32_16x16x32_bf16 v[116:119], a[156:159], a[236:239], v[116:119]
    s_sub_u32 s82, s12, s13
    ds_read_b128 a[132:135], v18 offset:17408
    v_cvt_pk_bf16_f32 v50, v100, v101
    v_mfma_f32_16x16x32_bf16 v[124:127], a[144:147], a[240:243], v[76:79]
    s_sub_u32 s82, s82, 1
    v_exp_f32 v102, v102
    v_mfma_f32_16x16x32_bf16 v[124:127], a[148:151], a[244:247], v[124:127]
    s_cmp_gt_u32 s12, s13
    s_cselect_b32 s82, s82, s12
    s_mul_i32 s82, s82, 65536
    ds_read_b128 a[136:139], v18 offset:18432
    v_mfma_f32_16x16x32_bf16 v[124:127], a[152:155], a[248:251], v[124:127]
    s_add_u32 s82, s82, s81
    v_exp_f32 v103, v103
    v_mfma_f32_16x16x32_bf16 v[124:127], a[156:159], a[252:255], v[124:127]
    s_cmp_ge_u32 s12, 17
    s_cselect_b32 s82, 2147471360, s82
    ds_read_b128 a[140:143], v18 offset:19456
    v_cvt_pk_bf16_f32 v51, v102, v103
    v_mfma_f32_16x16x32_bf16 v[40:43], v[28:31], v[56:59], v[40:43]
    s_add_u32 s12, s12, 1
    v_exp_f32 v104, v104
    v_mfma_f32_16x16x32_bf16 v[44:47], v[28:31], v[60:63], v[44:47]
    ds_read_b128 a[144:147], v18 offset:20480
    v_mfma_f32_16x16x32_bf16 v[192:195], a[160:163], v[56:59], v[192:195]
    v_exp_f32 v105, v105
    v_mfma_f32_16x16x32_bf16 v[224:227], a[160:163], v[60:63], v[224:227]
    ds_read_b128 a[148:151], v18 offset:21504
    v_cvt_pk_bf16_f32 v52, v104, v105
    v_mfma_f32_16x16x32_bf16 v[196:199], a[164:167], v[56:59], v[196:199]
    v_exp_f32 v106, v106
    v_mfma_f32_16x16x32_bf16 v[228:231], a[164:167], v[60:63], v[228:231]
    ds_read_b128 a[152:155], v18 offset:22528
    v_mfma_f32_16x16x32_bf16 v[200:203], a[168:171], v[56:59], v[200:203]
    v_exp_f32 v107, v107
    v_mfma_f32_16x16x32_bf16 v[232:235], a[168:171], v[60:63], v[232:235]
    ds_read_b128 a[156:159], v18 offset:23552
    v_cvt_pk_bf16_f32 v53, v106, v107
    v_mfma_f32_16x16x32_bf16 v[204:207], a[172:175], v[56:59], v[204:207]
    v_exp_f32 v108, v108
    v_mfma_f32_16x16x32_bf16 v[236:239], a[172:175], v[60:63], v[236:239]
    v_mfma_f32_16x16x32_bf16 v[208:211], a[176:179], v[56:59], v[208:211]
    v_exp_f32 v109, v109
    v_mfma_f32_16x16x32_bf16 v[240:243], a[176:179], v[60:63], v[240:243]
    v_cvt_pk_bf16_f32 v54, v108, v109
    v_xor_b32 v18, 196608, v18
    v_mfma_f32_16x16x32_bf16 v[212:215], a[180:183], v[56:59], v[212:215]
    v_exp_f32 v110, v110
    v_mfma_f32_16x16x32_bf16 v[244:247], a[180:183], v[60:63], v[244:247]
    v_mfma_f32_16x16x32_bf16 v[216:219], a[184:187], v[56:59], v[216:219]
    v_exp_f32 v111, v111
    v_mfma_f32_16x16x32_bf16 v[248:251], a[184:187], v[60:63], v[248:251]
    v_cvt_pk_bf16_f32 v55, v110, v111
    v_mfma_f32_16x16x32_bf16 v[220:223], a[188:191], v[56:59], v[220:223]
    v_mfma_f32_16x16x32_bf16 v[252:255], a[188:191], v[60:63], v[252:255]
    s_waitcnt vmcnt(0) lgkmcnt(0)
    s_barrier
    v_mfma_f32_16x16x32_bf16 v[96:99], a[128:131], a[192:195], v[64:67]
    s_add_u32 m0, s15, 0
    ds_read_b128 a[160:163], v19 offset:0
    v_mfma_f32_16x16x32_bf16 v[96:99], a[132:135], a[196:199], v[96:99]
    ds_read_b128 a[164:167], v19 offset:1024
    v_mfma_f32_16x16x32_bf16 v[96:99], a[136:139], a[200:203], v[96:99]
    v_exp_f32 v112, v112
    v_mfma_f32_16x16x32_bf16 v[96:99], a[140:143], a[204:207], v[96:99]
    buffer_load_dwordx4 v1, s[8:11], s82 offen offset:0  lds
    v_mfma_f32_16x16x32_bf16 v[104:107], a[128:131], a[208:211], v[68:71]
    v_exp_f32 v113, v113
    v_mfma_f32_16x16x32_bf16 v[104:107], a[132:135], a[212:215], v[104:107]
    ds_read_b128 a[168:171], v19 offset:2048
    v_cvt_pk_bf16_f32 v56, v112, v113
    v_mfma_f32_16x16x32_bf16 v[104:107], a[136:139], a[216:219], v[104:107]
    v_exp_f32 v114, v114
    v_mfma_f32_16x16x32_bf16 v[104:107], a[140:143], a[220:223], v[104:107]
    buffer_load_dwordx4 v1, s[8:11], s82 offen offset:1024  lds
    v_mfma_f32_16x16x32_bf16 v[100:103], a[144:147], a[192:195], v[64:67]
    v_exp_f32 v115, v115
    v_mfma_f32_16x16x32_bf16 v[100:103], a[148:151], a[196:199], v[100:103]
    ds_read_b128 a[172:175], v19 offset:3072
    v_cvt_pk_bf16_f32 v57, v114, v115
    v_mfma_f32_16x16x32_bf16 v[100:103], a[152:155], a[200:203], v[100:103]
    v_exp_f32 v116, v116
    v_mfma_f32_16x16x32_bf16 v[100:103], a[156:159], a[204:207], v[100:103]
    buffer_load_dwordx4 v1, s[8:11], s82 offen offset:2048  lds
    v_mfma_f32_16x16x32_bf16 v[108:111], a[144:147], a[208:211], v[68:71]
    v_exp_f32 v117, v117
    v_mfma_f32_16x16x32_bf16 v[108:111], a[148:151], a[212:215], v[108:111]
    ds_read_b128 a[176:179], v20 offset:4096
    v_cvt_pk_bf16_f32 v58, v116, v117
    v_mfma_f32_16x16x32_bf16 v[108:111], a[152:155], a[216:219], v[108:111]
    v_exp_f32 v118, v118
    v_mfma_f32_16x16x32_bf16 v[108:111], a[156:159], a[220:223], v[108:111]
    buffer_load_dwordx4 v1, s[8:11], s82 offen offset:3072  lds
    v_mfma_f32_16x16x32_bf16 v[32:35], v[28:31], v[48:51], v[32:35]
    s_add_u32 m0, s15, 4096
    v_exp_f32 v119, v119
    v_mfma_f32_16x16x32_bf16 v[36:39], v[28:31], v[52:55], v[36:39]
    s_waitcnt lgkmcnt(4)
    ds_read_b128 a[180:183], v20 offset:5120
    v_cvt_pk_bf16_f32 v59, v118, v119
    v_mfma_f32_16x16x32_bf16 v[128:131], a[160:163], v[48:51], v[128:131]
    s_waitcnt lgkmcnt(4)
    v_exp_f32 v120, v120
    v_mfma_f32_16x16x32_bf16 v[160:163], a[160:163], v[52:55], v[160:163]
    buffer_load_dwordx4 v15, s[8:11], s82 offen offset:0  lds
    v_mfma_f32_16x16x32_bf16 v[132:135], a[164:167], v[48:51], v[132:135]
    v_exp_f32 v121, v121
    v_mfma_f32_16x16x32_bf16 v[164:167], a[164:167], v[52:55], v[164:167]
    s_waitcnt lgkmcnt(3)
    ds_read_b128 a[184:187], v20 offset:6144
    v_cvt_pk_bf16_f32 v60, v120, v121
    v_mfma_f32_16x16x32_bf16 v[136:139], a[168:171], v[48:51], v[136:139]
    s_waitcnt lgkmcnt(3)
    v_exp_f32 v122, v122
    v_mfma_f32_16x16x32_bf16 v[168:171], a[168:171], v[52:55], v[168:171]
    buffer_load_dwordx4 v15, s[8:11], s82 offen offset:1024  lds
    v_mfma_f32_16x16x32_bf16 v[140:143], a[172:175], v[48:51], v[140:143]
    v_exp_f32 v123, v123
    v_mfma_f32_16x16x32_bf16 v[172:175], a[172:175], v[52:55], v[172:175]
    s_waitcnt lgkmcnt(2)
    ds_read_b128 a[188:191], v20 offset:7168
    v_cvt_pk_bf16_f32 v61, v122, v123
    v_mfma_f32_16x16x32_bf16 v[144:147], a[176:179], v[48:51], v[144:147]
    s_waitcnt lgkmcnt(2)
    v_exp_f32 v124, v124
    v_mfma_f32_16x16x32_bf16 v[176:179], a[176:179], v[52:55], v[176:179]
    buffer_load_dwordx4 v15, s[8:11], s82 offen offset:2048  lds
    v_mfma_f32_16x16x32_bf16 v[148:151], a[180:183], v[48:51], v[148:151]
    v_exp_f32 v125, v125
    v_mfma_f32_16x16x32_bf16 v[180:183], a[180:183], v[52:55], v[180:183]
    s_waitcnt lgkmcnt(1)
    v_cvt_pk_bf16_f32 v62, v124, v125
    v_mfma_f32_16x16x32_bf16 v[152:155], a[184:187], v[48:51], v[152:155]
    s_waitcnt lgkmcnt(0)
    v_exp_f32 v126, v126
    v_mfma_f32_16x16x32_bf16 v[184:187], a[184:187], v[52:55], v[184:187]
    buffer_load_dwordx4 v15, s[8:11], s82 offen offset:3072  lds
    v_mfma_f32_16x16x32_bf16 v[156:159], a[188:191], v[48:51], v[156:159]
    s_xor_b32 s15, s15, 196608
    v_exp_f32 v127, v127
    v_mfma_f32_16x16x32_bf16 v[188:191], a[188:191], v[52:55], v[188:191]
    s_add_u32 m0, s16, 0
    v_cvt_pk_bf16_f32 v63, v126, v127
    v_mfma_f32_16x16x32_bf16 v[112:115], a[128:131], a[224:227], v[72:75]
    v_mfma_f32_16x16x32_bf16 v[112:115], a[132:135], a[228:231], v[112:115]
    v_mfma_f32_16x16x32_bf16 v[112:115], a[136:139], a[232:235], v[112:115]
    v_exp_f32 v96, v96
    v_mfma_f32_16x16x32_bf16 v[112:115], a[140:143], a[236:239], v[112:115]
    buffer_load_dwordx4 v1, s[8:11], s19 offen offset:0  lds
    v_mfma_f32_16x16x32_bf16 v[120:123], a[128:131], a[240:243], v[76:79]
    v_exp_f32 v97, v97
    v_mfma_f32_16x16x32_bf16 v[120:123], a[132:135], a[244:247], v[120:123]
    ds_read_b128 a[128:131], v18 offset:0
    v_cvt_pk_bf16_f32 v48, v96, v97
    v_mfma_f32_16x16x32_bf16 v[120:123], a[136:139], a[248:251], v[120:123]
    v_exp_f32 v98, v98
    v_mfma_f32_16x16x32_bf16 v[120:123], a[140:143], a[252:255], v[120:123]
    buffer_load_dwordx4 v1, s[8:11], s19 offen offset:1024  lds
    v_mfma_f32_16x16x32_bf16 v[116:119], a[144:147], a[224:227], v[72:75]
    v_exp_f32 v99, v99
    v_mfma_f32_16x16x32_bf16 v[116:119], a[148:151], a[228:231], v[116:119]
    ds_read_b128 a[132:135], v18 offset:1024
    v_cvt_pk_bf16_f32 v49, v98, v99
    v_mfma_f32_16x16x32_bf16 v[116:119], a[152:155], a[232:235], v[116:119]
    v_exp_f32 v100, v100
    v_mfma_f32_16x16x32_bf16 v[116:119], a[156:159], a[236:239], v[116:119]
    buffer_load_dwordx4 v1, s[8:11], s19 offen offset:2048  lds
    v_mfma_f32_16x16x32_bf16 v[124:127], a[144:147], a[240:243], v[76:79]
    v_exp_f32 v101, v101
    v_mfma_f32_16x16x32_bf16 v[124:127], a[148:151], a[244:247], v[124:127]
    ds_read_b128 a[136:139], v18 offset:2048
    v_cvt_pk_bf16_f32 v50, v100, v101
    v_mfma_f32_16x16x32_bf16 v[124:127], a[152:155], a[248:251], v[124:127]
    v_exp_f32 v102, v102
    v_mfma_f32_16x16x32_bf16 v[124:127], a[156:159], a[252:255], v[124:127]
    buffer_load_dwordx4 v1, s[8:11], s19 offen offset:3072  lds
    v_mfma_f32_16x16x32_bf16 v[40:43], v[28:31], v[56:59], v[40:43]
    s_add_u32 m0, s16, 4096
    v_exp_f32 v103, v103
    v_mfma_f32_16x16x32_bf16 v[44:47], v[28:31], v[60:63], v[44:47]
    ds_read_b128 a[140:143], v18 offset:3072
    v_cvt_pk_bf16_f32 v51, v102, v103
    v_mfma_f32_16x16x32_bf16 v[192:195], a[160:163], v[56:59], v[192:195]
    v_exp_f32 v104, v104
    v_mfma_f32_16x16x32_bf16 v[224:227], a[160:163], v[60:63], v[224:227]
    buffer_load_dwordx4 v15, s[8:11], s19 offen offset:0  lds
    v_mfma_f32_16x16x32_bf16 v[196:199], a[164:167], v[56:59], v[196:199]
    v_exp_f32 v105, v105
    v_mfma_f32_16x16x32_bf16 v[228:231], a[164:167], v[60:63], v[228:231]
    ds_read_b128 a[144:147], v18 offset:4096
    v_cvt_pk_bf16_f32 v52, v104, v105
    v_mfma_f32_16x16x32_bf16 v[200:203], a[168:171], v[56:59], v[200:203]
    v_exp_f32 v106, v106
    v_mfma_f32_16x16x32_bf16 v[232:235], a[168:171], v[60:63], v[232:235]
    buffer_load_dwordx4 v15, s[8:11], s19 offen offset:1024  lds
    v_mfma_f32_16x16x32_bf16 v[204:207], a[172:175], v[56:59], v[204:207]
    v_exp_f32 v107, v107
    v_mfma_f32_16x16x32_bf16 v[236:239], a[172:175], v[60:63], v[236:239]
    ds_read_b128 a[148:151], v18 offset:5120
    v_cvt_pk_bf16_f32 v53, v106, v107
    v_mfma_f32_16x16x32_bf16 v[208:211], a[176:179], v[56:59], v[208:211]
    s_sub_u32 s14, s14, 1
    v_exp_f32 v108, v108
    v_mfma_f32_16x16x32_bf16 v[240:243], a[176:179], v[60:63], v[240:243]
    buffer_load_dwordx4 v15, s[8:11], s19 offen offset:2048  lds
    v_mfma_f32_16x16x32_bf16 v[212:215], a[180:183], v[56:59], v[212:215]
    v_exp_f32 v109, v109
    v_mfma_f32_16x16x32_bf16 v[244:247], a[180:183], v[60:63], v[244:247]
    ds_read_b128 a[152:155], v18 offset:6144
    v_cvt_pk_bf16_f32 v54, v108, v109
    v_mfma_f32_16x16x32_bf16 v[216:219], a[184:187], v[56:59], v[216:219]
    v_exp_f32 v110, v110
    v_mfma_f32_16x16x32_bf16 v[248:251], a[184:187], v[60:63], v[248:251]
    buffer_load_dwordx4 v15, s[8:11], s19 offen offset:3072  lds
    v_mfma_f32_16x16x32_bf16 v[220:223], a[188:191], v[56:59], v[220:223]
    s_xor_b32 s16, s16, 98304
    v_exp_f32 v111, v111
    v_mfma_f32_16x16x32_bf16 v[252:255], a[188:191], v[60:63], v[252:255]
    ds_read_b128 a[156:159], v18 offset:7168
    v_cvt_pk_bf16_f32 v55, v110, v111
    s_cmp_lg_u32 s14, 0
    s_cbranch_scc1 L_t2_loop
L_t2_diag:
    s_waitcnt lgkmcnt(7)
    v_mfma_f32_16x16x32_bf16 v[96:99], a[128:131], a[192:195], v[80:83]
    s_waitcnt lgkmcnt(6)
    ds_read_b128 a[160:163], v19 offset:16384
    v_mov_b32 v24, v8
    v_mov_b32 v25, v9
    v_mfma_f32_16x16x32_bf16 v[96:99], a[132:135], a[196:199], v[96:99]
    s_waitcnt lgkmcnt(6)
    ds_read_b128 a[164:167], v19 offset:17408
    v_mov_b32 v26, v10
    v_mov_b32 v27, v11
    v_mfma_f32_16x16x32_bf16 v[96:99], a[136:139], a[200:203], v[96:99]
    s_waitcnt lgkmcnt(6)
    v_exp_f32 v112, v112
    v_add_u32 v11, 131072, v16
    v_mfma_f32_16x16x32_bf16 v[96:99], a[140:143], a[204:207], v[96:99]
    v_lshlrev_b32 v12, 6, v0
    v_mfma_f32_16x16x32_bf16 v[104:107], a[128:131], a[208:211], v[88:91]
    s_mov_b32 s71, 1327104
    v_exp_f32 v113, v113
    v_mfma_f32_16x16x32_bf16 v[104:107], a[132:135], a[212:215], v[104:107]
    ds_read_b128 a[168:171], v19 offset:18432
    v_cvt_pk_bf16_f32 v56, v112, v113
    v_mfma_f32_16x16x32_bf16 v[104:107], a[136:139], a[216:219], v[104:107]
    s_waitcnt lgkmcnt(6)
    v_exp_f32 v114, v114
    v_mfma_f32_16x16x32_bf16 v[104:107], a[140:143], a[220:223], v[104:107]
    buffer_load_dword v3, v12, s[8:11], s71 offen sc0 sc1
    v_bfe_u32 v13, v2, 1, 4
    v_mfma_f32_16x16x32_bf16 v[100:103], a[144:147], a[192:195], v[84:87]
    s_waitcnt lgkmcnt(5)
    v_exp_f32 v115, v115
    v_lshlrev_b32 v13, 10, v13
    v_mfma_f32_16x16x32_bf16 v[100:103], a[148:151], a[196:199], v[100:103]
    s_waitcnt lgkmcnt(4)
    ds_read_b128 a[172:175], v19 offset:19456
    v_cvt_pk_bf16_f32 v57, v114, v115
    v_and_b32 v14, 1, v2
    v_mfma_f32_16x16x32_bf16 v[100:103], a[152:155], a[200:203], v[100:103]
    s_waitcnt lgkmcnt(4)
    v_exp_f32 v116, v116
    v_lshl_add_u32 v13, v14, 7, v13
    v_mfma_f32_16x16x32_bf16 v[100:103], a[156:159], a[204:207], v[100:103]
    s_lshl_b32 s74, s6, 2
    s_add_u32 s74, s74, s3
    v_mov_b32 v10, 1
    v_mfma_f32_16x16x32_bf16 v[108:111], a[144:147], a[208:211], v[92:95]
    s_lshl_b32 s73, s6, 2
    v_exp_f32 v117, v117
    v_mfma_f32_16x16x32_bf16 v[108:111], a[148:151], a[212:215], v[108:111]
    s_add_u32 s73, s73, s3
    ds_read_b128 a[176:179], v20 offset:20480
    v_cvt_pk_bf16_f32 v58, v116, v117
    v_mfma_f32_16x16x32_bf16 v[108:111], a[152:155], a[216:219], v[108:111]
    s_lshl_b32 s73, s73, 6
    v_exp_f32 v118, v118
    v_mfma_f32_16x16x32_bf16 v[108:111], a[156:159], a[220:223], v[108:111]
    s_lshl_b32 s74, s74, 14
    v_mfma_f32_16x16x32_bf16 v[32:35], v[28:31], v[48:51], v[32:35]
    s_add_u32 s73, s73, 1310752
    v_exp_f32 v119, v119
    v_mfma_f32_16x16x32_bf16 v[36:39], v[28:31], v[52:55], v[36:39]
    s_waitcnt lgkmcnt(4)
    ds_read_b128 a[180:183], v20 offset:21504
    v_cvt_pk_bf16_f32 v59, v118, v119
    v_mfma_f32_16x16x32_bf16 v[128:131], a[160:163], v[48:51], v[128:131]
    s_waitcnt lgkmcnt(4)
    v_exp_f32 v120, v120
    v_mfma_f32_16x16x32_bf16 v[160:163], a[160:163], v[52:55], v[160:163]
    buffer_load_dword v14, v13, s[28:31], s74 offen
    v_mfma_f32_16x16x32_bf16 v[132:135], a[164:167], v[48:51], v[132:135]
    v_exp_f32 v121, v121
    v_mfma_f32_16x16x32_bf16 v[164:167], a[164:167], v[52:55], v[164:167]
    s_waitcnt lgkmcnt(3)
    ds_read_b128 a[184:187], v20 offset:22528
    v_cvt_pk_bf16_f32 v60, v120, v121
    v_mfma_f32_16x16x32_bf16 v[136:139], a[168:171], v[48:51], v[136:139]
    v_exp_f32 v122, v122
    v_mfma_f32_16x16x32_bf16 v[168:171], a[168:171], v[52:55], v[168:171]
    s_waitcnt lgkmcnt(3)
    v_add_f32 v80, 0, v22
    v_min_f32 v80, v80, v72
    v_mfma_f32_16x16x32_bf16 v[140:143], a[172:175], v[48:51], v[140:143]
    v_exp_f32 v123, v123
    v_mfma_f32_16x16x32_bf16 v[172:175], a[172:175], v[52:55], v[172:175]
    s_waitcnt lgkmcnt(2)
    ds_read_b128 a[188:191], v20 offset:23552
    v_cvt_pk_bf16_f32 v61, v122, v123
    v_mfma_f32_16x16x32_bf16 v[144:147], a[176:179], v[48:51], v[144:147]
    v_exp_f32 v124, v124
    v_mfma_f32_16x16x32_bf16 v[176:179], a[176:179], v[52:55], v[176:179]
    s_waitcnt lgkmcnt(2)
    v_add_f32 v81, 0xf1800000, v22
    v_min_f32 v81, v81, v73
    v_mfma_f32_16x16x32_bf16 v[148:151], a[180:183], v[48:51], v[148:151]
    v_exp_f32 v125, v125
    v_mfma_f32_16x16x32_bf16 v[180:183], a[180:183], v[52:55], v[180:183]
    s_waitcnt lgkmcnt(1)
    v_cvt_pk_bf16_f32 v62, v124, v125
    v_xor_b32 v19, 98304, v19
    v_mfma_f32_16x16x32_bf16 v[152:155], a[184:187], v[48:51], v[152:155]
    v_exp_f32 v126, v126
    v_mfma_f32_16x16x32_bf16 v[184:187], a[184:187], v[52:55], v[184:187]
    s_waitcnt lgkmcnt(0)
    v_xor_b32 v20, 98304, v20
    v_add_f32 v82, 0xf2000000, v22
    v_mfma_f32_16x16x32_bf16 v[156:159], a[188:191], v[48:51], v[156:159]
    v_exp_f32 v127, v127
    v_mfma_f32_16x16x32_bf16 v[188:191], a[188:191], v[52:55], v[188:191]
    v_cvt_pk_bf16_f32 v63, v126, v127
    v_min_f32 v82, v82, v74
    v_add_f32 v83, 0xf2400000, v22
    v_min_f32 v83, v83, v75
    v_add_f32 v84, 0xf3800000, v22
    v_min_f32 v84, v84, v72
    v_mfma_f32_16x16x32_bf16 v[112:115], a[128:131], a[224:227], v[72:75]
    v_exp_f32 v96, v96
    v_mfma_f32_16x16x32_bf16 v[112:115], a[132:135], a[228:231], v[112:115]
    v_add_f32 v85, 0xf3880000, v22
    v_min_f32 v85, v85, v73
    s_getpc_b64 s[100:101]
L_ct3:
    s_lshr_b32 s99, s2, 3
    s_lshl_b32 s99, s99, 2
    s_add_u32 s99, s99, s3
    s_mul_i32 s99, s99, 4
    v_min_u32 v13, 3, v2
    v_add_u32 v13, s99, v13
    v_lshlrev_b32 v13, 7, v13
    v_add_u32 v13, L_ct3-L_ct3, v13
    v_min_u32 v13, L_end-L_ct3, v13
    global_load_dword v13, v13, s[100:101]
    v_mfma_f32_16x16x32_bf16 v[112:115], a[136:139], a[232:235], v[112:115]
    s_and_b32 s68, s2, 31
    v_exp_f32 v97, v97
    v_mfma_f32_16x16x32_bf16 v[112:115], a[140:143], a[236:239], v[112:115]
    s_lshl_b32 s68, s68, 2
    s_add_u32 s68, s68, s3
    v_cvt_pk_bf16_f32 v48, v96, v97
    buffer_atomic_add v10, v5, s[8:11], s73 offen sc0 sc1
    v_mfma_f32_16x16x32_bf16 v[120:123], a[128:131], a[240:243], v[76:79]
    s_lshl_b32 s69, s60, 7
    v_exp_f32 v98, v98
    v_mfma_f32_16x16x32_bf16 v[120:123], a[132:135], a[244:247], v[120:123]
    v_add_f32 v86, 0xf3900000, v22
    v_min_f32 v86, v86, v74
    v_mfma_f32_16x16x32_bf16 v[120:123], a[136:139], a[248:251], v[120:123]
    s_add_u32 s68, s68, s69
    v_exp_f32 v99, v99
    v_mfma_f32_16x16x32_bf16 v[120:123], a[140:143], a[252:255], v[120:123]
    v_add_f32 v87, 0xf3980000, v22
    v_min_f32 v87, v87, v75
    v_mfma_f32_16x16x32_bf16 v[116:119], a[144:147], a[224:227], v[72:75]
    s_lshl_b32 s68, s68, 10
    v_exp_f32 v100, v100
    v_mfma_f32_16x16x32_bf16 v[116:119], a[148:151], a[228:231], v[116:119]
    s_sub_u32 s69, s61, s60
    ds_read_b128 a[128:131], v18 offset:16384
    v_cvt_pk_bf16_f32 v49, v98, v99
    v_mfma_f32_16x16x32_bf16 v[116:119], a[152:155], a[232:235], v[116:119]
    s_lshl_b32 s69, s69, 17
    v_exp_f32 v101, v101
    v_mfma_f32_16x16x32_bf16 v[116:119], a[156:159], a[236:239], v[116:119]
    ds_read_b128 a[132:135], v18 offset:17408
    v_cvt_pk_bf16_f32 v50, v100, v101
    v_mfma_f32_16x16x32_bf16 v[124:127], a[144:147], a[240:243], v[76:79]
    v_exp_f32 v102, v102
    v_mfma_f32_16x16x32_bf16 v[124:127], a[148:151], a[244:247], v[124:127]
    ds_read_b128 a[136:139], v18 offset:18432
    v_bfe_u32 v9, v2, 3, 1
    v_mfma_f32_16x16x32_bf16 v[124:127], a[152:155], a[248:251], v[124:127]
    v_exp_f32 v103, v103
    v_mfma_f32_16x16x32_bf16 v[124:127], a[156:159], a[252:255], v[124:127]
    ds_read_b128 a[140:143], v18 offset:19456
    v_cvt_pk_bf16_f32 v51, v102, v103
    v_mfma_f32_16x16x32_bf16 v[40:43], v[28:31], v[56:59], v[40:43]
    v_exp_f32 v104, v104
    v_mfma_f32_16x16x32_bf16 v[44:47], v[28:31], v[60:63], v[44:47]
    ds_read_b128 a[144:147], v18 offset:20480
    v_mul_lo_u32 v9, v9, s69
    v_mfma_f32_16x16x32_bf16 v[192:195], a[160:163], v[56:59], v[192:195]
    v_exp_f32 v105, v105
    v_mfma_f32_16x16x32_bf16 v[224:227], a[160:163], v[60:63], v[224:227]
    ds_read_b128 a[148:151], v18 offset:21504
    v_cvt_pk_bf16_f32 v52, v104, v105
    v_mfma_f32_16x16x32_bf16 v[196:199], a[164:167], v[56:59], v[196:199]
    v_exp_f32 v106, v106
    v_mfma_f32_16x16x32_bf16 v[228:231], a[164:167], v[60:63], v[228:231]
    ds_read_b128 a[152:155], v18 offset:22528
    v_and_b32 v8, 7, v2
    v_mfma_f32_16x16x32_bf16 v[200:203], a[168:171], v[56:59], v[200:203]
    v_exp_f32 v107, v107
    v_mfma_f32_16x16x32_bf16 v[232:235], a[168:171], v[60:63], v[232:235]
    ds_read_b128 a[156:159], v18 offset:23552
    v_cvt_pk_bf16_f32 v53, v106, v107
    v_mfma_f32_16x16x32_bf16 v[204:207], a[172:175], v[56:59], v[204:207]
    v_exp_f32 v108, v108
    v_mfma_f32_16x16x32_bf16 v[236:239], a[172:175], v[60:63], v[236:239]
    v_lshl_add_u32 v9, v8, 7, v9
    v_add_f32 v88, 0x73800000, v22
    v_mfma_f32_16x16x32_bf16 v[208:211], a[176:179], v[56:59], v[208:211]
    v_exp_f32 v109, v109
    v_mfma_f32_16x16x32_bf16 v[240:243], a[176:179], v[60:63], v[240:243]
    v_cvt_pk_bf16_f32 v54, v108, v109
    v_xor_b32 v18, 196608, v18
    v_mfma_f32_16x16x32_bf16 v[212:215], a[180:183], v[56:59], v[212:215]
    v_exp_f32 v110, v110
    v_mfma_f32_16x16x32_bf16 v[244:247], a[180:183], v[60:63], v[244:247]
    buffer_load_dword v8, v9, s[32:35], s68 offen
    v_mfma_f32_16x16x32_bf16 v[216:219], a[184:187], v[56:59], v[216:219]
    v_exp_f32 v111, v111
    v_mfma_f32_16x16x32_bf16 v[248:251], a[184:187], v[60:63], v[248:251]
    v_cvt_pk_bf16_f32 v55, v110, v111
    v_min_f32 v88, v88, v76
    s_waitcnt vmcnt(4)
    v_cmp_ne_u32 vcc, 0, v3
    s_cmp_eq_u64 vcc, -1
    s_cbranch_scc0 L_F_slow_11
L_F_ok_12:
    v_mfma_f32_16x16x32_bf16 v[220:223], a[188:191], v[56:59], v[220:223]
    v_add_f32 v89, 0x73700000, v22
    v_min_f32 v89, v89, v77
    v_mfma_f32_16x16x32_bf16 v[252:255], a[188:191], v[60:63], v[252:255]
    v_add_f32 v90, 0x73600000, v22
    v_min_f32 v90, v90, v78
    v_add_f32 v91, 0x73500000, v22
    v_min_f32 v91, v91, v79
    v_add_f32 v92, 0, v22
    v_min_f32 v92, v92, v76
    v_add_f32 v93, 0xf1800000, v22
    v_min_f32 v93, v93, v77
    v_add_f32 v94, 0xf2000000, v22
    v_min_f32 v94, v94, v78
    v_add_f32 v95, 0xf2400000, v22
    v_min_f32 v95, v95, v79
    s_waitcnt lgkmcnt(0)
    s_barrier
    v_mfma_f32_16x16x32_bf16 v[96:99], a[128:131], a[224:227], v[80:83]
    s_xor_b32 s100, s62, 8192
    s_xor_b32 s98, s65, 262144
    ds_read_b128 a[176:179], v20 offset:4096
    s_waitcnt vmcnt(2)
    v_lshrrev_b32 v13, 1, v1
    v_mfma_f32_16x16x32_bf16 v[96:99], a[132:135], a[228:231], v[96:99]
    s_add_u32 m0, s62, 65536
    ds_read_b128 a[180:183], v20 offset:5120
    v_add_u32 v12, s100, v13
    v_mfma_f32_16x16x32_bf16 v[96:99], a[136:139], a[232:235], v[96:99]
    buffer_load_dwordx4 v24, s[28:31], s98 offen offset:0   lds
    v_exp_f32 v112, v112
    v_mfma_f32_16x16x32_bf16 v[96:99], a[140:143], a[236:239], v[96:99]
    v_exp_f32 v113, v113
    v_mfma_f32_16x16x32_bf16 v[100:103], a[144:147], a[224:227], v[84:87]
    ds_read_b128 a[184:187], v20 offset:6144
    v_cvt_pk_bf16_f32 v56, v112, v113
    v_mfma_f32_16x16x32_bf16 v[100:103], a[148:151], a[228:231], v[100:103]
    v_exp_f32 v114, v114
    v_mfma_f32_16x16x32_bf16 v[100:103], a[152:155], a[232:235], v[100:103]
    buffer_load_dwordx4 v25, s[28:31], s98 offen offset:1024   lds
    v_exp_f32 v115, v115
    v_mfma_f32_16x16x32_bf16 v[100:103], a[156:159], a[236:239], v[100:103]
    ds_read_b128 a[188:191], v20 offset:7168
    v_cvt_pk_bf16_f32 v57, v114, v115
    v_mfma_f32_16x16x32_bf16 v[104:107], a[128:131], a[240:243], v[88:91]
    v_exp_f32 v116, v116
    v_mfma_f32_16x16x32_bf16 v[104:107], a[132:135], a[244:247], v[104:107]
    v_exp_f32 v117, v117
    v_mfma_f32_16x16x32_bf16 v[104:107], a[136:139], a[248:251], v[104:107]
    ds_read_b128 a[160:163], v19 offset:0
    v_cvt_pk_bf16_f32 v58, v116, v117
    v_mfma_f32_16x16x32_bf16 v[104:107], a[140:143], a[252:255], v[104:107]
    buffer_load_dwordx4 v26, s[28:31], s98 offen offset:2048   lds
    v_exp_f32 v118, v118
    v_mfma_f32_16x16x32_bf16 v[108:111], a[144:147], a[240:243], v[92:95]
    v_exp_f32 v119, v119
    v_mfma_f32_16x16x32_bf16 v[108:111], a[148:151], a[244:247], v[108:111]
    ds_read_b128 a[164:167], v19 offset:1024
    v_cvt_pk_bf16_f32 v59, v118, v119
    v_mfma_f32_16x16x32_bf16 v[108:111], a[152:155], a[248:251], v[108:111]
    v_exp_f32 v120, v120
    v_mfma_f32_16x16x32_bf16 v[108:111], a[156:159], a[252:255], v[108:111]
    buffer_load_dwordx4 v27, s[28:31], s98 offen offset:3072   lds
    v_exp_f32 v121, v121
    v_mfma_f32_16x16x32_bf16 v[32:35], v[28:31], v[48:51], v[32:35]
    s_add_u32 m0, s62, 69632
    ds_read_b128 a[168:171], v19 offset:2048
    v_cvt_pk_bf16_f32 v60, v120, v121
    v_mfma_f32_16x16x32_bf16 v[36:39], v[28:31], v[52:55], v[36:39]
    s_waitcnt lgkmcnt(6)
    s_xor_b32 s98, s65, 294912
    v_exp_f32 v122, v122
    v_mfma_f32_16x16x32_bf16 v[144:147], a[176:179], v[48:51], v[144:147]
    v_exp_f32 v123, v123
    v_mfma_f32_16x16x32_bf16 v[176:179], a[176:179], v[52:55], v[176:179]
    s_waitcnt lgkmcnt(5)
    ds_read_b128 a[172:175], v19 offset:3072
    v_cvt_pk_bf16_f32 v61, v122, v123
    v_mfma_f32_16x16x32_bf16 v[148:151], a[180:183], v[48:51], v[148:151]
    buffer_load_dwordx4 v24, s[28:31], s98 offen offset:0   lds
    v_exp_f32 v124, v124
    v_mfma_f32_16x16x32_bf16 v[180:183], a[180:183], v[52:55], v[180:183]
    s_waitcnt lgkmcnt(5)
    v_exp_f32 v125, v125
    v_mfma_f32_16x16x32_bf16 v[152:155], a[184:187], v[48:51], v[152:155]
    s_waitcnt lgkmcnt(4)
    v_exp_f32 v126, v126
    v_mfma_f32_16x16x32_bf16 v[184:187], a[184:187], v[52:55], v[184:187]
    buffer_load_dwordx4 v25, s[28:31], s98 offen offset:1024   lds
    v_exp_f32 v127, v127
    v_mfma_f32_16x16x32_bf16 v[156:159], a[188:191], v[48:51], v[156:159]
    ds_write_b128 v11, v[144:147] offset:0
    v_cvt_pk_bf16_f32 v62, v124, v125
    v_mfma_f32_16x16x32_bf16 v[188:191], a[188:191], v[52:55], v[188:191]
    s_waitcnt lgkmcnt(4)
    v_exp_f32 v96, v96
    v_mfma_f32_16x16x32_bf16 v[128:131], a[160:163], v[48:51], v[128:131]
    v_exp_f32 v97, v97
    v_mfma_f32_16x16x32_bf16 v[160:163], a[160:163], v[52:55], v[160:163]
    s_waitcnt lgkmcnt(3)
    ds_write_b128 v11, v[176:179] offset:1024
    v_cvt_pk_bf16_f32 v63, v126, v127
    v_mfma_f32_16x16x32_bf16 v[132:135], a[164:167], v[48:51], v[132:135]
    s_waitcnt lgkmcnt(3)
    v_exp_f32 v98, v98
    v_mfma_f32_16x16x32_bf16 v[164:167], a[164:167], v[52:55], v[164:167]
    buffer_load_dwordx4 v26, s[28:31], s98 offen offset:2048   lds
    v_exp_f32 v99, v99
    v_mfma_f32_16x16x32_bf16 v[136:139], a[168:171], v[48:51], v[136:139]
    ds_write_b128 v11, v[148:151] offset:2048
    v_mfma_f32_16x16x32_bf16 v[168:171], a[168:171], v[52:55], v[168:171]
    s_waitcnt lgkmcnt(3)
    v_exp_f32 v100, v100
    v_mfma_f32_16x16x32_bf16 v[140:143], a[172:175], v[48:51], v[140:143]
    v_exp_f32 v101, v101
    v_mfma_f32_16x16x32_bf16 v[172:175], a[172:175], v[52:55], v[172:175]
    ds_write_b128 v11, v[180:183] offset:3072
    v_mov_b32 v33, v36
    v_mfma_f32_16x16x32_bf16 v[40:43], v[28:31], v[56:59], v[40:43]
    buffer_load_dwordx4 v27, s[28:31], s98 offen offset:3072   lds
    v_exp_f32 v102, v102
    v_mfma_f32_16x16x32_bf16 v[44:47], v[28:31], v[60:63], v[44:47]
    v_exp_f32 v103, v103
    v_mfma_f32_16x16x32_bf16 v[208:211], a[176:179], v[56:59], v[208:211]
    ds_write_b128 v11, v[152:155] offset:4096
    v_cvt_pk_bf16_f32 v48, v96, v97
    v_mfma_f32_16x16x32_bf16 v[240:243], a[176:179], v[60:63], v[240:243]
    ds_read_b128 a[176:179], v20 offset:20480
    v_exp_f32 v104, v104
    v_mfma_f32_16x16x32_bf16 v[212:215], a[180:183], v[56:59], v[212:215]
    v_exp_f32 v105, v105
    v_mfma_f32_16x16x32_bf16 v[244:247], a[180:183], v[60:63], v[244:247]
    ds_read_b128 a[180:183], v20 offset:21504
    v_exp_f32 v106, v106
    v_mfma_f32_16x16x32_bf16 v[216:219], a[184:187], v[56:59], v[216:219]
    ds_write_b128 v11, v[184:187] offset:5120
    v_cvt_pk_bf16_f32 v49, v98, v99
    v_mfma_f32_16x16x32_bf16 v[248:251], a[184:187], v[60:63], v[248:251]
    ds_read_b128 a[184:187], v20 offset:22528
    v_exp_f32 v107, v107
    v_mfma_f32_16x16x32_bf16 v[220:223], a[188:191], v[56:59], v[220:223]
    v_exp_f32 v108, v108
    v_mfma_f32_16x16x32_bf16 v[252:255], a[188:191], v[60:63], v[252:255]
    ds_read_b128 a[188:191], v20 offset:23552
    v_exp_f32 v109, v109
    v_mfma_f32_16x16x32_bf16 v[192:195], a[160:163], v[56:59], v[192:195]
    ds_write_b128 v11, v[156:159] offset:6144
    v_cvt_pk_bf16_f32 v50, v100, v101
    v_mfma_f32_16x16x32_bf16 v[224:227], a[160:163], v[60:63], v[224:227]
    ds_read_b128 a[160:163], v19 offset:16384
    v_exp_f32 v110, v110
    v_mfma_f32_16x16x32_bf16 v[196:199], a[164:167], v[56:59], v[196:199]
    v_exp_f32 v111, v111
    v_mfma_f32_16x16x32_bf16 v[228:231], a[164:167], v[60:63], v[228:231]
    ds_read_b128 a[164:167], v19 offset:17408
    v_cvt_pk_bf16_f32 v51, v102, v103
    v_mfma_f32_16x16x32_bf16 v[200:203], a[168:171], v[56:59], v[200:203]
    ds_write_b128 v11, v[188:191] offset:7168
    v_cvt_pk_bf16_f32 v52, v104, v105
    v_mfma_f32_16x16x32_bf16 v[232:235], a[168:171], v[60:63], v[232:235]
    ds_read_b128 a[168:171], v19 offset:18432
    v_cvt_pk_bf16_f32 v53, v106, v107
    v_mfma_f32_16x16x32_bf16 v[204:207], a[172:175], v[56:59], v[204:207]
    v_cvt_pk_bf16_f32 v54, v108, v109
    v_cvt_pk_bf16_f32 v55, v110, v111
    s_waitcnt vmcnt(9)
    v_readfirstlane_b32 s73, v10
    v_mfma_f32_16x16x32_bf16 v[236:239], a[172:175], v[60:63], v[236:239]
    ds_read_b128 a[172:175], v19 offset:19456
    ds_write_b64 v12, v[32:33]
    s_add_u32 s101, s62, 98304
    v_xor_b32 v12, 8192, v12
    v_add_u32 v9, s101, v1
    s_waitcnt vmcnt(8)
    v_xor_b32 v8, 8192, v11
    v_xor_b32 v10, 8192, v9
L_t2_join:
    v_xor_b32 v19, 98304, v19
    v_xor_b32 v20, 98304, v20
    s_waitcnt lgkmcnt(0)
    s_barrier
    v_mfma_f32_16x16x32_bf16 v[40:43], v[28:31], v[48:51], v[40:43]
    s_lshl_b32 s100, s61, 20
    s_add_u32 s101, s100, s21
    ds_read_b64 v[120:121], v12
    v_mfma_f32_16x16x32_bf16 v[44:47], v[28:31], v[52:55], v[44:47]
    s_add_u32 s100, s100, s20
    ds_read_b128 v[144:147], v8 offset:0
    v_lshrrev_b32 v11, 4, v2
    v_mfma_f32_16x16x32_bf16 v[208:211], a[176:179], v[48:51], v[208:211]
    ds_read_b128 v[176:179], v8 offset:1024
    v_lshrrev_b32 v13, 2, v1
    v_mfma_f32_16x16x32_bf16 v[240:243], a[176:179], v[52:55], v[240:243]
    ds_read_b128 v[148:151], v8 offset:2048
    v_add_u32 v13, 131072, v13
    v_mfma_f32_16x16x32_bf16 v[212:215], a[180:183], v[48:51], v[212:215]
    s_xor_b32 s99, s62, 8192
    ds_read_b128 v[180:183], v8 offset:3072
    v_add_u32 v14, s99, v13
    v_mfma_f32_16x16x32_bf16 v[244:247], a[180:183], v[52:55], v[244:247]
    ds_read_b128 v[152:155], v8 offset:4096
    v_cmp_eq_u32 vcc, 1, v11
    v_mfma_f32_16x16x32_bf16 v[216:219], a[184:187], v[48:51], v[216:219]
    ds_read_b128 v[184:187], v8 offset:5120
    s_waitcnt lgkmcnt(6)
    v_add_f32 v112, v120, v32
    v_mfma_f32_16x16x32_bf16 v[248:251], a[184:187], v[52:55], v[248:251]
    ds_read_b128 v[156:159], v8 offset:6144
    v_add_f32 v114, v121, v36
    v_mfma_f32_16x16x32_bf16 v[220:223], a[188:191], v[48:51], v[220:223]
    ds_read_b128 v[188:191], v8 offset:7168
    v_cndmask_b32 v12, v32, v36, vcc
    v_mfma_f32_16x16x32_bf16 v[252:255], a[188:191], v[52:55], v[252:255]
    v_rcp_f32 v112, v112
    v_mfma_f32_16x16x32_bf16 v[192:195], a[160:163], v[48:51], v[192:195]
    v_rcp_f32 v114, v114
    v_mfma_f32_16x16x32_bf16 v[224:227], a[160:163], v[52:55], v[224:227]
    v_cmp_eq_u32 vcc, 2, v11
    v_cmp_eq_u32 s[96:97], 3, v11
    v_mfma_f32_16x16x32_bf16 v[196:199], a[164:167], v[48:51], v[196:199]
    ds_write_b128 v9, v[208:211] offset:0
    v_mfma_f32_16x16x32_bf16 v[228:231], a[164:167], v[52:55], v[228:231]
    v_mfma_f32_16x16x32_bf16 v[200:203], a[168:171], v[48:51], v[200:203]
    ds_write_b128 v9, v[240:243] offset:1024
    v_mfma_f32_16x16x32_bf16 v[232:235], a[168:171], v[52:55], v[232:235]
    v_mfma_f32_16x16x32_bf16 v[204:207], a[172:175], v[48:51], v[204:207]
    ds_write_b128 v9, v[212:215] offset:2048
    v_mfma_f32_16x16x32_bf16 v[236:239], a[172:175], v[52:55], v[236:239]
    v_cndmask_b32 v12, v12, v40, vcc
    v_cndmask_b32 v12, v12, v44, s[96:97]
    ds_write_b128 v9, v[244:247] offset:3072
    s_waitcnt lgkmcnt(11)
    v_pk_add_f32 v[128:129], v[128:129], v[144:145]
    v_pk_add_f32 v[130:131], v[130:131], v[146:147]
    s_waitcnt lgkmcnt(9)
    v_pk_add_f32 v[132:133], v[132:133], v[148:149]
    v_pk_add_f32 v[134:135], v[134:135], v[150:151]
    v_pk_mul_f32 v[128:129], v[128:129], v[112:113] op_sel_hi:[1,0]
    v_pk_mul_f32 v[130:131], v[130:131], v[112:113] op_sel_hi:[1,0]
    v_pk_mul_f32 v[132:133], v[132:133], v[112:113] op_sel_hi:[1,0]
    v_pk_mul_f32 v[134:135], v[134:135], v[112:113] op_sel_hi:[1,0]
    v_cvt_pk_bf16_f32 v128, v128, v129
    v_cvt_pk_bf16_f32 v129, v130, v131
    v_cvt_pk_bf16_f32 v130, v132, v133
    v_lshrrev_b32 v58, 2, v2
    v_and_b32 v57, 3, v2
    ds_write_b128 v9, v[216:219] offset:4096
    v_cvt_pk_bf16_f32 v131, v134, v135
    buffer_store_dwordx4 v[128:131], v1, s[8:11], s100 offen offset:0 sc0 sc1
    s_waitcnt lgkmcnt(8)
    v_pk_add_f32 v[136:137], v[136:137], v[152:153]
    v_pk_add_f32 v[138:139], v[138:139], v[154:155]
    s_waitcnt lgkmcnt(6)
    v_pk_add_f32 v[140:141], v[140:141], v[156:157]
    v_pk_add_f32 v[142:143], v[142:143], v[158:159]
    v_pk_mul_f32 v[136:137], v[136:137], v[112:113] op_sel_hi:[1,0]
    v_pk_mul_f32 v[138:139], v[138:139], v[112:113] op_sel_hi:[1,0]
    v_pk_mul_f32 v[140:141], v[140:141], v[112:113] op_sel_hi:[1,0]
    v_pk_mul_f32 v[142:143], v[142:143], v[112:113] op_sel_hi:[1,0]
    v_cvt_pk_bf16_f32 v136, v136, v137
    v_lshlrev_b32 v56, 7, v58
    v_lshl_add_u32 v56, v57, 3, v56
    v_bfe_u32 v57, v2, 3, 2
    ds_write_b128 v9, v[248:251] offset:5120
    v_cvt_pk_bf16_f32 v137, v138, v139
    v_cvt_pk_bf16_f32 v138, v140, v141
    v_cvt_pk_bf16_f32 v139, v142, v143
    buffer_store_dwordx4 v[136:139], v1, s[8:11], s100 offen offset:1024 sc0 sc1
    v_pk_add_f32 v[160:161], v[160:161], v[176:177]
    v_pk_add_f32 v[162:163], v[162:163], v[178:179]
    v_pk_add_f32 v[164:165], v[164:165], v[180:181]
    v_pk_add_f32 v[166:167], v[166:167], v[182:183]
    v_pk_mul_f32 v[160:161], v[160:161], v[114:115] op_sel_hi:[1,0]
    v_pk_mul_f32 v[162:163], v[162:163], v[114:115] op_sel_hi:[1,0]
    v_pk_mul_f32 v[164:165], v[164:165], v[114:115] op_sel_hi:[1,0]
    v_lshl_add_u32 v56, v57, 5, v56
    v_xor_b32 v57, 32, v56
    ds_write_b128 v9, v[220:223] offset:6144
    v_pk_mul_f32 v[166:167], v[166:167], v[114:115] op_sel_hi:[1,0]
    v_cvt_pk_bf16_f32 v160, v160, v161
    v_cvt_pk_bf16_f32 v161, v162, v163
    v_cvt_pk_bf16_f32 v162, v164, v165
    v_cvt_pk_bf16_f32 v163, v166, v167
    buffer_store_dwordx4 v[160:163], v15, s[8:11], s100 offen offset:0 sc0 sc1
    v_pk_add_f32 v[168:169], v[168:169], v[184:185]
    v_pk_add_f32 v[170:171], v[170:171], v[186:187]
    s_waitcnt lgkmcnt(7)
    v_pk_add_f32 v[172:173], v[172:173], v[188:189]
    v_pk_add_f32 v[174:175], v[174:175], v[190:191]
    v_pk_mul_f32 v[168:169], v[168:169], v[114:115] op_sel_hi:[1,0]
    v_xor_b32 v58, 64, v56
    v_xor_b32 v59, 96, v56
    v_add_u32 v60, 65536, v56
    ds_write_b128 v9, v[252:255] offset:7168
    v_pk_mul_f32 v[170:171], v[170:171], v[114:115] op_sel_hi:[1,0]
    v_pk_mul_f32 v[172:173], v[172:173], v[114:115] op_sel_hi:[1,0]
    v_pk_mul_f32 v[174:175], v[174:175], v[114:115] op_sel_hi:[1,0]
    v_cvt_pk_bf16_f32 v168, v168, v169
    v_cvt_pk_bf16_f32 v169, v170, v171
    v_cvt_pk_bf16_f32 v170, v172, v173
    v_cvt_pk_bf16_f32 v171, v174, v175
    buffer_store_dwordx4 v[168:171], v15, s[8:11], s100 offen offset:1024 sc0 sc1
    v_add_u32 v61, 65536, v57
    v_add_u32 v62, 65536, v58
    v_add_u32 v63, 65536, v59
    ds_write_b32 v14, v12
    v_and_b32 v14, 4294967103, v13
    v_add_u32 v14, s62, v14
    s_waitcnt lgkmcnt(0)
    s_barrier
    ds_read_b32 v116, v14 offset:128
    ds_read_b32 v118, v14 offset:192
    ds_read_b128 v[208:211], v10 offset:0
    ds_read_b128 v[212:215], v10 offset:2048
    ds_read_b128 v[216:219], v10 offset:4096
    ds_read_b128 v[220:223], v10 offset:6144
    ds_read_b128 v[240:243], v10 offset:1024
    ds_read_b128 v[244:247], v10 offset:3072
    ds_read_b128 v[248:251], v10 offset:5120
    ds_read_b128 v[252:255], v10 offset:7168
    ds_read_b32 v120, v13 offset:0
    ds_read_b32 v121, v13 offset:8192
    ds_read_b32 v122, v13 offset:16384
    ds_read_b32 v123, v13 offset:24576
    s_waitcnt lgkmcnt(13)
    v_add_f32 v116, v116, v40
    s_waitcnt lgkmcnt(12)
    v_add_f32 v118, v118, v44
    v_rcp_f32 v116, v116
    v_rcp_f32 v118, v118
    s_waitcnt lgkmcnt(11)
    v_pk_add_f32 v[192:193], v[192:193], v[208:209]
    v_pk_add_f32 v[194:195], v[194:195], v[210:211]
    s_waitcnt lgkmcnt(10)
    v_pk_add_f32 v[196:197], v[196:197], v[212:213]
    v_pk_add_f32 v[198:199], v[198:199], v[214:215]
    v_pk_mul_f32 v[192:193], v[192:193], v[116:117] op_sel_hi:[1,0]
    v_pk_mul_f32 v[194:195], v[194:195], v[116:117] op_sel_hi:[1,0]
    v_pk_mul_f32 v[196:197], v[196:197], v[116:117] op_sel_hi:[1,0]
    v_pk_mul_f32 v[198:199], v[198:199], v[116:117] op_sel_hi:[1,0]
    v_cvt_pk_bf16_f32 v192, v192, v193
    v_cvt_pk_bf16_f32 v193, v194, v195
    v_cvt_pk_bf16_f32 v194, v196, v197
    v_cvt_pk_bf16_f32 v195, v198, v199
    buffer_store_dwordx4 v[192:195], v1, s[8:11], s101 offen offset:0 sc0 sc1
    s_waitcnt lgkmcnt(9)
    v_pk_add_f32 v[200:201], v[200:201], v[216:217]
    v_pk_add_f32 v[202:203], v[202:203], v[218:219]
    s_waitcnt lgkmcnt(8)
    v_pk_add_f32 v[204:205], v[204:205], v[220:221]
    v_pk_add_f32 v[206:207], v[206:207], v[222:223]
    v_pk_mul_f32 v[200:201], v[200:201], v[116:117] op_sel_hi:[1,0]
    v_pk_mul_f32 v[202:203], v[202:203], v[116:117] op_sel_hi:[1,0]
    v_pk_mul_f32 v[204:205], v[204:205], v[116:117] op_sel_hi:[1,0]
    v_pk_mul_f32 v[206:207], v[206:207], v[116:117] op_sel_hi:[1,0]
    v_cvt_pk_bf16_f32 v200, v200, v201
    v_cvt_pk_bf16_f32 v201, v202, v203
    v_cvt_pk_bf16_f32 v202, v204, v205
    v_cvt_pk_bf16_f32 v203, v206, v207
    buffer_store_dwordx4 v[200:203], v1, s[8:11], s101 offen offset:1024 sc0 sc1
    s_waitcnt lgkmcnt(2)
    v_add_f32 v120, v120, v121
    s_waitcnt lgkmcnt(0)
    v_add_f32 v122, v122, v123
    v_min_f32 v124, v120, v122
    v_add_f32 v120, v120, v122
    v_cmp_le_f32 vcc, 0x1f800000, v124
    s_mov_b64 s[96:97], vcc
    v_cmp_ge_f32 vcc, 0x67800000, v120
    s_and_b64 s[96:97], s[96:97], vcc
    s_cmp_eq_u64 s[96:97], -1
    s_cselect_b32 s96, s25, 1
    s_cmp_lg_u32 s96, 0
    s_cbranch_scc1 L_t2_redo
L_t2_safe:
    v_pk_add_f32 v[224:225], v[224:225], v[240:241]
    v_pk_add_f32 v[226:227], v[226:227], v[242:243]
    v_pk_add_f32 v[228:229], v[228:229], v[244:245]
    v_pk_add_f32 v[230:231], v[230:231], v[246:247]
    v_pk_mul_f32 v[224:225], v[224:225], v[118:119] op_sel_hi:[1,0]
    v_pk_mul_f32 v[226:227], v[226:227], v[118:119] op_sel_hi:[1,0]
    v_pk_mul_f32 v[228:229], v[228:229], v[118:119] op_sel_hi:[1,0]
    v_pk_mul_f32 v[230:231], v[230:231], v[118:119] op_sel_hi:[1,0]
    v_cvt_pk_bf16_f32 v224, v224, v225
    v_cvt_pk_bf16_f32 v225, v226, v227
    v_cvt_pk_bf16_f32 v226, v228, v229
    v_cvt_pk_bf16_f32 v227, v230, v231
    buffer_store_dwordx4 v[224:227], v15, s[8:11], s101 offen offset:0 sc0 sc1
    ds_read_b64_tr_b16 a[192:193], v56 offset:32768
    ds_read_b64_tr_b16 a[194:195], v56 offset:34816
    ds_read_b64_tr_b16 a[196:197], v56 offset:36864
    ds_read_b64_tr_b16 a[198:199], v56 offset:38912
    ds_read_b64_tr_b16 a[200:201], v57 offset:32768
    ds_read_b64_tr_b16 a[202:203], v57 offset:34816
    ds_read_b64_tr_b16 a[204:205], v57 offset:36864
    ds_read_b64_tr_b16 a[206:207], v57 offset:38912
    v_pk_add_f32 v[232:233], v[232:233], v[248:249]
    v_pk_add_f32 v[234:235], v[234:235], v[250:251]
    v_pk_add_f32 v[236:237], v[236:237], v[252:253]
    v_pk_add_f32 v[238:239], v[238:239], v[254:255]
    v_pk_mul_f32 v[232:233], v[232:233], v[118:119] op_sel_hi:[1,0]
    v_pk_mul_f32 v[234:235], v[234:235], v[118:119] op_sel_hi:[1,0]
    v_pk_mul_f32 v[236:237], v[236:237], v[118:119] op_sel_hi:[1,0]
    v_pk_mul_f32 v[238:239], v[238:239], v[118:119] op_sel_hi:[1,0]
    v_cvt_pk_bf16_f32 v232, v232, v233
    v_cvt_pk_bf16_f32 v233, v234, v235
    v_cvt_pk_bf16_f32 v234, v236, v237
    v_cvt_pk_bf16_f32 v235, v238, v239
    buffer_store_dwordx4 v[232:235], v15, s[8:11], s101 offen offset:1024 sc0 sc1
    ds_read_b64_tr_b16 a[208:209], v56 offset:40960
    ds_read_b64_tr_b16 a[210:211], v56 offset:43008
    ds_read_b64_tr_b16 a[212:213], v56 offset:45056
    ds_read_b64_tr_b16 a[214:215], v56 offset:47104
    ds_read_b64_tr_b16 a[216:217], v57 offset:40960
    ds_read_b64_tr_b16 a[218:219], v57 offset:43008
    ds_read_b64_tr_b16 a[220:221], v57 offset:45056
    ds_read_b64_tr_b16 a[222:223], v57 offset:47104
    s_cmp_ge_u32 s73, 24
    s_cbranch_scc1 L_op_odd
    s_waitcnt lgkmcnt(14)
    v_mfma_f32_16x16x32_bf16 v[64:67], a[192:195], a[64:67], 0
    s_waitcnt lgkmcnt(12)
    s_add_u32 m0, s62, 0
    ds_read_b64_tr_b16 a[224:225], v56 offset:49152
    v_mfma_f32_16x16x32_bf16 v[64:67], a[196:199], a[68:71], v[64:67]
    s_xor_b32 s98, s65, 128
    ds_read_b64_tr_b16 a[226:227], v56 offset:51200
    v_mfma_f32_16x16x32_bf16 v[72:75], a[192:195], a[80:83], 0
    buffer_load_dwordx4 v24, s[28:31], s98 offen offset:0   lds
    v_mfma_f32_16x16x32_bf16 v[72:75], a[196:199], a[84:87], v[72:75]
    s_waitcnt lgkmcnt(12)
    ds_read_b64_tr_b16 a[228:229], v56 offset:53248
    v_mfma_f32_16x16x32_bf16 v[68:71], a[200:203], a[64:67], 0
    s_waitcnt lgkmcnt(11)
    ds_read_b64_tr_b16 a[230:231], v56 offset:55296
    v_mfma_f32_16x16x32_bf16 v[68:71], a[204:207], a[68:71], v[68:71]
    s_add_u32 s22, s22, 65536
    ds_read_b64_tr_b16 a[232:233], v57 offset:49152
    v_mfma_f32_16x16x32_bf16 v[76:79], a[200:203], a[80:83], 0
    buffer_load_dwordx4 v25, s[28:31], s98 offen offset:1024   lds
    ds_read_b64_tr_b16 a[234:235], v57 offset:51200
    v_mfma_f32_16x16x32_bf16 v[76:79], a[204:207], a[84:87], v[76:79]
    s_waitcnt lgkmcnt(12)
    s_add_u32 s23, s23, 65536
    ds_read_b64_tr_b16 a[236:237], v57 offset:53248
    v_mfma_f32_16x16x32_bf16 v[64:67], a[208:211], a[72:75], v[64:67]
    s_waitcnt lgkmcnt(11)
    s_lshl_b32 s24, s61, 2
    ds_read_b64_tr_b16 a[238:239], v57 offset:55296
    v_mfma_f32_16x16x32_bf16 v[64:67], a[212:215], a[76:79], v[64:67]
    s_add_u32 s24, s24, s3
    ds_read_b64_tr_b16 a[240:241], v56 offset:57344
    v_mfma_f32_16x16x32_bf16 v[72:75], a[208:211], a[88:91], v[72:75]
    buffer_load_dwordx4 v26, s[28:31], s98 offen offset:2048   lds
    v_mfma_f32_16x16x32_bf16 v[72:75], a[212:215], a[92:95], v[72:75]
    s_waitcnt lgkmcnt(7)
    s_lshl_b32 s24, s24, 3
    ds_read_b64_tr_b16 a[242:243], v56 offset:59392
    v_mfma_f32_16x16x32_bf16 v[68:71], a[216:219], a[72:75], v[68:71]
    s_add_u32 s24, s24, s4
    ds_read_b64_tr_b16 a[244:245], v56 offset:61440
    v_mfma_f32_16x16x32_bf16 v[68:71], a[220:223], a[76:79], v[68:71]
    s_lshl_b32 s24, s24, 2
    ds_read_b64_tr_b16 a[246:247], v56 offset:63488
    v_mfma_f32_16x16x32_bf16 v[76:79], a[216:219], a[88:91], v[76:79]
    buffer_load_dwordx4 v27, s[28:31], s98 offen offset:3072   lds
    ds_read_b64_tr_b16 a[248:249], v57 offset:57344
    v_mfma_f32_16x16x32_bf16 v[76:79], a[220:223], a[92:95], v[76:79]
    s_add_u32 m0, s62, 4096
    ds_read_b64_tr_b16 a[250:251], v57 offset:59392
    v_mfma_f32_16x16x32_bf16 v[64:67], a[224:227], a[96:99], v[64:67]
    s_waitcnt lgkmcnt(8)
    s_xor_b32 s98, s65, 32896
    ds_read_b64_tr_b16 a[252:253], v57 offset:61440
    v_mfma_f32_16x16x32_bf16 v[64:67], a[228:231], a[100:103], v[64:67]
    s_add_u32 s24, s24, s5
    ds_read_b64_tr_b16 a[254:255], v57 offset:63488
    v_mfma_f32_16x16x32_bf16 v[72:75], a[224:227], a[112:115], v[72:75]
    buffer_load_dwordx4 v24, s[28:31], s98 offen offset:0   lds
    v_mfma_f32_16x16x32_bf16 v[72:75], a[228:231], a[116:119], v[72:75]
    s_lshl_b32 s24, s24, 13
    ds_read_b64_tr_b16 a[192:193], v58 offset:32768
    v_mfma_f32_16x16x32_bf16 v[68:71], a[232:235], a[96:99], v[68:71]
    s_waitcnt lgkmcnt(8)
    s_add_u32 s24, s24, 50331648
    ds_read_b64_tr_b16 a[194:195], v58 offset:34816
    v_mfma_f32_16x16x32_bf16 v[68:71], a[236:239], a[100:103], v[68:71]
    ds_read_b64_tr_b16 a[196:197], v58 offset:36864
    v_mfma_f32_16x16x32_bf16 v[76:79], a[232:235], a[112:115], v[76:79]
    buffer_load_dwordx4 v25, s[28:31], s98 offen offset:1024   lds
    ds_read_b64_tr_b16 a[198:199], v58 offset:38912
    v_mfma_f32_16x16x32_bf16 v[76:79], a[236:239], a[116:119], v[76:79]
    s_waitcnt lgkmcnt(8)
    ds_read_b64_tr_b16 a[200:201], v59 offset:32768
    v_mfma_f32_16x16x32_bf16 v[64:67], a[240:243], a[104:107], v[64:67]
    ds_read_b64_tr_b16 a[202:203], v59 offset:34816
    v_mfma_f32_16x16x32_bf16 v[64:67], a[244:247], a[108:111], v[64:67]
    ds_read_b64_tr_b16 a[204:205], v59 offset:36864
    v_mfma_f32_16x16x32_bf16 v[72:75], a[240:243], a[120:123], v[72:75]
    buffer_load_dwordx4 v26, s[28:31], s98 offen offset:2048   lds
    ds_read_b64_tr_b16 a[206:207], v59 offset:38912
    v_mfma_f32_16x16x32_bf16 v[72:75], a[244:247], a[124:127], v[72:75]
    s_waitcnt lgkmcnt(8)
    ds_read_b64_tr_b16 a[208:209], v58 offset:40960
    v_mfma_f32_16x16x32_bf16 v[68:71], a[248:251], a[104:107], v[68:71]
    ds_read_b64_tr_b16 a[210:211], v58 offset:43008
    v_mfma_f32_16x16x32_bf16 v[68:71], a[252:255], a[108:111], v[68:71]
    ds_read_b64_tr_b16 a[212:213], v58 offset:45056
    v_mfma_f32_16x16x32_bf16 v[76:79], a[248:251], a[120:123], v[76:79]
    buffer_load_dwordx4 v27, s[28:31], s98 offen offset:3072   lds
    ds_read_b64_tr_b16 a[214:215], v58 offset:47104
    v_mfma_f32_16x16x32_bf16 v[76:79], a[252:255], a[124:127], v[76:79]
    s_waitcnt lgkmcnt(9)
    ds_read_b64_tr_b16 a[216:217], v59 offset:40960
    v_mfma_f32_16x16x32_bf16 v[80:83], a[192:195], a[64:67], 0
    s_waitcnt lgkmcnt(9)
    ds_read_b64_tr_b16 a[218:219], v59 offset:43008
    v_mfma_f32_16x16x32_bf16 v[80:83], a[196:199], a[68:71], v[80:83]
    ds_read_b64_tr_b16 a[220:221], v59 offset:45056
    v_mfma_f32_16x16x32_bf16 v[88:91], a[192:195], a[80:83], 0
    ds_read_b64_tr_b16 a[222:223], v59 offset:47104
    s_waitcnt vmcnt(16)
    s_barrier
    v_mfma_f32_16x16x32_bf16 v[88:91], a[196:199], a[84:87], v[88:91]
    s_waitcnt lgkmcnt(9)
    s_add_u32 m0, s62, 98304
    ds_read_b64_tr_b16 a[224:225], v58 offset:49152
    v_mfma_f32_16x16x32_bf16 v[84:87], a[200:203], a[64:67], 0
    s_waitcnt lgkmcnt(9)
    s_xor_b32 s98, s65, 262272
    ds_read_b64_tr_b16 a[226:227], v58 offset:51200
    v_mfma_f32_16x16x32_bf16 v[84:87], a[204:207], a[68:71], v[84:87]
    buffer_load_dwordx4 v24, s[28:31], s98 offen offset:0   lds
    ds_read_b64_tr_b16 a[228:229], v58 offset:53248
    v_mfma_f32_16x16x32_bf16 v[92:95], a[200:203], a[80:83], 0
    ds_read_b64_tr_b16 a[230:231], v58 offset:55296
    v_mfma_f32_16x16x32_bf16 v[92:95], a[204:207], a[84:87], v[92:95]
    s_waitcnt lgkmcnt(9)
    ds_read_b64_tr_b16 a[232:233], v59 offset:49152
    v_mfma_f32_16x16x32_bf16 v[80:83], a[208:211], a[72:75], v[80:83]
    s_waitcnt lgkmcnt(9)
    ds_read_b64_tr_b16 a[234:235], v59 offset:51200
    v_mfma_f32_16x16x32_bf16 v[80:83], a[212:215], a[76:79], v[80:83]
    buffer_load_dwordx4 v25, s[28:31], s98 offen offset:1024   lds
    ds_read_b64_tr_b16 a[236:237], v59 offset:53248
    v_mfma_f32_16x16x32_bf16 v[88:91], a[208:211], a[88:91], v[88:91]
    ds_read_b64_tr_b16 a[238:239], v59 offset:55296
    v_mfma_f32_16x16x32_bf16 v[88:91], a[212:215], a[92:95], v[88:91]
    s_waitcnt lgkmcnt(9)
    ds_read_b64_tr_b16 a[240:241], v58 offset:57344
    v_mfma_f32_16x16x32_bf16 v[84:87], a[216:219], a[72:75], v[84:87]
    s_waitcnt lgkmcnt(9)
    ds_read_b64_tr_b16 a[242:243], v58 offset:59392
    v_mfma_f32_16x16x32_bf16 v[84:87], a[220:223], a[76:79], v[84:87]
    buffer_load_dwordx4 v26, s[28:31], s98 offen offset:2048   lds
    ds_read_b64_tr_b16 a[244:245], v58 offset:61440
    v_mfma_f32_16x16x32_bf16 v[92:95], a[216:219], a[88:91], v[92:95]
    ds_read_b64_tr_b16 a[246:247], v58 offset:63488
    v_mfma_f32_16x16x32_bf16 v[92:95], a[220:223], a[92:95], v[92:95]
    s_waitcnt lgkmcnt(9)
    ds_read_b64_tr_b16 a[248:249], v59 offset:57344
    v_mfma_f32_16x16x32_bf16 v[80:83], a[224:227], a[96:99], v[80:83]
    s_waitcnt lgkmcnt(9)
    ds_read_b64_tr_b16 a[250:251], v59 offset:59392
    v_mfma_f32_16x16x32_bf16 v[80:83], a[228:231], a[100:103], v[80:83]
    buffer_load_dwordx4 v27, s[28:31], s98 offen offset:3072   lds
    ds_read_b64_tr_b16 a[252:253], v59 offset:61440
    v_mfma_f32_16x16x32_bf16 v[88:91], a[224:227], a[112:115], v[88:91]
    s_add_u32 m0, s62, 102400
    ds_read_b64_tr_b16 a[254:255], v59 offset:63488
    v_mfma_f32_16x16x32_bf16 v[88:91], a[228:231], a[116:119], v[88:91]
    s_waitcnt lgkmcnt(9)
    s_xor_b32 s98, s65, 295040
    ds_read_b64_tr_b16 a[192:193], v60 offset:0
    v_mfma_f32_16x16x32_bf16 v[84:87], a[232:235], a[96:99], v[84:87]
    s_waitcnt lgkmcnt(9)
    ds_read_b64_tr_b16 a[194:195], v60 offset:2048
    v_mfma_f32_16x16x32_bf16 v[84:87], a[236:239], a[100:103], v[84:87]
    buffer_load_dwordx4 v24, s[28:31], s98 offen offset:0   lds
    ds_read_b64_tr_b16 a[196:197], v60 offset:4096
    v_mfma_f32_16x16x32_bf16 v[92:95], a[232:235], a[112:115], v[92:95]
    ds_read_b64_tr_b16 a[198:199], v60 offset:6144
    v_mfma_f32_16x16x32_bf16 v[92:95], a[236:239], a[116:119], v[92:95]
    s_waitcnt lgkmcnt(9)
    ds_read_b64_tr_b16 a[200:201], v61 offset:0
    v_mfma_f32_16x16x32_bf16 v[80:83], a[240:243], a[104:107], v[80:83]
    s_waitcnt lgkmcnt(9)
    ds_read_b64_tr_b16 a[202:203], v61 offset:2048
    v_mfma_f32_16x16x32_bf16 v[80:83], a[244:247], a[108:111], v[80:83]
    buffer_load_dwordx4 v25, s[28:31], s98 offen offset:1024   lds
    ds_read_b64_tr_b16 a[204:205], v61 offset:4096
    v_mfma_f32_16x16x32_bf16 v[88:91], a[240:243], a[120:123], v[88:91]
    ds_read_b64_tr_b16 a[206:207], v61 offset:6144
    v_mfma_f32_16x16x32_bf16 v[88:91], a[244:247], a[124:127], v[88:91]
    s_waitcnt lgkmcnt(9)
    ds_read_b64_tr_b16 a[208:209], v60 offset:8192
    v_mfma_f32_16x16x32_bf16 v[84:87], a[248:251], a[104:107], v[84:87]
    s_waitcnt lgkmcnt(9)
    ds_read_b64_tr_b16 a[210:211], v60 offset:10240
    v_lshrrev_b32 v46, 2, v2
    v_mfma_f32_16x16x32_bf16 v[84:87], a[252:255], a[108:111], v[84:87]
    buffer_load_dwordx4 v26, s[28:31], s98 offen offset:2048   lds
    ds_read_b64_tr_b16 a[212:213], v60 offset:12288
    v_mfma_f32_16x16x32_bf16 v[92:95], a[248:251], a[120:123], v[92:95]
    ds_read_b64_tr_b16 a[214:215], v60 offset:14336
    v_and_b32 v45, 3, v2
    v_mfma_f32_16x16x32_bf16 v[92:95], a[252:255], a[124:127], v[92:95]
    s_waitcnt lgkmcnt(9)
    ds_read_b64_tr_b16 a[216:217], v61 offset:8192
    v_lshlrev_b32 v44, 8, v46
    v_mfma_f32_16x16x32_bf16 v[64:67], a[192:195], a[0:3], v[64:67]
    s_waitcnt lgkmcnt(9)
    ds_read_b64_tr_b16 a[218:219], v61 offset:10240
    v_lshl_add_u32 v44, v45, 4, v44
    v_mfma_f32_16x16x32_bf16 v[64:67], a[196:199], a[4:7], v[64:67]
    buffer_load_dwordx4 v27, s[28:31], s98 offen offset:3072   lds
    ds_read_b64_tr_b16 a[220:221], v61 offset:12288
    v_mfma_f32_16x16x32_bf16 v[72:75], a[192:195], a[16:19], v[72:75]
    ds_read_b64_tr_b16 a[222:223], v61 offset:14336
    v_lshlrev_b32 v45, 3, v45
    v_mfma_f32_16x16x32_bf16 v[72:75], a[196:199], a[20:23], v[72:75]
    s_waitcnt lgkmcnt(9)
    ds_read_b64_tr_b16 a[224:225], v60 offset:16384
    v_lshl_add_u32 v45, v46, 6, v45
    v_mfma_f32_16x16x32_bf16 v[68:71], a[200:203], a[0:3], v[68:71]
    s_waitcnt lgkmcnt(9)
    ds_read_b64_tr_b16 a[226:227], v60 offset:18432
    v_lshlrev_b32 v46, 1, v45
    v_mfma_f32_16x16x32_bf16 v[68:71], a[204:207], a[4:7], v[68:71]
    s_lshl_b32 s70, s2, 15
    ds_read_b64_tr_b16 a[228:229], v60 offset:20480
    v_mfma_f32_16x16x32_bf16 v[76:79], a[200:203], a[16:19], v[76:79]
    s_lshl_b32 s100, s3, 6
    ds_read_b64_tr_b16 a[230:231], v60 offset:22528
    v_mfma_f32_16x16x32_bf16 v[76:79], a[204:207], a[20:23], v[76:79]
    s_waitcnt lgkmcnt(9)
    s_add_u32 s70, s70, s100
    ds_read_b64_tr_b16 a[232:233], v61 offset:16384
    v_mfma_f32_16x16x32_bf16 v[64:67], a[208:211], a[8:11], v[64:67]
    s_waitcnt lgkmcnt(9)
    s_add_u32 s70, s70, 67108864
    ds_read_b64_tr_b16 a[234:235], v61 offset:18432
    v_mfma_f32_16x16x32_bf16 v[64:67], a[212:215], a[12:15], v[64:67]
    s_and_b32 s68, s2, 31
    ds_read_b64_tr_b16 a[236:237], v61 offset:20480
    v_mfma_f32_16x16x32_bf16 v[72:75], a[208:211], a[24:27], v[72:75]
    s_lshl_b32 s68, s68, 2
    ds_read_b64_tr_b16 a[238:239], v61 offset:22528
    v_mfma_f32_16x16x32_bf16 v[72:75], a[212:215], a[28:31], v[72:75]
    s_waitcnt lgkmcnt(9)
    s_add_u32 s68, s68, s3
    ds_read_b64_tr_b16 a[240:241], v60 offset:24576
    v_mfma_f32_16x16x32_bf16 v[68:71], a[216:219], a[8:11], v[68:71]
    s_waitcnt lgkmcnt(9)
    s_lshl_b32 s69, s61, 7
    ds_read_b64_tr_b16 a[242:243], v60 offset:26624
    v_mfma_f32_16x16x32_bf16 v[68:71], a[220:223], a[12:15], v[68:71]
    s_add_u32 s69, s69, s68
    ds_read_b64_tr_b16 a[244:245], v60 offset:28672
    v_mfma_f32_16x16x32_bf16 v[76:79], a[216:219], a[24:27], v[76:79]
    s_lshl_b32 s100, s60, 7
    ds_read_b64_tr_b16 a[246:247], v60 offset:30720
    v_mfma_f32_16x16x32_bf16 v[76:79], a[220:223], a[28:31], v[76:79]
    s_waitcnt lgkmcnt(9)
    s_add_u32 s68, s68, s100
    ds_read_b64_tr_b16 a[248:249], v61 offset:24576
    v_mfma_f32_16x16x32_bf16 v[64:67], a[224:227], a[32:35], v[64:67]
    s_waitcnt lgkmcnt(9)
    s_lshl_b32 s100, s68, 10
    ds_read_b64_tr_b16 a[250:251], v61 offset:26624
    v_mfma_f32_16x16x32_bf16 v[64:67], a[228:231], a[36:39], v[64:67]
    s_lshl_b32 s101, s69, 10
    ds_read_b64_tr_b16 a[252:253], v61 offset:28672
    v_mfma_f32_16x16x32_bf16 v[72:75], a[224:227], a[48:51], v[72:75]
    ds_read_b64_tr_b16 a[254:255], v61 offset:30720
    ds_read_b64_tr_b16 a[208:209], v62 offset:8192
    v_mfma_f32_16x16x32_bf16 v[72:75], a[228:231], a[52:55], v[72:75]
    s_waitcnt lgkmcnt(10)
    ds_read_b64_tr_b16 a[192:193], v62 offset:0
    ds_read_b64_tr_b16 a[210:211], v62 offset:10240
    v_mfma_f32_16x16x32_bf16 v[68:71], a[232:235], a[32:35], v[68:71]
    s_waitcnt lgkmcnt(11)
    ds_read_b64_tr_b16 a[194:195], v62 offset:2048
    ds_read_b64_tr_b16 a[212:213], v62 offset:12288
    v_mfma_f32_16x16x32_bf16 v[68:71], a[236:239], a[36:39], v[68:71]
    ds_read_b64_tr_b16 a[196:197], v62 offset:4096
    ds_read_b64_tr_b16 a[214:215], v62 offset:14336
    v_mfma_f32_16x16x32_bf16 v[76:79], a[232:235], a[48:51], v[76:79]
    ds_read_b64_tr_b16 a[198:199], v62 offset:6144
    ds_read_b64_tr_b16 a[216:217], v63 offset:8192
    v_mfma_f32_16x16x32_bf16 v[76:79], a[236:239], a[52:55], v[76:79]
    s_waitcnt lgkmcnt(14)
    ds_read_b64_tr_b16 a[200:201], v63 offset:0
    ds_read_b64_tr_b16 a[218:219], v63 offset:10240
    v_mfma_f32_16x16x32_bf16 v[64:67], a[240:243], a[40:43], v[64:67]
    s_waitcnt lgkmcnt(15)
    ds_read_b64_tr_b16 a[202:203], v63 offset:2048
    ds_read_b64_tr_b16 a[220:221], v63 offset:12288
    v_mfma_f32_16x16x32_bf16 v[64:67], a[244:247], a[44:47], v[64:67]
    ds_read_b64_tr_b16 a[204:205], v63 offset:4096
    ds_read_b64_tr_b16 a[222:223], v63 offset:14336
    v_mfma_f32_16x16x32_bf16 v[72:75], a[240:243], a[56:59], v[72:75]
    s_waitcnt lgkmcnt(15)
    ds_read_b64_tr_b16 a[206:207], v63 offset:6144
    s_waitcnt vmcnt(16)
    v_mfma_f32_16x16x32_bf16 v[72:75], a[244:247], a[60:63], v[72:75]
    buffer_store_dword v6, v5, s[8:11], s22 offen sc0 sc1
    v_mfma_f32_16x16x32_bf16 v[68:71], a[248:251], a[40:43], v[68:71]
    ds_read_b64_tr_b16 a[224:225], v62 offset:16384
    v_mfma_f32_16x16x32_bf16 v[68:71], a[252:255], a[44:47], v[68:71]
    ds_read_b64_tr_b16 a[226:227], v62 offset:18432
    v_mfma_f32_16x16x32_bf16 v[76:79], a[248:251], a[56:59], v[76:79]
    ds_read_b64_tr_b16 a[228:229], v62 offset:20480
    v_mfma_f32_16x16x32_bf16 v[76:79], a[252:255], a[60:63], v[76:79]
    s_waitcnt lgkmcnt(12)
    ds_read_b64_tr_b16 a[230:231], v62 offset:22528
    v_mfma_f32_16x16x32_bf16 v[80:83], a[192:195], a[0:3], v[80:83]
    s_waitcnt lgkmcnt(11)
    ds_read_b64_tr_b16 a[232:233], v63 offset:16384
    v_mfma_f32_16x16x32_bf16 v[80:83], a[196:199], a[4:7], v[80:83]
    ds_read_b64_tr_b16 a[234:235], v63 offset:18432
    v_mfma_f32_16x16x32_bf16 v[88:91], a[192:195], a[16:19], v[88:91]
    ds_read_b64_tr_b16 a[236:237], v63 offset:20480
    v_mfma_f32_16x16x32_bf16 v[88:91], a[196:199], a[20:23], v[88:91]
    s_waitcnt lgkmcnt(8)
    ds_read_b64_tr_b16 a[238:239], v63 offset:22528
    v_mfma_f32_16x16x32_bf16 v[84:87], a[200:203], a[0:3], v[84:87]
    s_waitcnt lgkmcnt(8)
    ds_read_b64_tr_b16 a[240:241], v62 offset:24576
    v_mfma_f32_16x16x32_bf16 v[84:87], a[204:207], a[4:7], v[84:87]
    ds_read_b64_tr_b16 a[242:243], v62 offset:26624
    v_mfma_f32_16x16x32_bf16 v[92:95], a[200:203], a[16:19], v[92:95]
    ds_read_b64_tr_b16 a[244:245], v62 offset:28672
    v_cvt_pk_bf16_f32 v64, v64, v65
    s_waitcnt vmcnt(1)
    s_barrier
    v_mfma_f32_16x16x32_bf16 v[92:95], a[204:207], a[20:23], v[92:95]
    s_xor_b32 s74, s24, 0
    ds_read_b64_tr_b16 a[246:247], v62 offset:30720
    v_cvt_pk_bf16_f32 v65, v66, v67
    v_mfma_f32_16x16x32_bf16 v[80:83], a[208:211], a[8:11], v[80:83]
    buffer_load_dwordx4 v[128:131], v1, s[8:11], s74 offen offset:0
    v_mfma_f32_16x16x32_bf16 v[80:83], a[212:215], a[12:15], v[80:83]
    s_xor_b32 s74, s24, 4096
    ds_read_b64_tr_b16 a[248:249], v63 offset:24576
    v_cvt_pk_bf16_f32 v66, v68, v69
    v_mfma_f32_16x16x32_bf16 v[88:91], a[208:211], a[24:27], v[88:91]
    ds_read_b64_tr_b16 a[250:251], v63 offset:26624
    v_cvt_pk_bf16_f32 v67, v70, v71
    v_mfma_f32_16x16x32_bf16 v[88:91], a[212:215], a[28:31], v[88:91]
    buffer_load_dwordx4 v[144:147], v1, s[8:11], s74 offen offset:0
    ds_read_b64_tr_b16 a[252:253], v63 offset:28672
    v_mfma_f32_16x16x32_bf16 v[84:87], a[216:219], a[8:11], v[84:87]
    s_xor_b32 s74, s24, 0
    ds_read_b64_tr_b16 a[254:255], v63 offset:30720
    v_min_u32 v64, -2, v64
    v_mfma_f32_16x16x32_bf16 v[84:87], a[220:223], a[12:15], v[84:87]
    ds_read_b64_tr_b16 a[192:193], v56 offset:0
    v_min_u32 v65, -2, v65
    v_mfma_f32_16x16x32_bf16 v[92:95], a[216:219], a[24:27], v[92:95]
    buffer_load_dwordx4 v[132:135], v1, s[8:11], s74 offen offset:1024
    v_mfma_f32_16x16x32_bf16 v[92:95], a[220:223], a[28:31], v[92:95]
    s_waitcnt lgkmcnt(7)
    s_xor_b32 s74, s24, 4096
    ds_read_b64_tr_b16 a[194:195], v56 offset:2048
    v_min_u32 v66, -2, v66
    v_mfma_f32_16x16x32_bf16 v[80:83], a[224:227], a[32:35], v[80:83]
    ds_read_b64_tr_b16 a[196:197], v56 offset:4096
    v_min_u32 v67, -2, v67
    v_mfma_f32_16x16x32_bf16 v[80:83], a[228:231], a[36:39], v[80:83]
    buffer_load_dwordx4 v[148:151], v1, s[8:11], s74 offen offset:1024
    v_mfma_f32_16x16x32_bf16 v[88:91], a[224:227], a[48:51], v[88:91]
    s_xor_b32 s74, s24, 0
    ds_read_b64_tr_b16 a[198:199], v56 offset:6144
    v_mfma_f32_16x16x32_bf16 v[88:91], a[228:231], a[52:55], v[88:91]
    s_add_u32 s75, s18, 0
    ds_read_b64_tr_b16 a[200:201], v57 offset:0
    v_mfma_f32_16x16x32_bf16 v[84:87], a[232:235], a[32:35], v[84:87]
    buffer_load_dwordx4 v[136:139], v1, s[8:11], s74 offen offset:2048
    ds_read_b64_tr_b16 a[202:203], v57 offset:2048
    v_mfma_f32_16x16x32_bf16 v[84:87], a[236:239], a[36:39], v[84:87]
    s_xor_b32 s74, s24, 4096
    ds_read_b64_tr_b16 a[204:205], v57 offset:4096
    v_mfma_f32_16x16x32_bf16 v[92:95], a[232:235], a[48:51], v[92:95]
    buffer_store_dwordx4 v[64:67], v23, s[8:11], s75 offen offset:0 sc0 sc1
    ds_read_b64_tr_b16 a[206:207], v57 offset:6144
    v_mfma_f32_16x16x32_bf16 v[92:95], a[236:239], a[52:55], v[92:95]
    buffer_load_dwordx4 v[152:155], v1, s[8:11], s74 offen offset:2048
    v_mfma_f32_16x16x32_bf16 v[80:83], a[240:243], a[40:43], v[80:83]
    s_waitcnt lgkmcnt(7)
    s_xor_b32 s74, s24, 0
    ds_read_b64_tr_b16 a[208:209], v56 offset:8192
    v_cvt_pk_bf16_f32 v72, v72, v73
    v_mfma_f32_16x16x32_bf16 v[80:83], a[244:247], a[44:47], v[80:83]
    ds_read_b64_tr_b16 a[210:211], v56 offset:10240
    v_cvt_pk_bf16_f32 v73, v74, v75
    v_mfma_f32_16x16x32_bf16 v[88:91], a[240:243], a[56:59], v[88:91]
    buffer_load_dwordx4 v[140:143], v1, s[8:11], s74 offen offset:3072
    v_mfma_f32_16x16x32_bf16 v[88:91], a[244:247], a[60:63], v[88:91]
    s_xor_b32 s74, s24, 4096
    ds_read_b64_tr_b16 a[212:213], v56 offset:12288
    v_cvt_pk_bf16_f32 v74, v76, v77
    v_mfma_f32_16x16x32_bf16 v[84:87], a[248:251], a[40:43], v[84:87]
    ds_read_b64_tr_b16 a[214:215], v56 offset:14336
    v_cvt_pk_bf16_f32 v75, v78, v79
    v_mfma_f32_16x16x32_bf16 v[84:87], a[252:255], a[44:47], v[84:87]
    buffer_load_dwordx4 v[156:159], v1, s[8:11], s74 offen offset:3072
    ds_read_b64_tr_b16 a[216:217], v57 offset:8192
    v_mfma_f32_16x16x32_bf16 v[92:95], a[248:251], a[56:59], v[92:95]
    ds_read_b64_tr_b16 a[218:219], v57 offset:10240
    v_min_u32 v72, -2, v72
    v_mfma_f32_16x16x32_bf16 v[92:95], a[252:255], a[60:63], v[92:95]
    s_waitcnt lgkmcnt(7)
    ds_read_b64_tr_b16 a[220:221], v57 offset:12288
    v_min_u32 v73, -2, v73
    v_mfma_f32_16x16x32_bf16 v[96:99], a[192:195], a[64:67], 0
    ds_read_b64_tr_b16 a[222:223], v57 offset:14336
    v_min_u32 v74, -2, v74
    v_mfma_f32_16x16x32_bf16 v[96:99], a[196:199], a[68:71], v[96:99]
    ds_read_b64_tr_b16 a[224:225], v56 offset:16384
    v_min_u32 v75, -2, v75
    v_mfma_f32_16x16x32_bf16 v[104:107], a[192:195], a[80:83], 0
    s_add_u32 s75, s18, 131072
    ds_read_b64_tr_b16 a[226:227], v56 offset:18432
    v_mfma_f32_16x16x32_bf16 v[104:107], a[196:199], a[84:87], v[104:107]
    buffer_store_dwordx4 v[72:75], v23, s[8:11], s75 offen offset:0 sc0 sc1
    ds_read_b64_tr_b16 a[228:229], v56 offset:20480
    v_mfma_f32_16x16x32_bf16 v[100:103], a[200:203], a[64:67], 0
    s_waitcnt lgkmcnt(9)
    ds_read_b64_tr_b16 a[230:231], v56 offset:22528
    v_mfma_f32_16x16x32_bf16 v[100:103], a[204:207], a[68:71], v[100:103]
    ds_read_b64_tr_b16 a[232:233], v57 offset:16384
    v_mfma_f32_16x16x32_bf16 v[108:111], a[200:203], a[80:83], 0
    ds_read_b64_tr_b16 a[234:235], v57 offset:18432
    v_mfma_f32_16x16x32_bf16 v[108:111], a[204:207], a[84:87], v[108:111]
    ds_read_b64_tr_b16 a[236:237], v57 offset:20480
    v_mfma_f32_16x16x32_bf16 v[96:99], a[208:211], a[72:75], v[96:99]
    s_waitcnt lgkmcnt(9)
    ds_read_b64_tr_b16 a[238:239], v57 offset:22528
    v_mfma_f32_16x16x32_bf16 v[96:99], a[212:215], a[76:79], v[96:99]
    ds_read_b64_tr_b16 a[240:241], v56 offset:24576
    v_mfma_f32_16x16x32_bf16 v[104:107], a[208:211], a[88:91], v[104:107]
    ds_read_b64_tr_b16 a[242:243], v56 offset:26624
    v_mfma_f32_16x16x32_bf16 v[104:107], a[212:215], a[92:95], v[104:107]
    ds_read_b64_tr_b16 a[244:245], v56 offset:28672
    v_mfma_f32_16x16x32_bf16 v[100:103], a[216:219], a[72:75], v[100:103]
    s_waitcnt lgkmcnt(9)
    ds_read_b64_tr_b16 a[246:247], v56 offset:30720
    v_mfma_f32_16x16x32_bf16 v[100:103], a[220:223], a[76:79], v[100:103]
    ds_read_b64_tr_b16 a[248:249], v57 offset:24576
    v_mfma_f32_16x16x32_bf16 v[108:111], a[216:219], a[88:91], v[108:111]
    ds_read_b64_tr_b16 a[250:251], v57 offset:26624
    v_mfma_f32_16x16x32_bf16 v[108:111], a[220:223], a[92:95], v[108:111]
    ds_read_b64_tr_b16 a[252:253], v57 offset:28672
    v_mfma_f32_16x16x32_bf16 v[96:99], a[224:227], a[96:99], v[96:99]
    s_waitcnt lgkmcnt(9)
    ds_read_b64_tr_b16 a[254:255], v57 offset:30720
    v_mfma_f32_16x16x32_bf16 v[96:99], a[228:231], a[100:103], v[96:99]
    ds_read_b64_tr_b16 a[192:193], v60 offset:32768
    v_mfma_f32_16x16x32_bf16 v[104:107], a[224:227], a[112:115], v[104:107]
    ds_read_b64_tr_b16 a[194:195], v60 offset:34816
    v_mfma_f32_16x16x32_bf16 v[104:107], a[228:231], a[116:119], v[104:107]
    ds_read_b64_tr_b16 a[196:197], v60 offset:36864
    v_mfma_f32_16x16x32_bf16 v[100:103], a[232:235], a[96:99], v[100:103]
    s_waitcnt lgkmcnt(9)
    ds_read_b64_tr_b16 a[198:199], v60 offset:38912
    v_cvt_pk_bf16_f32 v80, v80, v81
    v_mfma_f32_16x16x32_bf16 v[100:103], a[236:239], a[100:103], v[100:103]
    ds_read_b64_tr_b16 a[200:201], v61 offset:32768
    v_cvt_pk_bf16_f32 v81, v82, v83
    v_mfma_f32_16x16x32_bf16 v[108:111], a[232:235], a[112:115], v[108:111]
    ds_read_b64_tr_b16 a[202:203], v61 offset:34816
    v_cvt_pk_bf16_f32 v82, v84, v85
    v_mfma_f32_16x16x32_bf16 v[108:111], a[236:239], a[116:119], v[108:111]
    ds_read_b64_tr_b16 a[204:205], v61 offset:36864
    v_cvt_pk_bf16_f32 v83, v86, v87
    v_mfma_f32_16x16x32_bf16 v[96:99], a[240:243], a[104:107], v[96:99]
    s_waitcnt lgkmcnt(9)
    ds_read_b64_tr_b16 a[206:207], v61 offset:38912
    v_min_u32 v80, -2, v80
    v_mfma_f32_16x16x32_bf16 v[96:99], a[244:247], a[108:111], v[96:99]
    ds_read_b64_tr_b16 a[208:209], v60 offset:40960
    v_min_u32 v81, -2, v81
    v_mfma_f32_16x16x32_bf16 v[104:107], a[240:243], a[120:123], v[104:107]
    ds_read_b64_tr_b16 a[210:211], v60 offset:43008
    v_min_u32 v82, -2, v82
    v_mfma_f32_16x16x32_bf16 v[104:107], a[244:247], a[124:127], v[104:107]
    buffer_load_dword v3, v4, s[8:11], s23 offen sc0 sc1
    ds_read_b64_tr_b16 a[212:213], v60 offset:45056
    v_mfma_f32_16x16x32_bf16 v[100:103], a[248:251], a[104:107], v[100:103]
    s_waitcnt lgkmcnt(9)
    ds_read_b64_tr_b16 a[214:215], v60 offset:47104
    v_min_u32 v83, -2, v83
    v_mfma_f32_16x16x32_bf16 v[100:103], a[252:255], a[108:111], v[100:103]
    s_add_u32 s75, s18, 0
    ds_read_b64_tr_b16 a[216:217], v61 offset:40960
    v_mfma_f32_16x16x32_bf16 v[108:111], a[248:251], a[120:123], v[108:111]
    buffer_store_dwordx4 v[80:83], v23, s[8:11], s75 offen offset:256 sc0 sc1
    ds_read_b64_tr_b16 a[218:219], v61 offset:43008
    v_mfma_f32_16x16x32_bf16 v[108:111], a[252:255], a[124:127], v[108:111]
    ds_read_b64_tr_b16 a[220:221], v61 offset:45056
    v_cvt_pk_bf16_f32 v88, v88, v89
    v_mfma_f32_16x16x32_bf16 v[96:99], a[192:195], a[0:3], v[96:99]
    s_waitcnt lgkmcnt(9)
    ds_read_b64_tr_b16 a[222:223], v61 offset:47104
    v_cvt_pk_bf16_f32 v89, v90, v91
    v_mfma_f32_16x16x32_bf16 v[96:99], a[196:199], a[4:7], v[96:99]
    ds_read_b64_tr_b16 a[224:225], v60 offset:49152
    v_cvt_pk_bf16_f32 v90, v92, v93
    v_mfma_f32_16x16x32_bf16 v[104:107], a[192:195], a[16:19], v[104:107]
    ds_read_b64_tr_b16 a[226:227], v60 offset:51200
    v_cvt_pk_bf16_f32 v91, v94, v95
    v_mfma_f32_16x16x32_bf16 v[104:107], a[196:199], a[20:23], v[104:107]
    ds_read_b64_tr_b16 a[228:229], v60 offset:53248
    v_min_u32 v88, -2, v88
    v_mfma_f32_16x16x32_bf16 v[100:103], a[200:203], a[0:3], v[100:103]
    s_waitcnt lgkmcnt(9)
    ds_read_b64_tr_b16 a[230:231], v60 offset:55296
    v_min_u32 v89, -2, v89
    v_mfma_f32_16x16x32_bf16 v[100:103], a[204:207], a[4:7], v[100:103]
    ds_read_b64_tr_b16 a[232:233], v61 offset:49152
    v_min_u32 v90, -2, v90
    v_mfma_f32_16x16x32_bf16 v[108:111], a[200:203], a[16:19], v[108:111]
    ds_read_b64_tr_b16 a[234:235], v61 offset:51200
    v_min_u32 v91, -2, v91
    v_mfma_f32_16x16x32_bf16 v[108:111], a[204:207], a[20:23], v[108:111]
    s_waitcnt lgkmcnt(9)
    s_add_u32 s75, s18, 131072
    ds_read_b64_tr_b16 a[236:237], v61 offset:53248
    v_mfma_f32_16x16x32_bf16 v[96:99], a[208:211], a[8:11], v[96:99]
    buffer_store_dwordx4 v[88:91], v23, s[8:11], s75 offen offset:256 sc0 sc1
    ds_read_b64_tr_b16 a[238:239], v61 offset:55296
    v_mfma_f32_16x16x32_bf16 v[96:99], a[212:215], a[12:15], v[96:99]
    ds_read_b64_tr_b16 a[240:241], v60 offset:57344
    v_mfma_f32_16x16x32_bf16 v[104:107], a[208:211], a[24:27], v[104:107]
    ds_read_b64_tr_b16 a[242:243], v60 offset:59392
    v_mfma_f32_16x16x32_bf16 v[104:107], a[212:215], a[28:31], v[104:107]
    s_waitcnt lgkmcnt(9)
    ds_read_b64_tr_b16 a[244:245], v60 offset:61440
    v_mfma_f32_16x16x32_bf16 v[100:103], a[216:219], a[8:11], v[100:103]
    ds_read_b64_tr_b16 a[246:247], v60 offset:63488
    v_mfma_f32_16x16x32_bf16 v[100:103], a[220:223], a[12:15], v[100:103]
    ds_read_b64_tr_b16 a[248:249], v61 offset:57344
    v_mfma_f32_16x16x32_bf16 v[108:111], a[216:219], a[24:27], v[108:111]
    ds_read_b64_tr_b16 a[250:251], v61 offset:59392
    v_mfma_f32_16x16x32_bf16 v[108:111], a[220:223], a[28:31], v[108:111]
    s_waitcnt lgkmcnt(9)
    ds_read_b64_tr_b16 a[252:253], v61 offset:61440
    v_mfma_f32_16x16x32_bf16 v[96:99], a[224:227], a[32:35], v[96:99]
    ds_read_b64_tr_b16 a[254:255], v61 offset:63488
    v_mfma_f32_16x16x32_bf16 v[96:99], a[228:231], a[36:39], v[96:99]
    ds_read_b64_tr_b16 a[192:193], v58 offset:0
    v_mfma_f32_16x16x32_bf16 v[104:107], a[224:227], a[48:51], v[104:107]
    ds_read_b64_tr_b16 a[194:195], v58 offset:2048
    v_mfma_f32_16x16x32_bf16 v[104:107], a[228:231], a[52:55], v[104:107]
    s_waitcnt lgkmcnt(9)
    ds_read_b64_tr_b16 a[196:197], v58 offset:4096
    v_mfma_f32_16x16x32_bf16 v[100:103], a[232:235], a[32:35], v[100:103]
    ds_read_b64_tr_b16 a[198:199], v58 offset:6144
    v_mfma_f32_16x16x32_bf16 v[100:103], a[236:239], a[36:39], v[100:103]
    ds_read_b64_tr_b16 a[200:201], v59 offset:0
    v_mfma_f32_16x16x32_bf16 v[108:111], a[232:235], a[48:51], v[108:111]
    ds_read_b64_tr_b16 a[202:203], v59 offset:2048
    v_mfma_f32_16x16x32_bf16 v[108:111], a[236:239], a[52:55], v[108:111]
    s_waitcnt lgkmcnt(9)
    ds_read_b64_tr_b16 a[204:205], v59 offset:4096
    v_mfma_f32_16x16x32_bf16 v[96:99], a[240:243], a[40:43], v[96:99]
    ds_read_b64_tr_b16 a[206:207], v59 offset:6144
    v_mfma_f32_16x16x32_bf16 v[96:99], a[244:247], a[44:47], v[96:99]
    ds_read_b64_tr_b16 a[208:209], v58 offset:8192
    v_mfma_f32_16x16x32_bf16 v[104:107], a[240:243], a[56:59], v[104:107]
    ds_read_b64_tr_b16 a[210:211], v58 offset:10240
    v_mfma_f32_16x16x32_bf16 v[104:107], a[244:247], a[60:63], v[104:107]
    s_waitcnt lgkmcnt(9)
    ds_read_b64_tr_b16 a[212:213], v58 offset:12288
    v_mfma_f32_16x16x32_bf16 v[100:103], a[248:251], a[40:43], v[100:103]
    ds_read_b64_tr_b16 a[214:215], v58 offset:14336
    v_mfma_f32_16x16x32_bf16 v[100:103], a[252:255], a[44:47], v[100:103]
    ds_read_b64_tr_b16 a[216:217], v59 offset:8192
    v_mfma_f32_16x16x32_bf16 v[108:111], a[248:251], a[56:59], v[108:111]
    ds_read_b64_tr_b16 a[218:219], v59 offset:10240
    v_mfma_f32_16x16x32_bf16 v[108:111], a[252:255], a[60:63], v[108:111]
    s_waitcnt lgkmcnt(9)
    ds_read_b64_tr_b16 a[220:221], v59 offset:12288
    v_mfma_f32_16x16x32_bf16 v[112:115], a[192:195], a[64:67], 0
    ds_read_b64_tr_b16 a[222:223], v59 offset:14336
    v_mfma_f32_16x16x32_bf16 v[112:115], a[196:199], a[68:71], v[112:115]
    ds_read_b64_tr_b16 a[224:225], v58 offset:16384
    v_mfma_f32_16x16x32_bf16 v[120:123], a[192:195], a[80:83], 0
    ds_read_b64_tr_b16 a[226:227], v58 offset:18432
    v_mfma_f32_16x16x32_bf16 v[120:123], a[196:199], a[84:87], v[120:123]
    s_waitcnt lgkmcnt(9)
    ds_read_b64_tr_b16 a[228:229], v58 offset:20480
    v_mfma_f32_16x16x32_bf16 v[116:119], a[200:203], a[64:67], 0
    ds_read_b64_tr_b16 a[230:231], v58 offset:22528
    v_mfma_f32_16x16x32_bf16 v[116:119], a[204:207], a[68:71], v[116:119]
    ds_read_b64_tr_b16 a[232:233], v59 offset:16384
    v_mfma_f32_16x16x32_bf16 v[124:127], a[200:203], a[80:83], 0
    ds_read_b64_tr_b16 a[234:235], v59 offset:18432
    v_mfma_f32_16x16x32_bf16 v[124:127], a[204:207], a[84:87], v[124:127]
    s_waitcnt lgkmcnt(9)
    ds_read_b64_tr_b16 a[236:237], v59 offset:20480
    v_mfma_f32_16x16x32_bf16 v[112:115], a[208:211], a[72:75], v[112:115]
    ds_read_b64_tr_b16 a[238:239], v59 offset:22528
    v_cvt_pk_bf16_f32 v96, v96, v97
    s_waitcnt vmcnt(2)
    v_cmp_ne_u32 vcc, 0, v3
    s_cmp_eq_u64 vcc, -1
    s_cbranch_scc0 L_C2_slow_13
L_C2_ok_14:
    v_mfma_f32_16x16x32_bf16 v[112:115], a[212:215], a[76:79], v[112:115]
    s_xor_b32 s74, s24, 8192
    ds_read_b64_tr_b16 a[240:241], v58 offset:24576
    v_cvt_pk_bf16_f32 v97, v98, v99
    v_mfma_f32_16x16x32_bf16 v[120:123], a[208:211], a[88:91], v[120:123]
    buffer_load_dwordx4 v[160:163], v1, s[8:11], s74 offen offset:0
    v_mfma_f32_16x16x32_bf16 v[120:123], a[212:215], a[92:95], v[120:123]
    s_waitcnt lgkmcnt(8)
    s_xor_b32 s74, s24, 12288
    ds_read_b64_tr_b16 a[242:243], v58 offset:26624
    v_cvt_pk_bf16_f32 v98, v100, v101
    v_mfma_f32_16x16x32_bf16 v[116:119], a[216:219], a[72:75], v[116:119]
    ds_read_b64_tr_b16 a[244:245], v58 offset:28672
    v_cvt_pk_bf16_f32 v99, v102, v103
    v_mfma_f32_16x16x32_bf16 v[116:119], a[220:223], a[76:79], v[116:119]
    ds_read_b64_tr_b16 a[246:247], v58 offset:30720
    v_min_u32 v96, -2, v96
    v_mfma_f32_16x16x32_bf16 v[124:127], a[216:219], a[88:91], v[124:127]
    buffer_load_dwordx4 v[176:179], v1, s[8:11], s74 offen offset:0
    ds_read_b64_tr_b16 a[248:249], v59 offset:24576
    v_mfma_f32_16x16x32_bf16 v[124:127], a[220:223], a[92:95], v[124:127]
    s_waitcnt lgkmcnt(8)
    s_xor_b32 s74, s24, 8192
    ds_read_b64_tr_b16 a[250:251], v59 offset:26624
    v_min_u32 v97, -2, v97
    v_mfma_f32_16x16x32_bf16 v[112:115], a[224:227], a[96:99], v[112:115]
    ds_read_b64_tr_b16 a[252:253], v59 offset:28672
    v_min_u32 v98, -2, v98
    v_mfma_f32_16x16x32_bf16 v[112:115], a[228:231], a[100:103], v[112:115]
    ds_read_b64_tr_b16 a[254:255], v59 offset:30720
    v_min_u32 v99, -2, v99
    v_mfma_f32_16x16x32_bf16 v[120:123], a[224:227], a[112:115], v[120:123]
    buffer_load_dwordx4 v[164:167], v1, s[8:11], s74 offen offset:1024
    v_mfma_f32_16x16x32_bf16 v[120:123], a[228:231], a[116:119], v[120:123]
    s_waitcnt lgkmcnt(7)
    s_xor_b32 s74, s24, 12288
    ds_read_b64_tr_b16 a[192:193], v62 offset:32768
    v_mfma_f32_16x16x32_bf16 v[116:119], a[232:235], a[96:99], v[116:119]
    s_add_u32 s75, s18, 0
    ds_read_b64_tr_b16 a[194:195], v62 offset:34816
    v_mfma_f32_16x16x32_bf16 v[116:119], a[236:239], a[100:103], v[116:119]
    buffer_store_dwordx4 v[96:99], v23, s[8:11], s75 offen offset:512 sc0 sc1
    ds_read_b64_tr_b16 a[196:197], v62 offset:36864
    v_mfma_f32_16x16x32_bf16 v[124:127], a[232:235], a[112:115], v[124:127]
    buffer_load_dwordx4 v[180:183], v1, s[8:11], s74 offen offset:1024
    ds_read_b64_tr_b16 a[198:199], v62 offset:38912
    v_mfma_f32_16x16x32_bf16 v[124:127], a[236:239], a[116:119], v[124:127]
    s_waitcnt lgkmcnt(8)
    s_xor_b32 s74, s24, 8192
    ds_read_b64_tr_b16 a[200:201], v63 offset:32768
    v_cvt_pk_bf16_f32 v104, v104, v105
    v_mfma_f32_16x16x32_bf16 v[112:115], a[240:243], a[104:107], v[112:115]
    ds_read_b64_tr_b16 a[202:203], v63 offset:34816
    v_cvt_pk_bf16_f32 v105, v106, v107
    v_mfma_f32_16x16x32_bf16 v[112:115], a[244:247], a[108:111], v[112:115]
    ds_read_b64_tr_b16 a[204:205], v63 offset:36864
    v_cvt_pk_bf16_f32 v106, v108, v109
    v_mfma_f32_16x16x32_bf16 v[120:123], a[240:243], a[120:123], v[120:123]
    buffer_load_dwordx4 v[168:171], v1, s[8:11], s74 offen offset:2048
    ds_read_b64_tr_b16 a[206:207], v63 offset:38912
    v_mfma_f32_16x16x32_bf16 v[120:123], a[244:247], a[124:127], v[120:123]
    s_waitcnt lgkmcnt(8)
    s_xor_b32 s74, s24, 12288
    ds_read_b64_tr_b16 a[208:209], v62 offset:40960
    v_cvt_pk_bf16_f32 v107, v110, v111
    v_mfma_f32_16x16x32_bf16 v[116:119], a[248:251], a[104:107], v[116:119]
    ds_read_b64_tr_b16 a[210:211], v62 offset:43008
    v_min_u32 v104, -2, v104
    v_mfma_f32_16x16x32_bf16 v[116:119], a[252:255], a[108:111], v[116:119]
    ds_read_b64_tr_b16 a[212:213], v62 offset:45056
    v_min_u32 v105, -2, v105
    v_mfma_f32_16x16x32_bf16 v[124:127], a[248:251], a[120:123], v[124:127]
    buffer_load_dwordx4 v[184:187], v1, s[8:11], s74 offen offset:2048
    ds_read_b64_tr_b16 a[214:215], v62 offset:47104
    v_mfma_f32_16x16x32_bf16 v[124:127], a[252:255], a[124:127], v[124:127]
    s_waitcnt lgkmcnt(9)
    s_xor_b32 s74, s24, 8192
    ds_read_b64_tr_b16 a[216:217], v63 offset:40960
    v_min_u32 v106, -2, v106
    v_mfma_f32_16x16x32_bf16 v[112:115], a[192:195], a[0:3], v[112:115]
    s_waitcnt lgkmcnt(9)
    ds_read_b64_tr_b16 a[218:219], v63 offset:43008
    v_min_u32 v107, -2, v107
    v_mfma_f32_16x16x32_bf16 v[112:115], a[196:199], a[4:7], v[112:115]
    s_add_u32 s75, s18, 131072
    ds_read_b64_tr_b16 a[220:221], v63 offset:45056
    v_mfma_f32_16x16x32_bf16 v[120:123], a[192:195], a[16:19], v[120:123]
    buffer_load_dwordx4 v[172:175], v1, s[8:11], s74 offen offset:3072
    ds_read_b64_tr_b16 a[222:223], v63 offset:47104
    v_mfma_f32_16x16x32_bf16 v[120:123], a[196:199], a[20:23], v[120:123]
    s_waitcnt lgkmcnt(8)
    s_xor_b32 s74, s24, 12288
    ds_read_b64_tr_b16 a[224:225], v62 offset:49152
    v_mfma_f32_16x16x32_bf16 v[116:119], a[200:203], a[0:3], v[116:119]
    buffer_store_dwordx4 v[104:107], v23, s[8:11], s75 offen offset:512 sc0 sc1
    ds_read_b64_tr_b16 a[226:227], v62 offset:51200
    v_mfma_f32_16x16x32_bf16 v[116:119], a[204:207], a[4:7], v[116:119]
    ds_read_b64_tr_b16 a[228:229], v62 offset:53248
    v_mfma_f32_16x16x32_bf16 v[124:127], a[200:203], a[16:19], v[124:127]
    buffer_load_dwordx4 v[188:191], v1, s[8:11], s74 offen offset:3072
    ds_read_b64_tr_b16 a[230:231], v62 offset:55296
    v_mfma_f32_16x16x32_bf16 v[124:127], a[204:207], a[20:23], v[124:127]
    s_waitcnt lgkmcnt(9)
    ds_read_b64_tr_b16 a[232:233], v63 offset:49152
    v_mfma_f32_16x16x32_bf16 v[112:115], a[208:211], a[8:11], v[112:115]
    s_waitcnt lgkmcnt(9)
    ds_read_b64_tr_b16 a[234:235], v63 offset:51200
    v_mfma_f32_16x16x32_bf16 v[112:115], a[212:215], a[12:15], v[112:115]
    ds_read_b64_tr_b16 a[236:237], v63 offset:53248
    v_mfma_f32_16x16x32_bf16 v[120:123], a[208:211], a[24:27], v[120:123]
    ds_read_b64_tr_b16 a[238:239], v63 offset:55296
    v_mfma_f32_16x16x32_bf16 v[120:123], a[212:215], a[28:31], v[120:123]
    s_waitcnt lgkmcnt(9)
    ds_read_b64_tr_b16 a[240:241], v62 offset:57344
    v_mfma_f32_16x16x32_bf16 v[116:119], a[216:219], a[8:11], v[116:119]
    s_waitcnt lgkmcnt(9)
    ds_read_b64_tr_b16 a[242:243], v62 offset:59392
    v_mfma_f32_16x16x32_bf16 v[116:119], a[220:223], a[12:15], v[116:119]
    ds_read_b64_tr_b16 a[244:245], v62 offset:61440
    v_mfma_f32_16x16x32_bf16 v[124:127], a[216:219], a[24:27], v[124:127]
    ds_read_b64_tr_b16 a[246:247], v62 offset:63488
    v_mfma_f32_16x16x32_bf16 v[124:127], a[220:223], a[28:31], v[124:127]
    s_waitcnt lgkmcnt(9)
    ds_read_b64_tr_b16 a[248:249], v63 offset:57344
    v_mfma_f32_16x16x32_bf16 v[112:115], a[224:227], a[32:35], v[112:115]
    s_waitcnt lgkmcnt(9)
    ds_read_b64_tr_b16 a[250:251], v63 offset:59392
    ds_read_b64_tr_b16 a[208:209], v56 offset:40960
    v_mfma_f32_16x16x32_bf16 v[112:115], a[228:231], a[36:39], v[112:115]
    ds_read_b64_tr_b16 a[252:253], v63 offset:61440
    ds_read_b64_tr_b16 a[210:211], v56 offset:43008
    v_mfma_f32_16x16x32_bf16 v[120:123], a[224:227], a[48:51], v[120:123]
    ds_read_b64_tr_b16 a[254:255], v63 offset:63488
    ds_read_b64_tr_b16 a[212:213], v56 offset:45056
    v_mfma_f32_16x16x32_bf16 v[120:123], a[228:231], a[52:55], v[120:123]
    s_waitcnt lgkmcnt(12)
    ds_read_b64_tr_b16 a[192:193], v56 offset:32768
    ds_read_b64_tr_b16 a[214:215], v56 offset:47104
    v_mfma_f32_16x16x32_bf16 v[116:119], a[232:235], a[32:35], v[116:119]
    s_waitcnt lgkmcnt(13)
    ds_read_b64_tr_b16 a[194:195], v56 offset:34816
    ds_read_b64_tr_b16 a[216:217], v57 offset:40960
    v_mfma_f32_16x16x32_bf16 v[116:119], a[236:239], a[36:39], v[116:119]
    ds_read_b64_tr_b16 a[196:197], v56 offset:36864
    ds_read_b64_tr_b16 a[218:219], v57 offset:43008
    v_mfma_f32_16x16x32_bf16 v[124:127], a[232:235], a[48:51], v[124:127]
    ds_read_b64_tr_b16 a[198:199], v56 offset:38912
    ds_read_b64_tr_b16 a[220:221], v57 offset:45056
    v_mfma_f32_16x16x32_bf16 v[124:127], a[236:239], a[52:55], v[124:127]
    s_waitcnt lgkmcnt(15)
    ds_read_b64_tr_b16 a[200:201], v57 offset:32768
    ds_read_b64_tr_b16 a[222:223], v57 offset:47104
    v_mfma_f32_16x16x32_bf16 v[112:115], a[240:243], a[40:43], v[112:115]
    ds_read_b64_tr_b16 a[202:203], v57 offset:34816
    v_mfma_f32_16x16x32_bf16 v[112:115], a[244:247], a[44:47], v[112:115]
    ds_read_b64_tr_b16 a[204:205], v57 offset:36864
    v_mfma_f32_16x16x32_bf16 v[120:123], a[240:243], a[56:59], v[120:123]
    s_waitcnt lgkmcnt(15)
    s_xor_b32 s74, s24, 16384
    ds_read_b64_tr_b16 a[206:207], v57 offset:38912
    v_mfma_f32_16x16x32_bf16 v[120:123], a[244:247], a[60:63], v[120:123]
    buffer_load_dwordx4 v[192:195], v1, s[8:11], s74 offen offset:0
    v_mfma_f32_16x16x32_bf16 v[116:119], a[248:251], a[40:43], v[116:119]
    s_waitcnt lgkmcnt(13)
    s_xor_b32 s74, s24, 20480
    ds_read_b64_tr_b16 a[224:225], v56 offset:49152
    v_mfma_f32_16x16x32_bf16 v[116:119], a[252:255], a[44:47], v[116:119]
    ds_read_b64_tr_b16 a[226:227], v56 offset:51200
    v_mfma_f32_16x16x32_bf16 v[124:127], a[248:251], a[56:59], v[124:127]
    ds_read_b64_tr_b16 a[228:229], v56 offset:53248
    v_mfma_f32_16x16x32_bf16 v[124:127], a[252:255], a[60:63], v[124:127]
    s_waitcnt lgkmcnt(9)
    ds_read_b64_tr_b16 a[230:231], v56 offset:55296
    v_mfma_f32_16x16x32_bf16 v[64:67], a[192:195], v[128:131], 0
    buffer_load_dwordx4 v[208:211], v1, s[8:11], s74 offen offset:0
    v_mfma_f32_16x16x32_bf16 v[64:67], a[196:199], v[132:135], v[64:67]
    s_xor_b32 s74, s24, 16384
    ds_read_b64_tr_b16 a[232:233], v57 offset:49152
    v_mfma_f32_16x16x32_bf16 v[72:75], a[192:195], v[144:147], 0
    ds_read_b64_tr_b16 a[234:235], v57 offset:51200
    v_mfma_f32_16x16x32_bf16 v[72:75], a[196:199], v[148:151], v[72:75]
    s_waitcnt lgkmcnt(7)
    ds_read_b64_tr_b16 a[236:237], v57 offset:53248
    v_mfma_f32_16x16x32_bf16 v[68:71], a[200:203], v[128:131], 0
    s_waitcnt lgkmcnt(7)
    ds_read_b64_tr_b16 a[238:239], v57 offset:55296
    v_mfma_f32_16x16x32_bf16 v[68:71], a[204:207], v[132:135], v[68:71]
    buffer_load_dwordx4 v[196:199], v1, s[8:11], s74 offen offset:1024
    v_mfma_f32_16x16x32_bf16 v[76:79], a[200:203], v[144:147], 0
    s_xor_b32 s74, s24, 20480
    ds_read_b64_tr_b16 a[240:241], v56 offset:57344
    v_cvt_pk_bf16_f32 v112, v112, v113
    v_mfma_f32_16x16x32_bf16 v[76:79], a[204:207], v[148:151], v[76:79]
    ds_read_b64_tr_b16 a[242:243], v56 offset:59392
    v_cvt_pk_bf16_f32 v113, v114, v115
    v_mfma_f32_16x16x32_bf16 v[64:67], a[208:211], v[136:139], v[64:67]
    ds_read_b64_tr_b16 a[244:245], v56 offset:61440
    v_cvt_pk_bf16_f32 v114, v116, v117
    v_mfma_f32_16x16x32_bf16 v[64:67], a[212:215], v[140:143], v[64:67]
    ds_read_b64_tr_b16 a[246:247], v56 offset:63488
    v_cvt_pk_bf16_f32 v115, v118, v119
    v_mfma_f32_16x16x32_bf16 v[72:75], a[208:211], v[152:155], v[72:75]
    buffer_load_dwordx4 v[212:215], v1, s[8:11], s74 offen offset:1024
    v_mfma_f32_16x16x32_bf16 v[72:75], a[212:215], v[156:159], v[72:75]
    s_xor_b32 s74, s24, 16384
    ds_read_b64_tr_b16 a[248:249], v57 offset:57344
    v_min_u32 v112, -2, v112
    v_mfma_f32_16x16x32_bf16 v[68:71], a[216:219], v[136:139], v[68:71]
    ds_read_b64_tr_b16 a[250:251], v57 offset:59392
    v_min_u32 v113, -2, v113
    v_mfma_f32_16x16x32_bf16 v[68:71], a[220:223], v[140:143], v[68:71]
    ds_read_b64_tr_b16 a[252:253], v57 offset:61440
    v_min_u32 v114, -2, v114
    v_mfma_f32_16x16x32_bf16 v[76:79], a[216:219], v[152:155], v[76:79]
    s_waitcnt vmcnt(13) lgkmcnt(7)
    ds_read_b64_tr_b16 a[254:255], v57 offset:63488
    v_min_u32 v115, -2, v115
    v_mfma_f32_16x16x32_bf16 v[76:79], a[220:223], v[156:159], v[76:79]
    buffer_load_dwordx4 v[200:203], v1, s[8:11], s74 offen offset:2048
    v_mfma_f32_16x16x32_bf16 v[64:67], a[224:227], v[160:163], v[64:67]
    s_waitcnt vmcnt(12)
    s_xor_b32 s74, s24, 20480
    ds_read_b64_tr_b16 a[192:193], v58 offset:32768
    v_mfma_f32_16x16x32_bf16 v[64:67], a[228:231], v[164:167], v[64:67]
    s_waitcnt vmcnt(10)
    s_add_u32 s75, s18, 0
    ds_read_b64_tr_b16 a[194:195], v58 offset:34816
    v_mfma_f32_16x16x32_bf16 v[72:75], a[224:227], v[176:179], v[72:75]
    buffer_store_dwordx4 v[112:115], v23, s[8:11], s75 offen offset:768 sc0 sc1
    v_mfma_f32_16x16x32_bf16 v[72:75], a[228:231], v[180:183], v[72:75]
    ds_read_b64_tr_b16 a[196:197], v58 offset:36864
    v_cvt_pk_bf16_f32 v120, v120, v121
    v_mfma_f32_16x16x32_bf16 v[68:71], a[232:235], v[160:163], v[68:71]
    buffer_load_dwordx4 v[216:219], v1, s[8:11], s74 offen offset:2048
    ds_read_b64_tr_b16 a[198:199], v58 offset:38912
    v_mfma_f32_16x16x32_bf16 v[68:71], a[236:239], v[164:167], v[68:71]
    s_xor_b32 s74, s24, 16384
    ds_read_b64_tr_b16 a[200:201], v59 offset:32768
    v_cvt_pk_bf16_f32 v121, v122, v123
    v_mfma_f32_16x16x32_bf16 v[76:79], a[232:235], v[176:179], v[76:79]
    ds_read_b64_tr_b16 a[202:203], v59 offset:34816
    v_cvt_pk_bf16_f32 v122, v124, v125
    v_mfma_f32_16x16x32_bf16 v[76:79], a[236:239], v[180:183], v[76:79]
    s_waitcnt vmcnt(11) lgkmcnt(7)
    ds_read_b64_tr_b16 a[204:205], v59 offset:36864
    v_cvt_pk_bf16_f32 v123, v126, v127
    v_mfma_f32_16x16x32_bf16 v[64:67], a[240:243], v[168:171], v[64:67]
    s_waitcnt vmcnt(9)
    ds_read_b64_tr_b16 a[206:207], v59 offset:38912
    v_min_u32 v120, -2, v120
    v_mfma_f32_16x16x32_bf16 v[64:67], a[244:247], v[172:175], v[64:67]
    buffer_load_dwordx4 v[204:207], v1, s[8:11], s74 offen offset:3072
    v_mfma_f32_16x16x32_bf16 v[72:75], a[240:243], v[184:187], v[72:75]
    s_waitcnt vmcnt(8)
    s_xor_b32 s74, s24, 20480
    ds_read_b64_tr_b16 a[208:209], v58 offset:40960
    v_min_u32 v121, -2, v121
    v_mfma_f32_16x16x32_bf16 v[72:75], a[244:247], v[188:191], v[72:75]
    ds_read_b64_tr_b16 a[210:211], v58 offset:43008
    v_min_u32 v122, -2, v122
    v_mfma_f32_16x16x32_bf16 v[68:71], a[248:251], v[168:171], v[68:71]
    s_waitcnt lgkmcnt(8)
    ds_read_b64_tr_b16 a[212:213], v58 offset:45056
    v_min_u32 v123, -2, v123
    v_mfma_f32_16x16x32_bf16 v[68:71], a[252:255], v[172:175], v[68:71]
    s_add_u32 s75, s18, 131072
    ds_read_b64_tr_b16 a[214:215], v58 offset:47104
    v_mfma_f32_16x16x32_bf16 v[76:79], a[248:251], v[184:187], v[76:79]
    buffer_load_dwordx4 v[220:223], v1, s[8:11], s74 offen offset:3072
    ds_read_b64_tr_b16 a[216:217], v59 offset:40960
    v_mfma_f32_16x16x32_bf16 v[76:79], a[252:255], v[188:191], v[76:79]
    s_waitcnt lgkmcnt(8)
    s_xor_b32 s74, s24, 24576
    ds_read_b64_tr_b16 a[218:219], v59 offset:43008
    v_mfma_f32_16x16x32_bf16 v[80:83], a[192:195], v[128:131], 0
    buffer_store_dwordx4 v[120:123], v23, s[8:11], s75 offen offset:768 sc0 sc1
    ds_read_b64_tr_b16 a[220:221], v59 offset:45056
    v_mfma_f32_16x16x32_bf16 v[80:83], a[196:199], v[132:135], v[80:83]
    ds_read_b64_tr_b16 a[222:223], v59 offset:47104
    v_mfma_f32_16x16x32_bf16 v[88:91], a[192:195], v[144:147], 0
    s_waitcnt lgkmcnt(8)
    ds_read_b64_tr_b16 a[224:225], v58 offset:49152
    v_mfma_f32_16x16x32_bf16 v[88:91], a[196:199], v[148:151], v[88:91]
    buffer_load_dwordx4 v[224:227], v1, s[8:11], s74 offen offset:0
    ds_read_b64_tr_b16 a[226:227], v58 offset:51200
    v_mfma_f32_16x16x32_bf16 v[84:87], a[200:203], v[128:131], 0
    s_xor_b32 s74, s24, 28672
    ds_read_b64_tr_b16 a[228:229], v58 offset:53248
    v_mfma_f32_16x16x32_bf16 v[84:87], a[204:207], v[132:135], v[84:87]
    ds_read_b64_tr_b16 a[230:231], v58 offset:55296
    v_mfma_f32_16x16x32_bf16 v[92:95], a[200:203], v[144:147], 0
    ds_read_b64_tr_b16 a[232:233], v59 offset:49152
    v_mfma_f32_16x16x32_bf16 v[92:95], a[204:207], v[148:151], v[92:95]
    s_waitcnt lgkmcnt(9)
    ds_read_b64_tr_b16 a[234:235], v59 offset:51200
    v_mfma_f32_16x16x32_bf16 v[80:83], a[208:211], v[136:139], v[80:83]
    buffer_load_dwordx4 v[240:243], v1, s[8:11], s74 offen offset:0
    ds_read_b64_tr_b16 a[236:237], v59 offset:53248
    v_mfma_f32_16x16x32_bf16 v[80:83], a[212:215], v[140:143], v[80:83]
    s_xor_b32 s74, s24, 24576
    ds_read_b64_tr_b16 a[238:239], v59 offset:55296
    v_mfma_f32_16x16x32_bf16 v[88:91], a[208:211], v[152:155], v[88:91]
    ds_read_b64_tr_b16 a[240:241], v58 offset:57344
    v_mfma_f32_16x16x32_bf16 v[88:91], a[212:215], v[156:159], v[88:91]
    s_waitcnt lgkmcnt(9)
    ds_read_b64_tr_b16 a[242:243], v58 offset:59392
    v_mfma_f32_16x16x32_bf16 v[84:87], a[216:219], v[136:139], v[84:87]
    ds_read_b64_tr_b16 a[244:245], v58 offset:61440
    v_mfma_f32_16x16x32_bf16 v[84:87], a[220:223], v[140:143], v[84:87]
    buffer_load_dwordx4 v[228:231], v1, s[8:11], s74 offen offset:1024
    ds_read_b64_tr_b16 a[246:247], v58 offset:63488
    v_mfma_f32_16x16x32_bf16 v[92:95], a[216:219], v[152:155], v[92:95]
    s_xor_b32 s74, s24, 28672
    ds_read_b64_tr_b16 a[248:249], v59 offset:57344
    v_mfma_f32_16x16x32_bf16 v[92:95], a[220:223], v[156:159], v[92:95]
    s_waitcnt lgkmcnt(9)
    ds_read_b64_tr_b16 a[250:251], v59 offset:59392
    v_mfma_f32_16x16x32_bf16 v[80:83], a[224:227], v[160:163], v[80:83]
    ds_read_b64_tr_b16 a[252:253], v59 offset:61440
    v_mfma_f32_16x16x32_bf16 v[80:83], a[228:231], v[164:167], v[80:83]
    ds_read_b64_tr_b16 a[254:255], v59 offset:63488
    v_mfma_f32_16x16x32_bf16 v[88:91], a[224:227], v[176:179], v[88:91]
    buffer_load_dwordx4 v[244:247], v1, s[8:11], s74 offen offset:1024
    v_mfma_f32_16x16x32_bf16 v[88:91], a[228:231], v[180:183], v[88:91]
    s_waitcnt lgkmcnt(8)
    s_xor_b32 s74, s24, 24576
    ds_read_b64_tr_b16 a[192:193], v56 offset:0
    v_mfma_f32_16x16x32_bf16 v[84:87], a[232:235], v[160:163], v[84:87]
    ds_read_b64_tr_b16 a[194:195], v56 offset:2048
    v_mfma_f32_16x16x32_bf16 v[84:87], a[236:239], v[164:167], v[84:87]
    ds_read_b64_tr_b16 a[196:197], v56 offset:4096
    v_mfma_f32_16x16x32_bf16 v[92:95], a[232:235], v[176:179], v[92:95]
    s_waitcnt lgkmcnt(8)
    ds_read_b64_tr_b16 a[198:199], v56 offset:6144
    v_mfma_f32_16x16x32_bf16 v[92:95], a[236:239], v[180:183], v[92:95]
    buffer_load_dwordx4 v[232:235], v1, s[8:11], s74 offen offset:2048
    ds_read_b64_tr_b16 a[200:201], v57 offset:0
    v_mfma_f32_16x16x32_bf16 v[80:83], a[240:243], v[168:171], v[80:83]
    s_waitcnt lgkmcnt(8)
    s_xor_b32 s74, s24, 28672
    ds_read_b64_tr_b16 a[202:203], v57 offset:2048
    v_mfma_f32_16x16x32_bf16 v[80:83], a[244:247], v[172:175], v[80:83]
    ds_read_b64_tr_b16 a[204:205], v57 offset:4096
    v_mfma_f32_16x16x32_bf16 v[88:91], a[240:243], v[184:187], v[88:91]
    ds_read_b64_tr_b16 a[206:207], v57 offset:6144
    v_mfma_f32_16x16x32_bf16 v[88:91], a[244:247], v[188:191], v[88:91]
    s_waitcnt lgkmcnt(8)
    ds_read_b64_tr_b16 a[208:209], v56 offset:8192
    v_mfma_f32_16x16x32_bf16 v[84:87], a[248:251], v[168:171], v[84:87]
    buffer_load_dwordx4 v[248:251], v1, s[8:11], s74 offen offset:2048
    ds_read_b64_tr_b16 a[210:211], v56 offset:10240
    v_mfma_f32_16x16x32_bf16 v[84:87], a[252:255], v[172:175], v[84:87]
    s_xor_b32 s74, s24, 24576
    ds_read_b64_tr_b16 a[212:213], v56 offset:12288
    v_mfma_f32_16x16x32_bf16 v[92:95], a[248:251], v[184:187], v[92:95]
    ds_read_b64_tr_b16 a[214:215], v56 offset:14336
    v_mfma_f32_16x16x32_bf16 v[92:95], a[252:255], v[188:191], v[92:95]
    s_waitcnt lgkmcnt(9)
    ds_read_b64_tr_b16 a[216:217], v57 offset:8192
    v_mfma_f32_16x16x32_bf16 v[96:99], a[192:195], v[128:131], 0
    s_waitcnt lgkmcnt(9)
    ds_read_b64_tr_b16 a[218:219], v57 offset:10240
    v_mfma_f32_16x16x32_bf16 v[96:99], a[196:199], v[132:135], v[96:99]
    buffer_load_dwordx4 v[236:239], v1, s[8:11], s74 offen offset:3072
    ds_read_b64_tr_b16 a[220:221], v57 offset:12288
    v_mfma_f32_16x16x32_bf16 v[104:107], a[192:195], v[144:147], 0
    s_xor_b32 s74, s24, 28672
    ds_read_b64_tr_b16 a[222:223], v57 offset:14336
    v_mfma_f32_16x16x32_bf16 v[104:107], a[196:199], v[148:151], v[104:107]
    s_waitcnt lgkmcnt(9)
    ds_read_b64_tr_b16 a[224:225], v56 offset:16384
    v_mfma_f32_16x16x32_bf16 v[100:103], a[200:203], v[128:131], 0
    s_waitcnt lgkmcnt(9)
    ds_read_b64_tr_b16 a[226:227], v56 offset:18432
    v_mfma_f32_16x16x32_bf16 v[100:103], a[204:207], v[132:135], v[100:103]
    ds_read_b64_tr_b16 a[228:229], v56 offset:20480
    v_mfma_f32_16x16x32_bf16 v[108:111], a[200:203], v[144:147], 0
    buffer_load_dwordx4 v[252:255], v1, s[8:11], s74 offen offset:3072
    ds_read_b64_tr_b16 a[230:231], v56 offset:22528
    v_mfma_f32_16x16x32_bf16 v[108:111], a[204:207], v[148:151], v[108:111]
    s_waitcnt lgkmcnt(9)
    ds_read_b64_tr_b16 a[232:233], v57 offset:16384
    v_mfma_f32_16x16x32_bf16 v[96:99], a[208:211], v[136:139], v[96:99]
    s_waitcnt lgkmcnt(9)
    ds_read_b64_tr_b16 a[234:235], v57 offset:18432
    v_mfma_f32_16x16x32_bf16 v[96:99], a[212:215], v[140:143], v[96:99]
    ds_read_b64_tr_b16 a[236:237], v57 offset:20480
    v_mfma_f32_16x16x32_bf16 v[104:107], a[208:211], v[152:155], v[104:107]
    ds_read_b64_tr_b16 a[238:239], v57 offset:22528
    v_mfma_f32_16x16x32_bf16 v[104:107], a[212:215], v[156:159], v[104:107]
    s_waitcnt lgkmcnt(9)
    ds_read_b64_tr_b16 a[240:241], v56 offset:24576
    v_mfma_f32_16x16x32_bf16 v[100:103], a[216:219], v[136:139], v[100:103]
    s_waitcnt lgkmcnt(9)
    ds_read_b64_tr_b16 a[242:243], v56 offset:26624
    v_mfma_f32_16x16x32_bf16 v[100:103], a[220:223], v[140:143], v[100:103]
    ds_read_b64_tr_b16 a[244:245], v56 offset:28672
    v_mfma_f32_16x16x32_bf16 v[108:111], a[216:219], v[152:155], v[108:111]
    ds_read_b64_tr_b16 a[246:247], v56 offset:30720
    v_mfma_f32_16x16x32_bf16 v[108:111], a[220:223], v[156:159], v[108:111]
    s_waitcnt lgkmcnt(9)
    ds_read_b64_tr_b16 a[248:249], v57 offset:24576
    v_mfma_f32_16x16x32_bf16 v[96:99], a[224:227], v[160:163], v[96:99]
    s_waitcnt lgkmcnt(9)
    ds_read_b64_tr_b16 a[250:251], v57 offset:26624
    v_mfma_f32_16x16x32_bf16 v[96:99], a[228:231], v[164:167], v[96:99]
    ds_read_b64_tr_b16 a[252:253], v57 offset:28672
    v_mfma_f32_16x16x32_bf16 v[104:107], a[224:227], v[176:179], v[104:107]
    ds_read_b64_tr_b16 a[254:255], v57 offset:30720
    v_mfma_f32_16x16x32_bf16 v[104:107], a[228:231], v[180:183], v[104:107]
    s_waitcnt lgkmcnt(8)
    ds_read_b64_tr_b16 a[192:193], v58 offset:0
    v_mfma_f32_16x16x32_bf16 v[100:103], a[232:235], v[160:163], v[100:103]
    buffer_load_dwordx2 v[32:33], v45, s[32:35], s100 offen
    ds_read_b64_tr_b16 a[194:195], v58 offset:2048
    v_mfma_f32_16x16x32_bf16 v[100:103], a[236:239], v[164:167], v[100:103]
    ds_read_b64_tr_b16 a[196:197], v58 offset:4096
    v_mfma_f32_16x16x32_bf16 v[108:111], a[232:235], v[176:179], v[108:111]
    ds_read_b64_tr_b16 a[198:199], v58 offset:6144
    v_mfma_f32_16x16x32_bf16 v[108:111], a[236:239], v[180:183], v[108:111]
    s_waitcnt lgkmcnt(8)
    ds_read_b64_tr_b16 a[200:201], v59 offset:0
    v_mfma_f32_16x16x32_bf16 v[96:99], a[240:243], v[168:171], v[96:99]
    buffer_load_dwordx2 v[34:35], v45, s[32:35], s100 offen offset:32
    ds_read_b64_tr_b16 a[202:203], v59 offset:2048
    v_mfma_f32_16x16x32_bf16 v[96:99], a[244:247], v[172:175], v[96:99]
    ds_read_b64_tr_b16 a[204:205], v59 offset:4096
    v_mfma_f32_16x16x32_bf16 v[104:107], a[240:243], v[184:187], v[104:107]
    ds_read_b64_tr_b16 a[206:207], v59 offset:6144
    v_mfma_f32_16x16x32_bf16 v[104:107], a[244:247], v[188:191], v[104:107]
    s_waitcnt lgkmcnt(8)
    ds_read_b64_tr_b16 a[208:209], v58 offset:8192
    v_mfma_f32_16x16x32_bf16 v[100:103], a[248:251], v[168:171], v[100:103]
    buffer_load_dwordx2 v[36:37], v45, s[32:35], s101 offen
    ds_read_b64_tr_b16 a[210:211], v58 offset:10240
    v_mfma_f32_16x16x32_bf16 v[100:103], a[252:255], v[172:175], v[100:103]
    ds_read_b64_tr_b16 a[212:213], v58 offset:12288
    v_mfma_f32_16x16x32_bf16 v[108:111], a[248:251], v[184:187], v[108:111]
    ds_read_b64_tr_b16 a[214:215], v58 offset:14336
    v_mfma_f32_16x16x32_bf16 v[108:111], a[252:255], v[188:191], v[108:111]
    s_waitcnt lgkmcnt(8)
    ds_read_b64_tr_b16 a[216:217], v59 offset:8192
    v_mfma_f32_16x16x32_bf16 v[112:115], a[192:195], v[128:131], 0
    buffer_load_dwordx2 v[38:39], v45, s[32:35], s101 offen offset:32
    ds_read_b64_tr_b16 a[218:219], v59 offset:10240
    v_mfma_f32_16x16x32_bf16 v[112:115], a[196:199], v[132:135], v[112:115]
    ds_read_b64_tr_b16 a[220:221], v59 offset:12288
    v_mfma_f32_16x16x32_bf16 v[120:123], a[192:195], v[144:147], 0
    ds_read_b64_tr_b16 a[222:223], v59 offset:14336
    v_mfma_f32_16x16x32_bf16 v[120:123], a[196:199], v[148:151], v[120:123]
    s_waitcnt lgkmcnt(8)
    ds_read_b64_tr_b16 a[224:225], v58 offset:16384
    v_mfma_f32_16x16x32_bf16 v[116:119], a[200:203], v[128:131], 0
    buffer_load_dwordx2 v[40:41], v45, s[56:59], 0 offen
    ds_read_b64_tr_b16 a[226:227], v58 offset:18432
    v_mfma_f32_16x16x32_bf16 v[116:119], a[204:207], v[132:135], v[116:119]
    ds_read_b64_tr_b16 a[228:229], v58 offset:20480
    v_mfma_f32_16x16x32_bf16 v[124:127], a[200:203], v[144:147], 0
    ds_read_b64_tr_b16 a[230:231], v58 offset:22528
    v_mfma_f32_16x16x32_bf16 v[124:127], a[204:207], v[148:151], v[124:127]
    s_waitcnt lgkmcnt(8)
    ds_read_b64_tr_b16 a[232:233], v59 offset:16384
    v_mfma_f32_16x16x32_bf16 v[112:115], a[208:211], v[136:139], v[112:115]
    buffer_load_dwordx2 v[42:43], v45, s[56:59], 0 offen offset:32
    ds_read_b64_tr_b16 a[234:235], v59 offset:18432
    v_mfma_f32_16x16x32_bf16 v[112:115], a[212:215], v[140:143], v[112:115]
    ds_read_b64_tr_b16 a[236:237], v59 offset:20480
    v_mfma_f32_16x16x32_bf16 v[120:123], a[208:211], v[152:155], v[120:123]
    ds_read_b64_tr_b16 a[238:239], v59 offset:22528
    v_mfma_f32_16x16x32_bf16 v[120:123], a[212:215], v[156:159], v[120:123]
    s_waitcnt lgkmcnt(9)
    ds_read_b64_tr_b16 a[240:241], v58 offset:24576
    v_mfma_f32_16x16x32_bf16 v[116:119], a[216:219], v[136:139], v[116:119]
    s_waitcnt lgkmcnt(9)
    ds_read_b64_tr_b16 a[242:243], v58 offset:26624
    v_mfma_f32_16x16x32_bf16 v[116:119], a[220:223], v[140:143], v[116:119]
    ds_read_b64_tr_b16 a[244:245], v58 offset:28672
    v_mfma_f32_16x16x32_bf16 v[124:127], a[216:219], v[152:155], v[124:127]
    ds_read_b64_tr_b16 a[246:247], v58 offset:30720
    v_mfma_f32_16x16x32_bf16 v[124:127], a[220:223], v[156:159], v[124:127]
    s_waitcnt lgkmcnt(9)
    ds_read_b64_tr_b16 a[248:249], v59 offset:24576
    v_mfma_f32_16x16x32_bf16 v[112:115], a[224:227], v[160:163], v[112:115]
    s_waitcnt lgkmcnt(9)
    ds_read_b64_tr_b16 a[250:251], v59 offset:26624
    v_mfma_f32_16x16x32_bf16 v[112:115], a[228:231], v[164:167], v[112:115]
    ds_read_b64_tr_b16 a[252:253], v59 offset:28672
    v_mfma_f32_16x16x32_bf16 v[120:123], a[224:227], v[176:179], v[120:123]
    ds_read_b64_tr_b16 a[254:255], v59 offset:30720
    v_mfma_f32_16x16x32_bf16 v[120:123], a[228:231], v[180:183], v[120:123]
    s_waitcnt lgkmcnt(9)
    ds_read_b64_tr_b16 a[192:193], v60 offset:0
    v_mfma_f32_16x16x32_bf16 v[116:119], a[232:235], v[160:163], v[116:119]
    s_waitcnt lgkmcnt(9)
    ds_read_b64_tr_b16 a[194:195], v60 offset:2048
    v_mfma_f32_16x16x32_bf16 v[116:119], a[236:239], v[164:167], v[116:119]
    ds_read_b64_tr_b16 a[196:197], v60 offset:4096
    v_mfma_f32_16x16x32_bf16 v[124:127], a[232:235], v[176:179], v[124:127]
    ds_read_b64_tr_b16 a[198:199], v60 offset:6144
    v_mfma_f32_16x16x32_bf16 v[124:127], a[236:239], v[180:183], v[124:127]
    s_waitcnt lgkmcnt(9)
    ds_read_b64_tr_b16 a[200:201], v61 offset:0
    v_mfma_f32_16x16x32_bf16 v[112:115], a[240:243], v[168:171], v[112:115]
    s_waitcnt lgkmcnt(9)
    ds_read_b64_tr_b16 a[202:203], v61 offset:2048
    ds_read_b64_tr_b16 a[224:225], v60 offset:16384
    v_mfma_f32_16x16x32_bf16 v[112:115], a[244:247], v[172:175], v[112:115]
    ds_read_b64_tr_b16 a[204:205], v61 offset:4096
    ds_read_b64_tr_b16 a[226:227], v60 offset:18432
    v_mfma_f32_16x16x32_bf16 v[120:123], a[240:243], v[184:187], v[120:123]
    ds_read_b64_tr_b16 a[206:207], v61 offset:6144
    ds_read_b64_tr_b16 a[228:229], v60 offset:20480
    v_mfma_f32_16x16x32_bf16 v[120:123], a[244:247], v[188:191], v[120:123]
    s_waitcnt lgkmcnt(12)
    ds_read_b64_tr_b16 a[208:209], v60 offset:8192
    ds_read_b64_tr_b16 a[230:231], v60 offset:22528
    v_mfma_f32_16x16x32_bf16 v[116:119], a[248:251], v[168:171], v[116:119]
    s_waitcnt lgkmcnt(13)
    ds_read_b64_tr_b16 a[210:211], v60 offset:10240
    ds_read_b64_tr_b16 a[232:233], v61 offset:16384
    v_mfma_f32_16x16x32_bf16 v[116:119], a[252:255], v[172:175], v[116:119]
    ds_read_b64_tr_b16 a[212:213], v60 offset:12288
    ds_read_b64_tr_b16 a[234:235], v61 offset:18432
    v_mfma_f32_16x16x32_bf16 v[124:127], a[248:251], v[184:187], v[124:127]
    ds_read_b64_tr_b16 a[214:215], v60 offset:14336
    ds_read_b64_tr_b16 a[236:237], v61 offset:20480
    v_mfma_f32_16x16x32_bf16 v[124:127], a[252:255], v[188:191], v[124:127]
    s_waitcnt vmcnt(23) lgkmcnt(15)
    ds_read_b64_tr_b16 a[216:217], v61 offset:8192
    ds_read_b64_tr_b16 a[238:239], v61 offset:22528
    v_mfma_f32_16x16x32_bf16 v[64:67], a[192:195], v[192:195], v[64:67]
    s_waitcnt vmcnt(21)
    ds_read_b64_tr_b16 a[218:219], v61 offset:10240
    v_mfma_f32_16x16x32_bf16 v[64:67], a[196:199], v[196:199], v[64:67]
    ds_read_b64_tr_b16 a[220:221], v61 offset:12288
    v_mfma_f32_16x16x32_bf16 v[72:75], a[192:195], v[208:211], v[72:75]
    s_waitcnt vmcnt(20) lgkmcnt(15)
    s_mov_b32 s74, 8192
    ds_read_b64_tr_b16 a[222:223], v61 offset:14336
    v_mfma_f32_16x16x32_bf16 v[72:75], a[196:199], v[212:215], v[72:75]
    buffer_load_dwordx4 v[168:171], v46, s[8:11], s74 offen
    v_mfma_f32_16x16x32_bf16 v[68:71], a[200:203], v[192:195], v[68:71]
    s_waitcnt lgkmcnt(13)
    ds_read_b64_tr_b16 a[240:241], v60 offset:24576
    v_mfma_f32_16x16x32_bf16 v[68:71], a[204:207], v[196:199], v[68:71]
    ds_read_b64_tr_b16 a[242:243], v60 offset:26624
    v_mfma_f32_16x16x32_bf16 v[76:79], a[200:203], v[208:211], v[76:79]
    buffer_load_dwordx4 v[172:175], v46, s[8:11], s74 offen offset:64
    v_mfma_f32_16x16x32_bf16 v[76:79], a[204:207], v[212:215], v[76:79]
    s_waitcnt vmcnt(21) lgkmcnt(9)
    s_mov_b32 s74, 6144
    ds_read_b64_tr_b16 a[244:245], v60 offset:28672
    v_mfma_f32_16x16x32_bf16 v[64:67], a[208:211], v[200:203], v[64:67]
    s_waitcnt vmcnt(18) lgkmcnt(8)
    ds_read_b64_tr_b16 a[246:247], v60 offset:30720
    v_mfma_f32_16x16x32_bf16 v[64:67], a[212:215], v[204:207], v[64:67]
    buffer_load_dwordx4 v[176:179], v46, s[8:11], s74 offen
    v_mfma_f32_16x16x32_bf16 v[72:75], a[208:211], v[216:219], v[72:75]
    s_waitcnt vmcnt(18)
    ds_read_b64_tr_b16 a[248:249], v61 offset:24576
    v_mfma_f32_16x16x32_bf16 v[72:75], a[212:215], v[220:223], v[72:75]
    s_waitcnt lgkmcnt(5)
    ds_read_b64_tr_b16 a[250:251], v61 offset:26624
    v_mfma_f32_16x16x32_bf16 v[68:71], a[216:219], v[200:203], v[68:71]
    buffer_load_dwordx4 v[180:183], v46, s[8:11], s74 offen offset:64
    ds_read_b64_tr_b16 a[252:253], v61 offset:28672
    v_mfma_f32_16x16x32_bf16 v[68:71], a[220:223], v[204:207], v[68:71]
    s_mov_b32 s74, 4096
    ds_read_b64_tr_b16 a[254:255], v61 offset:30720
    v_mfma_f32_16x16x32_bf16 v[76:79], a[216:219], v[216:219], v[76:79]
    s_waitcnt vmcnt(17)
    ds_read_b64_tr_b16 a[192:193], v62 offset:0
    v_mfma_f32_16x16x32_bf16 v[76:79], a[220:223], v[220:223], v[76:79]
    buffer_load_dwordx4 v[160:163], v46, s[8:11], s74 offen
    v_mfma_f32_16x16x32_bf16 v[64:67], a[224:227], v[224:227], v[64:67]
    s_waitcnt vmcnt(16)
    ds_read_b64_tr_b16 a[194:195], v62 offset:2048
    s_waitcnt vmcnt(6)
    v_lshlrev_b32 v48, 16, v40
    v_mfma_f32_16x16x32_bf16 v[64:67], a[228:231], v[228:231], v[64:67]
    ds_read_b64_tr_b16 a[196:197], v62 offset:4096
    v_and_b32 v49, 0xffff0000, v40
    v_mfma_f32_16x16x32_bf16 v[72:75], a[224:227], v[240:243], v[72:75]
    buffer_load_dwordx4 v[164:167], v46, s[8:11], s74 offen offset:64
    v_mfma_f32_16x16x32_bf16 v[72:75], a[228:231], v[244:247], v[72:75]
    s_mov_b32 s74, 10240
    ds_read_b64_tr_b16 a[198:199], v62 offset:6144
    v_lshlrev_b32 v50, 16, v41
    v_mfma_f32_16x16x32_bf16 v[68:71], a[232:235], v[224:227], v[68:71]
    ds_read_b64_tr_b16 a[200:201], v63 offset:0
    v_and_b32 v51, 0xffff0000, v41
    v_mfma_f32_16x16x32_bf16 v[68:71], a[236:239], v[228:231], v[68:71]
    buffer_load_dwordx4 v[184:187], v46, s[8:11], s74 offen
    ds_read_b64_tr_b16 a[202:203], v63 offset:2048
    v_mfma_f32_16x16x32_bf16 v[76:79], a[232:235], v[240:243], v[76:79]
    ds_read_b64_tr_b16 a[204:205], v63 offset:4096
    s_waitcnt vmcnt(7)
    v_lshlrev_b32 v52, 16, v42
    v_mfma_f32_16x16x32_bf16 v[76:79], a[236:239], v[244:247], v[76:79]
    s_waitcnt lgkmcnt(7)
    ds_read_b64_tr_b16 a[206:207], v63 offset:6144
    v_and_b32 v53, 0xffff0000, v42
    v_mfma_f32_16x16x32_bf16 v[64:67], a[240:243], v[232:235], v[64:67]
    buffer_load_dwordx4 v[188:191], v46, s[8:11], s74 offen offset:64
    v_mfma_f32_16x16x32_bf16 v[64:67], a[244:247], v[236:239], v[64:67]
    ds_read_b64_tr_b16 a[208:209], v62 offset:8192
    v_lshlrev_b32 v54, 16, v43
    v_mfma_f32_16x16x32_bf16 v[72:75], a[240:243], v[248:251], v[72:75]
    ds_read_b64_tr_b16 a[210:211], v62 offset:10240
    v_and_b32 v55, 0xffff0000, v43
    v_mfma_f32_16x16x32_bf16 v[72:75], a[244:247], v[252:255], v[72:75]
    ds_read_b64_tr_b16 a[212:213], v62 offset:12288
    v_mfma_f32_16x16x32_bf16 v[68:71], a[248:251], v[232:235], v[68:71]
    ds_read_b64_tr_b16 a[214:215], v62 offset:14336
    v_mfma_f32_16x16x32_bf16 v[68:71], a[252:255], v[236:239], v[68:71]
    ds_read_b64_tr_b16 a[216:217], v63 offset:8192
    v_mfma_f32_16x16x32_bf16 v[76:79], a[248:251], v[248:251], v[76:79]
    ds_read_b64_tr_b16 a[218:219], v63 offset:10240
    v_mfma_f32_16x16x32_bf16 v[76:79], a[252:255], v[252:255], v[76:79]
    s_waitcnt lgkmcnt(8)
    ds_read_b64_tr_b16 a[220:221], v63 offset:12288
    v_mfma_f32_16x16x32_bf16 v[80:83], a[192:195], v[192:195], v[80:83]
    ds_read_b64_tr_b16 a[222:223], v63 offset:14336
    v_mfma_f32_16x16x32_bf16 v[80:83], a[196:199], v[196:199], v[80:83]
    ds_read_b64_tr_b16 a[224:225], v62 offset:16384
    v_mfma_f32_16x16x32_bf16 v[88:91], a[192:195], v[208:211], v[88:91]
    ds_read_b64_tr_b16 a[226:227], v62 offset:18432
    v_mfma_f32_16x16x32_bf16 v[88:91], a[196:199], v[212:215], v[88:91]
    ds_read_b64_tr_b16 a[228:229], v62 offset:20480
    v_mfma_f32_16x16x32_bf16 v[84:87], a[200:203], v[192:195], v[84:87]
    s_waitcnt lgkmcnt(9)
    ds_read_b64_tr_b16 a[230:231], v62 offset:22528
    v_mfma_f32_16x16x32_bf16 v[84:87], a[204:207], v[196:199], v[84:87]
    ds_read_b64_tr_b16 a[232:233], v63 offset:16384
    v_mfma_f32_16x16x32_bf16 v[92:95], a[200:203], v[208:211], v[92:95]
    ds_read_b64_tr_b16 a[234:235], v63 offset:18432
    v_cvt_pk_bf16_f32 v64, v64, v65
    v_mfma_f32_16x16x32_bf16 v[92:95], a[204:207], v[212:215], v[92:95]
    ds_read_b64_tr_b16 a[236:237], v63 offset:20480
    v_cvt_pk_bf16_f32 v65, v66, v67
    v_mfma_f32_16x16x32_bf16 v[80:83], a[208:211], v[200:203], v[80:83]
    s_waitcnt lgkmcnt(9)
    ds_read_b64_tr_b16 a[238:239], v63 offset:22528
    v_cvt_pk_bf16_f32 v66, v68, v69
    v_mfma_f32_16x16x32_bf16 v[80:83], a[212:215], v[204:207], v[80:83]
    ds_read_b64_tr_b16 a[240:241], v62 offset:24576
    v_cvt_pk_bf16_f32 v67, v70, v71
    v_mfma_f32_16x16x32_bf16 v[88:91], a[208:211], v[216:219], v[88:91]
    ds_read_b64_tr_b16 a[242:243], v62 offset:26624
    v_min_u32 v64, -2, v64
    v_mfma_f32_16x16x32_bf16 v[88:91], a[212:215], v[220:223], v[88:91]
    ds_read_b64_tr_b16 a[244:245], v62 offset:28672
    v_min_u32 v65, -2, v65
    v_mfma_f32_16x16x32_bf16 v[84:87], a[216:219], v[200:203], v[84:87]
    s_waitcnt lgkmcnt(9)
    ds_read_b64_tr_b16 a[246:247], v62 offset:30720
    v_min_u32 v66, -2, v66
    v_mfma_f32_16x16x32_bf16 v[84:87], a[220:223], v[204:207], v[84:87]
    ds_read_b64_tr_b16 a[248:249], v63 offset:24576
    v_min_u32 v67, -2, v67
    v_mfma_f32_16x16x32_bf16 v[92:95], a[216:219], v[216:219], v[92:95]
    s_add_u32 s75, s18, 8388608
    ds_read_b64_tr_b16 a[250:251], v63 offset:26624
    v_mfma_f32_16x16x32_bf16 v[92:95], a[220:223], v[220:223], v[92:95]
    buffer_store_dwordx4 v[64:67], v23, s[8:11], s75 offen offset:0 sc0 sc1
    ds_read_b64_tr_b16 a[252:253], v63 offset:28672
    v_mfma_f32_16x16x32_bf16 v[80:83], a[224:227], v[224:227], v[80:83]
    s_waitcnt lgkmcnt(9)
    ds_read_b64_tr_b16 a[254:255], v63 offset:30720
    v_cvt_pk_bf16_f32 v72, v72, v73
    v_mfma_f32_16x16x32_bf16 v[80:83], a[228:231], v[228:231], v[80:83]
    ds_read_b64_tr_b16 a[192:193], v60 offset:32768
    v_cvt_pk_bf16_f32 v73, v74, v75
    v_mfma_f32_16x16x32_bf16 v[88:91], a[224:227], v[240:243], v[88:91]
    ds_read_b64_tr_b16 a[194:195], v60 offset:34816
    v_cvt_pk_bf16_f32 v74, v76, v77
    v_mfma_f32_16x16x32_bf16 v[88:91], a[228:231], v[244:247], v[88:91]
    ds_read_b64_tr_b16 a[196:197], v60 offset:36864
    v_cvt_pk_bf16_f32 v75, v78, v79
    v_mfma_f32_16x16x32_bf16 v[84:87], a[232:235], v[224:227], v[84:87]
    s_waitcnt lgkmcnt(9)
    ds_read_b64_tr_b16 a[198:199], v60 offset:38912
    v_min_u32 v72, -2, v72
    v_mfma_f32_16x16x32_bf16 v[84:87], a[236:239], v[228:231], v[84:87]
    ds_read_b64_tr_b16 a[200:201], v61 offset:32768
    v_min_u32 v73, -2, v73
    v_mfma_f32_16x16x32_bf16 v[92:95], a[232:235], v[240:243], v[92:95]
    ds_read_b64_tr_b16 a[202:203], v61 offset:34816
    v_min_u32 v74, -2, v74
    v_mfma_f32_16x16x32_bf16 v[92:95], a[236:239], v[244:247], v[92:95]
    ds_read_b64_tr_b16 a[204:205], v61 offset:36864
    v_min_u32 v75, -2, v75
    v_mfma_f32_16x16x32_bf16 v[80:83], a[240:243], v[232:235], v[80:83]
    s_waitcnt lgkmcnt(9)
    s_add_u32 s75, s18, 8519680
    ds_read_b64_tr_b16 a[206:207], v61 offset:38912
    s_waitcnt vmcnt(8)
    v_mul_f32 v8, v48, v168
    v_mfma_f32_16x16x32_bf16 v[80:83], a[244:247], v[236:239], v[80:83]
    buffer_store_dwordx4 v[72:75], v23, s[8:11], s75 offen offset:0 sc0 sc1
    v_mfma_f32_16x16x32_bf16 v[88:91], a[240:243], v[248:251], v[88:91]
    ds_read_b64_tr_b16 a[208:209], v60 offset:40960
    v_mul_f32 v9, v49, v169
    v_mfma_f32_16x16x32_bf16 v[88:91], a[244:247], v[252:255], v[88:91]
    ds_read_b64_tr_b16 a[210:211], v60 offset:43008
    v_mul_f32 v10, v50, v170
    v_mfma_f32_16x16x32_bf16 v[84:87], a[248:251], v[232:235], v[84:87]
    s_waitcnt lgkmcnt(8)
    ds_read_b64_tr_b16 a[212:213], v60 offset:45056
    v_mul_f32 v11, v51, v171
    v_mfma_f32_16x16x32_bf16 v[84:87], a[252:255], v[236:239], v[84:87]
    ds_read_b64_tr_b16 a[214:215], v60 offset:47104
    s_waitcnt vmcnt(8)
    v_mul_f32 v12, v52, v172
    v_mfma_f32_16x16x32_bf16 v[92:95], a[248:251], v[248:251], v[92:95]
    ds_read_b64_tr_b16 a[216:217], v61 offset:40960
    v_mul_f32 v13, v53, v173
    v_mfma_f32_16x16x32_bf16 v[92:95], a[252:255], v[252:255], v[92:95]
    ds_read_b64_tr_b16 a[218:219], v61 offset:43008
    v_mul_f32 v14, v54, v174
    v_mfma_f32_16x16x32_bf16 v[96:99], a[192:195], v[192:195], v[96:99]
    s_waitcnt lgkmcnt(8)
    ds_read_b64_tr_b16 a[220:221], v61 offset:45056
    v_mul_f32 v15, v55, v175
    v_mfma_f32_16x16x32_bf16 v[96:99], a[196:199], v[196:199], v[96:99]
    ds_read_b64_tr_b16 a[222:223], v61 offset:47104
    s_waitcnt vmcnt(7)
    v_mul_f32 v16, v48, v176
    v_mfma_f32_16x16x32_bf16 v[104:107], a[192:195], v[208:211], v[104:107]
    ds_read_b64_tr_b16 a[224:225], v60 offset:49152
    v_fmac_f32 v16, v49, v177
    v_mfma_f32_16x16x32_bf16 v[104:107], a[196:199], v[212:215], v[104:107]
    ds_read_b64_tr_b16 a[226:227], v60 offset:51200
    v_fmac_f32 v16, v50, v178
    v_mfma_f32_16x16x32_bf16 v[100:103], a[200:203], v[192:195], v[100:103]
    s_waitcnt lgkmcnt(9)
    ds_read_b64_tr_b16 a[228:229], v60 offset:53248
    v_fmac_f32 v16, v51, v179
    v_mfma_f32_16x16x32_bf16 v[100:103], a[204:207], v[196:199], v[100:103]
    ds_read_b64_tr_b16 a[230:231], v60 offset:55296
    s_waitcnt vmcnt(6)
    v_fmac_f32 v16, v52, v180
    v_mfma_f32_16x16x32_bf16 v[108:111], a[200:203], v[208:211], v[108:111]
    ds_read_b64_tr_b16 a[232:233], v61 offset:49152
    v_cvt_pk_bf16_f32 v80, v80, v81
    v_mfma_f32_16x16x32_bf16 v[108:111], a[204:207], v[212:215], v[108:111]
    s_waitcnt lgkmcnt(9)
    ds_read_b64_tr_b16 a[234:235], v61 offset:51200
    v_cvt_pk_bf16_f32 v81, v82, v83
    v_mfma_f32_16x16x32_bf16 v[96:99], a[208:211], v[200:203], v[96:99]
    ds_read_b64_tr_b16 a[236:237], v61 offset:53248
    v_cvt_pk_bf16_f32 v82, v84, v85
    v_mfma_f32_16x16x32_bf16 v[96:99], a[212:215], v[204:207], v[96:99]
    ds_read_b64_tr_b16 a[238:239], v61 offset:55296
    v_cvt_pk_bf16_f32 v83, v86, v87
    v_mfma_f32_16x16x32_bf16 v[104:107], a[208:211], v[216:219], v[104:107]
    ds_read_b64_tr_b16 a[240:241], v60 offset:57344
    v_min_u32 v80, -2, v80
    v_mfma_f32_16x16x32_bf16 v[104:107], a[212:215], v[220:223], v[104:107]
    s_waitcnt lgkmcnt(9)
    ds_read_b64_tr_b16 a[242:243], v60 offset:59392
    v_min_u32 v81, -2, v81
    v_mfma_f32_16x16x32_bf16 v[100:103], a[216:219], v[200:203], v[100:103]
    ds_read_b64_tr_b16 a[244:245], v60 offset:61440
    v_min_u32 v82, -2, v82
    v_mfma_f32_16x16x32_bf16 v[100:103], a[220:223], v[204:207], v[100:103]
    ds_read_b64_tr_b16 a[246:247], v60 offset:63488
    v_min_u32 v83, -2, v83
    v_mfma_f32_16x16x32_bf16 v[108:111], a[216:219], v[216:219], v[108:111]
    s_waitcnt lgkmcnt(9)
    s_add_u32 s75, s18, 8388608
    ds_read_b64_tr_b16 a[248:249], v61 offset:57344
    v_fmac_f32 v16, v53, v181
    v_mfma_f32_16x16x32_bf16 v[108:111], a[220:223], v[220:223], v[108:111]
    buffer_store_dwordx4 v[80:83], v23, s[8:11], s75 offen offset:256 sc0 sc1
    ds_read_b64_tr_b16 a[250:251], v61 offset:59392
    v_mfma_f32_16x16x32_bf16 v[96:99], a[224:227], v[224:227], v[96:99]
    s_waitcnt lgkmcnt(9)
    ds_read_b64_tr_b16 a[252:253], v61 offset:61440
    v_cvt_pk_bf16_f32 v88, v88, v89
    v_mfma_f32_16x16x32_bf16 v[96:99], a[228:231], v[228:231], v[96:99]
    ds_read_b64_tr_b16 a[254:255], v61 offset:63488
    v_cvt_pk_bf16_f32 v89, v90, v91
    v_mfma_f32_16x16x32_bf16 v[104:107], a[224:227], v[240:243], v[104:107]
    ds_read_b64_tr_b16 a[192:193], v62 offset:32768
    v_cvt_pk_bf16_f32 v90, v92, v93
    v_mfma_f32_16x16x32_bf16 v[104:107], a[228:231], v[244:247], v[104:107]
    s_waitcnt lgkmcnt(9)
    ds_read_b64_tr_b16 a[194:195], v62 offset:34816
    v_cvt_pk_bf16_f32 v91, v94, v95
    v_mfma_f32_16x16x32_bf16 v[100:103], a[232:235], v[224:227], v[100:103]
    ds_read_b64_tr_b16 a[196:197], v62 offset:36864
    v_min_u32 v88, -2, v88
    v_mfma_f32_16x16x32_bf16 v[100:103], a[236:239], v[228:231], v[100:103]
    ds_read_b64_tr_b16 a[198:199], v62 offset:38912
    v_min_u32 v89, -2, v89
    v_mfma_f32_16x16x32_bf16 v[108:111], a[232:235], v[240:243], v[108:111]
    ds_read_b64_tr_b16 a[200:201], v63 offset:32768
    v_min_u32 v90, -2, v90
    v_mfma_f32_16x16x32_bf16 v[108:111], a[236:239], v[244:247], v[108:111]
    s_waitcnt lgkmcnt(9)
    ds_read_b64_tr_b16 a[202:203], v63 offset:34816
    v_fmac_f32 v16, v54, v182
    v_mfma_f32_16x16x32_bf16 v[96:99], a[240:243], v[232:235], v[96:99]
    s_add_u32 s74, s70, 0
    ds_read_b64_tr_b16 a[204:205], v63 offset:36864
    v_min_u32 v91, -2, v91
    v_mfma_f32_16x16x32_bf16 v[96:99], a[244:247], v[236:239], v[96:99]
    buffer_load_dwordx4 v[128:131], v44, s[8:11], s74 offen sc0 sc1
    ds_read_b64_tr_b16 a[206:207], v63 offset:38912
    v_mfma_f32_16x16x32_bf16 v[104:107], a[240:243], v[248:251], v[104:107]
    s_add_u32 s74, s70, 4096
    ds_read_b64_tr_b16 a[208:209], v62 offset:40960
    v_fmac_f32 v16, v55, v183
    v_mfma_f32_16x16x32_bf16 v[104:107], a[244:247], v[252:255], v[104:107]
    s_waitcnt lgkmcnt(9)
    s_add_u32 s75, s18, 8519680
    ds_read_b64_tr_b16 a[210:211], v62 offset:43008
    v_add_f32_dpp v16, v16, v16 quad_perm:[1,0,3,2] row_mask:0xf bank_mask:0xf
    v_mfma_f32_16x16x32_bf16 v[100:103], a[248:251], v[232:235], v[100:103]
    buffer_store_dwordx4 v[88:91], v23, s[8:11], s75 offen offset:256 sc0 sc1
    ds_read_b64_tr_b16 a[212:213], v62 offset:45056
    v_mfma_f32_16x16x32_bf16 v[100:103], a[252:255], v[236:239], v[100:103]
    buffer_load_dwordx4 v[132:135], v44, s[8:11], s74 offen sc0 sc1
    ds_read_b64_tr_b16 a[214:215], v62 offset:47104
    v_mfma_f32_16x16x32_bf16 v[108:111], a[248:251], v[248:251], v[108:111]
    s_add_u32 s74, s70, 8192
    ds_read_b64_tr_b16 a[216:217], v63 offset:40960
    v_add_f32_dpp v16, v16, v16 quad_perm:[2,3,0,1] row_mask:0xf bank_mask:0xf
    v_mfma_f32_16x16x32_bf16 v[108:111], a[252:255], v[252:255], v[108:111]
    s_waitcnt lgkmcnt(9)
    ds_read_b64_tr_b16 a[218:219], v63 offset:43008
    v_add_f32_dpp v16, v16, v16 row_half_mirror row_mask:0xf bank_mask:0xf
    v_mfma_f32_16x16x32_bf16 v[112:115], a[192:195], v[192:195], v[112:115]
    ds_read_b64_tr_b16 a[220:221], v63 offset:45056
    v_add_f32_dpp v16, v16, v16 row_mirror row_mask:0xf bank_mask:0xf
    v_mfma_f32_16x16x32_bf16 v[112:115], a[196:199], v[196:199], v[112:115]
    buffer_load_dwordx4 v[136:139], v44, s[8:11], s74 offen sc0 sc1
    ds_read_b64_tr_b16 a[222:223], v63 offset:47104
    v_mfma_f32_16x16x32_bf16 v[120:123], a[192:195], v[208:211], v[120:123]
    s_add_u32 s74, s70, 12288
    ds_read_b64_tr_b16 a[224:225], v62 offset:49152
    v_mov_b32 v19, v16
    v_mfma_f32_16x16x32_bf16 v[120:123], a[196:199], v[212:215], v[120:123]
    s_waitcnt lgkmcnt(9)
    ds_read_b64_tr_b16 a[226:227], v62 offset:51200
    v_permlane16_swap_b32 v16, v19
    v_mfma_f32_16x16x32_bf16 v[116:119], a[200:203], v[192:195], v[116:119]
    ds_read_b64_tr_b16 a[228:229], v62 offset:53248
    v_add_f32 v16, v16, v19
    v_mfma_f32_16x16x32_bf16 v[116:119], a[204:207], v[196:199], v[116:119]
    buffer_load_dwordx4 v[140:143], v44, s[8:11], s74 offen sc0 sc1
    ds_read_b64_tr_b16 a[230:231], v62 offset:55296
    v_mfma_f32_16x16x32_bf16 v[124:127], a[200:203], v[208:211], v[124:127]
    s_add_u32 s74, s70, 16384
    ds_read_b64_tr_b16 a[232:233], v63 offset:49152
    v_cvt_pk_bf16_f32 v96, v96, v97
    v_mfma_f32_16x16x32_bf16 v[124:127], a[204:207], v[212:215], v[124:127]
    s_waitcnt lgkmcnt(9)
    ds_read_b64_tr_b16 a[234:235], v63 offset:51200
    v_cvt_pk_bf16_f32 v97, v98, v99
    v_mfma_f32_16x16x32_bf16 v[112:115], a[208:211], v[200:203], v[112:115]
    ds_read_b64_tr_b16 a[236:237], v63 offset:53248
    v_cvt_pk_bf16_f32 v98, v100, v101
    v_mfma_f32_16x16x32_bf16 v[112:115], a[212:215], v[204:207], v[112:115]
    buffer_load_dwordx4 v[144:147], v44, s[8:11], s74 offen sc0 sc1
    ds_read_b64_tr_b16 a[238:239], v63 offset:55296
    v_mfma_f32_16x16x32_bf16 v[120:123], a[208:211], v[216:219], v[120:123]
    s_add_u32 s74, s70, 20480
    ds_read_b64_tr_b16 a[240:241], v62 offset:57344
    v_cvt_pk_bf16_f32 v99, v102, v103
    v_mfma_f32_16x16x32_bf16 v[120:123], a[212:215], v[220:223], v[120:123]
    s_waitcnt lgkmcnt(9)
    ds_read_b64_tr_b16 a[242:243], v62 offset:59392
    v_min_u32 v96, -2, v96
    v_mfma_f32_16x16x32_bf16 v[116:119], a[216:219], v[200:203], v[116:119]
    ds_read_b64_tr_b16 a[244:245], v62 offset:61440
    v_min_u32 v97, -2, v97
    v_mfma_f32_16x16x32_bf16 v[116:119], a[220:223], v[204:207], v[116:119]
    buffer_load_dwordx4 v[148:151], v44, s[8:11], s74 offen sc0 sc1
    ds_read_b64_tr_b16 a[246:247], v62 offset:63488
    v_mfma_f32_16x16x32_bf16 v[124:127], a[216:219], v[216:219], v[124:127]
    s_add_u32 s74, s70, 24576
    ds_read_b64_tr_b16 a[248:249], v63 offset:57344
    v_min_u32 v98, -2, v98
    v_mfma_f32_16x16x32_bf16 v[124:127], a[220:223], v[220:223], v[124:127]
    s_waitcnt lgkmcnt(9)
    ds_read_b64_tr_b16 a[250:251], v63 offset:59392
    v_min_u32 v99, -2, v99
    v_mfma_f32_16x16x32_bf16 v[112:115], a[224:227], v[224:227], v[112:115]
    s_add_u32 s75, s18, 8388608
    ds_read_b64_tr_b16 a[252:253], v63 offset:61440
    v_mov_b32 v19, v16
    v_mfma_f32_16x16x32_bf16 v[112:115], a[228:231], v[228:231], v[112:115]
    buffer_load_dwordx4 v[152:155], v44, s[8:11], s74 offen sc0 sc1
    ds_read_b64_tr_b16 a[254:255], v63 offset:63488
    v_mfma_f32_16x16x32_bf16 v[120:123], a[224:227], v[240:243], v[120:123]
    s_waitcnt lgkmcnt(9)
    s_add_u32 s74, s70, 28672
    v_permlane32_swap_b32 v16, v19
    v_mfma_f32_16x16x32_bf16 v[120:123], a[228:231], v[244:247], v[120:123]
    buffer_store_dwordx4 v[96:99], v23, s[8:11], s75 offen offset:512 sc0 sc1
    v_add_f32 v16, v16, v19
    v_mfma_f32_16x16x32_bf16 v[116:119], a[232:235], v[224:227], v[116:119]
    s_waitcnt lgkmcnt(7)
    v_cvt_pk_bf16_f32 v104, v104, v105
    v_mfma_f32_16x16x32_bf16 v[116:119], a[236:239], v[228:231], v[116:119]
    buffer_load_dwordx4 v[156:159], v44, s[8:11], s74 offen sc0 sc1
    v_mfma_f32_16x16x32_bf16 v[124:127], a[232:235], v[240:243], v[124:127]
    v_cvt_pk_bf16_f32 v105, v106, v107
    v_mfma_f32_16x16x32_bf16 v[124:127], a[236:239], v[244:247], v[124:127]
    s_waitcnt lgkmcnt(4)
    v_cvt_pk_bf16_f32 v106, v108, v109
    v_mfma_f32_16x16x32_bf16 v[112:115], a[240:243], v[232:235], v[112:115]
    v_cvt_pk_bf16_f32 v107, v110, v111
    v_mfma_f32_16x16x32_bf16 v[112:115], a[244:247], v[236:239], v[112:115]
    v_min_u32 v104, -2, v104
    v_mfma_f32_16x16x32_bf16 v[120:123], a[240:243], v[248:251], v[120:123]
    v_min_u32 v105, -2, v105
    v_mfma_f32_16x16x32_bf16 v[120:123], a[244:247], v[252:255], v[120:123]
    s_waitcnt lgkmcnt(0)
    v_min_u32 v106, -2, v106
    v_mfma_f32_16x16x32_bf16 v[116:119], a[248:251], v[232:235], v[116:119]
    v_min_u32 v107, -2, v107
    v_mfma_f32_16x16x32_bf16 v[116:119], a[252:255], v[236:239], v[116:119]
    s_add_u32 s75, s18, 8519680
    v_mfma_f32_16x16x32_bf16 v[124:127], a[248:251], v[248:251], v[124:127]
    buffer_store_dwordx4 v[104:107], v23, s[8:11], s75 offen offset:512 sc0 sc1
    v_mfma_f32_16x16x32_bf16 v[124:127], a[252:255], v[252:255], v[124:127]
    v_cvt_pk_bf16_f32 v112, v112, v113
    v_cvt_pk_bf16_f32 v113, v114, v115
    s_nop 1
    v_cvt_pk_bf16_f32 v114, v116, v117
    v_cvt_pk_bf16_f32 v115, v118, v119
    v_min_u32 v112, -2, v112
    v_min_u32 v113, -2, v113
    v_min_u32 v114, -2, v114
    v_min_u32 v115, -2, v115
    s_add_u32 s75, s18, 8388608
    buffer_store_dwordx4 v[112:115], v23, s[8:11], s75 offen offset:768 sc0 sc1
    v_cvt_pk_bf16_f32 v120, v120, v121
    v_cvt_pk_bf16_f32 v121, v122, v123
    v_cvt_pk_bf16_f32 v122, v124, v125
    v_cvt_pk_bf16_f32 v123, v126, v127
    v_min_u32 v120, -2, v120
    v_min_u32 v121, -2, v121
    v_min_u32 v122, -2, v122
    v_min_u32 v123, -2, v123
    s_add_u32 s75, s18, 8519680
    buffer_store_dwordx4 v[120:123], v23, s[8:11], s75 offen offset:768 sc0 sc1
    s_mov_b32 s12, 0xf000f
    s_mov_b32 s13, 0xf000f
    v_mov_b64 v[192:193], -1
    v_mov_b64 v[194:195], -1
    v_mov_b64 v[196:197], -1
    v_mov_b64 v[198:199], -1
    v_mov_b64 v[200:201], -1
    v_mov_b64 v[202:203], -1
    v_mov_b64 v[204:205], -1
    v_mov_b64 v[206:207], -1
    v_mov_b64 v[208:209], -1
    v_mov_b64 v[210:211], -1
    v_mov_b64 v[212:213], -1
    v_mov_b64 v[214:215], -1
    v_mov_b64 v[216:217], -1
    v_mov_b64 v[218:219], -1
    v_mov_b64 v[220:221], -1
    v_mov_b64 v[222:223], -1
    s_mov_b64 exec, s[12:13]
    s_add_u32 s74, s70, 8388608
    buffer_load_dwordx4 v[192:195], v44, s[8:11], s74 offen sc0 sc1
    s_add_u32 s74, s70, 8392704
    buffer_load_dwordx4 v[196:199], v44, s[8:11], s74 offen sc0 sc1
    s_add_u32 s74, s70, 8396800
    buffer_load_dwordx4 v[200:203], v44, s[8:11], s74 offen sc0 sc1
    s_add_u32 s74, s70, 8400896
    buffer_load_dwordx4 v[204:207], v44, s[8:11], s74 offen sc0 sc1
    s_add_u32 s74, s70, 8404992
    buffer_load_dwordx4 v[208:211], v44, s[8:11], s74 offen sc0 sc1
    s_add_u32 s74, s70, 8409088
    buffer_load_dwordx4 v[212:215], v44, s[8:11], s74 offen sc0 sc1
    s_add_u32 s74, s70, 8413184
    buffer_load_dwordx4 v[216:219], v44, s[8:11], s74 offen sc0 sc1
    s_add_u32 s74, s70, 8417280
    buffer_load_dwordx4 v[220:223], v44, s[8:11], s74 offen sc0 sc1
    s_mov_b64 exec, -1
    v_mov_b32 v100, 0x3f80
    v_mov_b32 v101, 0x3f800000
    v_lshlrev_b32 v88, 16, v36
    v_and_b32 v89, 0xffff0000, v36
    v_lshlrev_b32 v90, 16, v37
    v_and_b32 v91, 0xffff0000, v37
    v_lshlrev_b32 v92, 16, v38
    v_and_b32 v93, 0xffff0000, v38
    v_lshlrev_b32 v94, 16, v39
    v_and_b32 v95, 0xffff0000, v39
    v_lshlrev_b32 v72, 16, v32
    v_and_b32 v73, 0xffff0000, v32
    v_lshlrev_b32 v74, 16, v33
    v_and_b32 v75, 0xffff0000, v33
    v_lshlrev_b32 v76, 16, v34
    v_and_b32 v77, 0xffff0000, v34
    v_lshlrev_b32 v78, 16, v35
    v_and_b32 v79, 0xffff0000, v35
    s_waitcnt vmcnt(20)
    v_max_u32 v3, v128, v129
    v_max3_u32 v3, v3, v130, v131
    s_waitcnt vmcnt(18)
    v_max3_u32 v3, v3, v132, v133
    v_max3_u32 v3, v3, v134, v135
    s_waitcnt vmcnt(17)
    v_max3_u32 v3, v3, v136, v137
    v_max3_u32 v3, v3, v138, v139
    s_waitcnt vmcnt(16)
    v_max3_u32 v3, v3, v140, v141
    v_max3_u32 v3, v3, v142, v143
    s_waitcnt vmcnt(15)
    v_max3_u32 v3, v3, v144, v145
    v_max3_u32 v3, v3, v146, v147
    s_waitcnt vmcnt(14)
    v_max3_u32 v3, v3, v148, v149
    v_max3_u32 v3, v3, v150, v151
    s_waitcnt vmcnt(13)
    v_max3_u32 v3, v3, v152, v153
    v_max3_u32 v3, v3, v154, v155
    s_waitcnt vmcnt(11)
    v_max3_u32 v3, v3, v156, v157
    v_max3_u32 v3, v3, v158, v159
    v_cmp_eq_u32 vcc, -1, v3
    s_cbranch_vccnz L_P1_slow_15
L_P1_ok_16:
    v_lshlrev_b32 v64, 16, v128
    v_and_b32 v65, 0xffff0000, v128
    v_lshlrev_b32 v66, 16, v129
    v_and_b32 v67, 0xffff0000, v129
    v_lshlrev_b32 v68, 16, v130
    v_and_b32 v69, 0xffff0000, v130
    v_lshlrev_b32 v70, 16, v131
    v_and_b32 v71, 0xffff0000, v131
    v_dot2c_f32_bf16 v64, v132, v100
    v_dot2c_f32_bf16 v65, v132, v101
    v_dot2c_f32_bf16 v66, v133, v100
    v_dot2c_f32_bf16 v67, v133, v101
    v_dot2c_f32_bf16 v68, v134, v100
    v_dot2c_f32_bf16 v69, v134, v101
    v_dot2c_f32_bf16 v70, v135, v100
    v_dot2c_f32_bf16 v71, v135, v101
    v_dot2c_f32_bf16 v64, v136, v100
    v_dot2c_f32_bf16 v65, v136, v101
    v_dot2c_f32_bf16 v66, v137, v100
    v_dot2c_f32_bf16 v67, v137, v101
    v_dot2c_f32_bf16 v68, v138, v100
    v_dot2c_f32_bf16 v69, v138, v101
    v_dot2c_f32_bf16 v70, v139, v100
    v_dot2c_f32_bf16 v71, v139, v101
    v_dot2c_f32_bf16 v64, v140, v100
    v_dot2c_f32_bf16 v65, v140, v101
    v_dot2c_f32_bf16 v66, v141, v100
    v_dot2c_f32_bf16 v67, v141, v101
    v_dot2c_f32_bf16 v68, v142, v100
    v_dot2c_f32_bf16 v69, v142, v101
    v_dot2c_f32_bf16 v70, v143, v100
    v_dot2c_f32_bf16 v71, v143, v101
    v_dot2c_f32_bf16 v64, v144, v100
    v_dot2c_f32_bf16 v65, v144, v101
    v_dot2c_f32_bf16 v66, v145, v100
    v_dot2c_f32_bf16 v67, v145, v101
    v_dot2c_f32_bf16 v68, v146, v100
    v_dot2c_f32_bf16 v69, v146, v101
    v_dot2c_f32_bf16 v70, v147, v100
    v_dot2c_f32_bf16 v71, v147, v101
    v_dot2c_f32_bf16 v64, v148, v100
    v_dot2c_f32_bf16 v65, v148, v101
    v_dot2c_f32_bf16 v66, v149, v100
    v_dot2c_f32_bf16 v67, v149, v101
    v_dot2c_f32_bf16 v68, v150, v100
    v_dot2c_f32_bf16 v69, v150, v101
    v_dot2c_f32_bf16 v70, v151, v100
    v_dot2c_f32_bf16 v71, v151, v101
    v_dot2c_f32_bf16 v64, v152, v100
    v_dot2c_f32_bf16 v65, v152, v101
    v_dot2c_f32_bf16 v66, v153, v100
    v_dot2c_f32_bf16 v67, v153, v101
    v_dot2c_f32_bf16 v68, v154, v100
    v_dot2c_f32_bf16 v69, v154, v101
    v_dot2c_f32_bf16 v70, v155, v100
    v_dot2c_f32_bf16 v71, v155, v101
    v_dot2c_f32_bf16 v64, v156, v100
    v_dot2c_f32_bf16 v65, v156, v101
    v_dot2c_f32_bf16 v66, v157, v100
    v_dot2c_f32_bf16 v67, v157, v101
    v_dot2c_f32_bf16 v68, v158, v100
    v_dot2c_f32_bf16 v69, v158, v101
    v_dot2c_f32_bf16 v70, v159, v100
    v_dot2c_f32_bf16 v71, v159, v101
    v_pk_fma_f32 v[64:65], v[64:65], v[160:161], v[72:73]
    v_pk_fma_f32 v[66:67], v[66:67], v[162:163], v[74:75]
    v_pk_fma_f32 v[68:69], v[68:69], v[164:165], v[76:77]
    v_pk_fma_f32 v[70:71], v[70:71], v[166:167], v[78:79]
    v_cvt_pk_bf16_f32 v32, v64, v65
    v_cvt_pk_bf16_f32 v33, v66, v67
    v_cvt_pk_bf16_f32 v34, v68, v69
    v_cvt_pk_bf16_f32 v35, v70, v71
    v_lshlrev_b32 v64, 16, v32
    v_and_b32 v65, 0xffff0000, v32
    v_lshlrev_b32 v66, 16, v33
    v_and_b32 v67, 0xffff0000, v33
    v_lshlrev_b32 v68, 16, v34
    v_and_b32 v69, 0xffff0000, v34
    v_lshlrev_b32 v70, 16, v35
    v_and_b32 v71, 0xffff0000, v35
    v_pk_add_f32 v[48:49], v[64:65], v[66:67]
    v_pk_add_f32 v[50:51], v[68:69], v[70:71]
    v_pk_add_f32 v[48:49], v[48:49], v[50:51]
    v_add_f32 v48, v48, v49
    s_nop 1
    v_add_f32_dpp v48, v48, v48 quad_perm:[1,0,3,2] row_mask:0xf bank_mask:0xf
    s_nop 1
    v_add_f32_dpp v48, v48, v48 quad_perm:[2,3,0,1] row_mask:0xf bank_mask:0xf
    s_nop 1
    v_add_f32_dpp v48, v48, v48 row_half_mirror row_mask:0xf bank_mask:0xf
    s_nop 1
    v_add_f32_dpp v48, v48, v48 row_mirror row_mask:0xf bank_mask:0xf
    v_mov_b32 v49, v48
    s_nop 1
    v_permlane16_swap_b32 v48, v49
    v_add_f32 v48, v48, v49
    v_mov_b32 v49, v48
    s_nop 1
    v_permlane32_swap_b32 v48, v49
    v_add_f32 v48, v48, v49
    v_mul_f32 v48, 0xbb000000, v48
    v_pk_add_f32 v[72:73], v[64:65], v[48:49] op_sel_hi:[1,0]
    v_pk_add_f32 v[74:75], v[66:67], v[48:49] op_sel_hi:[1,0]
    v_pk_add_f32 v[76:77], v[68:69], v[48:49] op_sel_hi:[1,0]
    v_pk_add_f32 v[78:79], v[70:71], v[48:49] op_sel_hi:[1,0]
    v_pk_mul_f32 v[50:51], v[72:73], v[72:73]
    v_pk_mul_f32 v[52:53], v[72:73], v[8:9]
    v_pk_fma_f32 v[50:51], v[74:75], v[74:75], v[50:51]
    v_pk_fma_f32 v[52:53], v[74:75], v[10:11], v[52:53]
    v_pk_fma_f32 v[50:51], v[76:77], v[76:77], v[50:51]
    v_pk_fma_f32 v[52:53], v[76:77], v[12:13], v[52:53]
    v_pk_fma_f32 v[50:51], v[78:79], v[78:79], v[50:51]
    v_pk_fma_f32 v[52:53], v[78:79], v[14:15], v[52:53]
    v_add_f32 v50, v50, v51
    v_add_f32 v52, v52, v53
    s_nop 0
    v_add_f32_dpp v50, v50, v50 quad_perm:[1,0,3,2] row_mask:0xf bank_mask:0xf
    v_add_f32_dpp v52, v52, v52 quad_perm:[1,0,3,2] row_mask:0xf bank_mask:0xf
    s_nop 0
    v_add_f32_dpp v50, v50, v50 quad_perm:[2,3,0,1] row_mask:0xf bank_mask:0xf
    v_add_f32_dpp v52, v52, v52 quad_perm:[2,3,0,1] row_mask:0xf bank_mask:0xf
    s_nop 0
    v_add_f32_dpp v50, v50, v50 row_half_mirror row_mask:0xf bank_mask:0xf
    v_add_f32_dpp v52, v52, v52 row_half_mirror row_mask:0xf bank_mask:0xf
    s_nop 0
    v_add_f32_dpp v50, v50, v50 row_mirror row_mask:0xf bank_mask:0xf
    v_add_f32_dpp v52, v52, v52 row_mirror row_mask:0xf bank_mask:0xf
    v_mov_b32 v51, v50
    v_mov_b32 v53, v52
    s_nop 0
    v_permlane16_swap_b32 v50, v51
    v_permlane16_swap_b32 v52, v53
    v_add_f32 v50, v50, v51
    v_add_f32 v52, v52, v53
    v_mov_b32 v51, v50
    v_mov_b32 v53, v52
    s_nop 0
    v_permlane32_swap_b32 v50, v51
    v_permlane32_swap_b32 v52, v53
    v_add_f32 v50, v50, v51
    v_add_f32 v52, v52, v53
    v_mov_b32 v48, 0x3727c5ac
    v_fmac_f32 v48, 0x3b000000, v50
    v_rsq_f32 v48, v48
    s_nop 0
    v_fma_f32 v52, v52, v48, v16
    v_ashrrev_i32 v53, 31, v52
    v_or_b32 v53, 0x80000000, v53
    v_xor_b32 v53, v53, v52
    v_and_b32 v53, 0xfffff800, v53
    v_or_b32 v17, s68, v53
    v_pk_mul_f32 v[72:73], v[72:73], v[48:49] op_sel_hi:[1,0]
    v_pk_mul_f32 v[74:75], v[74:75], v[48:49] op_sel_hi:[1,0]
    v_pk_mul_f32 v[76:77], v[76:77], v[48:49] op_sel_hi:[1,0]
    v_pk_mul_f32 v[78:79], v[78:79], v[48:49] op_sel_hi:[1,0]
    v_pk_fma_f32 v[72:73], v[72:73], v[168:169], v[176:177]
    v_pk_fma_f32 v[74:75], v[74:75], v[170:171], v[178:179]
    v_pk_fma_f32 v[76:77], v[76:77], v[172:173], v[180:181]
    v_pk_fma_f32 v[78:79], v[78:79], v[174:175], v[182:183]
    v_cvt_pk_bf16_f32 v20, v72, v73
    v_cvt_pk_bf16_f32 v21, v74, v75
    v_cvt_pk_bf16_f32 v22, v76, v77
    v_cvt_pk_bf16_f32 v23, v78, v79
    v_lshlrev_b32 v98, 4, v0
    v_cmp_gt_u32 vcc, 224, v0
    v_mov_b32 v99, 2147479552
    s_nop 0
    v_cndmask_b32 v99, v99, v98, vcc
    s_lshl_b32 s17, s66, 13
    s_add_u32 s17, s17, 4194304
    s_cmp_lt_u32 s66, 224
    s_cselect_b32 s17, s17, 2143285248
    s_lshl_b32 s100, s3, 2
    v_mov_b32 v47, s100
    v_mov_b32 v102, 0
    s_lshl_b32 s100, s2, 6
    s_add_u32 s100, s100, 65536
    s_lshl_b32 s101, s2, 11
    s_add_u32 s101, s101, 524288
    s_branch L_op_join
L_op_odd:
    s_waitcnt lgkmcnt(14)
    v_mfma_f32_16x16x32_bf16 v[64:67], a[192:195], a[64:67], 0
    s_waitcnt lgkmcnt(12)
    s_add_u32 m0, s62, 0
    ds_read_b64_tr_b16 a[224:225], v56 offset:49152
    v_mfma_f32_16x16x32_bf16 v[64:67], a[196:199], a[68:71], v[64:67]
    s_xor_b32 s98, s65, 128
    ds_read_b64_tr_b16 a[226:227], v56 offset:51200
    v_mfma_f32_16x16x32_bf16 v[72:75], a[192:195], a[80:83], 0
    buffer_load_dwordx4 v24, s[28:31], s98 offen offset:0   lds
    v_mfma_f32_16x16x32_bf16 v[72:75], a[196:199], a[84:87], v[72:75]
    s_waitcnt lgkmcnt(12)
    ds_read_b64_tr_b16 a[228:229], v56 offset:53248
    v_mfma_f32_16x16x32_bf16 v[68:71], a[200:203], a[64:67], 0
    s_waitcnt lgkmcnt(11)
    ds_read_b64_tr_b16 a[230:231], v56 offset:55296
    v_mfma_f32_16x16x32_bf16 v[68:71], a[204:207], a[68:71], v[68:71]
    s_add_u32 s22, s22, 65536
    ds_read_b64_tr_b16 a[232:233], v57 offset:49152
    v_mfma_f32_16x16x32_bf16 v[76:79], a[200:203], a[80:83], 0
    buffer_load_dwordx4 v25, s[28:31], s98 offen offset:1024   lds
    ds_read_b64_tr_b16 a[234:235], v57 offset:51200
    v_mfma_f32_16x16x32_bf16 v[76:79], a[204:207], a[84:87], v[76:79]
    s_waitcnt lgkmcnt(12)
    s_add_u32 s23, s23, 65536
    ds_read_b64_tr_b16 a[236:237], v57 offset:53248
    v_mfma_f32_16x16x32_bf16 v[64:67], a[208:211], a[72:75], v[64:67]
    s_waitcnt lgkmcnt(11)
    s_lshl_b32 s24, s61, 2
    ds_read_b64_tr_b16 a[238:239], v57 offset:55296
    v_mfma_f32_16x16x32_bf16 v[64:67], a[212:215], a[76:79], v[64:67]
    s_add_u32 s24, s24, s3
    ds_read_b64_tr_b16 a[240:241], v56 offset:57344
    v_mfma_f32_16x16x32_bf16 v[72:75], a[208:211], a[88:91], v[72:75]
    buffer_load_dwordx4 v26, s[28:31], s98 offen offset:2048   lds
    v_mfma_f32_16x16x32_bf16 v[72:75], a[212:215], a[92:95], v[72:75]
    s_waitcnt lgkmcnt(7)
    s_lshl_b32 s24, s24, 3
    ds_read_b64_tr_b16 a[242:243], v56 offset:59392
    v_mfma_f32_16x16x32_bf16 v[68:71], a[216:219], a[72:75], v[68:71]
    s_add_u32 s24, s24, s4
    ds_read_b64_tr_b16 a[244:245], v56 offset:61440
    v_mfma_f32_16x16x32_bf16 v[68:71], a[220:223], a[76:79], v[68:71]
    s_lshl_b32 s24, s24, 2
    ds_read_b64_tr_b16 a[246:247], v56 offset:63488
    v_mfma_f32_16x16x32_bf16 v[76:79], a[216:219], a[88:91], v[76:79]
    buffer_load_dwordx4 v27, s[28:31], s98 offen offset:3072   lds
    ds_read_b64_tr_b16 a[248:249], v57 offset:57344
    v_mfma_f32_16x16x32_bf16 v[76:79], a[220:223], a[92:95], v[76:79]
    s_add_u32 m0, s62, 4096
    ds_read_b64_tr_b16 a[250:251], v57 offset:59392
    v_mfma_f32_16x16x32_bf16 v[64:67], a[224:227], a[96:99], v[64:67]
    s_waitcnt lgkmcnt(8)
    s_xor_b32 s98, s65, 32896
    ds_read_b64_tr_b16 a[252:253], v57 offset:61440
    v_mfma_f32_16x16x32_bf16 v[64:67], a[228:231], a[100:103], v[64:67]
    s_add_u32 s24, s24, s5
    ds_read_b64_tr_b16 a[254:255], v57 offset:63488
    v_mfma_f32_16x16x32_bf16 v[72:75], a[224:227], a[112:115], v[72:75]
    buffer_load_dwordx4 v24, s[28:31], s98 offen offset:0   lds
    v_mfma_f32_16x16x32_bf16 v[72:75], a[228:231], a[116:119], v[72:75]
    s_lshl_b32 s24, s24, 13
    ds_read_b64_tr_b16 a[192:193], v58 offset:32768
    v_mfma_f32_16x16x32_bf16 v[68:71], a[232:235], a[96:99], v[68:71]
    s_waitcnt lgkmcnt(8)
    s_add_u32 s24, s24, 50331648
    ds_read_b64_tr_b16 a[194:195], v58 offset:34816
    v_mfma_f32_16x16x32_bf16 v[68:71], a[236:239], a[100:103], v[68:71]
    ds_read_b64_tr_b16 a[196:197], v58 offset:36864
    v_mfma_f32_16x16x32_bf16 v[76:79], a[232:235], a[112:115], v[76:79]
    buffer_load_dwordx4 v25, s[28:31], s98 offen offset:1024   lds
    ds_read_b64_tr_b16 a[198:199], v58 offset:38912
    v_mfma_f32_16x16x32_bf16 v[76:79], a[236:239], a[116:119], v[76:79]
    s_waitcnt lgkmcnt(8)
    ds_read_b64_tr_b16 a[200:201], v59 offset:32768
    v_mfma_f32_16x16x32_bf16 v[64:67], a[240:243], a[104:107], v[64:67]
    ds_read_b64_tr_b16 a[202:203], v59 offset:34816
    v_mfma_f32_16x16x32_bf16 v[64:67], a[244:247], a[108:111], v[64:67]
    ds_read_b64_tr_b16 a[204:205], v59 offset:36864
    v_mfma_f32_16x16x32_bf16 v[72:75], a[240:243], a[120:123], v[72:75]
    buffer_load_dwordx4 v26, s[28:31], s98 offen offset:2048   lds
    ds_read_b64_tr_b16 a[206:207], v59 offset:38912
    v_mfma_f32_16x16x32_bf16 v[72:75], a[244:247], a[124:127], v[72:75]
    s_waitcnt lgkmcnt(8)
    ds_read_b64_tr_b16 a[208:209], v58 offset:40960
    v_mfma_f32_16x16x32_bf16 v[68:71], a[248:251], a[104:107], v[68:71]
    ds_read_b64_tr_b16 a[210:211], v58 offset:43008
    v_mfma_f32_16x16x32_bf16 v[68:71], a[252:255], a[108:111], v[68:71]
    ds_read_b64_tr_b16 a[212:213], v58 offset:45056
    v_mfma_f32_16x16x32_bf16 v[76:79], a[248:251], a[120:123], v[76:79]
    buffer_load_dwordx4 v27, s[28:31], s98 offen offset:3072   lds
    ds_read_b64_tr_b16 a[214:215], v58 offset:47104
    v_mfma_f32_16x16x32_bf16 v[76:79], a[252:255], a[124:127], v[76:79]
    s_waitcnt lgkmcnt(9)
    ds_read_b64_tr_b16 a[216:217], v59 offset:40960
    v_mfma_f32_16x16x32_bf16 v[80:83], a[192:195], a[64:67], 0
    s_waitcnt lgkmcnt(9)
    ds_read_b64_tr_b16 a[218:219], v59 offset:43008
    v_mfma_f32_16x16x32_bf16 v[80:83], a[196:199], a[68:71], v[80:83]
    ds_read_b64_tr_b16 a[220:221], v59 offset:45056
    v_mfma_f32_16x16x32_bf16 v[88:91], a[192:195], a[80:83], 0
    ds_read_b64_tr_b16 a[222:223], v59 offset:47104
    s_waitcnt vmcnt(16)
    s_barrier
    v_mfma_f32_16x16x32_bf16 v[88:91], a[196:199], a[84:87], v[88:91]
    s_waitcnt lgkmcnt(9)
    s_add_u32 m0, s62, 98304
    ds_read_b64_tr_b16 a[224:225], v58 offset:49152
    v_mfma_f32_16x16x32_bf16 v[84:87], a[200:203], a[64:67], 0
    s_waitcnt lgkmcnt(9)
    s_xor_b32 s98, s65, 262272
    ds_read_b64_tr_b16 a[226:227], v58 offset:51200
    v_mfma_f32_16x16x32_bf16 v[84:87], a[204:207], a[68:71], v[84:87]
    buffer_load_dwordx4 v24, s[28:31], s98 offen offset:0   lds
    ds_read_b64_tr_b16 a[228:229], v58 offset:53248
    v_mfma_f32_16x16x32_bf16 v[92:95], a[200:203], a[80:83], 0
    ds_read_b64_tr_b16 a[230:231], v58 offset:55296
    v_mfma_f32_16x16x32_bf16 v[92:95], a[204:207], a[84:87], v[92:95]
    s_waitcnt lgkmcnt(9)
    ds_read_b64_tr_b16 a[232:233], v59 offset:49152
    v_mfma_f32_16x16x32_bf16 v[80:83], a[208:211], a[72:75], v[80:83]
    s_waitcnt lgkmcnt(9)
    ds_read_b64_tr_b16 a[234:235], v59 offset:51200
    v_mfma_f32_16x16x32_bf16 v[80:83], a[212:215], a[76:79], v[80:83]
    buffer_load_dwordx4 v25, s[28:31], s98 offen offset:1024   lds
    ds_read_b64_tr_b16 a[236:237], v59 offset:53248
    v_mfma_f32_16x16x32_bf16 v[88:91], a[208:211], a[88:91], v[88:91]
    ds_read_b64_tr_b16 a[238:239], v59 offset:55296
    v_mfma_f32_16x16x32_bf16 v[88:91], a[212:215], a[92:95], v[88:91]
    s_waitcnt lgkmcnt(9)
    ds_read_b64_tr_b16 a[240:241], v58 offset:57344
    v_mfma_f32_16x16x32_bf16 v[84:87], a[216:219], a[72:75], v[84:87]
    s_waitcnt lgkmcnt(9)
    ds_read_b64_tr_b16 a[242:243], v58 offset:59392
    v_mfma_f32_16x16x32_bf16 v[84:87], a[220:223], a[76:79], v[84:87]
    buffer_load_dwordx4 v26, s[28:31], s98 offen offset:2048   lds
    ds_read_b64_tr_b16 a[244:245], v58 offset:61440
    v_mfma_f32_16x16x32_bf16 v[92:95], a[216:219], a[88:91], v[92:95]
    ds_read_b64_tr_b16 a[246:247], v58 offset:63488
    v_mfma_f32_16x16x32_bf16 v[92:95], a[220:223], a[92:95], v[92:95]
    s_waitcnt lgkmcnt(9)
    ds_read_b64_tr_b16 a[248:249], v59 offset:57344
    v_mfma_f32_16x16x32_bf16 v[80:83], a[224:227], a[96:99], v[80:83]
    s_waitcnt lgkmcnt(9)
    ds_read_b64_tr_b16 a[250:251], v59 offset:59392
    v_mfma_f32_16x16x32_bf16 v[80:83], a[228:231], a[100:103], v[80:83]
    buffer_load_dwordx4 v27, s[28:31], s98 offen offset:3072   lds
    ds_read_b64_tr_b16 a[252:253], v59 offset:61440
    v_mfma_f32_16x16x32_bf16 v[88:91], a[224:227], a[112:115], v[88:91]
    s_add_u32 m0, s62, 102400
    ds_read_b64_tr_b16 a[254:255], v59 offset:63488
    v_mfma_f32_16x16x32_bf16 v[88:91], a[228:231], a[116:119], v[88:91]
    s_waitcnt lgkmcnt(9)
    s_xor_b32 s98, s65, 295040
    ds_read_b64_tr_b16 a[192:193], v60 offset:0
    v_mfma_f32_16x16x32_bf16 v[84:87], a[232:235], a[96:99], v[84:87]
    s_waitcnt lgkmcnt(9)
    ds_read_b64_tr_b16 a[194:195], v60 offset:2048
    v_mfma_f32_16x16x32_bf16 v[84:87], a[236:239], a[100:103], v[84:87]
    buffer_load_dwordx4 v24, s[28:31], s98 offen offset:0   lds
    ds_read_b64_tr_b16 a[196:197], v60 offset:4096
    v_mfma_f32_16x16x32_bf16 v[92:95], a[232:235], a[112:115], v[92:95]
    ds_read_b64_tr_b16 a[198:199], v60 offset:6144
    v_mfma_f32_16x16x32_bf16 v[92:95], a[236:239], a[116:119], v[92:95]
    s_waitcnt lgkmcnt(9)
    ds_read_b64_tr_b16 a[200:201], v61 offset:0
    v_mfma_f32_16x16x32_bf16 v[80:83], a[240:243], a[104:107], v[80:83]
    s_waitcnt lgkmcnt(9)
    ds_read_b64_tr_b16 a[202:203], v61 offset:2048
    v_mfma_f32_16x16x32_bf16 v[80:83], a[244:247], a[108:111], v[80:83]
    buffer_load_dwordx4 v25, s[28:31], s98 offen offset:1024   lds
    ds_read_b64_tr_b16 a[204:205], v61 offset:4096
    v_mfma_f32_16x16x32_bf16 v[88:91], a[240:243], a[120:123], v[88:91]
    ds_read_b64_tr_b16 a[206:207], v61 offset:6144
    v_mfma_f32_16x16x32_bf16 v[88:91], a[244:247], a[124:127], v[88:91]
    s_waitcnt lgkmcnt(9)
    ds_read_b64_tr_b16 a[208:209], v60 offset:8192
    v_mfma_f32_16x16x32_bf16 v[84:87], a[248:251], a[104:107], v[84:87]
    s_waitcnt lgkmcnt(9)
    ds_read_b64_tr_b16 a[210:211], v60 offset:10240
    v_lshrrev_b32 v46, 2, v2
    v_mfma_f32_16x16x32_bf16 v[84:87], a[252:255], a[108:111], v[84:87]
    buffer_load_dwordx4 v26, s[28:31], s98 offen offset:2048   lds
    ds_read_b64_tr_b16 a[212:213], v60 offset:12288
    v_mfma_f32_16x16x32_bf16 v[92:95], a[248:251], a[120:123], v[92:95]
    ds_read_b64_tr_b16 a[214:215], v60 offset:14336
    v_and_b32 v45, 3, v2
    v_mfma_f32_16x16x32_bf16 v[92:95], a[252:255], a[124:127], v[92:95]
    s_waitcnt lgkmcnt(9)
    ds_read_b64_tr_b16 a[216:217], v61 offset:8192
    v_lshlrev_b32 v44, 8, v46
    v_mfma_f32_16x16x32_bf16 v[64:67], a[192:195], a[0:3], v[64:67]
    s_waitcnt lgkmcnt(9)
    ds_read_b64_tr_b16 a[218:219], v61 offset:10240
    v_lshl_add_u32 v44, v45, 4, v44
    v_mfma_f32_16x16x32_bf16 v[64:67], a[196:199], a[4:7], v[64:67]
    buffer_load_dwordx4 v27, s[28:31], s98 offen offset:3072   lds
    ds_read_b64_tr_b16 a[220:221], v61 offset:12288
    v_mfma_f32_16x16x32_bf16 v[72:75], a[192:195], a[16:19], v[72:75]
    ds_read_b64_tr_b16 a[222:223], v61 offset:14336
    v_lshlrev_b32 v45, 3, v45
    v_mfma_f32_16x16x32_bf16 v[72:75], a[196:199], a[20:23], v[72:75]
    s_waitcnt lgkmcnt(9)
    ds_read_b64_tr_b16 a[224:225], v60 offset:16384
    v_lshl_add_u32 v45, v46, 6, v45
    v_mfma_f32_16x16x32_bf16 v[68:71], a[200:203], a[0:3], v[68:71]
    s_waitcnt lgkmcnt(9)
    ds_read_b64_tr_b16 a[226:227], v60 offset:18432
    v_lshlrev_b32 v46, 1, v45
    v_mfma_f32_16x16x32_bf16 v[68:71], a[204:207], a[4:7], v[68:71]
    s_lshl_b32 s70, s2, 15
    ds_read_b64_tr_b16 a[228:229], v60 offset:20480
    v_mfma_f32_16x16x32_bf16 v[76:79], a[200:203], a[16:19], v[76:79]
    s_lshl_b32 s100, s3, 6
    ds_read_b64_tr_b16 a[230:231], v60 offset:22528
    v_mfma_f32_16x16x32_bf16 v[76:79], a[204:207], a[20:23], v[76:79]
    s_waitcnt lgkmcnt(9)
    s_add_u32 s70, s70, s100
    ds_read_b64_tr_b16 a[232:233], v61 offset:16384
    v_mfma_f32_16x16x32_bf16 v[64:67], a[208:211], a[8:11], v[64:67]
    s_waitcnt lgkmcnt(9)
    s_add_u32 s70, s70, 67108864
    ds_read_b64_tr_b16 a[234:235], v61 offset:18432
    v_mfma_f32_16x16x32_bf16 v[64:67], a[212:215], a[12:15], v[64:67]
    s_and_b32 s68, s2, 31
    ds_read_b64_tr_b16 a[236:237], v61 offset:20480
    v_mfma_f32_16x16x32_bf16 v[72:75], a[208:211], a[24:27], v[72:75]
    s_lshl_b32 s68, s68, 2
    ds_read_b64_tr_b16 a[238:239], v61 offset:22528
    v_mfma_f32_16x16x32_bf16 v[72:75], a[212:215], a[28:31], v[72:75]
    s_waitcnt lgkmcnt(9)
    s_add_u32 s68, s68, s3
    ds_read_b64_tr_b16 a[240:241], v60 offset:24576
    v_mfma_f32_16x16x32_bf16 v[68:71], a[216:219], a[8:11], v[68:71]
    s_waitcnt lgkmcnt(9)
    s_lshl_b32 s69, s61, 7
    ds_read_b64_tr_b16 a[242:243], v60 offset:26624
    v_mfma_f32_16x16x32_bf16 v[68:71], a[220:223], a[12:15], v[68:71]
    s_add_u32 s69, s69, s68
    ds_read_b64_tr_b16 a[244:245], v60 offset:28672
    v_mfma_f32_16x16x32_bf16 v[76:79], a[216:219], a[24:27], v[76:79]
    s_lshl_b32 s100, s60, 7
    ds_read_b64_tr_b16 a[246:247], v60 offset:30720
    v_mfma_f32_16x16x32_bf16 v[76:79], a[220:223], a[28:31], v[76:79]
    s_waitcnt lgkmcnt(9)
    s_add_u32 s68, s68, s100
    ds_read_b64_tr_b16 a[248:249], v61 offset:24576
    v_mfma_f32_16x16x32_bf16 v[64:67], a[224:227], a[32:35], v[64:67]
    s_waitcnt lgkmcnt(9)
    s_lshl_b32 s100, s68, 10
    ds_read_b64_tr_b16 a[250:251], v61 offset:26624
    v_mfma_f32_16x16x32_bf16 v[64:67], a[228:231], a[36:39], v[64:67]
    s_lshl_b32 s101, s69, 10
    ds_read_b64_tr_b16 a[252:253], v61 offset:28672
    v_mfma_f32_16x16x32_bf16 v[72:75], a[224:227], a[48:51], v[72:75]
    ds_read_b64_tr_b16 a[254:255], v61 offset:30720
    ds_read_b64_tr_b16 a[208:209], v62 offset:8192
    v_mfma_f32_16x16x32_bf16 v[72:75], a[228:231], a[52:55], v[72:75]
    s_waitcnt lgkmcnt(10)
    ds_read_b64_tr_b16 a[192:193], v62 offset:0
    ds_read_b64_tr_b16 a[210:211], v62 offset:10240
    v_mfma_f32_16x16x32_bf16 v[68:71], a[232:235], a[32:35], v[68:71]
    s_waitcnt lgkmcnt(11)
    ds_read_b64_tr_b16 a[194:195], v62 offset:2048
    ds_read_b64_tr_b16 a[212:213], v62 offset:12288
    v_mfma_f32_16x16x32_bf16 v[68:71], a[236:239], a[36:39], v[68:71]
    ds_read_b64_tr_b16 a[196:197], v62 offset:4096
    ds_read_b64_tr_b16 a[214:215], v62 offset:14336
    v_mfma_f32_16x16x32_bf16 v[76:79], a[232:235], a[48:51], v[76:79]
    ds_read_b64_tr_b16 a[198:199], v62 offset:6144
    ds_read_b64_tr_b16 a[216:217], v63 offset:8192
    v_mfma_f32_16x16x32_bf16 v[76:79], a[236:239], a[52:55], v[76:79]
    s_waitcnt lgkmcnt(14)
    ds_read_b64_tr_b16 a[200:201], v63 offset:0
    ds_read_b64_tr_b16 a[218:219], v63 offset:10240
    v_mfma_f32_16x16x32_bf16 v[64:67], a[240:243], a[40:43], v[64:67]
    s_waitcnt lgkmcnt(15)
    ds_read_b64_tr_b16 a[202:203], v63 offset:2048
    ds_read_b64_tr_b16 a[220:221], v63 offset:12288
    v_mfma_f32_16x16x32_bf16 v[64:67], a[244:247], a[44:47], v[64:67]
    ds_read_b64_tr_b16 a[204:205], v63 offset:4096
    ds_read_b64_tr_b16 a[222:223], v63 offset:14336
    v_mfma_f32_16x16x32_bf16 v[72:75], a[240:243], a[56:59], v[72:75]
    s_waitcnt lgkmcnt(15)
    ds_read_b64_tr_b16 a[206:207], v63 offset:6144
    s_waitcnt vmcnt(16)
    v_mfma_f32_16x16x32_bf16 v[72:75], a[244:247], a[60:63], v[72:75]
    buffer_store_dword v6, v5, s[8:11], s22 offen sc0 sc1
    v_mfma_f32_16x16x32_bf16 v[68:71], a[248:251], a[40:43], v[68:71]
    ds_read_b64_tr_b16 a[224:225], v62 offset:16384
    v_mfma_f32_16x16x32_bf16 v[68:71], a[252:255], a[44:47], v[68:71]
    ds_read_b64_tr_b16 a[226:227], v62 offset:18432
    v_mfma_f32_16x16x32_bf16 v[76:79], a[248:251], a[56:59], v[76:79]
    ds_read_b64_tr_b16 a[228:229], v62 offset:20480
    v_mfma_f32_16x16x32_bf16 v[76:79], a[252:255], a[60:63], v[76:79]
    s_waitcnt lgkmcnt(12)
    ds_read_b64_tr_b16 a[230:231], v62 offset:22528
    v_mfma_f32_16x16x32_bf16 v[80:83], a[192:195], a[0:3], v[80:83]
    s_waitcnt lgkmcnt(11)
    ds_read_b64_tr_b16 a[232:233], v63 offset:16384
    v_mfma_f32_16x16x32_bf16 v[80:83], a[196:199], a[4:7], v[80:83]
    ds_read_b64_tr_b16 a[234:235], v63 offset:18432
    v_mfma_f32_16x16x32_bf16 v[88:91], a[192:195], a[16:19], v[88:91]
    ds_read_b64_tr_b16 a[236:237], v63 offset:20480
    v_mfma_f32_16x16x32_bf16 v[88:91], a[196:199], a[20:23], v[88:91]
    s_waitcnt lgkmcnt(8)
    ds_read_b64_tr_b16 a[238:239], v63 offset:22528
    v_mfma_f32_16x16x32_bf16 v[84:87], a[200:203], a[0:3], v[84:87]
    s_waitcnt lgkmcnt(8)
    ds_read_b64_tr_b16 a[240:241], v62 offset:24576
    v_mfma_f32_16x16x32_bf16 v[84:87], a[204:207], a[4:7], v[84:87]
    ds_read_b64_tr_b16 a[242:243], v62 offset:26624
    v_mfma_f32_16x16x32_bf16 v[92:95], a[200:203], a[16:19], v[92:95]
    ds_read_b64_tr_b16 a[244:245], v62 offset:28672
    v_cvt_pk_bf16_f32 v64, v64, v65
    s_waitcnt vmcnt(1)
    s_barrier
    v_mfma_f32_16x16x32_bf16 v[92:95], a[204:207], a[20:23], v[92:95]
    s_xor_b32 s74, s24, 0
    ds_read_b64_tr_b16 a[246:247], v62 offset:30720
    v_cvt_pk_bf16_f32 v65, v66, v67
    v_mfma_f32_16x16x32_bf16 v[80:83], a[208:211], a[8:11], v[80:83]
    buffer_load_dwordx4 v[128:131], v1, s[8:11], s74 offen offset:0
    v_mfma_f32_16x16x32_bf16 v[80:83], a[212:215], a[12:15], v[80:83]
    s_xor_b32 s74, s24, 4096
    ds_read_b64_tr_b16 a[248:249], v63 offset:24576
    v_cvt_pk_bf16_f32 v66, v68, v69
    v_mfma_f32_16x16x32_bf16 v[88:91], a[208:211], a[24:27], v[88:91]
    ds_read_b64_tr_b16 a[250:251], v63 offset:26624
    v_cvt_pk_bf16_f32 v67, v70, v71
    v_mfma_f32_16x16x32_bf16 v[88:91], a[212:215], a[28:31], v[88:91]
    buffer_load_dwordx4 v[144:147], v1, s[8:11], s74 offen offset:0
    ds_read_b64_tr_b16 a[252:253], v63 offset:28672
    v_mfma_f32_16x16x32_bf16 v[84:87], a[216:219], a[8:11], v[84:87]
    s_xor_b32 s74, s24, 0
    ds_read_b64_tr_b16 a[254:255], v63 offset:30720
    v_min_u32 v64, -2, v64
    v_mfma_f32_16x16x32_bf16 v[84:87], a[220:223], a[12:15], v[84:87]
    ds_read_b64_tr_b16 a[192:193], v56 offset:0
    v_min_u32 v65, -2, v65
    v_mfma_f32_16x16x32_bf16 v[92:95], a[216:219], a[24:27], v[92:95]
    buffer_load_dwordx4 v[132:135], v1, s[8:11], s74 offen offset:1024
    v_mfma_f32_16x16x32_bf16 v[92:95], a[220:223], a[28:31], v[92:95]
    s_waitcnt lgkmcnt(7)
    s_xor_b32 s74, s24, 4096
    ds_read_b64_tr_b16 a[194:195], v56 offset:2048
    v_min_u32 v66, -2, v66
    v_mfma_f32_16x16x32_bf16 v[80:83], a[224:227], a[32:35], v[80:83]
    ds_read_b64_tr_b16 a[196:197], v56 offset:4096
    v_min_u32 v67, -2, v67
    v_mfma_f32_16x16x32_bf16 v[80:83], a[228:231], a[36:39], v[80:83]
    buffer_load_dwordx4 v[148:151], v1, s[8:11], s74 offen offset:1024
    v_mfma_f32_16x16x32_bf16 v[88:91], a[224:227], a[48:51], v[88:91]
    s_xor_b32 s74, s24, 0
    ds_read_b64_tr_b16 a[198:199], v56 offset:6144
    v_mfma_f32_16x16x32_bf16 v[88:91], a[228:231], a[52:55], v[88:91]
    s_add_u32 s75, s18, 0
    ds_read_b64_tr_b16 a[200:201], v57 offset:0
    v_mfma_f32_16x16x32_bf16 v[84:87], a[232:235], a[32:35], v[84:87]
    buffer_load_dwordx4 v[136:139], v1, s[8:11], s74 offen offset:2048
    ds_read_b64_tr_b16 a[202:203], v57 offset:2048
    v_mfma_f32_16x16x32_bf16 v[84:87], a[236:239], a[36:39], v[84:87]
    s_xor_b32 s74, s24, 4096
    ds_read_b64_tr_b16 a[204:205], v57 offset:4096
    v_mfma_f32_16x16x32_bf16 v[92:95], a[232:235], a[48:51], v[92:95]
    buffer_store_dwordx4 v[64:67], v23, s[8:11], s75 offen offset:0 sc0 sc1
    ds_read_b64_tr_b16 a[206:207], v57 offset:6144
    v_mfma_f32_16x16x32_bf16 v[92:95], a[236:239], a[52:55], v[92:95]
    buffer_load_dwordx4 v[152:155], v1, s[8:11], s74 offen offset:2048
    v_mfma_f32_16x16x32_bf16 v[80:83], a[240:243], a[40:43], v[80:83]
    s_waitcnt lgkmcnt(7)
    s_xor_b32 s74, s24, 0
    ds_read_b64_tr_b16 a[208:209], v56 offset:8192
    v_cvt_pk_bf16_f32 v72, v72, v73
    v_mfma_f32_16x16x32_bf16 v[80:83], a[244:247], a[44:47], v[80:83]
    ds_read_b64_tr_b16 a[210:211], v56 offset:10240
    v_cvt_pk_bf16_f32 v73, v74, v75
    v_mfma_f32_16x16x32_bf16 v[88:91], a[240:243], a[56:59], v[88:91]
    buffer_load_dwordx4 v[140:143], v1, s[8:11], s74 offen offset:3072
    v_mfma_f32_16x16x32_bf16 v[88:91], a[244:247], a[60:63], v[88:91]
    s_xor_b32 s74, s24, 4096
    ds_read_b64_tr_b16 a[212:213], v56 offset:12288
    v_cvt_pk_bf16_f32 v74, v76, v77
    v_mfma_f32_16x16x32_bf16 v[84:87], a[248:251], a[40:43], v[84:87]
    ds_read_b64_tr_b16 a[214:215], v56 offset:14336
    v_cvt_pk_bf16_f32 v75, v78, v79
    v_mfma_f32_16x16x32_bf16 v[84:87], a[252:255], a[44:47], v[84:87]
    buffer_load_dwordx4 v[156:159], v1, s[8:11], s74 offen offset:3072
    ds_read_b64_tr_b16 a[216:217], v57 offset:8192
    v_mfma_f32_16x16x32_bf16 v[92:95], a[248:251], a[56:59], v[92:95]
    ds_read_b64_tr_b16 a[218:219], v57 offset:10240
    v_min_u32 v72, -2, v72
    v_mfma_f32_16x16x32_bf16 v[92:95], a[252:255], a[60:63], v[92:95]
    s_waitcnt lgkmcnt(7)
    ds_read_b64_tr_b16 a[220:221], v57 offset:12288
    v_min_u32 v73, -2, v73
    v_mfma_f32_16x16x32_bf16 v[96:99], a[192:195], a[64:67], 0
    ds_read_b64_tr_b16 a[222:223], v57 offset:14336
    v_min_u32 v74, -2, v74
    v_mfma_f32_16x16x32_bf16 v[96:99], a[196:199], a[68:71], v[96:99]
    ds_read_b64_tr_b16 a[224:225], v56 offset:16384
    v_min_u32 v75, -2, v75
    v_mfma_f32_16x16x32_bf16 v[104:107], a[192:195], a[80:83], 0
    s_add_u32 s75, s18, 131072
    ds_read_b64_tr_b16 a[226:227], v56 offset:18432
    v_mfma_f32_16x16x32_bf16 v[104:107], a[196:199], a[84:87], v[104:107]
    buffer_store_dwordx4 v[72:75], v23, s[8:11], s75 offen offset:0 sc0 sc1
    ds_read_b64_tr_b16 a[228:229], v56 offset:20480
    v_mfma_f32_16x16x32_bf16 v[100:103], a[200:203], a[64:67], 0
    s_waitcnt lgkmcnt(9)
    ds_read_b64_tr_b16 a[230:231], v56 offset:22528
    v_mfma_f32_16x16x32_bf16 v[100:103], a[204:207], a[68:71], v[100:103]
    ds_read_b64_tr_b16 a[232:233], v57 offset:16384
    v_mfma_f32_16x16x32_bf16 v[108:111], a[200:203], a[80:83], 0
    ds_read_b64_tr_b16 a[234:235], v57 offset:18432
    v_mfma_f32_16x16x32_bf16 v[108:111], a[204:207], a[84:87], v[108:111]
    ds_read_b64_tr_b16 a[236:237], v57 offset:20480
    v_mfma_f32_16x16x32_bf16 v[96:99], a[208:211], a[72:75], v[96:99]
    s_waitcnt lgkmcnt(9)
    ds_read_b64_tr_b16 a[238:239], v57 offset:22528
    v_mfma_f32_16x16x32_bf16 v[96:99], a[212:215], a[76:79], v[96:99]
    ds_read_b64_tr_b16 a[240:241], v56 offset:24576
    v_mfma_f32_16x16x32_bf16 v[104:107], a[208:211], a[88:91], v[104:107]
    ds_read_b64_tr_b16 a[242:243], v56 offset:26624
    v_mfma_f32_16x16x32_bf16 v[104:107], a[212:215], a[92:95], v[104:107]
    ds_read_b64_tr_b16 a[244:245], v56 offset:28672
    v_mfma_f32_16x16x32_bf16 v[100:103], a[216:219], a[72:75], v[100:103]
    s_waitcnt lgkmcnt(9)
    ds_read_b64_tr_b16 a[246:247], v56 offset:30720
    v_mfma_f32_16x16x32_bf16 v[100:103], a[220:223], a[76:79], v[100:103]
    ds_read_b64_tr_b16 a[248:249], v57 offset:24576
    v_mfma_f32_16x16x32_bf16 v[108:111], a[216:219], a[88:91], v[108:111]
    ds_read_b64_tr_b16 a[250:251], v57 offset:26624
    v_mfma_f32_16x16x32_bf16 v[108:111], a[220:223], a[92:95], v[108:111]
    ds_read_b64_tr_b16 a[252:253], v57 offset:28672
    v_mfma_f32_16x16x32_bf16 v[96:99], a[224:227], a[96:99], v[96:99]
    s_waitcnt lgkmcnt(9)
    ds_read_b64_tr_b16 a[254:255], v57 offset:30720
    v_mfma_f32_16x16x32_bf16 v[96:99], a[228:231], a[100:103], v[96:99]
    ds_read_b64_tr_b16 a[192:193], v60 offset:32768
    v_mfma_f32_16x16x32_bf16 v[104:107], a[224:227], a[112:115], v[104:107]
    ds_read_b64_tr_b16 a[194:195], v60 offset:34816
    v_mfma_f32_16x16x32_bf16 v[104:107], a[228:231], a[116:119], v[104:107]
    ds_read_b64_tr_b16 a[196:197], v60 offset:36864
    v_mfma_f32_16x16x32_bf16 v[100:103], a[232:235], a[96:99], v[100:103]
    s_waitcnt lgkmcnt(9)
    ds_read_b64_tr_b16 a[198:199], v60 offset:38912
    v_cvt_pk_bf16_f32 v80, v80, v81
    v_mfma_f32_16x16x32_bf16 v[100:103], a[236:239], a[100:103], v[100:103]
    ds_read_b64_tr_b16 a[200:201], v61 offset:32768
    v_cvt_pk_bf16_f32 v81, v82, v83
    v_mfma_f32_16x16x32_bf16 v[108:111], a[232:235], a[112:115], v[108:111]
    ds_read_b64_tr_b16 a[202:203], v61 offset:34816
    v_cvt_pk_bf16_f32 v82, v84, v85
    v_mfma_f32_16x16x32_bf16 v[108:111], a[236:239], a[116:119], v[108:111]
    ds_read_b64_tr_b16 a[204:205], v61 offset:36864
    v_cvt_pk_bf16_f32 v83, v86, v87
    v_mfma_f32_16x16x32_bf16 v[96:99], a[240:243], a[104:107], v[96:99]
    s_waitcnt lgkmcnt(9)
    ds_read_b64_tr_b16 a[206:207], v61 offset:38912
    v_min_u32 v80, -2, v80
    v_mfma_f32_16x16x32_bf16 v[96:99], a[244:247], a[108:111], v[96:99]
    ds_read_b64_tr_b16 a[208:209], v60 offset:40960
    v_min_u32 v81, -2, v81
    v_mfma_f32_16x16x32_bf16 v[104:107], a[240:243], a[120:123], v[104:107]
    ds_read_b64_tr_b16 a[210:211], v60 offset:43008
    v_min_u32 v82, -2, v82
    v_mfma_f32_16x16x32_bf16 v[104:107], a[244:247], a[124:127], v[104:107]
    buffer_load_dword v3, v4, s[8:11], s23 offen sc0 sc1
    ds_read_b64_tr_b16 a[212:213], v60 offset:45056
    v_mfma_f32_16x16x32_bf16 v[100:103], a[248:251], a[104:107], v[100:103]
    s_waitcnt lgkmcnt(9)
    ds_read_b64_tr_b16 a[214:215], v60 offset:47104
    v_min_u32 v83, -2, v83
    v_mfma_f32_16x16x32_bf16 v[100:103], a[252:255], a[108:111], v[100:103]
    s_add_u32 s75, s18, 0
    ds_read_b64_tr_b16 a[216:217], v61 offset:40960
    v_mfma_f32_16x16x32_bf16 v[108:111], a[248:251], a[120:123], v[108:111]
    buffer_store_dwordx4 v[80:83], v23, s[8:11], s75 offen offset:256 sc0 sc1
    ds_read_b64_tr_b16 a[218:219], v61 offset:43008
    v_mfma_f32_16x16x32_bf16 v[108:111], a[252:255], a[124:127], v[108:111]
    ds_read_b64_tr_b16 a[220:221], v61 offset:45056
    v_cvt_pk_bf16_f32 v88, v88, v89
    v_mfma_f32_16x16x32_bf16 v[96:99], a[192:195], a[0:3], v[96:99]
    s_waitcnt lgkmcnt(9)
    ds_read_b64_tr_b16 a[222:223], v61 offset:47104
    v_cvt_pk_bf16_f32 v89, v90, v91
    v_mfma_f32_16x16x32_bf16 v[96:99], a[196:199], a[4:7], v[96:99]
    ds_read_b64_tr_b16 a[224:225], v60 offset:49152
    v_cvt_pk_bf16_f32 v90, v92, v93
    v_mfma_f32_16x16x32_bf16 v[104:107], a[192:195], a[16:19], v[104:107]
    ds_read_b64_tr_b16 a[226:227], v60 offset:51200
    v_cvt_pk_bf16_f32 v91, v94, v95
    v_mfma_f32_16x16x32_bf16 v[104:107], a[196:199], a[20:23], v[104:107]
    ds_read_b64_tr_b16 a[228:229], v60 offset:53248
    v_min_u32 v88, -2, v88
    v_mfma_f32_16x16x32_bf16 v[100:103], a[200:203], a[0:3], v[100:103]
    s_waitcnt lgkmcnt(9)
    ds_read_b64_tr_b16 a[230:231], v60 offset:55296
    v_min_u32 v89, -2, v89
    v_mfma_f32_16x16x32_bf16 v[100:103], a[204:207], a[4:7], v[100:103]
    ds_read_b64_tr_b16 a[232:233], v61 offset:49152
    v_min_u32 v90, -2, v90
    v_mfma_f32_16x16x32_bf16 v[108:111], a[200:203], a[16:19], v[108:111]
    ds_read_b64_tr_b16 a[234:235], v61 offset:51200
    v_min_u32 v91, -2, v91
    v_mfma_f32_16x16x32_bf16 v[108:111], a[204:207], a[20:23], v[108:111]
    s_waitcnt lgkmcnt(9)
    s_add_u32 s75, s18, 131072
    ds_read_b64_tr_b16 a[236:237], v61 offset:53248
    v_mfma_f32_16x16x32_bf16 v[96:99], a[208:211], a[8:11], v[96:99]
    buffer_store_dwordx4 v[88:91], v23, s[8:11], s75 offen offset:256 sc0 sc1
    ds_read_b64_tr_b16 a[238:239], v61 offset:55296
    v_mfma_f32_16x16x32_bf16 v[96:99], a[212:215], a[12:15], v[96:99]
    ds_read_b64_tr_b16 a[240:241], v60 offset:57344
    v_mfma_f32_16x16x32_bf16 v[104:107], a[208:211], a[24:27], v[104:107]
    ds_read_b64_tr_b16 a[242:243], v60 offset:59392
    v_mfma_f32_16x16x32_bf16 v[104:107], a[212:215], a[28:31], v[104:107]
    s_waitcnt lgkmcnt(9)
    ds_read_b64_tr_b16 a[244:245], v60 offset:61440
    v_mfma_f32_16x16x32_bf16 v[100:103], a[216:219], a[8:11], v[100:103]
    ds_read_b64_tr_b16 a[246:247], v60 offset:63488
    v_mfma_f32_16x16x32_bf16 v[100:103], a[220:223], a[12:15], v[100:103]
    ds_read_b64_tr_b16 a[248:249], v61 offset:57344
    v_mfma_f32_16x16x32_bf16 v[108:111], a[216:219], a[24:27], v[108:111]
    ds_read_b64_tr_b16 a[250:251], v61 offset:59392
    v_mfma_f32_16x16x32_bf16 v[108:111], a[220:223], a[28:31], v[108:111]
    s_waitcnt lgkmcnt(9)
    ds_read_b64_tr_b16 a[252:253], v61 offset:61440
    v_mfma_f32_16x16x32_bf16 v[96:99], a[224:227], a[32:35], v[96:99]
    ds_read_b64_tr_b16 a[254:255], v61 offset:63488
    v_mfma_f32_16x16x32_bf16 v[96:99], a[228:231], a[36:39], v[96:99]
    ds_read_b64_tr_b16 a[192:193], v58 offset:0
    v_mfma_f32_16x16x32_bf16 v[104:107], a[224:227], a[48:51], v[104:107]
    ds_read_b64_tr_b16 a[194:195], v58 offset:2048
    v_mfma_f32_16x16x32_bf16 v[104:107], a[228:231], a[52:55], v[104:107]
    s_waitcnt lgkmcnt(9)
    ds_read_b64_tr_b16 a[196:197], v58 offset:4096
    v_mfma_f32_16x16x32_bf16 v[100:103], a[232:235], a[32:35], v[100:103]
    ds_read_b64_tr_b16 a[198:199], v58 offset:6144
    v_mfma_f32_16x16x32_bf16 v[100:103], a[236:239], a[36:39], v[100:103]
    ds_read_b64_tr_b16 a[200:201], v59 offset:0
    v_mfma_f32_16x16x32_bf16 v[108:111], a[232:235], a[48:51], v[108:111]
    ds_read_b64_tr_b16 a[202:203], v59 offset:2048
    v_mfma_f32_16x16x32_bf16 v[108:111], a[236:239], a[52:55], v[108:111]
    s_waitcnt lgkmcnt(9)
    ds_read_b64_tr_b16 a[204:205], v59 offset:4096
    v_mfma_f32_16x16x32_bf16 v[96:99], a[240:243], a[40:43], v[96:99]
    ds_read_b64_tr_b16 a[206:207], v59 offset:6144
    v_mfma_f32_16x16x32_bf16 v[96:99], a[244:247], a[44:47], v[96:99]
    ds_read_b64_tr_b16 a[208:209], v58 offset:8192
    v_mfma_f32_16x16x32_bf16 v[104:107], a[240:243], a[56:59], v[104:107]
    ds_read_b64_tr_b16 a[210:211], v58 offset:10240
    v_mfma_f32_16x16x32_bf16 v[104:107], a[244:247], a[60:63], v[104:107]
    s_waitcnt lgkmcnt(9)
    ds_read_b64_tr_b16 a[212:213], v58 offset:12288
    v_mfma_f32_16x16x32_bf16 v[100:103], a[248:251], a[40:43], v[100:103]
    ds_read_b64_tr_b16 a[214:215], v58 offset:14336
    v_mfma_f32_16x16x32_bf16 v[100:103], a[252:255], a[44:47], v[100:103]
    ds_read_b64_tr_b16 a[216:217], v59 offset:8192
    v_mfma_f32_16x16x32_bf16 v[108:111], a[248:251], a[56:59], v[108:111]
    ds_read_b64_tr_b16 a[218:219], v59 offset:10240
    v_mfma_f32_16x16x32_bf16 v[108:111], a[252:255], a[60:63], v[108:111]
    s_waitcnt lgkmcnt(9)
    ds_read_b64_tr_b16 a[220:221], v59 offset:12288
    v_mfma_f32_16x16x32_bf16 v[112:115], a[192:195], a[64:67], 0
    ds_read_b64_tr_b16 a[222:223], v59 offset:14336
    v_mfma_f32_16x16x32_bf16 v[112:115], a[196:199], a[68:71], v[112:115]
    ds_read_b64_tr_b16 a[224:225], v58 offset:16384
    v_mfma_f32_16x16x32_bf16 v[120:123], a[192:195], a[80:83], 0
    ds_read_b64_tr_b16 a[226:227], v58 offset:18432
    v_mfma_f32_16x16x32_bf16 v[120:123], a[196:199], a[84:87], v[120:123]
    s_waitcnt lgkmcnt(9)
    ds_read_b64_tr_b16 a[228:229], v58 offset:20480
    v_mfma_f32_16x16x32_bf16 v[116:119], a[200:203], a[64:67], 0
    ds_read_b64_tr_b16 a[230:231], v58 offset:22528
    v_mfma_f32_16x16x32_bf16 v[116:119], a[204:207], a[68:71], v[116:119]
    ds_read_b64_tr_b16 a[232:233], v59 offset:16384
    v_mfma_f32_16x16x32_bf16 v[124:127], a[200:203], a[80:83], 0
    ds_read_b64_tr_b16 a[234:235], v59 offset:18432
    v_mfma_f32_16x16x32_bf16 v[124:127], a[204:207], a[84:87], v[124:127]
    s_waitcnt lgkmcnt(9)
    ds_read_b64_tr_b16 a[236:237], v59 offset:20480
    v_mfma_f32_16x16x32_bf16 v[112:115], a[208:211], a[72:75], v[112:115]
    ds_read_b64_tr_b16 a[238:239], v59 offset:22528
    v_cvt_pk_bf16_f32 v96, v96, v97
    s_waitcnt vmcnt(2)
    v_cmp_ne_u32 vcc, 0, v3
    s_cmp_eq_u64 vcc, -1
    s_cbranch_scc0 L_C2_slow_17
L_C2_ok_18:
    v_mfma_f32_16x16x32_bf16 v[112:115], a[212:215], a[76:79], v[112:115]
    s_xor_b32 s74, s24, 8192
    ds_read_b64_tr_b16 a[240:241], v58 offset:24576
    v_cvt_pk_bf16_f32 v97, v98, v99
    v_mfma_f32_16x16x32_bf16 v[120:123], a[208:211], a[88:91], v[120:123]
    buffer_load_dwordx4 v[160:163], v1, s[8:11], s74 offen offset:0
    v_mfma_f32_16x16x32_bf16 v[120:123], a[212:215], a[92:95], v[120:123]
    s_waitcnt lgkmcnt(8)
    s_xor_b32 s74, s24, 12288
    ds_read_b64_tr_b16 a[242:243], v58 offset:26624
    v_cvt_pk_bf16_f32 v98, v100, v101
    v_mfma_f32_16x16x32_bf16 v[116:119], a[216:219], a[72:75], v[116:119]
    ds_read_b64_tr_b16 a[244:245], v58 offset:28672
    v_cvt_pk_bf16_f32 v99, v102, v103
    v_mfma_f32_16x16x32_bf16 v[116:119], a[220:223], a[76:79], v[116:119]
    ds_read_b64_tr_b16 a[246:247], v58 offset:30720
    v_min_u32 v96, -2, v96
    v_mfma_f32_16x16x32_bf16 v[124:127], a[216:219], a[88:91], v[124:127]
    buffer_load_dwordx4 v[176:179], v1, s[8:11], s74 offen offset:0
    ds_read_b64_tr_b16 a[248:249], v59 offset:24576
    v_mfma_f32_16x16x32_bf16 v[124:127], a[220:223], a[92:95], v[124:127]
    s_waitcnt lgkmcnt(8)
    s_xor_b32 s74, s24, 8192
    ds_read_b64_tr_b16 a[250:251], v59 offset:26624
    v_min_u32 v97, -2, v97
    v_mfma_f32_16x16x32_bf16 v[112:115], a[224:227], a[96:99], v[112:115]
    ds_read_b64_tr_b16 a[252:253], v59 offset:28672
    v_min_u32 v98, -2, v98
    v_mfma_f32_16x16x32_bf16 v[112:115], a[228:231], a[100:103], v[112:115]
    ds_read_b64_tr_b16 a[254:255], v59 offset:30720
    v_min_u32 v99, -2, v99
    v_mfma_f32_16x16x32_bf16 v[120:123], a[224:227], a[112:115], v[120:123]
    buffer_load_dwordx4 v[164:167], v1, s[8:11], s74 offen offset:1024
    v_mfma_f32_16x16x32_bf16 v[120:123], a[228:231], a[116:119], v[120:123]
    s_waitcnt lgkmcnt(7)
    s_xor_b32 s74, s24, 12288
    ds_read_b64_tr_b16 a[192:193], v62 offset:32768
    v_mfma_f32_16x16x32_bf16 v[116:119], a[232:235], a[96:99], v[116:119]
    s_add_u32 s75, s18, 0
    ds_read_b64_tr_b16 a[194:195], v62 offset:34816
    v_mfma_f32_16x16x32_bf16 v[116:119], a[236:239], a[100:103], v[116:119]
    buffer_store_dwordx4 v[96:99], v23, s[8:11], s75 offen offset:512 sc0 sc1
    ds_read_b64_tr_b16 a[196:197], v62 offset:36864
    v_mfma_f32_16x16x32_bf16 v[124:127], a[232:235], a[112:115], v[124:127]
    buffer_load_dwordx4 v[180:183], v1, s[8:11], s74 offen offset:1024
    ds_read_b64_tr_b16 a[198:199], v62 offset:38912
    v_mfma_f32_16x16x32_bf16 v[124:127], a[236:239], a[116:119], v[124:127]
    s_waitcnt lgkmcnt(8)
    s_xor_b32 s74, s24, 8192
    ds_read_b64_tr_b16 a[200:201], v63 offset:32768
    v_cvt_pk_bf16_f32 v104, v104, v105
    v_mfma_f32_16x16x32_bf16 v[112:115], a[240:243], a[104:107], v[112:115]
    ds_read_b64_tr_b16 a[202:203], v63 offset:34816
    v_cvt_pk_bf16_f32 v105, v106, v107
    v_mfma_f32_16x16x32_bf16 v[112:115], a[244:247], a[108:111], v[112:115]
    ds_read_b64_tr_b16 a[204:205], v63 offset:36864
    v_cvt_pk_bf16_f32 v106, v108, v109
    v_mfma_f32_16x16x32_bf16 v[120:123], a[240:243], a[120:123], v[120:123]
    buffer_load_dwordx4 v[168:171], v1, s[8:11], s74 offen offset:2048
    ds_read_b64_tr_b16 a[206:207], v63 offset:38912
    v_mfma_f32_16x16x32_bf16 v[120:123], a[244:247], a[124:127], v[120:123]
    s_waitcnt lgkmcnt(8)
    s_xor_b32 s74, s24, 12288
    ds_read_b64_tr_b16 a[208:209], v62 offset:40960
    v_cvt_pk_bf16_f32 v107, v110, v111
    v_mfma_f32_16x16x32_bf16 v[116:119], a[248:251], a[104:107], v[116:119]
    ds_read_b64_tr_b16 a[210:211], v62 offset:43008
    v_min_u32 v104, -2, v104
    v_mfma_f32_16x16x32_bf16 v[116:119], a[252:255], a[108:111], v[116:119]
    ds_read_b64_tr_b16 a[212:213], v62 offset:45056
    v_min_u32 v105, -2, v105
    v_mfma_f32_16x16x32_bf16 v[124:127], a[248:251], a[120:123], v[124:127]
    buffer_load_dwordx4 v[184:187], v1, s[8:11], s74 offen offset:2048
    ds_read_b64_tr_b16 a[214:215], v62 offset:47104
    v_mfma_f32_16x16x32_bf16 v[124:127], a[252:255], a[124:127], v[124:127]
    s_waitcnt lgkmcnt(9)
    s_xor_b32 s74, s24, 8192
    ds_read_b64_tr_b16 a[216:217], v63 offset:40960
    v_min_u32 v106, -2, v106
    v_mfma_f32_16x16x32_bf16 v[112:115], a[192:195], a[0:3], v[112:115]
    s_waitcnt lgkmcnt(9)
    ds_read_b64_tr_b16 a[218:219], v63 offset:43008
    v_min_u32 v107, -2, v107
    v_mfma_f32_16x16x32_bf16 v[112:115], a[196:199], a[4:7], v[112:115]
    s_add_u32 s75, s18, 131072
    ds_read_b64_tr_b16 a[220:221], v63 offset:45056
    v_mfma_f32_16x16x32_bf16 v[120:123], a[192:195], a[16:19], v[120:123]
    buffer_load_dwordx4 v[172:175], v1, s[8:11], s74 offen offset:3072
    ds_read_b64_tr_b16 a[222:223], v63 offset:47104
    v_mfma_f32_16x16x32_bf16 v[120:123], a[196:199], a[20:23], v[120:123]
    s_waitcnt lgkmcnt(8)
    s_xor_b32 s74, s24, 12288
    ds_read_b64_tr_b16 a[224:225], v62 offset:49152
    v_mfma_f32_16x16x32_bf16 v[116:119], a[200:203], a[0:3], v[116:119]
    buffer_store_dwordx4 v[104:107], v23, s[8:11], s75 offen offset:512 sc0 sc1
    ds_read_b64_tr_b16 a[226:227], v62 offset:51200
    v_mfma_f32_16x16x32_bf16 v[116:119], a[204:207], a[4:7], v[116:119]
    ds_read_b64_tr_b16 a[228:229], v62 offset:53248
    v_mfma_f32_16x16x32_bf16 v[124:127], a[200:203], a[16:19], v[124:127]
    buffer_load_dwordx4 v[188:191], v1, s[8:11], s74 offen offset:3072
    ds_read_b64_tr_b16 a[230:231], v62 offset:55296
    v_mfma_f32_16x16x32_bf16 v[124:127], a[204:207], a[20:23], v[124:127]
    s_waitcnt lgkmcnt(9)
    ds_read_b64_tr_b16 a[232:233], v63 offset:49152
    v_mfma_f32_16x16x32_bf16 v[112:115], a[208:211], a[8:11], v[112:115]
    s_waitcnt lgkmcnt(9)
    ds_read_b64_tr_b16 a[234:235], v63 offset:51200
    v_mfma_f32_16x16x32_bf16 v[112:115], a[212:215], a[12:15], v[112:115]
    ds_read_b64_tr_b16 a[236:237], v63 offset:53248
    v_mfma_f32_16x16x32_bf16 v[120:123], a[208:211], a[24:27], v[120:123]
    ds_read_b64_tr_b16 a[238:239], v63 offset:55296
    v_mfma_f32_16x16x32_bf16 v[120:123], a[212:215], a[28:31], v[120:123]
    s_waitcnt lgkmcnt(9)
    ds_read_b64_tr_b16 a[240:241], v62 offset:57344
    v_mfma_f32_16x16x32_bf16 v[116:119], a[216:219], a[8:11], v[116:119]
    s_waitcnt lgkmcnt(9)
    ds_read_b64_tr_b16 a[242:243], v62 offset:59392
    v_mfma_f32_16x16x32_bf16 v[116:119], a[220:223], a[12:15], v[116:119]
    ds_read_b64_tr_b16 a[244:245], v62 offset:61440
    v_mfma_f32_16x16x32_bf16 v[124:127], a[216:219], a[24:27], v[124:127]
    ds_read_b64_tr_b16 a[246:247], v62 offset:63488
    v_mfma_f32_16x16x32_bf16 v[124:127], a[220:223], a[28:31], v[124:127]
    s_waitcnt lgkmcnt(9)
    ds_read_b64_tr_b16 a[248:249], v63 offset:57344
    v_mfma_f32_16x16x32_bf16 v[112:115], a[224:227], a[32:35], v[112:115]
    s_waitcnt lgkmcnt(9)
    ds_read_b64_tr_b16 a[250:251], v63 offset:59392
    ds_read_b64_tr_b16 a[208:209], v56 offset:40960
    v_mfma_f32_16x16x32_bf16 v[112:115], a[228:231], a[36:39], v[112:115]
    ds_read_b64_tr_b16 a[252:253], v63 offset:61440
    ds_read_b64_tr_b16 a[210:211], v56 offset:43008
    v_mfma_f32_16x16x32_bf16 v[120:123], a[224:227], a[48:51], v[120:123]
    ds_read_b64_tr_b16 a[254:255], v63 offset:63488
    ds_read_b64_tr_b16 a[212:213], v56 offset:45056
    v_mfma_f32_16x16x32_bf16 v[120:123], a[228:231], a[52:55], v[120:123]
    s_waitcnt lgkmcnt(12)
    ds_read_b64_tr_b16 a[192:193], v56 offset:32768
    ds_read_b64_tr_b16 a[214:215], v56 offset:47104
    v_mfma_f32_16x16x32_bf16 v[116:119], a[232:235], a[32:35], v[116:119]
    s_waitcnt lgkmcnt(13)
    ds_read_b64_tr_b16 a[194:195], v56 offset:34816
    ds_read_b64_tr_b16 a[216:217], v57 offset:40960
    v_mfma_f32_16x16x32_bf16 v[116:119], a[236:239], a[36:39], v[116:119]
    ds_read_b64_tr_b16 a[196:197], v56 offset:36864
    ds_read_b64_tr_b16 a[218:219], v57 offset:43008
    v_mfma_f32_16x16x32_bf16 v[124:127], a[232:235], a[48:51], v[124:127]
    ds_read_b64_tr_b16 a[198:199], v56 offset:38912
    ds_read_b64_tr_b16 a[220:221], v57 offset:45056
    v_mfma_f32_16x16x32_bf16 v[124:127], a[236:239], a[52:55], v[124:127]
    s_waitcnt lgkmcnt(15)
    ds_read_b64_tr_b16 a[200:201], v57 offset:32768
    ds_read_b64_tr_b16 a[222:223], v57 offset:47104
    v_mfma_f32_16x16x32_bf16 v[112:115], a[240:243], a[40:43], v[112:115]
    ds_read_b64_tr_b16 a[202:203], v57 offset:34816
    v_mfma_f32_16x16x32_bf16 v[112:115], a[244:247], a[44:47], v[112:115]
    ds_read_b64_tr_b16 a[204:205], v57 offset:36864
    v_mfma_f32_16x16x32_bf16 v[120:123], a[240:243], a[56:59], v[120:123]
    s_waitcnt lgkmcnt(15)
    s_xor_b32 s74, s24, 16384
    ds_read_b64_tr_b16 a[206:207], v57 offset:38912
    v_mfma_f32_16x16x32_bf16 v[120:123], a[244:247], a[60:63], v[120:123]
    buffer_load_dwordx4 v[192:195], v1, s[8:11], s74 offen offset:0
    v_mfma_f32_16x16x32_bf16 v[116:119], a[248:251], a[40:43], v[116:119]
    s_waitcnt lgkmcnt(13)
    s_xor_b32 s74, s24, 20480
    ds_read_b64_tr_b16 a[224:225], v56 offset:49152
    v_mfma_f32_16x16x32_bf16 v[116:119], a[252:255], a[44:47], v[116:119]
    ds_read_b64_tr_b16 a[226:227], v56 offset:51200
    v_mfma_f32_16x16x32_bf16 v[124:127], a[248:251], a[56:59], v[124:127]
    ds_read_b64_tr_b16 a[228:229], v56 offset:53248
    v_mfma_f32_16x16x32_bf16 v[124:127], a[252:255], a[60:63], v[124:127]
    s_waitcnt lgkmcnt(9)
    ds_read_b64_tr_b16 a[230:231], v56 offset:55296
    v_mfma_f32_16x16x32_bf16 v[64:67], a[192:195], v[128:131], 0
    buffer_load_dwordx4 v[208:211], v1, s[8:11], s74 offen offset:0
    v_mfma_f32_16x16x32_bf16 v[64:67], a[196:199], v[132:135], v[64:67]
    s_xor_b32 s74, s24, 16384
    ds_read_b64_tr_b16 a[232:233], v57 offset:49152
    v_mfma_f32_16x16x32_bf16 v[72:75], a[192:195], v[144:147], 0
    ds_read_b64_tr_b16 a[234:235], v57 offset:51200
    v_mfma_f32_16x16x32_bf16 v[72:75], a[196:199], v[148:151], v[72:75]
    s_waitcnt lgkmcnt(7)
    ds_read_b64_tr_b16 a[236:237], v57 offset:53248
    v_mfma_f32_16x16x32_bf16 v[68:71], a[200:203], v[128:131], 0
    s_waitcnt lgkmcnt(7)
    ds_read_b64_tr_b16 a[238:239], v57 offset:55296
    v_mfma_f32_16x16x32_bf16 v[68:71], a[204:207], v[132:135], v[68:71]
    buffer_load_dwordx4 v[196:199], v1, s[8:11], s74 offen offset:1024
    v_mfma_f32_16x16x32_bf16 v[76:79], a[200:203], v[144:147], 0
    s_xor_b32 s74, s24, 20480
    ds_read_b64_tr_b16 a[240:241], v56 offset:57344
    v_cvt_pk_bf16_f32 v112, v112, v113
    v_mfma_f32_16x16x32_bf16 v[76:79], a[204:207], v[148:151], v[76:79]
    ds_read_b64_tr_b16 a[242:243], v56 offset:59392
    v_cvt_pk_bf16_f32 v113, v114, v115
    v_mfma_f32_16x16x32_bf16 v[64:67], a[208:211], v[136:139], v[64:67]
    ds_read_b64_tr_b16 a[244:245], v56 offset:61440
    v_cvt_pk_bf16_f32 v114, v116, v117
    v_mfma_f32_16x16x32_bf16 v[64:67], a[212:215], v[140:143], v[64:67]
    ds_read_b64_tr_b16 a[246:247], v56 offset:63488
    v_cvt_pk_bf16_f32 v115, v118, v119
    v_mfma_f32_16x16x32_bf16 v[72:75], a[208:211], v[152:155], v[72:75]
    buffer_load_dwordx4 v[212:215], v1, s[8:11], s74 offen offset:1024
    v_mfma_f32_16x16x32_bf16 v[72:75], a[212:215], v[156:159], v[72:75]
    s_xor_b32 s74, s24, 16384
    ds_read_b64_tr_b16 a[248:249], v57 offset:57344
    v_min_u32 v112, -2, v112
    v_mfma_f32_16x16x32_bf16 v[68:71], a[216:219], v[136:139], v[68:71]
    ds_read_b64_tr_b16 a[250:251], v57 offset:59392
    v_min_u32 v113, -2, v113
    v_mfma_f32_16x16x32_bf16 v[68:71], a[220:223], v[140:143], v[68:71]
    ds_read_b64_tr_b16 a[252:253], v57 offset:61440
    v_min_u32 v114, -2, v114
    v_mfma_f32_16x16x32_bf16 v[76:79], a[216:219], v[152:155], v[76:79]
    s_waitcnt vmcnt(13) lgkmcnt(7)
    ds_read_b64_tr_b16 a[254:255], v57 offset:63488
    v_min_u32 v115, -2, v115
    v_mfma_f32_16x16x32_bf16 v[76:79], a[220:223], v[156:159], v[76:79]
    buffer_load_dwordx4 v[200:203], v1, s[8:11], s74 offen offset:2048
    v_mfma_f32_16x16x32_bf16 v[64:67], a[224:227], v[160:163], v[64:67]
    s_waitcnt vmcnt(12)
    s_xor_b32 s74, s24, 20480
    ds_read_b64_tr_b16 a[192:193], v58 offset:32768
    v_mfma_f32_16x16x32_bf16 v[64:67], a[228:231], v[164:167], v[64:67]
    s_waitcnt vmcnt(10)
    s_add_u32 s75, s18, 0
    ds_read_b64_tr_b16 a[194:195], v58 offset:34816
    v_mfma_f32_16x16x32_bf16 v[72:75], a[224:227], v[176:179], v[72:75]
    buffer_store_dwordx4 v[112:115], v23, s[8:11], s75 offen offset:768 sc0 sc1
    v_mfma_f32_16x16x32_bf16 v[72:75], a[228:231], v[180:183], v[72:75]
    ds_read_b64_tr_b16 a[196:197], v58 offset:36864
    v_cvt_pk_bf16_f32 v120, v120, v121
    v_mfma_f32_16x16x32_bf16 v[68:71], a[232:235], v[160:163], v[68:71]
    buffer_load_dwordx4 v[216:219], v1, s[8:11], s74 offen offset:2048
    ds_read_b64_tr_b16 a[198:199], v58 offset:38912
    v_mfma_f32_16x16x32_bf16 v[68:71], a[236:239], v[164:167], v[68:71]
    s_xor_b32 s74, s24, 16384
    ds_read_b64_tr_b16 a[200:201], v59 offset:32768
    v_cvt_pk_bf16_f32 v121, v122, v123
    v_mfma_f32_16x16x32_bf16 v[76:79], a[232:235], v[176:179], v[76:79]
    ds_read_b64_tr_b16 a[202:203], v59 offset:34816
    v_cvt_pk_bf16_f32 v122, v124, v125
    v_mfma_f32_16x16x32_bf16 v[76:79], a[236:239], v[180:183], v[76:79]
    s_waitcnt vmcnt(11) lgkmcnt(7)
    ds_read_b64_tr_b16 a[204:205], v59 offset:36864
    v_cvt_pk_bf16_f32 v123, v126, v127
    v_mfma_f32_16x16x32_bf16 v[64:67], a[240:243], v[168:171], v[64:67]
    s_waitcnt vmcnt(9)
    ds_read_b64_tr_b16 a[206:207], v59 offset:38912
    v_min_u32 v120, -2, v120
    v_mfma_f32_16x16x32_bf16 v[64:67], a[244:247], v[172:175], v[64:67]
    buffer_load_dwordx4 v[204:207], v1, s[8:11], s74 offen offset:3072
    v_mfma_f32_16x16x32_bf16 v[72:75], a[240:243], v[184:187], v[72:75]
    s_waitcnt vmcnt(8)
    s_xor_b32 s74, s24, 20480
    ds_read_b64_tr_b16 a[208:209], v58 offset:40960
    v_min_u32 v121, -2, v121
    v_mfma_f32_16x16x32_bf16 v[72:75], a[244:247], v[188:191], v[72:75]
    ds_read_b64_tr_b16 a[210:211], v58 offset:43008
    v_min_u32 v122, -2, v122
    v_mfma_f32_16x16x32_bf16 v[68:71], a[248:251], v[168:171], v[68:71]
    s_waitcnt lgkmcnt(8)
    ds_read_b64_tr_b16 a[212:213], v58 offset:45056
    v_min_u32 v123, -2, v123
    v_mfma_f32_16x16x32_bf16 v[68:71], a[252:255], v[172:175], v[68:71]
    s_add_u32 s75, s18, 131072
    ds_read_b64_tr_b16 a[214:215], v58 offset:47104
    v_mfma_f32_16x16x32_bf16 v[76:79], a[248:251], v[184:187], v[76:79]
    buffer_load_dwordx4 v[220:223], v1, s[8:11], s74 offen offset:3072
    ds_read_b64_tr_b16 a[216:217], v59 offset:40960
    v_mfma_f32_16x16x32_bf16 v[76:79], a[252:255], v[188:191], v[76:79]
    s_waitcnt lgkmcnt(8)
    s_xor_b32 s74, s24, 24576
    ds_read_b64_tr_b16 a[218:219], v59 offset:43008
    v_mfma_f32_16x16x32_bf16 v[80:83], a[192:195], v[128:131], 0
    buffer_store_dwordx4 v[120:123], v23, s[8:11], s75 offen offset:768 sc0 sc1
    ds_read_b64_tr_b16 a[220:221], v59 offset:45056
    v_mfma_f32_16x16x32_bf16 v[80:83], a[196:199], v[132:135], v[80:83]
    ds_read_b64_tr_b16 a[222:223], v59 offset:47104
    v_mfma_f32_16x16x32_bf16 v[88:91], a[192:195], v[144:147], 0
    s_waitcnt lgkmcnt(8)
    ds_read_b64_tr_b16 a[224:225], v58 offset:49152
    v_mfma_f32_16x16x32_bf16 v[88:91], a[196:199], v[148:151], v[88:91]
    buffer_load_dwordx4 v[224:227], v1, s[8:11], s74 offen offset:0
    ds_read_b64_tr_b16 a[226:227], v58 offset:51200
    v_mfma_f32_16x16x32_bf16 v[84:87], a[200:203], v[128:131], 0
    s_xor_b32 s74, s24, 28672
    ds_read_b64_tr_b16 a[228:229], v58 offset:53248
    v_mfma_f32_16x16x32_bf16 v[84:87], a[204:207], v[132:135], v[84:87]
    ds_read_b64_tr_b16 a[230:231], v58 offset:55296
    v_mfma_f32_16x16x32_bf16 v[92:95], a[200:203], v[144:147], 0
    ds_read_b64_tr_b16 a[232:233], v59 offset:49152
    v_mfma_f32_16x16x32_bf16 v[92:95], a[204:207], v[148:151], v[92:95]
    s_waitcnt lgkmcnt(9)
    ds_read_b64_tr_b16 a[234:235], v59 offset:51200
    v_mfma_f32_16x16x32_bf16 v[80:83], a[208:211], v[136:139], v[80:83]
    buffer_load_dwordx4 v[240:243], v1, s[8:11], s74 offen offset:0
    ds_read_b64_tr_b16 a[236:237], v59 offset:53248
    v_mfma_f32_16x16x32_bf16 v[80:83], a[212:215], v[140:143], v[80:83]
    s_xor_b32 s74, s24, 24576
    ds_read_b64_tr_b16 a[238:239], v59 offset:55296
    v_mfma_f32_16x16x32_bf16 v[88:91], a[208:211], v[152:155], v[88:91]
    ds_read_b64_tr_b16 a[240:241], v58 offset:57344
    v_mfma_f32_16x16x32_bf16 v[88:91], a[212:215], v[156:159], v[88:91]
    s_waitcnt lgkmcnt(9)
    ds_read_b64_tr_b16 a[242:243], v58 offset:59392
    v_mfma_f32_16x16x32_bf16 v[84:87], a[216:219], v[136:139], v[84:87]
    ds_read_b64_tr_b16 a[244:245], v58 offset:61440
    v_mfma_f32_16x16x32_bf16 v[84:87], a[220:223], v[140:143], v[84:87]
    buffer_load_dwordx4 v[228:231], v1, s[8:11], s74 offen offset:1024
    ds_read_b64_tr_b16 a[246:247], v58 offset:63488
    v_mfma_f32_16x16x32_bf16 v[92:95], a[216:219], v[152:155], v[92:95]
    s_xor_b32 s74, s24, 28672
    ds_read_b64_tr_b16 a[248:249], v59 offset:57344
    v_mfma_f32_16x16x32_bf16 v[92:95], a[220:223], v[156:159], v[92:95]
    s_waitcnt lgkmcnt(9)
    ds_read_b64_tr_b16 a[250:251], v59 offset:59392
    v_mfma_f32_16x16x32_bf16 v[80:83], a[224:227], v[160:163], v[80:83]
    ds_read_b64_tr_b16 a[252:253], v59 offset:61440
    v_mfma_f32_16x16x32_bf16 v[80:83], a[228:231], v[164:167], v[80:83]
    ds_read_b64_tr_b16 a[254:255], v59 offset:63488
    v_mfma_f32_16x16x32_bf16 v[88:91], a[224:227], v[176:179], v[88:91]
    buffer_load_dwordx4 v[244:247], v1, s[8:11], s74 offen offset:1024
    v_mfma_f32_16x16x32_bf16 v[88:91], a[228:231], v[180:183], v[88:91]
    s_waitcnt lgkmcnt(8)
    s_xor_b32 s74, s24, 24576
    ds_read_b64_tr_b16 a[192:193], v56 offset:0
    v_mfma_f32_16x16x32_bf16 v[84:87], a[232:235], v[160:163], v[84:87]
    ds_read_b64_tr_b16 a[194:195], v56 offset:2048
    v_mfma_f32_16x16x32_bf16 v[84:87], a[236:239], v[164:167], v[84:87]
    ds_read_b64_tr_b16 a[196:197], v56 offset:4096
    v_mfma_f32_16x16x32_bf16 v[92:95], a[232:235], v[176:179], v[92:95]
    s_waitcnt lgkmcnt(8)
    ds_read_b64_tr_b16 a[198:199], v56 offset:6144
    v_mfma_f32_16x16x32_bf16 v[92:95], a[236:239], v[180:183], v[92:95]
    buffer_load_dwordx4 v[232:235], v1, s[8:11], s74 offen offset:2048
    ds_read_b64_tr_b16 a[200:201], v57 offset:0
    v_mfma_f32_16x16x32_bf16 v[80:83], a[240:243], v[168:171], v[80:83]
    s_waitcnt lgkmcnt(8)
    s_xor_b32 s74, s24, 28672
    ds_read_b64_tr_b16 a[202:203], v57 offset:2048
    v_mfma_f32_16x16x32_bf16 v[80:83], a[244:247], v[172:175], v[80:83]
    ds_read_b64_tr_b16 a[204:205], v57 offset:4096
    v_mfma_f32_16x16x32_bf16 v[88:91], a[240:243], v[184:187], v[88:91]
    ds_read_b64_tr_b16 a[206:207], v57 offset:6144
    v_mfma_f32_16x16x32_bf16 v[88:91], a[244:247], v[188:191], v[88:91]
    s_waitcnt lgkmcnt(8)
    ds_read_b64_tr_b16 a[208:209], v56 offset:8192
    v_mfma_f32_16x16x32_bf16 v[84:87], a[248:251], v[168:171], v[84:87]
    buffer_load_dwordx4 v[248:251], v1, s[8:11], s74 offen offset:2048
    ds_read_b64_tr_b16 a[210:211], v56 offset:10240
    v_mfma_f32_16x16x32_bf16 v[84:87], a[252:255], v[172:175], v[84:87]
    s_xor_b32 s74, s24, 24576
    ds_read_b64_tr_b16 a[212:213], v56 offset:12288
    v_mfma_f32_16x16x32_bf16 v[92:95], a[248:251], v[184:187], v[92:95]
    ds_read_b64_tr_b16 a[214:215], v56 offset:14336
    v_mfma_f32_16x16x32_bf16 v[92:95], a[252:255], v[188:191], v[92:95]
    s_waitcnt lgkmcnt(9)
    ds_read_b64_tr_b16 a[216:217], v57 offset:8192
    v_mfma_f32_16x16x32_bf16 v[96:99], a[192:195], v[128:131], 0
    s_waitcnt lgkmcnt(9)
    ds_read_b64_tr_b16 a[218:219], v57 offset:10240
    v_mfma_f32_16x16x32_bf16 v[96:99], a[196:199], v[132:135], v[96:99]
    buffer_load_dwordx4 v[236:239], v1, s[8:11], s74 offen offset:3072
    ds_read_b64_tr_b16 a[220:221], v57 offset:12288
    v_mfma_f32_16x16x32_bf16 v[104:107], a[192:195], v[144:147], 0
    s_xor_b32 s74, s24, 28672
    ds_read_b64_tr_b16 a[222:223], v57 offset:14336
    v_mfma_f32_16x16x32_bf16 v[104:107], a[196:199], v[148:151], v[104:107]
    s_waitcnt lgkmcnt(9)
    ds_read_b64_tr_b16 a[224:225], v56 offset:16384
    v_mfma_f32_16x16x32_bf16 v[100:103], a[200:203], v[128:131], 0
    s_waitcnt lgkmcnt(9)
    ds_read_b64_tr_b16 a[226:227], v56 offset:18432
    v_mfma_f32_16x16x32_bf16 v[100:103], a[204:207], v[132:135], v[100:103]
    ds_read_b64_tr_b16 a[228:229], v56 offset:20480
    v_mfma_f32_16x16x32_bf16 v[108:111], a[200:203], v[144:147], 0
    buffer_load_dwordx4 v[252:255], v1, s[8:11], s74 offen offset:3072
    ds_read_b64_tr_b16 a[230:231], v56 offset:22528
    v_mfma_f32_16x16x32_bf16 v[108:111], a[204:207], v[148:151], v[108:111]
    s_waitcnt lgkmcnt(9)
    ds_read_b64_tr_b16 a[232:233], v57 offset:16384
    v_mfma_f32_16x16x32_bf16 v[96:99], a[208:211], v[136:139], v[96:99]
    s_waitcnt lgkmcnt(9)
    ds_read_b64_tr_b16 a[234:235], v57 offset:18432
    v_mfma_f32_16x16x32_bf16 v[96:99], a[212:215], v[140:143], v[96:99]
    ds_read_b64_tr_b16 a[236:237], v57 offset:20480
    v_mfma_f32_16x16x32_bf16 v[104:107], a[208:211], v[152:155], v[104:107]
    ds_read_b64_tr_b16 a[238:239], v57 offset:22528
    v_mfma_f32_16x16x32_bf16 v[104:107], a[212:215], v[156:159], v[104:107]
    s_waitcnt lgkmcnt(9)
    ds_read_b64_tr_b16 a[240:241], v56 offset:24576
    v_mfma_f32_16x16x32_bf16 v[100:103], a[216:219], v[136:139], v[100:103]
    s_waitcnt lgkmcnt(9)
    ds_read_b64_tr_b16 a[242:243], v56 offset:26624
    v_mfma_f32_16x16x32_bf16 v[100:103], a[220:223], v[140:143], v[100:103]
    ds_read_b64_tr_b16 a[244:245], v56 offset:28672
    v_mfma_f32_16x16x32_bf16 v[108:111], a[216:219], v[152:155], v[108:111]
    ds_read_b64_tr_b16 a[246:247], v56 offset:30720
    v_mfma_f32_16x16x32_bf16 v[108:111], a[220:223], v[156:159], v[108:111]
    s_waitcnt lgkmcnt(9)
    ds_read_b64_tr_b16 a[248:249], v57 offset:24576
    v_mfma_f32_16x16x32_bf16 v[96:99], a[224:227], v[160:163], v[96:99]
    s_waitcnt lgkmcnt(9)
    ds_read_b64_tr_b16 a[250:251], v57 offset:26624
    v_mfma_f32_16x16x32_bf16 v[96:99], a[228:231], v[164:167], v[96:99]
    ds_read_b64_tr_b16 a[252:253], v57 offset:28672
    v_mfma_f32_16x16x32_bf16 v[104:107], a[224:227], v[176:179], v[104:107]
    ds_read_b64_tr_b16 a[254:255], v57 offset:30720
    v_mfma_f32_16x16x32_bf16 v[104:107], a[228:231], v[180:183], v[104:107]
    s_waitcnt lgkmcnt(8)
    ds_read_b64_tr_b16 a[192:193], v58 offset:0
    v_mfma_f32_16x16x32_bf16 v[100:103], a[232:235], v[160:163], v[100:103]
    buffer_load_dwordx2 v[32:33], v45, s[32:35], s100 offen
    ds_read_b64_tr_b16 a[194:195], v58 offset:2048
    v_mfma_f32_16x16x32_bf16 v[100:103], a[236:239], v[164:167], v[100:103]
    ds_read_b64_tr_b16 a[196:197], v58 offset:4096
    v_mfma_f32_16x16x32_bf16 v[108:111], a[232:235], v[176:179], v[108:111]
    ds_read_b64_tr_b16 a[198:199], v58 offset:6144
    v_mfma_f32_16x16x32_bf16 v[108:111], a[236:239], v[180:183], v[108:111]
    s_waitcnt lgkmcnt(8)
    ds_read_b64_tr_b16 a[200:201], v59 offset:0
    v_mfma_f32_16x16x32_bf16 v[96:99], a[240:243], v[168:171], v[96:99]
    buffer_load_dwordx2 v[34:35], v45, s[32:35], s100 offen offset:32
    ds_read_b64_tr_b16 a[202:203], v59 offset:2048
    v_mfma_f32_16x16x32_bf16 v[96:99], a[244:247], v[172:175], v[96:99]
    ds_read_b64_tr_b16 a[204:205], v59 offset:4096
    v_mfma_f32_16x16x32_bf16 v[104:107], a[240:243], v[184:187], v[104:107]
    ds_read_b64_tr_b16 a[206:207], v59 offset:6144
    v_mfma_f32_16x16x32_bf16 v[104:107], a[244:247], v[188:191], v[104:107]
    s_waitcnt lgkmcnt(8)
    ds_read_b64_tr_b16 a[208:209], v58 offset:8192
    v_mfma_f32_16x16x32_bf16 v[100:103], a[248:251], v[168:171], v[100:103]
    buffer_load_dwordx2 v[36:37], v45, s[32:35], s101 offen
    ds_read_b64_tr_b16 a[210:211], v58 offset:10240
    v_mfma_f32_16x16x32_bf16 v[100:103], a[252:255], v[172:175], v[100:103]
    ds_read_b64_tr_b16 a[212:213], v58 offset:12288
    v_mfma_f32_16x16x32_bf16 v[108:111], a[248:251], v[184:187], v[108:111]
    ds_read_b64_tr_b16 a[214:215], v58 offset:14336
    v_mfma_f32_16x16x32_bf16 v[108:111], a[252:255], v[188:191], v[108:111]
    s_waitcnt lgkmcnt(8)
    ds_read_b64_tr_b16 a[216:217], v59 offset:8192
    v_mfma_f32_16x16x32_bf16 v[112:115], a[192:195], v[128:131], 0
    buffer_load_dwordx2 v[38:39], v45, s[32:35], s101 offen offset:32
    ds_read_b64_tr_b16 a[218:219], v59 offset:10240
    v_mfma_f32_16x16x32_bf16 v[112:115], a[196:199], v[132:135], v[112:115]
    ds_read_b64_tr_b16 a[220:221], v59 offset:12288
    v_mfma_f32_16x16x32_bf16 v[120:123], a[192:195], v[144:147], 0
    ds_read_b64_tr_b16 a[222:223], v59 offset:14336
    v_mfma_f32_16x16x32_bf16 v[120:123], a[196:199], v[148:151], v[120:123]
    s_waitcnt lgkmcnt(8)
    ds_read_b64_tr_b16 a[224:225], v58 offset:16384
    v_mfma_f32_16x16x32_bf16 v[116:119], a[200:203], v[128:131], 0
    buffer_load_dwordx2 v[40:41], v45, s[56:59], 0 offen
    ds_read_b64_tr_b16 a[226:227], v58 offset:18432
    v_mfma_f32_16x16x32_bf16 v[116:119], a[204:207], v[132:135], v[116:119]
    ds_read_b64_tr_b16 a[228:229], v58 offset:20480
    v_mfma_f32_16x16x32_bf16 v[124:127], a[200:203], v[144:147], 0
    ds_read_b64_tr_b16 a[230:231], v58 offset:22528
    v_mfma_f32_16x16x32_bf16 v[124:127], a[204:207], v[148:151], v[124:127]
    s_waitcnt lgkmcnt(8)
    ds_read_b64_tr_b16 a[232:233], v59 offset:16384
    v_mfma_f32_16x16x32_bf16 v[112:115], a[208:211], v[136:139], v[112:115]
    buffer_load_dwordx2 v[42:43], v45, s[56:59], 0 offen offset:32
    ds_read_b64_tr_b16 a[234:235], v59 offset:18432
    v_mfma_f32_16x16x32_bf16 v[112:115], a[212:215], v[140:143], v[112:115]
    ds_read_b64_tr_b16 a[236:237], v59 offset:20480
    v_mfma_f32_16x16x32_bf16 v[120:123], a[208:211], v[152:155], v[120:123]
    ds_read_b64_tr_b16 a[238:239], v59 offset:22528
    v_mfma_f32_16x16x32_bf16 v[120:123], a[212:215], v[156:159], v[120:123]
    s_waitcnt lgkmcnt(9)
    ds_read_b64_tr_b16 a[240:241], v58 offset:24576
    v_mfma_f32_16x16x32_bf16 v[116:119], a[216:219], v[136:139], v[116:119]
    s_waitcnt lgkmcnt(9)
    ds_read_b64_tr_b16 a[242:243], v58 offset:26624
    v_mfma_f32_16x16x32_bf16 v[116:119], a[220:223], v[140:143], v[116:119]
    ds_read_b64_tr_b16 a[244:245], v58 offset:28672
    v_mfma_f32_16x16x32_bf16 v[124:127], a[216:219], v[152:155], v[124:127]
    ds_read_b64_tr_b16 a[246:247], v58 offset:30720
    v_mfma_f32_16x16x32_bf16 v[124:127], a[220:223], v[156:159], v[124:127]
    s_waitcnt lgkmcnt(9)
    ds_read_b64_tr_b16 a[248:249], v59 offset:24576
    v_mfma_f32_16x16x32_bf16 v[112:115], a[224:227], v[160:163], v[112:115]
    s_waitcnt lgkmcnt(9)
    ds_read_b64_tr_b16 a[250:251], v59 offset:26624
    v_mfma_f32_16x16x32_bf16 v[112:115], a[228:231], v[164:167], v[112:115]
    ds_read_b64_tr_b16 a[252:253], v59 offset:28672
    v_mfma_f32_16x16x32_bf16 v[120:123], a[224:227], v[176:179], v[120:123]
    ds_read_b64_tr_b16 a[254:255], v59 offset:30720
    v_mfma_f32_16x16x32_bf16 v[120:123], a[228:231], v[180:183], v[120:123]
    s_waitcnt lgkmcnt(9)
    ds_read_b64_tr_b16 a[192:193], v60 offset:0
    v_mfma_f32_16x16x32_bf16 v[116:119], a[232:235], v[160:163], v[116:119]
    s_waitcnt lgkmcnt(9)
    ds_read_b64_tr_b16 a[194:195], v60 offset:2048
    v_mfma_f32_16x16x32_bf16 v[116:119], a[236:239], v[164:167], v[116:119]
    ds_read_b64_tr_b16 a[196:197], v60 offset:4096
    v_mfma_f32_16x16x32_bf16 v[124:127], a[232:235], v[176:179], v[124:127]
    ds_read_b64_tr_b16 a[198:199], v60 offset:6144
    v_mfma_f32_16x16x32_bf16 v[124:127], a[236:239], v[180:183], v[124:127]
    s_waitcnt lgkmcnt(9)
    ds_read_b64_tr_b16 a[200:201], v61 offset:0
    v_mfma_f32_16x16x32_bf16 v[112:115], a[240:243], v[168:171], v[112:115]
    s_waitcnt lgkmcnt(9)
    ds_read_b64_tr_b16 a[202:203], v61 offset:2048
    ds_read_b64_tr_b16 a[224:225], v60 offset:16384
    v_mfma_f32_16x16x32_bf16 v[112:115], a[244:247], v[172:175], v[112:115]
    ds_read_b64_tr_b16 a[204:205], v61 offset:4096
    ds_read_b64_tr_b16 a[226:227], v60 offset:18432
    v_mfma_f32_16x16x32_bf16 v[120:123], a[240:243], v[184:187], v[120:123]
    ds_read_b64_tr_b16 a[206:207], v61 offset:6144
    ds_read_b64_tr_b16 a[228:229], v60 offset:20480
    v_mfma_f32_16x16x32_bf16 v[120:123], a[244:247], v[188:191], v[120:123]
    s_waitcnt lgkmcnt(12)
    ds_read_b64_tr_b16 a[208:209], v60 offset:8192
    ds_read_b64_tr_b16 a[230:231], v60 offset:22528
    v_mfma_f32_16x16x32_bf16 v[116:119], a[248:251], v[168:171], v[116:119]
    s_waitcnt lgkmcnt(13)
    ds_read_b64_tr_b16 a[210:211], v60 offset:10240
    ds_read_b64_tr_b16 a[232:233], v61 offset:16384
    v_mfma_f32_16x16x32_bf16 v[116:119], a[252:255], v[172:175], v[116:119]
    ds_read_b64_tr_b16 a[212:213], v60 offset:12288
    ds_read_b64_tr_b16 a[234:235], v61 offset:18432
    v_mfma_f32_16x16x32_bf16 v[124:127], a[248:251], v[184:187], v[124:127]
    ds_read_b64_tr_b16 a[214:215], v60 offset:14336
    ds_read_b64_tr_b16 a[236:237], v61 offset:20480
    v_mfma_f32_16x16x32_bf16 v[124:127], a[252:255], v[188:191], v[124:127]
    s_waitcnt vmcnt(23) lgkmcnt(15)
    ds_read_b64_tr_b16 a[216:217], v61 offset:8192
    ds_read_b64_tr_b16 a[238:239], v61 offset:22528
    v_mfma_f32_16x16x32_bf16 v[64:67], a[192:195], v[192:195], v[64:67]
    s_waitcnt vmcnt(21)
    ds_read_b64_tr_b16 a[218:219], v61 offset:10240
    v_mfma_f32_16x16x32_bf16 v[64:67], a[196:199], v[196:199], v[64:67]
    ds_read_b64_tr_b16 a[220:221], v61 offset:12288
    v_mfma_f32_16x16x32_bf16 v[72:75], a[192:195], v[208:211], v[72:75]
    s_waitcnt vmcnt(20) lgkmcnt(15)
    s_mov_b32 s74, 8192
    ds_read_b64_tr_b16 a[222:223], v61 offset:14336
    v_mfma_f32_16x16x32_bf16 v[72:75], a[196:199], v[212:215], v[72:75]
    buffer_load_dwordx4 v[168:171], v46, s[8:11], s74 offen
    v_mfma_f32_16x16x32_bf16 v[68:71], a[200:203], v[192:195], v[68:71]
    s_waitcnt lgkmcnt(13)
    ds_read_b64_tr_b16 a[240:241], v60 offset:24576
    v_mfma_f32_16x16x32_bf16 v[68:71], a[204:207], v[196:199], v[68:71]
    ds_read_b64_tr_b16 a[242:243], v60 offset:26624
    v_mfma_f32_16x16x32_bf16 v[76:79], a[200:203], v[208:211], v[76:79]
    buffer_load_dwordx4 v[172:175], v46, s[8:11], s74 offen offset:64
    v_mfma_f32_16x16x32_bf16 v[76:79], a[204:207], v[212:215], v[76:79]
    s_waitcnt vmcnt(21) lgkmcnt(9)
    s_mov_b32 s74, 6144
    ds_read_b64_tr_b16 a[244:245], v60 offset:28672
    v_mfma_f32_16x16x32_bf16 v[64:67], a[208:211], v[200:203], v[64:67]
    s_waitcnt vmcnt(18) lgkmcnt(8)
    ds_read_b64_tr_b16 a[246:247], v60 offset:30720
    v_mfma_f32_16x16x32_bf16 v[64:67], a[212:215], v[204:207], v[64:67]
    buffer_load_dwordx4 v[176:179], v46, s[8:11], s74 offen
    v_mfma_f32_16x16x32_bf16 v[72:75], a[208:211], v[216:219], v[72:75]
    s_waitcnt vmcnt(18)
    ds_read_b64_tr_b16 a[248:249], v61 offset:24576
    v_mfma_f32_16x16x32_bf16 v[72:75], a[212:215], v[220:223], v[72:75]
    s_waitcnt lgkmcnt(5)
    ds_read_b64_tr_b16 a[250:251], v61 offset:26624
    v_mfma_f32_16x16x32_bf16 v[68:71], a[216:219], v[200:203], v[68:71]
    buffer_load_dwordx4 v[180:183], v46, s[8:11], s74 offen offset:64
    ds_read_b64_tr_b16 a[252:253], v61 offset:28672
    v_mfma_f32_16x16x32_bf16 v[68:71], a[220:223], v[204:207], v[68:71]
    s_add_u32 s74, s70, 0
    ds_read_b64_tr_b16 a[254:255], v61 offset:30720
    v_mfma_f32_16x16x32_bf16 v[76:79], a[216:219], v[216:219], v[76:79]
    s_waitcnt vmcnt(17)
    ds_read_b64_tr_b16 a[192:193], v62 offset:0
    v_mfma_f32_16x16x32_bf16 v[76:79], a[220:223], v[220:223], v[76:79]
    buffer_load_dwordx4 v[128:131], v44, s[8:11], s74 offen sc0 sc1
    v_mfma_f32_16x16x32_bf16 v[64:67], a[224:227], v[224:227], v[64:67]
    s_waitcnt vmcnt(16)
    s_add_u32 s74, s70, 4096
    ds_read_b64_tr_b16 a[194:195], v62 offset:2048
    s_waitcnt vmcnt(6)
    v_lshlrev_b32 v48, 16, v40
    v_mfma_f32_16x16x32_bf16 v[64:67], a[228:231], v[228:231], v[64:67]
    ds_read_b64_tr_b16 a[196:197], v62 offset:4096
    v_and_b32 v49, 0xffff0000, v40
    v_mfma_f32_16x16x32_bf16 v[72:75], a[224:227], v[240:243], v[72:75]
    buffer_load_dwordx4 v[132:135], v44, s[8:11], s74 offen sc0 sc1
    v_mfma_f32_16x16x32_bf16 v[72:75], a[228:231], v[244:247], v[72:75]
    s_add_u32 s74, s70, 8192
    ds_read_b64_tr_b16 a[198:199], v62 offset:6144
    v_lshlrev_b32 v50, 16, v41
    v_mfma_f32_16x16x32_bf16 v[68:71], a[232:235], v[224:227], v[68:71]
    ds_read_b64_tr_b16 a[200:201], v63 offset:0
    v_and_b32 v51, 0xffff0000, v41
    v_mfma_f32_16x16x32_bf16 v[68:71], a[236:239], v[228:231], v[68:71]
    buffer_load_dwordx4 v[136:139], v44, s[8:11], s74 offen sc0 sc1
    ds_read_b64_tr_b16 a[202:203], v63 offset:2048
    v_mfma_f32_16x16x32_bf16 v[76:79], a[232:235], v[240:243], v[76:79]
    s_add_u32 s74, s70, 12288
    ds_read_b64_tr_b16 a[204:205], v63 offset:4096
    s_waitcnt vmcnt(7)
    v_lshlrev_b32 v52, 16, v42
    v_mfma_f32_16x16x32_bf16 v[76:79], a[236:239], v[244:247], v[76:79]
    s_waitcnt lgkmcnt(7)
    ds_read_b64_tr_b16 a[206:207], v63 offset:6144
    v_and_b32 v53, 0xffff0000, v42
    v_mfma_f32_16x16x32_bf16 v[64:67], a[240:243], v[232:235], v[64:67]
    buffer_load_dwordx4 v[140:143], v44, s[8:11], s74 offen sc0 sc1
    v_mfma_f32_16x16x32_bf16 v[64:67], a[244:247], v[236:239], v[64:67]
    s_add_u32 s74, s70, 16384
    ds_read_b64_tr_b16 a[208:209], v62 offset:8192
    v_lshlrev_b32 v54, 16, v43
    v_mfma_f32_16x16x32_bf16 v[72:75], a[240:243], v[248:251], v[72:75]
    ds_read_b64_tr_b16 a[210:211], v62 offset:10240
    v_and_b32 v55, 0xffff0000, v43
    v_mfma_f32_16x16x32_bf16 v[72:75], a[244:247], v[252:255], v[72:75]
    buffer_load_dwordx4 v[144:147], v44, s[8:11], s74 offen sc0 sc1
    ds_read_b64_tr_b16 a[212:213], v62 offset:12288
    v_mfma_f32_16x16x32_bf16 v[68:71], a[248:251], v[232:235], v[68:71]
    s_add_u32 s74, s70, 20480
    ds_read_b64_tr_b16 a[214:215], v62 offset:14336
    v_mfma_f32_16x16x32_bf16 v[68:71], a[252:255], v[236:239], v[68:71]
    ds_read_b64_tr_b16 a[216:217], v63 offset:8192
    v_mfma_f32_16x16x32_bf16 v[76:79], a[248:251], v[248:251], v[76:79]
    buffer_load_dwordx4 v[148:151], v44, s[8:11], s74 offen sc0 sc1
    ds_read_b64_tr_b16 a[218:219], v63 offset:10240
    v_mfma_f32_16x16x32_bf16 v[76:79], a[252:255], v[252:255], v[76:79]
    s_waitcnt lgkmcnt(8)
    s_add_u32 s74, s70, 24576
    ds_read_b64_tr_b16 a[220:221], v63 offset:12288
    v_mfma_f32_16x16x32_bf16 v[80:83], a[192:195], v[192:195], v[80:83]
    ds_read_b64_tr_b16 a[222:223], v63 offset:14336
    v_mfma_f32_16x16x32_bf16 v[80:83], a[196:199], v[196:199], v[80:83]
    buffer_load_dwordx4 v[152:155], v44, s[8:11], s74 offen sc0 sc1
    v_mfma_f32_16x16x32_bf16 v[88:91], a[192:195], v[208:211], v[88:91]
    s_add_u32 s74, s70, 28672
    ds_read_b64_tr_b16 a[224:225], v62 offset:16384
    v_mfma_f32_16x16x32_bf16 v[88:91], a[196:199], v[212:215], v[88:91]
    s_waitcnt lgkmcnt(8)
    ds_read_b64_tr_b16 a[226:227], v62 offset:18432
    v_mfma_f32_16x16x32_bf16 v[84:87], a[200:203], v[192:195], v[84:87]
    buffer_load_dwordx4 v[156:159], v44, s[8:11], s74 offen sc0 sc1
    ds_read_b64_tr_b16 a[228:229], v62 offset:20480
    v_mfma_f32_16x16x32_bf16 v[84:87], a[204:207], v[196:199], v[84:87]
    s_mov_b32 s74, 4096
    ds_read_b64_tr_b16 a[230:231], v62 offset:22528
    v_mfma_f32_16x16x32_bf16 v[92:95], a[200:203], v[208:211], v[92:95]
    s_waitcnt lgkmcnt(8)
    ds_read_b64_tr_b16 a[232:233], v63 offset:16384
    v_cvt_pk_bf16_f32 v64, v64, v65
    v_mfma_f32_16x16x32_bf16 v[92:95], a[204:207], v[212:215], v[92:95]
    buffer_load_dwordx4 v[160:163], v46, s[8:11], s74 offen
    ds_read_b64_tr_b16 a[234:235], v63 offset:18432
    v_mfma_f32_16x16x32_bf16 v[80:83], a[208:211], v[200:203], v[80:83]
    ds_read_b64_tr_b16 a[236:237], v63 offset:20480
    v_cvt_pk_bf16_f32 v65, v66, v67
    v_mfma_f32_16x16x32_bf16 v[80:83], a[212:215], v[204:207], v[80:83]
    ds_read_b64_tr_b16 a[238:239], v63 offset:22528
    v_cvt_pk_bf16_f32 v66, v68, v69
    v_mfma_f32_16x16x32_bf16 v[88:91], a[208:211], v[216:219], v[88:91]
    buffer_load_dwordx4 v[164:167], v46, s[8:11], s74 offen offset:64
    ds_read_b64_tr_b16 a[192:193], v60 offset:32768
    v_mfma_f32_16x16x32_bf16 v[88:91], a[212:215], v[220:223], v[88:91]
    s_waitcnt lgkmcnt(9)
    s_mov_b32 s74, 10240
    ds_read_b64_tr_b16 a[240:241], v62 offset:24576
    v_cvt_pk_bf16_f32 v67, v70, v71
    v_mfma_f32_16x16x32_bf16 v[84:87], a[216:219], v[200:203], v[84:87]
    ds_read_b64_tr_b16 a[242:243], v62 offset:26624
    v_min_u32 v64, -2, v64
    v_mfma_f32_16x16x32_bf16 v[84:87], a[220:223], v[204:207], v[84:87]
    buffer_load_dwordx4 v[184:187], v46, s[8:11], s74 offen
    ds_read_b64_tr_b16 a[244:245], v62 offset:28672
    v_mfma_f32_16x16x32_bf16 v[92:95], a[216:219], v[216:219], v[92:95]
    ds_read_b64_tr_b16 a[246:247], v62 offset:30720
    v_min_u32 v65, -2, v65
    v_mfma_f32_16x16x32_bf16 v[92:95], a[220:223], v[220:223], v[92:95]
    s_waitcnt lgkmcnt(9)
    ds_read_b64_tr_b16 a[248:249], v63 offset:24576
    v_min_u32 v66, -2, v66
    v_mfma_f32_16x16x32_bf16 v[80:83], a[224:227], v[224:227], v[80:83]
    buffer_load_dwordx4 v[188:191], v46, s[8:11], s74 offen offset:64
    ds_read_b64_tr_b16 a[250:251], v63 offset:26624
    v_mfma_f32_16x16x32_bf16 v[80:83], a[228:231], v[228:231], v[80:83]
    ds_read_b64_tr_b16 a[252:253], v63 offset:28672
    v_min_u32 v67, -2, v67
    v_mfma_f32_16x16x32_bf16 v[88:91], a[224:227], v[240:243], v[88:91]
    s_waitcnt lgkmcnt(9)
    s_add_u32 s75, s18, 8388608
    ds_read_b64_tr_b16 a[254:255], v63 offset:30720
    v_mfma_f32_16x16x32_bf16 v[88:91], a[228:231], v[244:247], v[88:91]
    buffer_store_dwordx4 v[64:67], v23, s[8:11], s75 offen offset:0 sc0 sc1
    ds_read_b64_tr_b16 a[194:195], v60 offset:34816
    v_mfma_f32_16x16x32_bf16 v[84:87], a[232:235], v[224:227], v[84:87]
    s_waitcnt lgkmcnt(9)
    ds_read_b64_tr_b16 a[196:197], v60 offset:36864
    v_cvt_pk_bf16_f32 v72, v72, v73
    v_mfma_f32_16x16x32_bf16 v[84:87], a[236:239], v[228:231], v[84:87]
    ds_read_b64_tr_b16 a[198:199], v60 offset:38912
    v_cvt_pk_bf16_f32 v73, v74, v75
    v_mfma_f32_16x16x32_bf16 v[92:95], a[232:235], v[240:243], v[92:95]
    ds_read_b64_tr_b16 a[200:201], v61 offset:32768
    v_cvt_pk_bf16_f32 v74, v76, v77
    v_mfma_f32_16x16x32_bf16 v[92:95], a[236:239], v[244:247], v[92:95]
    s_waitcnt lgkmcnt(9)
    ds_read_b64_tr_b16 a[202:203], v61 offset:34816
    v_cvt_pk_bf16_f32 v75, v78, v79
    v_mfma_f32_16x16x32_bf16 v[80:83], a[240:243], v[232:235], v[80:83]
    s_waitcnt lgkmcnt(9)
    ds_read_b64_tr_b16 a[204:205], v61 offset:36864
    v_min_u32 v72, -2, v72
    v_mfma_f32_16x16x32_bf16 v[80:83], a[244:247], v[236:239], v[80:83]
    ds_read_b64_tr_b16 a[206:207], v61 offset:38912
    v_min_u32 v73, -2, v73
    v_mfma_f32_16x16x32_bf16 v[88:91], a[240:243], v[248:251], v[88:91]
    ds_read_b64_tr_b16 a[208:209], v60 offset:40960
    v_min_u32 v74, -2, v74
    v_mfma_f32_16x16x32_bf16 v[88:91], a[244:247], v[252:255], v[88:91]
    s_waitcnt lgkmcnt(9)
    ds_read_b64_tr_b16 a[210:211], v60 offset:43008
    v_min_u32 v75, -2, v75
    v_mfma_f32_16x16x32_bf16 v[84:87], a[248:251], v[232:235], v[84:87]
    s_waitcnt lgkmcnt(9)
    s_add_u32 s75, s18, 8519680
    ds_read_b64_tr_b16 a[212:213], v60 offset:45056
    s_waitcnt vmcnt(16)
    v_mul_f32 v8, v48, v168
    v_mfma_f32_16x16x32_bf16 v[84:87], a[252:255], v[236:239], v[84:87]
    buffer_store_dwordx4 v[72:75], v23, s[8:11], s75 offen offset:0 sc0 sc1
    ds_read_b64_tr_b16 a[214:215], v60 offset:47104
    v_mfma_f32_16x16x32_bf16 v[92:95], a[248:251], v[248:251], v[92:95]
    ds_read_b64_tr_b16 a[216:217], v61 offset:40960
    v_mul_f32 v9, v49, v169
    v_mfma_f32_16x16x32_bf16 v[92:95], a[252:255], v[252:255], v[92:95]
    s_waitcnt lgkmcnt(9)
    ds_read_b64_tr_b16 a[218:219], v61 offset:43008
    v_mul_f32 v10, v50, v170
    v_mfma_f32_16x16x32_bf16 v[96:99], a[192:195], v[192:195], v[96:99]
    ds_read_b64_tr_b16 a[220:221], v61 offset:45056
    v_mul_f32 v11, v51, v171
    v_mfma_f32_16x16x32_bf16 v[96:99], a[196:199], v[196:199], v[96:99]
    ds_read_b64_tr_b16 a[222:223], v61 offset:47104
    s_waitcnt vmcnt(16)
    v_mul_f32 v12, v52, v172
    v_mfma_f32_16x16x32_bf16 v[104:107], a[192:195], v[208:211], v[104:107]
    ds_read_b64_tr_b16 a[224:225], v60 offset:49152
    v_mul_f32 v13, v53, v173
    v_mfma_f32_16x16x32_bf16 v[104:107], a[196:199], v[212:215], v[104:107]
    s_waitcnt lgkmcnt(9)
    ds_read_b64_tr_b16 a[226:227], v60 offset:51200
    v_mul_f32 v14, v54, v174
    v_mfma_f32_16x16x32_bf16 v[100:103], a[200:203], v[192:195], v[100:103]
    ds_read_b64_tr_b16 a[228:229], v60 offset:53248
    v_mul_f32 v15, v55, v175
    v_mfma_f32_16x16x32_bf16 v[100:103], a[204:207], v[196:199], v[100:103]
    ds_read_b64_tr_b16 a[230:231], v60 offset:55296
    s_waitcnt vmcnt(15)
    v_mul_f32 v16, v48, v176
    v_mfma_f32_16x16x32_bf16 v[108:111], a[200:203], v[208:211], v[108:111]
    ds_read_b64_tr_b16 a[232:233], v61 offset:49152
    v_cvt_pk_bf16_f32 v80, v80, v81
    v_mfma_f32_16x16x32_bf16 v[108:111], a[204:207], v[212:215], v[108:111]
    s_waitcnt lgkmcnt(9)
    ds_read_b64_tr_b16 a[234:235], v61 offset:51200
    v_cvt_pk_bf16_f32 v81, v82, v83
    v_mfma_f32_16x16x32_bf16 v[96:99], a[208:211], v[200:203], v[96:99]
    ds_read_b64_tr_b16 a[236:237], v61 offset:53248
    v_cvt_pk_bf16_f32 v82, v84, v85
    v_mfma_f32_16x16x32_bf16 v[96:99], a[212:215], v[204:207], v[96:99]
    ds_read_b64_tr_b16 a[238:239], v61 offset:55296
    v_cvt_pk_bf16_f32 v83, v86, v87
    v_mfma_f32_16x16x32_bf16 v[104:107], a[208:211], v[216:219], v[104:107]
    ds_read_b64_tr_b16 a[240:241], v60 offset:57344
    v_min_u32 v80, -2, v80
    v_mfma_f32_16x16x32_bf16 v[104:107], a[212:215], v[220:223], v[104:107]
    s_waitcnt lgkmcnt(9)
    ds_read_b64_tr_b16 a[242:243], v60 offset:59392
    v_min_u32 v81, -2, v81
    v_mfma_f32_16x16x32_bf16 v[100:103], a[216:219], v[200:203], v[100:103]
    ds_read_b64_tr_b16 a[244:245], v60 offset:61440
    v_min_u32 v82, -2, v82
    v_mfma_f32_16x16x32_bf16 v[100:103], a[220:223], v[204:207], v[100:103]
    ds_read_b64_tr_b16 a[246:247], v60 offset:63488
    v_min_u32 v83, -2, v83
    v_mfma_f32_16x16x32_bf16 v[108:111], a[216:219], v[216:219], v[108:111]
    s_waitcnt lgkmcnt(9)
    s_add_u32 s75, s18, 8388608
    ds_read_b64_tr_b16 a[248:249], v61 offset:57344
    v_fmac_f32 v16, v49, v177
    v_mfma_f32_16x16x32_bf16 v[108:111], a[220:223], v[220:223], v[108:111]
    buffer_store_dwordx4 v[80:83], v23, s[8:11], s75 offen offset:256 sc0 sc1
    ds_read_b64_tr_b16 a[250:251], v61 offset:59392
    v_mfma_f32_16x16x32_bf16 v[96:99], a[224:227], v[224:227], v[96:99]
    s_waitcnt lgkmcnt(9)
    ds_read_b64_tr_b16 a[252:253], v61 offset:61440
    v_cvt_pk_bf16_f32 v88, v88, v89
    v_mfma_f32_16x16x32_bf16 v[96:99], a[228:231], v[228:231], v[96:99]
    ds_read_b64_tr_b16 a[254:255], v61 offset:63488
    v_cvt_pk_bf16_f32 v89, v90, v91
    v_mfma_f32_16x16x32_bf16 v[104:107], a[224:227], v[240:243], v[104:107]
    ds_read_b64_tr_b16 a[192:193], v62 offset:32768
    v_cvt_pk_bf16_f32 v90, v92, v93
    v_mfma_f32_16x16x32_bf16 v[104:107], a[228:231], v[244:247], v[104:107]
    s_waitcnt lgkmcnt(9)
    ds_read_b64_tr_b16 a[194:195], v62 offset:34816
    v_cvt_pk_bf16_f32 v91, v94, v95
    v_mfma_f32_16x16x32_bf16 v[100:103], a[232:235], v[224:227], v[100:103]
    ds_read_b64_tr_b16 a[196:197], v62 offset:36864
    v_min_u32 v88, -2, v88
    v_mfma_f32_16x16x32_bf16 v[100:103], a[236:239], v[228:231], v[100:103]
    ds_read_b64_tr_b16 a[198:199], v62 offset:38912
    v_min_u32 v89, -2, v89
    v_mfma_f32_16x16x32_bf16 v[108:111], a[232:235], v[240:243], v[108:111]
    ds_read_b64_tr_b16 a[200:201], v63 offset:32768
    v_min_u32 v90, -2, v90
    v_mfma_f32_16x16x32_bf16 v[108:111], a[236:239], v[244:247], v[108:111]
    s_waitcnt lgkmcnt(9)
    ds_read_b64_tr_b16 a[202:203], v63 offset:34816
    v_min_u32 v91, -2, v91
    v_mfma_f32_16x16x32_bf16 v[96:99], a[240:243], v[232:235], v[96:99]
    s_add_u32 s75, s18, 8519680
    ds_read_b64_tr_b16 a[204:205], v63 offset:36864
    v_fmac_f32 v16, v50, v178
    v_mfma_f32_16x16x32_bf16 v[96:99], a[244:247], v[236:239], v[96:99]
    buffer_store_dwordx4 v[88:91], v23, s[8:11], s75 offen offset:256 sc0 sc1
    ds_read_b64_tr_b16 a[206:207], v63 offset:38912
    v_mfma_f32_16x16x32_bf16 v[104:107], a[240:243], v[248:251], v[104:107]
    ds_read_b64_tr_b16 a[208:209], v62 offset:40960
    v_fmac_f32 v16, v51, v179
    v_mfma_f32_16x16x32_bf16 v[104:107], a[244:247], v[252:255], v[104:107]
    s_waitcnt lgkmcnt(9)
    ds_read_b64_tr_b16 a[210:211], v62 offset:43008
    s_waitcnt vmcnt(16)
    v_fmac_f32 v16, v52, v180
    v_mfma_f32_16x16x32_bf16 v[100:103], a[248:251], v[232:235], v[100:103]
    ds_read_b64_tr_b16 a[212:213], v62 offset:45056
    v_fmac_f32 v16, v53, v181
    v_mfma_f32_16x16x32_bf16 v[100:103], a[252:255], v[236:239], v[100:103]
    ds_read_b64_tr_b16 a[214:215], v62 offset:47104
    v_fmac_f32 v16, v54, v182
    v_mfma_f32_16x16x32_bf16 v[108:111], a[248:251], v[248:251], v[108:111]
    ds_read_b64_tr_b16 a[216:217], v63 offset:40960
    v_fmac_f32 v16, v55, v183
    v_mfma_f32_16x16x32_bf16 v[108:111], a[252:255], v[252:255], v[108:111]
    s_waitcnt lgkmcnt(9)
    ds_read_b64_tr_b16 a[218:219], v63 offset:43008
    v_add_f32_dpp v16, v16, v16 quad_perm:[1,0,3,2] row_mask:0xf bank_mask:0xf
    v_mfma_f32_16x16x32_bf16 v[112:115], a[192:195], v[192:195], v[112:115]
    ds_read_b64_tr_b16 a[220:221], v63 offset:45056
    v_add_f32_dpp v16, v16, v16 quad_perm:[2,3,0,1] row_mask:0xf bank_mask:0xf
    v_mfma_f32_16x16x32_bf16 v[112:115], a[196:199], v[196:199], v[112:115]
    ds_read_b64_tr_b16 a[222:223], v63 offset:47104
    v_add_f32_dpp v16, v16, v16 row_half_mirror row_mask:0xf bank_mask:0xf
    v_mfma_f32_16x16x32_bf16 v[120:123], a[192:195], v[208:211], v[120:123]
    ds_read_b64_tr_b16 a[224:225], v62 offset:49152
    v_add_f32_dpp v16, v16, v16 row_mirror row_mask:0xf bank_mask:0xf
    v_mfma_f32_16x16x32_bf16 v[120:123], a[196:199], v[212:215], v[120:123]
    s_waitcnt lgkmcnt(9)
    ds_read_b64_tr_b16 a[226:227], v62 offset:51200
    v_mov_b32 v19, v16
    v_mfma_f32_16x16x32_bf16 v[116:119], a[200:203], v[192:195], v[116:119]
    ds_read_b64_tr_b16 a[228:229], v62 offset:53248
    v_permlane16_swap_b32 v16, v19
    v_mfma_f32_16x16x32_bf16 v[116:119], a[204:207], v[196:199], v[116:119]
    ds_read_b64_tr_b16 a[230:231], v62 offset:55296
    v_add_f32 v16, v16, v19
    v_mfma_f32_16x16x32_bf16 v[124:127], a[200:203], v[208:211], v[124:127]
    ds_read_b64_tr_b16 a[232:233], v63 offset:49152
    v_cvt_pk_bf16_f32 v96, v96, v97
    v_mfma_f32_16x16x32_bf16 v[124:127], a[204:207], v[212:215], v[124:127]
    s_waitcnt lgkmcnt(9)
    ds_read_b64_tr_b16 a[234:235], v63 offset:51200
    v_cvt_pk_bf16_f32 v97, v98, v99
    v_mfma_f32_16x16x32_bf16 v[112:115], a[208:211], v[200:203], v[112:115]
    ds_read_b64_tr_b16 a[236:237], v63 offset:53248
    v_cvt_pk_bf16_f32 v98, v100, v101
    v_mfma_f32_16x16x32_bf16 v[112:115], a[212:215], v[204:207], v[112:115]
    ds_read_b64_tr_b16 a[238:239], v63 offset:55296
    v_cvt_pk_bf16_f32 v99, v102, v103
    v_mfma_f32_16x16x32_bf16 v[120:123], a[208:211], v[216:219], v[120:123]
    ds_read_b64_tr_b16 a[240:241], v62 offset:57344
    v_min_u32 v96, -2, v96
    v_mfma_f32_16x16x32_bf16 v[120:123], a[212:215], v[220:223], v[120:123]
    s_waitcnt lgkmcnt(9)
    ds_read_b64_tr_b16 a[242:243], v62 offset:59392
    v_min_u32 v97, -2, v97
    v_mfma_f32_16x16x32_bf16 v[116:119], a[216:219], v[200:203], v[116:119]
    ds_read_b64_tr_b16 a[244:245], v62 offset:61440
    v_min_u32 v98, -2, v98
    v_mfma_f32_16x16x32_bf16 v[116:119], a[220:223], v[204:207], v[116:119]
    ds_read_b64_tr_b16 a[246:247], v62 offset:63488
    v_min_u32 v99, -2, v99
    v_mfma_f32_16x16x32_bf16 v[124:127], a[216:219], v[216:219], v[124:127]
    s_waitcnt lgkmcnt(9)
    s_add_u32 s75, s18, 8388608
    ds_read_b64_tr_b16 a[248:249], v63 offset:57344
    v_mov_b32 v19, v16
    v_mfma_f32_16x16x32_bf16 v[124:127], a[220:223], v[220:223], v[124:127]
    buffer_store_dwordx4 v[96:99], v23, s[8:11], s75 offen offset:512 sc0 sc1
    ds_read_b64_tr_b16 a[250:251], v63 offset:59392
    v_permlane32_swap_b32 v16, v19
    v_mfma_f32_16x16x32_bf16 v[112:115], a[224:227], v[224:227], v[112:115]
    s_waitcnt lgkmcnt(9)
    ds_read_b64_tr_b16 a[252:253], v63 offset:61440
    v_cvt_pk_bf16_f32 v104, v104, v105
    v_add_f32 v16, v16, v19
    v_mfma_f32_16x16x32_bf16 v[112:115], a[228:231], v[228:231], v[112:115]
    ds_read_b64_tr_b16 a[254:255], v63 offset:63488
    v_cvt_pk_bf16_f32 v105, v106, v107
    v_mfma_f32_16x16x32_bf16 v[120:123], a[224:227], v[240:243], v[120:123]
    v_cvt_pk_bf16_f32 v106, v108, v109
    v_mfma_f32_16x16x32_bf16 v[120:123], a[228:231], v[244:247], v[120:123]
    s_waitcnt lgkmcnt(8)
    v_cvt_pk_bf16_f32 v107, v110, v111
    v_mfma_f32_16x16x32_bf16 v[116:119], a[232:235], v[224:227], v[116:119]
    v_min_u32 v104, -2, v104
    v_mfma_f32_16x16x32_bf16 v[116:119], a[236:239], v[228:231], v[116:119]
    v_min_u32 v105, -2, v105
    v_mfma_f32_16x16x32_bf16 v[124:127], a[232:235], v[240:243], v[124:127]
    v_min_u32 v106, -2, v106
    v_mfma_f32_16x16x32_bf16 v[124:127], a[236:239], v[244:247], v[124:127]
    s_waitcnt lgkmcnt(4)
    v_min_u32 v107, -2, v107
    v_mfma_f32_16x16x32_bf16 v[112:115], a[240:243], v[232:235], v[112:115]
    s_add_u32 s75, s18, 8519680
    v_mfma_f32_16x16x32_bf16 v[112:115], a[244:247], v[236:239], v[112:115]
    buffer_store_dwordx4 v[104:107], v23, s[8:11], s75 offen offset:512 sc0 sc1
    v_mfma_f32_16x16x32_bf16 v[120:123], a[240:243], v[248:251], v[120:123]
    v_mfma_f32_16x16x32_bf16 v[120:123], a[244:247], v[252:255], v[120:123]
    s_waitcnt lgkmcnt(0)
    v_mfma_f32_16x16x32_bf16 v[116:119], a[248:251], v[232:235], v[116:119]
    v_mfma_f32_16x16x32_bf16 v[116:119], a[252:255], v[236:239], v[116:119]
    v_mfma_f32_16x16x32_bf16 v[124:127], a[248:251], v[248:251], v[124:127]
    v_mfma_f32_16x16x32_bf16 v[124:127], a[252:255], v[252:255], v[124:127]
    v_cvt_pk_bf16_f32 v112, v112, v113
    v_cvt_pk_bf16_f32 v113, v114, v115
    s_nop 3
    v_cvt_pk_bf16_f32 v114, v116, v117
    v_cvt_pk_bf16_f32 v115, v118, v119
    v_min_u32 v112, -2, v112
    v_min_u32 v113, -2, v113
    v_min_u32 v114, -2, v114
    v_min_u32 v115, -2, v115
    s_add_u32 s75, s18, 8388608
    buffer_store_dwordx4 v[112:115], v23, s[8:11], s75 offen offset:768 sc0 sc1
    v_cvt_pk_bf16_f32 v120, v120, v121
    v_cvt_pk_bf16_f32 v121, v122, v123
    v_cvt_pk_bf16_f32 v122, v124, v125
    v_cvt_pk_bf16_f32 v123, v126, v127
    v_min_u32 v120, -2, v120
    v_min_u32 v121, -2, v121
    v_min_u32 v122, -2, v122
    v_min_u32 v123, -2, v123
    s_add_u32 s75, s18, 8519680
    buffer_store_dwordx4 v[120:123], v23, s[8:11], s75 offen offset:768 sc0 sc1
    s_mov_b32 s12, 0xf000f
    s_mov_b32 s13, 0xf000f
    v_mov_b64 v[192:193], -1
    v_mov_b64 v[194:195], -1
    v_mov_b64 v[196:197], -1
    v_mov_b64 v[198:199], -1
    v_mov_b64 v[200:201], -1
    v_mov_b64 v[202:203], -1
    v_mov_b64 v[204:205], -1
    v_mov_b64 v[206:207], -1
    v_mov_b64 v[208:209], -1
    v_mov_b64 v[210:211], -1
    v_mov_b64 v[212:213], -1
    v_mov_b64 v[214:215], -1
    v_mov_b64 v[216:217], -1
    v_mov_b64 v[218:219], -1
    v_mov_b64 v[220:221], -1
    v_mov_b64 v[222:223], -1
    s_mov_b64 exec, s[12:13]
    s_add_u32 s74, s70, 8388608
    buffer_load_dwordx4 v[192:195], v44, s[8:11], s74 offen sc0 sc1
    s_add_u32 s74, s70, 8392704
    buffer_load_dwordx4 v[196:199], v44, s[8:11], s74 offen sc0 sc1
    s_add_u32 s74, s70, 8396800
    buffer_load_dwordx4 v[200:203], v44, s[8:11], s74 offen sc0 sc1
    s_add_u32 s74, s70, 8400896
    buffer_load_dwordx4 v[204:207], v44, s[8:11], s74 offen sc0 sc1
    s_add_u32 s74, s70, 8404992
    buffer_load_dwordx4 v[208:211], v44, s[8:11], s74 offen sc0 sc1
    s_add_u32 s74, s70, 8409088
    buffer_load_dwordx4 v[212:215], v44, s[8:11], s74 offen sc0 sc1
    s_add_u32 s74, s70, 8413184
    buffer_load_dwordx4 v[216:219], v44, s[8:11], s74 offen sc0 sc1
    s_add_u32 s74, s70, 8417280
    buffer_load_dwordx4 v[220:223], v44, s[8:11], s74 offen sc0 sc1
    s_mov_b64 exec, -1
    v_mov_b32 v100, 0x3f80
    v_mov_b32 v101, 0x3f800000
    v_lshlrev_b32 v88, 16, v36
    v_and_b32 v89, 0xffff0000, v36
    v_lshlrev_b32 v90, 16, v37
    v_and_b32 v91, 0xffff0000, v37
    v_lshlrev_b32 v92, 16, v38
    v_and_b32 v93, 0xffff0000, v38
    v_lshlrev_b32 v94, 16, v39
    v_and_b32 v95, 0xffff0000, v39
    v_lshlrev_b32 v72, 16, v32
    v_and_b32 v73, 0xffff0000, v32
    v_lshlrev_b32 v74, 16, v33
    v_and_b32 v75, 0xffff0000, v33
    v_lshlrev_b32 v76, 16, v34
    v_and_b32 v77, 0xffff0000, v34
    v_lshlrev_b32 v78, 16, v35
    v_and_b32 v79, 0xffff0000, v35
    s_waitcnt vmcnt(27)
    v_max_u32 v3, v128, v129
    v_max3_u32 v3, v3, v130, v131
    s_waitcnt vmcnt(26)
    v_max3_u32 v3, v3, v132, v133
    v_max3_u32 v3, v3, v134, v135
    s_waitcnt vmcnt(25)
    v_max3_u32 v3, v3, v136, v137
    v_max3_u32 v3, v3, v138, v139
    s_waitcnt vmcnt(24)
    v_max3_u32 v3, v3, v140, v141
    v_max3_u32 v3, v3, v142, v143
    s_waitcnt vmcnt(23)
    v_max3_u32 v3, v3, v144, v145
    v_max3_u32 v3, v3, v146, v147
    s_waitcnt vmcnt(22)
    v_max3_u32 v3, v3, v148, v149
    v_max3_u32 v3, v3, v150, v151
    s_waitcnt vmcnt(21)
    v_max3_u32 v3, v3, v152, v153
    v_max3_u32 v3, v3, v154, v155
    s_waitcnt vmcnt(20)
    v_max3_u32 v3, v3, v156, v157
    v_max3_u32 v3, v3, v158, v159
    v_cmp_eq_u32 vcc, -1, v3
    s_cbranch_vccnz L_P1_slow_19
L_P1_ok_20:
    v_lshlrev_b32 v64, 16, v128
    v_and_b32 v65, 0xffff0000, v128
    v_lshlrev_b32 v66, 16, v129
    v_and_b32 v67, 0xffff0000, v129
    v_lshlrev_b32 v68, 16, v130
    v_and_b32 v69, 0xffff0000, v130
    v_lshlrev_b32 v70, 16, v131
    v_and_b32 v71, 0xffff0000, v131
    v_dot2c_f32_bf16 v64, v132, v100
    v_dot2c_f32_bf16 v65, v132, v101
    v_dot2c_f32_bf16 v66, v133, v100
    v_dot2c_f32_bf16 v67, v133, v101
    v_dot2c_f32_bf16 v68, v134, v100
    v_dot2c_f32_bf16 v69, v134, v101
    v_dot2c_f32_bf16 v70, v135, v100
    v_dot2c_f32_bf16 v71, v135, v101
    v_dot2c_f32_bf16 v64, v136, v100
    v_dot2c_f32_bf16 v65, v136, v101
    v_dot2c_f32_bf16 v66, v137, v100
    v_dot2c_f32_bf16 v67, v137, v101
    v_dot2c_f32_bf16 v68, v138, v100
    v_dot2c_f32_bf16 v69, v138, v101
    v_dot2c_f32_bf16 v70, v139, v100
    v_dot2c_f32_bf16 v71, v139, v101
    v_dot2c_f32_bf16 v64, v140, v100
    v_dot2c_f32_bf16 v65, v140, v101
    v_dot2c_f32_bf16 v66, v141, v100
    v_dot2c_f32_bf16 v67, v141, v101
    v_dot2c_f32_bf16 v68, v142, v100
    v_dot2c_f32_bf16 v69, v142, v101
    v_dot2c_f32_bf16 v70, v143, v100
    v_dot2c_f32_bf16 v71, v143, v101
    v_dot2c_f32_bf16 v64, v144, v100
    v_dot2c_f32_bf16 v65, v144, v101
    v_dot2c_f32_bf16 v66, v145, v100
    v_dot2c_f32_bf16 v67, v145, v101
    v_dot2c_f32_bf16 v68, v146, v100
    v_dot2c_f32_bf16 v69, v146, v101
    v_dot2c_f32_bf16 v70, v147, v100
    v_dot2c_f32_bf16 v71, v147, v101
    v_dot2c_f32_bf16 v64, v148, v100
    v_dot2c_f32_bf16 v65, v148, v101
    v_dot2c_f32_bf16 v66, v149, v100
    v_dot2c_f32_bf16 v67, v149, v101
    v_dot2c_f32_bf16 v68, v150, v100
    v_dot2c_f32_bf16 v69, v150, v101
    v_dot2c_f32_bf16 v70, v151, v100
    v_dot2c_f32_bf16 v71, v151, v101
    v_dot2c_f32_bf16 v64, v152, v100
    v_dot2c_f32_bf16 v65, v152, v101
    v_dot2c_f32_bf16 v66, v153, v100
    v_dot2c_f32_bf16 v67, v153, v101
    v_dot2c_f32_bf16 v68, v154, v100
    v_dot2c_f32_bf16 v69, v154, v101
    v_dot2c_f32_bf16 v70, v155, v100
    v_dot2c_f32_bf16 v71, v155, v101
    v_dot2c_f32_bf16 v64, v156, v100
    v_dot2c_f32_bf16 v65, v156, v101
    v_dot2c_f32_bf16 v66, v157, v100
    v_dot2c_f32_bf16 v67, v157, v101
    v_dot2c_f32_bf16 v68, v158, v100
    v_dot2c_f32_bf16 v69, v158, v101
    v_dot2c_f32_bf16 v70, v159, v100
    v_dot2c_f32_bf16 v71, v159, v101
    s_waitcnt vmcnt(19)
    v_pk_fma_f32 v[64:65], v[64:65], v[160:161], v[72:73]
    v_pk_fma_f32 v[66:67], v[66:67], v[162:163], v[74:75]
    s_waitcnt vmcnt(18)
    v_pk_fma_f32 v[68:69], v[68:69], v[164:165], v[76:77]
    v_pk_fma_f32 v[70:71], v[70:71], v[166:167], v[78:79]
    v_cvt_pk_bf16_f32 v32, v64, v65
    v_cvt_pk_bf16_f32 v33, v66, v67
    v_cvt_pk_bf16_f32 v34, v68, v69
    v_cvt_pk_bf16_f32 v35, v70, v71
    v_lshlrev_b32 v64, 16, v32
    v_and_b32 v65, 0xffff0000, v32
    v_lshlrev_b32 v66, 16, v33
    v_and_b32 v67, 0xffff0000, v33
    v_lshlrev_b32 v68, 16, v34
    v_and_b32 v69, 0xffff0000, v34
    v_lshlrev_b32 v70, 16, v35
    v_and_b32 v71, 0xffff0000, v35
    v_pk_add_f32 v[48:49], v[64:65], v[66:67]
    v_pk_add_f32 v[50:51], v[68:69], v[70:71]
    v_pk_add_f32 v[48:49], v[48:49], v[50:51]
    v_add_f32 v48, v48, v49
    s_nop 1
    v_add_f32_dpp v48, v48, v48 quad_perm:[1,0,3,2] row_mask:0xf bank_mask:0xf
    s_nop 1
    v_add_f32_dpp v48, v48, v48 quad_perm:[2,3,0,1] row_mask:0xf bank_mask:0xf
    s_nop 1
    v_add_f32_dpp v48, v48, v48 row_half_mirror row_mask:0xf bank_mask:0xf
    s_nop 1
    v_add_f32_dpp v48, v48, v48 row_mirror row_mask:0xf bank_mask:0xf
    v_mov_b32 v49, v48
    s_nop 1
    v_permlane16_swap_b32 v48, v49
    v_add_f32 v48, v48, v49
    v_mov_b32 v49, v48
    s_nop 1
    v_permlane32_swap_b32 v48, v49
    v_add_f32 v48, v48, v49
    v_mul_f32 v48, 0xbb000000, v48
    v_pk_add_f32 v[72:73], v[64:65], v[48:49] op_sel_hi:[1,0]
    v_pk_add_f32 v[74:75], v[66:67], v[48:49] op_sel_hi:[1,0]
    v_pk_add_f32 v[76:77], v[68:69], v[48:49] op_sel_hi:[1,0]
    v_pk_add_f32 v[78:79], v[70:71], v[48:49] op_sel_hi:[1,0]
    v_pk_mul_f32 v[50:51], v[72:73], v[72:73]
    v_pk_mul_f32 v[52:53], v[72:73], v[8:9]
    v_pk_fma_f32 v[50:51], v[74:75], v[74:75], v[50:51]
    v_pk_fma_f32 v[52:53], v[74:75], v[10:11], v[52:53]
    v_pk_fma_f32 v[50:51], v[76:77], v[76:77], v[50:51]
    v_pk_fma_f32 v[52:53], v[76:77], v[12:13], v[52:53]
    v_pk_fma_f32 v[50:51], v[78:79], v[78:79], v[50:51]
    v_pk_fma_f32 v[52:53], v[78:79], v[14:15], v[52:53]
    v_add_f32 v50, v50, v51
    v_add_f32 v52, v52, v53
    s_nop 0
    v_add_f32_dpp v50, v50, v50 quad_perm:[1,0,3,2] row_mask:0xf bank_mask:0xf
    v_add_f32_dpp v52, v52, v52 quad_perm:[1,0,3,2] row_mask:0xf bank_mask:0xf
    s_nop 0
    v_add_f32_dpp v50, v50, v50 quad_perm:[2,3,0,1] row_mask:0xf bank_mask:0xf
    v_add_f32_dpp v52, v52, v52 quad_perm:[2,3,0,1] row_mask:0xf bank_mask:0xf
    s_nop 0
    v_add_f32_dpp v50, v50, v50 row_half_mirror row_mask:0xf bank_mask:0xf
    v_add_f32_dpp v52, v52, v52 row_half_mirror row_mask:0xf bank_mask:0xf
    s_nop 0
    v_add_f32_dpp v50, v50, v50 row_mirror row_mask:0xf bank_mask:0xf
    v_add_f32_dpp v52, v52, v52 row_mirror row_mask:0xf bank_mask:0xf
    v_mov_b32 v51, v50
    v_mov_b32 v53, v52
    s_nop 0
    v_permlane16_swap_b32 v50, v51
    v_permlane16_swap_b32 v52, v53
    v_add_f32 v50, v50, v51
    v_add_f32 v52, v52, v53
    v_mov_b32 v51, v50
    v_mov_b32 v53, v52
    s_nop 0
    v_permlane32_swap_b32 v50, v51
    v_permlane32_swap_b32 v52, v53
    v_add_f32 v50, v50, v51
    v_add_f32 v52, v52, v53
    v_mov_b32 v48, 0x3727c5ac
    v_fmac_f32 v48, 0x3b000000, v50
    v_rsq_f32 v48, v48
    s_nop 0
    v_fma_f32 v52, v52, v48, v16
    v_ashrrev_i32 v53, 31, v52
    v_or_b32 v53, 0x80000000, v53
    v_xor_b32 v53, v53, v52
    v_and_b32 v53, 0xfffff800, v53
    v_or_b32 v17, s68, v53
    v_pk_mul_f32 v[72:73], v[72:73], v[48:49] op_sel_hi:[1,0]
    v_pk_mul_f32 v[74:75], v[74:75], v[48:49] op_sel_hi:[1,0]
    v_pk_mul_f32 v[76:77], v[76:77], v[48:49] op_sel_hi:[1,0]
    v_pk_mul_f32 v[78:79], v[78:79], v[48:49] op_sel_hi:[1,0]
    v_pk_fma_f32 v[72:73], v[72:73], v[168:169], v[176:177]
    v_pk_fma_f32 v[74:75], v[74:75], v[170:171], v[178:179]
    v_pk_fma_f32 v[76:77], v[76:77], v[172:173], v[180:181]
    v_pk_fma_f32 v[78:79], v[78:79], v[174:175], v[182:183]
    v_cvt_pk_bf16_f32 v20, v72, v73
    v_cvt_pk_bf16_f32 v21, v74, v75
    v_cvt_pk_bf16_f32 v22, v76, v77
    v_cvt_pk_bf16_f32 v23, v78, v79
    v_lshlrev_b32 v98, 4, v0
    v_cmp_gt_u32 vcc, 224, v0
    v_mov_b32 v99, 2147479552
    s_nop 0
    v_cndmask_b32 v99, v99, v98, vcc
    s_lshl_b32 s17, s66, 13
    s_add_u32 s17, s17, 4194304
    s_cmp_lt_u32 s66, 224
    s_cselect_b32 s17, s17, 2143285248
    s_lshl_b32 s100, s3, 2
    v_mov_b32 v47, s100
    v_mov_b32 v102, 0
    s_lshl_b32 s100, s2, 6
    s_add_u32 s100, s100, 65536
    s_lshl_b32 s101, s2, 11
    s_add_u32 s101, s101, 524288
    s_branch L_pg_21
.p2align 12
L_pg_21:
L_op_join:
    s_mov_b32 s99, 0
L_P2_l_22:
    s_waitcnt vmcnt(0)
    v_max_u32 v48, v192, v193
    v_max3_u32 v48, v48, v194, v195
    v_max_u32 v49, v196, v197
    v_max3_u32 v49, v49, v198, v199
    v_max_u32 v50, v200, v201
    v_max3_u32 v50, v50, v202, v203
    v_max_u32 v51, v204, v205
    v_max3_u32 v51, v51, v206, v207
    v_max_u32 v52, v208, v209
    v_max3_u32 v52, v52, v210, v211
    v_max_u32 v53, v212, v213
    v_max3_u32 v53, v53, v214, v215
    v_max_u32 v54, v216, v217
    v_max3_u32 v54, v54, v218, v219
    v_max_u32 v55, v220, v221
    v_max3_u32 v55, v55, v222, v223
    v_max3_u32 v3, v48, v49, v50
    v_max3_u32 v3, v3, v51, v52
    v_max3_u32 v3, v3, v53, v54
    v_max_u32 v3, v3, v55
    v_cmp_eq_u32 vcc, -1, v3
    s_add_u32 s99, s99, 1
    s_cbranch_vccz L_P2_ok_23
    s_cmp_ge_u32 s99, 200000
    s_cbranch_scc1 L_P2_ok_23
    s_sleep 1
    v_cmp_eq_u32 vcc, -1, v48
    s_cbranch_vccz L_P2_s_24
    s_and_b64 s[96:97], vcc, s[12:13]
    s_cselect_b64 exec, s[96:97], vcc
    s_add_u32 s74, s70, 8388608
    buffer_load_dwordx4 v[192:195], v44, s[8:11], s74 offen sc0 sc1
    s_mov_b64 exec, -1
L_P2_s_24:
    v_cmp_eq_u32 vcc, -1, v49
    s_cbranch_vccz L_P2_s_25
    s_and_b64 s[96:97], vcc, s[12:13]
    s_cselect_b64 exec, s[96:97], vcc
    s_add_u32 s74, s70, 8392704
    buffer_load_dwordx4 v[196:199], v44, s[8:11], s74 offen sc0 sc1
    s_mov_b64 exec, -1
L_P2_s_25:
    v_cmp_eq_u32 vcc, -1, v50
    s_cbranch_vccz L_P2_s_26
    s_and_b64 s[96:97], vcc, s[12:13]
    s_cselect_b64 exec, s[96:97], vcc
    s_add_u32 s74, s70, 8396800
    buffer_load_dwordx4 v[200:203], v44, s[8:11], s74 offen sc0 sc1
    s_mov_b64 exec, -1
L_P2_s_26:
    v_cmp_eq_u32 vcc, -1, v51
    s_cbranch_vccz L_P2_s_27
    s_and_b64 s[96:97], vcc, s[12:13]
    s_cselect_b64 exec, s[96:97], vcc
    s_add_u32 s74, s70, 8400896
    buffer_load_dwordx4 v[204:207], v44, s[8:11], s74 offen sc0 sc1
    s_mov_b64 exec, -1
L_P2_s_27:
    v_cmp_eq_u32 vcc, -1, v52
    s_cbranch_vccz L_P2_s_28
    s_and_b64 s[96:97], vcc, s[12:13]
    s_cselect_b64 exec, s[96:97], vcc
    s_add_u32 s74, s70, 8404992
    buffer_load_dwordx4 v[208:211], v44, s[8:11], s74 offen sc0 sc1
    s_mov_b64 exec, -1
L_P2_s_28:
    v_cmp_eq_u32 vcc, -1, v53
    s_cbranch_vccz L_P2_s_29
    s_and_b64 s[96:97], vcc, s[12:13]
    s_cselect_b64 exec, s[96:97], vcc
    s_add_u32 s74, s70, 8409088
    buffer_load_dwordx4 v[212:215], v44, s[8:11], s74 offen sc0 sc1
    s_mov_b64 exec, -1
L_P2_s_29:
    v_cmp_eq_u32 vcc, -1, v54
    s_cbranch_vccz L_P2_s_30
    s_and_b64 s[96:97], vcc, s[12:13]
    s_cselect_b64 exec, s[96:97], vcc
    s_add_u32 s74, s70, 8413184
    buffer_load_dwordx4 v[216:219], v44, s[8:11], s74 offen sc0 sc1
    s_mov_b64 exec, -1
L_P2_s_30:
    v_cmp_eq_u32 vcc, -1, v55
    s_cbranch_vccz L_P2_s_31
    s_and_b64 s[96:97], vcc, s[12:13]
    s_cselect_b64 exec, s[96:97], vcc
    s_add_u32 s74, s70, 8417280
    buffer_load_dwordx4 v[220:223], v44, s[8:11], s74 offen sc0 sc1
    s_mov_b64 exec, -1
L_P2_s_31:
    s_branch L_P2_l_22
L_P2_ok_23:
    v_lshlrev_b32 v80, 16, v192
    v_and_b32 v81, 0xffff0000, v192
    v_lshlrev_b32 v82, 16, v193
    v_and_b32 v83, 0xffff0000, v193
    v_lshlrev_b32 v84, 16, v194
    v_and_b32 v85, 0xffff0000, v194
    v_lshlrev_b32 v86, 16, v195
    v_and_b32 v87, 0xffff0000, v195
    v_dot2c_f32_bf16 v80, v196, v100
    v_dot2c_f32_bf16 v81, v196, v101
    v_dot2c_f32_bf16 v82, v197, v100
    v_dot2c_f32_bf16 v83, v197, v101
    v_dot2c_f32_bf16 v84, v198, v100
    v_dot2c_f32_bf16 v85, v198, v101
    v_dot2c_f32_bf16 v86, v199, v100
    v_dot2c_f32_bf16 v87, v199, v101
    v_dot2c_f32_bf16 v80, v200, v100
    v_dot2c_f32_bf16 v81, v200, v101
    v_dot2c_f32_bf16 v82, v201, v100
    v_dot2c_f32_bf16 v83, v201, v101
    v_dot2c_f32_bf16 v84, v202, v100
    v_dot2c_f32_bf16 v85, v202, v101
    v_dot2c_f32_bf16 v86, v203, v100
    v_dot2c_f32_bf16 v87, v203, v101
    v_dot2c_f32_bf16 v80, v204, v100
    v_dot2c_f32_bf16 v81, v204, v101
    v_dot2c_f32_bf16 v82, v205, v100
    v_dot2c_f32_bf16 v83, v205, v101
    v_dot2c_f32_bf16 v84, v206, v100
    v_dot2c_f32_bf16 v85, v206, v101
    v_dot2c_f32_bf16 v86, v207, v100
    v_dot2c_f32_bf16 v87, v207, v101
    v_dot2c_f32_bf16 v80, v208, v100
    v_dot2c_f32_bf16 v81, v208, v101
    v_dot2c_f32_bf16 v82, v209, v100
    v_dot2c_f32_bf16 v83, v209, v101
    v_dot2c_f32_bf16 v84, v210, v100
    v_dot2c_f32_bf16 v85, v210, v101
    v_dot2c_f32_bf16 v86, v211, v100
    v_dot2c_f32_bf16 v87, v211, v101
    v_dot2c_f32_bf16 v80, v212, v100
    v_dot2c_f32_bf16 v81, v212, v101
    v_dot2c_f32_bf16 v82, v213, v100
    v_dot2c_f32_bf16 v83, v213, v101
    v_dot2c_f32_bf16 v84, v214, v100
    v_dot2c_f32_bf16 v85, v214, v101
    v_dot2c_f32_bf16 v86, v215, v100
    v_dot2c_f32_bf16 v87, v215, v101
    v_dot2c_f32_bf16 v80, v216, v100
    v_dot2c_f32_bf16 v81, v216, v101
    v_dot2c_f32_bf16 v82, v217, v100
    v_dot2c_f32_bf16 v83, v217, v101
    v_dot2c_f32_bf16 v84, v218, v100
    v_dot2c_f32_bf16 v85, v218, v101
    v_dot2c_f32_bf16 v86, v219, v100
    v_dot2c_f32_bf16 v87, v219, v101
    v_dot2c_f32_bf16 v80, v220, v100
    v_dot2c_f32_bf16 v81, v220, v101
    v_dot2c_f32_bf16 v82, v221, v100
    v_dot2c_f32_bf16 v83, v221, v101
    v_dot2c_f32_bf16 v84, v222, v100
    v_dot2c_f32_bf16 v85, v222, v101
    v_dot2c_f32_bf16 v86, v223, v100
    v_dot2c_f32_bf16 v87, v223, v101
    v_pk_fma_f32 v[80:81], v[80:81], v[160:161], v[88:89]
    v_pk_fma_f32 v[82:83], v[82:83], v[162:163], v[90:91]
    v_pk_fma_f32 v[84:85], v[84:85], v[164:165], v[92:93]
    v_pk_fma_f32 v[86:87], v[86:87], v[166:167], v[94:95]
    v_cvt_pk_bf16_f32 v36, v80, v81
    v_cvt_pk_bf16_f32 v37, v82, v83
    v_cvt_pk_bf16_f32 v38, v84, v85
    v_cvt_pk_bf16_f32 v39, v86, v87
    v_lshlrev_b32 v80, 16, v36
    v_and_b32 v81, 0xffff0000, v36
    v_lshlrev_b32 v82, 16, v37
    v_and_b32 v83, 0xffff0000, v37
    v_lshlrev_b32 v84, 16, v38
    v_and_b32 v85, 0xffff0000, v38
    v_lshlrev_b32 v86, 16, v39
    v_and_b32 v87, 0xffff0000, v39
    v_pk_add_f32 v[48:49], v[80:81], v[82:83]
    v_pk_add_f32 v[50:51], v[84:85], v[86:87]
    v_pk_add_f32 v[48:49], v[48:49], v[50:51]
    v_add_f32 v48, v48, v49
    s_nop 1
    v_add_f32_dpp v48, v48, v48 quad_perm:[1,0,3,2] row_mask:0xf bank_mask:0xf
    s_nop 1
    v_add_f32_dpp v48, v48, v48 quad_perm:[2,3,0,1] row_mask:0xf bank_mask:0xf
    s_nop 1
    v_add_f32_dpp v48, v48, v48 row_half_mirror row_mask:0xf bank_mask:0xf
    s_nop 1
    v_add_f32_dpp v48, v48, v48 row_mirror row_mask:0xf bank_mask:0xf
    v_mov_b32 v49, v48
    s_nop 1
    v_permlane16_swap_b32 v48, v49
    v_add_f32 v48, v48, v49
    v_mov_b32 v49, v48
    s_nop 1
    v_permlane32_swap_b32 v48, v49
    v_add_f32 v48, v48, v49
    v_mul_f32 v48, 0xbb000000, v48
    v_pk_add_f32 v[88:89], v[80:81], v[48:49] op_sel_hi:[1,0]
    v_pk_add_f32 v[90:91], v[82:83], v[48:49] op_sel_hi:[1,0]
    v_pk_add_f32 v[92:93], v[84:85], v[48:49] op_sel_hi:[1,0]
    v_pk_add_f32 v[94:95], v[86:87], v[48:49] op_sel_hi:[1,0]
    v_pk_mul_f32 v[50:51], v[88:89], v[88:89]
    v_pk_mul_f32 v[52:53], v[88:89], v[8:9]
    v_pk_fma_f32 v[50:51], v[90:91], v[90:91], v[50:51]
    v_pk_fma_f32 v[52:53], v[90:91], v[10:11], v[52:53]
    v_pk_fma_f32 v[50:51], v[92:93], v[92:93], v[50:51]
    v_pk_fma_f32 v[52:53], v[92:93], v[12:13], v[52:53]
    v_pk_fma_f32 v[50:51], v[94:95], v[94:95], v[50:51]
    v_pk_fma_f32 v[52:53], v[94:95], v[14:15], v[52:53]
    v_add_f32 v50, v50, v51
    v_add_f32 v52, v52, v53
    s_nop 0
    v_add_f32_dpp v50, v50, v50 quad_perm:[1,0,3,2] row_mask:0xf bank_mask:0xf
    v_add_f32_dpp v52, v52, v52 quad_perm:[1,0,3,2] row_mask:0xf bank_mask:0xf
    s_nop 0
    v_add_f32_dpp v50, v50, v50 quad_perm:[2,3,0,1] row_mask:0xf bank_mask:0xf
    v_add_f32_dpp v52, v52, v52 quad_perm:[2,3,0,1] row_mask:0xf bank_mask:0xf
    s_nop 0
    v_add_f32_dpp v50, v50, v50 row_half_mirror row_mask:0xf bank_mask:0xf
    v_add_f32_dpp v52, v52, v52 row_half_mirror row_mask:0xf bank_mask:0xf
    s_nop 0
    v_add_f32_dpp v50, v50, v50 row_mirror row_mask:0xf bank_mask:0xf
    v_add_f32_dpp v52, v52, v52 row_mirror row_mask:0xf bank_mask:0xf
    v_mov_b32 v51, v50
    v_mov_b32 v53, v52
    s_nop 0
    v_permlane16_swap_b32 v50, v51
    v_permlane16_swap_b32 v52, v53
    v_add_f32 v50, v50, v51
    v_add_f32 v52, v52, v53
    v_mov_b32 v51, v50
    v_mov_b32 v53, v52
    s_nop 0
    v_permlane32_swap_b32 v50, v51
    v_permlane32_swap_b32 v52, v53
    v_add_f32 v50, v50, v51
    v_add_f32 v52, v52, v53
    v_mov_b32 v48, 0x3727c5ac
    v_fmac_f32 v48, 0x3b000000, v50
    v_rsq_f32 v48, v48
    s_nop 0
    v_fma_f32 v52, v52, v48, v16
    v_ashrrev_i32 v53, 31, v52
    v_or_b32 v53, 0x80000000, v53
    v_xor_b32 v53, v53, v52
    v_and_b32 v53, 0xfffff800, v53
    v_or_b32 v18, s69, v53
    v_max3_u32 v19, v17, v18, 1
    ds_write_b32 v47, v19
    s_waitcnt lgkmcnt(0)
    s_barrier
    ds_read_b128 v[52:55], v102
    v_pk_mul_f32 v[88:89], v[88:89], v[48:49] op_sel_hi:[1,0]
    v_pk_mul_f32 v[90:91], v[90:91], v[48:49] op_sel_hi:[1,0]
    v_pk_mul_f32 v[92:93], v[92:93], v[48:49] op_sel_hi:[1,0]
    v_pk_mul_f32 v[94:95], v[94:95], v[48:49] op_sel_hi:[1,0]
    v_pk_fma_f32 v[88:89], v[88:89], v[168:169], v[176:177]
    v_pk_fma_f32 v[90:91], v[90:91], v[170:171], v[178:179]
    v_pk_fma_f32 v[92:93], v[92:93], v[172:173], v[180:181]
    v_pk_fma_f32 v[94:95], v[94:95], v[174:175], v[182:183]
    v_cvt_pk_bf16_f32 v24, v88, v89
    v_cvt_pk_bf16_f32 v25, v90, v91
    v_cvt_pk_bf16_f32 v26, v92, v93
    v_cvt_pk_bf16_f32 v27, v94, v95
    s_waitcnt lgkmcnt(0)
    v_max_u32 v52, v52, v53
    v_max3_u32 v52, v52, v54, v55
    v_cmp_eq_u32 vcc, v52, v19
    s_cbranch_vccz L_notbest
    buffer_store_dword v19, v5, s[8:11], s100 offen sc0 sc1
    v_cmp_gt_u32 vcc, v17, v18
    s_nop 1
    v_cndmask_b32 v28, v24, v20, vcc
    v_cndmask_b32 v40, v36, v32, vcc
    v_cndmask_b32 v29, v25, v21, vcc
    v_cndmask_b32 v41, v37, v33, vcc
    v_cndmask_b32 v30, v26, v22, vcc
    v_cndmask_b32 v42, v38, v34, vcc
    v_cndmask_b32 v31, v27, v23, vcc
    v_cndmask_b32 v43, v39, v35, vcc
    v_min_u32 v28, -2, v28
    v_min_u32 v40, -2, v40
    v_min_u32 v29, -2, v29
    v_min_u32 v41, -2, v41
    v_min_u32 v30, -2, v30
    v_min_u32 v42, -2, v42
    v_min_u32 v31, -2, v31
    v_min_u32 v43, -2, v43
    buffer_store_dwordx4 v[28:31], v1, s[8:11], s101 offen sc0 sc1
    buffer_store_dwordx4 v[40:43], v1, s[8:11], s101 offen offset:1024 sc0 sc1
L_notbest:
    buffer_load_dwordx4 v[112:115], v98, s[8:11], s17 offen
    s_add_u32 s17, s17, 4096
    buffer_load_dwordx4 v[116:119], v98, s[8:11], s17 offen
    s_add_u32 s17, s17, 2093056
    buffer_load_dwordx4 v[120:123], v98, s[8:11], s17 offen
    s_add_u32 s17, s17, 4096
    buffer_load_dwordx4 v[124:127], v98, s[8:11], s17 offen
    s_mul_i32 s17, s67, 28672
    s_add_u32 s17, s17, 8388608
    s_cmp_lt_u32 s67, 64
    s_cselect_b32 s17, s17, 2143285248
    buffer_load_dwordx4 v[128:131], v99, s[8:11], s17 offen offset:0
    buffer_load_dwordx4 v[132:135], v99, s[8:11], s17 offen offset:3584
    s_add_u32 s17, s17, 7168
    buffer_load_dwordx4 v[136:139], v99, s[8:11], s17 offen offset:0
    buffer_load_dwordx4 v[140:143], v99, s[8:11], s17 offen offset:3584
    s_add_u32 s17, s17, 7168
    buffer_load_dwordx4 v[144:147], v99, s[8:11], s17 offen offset:0
    buffer_load_dwordx4 v[148:151], v99, s[8:11], s17 offen offset:3584
    s_add_u32 s17, s17, 7168
    buffer_load_dwordx4 v[152:155], v99, s[8:11], s17 offen offset:0
    buffer_load_dwordx4 v[156:159], v99, s[8:11], s17 offen offset:3584
    v_lshlrev_b32 v72, 16, v20
    v_and_b32 v73, 0xffff0000, v20
    v_lshlrev_b32 v74, 16, v21
    v_and_b32 v75, 0xffff0000, v21
    v_lshlrev_b32 v76, 16, v22
    v_and_b32 v77, 0xffff0000, v22
    v_lshlrev_b32 v78, 16, v23
    v_and_b32 v79, 0xffff0000, v23
    v_pk_mul_f32 v[72:73], v[72:73], v[184:185]
    v_pk_mul_f32 v[74:75], v[74:75], v[186:187]
    v_pk_mul_f32 v[76:77], v[76:77], v[188:189]
    v_pk_mul_f32 v[78:79], v[78:79], v[190:191]
    v_cvt_pk_bf16_f32 v56, v72, v73
    v_cvt_pk_bf16_f32 v57, v74, v75
    v_cvt_pk_bf16_f32 v58, v76, v77
    v_cvt_pk_bf16_f32 v59, v78, v79
    v_lshlrev_b32 v72, 16, v56
    v_and_b32 v73, 0xffff0000, v56
    v_lshlrev_b32 v74, 16, v57
    v_and_b32 v75, 0xffff0000, v57
    v_lshlrev_b32 v76, 16, v58
    v_and_b32 v77, 0xffff0000, v58
    v_lshlrev_b32 v78, 16, v59
    v_and_b32 v79, 0xffff0000, v59
    v_pk_add_f32 v[72:73], v[72:73], v[64:65]
    v_pk_add_f32 v[74:75], v[74:75], v[66:67]
    v_pk_add_f32 v[76:77], v[76:77], v[68:69]
    v_pk_add_f32 v[78:79], v[78:79], v[70:71]
    v_cvt_pk_bf16_f32 v56, v72, v73
    v_cvt_pk_bf16_f32 v57, v74, v75
    v_cvt_pk_bf16_f32 v58, v76, v77
    v_cvt_pk_bf16_f32 v59, v78, v79
    v_lshlrev_b32 v88, 16, v24
    v_and_b32 v89, 0xffff0000, v24
    v_lshlrev_b32 v90, 16, v25
    v_and_b32 v91, 0xffff0000, v25
    v_lshlrev_b32 v92, 16, v26
    v_and_b32 v93, 0xffff0000, v26
    v_lshlrev_b32 v94, 16, v27
    v_and_b32 v95, 0xffff0000, v27
    v_pk_mul_f32 v[88:89], v[88:89], v[184:185]
    v_pk_mul_f32 v[90:91], v[90:91], v[186:187]
    v_pk_mul_f32 v[92:93], v[92:93], v[188:189]
    v_pk_mul_f32 v[94:95], v[94:95], v[190:191]
    v_cvt_pk_bf16_f32 v60, v88, v89
    v_cvt_pk_bf16_f32 v61, v90, v91
    v_cvt_pk_bf16_f32 v62, v92, v93
    v_cvt_pk_bf16_f32 v63, v94, v95
    v_lshlrev_b32 v88, 16, v60
    v_and_b32 v89, 0xffff0000, v60
    v_lshlrev_b32 v90, 16, v61
    v_and_b32 v91, 0xffff0000, v61
    v_lshlrev_b32 v92, 16, v62
    v_and_b32 v93, 0xffff0000, v62
    v_lshlrev_b32 v94, 16, v63
    v_and_b32 v95, 0xffff0000, v63
    v_pk_add_f32 v[88:89], v[88:89], v[80:81]
    v_pk_add_f32 v[90:91], v[90:91], v[82:83]
    v_pk_add_f32 v[92:93], v[92:93], v[84:85]
    v_pk_add_f32 v[94:95], v[94:95], v[86:87]
    v_cvt_pk_bf16_f32 v60, v88, v89
    v_cvt_pk_bf16_f32 v61, v90, v91
    v_cvt_pk_bf16_f32 v62, v92, v93
    v_cvt_pk_bf16_f32 v63, v94, v95
    v_and_b32 v104, 1, v2
    v_cmp_eq_u32 vcc, 1, v104
    s_nop 1
    v_cndmask_b32 v104, v58, v56, vcc
    v_cndmask_b32 v105, v59, v57, vcc
    s_nop 0
    v_mov_b32_dpp v106, v104 quad_perm:[1,0,3,2] row_mask:0xf bank_mask:0xf
    v_mov_b32_dpp v107, v105 quad_perm:[1,0,3,2] row_mask:0xf bank_mask:0xf
    v_cndmask_b32 v56, v56, v106, vcc
    v_cndmask_b32 v57, v57, v107, vcc
    v_cndmask_b32 v58, v106, v58, vcc
    v_cndmask_b32 v59, v107, v59, vcc
    v_cndmask_b32 v104, v62, v60, vcc
    v_cndmask_b32 v105, v63, v61, vcc
    s_nop 0
    v_mov_b32_dpp v106, v104 quad_perm:[1,0,3,2] row_mask:0xf bank_mask:0xf
    v_mov_b32_dpp v107, v105 quad_perm:[1,0,3,2] row_mask:0xf bank_mask:0xf
    v_cndmask_b32 v60, v60, v106, vcc
    v_cndmask_b32 v61, v61, v107, vcc
    v_cndmask_b32 v62, v106, v62, vcc
    v_cndmask_b32 v63, v107, v63, vcc
    v_lshrrev_b32 v103, 2, v2
    v_lshlrev_b32 v103, 6, v103
    v_and_b32 v104, 1, v2
    v_lshl_add_u32 v103, v104, 5, v103
    v_and_b32 v104, 2, v2
    v_lshl_add_u32 v103, v104, 3, v103
    v_lshlrev_b32 v4, 6, v0
    s_mov_b32 s71, 65536
    s_mov_b32 s99, 0
    s_branch L_pg_32
.p2align 12
L_pg_32:
L_kl:
    buffer_load_dword v3, v4, s[8:11], s71 offen sc0 sc1
    s_add_u32 s99, s99, 1
    s_waitcnt vmcnt(0)
    v_cmp_eq_u32 vcc, 0, v3
    s_cbranch_vccz L_kd
    s_cmp_ge_u32 s99, 200000
    s_cbranch_scc1 L_kd
    s_mov_b64 exec, vcc
    s_sleep 2
    s_branch L_kl
L_kd:
    s_mov_b64 exec, -1
    v_max_u32_dpp v3, v3, v3 quad_perm:[1,0,3,2] row_mask:0xf bank_mask:0xf
    s_nop 1
    v_max_u32_dpp v3, v3, v3 quad_perm:[2,3,0,1] row_mask:0xf bank_mask:0xf
    s_nop 1
    v_max_u32_dpp v3, v3, v3 row_half_mirror row_mask:0xf bank_mask:0xf
    s_nop 1
    v_max_u32_dpp v3, v3, v3 row_mirror row_mask:0xf bank_mask:0xf
    v_mov_b32 v19, v3
    s_nop 1
    v_permlane16_swap_b32 v3, v19
    v_max_u32 v3, v3, v19
    v_mov_b32 v19, v3
    s_nop 1
    v_permlane32_swap_b32 v3, v19
    v_max_u32 v3, v3, v19
    ds_write_b32 v47, v3 offset:64
    s_waitcnt lgkmcnt(0)
    s_barrier
    ds_read_b128 v[52:55], v102 offset:64
    v_lshlrev_b32 v4, 2, v0
    s_waitcnt lgkmcnt(0)
    v_max_u32 v52, v52, v53
    v_max3_u32 v52, v52, v54, v55
    s_nop 0
    v_readfirstlane_b32 s71, v52
    s_and_b32 s72, s71, 2047
    s_lshr_b32 s100, s72, 7
    s_sub_u32 s101, 15, s100
    s_min_u32 s100, s100, s101
    s_lshl_b32 s100, s100, 16
    s_and_b32 s101, s72, 1024
    s_cmp_eq_u32 s101, 0
    s_cselect_b32 s73, 31, 31
    s_lshr_b32 s101, s72, 2
    s_and_b32 s73, s73, s101
    s_lshl_b32 s73, s73, 2
    s_lshl_b32 s73, s73, 9
    s_add_u32 s73, s73, s100
    s_add_u32 s73, s73, 524288
    buffer_load_dword v19, v4, s[8:11], s73 offen sc0 sc1
    s_lshl_b32 s100, s68, 10
    s_cmp_eq_u32 s68, s72
    s_cselect_b32 s100, 2147479552, s100
    buffer_store_dwordx4 v[56:59], v103, s[52:55], s100 offen sc1
    s_lshl_b32 s100, s69, 10
    s_cmp_eq_u32 s69, s72
    s_cselect_b32 s100, 2147479552, s100
    buffer_store_dwordx4 v[60:63], v103, s[52:55], s100 offen sc1
    s_cmp_ge_u32 s66, 224
    s_cbranch_scc1 L_nprod
    v_lshlrev_b32 v160, 16, v112
    v_and_b32 v161, 0xffff0000, v112
    v_lshlrev_b32 v162, 16, v113
    v_and_b32 v163, 0xffff0000, v113
    v_lshlrev_b32 v164, 16, v114
    v_and_b32 v165, 0xffff0000, v114
    v_lshlrev_b32 v166, 16, v115
    v_and_b32 v167, 0xffff0000, v115
    v_lshlrev_b32 v168, 16, v116
    v_and_b32 v169, 0xffff0000, v116
    v_lshlrev_b32 v170, 16, v117
    v_and_b32 v171, 0xffff0000, v117
    v_lshlrev_b32 v172, 16, v118
    v_and_b32 v173, 0xffff0000, v118
    v_lshlrev_b32 v174, 16, v119
    v_and_b32 v175, 0xffff0000, v119
    v_lshlrev_b32 v176, 16, v120
    v_and_b32 v177, 0xffff0000, v120
    v_lshlrev_b32 v178, 16, v121
    v_and_b32 v179, 0xffff0000, v121
    v_lshlrev_b32 v180, 16, v122
    v_and_b32 v181, 0xffff0000, v122
    v_lshlrev_b32 v182, 16, v123
    v_and_b32 v183, 0xffff0000, v123
    v_lshlrev_b32 v184, 16, v124
    v_and_b32 v185, 0xffff0000, v124
    v_lshlrev_b32 v186, 16, v125
    v_and_b32 v187, 0xffff0000, v125
    v_lshlrev_b32 v188, 16, v126
    v_and_b32 v189, 0xffff0000, v126
    v_lshlrev_b32 v190, 16, v127
    v_and_b32 v191, 0xffff0000, v127
    s_mov_b32 s99, 0
    s_waitcnt vmcnt(2)
L_hl:
    v_cmp_eq_u32 vcc, -1, v19
    s_add_u32 s99, s99, 1
    s_cbranch_vccz L_hok
    s_cmp_ge_u32 s99, 200000
    s_cbranch_scc1 L_hok
    buffer_load_dword v19, v4, s[8:11], s73 offen sc0 sc1
    s_waitcnt vmcnt(0)
    s_branch L_hl
L_hok:
    v_lshlrev_b32 v48, 16, v19
    v_and_b32 v50, 0xffff0000, v19
    v_pk_mul_f32 v[64:65], v[160:161], v[48:49] op_sel_hi:[1,0]
    v_pk_mul_f32 v[66:67], v[162:163], v[48:49] op_sel_hi:[1,0]
    v_pk_mul_f32 v[68:69], v[164:165], v[48:49] op_sel_hi:[1,0]
    v_pk_mul_f32 v[70:71], v[166:167], v[48:49] op_sel_hi:[1,0]
    v_pk_mul_f32 v[72:73], v[176:177], v[48:49] op_sel_hi:[1,0]
    v_pk_mul_f32 v[74:75], v[178:179], v[48:49] op_sel_hi:[1,0]
    v_pk_mul_f32 v[76:77], v[180:181], v[48:49] op_sel_hi:[1,0]
    v_pk_mul_f32 v[78:79], v[182:183], v[48:49] op_sel_hi:[1,0]
    v_pk_fma_f32 v[64:65], v[168:169], v[50:51], v[64:65] op_sel_hi:[1,0,1]
    v_pk_fma_f32 v[66:67], v[170:171], v[50:51], v[66:67] op_sel_hi:[1,0,1]
    v_pk_fma_f32 v[68:69], v[172:173], v[50:51], v[68:69] op_sel_hi:[1,0,1]
    v_pk_fma_f32 v[70:71], v[174:175], v[50:51], v[70:71] op_sel_hi:[1,0,1]
    v_pk_fma_f32 v[72:73], v[184:185], v[50:51], v[72:73] op_sel_hi:[1,0,1]
    v_pk_fma_f32 v[74:75], v[186:187], v[50:51], v[74:75] op_sel_hi:[1,0,1]
    v_pk_fma_f32 v[76:77], v[188:189], v[50:51], v[76:77] op_sel_hi:[1,0,1]
    v_pk_fma_f32 v[78:79], v[190:191], v[50:51], v[78:79] op_sel_hi:[1,0,1]
    v_permlane32_swap_b32 v64, v72
    v_permlane32_swap_b32 v65, v73
    v_permlane32_swap_b32 v66, v74
    v_permlane32_swap_b32 v67, v75
    v_permlane32_swap_b32 v68, v76
    v_permlane32_swap_b32 v69, v77
    v_permlane32_swap_b32 v70, v78
    v_permlane32_swap_b32 v71, v79
    v_add_f32 v64, v64, v72
    v_add_f32 v65, v65, v73
    v_add_f32 v66, v66, v74
    v_add_f32 v67, v67, v75
    v_add_f32 v68, v68, v76
    v_add_f32 v69, v69, v77
    v_add_f32 v70, v70, v78
    v_add_f32 v71, v71, v79
    v_permlane16_swap_b32 v64, v68
    v_permlane16_swap_b32 v65, v69
    v_permlane16_swap_b32 v66, v70
    v_permlane16_swap_b32 v67, v71
    v_add_f32 v64, v64, v68
    v_add_f32 v65, v65, v69
    v_add_f32 v66, v66, v70
    v_add_f32 v67, v67, v71
    v_add_f32_dpp v64, v64, v64 quad_perm:[1,0,3,2] row_mask:0xf bank_mask:0xf
    v_add_f32_dpp v65, v65, v65 quad_perm:[1,0,3,2] row_mask:0xf bank_mask:0xf
    v_add_f32_dpp v66, v66, v66 quad_perm:[1,0,3,2] row_mask:0xf bank_mask:0xf
    v_add_f32_dpp v67, v67, v67 quad_perm:[1,0,3,2] row_mask:0xf bank_mask:0xf
    v_add_f32_dpp v64, v64, v64 quad_perm:[2,3,0,1] row_mask:0xf bank_mask:0xf
    v_add_f32_dpp v65, v65, v65 quad_perm:[2,3,0,1] row_mask:0xf bank_mask:0xf
    v_add_f32_dpp v66, v66, v66 quad_perm:[2,3,0,1] row_mask:0xf bank_mask:0xf
    v_add_f32_dpp v67, v67, v67 quad_perm:[2,3,0,1] row_mask:0xf bank_mask:0xf
    v_add_f32_dpp v64, v64, v64 row_half_mirror row_mask:0xf bank_mask:0xf
    v_add_f32_dpp v65, v65, v65 row_half_mirror row_mask:0xf bank_mask:0xf
    v_add_f32_dpp v66, v66, v66 row_half_mirror row_mask:0xf bank_mask:0xf
    v_add_f32_dpp v67, v67, v67 row_half_mirror row_mask:0xf bank_mask:0xf
    v_add_f32_dpp v64, v64, v64 row_mirror row_mask:0xf bank_mask:0xf
    v_add_f32_dpp v65, v65, v65 row_mirror row_mask:0xf bank_mask:0xf
    v_add_f32_dpp v66, v66, v66 row_mirror row_mask:0xf bank_mask:0xf
    v_add_f32_dpp v67, v67, v67 row_mirror row_mask:0xf bank_mask:0xf
    v_and_b32 v50, 15, v2
    v_cmp_eq_u32 vcc, 0, v50
    v_mov_b32 v51, 1024
    s_nop 0
    v_cndmask_b32 v51, v51, v0, vcc
    ds_write_b128 v51, v[64:67] offset:256
    v_lshlrev_b32 v50, 2, v50
    s_waitcnt lgkmcnt(0)
    s_barrier
    s_cmp_lg_u32 s3, 0
    s_cbranch_scc1 L_nprod
    ds_read_b32 v64, v50 offset:256
    ds_read_b32 v65, v50 offset:320
    ds_read_b32 v66, v50 offset:384
    ds_read_b32 v67, v50 offset:448
    v_cmp_gt_u32 vcc, 8, v2
    v_mov_b32 v51, 2147479552
    s_nop 0
    v_cndmask_b32 v51, v51, v50, vcc
    s_lshl_b32 s100, s66, 6
    s_add_u32 s100, s100, 81920
    s_waitcnt lgkmcnt(2)
    v_add_f32 v64, v64, v65
    s_waitcnt lgkmcnt(0)
    v_add_f32 v66, v66, v67
    v_add_f32 v64, v64, v66
    v_cvt_pk_bf16_f32 v64, v64, v64
    v_and_b32 v64, 0xffff0000, v64
    s_nop 1
    v_mov_b32_dpp v65, v64 row_ror:8 row_mask:0xf bank_mask:0xf
    v_mul_f32 v66, 0xbfb8aa3b, v64
    v_exp_f32 v66, v66
    s_nop 0
    v_add_f32 v66, 1.0, v66
    v_rcp_f32 v66, v66
    s_nop 0
    v_mul_f32 v64, v64, v66
    v_cvt_pk_bf16_f32 v64, v64, v64
    v_and_b32 v64, 0xffff0000, v64
    v_mul_f32 v64, v64, v65
    v_cvt_pk_bf16_f32 v64, v64, v64
    v_and_b32 v64, 0xffff0000, v64
    buffer_store_dword v64, v51, s[8:11], s100 offen sc0 sc1
L_nprod:
    s_cmp_ge_u32 s67, 64
    s_cbranch_scc1 L_fin
    v_lshlrev_b32 v4, 6, v0
    v_cmp_gt_u32 vcc, 224, v0
    v_mov_b32 v51, 2147479552
    s_nop 0
    v_cndmask_b32 v4, v51, v4, vcc
    s_mov_b32 s100, 81920
    v_and_b32 v52, 7, v2
    s_lshl_b32 s101, s67, 3
    v_add_u32 v52, s101, v52
    v_lshrrev_b32 v53, 5, v52
    v_lshlrev_b32 v53, 6, v53
    v_and_b32 v54, 12, v52
    v_lshl_add_u32 v53, v54, 2, v53
    v_bfe_u32 v54, v52, 4, 1
    v_lshl_add_u32 v53, v54, 3, v53
    v_and_b32 v54, 2, v52
    v_lshl_add_u32 v53, v54, 1, v53
    v_lshlrev_b32 v54, 2, v52
    s_mov_b32 s101, 10240
    buffer_load_dword v55, v54, s[8:11], s101 offen
    buffer_load_dword v88, v53, s[8:11], s73 offen sc0 sc1
    buffer_load_dword v89, v53, s[8:11], s73 offen offset:1024 sc0 sc1
    v_lshlrev_b32 v192, 16, v128
    v_and_b32 v193, 0xffff0000, v128
    v_lshlrev_b32 v194, 16, v129
    v_and_b32 v195, 0xffff0000, v129
    v_lshlrev_b32 v196, 16, v130
    v_and_b32 v197, 0xffff0000, v130
    v_lshlrev_b32 v198, 16, v131
    v_and_b32 v199, 0xffff0000, v131
    v_lshlrev_b32 v200, 16, v132
    v_and_b32 v201, 0xffff0000, v132
    v_lshlrev_b32 v202, 16, v133
    v_and_b32 v203, 0xffff0000, v133
    v_lshlrev_b32 v204, 16, v134
    v_and_b32 v205, 0xffff0000, v134
    v_lshlrev_b32 v206, 16, v135
    v_and_b32 v207, 0xffff0000, v135
    v_lshlrev_b32 v208, 16, v136
    v_and_b32 v209, 0xffff0000, v136
    v_lshlrev_b32 v210, 16, v137
    v_and_b32 v211, 0xffff0000, v137
    v_lshlrev_b32 v212, 16, v138
    v_and_b32 v213, 0xffff0000, v138
    v_lshlrev_b32 v214, 16, v139
    v_and_b32 v215, 0xffff0000, v139
    v_lshlrev_b32 v216, 16, v140
    v_and_b32 v217, 0xffff0000, v140
    v_lshlrev_b32 v218, 16, v141
    v_and_b32 v219, 0xffff0000, v141
    v_lshlrev_b32 v220, 16, v142
    v_and_b32 v221, 0xffff0000, v142
    v_lshlrev_b32 v222, 16, v143
    v_and_b32 v223, 0xffff0000, v143
    v_lshlrev_b32 v224, 16, v144
    v_and_b32 v225, 0xffff0000, v144
    v_lshlrev_b32 v226, 16, v145
    v_and_b32 v227, 0xffff0000, v145
    v_lshlrev_b32 v228, 16, v146
    v_and_b32 v229, 0xffff0000, v146
    v_lshlrev_b32 v230, 16, v147
    v_and_b32 v231, 0xffff0000, v147
    v_lshlrev_b32 v232, 16, v148
    v_and_b32 v233, 0xffff0000, v148
    v_lshlrev_b32 v234, 16, v149
    v_and_b32 v235, 0xffff0000, v149
    v_lshlrev_b32 v236, 16, v150
    v_and_b32 v237, 0xffff0000, v150
    v_lshlrev_b32 v238, 16, v151
    v_and_b32 v239, 0xffff0000, v151
    v_lshlrev_b32 v240, 16, v152
    v_and_b32 v241, 0xffff0000, v152
    v_lshlrev_b32 v242, 16, v153
    v_and_b32 v243, 0xffff0000, v153
    v_lshlrev_b32 v244, 16, v154
    v_and_b32 v245, 0xffff0000, v154
    v_lshlrev_b32 v246, 16, v155
    v_and_b32 v247, 0xffff0000, v155
    v_lshlrev_b32 v248, 16, v156
    v_and_b32 v249, 0xffff0000, v156
    v_lshlrev_b32 v250, 16, v157
    v_and_b32 v251, 0xffff0000, v157
    v_lshlrev_b32 v252, 16, v158
    v_and_b32 v253, 0xffff0000, v158
    v_lshlrev_b32 v254, 16, v159
    v_and_b32 v255, 0xffff0000, v159
    s_and_b32 s101, s71, 0xfffff800
    s_or_b32 s101, s101, 0x400
    v_mov_b32 v90, s101
    v_not_b32 v91, v90
    v_ashrrev_i32 v91, 31, v91
    v_or_b32 v91, 0x80000000, v91
    v_xor_b32 v90, v90, v91
    v_cvt_pk_bf16_f32 v90, v90, v90
    v_and_b32 v90, 0xffff0000, v90
    v_mul_f32 v90, 0xbfb8aa3b, v90
    v_exp_f32 v90, v90
    s_nop 0
    v_add_f32 v90, 1.0, v90
    v_rcp_f32 v90, v90
    s_nop 0
    v_cvt_pk_bf16_f32 v90, v90, v90
    v_and_b32 v90, 0xffff0000, v90
    s_mov_b32 s99, 0
L_CND_l_33:
    s_waitcnt vmcnt(0)
    v_max_u32 v3, v88, v89
    v_cmp_eq_u32 vcc, -1, v3
    s_add_u32 s99, s99, 1
    s_cbranch_vccz L_CND_ok_34
    s_cmp_ge_u32 s99, 200000
    s_cbranch_scc1 L_CND_ok_34
    s_mov_b64 exec, vcc
    s_sleep 1
    buffer_load_dword v88, v53, s[8:11], s73 offen sc0 sc1
    buffer_load_dword v89, v53, s[8:11], s73 offen offset:1024 sc0 sc1
    s_branch L_CND_l_33
L_CND_ok_34:
    s_mov_b64 exec, -1
    v_and_b32 v51, 1, v52
    v_cmp_eq_u32 vcc, 0, v51
    v_lshlrev_b32 v91, 16, v88
    v_and_b32 v88, 0xffff0000, v88
    v_cndmask_b32 v88, v88, v91, vcc
    v_lshlrev_b32 v91, 16, v89
    v_and_b32 v89, 0xffff0000, v89
    v_cndmask_b32 v89, v89, v91, vcc
    v_and_b32 v50, 15, v2
    v_cmp_eq_u32 vcc, 0, v50
    v_lshrrev_b32 v51, 1, v0
    v_mov_b32 v50, 1024
    v_cndmask_b32 v51, v50, v51, vcc
    v_and_b32 v50, 7, v2
    v_lshlrev_b32 v50, 2, v50
    v_cmp_gt_u32 vcc, 8, v2
    v_lshlrev_b32 v52, 1, v52
    v_mov_b32 v53, 2147479552
    v_cndmask_b32 v52, v53, v52, vcc
    s_cmp_lt_u32 s66, 224
    s_cbranch_scc1 L_asl
    s_sleep 16
L_asl:
    s_sleep 7
    buffer_load_dwordx4 v[80:83], v4, s[8:11], s100 offen sc0 sc1
    buffer_load_dwordx4 v[84:87], v4, s[8:11], s100 offen offset:16 sc0 sc1
    s_mov_b32 s99, 0
L_ACT_l_35:
    s_waitcnt vmcnt(0)
    v_max_u32 v3, v80, v81
    v_max3_u32 v3, v3, v82, v83
    v_max3_u32 v3, v3, v84, v85
    v_max3_u32 v3, v3, v86, v87
    v_cmp_eq_u32 vcc, -1, v3
    s_add_u32 s99, s99, 1
    s_cbranch_vccz L_ACT_ok_36
    s_cmp_ge_u32 s99, 200000
    s_cbranch_scc1 L_ACT_ok_36
    s_mov_b64 exec, vcc
    s_sleep 2
    buffer_load_dwordx4 v[80:83], v4, s[8:11], s100 offen sc0 sc1
    buffer_load_dwordx4 v[84:87], v4, s[8:11], s100 offen offset:16 sc0 sc1
    s_branch L_ACT_l_35
L_ACT_ok_36:
    s_mov_b64 exec, -1
    v_pk_mul_f32 v[64:65], v[192:193], v[80:81] op_sel_hi:[1,0]
    v_pk_mul_f32 v[66:67], v[194:195], v[80:81] op_sel_hi:[1,0]
    v_pk_mul_f32 v[68:69], v[196:197], v[80:81] op_sel_hi:[1,0]
    v_pk_mul_f32 v[70:71], v[198:199], v[80:81] op_sel_hi:[1,0]
    v_pk_fma_f32 v[64:65], v[200:201], v[80:81], v[64:65] op_sel:[0,1,0] op_sel_hi:[1,1,1]
    v_pk_fma_f32 v[66:67], v[202:203], v[80:81], v[66:67] op_sel:[0,1,0] op_sel_hi:[1,1,1]
    v_pk_fma_f32 v[68:69], v[204:205], v[80:81], v[68:69] op_sel:[0,1,0] op_sel_hi:[1,1,1]
    v_pk_fma_f32 v[70:71], v[206:207], v[80:81], v[70:71] op_sel:[0,1,0] op_sel_hi:[1,1,1]
    v_pk_fma_f32 v[64:65], v[208:209], v[82:83], v[64:65] op_sel:[0,0,0] op_sel_hi:[1,0,1]
    v_pk_fma_f32 v[66:67], v[210:211], v[82:83], v[66:67] op_sel:[0,0,0] op_sel_hi:[1,0,1]
    v_pk_fma_f32 v[68:69], v[212:213], v[82:83], v[68:69] op_sel:[0,0,0] op_sel_hi:[1,0,1]
    v_pk_fma_f32 v[70:71], v[214:215], v[82:83], v[70:71] op_sel:[0,0,0] op_sel_hi:[1,0,1]
    v_pk_fma_f32 v[64:65], v[216:217], v[82:83], v[64:65] op_sel:[0,1,0] op_sel_hi:[1,1,1]
    v_pk_fma_f32 v[66:67], v[218:219], v[82:83], v[66:67] op_sel:[0,1,0] op_sel_hi:[1,1,1]
    v_pk_fma_f32 v[68:69], v[220:221], v[82:83], v[68:69] op_sel:[0,1,0] op_sel_hi:[1,1,1]
    v_pk_fma_f32 v[70:71], v[222:223], v[82:83], v[70:71] op_sel:[0,1,0] op_sel_hi:[1,1,1]
    v_pk_fma_f32 v[64:65], v[224:225], v[84:85], v[64:65] op_sel:[0,0,0] op_sel_hi:[1,0,1]
    v_pk_fma_f32 v[66:67], v[226:227], v[84:85], v[66:67] op_sel:[0,0,0] op_sel_hi:[1,0,1]
    v_pk_fma_f32 v[68:69], v[228:229], v[84:85], v[68:69] op_sel:[0,0,0] op_sel_hi:[1,0,1]
    v_pk_fma_f32 v[70:71], v[230:231], v[84:85], v[70:71] op_sel:[0,0,0] op_sel_hi:[1,0,1]
    v_pk_fma_f32 v[64:65], v[232:233], v[84:85], v[64:65] op_sel:[0,1,0] op_sel_hi:[1,1,1]
    v_pk_fma_f32 v[66:67], v[234:235], v[84:85], v[66:67] op_sel:[0,1,0] op_sel_hi:[1,1,1]
    v_pk_fma_f32 v[68:69], v[236:237], v[84:85], v[68:69] op_sel:[0,1,0] op_sel_hi:[1,1,1]
    v_pk_fma_f32 v[70:71], v[238:239], v[84:85], v[70:71] op_sel:[0,1,0] op_sel_hi:[1,1,1]
    v_pk_fma_f32 v[64:65], v[240:241], v[86:87], v[64:65] op_sel:[0,0,0] op_sel_hi:[1,0,1]
    v_pk_fma_f32 v[66:67], v[242:243], v[86:87], v[66:67] op_sel:[0,0,0] op_sel_hi:[1,0,1]
    v_pk_fma_f32 v[68:69], v[244:245], v[86:87], v[68:69] op_sel:[0,0,0] op_sel_hi:[1,0,1]
    v_pk_fma_f32 v[70:71], v[246:247], v[86:87], v[70:71] op_sel:[0,0,0] op_sel_hi:[1,0,1]
    v_pk_fma_f32 v[64:65], v[248:249], v[86:87], v[64:65] op_sel:[0,1,0] op_sel_hi:[1,1,1]
    v_pk_fma_f32 v[66:67], v[250:251], v[86:87], v[66:67] op_sel:[0,1,0] op_sel_hi:[1,1,1]
    v_pk_fma_f32 v[68:69], v[252:253], v[86:87], v[68:69] op_sel:[0,1,0] op_sel_hi:[1,1,1]
    v_pk_fma_f32 v[70:71], v[254:255], v[86:87], v[70:71] op_sel:[0,1,0] op_sel_hi:[1,1,1]
    s_nop 0
    v_permlane32_swap_b32 v64, v68
    v_permlane32_swap_b32 v65, v69
    v_permlane32_swap_b32 v66, v70
    v_permlane32_swap_b32 v67, v71
    v_add_f32 v64, v64, v68
    v_add_f32 v65, v65, v69
    v_add_f32 v66, v66, v70
    v_add_f32 v67, v67, v71
    s_nop 0
    v_permlane16_swap_b32 v64, v66
    v_permlane16_swap_b32 v65, v67
    v_add_f32 v64, v64, v66
    v_add_f32 v65, v65, v67
    s_nop 0
    v_add_f32_dpp v64, v64, v64 quad_perm:[1,0,3,2] row_mask:0xf bank_mask:0xf
    v_add_f32_dpp v65, v65, v65 quad_perm:[1,0,3,2] row_mask:0xf bank_mask:0xf
    s_nop 0
    v_add_f32_dpp v64, v64, v64 quad_perm:[2,3,0,1] row_mask:0xf bank_mask:0xf
    v_add_f32_dpp v65, v65, v65 quad_perm:[2,3,0,1] row_mask:0xf bank_mask:0xf
    s_nop 0
    v_add_f32_dpp v64, v64, v64 row_half_mirror row_mask:0xf bank_mask:0xf
    v_add_f32_dpp v65, v65, v65 row_half_mirror row_mask:0xf bank_mask:0xf
    s_nop 0
    v_add_f32_dpp v64, v64, v64 row_mirror row_mask:0xf bank_mask:0xf
    v_add_f32_dpp v65, v65, v65 row_mirror row_mask:0xf bank_mask:0xf
    ds_write_b64 v51, v[64:65] offset:2048
    s_waitcnt lgkmcnt(0)
    s_barrier
    s_cmp_lg_u32 s3, 0
    s_cbranch_scc1 L_fin
    ds_read_b32 v64, v50 offset:2048
    ds_read_b32 v65, v50 offset:2080
    ds_read_b32 v66, v50 offset:2112
    ds_read_b32 v67, v50 offset:2144
    s_lshl_b32 s100, s72, 10
    s_waitcnt lgkmcnt(2)
    v_add_f32 v64, v64, v65
    s_waitcnt lgkmcnt(0)
    v_add_f32 v66, v66, v67
    v_add_f32 v64, v64, v66
    v_cvt_pk_bf16_f32 v64, v64, v64
    v_and_b32 v64, 0xffff0000, v64
    v_mul_f32 v64, v64, v90
    v_cvt_pk_bf16_f32 v64, v64, v64
    v_and_b32 v64, 0xffff0000, v64
    v_add_f32 v64, v64, v88
    v_cvt_pk_bf16_f32 v64, v64, v64
    v_and_b32 v64, 0xffff0000, v64
    v_mul_f32 v64, v64, v55
    v_cvt_pk_bf16_f32 v64, v64, v64
    v_and_b32 v64, 0xffff0000, v64
    v_add_f32 v64, v64, v89
    v_cvt_pk_bf16_f32 v64, v64, v64
    buffer_store_short v64, v52, s[52:55], s100 offen sc1
L_fin:
L_end:
    s_endpgm
L_E_slow_1:
    s_mov_b32 s99, 0
L_E_slow_1_l:
    s_sleep 20
    buffer_load_dword v3, v4, s[36:39], s67 offen sc0 sc1
    s_add_u32 s99, s99, 1
    s_waitcnt vmcnt(0)
    v_cmp_le_u32 vcc, s68, v3
    s_cmp_eq_u64 vcc, -1
    s_cbranch_scc1 L_E_ok_2
    s_cmp_lt_u32 s99, 200000
    s_cbranch_scc1 L_E_slow_1_l
    s_branch L_E_ok_2
L_H_slow_3:
    s_mov_b32 s99, 0
L_H_slow_3_l:
    s_sleep 4
    buffer_load_dword v3, v16, s[8:11], s78 offen sc0 sc1
    s_add_u32 s99, s99, 1
    s_waitcnt vmcnt(0)
    v_cmp_ne_u32 vcc, 0, v3
    s_cmp_eq_u64 vcc, -1
    s_cbranch_scc1 L_H_ok_4
    s_cmp_lt_u32 s99, 200000
    s_cbranch_scc1 L_H_slow_3_l
    s_branch L_H_ok_4
L_E2_slow_5:
    s_mov_b32 s99, 0
L_E2_slow_5_l:
    s_sleep 4
    buffer_load_dword v118, v119, s[8:11], s69 offen sc0 sc1
    s_add_u32 s99, s99, 1
    s_waitcnt vmcnt(0)
    v_cmp_ne_u32 vcc, 0, v118
    s_cmp_eq_u64 vcc, -1
    s_cbranch_scc1 L_E2_ok_6
    s_cmp_lt_u32 s99, 200000
    s_cbranch_scc1 L_E2_slow_5_l
    s_branch L_E2_ok_6
L_KV_slow_7:
    s_mov_b32 s99, 0
L_KV_slow_7_l:
    s_sleep 4
    buffer_load_dword v3, v17, s[8:11], s74 offen sc0 sc1
    s_add_u32 s99, s99, 1
    s_waitcnt vmcnt(0)
    v_cmp_ne_u32 vcc, 0, v3
    s_cmp_eq_u64 vcc, -1
    s_cbranch_scc1 L_KV_ok_8
    s_cmp_lt_u32 s99, 200000
    s_cbranch_scc1 L_KV_slow_7_l
    s_branch L_KV_ok_8
L_t1_start:
    v_mfma_f32_16x16x32_bf16 v[96:99], a[128:131], a[64:67], v[96:99]
    s_add_u32 s19, s82, 32768
    s_sub_u32 s82, s12, s13
    s_sub_u32 s82, s82, 1
    v_mfma_f32_16x16x32_bf16 v[96:99], a[132:135], a[68:71], v[96:99]
    s_cmp_gt_u32 s12, s13
    s_cselect_b32 s82, s82, s12
    s_mul_i32 s82, s82, 65536
    s_add_u32 s82, s82, s81
    v_mfma_f32_16x16x32_bf16 v[96:99], a[136:139], a[72:75], v[96:99]
    s_cmp_ge_u32 s12, 17
    s_cselect_b32 s82, 2147471360, s82
    s_add_u32 s12, s12, 1
    s_sub_u32 s14, s60, 1
    v_mfma_f32_16x16x32_bf16 v[96:99], a[140:143], a[76:79], v[96:99]
    v_mfma_f32_16x16x32_bf16 v[100:103], a[144:147], a[64:67], v[100:103]
    v_mfma_f32_16x16x32_bf16 v[100:103], a[148:151], a[68:71], v[100:103]
    v_mfma_f32_16x16x32_bf16 v[100:103], a[152:155], a[72:75], v[100:103]
    v_mfma_f32_16x16x32_bf16 v[100:103], a[156:159], a[76:79], v[100:103]
    v_mfma_f32_16x16x32_bf16 v[104:107], a[128:131], a[80:83], v[104:107]
    s_nop 2
    v_exp_f32 v96, v96
    v_mfma_f32_16x16x32_bf16 v[104:107], a[132:135], a[84:87], v[104:107]
    v_exp_f32 v97, v97
    v_mfma_f32_16x16x32_bf16 v[104:107], a[136:139], a[88:91], v[104:107]
    v_exp_f32 v98, v98
    v_mfma_f32_16x16x32_bf16 v[104:107], a[140:143], a[92:95], v[104:107]
    v_exp_f32 v99, v99
    v_mfma_f32_16x16x32_bf16 v[108:111], a[144:147], a[80:83], v[108:111]
    v_exp_f32 v100, v100
    v_mfma_f32_16x16x32_bf16 v[108:111], a[148:151], a[84:87], v[108:111]
    v_exp_f32 v101, v101
    v_mfma_f32_16x16x32_bf16 v[108:111], a[152:155], a[88:91], v[108:111]
    v_exp_f32 v102, v102
    v_mfma_f32_16x16x32_bf16 v[108:111], a[156:159], a[92:95], v[108:111]
    v_exp_f32 v103, v103
    v_mfma_f32_16x16x32_bf16 v[112:115], a[128:131], a[96:99], v[72:75]
    v_exp_f32 v104, v104
    v_mfma_f32_16x16x32_bf16 v[112:115], a[132:135], a[100:103], v[112:115]
    v_exp_f32 v105, v105
    v_mfma_f32_16x16x32_bf16 v[112:115], a[136:139], a[104:107], v[112:115]
    v_exp_f32 v106, v106
    v_mfma_f32_16x16x32_bf16 v[112:115], a[140:143], a[108:111], v[112:115]
    v_exp_f32 v107, v107
    v_mfma_f32_16x16x32_bf16 v[120:123], a[128:131], a[112:115], v[76:79]
    v_exp_f32 v108, v108
    v_mfma_f32_16x16x32_bf16 v[120:123], a[132:135], a[116:119], v[120:123]
    v_exp_f32 v109, v109
    v_mfma_f32_16x16x32_bf16 v[120:123], a[136:139], a[120:123], v[120:123]
    v_exp_f32 v110, v110
    v_mfma_f32_16x16x32_bf16 v[120:123], a[140:143], a[124:127], v[120:123]
    v_exp_f32 v111, v111
    v_mfma_f32_16x16x32_bf16 v[116:119], a[144:147], a[96:99], v[72:75]
    ds_read_b128 a[128:131], v18 offset:16384
    v_cvt_pk_bf16_f32 v48, v96, v97
    v_mfma_f32_16x16x32_bf16 v[116:119], a[148:151], a[100:103], v[116:119]
    ds_read_b128 a[132:135], v18 offset:17408
    v_cvt_pk_bf16_f32 v49, v98, v99
    v_mfma_f32_16x16x32_bf16 v[116:119], a[152:155], a[104:107], v[116:119]
    ds_read_b128 a[136:139], v18 offset:18432
    v_cvt_pk_bf16_f32 v50, v100, v101
    v_mfma_f32_16x16x32_bf16 v[116:119], a[156:159], a[108:111], v[116:119]
    ds_read_b128 a[140:143], v18 offset:19456
    v_cvt_pk_bf16_f32 v51, v102, v103
    v_mfma_f32_16x16x32_bf16 v[124:127], a[144:147], a[112:115], v[76:79]
    ds_read_b128 a[144:147], v18 offset:20480
    v_cvt_pk_bf16_f32 v52, v104, v105
    v_mfma_f32_16x16x32_bf16 v[124:127], a[148:151], a[116:119], v[124:127]
    ds_read_b128 a[148:151], v18 offset:21504
    v_cvt_pk_bf16_f32 v53, v106, v107
    v_mfma_f32_16x16x32_bf16 v[124:127], a[152:155], a[120:123], v[124:127]
    ds_read_b128 a[152:155], v18 offset:22528
    v_cvt_pk_bf16_f32 v54, v108, v109
    v_mfma_f32_16x16x32_bf16 v[124:127], a[156:159], a[124:127], v[124:127]
    ds_read_b128 a[156:159], v18 offset:23552
    v_cvt_pk_bf16_f32 v55, v110, v111
    v_xor_b32 v18, 196608, v18
    s_branch L_t1_p1
L_t1_zero:
    v_mfma_f32_16x16x32_bf16 v[96:99], a[128:131], a[96:99], v[80:83]
    s_xor_b32 s100, s16, 8192
    ds_read_b128 a[176:179], v20 offset:4096
    v_lshrrev_b32 v13, 1, v1
    v_mfma_f32_16x16x32_bf16 v[96:99], a[132:135], a[100:103], v[96:99]
    s_add_u32 m0, s15, 0
    ds_read_b128 a[180:183], v20 offset:5120
    v_add_u32 v12, s100, v13
    v_mfma_f32_16x16x32_bf16 v[96:99], a[136:139], a[104:107], v[96:99]
    buffer_load_dwordx4 v1, s[8:11], s82 offen offset:0  lds
    v_exp_f32 v112, v112
    v_mfma_f32_16x16x32_bf16 v[96:99], a[140:143], a[108:111], v[96:99]
    v_exp_f32 v113, v113
    v_mfma_f32_16x16x32_bf16 v[100:103], a[144:147], a[96:99], v[84:87]
    ds_read_b128 a[184:187], v20 offset:6144
    v_cvt_pk_bf16_f32 v56, v112, v113
    v_mfma_f32_16x16x32_bf16 v[100:103], a[148:151], a[100:103], v[100:103]
    v_exp_f32 v114, v114
    v_mfma_f32_16x16x32_bf16 v[100:103], a[152:155], a[104:107], v[100:103]
    buffer_load_dwordx4 v1, s[8:11], s82 offen offset:1024  lds
    v_exp_f32 v115, v115
    v_mfma_f32_16x16x32_bf16 v[100:103], a[156:159], a[108:111], v[100:103]
    ds_read_b128 a[188:191], v20 offset:7168
    v_cvt_pk_bf16_f32 v57, v114, v115
    v_mfma_f32_16x16x32_bf16 v[104:107], a[128:131], a[112:115], v[88:91]
    v_exp_f32 v116, v116
    v_mfma_f32_16x16x32_bf16 v[104:107], a[132:135], a[116:119], v[104:107]
    v_exp_f32 v117, v117
    v_mfma_f32_16x16x32_bf16 v[104:107], a[136:139], a[120:123], v[104:107]
    ds_read_b128 a[160:163], v19 offset:0
    v_cvt_pk_bf16_f32 v58, v116, v117
    v_mfma_f32_16x16x32_bf16 v[104:107], a[140:143], a[124:127], v[104:107]
    buffer_load_dwordx4 v1, s[8:11], s82 offen offset:2048  lds
    v_exp_f32 v118, v118
    v_mfma_f32_16x16x32_bf16 v[108:111], a[144:147], a[112:115], v[92:95]
    v_exp_f32 v119, v119
    v_mfma_f32_16x16x32_bf16 v[108:111], a[148:151], a[116:119], v[108:111]
    ds_read_b128 a[164:167], v19 offset:1024
    v_cvt_pk_bf16_f32 v59, v118, v119
    v_mfma_f32_16x16x32_bf16 v[108:111], a[152:155], a[120:123], v[108:111]
    v_exp_f32 v120, v120
    v_mfma_f32_16x16x32_bf16 v[108:111], a[156:159], a[124:127], v[108:111]
    buffer_load_dwordx4 v1, s[8:11], s82 offen offset:3072  lds
    v_exp_f32 v121, v121
    v_mfma_f32_16x16x32_bf16 v[32:35], v[28:31], v[48:51], 0
    s_add_u32 m0, s15, 4096
    ds_read_b128 a[168:171], v19 offset:2048
    v_cvt_pk_bf16_f32 v60, v120, v121
    v_mfma_f32_16x16x32_bf16 v[36:39], v[28:31], v[52:55], 0
    s_waitcnt lgkmcnt(6)
    v_exp_f32 v122, v122
    v_mfma_f32_16x16x32_bf16 v[144:147], a[176:179], v[48:51], 0
    v_exp_f32 v123, v123
    v_mfma_f32_16x16x32_bf16 v[176:179], a[176:179], v[52:55], 0
    s_waitcnt lgkmcnt(5)
    ds_read_b128 a[172:175], v19 offset:3072
    v_cvt_pk_bf16_f32 v61, v122, v123
    v_mfma_f32_16x16x32_bf16 v[148:151], a[180:183], v[48:51], 0
    buffer_load_dwordx4 v15, s[8:11], s82 offen offset:0  lds
    v_exp_f32 v124, v124
    v_mfma_f32_16x16x32_bf16 v[180:183], a[180:183], v[52:55], 0
    s_waitcnt lgkmcnt(5)
    v_exp_f32 v125, v125
    v_mfma_f32_16x16x32_bf16 v[152:155], a[184:187], v[48:51], 0
    s_waitcnt lgkmcnt(4)
    v_exp_f32 v126, v126
    v_mfma_f32_16x16x32_bf16 v[184:187], a[184:187], v[52:55], 0
    buffer_load_dwordx4 v15, s[8:11], s82 offen offset:1024  lds
    v_exp_f32 v127, v127
    v_mfma_f32_16x16x32_bf16 v[156:159], a[188:191], v[48:51], 0
    ds_write_b128 v16, v[144:147] offset:32768
    v_cvt_pk_bf16_f32 v62, v124, v125
    v_mfma_f32_16x16x32_bf16 v[188:191], a[188:191], v[52:55], 0
    s_waitcnt lgkmcnt(4)
    v_exp_f32 v96, v96
    v_mfma_f32_16x16x32_bf16 v[128:131], a[160:163], v[48:51], 0
    v_exp_f32 v97, v97
    v_mfma_f32_16x16x32_bf16 v[160:163], a[160:163], v[52:55], 0
    s_waitcnt lgkmcnt(3)
    ds_write_b128 v16, v[176:179] offset:33792
    v_cvt_pk_bf16_f32 v63, v126, v127
    v_mfma_f32_16x16x32_bf16 v[132:135], a[164:167], v[48:51], 0
    s_waitcnt lgkmcnt(3)
    v_exp_f32 v98, v98
    v_mfma_f32_16x16x32_bf16 v[164:167], a[164:167], v[52:55], 0
    buffer_load_dwordx4 v15, s[8:11], s82 offen offset:2048  lds
    v_exp_f32 v99, v99
    v_mfma_f32_16x16x32_bf16 v[136:139], a[168:171], v[48:51], 0
    ds_write_b128 v16, v[148:151] offset:34816
    v_mfma_f32_16x16x32_bf16 v[168:171], a[168:171], v[52:55], 0
    s_waitcnt lgkmcnt(3)
    v_exp_f32 v100, v100
    v_mfma_f32_16x16x32_bf16 v[140:143], a[172:175], v[48:51], 0
    v_exp_f32 v101, v101
    v_mfma_f32_16x16x32_bf16 v[172:175], a[172:175], v[52:55], 0
    ds_write_b128 v16, v[180:183] offset:35840
    v_mov_b32 v33, v36
    v_mfma_f32_16x16x32_bf16 v[40:43], v[28:31], v[56:59], 0
    buffer_load_dwordx4 v15, s[8:11], s82 offen offset:3072  lds
    v_exp_f32 v102, v102
    v_mfma_f32_16x16x32_bf16 v[44:47], v[28:31], v[60:63], 0
    s_xor_b32 s15, s15, 196608
    v_exp_f32 v103, v103
    v_mfma_f32_16x16x32_bf16 v[208:211], a[176:179], v[56:59], 0
    ds_write_b128 v16, v[152:155] offset:36864
    v_cvt_pk_bf16_f32 v48, v96, v97
    v_mfma_f32_16x16x32_bf16 v[240:243], a[176:179], v[60:63], 0
    ds_read_b128 a[176:179], v20 offset:20480
    v_exp_f32 v104, v104
    v_mfma_f32_16x16x32_bf16 v[212:215], a[180:183], v[56:59], 0
    v_exp_f32 v105, v105
    v_mfma_f32_16x16x32_bf16 v[244:247], a[180:183], v[60:63], 0
    ds_read_b128 a[180:183], v20 offset:21504
    v_exp_f32 v106, v106
    v_mfma_f32_16x16x32_bf16 v[216:219], a[184:187], v[56:59], 0
    ds_write_b128 v16, v[184:187] offset:37888
    v_cvt_pk_bf16_f32 v49, v98, v99
    v_mfma_f32_16x16x32_bf16 v[248:251], a[184:187], v[60:63], 0
    ds_read_b128 a[184:187], v20 offset:22528
    v_exp_f32 v107, v107
    v_mfma_f32_16x16x32_bf16 v[220:223], a[188:191], v[56:59], 0
    v_exp_f32 v108, v108
    v_mfma_f32_16x16x32_bf16 v[252:255], a[188:191], v[60:63], 0
    ds_read_b128 a[188:191], v20 offset:23552
    v_exp_f32 v109, v109
    v_mfma_f32_16x16x32_bf16 v[192:195], a[160:163], v[56:59], 0
    ds_write_b128 v16, v[156:159] offset:38912
    v_cvt_pk_bf16_f32 v50, v100, v101
    v_mfma_f32_16x16x32_bf16 v[224:227], a[160:163], v[60:63], 0
    ds_read_b128 a[160:163], v19 offset:16384
    v_exp_f32 v110, v110
    v_mfma_f32_16x16x32_bf16 v[196:199], a[164:167], v[56:59], 0
    v_exp_f32 v111, v111
    v_mfma_f32_16x16x32_bf16 v[228:231], a[164:167], v[60:63], 0
    ds_read_b128 a[164:167], v19 offset:17408
    v_cvt_pk_bf16_f32 v51, v102, v103
    v_mfma_f32_16x16x32_bf16 v[200:203], a[168:171], v[56:59], 0
    ds_write_b128 v16, v[188:191] offset:39936
    v_cvt_pk_bf16_f32 v52, v104, v105
    v_mfma_f32_16x16x32_bf16 v[232:235], a[168:171], v[60:63], 0
    ds_read_b128 a[168:171], v19 offset:18432
    v_cvt_pk_bf16_f32 v53, v106, v107
    v_mfma_f32_16x16x32_bf16 v[204:207], a[172:175], v[56:59], 0
    v_cvt_pk_bf16_f32 v54, v108, v109
    v_cvt_pk_bf16_f32 v55, v110, v111
    v_mfma_f32_16x16x32_bf16 v[236:239], a[172:175], v[60:63], 0
    ds_read_b128 a[172:175], v19 offset:19456
    ds_write_b64 v12, v[32:33]
    s_xor_b32 s101, s16, 98304
    v_xor_b32 v12, 8192, v12
    v_add_u32 v9, s101, v1
    v_xor_b32 v8, 8192, v16
    v_xor_b32 v10, 8192, v9
    s_branch L_t1_join
L_t1_redo:
    s_cmp_eq_u32 s25, 0
    s_cbranch_scc1 L_t1_max
    s_mov_b32 s25, 0
    v_mov_b32 v64, 0
    v_mov_b32 v65, 0
    v_mov_b32 v66, 0
    v_mov_b32 v67, 0
    v_mov_b32 v68, 0
    v_mov_b32 v69, 0
    v_mov_b32 v70, 0
    v_mov_b32 v71, 0
    v_mov_b32 v72, 0
    v_mov_b32 v73, 0
    v_mov_b32 v74, 0
    v_mov_b32 v75, 0
    v_mov_b32 v76, 0
    v_mov_b32 v77, 0
    v_mov_b32 v78, 0
    v_mov_b32 v79, 0
    s_nop 1
    s_branch L_t1_safe
L_t1_max:
    s_waitcnt vmcnt(0) lgkmcnt(0)
    s_barrier
    s_mov_b32 s25, 1
    s_and_b32 s100, s3, 1
    s_lshl_b32 s100, s100, 13
    s_sub_u32 s101, s81, s62
    s_add_u32 s101, s101, s100
    s_mov_b32 s14, s60
    v_mov_b32 v48, 0xff800000
    v_mov_b32 v49, 0xff800000
    v_mov_b32 v50, 0xff800000
    v_mov_b32 v51, 0xff800000
L_t1_maxl:
    s_cmp_eq_u32 s14, 0
    s_cbranch_scc1 L_t1_maxd
    s_add_u32 s100, s101, 0
    buffer_load_dwordx4 a[128:131], v1, s[8:11], s100 offen offset:0
    buffer_load_dwordx4 a[132:135], v1, s[8:11], s100 offen offset:1024
    buffer_load_dwordx4 a[136:139], v1, s[8:11], s100 offen offset:2048
    buffer_load_dwordx4 a[140:143], v1, s[8:11], s100 offen offset:3072
    buffer_load_dwordx4 a[144:147], v15, s[8:11], s100 offen offset:0
    buffer_load_dwordx4 a[148:151], v15, s[8:11], s100 offen offset:1024
    buffer_load_dwordx4 a[152:155], v15, s[8:11], s100 offen offset:2048
    buffer_load_dwordx4 a[156:159], v15, s[8:11], s100 offen offset:3072
    s_waitcnt vmcnt(7)
    v_mfma_f32_16x16x32_bf16 v[96:99], a[128:131], a[64:67], v[64:67]
    s_waitcnt vmcnt(6)
    v_mfma_f32_16x16x32_bf16 v[96:99], a[132:135], a[68:71], v[96:99]
    s_waitcnt vmcnt(5)
    v_mfma_f32_16x16x32_bf16 v[96:99], a[136:139], a[72:75], v[96:99]
    s_waitcnt vmcnt(4)
    v_mfma_f32_16x16x32_bf16 v[96:99], a[140:143], a[76:79], v[96:99]
    v_mfma_f32_16x16x32_bf16 v[104:107], a[128:131], a[80:83], v[68:71]
    v_mfma_f32_16x16x32_bf16 v[104:107], a[132:135], a[84:87], v[104:107]
    v_mfma_f32_16x16x32_bf16 v[104:107], a[136:139], a[88:91], v[104:107]
    v_mfma_f32_16x16x32_bf16 v[104:107], a[140:143], a[92:95], v[104:107]
    s_waitcnt vmcnt(3)
    v_mfma_f32_16x16x32_bf16 v[100:103], a[144:147], a[64:67], v[64:67]
    s_waitcnt vmcnt(2)
    v_mfma_f32_16x16x32_bf16 v[100:103], a[148:151], a[68:71], v[100:103]
    s_waitcnt vmcnt(1)
    v_mfma_f32_16x16x32_bf16 v[100:103], a[152:155], a[72:75], v[100:103]
    s_waitcnt vmcnt(0)
    v_mfma_f32_16x16x32_bf16 v[100:103], a[156:159], a[76:79], v[100:103]
    v_mfma_f32_16x16x32_bf16 v[108:111], a[144:147], a[80:83], v[68:71]
    v_mfma_f32_16x16x32_bf16 v[108:111], a[148:151], a[84:87], v[108:111]
    v_mfma_f32_16x16x32_bf16 v[108:111], a[152:155], a[88:91], v[108:111]
    v_mfma_f32_16x16x32_bf16 v[108:111], a[156:159], a[92:95], v[108:111]
    v_mfma_f32_16x16x32_bf16 v[112:115], a[128:131], a[96:99], v[72:75]
    v_mfma_f32_16x16x32_bf16 v[112:115], a[132:135], a[100:103], v[112:115]
    v_mfma_f32_16x16x32_bf16 v[112:115], a[136:139], a[104:107], v[112:115]
    v_mfma_f32_16x16x32_bf16 v[112:115], a[140:143], a[108:111], v[112:115]
    v_mfma_f32_16x16x32_bf16 v[120:123], a[128:131], a[112:115], v[76:79]
    v_mfma_f32_16x16x32_bf16 v[120:123], a[132:135], a[116:119], v[120:123]
    v_mfma_f32_16x16x32_bf16 v[120:123], a[136:139], a[120:123], v[120:123]
    v_mfma_f32_16x16x32_bf16 v[120:123], a[140:143], a[124:127], v[120:123]
    v_mfma_f32_16x16x32_bf16 v[116:119], a[144:147], a[96:99], v[72:75]
    v_mfma_f32_16x16x32_bf16 v[116:119], a[148:151], a[100:103], v[116:119]
    v_mfma_f32_16x16x32_bf16 v[116:119], a[152:155], a[104:107], v[116:119]
    v_mfma_f32_16x16x32_bf16 v[116:119], a[156:159], a[108:111], v[116:119]
    v_mfma_f32_16x16x32_bf16 v[124:127], a[144:147], a[112:115], v[76:79]
    v_mfma_f32_16x16x32_bf16 v[124:127], a[148:151], a[116:119], v[124:127]
    v_mfma_f32_16x16x32_bf16 v[124:127], a[152:155], a[120:123], v[124:127]
    v_mfma_f32_16x16x32_bf16 v[124:127], a[156:159], a[124:127], v[124:127]
    v_max3_f32 v48, v48, v96, v97
    v_max3_f32 v48, v48, v98, v99
    v_max3_f32 v48, v48, v100, v101
    v_max3_f32 v48, v48, v102, v103
    v_max3_f32 v49, v49, v104, v105
    v_max3_f32 v49, v49, v106, v107
    v_max3_f32 v49, v49, v108, v109
    v_max3_f32 v49, v49, v110, v111
    v_max3_f32 v50, v50, v112, v113
    v_max3_f32 v50, v50, v114, v115
    v_max3_f32 v50, v50, v116, v117
    v_max3_f32 v50, v50, v118, v119
    v_max3_f32 v51, v51, v120, v121
    v_max3_f32 v51, v51, v122, v123
    v_max3_f32 v51, v51, v124, v125
    v_max3_f32 v51, v51, v126, v127
    s_add_u32 s100, s101, 16384
    buffer_load_dwordx4 a[128:131], v1, s[8:11], s100 offen offset:0
    buffer_load_dwordx4 a[132:135], v1, s[8:11], s100 offen offset:1024
    buffer_load_dwordx4 a[136:139], v1, s[8:11], s100 offen offset:2048
    buffer_load_dwordx4 a[140:143], v1, s[8:11], s100 offen offset:3072
    buffer_load_dwordx4 a[144:147], v15, s[8:11], s100 offen offset:0
    buffer_load_dwordx4 a[148:151], v15, s[8:11], s100 offen offset:1024
    buffer_load_dwordx4 a[152:155], v15, s[8:11], s100 offen offset:2048
    buffer_load_dwordx4 a[156:159], v15, s[8:11], s100 offen offset:3072
    s_waitcnt vmcnt(7)
    v_mfma_f32_16x16x32_bf16 v[96:99], a[128:131], a[64:67], v[64:67]
    s_waitcnt vmcnt(6)
    v_mfma_f32_16x16x32_bf16 v[96:99], a[132:135], a[68:71], v[96:99]
    s_waitcnt vmcnt(5)
    v_mfma_f32_16x16x32_bf16 v[96:99], a[136:139], a[72:75], v[96:99]
    s_waitcnt vmcnt(4)
    v_mfma_f32_16x16x32_bf16 v[96:99], a[140:143], a[76:79], v[96:99]
    v_mfma_f32_16x16x32_bf16 v[104:107], a[128:131], a[80:83], v[68:71]
    v_mfma_f32_16x16x32_bf16 v[104:107], a[132:135], a[84:87], v[104:107]
    v_mfma_f32_16x16x32_bf16 v[104:107], a[136:139], a[88:91], v[104:107]
    v_mfma_f32_16x16x32_bf16 v[104:107], a[140:143], a[92:95], v[104:107]
    s_waitcnt vmcnt(3)
    v_mfma_f32_16x16x32_bf16 v[100:103], a[144:147], a[64:67], v[64:67]
    s_waitcnt vmcnt(2)
    v_mfma_f32_16x16x32_bf16 v[100:103], a[148:151], a[68:71], v[100:103]
    s_waitcnt vmcnt(1)
    v_mfma_f32_16x16x32_bf16 v[100:103], a[152:155], a[72:75], v[100:103]
    s_waitcnt vmcnt(0)
    v_mfma_f32_16x16x32_bf16 v[100:103], a[156:159], a[76:79], v[100:103]
    v_mfma_f32_16x16x32_bf16 v[108:111], a[144:147], a[80:83], v[68:71]
    v_mfma_f32_16x16x32_bf16 v[108:111], a[148:151], a[84:87], v[108:111]
    v_mfma_f32_16x16x32_bf16 v[108:111], a[152:155], a[88:91], v[108:111]
    v_mfma_f32_16x16x32_bf16 v[108:111], a[156:159], a[92:95], v[108:111]
    v_mfma_f32_16x16x32_bf16 v[112:115], a[128:131], a[96:99], v[72:75]
    v_mfma_f32_16x16x32_bf16 v[112:115], a[132:135], a[100:103], v[112:115]
    v_mfma_f32_16x16x32_bf16 v[112:115], a[136:139], a[104:107], v[112:115]
    v_mfma_f32_16x16x32_bf16 v[112:115], a[140:143], a[108:111], v[112:115]
    v_mfma_f32_16x16x32_bf16 v[120:123], a[128:131], a[112:115], v[76:79]
    v_mfma_f32_16x16x32_bf16 v[120:123], a[132:135], a[116:119], v[120:123]
    v_mfma_f32_16x16x32_bf16 v[120:123], a[136:139], a[120:123], v[120:123]
    v_mfma_f32_16x16x32_bf16 v[120:123], a[140:143], a[124:127], v[120:123]
    v_mfma_f32_16x16x32_bf16 v[116:119], a[144:147], a[96:99], v[72:75]
    v_mfma_f32_16x16x32_bf16 v[116:119], a[148:151], a[100:103], v[116:119]
    v_mfma_f32_16x16x32_bf16 v[116:119], a[152:155], a[104:107], v[116:119]
    v_mfma_f32_16x16x32_bf16 v[116:119], a[156:159], a[108:111], v[116:119]
    v_mfma_f32_16x16x32_bf16 v[124:127], a[144:147], a[112:115], v[76:79]
    v_mfma_f32_16x16x32_bf16 v[124:127], a[148:151], a[116:119], v[124:127]
    v_mfma_f32_16x16x32_bf16 v[124:127], a[152:155], a[120:123], v[124:127]
    v_mfma_f32_16x16x32_bf16 v[124:127], a[156:159], a[124:127], v[124:127]
    v_max3_f32 v48, v48, v96, v97
    v_max3_f32 v48, v48, v98, v99
    v_max3_f32 v48, v48, v100, v101
    v_max3_f32 v48, v48, v102, v103
    v_max3_f32 v49, v49, v104, v105
    v_max3_f32 v49, v49, v106, v107
    v_max3_f32 v49, v49, v108, v109
    v_max3_f32 v49, v49, v110, v111
    v_max3_f32 v50, v50, v112, v113
    v_max3_f32 v50, v50, v114, v115
    v_max3_f32 v50, v50, v116, v117
    v_max3_f32 v50, v50, v118, v119
    v_max3_f32 v51, v51, v120, v121
    v_max3_f32 v51, v51, v122, v123
    v_max3_f32 v51, v51, v124, v125
    v_max3_f32 v51, v51, v126, v127
    s_add_u32 s101, s101, 65536
    s_sub_u32 s14, s14, 1
    s_nop 7
    s_branch L_t1_maxl
L_t1_maxd:
    s_add_u32 s100, s101, 0
    buffer_load_dwordx4 a[128:131], v1, s[8:11], s100 offen offset:0
    buffer_load_dwordx4 a[132:135], v1, s[8:11], s100 offen offset:1024
    buffer_load_dwordx4 a[136:139], v1, s[8:11], s100 offen offset:2048
    buffer_load_dwordx4 a[140:143], v1, s[8:11], s100 offen offset:3072
    buffer_load_dwordx4 a[144:147], v15, s[8:11], s100 offen offset:0
    buffer_load_dwordx4 a[148:151], v15, s[8:11], s100 offen offset:1024
    buffer_load_dwordx4 a[152:155], v15, s[8:11], s100 offen offset:2048
    buffer_load_dwordx4 a[156:159], v15, s[8:11], s100 offen offset:3072
    v_add_f32 v80, 0, v21
    v_min_f32 v80, v80, v64
    v_add_f32 v81, 0xf1800000, v21
    v_min_f32 v81, v81, v65
    v_add_f32 v82, 0xf2000000, v21
    v_min_f32 v82, v82, v66
    v_add_f32 v83, 0xf2400000, v21
    v_min_f32 v83, v83, v67
    v_add_f32 v84, 0xf3800000, v21
    v_min_f32 v84, v84, v64
    v_add_f32 v85, 0xf3880000, v21
    v_min_f32 v85, v85, v65
    v_add_f32 v86, 0xf3900000, v21
    v_min_f32 v86, v86, v66
    v_add_f32 v87, 0xf3980000, v21
    v_min_f32 v87, v87, v67
    v_add_f32 v88, 0x73800000, v21
    v_min_f32 v88, v88, v68
    v_add_f32 v89, 0x73700000, v21
    v_min_f32 v89, v89, v69
    v_add_f32 v90, 0x73600000, v21
    v_min_f32 v90, v90, v70
    v_add_f32 v91, 0x73500000, v21
    v_min_f32 v91, v91, v71
    v_add_f32 v92, 0, v21
    v_min_f32 v92, v92, v68
    v_add_f32 v93, 0xf1800000, v21
    v_min_f32 v93, v93, v69
    v_add_f32 v94, 0xf2000000, v21
    v_min_f32 v94, v94, v70
    v_add_f32 v95, 0xf2400000, v21
    v_min_f32 v95, v95, v71
    s_waitcnt vmcnt(7)
    v_mfma_f32_16x16x32_bf16 v[96:99], a[128:131], a[64:67], v[80:83]
    s_waitcnt vmcnt(6)
    v_mfma_f32_16x16x32_bf16 v[96:99], a[132:135], a[68:71], v[96:99]
    s_waitcnt vmcnt(5)
    v_mfma_f32_16x16x32_bf16 v[96:99], a[136:139], a[72:75], v[96:99]
    s_waitcnt vmcnt(4)
    v_mfma_f32_16x16x32_bf16 v[96:99], a[140:143], a[76:79], v[96:99]
    v_mfma_f32_16x16x32_bf16 v[104:107], a[128:131], a[80:83], v[88:91]
    v_mfma_f32_16x16x32_bf16 v[104:107], a[132:135], a[84:87], v[104:107]
    v_mfma_f32_16x16x32_bf16 v[104:107], a[136:139], a[88:91], v[104:107]
    v_mfma_f32_16x16x32_bf16 v[104:107], a[140:143], a[92:95], v[104:107]
    s_waitcnt vmcnt(3)
    v_mfma_f32_16x16x32_bf16 v[100:103], a[144:147], a[64:67], v[84:87]
    s_waitcnt vmcnt(2)
    v_mfma_f32_16x16x32_bf16 v[100:103], a[148:151], a[68:71], v[100:103]
    s_waitcnt vmcnt(1)
    v_mfma_f32_16x16x32_bf16 v[100:103], a[152:155], a[72:75], v[100:103]
    s_waitcnt vmcnt(0)
    v_mfma_f32_16x16x32_bf16 v[100:103], a[156:159], a[76:79], v[100:103]
    v_mfma_f32_16x16x32_bf16 v[108:111], a[144:147], a[80:83], v[92:95]
    v_mfma_f32_16x16x32_bf16 v[108:111], a[148:151], a[84:87], v[108:111]
    v_mfma_f32_16x16x32_bf16 v[108:111], a[152:155], a[88:91], v[108:111]
    v_mfma_f32_16x16x32_bf16 v[108:111], a[156:159], a[92:95], v[108:111]
    v_mfma_f32_16x16x32_bf16 v[112:115], a[128:131], a[96:99], v[72:75]
    v_mfma_f32_16x16x32_bf16 v[112:115], a[132:135], a[100:103], v[112:115]
    v_mfma_f32_16x16x32_bf16 v[112:115], a[136:139], a[104:107], v[112:115]
    v_mfma_f32_16x16x32_bf16 v[112:115], a[140:143], a[108:111], v[112:115]
    v_mfma_f32_16x16x32_bf16 v[120:123], a[128:131], a[112:115], v[76:79]
    v_mfma_f32_16x16x32_bf16 v[120:123], a[132:135], a[116:119], v[120:123]
    v_mfma_f32_16x16x32_bf16 v[120:123], a[136:139], a[120:123], v[120:123]
    v_mfma_f32_16x16x32_bf16 v[120:123], a[140:143], a[124:127], v[120:123]
    v_mfma_f32_16x16x32_bf16 v[116:119], a[144:147], a[96:99], v[72:75]
    v_mfma_f32_16x16x32_bf16 v[116:119], a[148:151], a[100:103], v[116:119]
    v_mfma_f32_16x16x32_bf16 v[116:119], a[152:155], a[104:107], v[116:119]
    v_mfma_f32_16x16x32_bf16 v[116:119], a[156:159], a[108:111], v[116:119]
    v_mfma_f32_16x16x32_bf16 v[124:127], a[144:147], a[112:115], v[76:79]
    v_mfma_f32_16x16x32_bf16 v[124:127], a[148:151], a[116:119], v[124:127]
    v_mfma_f32_16x16x32_bf16 v[124:127], a[152:155], a[120:123], v[124:127]
    v_mfma_f32_16x16x32_bf16 v[124:127], a[156:159], a[124:127], v[124:127]
    v_max3_f32 v48, v48, v96, v97
    v_max3_f32 v48, v48, v98, v99
    v_max3_f32 v48, v48, v100, v101
    v_max3_f32 v48, v48, v102, v103
    v_max3_f32 v49, v49, v104, v105
    v_max3_f32 v49, v49, v106, v107
    v_max3_f32 v49, v49, v108, v109
    v_max3_f32 v49, v49, v110, v111
    v_max3_f32 v50, v50, v112, v113
    v_max3_f32 v50, v50, v114, v115
    v_max3_f32 v50, v50, v116, v117
    v_max3_f32 v50, v50, v118, v119
    v_max3_f32 v51, v51, v120, v121
    v_max3_f32 v51, v51, v122, v123
    v_max3_f32 v51, v51, v124, v125
    v_max3_f32 v51, v51, v126, v127
    s_add_u32 s100, s101, 16384
    buffer_load_dwordx4 a[128:131], v1, s[8:11], s100 offen offset:0
    buffer_load_dwordx4 a[132:135], v1, s[8:11], s100 offen offset:1024
    buffer_load_dwordx4 a[136:139], v1, s[8:11], s100 offen offset:2048
    buffer_load_dwordx4 a[140:143], v1, s[8:11], s100 offen offset:3072
    buffer_load_dwordx4 a[144:147], v15, s[8:11], s100 offen offset:0
    buffer_load_dwordx4 a[148:151], v15, s[8:11], s100 offen offset:1024
    buffer_load_dwordx4 a[152:155], v15, s[8:11], s100 offen offset:2048
    buffer_load_dwordx4 a[156:159], v15, s[8:11], s100 offen offset:3072
    v_add_f32 v80, 0, v22
    v_min_f32 v80, v80, v72
    v_add_f32 v81, 0xf1800000, v22
    v_min_f32 v81, v81, v73
    v_add_f32 v82, 0xf2000000, v22
    v_min_f32 v82, v82, v74
    v_add_f32 v83, 0xf2400000, v22
    v_min_f32 v83, v83, v75
    v_add_f32 v84, 0xf3800000, v22
    v_min_f32 v84, v84, v72
    v_add_f32 v85, 0xf3880000, v22
    v_min_f32 v85, v85, v73
    v_add_f32 v86, 0xf3900000, v22
    v_min_f32 v86, v86, v74
    v_add_f32 v87, 0xf3980000, v22
    v_min_f32 v87, v87, v75
    v_add_f32 v88, 0x73800000, v22
    v_min_f32 v88, v88, v76
    v_add_f32 v89, 0x73700000, v22
    v_min_f32 v89, v89, v77
    v_add_f32 v90, 0x73600000, v22
    v_min_f32 v90, v90, v78
    v_add_f32 v91, 0x73500000, v22
    v_min_f32 v91, v91, v79
    v_add_f32 v92, 0, v22
    v_min_f32 v92, v92, v76
    v_add_f32 v93, 0xf1800000, v22
    v_min_f32 v93, v93, v77
    v_add_f32 v94, 0xf2000000, v22
    v_min_f32 v94, v94, v78
    v_add_f32 v95, 0xf2400000, v22
    v_min_f32 v95, v95, v79
    s_waitcnt vmcnt(7)
    v_mfma_f32_16x16x32_bf16 v[96:99], a[128:131], a[96:99], v[80:83]
    s_waitcnt vmcnt(6)
    v_mfma_f32_16x16x32_bf16 v[96:99], a[132:135], a[100:103], v[96:99]
    s_waitcnt vmcnt(5)
    v_mfma_f32_16x16x32_bf16 v[96:99], a[136:139], a[104:107], v[96:99]
    s_waitcnt vmcnt(4)
    v_mfma_f32_16x16x32_bf16 v[96:99], a[140:143], a[108:111], v[96:99]
    v_mfma_f32_16x16x32_bf16 v[104:107], a[128:131], a[112:115], v[88:91]
    v_mfma_f32_16x16x32_bf16 v[104:107], a[132:135], a[116:119], v[104:107]
    v_mfma_f32_16x16x32_bf16 v[104:107], a[136:139], a[120:123], v[104:107]
    v_mfma_f32_16x16x32_bf16 v[104:107], a[140:143], a[124:127], v[104:107]
    s_waitcnt vmcnt(3)
    v_mfma_f32_16x16x32_bf16 v[100:103], a[144:147], a[96:99], v[84:87]
    s_waitcnt vmcnt(2)
    v_mfma_f32_16x16x32_bf16 v[100:103], a[148:151], a[100:103], v[100:103]
    s_waitcnt vmcnt(1)
    v_mfma_f32_16x16x32_bf16 v[100:103], a[152:155], a[104:107], v[100:103]
    s_waitcnt vmcnt(0)
    v_mfma_f32_16x16x32_bf16 v[100:103], a[156:159], a[108:111], v[100:103]
    v_mfma_f32_16x16x32_bf16 v[108:111], a[144:147], a[112:115], v[92:95]
    v_mfma_f32_16x16x32_bf16 v[108:111], a[148:151], a[116:119], v[108:111]
    v_mfma_f32_16x16x32_bf16 v[108:111], a[152:155], a[120:123], v[108:111]
    v_mfma_f32_16x16x32_bf16 v[108:111], a[156:159], a[124:127], v[108:111]
    v_max3_f32 v50, v50, v96, v97
    v_max3_f32 v50, v50, v98, v99
    s_nop 1
    v_max3_f32 v50, v50, v100, v101
    v_max3_f32 v50, v50, v102, v103
    v_max3_f32 v51, v51, v104, v105
    v_max3_f32 v51, v51, v106, v107
    v_max3_f32 v51, v51, v108, v109
    v_max3_f32 v51, v51, v110, v111
    v_mov_b32 v52, v48
    v_mov_b32 v53, v49
    v_mov_b32 v54, v50
    v_mov_b32 v55, v51
    v_permlane16_swap_b32 v48, v52
    v_permlane16_swap_b32 v49, v53
    v_permlane16_swap_b32 v50, v54
    v_permlane16_swap_b32 v51, v55
    v_max_f32 v48, v48, v52
    v_max_f32 v49, v49, v53
    v_max_f32 v50, v50, v54
    v_max_f32 v51, v51, v55
    v_mov_b32 v52, v48
    v_mov_b32 v53, v49
    v_mov_b32 v54, v50
    v_mov_b32 v55, v51
    v_permlane32_swap_b32 v48, v52
    v_permlane32_swap_b32 v49, v53
    v_permlane32_swap_b32 v50, v54
    v_permlane32_swap_b32 v51, v55
    v_max_f32 v48, v48, v52
    v_max_f32 v49, v49, v53
    v_max_f32 v50, v50, v54
    v_max_f32 v51, v51, v55
    ds_write_b128 v16, v[48:51] offset:32768
    v_xor_b32 v8, 8192, v16
    s_waitcnt lgkmcnt(0)
    s_barrier
    ds_read_b128 v[52:55], v8 offset:32768
    s_waitcnt lgkmcnt(0)
    v_max_f32 v48, v48, v52
    v_max_f32 v49, v49, v53
    v_max_f32 v50, v50, v54
    v_max_f32 v51, v51, v55
    v_sub_f32 v64, 0, v48
    v_sub_f32 v65, 0, v48
    v_sub_f32 v66, 0, v48
    v_sub_f32 v67, 0, v48
    v_sub_f32 v68, 0, v49
    v_sub_f32 v69, 0, v49
    v_sub_f32 v70, 0, v49
    v_sub_f32 v71, 0, v49
    v_sub_f32 v72, 0, v50
    v_sub_f32 v73, 0, v50
    v_sub_f32 v74, 0, v50
    v_sub_f32 v75, 0, v50
    v_sub_f32 v76, 0, v51
    v_sub_f32 v77, 0, v51
    v_sub_f32 v78, 0, v51
    v_sub_f32 v79, 0, v51
    s_mov_b32 s12, 0
    s_and_b32 s100, s12, 1
    s_mul_i32 s15, s100, 196608
    s_xor_b32 s15, s15, 65536
    s_mul_i32 s16, s100, 98304
    s_xor_b32 s16, s16, 98304
    v_and_b32 v18, 0x7fff, v18
    v_or_b32 v18, s15, v18
    v_and_b32 v19, 0x7fff, v19
    v_or_b32 v19, s16, v19
    v_and_b32 v20, 0x7fff, v20
    v_or_b32 v20, s16, v20
    s_add_u32 s15, s15, s62
    s_add_u32 s16, s16, s62
    s_add_u32 s12, s12, 2
    s_mov_b32 s82, s81
    s_add_u32 s19, s82, 32768
    s_add_u32 m0, s15, 0
    s_nop 0
    buffer_load_dwordx4 v1, s[8:11], s82 offen offset:0  lds
    buffer_load_dwordx4 v1, s[8:11], s82 offen offset:1024  lds
    buffer_load_dwordx4 v1, s[8:11], s82 offen offset:2048  lds
    buffer_load_dwordx4 v1, s[8:11], s82 offen offset:3072  lds
    s_add_u32 m0, s15, 4096
    s_nop 0
    buffer_load_dwordx4 v15, s[8:11], s82 offen offset:0  lds
    buffer_load_dwordx4 v15, s[8:11], s82 offen offset:1024  lds
    buffer_load_dwordx4 v15, s[8:11], s82 offen offset:2048  lds
    buffer_load_dwordx4 v15, s[8:11], s82 offen offset:3072  lds
    s_xor_b32 s15, s15, 196608
    s_add_u32 m0, s16, 0
    s_nop 0
    buffer_load_dwordx4 v1, s[8:11], s19 offen offset:0  lds
    buffer_load_dwordx4 v1, s[8:11], s19 offen offset:1024  lds
    buffer_load_dwordx4 v1, s[8:11], s19 offen offset:2048  lds
    buffer_load_dwordx4 v1, s[8:11], s19 offen offset:3072  lds
    s_add_u32 m0, s16, 4096
    s_nop 0
    buffer_load_dwordx4 v15, s[8:11], s19 offen offset:0  lds
    buffer_load_dwordx4 v15, s[8:11], s19 offen offset:1024  lds
    buffer_load_dwordx4 v15, s[8:11], s19 offen offset:2048  lds
    buffer_load_dwordx4 v15, s[8:11], s19 offen offset:3072  lds
    s_xor_b32 s16, s16, 98304
    s_cmp_eq_u32 s60, 0
    s_cselect_b32 s82, 0, 1
    s_mul_i32 s82, s82, 65536
    s_add_u32 s82, s82, s81
    s_add_u32 m0, s15, 0
    s_nop 0
    buffer_load_dwordx4 v1, s[8:11], s82 offen offset:0  lds
    buffer_load_dwordx4 v1, s[8:11], s82 offen offset:1024  lds
    buffer_load_dwordx4 v1, s[8:11], s82 offen offset:2048  lds
    buffer_load_dwordx4 v1, s[8:11], s82 offen offset:3072  lds
    s_add_u32 m0, s15, 4096
    s_nop 0
    buffer_load_dwordx4 v15, s[8:11], s82 offen offset:0  lds
    buffer_load_dwordx4 v15, s[8:11], s82 offen offset:1024  lds
    buffer_load_dwordx4 v15, s[8:11], s82 offen offset:2048  lds
    buffer_load_dwordx4 v15, s[8:11], s82 offen offset:3072  lds
    s_xor_b32 s15, s15, 196608
    s_cmp_eq_u32 s60, 0
    s_cselect_b32 s19, 0, 0x76800000
    v_add_f32 v3, s19, v21
    v_add_f32 v96, 0, v3
    v_min_f32 v96, v96, v64
    v_add_f32 v97, 0xf1800000, v3
    v_min_f32 v97, v97, v65
    v_add_f32 v98, 0xf2000000, v3
    v_min_f32 v98, v98, v66
    v_add_f32 v99, 0xf2400000, v3
    v_min_f32 v99, v99, v67
    v_add_f32 v100, 0xf3800000, v3
    v_min_f32 v100, v100, v64
    v_add_f32 v101, 0xf3880000, v3
    v_min_f32 v101, v101, v65
    v_add_f32 v102, 0xf3900000, v3
    v_min_f32 v102, v102, v66
    v_add_f32 v103, 0xf3980000, v3
    v_min_f32 v103, v103, v67
    v_add_f32 v104, 0x73800000, v3
    v_min_f32 v104, v104, v68
    v_add_f32 v105, 0x73700000, v3
    v_min_f32 v105, v105, v69
    v_add_f32 v106, 0x73600000, v3
    v_min_f32 v106, v106, v70
    v_add_f32 v107, 0x73500000, v3
    v_min_f32 v107, v107, v71
    v_add_f32 v108, 0, v3
    v_min_f32 v108, v108, v68
    v_add_f32 v109, 0xf1800000, v3
    v_min_f32 v109, v109, v69
    v_add_f32 v110, 0xf2000000, v3
    v_min_f32 v110, v110, v70
    v_add_f32 v111, 0xf2400000, v3
    v_min_f32 v111, v111, v71
    v_add_f32 v80, 0, v22
    v_min_f32 v80, v80, v72
    v_add_f32 v81, 0xf1800000, v22
    v_min_f32 v81, v81, v73
    v_add_f32 v82, 0xf2000000, v22
    v_min_f32 v82, v82, v74
    v_add_f32 v83, 0xf2400000, v22
    v_min_f32 v83, v83, v75
    v_add_f32 v84, 0xf3800000, v22
    v_min_f32 v84, v84, v72
    v_add_f32 v85, 0xf3880000, v22
    v_min_f32 v85, v85, v73
    v_add_f32 v86, 0xf3900000, v22
    v_min_f32 v86, v86, v74
    v_add_f32 v87, 0xf3980000, v22
    v_min_f32 v87, v87, v75
    v_add_f32 v88, 0x73800000, v22
    v_min_f32 v88, v88, v76
    v_add_f32 v89, 0x73700000, v22
    v_min_f32 v89, v89, v77
    v_add_f32 v90, 0x73600000, v22
    v_min_f32 v90, v90, v78
    v_add_f32 v91, 0x73500000, v22
    v_min_f32 v91, v91, v79
    v_add_f32 v92, 0, v22
    v_min_f32 v92, v92, v76
    v_add_f32 v93, 0xf1800000, v22
    v_min_f32 v93, v93, v77
    v_add_f32 v94, 0xf2000000, v22
    v_min_f32 v94, v94, v78
    v_add_f32 v95, 0xf2400000, v22
    v_min_f32 v95, v95, v79
    s_cmp_eq_u32 s60, 0
    s_cbranch_scc1 L_t1_mk
    v_add_f32 v80, 0, v21
    v_min_f32 v80, v80, v64
    v_add_f32 v81, 0xf1800000, v21
    v_min_f32 v81, v81, v65
    v_add_f32 v82, 0xf2000000, v21
    v_min_f32 v82, v82, v66
    v_add_f32 v83, 0xf2400000, v21
    v_min_f32 v83, v83, v67
    v_add_f32 v84, 0xf3800000, v21
    v_min_f32 v84, v84, v64
    v_add_f32 v85, 0xf3880000, v21
    v_min_f32 v85, v85, v65
    v_add_f32 v86, 0xf3900000, v21
    v_min_f32 v86, v86, v66
    v_add_f32 v87, 0xf3980000, v21
    v_min_f32 v87, v87, v67
    v_add_f32 v88, 0x73800000, v21
    v_min_f32 v88, v88, v68
    v_add_f32 v89, 0x73700000, v21
    v_min_f32 v89, v89, v69
    v_add_f32 v90, 0x73600000, v21
    v_min_f32 v90, v90, v70
    v_add_f32 v91, 0x73500000, v21
    v_min_f32 v91, v91, v71
    v_add_f32 v92, 0, v21
    v_min_f32 v92, v92, v68
    v_add_f32 v93, 0xf1800000, v21
    v_min_f32 v93, v93, v69
    v_add_f32 v94, 0xf2000000, v21
    v_min_f32 v94, v94, v70
    v_add_f32 v95, 0xf2400000, v21
    v_min_f32 v95, v95, v71
L_t1_mk:
    s_waitcnt vmcnt(0) lgkmcnt(0)
    s_barrier
    ds_read_b128 a[128:131], v18 offset:0
    ds_read_b128 a[132:135], v18 offset:1024
    ds_read_b128 a[136:139], v18 offset:2048
    ds_read_b128 a[140:143], v18 offset:3072
    ds_read_b128 a[144:147], v18 offset:4096
    ds_read_b128 a[148:151], v18 offset:5120
    ds_read_b128 a[152:155], v18 offset:6144
    ds_read_b128 a[156:159], v18 offset:7168
    s_waitcnt lgkmcnt(0)
    s_branch L_t1_start
L_C1_slow_9:
    s_mov_b32 s99, 0
L_C1_slow_9_l:
    s_sleep 4
    buffer_load_dword v3, v4, s[8:11], s23 offen sc0 sc1
    s_add_u32 s99, s99, 1
    s_waitcnt vmcnt(0)
    v_cmp_ne_u32 vcc, 0, v3
    s_cmp_eq_u64 vcc, -1
    s_cbranch_scc1 L_C1_ok_10
    s_cmp_lt_u32 s99, 200000
    s_cbranch_scc1 L_C1_slow_9_l
    s_branch L_C1_ok_10
L_F_slow_11:
    s_mov_b32 s99, 0
L_F_slow_11_l:
    s_sleep 4
    buffer_load_dword v3, v12, s[8:11], s71 offen sc0 sc1
    s_add_u32 s99, s99, 1
    s_waitcnt vmcnt(0)
    v_cmp_ne_u32 vcc, 0, v3
    s_cmp_eq_u64 vcc, -1
    s_cbranch_scc1 L_F_ok_12
    s_cmp_lt_u32 s99, 200000
    s_cbranch_scc1 L_F_slow_11_l
    s_branch L_F_ok_12
L_t2_redo:
    s_cmp_eq_u32 s25, 0
    s_cbranch_scc1 L_t2_max
    s_mov_b32 s25, 0
    v_mov_b32 v64, 0
    v_mov_b32 v65, 0
    v_mov_b32 v66, 0
    v_mov_b32 v67, 0
    v_mov_b32 v68, 0
    v_mov_b32 v69, 0
    v_mov_b32 v70, 0
    v_mov_b32 v71, 0
    v_mov_b32 v72, 0
    v_mov_b32 v73, 0
    v_mov_b32 v74, 0
    v_mov_b32 v75, 0
    v_mov_b32 v76, 0
    v_mov_b32 v77, 0
    v_mov_b32 v78, 0
    v_mov_b32 v79, 0
    s_nop 1
    s_branch L_t2_safe
L_t2_max:
    s_waitcnt vmcnt(0) lgkmcnt(0)
    s_barrier
    s_mov_b32 s25, 1
    s_and_b32 s100, s3, 1
    s_lshl_b32 s100, s100, 13
    s_sub_u32 s101, s81, s62
    s_add_u32 s101, s101, s100
    s_mov_b32 s14, s61
    s_mov_b32 s26, 0
    v_mov_b32 v24, -1
    v_mov_b32 v25, -1
    v_mov_b32 v26, -1
    v_mov_b32 v27, -1
    v_mov_b32 v48, 0xff800000
    v_mov_b32 v49, 0xff800000
    v_mov_b32 v50, 0xff800000
    v_mov_b32 v51, 0xff800000
L_t2_maxl:
    s_cmp_eq_u32 s14, 0
    s_cbranch_scc1 L_t2_maxd
    s_add_u32 s100, s101, 0
    buffer_load_dwordx4 a[128:131], v1, s[8:11], s100 offen offset:0
    buffer_load_dwordx4 a[132:135], v1, s[8:11], s100 offen offset:1024
    buffer_load_dwordx4 a[136:139], v1, s[8:11], s100 offen offset:2048
    buffer_load_dwordx4 a[140:143], v1, s[8:11], s100 offen offset:3072
    buffer_load_dwordx4 a[144:147], v15, s[8:11], s100 offen offset:0
    buffer_load_dwordx4 a[148:151], v15, s[8:11], s100 offen offset:1024
    buffer_load_dwordx4 a[152:155], v15, s[8:11], s100 offen offset:2048
    buffer_load_dwordx4 a[156:159], v15, s[8:11], s100 offen offset:3072
    s_waitcnt vmcnt(7)
    v_mfma_f32_16x16x32_bf16 v[96:99], a[128:131], a[192:195], v[64:67]
    s_waitcnt vmcnt(6)
    v_mfma_f32_16x16x32_bf16 v[96:99], a[132:135], a[196:199], v[96:99]
    s_waitcnt vmcnt(5)
    v_mfma_f32_16x16x32_bf16 v[96:99], a[136:139], a[200:203], v[96:99]
    s_waitcnt vmcnt(4)
    v_mfma_f32_16x16x32_bf16 v[96:99], a[140:143], a[204:207], v[96:99]
    v_mfma_f32_16x16x32_bf16 v[104:107], a[128:131], a[208:211], v[68:71]
    v_mfma_f32_16x16x32_bf16 v[104:107], a[132:135], a[212:215], v[104:107]
    v_mfma_f32_16x16x32_bf16 v[104:107], a[136:139], a[216:219], v[104:107]
    v_mfma_f32_16x16x32_bf16 v[104:107], a[140:143], a[220:223], v[104:107]
    s_waitcnt vmcnt(3)
    v_mfma_f32_16x16x32_bf16 v[100:103], a[144:147], a[192:195], v[64:67]
    s_waitcnt vmcnt(2)
    v_mfma_f32_16x16x32_bf16 v[100:103], a[148:151], a[196:199], v[100:103]
    s_waitcnt vmcnt(1)
    v_mfma_f32_16x16x32_bf16 v[100:103], a[152:155], a[200:203], v[100:103]
    s_waitcnt vmcnt(0)
    v_mfma_f32_16x16x32_bf16 v[100:103], a[156:159], a[204:207], v[100:103]
    v_mfma_f32_16x16x32_bf16 v[108:111], a[144:147], a[208:211], v[68:71]
    v_mfma_f32_16x16x32_bf16 v[108:111], a[148:151], a[212:215], v[108:111]
    v_mfma_f32_16x16x32_bf16 v[108:111], a[152:155], a[216:219], v[108:111]
    v_mfma_f32_16x16x32_bf16 v[108:111], a[156:159], a[220:223], v[108:111]
    v_mfma_f32_16x16x32_bf16 v[112:115], a[128:131], a[224:227], v[72:75]
    v_mfma_f32_16x16x32_bf16 v[112:115], a[132:135], a[228:231], v[112:115]
    v_mfma_f32_16x16x32_bf16 v[112:115], a[136:139], a[232:235], v[112:115]
    v_mfma_f32_16x16x32_bf16 v[112:115], a[140:143], a[236:239], v[112:115]
    v_mfma_f32_16x16x32_bf16 v[120:123], a[128:131], a[240:243], v[76:79]
    v_mfma_f32_16x16x32_bf16 v[120:123], a[132:135], a[244:247], v[120:123]
    v_mfma_f32_16x16x32_bf16 v[120:123], a[136:139], a[248:251], v[120:123]
    v_mfma_f32_16x16x32_bf16 v[120:123], a[140:143], a[252:255], v[120:123]
    v_mfma_f32_16x16x32_bf16 v[116:119], a[144:147], a[224:227], v[72:75]
    v_mfma_f32_16x16x32_bf16 v[116:119], a[148:151], a[228:231], v[116:119]
    v_mfma_f32_16x16x32_bf16 v[116:119], a[152:155], a[232:235], v[116:119]
    v_mfma_f32_16x16x32_bf16 v[116:119], a[156:159], a[236:239], v[116:119]
    v_mfma_f32_16x16x32_bf16 v[124:127], a[144:147], a[240:243], v[76:79]
    v_mfma_f32_16x16x32_bf16 v[124:127], a[148:151], a[244:247], v[124:127]
    v_mfma_f32_16x16x32_bf16 v[124:127], a[152:155], a[248:251], v[124:127]
    v_mfma_f32_16x16x32_bf16 v[124:127], a[156:159], a[252:255], v[124:127]
    v_max3_f32 v48, v48, v96, v97
    v_max3_f32 v48, v48, v98, v99
    v_max3_f32 v48, v48, v100, v101
    v_max3_f32 v48, v48, v102, v103
    v_max3_f32 v49, v49, v104, v105
    v_max3_f32 v49, v49, v106, v107
    v_max3_f32 v49, v49, v108, v109
    v_max3_f32 v49, v49, v110, v111
    v_max3_f32 v50, v50, v112, v113
    v_max3_f32 v50, v50, v114, v115
    v_max3_f32 v50, v50, v116, v117
    v_max3_f32 v50, v50, v118, v119
    v_max3_f32 v51, v51, v120, v121
    v_max3_f32 v51, v51, v122, v123
    v_max3_f32 v51, v51, v124, v125
    v_max3_f32 v51, v51, v126, v127
    s_add_u32 s100, s101, 16384
    buffer_load_dwordx4 a[128:131], v1, s[8:11], s100 offen offset:0
    buffer_load_dwordx4 a[132:135], v1, s[8:11], s100 offen offset:1024
    buffer_load_dwordx4 a[136:139], v1, s[8:11], s100 offen offset:2048
    buffer_load_dwordx4 a[140:143], v1, s[8:11], s100 offen offset:3072
    buffer_load_dwordx4 a[144:147], v15, s[8:11], s100 offen offset:0
    buffer_load_dwordx4 a[148:151], v15, s[8:11], s100 offen offset:1024
    buffer_load_dwordx4 a[152:155], v15, s[8:11], s100 offen offset:2048
    buffer_load_dwordx4 a[156:159], v15, s[8:11], s100 offen offset:3072
    s_waitcnt vmcnt(7)
    v_mfma_f32_16x16x32_bf16 v[96:99], a[128:131], a[192:195], v[64:67]
    s_waitcnt vmcnt(6)
    v_mfma_f32_16x16x32_bf16 v[96:99], a[132:135], a[196:199], v[96:99]
    s_waitcnt vmcnt(5)
    v_mfma_f32_16x16x32_bf16 v[96:99], a[136:139], a[200:203], v[96:99]
    s_waitcnt vmcnt(4)
    v_mfma_f32_16x16x32_bf16 v[96:99], a[140:143], a[204:207], v[96:99]
    v_mfma_f32_16x16x32_bf16 v[104:107], a[128:131], a[208:211], v[68:71]
    v_mfma_f32_16x16x32_bf16 v[104:107], a[132:135], a[212:215], v[104:107]
    v_mfma_f32_16x16x32_bf16 v[104:107], a[136:139], a[216:219], v[104:107]
    v_mfma_f32_16x16x32_bf16 v[104:107], a[140:143], a[220:223], v[104:107]
    s_waitcnt vmcnt(3)
    v_mfma_f32_16x16x32_bf16 v[100:103], a[144:147], a[192:195], v[64:67]
    s_waitcnt vmcnt(2)
    v_mfma_f32_16x16x32_bf16 v[100:103], a[148:151], a[196:199], v[100:103]
    s_waitcnt vmcnt(1)
    v_mfma_f32_16x16x32_bf16 v[100:103], a[152:155], a[200:203], v[100:103]
    s_waitcnt vmcnt(0)
    v_mfma_f32_16x16x32_bf16 v[100:103], a[156:159], a[204:207], v[100:103]
    v_mfma_f32_16x16x32_bf16 v[108:111], a[144:147], a[208:211], v[68:71]
    v_mfma_f32_16x16x32_bf16 v[108:111], a[148:151], a[212:215], v[108:111]
    v_mfma_f32_16x16x32_bf16 v[108:111], a[152:155], a[216:219], v[108:111]
    v_mfma_f32_16x16x32_bf16 v[108:111], a[156:159], a[220:223], v[108:111]
    v_mfma_f32_16x16x32_bf16 v[112:115], a[128:131], a[224:227], v[72:75]
    v_mfma_f32_16x16x32_bf16 v[112:115], a[132:135], a[228:231], v[112:115]
    v_mfma_f32_16x16x32_bf16 v[112:115], a[136:139], a[232:235], v[112:115]
    v_mfma_f32_16x16x32_bf16 v[112:115], a[140:143], a[236:239], v[112:115]
    v_mfma_f32_16x16x32_bf16 v[120:123], a[128:131], a[240:243], v[76:79]
    v_mfma_f32_16x16x32_bf16 v[120:123], a[132:135], a[244:247], v[120:123]
    v_mfma_f32_16x16x32_bf16 v[120:123], a[136:139], a[248:251], v[120:123]
    v_mfma_f32_16x16x32_bf16 v[120:123], a[140:143], a[252:255], v[120:123]
    v_mfma_f32_16x16x32_bf16 v[116:119], a[144:147], a[224:227], v[72:75]
    v_mfma_f32_16x16x32_bf16 v[116:119], a[148:151], a[228:231], v[116:119]
    v_mfma_f32_16x16x32_bf16 v[116:119], a[152:155], a[232:235], v[116:119]
    v_mfma_f32_16x16x32_bf16 v[116:119], a[156:159], a[236:239], v[116:119]
    v_mfma_f32_16x16x32_bf16 v[124:127], a[144:147], a[240:243], v[76:79]
    v_mfma_f32_16x16x32_bf16 v[124:127], a[148:151], a[244:247], v[124:127]
    v_mfma_f32_16x16x32_bf16 v[124:127], a[152:155], a[248:251], v[124:127]
    v_mfma_f32_16x16x32_bf16 v[124:127], a[156:159], a[252:255], v[124:127]
    v_max3_f32 v48, v48, v96, v97
    v_max3_f32 v48, v48, v98, v99
    v_max3_f32 v48, v48, v100, v101
    v_max3_f32 v48, v48, v102, v103
    v_max3_f32 v49, v49, v104, v105
    v_max3_f32 v49, v49, v106, v107
    v_max3_f32 v49, v49, v108, v109
    v_max3_f32 v49, v49, v110, v111
    v_max3_f32 v50, v50, v112, v113
    v_max3_f32 v50, v50, v114, v115
    v_max3_f32 v50, v50, v116, v117
    v_max3_f32 v50, v50, v118, v119
    v_max3_f32 v51, v51, v120, v121
    v_max3_f32 v51, v51, v122, v123
    v_max3_f32 v51, v51, v124, v125
    v_max3_f32 v51, v51, v126, v127
    s_add_u32 s101, s101, 65536
    s_sub_u32 s14, s14, 1
    s_nop 7
    s_branch L_t2_maxl
L_t2_maxd:
    s_add_u32 s100, s101, 0
    buffer_load_dwordx4 a[128:131], v1, s[8:11], s100 offen offset:0
    buffer_load_dwordx4 a[132:135], v1, s[8:11], s100 offen offset:1024
    buffer_load_dwordx4 a[136:139], v1, s[8:11], s100 offen offset:2048
    buffer_load_dwordx4 a[140:143], v1, s[8:11], s100 offen offset:3072
    buffer_load_dwordx4 a[144:147], v15, s[8:11], s100 offen offset:0
    buffer_load_dwordx4 a[148:151], v15, s[8:11], s100 offen offset:1024
    buffer_load_dwordx4 a[152:155], v15, s[8:11], s100 offen offset:2048
    buffer_load_dwordx4 a[156:159], v15, s[8:11], s100 offen offset:3072
    v_add_f32 v80, 0, v21
    v_min_f32 v80, v80, v64
    v_add_f32 v81, 0xf1800000, v21
    v_min_f32 v81, v81, v65
    v_add_f32 v82, 0xf2000000, v21
    v_min_f32 v82, v82, v66
    v_add_f32 v83, 0xf2400000, v21
    v_min_f32 v83, v83, v67
    v_add_f32 v84, 0xf3800000, v21
    v_min_f32 v84, v84, v64
    v_add_f32 v85, 0xf3880000, v21
    v_min_f32 v85, v85, v65
    v_add_f32 v86, 0xf3900000, v21
    v_min_f32 v86, v86, v66
    v_add_f32 v87, 0xf3980000, v21
    v_min_f32 v87, v87, v67
    v_add_f32 v88, 0x73800000, v21
    v_min_f32 v88, v88, v68
    v_add_f32 v89, 0x73700000, v21
    v_min_f32 v89, v89, v69
    v_add_f32 v90, 0x73600000, v21
    v_min_f32 v90, v90, v70
    v_add_f32 v91, 0x73500000, v21
    v_min_f32 v91, v91, v71
    v_add_f32 v92, 0, v21
    v_min_f32 v92, v92, v68
    v_add_f32 v93, 0xf1800000, v21
    v_min_f32 v93, v93, v69
    v_add_f32 v94, 0xf2000000, v21
    v_min_f32 v94, v94, v70
    v_add_f32 v95, 0xf2400000, v21
    v_min_f32 v95, v95, v71
    s_waitcnt vmcnt(7)
    v_mfma_f32_16x16x32_bf16 v[96:99], a[128:131], a[192:195], v[80:83]
    s_waitcnt vmcnt(6)
    v_mfma_f32_16x16x32_bf16 v[96:99], a[132:135], a[196:199], v[96:99]
    s_waitcnt vmcnt(5)
    v_mfma_f32_16x16x32_bf16 v[96:99], a[136:139], a[200:203], v[96:99]
    s_waitcnt vmcnt(4)
    v_mfma_f32_16x16x32_bf16 v[96:99], a[140:143], a[204:207], v[96:99]
    v_mfma_f32_16x16x32_bf16 v[104:107], a[128:131], a[208:211], v[88:91]
    v_mfma_f32_16x16x32_bf16 v[104:107], a[132:135], a[212:215], v[104:107]
    v_mfma_f32_16x16x32_bf16 v[104:107], a[136:139], a[216:219], v[104:107]
    v_mfma_f32_16x16x32_bf16 v[104:107], a[140:143], a[220:223], v[104:107]
    s_waitcnt vmcnt(3)
    v_mfma_f32_16x16x32_bf16 v[100:103], a[144:147], a[192:195], v[84:87]
    s_waitcnt vmcnt(2)
    v_mfma_f32_16x16x32_bf16 v[100:103], a[148:151], a[196:199], v[100:103]
    s_waitcnt vmcnt(1)
    v_mfma_f32_16x16x32_bf16 v[100:103], a[152:155], a[200:203], v[100:103]
    s_waitcnt vmcnt(0)
    v_mfma_f32_16x16x32_bf16 v[100:103], a[156:159], a[204:207], v[100:103]
    v_mfma_f32_16x16x32_bf16 v[108:111], a[144:147], a[208:211], v[92:95]
    v_mfma_f32_16x16x32_bf16 v[108:111], a[148:151], a[212:215], v[108:111]
    v_mfma_f32_16x16x32_bf16 v[108:111], a[152:155], a[216:219], v[108:111]
    v_mfma_f32_16x16x32_bf16 v[108:111], a[156:159], a[220:223], v[108:111]
    v_mfma_f32_16x16x32_bf16 v[112:115], a[128:131], a[224:227], v[72:75]
    v_mfma_f32_16x16x32_bf16 v[112:115], a[132:135], a[228:231], v[112:115]
    v_mfma_f32_16x16x32_bf16 v[112:115], a[136:139], a[232:235], v[112:115]
    v_mfma_f32_16x16x32_bf16 v[112:115], a[140:143], a[236:239], v[112:115]
    v_mfma_f32_16x16x32_bf16 v[120:123], a[128:131], a[240:243], v[76:79]
    v_mfma_f32_16x16x32_bf16 v[120:123], a[132:135], a[244:247], v[120:123]
    v_mfma_f32_16x16x32_bf16 v[120:123], a[136:139], a[248:251], v[120:123]
    v_mfma_f32_16x16x32_bf16 v[120:123], a[140:143], a[252:255], v[120:123]
    v_mfma_f32_16x16x32_bf16 v[116:119], a[144:147], a[224:227], v[72:75]
    v_mfma_f32_16x16x32_bf16 v[116:119], a[148:151], a[228:231], v[116:119]
    v_mfma_f32_16x16x32_bf16 v[116:119], a[152:155], a[232:235], v[116:119]
    v_mfma_f32_16x16x32_bf16 v[116:119], a[156:159], a[236:239], v[116:119]
    v_mfma_f32_16x16x32_bf16 v[124:127], a[144:147], a[240:243], v[76:79]
    v_mfma_f32_16x16x32_bf16 v[124:127], a[148:151], a[244:247], v[124:127]
    v_mfma_f32_16x16x32_bf16 v[124:127], a[152:155], a[248:251], v[124:127]
    v_mfma_f32_16x16x32_bf16 v[124:127], a[156:159], a[252:255], v[124:127]
    v_max3_f32 v48, v48, v96, v97
    v_max3_f32 v48, v48, v98, v99
    v_max3_f32 v48, v48, v100, v101
    v_max3_f32 v48, v48, v102, v103
    v_max3_f32 v49, v49, v104, v105
    v_max3_f32 v49, v49, v106, v107
    v_max3_f32 v49, v49, v108, v109
    v_max3_f32 v49, v49, v110, v111
    v_max3_f32 v50, v50, v112, v113
    v_max3_f32 v50, v50, v114, v115
    v_max3_f32 v50, v50, v116, v117
    v_max3_f32 v50, v50, v118, v119
    v_max3_f32 v51, v51, v120, v121
    v_max3_f32 v51, v51, v122, v123
    v_max3_f32 v51, v51, v124, v125
    v_max3_f32 v51, v51, v126, v127
    s_add_u32 s100, s101, 16384
    buffer_load_dwordx4 a[128:131], v1, s[8:11], s100 offen offset:0
    buffer_load_dwordx4 a[132:135], v1, s[8:11], s100 offen offset:1024
    buffer_load_dwordx4 a[136:139], v1, s[8:11], s100 offen offset:2048
    buffer_load_dwordx4 a[140:143], v1, s[8:11], s100 offen offset:3072
    buffer_load_dwordx4 a[144:147], v15, s[8:11], s100 offen offset:0
    buffer_load_dwordx4 a[148:151], v15, s[8:11], s100 offen offset:1024
    buffer_load_dwordx4 a[152:155], v15, s[8:11], s100 offen offset:2048
    buffer_load_dwordx4 a[156:159], v15, s[8:11], s100 offen offset:3072
    v_add_f32 v80, 0, v22
    v_min_f32 v80, v80, v72
    v_add_f32 v81, 0xf1800000, v22
    v_min_f32 v81, v81, v73
    v_add_f32 v82, 0xf2000000, v22
    v_min_f32 v82, v82, v74
    v_add_f32 v83, 0xf2400000, v22
    v_min_f32 v83, v83, v75
    v_add_f32 v84, 0xf3800000, v22
    v_min_f32 v84, v84, v72
    v_add_f32 v85, 0xf3880000, v22
    v_min_f32 v85, v85, v73
    v_add_f32 v86, 0xf3900000, v22
    v_min_f32 v86, v86, v74
    v_add_f32 v87, 0xf3980000, v22
    v_min_f32 v87, v87, v75
    v_add_f32 v88, 0x73800000, v22
    v_min_f32 v88, v88, v76
    v_add_f32 v89, 0x73700000, v22
    v_min_f32 v89, v89, v77
    v_add_f32 v90, 0x73600000, v22
    v_min_f32 v90, v90, v78
    v_add_f32 v91, 0x73500000, v22
    v_min_f32 v91, v91, v79
    v_add_f32 v92, 0, v22
    v_min_f32 v92, v92, v76
    v_add_f32 v93, 0xf1800000, v22
    v_min_f32 v93, v93, v77
    v_add_f32 v94, 0xf2000000, v22
    v_min_f32 v94, v94, v78
    v_add_f32 v95, 0xf2400000, v22
    v_min_f32 v95, v95, v79
    s_waitcnt vmcnt(7)
    v_mfma_f32_16x16x32_bf16 v[96:99], a[128:131], a[224:227], v[80:83]
    s_waitcnt vmcnt(6)
    v_mfma_f32_16x16x32_bf16 v[96:99], a[132:135], a[228:231], v[96:99]
    s_waitcnt vmcnt(5)
    v_mfma_f32_16x16x32_bf16 v[96:99], a[136:139], a[232:235], v[96:99]
    s_waitcnt vmcnt(4)
    v_mfma_f32_16x16x32_bf16 v[96:99], a[140:143], a[236:239], v[96:99]
    v_mfma_f32_16x16x32_bf16 v[104:107], a[128:131], a[240:243], v[88:91]
    v_mfma_f32_16x16x32_bf16 v[104:107], a[132:135], a[244:247], v[104:107]
    v_mfma_f32_16x16x32_bf16 v[104:107], a[136:139], a[248:251], v[104:107]
    v_mfma_f32_16x16x32_bf16 v[104:107], a[140:143], a[252:255], v[104:107]
    s_waitcnt vmcnt(3)
    v_mfma_f32_16x16x32_bf16 v[100:103], a[144:147], a[224:227], v[84:87]
    s_waitcnt vmcnt(2)
    v_mfma_f32_16x16x32_bf16 v[100:103], a[148:151], a[228:231], v[100:103]
    s_waitcnt vmcnt(1)
    v_mfma_f32_16x16x32_bf16 v[100:103], a[152:155], a[232:235], v[100:103]
    s_waitcnt vmcnt(0)
    v_mfma_f32_16x16x32_bf16 v[100:103], a[156:159], a[236:239], v[100:103]
    v_mfma_f32_16x16x32_bf16 v[108:111], a[144:147], a[240:243], v[92:95]
    v_mfma_f32_16x16x32_bf16 v[108:111], a[148:151], a[244:247], v[108:111]
    v_mfma_f32_16x16x32_bf16 v[108:111], a[152:155], a[248:251], v[108:111]
    v_mfma_f32_16x16x32_bf16 v[108:111], a[156:159], a[252:255], v[108:111]
    v_max3_f32 v50, v50, v96, v97
    v_max3_f32 v50, v50, v98, v99
    s_nop 1
    v_max3_f32 v50, v50, v100, v101
    v_max3_f32 v50, v50, v102, v103
    v_max3_f32 v51, v51, v104, v105
    v_max3_f32 v51, v51, v106, v107
    v_max3_f32 v51, v51, v108, v109
    v_max3_f32 v51, v51, v110, v111
    v_mov_b32 v52, v48
    v_mov_b32 v53, v49
    v_mov_b32 v54, v50
    v_mov_b32 v55, v51
    v_permlane16_swap_b32 v48, v52
    v_permlane16_swap_b32 v49, v53
    v_permlane16_swap_b32 v50, v54
    v_permlane16_swap_b32 v51, v55
    v_max_f32 v48, v48, v52
    v_max_f32 v49, v49, v53
    v_max_f32 v50, v50, v54
    v_max_f32 v51, v51, v55
    v_mov_b32 v52, v48
    v_mov_b32 v53, v49
    v_mov_b32 v54, v50
    v_mov_b32 v55, v51
    v_permlane32_swap_b32 v48, v52
    v_permlane32_swap_b32 v49, v53
    v_permlane32_swap_b32 v50, v54
    v_permlane32_swap_b32 v51, v55
    v_max_f32 v48, v48, v52
    v_max_f32 v49, v49, v53
    v_max_f32 v50, v50, v54
    v_max_f32 v51, v51, v55
    ds_write_b128 v16, v[48:51] offset:32768
    v_xor_b32 v8, 8192, v16
    s_waitcnt lgkmcnt(0)
    s_barrier
    ds_read_b128 v[52:55], v8 offset:32768
    s_waitcnt lgkmcnt(0)
    v_max_f32 v48, v48, v52
    v_max_f32 v49, v49, v53
    v_max_f32 v50, v50, v54
    v_max_f32 v51, v51, v55
    v_sub_f32 v64, 0, v48
    v_sub_f32 v65, 0, v48
    v_sub_f32 v66, 0, v48
    v_sub_f32 v67, 0, v48
    v_sub_f32 v68, 0, v49
    v_sub_f32 v69, 0, v49
    v_sub_f32 v70, 0, v49
    v_sub_f32 v71, 0, v49
    v_sub_f32 v72, 0, v50
    v_sub_f32 v73, 0, v50
    v_sub_f32 v74, 0, v50
    v_sub_f32 v75, 0, v50
    v_sub_f32 v76, 0, v51
    v_sub_f32 v77, 0, v51
    v_sub_f32 v78, 0, v51
    v_sub_f32 v79, 0, v51
    s_add_u32 s12, s13, 1
    s_and_b32 s100, s12, 1
    s_mul_i32 s15, s100, 196608
    s_xor_b32 s15, s15, 65536
    s_mul_i32 s16, s100, 98304
    s_xor_b32 s16, s16, 98304
    v_and_b32 v18, 0x7fff, v18
    v_or_b32 v18, s15, v18
    v_and_b32 v19, 0x7fff, v19
    v_or_b32 v19, s16, v19
    v_and_b32 v20, 0x7fff, v20
    v_or_b32 v20, s16, v20
    s_add_u32 s15, s15, s62
    s_add_u32 s16, s16, s62
    s_add_u32 s12, s12, 2
    s_mov_b32 s82, s81
    s_add_u32 s19, s82, 32768
    s_add_u32 m0, s15, 0
    s_nop 0
    buffer_load_dwordx4 v1, s[8:11], s82 offen offset:0  lds
    buffer_load_dwordx4 v1, s[8:11], s82 offen offset:1024  lds
    buffer_load_dwordx4 v1, s[8:11], s82 offen offset:2048  lds
    buffer_load_dwordx4 v1, s[8:11], s82 offen offset:3072  lds
    s_add_u32 m0, s15, 4096
    s_nop 0
    buffer_load_dwordx4 v15, s[8:11], s82 offen offset:0  lds
    buffer_load_dwordx4 v15, s[8:11], s82 offen offset:1024  lds
    buffer_load_dwordx4 v15, s[8:11], s82 offen offset:2048  lds
    buffer_load_dwordx4 v15, s[8:11], s82 offen offset:3072  lds
    s_xor_b32 s15, s15, 196608
    s_add_u32 m0, s16, 0
    s_nop 0
    buffer_load_dwordx4 v1, s[8:11], s19 offen offset:0  lds
    buffer_load_dwordx4 v1, s[8:11], s19 offen offset:1024  lds
    buffer_load_dwordx4 v1, s[8:11], s19 offen offset:2048  lds
    buffer_load_dwordx4 v1, s[8:11], s19 offen offset:3072  lds
    s_add_u32 m0, s16, 4096
    s_nop 0
    buffer_load_dwordx4 v15, s[8:11], s19 offen offset:0  lds
    buffer_load_dwordx4 v15, s[8:11], s19 offen offset:1024  lds
    buffer_load_dwordx4 v15, s[8:11], s19 offen offset:2048  lds
    buffer_load_dwordx4 v15, s[8:11], s19 offen offset:3072  lds
    s_xor_b32 s16, s16, 98304
    s_cmp_eq_u32 s61, 0
    s_cselect_b32 s82, 0, 1
    s_mul_i32 s82, s82, 65536
    s_add_u32 s82, s82, s81
    s_add_u32 m0, s15, 0
    s_nop 0
    buffer_load_dwordx4 v1, s[8:11], s82 offen offset:0  lds
    buffer_load_dwordx4 v1, s[8:11], s82 offen offset:1024  lds
    buffer_load_dwordx4 v1, s[8:11], s82 offen offset:2048  lds
    buffer_load_dwordx4 v1, s[8:11], s82 offen offset:3072  lds
    s_add_u32 m0, s15, 4096
    s_nop 0
    buffer_load_dwordx4 v15, s[8:11], s82 offen offset:0  lds
    buffer_load_dwordx4 v15, s[8:11], s82 offen offset:1024  lds
    buffer_load_dwordx4 v15, s[8:11], s82 offen offset:2048  lds
    buffer_load_dwordx4 v15, s[8:11], s82 offen offset:3072  lds
    s_xor_b32 s15, s15, 196608
    s_waitcnt vmcnt(0) lgkmcnt(0)
    s_barrier
    ds_read_b128 a[128:131], v18 offset:0
    ds_read_b128 a[132:135], v18 offset:1024
    ds_read_b128 a[136:139], v18 offset:2048
    ds_read_b128 a[140:143], v18 offset:3072
    ds_read_b128 a[144:147], v18 offset:4096
    ds_read_b128 a[148:151], v18 offset:5120
    ds_read_b128 a[152:155], v18 offset:6144
    ds_read_b128 a[156:159], v18 offset:7168
    s_waitcnt lgkmcnt(0)
    s_branch L_t2_start
L_C2_slow_13:
    s_mov_b32 s99, 0
L_C2_slow_13_l:
    s_sleep 4
    buffer_load_dword v3, v4, s[8:11], s23 offen sc0 sc1
    s_add_u32 s99, s99, 1
    s_waitcnt vmcnt(0)
    v_cmp_ne_u32 vcc, 0, v3
    s_cmp_eq_u64 vcc, -1
    s_cbranch_scc1 L_C2_ok_14
    s_cmp_lt_u32 s99, 200000
    s_cbranch_scc1 L_C2_slow_13_l
    s_branch L_C2_ok_14
L_P1_slow_15:
    s_mov_b32 s14, 0xf000f000
    s_mov_b32 s15, 0xf000f000
    s_mov_b32 s99, 0
L_P2_l_5321:
    s_waitcnt vmcnt(0)
    v_max_u32 v48, v128, v129
    v_max3_u32 v48, v48, v130, v131
    v_max_u32 v49, v132, v133
    v_max3_u32 v49, v49, v134, v135
    v_max_u32 v50, v136, v137
    v_max3_u32 v50, v50, v138, v139
    v_max_u32 v51, v140, v141
    v_max3_u32 v51, v51, v142, v143
    v_max_u32 v52, v144, v145
    v_max3_u32 v52, v52, v146, v147
    v_max_u32 v53, v148, v149
    v_max3_u32 v53, v53, v150, v151
    v_max_u32 v54, v152, v153
    v_max3_u32 v54, v54, v154, v155
    v_max_u32 v55, v156, v157
    v_max3_u32 v55, v55, v158, v159
    v_max3_u32 v3, v48, v49, v50
    v_max3_u32 v3, v3, v51, v52
    v_max3_u32 v3, v3, v53, v54
    v_max_u32 v3, v3, v55
    v_cmp_eq_u32 vcc, -1, v3
    s_add_u32 s99, s99, 1
    s_cbranch_vccz L_P2_ok_5322
    s_cmp_ge_u32 s99, 200000
    s_cbranch_scc1 L_P2_ok_5322
    s_sleep 1
    v_cmp_eq_u32 vcc, -1, v48
    s_cbranch_vccz L_P2_s_5323
    s_and_b64 s[96:97], vcc, s[14:15]
    s_cselect_b64 exec, s[96:97], vcc
    s_add_u32 s74, s70, 0
    buffer_load_dwordx4 v[128:131], v44, s[8:11], s74 offen sc0 sc1
    s_mov_b64 exec, -1
L_P2_s_5323:
    v_cmp_eq_u32 vcc, -1, v49
    s_cbranch_vccz L_P2_s_5324
    s_and_b64 s[96:97], vcc, s[14:15]
    s_cselect_b64 exec, s[96:97], vcc
    s_add_u32 s74, s70, 4096
    buffer_load_dwordx4 v[132:135], v44, s[8:11], s74 offen sc0 sc1
    s_mov_b64 exec, -1
L_P2_s_5324:
    v_cmp_eq_u32 vcc, -1, v50
    s_cbranch_vccz L_P2_s_5325
    s_and_b64 s[96:97], vcc, s[14:15]
    s_cselect_b64 exec, s[96:97], vcc
    s_add_u32 s74, s70, 8192
    buffer_load_dwordx4 v[136:139], v44, s[8:11], s74 offen sc0 sc1
    s_mov_b64 exec, -1
L_P2_s_5325:
    v_cmp_eq_u32 vcc, -1, v51
    s_cbranch_vccz L_P2_s_5326
    s_and_b64 s[96:97], vcc, s[14:15]
    s_cselect_b64 exec, s[96:97], vcc
    s_add_u32 s74, s70, 12288
    buffer_load_dwordx4 v[140:143], v44, s[8:11], s74 offen sc0 sc1
    s_mov_b64 exec, -1
L_P2_s_5326:
    v_cmp_eq_u32 vcc, -1, v52
    s_cbranch_vccz L_P2_s_5327
    s_and_b64 s[96:97], vcc, s[14:15]
    s_cselect_b64 exec, s[96:97], vcc
    s_add_u32 s74, s70, 16384
    buffer_load_dwordx4 v[144:147], v44, s[8:11], s74 offen sc0 sc1
    s_mov_b64 exec, -1
L_P2_s_5327:
    v_cmp_eq_u32 vcc, -1, v53
    s_cbranch_vccz L_P2_s_5328
    s_and_b64 s[96:97], vcc, s[14:15]
    s_cselect_b64 exec, s[96:97], vcc
    s_add_u32 s74, s70, 20480
    buffer_load_dwordx4 v[148:151], v44, s[8:11], s74 offen sc0 sc1
    s_mov_b64 exec, -1
L_P2_s_5328:
    v_cmp_eq_u32 vcc, -1, v54
    s_cbranch_vccz L_P2_s_5329
    s_and_b64 s[96:97], vcc, s[14:15]
    s_cselect_b64 exec, s[96:97], vcc
    s_add_u32 s74, s70, 24576
    buffer_load_dwordx4 v[152:155], v44, s[8:11], s74 offen sc0 sc1
    s_mov_b64 exec, -1
L_P2_s_5329:
    v_cmp_eq_u32 vcc, -1, v55
    s_cbranch_vccz L_P2_s_5330
    s_and_b64 s[96:97], vcc, s[14:15]
    s_cselect_b64 exec, s[96:97], vcc
    s_add_u32 s74, s70, 28672
    buffer_load_dwordx4 v[156:159], v44, s[8:11], s74 offen sc0 sc1
    s_mov_b64 exec, -1
L_P2_s_5330:
    s_branch L_P2_l_5321
L_P2_ok_5322:
    s_branch L_P1_ok_16
L_C2_slow_17:
    s_mov_b32 s99, 0
L_C2_slow_17_l:
    s_sleep 4
    buffer_load_dword v3, v4, s[8:11], s23 offen sc0 sc1
    s_add_u32 s99, s99, 1
    s_waitcnt vmcnt(0)
    v_cmp_ne_u32 vcc, 0, v3
    s_cmp_eq_u64 vcc, -1
    s_cbranch_scc1 L_C2_ok_18
    s_cmp_lt_u32 s99, 200000
    s_cbranch_scc1 L_C2_slow_17_l
    s_branch L_C2_ok_18
L_P1_slow_19:
    s_mov_b32 s14, 0xf000f000
    s_mov_b32 s15, 0xf000f000
    s_mov_b32 s99, 0
L_P2_l_5401:
    s_waitcnt vmcnt(0)
    v_max_u32 v48, v128, v129
    v_max3_u32 v48, v48, v130, v131
    v_max_u32 v49, v132, v133
    v_max3_u32 v49, v49, v134, v135
    v_max_u32 v50, v136, v137
    v_max3_u32 v50, v50, v138, v139
    v_max_u32 v51, v140, v141
    v_max3_u32 v51, v51, v142, v143
    v_max_u32 v52, v144, v145
    v_max3_u32 v52, v52, v146, v147
    v_max_u32 v53, v148, v149
    v_max3_u32 v53, v53, v150, v151
    v_max_u32 v54, v152, v153
    v_max3_u32 v54, v54, v154, v155
    v_max_u32 v55, v156, v157
    v_max3_u32 v55, v55, v158, v159
    v_max3_u32 v3, v48, v49, v50
    v_max3_u32 v3, v3, v51, v52
    v_max3_u32 v3, v3, v53, v54
    v_max_u32 v3, v3, v55
    v_cmp_eq_u32 vcc, -1, v3
    s_add_u32 s99, s99, 1
    s_cbranch_vccz L_P2_ok_5402
    s_cmp_ge_u32 s99, 200000
    s_cbranch_scc1 L_P2_ok_5402
    s_sleep 1
    v_cmp_eq_u32 vcc, -1, v48
    s_cbranch_vccz L_P2_s_5403
    s_and_b64 s[96:97], vcc, s[14:15]
    s_cselect_b64 exec, s[96:97], vcc
    s_add_u32 s74, s70, 0
    buffer_load_dwordx4 v[128:131], v44, s[8:11], s74 offen sc0 sc1
    s_mov_b64 exec, -1
L_P2_s_5403:
    v_cmp_eq_u32 vcc, -1, v49
    s_cbranch_vccz L_P2_s_5404
    s_and_b64 s[96:97], vcc, s[14:15]
    s_cselect_b64 exec, s[96:97], vcc
    s_add_u32 s74, s70, 4096
    buffer_load_dwordx4 v[132:135], v44, s[8:11], s74 offen sc0 sc1
    s_mov_b64 exec, -1
L_P2_s_5404:
    v_cmp_eq_u32 vcc, -1, v50
    s_cbranch_vccz L_P2_s_5405
    s_and_b64 s[96:97], vcc, s[14:15]
    s_cselect_b64 exec, s[96:97], vcc
    s_add_u32 s74, s70, 8192
    buffer_load_dwordx4 v[136:139], v44, s[8:11], s74 offen sc0 sc1
    s_mov_b64 exec, -1
L_P2_s_5405:
    v_cmp_eq_u32 vcc, -1, v51
    s_cbranch_vccz L_P2_s_5406
    s_and_b64 s[96:97], vcc, s[14:15]
    s_cselect_b64 exec, s[96:97], vcc
    s_add_u32 s74, s70, 12288
    buffer_load_dwordx4 v[140:143], v44, s[8:11], s74 offen sc0 sc1
    s_mov_b64 exec, -1
L_P2_s_5406:
    v_cmp_eq_u32 vcc, -1, v52
    s_cbranch_vccz L_P2_s_5407
    s_and_b64 s[96:97], vcc, s[14:15]
    s_cselect_b64 exec, s[96:97], vcc
    s_add_u32 s74, s70, 16384
    buffer_load_dwordx4 v[144:147], v44, s[8:11], s74 offen sc0 sc1
    s_mov_b64 exec, -1
L_P2_s_5407:
    v_cmp_eq_u32 vcc, -1, v53
    s_cbranch_vccz L_P2_s_5408
    s_and_b64 s[96:97], vcc, s[14:15]
    s_cselect_b64 exec, s[96:97], vcc
    s_add_u32 s74, s70, 20480
    buffer_load_dwordx4 v[148:151], v44, s[8:11], s74 offen sc0 sc1
    s_mov_b64 exec, -1
L_P2_s_5408:
    v_cmp_eq_u32 vcc, -1, v54
    s_cbranch_vccz L_P2_s_5409
    s_and_b64 s[96:97], vcc, s[14:15]
    s_cselect_b64 exec, s[96:97], vcc
    s_add_u32 s74, s70, 24576
    buffer_load_dwordx4 v[152:155], v44, s[8:11], s74 offen sc0 sc1
    s_mov_b64 exec, -1
L_P2_s_5409:
    v_cmp_eq_u32 vcc, -1, v55
    s_cbranch_vccz L_P2_s_5410
    s_and_b64 s[96:97], vcc, s[14:15]
    s_cselect_b64 exec, s[96:97], vcc
    s_add_u32 s74, s70, 28672
    buffer_load_dwordx4 v[156:159], v44, s[8:11], s74 offen sc0 sc1
    s_mov_b64 exec, -1
L_P2_s_5410:
    s_branch L_P2_l_5401
L_P2_ok_5402:
    s_branch L_P1_ok_20
L_code_end:
    s_endpgm
.section .rodata,"a"
.p2align 6
.amdhsa_kernel adaLN_cond__compressed_kv_cla__moe_arch_mod__prompt_kernel
  .amdhsa_next_free_vgpr 512
  .amdhsa_next_free_sgpr 102
  .amdhsa_accum_offset 256
  .amdhsa_group_segment_fixed_size 0
  .amdhsa_kernarg_size 128
  .amdhsa_user_sgpr_count 2
  .amdhsa_user_sgpr_kernarg_segment_ptr 1
  .amdhsa_system_sgpr_workgroup_id_x 1
.end_amdhsa_kernel
```

```asm
; @launch grid=(256,1,1) block=(256,1,1) lds=163840
.amdgcn_target "amdgcn-amd-amdhsa--gfx950"
.text
.globl adaLN_cond__compressed_kv_cla__moe_arch_mod__prompt_kernel
.p2align 8
.type adaLN_cond__compressed_kv_cla__moe_arch_mod__prompt_kernel,@function
adaLN_cond__compressed_kv_cla__moe_arch_mod__prompt_kernel:
    s_cmp_ge_u32 s2, 256
    s_cbranch_scc1 L_end
    s_load_dwordx16 s[64:79], s[0:1], 0
    s_load_dwordx16 s[80:95], s[0:1], 64
    s_getpc_b64 s[100:101]
L_pf1:
    v_lshrrev_b32 v3, 6, v0
    v_and_b32 v2, 63, v0
    s_lshr_b32 s5, s2, 3
    s_mul_i32 s98, s5, 24
    v_min_u32 v5, 5, v2
    v_mad_u32_u24 v5, v3, 6, v5
    v_add_u32 v5, s98, v5
    v_lshlrev_b32 v5, 7, v5
    v_min_u32 v5, L_code_end-L_pf1, v5
    global_load_dword a255, v5, s[100:101]
    v_readfirstlane_b32 s3, v3
    v_lshlrev_b32 v1, 4, v2
    s_and_b32 s4, s2, 7
    s_and_b32 s5, s5, 3
    s_lshr_b32 s6, s2, 5
    s_lshl_b32 s7, s4, 2
    s_add_u32 s7, s7, s5
    s_mov_b32 s60, s6
    s_sub_u32 s61, 15, s6
    v_lshrrev_b32 v3, 3, v2
    v_lshrrev_b32 v4, 4, v2
    v_and_b32 v5, 7, v2
    v_xor_b32 v5, v5, v4
    v_lshlrev_b32 v5, 4, v5
    v_lshl_add_u32 v16, v3, 10, v5
    v_xor_b32 v17, 64, v16
    v_add_u32 v17, 7168, v17
    v_add_u32 v18, 14336, v16
    v_add_u32 v19, 14336, v17
    v_bfe_u32 v5, v2, 1, 3
    v_xor_b32 v5, v5, v4
    v_lshlrev_b32 v5, 5, v5
    v_and_b32 v6, 1, v2
    v_lshl_add_u32 v5, v6, 4, v5
    v_lshl_add_u32 v20, v4, 13, v5
    v_add_u32 v21, 31744, v20
    v_xor_b32 v22, 128, v20
    v_add_u32 v22, 63488, v22
    v_add_u32 v23, 31744, v22
    s_lshl_b32 s62, s3, 13
    s_lshl_b32 s63, s3, 12
    s_lshl_b32 s96, s6, 18
    s_lshl_b32 s98, s3, 16
    s_add_u32 s96, s96, s98
    s_lshl_b32 s97, s3, 17
    s_lshl_b32 s99, s5, 0
    s_xor_b32 s99, s99, s6
    s_lshl_b32 s99, s99, 3
    s_and_b32 s99, s99, 7
    s_lshl_b32 s98, s99, 7
    s_add_u32 s96, s96, s98
    s_lshl_b32 s98, s99, 19
    s_add_u32 s97, s97, s98
    v_and_b32 v84, 7, v2
    v_lshrrev_b32 v65, 3, v0
    v_mul_u32_u24 v64, 24576, v65
    v_lshl_add_u32 v64, v84, 4, v64
    v_lshlrev_b32 v65, 3, v65
    v_lshrrev_b32 v85, 3, v2
    v_lshlrev_b32 v86, 10, v84
    v_lshl_add_u32 v86, v85, 4, v86
    s_lshl_b32 s100, s7, 8
    s_waitcnt lgkmcnt(0)
    s_add_u32 s16, s70, s100
    s_addc_u32 s17, s71, 0
    s_sub_u32 s18, 4194304, s100
    s_mov_b32 s19, 0x00020000
    s_mov_b32 s12, s66
    s_mov_b32 s13, s67
    s_mov_b32 s14, 2097152
    s_mov_b32 s15, 0x00020000
    s_add_u32 m0, s63, 98304
    s_xor_b32 s98, s97, 0
    buffer_load_dwordx4 v20, s[16:19], s98 offen offset:0   lds
    buffer_load_dwordx4 v21, s[16:19], s98 offen offset:1024   lds
    buffer_load_dwordx4 v22, s[16:19], s98 offen offset:2048   lds
    buffer_load_dwordx4 v23, s[16:19], s98 offen offset:3072   lds
    s_add_u32 m0, s62, 0
    s_xor_b32 s98, s96, 0
    buffer_load_dwordx4 v16, s[12:15], s98 offen offset:0   lds
    buffer_load_dwordx4 v17, s[12:15], s98 offen offset:1024   lds
    buffer_load_dwordx4 v18, s[12:15], s98 offen offset:2048   lds
    buffer_load_dwordx4 v19, s[12:15], s98 offen offset:3072   lds
    s_add_u32 m0, s62, 4096
    s_xor_b32 s98, s96, 32768
    buffer_load_dwordx4 v16, s[12:15], s98 offen offset:0   lds
    buffer_load_dwordx4 v17, s[12:15], s98 offen offset:1024   lds
    buffer_load_dwordx4 v18, s[12:15], s98 offen offset:2048   lds
    buffer_load_dwordx4 v19, s[12:15], s98 offen offset:3072   lds
    s_mov_b32 s40, s88
    s_mov_b32 s41, s89
    s_mov_b32 s42, 3145728
    s_mov_b32 s43, 0x00020000
    s_mov_b32 s44, s86
    s_mov_b32 s45, s87
    s_mov_b32 s46, 1024
    s_mov_b32 s47, 0x00020000
    s_mov_b32 s32, s64
    s_mov_b32 s33, s65
    s_mov_b32 s34, 2097152
    s_mov_b32 s35, 0x00020000
    s_mov_b32 s8, s94
    s_mov_b32 s9, s95
    s_mov_b32 s10, 268435456
    s_mov_b32 s11, 0x00020000
    s_add_u32 s20, s72, s100
    s_addc_u32 s21, s73, 0
    s_sub_u32 s22, 4194304, s100
    s_mov_b32 s23, 0x00020000
    s_add_u32 s24, s68, s100
    s_addc_u32 s25, s69, 0
    s_sub_u32 s26, 4194304, s100
    s_mov_b32 s27, 0x00020000
    s_mov_b32 s36, s92
    s_mov_b32 s37, s93
    s_mov_b32 s38, 256
    s_mov_b32 s39, 0x00020000
    s_lshl_b32 s100, s4, 19
    s_lshl_b32 s99, s5, 8
    s_add_u32 s100, s100, s99
    s_add_u32 s28, s74, s100
    s_addc_u32 s29, s75, 0
    s_sub_u32 s30, 4194304, s100
    s_mov_b32 s31, 0x00020000
    s_mov_b32 s48, s84
    s_mov_b32 s49, s85
    s_mov_b32 s50, 1835008
    s_mov_b32 s51, 0x00020000
    s_mov_b32 s52, s90
    s_mov_b32 s53, s91
    s_mov_b32 s54, 2097152
    s_mov_b32 s55, 0x00020000
    s_mov_b64 s[92:93], s[80:81]
    s_mov_b64 s[94:95], s[82:83]
    s_mov_b32 s56, s78
    s_mov_b32 s57, s79
    s_mov_b32 s58, 1024
    s_mov_b32 s59, 0x00020000
    s_load_dword s90, s[36:37], 64
    s_load_dword s91, s[8:9], 0x3f00
    s_lshl_b32 s64, s3, 19
    s_and_b32 s100, s97, 3670016
    s_xor_b32 s64, s64, s100
    s_lshr_b32 s100, s6, 1
    s_and_b32 s100, s100, 0
    s_lshl_b32 s1, s100, 12
    s_lshl_b32 s100, s100, 7
    s_add_u32 s64, s64, s100
    s_lshl_b32 s100, s5, 1
    s_xor_b32 s100, s100, s6
    s_and_b32 s100, s100, 0
    s_lshl_b32 s68, s100, 11
    s_lshl_b32 s100, s100, 19
    s_lshl_b32 s0, s3, 17
    s_add_u32 s0, s0, s100
    s_mul_i32 s81, s7, 1048576
    s_add_u32 s81, s81, 16777216
    s_mul_i32 s100, s6, 131072
    s_add_u32 s65, s81, s100
    s_lshr_b32 s100, s3, 1
    s_mul_i32 s100, s100, 65536
    s_add_u32 s65, s65, s100
    s_and_b32 s100, s3, 1
    s_lshl_b32 s100, s100, 14
    s_add_u32 s65, s65, s100
    s_add_u32 s81, s81, s62
    s_cmp_eq_u32 s60, 0
    s_cselect_b32 s82, 0, 1
    s_mul_i32 s82, s82, 65536
    s_add_u32 s82, s82, s81
    s_sub_u32 s100, s6, 2
    s_lshl_b32 s69, s100, 7
    s_lshl_b32 s100, s100, 3
    s_add_u32 s100, s100, s4
    s_lshl_b32 s100, s100, 8
    s_mul_i32 s101, s5, 12288
    s_add_u32 s100, s100, s101
    s_add_u32 s100, s100, 16384
    s_cmp_ge_u32 s6, 2
    s_cselect_b32 s66, s100, 2147479552
    s_cselect_b32 s69, s69, 2147479552
    s_cmp_eq_u32 s3, 0
    s_cselect_b32 s66, s66, 2147479552
    s_lshl_b32 s70, s3, 9
    s_add_u32 s70, s70, 16384
    s_lshr_b32 s71, s2, 1
    s_lshl_b32 s71, s71, 14
    s_and_b32 s100, s2, 1
    s_lshl_b32 s100, s100, 7
    s_add_u32 s71, s71, s100
    s_add_u32 s71, s71, s63
    s_add_u32 s71, s71, 2097152
    s_lshl_b32 s72, s2, 2
    s_add_u32 s72, s72, s3
    s_lshl_b32 s72, s72, 6
    s_add_u32 s72, s72, 1048576
    s_lshl_b32 s74, s7, 11
    s_add_u32 s74, s74, 1114112
    s_lshl_b32 s73, s6, 2
    s_add_u32 s73, s73, s3
    s_lshl_b32 s73, s73, 6
    s_add_u32 s73, s73, s74
    s_lshr_b32 s100, s3, 1
    s_sub_u32 s101, 3, s100
    s_and_b32 s98, s3, 1
    s_cselect_b32 s100, s101, s100
    s_lshl_b32 s75, s60, 2
    s_add_u32 s75, s75, s100
    s_lshl_b32 s76, s61, 2
    s_add_u32 s76, s76, s100
    s_sub_u32 s77, s76, s75
    s_lshl_b32 s77, s77, 10
    s_lshl_b32 s78, s75, 10
    s_add_u32 s78, s78, 983040
    s_lshl_b32 s75, s75, 15
    s_add_u32 s75, s75, 2097152
    s_add_u32 s75, s75, s68
    s_lshl_b32 s76, s76, 15
    s_add_u32 s76, s76, 2097152
    s_add_u32 s76, s76, s68
    s_add_u32 s1, s1, s65
    s_cmp_eq_u32 s3, 0
    s_cselect_b32 s68, 32, 0
    s_cselect_b32 s67, 0, 2147479552
    v_and_b32 v48, 15, v2
    v_lshrrev_b32 v49, 4, v2
    v_lshrrev_b32 v50, 1, v48
    v_xor_b32 v50, v50, v49
    v_lshlrev_b32 v50, 4, v50
    v_lshl_add_u32 v28, v48, 7, v50
    v_add_u32 v28, s62, v28
    v_xor_b32 v29, 64, v28
    v_add_u32 v30, 65536, v28
    v_add_u32 v31, 65536, v29
    v_lshrrev_b32 v50, 2, v48
    v_and_b32 v51, 3, v48
    v_lshl_add_u32 v52, v49, 3, v50
    v_lshlrev_b32 v53, 8, v52
    v_lshl_add_u32 v53, v51, 3, v53
    v_add_u32 v53, 98304, v53
    v_and_b32 v54, 1, v49
    v_lshl_add_u32 v54, v54, 2, v50
    v_xor_b32 v55, 0, v54
    v_lshl_add_u32 v8, v55, 5, v53
    v_xor_b32 v55, 1, v54
    v_lshl_add_u32 v9, v55, 5, v53
    v_xor_b32 v55, 2, v54
    v_lshl_add_u32 v10, v55, 5, v53
    v_xor_b32 v55, 3, v54
    v_lshl_add_u32 v11, v55, 5, v53
    v_xor_b32 v55, 4, v54
    v_lshl_add_u32 v12, v55, 5, v53
    v_xor_b32 v55, 5, v54
    v_lshl_add_u32 v13, v55, 5, v53
    v_xor_b32 v55, 6, v54
    v_lshl_add_u32 v14, v55, 5, v53
    v_xor_b32 v55, 7, v54
    v_lshl_add_u32 v15, v55, 5, v53
    v_bfe_u32 v49, v2, 1, 2
    v_bfe_u32 v50, v2, 4, 1
    v_xor_b32 v49, v49, v50
    v_lshlrev_b32 v49, 5, v49
    v_and_b32 v50, 1, v2
    v_lshl_add_u32 v49, v50, 4, v49
    v_lshl_add_u32 v24, v85, 13, v49
    v_xor_b32 v25, 64, v24
    v_add_u32 v25, 64512, v25
    v_add_u32 v26, 129024, v24
    v_add_u32 v27, 129024, v25
    v_cmp_eq_u32 vcc, 0, v2
    v_mov_b32 v6, 2147479552
    s_nop 0
    v_cndmask_b32 v5, v6, v2, vcc
    v_cmp_eq_u32 vcc, 0, v0
    s_nop 1
    v_cndmask_b32 v7, v6, v0, vcc
    v_and_b32 v48, 8, v2
    v_cmp_eq_u32 vcc, 0, v48
    v_lshlrev_b32 v48, 5, v84
    v_lshrrev_b32 v49, 1, v2
    v_and_b32 v49, 24, v49
    v_add_u32 v48, v48, v49
    s_lshl_b32 s100, s3, 8
    s_add_u32 s100, s100, 147456
    v_add_u32 v48, s100, v48
    v_mov_b32 v49, 148480
    v_cndmask_b32 v98, v49, v48, vcc
    v_lshlrev_b32 v99, 5, v84
    v_add_u32 v99, 149504, v99
    s_lshl_b32 s100, s3, 3
    v_add_u32 v100, s100, v99
    v_lshlrev_b32 v106, 5, v85
    v_lshlrev_b32 v107, 8, v85
    v_lshl_add_u32 v107, v84, 4, v107
    s_sub_u32 s100, s2, 64
    s_lshl_b32 s80, s100, 12
    s_add_u32 s80, s80, 1048576
    s_cmp_lt_u32 s100, 64
    s_cselect_b32 s80, s80, 2147479552
    s_mul_i32 s99, s5, 786432
    s_sub_u32 s79, s6, 2
    s_lshl_b32 s79, s79, 3
    s_add_u32 s79, s79, s4
    s_lshl_b32 s79, s79, 7
    s_add_u32 s79, s79, s99
    s_cmp_ge_u32 s6, 2
    s_cselect_b32 s79, s79, 2147414016
    s_lshl_b32 s100, s5, 8
    v_add_u32 v65, s100, v65
    v_mov_b32 v6, 1
    v_and_b32 v4, 1, v2
    v_lshlrev_b32 v4, 7, v4
    buffer_load_dwordx2 v[66:67], v65, s[44:47], 0 offen
    buffer_load_dwordx4 v[68:71], v64, s[40:43], s79 offen
    s_add_u32 s79, s79, 6144
    buffer_load_dwordx4 v[72:75], v64, s[40:43], s79 offen
    s_add_u32 s79, s79, 6144
    buffer_load_dwordx4 v[76:79], v64, s[40:43], s79 offen
    s_add_u32 s79, s79, 6144
    buffer_load_dwordx4 v[80:83], v64, s[40:43], s79 offen
    s_lshl_b32 s79, s2, 5
    s_add_u32 s79, s79, s3
    s_lshl_b32 s79, s79, 8
    buffer_load_dwordx4 v[88:91], v86, s[32:35], s79 offen
    buffer_load_dwordx4 v[92:95], v86, s[32:35], s79 offen offset:128
    s_add_u32 m0, s63, 114688
    s_xor_b32 s98, s97, 524288
    buffer_load_dwordx4 v20, s[16:19], s98 offen offset:0   lds
    buffer_load_dwordx4 v21, s[16:19], s98 offen offset:1024   lds
    buffer_load_dwordx4 v22, s[16:19], s98 offen offset:2048   lds
    buffer_load_dwordx4 v23, s[16:19], s98 offen offset:3072   lds
    s_add_u32 m0, s62, 32768
    s_xor_b32 s98, s96, 128
    buffer_load_dwordx4 v16, s[12:15], s98 offen offset:0   lds
    buffer_load_dwordx4 v17, s[12:15], s98 offen offset:1024   lds
    buffer_load_dwordx4 v18, s[12:15], s98 offen offset:2048   lds
    buffer_load_dwordx4 v19, s[12:15], s98 offen offset:3072   lds
    s_add_u32 m0, s62, 36864
    s_xor_b32 s98, s96, 32896
    buffer_load_dwordx4 v16, s[12:15], s98 offen offset:0   lds
    buffer_load_dwordx4 v17, s[12:15], s98 offen offset:1024   lds
    buffer_load_dwordx4 v18, s[12:15], s98 offen offset:2048   lds
    buffer_load_dwordx4 v19, s[12:15], s98 offen offset:3072   lds
    s_waitcnt vmcnt(19) lgkmcnt(0)
    s_barrier
    ds_read_b64_tr_b16 v[32:33], v8 offset:0
    ds_read_b64_tr_b16 v[34:35], v8 offset:1024
    ds_read_b128 a[0:3], v28 offset:0
    ds_read_b128 a[4:7], v28 offset:2048
    ds_read_b128 a[8:11], v28 offset:4096
    ds_read_b128 a[12:15], v28 offset:6144
    ds_read_b64_tr_b16 v[36:37], v9 offset:0
    ds_read_b64_tr_b16 v[38:39], v9 offset:1024
    ds_read_b64_tr_b16 v[40:41], v10 offset:0
    ds_read_b64_tr_b16 v[42:43], v10 offset:1024
    ds_read_b64_tr_b16 v[44:45], v11 offset:0
    ds_read_b64_tr_b16 v[46:47], v11 offset:1024
    ds_read_b64_tr_b16 v[48:49], v12 offset:0
    ds_read_b64_tr_b16 v[50:51], v12 offset:1024
    ds_read_b64_tr_b16 v[52:53], v13 offset:0
    ds_read_b64_tr_b16 v[54:55], v13 offset:1024
    ds_read_b64_tr_b16 v[56:57], v14 offset:0
    ds_read_b64_tr_b16 v[58:59], v14 offset:1024
    ds_read_b64_tr_b16 v[60:61], v15 offset:0
    ds_read_b64_tr_b16 v[62:63], v15 offset:1024
    s_waitcnt lgkmcnt(15)
    v_mfma_f32_16x16x32_bf16 v[128:131], v[32:35], a[0:3], 0
    v_mfma_f32_16x16x32_bf16 v[160:163], v[32:35], a[4:7], 0
    v_mfma_f32_16x16x32_bf16 v[192:195], v[32:35], a[8:11], 0
    s_waitcnt lgkmcnt(14)
    s_add_u32 m0, s63, 131072
    s_xor_b32 s98, s97, 1048576
    ds_read_b128 a[16:19], v29 offset:0
    v_mfma_f32_16x16x32_bf16 v[224:227], v[32:35], a[12:15], 0
    s_waitcnt lgkmcnt(13)
    ds_read_b128 a[20:23], v29 offset:2048
    v_mfma_f32_16x16x32_bf16 v[132:135], v[36:39], a[0:3], 0
    ds_read_b64_tr_b16 v[32:33], v8 offset:8192
    v_mfma_f32_16x16x32_bf16 v[164:167], v[36:39], a[4:7], 0
    ds_read_b64_tr_b16 v[34:35], v8 offset:9216
    v_mfma_f32_16x16x32_bf16 v[196:199], v[36:39], a[8:11], 0
    ds_read_b128 a[24:27], v29 offset:4096
    v_mfma_f32_16x16x32_bf16 v[228:231], v[36:39], a[12:15], 0
    s_waitcnt lgkmcnt(15)
    ds_read_b128 a[28:31], v29 offset:6144
    v_mfma_f32_16x16x32_bf16 v[136:139], v[40:43], a[0:3], 0
    ds_read_b64_tr_b16 v[36:37], v9 offset:8192
    v_mfma_f32_16x16x32_bf16 v[168:171], v[40:43], a[4:7], 0
    s_waitcnt lgkmcnt(7)
    ds_read_b64_tr_b16 v[38:39], v9 offset:9216
    v_mfma_f32_16x16x32_bf16 v[200:203], v[40:43], a[8:11], 0
    buffer_load_dwordx4 v20, s[16:19], s98 offen offset:0   lds
    v_mfma_f32_16x16x32_bf16 v[232:235], v[40:43], a[12:15], 0
    buffer_load_dwordx4 v21, s[16:19], s98 offen offset:1024   lds
    v_mfma_f32_16x16x32_bf16 v[140:143], v[44:47], a[0:3], 0
    ds_read_b64_tr_b16 v[40:41], v10 offset:8192
    v_mfma_f32_16x16x32_bf16 v[172:175], v[44:47], a[4:7], 0
    ds_read_b64_tr_b16 v[42:43], v10 offset:9216
    v_mfma_f32_16x16x32_bf16 v[204:207], v[44:47], a[8:11], 0
    buffer_load_dwordx4 v22, s[16:19], s98 offen offset:2048   lds
    v_mfma_f32_16x16x32_bf16 v[236:239], v[44:47], a[12:15], 0
    buffer_load_dwordx4 v23, s[16:19], s98 offen offset:3072   lds
    v_mfma_f32_16x16x32_bf16 v[144:147], v[48:51], a[0:3], 0
    s_add_u32 m0, s62, 65536
    s_xor_b32 s98, s96, 256
    ds_read_b64_tr_b16 v[44:45], v11 offset:8192
    v_mfma_f32_16x16x32_bf16 v[176:179], v[48:51], a[4:7], 0
    ds_read_b64_tr_b16 v[46:47], v11 offset:9216
    v_mfma_f32_16x16x32_bf16 v[208:211], v[48:51], a[8:11], 0
    buffer_load_dwordx4 v16, s[12:15], s98 offen offset:0   lds
    v_mfma_f32_16x16x32_bf16 v[240:243], v[48:51], a[12:15], 0
    buffer_load_dwordx4 v17, s[12:15], s98 offen offset:1024   lds
    v_mfma_f32_16x16x32_bf16 v[148:151], v[52:55], a[0:3], 0
    ds_read_b64_tr_b16 v[48:49], v12 offset:8192
    v_mfma_f32_16x16x32_bf16 v[180:183], v[52:55], a[4:7], 0
    ds_read_b64_tr_b16 v[50:51], v12 offset:9216
    v_mfma_f32_16x16x32_bf16 v[212:215], v[52:55], a[8:11], 0
    buffer_load_dwordx4 v18, s[12:15], s98 offen offset:2048   lds
    v_mfma_f32_16x16x32_bf16 v[244:247], v[52:55], a[12:15], 0
    buffer_load_dwordx4 v19, s[12:15], s98 offen offset:3072   lds
    v_mfma_f32_16x16x32_bf16 v[152:155], v[56:59], a[0:3], 0
    s_add_u32 m0, s62, 69632
    s_xor_b32 s98, s96, 33024
    ds_read_b64_tr_b16 v[52:53], v13 offset:8192
    v_mfma_f32_16x16x32_bf16 v[184:187], v[56:59], a[4:7], 0
    ds_read_b64_tr_b16 v[54:55], v13 offset:9216
    v_mfma_f32_16x16x32_bf16 v[216:219], v[56:59], a[8:11], 0
    buffer_load_dwordx4 v16, s[12:15], s98 offen offset:0   lds
    v_mfma_f32_16x16x32_bf16 v[248:251], v[56:59], a[12:15], 0
    buffer_load_dwordx4 v17, s[12:15], s98 offen offset:1024   lds
    v_mfma_f32_16x16x32_bf16 v[156:159], v[60:63], a[0:3], 0
    ds_read_b64_tr_b16 v[56:57], v14 offset:8192
    v_mfma_f32_16x16x32_bf16 v[188:191], v[60:63], a[4:7], 0
    s_waitcnt lgkmcnt(5)
    ds_read_b64_tr_b16 v[58:59], v14 offset:9216
    v_mfma_f32_16x16x32_bf16 v[220:223], v[60:63], a[8:11], 0
    buffer_load_dwordx4 v18, s[12:15], s98 offen offset:2048   lds
    v_mfma_f32_16x16x32_bf16 v[252:255], v[60:63], a[12:15], 0
    buffer_load_dwordx4 v19, s[12:15], s98 offen offset:3072   lds
    v_mfma_f32_16x16x32_bf16 v[128:131], v[32:35], a[16:19], v[128:131]
    ds_read_b64_tr_b16 v[60:61], v15 offset:8192
    v_mfma_f32_16x16x32_bf16 v[160:163], v[32:35], a[20:23], v[160:163]
    ds_read_b64_tr_b16 v[62:63], v15 offset:9216
    v_mfma_f32_16x16x32_bf16 v[192:195], v[32:35], a[24:27], v[192:195]
    v_mfma_f32_16x16x32_bf16 v[224:227], v[32:35], a[28:31], v[224:227]
    v_mfma_f32_16x16x32_bf16 v[132:135], v[36:39], a[16:19], v[132:135]
    v_mfma_f32_16x16x32_bf16 v[164:167], v[36:39], a[20:23], v[164:167]
    v_mfma_f32_16x16x32_bf16 v[196:199], v[36:39], a[24:27], v[196:199]
    v_mfma_f32_16x16x32_bf16 v[228:231], v[36:39], a[28:31], v[228:231]
    v_mfma_f32_16x16x32_bf16 v[136:139], v[40:43], a[16:19], v[136:139]
    s_waitcnt vmcnt(12) lgkmcnt(0)
    s_barrier
    v_mfma_f32_16x16x32_bf16 v[168:171], v[40:43], a[20:23], v[168:171]
    s_add_u32 m0, s63, 98304
    s_xor_b32 s98, s97, 1572864
    ds_read_b64_tr_b16 v[32:33], v8 offset:16384
    v_lshlrev_b32 v102, 16, v66
    v_and_b32 v103, 0xffff0000, v66
    v_lshlrev_b32 v104, 16, v67
    v_mfma_f32_16x16x32_bf16 v[200:203], v[40:43], a[24:27], v[200:203]
    ds_read_b64_tr_b16 v[34:35], v8 offset:17408
    v_and_b32 v105, 0xffff0000, v67
    v_mul_f32 v108, 0xbfb8aa3b, v102
    v_mul_f32 v109, 0xbfb8aa3b, v103
    v_mfma_f32_16x16x32_bf16 v[232:235], v[40:43], a[28:31], v[232:235]
    ds_read_b64_tr_b16 v[36:37], v9 offset:16384
    v_mul_f32 v110, 0xbfb8aa3b, v104
    v_mul_f32 v111, 0xbfb8aa3b, v105
    v_mfma_f32_16x16x32_bf16 v[140:143], v[44:47], a[16:19], v[140:143]
    ds_read_b64_tr_b16 v[38:39], v9 offset:17408
    v_exp_f32 v108, v108
    v_mfma_f32_16x16x32_bf16 v[172:175], v[44:47], a[20:23], v[172:175]
    ds_read_b64_tr_b16 v[40:41], v10 offset:16384
    v_exp_f32 v109, v109
    v_mfma_f32_16x16x32_bf16 v[204:207], v[44:47], a[24:27], v[204:207]
    ds_read_b64_tr_b16 v[42:43], v10 offset:17408
    v_exp_f32 v110, v110
    v_mfma_f32_16x16x32_bf16 v[236:239], v[44:47], a[28:31], v[236:239]
    ds_read_b128 a[32:35], v28 offset:32768
    v_exp_f32 v111, v111
    v_add_f32 v108, 1.0, v108
    v_mfma_f32_16x16x32_bf16 v[144:147], v[48:51], a[16:19], v[144:147]
    ds_read_b64_tr_b16 v[44:45], v11 offset:16384
    v_add_f32 v109, 1.0, v109
    v_add_f32 v110, 1.0, v110
    v_add_f32 v111, 1.0, v111
    v_mfma_f32_16x16x32_bf16 v[176:179], v[48:51], a[20:23], v[176:179]
    ds_read_b64_tr_b16 v[46:47], v11 offset:17408
    v_rcp_f32 v108, v108
    v_mfma_f32_16x16x32_bf16 v[208:211], v[48:51], a[24:27], v[208:211]
    ds_read_b128 a[36:39], v28 offset:34816
    v_mov_b32 v112, 0
    v_rcp_f32 v109, v109
    v_mfma_f32_16x16x32_bf16 v[240:243], v[48:51], a[28:31], v[240:243]
    ds_read_b128 a[40:43], v28 offset:36864
    v_mov_b32 v113, 0
    v_rcp_f32 v110, v110
    v_mfma_f32_16x16x32_bf16 v[148:151], v[52:55], a[16:19], v[148:151]
    ds_read_b64_tr_b16 v[48:49], v12 offset:16384
    v_mov_b32 v114, 0
    v_rcp_f32 v111, v111
    v_mfma_f32_16x16x32_bf16 v[180:183], v[52:55], a[20:23], v[180:183]
    ds_read_b64_tr_b16 v[50:51], v12 offset:17408
    v_mov_b32 v115, 0
    v_mul_f32 v102, v102, v108
    v_mul_f32 v103, v103, v109
    v_mfma_f32_16x16x32_bf16 v[212:215], v[52:55], a[24:27], v[212:215]
    ds_read_b128 a[44:47], v28 offset:38912
    v_lshlrev_b32 v116, 4, v0
    v_mul_f32 v104, v104, v110
    v_mul_f32 v105, v105, v111
    v_mfma_f32_16x16x32_bf16 v[244:247], v[52:55], a[28:31], v[244:247]
    buffer_load_dwordx4 v20, s[16:19], s98 offen offset:0   lds
    v_cvt_pk_bf16_f32 v108, v102, v103
    v_cvt_pk_bf16_f32 v109, v104, v105
    v_mfma_f32_16x16x32_bf16 v[152:155], v[56:59], a[16:19], v[152:155]
    ds_read_b64_tr_b16 v[52:53], v13 offset:16384
    v_lshlrev_b32 v102, 16, v108
    v_and_b32 v103, 0xffff0000, v108
    v_lshlrev_b32 v104, 16, v109
    v_mfma_f32_16x16x32_bf16 v[184:187], v[56:59], a[20:23], v[184:187]
    ds_read_b64_tr_b16 v[54:55], v13 offset:17408
    v_and_b32 v105, 0xffff0000, v109
    v_lshlrev_b32 v108, 16, v68
    v_and_b32 v109, 0xffff0000, v68
    v_mfma_f32_16x16x32_bf16 v[216:219], v[56:59], a[24:27], v[216:219]
    buffer_load_dwordx4 v21, s[16:19], s98 offen offset:1024   lds
    v_mul_f32 v120, v108, v102
    v_mul_f32 v121, v109, v102
    v_mfma_f32_16x16x32_bf16 v[248:251], v[56:59], a[28:31], v[248:251]
    buffer_store_dwordx4 v[112:115], v116, s[8:11], s80 offen sc0 sc1
    v_lshlrev_b32 v110, 16, v69
    v_and_b32 v111, 0xffff0000, v69
    v_mfma_f32_16x16x32_bf16 v[156:159], v[60:63], a[16:19], v[156:159]
    ds_read_b64_tr_b16 v[56:57], v14 offset:16384
    v_lshlrev_b32 v117, 13, v2
    v_mul_f32 v122, v110, v102
    v_mul_f32 v123, v111, v102
    v_mfma_f32_16x16x32_bf16 v[188:191], v[60:63], a[20:23], v[188:191]
    s_lshl_b32 s100, s6, 19
    s_and_b32 s101, s3, 1
    ds_read_b64_tr_b16 v[58:59], v14 offset:17408
    v_lshlrev_b32 v108, 16, v70
    v_and_b32 v109, 0xffff0000, v70
    v_mul_f32 v124, v108, v102
    v_mfma_f32_16x16x32_bf16 v[220:223], v[60:63], a[24:27], v[220:223]
    buffer_load_dwordx4 v22, s[16:19], s98 offen offset:2048   lds
    v_mul_f32 v125, v109, v102
    v_lshlrev_b32 v110, 16, v71
    v_mfma_f32_16x16x32_bf16 v[252:255], v[60:63], a[28:31], v[252:255]
    s_waitcnt lgkmcnt(5)
    s_lshl_b32 s101, s101, 7
    s_add_u32 s100, s100, s101
    v_min_u32 v116, 496, v116
    v_and_b32 v111, 0xffff0000, v71
    v_mul_f32 v126, v110, v102
    v_mul_f32 v127, v111, v102
    v_mfma_f32_16x16x32_bf16 v[128:131], v[32:35], a[32:35], v[128:131]
    s_sub_u32 s80, s80, 1048576
    s_lshr_b32 s80, s80, 3
    ds_read_b64_tr_b16 v[60:61], v15 offset:16384
    v_lshlrev_b32 v108, 16, v72
    v_and_b32 v109, 0xffff0000, v72
    v_fmac_f32 v120, v108, v103
    v_mfma_f32_16x16x32_bf16 v[160:163], v[32:35], a[36:39], v[160:163]
    s_add_u32 s80, s80, 1310720
    s_cmp_lt_u32 s80, 1343488
    s_cselect_b32 s80, s80, 2147479552
    ds_read_b64_tr_b16 v[62:63], v15 offset:17408
    v_fmac_f32 v121, v109, v103
    v_lshlrev_b32 v110, 16, v73
    v_and_b32 v111, 0xffff0000, v73
    v_mfma_f32_16x16x32_bf16 v[192:195], v[32:35], a[40:43], v[192:195]
    s_waitcnt lgkmcnt(5)
    ds_read_b128 a[48:51], v29 offset:32768
    v_fmac_f32 v122, v110, v103
    v_fmac_f32 v123, v111, v103
    v_lshlrev_b32 v108, 16, v74
    v_mfma_f32_16x16x32_bf16 v[224:227], v[32:35], a[44:47], v[224:227]
    ds_read_b128 a[52:55], v29 offset:34816
    v_and_b32 v109, 0xffff0000, v74
    v_fmac_f32 v124, v108, v103
    v_fmac_f32 v125, v109, v103
    v_mfma_f32_16x16x32_bf16 v[132:135], v[36:39], a[32:35], v[132:135]
    ds_read_b64_tr_b16 v[32:33], v8 offset:24576
    v_lshlrev_b32 v110, 16, v75
    v_and_b32 v111, 0xffff0000, v75
    v_fmac_f32 v126, v110, v103
    v_mfma_f32_16x16x32_bf16 v[164:167], v[36:39], a[36:39], v[164:167]
    ds_read_b64_tr_b16 v[34:35], v8 offset:25600
    v_fmac_f32 v127, v111, v103
    v_lshlrev_b32 v108, 16, v76
    v_and_b32 v109, 0xffff0000, v76
    v_mfma_f32_16x16x32_bf16 v[196:199], v[36:39], a[40:43], v[196:199]
    ds_read_b128 a[56:59], v29 offset:36864
    v_fmac_f32 v120, v108, v104
    v_fmac_f32 v121, v109, v104
    v_lshlrev_b32 v110, 16, v77
    v_mfma_f32_16x16x32_bf16 v[228:231], v[36:39], a[44:47], v[228:231]
    ds_read_b128 a[60:63], v29 offset:38912
    v_and_b32 v111, 0xffff0000, v77
    v_fmac_f32 v122, v110, v104
    v_fmac_f32 v123, v111, v104
    v_mfma_f32_16x16x32_bf16 v[136:139], v[40:43], a[32:35], v[136:139]
    ds_read_b64_tr_b16 v[36:37], v9 offset:24576
    v_lshlrev_b32 v108, 16, v78
    v_and_b32 v109, 0xffff0000, v78
    v_fmac_f32 v124, v108, v104
    v_mfma_f32_16x16x32_bf16 v[168:171], v[40:43], a[36:39], v[168:171]
    ds_read_b64_tr_b16 v[38:39], v9 offset:25600
    v_fmac_f32 v125, v109, v104
    v_lshlrev_b32 v110, 16, v79
    v_and_b32 v111, 0xffff0000, v79
    v_mfma_f32_16x16x32_bf16 v[200:203], v[40:43], a[40:43], v[200:203]
    buffer_load_dwordx4 v23, s[16:19], s98 offen offset:3072   lds
    v_fmac_f32 v126, v110, v104
    v_fmac_f32 v127, v111, v104
    v_mfma_f32_16x16x32_bf16 v[232:235], v[40:43], a[44:47], v[232:235]
    buffer_store_dwordx4 v[112:115], v116, s[8:11], s80 offen sc0 sc1
    v_lshlrev_b32 v108, 16, v80
    v_and_b32 v109, 0xffff0000, v80
    v_mfma_f32_16x16x32_bf16 v[140:143], v[44:47], a[32:35], v[140:143]
    s_add_u32 m0, s62, 0
    s_xor_b32 s98, s96, 384
    ds_read_b64_tr_b16 v[40:41], v10 offset:24576
    v_fmac_f32 v120, v108, v105
    v_fmac_f32 v121, v109, v105
    v_lshlrev_b32 v110, 16, v81
    v_mfma_f32_16x16x32_bf16 v[172:175], v[44:47], a[36:39], v[172:175]
    ds_read_b64_tr_b16 v[42:43], v10 offset:25600
    v_and_b32 v111, 0xffff0000, v81
    v_fmac_f32 v122, v110, v105
    v_fmac_f32 v123, v111, v105
    v_mfma_f32_16x16x32_bf16 v[204:207], v[44:47], a[40:43], v[204:207]
    buffer_load_dwordx4 v16, s[12:15], s98 offen offset:0   lds
    v_lshlrev_b32 v108, 16, v82
    v_and_b32 v109, 0xffff0000, v82
    v_mfma_f32_16x16x32_bf16 v[236:239], v[44:47], a[44:47], v[236:239]
    v_fmac_f32 v124, v108, v105
    v_fmac_f32 v125, v109, v105
    v_lshlrev_b32 v110, 16, v83
    v_and_b32 v111, 0xffff0000, v83
    v_mfma_f32_16x16x32_bf16 v[144:147], v[48:51], a[32:35], v[144:147]
    ds_read_b64_tr_b16 v[44:45], v11 offset:24576
    v_fmac_f32 v126, v110, v105
    v_fmac_f32 v127, v111, v105
    v_permlane32_swap_b32 v120, v124
    v_mfma_f32_16x16x32_bf16 v[176:179], v[48:51], a[36:39], v[176:179]
    ds_read_b64_tr_b16 v[46:47], v11 offset:25600
    v_permlane32_swap_b32 v121, v125
    v_permlane32_swap_b32 v122, v126
    v_permlane32_swap_b32 v123, v127
    v_mfma_f32_16x16x32_bf16 v[208:211], v[48:51], a[40:43], v[208:211]
    buffer_load_dwordx4 v17, s[12:15], s98 offen offset:1024   lds
    v_add_f32 v120, v120, v124
    v_add_f32 v121, v121, v125
    v_mfma_f32_16x16x32_bf16 v[240:243], v[48:51], a[44:47], v[240:243]
    s_waitcnt lgkmcnt(4)
    v_add_f32 v122, v122, v126
    v_add_f32 v123, v123, v127
    s_nop 0
    v_permlane16_swap_b32 v120, v122
    v_permlane16_swap_b32 v121, v123
    v_mfma_f32_16x16x32_bf16 v[148:151], v[52:55], a[32:35], v[148:151]
    ds_read_b64_tr_b16 v[48:49], v12 offset:24576
    v_add_f32 v120, v120, v122
    v_add_f32 v121, v121, v123
    s_nop 0
    v_add_f32_dpp v120, v120, v120 row_ror:8 row_mask:0xf bank_mask:0xf
    v_mfma_f32_16x16x32_bf16 v[180:183], v[52:55], a[36:39], v[180:183]
    ds_read_b64_tr_b16 v[50:51], v12 offset:25600
    v_add_f32_dpp v121, v121, v121 row_ror:8 row_mask:0xf bank_mask:0xf
    v_mfma_f32_16x16x32_bf16 v[212:215], v[52:55], a[40:43], v[212:215]
    buffer_load_dwordx4 v18, s[12:15], s98 offen offset:2048   lds
    ds_write_b64 v98, v[120:121]
    v_mfma_f32_16x16x32_bf16 v[244:247], v[52:55], a[44:47], v[244:247]
    v_mfma_f32_16x16x32_bf16 v[152:155], v[56:59], a[32:35], v[152:155]
    ds_read_b64_tr_b16 v[52:53], v13 offset:24576
    v_lshlrev_b32 v64, 16, v88
    v_mfma_f32_16x16x32_bf16 v[184:187], v[56:59], a[36:39], v[184:187]
    ds_read_b64_tr_b16 v[54:55], v13 offset:25600
    v_and_b32 v65, 0xffff0000, v88
    v_mfma_f32_16x16x32_bf16 v[216:219], v[56:59], a[40:43], v[216:219]
    buffer_load_dwordx4 v19, s[12:15], s98 offen offset:3072   lds
    v_mfma_f32_16x16x32_bf16 v[248:251], v[56:59], a[44:47], v[248:251]
    v_lshlrev_b32 v66, 16, v89
    v_and_b32 v67, 0xffff0000, v89
    v_mfma_f32_16x16x32_bf16 v[156:159], v[60:63], a[32:35], v[156:159]
    s_add_u32 m0, s62, 4096
    s_xor_b32 s98, s96, 33152
    ds_read_b64_tr_b16 v[56:57], v14 offset:24576
    v_mfma_f32_16x16x32_bf16 v[188:191], v[60:63], a[36:39], v[188:191]
    ds_read_b64_tr_b16 v[58:59], v14 offset:25600
    v_lshlrev_b32 v68, 16, v90
    v_mfma_f32_16x16x32_bf16 v[220:223], v[60:63], a[40:43], v[220:223]
    buffer_load_dwordx4 v16, s[12:15], s98 offen offset:0   lds
    v_mfma_f32_16x16x32_bf16 v[252:255], v[60:63], a[44:47], v[252:255]
    v_and_b32 v69, 0xffff0000, v90
    v_lshlrev_b32 v70, 16, v91
    v_mfma_f32_16x16x32_bf16 v[128:131], v[32:35], a[48:51], v[128:131]
    ds_read_b64_tr_b16 v[60:61], v15 offset:24576
    v_and_b32 v71, 0xffff0000, v91
    v_mfma_f32_16x16x32_bf16 v[160:163], v[32:35], a[52:55], v[160:163]
    ds_read_b64_tr_b16 v[62:63], v15 offset:25600
    v_lshlrev_b32 v72, 16, v92
    v_mfma_f32_16x16x32_bf16 v[192:195], v[32:35], a[56:59], v[192:195]
    buffer_load_dwordx4 v17, s[12:15], s98 offen offset:1024   lds
    v_mfma_f32_16x16x32_bf16 v[224:227], v[32:35], a[60:63], v[224:227]
    v_and_b32 v73, 0xffff0000, v92
    v_lshlrev_b32 v74, 16, v93
    v_mfma_f32_16x16x32_bf16 v[132:135], v[36:39], a[48:51], v[132:135]
    buffer_load_dwordx4 v18, s[12:15], s98 offen offset:2048   lds
    v_mfma_f32_16x16x32_bf16 v[164:167], v[36:39], a[52:55], v[164:167]
    v_and_b32 v75, 0xffff0000, v93
    v_lshlrev_b32 v76, 16, v94
    v_mfma_f32_16x16x32_bf16 v[196:199], v[36:39], a[56:59], v[196:199]
    buffer_load_dwordx4 v19, s[12:15], s98 offen offset:3072   lds
    s_cmp_eq_u32 s3, 0
    s_cselect_b32 s101, s100, 2147479552
    buffer_load_dword a241, v117, s[20:23], s101 offen offset:4
    v_mfma_f32_16x16x32_bf16 v[228:231], v[36:39], a[60:63], v[228:231]
    s_waitcnt lgkmcnt(2)
    v_and_b32 v77, 0xffff0000, v94
    v_lshlrev_b32 v78, 16, v95
    s_waitcnt vmcnt(9)
    v_mfma_f32_16x16x32_bf16 v[136:139], v[40:43], a[48:51], v[136:139]
    v_and_b32 v79, 0xffff0000, v95
    v_add_f32 v108, v64, v65
    s_waitcnt lgkmcnt(0)
    s_barrier
    v_mfma_f32_16x16x32_bf16 v[168:171], v[40:43], a[52:55], v[168:171]
    s_add_u32 m0, s63, 114688
    s_xor_b32 s98, s97, 2097152
    ds_read_b64_tr_b16 v[32:33], v8 offset:32768
    v_lshrrev_b32 v87, 2, v1
    v_add_u32 v101, 147456, v87
    v_mfma_f32_16x16x32_bf16 v[200:203], v[40:43], a[56:59], v[200:203]
    ds_read_b64_tr_b16 v[34:35], v8 offset:33792
    ds_read_b32 v102, v101
    v_mfma_f32_16x16x32_bf16 v[232:235], v[40:43], a[60:63], v[232:235]
    ds_read_b64_tr_b16 v[36:37], v9 offset:32768
    ds_read_b32 v103, v101 offset:256
    v_mfma_f32_16x16x32_bf16 v[140:143], v[44:47], a[48:51], v[140:143]
    ds_read_b64_tr_b16 v[38:39], v9 offset:33792
    ds_read_b32 v104, v101 offset:512
    v_mfma_f32_16x16x32_bf16 v[172:175], v[44:47], a[52:55], v[172:175]
    ds_read_b64_tr_b16 v[40:41], v10 offset:32768
    ds_read_b32 v105, v101 offset:768
    v_mfma_f32_16x16x32_bf16 v[204:207], v[44:47], a[56:59], v[204:207]
    ds_read_b64_tr_b16 v[42:43], v10 offset:33792
    v_add_f32 v109, v66, v67
    v_mfma_f32_16x16x32_bf16 v[236:239], v[44:47], a[60:63], v[236:239]
    ds_read_b128 a[64:67], v30 offset:0
    v_add_f32 v108, v108, v68
    v_mfma_f32_16x16x32_bf16 v[144:147], v[48:51], a[48:51], v[144:147]
    ds_read_b64_tr_b16 v[44:45], v11 offset:32768
    v_add_f32 v109, v109, v69
    v_mfma_f32_16x16x32_bf16 v[176:179], v[48:51], a[52:55], v[176:179]
    ds_read_b64_tr_b16 v[46:47], v11 offset:33792
    v_add_f32 v108, v108, v70
    v_mfma_f32_16x16x32_bf16 v[208:211], v[48:51], a[56:59], v[208:211]
    ds_read_b128 a[68:71], v30 offset:2048
    v_add_f32 v109, v109, v71
    v_mfma_f32_16x16x32_bf16 v[240:243], v[48:51], a[60:63], v[240:243]
    ds_read_b128 a[72:75], v30 offset:4096
    s_waitcnt lgkmcnt(10)
    v_add_f32 v102, v102, v103
    v_mfma_f32_16x16x32_bf16 v[148:151], v[52:55], a[48:51], v[148:151]
    ds_read_b64_tr_b16 v[48:49], v12 offset:32768
    s_waitcnt lgkmcnt(7)
    v_add_f32 v104, v104, v105
    v_mfma_f32_16x16x32_bf16 v[180:183], v[52:55], a[52:55], v[180:183]
    ds_read_b64_tr_b16 v[50:51], v12 offset:33792
    v_add_f32 v102, v102, v104
    buffer_store_dword v102, v87, s[8:11], s66 offen sc0 sc1
    v_mfma_f32_16x16x32_bf16 v[212:215], v[52:55], a[56:59], v[212:215]
    ds_read_b128 a[76:79], v30 offset:6144
    v_add_f32 v108, v108, v72
    v_mfma_f32_16x16x32_bf16 v[244:247], v[52:55], a[60:63], v[244:247]
    buffer_load_dwordx4 v20, s[16:19], s98 offen offset:0   lds
    v_mfma_f32_16x16x32_bf16 v[152:155], v[56:59], a[48:51], v[152:155]
    s_mov_b32 s40, s92
    s_mov_b32 s41, s93
    ds_read_b64_tr_b16 v[52:53], v13 offset:32768
    v_mfma_f32_16x16x32_bf16 v[184:187], v[56:59], a[52:55], v[184:187]
    s_mov_b32 s42, 1835008
    s_mov_b32 s44, s94
    ds_read_b64_tr_b16 v[54:55], v13 offset:33792
    v_mfma_f32_16x16x32_bf16 v[216:219], v[56:59], a[56:59], v[216:219]
    s_mov_b32 s45, s95
    s_mov_b32 s46, 1835008
    v_add_f32 v109, v109, v73
    v_mfma_f32_16x16x32_bf16 v[248:251], v[56:59], a[60:63], v[248:251]
    buffer_load_dwordx4 v21, s[16:19], s98 offen offset:1024   lds
    v_mfma_f32_16x16x32_bf16 v[156:159], v[60:63], a[48:51], v[156:159]
    ds_read_b64_tr_b16 v[56:57], v14 offset:32768
    v_add_f32 v108, v108, v74
    v_mfma_f32_16x16x32_bf16 v[188:191], v[60:63], a[52:55], v[188:191]
    ds_read_b64_tr_b16 v[58:59], v14 offset:33792
    v_add_f32 v109, v109, v75
    v_mfma_f32_16x16x32_bf16 v[220:223], v[60:63], a[56:59], v[220:223]
    buffer_load_dwordx4 v22, s[16:19], s98 offen offset:2048   lds
    v_mfma_f32_16x16x32_bf16 v[252:255], v[60:63], a[60:63], v[252:255]
    s_waitcnt lgkmcnt(5)
    v_add_f32 v108, v108, v76
    v_add_f32 v109, v109, v77
    v_mfma_f32_16x16x32_bf16 v[128:131], v[32:35], a[64:67], v[128:131]
    ds_read_b64_tr_b16 v[60:61], v15 offset:32768
    v_add_f32 v108, v108, v78
    v_mfma_f32_16x16x32_bf16 v[160:163], v[32:35], a[68:71], v[160:163]
    ds_read_b64_tr_b16 v[62:63], v15 offset:33792
    v_add_f32 v109, v109, v79
    v_mfma_f32_16x16x32_bf16 v[192:195], v[32:35], a[72:75], v[192:195]
    s_waitcnt lgkmcnt(5)
    ds_read_b128 a[80:83], v31 offset:0
    v_add_f32 v108, v108, v109
    v_mfma_f32_16x16x32_bf16 v[224:227], v[32:35], a[76:79], v[224:227]
    ds_read_b128 a[84:87], v31 offset:2048
    v_add_f32_dpp v108, v108, v108 row_ror:8 row_mask:0xf bank_mask:0xf
    v_mfma_f32_16x16x32_bf16 v[132:135], v[36:39], a[64:67], v[132:135]
    ds_read_b64_tr_b16 v[32:33], v8 offset:40960
    v_mov_b32 v110, v108
    v_mfma_f32_16x16x32_bf16 v[164:167], v[36:39], a[68:71], v[164:167]
    ds_read_b64_tr_b16 v[34:35], v8 offset:41984
    v_permlane16_swap_b32 v108, v110
    v_mfma_f32_16x16x32_bf16 v[196:199], v[36:39], a[72:75], v[196:199]
    ds_read_b128 a[88:91], v31 offset:4096
    v_add_f32 v108, v108, v110
    v_mfma_f32_16x16x32_bf16 v[228:231], v[36:39], a[76:79], v[228:231]
    ds_read_b128 a[92:95], v31 offset:6144
    v_mov_b32 v110, v108
    v_mfma_f32_16x16x32_bf16 v[136:139], v[40:43], a[64:67], v[136:139]
    ds_read_b64_tr_b16 v[36:37], v9 offset:40960
    v_permlane32_swap_b32 v108, v110
    v_mfma_f32_16x16x32_bf16 v[168:171], v[40:43], a[68:71], v[168:171]
    ds_read_b64_tr_b16 v[38:39], v9 offset:41984
    v_add_f32 v108, v108, v110
    v_mfma_f32_16x16x32_bf16 v[200:203], v[40:43], a[72:75], v[200:203]
    buffer_load_dwordx4 v23, s[16:19], s98 offen offset:3072   lds
    v_mfma_f32_16x16x32_bf16 v[232:235], v[40:43], a[76:79], v[232:235]
    v_mul_f32 v108, 0x3c000000, v108
    v_sub_f32 v110, v64, v108
    v_mfma_f32_16x16x32_bf16 v[140:143], v[44:47], a[64:67], v[140:143]
    s_add_u32 m0, s62, 32768
    s_xor_b32 s98, s96, 512
    ds_read_b64_tr_b16 v[40:41], v10 offset:40960
    v_mfma_f32_16x16x32_bf16 v[172:175], v[44:47], a[68:71], v[172:175]
    ds_read_b64_tr_b16 v[42:43], v10 offset:41984
    v_mul_f32 v109, v110, v110
    v_mfma_f32_16x16x32_bf16 v[204:207], v[44:47], a[72:75], v[204:207]
    buffer_load_dwordx4 v16, s[12:15], s98 offen offset:0   lds
    v_mfma_f32_16x16x32_bf16 v[236:239], v[44:47], a[76:79], v[236:239]
    v_sub_f32 v111, v65, v108
    v_fmac_f32 v109, v111, v111
    v_mfma_f32_16x16x32_bf16 v[144:147], v[48:51], a[64:67], v[144:147]
    ds_read_b64_tr_b16 v[44:45], v11 offset:40960
    v_sub_f32 v110, v66, v108
    v_mfma_f32_16x16x32_bf16 v[176:179], v[48:51], a[68:71], v[176:179]
    ds_read_b64_tr_b16 v[46:47], v11 offset:41984
    v_fmac_f32 v109, v110, v110
    v_mfma_f32_16x16x32_bf16 v[208:211], v[48:51], a[72:75], v[208:211]
    buffer_load_dwordx4 v17, s[12:15], s98 offen offset:1024   lds
    v_mfma_f32_16x16x32_bf16 v[240:243], v[48:51], a[76:79], v[240:243]
    s_waitcnt lgkmcnt(4)
    v_sub_f32 v111, v67, v108
    v_fmac_f32 v109, v111, v111
    v_mfma_f32_16x16x32_bf16 v[148:151], v[52:55], a[64:67], v[148:151]
    ds_read_b64_tr_b16 v[48:49], v12 offset:40960
    v_sub_f32 v110, v68, v108
    v_mfma_f32_16x16x32_bf16 v[180:183], v[52:55], a[68:71], v[180:183]
    ds_read_b64_tr_b16 v[50:51], v12 offset:41984
    v_fmac_f32 v109, v110, v110
    v_mfma_f32_16x16x32_bf16 v[212:215], v[52:55], a[72:75], v[212:215]
    buffer_load_dwordx4 v18, s[12:15], s98 offen offset:2048   lds
    v_mfma_f32_16x16x32_bf16 v[244:247], v[52:55], a[76:79], v[244:247]
    v_sub_f32 v111, v69, v108
    v_fmac_f32 v109, v111, v111
    v_mfma_f32_16x16x32_bf16 v[152:155], v[56:59], a[64:67], v[152:155]
    ds_read_b64_tr_b16 v[52:53], v13 offset:40960
    v_sub_f32 v110, v70, v108
    v_mfma_f32_16x16x32_bf16 v[184:187], v[56:59], a[68:71], v[184:187]
    ds_read_b64_tr_b16 v[54:55], v13 offset:41984
    v_fmac_f32 v109, v110, v110
    v_mfma_f32_16x16x32_bf16 v[216:219], v[56:59], a[72:75], v[216:219]
    buffer_load_dwordx4 v19, s[12:15], s98 offen offset:3072   lds
    v_mfma_f32_16x16x32_bf16 v[248:251], v[56:59], a[76:79], v[248:251]
    v_sub_f32 v111, v71, v108
    v_fmac_f32 v109, v111, v111
    v_mfma_f32_16x16x32_bf16 v[156:159], v[60:63], a[64:67], v[156:159]
    s_add_u32 m0, s62, 36864
    s_xor_b32 s98, s96, 33280
    ds_read_b64_tr_b16 v[56:57], v14 offset:40960
    v_mfma_f32_16x16x32_bf16 v[188:191], v[60:63], a[68:71], v[188:191]
    ds_read_b64_tr_b16 v[58:59], v14 offset:41984
    v_sub_f32 v110, v72, v108
    v_mfma_f32_16x16x32_bf16 v[220:223], v[60:63], a[72:75], v[220:223]
    buffer_load_dwordx4 v16, s[12:15], s98 offen offset:0   lds
    v_mfma_f32_16x16x32_bf16 v[252:255], v[60:63], a[76:79], v[252:255]
    v_fmac_f32 v109, v110, v110
    v_sub_f32 v111, v73, v108
    v_mfma_f32_16x16x32_bf16 v[128:131], v[32:35], a[80:83], v[128:131]
    ds_read_b64_tr_b16 v[60:61], v15 offset:40960
    v_fmac_f32 v109, v111, v111
    v_mfma_f32_16x16x32_bf16 v[160:163], v[32:35], a[84:87], v[160:163]
    ds_read_b64_tr_b16 v[62:63], v15 offset:41984
    v_sub_f32 v110, v74, v108
    v_mfma_f32_16x16x32_bf16 v[192:195], v[32:35], a[88:91], v[192:195]
    buffer_load_dwordx4 v17, s[12:15], s98 offen offset:1024   lds
    v_mfma_f32_16x16x32_bf16 v[224:227], v[32:35], a[92:95], v[224:227]
    v_fmac_f32 v109, v110, v110
    v_sub_f32 v111, v75, v108
    v_mfma_f32_16x16x32_bf16 v[132:135], v[36:39], a[80:83], v[132:135]
    buffer_load_dwordx4 v18, s[12:15], s98 offen offset:2048   lds
    v_mfma_f32_16x16x32_bf16 v[164:167], v[36:39], a[84:87], v[164:167]
    v_fmac_f32 v109, v111, v111
    v_sub_f32 v110, v76, v108
    v_mfma_f32_16x16x32_bf16 v[196:199], v[36:39], a[88:91], v[196:199]
    buffer_load_dwordx4 v19, s[12:15], s98 offen offset:3072   lds
    s_cmp_eq_u32 s3, 1
    s_cselect_b32 s101, s100, 2147479552
    buffer_load_dword a243, v117, s[20:23], s101 offen offset:4
    v_mfma_f32_16x16x32_bf16 v[228:231], v[36:39], a[92:95], v[228:231]
    s_waitcnt lgkmcnt(2)
    v_fmac_f32 v109, v110, v110
    v_sub_f32 v111, v77, v108
    v_mfma_f32_16x16x32_bf16 v[136:139], v[40:43], a[80:83], v[136:139]
    v_fmac_f32 v109, v111, v111
    v_sub_f32 v110, v78, v108
    s_waitcnt vmcnt(15) lgkmcnt(0)
    s_barrier
    v_mfma_f32_16x16x32_bf16 v[168:171], v[40:43], a[84:87], v[168:171]
    s_add_u32 m0, s63, 131072
    s_xor_b32 s98, s97, 2621440
    ds_read_b64_tr_b16 v[32:33], v8 offset:0
    v_mfma_f32_16x16x32_bf16 v[200:203], v[40:43], a[88:91], v[200:203]
    ds_read_b64_tr_b16 v[34:35], v8 offset:1024
    v_fmac_f32 v109, v110, v110
    v_mfma_f32_16x16x32_bf16 v[232:235], v[40:43], a[92:95], v[232:235]
    ds_read_b64_tr_b16 v[36:37], v9 offset:0
    v_sub_f32 v111, v79, v108
    v_mfma_f32_16x16x32_bf16 v[140:143], v[44:47], a[80:83], v[140:143]
    ds_read_b64_tr_b16 v[38:39], v9 offset:1024
    v_fmac_f32 v109, v111, v111
    v_mfma_f32_16x16x32_bf16 v[172:175], v[44:47], a[84:87], v[172:175]
    ds_read_b64_tr_b16 v[40:41], v10 offset:0
    v_add_f32_dpp v109, v109, v109 row_ror:8 row_mask:0xf bank_mask:0xf
    v_mfma_f32_16x16x32_bf16 v[204:207], v[44:47], a[88:91], v[204:207]
    ds_read_b64_tr_b16 v[42:43], v10 offset:1024
    v_mov_b32 v110, v109
    v_mfma_f32_16x16x32_bf16 v[236:239], v[44:47], a[92:95], v[236:239]
    ds_read_b128 a[96:99], v28 offset:0
    v_permlane16_swap_b32 v109, v110
    v_mfma_f32_16x16x32_bf16 v[144:147], v[48:51], a[80:83], v[144:147]
    ds_read_b64_tr_b16 v[44:45], v11 offset:0
    v_add_f32 v109, v109, v110
    v_mfma_f32_16x16x32_bf16 v[176:179], v[48:51], a[84:87], v[176:179]
    ds_read_b64_tr_b16 v[46:47], v11 offset:1024
    v_mov_b32 v110, v109
    s_waitcnt vmcnt(13)
    buffer_atomic_add v6, v7, s[36:39], s69 offen sc1
    v_mfma_f32_16x16x32_bf16 v[208:211], v[48:51], a[88:91], v[208:211]
    ds_read_b128 a[100:103], v28 offset:2048
    v_permlane32_swap_b32 v109, v110
    v_mfma_f32_16x16x32_bf16 v[240:243], v[48:51], a[92:95], v[240:243]
    ds_read_b128 a[104:107], v28 offset:4096
    v_add_f32 v109, v109, v110
    v_mfma_f32_16x16x32_bf16 v[148:151], v[52:55], a[80:83], v[148:151]
    ds_read_b64_tr_b16 v[48:49], v12 offset:0
    v_mfma_f32_16x16x32_bf16 v[180:183], v[52:55], a[84:87], v[180:183]
    ds_read_b64_tr_b16 v[50:51], v12 offset:1024
    v_mfma_f32_16x16x32_bf16 v[212:215], v[52:55], a[88:91], v[212:215]
    ds_read_b128 a[108:111], v28 offset:6144
    v_mfma_f32_16x16x32_bf16 v[244:247], v[52:55], a[92:95], v[244:247]
    buffer_load_dwordx4 v20, s[16:19], s98 offen offset:0   lds
    v_mfma_f32_16x16x32_bf16 v[152:155], v[56:59], a[80:83], v[152:155]
    ds_read_b64_tr_b16 v[52:53], v13 offset:0
    v_mfma_f32_16x16x32_bf16 v[184:187], v[56:59], a[84:87], v[184:187]
    ds_read_b64_tr_b16 v[54:55], v13 offset:1024
    v_mfma_f32_16x16x32_bf16 v[216:219], v[56:59], a[88:91], v[216:219]
    buffer_load_dwordx4 v21, s[16:19], s98 offen offset:1024   lds
    v_mfma_f32_16x16x32_bf16 v[248:251], v[56:59], a[92:95], v[248:251]
    ds_write_b64 v100, v[108:109]
    v_mfma_f32_16x16x32_bf16 v[156:159], v[60:63], a[80:83], v[156:159]
    ds_read_b64_tr_b16 v[56:57], v14 offset:0
    v_mfma_f32_16x16x32_bf16 v[188:191], v[60:63], a[84:87], v[188:191]
    ds_read_b64_tr_b16 v[58:59], v14 offset:1024
    v_mfma_f32_16x16x32_bf16 v[220:223], v[60:63], a[88:91], v[220:223]
    buffer_load_dwordx4 v22, s[16:19], s98 offen offset:2048   lds
    v_mfma_f32_16x16x32_bf16 v[252:255], v[60:63], a[92:95], v[252:255]
    s_waitcnt lgkmcnt(6)
    v_mfma_f32_16x16x32_bf16 v[128:131], v[32:35], a[96:99], v[128:131]
    ds_read_b64_tr_b16 v[60:61], v15 offset:0
    v_mfma_f32_16x16x32_bf16 v[160:163], v[32:35], a[100:103], v[160:163]
    ds_read_b64_tr_b16 v[62:63], v15 offset:1024
    v_mfma_f32_16x16x32_bf16 v[192:195], v[32:35], a[104:107], v[192:195]
    s_waitcnt lgkmcnt(6)
    ds_read_b128 a[112:115], v29 offset:0
    v_mfma_f32_16x16x32_bf16 v[224:227], v[32:35], a[108:111], v[224:227]
    ds_read_b128 a[116:119], v29 offset:2048
    v_mfma_f32_16x16x32_bf16 v[132:135], v[36:39], a[96:99], v[132:135]
    ds_read_b64_tr_b16 v[32:33], v8 offset:8192
    v_mfma_f32_16x16x32_bf16 v[164:167], v[36:39], a[100:103], v[164:167]
    ds_read_b64_tr_b16 v[34:35], v8 offset:9216
    v_mfma_f32_16x16x32_bf16 v[196:199], v[36:39], a[104:107], v[196:199]
    ds_read_b128 a[120:123], v29 offset:4096
    v_mfma_f32_16x16x32_bf16 v[228:231], v[36:39], a[108:111], v[228:231]
    ds_read_b128 a[124:127], v29 offset:6144
    v_mfma_f32_16x16x32_bf16 v[136:139], v[40:43], a[96:99], v[136:139]
    ds_read_b64_tr_b16 v[36:37], v9 offset:8192
    v_mfma_f32_16x16x32_bf16 v[168:171], v[40:43], a[100:103], v[168:171]
    ds_read_b64_tr_b16 v[38:39], v9 offset:9216
    v_mfma_f32_16x16x32_bf16 v[200:203], v[40:43], a[104:107], v[200:203]
    buffer_load_dwordx4 v23, s[16:19], s98 offen offset:3072   lds
    v_mfma_f32_16x16x32_bf16 v[232:235], v[40:43], a[108:111], v[232:235]
    v_mfma_f32_16x16x32_bf16 v[140:143], v[44:47], a[96:99], v[140:143]
    s_add_u32 m0, s62, 65536
    s_xor_b32 s98, s96, 640
    ds_read_b64_tr_b16 v[40:41], v10 offset:8192
    v_mfma_f32_16x16x32_bf16 v[172:175], v[44:47], a[100:103], v[172:175]
    ds_read_b64_tr_b16 v[42:43], v10 offset:9216
    v_mfma_f32_16x16x32_bf16 v[204:207], v[44:47], a[104:107], v[204:207]
    buffer_load_dwordx4 v16, s[12:15], s98 offen offset:0   lds
    v_mfma_f32_16x16x32_bf16 v[236:239], v[44:47], a[108:111], v[236:239]
    v_mfma_f32_16x16x32_bf16 v[144:147], v[48:51], a[96:99], v[144:147]
    ds_read_b64_tr_b16 v[44:45], v11 offset:8192
    v_mfma_f32_16x16x32_bf16 v[176:179], v[48:51], a[100:103], v[176:179]
    ds_read_b64_tr_b16 v[46:47], v11 offset:9216
    v_mfma_f32_16x16x32_bf16 v[208:211], v[48:51], a[104:107], v[208:211]
    buffer_load_dwordx4 v17, s[12:15], s98 offen offset:1024   lds
    v_mfma_f32_16x16x32_bf16 v[240:243], v[48:51], a[108:111], v[240:243]
    s_waitcnt lgkmcnt(4)
    v_mfma_f32_16x16x32_bf16 v[148:151], v[52:55], a[96:99], v[148:151]
    ds_read_b64_tr_b16 v[48:49], v12 offset:8192
    v_mfma_f32_16x16x32_bf16 v[180:183], v[52:55], a[100:103], v[180:183]
    ds_read_b64_tr_b16 v[50:51], v12 offset:9216
    v_mfma_f32_16x16x32_bf16 v[212:215], v[52:55], a[104:107], v[212:215]
    buffer_load_dwordx4 v18, s[12:15], s98 offen offset:2048   lds
    v_mfma_f32_16x16x32_bf16 v[244:247], v[52:55], a[108:111], v[244:247]
    v_mfma_f32_16x16x32_bf16 v[152:155], v[56:59], a[96:99], v[152:155]
    ds_read_b64_tr_b16 v[52:53], v13 offset:8192
    v_mfma_f32_16x16x32_bf16 v[184:187], v[56:59], a[100:103], v[184:187]
    ds_read_b64_tr_b16 v[54:55], v13 offset:9216
    v_mfma_f32_16x16x32_bf16 v[216:219], v[56:59], a[104:107], v[216:219]
    buffer_load_dwordx4 v19, s[12:15], s98 offen offset:3072   lds
    v_mfma_f32_16x16x32_bf16 v[248:251], v[56:59], a[108:111], v[248:251]
    v_mfma_f32_16x16x32_bf16 v[156:159], v[60:63], a[96:99], v[156:159]
    s_add_u32 m0, s62, 69632
    s_xor_b32 s98, s96, 33408
    ds_read_b64_tr_b16 v[56:57], v14 offset:8192
    v_mfma_f32_16x16x32_bf16 v[188:191], v[60:63], a[100:103], v[188:191]
    ds_read_b64_tr_b16 v[58:59], v14 offset:9216
    v_mfma_f32_16x16x32_bf16 v[220:223], v[60:63], a[104:107], v[220:223]
    buffer_load_dwordx4 v16, s[12:15], s98 offen offset:0   lds
    v_mfma_f32_16x16x32_bf16 v[252:255], v[60:63], a[108:111], v[252:255]
    v_mfma_f32_16x16x32_bf16 v[128:131], v[32:35], a[112:115], v[128:131]
    ds_read_b64_tr_b16 v[60:61], v15 offset:8192
    v_mfma_f32_16x16x32_bf16 v[160:163], v[32:35], a[116:119], v[160:163]
    ds_read_b64_tr_b16 v[62:63], v15 offset:9216
    v_mfma_f32_16x16x32_bf16 v[192:195], v[32:35], a[120:123], v[192:195]
    buffer_load_dwordx4 v17, s[12:15], s98 offen offset:1024   lds
    v_mfma_f32_16x16x32_bf16 v[224:227], v[32:35], a[124:127], v[224:227]
    v_mfma_f32_16x16x32_bf16 v[132:135], v[36:39], a[112:115], v[132:135]
    buffer_load_dwordx4 v18, s[12:15], s98 offen offset:2048   lds
    v_mfma_f32_16x16x32_bf16 v[164:167], v[36:39], a[116:119], v[164:167]
    v_mfma_f32_16x16x32_bf16 v[196:199], v[36:39], a[120:123], v[196:199]
    buffer_load_dwordx4 v19, s[12:15], s98 offen offset:3072   lds
    s_cmp_eq_u32 s3, 2
    s_cselect_b32 s101, s100, 2147479552
    buffer_load_dword a245, v117, s[24:27], s101 offen offset:4
    v_mfma_f32_16x16x32_bf16 v[228:231], v[36:39], a[124:127], v[228:231]
    s_waitcnt lgkmcnt(2)
    v_mfma_f32_16x16x32_bf16 v[136:139], v[40:43], a[112:115], v[136:139]
    s_waitcnt vmcnt(15) lgkmcnt(0)
    s_barrier
    v_mfma_f32_16x16x32_bf16 v[168:171], v[40:43], a[116:119], v[168:171]
    s_add_u32 m0, s63, 98304
    s_xor_b32 s98, s97, 3145728
    ds_read_b64_tr_b16 v[32:33], v8 offset:16384
    v_mfma_f32_16x16x32_bf16 v[200:203], v[40:43], a[120:123], v[200:203]
    ds_read_b64_tr_b16 v[34:35], v8 offset:17408
    v_mfma_f32_16x16x32_bf16 v[232:235], v[40:43], a[124:127], v[232:235]
    ds_read_b64_tr_b16 v[36:37], v9 offset:16384
    v_mfma_f32_16x16x32_bf16 v[140:143], v[44:47], a[112:115], v[140:143]
    ds_read_b64_tr_b16 v[38:39], v9 offset:17408
    v_mfma_f32_16x16x32_bf16 v[172:175], v[44:47], a[116:119], v[172:175]
    ds_read_b64_tr_b16 v[40:41], v10 offset:16384
    v_mfma_f32_16x16x32_bf16 v[204:207], v[44:47], a[120:123], v[204:207]
    ds_read_b64_tr_b16 v[42:43], v10 offset:17408
    v_mfma_f32_16x16x32_bf16 v[236:239], v[44:47], a[124:127], v[236:239]
    ds_read_b128 a[128:131], v28 offset:32768
    v_mfma_f32_16x16x32_bf16 v[144:147], v[48:51], a[112:115], v[144:147]
    ds_read_b64_tr_b16 v[44:45], v11 offset:16384
    v_mfma_f32_16x16x32_bf16 v[176:179], v[48:51], a[116:119], v[176:179]
    ds_read_b64_tr_b16 v[46:47], v11 offset:17408
    v_mfma_f32_16x16x32_bf16 v[208:211], v[48:51], a[120:123], v[208:211]
    ds_read_b128 a[132:135], v28 offset:34816
    v_mfma_f32_16x16x32_bf16 v[240:243], v[48:51], a[124:127], v[240:243]
    ds_read_b128 a[136:139], v28 offset:36864
    v_mfma_f32_16x16x32_bf16 v[148:151], v[52:55], a[112:115], v[148:151]
    ds_read_b64_tr_b16 v[48:49], v12 offset:16384
    v_mfma_f32_16x16x32_bf16 v[180:183], v[52:55], a[116:119], v[180:183]
    ds_read_b64_tr_b16 v[50:51], v12 offset:17408
    v_mfma_f32_16x16x32_bf16 v[212:215], v[52:55], a[120:123], v[212:215]
    ds_read_b128 a[140:143], v28 offset:38912
    v_mfma_f32_16x16x32_bf16 v[244:247], v[52:55], a[124:127], v[244:247]
    buffer_load_dwordx4 v20, s[16:19], s98 offen offset:0   lds
    v_mfma_f32_16x16x32_bf16 v[152:155], v[56:59], a[112:115], v[152:155]
    ds_read_b64_tr_b16 v[52:53], v13 offset:16384
    v_mfma_f32_16x16x32_bf16 v[184:187], v[56:59], a[116:119], v[184:187]
    ds_read_b64_tr_b16 v[54:55], v13 offset:17408
    v_mfma_f32_16x16x32_bf16 v[216:219], v[56:59], a[120:123], v[216:219]
    buffer_load_dwordx4 v21, s[16:19], s98 offen offset:1024   lds
    v_mfma_f32_16x16x32_bf16 v[248:251], v[56:59], a[124:127], v[248:251]
    ds_read_b128 v[88:91], v99
    v_mfma_f32_16x16x32_bf16 v[156:159], v[60:63], a[112:115], v[156:159]
    ds_read_b64_tr_b16 v[56:57], v14 offset:16384
    v_mfma_f32_16x16x32_bf16 v[188:191], v[60:63], a[116:119], v[188:191]
    ds_read_b64_tr_b16 v[58:59], v14 offset:17408
    v_mfma_f32_16x16x32_bf16 v[220:223], v[60:63], a[120:123], v[220:223]
    buffer_load_dwordx4 v22, s[16:19], s98 offen offset:2048   lds
    v_mfma_f32_16x16x32_bf16 v[252:255], v[60:63], a[124:127], v[252:255]
    s_waitcnt lgkmcnt(6)
    ds_read_b128 v[92:95], v99 offset:16
    v_mfma_f32_16x16x32_bf16 v[128:131], v[32:35], a[128:131], v[128:131]
    ds_read_b64_tr_b16 v[60:61], v15 offset:16384
    v_mfma_f32_16x16x32_bf16 v[160:163], v[32:35], a[132:135], v[160:163]
    ds_read_b64_tr_b16 v[62:63], v15 offset:17408
    v_mfma_f32_16x16x32_bf16 v[192:195], v[32:35], a[136:139], v[192:195]
    s_waitcnt lgkmcnt(7)
    ds_read_b128 a[144:147], v29 offset:32768
    v_mfma_f32_16x16x32_bf16 v[224:227], v[32:35], a[140:143], v[224:227]
    ds_read_b128 a[148:151], v29 offset:34816
    v_mfma_f32_16x16x32_bf16 v[132:135], v[36:39], a[128:131], v[132:135]
    ds_read_b64_tr_b16 v[32:33], v8 offset:24576
    v_mfma_f32_16x16x32_bf16 v[164:167], v[36:39], a[132:135], v[164:167]
    ds_read_b64_tr_b16 v[34:35], v8 offset:25600
    v_mfma_f32_16x16x32_bf16 v[196:199], v[36:39], a[136:139], v[196:199]
    ds_read_b128 a[152:155], v29 offset:36864
    v_mfma_f32_16x16x32_bf16 v[228:231], v[36:39], a[140:143], v[228:231]
    ds_read_b128 a[156:159], v29 offset:38912
    s_waitcnt lgkmcnt(11)
    v_add_f32 v108, v88, v90
    v_mfma_f32_16x16x32_bf16 v[136:139], v[40:43], a[128:131], v[136:139]
    ds_read_b64_tr_b16 v[36:37], v9 offset:24576
    s_waitcnt lgkmcnt(9)
    v_add_f32 v109, v92, v94
    v_mfma_f32_16x16x32_bf16 v[168:171], v[40:43], a[132:135], v[168:171]
    ds_read_b64_tr_b16 v[38:39], v9 offset:25600
    v_add_f32 v108, v108, v109
    v_mfma_f32_16x16x32_bf16 v[200:203], v[40:43], a[136:139], v[200:203]
    buffer_load_dwordx4 v23, s[16:19], s98 offen offset:3072   lds
    v_mfma_f32_16x16x32_bf16 v[232:235], v[40:43], a[140:143], v[232:235]
    v_mul_f32 v108, 0x3e800000, v108
    v_add_f32 v109, v89, v91
    v_mfma_f32_16x16x32_bf16 v[140:143], v[44:47], a[128:131], v[140:143]
    s_add_u32 m0, s62, 0
    s_xor_b32 s98, s96, 768
    ds_read_b64_tr_b16 v[40:41], v10 offset:24576
    v_mfma_f32_16x16x32_bf16 v[172:175], v[44:47], a[132:135], v[172:175]
    ds_read_b64_tr_b16 v[42:43], v10 offset:25600
    v_add_f32 v110, v93, v95
    v_mfma_f32_16x16x32_bf16 v[204:207], v[44:47], a[136:139], v[204:207]
    buffer_load_dwordx4 v16, s[12:15], s98 offen offset:0   lds
    v_mfma_f32_16x16x32_bf16 v[236:239], v[44:47], a[140:143], v[236:239]
    v_add_f32 v109, v109, v110
    v_sub_f32 v88, v88, v108
    v_mfma_f32_16x16x32_bf16 v[144:147], v[48:51], a[128:131], v[144:147]
    ds_read_b64_tr_b16 v[44:45], v11 offset:24576
    v_sub_f32 v90, v90, v108
    v_mfma_f32_16x16x32_bf16 v[176:179], v[48:51], a[132:135], v[176:179]
    ds_read_b64_tr_b16 v[46:47], v11 offset:25600
    v_sub_f32 v92, v92, v108
    v_mfma_f32_16x16x32_bf16 v[208:211], v[48:51], a[136:139], v[208:211]
    buffer_load_dwordx4 v17, s[12:15], s98 offen offset:1024   lds
    v_mfma_f32_16x16x32_bf16 v[240:243], v[48:51], a[140:143], v[240:243]
    v_sub_f32 v94, v94, v108
    v_mul_f32 v110, v88, v88
    v_mfma_f32_16x16x32_bf16 v[148:151], v[52:55], a[128:131], v[148:151]
    ds_read_b64_tr_b16 v[48:49], v12 offset:24576
    v_fmac_f32 v110, v90, v90
    v_mfma_f32_16x16x32_bf16 v[180:183], v[52:55], a[132:135], v[180:183]
    ds_read_b64_tr_b16 v[50:51], v12 offset:25600
    v_fmac_f32 v110, v92, v92
    v_mfma_f32_16x16x32_bf16 v[212:215], v[52:55], a[136:139], v[212:215]
    buffer_load_dwordx4 v18, s[12:15], s98 offen offset:2048   lds
    v_mfma_f32_16x16x32_bf16 v[244:247], v[52:55], a[140:143], v[244:247]
    v_fmac_f32 v110, v94, v94
    v_fmac_f32 v109, 0x43000000, v110
    v_mfma_f32_16x16x32_bf16 v[152:155], v[56:59], a[128:131], v[152:155]
    ds_read_b64_tr_b16 v[52:53], v13 offset:24576
    v_mov_b32 v110, 0x3727c5ac
    v_mfma_f32_16x16x32_bf16 v[184:187], v[56:59], a[132:135], v[184:187]
    ds_read_b64_tr_b16 v[54:55], v13 offset:25600
    v_fmac_f32 v110, 0x3b000000, v109
    v_mfma_f32_16x16x32_bf16 v[216:219], v[56:59], a[136:139], v[216:219]
    buffer_load_dwordx4 v19, s[12:15], s98 offen offset:3072   lds
    v_mfma_f32_16x16x32_bf16 v[248:251], v[56:59], a[140:143], v[248:251]
    s_waitcnt lgkmcnt(4)
    v_rsq_f32 v110, v110
    v_mfma_f32_16x16x32_bf16 v[156:159], v[60:63], a[128:131], v[156:159]
    s_add_u32 m0, s62, 4096
    s_xor_b32 s98, s96, 33536
    ds_read_b64_tr_b16 v[56:57], v14 offset:24576
    v_mfma_f32_16x16x32_bf16 v[188:191], v[60:63], a[132:135], v[188:191]
    ds_read_b64_tr_b16 v[58:59], v14 offset:25600
    v_sub_f32 v64, v64, v108
    v_mfma_f32_16x16x32_bf16 v[220:223], v[60:63], a[136:139], v[220:223]
    buffer_load_dwordx4 v16, s[12:15], s98 offen offset:0   lds
    v_mfma_f32_16x16x32_bf16 v[252:255], v[60:63], a[140:143], v[252:255]
    v_sub_f32 v65, v65, v108
    v_sub_f32 v66, v66, v108
    v_mfma_f32_16x16x32_bf16 v[128:131], v[32:35], a[144:147], v[128:131]
    ds_read_b64_tr_b16 v[60:61], v15 offset:24576
    v_sub_f32 v67, v67, v108
    v_mfma_f32_16x16x32_bf16 v[160:163], v[32:35], a[148:151], v[160:163]
    ds_read_b64_tr_b16 v[62:63], v15 offset:25600
    v_sub_f32 v68, v68, v108
    v_mfma_f32_16x16x32_bf16 v[192:195], v[32:35], a[152:155], v[192:195]
    buffer_load_dwordx4 v17, s[12:15], s98 offen offset:1024   lds
    v_mfma_f32_16x16x32_bf16 v[224:227], v[32:35], a[156:159], v[224:227]
    v_sub_f32 v69, v69, v108
    v_sub_f32 v70, v70, v108
    v_mfma_f32_16x16x32_bf16 v[132:135], v[36:39], a[144:147], v[132:135]
    buffer_load_dwordx4 v18, s[12:15], s98 offen offset:2048   lds
    v_mfma_f32_16x16x32_bf16 v[164:167], v[36:39], a[148:151], v[164:167]
    v_sub_f32 v71, v71, v108
    v_sub_f32 v72, v72, v108
    v_mfma_f32_16x16x32_bf16 v[196:199], v[36:39], a[152:155], v[196:199]
    buffer_load_dwordx4 v19, s[12:15], s98 offen offset:3072   lds
    s_cmp_eq_u32 s3, 3
    s_cselect_b32 s101, s100, 2147479552
    buffer_load_dword a247, v117, s[24:27], s101 offen offset:4
    v_mfma_f32_16x16x32_bf16 v[228:231], v[36:39], a[156:159], v[228:231]
    v_sub_f32 v73, v73, v108
    v_sub_f32 v74, v74, v108
    v_mfma_f32_16x16x32_bf16 v[136:139], v[40:43], a[144:147], v[136:139]
    v_sub_f32 v75, v75, v108
    v_sub_f32 v76, v76, v108
    s_waitcnt vmcnt(14) lgkmcnt(0)
    s_barrier
    v_mfma_f32_16x16x32_bf16 v[168:171], v[40:43], a[148:151], v[168:171]
    s_add_u32 m0, s63, 114688
    s_xor_b32 s98, s97, 3670016
    ds_read_b64_tr_b16 v[32:33], v8 offset:32768
    v_mfma_f32_16x16x32_bf16 v[200:203], v[40:43], a[152:155], v[200:203]
    ds_read_b64_tr_b16 v[34:35], v8 offset:33792
    v_sub_f32 v77, v77, v108
    v_mfma_f32_16x16x32_bf16 v[232:235], v[40:43], a[156:159], v[232:235]
    ds_read_b64_tr_b16 v[36:37], v9 offset:32768
    v_sub_f32 v78, v78, v108
    v_mfma_f32_16x16x32_bf16 v[140:143], v[44:47], a[144:147], v[140:143]
    ds_read_b64_tr_b16 v[38:39], v9 offset:33792
    v_sub_f32 v79, v79, v108
    v_mfma_f32_16x16x32_bf16 v[172:175], v[44:47], a[148:151], v[172:175]
    ds_read_b64_tr_b16 v[40:41], v10 offset:32768
    v_mul_f32 v64, v64, v110
    v_mfma_f32_16x16x32_bf16 v[204:207], v[44:47], a[152:155], v[204:207]
    ds_read_b64_tr_b16 v[42:43], v10 offset:33792
    v_mul_f32 v65, v65, v110
    v_mfma_f32_16x16x32_bf16 v[236:239], v[44:47], a[156:159], v[236:239]
    ds_read_b128 a[160:163], v30 offset:0
    v_mul_f32 v66, v66, v110
    v_mfma_f32_16x16x32_bf16 v[144:147], v[48:51], a[144:147], v[144:147]
    ds_read_b64_tr_b16 v[44:45], v11 offset:32768
    v_mul_f32 v67, v67, v110
    v_mfma_f32_16x16x32_bf16 v[176:179], v[48:51], a[148:151], v[176:179]
    ds_read_b64_tr_b16 v[46:47], v11 offset:33792
    v_mul_f32 v68, v68, v110
    v_mfma_f32_16x16x32_bf16 v[208:211], v[48:51], a[152:155], v[208:211]
    ds_read_b128 a[164:167], v30 offset:2048
    v_mul_f32 v69, v69, v110
    v_mfma_f32_16x16x32_bf16 v[240:243], v[48:51], a[156:159], v[240:243]
    ds_read_b128 a[168:171], v30 offset:4096
    v_mul_f32 v70, v70, v110
    v_mfma_f32_16x16x32_bf16 v[148:151], v[52:55], a[144:147], v[148:151]
    ds_read_b64_tr_b16 v[48:49], v12 offset:32768
    v_mul_f32 v71, v71, v110
    v_mfma_f32_16x16x32_bf16 v[180:183], v[52:55], a[148:151], v[180:183]
    ds_read_b64_tr_b16 v[50:51], v12 offset:33792
    v_mul_f32 v72, v72, v110
    v_mfma_f32_16x16x32_bf16 v[212:215], v[52:55], a[152:155], v[212:215]
    ds_read_b128 a[172:175], v30 offset:6144
    v_mul_f32 v73, v73, v110
    buffer_load_dword v3, v4, s[36:39], s67 offen sc0 sc1
    v_mfma_f32_16x16x32_bf16 v[244:247], v[52:55], a[156:159], v[244:247]
    buffer_load_dwordx4 v20, s[16:19], s98 offen offset:0   lds
    v_mfma_f32_16x16x32_bf16 v[152:155], v[56:59], a[144:147], v[152:155]
    ds_read_b64_tr_b16 v[52:53], v13 offset:32768
    v_mul_f32 v74, v74, v110
    v_mfma_f32_16x16x32_bf16 v[184:187], v[56:59], a[148:151], v[184:187]
    ds_read_b64_tr_b16 v[54:55], v13 offset:33792
    v_mul_f32 v75, v75, v110
    v_mfma_f32_16x16x32_bf16 v[216:219], v[56:59], a[152:155], v[216:219]
    buffer_load_dwordx4 v21, s[16:19], s98 offen offset:1024   lds
    v_mfma_f32_16x16x32_bf16 v[248:251], v[56:59], a[156:159], v[248:251]
    v_mul_f32 v76, v76, v110
    v_mul_f32 v77, v77, v110
    v_mfma_f32_16x16x32_bf16 v[156:159], v[60:63], a[144:147], v[156:159]
    ds_read_b64_tr_b16 v[56:57], v14 offset:32768
    v_mul_f32 v78, v78, v110
    v_mfma_f32_16x16x32_bf16 v[188:191], v[60:63], a[148:151], v[188:191]
    ds_read_b64_tr_b16 v[58:59], v14 offset:33792
    v_mul_f32 v79, v79, v110
    v_mfma_f32_16x16x32_bf16 v[220:223], v[60:63], a[152:155], v[220:223]
    buffer_load_dwordx4 v22, s[16:19], s98 offen offset:2048   lds
    v_mfma_f32_16x16x32_bf16 v[252:255], v[60:63], a[156:159], v[252:255]
    s_waitcnt lgkmcnt(5)
    v_mfma_f32_16x16x32_bf16 v[128:131], v[32:35], a[160:163], v[128:131]
    ds_read_b64_tr_b16 v[60:61], v15 offset:32768
    v_and_b32 v96, 31, v2
    v_mfma_f32_16x16x32_bf16 v[160:163], v[32:35], a[164:167], v[160:163]
    ds_read_b64_tr_b16 v[62:63], v15 offset:33792
    v_lshlrev_b32 v96, 4, v96
    v_mfma_f32_16x16x32_bf16 v[192:195], v[32:35], a[168:171], v[192:195]
    s_waitcnt lgkmcnt(5)
    ds_read_b128 a[176:179], v31 offset:0
    v_lshrrev_b32 v97, 5, v2
    v_mfma_f32_16x16x32_bf16 v[224:227], v[32:35], a[172:175], v[224:227]
    ds_read_b128 a[180:183], v31 offset:2048
    v_lshl_add_u32 v96, v97, 11, v96
    v_mfma_f32_16x16x32_bf16 v[132:135], v[36:39], a[160:163], v[132:135]
    ds_read_b64_tr_b16 v[32:33], v8 offset:40960
    v_mfma_f32_16x16x32_bf16 v[164:167], v[36:39], a[164:167], v[164:167]
    ds_read_b64_tr_b16 v[34:35], v8 offset:41984
    v_mfma_f32_16x16x32_bf16 v[196:199], v[36:39], a[168:171], v[196:199]
    ds_read_b128 a[184:187], v31 offset:4096
    v_mfma_f32_16x16x32_bf16 v[228:231], v[36:39], a[172:175], v[228:231]
    ds_read_b128 a[188:191], v31 offset:6144
    v_mfma_f32_16x16x32_bf16 v[136:139], v[40:43], a[160:163], v[136:139]
    ds_read_b64_tr_b16 v[36:37], v9 offset:40960
    v_mfma_f32_16x16x32_bf16 v[168:171], v[40:43], a[164:167], v[168:171]
    ds_read_b64_tr_b16 v[38:39], v9 offset:41984
    v_mfma_f32_16x16x32_bf16 v[200:203], v[40:43], a[168:171], v[200:203]
    buffer_load_dwordx4 v23, s[16:19], s98 offen offset:3072   lds
    v_mfma_f32_16x16x32_bf16 v[232:235], v[40:43], a[172:175], v[232:235]
    v_mfma_f32_16x16x32_bf16 v[140:143], v[44:47], a[160:163], v[140:143]
    s_add_u32 m0, s62, 32768
    s_xor_b32 s98, s96, 896
    ds_read_b64_tr_b16 v[40:41], v10 offset:40960
    v_mfma_f32_16x16x32_bf16 v[172:175], v[44:47], a[164:167], v[172:175]
    ds_read_b64_tr_b16 v[42:43], v10 offset:41984
    v_mfma_f32_16x16x32_bf16 v[204:207], v[44:47], a[168:171], v[204:207]
    buffer_load_dwordx4 v16, s[12:15], s98 offen offset:0   lds
    v_mfma_f32_16x16x32_bf16 v[236:239], v[44:47], a[172:175], v[236:239]
    v_mfma_f32_16x16x32_bf16 v[144:147], v[48:51], a[160:163], v[144:147]
    ds_read_b64_tr_b16 v[44:45], v11 offset:40960
    v_mfma_f32_16x16x32_bf16 v[176:179], v[48:51], a[164:167], v[176:179]
    ds_read_b64_tr_b16 v[46:47], v11 offset:41984
    v_mfma_f32_16x16x32_bf16 v[208:211], v[48:51], a[168:171], v[208:211]
    buffer_load_dwordx4 v17, s[12:15], s98 offen offset:1024   lds
    v_mfma_f32_16x16x32_bf16 v[240:243], v[48:51], a[172:175], v[240:243]
    s_waitcnt lgkmcnt(4)
    v_mfma_f32_16x16x32_bf16 v[148:151], v[52:55], a[160:163], v[148:151]
    ds_read_b64_tr_b16 v[48:49], v12 offset:40960
    v_mfma_f32_16x16x32_bf16 v[180:183], v[52:55], a[164:167], v[180:183]
    ds_read_b64_tr_b16 v[50:51], v12 offset:41984
    v_mfma_f32_16x16x32_bf16 v[212:215], v[52:55], a[168:171], v[212:215]
    buffer_load_dwordx4 v18, s[12:15], s98 offen offset:2048   lds
    v_mfma_f32_16x16x32_bf16 v[244:247], v[52:55], a[172:175], v[244:247]
    v_mfma_f32_16x16x32_bf16 v[152:155], v[56:59], a[160:163], v[152:155]
    ds_read_b64_tr_b16 v[52:53], v13 offset:40960
    v_mfma_f32_16x16x32_bf16 v[184:187], v[56:59], a[164:167], v[184:187]
    ds_read_b64_tr_b16 v[54:55], v13 offset:41984
    v_mfma_f32_16x16x32_bf16 v[216:219], v[56:59], a[168:171], v[216:219]
    buffer_load_dwordx4 v19, s[12:15], s98 offen offset:3072   lds
    v_mfma_f32_16x16x32_bf16 v[248:251], v[56:59], a[172:175], v[248:251]
    v_mfma_f32_16x16x32_bf16 v[156:159], v[60:63], a[160:163], v[156:159]
    s_add_u32 m0, s62, 36864
    s_xor_b32 s98, s96, 33664
    ds_read_b64_tr_b16 v[56:57], v14 offset:40960
    v_mfma_f32_16x16x32_bf16 v[188:191], v[60:63], a[164:167], v[188:191]
    ds_read_b64_tr_b16 v[58:59], v14 offset:41984
    v_mfma_f32_16x16x32_bf16 v[220:223], v[60:63], a[168:171], v[220:223]
    buffer_load_dwordx4 v16, s[12:15], s98 offen offset:0   lds
    v_mfma_f32_16x16x32_bf16 v[252:255], v[60:63], a[172:175], v[252:255]
    v_mfma_f32_16x16x32_bf16 v[128:131], v[32:35], a[176:179], v[128:131]
    ds_read_b64_tr_b16 v[60:61], v15 offset:40960
    v_mfma_f32_16x16x32_bf16 v[160:163], v[32:35], a[180:183], v[160:163]
    ds_read_b64_tr_b16 v[62:63], v15 offset:41984
    v_mfma_f32_16x16x32_bf16 v[192:195], v[32:35], a[184:187], v[192:195]
    buffer_load_dwordx4 v17, s[12:15], s98 offen offset:1024   lds
    v_mfma_f32_16x16x32_bf16 v[224:227], v[32:35], a[188:191], v[224:227]
    v_mfma_f32_16x16x32_bf16 v[132:135], v[36:39], a[176:179], v[132:135]
    buffer_load_dwordx4 v18, s[12:15], s98 offen offset:2048   lds
    v_mfma_f32_16x16x32_bf16 v[164:167], v[36:39], a[180:183], v[164:167]
    v_mfma_f32_16x16x32_bf16 v[196:199], v[36:39], a[184:187], v[196:199]
    buffer_load_dwordx4 v19, s[12:15], s98 offen offset:3072   lds
    v_mfma_f32_16x16x32_bf16 v[228:231], v[36:39], a[188:191], v[228:231]
    s_waitcnt lgkmcnt(2)
    s_waitcnt vmcnt(12)
    v_cmp_le_u32 vcc, s68, v3
    s_cmp_eq_u64 vcc, -1
    s_cbranch_scc0 L_E_slow_1
L_E_ok_2:
    v_mfma_f32_16x16x32_bf16 v[136:139], v[40:43], a[176:179], v[136:139]
    s_waitcnt lgkmcnt(0)
    s_barrier
    v_mfma_f32_16x16x32_bf16 v[168:171], v[40:43], a[180:183], v[168:171]
    s_add_u32 m0, s62, 65536
    s_xor_b32 s98, s64, 0
    ds_read_b64_tr_b16 v[32:33], v8 offset:0
    v_mfma_f32_16x16x32_bf16 v[200:203], v[40:43], a[184:187], v[200:203]
    ds_read_b64_tr_b16 v[34:35], v8 offset:1024
    v_mov_b32 v18, v106
    v_mfma_f32_16x16x32_bf16 v[232:235], v[40:43], a[188:191], v[232:235]
    ds_read_b64_tr_b16 v[36:37], v9 offset:0
    v_mov_b32 v19, v107
    v_mfma_f32_16x16x32_bf16 v[140:143], v[44:47], a[176:179], v[140:143]
    ds_read_b64_tr_b16 v[38:39], v9 offset:1024
    v_mfma_f32_16x16x32_bf16 v[172:175], v[44:47], a[180:183], v[172:175]
    ds_read_b64_tr_b16 v[40:41], v10 offset:0
    v_mfma_f32_16x16x32_bf16 v[204:207], v[44:47], a[184:187], v[204:207]
    ds_read_b64_tr_b16 v[42:43], v10 offset:1024
    v_mfma_f32_16x16x32_bf16 v[236:239], v[44:47], a[188:191], v[236:239]
    ds_read_b128 a[192:195], v28 offset:0
    v_mfma_f32_16x16x32_bf16 v[144:147], v[48:51], a[176:179], v[144:147]
    ds_read_b64_tr_b16 v[44:45], v11 offset:0
    v_mfma_f32_16x16x32_bf16 v[176:179], v[48:51], a[180:183], v[176:179]
    ds_read_b64_tr_b16 v[46:47], v11 offset:1024
    v_mfma_f32_16x16x32_bf16 v[208:211], v[48:51], a[184:187], v[208:211]
    ds_read_b128 a[196:199], v28 offset:2048
    v_mfma_f32_16x16x32_bf16 v[240:243], v[48:51], a[188:191], v[240:243]
    ds_read_b128 a[200:203], v28 offset:4096
    v_mfma_f32_16x16x32_bf16 v[148:151], v[52:55], a[176:179], v[148:151]
    ds_read_b64_tr_b16 v[48:49], v12 offset:0
    v_mfma_f32_16x16x32_bf16 v[180:183], v[52:55], a[180:183], v[180:183]
    ds_read_b64_tr_b16 v[50:51], v12 offset:1024
    v_mfma_f32_16x16x32_bf16 v[212:215], v[52:55], a[184:187], v[212:215]
    ds_read_b128 a[204:207], v28 offset:6144
    v_mfma_f32_16x16x32_bf16 v[244:247], v[52:55], a[188:191], v[244:247]
    buffer_load_dwordx4 v24, s[20:23], s98 offen offset:0   lds
    v_mfma_f32_16x16x32_bf16 v[152:155], v[56:59], a[176:179], v[152:155]
    ds_read_b64_tr_b16 v[52:53], v13 offset:0
    v_mfma_f32_16x16x32_bf16 v[184:187], v[56:59], a[180:183], v[184:187]
    ds_read_b64_tr_b16 v[54:55], v13 offset:1024
    v_mfma_f32_16x16x32_bf16 v[216:219], v[56:59], a[184:187], v[216:219]
    buffer_load_dwordx4 v[80:83], v96, s[8:11], s70 offen
    v_mfma_f32_16x16x32_bf16 v[248:251], v[56:59], a[188:191], v[248:251]
    buffer_load_dwordx4 v25, s[20:23], s98 offen offset:1024   lds
    v_mfma_f32_16x16x32_bf16 v[156:159], v[60:63], a[176:179], v[156:159]
    s_lshl_b32 s80, s2, 6
    s_add_u32 s80, s80, 1310720
    ds_read_b64_tr_b16 v[56:57], v14 offset:0
    v_mfma_f32_16x16x32_bf16 v[188:191], v[60:63], a[180:183], v[188:191]
    s_waitcnt lgkmcnt(6)
    s_add_u32 s70, s70, 12288
    ds_read_b64_tr_b16 v[58:59], v14 offset:1024
    v_mfma_f32_16x16x32_bf16 v[220:223], v[60:63], a[184:187], v[220:223]
    buffer_store_dword v6, v7, s[8:11], s80 offen sc0 sc1
    v_mfma_f32_16x16x32_bf16 v[252:255], v[60:63], a[188:191], v[252:255]
    buffer_load_dwordx4 v26, s[20:23], s98 offen offset:2048   lds
    v_mfma_f32_16x16x32_bf16 v[128:131], v[32:35], a[192:195], v[128:131]
    ds_read_b64_tr_b16 v[60:61], v15 offset:0
    v_mfma_f32_16x16x32_bf16 v[160:163], v[32:35], a[196:199], v[160:163]
    ds_read_b64_tr_b16 v[62:63], v15 offset:1024
    v_mfma_f32_16x16x32_bf16 v[192:195], v[32:35], a[200:203], v[192:195]
    s_waitcnt lgkmcnt(5)
    ds_read_b128 a[208:211], v29 offset:0
    v_mfma_f32_16x16x32_bf16 v[224:227], v[32:35], a[204:207], v[224:227]
    ds_read_b128 a[212:215], v29 offset:2048
    v_mfma_f32_16x16x32_bf16 v[132:135], v[36:39], a[192:195], v[132:135]
    ds_read_b64_tr_b16 v[32:33], v8 offset:8192
    v_mfma_f32_16x16x32_bf16 v[164:167], v[36:39], a[196:199], v[164:167]
    ds_read_b64_tr_b16 v[34:35], v8 offset:9216
    v_mfma_f32_16x16x32_bf16 v[196:199], v[36:39], a[200:203], v[196:199]
    ds_read_b128 a[216:219], v29 offset:4096
    v_mfma_f32_16x16x32_bf16 v[228:231], v[36:39], a[204:207], v[228:231]
    ds_read_b128 a[220:223], v29 offset:6144
    v_mfma_f32_16x16x32_bf16 v[136:139], v[40:43], a[192:195], v[136:139]
    ds_read_b64_tr_b16 v[36:37], v9 offset:8192
    v_mfma_f32_16x16x32_bf16 v[168:171], v[40:43], a[196:199], v[168:171]
    ds_read_b64_tr_b16 v[38:39], v9 offset:9216
    v_mfma_f32_16x16x32_bf16 v[200:203], v[40:43], a[200:203], v[200:203]
    buffer_load_dwordx4 v27, s[20:23], s98 offen offset:3072   lds
    v_mfma_f32_16x16x32_bf16 v[232:235], v[40:43], a[204:207], v[232:235]
    buffer_load_dwordx4 v[84:87], v96, s[8:11], s70 offen
    v_mfma_f32_16x16x32_bf16 v[140:143], v[44:47], a[192:195], v[140:143]
    s_add_u32 m0, s62, 69632
    s_xor_b32 s98, s64, 262144
    ds_read_b64_tr_b16 v[40:41], v10 offset:8192
    v_mfma_f32_16x16x32_bf16 v[172:175], v[44:47], a[196:199], v[172:175]
    s_add_u32 s70, s70, 12288
    ds_read_b64_tr_b16 v[42:43], v10 offset:9216
    v_mfma_f32_16x16x32_bf16 v[204:207], v[44:47], a[200:203], v[204:207]
    buffer_load_dwordx4 v24, s[20:23], s98 offen offset:0   lds
    v_mfma_f32_16x16x32_bf16 v[236:239], v[44:47], a[204:207], v[236:239]
    buffer_load_dwordx4 v[88:91], v96, s[8:11], s70 offen
    v_mfma_f32_16x16x32_bf16 v[144:147], v[48:51], a[192:195], v[144:147]
    s_add_u32 s70, s70, 12288
    ds_read_b64_tr_b16 v[44:45], v11 offset:8192
    v_mfma_f32_16x16x32_bf16 v[176:179], v[48:51], a[196:199], v[176:179]
    s_waitcnt lgkmcnt(5)
    ds_read_b64_tr_b16 v[46:47], v11 offset:9216
    v_mfma_f32_16x16x32_bf16 v[208:211], v[48:51], a[200:203], v[208:211]
    buffer_load_dwordx4 v25, s[20:23], s98 offen offset:1024   lds
    v_mfma_f32_16x16x32_bf16 v[240:243], v[48:51], a[204:207], v[240:243]
    buffer_load_dwordx4 v[92:95], v96, s[8:11], s70 offen
    v_mfma_f32_16x16x32_bf16 v[148:151], v[52:55], a[192:195], v[148:151]
    ds_read_b64_tr_b16 v[48:49], v12 offset:8192
    v_mfma_f32_16x16x32_bf16 v[180:183], v[52:55], a[196:199], v[180:183]
    ds_read_b64_tr_b16 v[50:51], v12 offset:9216
    v_mfma_f32_16x16x32_bf16 v[212:215], v[52:55], a[200:203], v[212:215]
    buffer_load_dwordx4 v26, s[20:23], s98 offen offset:2048   lds
    v_mfma_f32_16x16x32_bf16 v[244:247], v[52:55], a[204:207], v[244:247]
    v_mfma_f32_16x16x32_bf16 v[152:155], v[56:59], a[192:195], v[152:155]
    ds_read_b64_tr_b16 v[52:53], v13 offset:8192
    v_mfma_f32_16x16x32_bf16 v[184:187], v[56:59], a[196:199], v[184:187]
    ds_read_b64_tr_b16 v[54:55], v13 offset:9216
    v_mfma_f32_16x16x32_bf16 v[216:219], v[56:59], a[200:203], v[216:219]
    buffer_load_dwordx4 v27, s[20:23], s98 offen offset:3072   lds
    v_mfma_f32_16x16x32_bf16 v[248:251], v[56:59], a[204:207], v[248:251]
    v_mfma_f32_16x16x32_bf16 v[156:159], v[60:63], a[192:195], v[156:159]
    ds_read_b64_tr_b16 v[56:57], v14 offset:8192
    v_mfma_f32_16x16x32_bf16 v[188:191], v[60:63], a[196:199], v[188:191]
    ds_read_b64_tr_b16 v[58:59], v14 offset:9216
    v_mfma_f32_16x16x32_bf16 v[220:223], v[60:63], a[200:203], v[220:223]
    v_mfma_f32_16x16x32_bf16 v[252:255], v[60:63], a[204:207], v[252:255]
    v_mfma_f32_16x16x32_bf16 v[128:131], v[32:35], a[208:211], v[128:131]
    ds_read_b64_tr_b16 v[60:61], v15 offset:8192
    v_mfma_f32_16x16x32_bf16 v[160:163], v[32:35], a[212:215], v[160:163]
    ds_read_b64_tr_b16 v[62:63], v15 offset:9216
    v_mfma_f32_16x16x32_bf16 v[192:195], v[32:35], a[216:219], v[192:195]
    s_getpc_b64 s[100:101]
L_ct1:
    s_lshr_b32 s99, s2, 3
    s_lshl_b32 s99, s99, 2
    s_add_u32 s99, s99, s3
    s_mul_i32 s99, s99, 2
    v_min_u32 v3, 1, v2
    v_add_u32 v3, s99, v3
    v_lshlrev_b32 v3, 7, v3
    v_add_u32 v3, L_ct1-L_ct1, v3
    v_min_u32 v3, L_attn-L_ct1, v3
    global_load_dword v3, v3, s[100:101]
    v_mfma_f32_16x16x32_bf16 v[224:227], v[32:35], a[220:223], v[224:227]
    s_waitcnt lgkmcnt(4)
    v_mfma_f32_16x16x32_bf16 v[132:135], v[36:39], a[208:211], v[132:135]
    v_mfma_f32_16x16x32_bf16 v[164:167], v[36:39], a[212:215], v[164:167]
    v_mfma_f32_16x16x32_bf16 v[196:199], v[36:39], a[216:219], v[196:199]
    v_mfma_f32_16x16x32_bf16 v[228:231], v[36:39], a[220:223], v[228:231]
    v_mfma_f32_16x16x32_bf16 v[136:139], v[40:43], a[208:211], v[136:139]
    s_waitcnt vmcnt(14) lgkmcnt(0)
    s_barrier
    v_mfma_f32_16x16x32_bf16 v[168:171], v[40:43], a[212:215], v[168:171]
    s_add_u32 m0, s62, 0
    s_xor_b32 s98, s64, 2097152
    ds_read_b64_tr_b16 v[32:33], v8 offset:16384
    v_mfma_f32_16x16x32_bf16 v[200:203], v[40:43], a[216:219], v[200:203]
    ds_read_b64_tr_b16 v[34:35], v8 offset:17408
    v_mfma_f32_16x16x32_bf16 v[232:235], v[40:43], a[220:223], v[232:235]
    ds_read_b64_tr_b16 v[96:97], v8 offset:24576
    v_mfma_f32_16x16x32_bf16 v[140:143], v[44:47], a[208:211], v[140:143]
    ds_read_b64_tr_b16 v[98:99], v8 offset:25600
    v_mfma_f32_16x16x32_bf16 v[172:175], v[44:47], a[212:215], v[172:175]
    ds_read_b128 a[224:227], v28 offset:32768
    v_mfma_f32_16x16x32_bf16 v[204:207], v[44:47], a[216:219], v[204:207]
    ds_read_b128 a[240:243], v29 offset:32768
    v_mfma_f32_16x16x32_bf16 v[236:239], v[44:47], a[220:223], v[236:239]
    ds_read_b64_tr_b16 v[36:37], v9 offset:16384
    v_mfma_f32_16x16x32_bf16 v[144:147], v[48:51], a[208:211], v[144:147]
    ds_read_b64_tr_b16 v[38:39], v9 offset:17408
    v_mfma_f32_16x16x32_bf16 v[176:179], v[48:51], a[212:215], v[176:179]
    ds_read_b64_tr_b16 v[100:101], v9 offset:24576
    v_mfma_f32_16x16x32_bf16 v[208:211], v[48:51], a[216:219], v[208:211]
    ds_read_b64_tr_b16 v[102:103], v9 offset:25600
    v_mfma_f32_16x16x32_bf16 v[240:243], v[48:51], a[220:223], v[240:243]
    ds_read_b128 a[228:231], v28 offset:34816
    v_mfma_f32_16x16x32_bf16 v[148:151], v[52:55], a[208:211], v[148:151]
    ds_read_b128 a[244:247], v29 offset:34816
    v_mfma_f32_16x16x32_bf16 v[180:183], v[52:55], a[212:215], v[180:183]
    ds_read_b128 a[232:235], v28 offset:36864
    v_mfma_f32_16x16x32_bf16 v[212:215], v[52:55], a[216:219], v[212:215]
    ds_read_b128 a[248:251], v29 offset:36864
    v_mfma_f32_16x16x32_bf16 v[244:247], v[52:55], a[220:223], v[244:247]
    ds_read_b128 a[236:239], v28 offset:38912
    v_mfma_f32_16x16x32_bf16 v[152:155], v[56:59], a[208:211], v[152:155]
    ds_read_b128 a[252:255], v29 offset:38912
    v_mfma_f32_16x16x32_bf16 v[184:187], v[56:59], a[212:215], v[184:187]
    ds_read_b64_tr_b16 v[40:41], v10 offset:16384
    v_and_b32 v16, 15, v2
    v_mfma_f32_16x16x32_bf16 v[216:219], v[56:59], a[216:219], v[216:219]
    ds_read_b64_tr_b16 v[42:43], v10 offset:17408
    v_lshrrev_b32 v17, 4, v2
    v_mfma_f32_16x16x32_bf16 v[248:251], v[56:59], a[220:223], v[248:251]
    ds_read_b64_tr_b16 v[104:105], v10 offset:24576
    v_lshrrev_b32 v29, 2, v16
    v_mfma_f32_16x16x32_bf16 v[156:159], v[60:63], a[208:211], v[156:159]
    ds_read_b64_tr_b16 v[106:107], v10 offset:25600
    v_and_b32 v16, 3, v16
    v_mfma_f32_16x16x32_bf16 v[188:191], v[60:63], a[212:215], v[188:191]
    ds_read_b64_tr_b16 v[44:45], v11 offset:16384
    v_lshl_add_u32 v28, v17, 3, v29
    v_mfma_f32_16x16x32_bf16 v[220:223], v[60:63], a[216:219], v[220:223]
    ds_read_b64_tr_b16 v[46:47], v11 offset:17408
    v_lshlrev_b32 v28, 7, v28
    v_mfma_f32_16x16x32_bf16 v[252:255], v[60:63], a[220:223], v[252:255]
    s_waitcnt lgkmcnt(9)
    ds_read_b64_tr_b16 v[108:109], v11 offset:24576
    v_lshl_add_u32 v28, v16, 3, v28
    v_mfma_f32_16x16x32_bf16 v[128:131], v[32:35], a[224:227], v[128:131]
    ds_read_b64_tr_b16 v[110:111], v11 offset:25600
    v_and_b32 v17, 1, v17
    v_mfma_f32_16x16x32_bf16 v[128:131], v[96:99], a[240:243], v[128:131]
    v_lshrrev_b32 v29, 1, v29
    v_lshl_add_u32 v29, v17, 1, v29
    v_mfma_f32_16x16x32_bf16 v[132:135], v[36:39], a[224:227], v[132:135]
    v_lshl_add_u32 v28, v29, 5, v28
    v_add_u32 v28, 65536, v28
    v_mfma_f32_16x16x32_bf16 v[132:135], v[100:103], a[240:243], v[132:135]
    v_xor_b32 v29, 32, v28
    v_xor_b32 v30, 64, v28
    v_mfma_f32_16x16x32_bf16 v[160:163], v[32:35], a[228:231], v[160:163]
    v_xor_b32 v31, 96, v28
    v_and_b32 v16, 15, v2
    v_mfma_f32_16x16x32_bf16 v[160:163], v[96:99], a[244:247], v[160:163]
    v_lshlrev_b32 v16, 6, v16
    v_add_u32 v16, 65536, v16
    s_waitcnt vmcnt(7)
    v_add_f32 v80, v80, v84
    v_mfma_f32_16x16x32_bf16 v[164:167], v[36:39], a[228:231], v[164:167]
    v_mad_i32_i24 v16, v17, s77, v16
    v_and_b32 v17, 31, v2
    s_waitcnt vmcnt(3)
    v_add_f32 v88, v88, v92
    v_mfma_f32_16x16x32_bf16 v[164:167], v[100:103], a[244:247], v[164:167]
    buffer_load_dwordx4 v24, s[20:23], s98 offen offset:0   lds
    v_add_f32 v81, v81, v85
    v_mfma_f32_16x16x32_bf16 v[192:195], v[32:35], a[232:235], v[192:195]
    s_waitcnt lgkmcnt(2)
    ds_read_b64_tr_b16 v[48:49], v12 offset:16384
    v_lshlrev_b32 v17, 6, v17
    v_add_f32 v89, v89, v93
    v_mfma_f32_16x16x32_bf16 v[192:195], v[96:99], a[248:251], v[192:195]
    ds_read_b64_tr_b16 v[50:51], v12 offset:17408
    v_add_f32 v82, v82, v86
    v_add_f32 v90, v90, v94
    v_mfma_f32_16x16x32_bf16 v[196:199], v[36:39], a[232:235], v[196:199]
    ds_read_b64_tr_b16 v[112:113], v12 offset:24576
    v_add_f32 v83, v83, v87
    v_add_f32 v91, v91, v95
    v_mfma_f32_16x16x32_bf16 v[196:199], v[100:103], a[248:251], v[196:199]
    ds_read_b64_tr_b16 v[114:115], v12 offset:25600
    v_add_f32 v80, v80, v88
    v_add_f32 v81, v81, v89
    v_mfma_f32_16x16x32_bf16 v[224:227], v[32:35], a[236:239], v[224:227]
    ds_read_b64_tr_b16 v[52:53], v13 offset:16384
    v_add_f32 v82, v82, v90
    v_add_f32 v83, v83, v91
    v_mfma_f32_16x16x32_bf16 v[224:227], v[96:99], a[252:255], v[224:227]
    ds_read_b64_tr_b16 v[54:55], v13 offset:17408
    v_lshrrev_b32 v88, 5, v2
    v_cvt_f32_u32 v88, v88
    v_mfma_f32_16x16x32_bf16 v[228:231], v[36:39], a[236:239], v[228:231]
    ds_read_b64_tr_b16 v[116:117], v13 offset:24576
    v_cvt_pk_bf16_f32 v84, v80, v81
    v_cvt_pk_bf16_f32 v85, v82, v83
    v_mfma_f32_16x16x32_bf16 v[228:231], v[100:103], a[252:255], v[228:231]
    ds_read_b64_tr_b16 v[118:119], v13 offset:25600
    v_lshlrev_b32 v80, 16, v84
    v_and_b32 v81, 0xffff0000, v84
    v_mfma_f32_16x16x32_bf16 v[136:139], v[40:43], a[224:227], v[136:139]
    buffer_load_dwordx4 v25, s[20:23], s98 offen offset:1024   lds
    v_lshlrev_b32 v82, 16, v85
    v_mfma_f32_16x16x32_bf16 v[136:139], v[104:107], a[240:243], v[136:139]
    s_waitcnt lgkmcnt(8)
    v_and_b32 v83, 0xffff0000, v85
    v_add_f32 v80, v80, v88
    v_add_f32 v81, v81, v88
    v_mfma_f32_16x16x32_bf16 v[140:143], v[44:47], a[224:227], v[140:143]
    buffer_load_dwordx4 v26, s[20:23], s98 offen offset:2048   lds
    v_add_f32 v82, v82, v88
    v_mfma_f32_16x16x32_bf16 v[140:143], v[108:111], a[240:243], v[140:143]
    v_add_f32 v83, v83, v88
    v_cvt_pk_bf16_f32 v84, v80, v81
    v_cvt_pk_bf16_f32 v85, v82, v83
    v_mfma_f32_16x16x32_bf16 v[168:171], v[40:43], a[228:231], v[168:171]
    buffer_load_dwordx4 v27, s[20:23], s98 offen offset:3072   lds
    v_lshlrev_b32 v80, 16, v84
    v_mfma_f32_16x16x32_bf16 v[168:171], v[104:107], a[244:247], v[168:171]
    s_add_u32 m0, s62, 4096
    s_xor_b32 s98, s64, 2359296
    v_and_b32 v81, 0xffff0000, v84
    v_lshlrev_b32 v82, 16, v85
    v_and_b32 v83, 0xffff0000, v85
    v_mfma_f32_16x16x32_bf16 v[172:175], v[44:47], a[228:231], v[172:175]
    buffer_load_dwordx4 v24, s[20:23], s98 offen offset:0   lds
    v_mul_f32 v80, 0x3e0293ee, v80
    v_mfma_f32_16x16x32_bf16 v[172:175], v[108:111], a[244:247], v[172:175]
    v_mul_f32 v81, 0x3e0293ee, v81
    v_mul_f32 v82, 0x3e0293ee, v82
    v_mul_f32 v83, 0x3e0293ee, v83
    v_mfma_f32_16x16x32_bf16 v[200:203], v[40:43], a[232:235], v[200:203]
    s_lshl_b32 s70, s3, 10
    s_add_u32 s70, s70, 151552
    ds_read_b64_tr_b16 v[56:57], v14 offset:16384
    v_add_u32 v88, s70, v1
    v_add_u32 v18, s70, v18
    v_mfma_f32_16x16x32_bf16 v[200:203], v[104:107], a[248:251], v[200:203]
    ds_read_b64_tr_b16 v[58:59], v14 offset:17408
    ds_write_b128 v88, v[80:83]
    v_mfma_f32_16x16x32_bf16 v[204:207], v[44:47], a[232:235], v[204:207]
    ds_read_b64_tr_b16 v[120:121], v14 offset:24576
    v_cvt_pk_bf16_f32 v128, v128, v129
    v_mfma_f32_16x16x32_bf16 v[204:207], v[108:111], a[248:251], v[204:207]
    ds_read_b64_tr_b16 v[122:123], v14 offset:25600
    v_cvt_pk_bf16_f32 v129, v130, v131
    v_mfma_f32_16x16x32_bf16 v[232:235], v[40:43], a[236:239], v[232:235]
    ds_read_b64_tr_b16 v[60:61], v15 offset:16384
    v_cvt_pk_bf16_f32 v130, v132, v133
    v_mfma_f32_16x16x32_bf16 v[232:235], v[104:107], a[252:255], v[232:235]
    ds_read_b64_tr_b16 v[62:63], v15 offset:17408
    v_cvt_pk_bf16_f32 v131, v134, v135
    v_mfma_f32_16x16x32_bf16 v[236:239], v[44:47], a[236:239], v[236:239]
    s_xor_b32 s79, s65, 0
    ds_read_b64_tr_b16 v[124:125], v15 offset:24576
    v_mfma_f32_16x16x32_bf16 v[236:239], v[108:111], a[252:255], v[236:239]
    s_waitcnt lgkmcnt(8)
    ds_read_b64_tr_b16 v[126:127], v15 offset:25600
    v_mfma_f32_16x16x32_bf16 v[144:147], v[48:51], a[224:227], v[144:147]
    buffer_load_dwordx4 v25, s[20:23], s98 offen offset:1024   lds
    v_mfma_f32_16x16x32_bf16 v[144:147], v[112:115], a[240:243], v[144:147]
    ds_read_b128 v[80:83], v18 offset:0
    v_mfma_f32_16x16x32_bf16 v[148:151], v[52:55], a[224:227], v[148:151]
    buffer_load_dwordx4 v26, s[20:23], s98 offen offset:2048   lds
    v_mfma_f32_16x16x32_bf16 v[148:151], v[116:119], a[240:243], v[148:151]
    ds_read_b128 v[84:87], v18 offset:16
    v_mfma_f32_16x16x32_bf16 v[176:179], v[48:51], a[228:231], v[176:179]
    buffer_load_dwordx4 v27, s[20:23], s98 offen offset:3072   lds
    v_mfma_f32_16x16x32_bf16 v[176:179], v[112:115], a[244:247], v[176:179]
    ds_read_b128 v[88:91], v18 offset:512
    v_mfma_f32_16x16x32_bf16 v[180:183], v[52:55], a[228:231], v[180:183]
    ds_read_b128 v[92:95], v18 offset:528
    v_mfma_f32_16x16x32_bf16 v[180:183], v[116:119], a[244:247], v[180:183]
    buffer_store_dwordx4 v[128:131], v1, s[8:11], s79 offen offset:0 sc0 sc1
    v_mfma_f32_16x16x32_bf16 v[208:211], v[48:51], a[232:235], v[208:211]
    v_cvt_pk_bf16_f32 v160, v160, v161
    v_cvt_pk_bf16_f32 v161, v162, v163
    s_waitcnt vmcnt(10) lgkmcnt(0)
    s_barrier
    v_mfma_f32_16x16x32_bf16 v[208:211], v[112:115], a[248:251], v[208:211]
    s_add_u32 m0, s62, 32768
    s_xor_b32 s98, s64, 128
    ds_read_b64_tr_b16 v[32:33], v28 offset:0
    v_mfma_f32_16x16x32_bf16 v[212:215], v[52:55], a[232:235], v[212:215]
    ds_read_b64_tr_b16 v[34:35], v28 offset:512
    v_cvt_pk_bf16_f32 v162, v164, v165
    v_mfma_f32_16x16x32_bf16 v[212:215], v[116:119], a[248:251], v[212:215]
    ds_read_b64_tr_b16 v[36:37], v28 offset:4096
    v_cvt_pk_bf16_f32 v163, v166, v167
    v_mfma_f32_16x16x32_bf16 v[240:243], v[48:51], a[236:239], v[240:243]
    s_xor_b32 s79, s65, 4096
    ds_read_b64_tr_b16 v[38:39], v28 offset:4608
    v_fma_f32 v64, v64, v88, v80
    v_mfma_f32_16x16x32_bf16 v[240:243], v[112:115], a[252:255], v[240:243]
    ds_read_b64_tr_b16 v[40:41], v28 offset:8192
    v_fma_f32 v65, v65, v89, v81
    v_mfma_f32_16x16x32_bf16 v[244:247], v[52:55], a[236:239], v[244:247]
    ds_read_b64_tr_b16 v[42:43], v28 offset:8704
    v_fma_f32 v66, v66, v90, v82
    v_mfma_f32_16x16x32_bf16 v[244:247], v[116:119], a[252:255], v[244:247]
    ds_read_b64_tr_b16 v[44:45], v28 offset:12288
    v_fma_f32 v67, v67, v91, v83
    v_mfma_f32_16x16x32_bf16 v[152:155], v[56:59], a[224:227], v[152:155]
    ds_read_b64_tr_b16 v[46:47], v28 offset:12800
    v_fma_f32 v68, v68, v92, v84
    v_mfma_f32_16x16x32_bf16 v[152:155], v[120:123], a[240:243], v[152:155]
    ds_read_b64_tr_b16 v[48:49], v29 offset:0
    v_fma_f32 v69, v69, v93, v85
    v_mfma_f32_16x16x32_bf16 v[156:159], v[60:63], a[224:227], v[156:159]
    ds_read_b64_tr_b16 v[50:51], v29 offset:512
    v_fma_f32 v70, v70, v94, v86
    v_mfma_f32_16x16x32_bf16 v[156:159], v[124:127], a[240:243], v[156:159]
    ds_read_b64_tr_b16 v[52:53], v29 offset:4096
    v_fma_f32 v71, v71, v95, v87
    v_mfma_f32_16x16x32_bf16 v[184:187], v[56:59], a[228:231], v[184:187]
    ds_read_b64_tr_b16 v[54:55], v29 offset:4608
    v_cvt_pk_bf16_f32 v64, v64, v65
    v_mfma_f32_16x16x32_bf16 v[184:187], v[120:123], a[244:247], v[184:187]
    buffer_load_dwordx4 v24, s[20:23], s98 offen offset:0   lds
    v_mfma_f32_16x16x32_bf16 v[188:191], v[60:63], a[228:231], v[188:191]
    v_cvt_pk_bf16_f32 v65, v66, v67
    v_cvt_pk_bf16_f32 v66, v68, v69
    v_mfma_f32_16x16x32_bf16 v[188:191], v[124:127], a[244:247], v[188:191]
    ds_read_b128 v[80:83], v18 offset:256
    v_cvt_pk_bf16_f32 v67, v70, v71
    v_mfma_f32_16x16x32_bf16 v[216:219], v[56:59], a[232:235], v[216:219]
    buffer_store_dwordx4 v[64:67], v19, s[8:11], s71 offen offset:0 sc0 sc1
    v_mfma_f32_16x16x32_bf16 v[216:219], v[120:123], a[248:251], v[216:219]
    buffer_load_dwordx4 v25, s[20:23], s98 offen offset:1024   lds
    v_mfma_f32_16x16x32_bf16 v[220:223], v[60:63], a[232:235], v[220:223]
    ds_read_b128 v[84:87], v18 offset:272
    v_mfma_f32_16x16x32_bf16 v[220:223], v[124:127], a[248:251], v[220:223]
    ds_read_b128 v[88:91], v18 offset:768
    v_mfma_f32_16x16x32_bf16 v[248:251], v[56:59], a[236:239], v[248:251]
    ds_read_b128 v[92:95], v18 offset:784
    v_mfma_f32_16x16x32_bf16 v[248:251], v[120:123], a[252:255], v[248:251]
    buffer_load_dwordx4 v26, s[20:23], s98 offen offset:2048   lds
    v_mfma_f32_16x16x32_bf16 v[252:255], v[60:63], a[236:239], v[252:255]
    buffer_store_dwordx4 v[160:163], v1, s[8:11], s79 offen offset:0 sc0 sc1
    v_mfma_f32_16x16x32_bf16 v[252:255], v[124:127], a[252:255], v[252:255]
    s_waitcnt lgkmcnt(4)
    v_mfma_f32_16x16x32_bf16 v[96:99], a[0:3], v[32:35], 0
    ds_read_b64_tr_b16 v[56:57], v29 offset:8192
    v_cvt_pk_bf16_f32 v192, v192, v193
    v_mfma_f32_16x16x32_bf16 v[96:99], a[16:19], v[36:39], v[96:99]
    ds_read_b64_tr_b16 v[58:59], v29 offset:8704
    v_cvt_pk_bf16_f32 v193, v194, v195
    v_mfma_f32_16x16x32_bf16 v[96:99], a[32:35], v[40:43], v[96:99]
    ds_read_b64_tr_b16 v[60:61], v29 offset:12288
    s_waitcnt lgkmcnt(4)
    v_fma_f32 v72, v72, v88, v80
    v_mfma_f32_16x16x32_bf16 v[96:99], a[48:51], v[44:47], v[96:99]
    ds_read_b64_tr_b16 v[62:63], v29 offset:12800
    v_fma_f32 v73, v73, v89, v81
    v_mfma_f32_16x16x32_bf16 v[100:103], a[4:7], v[32:35], 0
    buffer_load_dwordx4 v27, s[20:23], s98 offen offset:3072   lds
    v_mfma_f32_16x16x32_bf16 v[100:103], a[20:23], v[36:39], v[100:103]
    s_add_u32 m0, s62, 36864
    s_xor_b32 s98, s64, 262272
    v_fma_f32 v74, v74, v90, v82
    v_mfma_f32_16x16x32_bf16 v[100:103], a[36:39], v[40:43], v[100:103]
    v_fma_f32 v75, v75, v91, v83
    s_waitcnt lgkmcnt(4)
    v_fma_f32 v76, v76, v92, v84
    v_mfma_f32_16x16x32_bf16 v[100:103], a[52:55], v[44:47], v[100:103]
    v_fma_f32 v77, v77, v93, v85
    v_fma_f32 v78, v78, v94, v86
    v_mfma_f32_16x16x32_bf16 v[104:107], a[8:11], v[32:35], 0
    buffer_load_dwordx4 v24, s[20:23], s98 offen offset:0   lds
    v_mfma_f32_16x16x32_bf16 v[104:107], a[24:27], v[36:39], v[104:107]
    v_fma_f32 v79, v79, v95, v87
    v_cvt_pk_bf16_f32 v194, v196, v197
    v_mfma_f32_16x16x32_bf16 v[104:107], a[40:43], v[40:43], v[104:107]
    v_cvt_pk_bf16_f32 v72, v72, v73
    v_cvt_pk_bf16_f32 v73, v74, v75
    v_mfma_f32_16x16x32_bf16 v[104:107], a[56:59], v[44:47], v[104:107]
    v_cvt_pk_bf16_f32 v74, v76, v77
    v_cvt_pk_bf16_f32 v75, v78, v79
    v_mfma_f32_16x16x32_bf16 v[108:111], a[12:15], v[32:35], 0
    buffer_load_dwordx4 v25, s[20:23], s98 offen offset:1024   lds
    v_mfma_f32_16x16x32_bf16 v[108:111], a[28:31], v[36:39], v[108:111]
    ds_read_b64_tr_b16 v[32:33], v28 offset:16384
    v_cvt_pk_bf16_f32 v195, v198, v199
    v_mfma_f32_16x16x32_bf16 v[108:111], a[44:47], v[40:43], v[108:111]
    s_xor_b32 s79, s65, 8192
    ds_read_b64_tr_b16 v[34:35], v28 offset:16896
    v_mfma_f32_16x16x32_bf16 v[108:111], a[60:63], v[44:47], v[108:111]
    ds_read_b64_tr_b16 v[36:37], v28 offset:20480
    v_mfma_f32_16x16x32_bf16 v[112:115], a[0:3], v[48:51], 0
    ds_read_b64_tr_b16 v[38:39], v28 offset:20992
    v_mfma_f32_16x16x32_bf16 v[112:115], a[16:19], v[52:55], v[112:115]
    s_waitcnt lgkmcnt(4)
    ds_read_b64_tr_b16 v[40:41], v28 offset:24576
    v_mfma_f32_16x16x32_bf16 v[112:115], a[32:35], v[56:59], v[112:115]
    ds_read_b64_tr_b16 v[42:43], v28 offset:25088
    v_mfma_f32_16x16x32_bf16 v[112:115], a[48:51], v[60:63], v[112:115]
    ds_read_b64_tr_b16 v[44:45], v28 offset:28672
    v_mfma_f32_16x16x32_bf16 v[116:119], a[4:7], v[48:51], 0
    s_lshr_b32 s100, s2, 3
    s_mul_i32 s66, s4, 28
    ds_read_b64_tr_b16 v[46:47], v28 offset:29184
    v_mfma_f32_16x16x32_bf16 v[116:119], a[20:23], v[52:55], v[116:119]
    buffer_load_dwordx4 v26, s[20:23], s98 offen offset:2048   lds
    v_mfma_f32_16x16x32_bf16 v[116:119], a[36:39], v[56:59], v[116:119]
    buffer_store_dwordx4 v[72:75], v19, s[8:11], s71 offen offset:2048 sc0 sc1
    v_mfma_f32_16x16x32_bf16 v[116:119], a[52:55], v[60:63], v[116:119]
    buffer_store_dwordx4 v[192:195], v1, s[8:11], s79 offen offset:0 sc0 sc1
    v_mfma_f32_16x16x32_bf16 v[120:123], a[8:11], v[48:51], 0
    s_add_u32 s66, s66, s100
    s_cmp_lt_u32 s100, 28
    s_cselect_b32 s66, s66, 255
    s_lshl_b32 s67, s4, 3
    v_mfma_f32_16x16x32_bf16 v[120:123], a[24:27], v[52:55], v[120:123]
    buffer_load_dwordx4 v27, s[20:23], s98 offen offset:3072   lds
    v_mfma_f32_16x16x32_bf16 v[120:123], a[40:43], v[56:59], v[120:123]
    s_add_u32 m0, s63, 131072
    s_xor_b32 s98, s0, 0
    v_cvt_pk_bf16_f32 v224, v224, v225
    v_mfma_f32_16x16x32_bf16 v[120:123], a[56:59], v[60:63], v[120:123]
    s_add_u32 s67, s67, s100
    v_cvt_pk_bf16_f32 v225, v226, v227
    v_cvt_pk_bf16_f32 v226, v228, v229
    v_mfma_f32_16x16x32_bf16 v[124:127], a[12:15], v[48:51], 0
    v_mfma_f32_16x16x32_bf16 v[124:127], a[28:31], v[52:55], v[124:127]
    s_sub_u32 s67, s67, 24
    ds_read_b64_tr_b16 v[48:49], v29 offset:16384
    v_cvt_pk_bf16_f32 v227, v230, v231
    v_mfma_f32_16x16x32_bf16 v[124:127], a[44:47], v[56:59], v[124:127]
    s_xor_b32 s79, s65, 12288
    s_cmp_ge_u32 s100, 24
    s_cselect_b32 s67, s67, 255
    ds_read_b64_tr_b16 v[50:51], v29 offset:16896
    v_mfma_f32_16x16x32_bf16 v[124:127], a[60:63], v[60:63], v[124:127]
    s_waitcnt lgkmcnt(2)
    ds_read_b64_tr_b16 v[52:53], v29 offset:20480
    v_mfma_f32_16x16x32_bf16 v[96:99], a[64:67], v[32:35], v[96:99]
    ds_read_b64_tr_b16 v[54:55], v29 offset:20992
    v_mfma_f32_16x16x32_bf16 v[96:99], a[80:83], v[36:39], v[96:99]
    ds_read_b64_tr_b16 v[56:57], v29 offset:24576
    v_mfma_f32_16x16x32_bf16 v[96:99], a[96:99], v[40:43], v[96:99]
    ds_read_b64_tr_b16 v[58:59], v29 offset:25088
    v_mfma_f32_16x16x32_bf16 v[96:99], a[112:115], v[44:47], v[96:99]
    ds_read_b64_tr_b16 v[60:61], v29 offset:28672
    v_mfma_f32_16x16x32_bf16 v[100:103], a[68:71], v[32:35], v[100:103]
    ds_read_b64_tr_b16 v[62:63], v29 offset:29184
    v_mfma_f32_16x16x32_bf16 v[100:103], a[84:87], v[36:39], v[100:103]
    buffer_load_dwordx4 v20, s[24:27], s98 offen offset:0   lds
    v_mfma_f32_16x16x32_bf16 v[100:103], a[100:103], v[40:43], v[100:103]
    buffer_store_dwordx4 v[224:227], v1, s[8:11], s79 offen offset:0 sc0 sc1
    v_mfma_f32_16x16x32_bf16 v[100:103], a[116:119], v[44:47], v[100:103]
    v_cvt_pk_bf16_f32 v136, v136, v137
    v_cvt_pk_bf16_f32 v137, v138, v139
    v_mfma_f32_16x16x32_bf16 v[104:107], a[72:75], v[32:35], v[104:107]
    v_cvt_pk_bf16_f32 v138, v140, v141
    v_cvt_pk_bf16_f32 v139, v142, v143
    v_mfma_f32_16x16x32_bf16 v[104:107], a[88:91], v[36:39], v[104:107]
    buffer_load_dwordx4 v21, s[24:27], s98 offen offset:1024   lds
    v_mfma_f32_16x16x32_bf16 v[104:107], a[104:107], v[40:43], v[104:107]
    s_xor_b32 s79, s65, 0
    v_mfma_f32_16x16x32_bf16 v[104:107], a[120:123], v[44:47], v[104:107]
    buffer_store_dwordx4 v[136:139], v1, s[8:11], s79 offen offset:1024 sc0 sc1
    v_mfma_f32_16x16x32_bf16 v[108:111], a[76:79], v[32:35], v[108:111]
    v_mfma_f32_16x16x32_bf16 v[108:111], a[92:95], v[36:39], v[108:111]
    ds_read_b64_tr_b16 v[32:33], v30 offset:0
    v_cvt_pk_bf16_f32 v168, v168, v169
    v_mfma_f32_16x16x32_bf16 v[108:111], a[108:111], v[40:43], v[108:111]
    ds_read_b64_tr_b16 v[34:35], v30 offset:512
    v_cvt_pk_bf16_f32 v169, v170, v171
    v_mfma_f32_16x16x32_bf16 v[108:111], a[124:127], v[44:47], v[108:111]
    s_waitcnt lgkmcnt(2)
    ds_read_b64_tr_b16 v[36:37], v30 offset:4096
    v_cvt_pk_bf16_f32 v170, v172, v173
    v_mfma_f32_16x16x32_bf16 v[112:115], a[64:67], v[48:51], v[112:115]
    ds_read_b64_tr_b16 v[38:39], v30 offset:4608
    v_cvt_pk_bf16_f32 v171, v174, v175
    v_mfma_f32_16x16x32_bf16 v[112:115], a[80:83], v[52:55], v[112:115]
    s_xor_b32 s79, s65, 4096
    ds_read_b64_tr_b16 v[40:41], v30 offset:8192
    v_mfma_f32_16x16x32_bf16 v[112:115], a[96:99], v[56:59], v[112:115]
    ds_read_b64_tr_b16 v[42:43], v30 offset:8704
    v_mfma_f32_16x16x32_bf16 v[112:115], a[112:115], v[60:63], v[112:115]
    ds_read_b64_tr_b16 v[44:45], v30 offset:12288
    v_mfma_f32_16x16x32_bf16 v[116:119], a[68:71], v[48:51], v[116:119]
    ds_read_b64_tr_b16 v[46:47], v30 offset:12800
    v_mfma_f32_16x16x32_bf16 v[116:119], a[84:87], v[52:55], v[116:119]
    buffer_load_dwordx4 v22, s[24:27], s98 offen offset:2048   lds
    v_mfma_f32_16x16x32_bf16 v[116:119], a[100:103], v[56:59], v[116:119]
    buffer_store_dwordx4 v[168:171], v1, s[8:11], s79 offen offset:1024 sc0 sc1
    v_mfma_f32_16x16x32_bf16 v[116:119], a[116:119], v[60:63], v[116:119]
    v_cvt_pk_bf16_f32 v200, v200, v201
    v_cvt_pk_bf16_f32 v201, v202, v203
    v_mfma_f32_16x16x32_bf16 v[120:123], a[72:75], v[48:51], v[120:123]
    v_cvt_pk_bf16_f32 v202, v204, v205
    v_cvt_pk_bf16_f32 v203, v206, v207
    v_mfma_f32_16x16x32_bf16 v[120:123], a[88:91], v[52:55], v[120:123]
    buffer_load_dwordx4 v23, s[24:27], s98 offen offset:3072   lds
    v_mfma_f32_16x16x32_bf16 v[120:123], a[104:107], v[56:59], v[120:123]
    s_add_u32 m0, s63, 98304
    s_xor_b32 s98, s0, 524288
    s_xor_b32 s79, s65, 8192
    v_mfma_f32_16x16x32_bf16 v[120:123], a[120:123], v[60:63], v[120:123]
    buffer_store_dwordx4 v[200:203], v1, s[8:11], s79 offen offset:1024 sc0 sc1
    v_mfma_f32_16x16x32_bf16 v[124:127], a[76:79], v[48:51], v[124:127]
    v_mfma_f32_16x16x32_bf16 v[124:127], a[92:95], v[52:55], v[124:127]
    ds_read_b64_tr_b16 v[48:49], v31 offset:0
    v_cvt_pk_bf16_f32 v232, v232, v233
    v_mfma_f32_16x16x32_bf16 v[124:127], a[108:111], v[56:59], v[124:127]
    ds_read_b64_tr_b16 v[50:51], v31 offset:512
    v_cvt_pk_bf16_f32 v233, v234, v235
    v_mfma_f32_16x16x32_bf16 v[124:127], a[124:127], v[60:63], v[124:127]
    s_waitcnt lgkmcnt(2)
    ds_read_b64_tr_b16 v[52:53], v31 offset:4096
    v_cvt_pk_bf16_f32 v234, v236, v237
    v_mfma_f32_16x16x32_bf16 v[64:67], a[0:3], v[32:35], 0
    ds_read_b64_tr_b16 v[54:55], v31 offset:4608
    v_cvt_pk_bf16_f32 v235, v238, v239
    v_mfma_f32_16x16x32_bf16 v[64:67], a[16:19], v[36:39], v[64:67]
    s_xor_b32 s79, s65, 12288
    ds_read_b64_tr_b16 v[56:57], v31 offset:8192
    v_mfma_f32_16x16x32_bf16 v[64:67], a[32:35], v[40:43], v[64:67]
    ds_read_b64_tr_b16 v[58:59], v31 offset:8704
    v_mfma_f32_16x16x32_bf16 v[64:67], a[48:51], v[44:47], v[64:67]
    ds_read_b64_tr_b16 v[60:61], v31 offset:12288
    v_mfma_f32_16x16x32_bf16 v[68:71], a[4:7], v[32:35], 0
    ds_read_b64_tr_b16 v[62:63], v31 offset:12800
    v_mfma_f32_16x16x32_bf16 v[68:71], a[20:23], v[36:39], v[68:71]
    buffer_load_dwordx4 v20, s[24:27], s98 offen offset:0   lds
    v_mfma_f32_16x16x32_bf16 v[68:71], a[36:39], v[40:43], v[68:71]
    buffer_store_dwordx4 v[232:235], v1, s[8:11], s79 offen offset:1024 sc0 sc1
    v_mfma_f32_16x16x32_bf16 v[68:71], a[52:55], v[44:47], v[68:71]
    v_mfma_f32_16x16x32_bf16 v[72:75], a[8:11], v[32:35], 0
    v_mfma_f32_16x16x32_bf16 v[72:75], a[24:27], v[36:39], v[72:75]
    buffer_load_dwordx4 v21, s[24:27], s98 offen offset:1024   lds
    v_mfma_f32_16x16x32_bf16 v[72:75], a[40:43], v[40:43], v[72:75]
    v_cvt_pk_bf16_f32 v144, v144, v145
    v_cvt_pk_bf16_f32 v145, v146, v147
    v_mfma_f32_16x16x32_bf16 v[72:75], a[56:59], v[44:47], v[72:75]
    v_cvt_pk_bf16_f32 v146, v148, v149
    v_cvt_pk_bf16_f32 v147, v150, v151
    v_mfma_f32_16x16x32_bf16 v[76:79], a[12:15], v[32:35], 0
    v_mfma_f32_16x16x32_bf16 v[76:79], a[28:31], v[36:39], v[76:79]
    s_xor_b32 s79, s65, 0
    ds_read_b64_tr_b16 v[32:33], v30 offset:16384
    v_mfma_f32_16x16x32_bf16 v[76:79], a[44:47], v[40:43], v[76:79]
    ds_read_b64_tr_b16 v[34:35], v30 offset:16896
    v_mfma_f32_16x16x32_bf16 v[76:79], a[60:63], v[44:47], v[76:79]
    s_waitcnt lgkmcnt(2)
    ds_read_b64_tr_b16 v[36:37], v30 offset:20480
    v_mfma_f32_16x16x32_bf16 v[80:83], a[0:3], v[48:51], 0
    ds_read_b64_tr_b16 v[38:39], v30 offset:20992
    v_mfma_f32_16x16x32_bf16 v[80:83], a[16:19], v[52:55], v[80:83]
    ds_read_b64_tr_b16 v[40:41], v30 offset:24576
    v_mfma_f32_16x16x32_bf16 v[80:83], a[32:35], v[56:59], v[80:83]
    ds_read_b64_tr_b16 v[42:43], v30 offset:25088
    v_mfma_f32_16x16x32_bf16 v[80:83], a[48:51], v[60:63], v[80:83]
    ds_read_b64_tr_b16 v[44:45], v30 offset:28672
    v_mfma_f32_16x16x32_bf16 v[84:87], a[4:7], v[48:51], 0
    ds_read_b64_tr_b16 v[46:47], v30 offset:29184
    v_mfma_f32_16x16x32_bf16 v[84:87], a[20:23], v[52:55], v[84:87]
    buffer_load_dwordx4 v22, s[24:27], s98 offen offset:2048   lds
    v_mfma_f32_16x16x32_bf16 v[84:87], a[36:39], v[56:59], v[84:87]
    buffer_store_dwordx4 v[144:147], v1, s[8:11], s79 offen offset:2048 sc0 sc1
    v_mfma_f32_16x16x32_bf16 v[84:87], a[52:55], v[60:63], v[84:87]
    v_mfma_f32_16x16x32_bf16 v[88:91], a[8:11], v[48:51], 0
    v_mfma_f32_16x16x32_bf16 v[88:91], a[24:27], v[52:55], v[88:91]
    buffer_load_dwordx4 v23, s[24:27], s98 offen offset:3072   lds
    v_mfma_f32_16x16x32_bf16 v[88:91], a[40:43], v[56:59], v[88:91]
    v_mfma_f32_16x16x32_bf16 v[88:91], a[56:59], v[60:63], v[88:91]
    v_mfma_f32_16x16x32_bf16 v[92:95], a[12:15], v[48:51], 0
    v_cvt_pk_bf16_f32 v176, v176, v177
    v_cvt_pk_bf16_f32 v177, v178, v179
    s_waitcnt vmcnt(16)
    v_mfma_f32_16x16x32_bf16 v[92:95], a[28:31], v[52:55], v[92:95]
    ds_read_b64_tr_b16 v[48:49], v31 offset:16384
    v_cvt_pk_bf16_f32 v178, v180, v181
    v_mfma_f32_16x16x32_bf16 v[92:95], a[44:47], v[56:59], v[92:95]
    ds_read_b64_tr_b16 v[50:51], v31 offset:16896
    v_cvt_pk_bf16_f32 v179, v182, v183
    v_mfma_f32_16x16x32_bf16 v[92:95], a[60:63], v[60:63], v[92:95]
    s_waitcnt lgkmcnt(2)
    s_xor_b32 s79, s65, 4096
    ds_read_b64_tr_b16 v[52:53], v31 offset:20480
    v_mfma_f32_16x16x32_bf16 v[64:67], a[64:67], v[32:35], v[64:67]
    ds_read_b64_tr_b16 v[54:55], v31 offset:20992
    v_mfma_f32_16x16x32_bf16 v[64:67], a[80:83], v[36:39], v[64:67]
    ds_read_b64_tr_b16 v[56:57], v31 offset:24576
    v_mfma_f32_16x16x32_bf16 v[64:67], a[96:99], v[40:43], v[64:67]
    ds_read_b64_tr_b16 v[58:59], v31 offset:25088
    v_mfma_f32_16x16x32_bf16 v[64:67], a[112:115], v[44:47], v[64:67]
    ds_read_b64_tr_b16 v[60:61], v31 offset:28672
    v_mfma_f32_16x16x32_bf16 v[68:71], a[68:71], v[32:35], v[68:71]
    ds_read_b64_tr_b16 v[62:63], v31 offset:29184
    v_mfma_f32_16x16x32_bf16 v[68:71], a[84:87], v[36:39], v[68:71]
    buffer_store_dword v6, v5, s[8:11], s72 offen sc0 sc1
    v_mfma_f32_16x16x32_bf16 v[68:71], a[100:103], v[40:43], v[68:71]
    buffer_store_dwordx4 v[176:179], v1, s[8:11], s79 offen offset:2048 sc0 sc1
    v_mfma_f32_16x16x32_bf16 v[68:71], a[116:119], v[44:47], v[68:71]
    v_mfma_f32_16x16x32_bf16 v[72:75], a[72:75], v[32:35], v[72:75]
    v_mfma_f32_16x16x32_bf16 v[72:75], a[88:91], v[36:39], v[72:75]
    v_mfma_f32_16x16x32_bf16 v[72:75], a[104:107], v[40:43], v[72:75]
    v_cvt_pk_bf16_f32 v208, v208, v209
    v_cvt_pk_bf16_f32 v209, v210, v211
    v_mfma_f32_16x16x32_bf16 v[72:75], a[120:123], v[44:47], v[72:75]
    v_cvt_pk_bf16_f32 v210, v212, v213
    v_cvt_pk_bf16_f32 v211, v214, v215
    v_mfma_f32_16x16x32_bf16 v[76:79], a[76:79], v[32:35], v[76:79]
    v_mfma_f32_16x16x32_bf16 v[76:79], a[92:95], v[36:39], v[76:79]
    v_mfma_f32_16x16x32_bf16 v[76:79], a[108:111], v[40:43], v[76:79]
    s_xor_b32 s79, s65, 8192
    v_xor_b32 v28, 65536, v28
    s_waitcnt lgkmcnt(0)
    s_barrier
    v_mfma_f32_16x16x32_bf16 v[76:79], a[124:127], v[44:47], v[76:79]
    s_add_u32 m0, s62, 65536
    s_xor_b32 s98, s64, 2097280
    ds_read_b64_tr_b16 v[32:33], v28 offset:0
    v_mfma_f32_16x16x32_bf16 v[80:83], a[64:67], v[48:51], v[80:83]
    ds_read_b64_tr_b16 v[34:35], v28 offset:512
    v_mfma_f32_16x16x32_bf16 v[80:83], a[80:83], v[52:55], v[80:83]
    ds_read_b64_tr_b16 v[36:37], v28 offset:4096
    v_mfma_f32_16x16x32_bf16 v[80:83], a[96:99], v[56:59], v[80:83]
    ds_read_b64_tr_b16 v[38:39], v28 offset:4608
    v_mfma_f32_16x16x32_bf16 v[80:83], a[112:115], v[60:63], v[80:83]
    ds_read_b64_tr_b16 v[40:41], v28 offset:8192
    v_mfma_f32_16x16x32_bf16 v[84:87], a[68:71], v[48:51], v[84:87]
    ds_read_b64_tr_b16 v[42:43], v28 offset:8704
    v_mfma_f32_16x16x32_bf16 v[84:87], a[84:87], v[52:55], v[84:87]
    ds_read_b64_tr_b16 v[44:45], v28 offset:12288
    v_mfma_f32_16x16x32_bf16 v[84:87], a[100:103], v[56:59], v[84:87]
    ds_read_b64_tr_b16 v[46:47], v28 offset:12800
    v_mfma_f32_16x16x32_bf16 v[84:87], a[116:119], v[60:63], v[84:87]
    buffer_load_dwordx4 v24, s[20:23], s98 offen offset:0   lds
    v_mfma_f32_16x16x32_bf16 v[88:91], a[72:75], v[48:51], v[88:91]
    buffer_store_dwordx4 v[208:211], v1, s[8:11], s79 offen offset:2048 sc0 sc1
    v_mfma_f32_16x16x32_bf16 v[88:91], a[88:91], v[52:55], v[88:91]
    v_mfma_f32_16x16x32_bf16 v[88:91], a[104:107], v[56:59], v[88:91]
    buffer_load_dwordx4 v25, s[20:23], s98 offen offset:1024   lds
    v_mfma_f32_16x16x32_bf16 v[88:91], a[120:123], v[60:63], v[88:91]
    v_mfma_f32_16x16x32_bf16 v[92:95], a[76:79], v[48:51], v[92:95]
    v_xor_b32 v29, 65536, v29
    v_cvt_pk_bf16_f32 v240, v240, v241
    v_mfma_f32_16x16x32_bf16 v[92:95], a[92:95], v[52:55], v[92:95]
    ds_read_b64_tr_b16 v[48:49], v29 offset:0
    v_cvt_pk_bf16_f32 v241, v242, v243
    v_mfma_f32_16x16x32_bf16 v[92:95], a[108:111], v[56:59], v[92:95]
    ds_read_b64_tr_b16 v[50:51], v29 offset:512
    v_cvt_pk_bf16_f32 v242, v244, v245
    v_mfma_f32_16x16x32_bf16 v[92:95], a[124:127], v[60:63], v[92:95]
    s_waitcnt lgkmcnt(3)
    ds_read_b64_tr_b16 v[52:53], v29 offset:4096
    v_cvt_pk_bf16_f32 v243, v246, v247
    v_mfma_f32_16x16x32_bf16 v[96:99], a[128:131], v[32:35], v[96:99]
    s_xor_b32 s79, s65, 12288
    ds_read_b64_tr_b16 v[54:55], v29 offset:4608
    v_mfma_f32_16x16x32_bf16 v[96:99], a[144:147], v[36:39], v[96:99]
    ds_read_b64_tr_b16 v[56:57], v29 offset:8192
    v_mfma_f32_16x16x32_bf16 v[96:99], a[160:163], v[40:43], v[96:99]
    s_waitcnt lgkmcnt(5)
    ds_read_b64_tr_b16 v[58:59], v29 offset:8704
    v_mfma_f32_16x16x32_bf16 v[96:99], a[176:179], v[44:47], v[96:99]
    ds_read_b64_tr_b16 v[60:61], v29 offset:12288
    v_mfma_f32_16x16x32_bf16 v[100:103], a[132:135], v[32:35], v[100:103]
    ds_read_b64_tr_b16 v[62:63], v29 offset:12800
    v_mfma_f32_16x16x32_bf16 v[100:103], a[148:151], v[36:39], v[100:103]
    buffer_load_dwordx4 v26, s[20:23], s98 offen offset:2048   lds
    v_mfma_f32_16x16x32_bf16 v[100:103], a[164:167], v[40:43], v[100:103]
    buffer_store_dwordx4 v[240:243], v1, s[8:11], s79 offen offset:2048 sc0 sc1
    v_mfma_f32_16x16x32_bf16 v[100:103], a[180:183], v[44:47], v[100:103]
    v_mfma_f32_16x16x32_bf16 v[104:107], a[136:139], v[32:35], v[104:107]
    buffer_load_dwordx4 v27, s[20:23], s98 offen offset:3072   lds
    v_mfma_f32_16x16x32_bf16 v[104:107], a[152:155], v[36:39], v[104:107]
    s_add_u32 m0, s62, 69632
    s_xor_b32 s98, s64, 2359424
    v_mfma_f32_16x16x32_bf16 v[104:107], a[168:171], v[40:43], v[104:107]
    v_cvt_pk_bf16_f32 v152, v152, v153
    v_cvt_pk_bf16_f32 v153, v154, v155
    v_mfma_f32_16x16x32_bf16 v[104:107], a[184:187], v[44:47], v[104:107]
    buffer_load_dwordx4 v24, s[20:23], s98 offen offset:0   lds
    v_mfma_f32_16x16x32_bf16 v[108:111], a[140:143], v[32:35], v[108:111]
    v_cvt_pk_bf16_f32 v154, v156, v157
    v_cvt_pk_bf16_f32 v155, v158, v159
    v_mfma_f32_16x16x32_bf16 v[108:111], a[156:159], v[36:39], v[108:111]
    s_xor_b32 s79, s65, 0
    ds_read_b64_tr_b16 v[32:33], v28 offset:16384
    v_mfma_f32_16x16x32_bf16 v[108:111], a[172:175], v[40:43], v[108:111]
    ds_read_b64_tr_b16 v[34:35], v28 offset:16896
    v_mfma_f32_16x16x32_bf16 v[108:111], a[188:191], v[44:47], v[108:111]
    s_waitcnt lgkmcnt(2)
    ds_read_b64_tr_b16 v[36:37], v28 offset:20480
    v_mfma_f32_16x16x32_bf16 v[112:115], a[128:131], v[48:51], v[112:115]
    ds_read_b64_tr_b16 v[38:39], v28 offset:20992
    v_mfma_f32_16x16x32_bf16 v[112:115], a[144:147], v[52:55], v[112:115]
    ds_read_b64_tr_b16 v[40:41], v28 offset:24576
    v_mfma_f32_16x16x32_bf16 v[112:115], a[160:163], v[56:59], v[112:115]
    ds_read_b64_tr_b16 v[42:43], v28 offset:25088
    v_mfma_f32_16x16x32_bf16 v[112:115], a[176:179], v[60:63], v[112:115]
    ds_read_b64_tr_b16 v[44:45], v28 offset:28672
    v_mfma_f32_16x16x32_bf16 v[116:119], a[132:135], v[48:51], v[116:119]
    ds_read_b64_tr_b16 v[46:47], v28 offset:29184
    v_mfma_f32_16x16x32_bf16 v[116:119], a[148:151], v[52:55], v[116:119]
    buffer_load_dwordx4 v25, s[20:23], s98 offen offset:1024   lds
    v_mfma_f32_16x16x32_bf16 v[116:119], a[164:167], v[56:59], v[116:119]
    buffer_store_dwordx4 v[152:155], v1, s[8:11], s79 offen offset:3072 sc0 sc1
    v_mfma_f32_16x16x32_bf16 v[116:119], a[180:183], v[60:63], v[116:119]
    v_mfma_f32_16x16x32_bf16 v[120:123], a[136:139], v[48:51], v[120:123]
    buffer_load_dwordx4 v26, s[20:23], s98 offen offset:2048   lds
    v_mfma_f32_16x16x32_bf16 v[120:123], a[152:155], v[52:55], v[120:123]
    v_mfma_f32_16x16x32_bf16 v[120:123], a[168:171], v[56:59], v[120:123]
    v_cvt_pk_bf16_f32 v184, v184, v185
    v_cvt_pk_bf16_f32 v185, v186, v187
    v_mfma_f32_16x16x32_bf16 v[120:123], a[184:187], v[60:63], v[120:123]
    buffer_load_dwordx4 v27, s[20:23], s98 offen offset:3072   lds
    v_mfma_f32_16x16x32_bf16 v[124:127], a[140:143], v[48:51], v[124:127]
    v_cvt_pk_bf16_f32 v186, v188, v189
    v_cvt_pk_bf16_f32 v187, v190, v191
    v_mfma_f32_16x16x32_bf16 v[124:127], a[156:159], v[52:55], v[124:127]
    s_add_u32 m0, s63, 114688
    s_xor_b32 s98, s0, 1048576
    ds_read_b64_tr_b16 v[48:49], v29 offset:16384
    v_mfma_f32_16x16x32_bf16 v[124:127], a[172:175], v[56:59], v[124:127]
    s_xor_b32 s79, s65, 4096
    ds_read_b64_tr_b16 v[50:51], v29 offset:16896
    v_mfma_f32_16x16x32_bf16 v[124:127], a[188:191], v[60:63], v[124:127]
    s_waitcnt lgkmcnt(2)
    ds_read_b64_tr_b16 v[52:53], v29 offset:20480
    v_mfma_f32_16x16x32_bf16 v[96:99], a[192:195], v[32:35], v[96:99]
    ds_read_b64_tr_b16 v[54:55], v29 offset:20992
    v_mfma_f32_16x16x32_bf16 v[96:99], a[208:211], v[36:39], v[96:99]
    ds_read_b64_tr_b16 v[56:57], v29 offset:24576
    v_mfma_f32_16x16x32_bf16 v[96:99], a[224:227], v[40:43], v[96:99]
    ds_read_b64_tr_b16 v[58:59], v29 offset:25088
    v_mfma_f32_16x16x32_bf16 v[96:99], a[240:243], v[44:47], v[96:99]
    ds_read_b64_tr_b16 v[60:61], v29 offset:28672
    v_mfma_f32_16x16x32_bf16 v[100:103], a[196:199], v[32:35], v[100:103]
    ds_read_b64_tr_b16 v[62:63], v29 offset:29184
    v_mfma_f32_16x16x32_bf16 v[100:103], a[212:215], v[36:39], v[100:103]
    buffer_load_dwordx4 v20, s[24:27], s98 offen offset:0   lds
    v_mfma_f32_16x16x32_bf16 v[100:103], a[228:231], v[40:43], v[100:103]
    buffer_store_dwordx4 v[184:187], v1, s[8:11], s79 offen offset:3072 sc0 sc1
    v_mfma_f32_16x16x32_bf16 v[100:103], a[244:247], v[44:47], v[100:103]
    v_mfma_f32_16x16x32_bf16 v[104:107], a[200:203], v[32:35], v[104:107]
    buffer_load_dwordx4 v21, s[24:27], s98 offen offset:1024   lds
    v_mfma_f32_16x16x32_bf16 v[104:107], a[216:219], v[36:39], v[104:107]
    v_mfma_f32_16x16x32_bf16 v[104:107], a[232:235], v[40:43], v[104:107]
    v_mfma_f32_16x16x32_bf16 v[104:107], a[248:251], v[44:47], v[104:107]
    buffer_load_dwordx4 v22, s[24:27], s98 offen offset:2048   lds
    v_mfma_f32_16x16x32_bf16 v[108:111], a[204:207], v[32:35], v[108:111]
    v_xor_b32 v30, 65536, v30
    v_cvt_pk_bf16_f32 v216, v216, v217
    v_mfma_f32_16x16x32_bf16 v[108:111], a[220:223], v[36:39], v[108:111]
    ds_read_b64_tr_b16 v[32:33], v30 offset:0
    v_cvt_pk_bf16_f32 v217, v218, v219
    v_mfma_f32_16x16x32_bf16 v[108:111], a[236:239], v[40:43], v[108:111]
    ds_read_b64_tr_b16 v[34:35], v30 offset:512
    v_cvt_pk_bf16_f32 v218, v220, v221
    v_mfma_f32_16x16x32_bf16 v[108:111], a[252:255], v[44:47], v[108:111]
    s_waitcnt lgkmcnt(2)
    ds_read_b64_tr_b16 v[36:37], v30 offset:4096
    v_cvt_pk_bf16_f32 v219, v222, v223
    v_mfma_f32_16x16x32_bf16 v[112:115], a[192:195], v[48:51], v[112:115]
    s_xor_b32 s79, s65, 8192
    ds_read_b64_tr_b16 v[38:39], v30 offset:4608
    v_mfma_f32_16x16x32_bf16 v[112:115], a[208:211], v[52:55], v[112:115]
    ds_read_b64_tr_b16 v[40:41], v30 offset:8192
    v_mfma_f32_16x16x32_bf16 v[112:115], a[224:227], v[56:59], v[112:115]
    ds_read_b64_tr_b16 v[42:43], v30 offset:8704
    v_mfma_f32_16x16x32_bf16 v[112:115], a[240:243], v[60:63], v[112:115]
    ds_read_b64_tr_b16 v[44:45], v30 offset:12288
    v_mfma_f32_16x16x32_bf16 v[116:119], a[196:199], v[48:51], v[116:119]
    ds_read_b64_tr_b16 v[46:47], v30 offset:12800
    v_mfma_f32_16x16x32_bf16 v[116:119], a[212:215], v[52:55], v[116:119]
    buffer_load_dwordx4 v23, s[24:27], s98 offen offset:3072   lds
    v_mfma_f32_16x16x32_bf16 v[116:119], a[228:231], v[56:59], v[116:119]
    s_add_u32 m0, s63, 147456
    s_xor_b32 s98, s0, 1572864
    v_mfma_f32_16x16x32_bf16 v[116:119], a[244:247], v[60:63], v[116:119]
    buffer_store_dwordx4 v[216:219], v1, s[8:11], s79 offen offset:3072 sc0 sc1
    v_mfma_f32_16x16x32_bf16 v[120:123], a[200:203], v[48:51], v[120:123]
    buffer_load_dwordx4 v20, s[24:27], s98 offen offset:0   lds
    v_mfma_f32_16x16x32_bf16 v[120:123], a[216:219], v[52:55], v[120:123]
    v_mfma_f32_16x16x32_bf16 v[120:123], a[232:235], v[56:59], v[120:123]
    v_mfma_f32_16x16x32_bf16 v[120:123], a[248:251], v[60:63], v[120:123]
    buffer_load_dwordx4 v21, s[24:27], s98 offen offset:1024   lds
    v_mfma_f32_16x16x32_bf16 v[124:127], a[204:207], v[48:51], v[124:127]
    v_xor_b32 v31, 65536, v31
    v_mfma_f32_16x16x32_bf16 v[124:127], a[220:223], v[52:55], v[124:127]
    ds_read_b64_tr_b16 v[48:49], v31 offset:0
    v_mfma_f32_16x16x32_bf16 v[124:127], a[236:239], v[56:59], v[124:127]
    ds_read_b64_tr_b16 v[50:51], v31 offset:512
    v_mfma_f32_16x16x32_bf16 v[124:127], a[252:255], v[60:63], v[124:127]
    s_waitcnt lgkmcnt(2)
    ds_read_b64_tr_b16 v[52:53], v31 offset:4096
    v_mfma_f32_16x16x32_bf16 v[64:67], a[128:131], v[32:35], v[64:67]
    ds_read_b64_tr_b16 v[54:55], v31 offset:4608
    v_mfma_f32_16x16x32_bf16 v[64:67], a[144:147], v[36:39], v[64:67]
    ds_read_b64_tr_b16 v[56:57], v31 offset:8192
    v_mfma_f32_16x16x32_bf16 v[64:67], a[160:163], v[40:43], v[64:67]
    ds_read_b64_tr_b16 v[58:59], v31 offset:8704
    v_mfma_f32_16x16x32_bf16 v[64:67], a[176:179], v[44:47], v[64:67]
    ds_read_b64_tr_b16 v[60:61], v31 offset:12288
    v_mfma_f32_16x16x32_bf16 v[68:71], a[132:135], v[32:35], v[68:71]
    ds_read_b64_tr_b16 v[62:63], v31 offset:12800
    v_mfma_f32_16x16x32_bf16 v[68:71], a[148:151], v[36:39], v[68:71]
    buffer_load_dwordx4 v22, s[24:27], s98 offen offset:2048   lds
    v_mfma_f32_16x16x32_bf16 v[68:71], a[164:167], v[40:43], v[68:71]
    v_cvt_pk_bf16_f32 v96, v96, v97
    v_cvt_pk_bf16_f32 v97, v98, v99
    v_mfma_f32_16x16x32_bf16 v[68:71], a[180:183], v[44:47], v[68:71]
    v_cvt_pk_bf16_f32 v98, v100, v101
    v_cvt_pk_bf16_f32 v99, v102, v103
    v_mfma_f32_16x16x32_bf16 v[72:75], a[136:139], v[32:35], v[72:75]
    buffer_load_dwordx4 v23, s[24:27], s98 offen offset:3072   lds
    v_mfma_f32_16x16x32_bf16 v[72:75], a[152:155], v[36:39], v[72:75]
    s_xor_b32 s79, s1, 32768
    v_mfma_f32_16x16x32_bf16 v[72:75], a[168:171], v[40:43], v[72:75]
    buffer_store_dwordx4 v[96:99], v1, s[8:11], s79 offen offset:0 sc0 sc1
    v_mfma_f32_16x16x32_bf16 v[72:75], a[184:187], v[44:47], v[72:75]
    v_mfma_f32_16x16x32_bf16 v[76:79], a[140:143], v[32:35], v[76:79]
    v_mfma_f32_16x16x32_bf16 v[76:79], a[156:159], v[36:39], v[76:79]
    ds_read_b64_tr_b16 v[32:33], v30 offset:16384
    v_mfma_f32_16x16x32_bf16 v[76:79], a[172:175], v[40:43], v[76:79]
    ds_read_b64_tr_b16 v[34:35], v30 offset:16896
    v_mfma_f32_16x16x32_bf16 v[76:79], a[188:191], v[44:47], v[76:79]
    s_waitcnt lgkmcnt(2)
    ds_read_b64_tr_b16 v[36:37], v30 offset:20480
    v_mfma_f32_16x16x32_bf16 v[80:83], a[128:131], v[48:51], v[80:83]
    ds_read_b64_tr_b16 v[38:39], v30 offset:20992
    v_mfma_f32_16x16x32_bf16 v[80:83], a[144:147], v[52:55], v[80:83]
    ds_read_b64_tr_b16 v[40:41], v30 offset:24576
    v_mfma_f32_16x16x32_bf16 v[80:83], a[160:163], v[56:59], v[80:83]
    ds_read_b64_tr_b16 v[42:43], v30 offset:25088
    v_mfma_f32_16x16x32_bf16 v[80:83], a[176:179], v[60:63], v[80:83]
    ds_read_b64_tr_b16 v[44:45], v30 offset:28672
    v_mfma_f32_16x16x32_bf16 v[84:87], a[132:135], v[48:51], v[84:87]
    ds_read_b64_tr_b16 v[46:47], v30 offset:29184
    v_cvt_pk_bf16_f32 v104, v104, v105
    v_mfma_f32_16x16x32_bf16 v[84:87], a[148:151], v[52:55], v[84:87]
    v_cvt_pk_bf16_f32 v105, v106, v107
    v_cvt_pk_bf16_f32 v106, v108, v109
    v_mfma_f32_16x16x32_bf16 v[84:87], a[164:167], v[56:59], v[84:87]
    v_cvt_pk_bf16_f32 v107, v110, v111
    v_mfma_f32_16x16x32_bf16 v[84:87], a[180:183], v[60:63], v[84:87]
    s_xor_b32 s79, s1, 40960
    v_mfma_f32_16x16x32_bf16 v[88:91], a[136:139], v[48:51], v[88:91]
    buffer_store_dwordx4 v[104:107], v1, s[8:11], s79 offen offset:0 sc0 sc1
    v_mfma_f32_16x16x32_bf16 v[88:91], a[152:155], v[52:55], v[88:91]
    v_mfma_f32_16x16x32_bf16 v[88:91], a[168:171], v[56:59], v[88:91]
    v_mfma_f32_16x16x32_bf16 v[88:91], a[184:187], v[60:63], v[88:91]
    v_mfma_f32_16x16x32_bf16 v[92:95], a[140:143], v[48:51], v[92:95]
    v_mfma_f32_16x16x32_bf16 v[92:95], a[156:159], v[52:55], v[92:95]
    ds_read_b64_tr_b16 v[48:49], v31 offset:16384
    v_mfma_f32_16x16x32_bf16 v[92:95], a[172:175], v[56:59], v[92:95]
    ds_read_b64_tr_b16 v[50:51], v31 offset:16896
    v_mfma_f32_16x16x32_bf16 v[92:95], a[188:191], v[60:63], v[92:95]
    s_waitcnt lgkmcnt(2)
    ds_read_b64_tr_b16 v[52:53], v31 offset:20480
    v_mfma_f32_16x16x32_bf16 v[64:67], a[192:195], v[32:35], v[64:67]
    ds_read_b64_tr_b16 v[54:55], v31 offset:20992
    v_mfma_f32_16x16x32_bf16 v[64:67], a[208:211], v[36:39], v[64:67]
    ds_read_b64_tr_b16 v[56:57], v31 offset:24576
    v_mfma_f32_16x16x32_bf16 v[64:67], a[224:227], v[40:43], v[64:67]
    ds_read_b64_tr_b16 v[58:59], v31 offset:25088
    v_cvt_pk_bf16_f32 v112, v112, v113
    v_mfma_f32_16x16x32_bf16 v[64:67], a[240:243], v[44:47], v[64:67]
    ds_read_b64_tr_b16 v[60:61], v31 offset:28672
    v_cvt_pk_bf16_f32 v113, v114, v115
    v_mfma_f32_16x16x32_bf16 v[68:71], a[196:199], v[32:35], v[68:71]
    ds_read_b64_tr_b16 v[62:63], v31 offset:29184
    v_cvt_pk_bf16_f32 v114, v116, v117
    v_mfma_f32_16x16x32_bf16 v[68:71], a[212:215], v[36:39], v[68:71]
    v_cvt_pk_bf16_f32 v115, v118, v119
    v_mfma_f32_16x16x32_bf16 v[68:71], a[228:231], v[40:43], v[68:71]
    s_xor_b32 s79, s1, 32768
    v_mfma_f32_16x16x32_bf16 v[68:71], a[244:247], v[44:47], v[68:71]
    buffer_store_dwordx4 v[112:115], v1, s[8:11], s79 offen offset:1024 sc0 sc1
    v_mfma_f32_16x16x32_bf16 v[72:75], a[200:203], v[32:35], v[72:75]
    v_mfma_f32_16x16x32_bf16 v[72:75], a[216:219], v[36:39], v[72:75]
    v_mfma_f32_16x16x32_bf16 v[72:75], a[232:235], v[40:43], v[72:75]
    v_mfma_f32_16x16x32_bf16 v[72:75], a[248:251], v[44:47], v[72:75]
    v_mfma_f32_16x16x32_bf16 v[76:79], a[204:207], v[32:35], v[76:79]
    v_mfma_f32_16x16x32_bf16 v[76:79], a[220:223], v[36:39], v[76:79]
    v_mfma_f32_16x16x32_bf16 v[76:79], a[236:239], v[40:43], v[76:79]
    s_waitcnt vmcnt(40) lgkmcnt(0)
    s_barrier
    v_mfma_f32_16x16x32_bf16 v[76:79], a[252:255], v[44:47], v[76:79]
    s_add_u32 m0, s63, 0
    s_xor_b32 s98, s0, 2097152
    ds_read_b64_tr_b16 v[32:33], v28 offset:32768
    v_mfma_f32_16x16x32_bf16 v[80:83], a[192:195], v[48:51], v[80:83]
    ds_read_b64_tr_b16 v[34:35], v28 offset:33280
    v_cvt_pk_bf16_f32 v120, v120, v121
    v_mfma_f32_16x16x32_bf16 v[80:83], a[208:211], v[52:55], v[80:83]
    ds_read_b64_tr_b16 v[36:37], v28 offset:36864
    v_cvt_pk_bf16_f32 v121, v122, v123
    v_mfma_f32_16x16x32_bf16 v[80:83], a[224:227], v[56:59], v[80:83]
    ds_read_b64_tr_b16 v[38:39], v28 offset:37376
    v_cvt_pk_bf16_f32 v122, v124, v125
    v_mfma_f32_16x16x32_bf16 v[80:83], a[240:243], v[60:63], v[80:83]
    ds_read_b64_tr_b16 v[40:41], v28 offset:40960
    v_cvt_pk_bf16_f32 v123, v126, v127
    v_mfma_f32_16x16x32_bf16 v[84:87], a[196:199], v[48:51], v[84:87]
    s_xor_b32 s79, s1, 40960
    ds_read_b64_tr_b16 v[42:43], v28 offset:41472
    v_mfma_f32_16x16x32_bf16 v[84:87], a[212:215], v[52:55], v[84:87]
    ds_read_b64_tr_b16 v[44:45], v28 offset:45056
    v_mfma_f32_16x16x32_bf16 v[84:87], a[228:231], v[56:59], v[84:87]
    ds_read_b64_tr_b16 v[46:47], v28 offset:45568
    v_mfma_f32_16x16x32_bf16 v[84:87], a[244:247], v[60:63], v[84:87]
    buffer_load_dwordx4 v20, s[24:27], s98 offen offset:0   lds
    v_mfma_f32_16x16x32_bf16 v[88:91], a[200:203], v[48:51], v[88:91]
    buffer_store_dwordx4 v[120:123], v1, s[8:11], s79 offen offset:1024 sc0 sc1
    v_mfma_f32_16x16x32_bf16 v[88:91], a[216:219], v[52:55], v[88:91]
    v_mfma_f32_16x16x32_bf16 v[88:91], a[232:235], v[56:59], v[88:91]
    v_mfma_f32_16x16x32_bf16 v[88:91], a[248:251], v[60:63], v[88:91]
    v_mfma_f32_16x16x32_bf16 v[92:95], a[204:207], v[48:51], v[92:95]
    v_mfma_f32_16x16x32_bf16 v[92:95], a[220:223], v[52:55], v[92:95]
    ds_read_b64_tr_b16 v[48:49], v29 offset:32768
    v_mfma_f32_16x16x32_bf16 v[92:95], a[236:239], v[56:59], v[92:95]
    ds_read_b64_tr_b16 v[50:51], v29 offset:33280
    v_mfma_f32_16x16x32_bf16 v[92:95], a[252:255], v[60:63], v[92:95]
    s_waitcnt lgkmcnt(3)
    ds_read_b64_tr_b16 v[52:53], v29 offset:36864
    v_mfma_f32_16x16x32_bf16 v[96:99], a[0:3], v[32:35], 0
    ds_read_b64_tr_b16 v[54:55], v29 offset:37376
    v_mfma_f32_16x16x32_bf16 v[96:99], a[16:19], v[36:39], v[96:99]
    ds_read_b64_tr_b16 v[56:57], v29 offset:40960
    v_mfma_f32_16x16x32_bf16 v[96:99], a[32:35], v[40:43], v[96:99]
    s_waitcnt lgkmcnt(5)
    ds_read_b64_tr_b16 v[58:59], v29 offset:41472
    v_mfma_f32_16x16x32_bf16 v[96:99], a[48:51], v[44:47], v[96:99]
    ds_read_b64_tr_b16 v[60:61], v29 offset:45056
    v_mfma_f32_16x16x32_bf16 v[100:103], a[4:7], v[32:35], 0
    ds_read_b64_tr_b16 v[62:63], v29 offset:45568
    v_mfma_f32_16x16x32_bf16 v[100:103], a[20:23], v[36:39], v[100:103]
    buffer_load_dwordx4 v21, s[24:27], s98 offen offset:1024   lds
    v_mfma_f32_16x16x32_bf16 v[100:103], a[36:39], v[40:43], v[100:103]
    v_cvt_pk_bf16_f32 v64, v64, v65
    v_cvt_pk_bf16_f32 v65, v66, v67
    v_mfma_f32_16x16x32_bf16 v[100:103], a[52:55], v[44:47], v[100:103]
    v_cvt_pk_bf16_f32 v66, v68, v69
    v_cvt_pk_bf16_f32 v67, v70, v71
    v_mfma_f32_16x16x32_bf16 v[104:107], a[8:11], v[32:35], 0
    s_xor_b32 s79, s1, 32768
    v_mfma_f32_16x16x32_bf16 v[104:107], a[24:27], v[36:39], v[104:107]
    buffer_store_dwordx4 v[64:67], v1, s[8:11], s79 offen offset:2048 sc0 sc1
    v_mfma_f32_16x16x32_bf16 v[104:107], a[40:43], v[40:43], v[104:107]
    v_mfma_f32_16x16x32_bf16 v[104:107], a[56:59], v[44:47], v[104:107]
    buffer_load_dwordx4 v22, s[24:27], s98 offen offset:2048   lds
    v_mfma_f32_16x16x32_bf16 v[108:111], a[12:15], v[32:35], 0
    v_mfma_f32_16x16x32_bf16 v[108:111], a[28:31], v[36:39], v[108:111]
    ds_read_b64_tr_b16 v[32:33], v28 offset:49152
    v_mfma_f32_16x16x32_bf16 v[108:111], a[44:47], v[40:43], v[108:111]
    ds_read_b64_tr_b16 v[34:35], v28 offset:49664
    v_mfma_f32_16x16x32_bf16 v[108:111], a[60:63], v[44:47], v[108:111]
    s_waitcnt lgkmcnt(2)
    ds_read_b64_tr_b16 v[36:37], v28 offset:53248
    v_mfma_f32_16x16x32_bf16 v[112:115], a[0:3], v[48:51], 0
    ds_read_b64_tr_b16 v[38:39], v28 offset:53760
    v_mfma_f32_16x16x32_bf16 v[112:115], a[16:19], v[52:55], v[112:115]
    ds_read_b64_tr_b16 v[40:41], v28 offset:57344
    v_mfma_f32_16x16x32_bf16 v[112:115], a[32:35], v[56:59], v[112:115]
    ds_read_b64_tr_b16 v[42:43], v28 offset:57856
    v_mfma_f32_16x16x32_bf16 v[112:115], a[48:51], v[60:63], v[112:115]
    ds_read_b64_tr_b16 v[44:45], v28 offset:61440
    v_mfma_f32_16x16x32_bf16 v[116:119], a[4:7], v[48:51], 0
    ds_read_b64_tr_b16 v[46:47], v28 offset:61952
    v_cvt_pk_bf16_f32 v72, v72, v73
    v_mfma_f32_16x16x32_bf16 v[116:119], a[20:23], v[52:55], v[116:119]
    buffer_load_dwordx4 v23, s[24:27], s98 offen offset:3072   lds
    v_mfma_f32_16x16x32_bf16 v[116:119], a[36:39], v[56:59], v[116:119]
    s_add_u32 m0, s63, 16384
    s_xor_b32 s98, s0, 2621440
    v_cvt_pk_bf16_f32 v73, v74, v75
    v_mfma_f32_16x16x32_bf16 v[116:119], a[52:55], v[60:63], v[116:119]
    v_cvt_pk_bf16_f32 v74, v76, v77
    v_cvt_pk_bf16_f32 v75, v78, v79
    v_mfma_f32_16x16x32_bf16 v[120:123], a[8:11], v[48:51], 0
    s_xor_b32 s79, s1, 40960
    v_mfma_f32_16x16x32_bf16 v[120:123], a[24:27], v[52:55], v[120:123]
    buffer_store_dwordx4 v[72:75], v1, s[8:11], s79 offen offset:2048 sc0 sc1
    v_mfma_f32_16x16x32_bf16 v[120:123], a[40:43], v[56:59], v[120:123]
    v_mfma_f32_16x16x32_bf16 v[120:123], a[56:59], v[60:63], v[120:123]
    buffer_load_dwordx4 v20, s[24:27], s98 offen offset:0   lds
    v_mfma_f32_16x16x32_bf16 v[124:127], a[12:15], v[48:51], 0
    v_mfma_f32_16x16x32_bf16 v[124:127], a[28:31], v[52:55], v[124:127]
    ds_read_b64_tr_b16 v[48:49], v29 offset:49152
    v_mfma_f32_16x16x32_bf16 v[124:127], a[44:47], v[56:59], v[124:127]
    ds_read_b64_tr_b16 v[50:51], v29 offset:49664
    v_mfma_f32_16x16x32_bf16 v[124:127], a[60:63], v[60:63], v[124:127]
    s_waitcnt lgkmcnt(2)
    ds_read_b64_tr_b16 v[52:53], v29 offset:53248
    v_mfma_f32_16x16x32_bf16 v[96:99], a[64:67], v[32:35], v[96:99]
    ds_read_b64_tr_b16 v[54:55], v29 offset:53760
    v_mfma_f32_16x16x32_bf16 v[96:99], a[80:83], v[36:39], v[96:99]
    ds_read_b64_tr_b16 v[56:57], v29 offset:57344
    v_mfma_f32_16x16x32_bf16 v[96:99], a[96:99], v[40:43], v[96:99]
    ds_read_b64_tr_b16 v[58:59], v29 offset:57856
    v_cvt_pk_bf16_f32 v80, v80, v81
    v_mfma_f32_16x16x32_bf16 v[96:99], a[112:115], v[44:47], v[96:99]
    ds_read_b64_tr_b16 v[60:61], v29 offset:61440
    v_cvt_pk_bf16_f32 v81, v82, v83
    v_mfma_f32_16x16x32_bf16 v[100:103], a[68:71], v[32:35], v[100:103]
    ds_read_b64_tr_b16 v[62:63], v29 offset:61952
    v_cvt_pk_bf16_f32 v82, v84, v85
    v_mfma_f32_16x16x32_bf16 v[100:103], a[84:87], v[36:39], v[100:103]
    buffer_load_dwordx4 v21, s[24:27], s98 offen offset:1024   lds
    v_mfma_f32_16x16x32_bf16 v[100:103], a[100:103], v[40:43], v[100:103]
    v_cvt_pk_bf16_f32 v83, v86, v87
    v_mfma_f32_16x16x32_bf16 v[100:103], a[116:119], v[44:47], v[100:103]
    s_xor_b32 s79, s1, 32768
    v_mfma_f32_16x16x32_bf16 v[104:107], a[72:75], v[32:35], v[104:107]
    buffer_store_dwordx4 v[80:83], v1, s[8:11], s79 offen offset:3072 sc0 sc1
    v_mfma_f32_16x16x32_bf16 v[104:107], a[88:91], v[36:39], v[104:107]
    v_mfma_f32_16x16x32_bf16 v[104:107], a[104:107], v[40:43], v[104:107]
    v_mfma_f32_16x16x32_bf16 v[104:107], a[120:123], v[44:47], v[104:107]
    buffer_load_dwordx4 v22, s[24:27], s98 offen offset:2048   lds
    v_mfma_f32_16x16x32_bf16 v[108:111], a[76:79], v[32:35], v[108:111]
    v_mfma_f32_16x16x32_bf16 v[108:111], a[92:95], v[36:39], v[108:111]
    ds_read_b64_tr_b16 v[32:33], v30 offset:32768
    v_mfma_f32_16x16x32_bf16 v[108:111], a[108:111], v[40:43], v[108:111]
    ds_read_b64_tr_b16 v[34:35], v30 offset:33280
    v_mfma_f32_16x16x32_bf16 v[108:111], a[124:127], v[44:47], v[108:111]
    s_waitcnt lgkmcnt(2)
    ds_read_b64_tr_b16 v[36:37], v30 offset:36864
    v_mfma_f32_16x16x32_bf16 v[112:115], a[64:67], v[48:51], v[112:115]
    ds_read_b64_tr_b16 v[38:39], v30 offset:37376
    v_cvt_pk_bf16_f32 v88, v88, v89
    v_mfma_f32_16x16x32_bf16 v[112:115], a[80:83], v[52:55], v[112:115]
    ds_read_b64_tr_b16 v[40:41], v30 offset:40960
    v_cvt_pk_bf16_f32 v89, v90, v91
    v_mfma_f32_16x16x32_bf16 v[112:115], a[96:99], v[56:59], v[112:115]
    ds_read_b64_tr_b16 v[42:43], v30 offset:41472
    v_cvt_pk_bf16_f32 v90, v92, v93
    v_mfma_f32_16x16x32_bf16 v[112:115], a[112:115], v[60:63], v[112:115]
    ds_read_b64_tr_b16 v[44:45], v30 offset:45056
    v_cvt_pk_bf16_f32 v91, v94, v95
    v_mfma_f32_16x16x32_bf16 v[116:119], a[68:71], v[48:51], v[116:119]
    s_xor_b32 s79, s1, 40960
    ds_read_b64_tr_b16 v[46:47], v30 offset:45568
    v_mfma_f32_16x16x32_bf16 v[116:119], a[84:87], v[52:55], v[116:119]
    buffer_load_dwordx4 v23, s[24:27], s98 offen offset:3072   lds
    v_mfma_f32_16x16x32_bf16 v[116:119], a[100:103], v[56:59], v[116:119]
    buffer_store_dwordx4 v[88:91], v1, s[8:11], s79 offen offset:3072 sc0 sc1
    v_mfma_f32_16x16x32_bf16 v[116:119], a[116:119], v[60:63], v[116:119]
    v_mfma_f32_16x16x32_bf16 v[120:123], a[72:75], v[48:51], v[120:123]
    v_mfma_f32_16x16x32_bf16 v[120:123], a[88:91], v[52:55], v[120:123]
    v_mfma_f32_16x16x32_bf16 v[120:123], a[104:107], v[56:59], v[120:123]
    v_mfma_f32_16x16x32_bf16 v[120:123], a[120:123], v[60:63], v[120:123]
    v_mfma_f32_16x16x32_bf16 v[124:127], a[76:79], v[48:51], v[124:127]
    v_mfma_f32_16x16x32_bf16 v[124:127], a[92:95], v[52:55], v[124:127]
    ds_read_b64_tr_b16 v[48:49], v31 offset:32768
    v_mfma_f32_16x16x32_bf16 v[124:127], a[108:111], v[56:59], v[124:127]
    ds_read_b64_tr_b16 v[50:51], v31 offset:33280
    v_mfma_f32_16x16x32_bf16 v[124:127], a[124:127], v[60:63], v[124:127]
    s_waitcnt lgkmcnt(2)
    ds_read_b64_tr_b16 v[52:53], v31 offset:36864
    v_mfma_f32_16x16x32_bf16 v[64:67], a[0:3], v[32:35], 0
    ds_read_b64_tr_b16 v[54:55], v31 offset:37376
    v_mfma_f32_16x16x32_bf16 v[64:67], a[16:19], v[36:39], v[64:67]
    ds_read_b64_tr_b16 v[56:57], v31 offset:40960
    v_mfma_f32_16x16x32_bf16 v[64:67], a[32:35], v[40:43], v[64:67]
    ds_read_b64_tr_b16 v[58:59], v31 offset:41472
    v_mfma_f32_16x16x32_bf16 v[64:67], a[48:51], v[44:47], v[64:67]
    ds_read_b64_tr_b16 v[60:61], v31 offset:45056
    v_mfma_f32_16x16x32_bf16 v[68:71], a[4:7], v[32:35], 0
    ds_read_b64_tr_b16 v[62:63], v31 offset:45568
    v_mfma_f32_16x16x32_bf16 v[68:71], a[20:23], v[36:39], v[68:71]
    v_mfma_f32_16x16x32_bf16 v[68:71], a[36:39], v[40:43], v[68:71]
    v_mfma_f32_16x16x32_bf16 v[68:71], a[52:55], v[44:47], v[68:71]
    v_mfma_f32_16x16x32_bf16 v[72:75], a[8:11], v[32:35], 0
    v_mfma_f32_16x16x32_bf16 v[72:75], a[24:27], v[36:39], v[72:75]
    v_mfma_f32_16x16x32_bf16 v[72:75], a[40:43], v[40:43], v[72:75]
    v_cvt_pk_bf16_f32 v248, v248, v249
    v_cvt_pk_bf16_f32 v249, v250, v251
    v_mfma_f32_16x16x32_bf16 v[72:75], a[56:59], v[44:47], v[72:75]
    v_cvt_pk_bf16_f32 v250, v252, v253
    v_cvt_pk_bf16_f32 v251, v254, v255
    v_mfma_f32_16x16x32_bf16 v[76:79], a[12:15], v[32:35], 0
    v_mfma_f32_16x16x32_bf16 v[76:79], a[28:31], v[36:39], v[76:79]
    s_xor_b32 s79, s65, 12288
    ds_read_b64_tr_b16 v[32:33], v30 offset:49152
    v_mfma_f32_16x16x32_bf16 v[76:79], a[44:47], v[40:43], v[76:79]
    ds_read_b64_tr_b16 v[34:35], v30 offset:49664
    v_mfma_f32_16x16x32_bf16 v[76:79], a[60:63], v[44:47], v[76:79]
    s_waitcnt lgkmcnt(2)
    ds_read_b64_tr_b16 v[36:37], v30 offset:53248
    v_mfma_f32_16x16x32_bf16 v[80:83], a[0:3], v[48:51], 0
    ds_read_b64_tr_b16 v[38:39], v30 offset:53760
    v_mfma_f32_16x16x32_bf16 v[80:83], a[16:19], v[52:55], v[80:83]
    ds_read_b64_tr_b16 v[40:41], v30 offset:57344
    v_mfma_f32_16x16x32_bf16 v[80:83], a[32:35], v[56:59], v[80:83]
    ds_read_b64_tr_b16 v[42:43], v30 offset:57856
    v_mfma_f32_16x16x32_bf16 v[80:83], a[48:51], v[60:63], v[80:83]
    ds_read_b64_tr_b16 v[44:45], v30 offset:61440
    v_mfma_f32_16x16x32_bf16 v[84:87], a[4:7], v[48:51], 0
    ds_read_b64_tr_b16 v[46:47], v30 offset:61952
    v_mfma_f32_16x16x32_bf16 v[84:87], a[20:23], v[52:55], v[84:87]
    buffer_store_dwordx4 v[248:251], v1, s[8:11], s79 offen offset:3072 sc0 sc1
    v_mfma_f32_16x16x32_bf16 v[84:87], a[36:39], v[56:59], v[84:87]
    buffer_load_dword v3, v16, s[8:11], s78 offen sc0 sc1
    v_mfma_f32_16x16x32_bf16 v[84:87], a[52:55], v[60:63], v[84:87]
    v_mfma_f32_16x16x32_bf16 v[88:91], a[8:11], v[48:51], 0
    v_mfma_f32_16x16x32_bf16 v[88:91], a[24:27], v[52:55], v[88:91]
    v_mfma_f32_16x16x32_bf16 v[88:91], a[40:43], v[56:59], v[88:91]
    v_mfma_f32_16x16x32_bf16 v[88:91], a[56:59], v[60:63], v[88:91]
    v_mfma_f32_16x16x32_bf16 v[92:95], a[12:15], v[48:51], 0
    v_mfma_f32_16x16x32_bf16 v[92:95], a[28:31], v[52:55], v[92:95]
    ds_read_b64_tr_b16 v[48:49], v31 offset:49152
    v_mfma_f32_16x16x32_bf16 v[92:95], a[44:47], v[56:59], v[92:95]
    ds_read_b64_tr_b16 v[50:51], v31 offset:49664
    v_mfma_f32_16x16x32_bf16 v[92:95], a[60:63], v[60:63], v[92:95]
    s_waitcnt lgkmcnt(2)
    ds_read_b64_tr_b16 v[52:53], v31 offset:53248
    v_mfma_f32_16x16x32_bf16 v[64:67], a[64:67], v[32:35], v[64:67]
    ds_read_b64_tr_b16 v[54:55], v31 offset:53760
    v_mfma_f32_16x16x32_bf16 v[64:67], a[80:83], v[36:39], v[64:67]
    ds_read_b64_tr_b16 v[56:57], v31 offset:57344
    v_mfma_f32_16x16x32_bf16 v[64:67], a[96:99], v[40:43], v[64:67]
    ds_read_b64_tr_b16 v[58:59], v31 offset:57856
    v_mfma_f32_16x16x32_bf16 v[64:67], a[112:115], v[44:47], v[64:67]
    ds_read_b64_tr_b16 v[60:61], v31 offset:61440
    v_mfma_f32_16x16x32_bf16 v[68:71], a[68:71], v[32:35], v[68:71]
    ds_read_b64_tr_b16 v[62:63], v31 offset:61952
    v_mfma_f32_16x16x32_bf16 v[68:71], a[84:87], v[36:39], v[68:71]
    v_mfma_f32_16x16x32_bf16 v[68:71], a[100:103], v[40:43], v[68:71]
    v_mfma_f32_16x16x32_bf16 v[68:71], a[116:119], v[44:47], v[68:71]
    v_mfma_f32_16x16x32_bf16 v[72:75], a[72:75], v[32:35], v[72:75]
    v_mfma_f32_16x16x32_bf16 v[72:75], a[88:91], v[36:39], v[72:75]
    v_mfma_f32_16x16x32_bf16 v[72:75], a[104:107], v[40:43], v[72:75]
    v_mfma_f32_16x16x32_bf16 v[72:75], a[120:123], v[44:47], v[72:75]
    v_mfma_f32_16x16x32_bf16 v[76:79], a[76:79], v[32:35], v[76:79]
    v_mfma_f32_16x16x32_bf16 v[76:79], a[92:95], v[36:39], v[76:79]
    v_mfma_f32_16x16x32_bf16 v[76:79], a[108:111], v[40:43], v[76:79]
    v_xor_b32 v28, 65536, v28
    s_waitcnt vmcnt(28) lgkmcnt(0)
    s_barrier
    v_mfma_f32_16x16x32_bf16 v[76:79], a[124:127], v[44:47], v[76:79]
    s_add_u32 m0, s63, 32768
    s_xor_b32 s98, s0, 3145728
    ds_read_b64_tr_b16 v[32:33], v28 offset:0
    v_mfma_f32_16x16x32_bf16 v[80:83], a[64:67], v[48:51], v[80:83]
    ds_read_b64_tr_b16 v[34:35], v28 offset:512
    v_mfma_f32_16x16x32_bf16 v[80:83], a[80:83], v[52:55], v[80:83]
    ds_read_b64_tr_b16 v[36:37], v28 offset:4096
    v_mfma_f32_16x16x32_bf16 v[80:83], a[96:99], v[56:59], v[80:83]
    ds_read_b64_tr_b16 v[38:39], v28 offset:4608
    v_mfma_f32_16x16x32_bf16 v[80:83], a[112:115], v[60:63], v[80:83]
    ds_read_b64_tr_b16 v[40:41], v28 offset:8192
    v_mfma_f32_16x16x32_bf16 v[84:87], a[68:71], v[48:51], v[84:87]
    ds_read_b64_tr_b16 v[42:43], v28 offset:8704
    v_mfma_f32_16x16x32_bf16 v[84:87], a[84:87], v[52:55], v[84:87]
    ds_read_b64_tr_b16 v[44:45], v28 offset:12288
    v_mfma_f32_16x16x32_bf16 v[84:87], a[100:103], v[56:59], v[84:87]
    ds_read_b64_tr_b16 v[46:47], v28 offset:12800
    v_mfma_f32_16x16x32_bf16 v[84:87], a[116:119], v[60:63], v[84:87]
    buffer_load_dwordx4 v20, s[24:27], s98 offen offset:0   lds
    v_mfma_f32_16x16x32_bf16 v[88:91], a[72:75], v[48:51], v[88:91]
    v_mfma_f32_16x16x32_bf16 v[88:91], a[88:91], v[52:55], v[88:91]
    v_mfma_f32_16x16x32_bf16 v[88:91], a[104:107], v[56:59], v[88:91]
    v_mfma_f32_16x16x32_bf16 v[88:91], a[120:123], v[60:63], v[88:91]
    v_mfma_f32_16x16x32_bf16 v[92:95], a[76:79], v[48:51], v[92:95]
    v_xor_b32 v29, 65536, v29
    v_mfma_f32_16x16x32_bf16 v[92:95], a[92:95], v[52:55], v[92:95]
    ds_read_b64_tr_b16 v[48:49], v29 offset:0
    v_mfma_f32_16x16x32_bf16 v[92:95], a[108:111], v[56:59], v[92:95]
    ds_read_b64_tr_b16 v[50:51], v29 offset:512
    v_mfma_f32_16x16x32_bf16 v[92:95], a[124:127], v[60:63], v[92:95]
    s_waitcnt lgkmcnt(3)
    ds_read_b64_tr_b16 v[52:53], v29 offset:4096
    v_mfma_f32_16x16x32_bf16 v[96:99], a[128:131], v[32:35], v[96:99]
    ds_read_b64_tr_b16 v[54:55], v29 offset:4608
    s_waitcnt vmcnt(1)
    v_cmp_ne_u32 vcc, 0, v3
    s_cmp_eq_u64 vcc, -1
    s_cbranch_scc0 L_H_slow_3
L_H_ok_4:
    v_mfma_f32_16x16x32_bf16 v[96:99], a[144:147], v[36:39], v[96:99]
    ds_read_b64_tr_b16 v[56:57], v29 offset:8192
    v_mfma_f32_16x16x32_bf16 v[96:99], a[160:163], v[40:43], v[96:99]
    s_waitcnt lgkmcnt(5)
    s_xor_b32 s80, s75, 0
    ds_read_b64_tr_b16 v[58:59], v29 offset:8704
    v_mfma_f32_16x16x32_bf16 v[96:99], a[176:179], v[44:47], v[96:99]
    ds_read_b64_tr_b16 v[60:61], v29 offset:12288
    v_mfma_f32_16x16x32_bf16 v[100:103], a[132:135], v[32:35], v[100:103]
    ds_read_b64_tr_b16 v[62:63], v29 offset:12800
    v_mfma_f32_16x16x32_bf16 v[100:103], a[148:151], v[36:39], v[100:103]
    buffer_load_dwordx4 v21, s[24:27], s98 offen offset:1024   lds
    v_mfma_f32_16x16x32_bf16 v[100:103], a[164:167], v[40:43], v[100:103]
    buffer_load_dwordx4 a[0:3], v1, s[8:11], s80 offen offset:0
    v_mfma_f32_16x16x32_bf16 v[100:103], a[180:183], v[44:47], v[100:103]
    v_mfma_f32_16x16x32_bf16 v[104:107], a[136:139], v[32:35], v[104:107]
    s_xor_b32 s80, s75, 16384
    v_mfma_f32_16x16x32_bf16 v[104:107], a[152:155], v[36:39], v[104:107]
    buffer_load_dwordx4 a[4:7], v1, s[8:11], s80 offen offset:0
    v_mfma_f32_16x16x32_bf16 v[104:107], a[168:171], v[40:43], v[104:107]
    v_mfma_f32_16x16x32_bf16 v[104:107], a[184:187], v[44:47], v[104:107]
    buffer_load_dwordx4 v22, s[24:27], s98 offen offset:2048   lds
    v_mfma_f32_16x16x32_bf16 v[108:111], a[140:143], v[32:35], v[108:111]
    v_mfma_f32_16x16x32_bf16 v[108:111], a[156:159], v[36:39], v[108:111]
    ds_read_b64_tr_b16 v[32:33], v28 offset:16384
    v_mfma_f32_16x16x32_bf16 v[108:111], a[172:175], v[40:43], v[108:111]
    ds_read_b64_tr_b16 v[34:35], v28 offset:16896
    v_mfma_f32_16x16x32_bf16 v[108:111], a[188:191], v[44:47], v[108:111]
    s_waitcnt lgkmcnt(2)
    s_xor_b32 s80, s76, 0
    ds_read_b64_tr_b16 v[36:37], v28 offset:20480
    v_mfma_f32_16x16x32_bf16 v[112:115], a[128:131], v[48:51], v[112:115]
    ds_read_b64_tr_b16 v[38:39], v28 offset:20992
    v_mfma_f32_16x16x32_bf16 v[112:115], a[144:147], v[52:55], v[112:115]
    ds_read_b64_tr_b16 v[40:41], v28 offset:24576
    v_mfma_f32_16x16x32_bf16 v[112:115], a[160:163], v[56:59], v[112:115]
    ds_read_b64_tr_b16 v[42:43], v28 offset:25088
    v_mfma_f32_16x16x32_bf16 v[112:115], a[176:179], v[60:63], v[112:115]
    ds_read_b64_tr_b16 v[44:45], v28 offset:28672
    v_mfma_f32_16x16x32_bf16 v[116:119], a[132:135], v[48:51], v[116:119]
    ds_read_b64_tr_b16 v[46:47], v28 offset:29184
    v_mfma_f32_16x16x32_bf16 v[116:119], a[148:151], v[52:55], v[116:119]
    buffer_load_dwordx4 v23, s[24:27], s98 offen offset:3072   lds
    v_mfma_f32_16x16x32_bf16 v[116:119], a[164:167], v[56:59], v[116:119]
    s_add_u32 m0, s63, 49152
    s_xor_b32 s98, s0, 3670016
    v_mfma_f32_16x16x32_bf16 v[116:119], a[180:183], v[60:63], v[116:119]
    buffer_load_dwordx4 a[8:11], v1, s[8:11], s80 offen offset:0
    v_mfma_f32_16x16x32_bf16 v[120:123], a[136:139], v[48:51], v[120:123]
    s_xor_b32 s80, s76, 16384
    v_mfma_f32_16x16x32_bf16 v[120:123], a[152:155], v[52:55], v[120:123]
    buffer_load_dwordx4 a[12:15], v1, s[8:11], s80 offen offset:0
    v_mfma_f32_16x16x32_bf16 v[120:123], a[168:171], v[56:59], v[120:123]
    v_mfma_f32_16x16x32_bf16 v[120:123], a[184:187], v[60:63], v[120:123]
    buffer_load_dwordx4 v20, s[24:27], s98 offen offset:0   lds
    v_mfma_f32_16x16x32_bf16 v[124:127], a[140:143], v[48:51], v[124:127]
    v_mfma_f32_16x16x32_bf16 v[124:127], a[156:159], v[52:55], v[124:127]
    s_xor_b32 s80, s75, 0
    ds_read_b64_tr_b16 v[48:49], v29 offset:16384
    v_mfma_f32_16x16x32_bf16 v[124:127], a[172:175], v[56:59], v[124:127]
    ds_read_b64_tr_b16 v[50:51], v29 offset:16896
    v_mfma_f32_16x16x32_bf16 v[124:127], a[188:191], v[60:63], v[124:127]
    s_waitcnt lgkmcnt(2)
    ds_read_b64_tr_b16 v[52:53], v29 offset:20480
    v_mfma_f32_16x16x32_bf16 v[96:99], a[192:195], v[32:35], v[96:99]
    ds_read_b64_tr_b16 v[54:55], v29 offset:20992
    v_mfma_f32_16x16x32_bf16 v[96:99], a[208:211], v[36:39], v[96:99]
    ds_read_b64_tr_b16 v[56:57], v29 offset:24576
    v_mfma_f32_16x16x32_bf16 v[96:99], a[224:227], v[40:43], v[96:99]
    ds_read_b64_tr_b16 v[58:59], v29 offset:25088
    v_mfma_f32_16x16x32_bf16 v[96:99], a[240:243], v[44:47], v[96:99]
    ds_read_b64_tr_b16 v[60:61], v29 offset:28672
    v_mfma_f32_16x16x32_bf16 v[100:103], a[196:199], v[32:35], v[100:103]
    ds_read_b64_tr_b16 v[62:63], v29 offset:29184
    v_mfma_f32_16x16x32_bf16 v[100:103], a[212:215], v[36:39], v[100:103]
    buffer_load_dwordx4 v21, s[24:27], s98 offen offset:1024   lds
    v_mfma_f32_16x16x32_bf16 v[100:103], a[228:231], v[40:43], v[100:103]
    buffer_load_dwordx4 a[16:19], v1, s[8:11], s80 offen offset:1024
    v_mfma_f32_16x16x32_bf16 v[100:103], a[244:247], v[44:47], v[100:103]
    s_xor_b32 s80, s75, 16384
    v_mfma_f32_16x16x32_bf16 v[104:107], a[200:203], v[32:35], v[104:107]
    buffer_load_dwordx4 a[20:23], v1, s[8:11], s80 offen offset:1024
    v_mfma_f32_16x16x32_bf16 v[104:107], a[216:219], v[36:39], v[104:107]
    v_mfma_f32_16x16x32_bf16 v[104:107], a[232:235], v[40:43], v[104:107]
    v_mfma_f32_16x16x32_bf16 v[104:107], a[248:251], v[44:47], v[104:107]
    buffer_load_dwordx4 v22, s[24:27], s98 offen offset:2048   lds
    v_mfma_f32_16x16x32_bf16 v[108:111], a[204:207], v[32:35], v[108:111]
    s_xor_b32 s80, s76, 0
    v_xor_b32 v30, 65536, v30
    v_mfma_f32_16x16x32_bf16 v[108:111], a[220:223], v[36:39], v[108:111]
    ds_read_b64_tr_b16 v[32:33], v30 offset:0
    v_mfma_f32_16x16x32_bf16 v[108:111], a[236:239], v[40:43], v[108:111]
    ds_read_b64_tr_b16 v[34:35], v30 offset:512
    v_mfma_f32_16x16x32_bf16 v[108:111], a[252:255], v[44:47], v[108:111]
    s_waitcnt lgkmcnt(2)
    ds_read_b64_tr_b16 v[36:37], v30 offset:4096
    v_mfma_f32_16x16x32_bf16 v[112:115], a[192:195], v[48:51], v[112:115]
    ds_read_b64_tr_b16 v[38:39], v30 offset:4608
    v_mfma_f32_16x16x32_bf16 v[112:115], a[208:211], v[52:55], v[112:115]
    ds_read_b64_tr_b16 v[40:41], v30 offset:8192
    v_mfma_f32_16x16x32_bf16 v[112:115], a[224:227], v[56:59], v[112:115]
    ds_read_b64_tr_b16 v[42:43], v30 offset:8704
    v_mfma_f32_16x16x32_bf16 v[112:115], a[240:243], v[60:63], v[112:115]
    ds_read_b64_tr_b16 v[44:45], v30 offset:12288
    v_mfma_f32_16x16x32_bf16 v[116:119], a[196:199], v[48:51], v[116:119]
    ds_read_b64_tr_b16 v[46:47], v30 offset:12800
    v_mfma_f32_16x16x32_bf16 v[116:119], a[212:215], v[52:55], v[116:119]
    buffer_load_dwordx4 v23, s[24:27], s98 offen offset:3072   lds
    v_mfma_f32_16x16x32_bf16 v[116:119], a[228:231], v[56:59], v[116:119]
    buffer_load_dwordx4 a[24:27], v1, s[8:11], s80 offen offset:1024
    v_mfma_f32_16x16x32_bf16 v[116:119], a[244:247], v[60:63], v[116:119]
    s_xor_b32 s80, s76, 16384
    v_mfma_f32_16x16x32_bf16 v[120:123], a[200:203], v[48:51], v[120:123]
    buffer_load_dwordx4 a[28:31], v1, s[8:11], s80 offen offset:1024
    v_mfma_f32_16x16x32_bf16 v[120:123], a[216:219], v[52:55], v[120:123]
    s_xor_b32 s80, s75, 2048
    v_mfma_f32_16x16x32_bf16 v[120:123], a[232:235], v[56:59], v[120:123]
    buffer_load_dwordx4 a[32:35], v1, s[8:11], s80 offen offset:0
    v_mfma_f32_16x16x32_bf16 v[120:123], a[248:251], v[60:63], v[120:123]
    v_mfma_f32_16x16x32_bf16 v[124:127], a[204:207], v[48:51], v[124:127]
    v_xor_b32 v31, 65536, v31
    v_mfma_f32_16x16x32_bf16 v[124:127], a[220:223], v[52:55], v[124:127]
    ds_read_b64_tr_b16 v[48:49], v31 offset:0
    v_mfma_f32_16x16x32_bf16 v[124:127], a[236:239], v[56:59], v[124:127]
    ds_read_b64_tr_b16 v[50:51], v31 offset:512
    v_mfma_f32_16x16x32_bf16 v[124:127], a[252:255], v[60:63], v[124:127]
    s_waitcnt lgkmcnt(2)
    ds_read_b64_tr_b16 v[52:53], v31 offset:4096
    v_mfma_f32_16x16x32_bf16 v[64:67], a[128:131], v[32:35], v[64:67]
    s_xor_b32 s80, s75, 18432
    ds_read_b64_tr_b16 v[54:55], v31 offset:4608
    v_mfma_f32_16x16x32_bf16 v[64:67], a[144:147], v[36:39], v[64:67]
    ds_read_b64_tr_b16 v[56:57], v31 offset:8192
    v_mfma_f32_16x16x32_bf16 v[64:67], a[160:163], v[40:43], v[64:67]
    ds_read_b64_tr_b16 v[58:59], v31 offset:8704
    v_mfma_f32_16x16x32_bf16 v[64:67], a[176:179], v[44:47], v[64:67]
    ds_read_b64_tr_b16 v[60:61], v31 offset:12288
    v_mfma_f32_16x16x32_bf16 v[68:71], a[132:135], v[32:35], v[68:71]
    ds_read_b64_tr_b16 v[62:63], v31 offset:12800
    v_mfma_f32_16x16x32_bf16 v[68:71], a[148:151], v[36:39], v[68:71]
    buffer_load_dwordx4 a[36:39], v1, s[8:11], s80 offen offset:0
    v_mfma_f32_16x16x32_bf16 v[68:71], a[164:167], v[40:43], v[68:71]
    v_cvt_pk_bf16_f32 v96, v96, v97
    v_cvt_pk_bf16_f32 v97, v98, v99
    v_mfma_f32_16x16x32_bf16 v[68:71], a[180:183], v[44:47], v[68:71]
    s_xor_b32 s80, s76, 2048
    v_cvt_pk_bf16_f32 v98, v100, v101
    v_cvt_pk_bf16_f32 v99, v102, v103
    v_mfma_f32_16x16x32_bf16 v[72:75], a[136:139], v[32:35], v[72:75]
    s_xor_b32 s79, s1, 36864
    v_mfma_f32_16x16x32_bf16 v[72:75], a[152:155], v[36:39], v[72:75]
    buffer_store_dwordx4 v[96:99], v1, s[8:11], s79 offen offset:0 sc0 sc1
    v_mfma_f32_16x16x32_bf16 v[72:75], a[168:171], v[40:43], v[72:75]
    buffer_load_dwordx4 a[40:43], v1, s[8:11], s80 offen offset:0
    v_mfma_f32_16x16x32_bf16 v[72:75], a[184:187], v[44:47], v[72:75]
    v_mfma_f32_16x16x32_bf16 v[76:79], a[140:143], v[32:35], v[76:79]
    v_mfma_f32_16x16x32_bf16 v[76:79], a[156:159], v[36:39], v[76:79]
    ds_read_b64_tr_b16 v[32:33], v30 offset:16384
    v_mfma_f32_16x16x32_bf16 v[76:79], a[172:175], v[40:43], v[76:79]
    s_xor_b32 s80, s76, 18432
    ds_read_b64_tr_b16 v[34:35], v30 offset:16896
    v_mfma_f32_16x16x32_bf16 v[76:79], a[188:191], v[44:47], v[76:79]
    s_waitcnt lgkmcnt(2)
    ds_read_b64_tr_b16 v[36:37], v30 offset:20480
    v_mfma_f32_16x16x32_bf16 v[80:83], a[128:131], v[48:51], v[80:83]
    ds_read_b64_tr_b16 v[38:39], v30 offset:20992
    v_mfma_f32_16x16x32_bf16 v[80:83], a[144:147], v[52:55], v[80:83]
    ds_read_b64_tr_b16 v[40:41], v30 offset:24576
    v_mfma_f32_16x16x32_bf16 v[80:83], a[160:163], v[56:59], v[80:83]
    ds_read_b64_tr_b16 v[42:43], v30 offset:25088
    v_mfma_f32_16x16x32_bf16 v[80:83], a[176:179], v[60:63], v[80:83]
    ds_read_b64_tr_b16 v[44:45], v30 offset:28672
    v_mfma_f32_16x16x32_bf16 v[84:87], a[132:135], v[48:51], v[84:87]
    ds_read_b64_tr_b16 v[46:47], v30 offset:29184
    v_mfma_f32_16x16x32_bf16 v[84:87], a[148:151], v[52:55], v[84:87]
    buffer_load_dwordx4 a[44:47], v1, s[8:11], s80 offen offset:0
    v_mfma_f32_16x16x32_bf16 v[84:87], a[164:167], v[56:59], v[84:87]
    s_xor_b32 s80, s75, 2048
    v_cvt_pk_bf16_f32 v104, v104, v105
    v_cvt_pk_bf16_f32 v105, v106, v107
    v_mfma_f32_16x16x32_bf16 v[84:87], a[180:183], v[60:63], v[84:87]
    v_cvt_pk_bf16_f32 v106, v108, v109
    v_cvt_pk_bf16_f32 v107, v110, v111
    v_mfma_f32_16x16x32_bf16 v[88:91], a[136:139], v[48:51], v[88:91]
    s_xor_b32 s79, s1, 45056
    v_mfma_f32_16x16x32_bf16 v[88:91], a[152:155], v[52:55], v[88:91]
    buffer_store_dwordx4 v[104:107], v1, s[8:11], s79 offen offset:0 sc0 sc1
    v_mfma_f32_16x16x32_bf16 v[88:91], a[168:171], v[56:59], v[88:91]
    buffer_load_dwordx4 a[48:51], v1, s[8:11], s80 offen offset:1024
    v_mfma_f32_16x16x32_bf16 v[88:91], a[184:187], v[60:63], v[88:91]
    v_mfma_f32_16x16x32_bf16 v[92:95], a[140:143], v[48:51], v[92:95]
    v_mfma_f32_16x16x32_bf16 v[92:95], a[156:159], v[52:55], v[92:95]
    s_xor_b32 s80, s75, 18432
    ds_read_b64_tr_b16 v[48:49], v31 offset:16384
    v_mfma_f32_16x16x32_bf16 v[92:95], a[172:175], v[56:59], v[92:95]
    ds_read_b64_tr_b16 v[50:51], v31 offset:16896
    v_mfma_f32_16x16x32_bf16 v[92:95], a[188:191], v[60:63], v[92:95]
    s_waitcnt lgkmcnt(2)
    ds_read_b64_tr_b16 v[52:53], v31 offset:20480
    v_mfma_f32_16x16x32_bf16 v[64:67], a[192:195], v[32:35], v[64:67]
    ds_read_b64_tr_b16 v[54:55], v31 offset:20992
    v_mfma_f32_16x16x32_bf16 v[64:67], a[208:211], v[36:39], v[64:67]
    ds_read_b64_tr_b16 v[56:57], v31 offset:24576
    v_mfma_f32_16x16x32_bf16 v[64:67], a[224:227], v[40:43], v[64:67]
    ds_read_b64_tr_b16 v[58:59], v31 offset:25088
    v_mfma_f32_16x16x32_bf16 v[64:67], a[240:243], v[44:47], v[64:67]
    ds_read_b64_tr_b16 v[60:61], v31 offset:28672
    v_mfma_f32_16x16x32_bf16 v[68:71], a[196:199], v[32:35], v[68:71]
    ds_read_b64_tr_b16 v[62:63], v31 offset:29184
    v_mfma_f32_16x16x32_bf16 v[68:71], a[212:215], v[36:39], v[68:71]
    buffer_load_dwordx4 a[52:55], v1, s[8:11], s80 offen offset:1024
    v_mfma_f32_16x16x32_bf16 v[68:71], a[228:231], v[40:43], v[68:71]
    s_xor_b32 s80, s76, 2048
    v_cvt_pk_bf16_f32 v112, v112, v113
    v_cvt_pk_bf16_f32 v113, v114, v115
    v_mfma_f32_16x16x32_bf16 v[68:71], a[244:247], v[44:47], v[68:71]
    v_cvt_pk_bf16_f32 v114, v116, v117
    v_cvt_pk_bf16_f32 v115, v118, v119
    v_mfma_f32_16x16x32_bf16 v[72:75], a[200:203], v[32:35], v[72:75]
    s_xor_b32 s79, s1, 36864
    v_mfma_f32_16x16x32_bf16 v[72:75], a[216:219], v[36:39], v[72:75]
    buffer_store_dwordx4 v[112:115], v1, s[8:11], s79 offen offset:1024 sc0 sc1
    v_mfma_f32_16x16x32_bf16 v[72:75], a[232:235], v[40:43], v[72:75]
    buffer_load_dwordx4 a[56:59], v1, s[8:11], s80 offen offset:1024
    v_mfma_f32_16x16x32_bf16 v[72:75], a[248:251], v[44:47], v[72:75]
    s_xor_b32 s80, s76, 18432
    v_mfma_f32_16x16x32_bf16 v[76:79], a[204:207], v[32:35], v[76:79]
    buffer_load_dwordx4 a[60:63], v1, s[8:11], s80 offen offset:1024
    v_mfma_f32_16x16x32_bf16 v[76:79], a[220:223], v[36:39], v[76:79]
    v_mfma_f32_16x16x32_bf16 v[76:79], a[236:239], v[40:43], v[76:79]
    s_waitcnt lgkmcnt(0)
    s_barrier
    v_mfma_f32_16x16x32_bf16 v[76:79], a[252:255], v[44:47], v[76:79]
    ds_read_b64_tr_b16 v[32:33], v8 offset:32768
    v_mfma_f32_16x16x32_bf16 v[80:83], a[192:195], v[48:51], v[80:83]
    ds_read_b64_tr_b16 v[34:35], v8 offset:33792
    v_mfma_f32_16x16x32_bf16 v[80:83], a[208:211], v[52:55], v[80:83]
    s_xor_b32 s80, s75, 4096
    ds_read_b64_tr_b16 v[36:37], v9 offset:32768
    v_mfma_f32_16x16x32_bf16 v[80:83], a[224:227], v[56:59], v[80:83]
    ds_read_b64_tr_b16 v[38:39], v9 offset:33792
    v_mfma_f32_16x16x32_bf16 v[80:83], a[240:243], v[60:63], v[80:83]
    ds_read_b64_tr_b16 v[40:41], v10 offset:32768
    v_mfma_f32_16x16x32_bf16 v[84:87], a[196:199], v[48:51], v[84:87]
    ds_read_b64_tr_b16 v[42:43], v10 offset:33792
    v_mfma_f32_16x16x32_bf16 v[84:87], a[212:215], v[52:55], v[84:87]
    ds_read_b64_tr_b16 v[44:45], v11 offset:32768
    v_mfma_f32_16x16x32_bf16 v[84:87], a[228:231], v[56:59], v[84:87]
    ds_read_b64_tr_b16 v[46:47], v11 offset:33792
    v_cvt_pk_bf16_f32 v120, v120, v121
    v_mfma_f32_16x16x32_bf16 v[84:87], a[244:247], v[60:63], v[84:87]
    v_cvt_pk_bf16_f32 v121, v122, v123
    v_cvt_pk_bf16_f32 v122, v124, v125
    v_mfma_f32_16x16x32_bf16 v[88:91], a[200:203], v[48:51], v[88:91]
    v_cvt_pk_bf16_f32 v123, v126, v127
    v_mfma_f32_16x16x32_bf16 v[88:91], a[216:219], v[52:55], v[88:91]
    s_xor_b32 s79, s1, 45056
    v_mfma_f32_16x16x32_bf16 v[88:91], a[232:235], v[56:59], v[88:91]
    buffer_store_dwordx4 v[120:123], v1, s[8:11], s79 offen offset:1024 sc0 sc1
    v_mfma_f32_16x16x32_bf16 v[88:91], a[248:251], v[60:63], v[88:91]
    buffer_load_dwordx4 a[64:67], v1, s[8:11], s80 offen offset:0
    v_mfma_f32_16x16x32_bf16 v[92:95], a[204:207], v[48:51], v[92:95]
    v_mfma_f32_16x16x32_bf16 v[92:95], a[220:223], v[52:55], v[92:95]
    s_xor_b32 s80, s75, 20480
    ds_read_b64_tr_b16 v[48:49], v12 offset:32768
    v_mfma_f32_16x16x32_bf16 v[92:95], a[236:239], v[56:59], v[92:95]
    ds_read_b64_tr_b16 v[50:51], v12 offset:33792
    v_mfma_f32_16x16x32_bf16 v[92:95], a[252:255], v[60:63], v[92:95]
    s_waitcnt vmcnt(26) lgkmcnt(3)
    ds_read_b64_tr_b16 v[52:53], v13 offset:32768
    v_mfma_f32_16x16x32_bf16 v[128:131], v[32:35], a[0:3], 0
    s_waitcnt vmcnt(25)
    ds_read_b64_tr_b16 v[54:55], v13 offset:33792
    v_mfma_f32_16x16x32_bf16 v[160:163], v[32:35], a[4:7], 0
    s_waitcnt vmcnt(22)
    ds_read_b64_tr_b16 v[56:57], v14 offset:32768
    v_mfma_f32_16x16x32_bf16 v[192:195], v[32:35], a[8:11], 0
    s_waitcnt vmcnt(21)
    ds_read_b64_tr_b16 v[58:59], v14 offset:33792
    v_mfma_f32_16x16x32_bf16 v[224:227], v[32:35], a[12:15], 0
    ds_read_b64_tr_b16 v[60:61], v15 offset:32768
    v_mfma_f32_16x16x32_bf16 v[132:135], v[36:39], a[0:3], 0
    ds_read_b64_tr_b16 v[62:63], v15 offset:33792
    v_mfma_f32_16x16x32_bf16 v[164:167], v[36:39], a[4:7], 0
    ds_read_b64_tr_b16 v[32:33], v8 offset:40960
    v_mfma_f32_16x16x32_bf16 v[196:199], v[36:39], a[8:11], 0
    ds_read_b64_tr_b16 v[34:35], v8 offset:41984
    v_cvt_pk_bf16_f32 v64, v64, v65
    v_mfma_f32_16x16x32_bf16 v[228:231], v[36:39], a[12:15], 0
    buffer_load_dwordx4 a[68:71], v1, s[8:11], s80 offen offset:0
    v_mfma_f32_16x16x32_bf16 v[136:139], v[40:43], a[0:3], 0
    s_xor_b32 s80, s76, 4096
    ds_read_b64_tr_b16 v[36:37], v9 offset:40960
    v_cvt_pk_bf16_f32 v65, v66, v67
    v_mfma_f32_16x16x32_bf16 v[168:171], v[40:43], a[4:7], 0
    ds_read_b64_tr_b16 v[38:39], v9 offset:41984
    v_cvt_pk_bf16_f32 v66, v68, v69
    v_mfma_f32_16x16x32_bf16 v[200:203], v[40:43], a[8:11], 0
    s_waitcnt lgkmcnt(8)
    v_cvt_pk_bf16_f32 v67, v70, v71
    v_mfma_f32_16x16x32_bf16 v[232:235], v[40:43], a[12:15], 0
    buffer_load_dwordx4 a[72:75], v1, s[8:11], s80 offen offset:0
    v_mfma_f32_16x16x32_bf16 v[140:143], v[44:47], a[0:3], 0
    s_xor_b32 s79, s1, 36864
    s_xor_b32 s80, s76, 20480
    ds_read_b64_tr_b16 v[40:41], v10 offset:40960
    v_mfma_f32_16x16x32_bf16 v[172:175], v[44:47], a[4:7], 0
    ds_read_b64_tr_b16 v[42:43], v10 offset:41984
    v_mfma_f32_16x16x32_bf16 v[204:207], v[44:47], a[8:11], 0
    buffer_store_dwordx4 v[64:67], v1, s[8:11], s79 offen offset:2048 sc0 sc1
    v_mfma_f32_16x16x32_bf16 v[236:239], v[44:47], a[12:15], 0
    buffer_load_dwordx4 a[76:79], v1, s[8:11], s80 offen offset:0
    v_mfma_f32_16x16x32_bf16 v[144:147], v[48:51], a[0:3], 0
    s_xor_b32 s80, s75, 4096
    ds_read_b64_tr_b16 v[44:45], v11 offset:40960
    v_mfma_f32_16x16x32_bf16 v[176:179], v[48:51], a[4:7], 0
    ds_read_b64_tr_b16 v[46:47], v11 offset:41984
    v_mfma_f32_16x16x32_bf16 v[208:211], v[48:51], a[8:11], 0
    buffer_load_dwordx4 a[80:83], v1, s[8:11], s80 offen offset:1024
    v_mfma_f32_16x16x32_bf16 v[240:243], v[48:51], a[12:15], 0
    v_mfma_f32_16x16x32_bf16 v[148:151], v[52:55], a[0:3], 0
    s_xor_b32 s80, s75, 20480
    ds_read_b64_tr_b16 v[48:49], v12 offset:40960
    v_mfma_f32_16x16x32_bf16 v[180:183], v[52:55], a[4:7], 0
    ds_read_b64_tr_b16 v[50:51], v12 offset:41984
    v_mfma_f32_16x16x32_bf16 v[212:215], v[52:55], a[8:11], 0
    buffer_load_dwordx4 a[84:87], v1, s[8:11], s80 offen offset:1024
    v_mfma_f32_16x16x32_bf16 v[244:247], v[52:55], a[12:15], 0
    s_waitcnt lgkmcnt(4)
    v_mfma_f32_16x16x32_bf16 v[152:155], v[56:59], a[0:3], 0
    ds_read_b64_tr_b16 v[52:53], v13 offset:40960
    v_cvt_pk_bf16_f32 v72, v72, v73
    v_mfma_f32_16x16x32_bf16 v[184:187], v[56:59], a[4:7], 0
    ds_read_b64_tr_b16 v[54:55], v13 offset:41984
    v_cvt_pk_bf16_f32 v73, v74, v75
    v_mfma_f32_16x16x32_bf16 v[216:219], v[56:59], a[8:11], 0
    v_cvt_pk_bf16_f32 v74, v76, v77
    v_cvt_pk_bf16_f32 v75, v78, v79
    v_mfma_f32_16x16x32_bf16 v[248:251], v[56:59], a[12:15], 0
    v_mfma_f32_16x16x32_bf16 v[156:159], v[60:63], a[0:3], 0
    s_xor_b32 s79, s1, 45056
    s_xor_b32 s80, s76, 4096
    ds_read_b64_tr_b16 v[56:57], v14 offset:40960
    v_mfma_f32_16x16x32_bf16 v[188:191], v[60:63], a[4:7], 0
    s_waitcnt vmcnt(24)
    ds_read_b64_tr_b16 v[58:59], v14 offset:41984
    v_mfma_f32_16x16x32_bf16 v[220:223], v[60:63], a[8:11], 0
    buffer_store_dwordx4 v[72:75], v1, s[8:11], s79 offen offset:2048 sc0 sc1
    v_mfma_f32_16x16x32_bf16 v[252:255], v[60:63], a[12:15], 0
    buffer_load_dwordx4 a[88:91], v1, s[8:11], s80 offen offset:1024
    v_mfma_f32_16x16x32_bf16 v[128:131], v[32:35], a[16:19], v[128:131]
    s_waitcnt vmcnt(25)
    ds_read_b64_tr_b16 v[60:61], v15 offset:40960
    v_mfma_f32_16x16x32_bf16 v[160:163], v[32:35], a[20:23], v[160:163]
    s_waitcnt vmcnt(22)
    ds_read_b64_tr_b16 v[62:63], v15 offset:41984
    v_mfma_f32_16x16x32_bf16 v[192:195], v[32:35], a[24:27], v[192:195]
    s_waitcnt vmcnt(21)
    v_mfma_f32_16x16x32_bf16 v[224:227], v[32:35], a[28:31], v[224:227]
    v_mfma_f32_16x16x32_bf16 v[132:135], v[36:39], a[16:19], v[132:135]
    s_xor_b32 s80, s76, 20480
    ds_read_b64_tr_b16 v[32:33], v8 offset:0
    v_mfma_f32_16x16x32_bf16 v[164:167], v[36:39], a[20:23], v[164:167]
    ds_read_b64_tr_b16 v[34:35], v8 offset:1024
    v_mfma_f32_16x16x32_bf16 v[196:199], v[36:39], a[24:27], v[196:199]
    buffer_load_dwordx4 a[92:95], v1, s[8:11], s80 offen offset:1024
    v_mfma_f32_16x16x32_bf16 v[228:231], v[36:39], a[28:31], v[228:231]
    v_mfma_f32_16x16x32_bf16 v[136:139], v[40:43], a[16:19], v[136:139]
    ds_read_b64_tr_b16 v[36:37], v9 offset:0
    v_cvt_pk_bf16_f32 v80, v80, v81
    v_mfma_f32_16x16x32_bf16 v[168:171], v[40:43], a[20:23], v[168:171]
    s_xor_b32 s80, s75, 6144
    ds_read_b64_tr_b16 v[38:39], v9 offset:1024
    v_cvt_pk_bf16_f32 v81, v82, v83
    v_mfma_f32_16x16x32_bf16 v[200:203], v[40:43], a[24:27], v[200:203]
    s_waitcnt lgkmcnt(5)
    v_cvt_pk_bf16_f32 v82, v84, v85
    v_cvt_pk_bf16_f32 v83, v86, v87
    v_mfma_f32_16x16x32_bf16 v[232:235], v[40:43], a[28:31], v[232:235]
    buffer_load_dwordx4 a[96:99], v1, s[8:11], s80 offen offset:0
    v_mfma_f32_16x16x32_bf16 v[140:143], v[44:47], a[16:19], v[140:143]
    s_xor_b32 s79, s1, 36864
    ds_read_b64_tr_b16 v[40:41], v10 offset:0
    v_mfma_f32_16x16x32_bf16 v[172:175], v[44:47], a[20:23], v[172:175]
    ds_read_b64_tr_b16 v[42:43], v10 offset:1024
    v_mfma_f32_16x16x32_bf16 v[204:207], v[44:47], a[24:27], v[204:207]
    buffer_store_dwordx4 v[80:83], v1, s[8:11], s79 offen offset:3072 sc0 sc1
    v_mfma_f32_16x16x32_bf16 v[236:239], v[44:47], a[28:31], v[236:239]
    v_mfma_f32_16x16x32_bf16 v[144:147], v[48:51], a[16:19], v[144:147]
    s_xor_b32 s80, s75, 22528
    ds_read_b64_tr_b16 v[44:45], v11 offset:0
    v_mfma_f32_16x16x32_bf16 v[176:179], v[48:51], a[20:23], v[176:179]
    ds_read_b64_tr_b16 v[46:47], v11 offset:1024
    v_mfma_f32_16x16x32_bf16 v[208:211], v[48:51], a[24:27], v[208:211]
    buffer_load_dwordx4 a[100:103], v1, s[8:11], s80 offen offset:0
    v_mfma_f32_16x16x32_bf16 v[240:243], v[48:51], a[28:31], v[240:243]
    v_mfma_f32_16x16x32_bf16 v[148:151], v[52:55], a[16:19], v[148:151]
    ds_read_b64_tr_b16 v[48:49], v12 offset:0
    v_mfma_f32_16x16x32_bf16 v[180:183], v[52:55], a[20:23], v[180:183]
    ds_read_b64_tr_b16 v[50:51], v12 offset:1024
    v_mfma_f32_16x16x32_bf16 v[212:215], v[52:55], a[24:27], v[212:215]
    v_mfma_f32_16x16x32_bf16 v[244:247], v[52:55], a[28:31], v[244:247]
    v_mfma_f32_16x16x32_bf16 v[152:155], v[56:59], a[16:19], v[152:155]
    s_xor_b32 s80, s76, 6144
    ds_read_b64_tr_b16 v[52:53], v13 offset:0
    v_cvt_pk_bf16_f32 v88, v88, v89
    v_mfma_f32_16x16x32_bf16 v[184:187], v[56:59], a[20:23], v[184:187]
    ds_read_b64_tr_b16 v[54:55], v13 offset:1024
    v_cvt_pk_bf16_f32 v89, v90, v91
    v_mfma_f32_16x16x32_bf16 v[216:219], v[56:59], a[24:27], v[216:219]
    s_waitcnt lgkmcnt(5)
    v_cvt_pk_bf16_f32 v90, v92, v93
    v_cvt_pk_bf16_f32 v91, v94, v95
    v_mfma_f32_16x16x32_bf16 v[248:251], v[56:59], a[28:31], v[248:251]
    buffer_load_dwordx4 a[104:107], v1, s[8:11], s80 offen offset:0
    v_mfma_f32_16x16x32_bf16 v[156:159], v[60:63], a[16:19], v[156:159]
    s_xor_b32 s79, s1, 45056
    ds_read_b64_tr_b16 v[56:57], v14 offset:0
    v_mfma_f32_16x16x32_bf16 v[188:191], v[60:63], a[20:23], v[188:191]
    ds_read_b64_tr_b16 v[58:59], v14 offset:1024
    v_mfma_f32_16x16x32_bf16 v[220:223], v[60:63], a[24:27], v[220:223]
    buffer_store_dwordx4 v[88:91], v1, s[8:11], s79 offen offset:3072 sc0 sc1
    v_mfma_f32_16x16x32_bf16 v[252:255], v[60:63], a[28:31], v[252:255]
    s_waitcnt vmcnt(26)
    v_mfma_f32_16x16x32_bf16 v[128:131], v[32:35], a[32:35], v[128:131]
    s_waitcnt vmcnt(25)
    s_xor_b32 s80, s76, 22528
    ds_read_b64_tr_b16 v[60:61], v15 offset:0
    v_mfma_f32_16x16x32_bf16 v[160:163], v[32:35], a[36:39], v[160:163]
    s_waitcnt vmcnt(22)
    ds_read_b64_tr_b16 v[62:63], v15 offset:1024
    v_mfma_f32_16x16x32_bf16 v[192:195], v[32:35], a[40:43], v[192:195]
    buffer_load_dwordx4 a[108:111], v1, s[8:11], s80 offen offset:0
    v_mfma_f32_16x16x32_bf16 v[224:227], v[32:35], a[44:47], v[224:227]
    v_mfma_f32_16x16x32_bf16 v[132:135], v[36:39], a[32:35], v[132:135]
    ds_read_b64_tr_b16 v[32:33], v8 offset:8192
    v_mfma_f32_16x16x32_bf16 v[164:167], v[36:39], a[36:39], v[164:167]
    s_xor_b32 s80, s75, 6144
    ds_read_b64_tr_b16 v[34:35], v8 offset:9216
    v_mfma_f32_16x16x32_bf16 v[196:199], v[36:39], a[40:43], v[196:199]
    buffer_load_dwordx4 a[112:115], v1, s[8:11], s80 offen offset:1024
    v_mfma_f32_16x16x32_bf16 v[228:231], v[36:39], a[44:47], v[228:231]
    v_mfma_f32_16x16x32_bf16 v[136:139], v[40:43], a[32:35], v[136:139]
    ds_read_b64_tr_b16 v[36:37], v9 offset:8192
    v_mfma_f32_16x16x32_bf16 v[168:171], v[40:43], a[36:39], v[168:171]
    ds_read_b64_tr_b16 v[38:39], v9 offset:9216
    v_mfma_f32_16x16x32_bf16 v[200:203], v[40:43], a[40:43], v[200:203]
    v_mfma_f32_16x16x32_bf16 v[232:235], v[40:43], a[44:47], v[232:235]
    s_waitcnt lgkmcnt(4)
    v_mfma_f32_16x16x32_bf16 v[140:143], v[44:47], a[32:35], v[140:143]
    s_xor_b32 s80, s75, 22528
    ds_read_b64_tr_b16 v[40:41], v10 offset:8192
    v_mfma_f32_16x16x32_bf16 v[172:175], v[44:47], a[36:39], v[172:175]
    ds_read_b64_tr_b16 v[42:43], v10 offset:9216
    v_mfma_f32_16x16x32_bf16 v[204:207], v[44:47], a[40:43], v[204:207]
    buffer_load_dwordx4 a[116:119], v1, s[8:11], s80 offen offset:1024
    v_mfma_f32_16x16x32_bf16 v[236:239], v[44:47], a[44:47], v[236:239]
    v_mfma_f32_16x16x32_bf16 v[144:147], v[48:51], a[32:35], v[144:147]
    ds_read_b64_tr_b16 v[44:45], v11 offset:8192
    v_mfma_f32_16x16x32_bf16 v[176:179], v[48:51], a[36:39], v[176:179]
    ds_read_b64_tr_b16 v[46:47], v11 offset:9216
    v_mfma_f32_16x16x32_bf16 v[208:211], v[48:51], a[40:43], v[208:211]
    v_mfma_f32_16x16x32_bf16 v[240:243], v[48:51], a[44:47], v[240:243]
    v_mfma_f32_16x16x32_bf16 v[148:151], v[52:55], a[32:35], v[148:151]
    s_xor_b32 s80, s76, 6144
    ds_read_b64_tr_b16 v[48:49], v12 offset:8192
    v_mfma_f32_16x16x32_bf16 v[180:183], v[52:55], a[36:39], v[180:183]
    ds_read_b64_tr_b16 v[50:51], v12 offset:9216
    v_mfma_f32_16x16x32_bf16 v[212:215], v[52:55], a[40:43], v[212:215]
    buffer_load_dwordx4 a[120:123], v1, s[8:11], s80 offen offset:1024
    v_mfma_f32_16x16x32_bf16 v[244:247], v[52:55], a[44:47], v[244:247]
    v_mfma_f32_16x16x32_bf16 v[152:155], v[56:59], a[32:35], v[152:155]
    ds_read_b64_tr_b16 v[52:53], v13 offset:8192
    v_mfma_f32_16x16x32_bf16 v[184:187], v[56:59], a[36:39], v[184:187]
    ds_read_b64_tr_b16 v[54:55], v13 offset:9216
    v_mfma_f32_16x16x32_bf16 v[216:219], v[56:59], a[40:43], v[216:219]
    v_mfma_f32_16x16x32_bf16 v[248:251], v[56:59], a[44:47], v[248:251]
    v_mfma_f32_16x16x32_bf16 v[156:159], v[60:63], a[32:35], v[156:159]
    s_xor_b32 s80, s76, 22528
    ds_read_b64_tr_b16 v[56:57], v14 offset:8192
    v_mfma_f32_16x16x32_bf16 v[188:191], v[60:63], a[36:39], v[188:191]
    ds_read_b64_tr_b16 v[58:59], v14 offset:9216
    v_mfma_f32_16x16x32_bf16 v[220:223], v[60:63], a[40:43], v[220:223]
    buffer_load_dwordx4 a[124:127], v1, s[8:11], s80 offen offset:1024
    v_mfma_f32_16x16x32_bf16 v[252:255], v[60:63], a[44:47], v[252:255]
    s_waitcnt vmcnt(25) lgkmcnt(4)
    v_mfma_f32_16x16x32_bf16 v[128:131], v[32:35], a[48:51], v[128:131]
    s_waitcnt vmcnt(24)
    ds_read_b64_tr_b16 v[60:61], v15 offset:8192
    v_mfma_f32_16x16x32_bf16 v[160:163], v[32:35], a[52:55], v[160:163]
    s_waitcnt vmcnt(21)
    s_xor_b32 s80, s75, 8192
    ds_read_b64_tr_b16 v[62:63], v15 offset:9216
    v_mfma_f32_16x16x32_bf16 v[192:195], v[32:35], a[56:59], v[192:195]
    buffer_load_dwordx4 a[128:131], v1, s[8:11], s80 offen offset:0
    v_mfma_f32_16x16x32_bf16 v[224:227], v[32:35], a[60:63], v[224:227]
    v_mfma_f32_16x16x32_bf16 v[132:135], v[36:39], a[48:51], v[132:135]
    ds_read_b64_tr_b16 v[32:33], v8 offset:16384
    v_mfma_f32_16x16x32_bf16 v[164:167], v[36:39], a[52:55], v[164:167]
    ds_read_b64_tr_b16 v[34:35], v8 offset:17408
    v_mfma_f32_16x16x32_bf16 v[196:199], v[36:39], a[56:59], v[196:199]
    v_mfma_f32_16x16x32_bf16 v[228:231], v[36:39], a[60:63], v[228:231]
    v_mfma_f32_16x16x32_bf16 v[136:139], v[40:43], a[48:51], v[136:139]
    s_xor_b32 s80, s75, 24576
    ds_read_b64_tr_b16 v[36:37], v9 offset:16384
    v_mfma_f32_16x16x32_bf16 v[168:171], v[40:43], a[52:55], v[168:171]
    ds_read_b64_tr_b16 v[38:39], v9 offset:17408
    v_mfma_f32_16x16x32_bf16 v[200:203], v[40:43], a[56:59], v[200:203]
    buffer_load_dwordx4 a[132:135], v1, s[8:11], s80 offen offset:0
    v_mfma_f32_16x16x32_bf16 v[232:235], v[40:43], a[60:63], v[232:235]
    v_mfma_f32_16x16x32_bf16 v[140:143], v[44:47], a[48:51], v[140:143]
    ds_read_b64_tr_b16 v[40:41], v10 offset:16384
    v_mfma_f32_16x16x32_bf16 v[172:175], v[44:47], a[52:55], v[172:175]
    ds_read_b64_tr_b16 v[42:43], v10 offset:17408
    v_mfma_f32_16x16x32_bf16 v[204:207], v[44:47], a[56:59], v[204:207]
    v_mfma_f32_16x16x32_bf16 v[236:239], v[44:47], a[60:63], v[236:239]
    v_mfma_f32_16x16x32_bf16 v[144:147], v[48:51], a[48:51], v[144:147]
    s_xor_b32 s80, s76, 8192
    ds_read_b64_tr_b16 v[44:45], v11 offset:16384
    v_mfma_f32_16x16x32_bf16 v[176:179], v[48:51], a[52:55], v[176:179]
    ds_read_b64_tr_b16 v[46:47], v11 offset:17408
    v_mfma_f32_16x16x32_bf16 v[208:211], v[48:51], a[56:59], v[208:211]
    buffer_load_dwordx4 a[136:139], v1, s[8:11], s80 offen offset:0
    v_mfma_f32_16x16x32_bf16 v[240:243], v[48:51], a[60:63], v[240:243]
    s_waitcnt lgkmcnt(4)
    v_mfma_f32_16x16x32_bf16 v[148:151], v[52:55], a[48:51], v[148:151]
    ds_read_b64_tr_b16 v[48:49], v12 offset:16384
    v_mfma_f32_16x16x32_bf16 v[180:183], v[52:55], a[52:55], v[180:183]
    ds_read_b64_tr_b16 v[50:51], v12 offset:17408
    v_mfma_f32_16x16x32_bf16 v[212:215], v[52:55], a[56:59], v[212:215]
    v_mfma_f32_16x16x32_bf16 v[244:247], v[52:55], a[60:63], v[244:247]
    v_mfma_f32_16x16x32_bf16 v[152:155], v[56:59], a[48:51], v[152:155]
    s_xor_b32 s80, s76, 24576
    ds_read_b64_tr_b16 v[52:53], v13 offset:16384
    v_mfma_f32_16x16x32_bf16 v[184:187], v[56:59], a[52:55], v[184:187]
    ds_read_b64_tr_b16 v[54:55], v13 offset:17408
    v_mfma_f32_16x16x32_bf16 v[216:219], v[56:59], a[56:59], v[216:219]
    buffer_load_dwordx4 a[140:143], v1, s[8:11], s80 offen offset:0
    s_waitcnt vmcnt(9)
    v_mfma_f32_16x16x32_bf16 v[248:251], v[56:59], a[60:63], v[248:251]
    buffer_store_dword v6, v5, s[8:11], s73 offen sc0 sc1
    v_mfma_f32_16x16x32_bf16 v[156:159], v[60:63], a[48:51], v[156:159]
    ds_read_b64_tr_b16 v[56:57], v14 offset:16384
    v_mfma_f32_16x16x32_bf16 v[188:191], v[60:63], a[52:55], v[188:191]
    s_xor_b32 s80, s75, 8192
    ds_read_b64_tr_b16 v[58:59], v14 offset:17408
    v_mfma_f32_16x16x32_bf16 v[220:223], v[60:63], a[56:59], v[220:223]
    buffer_load_dwordx4 a[144:147], v1, s[8:11], s80 offen offset:1024
    v_mfma_f32_16x16x32_bf16 v[252:255], v[60:63], a[60:63], v[252:255]
    v_mfma_f32_16x16x32_bf16 v[128:131], v[32:35], a[64:67], v[128:131]
    ds_read_b64_tr_b16 v[60:61], v15 offset:16384
    v_mfma_f32_16x16x32_bf16 v[160:163], v[32:35], a[68:71], v[160:163]
    ds_read_b64_tr_b16 v[62:63], v15 offset:17408
    v_mfma_f32_16x16x32_bf16 v[192:195], v[32:35], a[72:75], v[192:195]
    v_mfma_f32_16x16x32_bf16 v[224:227], v[32:35], a[76:79], v[224:227]
    v_mfma_f32_16x16x32_bf16 v[132:135], v[36:39], a[64:67], v[132:135]
    s_xor_b32 s80, s75, 24576
    ds_read_b64_tr_b16 v[32:33], v8 offset:24576
    v_mfma_f32_16x16x32_bf16 v[164:167], v[36:39], a[68:71], v[164:167]
    ds_read_b64_tr_b16 v[34:35], v8 offset:25600
    v_mfma_f32_16x16x32_bf16 v[196:199], v[36:39], a[72:75], v[196:199]
    buffer_load_dwordx4 a[148:151], v1, s[8:11], s80 offen offset:1024
    v_mfma_f32_16x16x32_bf16 v[228:231], v[36:39], a[76:79], v[228:231]
    s_waitcnt lgkmcnt(4)
    v_mfma_f32_16x16x32_bf16 v[136:139], v[40:43], a[64:67], v[136:139]
    ds_read_b64_tr_b16 v[36:37], v9 offset:24576
    v_mfma_f32_16x16x32_bf16 v[168:171], v[40:43], a[68:71], v[168:171]
    ds_read_b64_tr_b16 v[38:39], v9 offset:25600
    v_mfma_f32_16x16x32_bf16 v[200:203], v[40:43], a[72:75], v[200:203]
    v_mfma_f32_16x16x32_bf16 v[232:235], v[40:43], a[76:79], v[232:235]
    v_mfma_f32_16x16x32_bf16 v[140:143], v[44:47], a[64:67], v[140:143]
    s_xor_b32 s80, s76, 8192
    ds_read_b64_tr_b16 v[40:41], v10 offset:24576
    v_mfma_f32_16x16x32_bf16 v[172:175], v[44:47], a[68:71], v[172:175]
    ds_read_b64_tr_b16 v[42:43], v10 offset:25600
    v_mfma_f32_16x16x32_bf16 v[204:207], v[44:47], a[72:75], v[204:207]
    buffer_load_dwordx4 a[152:155], v1, s[8:11], s80 offen offset:1024
    v_mfma_f32_16x16x32_bf16 v[236:239], v[44:47], a[76:79], v[236:239]
    v_mfma_f32_16x16x32_bf16 v[144:147], v[48:51], a[64:67], v[144:147]
    ds_read_b64_tr_b16 v[44:45], v11 offset:24576
    v_mfma_f32_16x16x32_bf16 v[176:179], v[48:51], a[68:71], v[176:179]
    ds_read_b64_tr_b16 v[46:47], v11 offset:25600
    v_mfma_f32_16x16x32_bf16 v[208:211], v[48:51], a[72:75], v[208:211]
    v_mfma_f32_16x16x32_bf16 v[240:243], v[48:51], a[76:79], v[240:243]
    v_mfma_f32_16x16x32_bf16 v[148:151], v[52:55], a[64:67], v[148:151]
    s_xor_b32 s80, s76, 24576
    ds_read_b64_tr_b16 v[48:49], v12 offset:24576
    v_mfma_f32_16x16x32_bf16 v[180:183], v[52:55], a[68:71], v[180:183]
    ds_read_b64_tr_b16 v[50:51], v12 offset:25600
    v_mfma_f32_16x16x32_bf16 v[212:215], v[52:55], a[72:75], v[212:215]
    buffer_load_dwordx4 a[156:159], v1, s[8:11], s80 offen offset:1024
    v_mfma_f32_16x16x32_bf16 v[244:247], v[52:55], a[76:79], v[244:247]
    v_mfma_f32_16x16x32_bf16 v[152:155], v[56:59], a[64:67], v[152:155]
    ds_read_b64_tr_b16 v[52:53], v13 offset:24576
    v_mfma_f32_16x16x32_bf16 v[184:187], v[56:59], a[68:71], v[184:187]
    s_xor_b32 s80, s75, 10240
    ds_read_b64_tr_b16 v[54:55], v13 offset:25600
    v_mfma_f32_16x16x32_bf16 v[216:219], v[56:59], a[72:75], v[216:219]
    buffer_load_dwordx4 a[160:163], v1, s[8:11], s80 offen offset:0
    v_mfma_f32_16x16x32_bf16 v[248:251], v[56:59], a[76:79], v[248:251]
    s_waitcnt lgkmcnt(4)
    v_mfma_f32_16x16x32_bf16 v[156:159], v[60:63], a[64:67], v[156:159]
    ds_read_b64_tr_b16 v[56:57], v14 offset:24576
    v_mfma_f32_16x16x32_bf16 v[188:191], v[60:63], a[68:71], v[188:191]
    ds_read_b64_tr_b16 v[58:59], v14 offset:25600
    v_mfma_f32_16x16x32_bf16 v[220:223], v[60:63], a[72:75], v[220:223]
    v_mfma_f32_16x16x32_bf16 v[252:255], v[60:63], a[76:79], v[252:255]
    v_mfma_f32_16x16x32_bf16 v[128:131], v[32:35], a[80:83], v[128:131]
    s_xor_b32 s80, s75, 26624
    s_and_b32 s100, s3, 1
    ds_read_b64_tr_b16 v[60:61], v15 offset:24576
    v_mfma_f32_16x16x32_bf16 v[160:163], v[32:35], a[84:87], v[160:163]
    s_lshr_b32 s101, s3, 1
    s_lshl_b32 s19, s100, 13
    ds_read_b64_tr_b16 v[62:63], v15 offset:25600
    v_mfma_f32_16x16x32_bf16 v[192:195], v[32:35], a[88:91], v[192:195]
    buffer_load_dwordx4 a[164:167], v1, s[8:11], s80 offen offset:0
    v_mfma_f32_16x16x32_bf16 v[224:227], v[32:35], a[92:95], v[224:227]
    s_add_u32 s19, s19, 65536
    v_add_u32 v18, s19, v1
    v_mfma_f32_16x16x32_bf16 v[132:135], v[36:39], a[80:83], v[132:135]
    s_mul_i32 s19, s100, 12288
    s_add_u32 s19, s19, 98304
    ds_read_b64_tr_b16 v[32:33], v8 offset:49152
    v_mfma_f32_16x16x32_bf16 v[164:167], v[36:39], a[84:87], v[164:167]
    ds_read_b64_tr_b16 v[34:35], v8 offset:50176
    v_add_u32 v19, s19, v1
    v_mfma_f32_16x16x32_bf16 v[196:199], v[36:39], a[88:91], v[196:199]
    v_mfma_f32_16x16x32_bf16 v[228:231], v[36:39], a[92:95], v[228:231]
    v_mfma_f32_16x16x32_bf16 v[136:139], v[40:43], a[80:83], v[136:139]
    s_xor_b32 s80, s76, 10240
    s_lshl_b32 s19, s100, 12
    ds_read_b64_tr_b16 v[36:37], v9 offset:49152
    v_mfma_f32_16x16x32_bf16 v[168:171], v[40:43], a[84:87], v[168:171]
    s_add_u32 s19, s19, 98304
    ds_read_b64_tr_b16 v[38:39], v9 offset:50176
    v_add_u32 v20, s19, v1
    v_mfma_f32_16x16x32_bf16 v[200:203], v[40:43], a[88:91], v[200:203]
    buffer_load_dwordx4 a[168:171], v1, s[8:11], s80 offen offset:0
    v_mfma_f32_16x16x32_bf16 v[232:235], v[40:43], a[92:95], v[232:235]
    v_and_b32 v23, 15, v2
    v_lshrrev_b32 v24, 4, v2
    v_mfma_f32_16x16x32_bf16 v[140:143], v[44:47], a[80:83], v[140:143]
    ds_read_b64_tr_b16 v[40:41], v10 offset:49152
    v_lshlrev_b32 v116, 2, v0
    v_mfma_f32_16x16x32_bf16 v[172:175], v[44:47], a[84:87], v[172:175]
    ds_read_b64_tr_b16 v[42:43], v10 offset:50176
    v_cmp_gt_u32 vcc, 8, v0
    v_mfma_f32_16x16x32_bf16 v[204:207], v[44:47], a[88:91], v[204:207]
    v_mov_b32 v117, 2147479552
    v_cndmask_b32 v116, v117, v116, vcc
    v_mfma_f32_16x16x32_bf16 v[236:239], v[44:47], a[92:95], v[236:239]
    s_waitcnt lgkmcnt(4)
    v_lshlrev_b32 v25, 2, v24
    v_sub_u32 v25, v23, v25
    v_mfma_f32_16x16x32_bf16 v[144:147], v[48:51], a[80:83], v[144:147]
    s_xor_b32 s80, s76, 26624
    s_lshl_b32 s70, s2, 5
    ds_read_b64_tr_b16 v[44:45], v11 offset:49152
    v_mfma_f32_16x16x32_bf16 v[176:179], v[48:51], a[84:87], v[176:179]
    s_add_u32 s70, s70, 20480
    ds_read_b64_tr_b16 v[46:47], v11 offset:50176
    v_and_b32 v119, 3, v2
    v_mfma_f32_16x16x32_bf16 v[208:211], v[48:51], a[88:91], v[208:211]
    buffer_load_dwordx4 a[172:175], v1, s[8:11], s80 offen offset:0
    v_mfma_f32_16x16x32_bf16 v[240:243], v[48:51], a[92:95], v[240:243]
    s_sub_i32 s19, s101, s100
    s_lshl_b32 s19, s19, 5
    v_lshlrev_b32 v119, 9, v119
    v_mfma_f32_16x16x32_bf16 v[148:151], v[52:55], a[80:83], v[148:151]
    s_lshr_b32 s69, s2, 6
    s_add_u32 s69, s69, 4
    ds_read_b64_tr_b16 v[48:49], v12 offset:49152
    v_mfma_f32_16x16x32_bf16 v[180:183], v[52:55], a[84:87], v[180:183]
    s_xor_b32 s80, s75, 10240
    s_lshl_b32 s69, s69, 5
    ds_read_b64_tr_b16 v[50:51], v12 offset:50176
    v_mfma_f32_16x16x32_bf16 v[212:215], v[52:55], a[88:91], v[212:215]
    buffer_load_dwordx4 a[176:179], v1, s[8:11], s80 offen offset:1024
    v_mfma_f32_16x16x32_bf16 v[244:247], v[52:55], a[92:95], v[244:247]
    s_bfe_u32 s68, s2, 196611
    s_add_u32 s69, s69, s68
    s_lshl_b32 s69, s69, 6
    v_mfma_f32_16x16x32_bf16 v[152:155], v[56:59], a[80:83], v[152:155]
    s_add_u32 s69, s69, 1310720
    ds_read_b64_tr_b16 v[52:53], v13 offset:49152
    v_add_u32 v21, s19, v25
    v_mfma_f32_16x16x32_bf16 v[184:187], v[56:59], a[84:87], v[184:187]
    s_add_u32 s19, s101, s100
    s_sub_i32 s19, 1, s19
    ds_read_b64_tr_b16 v[54:55], v13 offset:50176
    v_mfma_f32_16x16x32_bf16 v[216:219], v[56:59], a[88:91], v[216:219]
    buffer_load_dword v118, v119, s[8:11], s69 offen sc0 sc1
    v_mfma_f32_16x16x32_bf16 v[248:251], v[56:59], a[92:95], v[248:251]
    s_lshl_b32 s19, s19, 5
    v_add_u32 v22, s19, v25
    v_cvt_f32_i32 v21, v21
    v_mfma_f32_16x16x32_bf16 v[156:159], v[60:63], a[80:83], v[156:159]
    s_xor_b32 s80, s75, 26624
    ds_read_b64_tr_b16 v[56:57], v14 offset:49152
    v_cvt_f32_i32 v22, v22
    v_mfma_f32_16x16x32_bf16 v[188:191], v[60:63], a[84:87], v[188:191]
    ds_read_b64_tr_b16 v[58:59], v14 offset:50176
    v_add_f32 v21, 0.5, v21
    v_mfma_f32_16x16x32_bf16 v[220:223], v[60:63], a[88:91], v[220:223]
    buffer_load_dwordx4 a[180:183], v1, s[8:11], s80 offen offset:1024
    v_mfma_f32_16x16x32_bf16 v[252:255], v[60:63], a[92:95], v[252:255]
    v_add_f32 v22, 0.5, v22
    v_mul_f32 v21, 0x71800000, v21
    v_mfma_f32_16x16x32_bf16 v[128:131], v[32:35], a[96:99], v[128:131]
    ds_read_b64_tr_b16 v[60:61], v15 offset:49152
    v_mul_f32 v22, 0x71800000, v22
    v_mfma_f32_16x16x32_bf16 v[160:163], v[32:35], a[100:103], v[160:163]
    ds_read_b64_tr_b16 v[62:63], v15 offset:50176
    v_lshrrev_b32 v25, 2, v23
    v_mfma_f32_16x16x32_bf16 v[192:195], v[32:35], a[104:107], v[192:195]
    s_waitcnt vmcnt(20)
    v_and_b32 v23, 3, v23
    v_lshlrev_b32 v23, 6, v23
    v_mfma_f32_16x16x32_bf16 v[224:227], v[32:35], a[108:111], v[224:227]
    s_waitcnt lgkmcnt(4)
    v_mfma_f32_16x16x32_bf16 v[132:135], v[36:39], a[96:99], v[132:135]
    s_xor_b32 s80, s76, 10240
    ds_read_b64_tr_b16 v[32:33], v8 offset:57344
    v_lshl_add_u32 v23, v25, 15, v23
    v_mfma_f32_16x16x32_bf16 v[164:167], v[36:39], a[100:103], v[164:167]
    ds_read_b64_tr_b16 v[34:35], v8 offset:58368
    v_lshl_add_u32 v23, v24, 4, v23
    v_mfma_f32_16x16x32_bf16 v[196:199], v[36:39], a[104:107], v[196:199]
    buffer_load_dwordx4 a[184:187], v1, s[8:11], s80 offen offset:1024
    v_mfma_f32_16x16x32_bf16 v[228:231], v[36:39], a[108:111], v[228:231]
    v_mfma_f32_16x16x32_bf16 v[136:139], v[40:43], a[96:99], v[136:139]
    s_lshl_b32 s18, s6, 20
    s_lshl_b32 s19, s3, 18
    ds_read_b64_tr_b16 v[36:37], v9 offset:57344
    v_mfma_f32_16x16x32_bf16 v[168:171], v[40:43], a[100:103], v[168:171]
    s_add_u32 s18, s18, s19
    s_lshl_b32 s19, s7, 10
    ds_read_b64_tr_b16 v[38:39], v9 offset:58368
    v_mfma_f32_16x16x32_bf16 v[200:203], v[40:43], a[104:107], v[200:203]
    s_add_u32 s18, s18, s19
    s_add_u32 s18, s18, 67108864
    s_mov_b32 s13, s60
    v_mfma_f32_16x16x32_bf16 v[232:235], v[40:43], a[108:111], v[232:235]
    v_mfma_f32_16x16x32_bf16 v[140:143], v[44:47], a[96:99], v[140:143]
    s_xor_b32 s80, s76, 26624
    s_mov_b32 s12, 2
    ds_read_b64_tr_b16 v[40:41], v10 offset:57344
    v_mfma_f32_16x16x32_bf16 v[172:175], v[44:47], a[100:103], v[172:175]
    s_mov_b32 s25, 0
    s_mov_b32 s26, 28
    ds_read_b64_tr_b16 v[42:43], v10 offset:58368
    v_mfma_f32_16x16x32_bf16 v[204:207], v[44:47], a[104:107], v[204:207]
    buffer_load_dwordx4 a[188:191], v1, s[8:11], s80 offen offset:1024
    v_mfma_f32_16x16x32_bf16 v[236:239], v[44:47], a[108:111], v[236:239]
    s_mov_b32 s64, 128
    s_lshl_b32 s65, s5, 1
    s_and_b32 s65, s65, 7
    v_mfma_f32_16x16x32_bf16 v[144:147], v[48:51], a[96:99], v[144:147]
    s_xor_b32 s65, s65, s3
    s_lshl_b32 s65, s65, 16
    ds_read_b64_tr_b16 v[44:45], v11 offset:57344
    v_mfma_f32_16x16x32_bf16 v[176:179], v[48:51], a[100:103], v[176:179]
    s_xor_b32 s80, s75, 12288
    s_add_u32 s15, s62, 65536
    ds_read_b64_tr_b16 v[46:47], v11 offset:58368
    v_mfma_f32_16x16x32_bf16 v[208:211], v[48:51], a[104:107], v[208:211]
    buffer_load_dwordx4 a[192:195], v1, s[8:11], s80 offen offset:0
    v_mfma_f32_16x16x32_bf16 v[240:243], v[48:51], a[108:111], v[240:243]
    s_add_u32 s16, s62, 0
    s_lshl_b32 s20, s7, 13
    s_lshl_b32 s19, s100, 11
    v_mfma_f32_16x16x32_bf16 v[148:151], v[52:55], a[96:99], v[148:151]
    s_add_u32 s20, s20, s19
    s_add_u32 s20, s20, 50331648
    ds_read_b64_tr_b16 v[48:49], v12 offset:57344
    v_mfma_f32_16x16x32_bf16 v[180:183], v[52:55], a[100:103], v[180:183]
    s_sub_u32 s19, 3, s101
    s_lshl_b32 s19, s19, 18
    ds_read_b64_tr_b16 v[50:51], v12 offset:58368
    v_mfma_f32_16x16x32_bf16 v[212:215], v[52:55], a[104:107], v[212:215]
    s_add_u32 s21, s20, s19
    s_lshl_b32 s19, s101, 18
    s_add_u32 s20, s20, s19
    v_mfma_f32_16x16x32_bf16 v[244:247], v[52:55], a[108:111], v[244:247]
    s_waitcnt lgkmcnt(4)
    v_mfma_f32_16x16x32_bf16 v[152:155], v[56:59], a[96:99], v[152:155]
    s_xor_b32 s80, s75, 28672
    s_add_u32 s22, s72, 131072
    ds_read_b64_tr_b16 v[52:53], v13 offset:57344
    v_mfma_f32_16x16x32_bf16 v[184:187], v[56:59], a[100:103], v[184:187]
    s_and_b32 s23, s2, 231
    s_lshl_b32 s23, s23, 8
    ds_read_b64_tr_b16 v[54:55], v13 offset:58368
    v_mfma_f32_16x16x32_bf16 v[216:219], v[56:59], a[104:107], v[216:219]
    buffer_load_dwordx4 a[196:199], v1, s[8:11], s80 offen offset:0
    v_mfma_f32_16x16x32_bf16 v[248:251], v[56:59], a[108:111], v[248:251]
    s_sub_u32 s19, 3, s3
    s_min_u32 s19, s19, s3
    s_lshl_b32 s19, s19, 7
    v_mfma_f32_16x16x32_bf16 v[156:159], v[60:63], a[96:99], v[156:159]
    s_add_u32 s23, s23, s19
    s_add_u32 s23, s23, 1179648
    ds_read_b64_tr_b16 v[56:57], v14 offset:57344
    v_mfma_f32_16x16x32_bf16 v[188:191], v[60:63], a[100:103], v[188:191]
    s_lshl_b32 s71, s2, 2
    s_add_u32 s71, s71, s3
    ds_read_b64_tr_b16 v[58:59], v14 offset:58368
    v_mfma_f32_16x16x32_bf16 v[220:223], v[60:63], a[104:107], v[220:223]
    s_and_b32 s100, s71, 31
    s_lshr_b32 s101, s71, 5
    s_sub_u32 s101, s101, 4
    v_mfma_f32_16x16x32_bf16 v[252:255], v[60:63], a[108:111], v[252:255]
    s_waitcnt vmcnt(23)
    v_mfma_f32_16x16x32_bf16 v[128:131], v[32:35], a[112:115], v[128:131]
    s_waitcnt vmcnt(22)
    s_xor_b32 s80, s76, 12288
    s_and_b32 s101, s101, 31
    ds_read_b64_tr_b16 v[60:61], v15 offset:57344
    v_mfma_f32_16x16x32_bf16 v[160:163], v[32:35], a[116:119], v[160:163]
    s_waitcnt vmcnt(20)
    ds_read_b64_tr_b16 v[62:63], v15 offset:58368
    v_and_b32 v121, 7, v2
    v_mfma_f32_16x16x32_bf16 v[192:195], v[32:35], a[120:123], v[192:195]
    buffer_load_dwordx4 a[200:203], v1, s[8:11], s80 offen offset:0
    v_mfma_f32_16x16x32_bf16 v[224:227], v[32:35], a[124:127], v[224:227]
    v_and_b32 v120, 4, v121
    v_and_b32 v122, 2, v121
    v_mfma_f32_16x16x32_bf16 v[132:135], v[36:39], a[112:115], v[132:135]
    v_lshl_add_u32 v120, v122, 3, v120
    v_and_b32 v122, 1, v121
    v_mfma_f32_16x16x32_bf16 v[164:167], v[36:39], a[116:119], v[164:167]
    v_lshl_add_u32 v120, v122, 1, v120
    v_mul_u32_u24 v120, 3584, v120
    v_mfma_f32_16x16x32_bf16 v[196:199], v[36:39], a[120:123], v[196:199]
    v_lshrrev_b32 v122, 3, v2
    v_lshl_add_u32 v120, v122, 4, v120
    v_mfma_f32_16x16x32_bf16 v[228:231], v[36:39], a[124:127], v[228:231]
    v_lshlrev_b32 v121, 13, v121
    v_lshl_add_u32 v121, v122, 4, v121
    v_mfma_f32_16x16x32_bf16 v[136:139], v[40:43], a[112:115], v[136:139]
    s_xor_b32 s80, s76, 28672
    v_subrev_u32 v8, 98304, v8
    v_subrev_u32 v9, 98304, v9
    s_waitcnt lgkmcnt(0)
    s_barrier
    v_mfma_f32_16x16x32_bf16 v[168:171], v[40:43], a[116:119], v[168:171]
    s_lshr_b32 s71, s100, 1
    s_lshl_b32 s71, s71, 2
    ds_read_b64_tr_b16 v[32:33], v8 offset:0
    v_mfma_f32_16x16x32_bf16 v[200:203], v[40:43], a[120:123], v[200:203]
    s_and_b32 s100, s100, 1
    s_add_u32 s71, s71, s100
    ds_read_b64_tr_b16 v[34:35], v8 offset:1024
    v_mfma_f32_16x16x32_bf16 v[232:235], v[40:43], a[124:127], v[232:235]
    s_mul_i32 s71, s71, 28672
    ds_read_b64_tr_b16 v[36:37], v9 offset:0
    v_subrev_u32 v10, 98304, v10
    v_mfma_f32_16x16x32_bf16 v[140:143], v[44:47], a[112:115], v[140:143]
    s_lshl_b32 s100, s101, 7
    s_add_u32 s71, s71, s100
    ds_read_b64_tr_b16 v[38:39], v9 offset:1024
    s_waitcnt vmcnt(6)
    v_cmp_ne_u32 vcc, 0, v118
    s_cmp_eq_u64 vcc, -1
    s_cbranch_scc0 L_E2_slow_5
L_E2_ok_6:
    v_mfma_f32_16x16x32_bf16 v[172:175], v[44:47], a[116:119], v[172:175]
    s_cmp_lt_u32 s101, 28
    s_cselect_b32 s71, s71, 2147479552
    ds_read_b64_tr_b16 v[40:41], v10 offset:0
    v_mfma_f32_16x16x32_bf16 v[204:207], v[44:47], a[120:123], v[204:207]
    ds_read_b64_tr_b16 v[42:43], v10 offset:1024
    v_mfma_f32_16x16x32_bf16 v[236:239], v[44:47], a[124:127], v[236:239]
    v_subrev_u32 v11, 98304, v11
    v_mfma_f32_16x16x32_bf16 v[144:147], v[48:51], a[112:115], v[144:147]
    ds_read_b64_tr_b16 v[44:45], v11 offset:0
    v_mfma_f32_16x16x32_bf16 v[176:179], v[48:51], a[116:119], v[176:179]
    ds_read_b64_tr_b16 v[46:47], v11 offset:1024
    v_mfma_f32_16x16x32_bf16 v[208:211], v[48:51], a[120:123], v[208:211]
    buffer_load_dwordx4 a[204:207], v1, s[8:11], s80 offen offset:0
    v_mfma_f32_16x16x32_bf16 v[240:243], v[48:51], a[124:127], v[240:243]
    s_xor_b32 s80, s75, 12288
    v_subrev_u32 v12, 98304, v12
    v_mfma_f32_16x16x32_bf16 v[148:151], v[52:55], a[112:115], v[148:151]
    ds_read_b64_tr_b16 v[48:49], v12 offset:0
    v_mfma_f32_16x16x32_bf16 v[180:183], v[52:55], a[116:119], v[180:183]
    ds_read_b64_tr_b16 v[50:51], v12 offset:1024
    v_mfma_f32_16x16x32_bf16 v[212:215], v[52:55], a[120:123], v[212:215]
    buffer_load_dwordx4 a[208:211], v1, s[8:11], s80 offen offset:1024
    v_mfma_f32_16x16x32_bf16 v[244:247], v[52:55], a[124:127], v[244:247]
    s_xor_b32 s80, s75, 28672
    v_subrev_u32 v13, 98304, v13
    v_mfma_f32_16x16x32_bf16 v[152:155], v[56:59], a[112:115], v[152:155]
    ds_read_b64_tr_b16 v[52:53], v13 offset:0
    v_mfma_f32_16x16x32_bf16 v[184:187], v[56:59], a[116:119], v[184:187]
    ds_read_b64_tr_b16 v[54:55], v13 offset:1024
    v_mfma_f32_16x16x32_bf16 v[216:219], v[56:59], a[120:123], v[216:219]
    buffer_load_dwordx4 a[212:215], v1, s[8:11], s80 offen offset:1024
    v_mfma_f32_16x16x32_bf16 v[248:251], v[56:59], a[124:127], v[248:251]
    s_xor_b32 s80, s76, 12288
    v_subrev_u32 v14, 98304, v14
    v_mfma_f32_16x16x32_bf16 v[156:159], v[60:63], a[112:115], v[156:159]
    ds_read_b64_tr_b16 v[56:57], v14 offset:0
    v_mfma_f32_16x16x32_bf16 v[188:191], v[60:63], a[116:119], v[188:191]
    ds_read_b64_tr_b16 v[58:59], v14 offset:1024
    v_mfma_f32_16x16x32_bf16 v[220:223], v[60:63], a[120:123], v[220:223]
    buffer_load_dwordx4 a[216:219], v1, s[8:11], s80 offen offset:1024
    v_mfma_f32_16x16x32_bf16 v[252:255], v[60:63], a[124:127], v[252:255]
    s_waitcnt lgkmcnt(4)
    v_subrev_u32 v15, 98304, v15
    v_mfma_f32_16x16x32_bf16 v[128:131], v[32:35], a[128:131], v[128:131]
    ds_read_b64_tr_b16 v[60:61], v15 offset:0
    v_mfma_f32_16x16x32_bf16 v[160:163], v[32:35], a[132:135], v[160:163]
    ds_read_b64_tr_b16 v[62:63], v15 offset:1024
    v_mfma_f32_16x16x32_bf16 v[192:195], v[32:35], a[136:139], v[192:195]
    buffer_load_dword v112, v116, s[8:11], s70 offen
    v_mfma_f32_16x16x32_bf16 v[224:227], v[32:35], a[140:143], v[224:227]
    buffer_load_dword v3, v17, s[8:11], s74 offen sc0 sc1
    v_mfma_f32_16x16x32_bf16 v[132:135], v[36:39], a[128:131], v[132:135]
    s_xor_b32 s80, s76, 28672
    s_add_u32 s70, s70, 12288
    ds_read_b64_tr_b16 v[32:33], v8 offset:8192
    v_mfma_f32_16x16x32_bf16 v[164:167], v[36:39], a[132:135], v[164:167]
    ds_read_b64_tr_b16 v[34:35], v8 offset:9216
    v_mfma_f32_16x16x32_bf16 v[196:199], v[36:39], a[136:139], v[196:199]
    buffer_load_dwordx4 a[220:223], v1, s[8:11], s80 offen offset:1024
    v_mfma_f32_16x16x32_bf16 v[228:231], v[36:39], a[140:143], v[228:231]
    buffer_load_dword v113, v116, s[8:11], s70 offen
    v_mfma_f32_16x16x32_bf16 v[136:139], v[40:43], a[128:131], v[136:139]
    s_add_u32 s70, s70, 12288
    ds_read_b64_tr_b16 v[36:37], v9 offset:8192
    v_mfma_f32_16x16x32_bf16 v[168:171], v[40:43], a[132:135], v[168:171]
    s_xor_b32 s80, s75, 14336
    ds_read_b64_tr_b16 v[38:39], v9 offset:9216
    v_mfma_f32_16x16x32_bf16 v[200:203], v[40:43], a[136:139], v[200:203]
    buffer_load_dwordx4 a[224:227], v1, s[8:11], s80 offen offset:0
    v_mfma_f32_16x16x32_bf16 v[232:235], v[40:43], a[140:143], v[232:235]
    buffer_load_dword v114, v116, s[8:11], s70 offen
    v_mfma_f32_16x16x32_bf16 v[140:143], v[44:47], a[128:131], v[140:143]
    s_add_u32 s70, s70, 12288
    ds_read_b64_tr_b16 v[40:41], v10 offset:8192
    v_mfma_f32_16x16x32_bf16 v[172:175], v[44:47], a[132:135], v[172:175]
    ds_read_b64_tr_b16 v[42:43], v10 offset:9216
    v_mfma_f32_16x16x32_bf16 v[204:207], v[44:47], a[136:139], v[204:207]
    buffer_load_dword v115, v116, s[8:11], s70 offen
    v_mfma_f32_16x16x32_bf16 v[236:239], v[44:47], a[140:143], v[236:239]
    v_mfma_f32_16x16x32_bf16 v[144:147], v[48:51], a[128:131], v[144:147]
    s_xor_b32 s80, s75, 30720
    s_add_u32 s70, s70, 12288
    ds_read_b64_tr_b16 v[44:45], v11 offset:8192
    v_mfma_f32_16x16x32_bf16 v[176:179], v[48:51], a[132:135], v[176:179]
    ds_read_b64_tr_b16 v[46:47], v11 offset:9216
    v_mfma_f32_16x16x32_bf16 v[208:211], v[48:51], a[136:139], v[208:211]
    buffer_load_dwordx4 a[228:231], v1, s[8:11], s80 offen offset:0
    v_mfma_f32_16x16x32_bf16 v[240:243], v[48:51], a[140:143], v[240:243]
    s_waitcnt lgkmcnt(4)
    v_mfma_f32_16x16x32_bf16 v[148:151], v[52:55], a[128:131], v[148:151]
    ds_read_b64_tr_b16 v[48:49], v12 offset:8192
    v_mfma_f32_16x16x32_bf16 v[180:183], v[52:55], a[132:135], v[180:183]
    ds_read_b64_tr_b16 v[50:51], v12 offset:9216
    v_mfma_f32_16x16x32_bf16 v[212:215], v[52:55], a[136:139], v[212:215]
    v_mfma_f32_16x16x32_bf16 v[244:247], v[52:55], a[140:143], v[244:247]
    v_mfma_f32_16x16x32_bf16 v[152:155], v[56:59], a[128:131], v[152:155]
    s_xor_b32 s80, s76, 14336
    ds_read_b64_tr_b16 v[52:53], v13 offset:8192
    v_mfma_f32_16x16x32_bf16 v[184:187], v[56:59], a[132:135], v[184:187]
    ds_read_b64_tr_b16 v[54:55], v13 offset:9216
    v_mfma_f32_16x16x32_bf16 v[216:219], v[56:59], a[136:139], v[216:219]
    buffer_load_dwordx4 a[232:235], v1, s[8:11], s80 offen offset:0
    s_waitcnt vmcnt(7)
    v_cmp_ne_u32 vcc, 0, v3
    s_cmp_eq_u64 vcc, -1
    s_cbranch_scc0 L_KV_slow_7
L_KV_ok_8:
    v_mfma_f32_16x16x32_bf16 v[248:251], v[56:59], a[140:143], v[248:251]
    v_mfma_f32_16x16x32_bf16 v[156:159], v[60:63], a[128:131], v[156:159]
    s_add_u32 m0, s62, 65536
    s_add_u32 s98, s81, 0
    ds_read_b64_tr_b16 v[56:57], v14 offset:8192
    v_mfma_f32_16x16x32_bf16 v[188:191], v[60:63], a[132:135], v[188:191]
    ds_read_b64_tr_b16 v[58:59], v14 offset:9216
    v_add_u32 v16, s62, v1
    v_mfma_f32_16x16x32_bf16 v[220:223], v[60:63], a[136:139], v[220:223]
    buffer_load_dwordx4 v1, s[8:11], s98 offen offset:0   lds
    v_mfma_f32_16x16x32_bf16 v[252:255], v[60:63], a[140:143], v[252:255]
    v_and_b32 v17, 4294959103, v16
    v_mov_b32 v24, -1
    v_mfma_f32_16x16x32_bf16 v[128:131], v[32:35], a[144:147], v[128:131]
    s_xor_b32 s80, s76, 30720
    ds_read_b64_tr_b16 v[60:61], v15 offset:8192
    v_mov_b32 v28, 0x3f803f80
    v_mfma_f32_16x16x32_bf16 v[160:163], v[32:35], a[148:151], v[160:163]
    ds_read_b64_tr_b16 v[62:63], v15 offset:9216
    v_mov_b32 v25, -1
    v_mfma_f32_16x16x32_bf16 v[192:195], v[32:35], a[152:155], v[192:195]
    buffer_load_dwordx4 a[236:239], v1, s[8:11], s80 offen offset:0
    v_mfma_f32_16x16x32_bf16 v[224:227], v[32:35], a[156:159], v[224:227]
    buffer_load_dwordx4 v1, s[8:11], s98 offen offset:1024   lds
    v_mfma_f32_16x16x32_bf16 v[132:135], v[36:39], a[144:147], v[132:135]
    ds_read_b64_tr_b16 v[32:33], v8 offset:16384
    v_mov_b32 v29, 0x3f803f80
    v_mfma_f32_16x16x32_bf16 v[164:167], v[36:39], a[148:151], v[164:167]
    s_xor_b32 s80, s75, 14336
    ds_read_b64_tr_b16 v[34:35], v8 offset:17408
    v_mov_b32 v26, -1
    v_mfma_f32_16x16x32_bf16 v[196:199], v[36:39], a[152:155], v[196:199]
    buffer_load_dwordx4 a[240:243], v1, s[8:11], s80 offen offset:1024
    v_mfma_f32_16x16x32_bf16 v[228:231], v[36:39], a[156:159], v[228:231]
    s_waitcnt lgkmcnt(4)
    ds_read_b64_tr_b16 a[96:97], v8 offset:49152
    v_mov_b32 v30, 0x3f803f80
    v_mfma_f32_16x16x32_bf16 v[136:139], v[40:43], a[144:147], v[136:139]
    ds_read_b64_tr_b16 v[36:37], v9 offset:16384
    v_mov_b32 v27, -1
    v_mfma_f32_16x16x32_bf16 v[168:171], v[40:43], a[148:151], v[168:171]
    ds_read_b64_tr_b16 v[38:39], v9 offset:17408
    v_mov_b32 v31, 0x3f803f80
    v_mfma_f32_16x16x32_bf16 v[200:203], v[40:43], a[152:155], v[200:203]
    ds_read_b64_tr_b16 a[98:99], v8 offset:50176
    v_mov_b32 v64, 0
    v_mfma_f32_16x16x32_bf16 v[232:235], v[40:43], a[156:159], v[232:235]
    buffer_load_dwordx4 v1, s[8:11], s98 offen offset:2048   lds
    v_mfma_f32_16x16x32_bf16 v[140:143], v[44:47], a[144:147], v[140:143]
    s_xor_b32 s80, s75, 30720
    ds_read_b64_tr_b16 v[40:41], v10 offset:16384
    v_mov_b32 v65, 0
    v_mfma_f32_16x16x32_bf16 v[172:175], v[44:47], a[148:151], v[172:175]
    ds_read_b64_tr_b16 v[42:43], v10 offset:17408
    v_mov_b32 v66, 0
    v_mfma_f32_16x16x32_bf16 v[204:207], v[44:47], a[152:155], v[204:207]
    ds_read_b64_tr_b16 a[100:101], v9 offset:49152
    v_mov_b32 v67, 0
    v_mfma_f32_16x16x32_bf16 v[236:239], v[44:47], a[156:159], v[236:239]
    buffer_load_dwordx4 a[244:247], v1, s[8:11], s80 offen offset:1024
    v_mfma_f32_16x16x32_bf16 v[144:147], v[48:51], a[144:147], v[144:147]
    ds_read_b64_tr_b16 v[44:45], v11 offset:16384
    v_mov_b32 v68, 0
    v_mfma_f32_16x16x32_bf16 v[176:179], v[48:51], a[148:151], v[176:179]
    ds_read_b64_tr_b16 v[46:47], v11 offset:17408
    v_mov_b32 v69, 0
    v_mfma_f32_16x16x32_bf16 v[208:211], v[48:51], a[152:155], v[208:211]
    ds_read_b64_tr_b16 a[102:103], v9 offset:50176
    v_mov_b32 v70, 0
    v_mfma_f32_16x16x32_bf16 v[240:243], v[48:51], a[156:159], v[240:243]
    buffer_load_dwordx4 v1, s[8:11], s98 offen offset:3072   lds
    v_mfma_f32_16x16x32_bf16 v[148:151], v[52:55], a[144:147], v[148:151]
    s_xor_b32 s80, s76, 14336
    s_add_u32 m0, s62, 69632
    ds_read_b64_tr_b16 v[48:49], v12 offset:16384
    v_mfma_f32_16x16x32_bf16 v[180:183], v[52:55], a[148:151], v[180:183]
    s_add_u32 s98, s81, 4096
    ds_read_b64_tr_b16 v[50:51], v12 offset:17408
    v_mov_b32 v71, 0
    v_mfma_f32_16x16x32_bf16 v[212:215], v[52:55], a[152:155], v[212:215]
    ds_read_b64_tr_b16 a[104:105], v10 offset:49152
    v_mov_b32 v72, 0
    v_mfma_f32_16x16x32_bf16 v[244:247], v[52:55], a[156:159], v[244:247]
    buffer_load_dwordx4 a[248:251], v1, s[8:11], s80 offen offset:1024
    v_mfma_f32_16x16x32_bf16 v[152:155], v[56:59], a[144:147], v[152:155]
    ds_read_b64_tr_b16 v[52:53], v13 offset:16384
    v_mov_b32 v73, 0
    v_mfma_f32_16x16x32_bf16 v[184:187], v[56:59], a[148:151], v[184:187]
    ds_read_b64_tr_b16 v[54:55], v13 offset:17408
    v_mov_b32 v74, 0
    v_mfma_f32_16x16x32_bf16 v[216:219], v[56:59], a[152:155], v[216:219]
    s_waitcnt lgkmcnt(7)
    s_xor_b32 s80, s76, 30720
    ds_read_b64_tr_b16 a[106:107], v10 offset:50176
    v_mov_b32 v75, 0
    v_mfma_f32_16x16x32_bf16 v[248:251], v[56:59], a[156:159], v[248:251]
    buffer_load_dwordx4 a[252:255], v1, s[8:11], s80 offen offset:1024
    v_mfma_f32_16x16x32_bf16 v[156:159], v[60:63], a[144:147], v[156:159]
    ds_read_b64_tr_b16 v[56:57], v14 offset:16384
    v_mov_b32 v76, 0
    v_mfma_f32_16x16x32_bf16 v[188:191], v[60:63], a[148:151], v[188:191]
    ds_read_b64_tr_b16 v[58:59], v14 offset:17408
    v_mov_b32 v77, 0
    v_mfma_f32_16x16x32_bf16 v[220:223], v[60:63], a[152:155], v[220:223]
    ds_read_b64_tr_b16 a[108:109], v11 offset:49152
    v_mov_b32 v78, 0
    v_mfma_f32_16x16x32_bf16 v[252:255], v[60:63], a[156:159], v[252:255]
    buffer_load_dwordx4 v1, s[8:11], s98 offen offset:0   lds
    v_mfma_f32_16x16x32_bf16 v[128:131], v[32:35], a[160:163], v[128:131]
    ds_read_b64_tr_b16 v[60:61], v15 offset:16384
    v_mov_b32 v79, 0
    v_mfma_f32_16x16x32_bf16 v[160:163], v[32:35], a[164:167], v[160:163]
    s_cmp_eq_u32 s60, 0
    s_cselect_b32 s19, 0, 0x76800000
    ds_read_b64_tr_b16 v[62:63], v15 offset:17408
    v_add_f32 v3, s19, v21
    v_mfma_f32_16x16x32_bf16 v[192:195], v[32:35], a[168:171], v[192:195]
    ds_read_b64_tr_b16 a[110:111], v11 offset:50176
    v_add_f32 v96, 0, v3
    v_mfma_f32_16x16x32_bf16 v[224:227], v[32:35], a[172:175], v[224:227]
    buffer_load_dwordx4 v1, s[8:11], s98 offen offset:1024   lds
    v_mfma_f32_16x16x32_bf16 v[132:135], v[36:39], a[160:163], v[132:135]
    ds_read_b64_tr_b16 v[32:33], v8 offset:24576
    v_min_f32 v96, v96, v64
    v_mfma_f32_16x16x32_bf16 v[164:167], v[36:39], a[164:167], v[164:167]
    ds_read_b64_tr_b16 v[34:35], v8 offset:25600
    v_add_f32 v97, 0xf1800000, v3
    v_mfma_f32_16x16x32_bf16 v[196:199], v[36:39], a[168:171], v[196:199]
    ds_read_b64_tr_b16 a[112:113], v12 offset:49152
    v_min_f32 v97, v97, v65
    v_mfma_f32_16x16x32_bf16 v[228:231], v[36:39], a[172:175], v[228:231]
    buffer_load_dwordx4 v1, s[8:11], s98 offen offset:2048   lds
    v_mfma_f32_16x16x32_bf16 v[136:139], v[40:43], a[160:163], v[136:139]
    ds_read_b64_tr_b16 v[36:37], v9 offset:24576
    v_add_f32 v98, 0xf2000000, v3
    v_mfma_f32_16x16x32_bf16 v[168:171], v[40:43], a[164:167], v[168:171]
    ds_read_b64_tr_b16 v[38:39], v9 offset:25600
    v_min_f32 v98, v98, v66
    v_mfma_f32_16x16x32_bf16 v[200:203], v[40:43], a[168:171], v[200:203]
    s_waitcnt lgkmcnt(7)
    ds_read_b64_tr_b16 a[114:115], v12 offset:50176
    v_add_f32 v99, 0xf2400000, v3
    v_mfma_f32_16x16x32_bf16 v[232:235], v[40:43], a[172:175], v[232:235]
    buffer_load_dwordx4 v1, s[8:11], s98 offen offset:3072   lds
    v_mfma_f32_16x16x32_bf16 v[140:143], v[44:47], a[160:163], v[140:143]
    s_add_u32 m0, s62, 98304
    ds_read_b64_tr_b16 v[40:41], v10 offset:24576
    s_waitcnt vmcnt(18)
    v_add_f32 v112, v112, v113
    v_mfma_f32_16x16x32_bf16 v[172:175], v[44:47], a[164:167], v[172:175]
    s_add_u32 s98, s81, 32768
    ds_read_b64_tr_b16 v[42:43], v10 offset:25600
    s_waitcnt vmcnt(15)
    v_add_f32 v114, v114, v115
    v_mfma_f32_16x16x32_bf16 v[204:207], v[44:47], a[168:171], v[204:207]
    ds_read_b64_tr_b16 a[116:117], v13 offset:49152
    v_add_f32 v112, v112, v114
    v_mfma_f32_16x16x32_bf16 v[236:239], v[44:47], a[172:175], v[236:239]
    buffer_load_dwordx4 v1, s[8:11], s98 offen offset:0   lds
    v_mfma_f32_16x16x32_bf16 v[144:147], v[48:51], a[160:163], v[144:147]
    ds_read_b64_tr_b16 v[44:45], v11 offset:24576
    v_cvt_pk_bf16_f32 v112, v112, v112
    v_mfma_f32_16x16x32_bf16 v[176:179], v[48:51], a[164:167], v[176:179]
    ds_read_b64_tr_b16 v[46:47], v11 offset:25600
    v_and_b32 v112, 0xffff0000, v112
    v_mfma_f32_16x16x32_bf16 v[208:211], v[48:51], a[168:171], v[208:211]
    s_lshr_b32 s70, s2, 6
    s_cmp_eq_u32 s70, 2
    s_cselect_b32 s70, 1.0, 0
    ds_read_b64_tr_b16 a[118:119], v13 offset:50176
    v_mfma_f32_16x16x32_bf16 v[240:243], v[48:51], a[172:175], v[240:243]
    buffer_load_dwordx4 v1, s[8:11], s98 offen offset:1024   lds
    v_mfma_f32_16x16x32_bf16 v[148:151], v[52:55], a[160:163], v[148:151]
    ds_read_b64_tr_b16 v[48:49], v12 offset:24576
    v_add_f32 v112, s70, v112
    v_mfma_f32_16x16x32_bf16 v[180:183], v[52:55], a[164:167], v[180:183]
    ds_read_b64_tr_b16 v[50:51], v12 offset:25600
    v_cvt_pk_bf16_f32 v112, v112, v112
    v_mfma_f32_16x16x32_bf16 v[212:215], v[52:55], a[168:171], v[212:215]
    ds_read_b64_tr_b16 a[120:121], v14 offset:49152
    v_and_b32 v112, 0xffff0000, v112
    v_mfma_f32_16x16x32_bf16 v[244:247], v[52:55], a[172:175], v[244:247]
    buffer_load_dwordx4 v1, s[8:11], s98 offen offset:2048   lds
    v_mfma_f32_16x16x32_bf16 v[152:155], v[56:59], a[160:163], v[152:155]
    s_lshl_b32 s70, s2, 5
    s_add_u32 s70, s70, 4096
    ds_read_b64_tr_b16 v[52:53], v13 offset:24576
    v_mfma_f32_16x16x32_bf16 v[184:187], v[56:59], a[164:167], v[184:187]
    ds_read_b64_tr_b16 v[54:55], v13 offset:25600
    v_min_f32 v99, v99, v67
    v_mfma_f32_16x16x32_bf16 v[216:219], v[56:59], a[168:171], v[216:219]
    s_waitcnt lgkmcnt(7)
    ds_read_b64_tr_b16 a[122:123], v14 offset:50176
    v_add_f32 v100, 0xf3800000, v3
    v_mfma_f32_16x16x32_bf16 v[248:251], v[56:59], a[172:175], v[248:251]
    buffer_store_dword v112, v116, s[8:11], s70 offen sc0 sc1
    v_mfma_f32_16x16x32_bf16 v[156:159], v[60:63], a[160:163], v[156:159]
    ds_read_b64_tr_b16 v[56:57], v14 offset:24576
    v_min_f32 v100, v100, v64
    v_mfma_f32_16x16x32_bf16 v[188:191], v[60:63], a[164:167], v[188:191]
    ds_read_b64_tr_b16 v[58:59], v14 offset:25600
    v_add_f32 v101, 0xf3880000, v3
    v_mfma_f32_16x16x32_bf16 v[220:223], v[60:63], a[168:171], v[220:223]
    ds_read_b64_tr_b16 a[124:125], v15 offset:49152
    v_min_f32 v101, v101, v65
    v_mfma_f32_16x16x32_bf16 v[252:255], v[60:63], a[172:175], v[252:255]
    buffer_load_dwordx4 v1, s[8:11], s98 offen offset:3072   lds
    v_mfma_f32_16x16x32_bf16 v[128:131], v[32:35], a[176:179], v[128:131]
    s_add_u32 m0, s62, 102400
    s_add_u32 s98, s81, 36864
    ds_read_b64_tr_b16 v[60:61], v15 offset:24576
    v_mfma_f32_16x16x32_bf16 v[160:163], v[32:35], a[180:183], v[160:163]
    ds_read_b64_tr_b16 v[62:63], v15 offset:25600
    v_add_f32 v102, 0xf3900000, v3
    v_mfma_f32_16x16x32_bf16 v[192:195], v[32:35], a[184:187], v[192:195]
    ds_read_b64_tr_b16 a[126:127], v15 offset:50176
    v_min_f32 v102, v102, v66
    v_mfma_f32_16x16x32_bf16 v[224:227], v[32:35], a[188:191], v[224:227]
    buffer_load_dwordx4 v1, s[8:11], s98 offen offset:0   lds
    v_mfma_f32_16x16x32_bf16 v[132:135], v[36:39], a[176:179], v[132:135]
    ds_read_b64_tr_b16 v[32:33], v8 offset:32768
    v_add_f32 v103, 0xf3980000, v3
    v_mfma_f32_16x16x32_bf16 v[164:167], v[36:39], a[180:183], v[164:167]
    ds_read_b64_tr_b16 v[34:35], v8 offset:33792
    v_min_f32 v103, v103, v67
    v_mfma_f32_16x16x32_bf16 v[196:199], v[36:39], a[184:187], v[196:199]
    ds_read_b64_tr_b16 a[64:65], v8 offset:57344
    v_add_f32 v104, 0x73800000, v3
    v_mfma_f32_16x16x32_bf16 v[228:231], v[36:39], a[188:191], v[228:231]
    buffer_load_dwordx4 v1, s[8:11], s98 offen offset:1024   lds
    v_mfma_f32_16x16x32_bf16 v[136:139], v[40:43], a[176:179], v[136:139]
    ds_read_b64_tr_b16 v[36:37], v9 offset:32768
    v_min_f32 v104, v104, v68
    v_mfma_f32_16x16x32_bf16 v[168:171], v[40:43], a[180:183], v[168:171]
    ds_read_b64_tr_b16 v[38:39], v9 offset:33792
    v_add_f32 v105, 0x73700000, v3
    v_mfma_f32_16x16x32_bf16 v[200:203], v[40:43], a[184:187], v[200:203]
    s_waitcnt lgkmcnt(7)
    ds_read_b64_tr_b16 a[66:67], v8 offset:58368
    v_min_f32 v105, v105, v69
    v_mfma_f32_16x16x32_bf16 v[232:235], v[40:43], a[188:191], v[232:235]
    buffer_load_dwordx4 v1, s[8:11], s98 offen offset:2048   lds
    v_mfma_f32_16x16x32_bf16 v[140:143], v[44:47], a[176:179], v[140:143]
    ds_read_b64_tr_b16 v[40:41], v10 offset:32768
    v_add_f32 v106, 0x73600000, v3
    v_mfma_f32_16x16x32_bf16 v[172:175], v[44:47], a[180:183], v[172:175]
    ds_read_b64_tr_b16 v[42:43], v10 offset:33792
    v_min_f32 v106, v106, v70
    v_mfma_f32_16x16x32_bf16 v[204:207], v[44:47], a[184:187], v[204:207]
    ds_read_b64_tr_b16 a[68:69], v9 offset:57344
    v_add_f32 v107, 0x73500000, v3
    v_mfma_f32_16x16x32_bf16 v[236:239], v[44:47], a[188:191], v[236:239]
    buffer_load_dwordx4 v1, s[8:11], s98 offen offset:3072   lds
    v_mfma_f32_16x16x32_bf16 v[144:147], v[48:51], a[176:179], v[144:147]
    s_add_u32 m0, s62, 131072
    s_add_u32 s98, s82, 0
    ds_read_b64_tr_b16 v[44:45], v11 offset:32768
    v_mfma_f32_16x16x32_bf16 v[176:179], v[48:51], a[180:183], v[176:179]
    ds_read_b64_tr_b16 v[46:47], v11 offset:33792
    v_min_f32 v107, v107, v71
    v_mfma_f32_16x16x32_bf16 v[208:211], v[48:51], a[184:187], v[208:211]
    ds_read_b64_tr_b16 a[70:71], v9 offset:58368
    v_add_f32 v108, 0, v3
    v_mfma_f32_16x16x32_bf16 v[240:243], v[48:51], a[188:191], v[240:243]
    buffer_load_dwordx4 v1, s[8:11], s98 offen offset:0   lds
    v_mfma_f32_16x16x32_bf16 v[148:151], v[52:55], a[176:179], v[148:151]
    ds_read_b64_tr_b16 v[48:49], v12 offset:32768
    v_min_f32 v108, v108, v68
    v_mfma_f32_16x16x32_bf16 v[180:183], v[52:55], a[180:183], v[180:183]
    ds_read_b64_tr_b16 v[50:51], v12 offset:33792
    v_add_f32 v109, 0xf1800000, v3
    v_mfma_f32_16x16x32_bf16 v[212:215], v[52:55], a[184:187], v[212:215]
    ds_read_b64_tr_b16 a[72:73], v10 offset:57344
    v_min_f32 v109, v109, v69
    v_mfma_f32_16x16x32_bf16 v[244:247], v[52:55], a[188:191], v[244:247]
    buffer_load_dwordx4 v1, s[8:11], s98 offen offset:1024   lds
    v_mfma_f32_16x16x32_bf16 v[152:155], v[56:59], a[176:179], v[152:155]
    ds_read_b64_tr_b16 v[52:53], v13 offset:32768
    v_add_f32 v110, 0xf2000000, v3
    v_mfma_f32_16x16x32_bf16 v[184:187], v[56:59], a[180:183], v[184:187]
    ds_read_b64_tr_b16 v[54:55], v13 offset:33792
    v_min_f32 v110, v110, v70
    v_mfma_f32_16x16x32_bf16 v[216:219], v[56:59], a[184:187], v[216:219]
    s_waitcnt lgkmcnt(7)
    ds_read_b64_tr_b16 a[74:75], v10 offset:58368
    v_add_f32 v111, 0xf2400000, v3
    v_mfma_f32_16x16x32_bf16 v[248:251], v[56:59], a[188:191], v[248:251]
    buffer_load_dwordx4 v1, s[8:11], s98 offen offset:2048   lds
    v_mfma_f32_16x16x32_bf16 v[156:159], v[60:63], a[176:179], v[156:159]
    ds_read_b64_tr_b16 v[56:57], v14 offset:32768
    v_min_f32 v111, v111, v71
    v_mfma_f32_16x16x32_bf16 v[188:191], v[60:63], a[180:183], v[188:191]
    s_cmp_eq_u32 s60, 0
    s_cselect_b32 s19, 1.0, 0
    ds_read_b64_tr_b16 v[58:59], v14 offset:33792
    v_sub_f32 v3, v22, v21
    v_mfma_f32_16x16x32_bf16 v[220:223], v[60:63], a[184:187], v[220:223]
    ds_read_b64_tr_b16 a[76:77], v11 offset:57344
    v_fma_f32 v3, s19, v3, v21
    v_mfma_f32_16x16x32_bf16 v[252:255], v[60:63], a[188:191], v[252:255]
    buffer_load_dwordx4 v1, s[8:11], s98 offen offset:3072   lds
    v_mfma_f32_16x16x32_bf16 v[128:131], v[32:35], a[192:195], v[128:131]
    s_add_u32 m0, s62, 135168
    s_add_u32 s98, s82, 4096
    ds_read_b64_tr_b16 v[60:61], v15 offset:32768
    v_mfma_f32_16x16x32_bf16 v[160:163], v[32:35], a[196:199], v[160:163]
    ds_read_b64_tr_b16 v[62:63], v15 offset:33792
    v_add_f32 v80, 0, v3
    v_mfma_f32_16x16x32_bf16 v[192:195], v[32:35], a[200:203], v[192:195]
    ds_read_b64_tr_b16 a[78:79], v11 offset:58368
    v_min_f32 v80, v80, v64
    v_mfma_f32_16x16x32_bf16 v[224:227], v[32:35], a[204:207], v[224:227]
    buffer_load_dwordx4 v1, s[8:11], s98 offen offset:0   lds
    v_mfma_f32_16x16x32_bf16 v[132:135], v[36:39], a[192:195], v[132:135]
    ds_read_b64_tr_b16 v[32:33], v8 offset:40960
    v_add_f32 v81, 0xf1800000, v3
    v_mfma_f32_16x16x32_bf16 v[164:167], v[36:39], a[196:199], v[164:167]
    ds_read_b64_tr_b16 v[34:35], v8 offset:41984
    v_min_f32 v81, v81, v65
    v_mfma_f32_16x16x32_bf16 v[196:199], v[36:39], a[200:203], v[196:199]
    ds_read_b64_tr_b16 a[80:81], v12 offset:57344
    v_add_f32 v82, 0xf2000000, v3
    v_mfma_f32_16x16x32_bf16 v[228:231], v[36:39], a[204:207], v[228:231]
    buffer_load_dwordx4 v1, s[8:11], s98 offen offset:1024   lds
    v_mfma_f32_16x16x32_bf16 v[136:139], v[40:43], a[192:195], v[136:139]
    ds_read_b64_tr_b16 v[36:37], v9 offset:40960
    v_min_f32 v82, v82, v66
    v_mfma_f32_16x16x32_bf16 v[168:171], v[40:43], a[196:199], v[168:171]
    ds_read_b64_tr_b16 v[38:39], v9 offset:41984
    v_add_f32 v83, 0xf2400000, v3
    v_mfma_f32_16x16x32_bf16 v[200:203], v[40:43], a[200:203], v[200:203]
    s_waitcnt lgkmcnt(7)
    ds_read_b64_tr_b16 a[82:83], v12 offset:58368
    v_min_f32 v83, v83, v67
    v_mfma_f32_16x16x32_bf16 v[232:235], v[40:43], a[204:207], v[232:235]
    buffer_load_dwordx4 v1, s[8:11], s98 offen offset:2048   lds
    v_mfma_f32_16x16x32_bf16 v[140:143], v[44:47], a[192:195], v[140:143]
    ds_read_b64_tr_b16 v[40:41], v10 offset:40960
    v_add_f32 v84, 0xf3800000, v3
    v_mfma_f32_16x16x32_bf16 v[172:175], v[44:47], a[196:199], v[172:175]
    ds_read_b64_tr_b16 v[42:43], v10 offset:41984
    v_min_f32 v84, v84, v64
    v_mfma_f32_16x16x32_bf16 v[204:207], v[44:47], a[200:203], v[204:207]
    ds_read_b64_tr_b16 a[84:85], v13 offset:57344
    v_add_f32 v85, 0xf3880000, v3
    v_mfma_f32_16x16x32_bf16 v[236:239], v[44:47], a[204:207], v[236:239]
    buffer_load_dwordx4 v1, s[8:11], s98 offen offset:3072   lds
    v_mfma_f32_16x16x32_bf16 v[144:147], v[48:51], a[192:195], v[144:147]
    ds_read_b64_tr_b16 v[44:45], v11 offset:40960
    v_min_f32 v85, v85, v65
    v_mfma_f32_16x16x32_bf16 v[176:179], v[48:51], a[196:199], v[176:179]
    ds_read_b64_tr_b16 v[46:47], v11 offset:41984
    v_add_f32 v86, 0xf3900000, v3
    v_mfma_f32_16x16x32_bf16 v[208:211], v[48:51], a[200:203], v[208:211]
    ds_read_b64_tr_b16 a[86:87], v13 offset:58368
    v_min_f32 v86, v86, v66
    v_mfma_f32_16x16x32_bf16 v[240:243], v[48:51], a[204:207], v[240:243]
    buffer_load_dwordx4 a[0:3], v120, s[40:43], s71 offen
    v_mfma_f32_16x16x32_bf16 v[148:151], v[52:55], a[192:195], v[148:151]
    ds_read_b64_tr_b16 v[48:49], v12 offset:40960
    v_add_f32 v87, 0xf3980000, v3
    v_mfma_f32_16x16x32_bf16 v[180:183], v[52:55], a[196:199], v[180:183]
    ds_read_b64_tr_b16 v[50:51], v12 offset:41984
    v_min_f32 v87, v87, v67
    v_mfma_f32_16x16x32_bf16 v[212:215], v[52:55], a[200:203], v[212:215]
    ds_read_b64_tr_b16 a[88:89], v14 offset:57344
    v_add_f32 v88, 0x73800000, v3
    v_mfma_f32_16x16x32_bf16 v[244:247], v[52:55], a[204:207], v[244:247]
    buffer_load_dwordx4 a[4:7], v120, s[40:43], s71 offen offset:3584
    v_mfma_f32_16x16x32_bf16 v[152:155], v[56:59], a[192:195], v[152:155]
    ds_read_b64_tr_b16 v[52:53], v13 offset:40960
    v_min_f32 v88, v88, v68
    v_mfma_f32_16x16x32_bf16 v[184:187], v[56:59], a[196:199], v[184:187]
    ds_read_b64_tr_b16 v[54:55], v13 offset:41984
    v_add_f32 v89, 0x73700000, v3
    v_mfma_f32_16x16x32_bf16 v[216:219], v[56:59], a[200:203], v[216:219]
    s_waitcnt lgkmcnt(7)
    ds_read_b64_tr_b16 a[90:91], v14 offset:58368
    v_min_f32 v89, v89, v69
    v_mfma_f32_16x16x32_bf16 v[248:251], v[56:59], a[204:207], v[248:251]
    buffer_load_dwordx4 a[8:11], v120, s[44:47], s71 offen
    v_mfma_f32_16x16x32_bf16 v[156:159], v[60:63], a[192:195], v[156:159]
    ds_read_b64_tr_b16 v[56:57], v14 offset:40960
    v_add_f32 v90, 0x73600000, v3
    v_mfma_f32_16x16x32_bf16 v[188:191], v[60:63], a[196:199], v[188:191]
    ds_read_b64_tr_b16 v[58:59], v14 offset:41984
    v_min_f32 v90, v90, v70
    v_mfma_f32_16x16x32_bf16 v[220:223], v[60:63], a[200:203], v[220:223]
    ds_read_b64_tr_b16 a[92:93], v15 offset:57344
    v_add_f32 v91, 0x73500000, v3
    v_mfma_f32_16x16x32_bf16 v[252:255], v[60:63], a[204:207], v[252:255]
    buffer_load_dwordx4 a[12:15], v120, s[44:47], s71 offen offset:3584
    v_mfma_f32_16x16x32_bf16 v[192:195], v[32:35], a[216:219], v[192:195]
    s_waitcnt vmcnt(34)
    s_lshl_b32 s71, s101, 16
    ds_read_b64_tr_b16 v[60:61], v15 offset:40960
    v_min_f32 v91, v91, v71
    v_mfma_f32_16x16x32_bf16 v[192:195], a[96:99], a[232:235], v[192:195]
    s_waitcnt vmcnt(26)
    s_lshl_b32 s100, s3, 11
    ds_read_b64_tr_b16 v[62:63], v15 offset:41984
    v_add_f32 v92, 0, v3
    v_mfma_f32_16x16x32_bf16 v[192:195], a[64:67], a[248:251], v[192:195]
    s_add_u32 s71, s71, s100
    ds_read_b64_tr_b16 a[94:95], v15 offset:58368
    v_min_f32 v92, v92, v68
    v_mfma_f32_16x16x32_bf16 v[196:199], v[36:39], a[216:219], v[196:199]
    s_lshl_b32 s100, s4, 7
    v_add_f32 v93, 0xf1800000, v3
    v_min_f32 v93, v93, v69
    v_mfma_f32_16x16x32_bf16 v[196:199], a[100:103], a[232:235], v[196:199]
    s_add_u32 s71, s71, s100
    v_add_f32 v94, 0xf2000000, v3
    v_min_f32 v94, v94, v70
    v_mfma_f32_16x16x32_bf16 v[196:199], a[68:71], a[248:251], v[196:199]
    s_waitcnt vmcnt(25)
    v_add_f32 v95, 0xf2400000, v3
    v_min_f32 v95, v95, v71
    v_mfma_f32_16x16x32_bf16 v[224:227], v[32:35], a[220:223], v[224:227]
    buffer_load_dwordx4 a[16:19], v121, s[48:51], s71 offen
    v_mfma_f32_16x16x32_bf16 v[224:227], a[96:99], a[236:239], v[224:227]
    buffer_load_dwordx4 a[20:23], v121, s[48:51], s71 offen offset:1024
    s_waitcnt lgkmcnt(0)
    s_barrier
    v_mfma_f32_16x16x32_bf16 v[224:227], a[64:67], a[252:255], v[224:227]
    v_lshrrev_b32 v121, 1, v2
    v_and_b32 v121, 15, v121
    v_mfma_f32_16x16x32_bf16 v[228:231], v[36:39], a[220:223], v[228:231]
    v_cvt_pk_bf16_f32 v192, v192, v193
    v_cvt_pk_bf16_f32 v193, v194, v195
    v_mfma_f32_16x16x32_bf16 v[228:231], a[100:103], a[236:239], v[228:231]
    v_cvt_pk_bf16_f32 v194, v196, v197
    v_cvt_pk_bf16_f32 v195, v198, v199
    v_mfma_f32_16x16x32_bf16 v[228:231], a[68:71], a[252:255], v[228:231]
    ds_write_b128 v16, v[192:195] offset:32768
    v_lshlrev_b32 v121, 10, v121
    v_mfma_f32_16x16x32_bf16 v[128:131], v[32:35], a[208:211], v[128:131]
    v_and_b32 v122, 1, v2
    v_lshl_add_u32 v121, v122, 7, v121
    v_mfma_f32_16x16x32_bf16 v[128:131], a[96:99], a[224:227], v[128:131]
    v_mfma_f32_16x16x32_bf16 v[128:131], a[64:67], a[240:243], v[128:131]
    v_mfma_f32_16x16x32_bf16 v[132:135], v[36:39], a[208:211], v[132:135]
    s_lshl_b32 s71, s6, 2
    v_cvt_pk_bf16_f32 v224, v224, v225
    v_cvt_pk_bf16_f32 v225, v226, v227
    v_mfma_f32_16x16x32_bf16 v[132:135], a[100:103], a[224:227], v[132:135]
    s_add_u32 s71, s71, s3
    v_cvt_pk_bf16_f32 v226, v228, v229
    v_cvt_pk_bf16_f32 v227, v230, v231
    v_mfma_f32_16x16x32_bf16 v[132:135], a[68:71], a[240:243], v[132:135]
    s_lshl_b32 s71, s71, 14
    ds_write_b128 v16, v[224:227] offset:36864
    v_mfma_f32_16x16x32_bf16 v[160:163], v[32:35], a[212:215], v[160:163]
    buffer_load_dword a60, v121, s[28:31], s71 offen
    v_mfma_f32_16x16x32_bf16 v[160:163], a[96:99], a[228:231], v[160:163]
    v_mfma_f32_16x16x32_bf16 v[160:163], a[64:67], a[244:247], v[160:163]
    s_getpc_b64 s[100:101]
L_ct2:
    s_lshr_b32 s99, s2, 3
    s_lshl_b32 s99, s99, 2
    s_add_u32 s99, s99, s3
    s_mul_i32 s99, s99, 6
    v_min_u32 v123, 5, v2
    v_add_u32 v123, s99, v123
    v_lshlrev_b32 v123, 7, v123
    v_add_u32 v123, L_attn-L_ct2, v123
    v_min_u32 v123, L_code_end-L_ct2, v123
    global_load_dword a61, v123, s[100:101]
    v_mfma_f32_16x16x32_bf16 v[164:167], v[36:39], a[212:215], v[164:167]
    v_cvt_pk_bf16_f32 v128, v128, v129
    v_cvt_pk_bf16_f32 v129, v130, v131
    v_mfma_f32_16x16x32_bf16 v[164:167], a[100:103], a[228:231], v[164:167]
    v_cvt_pk_bf16_f32 v130, v132, v133
    v_cvt_pk_bf16_f32 v131, v134, v135
    v_mfma_f32_16x16x32_bf16 v[164:167], a[68:71], a[244:247], v[164:167]
    ds_write_b128 v16, v[128:131] offset:0
    v_mfma_f32_16x16x32_bf16 v[200:203], v[40:43], a[216:219], v[200:203]
    v_mfma_f32_16x16x32_bf16 v[200:203], a[104:107], a[232:235], v[200:203]
    v_mfma_f32_16x16x32_bf16 v[200:203], a[72:75], a[248:251], v[200:203]
    v_mfma_f32_16x16x32_bf16 v[204:207], v[44:47], a[216:219], v[204:207]
    v_cvt_pk_bf16_f32 v160, v160, v161
    v_cvt_pk_bf16_f32 v161, v162, v163
    v_mfma_f32_16x16x32_bf16 v[204:207], a[108:111], a[232:235], v[204:207]
    v_cvt_pk_bf16_f32 v162, v164, v165
    v_cvt_pk_bf16_f32 v163, v166, v167
    v_mfma_f32_16x16x32_bf16 v[204:207], a[76:79], a[248:251], v[204:207]
    ds_write_b128 v16, v[160:163] offset:4096
    v_mfma_f32_16x16x32_bf16 v[232:235], v[40:43], a[220:223], v[232:235]
    v_mfma_f32_16x16x32_bf16 v[232:235], a[104:107], a[236:239], v[232:235]
    v_mfma_f32_16x16x32_bf16 v[232:235], a[72:75], a[252:255], v[232:235]
    v_mfma_f32_16x16x32_bf16 v[236:239], v[44:47], a[220:223], v[236:239]
    v_cvt_pk_bf16_f32 v200, v200, v201
    v_cvt_pk_bf16_f32 v201, v202, v203
    v_mfma_f32_16x16x32_bf16 v[236:239], a[108:111], a[236:239], v[236:239]
    v_cvt_pk_bf16_f32 v202, v204, v205
    v_cvt_pk_bf16_f32 v203, v206, v207
    v_mfma_f32_16x16x32_bf16 v[236:239], a[76:79], a[252:255], v[236:239]
    ds_write_b128 v16, v[200:203] offset:33792
    v_mfma_f32_16x16x32_bf16 v[136:139], v[40:43], a[208:211], v[136:139]
    v_mfma_f32_16x16x32_bf16 v[136:139], a[104:107], a[224:227], v[136:139]
    v_mfma_f32_16x16x32_bf16 v[136:139], a[72:75], a[240:243], v[136:139]
    v_mfma_f32_16x16x32_bf16 v[140:143], v[44:47], a[208:211], v[140:143]
    v_cvt_pk_bf16_f32 v232, v232, v233
    v_cvt_pk_bf16_f32 v233, v234, v235
    v_mfma_f32_16x16x32_bf16 v[140:143], a[108:111], a[224:227], v[140:143]
    v_cvt_pk_bf16_f32 v234, v236, v237
    v_cvt_pk_bf16_f32 v235, v238, v239
    v_mfma_f32_16x16x32_bf16 v[140:143], a[76:79], a[240:243], v[140:143]
    ds_write_b128 v16, v[232:235] offset:37888
    v_mfma_f32_16x16x32_bf16 v[168:171], v[40:43], a[212:215], v[168:171]
    v_mfma_f32_16x16x32_bf16 v[168:171], a[104:107], a[228:231], v[168:171]
    v_mfma_f32_16x16x32_bf16 v[168:171], a[72:75], a[244:247], v[168:171]
    v_mfma_f32_16x16x32_bf16 v[172:175], v[44:47], a[212:215], v[172:175]
    v_cvt_pk_bf16_f32 v136, v136, v137
    v_cvt_pk_bf16_f32 v137, v138, v139
    v_mfma_f32_16x16x32_bf16 v[172:175], a[108:111], a[228:231], v[172:175]
    v_cvt_pk_bf16_f32 v138, v140, v141
    v_cvt_pk_bf16_f32 v139, v142, v143
    v_mfma_f32_16x16x32_bf16 v[172:175], a[76:79], a[244:247], v[172:175]
    ds_write_b128 v16, v[136:139] offset:1024
    v_mfma_f32_16x16x32_bf16 v[208:211], v[48:51], a[216:219], v[208:211]
    v_mfma_f32_16x16x32_bf16 v[208:211], a[112:115], a[232:235], v[208:211]
    v_mfma_f32_16x16x32_bf16 v[208:211], a[80:83], a[248:251], v[208:211]
    v_mfma_f32_16x16x32_bf16 v[212:215], v[52:55], a[216:219], v[212:215]
    v_cvt_pk_bf16_f32 v168, v168, v169
    v_cvt_pk_bf16_f32 v169, v170, v171
    v_mfma_f32_16x16x32_bf16 v[212:215], a[116:119], a[232:235], v[212:215]
    v_cvt_pk_bf16_f32 v170, v172, v173
    v_cvt_pk_bf16_f32 v171, v174, v175
    v_mfma_f32_16x16x32_bf16 v[212:215], a[84:87], a[248:251], v[212:215]
    ds_write_b128 v16, v[168:171] offset:5120
    v_mfma_f32_16x16x32_bf16 v[240:243], v[48:51], a[220:223], v[240:243]
    v_mfma_f32_16x16x32_bf16 v[240:243], a[112:115], a[236:239], v[240:243]
    v_mfma_f32_16x16x32_bf16 v[240:243], a[80:83], a[252:255], v[240:243]
    v_mfma_f32_16x16x32_bf16 v[244:247], v[52:55], a[220:223], v[244:247]
    v_cvt_pk_bf16_f32 v208, v208, v209
    v_cvt_pk_bf16_f32 v209, v210, v211
    v_mfma_f32_16x16x32_bf16 v[244:247], a[116:119], a[236:239], v[244:247]
    v_cvt_pk_bf16_f32 v210, v212, v213
    v_cvt_pk_bf16_f32 v211, v214, v215
    v_mfma_f32_16x16x32_bf16 v[244:247], a[84:87], a[252:255], v[244:247]
    ds_write_b128 v16, v[208:211] offset:34816
    v_mfma_f32_16x16x32_bf16 v[144:147], v[48:51], a[208:211], v[144:147]
    v_mfma_f32_16x16x32_bf16 v[144:147], a[112:115], a[224:227], v[144:147]
    v_mfma_f32_16x16x32_bf16 v[144:147], a[80:83], a[240:243], v[144:147]
    v_mfma_f32_16x16x32_bf16 v[148:151], v[52:55], a[208:211], v[148:151]
    v_cvt_pk_bf16_f32 v240, v240, v241
    v_cvt_pk_bf16_f32 v241, v242, v243
    v_mfma_f32_16x16x32_bf16 v[148:151], a[116:119], a[224:227], v[148:151]
    v_cvt_pk_bf16_f32 v242, v244, v245
    v_cvt_pk_bf16_f32 v243, v246, v247
    v_mfma_f32_16x16x32_bf16 v[148:151], a[84:87], a[240:243], v[148:151]
    ds_write_b128 v16, v[240:243] offset:38912
    v_mfma_f32_16x16x32_bf16 v[176:179], v[48:51], a[212:215], v[176:179]
    v_mfma_f32_16x16x32_bf16 v[176:179], a[112:115], a[228:231], v[176:179]
    v_mfma_f32_16x16x32_bf16 v[176:179], a[80:83], a[244:247], v[176:179]
    v_mfma_f32_16x16x32_bf16 v[180:183], v[52:55], a[212:215], v[180:183]
    v_cvt_pk_bf16_f32 v144, v144, v145
    v_cvt_pk_bf16_f32 v145, v146, v147
    v_mfma_f32_16x16x32_bf16 v[180:183], a[116:119], a[228:231], v[180:183]
    v_cvt_pk_bf16_f32 v146, v148, v149
    v_cvt_pk_bf16_f32 v147, v150, v151
    v_mfma_f32_16x16x32_bf16 v[180:183], a[84:87], a[244:247], v[180:183]
    ds_write_b128 v16, v[144:147] offset:2048
    v_mfma_f32_16x16x32_bf16 v[216:219], v[56:59], a[216:219], v[216:219]
    v_mfma_f32_16x16x32_bf16 v[216:219], a[120:123], a[232:235], v[216:219]
    v_mfma_f32_16x16x32_bf16 v[216:219], a[88:91], a[248:251], v[216:219]
    v_mfma_f32_16x16x32_bf16 v[220:223], v[60:63], a[216:219], v[220:223]
    v_cvt_pk_bf16_f32 v176, v176, v177
    v_cvt_pk_bf16_f32 v177, v178, v179
    v_mfma_f32_16x16x32_bf16 v[220:223], a[124:127], a[232:235], v[220:223]
    v_cvt_pk_bf16_f32 v178, v180, v181
    v_cvt_pk_bf16_f32 v179, v182, v183
    v_mfma_f32_16x16x32_bf16 v[220:223], a[92:95], a[248:251], v[220:223]
    ds_write_b128 v16, v[176:179] offset:6144
    v_mfma_f32_16x16x32_bf16 v[248:251], v[56:59], a[220:223], v[248:251]
    v_mfma_f32_16x16x32_bf16 v[248:251], a[120:123], a[236:239], v[248:251]
    v_mfma_f32_16x16x32_bf16 v[248:251], a[88:91], a[252:255], v[248:251]
    v_mfma_f32_16x16x32_bf16 v[252:255], v[60:63], a[220:223], v[252:255]
    v_cvt_pk_bf16_f32 v216, v216, v217
    v_cvt_pk_bf16_f32 v217, v218, v219
    v_mfma_f32_16x16x32_bf16 v[252:255], a[124:127], a[236:239], v[252:255]
    v_cvt_pk_bf16_f32 v218, v220, v221
    v_cvt_pk_bf16_f32 v219, v222, v223
    v_mfma_f32_16x16x32_bf16 v[252:255], a[92:95], a[252:255], v[252:255]
    ds_write_b128 v16, v[216:219] offset:35840
    v_mfma_f32_16x16x32_bf16 v[152:155], v[56:59], a[208:211], v[152:155]
    v_mfma_f32_16x16x32_bf16 v[152:155], a[120:123], a[224:227], v[152:155]
    v_mfma_f32_16x16x32_bf16 v[152:155], a[88:91], a[240:243], v[152:155]
    v_mfma_f32_16x16x32_bf16 v[156:159], v[60:63], a[208:211], v[156:159]
    v_cvt_pk_bf16_f32 v248, v248, v249
    v_cvt_pk_bf16_f32 v249, v250, v251
    v_mfma_f32_16x16x32_bf16 v[156:159], a[124:127], a[224:227], v[156:159]
    v_cvt_pk_bf16_f32 v250, v252, v253
    v_cvt_pk_bf16_f32 v251, v254, v255
    v_mfma_f32_16x16x32_bf16 v[156:159], a[92:95], a[240:243], v[156:159]
    ds_write_b128 v16, v[248:251] offset:39936
    v_mfma_f32_16x16x32_bf16 v[184:187], v[56:59], a[212:215], v[184:187]
    v_mfma_f32_16x16x32_bf16 v[184:187], a[120:123], a[228:231], v[184:187]
    v_mfma_f32_16x16x32_bf16 v[184:187], a[88:91], a[244:247], v[184:187]
    v_mfma_f32_16x16x32_bf16 v[188:191], v[60:63], a[212:215], v[188:191]
    v_cvt_pk_bf16_f32 v152, v152, v153
    v_cvt_pk_bf16_f32 v153, v154, v155
    v_mfma_f32_16x16x32_bf16 v[188:191], a[124:127], a[228:231], v[188:191]
    v_cvt_pk_bf16_f32 v154, v156, v157
    v_cvt_pk_bf16_f32 v155, v158, v159
    v_mfma_f32_16x16x32_bf16 v[188:191], a[92:95], a[244:247], v[188:191]
    ds_write_b128 v16, v[152:155] offset:3072
L_attn:
    v_add_u32 v15, 4096, v1
    v_cvt_pk_bf16_f32 v184, v184, v185
    v_cvt_pk_bf16_f32 v185, v186, v187
    s_nop 3
    v_cvt_pk_bf16_f32 v186, v188, v189
    v_cvt_pk_bf16_f32 v187, v190, v191
    ds_write_b128 v16, v[184:187] offset:7168
    s_waitcnt vmcnt(25) lgkmcnt(0)
    s_barrier
    ds_read_b128 a[64:67], v17 offset:0
    ds_read_b128 a[128:131], v18 offset:0
    ds_read_b128 a[68:71], v17 offset:1024
    ds_read_b128 a[132:135], v18 offset:1024
    ds_read_b128 a[72:75], v17 offset:2048
    ds_read_b128 a[136:139], v18 offset:2048
    ds_read_b128 a[76:79], v17 offset:3072
    ds_read_b128 a[140:143], v18 offset:3072
    ds_read_b128 a[144:147], v18 offset:4096
    ds_read_b128 a[148:151], v18 offset:5120
    ds_read_b128 a[152:155], v18 offset:6144
    ds_read_b128 a[156:159], v18 offset:7168
    ds_read_b128 a[80:83], v17 offset:4096
    ds_read_b128 a[84:87], v17 offset:5120
    ds_read_b128 a[88:91], v17 offset:6144
    ds_read_b128 a[92:95], v17 offset:7168
    s_waitcnt lgkmcnt(14)
    v_mfma_f32_16x16x32_bf16 v[96:99], a[128:131], a[64:67], v[96:99]
    s_waitcnt lgkmcnt(12)
    s_add_u32 s19, s82, 32768
    s_sub_u32 s82, s12, s13
    ds_read_b128 a[96:99], v17 offset:8192
    v_mfma_f32_16x16x32_bf16 v[96:99], a[132:135], a[68:71], v[96:99]
    s_waitcnt lgkmcnt(11)
    s_sub_u32 s82, s82, 1
    s_cmp_gt_u32 s12, s13
    s_cselect_b32 s82, s82, s12
    ds_read_b128 a[100:103], v17 offset:9216
    v_mfma_f32_16x16x32_bf16 v[96:99], a[136:139], a[72:75], v[96:99]
    s_waitcnt lgkmcnt(10)
    s_mul_i32 s82, s82, 65536
    s_add_u32 s82, s82, s81
    ds_read_b128 a[104:107], v17 offset:10240
    v_mfma_f32_16x16x32_bf16 v[96:99], a[140:143], a[76:79], v[96:99]
    s_waitcnt lgkmcnt(10)
    s_cmp_ge_u32 s12, 17
    s_cselect_b32 s82, 2147471360, s82
    s_add_u32 s12, s12, 1
    ds_read_b128 a[108:111], v17 offset:11264
    v_mfma_f32_16x16x32_bf16 v[100:103], a[144:147], a[64:67], v[100:103]
    s_waitcnt lgkmcnt(10)
    s_sub_u32 s14, s60, 1
    ds_read_b128 a[112:115], v17 offset:12288
    v_mfma_f32_16x16x32_bf16 v[100:103], a[148:151], a[68:71], v[100:103]
    s_waitcnt lgkmcnt(10)
    ds_read_b128 a[116:119], v17 offset:13312
    v_mfma_f32_16x16x32_bf16 v[100:103], a[152:155], a[72:75], v[100:103]
    s_waitcnt lgkmcnt(10)
    ds_read_b128 a[120:123], v17 offset:14336
    v_mfma_f32_16x16x32_bf16 v[100:103], a[156:159], a[76:79], v[100:103]
    s_waitcnt lgkmcnt(10)
    ds_read_b128 a[124:127], v17 offset:15360
    v_mfma_f32_16x16x32_bf16 v[104:107], a[128:131], a[80:83], v[104:107]
    s_waitcnt lgkmcnt(10)
    ds_read_b128 a[192:195], v17 offset:32768
    v_exp_f32 v96, v96
    v_mfma_f32_16x16x32_bf16 v[104:107], a[132:135], a[84:87], v[104:107]
    s_waitcnt lgkmcnt(10)
    ds_read_b128 a[196:199], v17 offset:33792
    v_exp_f32 v97, v97
    v_mfma_f32_16x16x32_bf16 v[104:107], a[136:139], a[88:91], v[104:107]
    s_waitcnt lgkmcnt(10)
    ds_read_b128 a[200:203], v17 offset:34816
    v_exp_f32 v98, v98
    v_mfma_f32_16x16x32_bf16 v[104:107], a[140:143], a[92:95], v[104:107]
    ds_read_b128 a[204:207], v17 offset:35840
    v_exp_f32 v99, v99
    v_mfma_f32_16x16x32_bf16 v[108:111], a[144:147], a[80:83], v[108:111]
    ds_read_b128 a[208:211], v17 offset:36864
    v_exp_f32 v100, v100
    v_mfma_f32_16x16x32_bf16 v[108:111], a[148:151], a[84:87], v[108:111]
    ds_read_b128 a[212:215], v17 offset:37888
    v_exp_f32 v101, v101
    v_mfma_f32_16x16x32_bf16 v[108:111], a[152:155], a[88:91], v[108:111]
    ds_read_b128 a[216:219], v17 offset:38912
    v_exp_f32 v102, v102
    v_mfma_f32_16x16x32_bf16 v[108:111], a[156:159], a[92:95], v[108:111]
    s_waitcnt lgkmcnt(14)
    ds_read_b128 a[220:223], v17 offset:39936
    v_exp_f32 v103, v103
    v_mfma_f32_16x16x32_bf16 v[112:115], a[128:131], a[96:99], v[72:75]
    s_waitcnt lgkmcnt(14)
    ds_read_b128 a[224:227], v17 offset:40960
    v_exp_f32 v104, v104
    v_mfma_f32_16x16x32_bf16 v[112:115], a[132:135], a[100:103], v[112:115]
    s_waitcnt lgkmcnt(14)
    ds_read_b128 a[228:231], v17 offset:41984
    v_exp_f32 v105, v105
    v_mfma_f32_16x16x32_bf16 v[112:115], a[136:139], a[104:107], v[112:115]
    s_waitcnt lgkmcnt(14)
    ds_read_b128 a[232:235], v17 offset:43008
    v_exp_f32 v106, v106
    v_mfma_f32_16x16x32_bf16 v[112:115], a[140:143], a[108:111], v[112:115]
    s_waitcnt lgkmcnt(14)
    ds_read_b128 a[236:239], v17 offset:44032
    v_exp_f32 v107, v107
    v_mfma_f32_16x16x32_bf16 v[120:123], a[128:131], a[112:115], v[76:79]
    s_waitcnt lgkmcnt(14)
    ds_read_b128 a[240:243], v17 offset:45056
    v_exp_f32 v108, v108
    v_mfma_f32_16x16x32_bf16 v[120:123], a[132:135], a[116:119], v[120:123]
    s_waitcnt lgkmcnt(14)
    ds_read_b128 a[244:247], v17 offset:46080
    v_exp_f32 v109, v109
    v_mfma_f32_16x16x32_bf16 v[120:123], a[136:139], a[120:123], v[120:123]
    s_waitcnt lgkmcnt(14)
    ds_read_b128 a[248:251], v17 offset:47104
    v_exp_f32 v110, v110
    v_mfma_f32_16x16x32_bf16 v[120:123], a[140:143], a[124:127], v[120:123]
    ds_read_b128 a[252:255], v17 offset:48128
    v_exp_f32 v111, v111
    v_mfma_f32_16x16x32_bf16 v[116:119], a[144:147], a[96:99], v[72:75]
    ds_read_b128 a[128:131], v18 offset:16384
    v_cvt_pk_bf16_f32 v48, v96, v97
    v_mfma_f32_16x16x32_bf16 v[116:119], a[148:151], a[100:103], v[116:119]
    ds_read_b128 a[132:135], v18 offset:17408
    v_cvt_pk_bf16_f32 v49, v98, v99
    v_mfma_f32_16x16x32_bf16 v[116:119], a[152:155], a[104:107], v[116:119]
    ds_read_b128 a[136:139], v18 offset:18432
    v_cvt_pk_bf16_f32 v50, v100, v101
    v_mfma_f32_16x16x32_bf16 v[116:119], a[156:159], a[108:111], v[116:119]
    ds_read_b128 a[140:143], v18 offset:19456
    v_cvt_pk_bf16_f32 v51, v102, v103
    v_mfma_f32_16x16x32_bf16 v[124:127], a[144:147], a[112:115], v[76:79]
    ds_read_b128 a[144:147], v18 offset:20480
    v_cvt_pk_bf16_f32 v52, v104, v105
    v_mfma_f32_16x16x32_bf16 v[124:127], a[148:151], a[116:119], v[124:127]
    ds_read_b128 a[148:151], v18 offset:21504
    v_cvt_pk_bf16_f32 v53, v106, v107
    v_mfma_f32_16x16x32_bf16 v[124:127], a[152:155], a[120:123], v[124:127]
    ds_read_b128 a[152:155], v18 offset:22528
    v_cvt_pk_bf16_f32 v54, v108, v109
    v_mfma_f32_16x16x32_bf16 v[124:127], a[156:159], a[124:127], v[124:127]
    ds_read_b128 a[156:159], v18 offset:23552
    v_cvt_pk_bf16_f32 v55, v110, v111
    v_xor_b32 v18, 196608, v18
    v_lshrrev_b32 v17, 4, v2
    v_lshlrev_b32 v17, 15, v17
    v_and_b32 v14, 255, v1
    v_add_u32 v17, v17, v14
L_t1_p1:
    s_waitcnt vmcnt(8) lgkmcnt(0)
    s_barrier
    s_cmp_eq_u32 s60, 0
    s_cbranch_scc1 L_t1_zero
    v_mfma_f32_16x16x32_bf16 v[96:99], a[128:131], a[64:67], v[64:67]
    s_add_u32 m0, s15, 0
    ds_read_b128 a[160:163], v19 offset:0
    v_mfma_f32_16x16x32_bf16 v[96:99], a[132:135], a[68:71], v[96:99]
    ds_read_b128 a[164:167], v19 offset:1024
    v_mfma_f32_16x16x32_bf16 v[96:99], a[136:139], a[72:75], v[96:99]
    v_exp_f32 v112, v112
    v_mfma_f32_16x16x32_bf16 v[96:99], a[140:143], a[76:79], v[96:99]
    buffer_load_dwordx4 v1, s[8:11], s82 offen offset:0  lds
    v_mfma_f32_16x16x32_bf16 v[104:107], a[128:131], a[80:83], v[68:71]
    v_exp_f32 v113, v113
    v_mfma_f32_16x16x32_bf16 v[104:107], a[132:135], a[84:87], v[104:107]
    ds_read_b128 a[168:171], v19 offset:2048
    v_cvt_pk_bf16_f32 v56, v112, v113
    v_mfma_f32_16x16x32_bf16 v[104:107], a[136:139], a[88:91], v[104:107]
    v_exp_f32 v114, v114
    v_mfma_f32_16x16x32_bf16 v[104:107], a[140:143], a[92:95], v[104:107]
    buffer_load_dwordx4 v1, s[8:11], s82 offen offset:1024  lds
    v_mfma_f32_16x16x32_bf16 v[100:103], a[144:147], a[64:67], v[64:67]
    v_exp_f32 v115, v115
    v_mfma_f32_16x16x32_bf16 v[100:103], a[148:151], a[68:71], v[100:103]
    ds_read_b128 a[172:175], v19 offset:3072
    v_cvt_pk_bf16_f32 v57, v114, v115
    v_mfma_f32_16x16x32_bf16 v[100:103], a[152:155], a[72:75], v[100:103]
    v_exp_f32 v116, v116
    v_mfma_f32_16x16x32_bf16 v[100:103], a[156:159], a[76:79], v[100:103]
    buffer_load_dwordx4 v1, s[8:11], s82 offen offset:2048  lds
    v_mfma_f32_16x16x32_bf16 v[108:111], a[144:147], a[80:83], v[68:71]
    v_exp_f32 v117, v117
    v_mfma_f32_16x16x32_bf16 v[108:111], a[148:151], a[84:87], v[108:111]
    ds_read_b128 a[176:179], v20 offset:4096
    v_cvt_pk_bf16_f32 v58, v116, v117
    v_mfma_f32_16x16x32_bf16 v[108:111], a[152:155], a[88:91], v[108:111]
    v_exp_f32 v118, v118
    v_mfma_f32_16x16x32_bf16 v[108:111], a[156:159], a[92:95], v[108:111]
    buffer_load_dwordx4 v1, s[8:11], s82 offen offset:3072  lds
    v_mfma_f32_16x16x32_bf16 v[32:35], v[28:31], v[48:51], 0
    s_add_u32 m0, s15, 4096
    v_exp_f32 v119, v119
    v_mfma_f32_16x16x32_bf16 v[36:39], v[28:31], v[52:55], 0
    s_waitcnt lgkmcnt(4)
    ds_read_b128 a[180:183], v20 offset:5120
    v_cvt_pk_bf16_f32 v59, v118, v119
    v_mfma_f32_16x16x32_bf16 v[128:131], a[160:163], v[48:51], 0
    s_waitcnt lgkmcnt(4)
    v_exp_f32 v120, v120
    v_mfma_f32_16x16x32_bf16 v[160:163], a[160:163], v[52:55], 0
    buffer_load_dwordx4 v15, s[8:11], s82 offen offset:0  lds
    v_mfma_f32_16x16x32_bf16 v[132:135], a[164:167], v[48:51], 0
    v_exp_f32 v121, v121
    v_mfma_f32_16x16x32_bf16 v[164:167], a[164:167], v[52:55], 0
    s_waitcnt lgkmcnt(3)
    ds_read_b128 a[184:187], v20 offset:6144
    v_cvt_pk_bf16_f32 v60, v120, v121
    v_mfma_f32_16x16x32_bf16 v[136:139], a[168:171], v[48:51], 0
    s_waitcnt lgkmcnt(3)
    v_exp_f32 v122, v122
    v_mfma_f32_16x16x32_bf16 v[168:171], a[168:171], v[52:55], 0
    buffer_load_dwordx4 v15, s[8:11], s82 offen offset:1024  lds
    v_mfma_f32_16x16x32_bf16 v[140:143], a[172:175], v[48:51], 0
    v_exp_f32 v123, v123
    v_mfma_f32_16x16x32_bf16 v[172:175], a[172:175], v[52:55], 0
    s_waitcnt lgkmcnt(2)
    ds_read_b128 a[188:191], v20 offset:7168
    v_cvt_pk_bf16_f32 v61, v122, v123
    v_mfma_f32_16x16x32_bf16 v[144:147], a[176:179], v[48:51], 0
    s_waitcnt lgkmcnt(2)
    v_exp_f32 v124, v124
    v_mfma_f32_16x16x32_bf16 v[176:179], a[176:179], v[52:55], 0
    buffer_load_dwordx4 v15, s[8:11], s82 offen offset:2048  lds
    v_mfma_f32_16x16x32_bf16 v[148:151], a[180:183], v[48:51], 0
    v_exp_f32 v125, v125
    v_mfma_f32_16x16x32_bf16 v[180:183], a[180:183], v[52:55], 0
    s_waitcnt lgkmcnt(1)
    v_cvt_pk_bf16_f32 v62, v124, v125
    v_mfma_f32_16x16x32_bf16 v[152:155], a[184:187], v[48:51], 0
    s_waitcnt lgkmcnt(0)
    v_exp_f32 v126, v126
    v_mfma_f32_16x16x32_bf16 v[184:187], a[184:187], v[52:55], 0
    buffer_load_dwordx4 v15, s[8:11], s82 offen offset:3072  lds
    v_mfma_f32_16x16x32_bf16 v[156:159], a[188:191], v[48:51], 0
    s_xor_b32 s15, s15, 196608
    v_exp_f32 v127, v127
    v_mfma_f32_16x16x32_bf16 v[188:191], a[188:191], v[52:55], 0
    s_add_u32 m0, s16, 0
    v_cvt_pk_bf16_f32 v63, v126, v127
    v_mfma_f32_16x16x32_bf16 v[112:115], a[128:131], a[96:99], v[72:75]
    v_mfma_f32_16x16x32_bf16 v[112:115], a[132:135], a[100:103], v[112:115]
    v_mfma_f32_16x16x32_bf16 v[112:115], a[136:139], a[104:107], v[112:115]
    v_exp_f32 v96, v96
    v_mfma_f32_16x16x32_bf16 v[112:115], a[140:143], a[108:111], v[112:115]
    buffer_load_dwordx4 v1, s[8:11], s19 offen offset:0  lds
    v_mfma_f32_16x16x32_bf16 v[120:123], a[128:131], a[112:115], v[76:79]
    v_exp_f32 v97, v97
    v_mfma_f32_16x16x32_bf16 v[120:123], a[132:135], a[116:119], v[120:123]
    ds_read_b128 a[128:131], v18 offset:0
    v_cvt_pk_bf16_f32 v48, v96, v97
    v_mfma_f32_16x16x32_bf16 v[120:123], a[136:139], a[120:123], v[120:123]
    v_exp_f32 v98, v98
    v_mfma_f32_16x16x32_bf16 v[120:123], a[140:143], a[124:127], v[120:123]
    buffer_load_dwordx4 v1, s[8:11], s19 offen offset:1024  lds
    v_mfma_f32_16x16x32_bf16 v[116:119], a[144:147], a[96:99], v[72:75]
    v_exp_f32 v99, v99
    v_mfma_f32_16x16x32_bf16 v[116:119], a[148:151], a[100:103], v[116:119]
    ds_read_b128 a[132:135], v18 offset:1024
    v_cvt_pk_bf16_f32 v49, v98, v99
    v_mfma_f32_16x16x32_bf16 v[116:119], a[152:155], a[104:107], v[116:119]
    v_exp_f32 v100, v100
    v_mfma_f32_16x16x32_bf16 v[116:119], a[156:159], a[108:111], v[116:119]
    buffer_load_dwordx4 v1, s[8:11], s19 offen offset:2048  lds
    v_mfma_f32_16x16x32_bf16 v[124:127], a[144:147], a[112:115], v[76:79]
    v_exp_f32 v101, v101
    v_mfma_f32_16x16x32_bf16 v[124:127], a[148:151], a[116:119], v[124:127]
    ds_read_b128 a[136:139], v18 offset:2048
    v_cvt_pk_bf16_f32 v50, v100, v101
    v_mfma_f32_16x16x32_bf16 v[124:127], a[152:155], a[120:123], v[124:127]
    v_exp_f32 v102, v102
    v_mfma_f32_16x16x32_bf16 v[124:127], a[156:159], a[124:127], v[124:127]
    buffer_load_dwordx4 v1, s[8:11], s19 offen offset:3072  lds
    v_mfma_f32_16x16x32_bf16 v[40:43], v[28:31], v[56:59], 0
    s_add_u32 m0, s16, 4096
    v_exp_f32 v103, v103
    v_mfma_f32_16x16x32_bf16 v[44:47], v[28:31], v[60:63], 0
    ds_read_b128 a[140:143], v18 offset:3072
    v_cvt_pk_bf16_f32 v51, v102, v103
    v_mfma_f32_16x16x32_bf16 v[192:195], a[160:163], v[56:59], 0
    v_exp_f32 v104, v104
    v_mfma_f32_16x16x32_bf16 v[224:227], a[160:163], v[60:63], 0
    buffer_load_dwordx4 v15, s[8:11], s19 offen offset:0  lds
    v_mfma_f32_16x16x32_bf16 v[196:199], a[164:167], v[56:59], 0
    v_exp_f32 v105, v105
    v_mfma_f32_16x16x32_bf16 v[228:231], a[164:167], v[60:63], 0
    ds_read_b128 a[144:147], v18 offset:4096
    v_cvt_pk_bf16_f32 v52, v104, v105
    v_mfma_f32_16x16x32_bf16 v[200:203], a[168:171], v[56:59], 0
    v_exp_f32 v106, v106
    v_mfma_f32_16x16x32_bf16 v[232:235], a[168:171], v[60:63], 0
    buffer_load_dwordx4 v15, s[8:11], s19 offen offset:1024  lds
    v_mfma_f32_16x16x32_bf16 v[204:207], a[172:175], v[56:59], 0
    v_exp_f32 v107, v107
    v_mfma_f32_16x16x32_bf16 v[236:239], a[172:175], v[60:63], 0
    ds_read_b128 a[148:151], v18 offset:5120
    v_cvt_pk_bf16_f32 v53, v106, v107
    v_mfma_f32_16x16x32_bf16 v[208:211], a[176:179], v[56:59], 0
    v_exp_f32 v108, v108
    v_mfma_f32_16x16x32_bf16 v[240:243], a[176:179], v[60:63], 0
    buffer_load_dwordx4 v15, s[8:11], s19 offen offset:2048  lds
    v_mfma_f32_16x16x32_bf16 v[212:215], a[180:183], v[56:59], 0
    v_exp_f32 v109, v109
    v_mfma_f32_16x16x32_bf16 v[244:247], a[180:183], v[60:63], 0
    ds_read_b128 a[152:155], v18 offset:6144
    v_cvt_pk_bf16_f32 v54, v108, v109
    v_mfma_f32_16x16x32_bf16 v[216:219], a[184:187], v[56:59], 0
    v_exp_f32 v110, v110
    v_mfma_f32_16x16x32_bf16 v[248:251], a[184:187], v[60:63], 0
    buffer_load_dwordx4 v15, s[8:11], s19 offen offset:3072  lds
    v_mfma_f32_16x16x32_bf16 v[220:223], a[188:191], v[56:59], 0
    s_xor_b32 s16, s16, 98304
    v_exp_f32 v111, v111
    v_mfma_f32_16x16x32_bf16 v[252:255], a[188:191], v[60:63], 0
    ds_read_b128 a[156:159], v18 offset:7168
    v_cvt_pk_bf16_f32 v55, v110, v111
    s_cmp_eq_u32 s14, 0
    s_cbranch_scc1 L_t1_diag
.p2align 3
L_t1_loop:
    s_waitcnt lgkmcnt(7)
    v_mfma_f32_16x16x32_bf16 v[96:99], a[128:131], a[64:67], v[64:67]
    s_waitcnt lgkmcnt(6)
    ds_read_b128 a[160:163], v19 offset:16384
    v_mfma_f32_16x16x32_bf16 v[96:99], a[132:135], a[68:71], v[96:99]
    s_waitcnt lgkmcnt(6)
    ds_read_b128 a[164:167], v19 offset:17408
    v_mfma_f32_16x16x32_bf16 v[96:99], a[136:139], a[72:75], v[96:99]
    s_waitcnt lgkmcnt(6)
    v_exp_f32 v112, v112
    v_mfma_f32_16x16x32_bf16 v[96:99], a[140:143], a[76:79], v[96:99]
    v_mfma_f32_16x16x32_bf16 v[104:107], a[128:131], a[80:83], v[68:71]
    v_exp_f32 v113, v113
    v_mfma_f32_16x16x32_bf16 v[104:107], a[132:135], a[84:87], v[104:107]
    ds_read_b128 a[168:171], v19 offset:18432
    v_cvt_pk_bf16_f32 v56, v112, v113
    v_mfma_f32_16x16x32_bf16 v[104:107], a[136:139], a[88:91], v[104:107]
    v_exp_f32 v114, v114
    v_mfma_f32_16x16x32_bf16 v[104:107], a[140:143], a[92:95], v[104:107]
    s_waitcnt lgkmcnt(6)
    v_mfma_f32_16x16x32_bf16 v[100:103], a[144:147], a[64:67], v[64:67]
    s_waitcnt lgkmcnt(5)
    v_exp_f32 v115, v115
    v_mfma_f32_16x16x32_bf16 v[100:103], a[148:151], a[68:71], v[100:103]
    s_waitcnt lgkmcnt(4)
    ds_read_b128 a[172:175], v19 offset:19456
    v_cvt_pk_bf16_f32 v57, v114, v115
    v_mfma_f32_16x16x32_bf16 v[100:103], a[152:155], a[72:75], v[100:103]
    s_waitcnt lgkmcnt(4)
    v_exp_f32 v116, v116
    v_mfma_f32_16x16x32_bf16 v[100:103], a[156:159], a[76:79], v[100:103]
    v_mfma_f32_16x16x32_bf16 v[108:111], a[144:147], a[80:83], v[68:71]
    v_exp_f32 v117, v117
    v_mfma_f32_16x16x32_bf16 v[108:111], a[148:151], a[84:87], v[108:111]
    ds_read_b128 a[176:179], v20 offset:20480
    v_cvt_pk_bf16_f32 v58, v116, v117
    v_mfma_f32_16x16x32_bf16 v[108:111], a[152:155], a[88:91], v[108:111]
    v_exp_f32 v118, v118
    v_mfma_f32_16x16x32_bf16 v[108:111], a[156:159], a[92:95], v[108:111]
    v_mfma_f32_16x16x32_bf16 v[32:35], v[28:31], v[48:51], v[32:35]
    v_exp_f32 v119, v119
    v_mfma_f32_16x16x32_bf16 v[36:39], v[28:31], v[52:55], v[36:39]
    s_waitcnt lgkmcnt(4)
    ds_read_b128 a[180:183], v20 offset:21504
    v_cvt_pk_bf16_f32 v59, v118, v119
    v_mfma_f32_16x16x32_bf16 v[128:131], a[160:163], v[48:51], v[128:131]
    v_exp_f32 v120, v120
    v_mfma_f32_16x16x32_bf16 v[160:163], a[160:163], v[52:55], v[160:163]
    s_waitcnt lgkmcnt(4)
    v_mfma_f32_16x16x32_bf16 v[132:135], a[164:167], v[48:51], v[132:135]
    v_exp_f32 v121, v121
    v_mfma_f32_16x16x32_bf16 v[164:167], a[164:167], v[52:55], v[164:167]
    s_waitcnt lgkmcnt(3)
    ds_read_b128 a[184:187], v20 offset:22528
    v_cvt_pk_bf16_f32 v60, v120, v121
    v_mfma_f32_16x16x32_bf16 v[136:139], a[168:171], v[48:51], v[136:139]
    v_exp_f32 v122, v122
    v_mfma_f32_16x16x32_bf16 v[168:171], a[168:171], v[52:55], v[168:171]
    s_waitcnt lgkmcnt(3)
    v_mfma_f32_16x16x32_bf16 v[140:143], a[172:175], v[48:51], v[140:143]
    v_exp_f32 v123, v123
    v_mfma_f32_16x16x32_bf16 v[172:175], a[172:175], v[52:55], v[172:175]
    s_waitcnt lgkmcnt(2)
    ds_read_b128 a[188:191], v20 offset:23552
    v_cvt_pk_bf16_f32 v61, v122, v123
    v_mfma_f32_16x16x32_bf16 v[144:147], a[176:179], v[48:51], v[144:147]
    v_exp_f32 v124, v124
    v_mfma_f32_16x16x32_bf16 v[176:179], a[176:179], v[52:55], v[176:179]
    s_waitcnt lgkmcnt(2)
    v_mfma_f32_16x16x32_bf16 v[148:151], a[180:183], v[48:51], v[148:151]
    v_exp_f32 v125, v125
    v_mfma_f32_16x16x32_bf16 v[180:183], a[180:183], v[52:55], v[180:183]
    s_waitcnt lgkmcnt(1)
    v_cvt_pk_bf16_f32 v62, v124, v125
    v_xor_b32 v19, 98304, v19
    v_mfma_f32_16x16x32_bf16 v[152:155], a[184:187], v[48:51], v[152:155]
    v_exp_f32 v126, v126
    v_mfma_f32_16x16x32_bf16 v[184:187], a[184:187], v[52:55], v[184:187]
    s_waitcnt lgkmcnt(0)
    v_xor_b32 v20, 98304, v20
    v_mfma_f32_16x16x32_bf16 v[156:159], a[188:191], v[48:51], v[156:159]
    v_exp_f32 v127, v127
    v_mfma_f32_16x16x32_bf16 v[188:191], a[188:191], v[52:55], v[188:191]
    v_cvt_pk_bf16_f32 v63, v126, v127
    v_mfma_f32_16x16x32_bf16 v[112:115], a[128:131], a[96:99], v[72:75]
    v_exp_f32 v96, v96
    v_mfma_f32_16x16x32_bf16 v[112:115], a[132:135], a[100:103], v[112:115]
    v_mfma_f32_16x16x32_bf16 v[112:115], a[136:139], a[104:107], v[112:115]
    v_exp_f32 v97, v97
    v_mfma_f32_16x16x32_bf16 v[112:115], a[140:143], a[108:111], v[112:115]
    v_cvt_pk_bf16_f32 v48, v96, v97
    v_mfma_f32_16x16x32_bf16 v[120:123], a[128:131], a[112:115], v[76:79]
    v_exp_f32 v98, v98
    v_mfma_f32_16x16x32_bf16 v[120:123], a[132:135], a[116:119], v[120:123]
    v_mfma_f32_16x16x32_bf16 v[120:123], a[136:139], a[120:123], v[120:123]
    v_exp_f32 v99, v99
    v_mfma_f32_16x16x32_bf16 v[120:123], a[140:143], a[124:127], v[120:123]
    v_mfma_f32_16x16x32_bf16 v[116:119], a[144:147], a[96:99], v[72:75]
    v_exp_f32 v100, v100
    v_mfma_f32_16x16x32_bf16 v[116:119], a[148:151], a[100:103], v[116:119]
    ds_read_b128 a[128:131], v18 offset:16384
    v_cvt_pk_bf16_f32 v49, v98, v99
    v_mfma_f32_16x16x32_bf16 v[116:119], a[152:155], a[104:107], v[116:119]
    s_add_u32 s19, s82, 32768
    v_exp_f32 v101, v101
    v_mfma_f32_16x16x32_bf16 v[116:119], a[156:159], a[108:111], v[116:119]
    s_sub_u32 s82, s12, s13
    ds_read_b128 a[132:135], v18 offset:17408
    v_cvt_pk_bf16_f32 v50, v100, v101
    v_mfma_f32_16x16x32_bf16 v[124:127], a[144:147], a[112:115], v[76:79]
    s_sub_u32 s82, s82, 1
    v_exp_f32 v102, v102
    v_mfma_f32_16x16x32_bf16 v[124:127], a[148:151], a[116:119], v[124:127]
    s_cmp_gt_u32 s12, s13
    s_cselect_b32 s82, s82, s12
    s_mul_i32 s82, s82, 65536
    ds_read_b128 a[136:139], v18 offset:18432
    v_mfma_f32_16x16x32_bf16 v[124:127], a[152:155], a[120:123], v[124:127]
    s_add_u32 s82, s82, s81
    v_exp_f32 v103, v103
    v_mfma_f32_16x16x32_bf16 v[124:127], a[156:159], a[124:127], v[124:127]
    s_cmp_ge_u32 s12, 17
    s_cselect_b32 s82, 2147471360, s82
    ds_read_b128 a[140:143], v18 offset:19456
    v_cvt_pk_bf16_f32 v51, v102, v103
    v_mfma_f32_16x16x32_bf16 v[40:43], v[28:31], v[56:59], v[40:43]
    s_add_u32 s12, s12, 1
    v_exp_f32 v104, v104
    v_mfma_f32_16x16x32_bf16 v[44:47], v[28:31], v[60:63], v[44:47]
    ds_read_b128 a[144:147], v18 offset:20480
    v_mfma_f32_16x16x32_bf16 v[192:195], a[160:163], v[56:59], v[192:195]
    v_exp_f32 v105, v105
    v_mfma_f32_16x16x32_bf16 v[224:227], a[160:163], v[60:63], v[224:227]
    ds_read_b128 a[148:151], v18 offset:21504
    v_cvt_pk_bf16_f32 v52, v104, v105
    v_mfma_f32_16x16x32_bf16 v[196:199], a[164:167], v[56:59], v[196:199]
    v_exp_f32 v106, v106
    v_mfma_f32_16x16x32_bf16 v[228:231], a[164:167], v[60:63], v[228:231]
    ds_read_b128 a[152:155], v18 offset:22528
    v_mfma_f32_16x16x32_bf16 v[200:203], a[168:171], v[56:59], v[200:203]
    v_exp_f32 v107, v107
    v_mfma_f32_16x16x32_bf16 v[232:235], a[168:171], v[60:63], v[232:235]
    ds_read_b128 a[156:159], v18 offset:23552
    v_cvt_pk_bf16_f32 v53, v106, v107
    v_mfma_f32_16x16x32_bf16 v[204:207], a[172:175], v[56:59], v[204:207]
    v_exp_f32 v108, v108
    v_mfma_f32_16x16x32_bf16 v[236:239], a[172:175], v[60:63], v[236:239]
    v_mfma_f32_16x16x32_bf16 v[208:211], a[176:179], v[56:59], v[208:211]
    v_exp_f32 v109, v109
    v_mfma_f32_16x16x32_bf16 v[240:243], a[176:179], v[60:63], v[240:243]
    v_cvt_pk_bf16_f32 v54, v108, v109
    v_xor_b32 v18, 196608, v18
    v_mfma_f32_16x16x32_bf16 v[212:215], a[180:183], v[56:59], v[212:215]
    v_exp_f32 v110, v110
    v_mfma_f32_16x16x32_bf16 v[244:247], a[180:183], v[60:63], v[244:247]
    v_mfma_f32_16x16x32_bf16 v[216:219], a[184:187], v[56:59], v[216:219]
    v_exp_f32 v111, v111
    v_mfma_f32_16x16x32_bf16 v[248:251], a[184:187], v[60:63], v[248:251]
    v_cvt_pk_bf16_f32 v55, v110, v111
    v_mfma_f32_16x16x32_bf16 v[220:223], a[188:191], v[56:59], v[220:223]
    v_mfma_f32_16x16x32_bf16 v[252:255], a[188:191], v[60:63], v[252:255]
    s_waitcnt vmcnt(0) lgkmcnt(0)
    s_barrier
    v_mfma_f32_16x16x32_bf16 v[96:99], a[128:131], a[64:67], v[64:67]
    s_add_u32 m0, s15, 0
    ds_read_b128 a[160:163], v19 offset:0
    v_mfma_f32_16x16x32_bf16 v[96:99], a[132:135], a[68:71], v[96:99]
    ds_read_b128 a[164:167], v19 offset:1024
    v_mfma_f32_16x16x32_bf16 v[96:99], a[136:139], a[72:75], v[96:99]
    v_exp_f32 v112, v112
    v_mfma_f32_16x16x32_bf16 v[96:99], a[140:143], a[76:79], v[96:99]
    buffer_load_dwordx4 v1, s[8:11], s82 offen offset:0  lds
    v_mfma_f32_16x16x32_bf16 v[104:107], a[128:131], a[80:83], v[68:71]
    v_exp_f32 v113, v113
    v_mfma_f32_16x16x32_bf16 v[104:107], a[132:135], a[84:87], v[104:107]
    ds_read_b128 a[168:171], v19 offset:2048
    v_cvt_pk_bf16_f32 v56, v112, v113
    v_mfma_f32_16x16x32_bf16 v[104:107], a[136:139], a[88:91], v[104:107]
    v_exp_f32 v114, v114
    v_mfma_f32_16x16x32_bf16 v[104:107], a[140:143], a[92:95], v[104:107]
    buffer_load_dwordx4 v1, s[8:11], s82 offen offset:1024  lds
    v_mfma_f32_16x16x32_bf16 v[100:103], a[144:147], a[64:67], v[64:67]
    v_exp_f32 v115, v115
    v_mfma_f32_16x16x32_bf16 v[100:103], a[148:151], a[68:71], v[100:103]
    ds_read_b128 a[172:175], v19 offset:3072
    v_cvt_pk_bf16_f32 v57, v114, v115
    v_mfma_f32_16x16x32_bf16 v[100:103], a[152:155], a[72:75], v[100:103]
    v_exp_f32 v116, v116
    v_mfma_f32_16x16x32_bf16 v[100:103], a[156:159], a[76:79], v[100:103]
    buffer_load_dwordx4 v1, s[8:11], s82 offen offset:2048  lds
    v_mfma_f32_16x16x32_bf16 v[108:111], a[144:147], a[80:83], v[68:71]
    v_exp_f32 v117, v117
    v_mfma_f32_16x16x32_bf16 v[108:111], a[148:151], a[84:87], v[108:111]
    ds_read_b128 a[176:179], v20 offset:4096
    v_cvt_pk_bf16_f32 v58, v116, v117
    v_mfma_f32_16x16x32_bf16 v[108:111], a[152:155], a[88:91], v[108:111]
    v_exp_f32 v118, v118
    v_mfma_f32_16x16x32_bf16 v[108:111], a[156:159], a[92:95], v[108:111]
    buffer_load_dwordx4 v1, s[8:11], s82 offen offset:3072  lds
    v_mfma_f32_16x16x32_bf16 v[32:35], v[28:31], v[48:51], v[32:35]
    s_add_u32 m0, s15, 4096
    v_exp_f32 v119, v119
    v_mfma_f32_16x16x32_bf16 v[36:39], v[28:31], v[52:55], v[36:39]
    s_waitcnt lgkmcnt(4)
    ds_read_b128 a[180:183], v20 offset:5120
    v_cvt_pk_bf16_f32 v59, v118, v119
    v_mfma_f32_16x16x32_bf16 v[128:131], a[160:163], v[48:51], v[128:131]
    s_waitcnt lgkmcnt(4)
    v_exp_f32 v120, v120
    v_mfma_f32_16x16x32_bf16 v[160:163], a[160:163], v[52:55], v[160:163]
    buffer_load_dwordx4 v15, s[8:11], s82 offen offset:0  lds
    v_mfma_f32_16x16x32_bf16 v[132:135], a[164:167], v[48:51], v[132:135]
    v_exp_f32 v121, v121
    v_mfma_f32_16x16x32_bf16 v[164:167], a[164:167], v[52:55], v[164:167]
    s_waitcnt lgkmcnt(3)
    ds_read_b128 a[184:187], v20 offset:6144
    v_cvt_pk_bf16_f32 v60, v120, v121
    v_mfma_f32_16x16x32_bf16 v[136:139], a[168:171], v[48:51], v[136:139]
    s_waitcnt lgkmcnt(3)
    v_exp_f32 v122, v122
    v_mfma_f32_16x16x32_bf16 v[168:171], a[168:171], v[52:55], v[168:171]
    buffer_load_dwordx4 v15, s[8:11], s82 offen offset:1024  lds
    v_mfma_f32_16x16x32_bf16 v[140:143], a[172:175], v[48:51], v[140:143]
    v_exp_f32 v123, v123
    v_mfma_f32_16x16x32_bf16 v[172:175], a[172:175], v[52:55], v[172:175]
    s_waitcnt lgkmcnt(2)
    ds_read_b128 a[188:191], v20 offset:7168
    v_cvt_pk_bf16_f32 v61, v122, v123
    v_mfma_f32_16x16x32_bf16 v[144:147], a[176:179], v[48:51], v[144:147]
    s_waitcnt lgkmcnt(2)
    v_exp_f32 v124, v124
    v_mfma_f32_16x16x32_bf16 v[176:179], a[176:179], v[52:55], v[176:179]
    buffer_load_dwordx4 v15, s[8:11], s82 offen offset:2048  lds
    v_mfma_f32_16x16x32_bf16 v[148:151], a[180:183], v[48:51], v[148:151]
    v_exp_f32 v125, v125
    v_mfma_f32_16x16x32_bf16 v[180:183], a[180:183], v[52:55], v[180:183]
    s_waitcnt lgkmcnt(1)
    v_cvt_pk_bf16_f32 v62, v124, v125
    v_mfma_f32_16x16x32_bf16 v[152:155], a[184:187], v[48:51], v[152:155]
    s_waitcnt lgkmcnt(0)
    v_exp_f32 v126, v126
    v_mfma_f32_16x16x32_bf16 v[184:187], a[184:187], v[52:55], v[184:187]
    buffer_load_dwordx4 v15, s[8:11], s82 offen offset:3072  lds
    v_mfma_f32_16x16x32_bf16 v[156:159], a[188:191], v[48:51], v[156:159]
    s_xor_b32 s15, s15, 196608
    v_exp_f32 v127, v127
    v_mfma_f32_16x16x32_bf16 v[188:191], a[188:191], v[52:55], v[188:191]
    s_add_u32 m0, s16, 0
    v_cvt_pk_bf16_f32 v63, v126, v127
    v_mfma_f32_16x16x32_bf16 v[112:115], a[128:131], a[96:99], v[72:75]
    v_mfma_f32_16x16x32_bf16 v[112:115], a[132:135], a[100:103], v[112:115]
    v_mfma_f32_16x16x32_bf16 v[112:115], a[136:139], a[104:107], v[112:115]
    v_exp_f32 v96, v96
    v_mfma_f32_16x16x32_bf16 v[112:115], a[140:143], a[108:111], v[112:115]
    buffer_load_dwordx4 v1, s[8:11], s19 offen offset:0  lds
    v_mfma_f32_16x16x32_bf16 v[120:123], a[128:131], a[112:115], v[76:79]
    v_exp_f32 v97, v97
    v_mfma_f32_16x16x32_bf16 v[120:123], a[132:135], a[116:119], v[120:123]
    ds_read_b128 a[128:131], v18 offset:0
    v_cvt_pk_bf16_f32 v48, v96, v97
    v_mfma_f32_16x16x32_bf16 v[120:123], a[136:139], a[120:123], v[120:123]
    v_exp_f32 v98, v98
    v_mfma_f32_16x16x32_bf16 v[120:123], a[140:143], a[124:127], v[120:123]
    buffer_load_dwordx4 v1, s[8:11], s19 offen offset:1024  lds
    v_mfma_f32_16x16x32_bf16 v[116:119], a[144:147], a[96:99], v[72:75]
    v_exp_f32 v99, v99
    v_mfma_f32_16x16x32_bf16 v[116:119], a[148:151], a[100:103], v[116:119]
    ds_read_b128 a[132:135], v18 offset:1024
    v_cvt_pk_bf16_f32 v49, v98, v99
    v_mfma_f32_16x16x32_bf16 v[116:119], a[152:155], a[104:107], v[116:119]
    v_exp_f32 v100, v100
    v_mfma_f32_16x16x32_bf16 v[116:119], a[156:159], a[108:111], v[116:119]
    buffer_load_dwordx4 v1, s[8:11], s19 offen offset:2048  lds
    v_mfma_f32_16x16x32_bf16 v[124:127], a[144:147], a[112:115], v[76:79]
    v_exp_f32 v101, v101
    v_mfma_f32_16x16x32_bf16 v[124:127], a[148:151], a[116:119], v[124:127]
    ds_read_b128 a[136:139], v18 offset:2048
    v_cvt_pk_bf16_f32 v50, v100, v101
    v_mfma_f32_16x16x32_bf16 v[124:127], a[152:155], a[120:123], v[124:127]
    v_exp_f32 v102, v102
    v_mfma_f32_16x16x32_bf16 v[124:127], a[156:159], a[124:127], v[124:127]
    buffer_load_dwordx4 v1, s[8:11], s19 offen offset:3072  lds
    v_mfma_f32_16x16x32_bf16 v[40:43], v[28:31], v[56:59], v[40:43]
    s_add_u32 m0, s16, 4096
    v_exp_f32 v103, v103
    v_mfma_f32_16x16x32_bf16 v[44:47], v[28:31], v[60:63], v[44:47]
    ds_read_b128 a[140:143], v18 offset:3072
    v_cvt_pk_bf16_f32 v51, v102, v103
    v_mfma_f32_16x16x32_bf16 v[192:195], a[160:163], v[56:59], v[192:195]
    v_exp_f32 v104, v104
    v_mfma_f32_16x16x32_bf16 v[224:227], a[160:163], v[60:63], v[224:227]
    buffer_load_dwordx4 v15, s[8:11], s19 offen offset:0  lds
    v_mfma_f32_16x16x32_bf16 v[196:199], a[164:167], v[56:59], v[196:199]
    v_exp_f32 v105, v105
    v_mfma_f32_16x16x32_bf16 v[228:231], a[164:167], v[60:63], v[228:231]
    ds_read_b128 a[144:147], v18 offset:4096
    v_cvt_pk_bf16_f32 v52, v104, v105
    v_mfma_f32_16x16x32_bf16 v[200:203], a[168:171], v[56:59], v[200:203]
    v_exp_f32 v106, v106
    v_mfma_f32_16x16x32_bf16 v[232:235], a[168:171], v[60:63], v[232:235]
    buffer_load_dwordx4 v15, s[8:11], s19 offen offset:1024  lds
    v_mfma_f32_16x16x32_bf16 v[204:207], a[172:175], v[56:59], v[204:207]
    v_exp_f32 v107, v107
    v_mfma_f32_16x16x32_bf16 v[236:239], a[172:175], v[60:63], v[236:239]
    ds_read_b128 a[148:151], v18 offset:5120
    v_cvt_pk_bf16_f32 v53, v106, v107
    v_mfma_f32_16x16x32_bf16 v[208:211], a[176:179], v[56:59], v[208:211]
    s_sub_u32 s14, s14, 1
    v_exp_f32 v108, v108
    v_mfma_f32_16x16x32_bf16 v[240:243], a[176:179], v[60:63], v[240:243]
    buffer_load_dwordx4 v15, s[8:11], s19 offen offset:2048  lds
    v_mfma_f32_16x16x32_bf16 v[212:215], a[180:183], v[56:59], v[212:215]
    v_exp_f32 v109, v109
    v_mfma_f32_16x16x32_bf16 v[244:247], a[180:183], v[60:63], v[244:247]
    ds_read_b128 a[152:155], v18 offset:6144
    v_cvt_pk_bf16_f32 v54, v108, v109
    v_mfma_f32_16x16x32_bf16 v[216:219], a[184:187], v[56:59], v[216:219]
    v_exp_f32 v110, v110
    v_mfma_f32_16x16x32_bf16 v[248:251], a[184:187], v[60:63], v[248:251]
    buffer_load_dwordx4 v15, s[8:11], s19 offen offset:3072  lds
    v_mfma_f32_16x16x32_bf16 v[220:223], a[188:191], v[56:59], v[220:223]
    s_xor_b32 s16, s16, 98304
    v_exp_f32 v111, v111
    v_mfma_f32_16x16x32_bf16 v[252:255], a[188:191], v[60:63], v[252:255]
    ds_read_b128 a[156:159], v18 offset:7168
    v_cvt_pk_bf16_f32 v55, v110, v111
    s_cmp_lg_u32 s14, 0
    s_cbranch_scc1 L_t1_loop
L_t1_diag:
    s_waitcnt lgkmcnt(7)
    v_mfma_f32_16x16x32_bf16 v[96:99], a[128:131], a[64:67], v[80:83]
    s_waitcnt lgkmcnt(6)
    ds_read_b128 a[160:163], v19 offset:16384
    v_mfma_f32_16x16x32_bf16 v[96:99], a[132:135], a[68:71], v[96:99]
    s_waitcnt lgkmcnt(6)
    ds_read_b128 a[164:167], v19 offset:17408
    v_mfma_f32_16x16x32_bf16 v[96:99], a[136:139], a[72:75], v[96:99]
    s_waitcnt lgkmcnt(6)
    v_exp_f32 v112, v112
    v_mfma_f32_16x16x32_bf16 v[96:99], a[140:143], a[76:79], v[96:99]
    v_mfma_f32_16x16x32_bf16 v[104:107], a[128:131], a[80:83], v[88:91]
    v_exp_f32 v113, v113
    v_mfma_f32_16x16x32_bf16 v[104:107], a[132:135], a[84:87], v[104:107]
    ds_read_b128 a[168:171], v19 offset:18432
    v_cvt_pk_bf16_f32 v56, v112, v113
    v_mfma_f32_16x16x32_bf16 v[104:107], a[136:139], a[88:91], v[104:107]
    v_exp_f32 v114, v114
    v_mfma_f32_16x16x32_bf16 v[104:107], a[140:143], a[92:95], v[104:107]
    s_waitcnt lgkmcnt(6)
    v_mfma_f32_16x16x32_bf16 v[100:103], a[144:147], a[64:67], v[84:87]
    s_waitcnt lgkmcnt(5)
    v_exp_f32 v115, v115
    v_mfma_f32_16x16x32_bf16 v[100:103], a[148:151], a[68:71], v[100:103]
    s_waitcnt lgkmcnt(4)
    ds_read_b128 a[172:175], v19 offset:19456
    v_cvt_pk_bf16_f32 v57, v114, v115
    v_mfma_f32_16x16x32_bf16 v[100:103], a[152:155], a[72:75], v[100:103]
    s_waitcnt lgkmcnt(4)
    v_exp_f32 v116, v116
    v_mfma_f32_16x16x32_bf16 v[100:103], a[156:159], a[76:79], v[100:103]
    v_mfma_f32_16x16x32_bf16 v[108:111], a[144:147], a[80:83], v[92:95]
    v_exp_f32 v117, v117
    v_mfma_f32_16x16x32_bf16 v[108:111], a[148:151], a[84:87], v[108:111]
    ds_read_b128 a[176:179], v20 offset:20480
    v_cvt_pk_bf16_f32 v58, v116, v117
    v_mfma_f32_16x16x32_bf16 v[108:111], a[152:155], a[88:91], v[108:111]
    v_exp_f32 v118, v118
    v_mfma_f32_16x16x32_bf16 v[108:111], a[156:159], a[92:95], v[108:111]
    v_mfma_f32_16x16x32_bf16 v[32:35], v[28:31], v[48:51], v[32:35]
    v_exp_f32 v119, v119
    v_mfma_f32_16x16x32_bf16 v[36:39], v[28:31], v[52:55], v[36:39]
    s_waitcnt lgkmcnt(4)
    ds_read_b128 a[180:183], v20 offset:21504
    v_cvt_pk_bf16_f32 v59, v118, v119
    v_mfma_f32_16x16x32_bf16 v[128:131], a[160:163], v[48:51], v[128:131]
    v_exp_f32 v120, v120
    v_mfma_f32_16x16x32_bf16 v[160:163], a[160:163], v[52:55], v[160:163]
    s_waitcnt lgkmcnt(4)
    v_add_f32 v80, 0, v22
    v_min_f32 v80, v80, v72
    v_mfma_f32_16x16x32_bf16 v[132:135], a[164:167], v[48:51], v[132:135]
    v_exp_f32 v121, v121
    v_mfma_f32_16x16x32_bf16 v[164:167], a[164:167], v[52:55], v[164:167]
    s_waitcnt lgkmcnt(3)
    ds_read_b128 a[184:187], v20 offset:22528
    v_cvt_pk_bf16_f32 v60, v120, v121
    v_mfma_f32_16x16x32_bf16 v[136:139], a[168:171], v[48:51], v[136:139]
    v_exp_f32 v122, v122
    v_mfma_f32_16x16x32_bf16 v[168:171], a[168:171], v[52:55], v[168:171]
    s_waitcnt lgkmcnt(3)
    v_add_f32 v81, 0xf1800000, v22
    v_min_f32 v81, v81, v73
    v_mfma_f32_16x16x32_bf16 v[140:143], a[172:175], v[48:51], v[140:143]
    v_exp_f32 v123, v123
    v_mfma_f32_16x16x32_bf16 v[172:175], a[172:175], v[52:55], v[172:175]
    s_waitcnt lgkmcnt(2)
    ds_read_b128 a[188:191], v20 offset:23552
    v_cvt_pk_bf16_f32 v61, v122, v123
    v_mfma_f32_16x16x32_bf16 v[144:147], a[176:179], v[48:51], v[144:147]
    v_exp_f32 v124, v124
    v_mfma_f32_16x16x32_bf16 v[176:179], a[176:179], v[52:55], v[176:179]
    s_waitcnt lgkmcnt(2)
    v_add_f32 v82, 0xf2000000, v22
    v_min_f32 v82, v82, v74
    v_mfma_f32_16x16x32_bf16 v[148:151], a[180:183], v[48:51], v[148:151]
    v_exp_f32 v125, v125
    v_mfma_f32_16x16x32_bf16 v[180:183], a[180:183], v[52:55], v[180:183]
    s_waitcnt lgkmcnt(1)
    v_cvt_pk_bf16_f32 v62, v124, v125
    v_xor_b32 v19, 98304, v19
    v_mfma_f32_16x16x32_bf16 v[152:155], a[184:187], v[48:51], v[152:155]
    v_exp_f32 v126, v126
    v_mfma_f32_16x16x32_bf16 v[184:187], a[184:187], v[52:55], v[184:187]
    s_waitcnt lgkmcnt(0)
    v_xor_b32 v20, 98304, v20
    v_add_f32 v83, 0xf2400000, v22
    v_mfma_f32_16x16x32_bf16 v[156:159], a[188:191], v[48:51], v[156:159]
    v_exp_f32 v127, v127
    v_mfma_f32_16x16x32_bf16 v[188:191], a[188:191], v[52:55], v[188:191]
    v_cvt_pk_bf16_f32 v63, v126, v127
    v_min_f32 v83, v83, v75
    v_add_f32 v84, 0xf3800000, v22
    v_min_f32 v84, v84, v72
    v_mfma_f32_16x16x32_bf16 v[112:115], a[128:131], a[96:99], v[72:75]
    v_exp_f32 v96, v96
    v_mfma_f32_16x16x32_bf16 v[112:115], a[132:135], a[100:103], v[112:115]
    v_mfma_f32_16x16x32_bf16 v[112:115], a[136:139], a[104:107], v[112:115]
    v_exp_f32 v97, v97
    v_mfma_f32_16x16x32_bf16 v[112:115], a[140:143], a[108:111], v[112:115]
    v_cvt_pk_bf16_f32 v48, v96, v97
    v_add_f32 v85, 0xf3880000, v22
    v_mfma_f32_16x16x32_bf16 v[120:123], a[128:131], a[112:115], v[76:79]
    v_exp_f32 v98, v98
    v_mfma_f32_16x16x32_bf16 v[120:123], a[132:135], a[116:119], v[120:123]
    v_min_f32 v85, v85, v73
    v_add_f32 v86, 0xf3900000, v22
    v_mfma_f32_16x16x32_bf16 v[120:123], a[136:139], a[120:123], v[120:123]
    v_exp_f32 v99, v99
    v_mfma_f32_16x16x32_bf16 v[120:123], a[140:143], a[124:127], v[120:123]
    v_min_f32 v86, v86, v74
    v_add_f32 v87, 0xf3980000, v22
    v_mfma_f32_16x16x32_bf16 v[116:119], a[144:147], a[96:99], v[72:75]
    v_exp_f32 v100, v100
    v_mfma_f32_16x16x32_bf16 v[116:119], a[148:151], a[100:103], v[116:119]
    ds_read_b128 a[128:131], v18 offset:16384
    v_cvt_pk_bf16_f32 v49, v98, v99
    v_mfma_f32_16x16x32_bf16 v[116:119], a[152:155], a[104:107], v[116:119]
    s_add_u32 s19, s82, 32768
    v_exp_f32 v101, v101
    v_mfma_f32_16x16x32_bf16 v[116:119], a[156:159], a[108:111], v[116:119]
    s_sub_u32 s82, s12, s13
    ds_read_b128 a[132:135], v18 offset:17408
    v_cvt_pk_bf16_f32 v50, v100, v101
    v_mfma_f32_16x16x32_bf16 v[124:127], a[144:147], a[112:115], v[76:79]
    s_sub_u32 s82, s82, 1
    v_exp_f32 v102, v102
    v_mfma_f32_16x16x32_bf16 v[124:127], a[148:151], a[116:119], v[124:127]
    s_cmp_gt_u32 s12, s13
    s_cselect_b32 s82, s82, s12
    s_mul_i32 s82, s82, 65536
    ds_read_b128 a[136:139], v18 offset:18432
    v_mfma_f32_16x16x32_bf16 v[124:127], a[152:155], a[120:123], v[124:127]
    s_add_u32 s82, s82, s81
    v_exp_f32 v103, v103
    v_mfma_f32_16x16x32_bf16 v[124:127], a[156:159], a[124:127], v[124:127]
    s_cmp_ge_u32 s12, 17
    s_cselect_b32 s82, 2147471360, s82
    ds_read_b128 a[140:143], v18 offset:19456
    v_cvt_pk_bf16_f32 v51, v102, v103
    v_mfma_f32_16x16x32_bf16 v[40:43], v[28:31], v[56:59], v[40:43]
    s_add_u32 s12, s12, 1
    v_exp_f32 v104, v104
    v_mfma_f32_16x16x32_bf16 v[44:47], v[28:31], v[60:63], v[44:47]
    ds_read_b128 a[144:147], v18 offset:20480
    v_min_f32 v87, v87, v75
    v_mfma_f32_16x16x32_bf16 v[192:195], a[160:163], v[56:59], v[192:195]
    v_exp_f32 v105, v105
    v_mfma_f32_16x16x32_bf16 v[224:227], a[160:163], v[60:63], v[224:227]
    ds_read_b128 a[148:151], v18 offset:21504
    v_cvt_pk_bf16_f32 v52, v104, v105
    v_mfma_f32_16x16x32_bf16 v[196:199], a[164:167], v[56:59], v[196:199]
    v_exp_f32 v106, v106
    v_mfma_f32_16x16x32_bf16 v[228:231], a[164:167], v[60:63], v[228:231]
    ds_read_b128 a[152:155], v18 offset:22528
    v_add_f32 v88, 0x73800000, v22
    v_mfma_f32_16x16x32_bf16 v[200:203], a[168:171], v[56:59], v[200:203]
    v_exp_f32 v107, v107
    v_mfma_f32_16x16x32_bf16 v[232:235], a[168:171], v[60:63], v[232:235]
    ds_read_b128 a[156:159], v18 offset:23552
    v_cvt_pk_bf16_f32 v53, v106, v107
    v_mfma_f32_16x16x32_bf16 v[204:207], a[172:175], v[56:59], v[204:207]
    v_exp_f32 v108, v108
    v_mfma_f32_16x16x32_bf16 v[236:239], a[172:175], v[60:63], v[236:239]
    v_min_f32 v88, v88, v76
    v_add_f32 v89, 0x73700000, v22
    v_mfma_f32_16x16x32_bf16 v[208:211], a[176:179], v[56:59], v[208:211]
    v_exp_f32 v109, v109
    v_mfma_f32_16x16x32_bf16 v[240:243], a[176:179], v[60:63], v[240:243]
    v_cvt_pk_bf16_f32 v54, v108, v109
    v_xor_b32 v18, 196608, v18
    v_mfma_f32_16x16x32_bf16 v[212:215], a[180:183], v[56:59], v[212:215]
    v_exp_f32 v110, v110
    v_mfma_f32_16x16x32_bf16 v[244:247], a[180:183], v[60:63], v[244:247]
    v_min_f32 v89, v89, v77
    v_add_f32 v90, 0x73600000, v22
    v_mfma_f32_16x16x32_bf16 v[216:219], a[184:187], v[56:59], v[216:219]
    v_exp_f32 v111, v111
    v_mfma_f32_16x16x32_bf16 v[248:251], a[184:187], v[60:63], v[248:251]
    v_cvt_pk_bf16_f32 v55, v110, v111
    v_min_f32 v90, v90, v78
    v_mfma_f32_16x16x32_bf16 v[220:223], a[188:191], v[56:59], v[220:223]
    v_add_f32 v91, 0x73500000, v22
    v_min_f32 v91, v91, v79
    v_mfma_f32_16x16x32_bf16 v[252:255], a[188:191], v[60:63], v[252:255]
    v_add_f32 v92, 0, v22
    v_min_f32 v92, v92, v76
    v_add_f32 v93, 0xf1800000, v22
    v_min_f32 v93, v93, v77
    v_add_f32 v94, 0xf2000000, v22
    v_min_f32 v94, v94, v78
    v_add_f32 v95, 0xf2400000, v22
    v_min_f32 v95, v95, v79
    s_waitcnt vmcnt(0) lgkmcnt(0)
    s_barrier
    v_mfma_f32_16x16x32_bf16 v[96:99], a[128:131], a[96:99], v[80:83]
    s_xor_b32 s100, s16, 8192
    ds_read_b128 a[176:179], v20 offset:4096
    v_lshrrev_b32 v13, 1, v1
    v_mfma_f32_16x16x32_bf16 v[96:99], a[132:135], a[100:103], v[96:99]
    s_add_u32 m0, s15, 0
    ds_read_b128 a[180:183], v20 offset:5120
    v_add_u32 v12, s100, v13
    v_mfma_f32_16x16x32_bf16 v[96:99], a[136:139], a[104:107], v[96:99]
    buffer_load_dwordx4 v1, s[8:11], s82 offen offset:0  lds
    v_exp_f32 v112, v112
    v_mfma_f32_16x16x32_bf16 v[96:99], a[140:143], a[108:111], v[96:99]
    v_exp_f32 v113, v113
    v_mfma_f32_16x16x32_bf16 v[100:103], a[144:147], a[96:99], v[84:87]
    ds_read_b128 a[184:187], v20 offset:6144
    v_cvt_pk_bf16_f32 v56, v112, v113
    v_mfma_f32_16x16x32_bf16 v[100:103], a[148:151], a[100:103], v[100:103]
    v_exp_f32 v114, v114
    v_mfma_f32_16x16x32_bf16 v[100:103], a[152:155], a[104:107], v[100:103]
    buffer_load_dwordx4 v1, s[8:11], s82 offen offset:1024  lds
    v_exp_f32 v115, v115
    v_mfma_f32_16x16x32_bf16 v[100:103], a[156:159], a[108:111], v[100:103]
    ds_read_b128 a[188:191], v20 offset:7168
    v_cvt_pk_bf16_f32 v57, v114, v115
    v_mfma_f32_16x16x32_bf16 v[104:107], a[128:131], a[112:115], v[88:91]
    v_exp_f32 v116, v116
    v_mfma_f32_16x16x32_bf16 v[104:107], a[132:135], a[116:119], v[104:107]
    v_exp_f32 v117, v117
    v_mfma_f32_16x16x32_bf16 v[104:107], a[136:139], a[120:123], v[104:107]
    ds_read_b128 a[160:163], v19 offset:0
    v_cvt_pk_bf16_f32 v58, v116, v117
    v_mfma_f32_16x16x32_bf16 v[104:107], a[140:143], a[124:127], v[104:107]
    buffer_load_dwordx4 v1, s[8:11], s82 offen offset:2048  lds
    v_exp_f32 v118, v118
    v_mfma_f32_16x16x32_bf16 v[108:111], a[144:147], a[112:115], v[92:95]
    v_exp_f32 v119, v119
    v_mfma_f32_16x16x32_bf16 v[108:111], a[148:151], a[116:119], v[108:111]
    ds_read_b128 a[164:167], v19 offset:1024
    v_cvt_pk_bf16_f32 v59, v118, v119
    v_mfma_f32_16x16x32_bf16 v[108:111], a[152:155], a[120:123], v[108:111]
    v_exp_f32 v120, v120
    v_mfma_f32_16x16x32_bf16 v[108:111], a[156:159], a[124:127], v[108:111]
    buffer_load_dwordx4 v1, s[8:11], s82 offen offset:3072  lds
    v_exp_f32 v121, v121
    v_mfma_f32_16x16x32_bf16 v[32:35], v[28:31], v[48:51], v[32:35]
    s_add_u32 m0, s15, 4096
    ds_read_b128 a[168:171], v19 offset:2048
    v_cvt_pk_bf16_f32 v60, v120, v121
    v_mfma_f32_16x16x32_bf16 v[36:39], v[28:31], v[52:55], v[36:39]
    s_waitcnt lgkmcnt(6)
    v_exp_f32 v122, v122
    v_mfma_f32_16x16x32_bf16 v[144:147], a[176:179], v[48:51], v[144:147]
    v_exp_f32 v123, v123
    v_mfma_f32_16x16x32_bf16 v[176:179], a[176:179], v[52:55], v[176:179]
    s_waitcnt lgkmcnt(5)
    ds_read_b128 a[172:175], v19 offset:3072
    v_cvt_pk_bf16_f32 v61, v122, v123
    v_mfma_f32_16x16x32_bf16 v[148:151], a[180:183], v[48:51], v[148:151]
    buffer_load_dwordx4 v15, s[8:11], s82 offen offset:0  lds
    v_exp_f32 v124, v124
    v_mfma_f32_16x16x32_bf16 v[180:183], a[180:183], v[52:55], v[180:183]
    s_waitcnt lgkmcnt(5)
    v_exp_f32 v125, v125
    v_mfma_f32_16x16x32_bf16 v[152:155], a[184:187], v[48:51], v[152:155]
    s_waitcnt lgkmcnt(4)
    v_exp_f32 v126, v126
    v_mfma_f32_16x16x32_bf16 v[184:187], a[184:187], v[52:55], v[184:187]
    buffer_load_dwordx4 v15, s[8:11], s82 offen offset:1024  lds
    v_exp_f32 v127, v127
    v_mfma_f32_16x16x32_bf16 v[156:159], a[188:191], v[48:51], v[156:159]
    ds_write_b128 v16, v[144:147] offset:32768
    v_cvt_pk_bf16_f32 v62, v124, v125
    v_mfma_f32_16x16x32_bf16 v[188:191], a[188:191], v[52:55], v[188:191]
    s_waitcnt lgkmcnt(4)
    v_exp_f32 v96, v96
    v_mfma_f32_16x16x32_bf16 v[128:131], a[160:163], v[48:51], v[128:131]
    v_exp_f32 v97, v97
    v_mfma_f32_16x16x32_bf16 v[160:163], a[160:163], v[52:55], v[160:163]
    s_waitcnt lgkmcnt(3)
    ds_write_b128 v16, v[176:179] offset:33792
    v_cvt_pk_bf16_f32 v63, v126, v127
    v_mfma_f32_16x16x32_bf16 v[132:135], a[164:167], v[48:51], v[132:135]
    s_waitcnt lgkmcnt(3)
    v_exp_f32 v98, v98
    v_mfma_f32_16x16x32_bf16 v[164:167], a[164:167], v[52:55], v[164:167]
    buffer_load_dwordx4 v15, s[8:11], s82 offen offset:2048  lds
    v_exp_f32 v99, v99
    v_mfma_f32_16x16x32_bf16 v[136:139], a[168:171], v[48:51], v[136:139]
    ds_write_b128 v16, v[148:151] offset:34816
    v_mfma_f32_16x16x32_bf16 v[168:171], a[168:171], v[52:55], v[168:171]
    s_waitcnt lgkmcnt(3)
    v_exp_f32 v100, v100
    v_mfma_f32_16x16x32_bf16 v[140:143], a[172:175], v[48:51], v[140:143]
    v_exp_f32 v101, v101
    v_mfma_f32_16x16x32_bf16 v[172:175], a[172:175], v[52:55], v[172:175]
    ds_write_b128 v16, v[180:183] offset:35840
    v_mov_b32 v33, v36
    v_mfma_f32_16x16x32_bf16 v[40:43], v[28:31], v[56:59], v[40:43]
    buffer_load_dwordx4 v15, s[8:11], s82 offen offset:3072  lds
    v_exp_f32 v102, v102
    v_mfma_f32_16x16x32_bf16 v[44:47], v[28:31], v[60:63], v[44:47]
    s_xor_b32 s15, s15, 196608
    v_exp_f32 v103, v103
    v_mfma_f32_16x16x32_bf16 v[208:211], a[176:179], v[56:59], v[208:211]
    ds_write_b128 v16, v[152:155] offset:36864
    v_cvt_pk_bf16_f32 v48, v96, v97
    v_mfma_f32_16x16x32_bf16 v[240:243], a[176:179], v[60:63], v[240:243]
    ds_read_b128 a[176:179], v20 offset:20480
    v_exp_f32 v104, v104
    v_mfma_f32_16x16x32_bf16 v[212:215], a[180:183], v[56:59], v[212:215]
    v_exp_f32 v105, v105
    v_mfma_f32_16x16x32_bf16 v[244:247], a[180:183], v[60:63], v[244:247]
    ds_read_b128 a[180:183], v20 offset:21504
    v_exp_f32 v106, v106
    v_mfma_f32_16x16x32_bf16 v[216:219], a[184:187], v[56:59], v[216:219]
    ds_write_b128 v16, v[184:187] offset:37888
    v_cvt_pk_bf16_f32 v49, v98, v99
    v_mfma_f32_16x16x32_bf16 v[248:251], a[184:187], v[60:63], v[248:251]
    ds_read_b128 a[184:187], v20 offset:22528
    v_exp_f32 v107, v107
    v_mfma_f32_16x16x32_bf16 v[220:223], a[188:191], v[56:59], v[220:223]
    v_exp_f32 v108, v108
    v_mfma_f32_16x16x32_bf16 v[252:255], a[188:191], v[60:63], v[252:255]
    ds_read_b128 a[188:191], v20 offset:23552
    v_exp_f32 v109, v109
    v_mfma_f32_16x16x32_bf16 v[192:195], a[160:163], v[56:59], v[192:195]
    ds_write_b128 v16, v[156:159] offset:38912
    v_cvt_pk_bf16_f32 v50, v100, v101
    v_mfma_f32_16x16x32_bf16 v[224:227], a[160:163], v[60:63], v[224:227]
    ds_read_b128 a[160:163], v19 offset:16384
    v_exp_f32 v110, v110
    v_mfma_f32_16x16x32_bf16 v[196:199], a[164:167], v[56:59], v[196:199]
    v_exp_f32 v111, v111
    v_mfma_f32_16x16x32_bf16 v[228:231], a[164:167], v[60:63], v[228:231]
    ds_read_b128 a[164:167], v19 offset:17408
    v_cvt_pk_bf16_f32 v51, v102, v103
    v_mfma_f32_16x16x32_bf16 v[200:203], a[168:171], v[56:59], v[200:203]
    ds_write_b128 v16, v[188:191] offset:39936
    v_cvt_pk_bf16_f32 v52, v104, v105
    v_mfma_f32_16x16x32_bf16 v[232:235], a[168:171], v[60:63], v[232:235]
    ds_read_b128 a[168:171], v19 offset:18432
    v_cvt_pk_bf16_f32 v53, v106, v107
    v_mfma_f32_16x16x32_bf16 v[204:207], a[172:175], v[56:59], v[204:207]
    v_cvt_pk_bf16_f32 v54, v108, v109
    v_cvt_pk_bf16_f32 v55, v110, v111
    v_mfma_f32_16x16x32_bf16 v[236:239], a[172:175], v[60:63], v[236:239]
    ds_read_b128 a[172:175], v19 offset:19456
    ds_write_b64 v12, v[32:33]
    s_xor_b32 s101, s16, 98304
    v_xor_b32 v12, 8192, v12
    v_add_u32 v9, s101, v1
    v_xor_b32 v8, 8192, v16
    v_xor_b32 v10, 8192, v9
L_t1_join:
    v_xor_b32 v19, 98304, v19
    v_xor_b32 v20, 98304, v20
    s_waitcnt lgkmcnt(0)
    s_barrier
    v_mfma_f32_16x16x32_bf16 v[40:43], v[28:31], v[48:51], v[40:43]
    s_lshl_b32 s100, s60, 20
    s_add_u32 s101, s100, s21
    ds_read_b64 v[120:121], v12
    v_mfma_f32_16x16x32_bf16 v[44:47], v[28:31], v[52:55], v[44:47]
    s_add_u32 s100, s100, s20
    ds_read_b128 v[144:147], v8 offset:32768
    v_lshrrev_b32 v11, 4, v2
    v_mfma_f32_16x16x32_bf16 v[208:211], a[176:179], v[48:51], v[208:211]
    ds_read_b128 v[176:179], v8 offset:33792
    v_lshrrev_b32 v13, 2, v1
    v_mfma_f32_16x16x32_bf16 v[240:243], a[176:179], v[52:55], v[240:243]
    ds_read_b128 v[148:151], v8 offset:34816
    v_add_u32 v13, 32768, v13
    v_mfma_f32_16x16x32_bf16 v[212:215], a[180:183], v[48:51], v[212:215]
    s_xor_b32 s99, s62, 8192
    ds_read_b128 v[180:183], v8 offset:35840
    v_add_u32 v14, s99, v13
    v_mfma_f32_16x16x32_bf16 v[244:247], a[180:183], v[52:55], v[244:247]
    ds_read_b128 v[152:155], v8 offset:36864
    v_cmp_eq_u32 vcc, 1, v11
    v_mfma_f32_16x16x32_bf16 v[216:219], a[184:187], v[48:51], v[216:219]
    ds_read_b128 v[184:187], v8 offset:37888
    s_waitcnt lgkmcnt(6)
    v_add_f32 v112, v120, v32
    v_mfma_f32_16x16x32_bf16 v[248:251], a[184:187], v[52:55], v[248:251]
    ds_read_b128 v[156:159], v8 offset:38912
    v_add_f32 v114, v121, v36
    v_mfma_f32_16x16x32_bf16 v[220:223], a[188:191], v[48:51], v[220:223]
    ds_read_b128 v[188:191], v8 offset:39936
    v_cndmask_b32 v12, v32, v36, vcc
    v_mfma_f32_16x16x32_bf16 v[252:255], a[188:191], v[52:55], v[252:255]
    v_rcp_f32 v112, v112
    v_mfma_f32_16x16x32_bf16 v[192:195], a[160:163], v[48:51], v[192:195]
    v_rcp_f32 v114, v114
    v_mfma_f32_16x16x32_bf16 v[224:227], a[160:163], v[52:55], v[224:227]
    v_cmp_eq_u32 vcc, 2, v11
    v_cmp_eq_u32 s[96:97], 3, v11
    v_mfma_f32_16x16x32_bf16 v[196:199], a[164:167], v[48:51], v[196:199]
    ds_write_b128 v9, v[208:211] offset:0
    v_mfma_f32_16x16x32_bf16 v[228:231], a[164:167], v[52:55], v[228:231]
    v_mfma_f32_16x16x32_bf16 v[200:203], a[168:171], v[48:51], v[200:203]
    ds_write_b128 v9, v[240:243] offset:1024
    v_mfma_f32_16x16x32_bf16 v[232:235], a[168:171], v[52:55], v[232:235]
    v_mfma_f32_16x16x32_bf16 v[204:207], a[172:175], v[48:51], v[204:207]
    ds_write_b128 v9, v[212:215] offset:2048
    v_mfma_f32_16x16x32_bf16 v[236:239], a[172:175], v[52:55], v[236:239]
    v_cndmask_b32 v12, v12, v40, vcc
    v_cndmask_b32 v12, v12, v44, s[96:97]
    ds_write_b128 v9, v[244:247] offset:3072
    s_waitcnt lgkmcnt(11)
    v_pk_add_f32 v[128:129], v[128:129], v[144:145]
    v_pk_add_f32 v[130:131], v[130:131], v[146:147]
    s_waitcnt lgkmcnt(9)
    v_pk_add_f32 v[132:133], v[132:133], v[148:149]
    v_pk_add_f32 v[134:135], v[134:135], v[150:151]
    v_pk_mul_f32 v[128:129], v[128:129], v[112:113] op_sel_hi:[1,0]
    v_pk_mul_f32 v[130:131], v[130:131], v[112:113] op_sel_hi:[1,0]
    v_pk_mul_f32 v[132:133], v[132:133], v[112:113] op_sel_hi:[1,0]
    v_pk_mul_f32 v[134:135], v[134:135], v[112:113] op_sel_hi:[1,0]
    v_cvt_pk_bf16_f32 v128, v128, v129
    v_cvt_pk_bf16_f32 v129, v130, v131
    v_cvt_pk_bf16_f32 v130, v132, v133
    s_add_u32 m0, s16, 0
    ds_write_b128 v9, v[216:219] offset:4096
    v_cvt_pk_bf16_f32 v131, v134, v135
    buffer_store_dwordx4 v[128:131], v1, s[8:11], s100 offen offset:0 sc0 sc1
    s_waitcnt lgkmcnt(8)
    v_pk_add_f32 v[136:137], v[136:137], v[152:153]
    v_pk_add_f32 v[138:139], v[138:139], v[154:155]
    s_waitcnt lgkmcnt(6)
    v_pk_add_f32 v[140:141], v[140:141], v[156:157]
    v_pk_add_f32 v[142:143], v[142:143], v[158:159]
    v_pk_mul_f32 v[136:137], v[136:137], v[112:113] op_sel_hi:[1,0]
    v_pk_mul_f32 v[138:139], v[138:139], v[112:113] op_sel_hi:[1,0]
    v_pk_mul_f32 v[140:141], v[140:141], v[112:113] op_sel_hi:[1,0]
    v_pk_mul_f32 v[142:143], v[142:143], v[112:113] op_sel_hi:[1,0]
    v_cvt_pk_bf16_f32 v136, v136, v137
    buffer_load_dwordx4 v1, s[8:11], s19 offen offset:0  lds
    ds_write_b128 v9, v[248:251] offset:5120
    v_cvt_pk_bf16_f32 v137, v138, v139
    v_cvt_pk_bf16_f32 v138, v140, v141
    v_cvt_pk_bf16_f32 v139, v142, v143
    buffer_store_dwordx4 v[136:139], v1, s[8:11], s100 offen offset:1024 sc0 sc1
    v_pk_add_f32 v[160:161], v[160:161], v[176:177]
    v_pk_add_f32 v[162:163], v[162:163], v[178:179]
    v_pk_add_f32 v[164:165], v[164:165], v[180:181]
    v_pk_add_f32 v[166:167], v[166:167], v[182:183]
    v_pk_mul_f32 v[160:161], v[160:161], v[114:115] op_sel_hi:[1,0]
    v_pk_mul_f32 v[162:163], v[162:163], v[114:115] op_sel_hi:[1,0]
    v_pk_mul_f32 v[164:165], v[164:165], v[114:115] op_sel_hi:[1,0]
    buffer_load_dwordx4 v1, s[8:11], s19 offen offset:1024  lds
    ds_write_b128 v9, v[220:223] offset:6144
    v_pk_mul_f32 v[166:167], v[166:167], v[114:115] op_sel_hi:[1,0]
    v_cvt_pk_bf16_f32 v160, v160, v161
    v_cvt_pk_bf16_f32 v161, v162, v163
    v_cvt_pk_bf16_f32 v162, v164, v165
    v_cvt_pk_bf16_f32 v163, v166, v167
    buffer_store_dwordx4 v[160:163], v15, s[8:11], s100 offen offset:0 sc0 sc1
    v_pk_add_f32 v[168:169], v[168:169], v[184:185]
    v_pk_add_f32 v[170:171], v[170:171], v[186:187]
    s_waitcnt lgkmcnt(7)
    v_pk_add_f32 v[172:173], v[172:173], v[188:189]
    v_pk_add_f32 v[174:175], v[174:175], v[190:191]
    v_pk_mul_f32 v[168:169], v[168:169], v[114:115] op_sel_hi:[1,0]
    buffer_load_dwordx4 v1, s[8:11], s19 offen offset:2048  lds
    ds_write_b128 v9, v[252:255] offset:7168
    v_pk_mul_f32 v[170:171], v[170:171], v[114:115] op_sel_hi:[1,0]
    v_pk_mul_f32 v[172:173], v[172:173], v[114:115] op_sel_hi:[1,0]
    v_pk_mul_f32 v[174:175], v[174:175], v[114:115] op_sel_hi:[1,0]
    v_cvt_pk_bf16_f32 v168, v168, v169
    v_cvt_pk_bf16_f32 v169, v170, v171
    v_cvt_pk_bf16_f32 v170, v172, v173
    v_cvt_pk_bf16_f32 v171, v174, v175
    buffer_store_dwordx4 v[168:171], v15, s[8:11], s100 offen offset:1024 sc0 sc1
    buffer_load_dwordx4 v1, s[8:11], s19 offen offset:3072  lds
    ds_write_b32 v14, v12
    v_and_b32 v14, 4294967103, v13
    v_add_u32 v14, s62, v14
    s_waitcnt lgkmcnt(0)
    s_barrier
    ds_read_b32 v116, v14 offset:128
    ds_read_b32 v118, v14 offset:192
    ds_read_b128 v[208:211], v10 offset:0
    ds_read_b128 v[212:215], v10 offset:2048
    ds_read_b128 v[216:219], v10 offset:4096
    ds_read_b128 v[220:223], v10 offset:6144
    ds_read_b128 v[240:243], v10 offset:1024
    ds_read_b128 v[244:247], v10 offset:3072
    ds_read_b128 v[248:251], v10 offset:5120
    ds_read_b128 v[252:255], v10 offset:7168
    ds_read_b32 v120, v13 offset:0
    ds_read_b32 v121, v13 offset:8192
    ds_read_b32 v122, v13 offset:16384
    ds_read_b32 v123, v13 offset:24576
    s_waitcnt lgkmcnt(13)
    v_add_f32 v116, v116, v40
    s_waitcnt lgkmcnt(12)
    v_add_f32 v118, v118, v44
    v_rcp_f32 v116, v116
    v_rcp_f32 v118, v118
    s_waitcnt lgkmcnt(11)
    v_pk_add_f32 v[192:193], v[192:193], v[208:209]
    v_pk_add_f32 v[194:195], v[194:195], v[210:211]
    s_waitcnt lgkmcnt(10)
    v_pk_add_f32 v[196:197], v[196:197], v[212:213]
    v_pk_add_f32 v[198:199], v[198:199], v[214:215]
    v_pk_mul_f32 v[192:193], v[192:193], v[116:117] op_sel_hi:[1,0]
    v_pk_mul_f32 v[194:195], v[194:195], v[116:117] op_sel_hi:[1,0]
    v_pk_mul_f32 v[196:197], v[196:197], v[116:117] op_sel_hi:[1,0]
    v_pk_mul_f32 v[198:199], v[198:199], v[116:117] op_sel_hi:[1,0]
    v_cvt_pk_bf16_f32 v192, v192, v193
    v_cvt_pk_bf16_f32 v193, v194, v195
    v_cvt_pk_bf16_f32 v194, v196, v197
    v_cvt_pk_bf16_f32 v195, v198, v199
    buffer_store_dwordx4 v[192:195], v1, s[8:11], s101 offen offset:0 sc0 sc1
    s_add_u32 m0, s16, 4096
    s_waitcnt lgkmcnt(9)
    v_pk_add_f32 v[200:201], v[200:201], v[216:217]
    v_pk_add_f32 v[202:203], v[202:203], v[218:219]
    s_waitcnt lgkmcnt(8)
    v_pk_add_f32 v[204:205], v[204:205], v[220:221]
    v_pk_add_f32 v[206:207], v[206:207], v[222:223]
    v_pk_mul_f32 v[200:201], v[200:201], v[116:117] op_sel_hi:[1,0]
    v_pk_mul_f32 v[202:203], v[202:203], v[116:117] op_sel_hi:[1,0]
    v_pk_mul_f32 v[204:205], v[204:205], v[116:117] op_sel_hi:[1,0]
    v_pk_mul_f32 v[206:207], v[206:207], v[116:117] op_sel_hi:[1,0]
    v_cvt_pk_bf16_f32 v200, v200, v201
    v_cvt_pk_bf16_f32 v201, v202, v203
    v_cvt_pk_bf16_f32 v202, v204, v205
    v_cvt_pk_bf16_f32 v203, v206, v207
    buffer_store_dwordx4 v[200:203], v1, s[8:11], s101 offen offset:1024 sc0 sc1
    buffer_load_dwordx4 v15, s[8:11], s19 offen offset:0  lds
    buffer_load_dwordx4 v15, s[8:11], s19 offen offset:1024  lds
    s_waitcnt lgkmcnt(2)
    v_add_f32 v120, v120, v121
    s_waitcnt lgkmcnt(0)
    v_add_f32 v122, v122, v123
    v_min_f32 v124, v120, v122
    v_add_f32 v120, v120, v122
    v_cmp_le_f32 vcc, 0x1f800000, v124
    s_mov_b64 s[96:97], vcc
    v_cmp_ge_f32 vcc, 0x67800000, v120
    s_and_b64 s[96:97], s[96:97], vcc
    s_cmp_eq_u64 s[96:97], -1
    s_cselect_b32 s96, s25, 1
    s_cmp_lg_u32 s96, 0
    s_cbranch_scc1 L_t1_redo
L_t1_safe:
    v_pk_add_f32 v[224:225], v[224:225], v[240:241]
    v_pk_add_f32 v[226:227], v[226:227], v[242:243]
    v_pk_add_f32 v[228:229], v[228:229], v[244:245]
    v_pk_add_f32 v[230:231], v[230:231], v[246:247]
    v_pk_mul_f32 v[224:225], v[224:225], v[118:119] op_sel_hi:[1,0]
    v_pk_mul_f32 v[226:227], v[226:227], v[118:119] op_sel_hi:[1,0]
    v_pk_mul_f32 v[228:229], v[228:229], v[118:119] op_sel_hi:[1,0]
    v_pk_mul_f32 v[230:231], v[230:231], v[118:119] op_sel_hi:[1,0]
    v_cvt_pk_bf16_f32 v224, v224, v225
    v_cvt_pk_bf16_f32 v225, v226, v227
    v_cvt_pk_bf16_f32 v226, v228, v229
    v_cvt_pk_bf16_f32 v227, v230, v231
    buffer_store_dwordx4 v[224:227], v15, s[8:11], s101 offen offset:0 sc0 sc1
    buffer_load_dwordx4 v15, s[8:11], s19 offen offset:2048  lds
    ds_read_b128 a[128:131], v18 offset:0
    ds_read_b128 a[132:135], v18 offset:1024
    ds_read_b128 a[136:139], v18 offset:2048
    ds_read_b128 a[140:143], v18 offset:3072
    v_pk_add_f32 v[232:233], v[232:233], v[248:249]
    v_pk_add_f32 v[234:235], v[234:235], v[250:251]
    v_pk_add_f32 v[236:237], v[236:237], v[252:253]
    v_pk_add_f32 v[238:239], v[238:239], v[254:255]
    v_pk_mul_f32 v[232:233], v[232:233], v[118:119] op_sel_hi:[1,0]
    v_pk_mul_f32 v[234:235], v[234:235], v[118:119] op_sel_hi:[1,0]
    v_pk_mul_f32 v[236:237], v[236:237], v[118:119] op_sel_hi:[1,0]
    v_pk_mul_f32 v[238:239], v[238:239], v[118:119] op_sel_hi:[1,0]
    v_cvt_pk_bf16_f32 v232, v232, v233
    v_cvt_pk_bf16_f32 v233, v234, v235
    v_cvt_pk_bf16_f32 v234, v236, v237
    v_cvt_pk_bf16_f32 v235, v238, v239
    buffer_store_dwordx4 v[232:235], v15, s[8:11], s101 offen offset:1024 sc0 sc1
    buffer_load_dwordx4 v15, s[8:11], s19 offen offset:3072  lds
    s_xor_b32 s16, s16, 98304
    ds_read_b128 a[144:147], v18 offset:4096
    ds_read_b128 a[148:151], v18 offset:5120
    ds_read_b128 a[152:155], v18 offset:6144
    ds_read_b128 a[156:159], v18 offset:7168
L_t2_start:
    s_waitcnt lgkmcnt(7)
    v_mfma_f32_16x16x32_bf16 v[96:99], a[128:131], a[192:195], v[64:67]
    s_waitcnt lgkmcnt(6)
    s_add_u32 s19, s82, 32768
    s_sub_u32 s82, s12, s13
    s_sub_u32 s82, s82, 1
    v_mfma_f32_16x16x32_bf16 v[96:99], a[132:135], a[196:199], v[96:99]
    s_waitcnt lgkmcnt(5)
    s_cmp_gt_u32 s12, s13
    s_cselect_b32 s82, s82, s12
    s_mul_i32 s82, s82, 65536
    s_add_u32 s82, s82, s81
    v_mfma_f32_16x16x32_bf16 v[96:99], a[136:139], a[200:203], v[96:99]
    s_waitcnt lgkmcnt(4)
    s_cmp_ge_u32 s12, 17
    s_cselect_b32 s82, 2147471360, s82
    s_add_u32 s12, s12, 1
    s_sub_u32 s14, s61, 8
    v_mfma_f32_16x16x32_bf16 v[96:99], a[140:143], a[204:207], v[96:99]
    s_waitcnt lgkmcnt(3)
    v_mfma_f32_16x16x32_bf16 v[100:103], a[144:147], a[192:195], v[64:67]
    s_waitcnt lgkmcnt(2)
    v_mfma_f32_16x16x32_bf16 v[100:103], a[148:151], a[196:199], v[100:103]
    s_waitcnt lgkmcnt(1)
    v_mfma_f32_16x16x32_bf16 v[100:103], a[152:155], a[200:203], v[100:103]
    s_waitcnt lgkmcnt(0)
    v_mfma_f32_16x16x32_bf16 v[100:103], a[156:159], a[204:207], v[100:103]
    v_mfma_f32_16x16x32_bf16 v[104:107], a[128:131], a[208:211], v[68:71]
    v_exp_f32 v96, v96
    v_mfma_f32_16x16x32_bf16 v[104:107], a[132:135], a[212:215], v[104:107]
    v_exp_f32 v97, v97
    v_mfma_f32_16x16x32_bf16 v[104:107], a[136:139], a[216:219], v[104:107]
    v_exp_f32 v98, v98
    v_mfma_f32_16x16x32_bf16 v[104:107], a[140:143], a[220:223], v[104:107]
    v_exp_f32 v99, v99
    v_mfma_f32_16x16x32_bf16 v[108:111], a[144:147], a[208:211], v[68:71]
    v_exp_f32 v100, v100
    v_mfma_f32_16x16x32_bf16 v[108:111], a[148:151], a[212:215], v[108:111]
    v_exp_f32 v101, v101
    v_mfma_f32_16x16x32_bf16 v[108:111], a[152:155], a[216:219], v[108:111]
    v_exp_f32 v102, v102
    v_mfma_f32_16x16x32_bf16 v[108:111], a[156:159], a[220:223], v[108:111]
    v_exp_f32 v103, v103
    v_mfma_f32_16x16x32_bf16 v[112:115], a[128:131], a[224:227], v[72:75]
    v_exp_f32 v104, v104
    v_mfma_f32_16x16x32_bf16 v[112:115], a[132:135], a[228:231], v[112:115]
    v_exp_f32 v105, v105
    v_mfma_f32_16x16x32_bf16 v[112:115], a[136:139], a[232:235], v[112:115]
    v_exp_f32 v106, v106
    v_mfma_f32_16x16x32_bf16 v[112:115], a[140:143], a[236:239], v[112:115]
    v_exp_f32 v107, v107
    v_mfma_f32_16x16x32_bf16 v[120:123], a[128:131], a[240:243], v[76:79]
    v_exp_f32 v108, v108
    v_mfma_f32_16x16x32_bf16 v[120:123], a[132:135], a[244:247], v[120:123]
    v_exp_f32 v109, v109
    v_mfma_f32_16x16x32_bf16 v[120:123], a[136:139], a[248:251], v[120:123]
    v_exp_f32 v110, v110
    v_mfma_f32_16x16x32_bf16 v[120:123], a[140:143], a[252:255], v[120:123]
    v_exp_f32 v111, v111
    v_mfma_f32_16x16x32_bf16 v[116:119], a[144:147], a[224:227], v[72:75]
    ds_read_b128 a[128:131], v18 offset:16384
    v_cvt_pk_bf16_f32 v48, v96, v97
    v_mfma_f32_16x16x32_bf16 v[116:119], a[148:151], a[228:231], v[116:119]
    ds_read_b128 a[132:135], v18 offset:17408
    v_cvt_pk_bf16_f32 v49, v98, v99
    v_mfma_f32_16x16x32_bf16 v[116:119], a[152:155], a[232:235], v[116:119]
    ds_read_b128 a[136:139], v18 offset:18432
    v_cvt_pk_bf16_f32 v50, v100, v101
    v_mfma_f32_16x16x32_bf16 v[116:119], a[156:159], a[236:239], v[116:119]
    ds_read_b128 a[140:143], v18 offset:19456
    v_cvt_pk_bf16_f32 v51, v102, v103
    v_mfma_f32_16x16x32_bf16 v[124:127], a[144:147], a[240:243], v[76:79]
    ds_read_b128 a[144:147], v18 offset:20480
    v_cvt_pk_bf16_f32 v52, v104, v105
    v_mfma_f32_16x16x32_bf16 v[124:127], a[148:151], a[244:247], v[124:127]
    ds_read_b128 a[148:151], v18 offset:21504
    v_cvt_pk_bf16_f32 v53, v106, v107
    v_mfma_f32_16x16x32_bf16 v[124:127], a[152:155], a[248:251], v[124:127]
    ds_read_b128 a[152:155], v18 offset:22528
    v_cvt_pk_bf16_f32 v54, v108, v109
    v_mfma_f32_16x16x32_bf16 v[124:127], a[156:159], a[252:255], v[124:127]
    ds_read_b128 a[156:159], v18 offset:23552
    v_cvt_pk_bf16_f32 v55, v110, v111
    v_xor_b32 v18, 196608, v18
    s_waitcnt vmcnt(0) lgkmcnt(0)
    s_barrier
    v_mfma_f32_16x16x32_bf16 v[96:99], a[128:131], a[192:195], v[64:67]
    s_add_u32 m0, s15, 0
    ds_read_b128 a[160:163], v19 offset:0
    v_mfma_f32_16x16x32_bf16 v[96:99], a[132:135], a[196:199], v[96:99]
    ds_read_b128 a[164:167], v19 offset:1024
    v_mfma_f32_16x16x32_bf16 v[96:99], a[136:139], a[200:203], v[96:99]
    v_exp_f32 v112, v112
    v_mfma_f32_16x16x32_bf16 v[96:99], a[140:143], a[204:207], v[96:99]
    buffer_load_dwordx4 v1, s[8:11], s82 offen offset:0  lds
    v_mfma_f32_16x16x32_bf16 v[104:107], a[128:131], a[208:211], v[68:71]
    v_exp_f32 v113, v113
    v_mfma_f32_16x16x32_bf16 v[104:107], a[132:135], a[212:215], v[104:107]
    ds_read_b128 a[168:171], v19 offset:2048
    v_cvt_pk_bf16_f32 v56, v112, v113
    v_mfma_f32_16x16x32_bf16 v[104:107], a[136:139], a[216:219], v[104:107]
    v_exp_f32 v114, v114
    v_mfma_f32_16x16x32_bf16 v[104:107], a[140:143], a[220:223], v[104:107]
    buffer_load_dwordx4 v1, s[8:11], s82 offen offset:1024  lds
    v_mfma_f32_16x16x32_bf16 v[100:103], a[144:147], a[192:195], v[64:67]
    v_exp_f32 v115, v115
    v_mfma_f32_16x16x32_bf16 v[100:103], a[148:151], a[196:199], v[100:103]
    ds_read_b128 a[172:175], v19 offset:3072
    v_cvt_pk_bf16_f32 v57, v114, v115
    v_mfma_f32_16x16x32_bf16 v[100:103], a[152:155], a[200:203], v[100:103]
    v_exp_f32 v116, v116
    v_mfma_f32_16x16x32_bf16 v[100:103], a[156:159], a[204:207], v[100:103]
    buffer_load_dwordx4 v1, s[8:11], s82 offen offset:2048  lds
    v_mfma_f32_16x16x32_bf16 v[108:111], a[144:147], a[208:211], v[68:71]
    v_exp_f32 v117, v117
    v_mfma_f32_16x16x32_bf16 v[108:111], a[148:151], a[212:215], v[108:111]
    ds_read_b128 a[176:179], v20 offset:4096
    v_cvt_pk_bf16_f32 v58, v116, v117
    v_mfma_f32_16x16x32_bf16 v[108:111], a[152:155], a[216:219], v[108:111]
    v_exp_f32 v118, v118
    v_mfma_f32_16x16x32_bf16 v[108:111], a[156:159], a[220:223], v[108:111]
    buffer_load_dwordx4 v1, s[8:11], s82 offen offset:3072  lds
    v_mfma_f32_16x16x32_bf16 v[32:35], v[28:31], v[48:51], 0
    s_add_u32 m0, s15, 4096
    v_exp_f32 v119, v119
    v_mfma_f32_16x16x32_bf16 v[36:39], v[28:31], v[52:55], 0
    s_waitcnt lgkmcnt(4)
    ds_read_b128 a[180:183], v20 offset:5120
    v_cvt_pk_bf16_f32 v59, v118, v119
    v_mfma_f32_16x16x32_bf16 v[128:131], a[160:163], v[48:51], 0
    s_waitcnt lgkmcnt(4)
    v_exp_f32 v120, v120
    v_mfma_f32_16x16x32_bf16 v[160:163], a[160:163], v[52:55], 0
    buffer_load_dwordx4 v15, s[8:11], s82 offen offset:0  lds
    v_mfma_f32_16x16x32_bf16 v[132:135], a[164:167], v[48:51], 0
    v_exp_f32 v121, v121
    v_mfma_f32_16x16x32_bf16 v[164:167], a[164:167], v[52:55], 0
    s_waitcnt lgkmcnt(3)
    ds_read_b128 a[184:187], v20 offset:6144
    v_cvt_pk_bf16_f32 v60, v120, v121
    v_mfma_f32_16x16x32_bf16 v[136:139], a[168:171], v[48:51], 0
    s_waitcnt lgkmcnt(3)
    v_exp_f32 v122, v122
    v_mfma_f32_16x16x32_bf16 v[168:171], a[168:171], v[52:55], 0
    buffer_load_dwordx4 v15, s[8:11], s82 offen offset:1024  lds
    v_mfma_f32_16x16x32_bf16 v[140:143], a[172:175], v[48:51], 0
    v_exp_f32 v123, v123
    v_mfma_f32_16x16x32_bf16 v[172:175], a[172:175], v[52:55], 0
    s_waitcnt lgkmcnt(2)
    ds_read_b128 a[188:191], v20 offset:7168
    v_cvt_pk_bf16_f32 v61, v122, v123
    v_mfma_f32_16x16x32_bf16 v[144:147], a[176:179], v[48:51], 0
    s_waitcnt lgkmcnt(2)
    v_exp_f32 v124, v124
    v_mfma_f32_16x16x32_bf16 v[176:179], a[176:179], v[52:55], 0
    buffer_load_dwordx4 v15, s[8:11], s82 offen offset:2048  lds
    v_mfma_f32_16x16x32_bf16 v[148:151], a[180:183], v[48:51], 0
    v_exp_f32 v125, v125
    v_mfma_f32_16x16x32_bf16 v[180:183], a[180:183], v[52:55], 0
    s_waitcnt lgkmcnt(1)
    v_cvt_pk_bf16_f32 v62, v124, v125
    v_mfma_f32_16x16x32_bf16 v[152:155], a[184:187], v[48:51], 0
    s_waitcnt lgkmcnt(0)
    v_exp_f32 v126, v126
    v_mfma_f32_16x16x32_bf16 v[184:187], a[184:187], v[52:55], 0
    buffer_load_dwordx4 v15, s[8:11], s82 offen offset:3072  lds
    v_mfma_f32_16x16x32_bf16 v[156:159], a[188:191], v[48:51], 0
    s_xor_b32 s15, s15, 196608
    v_exp_f32 v127, v127
    v_mfma_f32_16x16x32_bf16 v[188:191], a[188:191], v[52:55], 0
    s_add_u32 m0, s16, 0
    v_cvt_pk_bf16_f32 v63, v126, v127
    v_mfma_f32_16x16x32_bf16 v[112:115], a[128:131], a[224:227], v[72:75]
    v_mfma_f32_16x16x32_bf16 v[112:115], a[132:135], a[228:231], v[112:115]
    v_mfma_f32_16x16x32_bf16 v[112:115], a[136:139], a[232:235], v[112:115]
    v_exp_f32 v96, v96
    v_mfma_f32_16x16x32_bf16 v[112:115], a[140:143], a[236:239], v[112:115]
    buffer_load_dwordx4 v1, s[8:11], s19 offen offset:0  lds
    v_mfma_f32_16x16x32_bf16 v[120:123], a[128:131], a[240:243], v[76:79]
    v_exp_f32 v97, v97
    v_mfma_f32_16x16x32_bf16 v[120:123], a[132:135], a[244:247], v[120:123]
    ds_read_b128 a[128:131], v18 offset:0
    v_cvt_pk_bf16_f32 v48, v96, v97
    v_mfma_f32_16x16x32_bf16 v[120:123], a[136:139], a[248:251], v[120:123]
    v_exp_f32 v98, v98
    v_mfma_f32_16x16x32_bf16 v[120:123], a[140:143], a[252:255], v[120:123]
    buffer_load_dwordx4 v1, s[8:11], s19 offen offset:1024  lds
    v_mfma_f32_16x16x32_bf16 v[116:119], a[144:147], a[224:227], v[72:75]
    v_exp_f32 v99, v99
    v_mfma_f32_16x16x32_bf16 v[116:119], a[148:151], a[228:231], v[116:119]
    ds_read_b128 a[132:135], v18 offset:1024
    v_cvt_pk_bf16_f32 v49, v98, v99
    v_mfma_f32_16x16x32_bf16 v[116:119], a[152:155], a[232:235], v[116:119]
    v_exp_f32 v100, v100
    v_mfma_f32_16x16x32_bf16 v[116:119], a[156:159], a[236:239], v[116:119]
    buffer_load_dwordx4 v1, s[8:11], s19 offen offset:2048  lds
    v_mfma_f32_16x16x32_bf16 v[124:127], a[144:147], a[240:243], v[76:79]
    v_exp_f32 v101, v101
    v_mfma_f32_16x16x32_bf16 v[124:127], a[148:151], a[244:247], v[124:127]
    ds_read_b128 a[136:139], v18 offset:2048
    v_cvt_pk_bf16_f32 v50, v100, v101
    v_mfma_f32_16x16x32_bf16 v[124:127], a[152:155], a[248:251], v[124:127]
    v_exp_f32 v102, v102
    v_mfma_f32_16x16x32_bf16 v[124:127], a[156:159], a[252:255], v[124:127]
    buffer_load_dwordx4 v1, s[8:11], s19 offen offset:3072  lds
    v_mfma_f32_16x16x32_bf16 v[40:43], v[28:31], v[56:59], 0
    s_add_u32 m0, s16, 4096
    v_exp_f32 v103, v103
    v_mfma_f32_16x16x32_bf16 v[44:47], v[28:31], v[60:63], 0
    ds_read_b128 a[140:143], v18 offset:3072
    v_cvt_pk_bf16_f32 v51, v102, v103
    v_mfma_f32_16x16x32_bf16 v[192:195], a[160:163], v[56:59], 0
    v_exp_f32 v104, v104
    v_mfma_f32_16x16x32_bf16 v[224:227], a[160:163], v[60:63], 0
    buffer_load_dwordx4 v15, s[8:11], s19 offen offset:0  lds
    v_mfma_f32_16x16x32_bf16 v[196:199], a[164:167], v[56:59], 0
    v_exp_f32 v105, v105
    v_mfma_f32_16x16x32_bf16 v[228:231], a[164:167], v[60:63], 0
    ds_read_b128 a[144:147], v18 offset:4096
    v_cvt_pk_bf16_f32 v52, v104, v105
    v_mfma_f32_16x16x32_bf16 v[200:203], a[168:171], v[56:59], 0
    v_exp_f32 v106, v106
    v_mfma_f32_16x16x32_bf16 v[232:235], a[168:171], v[60:63], 0
    buffer_load_dwordx4 v15, s[8:11], s19 offen offset:1024  lds
    v_mfma_f32_16x16x32_bf16 v[204:207], a[172:175], v[56:59], 0
    v_exp_f32 v107, v107
    v_mfma_f32_16x16x32_bf16 v[236:239], a[172:175], v[60:63], 0
    ds_read_b128 a[148:151], v18 offset:5120
    v_cvt_pk_bf16_f32 v53, v106, v107
    v_mfma_f32_16x16x32_bf16 v[208:211], a[176:179], v[56:59], 0
    v_exp_f32 v108, v108
    v_mfma_f32_16x16x32_bf16 v[240:243], a[176:179], v[60:63], 0
    buffer_load_dwordx4 v15, s[8:11], s19 offen offset:2048  lds
    v_mfma_f32_16x16x32_bf16 v[212:215], a[180:183], v[56:59], 0
    v_exp_f32 v109, v109
    v_mfma_f32_16x16x32_bf16 v[244:247], a[180:183], v[60:63], 0
    ds_read_b128 a[152:155], v18 offset:6144
    v_cvt_pk_bf16_f32 v54, v108, v109
    v_mfma_f32_16x16x32_bf16 v[216:219], a[184:187], v[56:59], 0
    v_exp_f32 v110, v110
    v_mfma_f32_16x16x32_bf16 v[248:251], a[184:187], v[60:63], 0
    buffer_load_dwordx4 v15, s[8:11], s19 offen offset:3072  lds
    v_mfma_f32_16x16x32_bf16 v[220:223], a[188:191], v[56:59], 0
    s_xor_b32 s16, s16, 98304
    v_exp_f32 v111, v111
    v_mfma_f32_16x16x32_bf16 v[252:255], a[188:191], v[60:63], 0
    ds_read_b128 a[156:159], v18 offset:7168
    v_cvt_pk_bf16_f32 v55, v110, v111
    s_waitcnt lgkmcnt(7)
    v_mfma_f32_16x16x32_bf16 v[96:99], a[128:131], a[192:195], v[64:67]
    s_waitcnt lgkmcnt(6)
    s_lshr_b32 s101, s2, 3
    s_sub_u32 s101, s101, 4
    ds_read_b128 a[160:163], v19 offset:16384
    v_mfma_f32_16x16x32_bf16 v[96:99], a[132:135], a[196:199], v[96:99]
    s_waitcnt lgkmcnt(6)
    s_and_b32 s101, s101, 31
    ds_read_b128 a[164:167], v19 offset:17408
    v_and_b32 v14, 7, v2
    v_mfma_f32_16x16x32_bf16 v[96:99], a[136:139], a[200:203], v[96:99]
    s_waitcnt lgkmcnt(6)
    v_exp_f32 v112, v112
    v_mfma_f32_16x16x32_bf16 v[96:99], a[140:143], a[204:207], v[96:99]
    v_lshlrev_b32 v14, 4, v14
    v_lshrrev_b32 v13, 3, v2
    v_mfma_f32_16x16x32_bf16 v[104:107], a[128:131], a[208:211], v[68:71]
    v_exp_f32 v113, v113
    v_mfma_f32_16x16x32_bf16 v[104:107], a[132:135], a[212:215], v[104:107]
    ds_read_b128 a[168:171], v19 offset:18432
    v_cvt_pk_bf16_f32 v56, v112, v113
    v_mfma_f32_16x16x32_bf16 v[104:107], a[136:139], a[216:219], v[104:107]
    v_exp_f32 v114, v114
    v_mfma_f32_16x16x32_bf16 v[104:107], a[140:143], a[220:223], v[104:107]
    s_waitcnt lgkmcnt(6)
    v_lshl_add_u32 v12, v13, 13, v14
    v_mul_u32_u24 v13, 28672, v13
    v_mfma_f32_16x16x32_bf16 v[100:103], a[144:147], a[192:195], v[64:67]
    s_waitcnt lgkmcnt(5)
    s_add_u32 s27, s18, 0
    v_exp_f32 v115, v115
    v_mfma_f32_16x16x32_bf16 v[100:103], a[148:151], a[196:199], v[100:103]
    s_waitcnt lgkmcnt(4)
    ds_read_b128 a[172:175], v19 offset:19456
    v_cvt_pk_bf16_f32 v57, v114, v115
    v_mfma_f32_16x16x32_bf16 v[100:103], a[152:155], a[200:203], v[100:103]
    s_waitcnt lgkmcnt(4)
    v_exp_f32 v116, v116
    v_mfma_f32_16x16x32_bf16 v[100:103], a[156:159], a[204:207], v[100:103]
    buffer_store_dwordx4 v[24:27], v17, s[8:11], s27 offen offset:0 sc0 sc1
    v_mfma_f32_16x16x32_bf16 v[108:111], a[144:147], a[208:211], v[68:71]
    s_add_u32 s27, s18, 131072
    v_exp_f32 v117, v117
    v_mfma_f32_16x16x32_bf16 v[108:111], a[148:151], a[212:215], v[108:111]
    ds_read_b128 a[176:179], v20 offset:20480
    v_cvt_pk_bf16_f32 v58, v116, v117
    v_mfma_f32_16x16x32_bf16 v[108:111], a[152:155], a[216:219], v[108:111]
    v_exp_f32 v118, v118
    v_mfma_f32_16x16x32_bf16 v[108:111], a[156:159], a[220:223], v[108:111]
    buffer_store_dwordx4 v[24:27], v17, s[8:11], s27 offen offset:0 sc0 sc1
    v_mfma_f32_16x16x32_bf16 v[32:35], v[28:31], v[48:51], v[32:35]
    v_exp_f32 v119, v119
    v_mfma_f32_16x16x32_bf16 v[36:39], v[28:31], v[52:55], v[36:39]
    s_waitcnt lgkmcnt(4)
    ds_read_b128 a[180:183], v20 offset:21504
    v_cvt_pk_bf16_f32 v59, v118, v119
    v_mfma_f32_16x16x32_bf16 v[128:131], a[160:163], v[48:51], v[128:131]
    v_exp_f32 v120, v120
    v_mfma_f32_16x16x32_bf16 v[160:163], a[160:163], v[52:55], v[160:163]
    s_waitcnt lgkmcnt(4)
    v_add_u32 v13, v13, v14
    v_mfma_f32_16x16x32_bf16 v[132:135], a[164:167], v[48:51], v[132:135]
    s_lshl_b32 s17, s4, 2
    v_exp_f32 v121, v121
    v_mfma_f32_16x16x32_bf16 v[164:167], a[164:167], v[52:55], v[164:167]
    s_waitcnt lgkmcnt(3)
    s_add_u32 s17, s17, s3
    ds_read_b128 a[184:187], v20 offset:22528
    v_cvt_pk_bf16_f32 v60, v120, v121
    v_mfma_f32_16x16x32_bf16 v[136:139], a[168:171], v[48:51], v[136:139]
    s_lshl_b32 s17, s17, 7
    v_exp_f32 v122, v122
    v_mfma_f32_16x16x32_bf16 v[168:171], a[168:171], v[52:55], v[168:171]
    s_waitcnt lgkmcnt(3)
    v_mfma_f32_16x16x32_bf16 v[140:143], a[172:175], v[48:51], v[140:143]
    s_lshl_b32 s100, s101, 16
    v_exp_f32 v123, v123
    v_mfma_f32_16x16x32_bf16 v[172:175], a[172:175], v[52:55], v[172:175]
    s_waitcnt lgkmcnt(2)
    s_add_u32 s17, s17, s100
    ds_read_b128 a[188:191], v20 offset:23552
    v_cvt_pk_bf16_f32 v61, v122, v123
    v_mfma_f32_16x16x32_bf16 v[144:147], a[176:179], v[48:51], v[144:147]
    s_add_u32 s17, s17, 4194304
    v_exp_f32 v124, v124
    v_mfma_f32_16x16x32_bf16 v[176:179], a[176:179], v[52:55], v[176:179]
    s_waitcnt lgkmcnt(2)
    v_mfma_f32_16x16x32_bf16 v[148:151], a[180:183], v[48:51], v[148:151]
    s_cmp_lt_u32 s101, s26
    s_cselect_b32 s17, s17, 2143285248
    v_exp_f32 v125, v125
    v_mfma_f32_16x16x32_bf16 v[180:183], a[180:183], v[52:55], v[180:183]
    s_waitcnt lgkmcnt(1)
    v_cvt_pk_bf16_f32 v62, v124, v125
    v_xor_b32 v19, 98304, v19
    v_mfma_f32_16x16x32_bf16 v[152:155], a[184:187], v[48:51], v[152:155]
    buffer_store_dwordx4 a[0:3], v12, s[8:11], s17 offen sc0 sc1
    v_exp_f32 v126, v126
    v_mfma_f32_16x16x32_bf16 v[184:187], a[184:187], v[52:55], v[184:187]
    s_waitcnt lgkmcnt(0)
    v_xor_b32 v20, 98304, v20
    v_mfma_f32_16x16x32_bf16 v[156:159], a[188:191], v[48:51], v[156:159]
    v_exp_f32 v127, v127
    v_mfma_f32_16x16x32_bf16 v[188:191], a[188:191], v[52:55], v[188:191]
    v_cvt_pk_bf16_f32 v63, v126, v127
    v_mfma_f32_16x16x32_bf16 v[112:115], a[128:131], a[224:227], v[72:75]
    s_add_u32 s17, s17, 4096
    v_exp_f32 v96, v96
    v_mfma_f32_16x16x32_bf16 v[112:115], a[132:135], a[228:231], v[112:115]
    buffer_store_dwordx4 a[4:7], v12, s[8:11], s17 offen sc0 sc1
    v_mfma_f32_16x16x32_bf16 v[112:115], a[136:139], a[232:235], v[112:115]
    s_add_u32 s27, s18, 0
    v_exp_f32 v97, v97
    v_mfma_f32_16x16x32_bf16 v[112:115], a[140:143], a[236:239], v[112:115]
    v_cvt_pk_bf16_f32 v48, v96, v97
    v_lshrrev_b32 v9, 1, v2
    v_mfma_f32_16x16x32_bf16 v[120:123], a[128:131], a[240:243], v[76:79]
    v_exp_f32 v98, v98
    v_mfma_f32_16x16x32_bf16 v[120:123], a[132:135], a[244:247], v[120:123]
    buffer_store_dwordx4 v[24:27], v17, s[8:11], s27 offen offset:256 sc0 sc1
    v_mfma_f32_16x16x32_bf16 v[120:123], a[136:139], a[248:251], v[120:123]
    s_add_u32 s27, s18, 131072
    v_exp_f32 v99, v99
    v_mfma_f32_16x16x32_bf16 v[120:123], a[140:143], a[252:255], v[120:123]
    buffer_store_dwordx4 v[24:27], v17, s[8:11], s27 offen offset:256 sc0 sc1
    v_mfma_f32_16x16x32_bf16 v[116:119], a[144:147], a[224:227], v[72:75]
    s_add_u32 s27, s18, 0
    v_exp_f32 v100, v100
    v_mfma_f32_16x16x32_bf16 v[116:119], a[148:151], a[228:231], v[116:119]
    ds_read_b128 a[128:131], v18 offset:16384
    v_cvt_pk_bf16_f32 v49, v98, v99
    v_mfma_f32_16x16x32_bf16 v[116:119], a[152:155], a[232:235], v[116:119]
    s_add_u32 s19, s82, 32768
    v_exp_f32 v101, v101
    v_mfma_f32_16x16x32_bf16 v[116:119], a[156:159], a[236:239], v[116:119]
    s_sub_u32 s82, s12, s13
    ds_read_b128 a[132:135], v18 offset:17408
    v_cvt_pk_bf16_f32 v50, v100, v101
    v_mfma_f32_16x16x32_bf16 v[124:127], a[144:147], a[240:243], v[76:79]
    s_sub_u32 s82, s82, 1
    v_exp_f32 v102, v102
    v_mfma_f32_16x16x32_bf16 v[124:127], a[148:151], a[244:247], v[124:127]
    s_cmp_gt_u32 s12, s13
    s_cselect_b32 s82, s82, s12
    s_mul_i32 s82, s82, 65536
    ds_read_b128 a[136:139], v18 offset:18432
    v_mfma_f32_16x16x32_bf16 v[124:127], a[152:155], a[248:251], v[124:127]
    s_add_u32 s82, s82, s81
    v_exp_f32 v103, v103
    v_mfma_f32_16x16x32_bf16 v[124:127], a[156:159], a[252:255], v[124:127]
    s_cmp_ge_u32 s12, 17
    s_cselect_b32 s82, 2147471360, s82
    ds_read_b128 a[140:143], v18 offset:19456
    v_cvt_pk_bf16_f32 v51, v102, v103
    v_mfma_f32_16x16x32_bf16 v[40:43], v[28:31], v[56:59], v[40:43]
    s_add_u32 s12, s12, 1
    v_exp_f32 v104, v104
    v_mfma_f32_16x16x32_bf16 v[44:47], v[28:31], v[60:63], v[44:47]
    ds_read_b128 a[144:147], v18 offset:20480
    v_lshrrev_b32 v10, 4, v2
    v_mfma_f32_16x16x32_bf16 v[192:195], a[160:163], v[56:59], v[192:195]
    v_exp_f32 v105, v105
    v_mfma_f32_16x16x32_bf16 v[224:227], a[160:163], v[60:63], v[224:227]
    ds_read_b128 a[148:151], v18 offset:21504
    v_cvt_pk_bf16_f32 v52, v104, v105
    v_mfma_f32_16x16x32_bf16 v[196:199], a[164:167], v[56:59], v[196:199]
    v_exp_f32 v106, v106
    v_mfma_f32_16x16x32_bf16 v[228:231], a[164:167], v[60:63], v[228:231]
    ds_read_b128 a[152:155], v18 offset:22528
    v_xor_b32 v9, v9, v10
    v_mfma_f32_16x16x32_bf16 v[200:203], a[168:171], v[56:59], v[200:203]
    v_exp_f32 v107, v107
    v_mfma_f32_16x16x32_bf16 v[232:235], a[168:171], v[60:63], v[232:235]
    ds_read_b128 a[156:159], v18 offset:23552
    v_cvt_pk_bf16_f32 v53, v106, v107
    v_mfma_f32_16x16x32_bf16 v[204:207], a[172:175], v[56:59], v[204:207]
    v_exp_f32 v108, v108
    v_mfma_f32_16x16x32_bf16 v[236:239], a[172:175], v[60:63], v[236:239]
    buffer_store_dwordx4 v[24:27], v17, s[8:11], s27 offen offset:512 sc0 sc1
    v_mfma_f32_16x16x32_bf16 v[208:211], a[176:179], v[56:59], v[208:211]
    s_add_u32 s27, s18, 131072
    v_exp_f32 v109, v109
    v_mfma_f32_16x16x32_bf16 v[240:243], a[176:179], v[60:63], v[240:243]
    v_cvt_pk_bf16_f32 v54, v108, v109
    v_xor_b32 v18, 196608, v18
    v_mfma_f32_16x16x32_bf16 v[212:215], a[180:183], v[56:59], v[212:215]
    v_exp_f32 v110, v110
    v_mfma_f32_16x16x32_bf16 v[244:247], a[180:183], v[60:63], v[244:247]
    buffer_store_dwordx4 v[24:27], v17, s[8:11], s27 offen offset:512 sc0 sc1
    v_mfma_f32_16x16x32_bf16 v[216:219], a[184:187], v[56:59], v[216:219]
    s_add_u32 s27, s18, 0
    v_exp_f32 v111, v111
    v_mfma_f32_16x16x32_bf16 v[248:251], a[184:187], v[60:63], v[248:251]
    v_cvt_pk_bf16_f32 v55, v110, v111
    v_and_b32 v9, 3, v9
    v_mfma_f32_16x16x32_bf16 v[220:223], a[188:191], v[56:59], v[220:223]
    buffer_store_dwordx4 v[24:27], v17, s[8:11], s27 offen offset:768 sc0 sc1
    v_mfma_f32_16x16x32_bf16 v[252:255], a[188:191], v[60:63], v[252:255]
    v_lshlrev_b32 v9, 5, v9
    v_and_b32 v10, 1, v2
    v_lshl_add_u32 v9, v10, 4, v9
    v_lshrrev_b32 v8, 3, v2
    s_waitcnt vmcnt(9) lgkmcnt(0)
    s_barrier
    buffer_store_dword v6, v5, s[8:11], s22 offen sc0 sc1
    v_mfma_f32_16x16x32_bf16 v[96:99], a[128:131], a[192:195], v[64:67]
    s_add_u32 m0, s15, 0
    ds_read_b128 a[160:163], v19 offset:0
    v_mfma_f32_16x16x32_bf16 v[96:99], a[132:135], a[196:199], v[96:99]
    ds_read_b128 a[164:167], v19 offset:1024
    v_mfma_f32_16x16x32_bf16 v[96:99], a[136:139], a[200:203], v[96:99]
    v_exp_f32 v112, v112
    v_mfma_f32_16x16x32_bf16 v[96:99], a[140:143], a[204:207], v[96:99]
    buffer_load_dwordx4 v1, s[8:11], s82 offen offset:0  lds
    v_mfma_f32_16x16x32_bf16 v[104:107], a[128:131], a[208:211], v[68:71]
    v_exp_f32 v113, v113
    v_mfma_f32_16x16x32_bf16 v[104:107], a[132:135], a[212:215], v[104:107]
    ds_read_b128 a[168:171], v19 offset:2048
    v_cvt_pk_bf16_f32 v56, v112, v113
    v_mfma_f32_16x16x32_bf16 v[104:107], a[136:139], a[216:219], v[104:107]
    v_exp_f32 v114, v114
    v_mfma_f32_16x16x32_bf16 v[104:107], a[140:143], a[220:223], v[104:107]
    buffer_load_dwordx4 v1, s[8:11], s82 offen offset:1024  lds
    v_mfma_f32_16x16x32_bf16 v[100:103], a[144:147], a[192:195], v[64:67]
    v_exp_f32 v115, v115
    v_mfma_f32_16x16x32_bf16 v[100:103], a[148:151], a[196:199], v[100:103]
    ds_read_b128 a[172:175], v19 offset:3072
    v_cvt_pk_bf16_f32 v57, v114, v115
    v_mfma_f32_16x16x32_bf16 v[100:103], a[152:155], a[200:203], v[100:103]
    v_exp_f32 v116, v116
    v_mfma_f32_16x16x32_bf16 v[100:103], a[156:159], a[204:207], v[100:103]
    buffer_load_dwordx4 v1, s[8:11], s82 offen offset:2048  lds
    v_mfma_f32_16x16x32_bf16 v[108:111], a[144:147], a[208:211], v[68:71]
    v_exp_f32 v117, v117
    v_mfma_f32_16x16x32_bf16 v[108:111], a[148:151], a[212:215], v[108:111]
    ds_read_b128 a[176:179], v20 offset:4096
    v_cvt_pk_bf16_f32 v58, v116, v117
    v_mfma_f32_16x16x32_bf16 v[108:111], a[152:155], a[216:219], v[108:111]
    v_exp_f32 v118, v118
    v_mfma_f32_16x16x32_bf16 v[108:111], a[156:159], a[220:223], v[108:111]
    buffer_load_dwordx4 v1, s[8:11], s82 offen offset:3072  lds
    v_mfma_f32_16x16x32_bf16 v[32:35], v[28:31], v[48:51], v[32:35]
    s_add_u32 m0, s15, 4096
    v_exp_f32 v119, v119
    v_mfma_f32_16x16x32_bf16 v[36:39], v[28:31], v[52:55], v[36:39]
    s_waitcnt lgkmcnt(4)
    ds_read_b128 a[180:183], v20 offset:5120
    v_cvt_pk_bf16_f32 v59, v118, v119
    v_mfma_f32_16x16x32_bf16 v[128:131], a[160:163], v[48:51], v[128:131]
    s_waitcnt lgkmcnt(4)
    v_exp_f32 v120, v120
    v_mfma_f32_16x16x32_bf16 v[160:163], a[160:163], v[52:55], v[160:163]
    buffer_load_dwordx4 v15, s[8:11], s82 offen offset:0  lds
    v_mfma_f32_16x16x32_bf16 v[132:135], a[164:167], v[48:51], v[132:135]
    v_exp_f32 v121, v121
    v_mfma_f32_16x16x32_bf16 v[164:167], a[164:167], v[52:55], v[164:167]
    s_waitcnt lgkmcnt(3)
    ds_read_b128 a[184:187], v20 offset:6144
    v_cvt_pk_bf16_f32 v60, v120, v121
    v_mfma_f32_16x16x32_bf16 v[136:139], a[168:171], v[48:51], v[136:139]
    s_waitcnt lgkmcnt(3)
    v_exp_f32 v122, v122
    v_mfma_f32_16x16x32_bf16 v[168:171], a[168:171], v[52:55], v[168:171]
    buffer_load_dwordx4 v15, s[8:11], s82 offen offset:1024  lds
    v_mfma_f32_16x16x32_bf16 v[140:143], a[172:175], v[48:51], v[140:143]
    v_exp_f32 v123, v123
    v_mfma_f32_16x16x32_bf16 v[172:175], a[172:175], v[52:55], v[172:175]
    s_waitcnt lgkmcnt(2)
    ds_read_b128 a[188:191], v20 offset:7168
    v_cvt_pk_bf16_f32 v61, v122, v123
    v_mfma_f32_16x16x32_bf16 v[144:147], a[176:179], v[48:51], v[144:147]
    s_waitcnt lgkmcnt(2)
    v_exp_f32 v124, v124
    v_mfma_f32_16x16x32_bf16 v[176:179], a[176:179], v[52:55], v[176:179]
    buffer_load_dwordx4 v15, s[8:11], s82 offen offset:2048  lds
    v_mfma_f32_16x16x32_bf16 v[148:151], a[180:183], v[48:51], v[148:151]
    v_exp_f32 v125, v125
    v_mfma_f32_16x16x32_bf16 v[180:183], a[180:183], v[52:55], v[180:183]
    s_waitcnt lgkmcnt(1)
    v_cvt_pk_bf16_f32 v62, v124, v125
    v_mfma_f32_16x16x32_bf16 v[152:155], a[184:187], v[48:51], v[152:155]
    s_waitcnt lgkmcnt(0)
    v_exp_f32 v126, v126
    v_mfma_f32_16x16x32_bf16 v[184:187], a[184:187], v[52:55], v[184:187]
    buffer_load_dwordx4 v15, s[8:11], s82 offen offset:3072  lds
    v_mfma_f32_16x16x32_bf16 v[156:159], a[188:191], v[48:51], v[156:159]
    s_xor_b32 s15, s15, 196608
    v_exp_f32 v127, v127
    v_mfma_f32_16x16x32_bf16 v[188:191], a[188:191], v[52:55], v[188:191]
    s_add_u32 m0, s16, 0
    v_cvt_pk_bf16_f32 v63, v126, v127
    v_mfma_f32_16x16x32_bf16 v[112:115], a[128:131], a[224:227], v[72:75]
    v_mfma_f32_16x16x32_bf16 v[112:115], a[132:135], a[228:231], v[112:115]
    v_mfma_f32_16x16x32_bf16 v[112:115], a[136:139], a[232:235], v[112:115]
    v_exp_f32 v96, v96
    v_mfma_f32_16x16x32_bf16 v[112:115], a[140:143], a[236:239], v[112:115]
    buffer_load_dwordx4 v1, s[8:11], s19 offen offset:0  lds
    v_mfma_f32_16x16x32_bf16 v[120:123], a[128:131], a[240:243], v[76:79]
    v_exp_f32 v97, v97
    v_mfma_f32_16x16x32_bf16 v[120:123], a[132:135], a[244:247], v[120:123]
    ds_read_b128 a[128:131], v18 offset:0
    v_cvt_pk_bf16_f32 v48, v96, v97
    v_mfma_f32_16x16x32_bf16 v[120:123], a[136:139], a[248:251], v[120:123]
    v_exp_f32 v98, v98
    v_mfma_f32_16x16x32_bf16 v[120:123], a[140:143], a[252:255], v[120:123]
    buffer_load_dwordx4 v1, s[8:11], s19 offen offset:1024  lds
    v_mfma_f32_16x16x32_bf16 v[116:119], a[144:147], a[224:227], v[72:75]
    v_exp_f32 v99, v99
    v_mfma_f32_16x16x32_bf16 v[116:119], a[148:151], a[228:231], v[116:119]
    ds_read_b128 a[132:135], v18 offset:1024
    v_cvt_pk_bf16_f32 v49, v98, v99
    v_mfma_f32_16x16x32_bf16 v[116:119], a[152:155], a[232:235], v[116:119]
    v_exp_f32 v100, v100
    v_mfma_f32_16x16x32_bf16 v[116:119], a[156:159], a[236:239], v[116:119]
    buffer_load_dwordx4 v1, s[8:11], s19 offen offset:2048  lds
    v_mfma_f32_16x16x32_bf16 v[124:127], a[144:147], a[240:243], v[76:79]
    v_exp_f32 v101, v101
    v_mfma_f32_16x16x32_bf16 v[124:127], a[148:151], a[244:247], v[124:127]
    ds_read_b128 a[136:139], v18 offset:2048
    v_cvt_pk_bf16_f32 v50, v100, v101
    v_mfma_f32_16x16x32_bf16 v[124:127], a[152:155], a[248:251], v[124:127]
    v_exp_f32 v102, v102
    v_mfma_f32_16x16x32_bf16 v[124:127], a[156:159], a[252:255], v[124:127]
    buffer_load_dwordx4 v1, s[8:11], s19 offen offset:3072  lds
    v_mfma_f32_16x16x32_bf16 v[40:43], v[28:31], v[56:59], v[40:43]
    s_add_u32 m0, s16, 4096
    v_exp_f32 v103, v103
    v_mfma_f32_16x16x32_bf16 v[44:47], v[28:31], v[60:63], v[44:47]
    ds_read_b128 a[140:143], v18 offset:3072
    v_cvt_pk_bf16_f32 v51, v102, v103
    v_mfma_f32_16x16x32_bf16 v[192:195], a[160:163], v[56:59], v[192:195]
    v_exp_f32 v104, v104
    v_mfma_f32_16x16x32_bf16 v[224:227], a[160:163], v[60:63], v[224:227]
    buffer_load_dwordx4 v15, s[8:11], s19 offen offset:0  lds
    v_mfma_f32_16x16x32_bf16 v[196:199], a[164:167], v[56:59], v[196:199]
    v_exp_f32 v105, v105
    v_mfma_f32_16x16x32_bf16 v[228:231], a[164:167], v[60:63], v[228:231]
    ds_read_b128 a[144:147], v18 offset:4096
    v_cvt_pk_bf16_f32 v52, v104, v105
    v_mfma_f32_16x16x32_bf16 v[200:203], a[168:171], v[56:59], v[200:203]
    v_exp_f32 v106, v106
    v_mfma_f32_16x16x32_bf16 v[232:235], a[168:171], v[60:63], v[232:235]
    buffer_load_dwordx4 v15, s[8:11], s19 offen offset:1024  lds
    v_mfma_f32_16x16x32_bf16 v[204:207], a[172:175], v[56:59], v[204:207]
    v_exp_f32 v107, v107
    v_mfma_f32_16x16x32_bf16 v[236:239], a[172:175], v[60:63], v[236:239]
    ds_read_b128 a[148:151], v18 offset:5120
    v_cvt_pk_bf16_f32 v53, v106, v107
    v_mfma_f32_16x16x32_bf16 v[208:211], a[176:179], v[56:59], v[208:211]
    v_exp_f32 v108, v108
    v_mfma_f32_16x16x32_bf16 v[240:243], a[176:179], v[60:63], v[240:243]
    buffer_load_dwordx4 v15, s[8:11], s19 offen offset:2048  lds
    v_mfma_f32_16x16x32_bf16 v[212:215], a[180:183], v[56:59], v[212:215]
    v_exp_f32 v109, v109
    v_mfma_f32_16x16x32_bf16 v[244:247], a[180:183], v[60:63], v[244:247]
    ds_read_b128 a[152:155], v18 offset:6144
    v_cvt_pk_bf16_f32 v54, v108, v109
    v_mfma_f32_16x16x32_bf16 v[216:219], a[184:187], v[56:59], v[216:219]
    v_exp_f32 v110, v110
    v_mfma_f32_16x16x32_bf16 v[248:251], a[184:187], v[60:63], v[248:251]
    buffer_load_dwordx4 v15, s[8:11], s19 offen offset:3072  lds
    v_mfma_f32_16x16x32_bf16 v[220:223], a[188:191], v[56:59], v[220:223]
    s_xor_b32 s16, s16, 98304
    v_exp_f32 v111, v111
    v_mfma_f32_16x16x32_bf16 v[252:255], a[188:191], v[60:63], v[252:255]
    ds_read_b128 a[156:159], v18 offset:7168
    v_cvt_pk_bf16_f32 v55, v110, v111
    s_waitcnt lgkmcnt(7)
    v_mfma_f32_16x16x32_bf16 v[96:99], a[128:131], a[192:195], v[64:67]
    s_waitcnt lgkmcnt(6)
    ds_read_b128 a[160:163], v19 offset:16384
    v_mfma_f32_16x16x32_bf16 v[96:99], a[132:135], a[196:199], v[96:99]
    s_waitcnt lgkmcnt(6)
    ds_read_b128 a[164:167], v19 offset:17408
    v_mfma_f32_16x16x32_bf16 v[96:99], a[136:139], a[200:203], v[96:99]
    s_waitcnt lgkmcnt(6)
    v_exp_f32 v112, v112
    v_mfma_f32_16x16x32_bf16 v[96:99], a[140:143], a[204:207], v[96:99]
    v_mfma_f32_16x16x32_bf16 v[104:107], a[128:131], a[208:211], v[68:71]
    v_exp_f32 v113, v113
    v_mfma_f32_16x16x32_bf16 v[104:107], a[132:135], a[212:215], v[104:107]
    ds_read_b128 a[168:171], v19 offset:18432
    v_cvt_pk_bf16_f32 v56, v112, v113
    v_mfma_f32_16x16x32_bf16 v[104:107], a[136:139], a[216:219], v[104:107]
    v_exp_f32 v114, v114
    v_mfma_f32_16x16x32_bf16 v[104:107], a[140:143], a[220:223], v[104:107]
    s_waitcnt lgkmcnt(6)
    v_mfma_f32_16x16x32_bf16 v[100:103], a[144:147], a[192:195], v[64:67]
    s_waitcnt lgkmcnt(5)
    s_add_u32 s17, s17, 2093056
    v_exp_f32 v115, v115
    v_mfma_f32_16x16x32_bf16 v[100:103], a[148:151], a[196:199], v[100:103]
    s_waitcnt lgkmcnt(4)
    ds_read_b128 a[172:175], v19 offset:19456
    v_cvt_pk_bf16_f32 v57, v114, v115
    v_mfma_f32_16x16x32_bf16 v[100:103], a[152:155], a[200:203], v[100:103]
    s_waitcnt lgkmcnt(4)
    v_exp_f32 v116, v116
    v_mfma_f32_16x16x32_bf16 v[100:103], a[156:159], a[204:207], v[100:103]
    buffer_store_dwordx4 a[8:11], v12, s[8:11], s17 offen sc0 sc1
    v_mfma_f32_16x16x32_bf16 v[108:111], a[144:147], a[208:211], v[68:71]
    s_add_u32 s27, s18, 131072
    v_exp_f32 v117, v117
    v_mfma_f32_16x16x32_bf16 v[108:111], a[148:151], a[212:215], v[108:111]
    ds_read_b128 a[176:179], v20 offset:20480
    v_cvt_pk_bf16_f32 v58, v116, v117
    v_mfma_f32_16x16x32_bf16 v[108:111], a[152:155], a[216:219], v[108:111]
    v_exp_f32 v118, v118
    v_mfma_f32_16x16x32_bf16 v[108:111], a[156:159], a[220:223], v[108:111]
    buffer_store_dwordx4 v[24:27], v17, s[8:11], s27 offen offset:768 sc0 sc1
    v_mfma_f32_16x16x32_bf16 v[32:35], v[28:31], v[48:51], v[32:35]
    s_add_u32 s27, s18, 8388608
    v_exp_f32 v119, v119
    v_mfma_f32_16x16x32_bf16 v[36:39], v[28:31], v[52:55], v[36:39]
    s_waitcnt lgkmcnt(4)
    ds_read_b128 a[180:183], v20 offset:21504
    v_cvt_pk_bf16_f32 v59, v118, v119
    v_mfma_f32_16x16x32_bf16 v[128:131], a[160:163], v[48:51], v[128:131]
    s_waitcnt lgkmcnt(4)
    v_exp_f32 v120, v120
    v_mfma_f32_16x16x32_bf16 v[160:163], a[160:163], v[52:55], v[160:163]
    buffer_store_dwordx4 v[24:27], v17, s[8:11], s27 offen offset:0 sc0 sc1
    v_mfma_f32_16x16x32_bf16 v[132:135], a[164:167], v[48:51], v[132:135]
    s_add_u32 s27, s18, 8519680
    v_exp_f32 v121, v121
    v_mfma_f32_16x16x32_bf16 v[164:167], a[164:167], v[52:55], v[164:167]
    s_waitcnt lgkmcnt(3)
    ds_read_b128 a[184:187], v20 offset:22528
    v_cvt_pk_bf16_f32 v60, v120, v121
    v_mfma_f32_16x16x32_bf16 v[136:139], a[168:171], v[48:51], v[136:139]
    s_waitcnt lgkmcnt(3)
    v_exp_f32 v122, v122
    v_mfma_f32_16x16x32_bf16 v[168:171], a[168:171], v[52:55], v[168:171]
    buffer_store_dwordx4 v[24:27], v17, s[8:11], s27 offen offset:0 sc0 sc1
    v_mfma_f32_16x16x32_bf16 v[140:143], a[172:175], v[48:51], v[140:143]
    v_exp_f32 v123, v123
    v_mfma_f32_16x16x32_bf16 v[172:175], a[172:175], v[52:55], v[172:175]
    s_waitcnt lgkmcnt(2)
    ds_read_b128 a[188:191], v20 offset:23552
    v_cvt_pk_bf16_f32 v61, v122, v123
    v_mfma_f32_16x16x32_bf16 v[144:147], a[176:179], v[48:51], v[144:147]
    v_exp_f32 v124, v124
    v_mfma_f32_16x16x32_bf16 v[176:179], a[176:179], v[52:55], v[176:179]
    s_waitcnt lgkmcnt(2)
    v_mfma_f32_16x16x32_bf16 v[148:151], a[180:183], v[48:51], v[148:151]
    v_exp_f32 v125, v125
    v_mfma_f32_16x16x32_bf16 v[180:183], a[180:183], v[52:55], v[180:183]
    s_waitcnt lgkmcnt(1)
    v_cvt_pk_bf16_f32 v62, v124, v125
    v_xor_b32 v19, 98304, v19
    v_mfma_f32_16x16x32_bf16 v[152:155], a[184:187], v[48:51], v[152:155]
    v_exp_f32 v126, v126
    v_mfma_f32_16x16x32_bf16 v[184:187], a[184:187], v[52:55], v[184:187]
    s_waitcnt lgkmcnt(0)
    v_xor_b32 v20, 98304, v20
    v_mfma_f32_16x16x32_bf16 v[156:159], a[188:191], v[48:51], v[156:159]
    v_exp_f32 v127, v127
    v_mfma_f32_16x16x32_bf16 v[188:191], a[188:191], v[52:55], v[188:191]
    v_cvt_pk_bf16_f32 v63, v126, v127
    v_mfma_f32_16x16x32_bf16 v[112:115], a[128:131], a[224:227], v[72:75]
    s_add_u32 s17, s17, 4096
    v_exp_f32 v96, v96
    v_mfma_f32_16x16x32_bf16 v[112:115], a[132:135], a[228:231], v[112:115]
    buffer_store_dwordx4 a[12:15], v12, s[8:11], s17 offen sc0 sc1
    v_mfma_f32_16x16x32_bf16 v[112:115], a[136:139], a[232:235], v[112:115]
    s_add_u32 s27, s18, 8388608
    v_exp_f32 v97, v97
    v_mfma_f32_16x16x32_bf16 v[112:115], a[140:143], a[236:239], v[112:115]
    v_cvt_pk_bf16_f32 v48, v96, v97
    v_lshl_add_u32 v8, v8, 10, v9
    v_mfma_f32_16x16x32_bf16 v[120:123], a[128:131], a[240:243], v[76:79]
    v_exp_f32 v98, v98
    v_mfma_f32_16x16x32_bf16 v[120:123], a[132:135], a[244:247], v[120:123]
    buffer_store_dwordx4 v[24:27], v17, s[8:11], s27 offen offset:256 sc0 sc1
    v_mfma_f32_16x16x32_bf16 v[120:123], a[136:139], a[248:251], v[120:123]
    s_add_u32 s27, s18, 8519680
    v_exp_f32 v99, v99
    v_mfma_f32_16x16x32_bf16 v[120:123], a[140:143], a[252:255], v[120:123]
    buffer_store_dwordx4 v[24:27], v17, s[8:11], s27 offen offset:256 sc0 sc1
    v_mfma_f32_16x16x32_bf16 v[116:119], a[144:147], a[224:227], v[72:75]
    s_add_u32 s27, s18, 8388608
    v_exp_f32 v100, v100
    v_mfma_f32_16x16x32_bf16 v[116:119], a[148:151], a[228:231], v[116:119]
    ds_read_b128 a[128:131], v18 offset:16384
    v_cvt_pk_bf16_f32 v49, v98, v99
    v_mfma_f32_16x16x32_bf16 v[116:119], a[152:155], a[232:235], v[116:119]
    s_add_u32 s19, s82, 32768
    v_exp_f32 v101, v101
    v_mfma_f32_16x16x32_bf16 v[116:119], a[156:159], a[236:239], v[116:119]
    s_sub_u32 s82, s12, s13
    ds_read_b128 a[132:135], v18 offset:17408
    v_cvt_pk_bf16_f32 v50, v100, v101
    v_mfma_f32_16x16x32_bf16 v[124:127], a[144:147], a[240:243], v[76:79]
    s_sub_u32 s82, s82, 1
    v_exp_f32 v102, v102
    v_mfma_f32_16x16x32_bf16 v[124:127], a[148:151], a[244:247], v[124:127]
    s_cmp_gt_u32 s12, s13
    s_cselect_b32 s82, s82, s12
    s_mul_i32 s82, s82, 65536
    ds_read_b128 a[136:139], v18 offset:18432
    v_mfma_f32_16x16x32_bf16 v[124:127], a[152:155], a[248:251], v[124:127]
    s_add_u32 s82, s82, s81
    v_exp_f32 v103, v103
    v_mfma_f32_16x16x32_bf16 v[124:127], a[156:159], a[252:255], v[124:127]
    s_cmp_ge_u32 s12, 17
    s_cselect_b32 s82, 2147471360, s82
    ds_read_b128 a[140:143], v18 offset:19456
    v_cvt_pk_bf16_f32 v51, v102, v103
    v_mfma_f32_16x16x32_bf16 v[40:43], v[28:31], v[56:59], v[40:43]
    s_add_u32 s12, s12, 1
    v_exp_f32 v104, v104
    v_mfma_f32_16x16x32_bf16 v[44:47], v[28:31], v[60:63], v[44:47]
    ds_read_b128 a[144:147], v18 offset:20480
    v_bfe_u32 v4, v2, 1, 2
    v_mfma_f32_16x16x32_bf16 v[192:195], a[160:163], v[56:59], v[192:195]
    v_exp_f32 v105, v105
    v_mfma_f32_16x16x32_bf16 v[224:227], a[160:163], v[60:63], v[224:227]
    ds_read_b128 a[148:151], v18 offset:21504
    v_cvt_pk_bf16_f32 v52, v104, v105
    v_mfma_f32_16x16x32_bf16 v[196:199], a[164:167], v[56:59], v[196:199]
    v_exp_f32 v106, v106
    v_mfma_f32_16x16x32_bf16 v[228:231], a[164:167], v[60:63], v[228:231]
    ds_read_b128 a[152:155], v18 offset:22528
    v_lshlrev_b32 v4, 11, v4
    v_mfma_f32_16x16x32_bf16 v[200:203], a[168:171], v[56:59], v[200:203]
    v_exp_f32 v107, v107
    v_mfma_f32_16x16x32_bf16 v[232:235], a[168:171], v[60:63], v[232:235]
    ds_read_b128 a[156:159], v18 offset:23552
    v_cvt_pk_bf16_f32 v53, v106, v107
    v_mfma_f32_16x16x32_bf16 v[204:207], a[172:175], v[56:59], v[204:207]
    v_exp_f32 v108, v108
    v_mfma_f32_16x16x32_bf16 v[236:239], a[172:175], v[60:63], v[236:239]
    buffer_store_dwordx4 v[24:27], v17, s[8:11], s27 offen offset:512 sc0 sc1
    v_mfma_f32_16x16x32_bf16 v[208:211], a[176:179], v[56:59], v[208:211]
    s_add_u32 s27, s18, 8519680
    v_exp_f32 v109, v109
    v_mfma_f32_16x16x32_bf16 v[240:243], a[176:179], v[60:63], v[240:243]
    v_cvt_pk_bf16_f32 v54, v108, v109
    v_xor_b32 v18, 196608, v18
    v_mfma_f32_16x16x32_bf16 v[212:215], a[180:183], v[56:59], v[212:215]
    v_exp_f32 v110, v110
    v_mfma_f32_16x16x32_bf16 v[244:247], a[180:183], v[60:63], v[244:247]
    buffer_store_dwordx4 v[24:27], v17, s[8:11], s27 offen offset:512 sc0 sc1
    v_mfma_f32_16x16x32_bf16 v[216:219], a[184:187], v[56:59], v[216:219]
    v_exp_f32 v111, v111
    v_mfma_f32_16x16x32_bf16 v[248:251], a[184:187], v[60:63], v[248:251]
    v_cvt_pk_bf16_f32 v55, v110, v111
    v_lshl_add_u32 v4, v10, 6, v4
    v_mfma_f32_16x16x32_bf16 v[220:223], a[188:191], v[56:59], v[220:223]
    v_add_u32 v9, 7168, v8
    v_add_u32 v10, 14336, v8
    v_mfma_f32_16x16x32_bf16 v[252:255], a[188:191], v[60:63], v[252:255]
    v_add_u32 v11, 21504, v8
    s_waitcnt vmcnt(9) lgkmcnt(0)
    s_barrier
    v_mfma_f32_16x16x32_bf16 v[96:99], a[128:131], a[192:195], v[64:67]
    s_add_u32 m0, s15, 0
    ds_read_b128 a[160:163], v19 offset:0
    v_mfma_f32_16x16x32_bf16 v[96:99], a[132:135], a[196:199], v[96:99]
    ds_read_b128 a[164:167], v19 offset:1024
    v_mfma_f32_16x16x32_bf16 v[96:99], a[136:139], a[200:203], v[96:99]
    v_exp_f32 v112, v112
    v_mfma_f32_16x16x32_bf16 v[96:99], a[140:143], a[204:207], v[96:99]
    buffer_load_dwordx4 v1, s[8:11], s82 offen offset:0  lds
    v_mfma_f32_16x16x32_bf16 v[104:107], a[128:131], a[208:211], v[68:71]
    v_exp_f32 v113, v113
    v_mfma_f32_16x16x32_bf16 v[104:107], a[132:135], a[212:215], v[104:107]
    ds_read_b128 a[168:171], v19 offset:2048
    v_cvt_pk_bf16_f32 v56, v112, v113
    v_mfma_f32_16x16x32_bf16 v[104:107], a[136:139], a[216:219], v[104:107]
    v_exp_f32 v114, v114
    v_mfma_f32_16x16x32_bf16 v[104:107], a[140:143], a[220:223], v[104:107]
    buffer_load_dwordx4 v1, s[8:11], s82 offen offset:1024  lds
    v_mfma_f32_16x16x32_bf16 v[100:103], a[144:147], a[192:195], v[64:67]
    v_exp_f32 v115, v115
    v_mfma_f32_16x16x32_bf16 v[100:103], a[148:151], a[196:199], v[100:103]
    ds_read_b128 a[172:175], v19 offset:3072
    v_cvt_pk_bf16_f32 v57, v114, v115
    v_mfma_f32_16x16x32_bf16 v[100:103], a[152:155], a[200:203], v[100:103]
    v_exp_f32 v116, v116
    v_mfma_f32_16x16x32_bf16 v[100:103], a[156:159], a[204:207], v[100:103]
    buffer_load_dwordx4 v1, s[8:11], s82 offen offset:2048  lds
    v_mfma_f32_16x16x32_bf16 v[108:111], a[144:147], a[208:211], v[68:71]
    v_exp_f32 v117, v117
    v_mfma_f32_16x16x32_bf16 v[108:111], a[148:151], a[212:215], v[108:111]
    ds_read_b128 a[176:179], v20 offset:4096
    v_cvt_pk_bf16_f32 v58, v116, v117
    v_mfma_f32_16x16x32_bf16 v[108:111], a[152:155], a[216:219], v[108:111]
    v_exp_f32 v118, v118
    v_mfma_f32_16x16x32_bf16 v[108:111], a[156:159], a[220:223], v[108:111]
    buffer_load_dwordx4 v1, s[8:11], s82 offen offset:3072  lds
    v_mfma_f32_16x16x32_bf16 v[32:35], v[28:31], v[48:51], v[32:35]
    s_add_u32 m0, s15, 4096
    v_exp_f32 v119, v119
    v_mfma_f32_16x16x32_bf16 v[36:39], v[28:31], v[52:55], v[36:39]
    s_waitcnt lgkmcnt(4)
    ds_read_b128 a[180:183], v20 offset:5120
    v_cvt_pk_bf16_f32 v59, v118, v119
    v_mfma_f32_16x16x32_bf16 v[128:131], a[160:163], v[48:51], v[128:131]
    s_waitcnt lgkmcnt(4)
    v_exp_f32 v120, v120
    v_mfma_f32_16x16x32_bf16 v[160:163], a[160:163], v[52:55], v[160:163]
    buffer_load_dwordx4 v15, s[8:11], s82 offen offset:0  lds
    v_mfma_f32_16x16x32_bf16 v[132:135], a[164:167], v[48:51], v[132:135]
    v_exp_f32 v121, v121
    v_mfma_f32_16x16x32_bf16 v[164:167], a[164:167], v[52:55], v[164:167]
    s_waitcnt lgkmcnt(3)
    ds_read_b128 a[184:187], v20 offset:6144
    v_cvt_pk_bf16_f32 v60, v120, v121
    v_mfma_f32_16x16x32_bf16 v[136:139], a[168:171], v[48:51], v[136:139]
    s_waitcnt lgkmcnt(3)
    v_exp_f32 v122, v122
    v_mfma_f32_16x16x32_bf16 v[168:171], a[168:171], v[52:55], v[168:171]
    buffer_load_dwordx4 v15, s[8:11], s82 offen offset:1024  lds
    v_mfma_f32_16x16x32_bf16 v[140:143], a[172:175], v[48:51], v[140:143]
    v_exp_f32 v123, v123
    v_mfma_f32_16x16x32_bf16 v[172:175], a[172:175], v[52:55], v[172:175]
    s_waitcnt lgkmcnt(2)
    ds_read_b128 a[188:191], v20 offset:7168
    v_cvt_pk_bf16_f32 v61, v122, v123
    v_mfma_f32_16x16x32_bf16 v[144:147], a[176:179], v[48:51], v[144:147]
    s_waitcnt lgkmcnt(2)
    v_exp_f32 v124, v124
    v_mfma_f32_16x16x32_bf16 v[176:179], a[176:179], v[52:55], v[176:179]
    buffer_load_dwordx4 v15, s[8:11], s82 offen offset:2048  lds
    v_mfma_f32_16x16x32_bf16 v[148:151], a[180:183], v[48:51], v[148:151]
    v_exp_f32 v125, v125
    v_mfma_f32_16x16x32_bf16 v[180:183], a[180:183], v[52:55], v[180:183]
    s_waitcnt lgkmcnt(1)
    v_cvt_pk_bf16_f32 v62, v124, v125
    v_mfma_f32_16x16x32_bf16 v[152:155], a[184:187], v[48:51], v[152:155]
    s_waitcnt lgkmcnt(0)
    v_exp_f32 v126, v126
    v_mfma_f32_16x16x32_bf16 v[184:187], a[184:187], v[52:55], v[184:187]
    buffer_load_dwordx4 v15, s[8:11], s82 offen offset:3072  lds
    v_mfma_f32_16x16x32_bf16 v[156:159], a[188:191], v[48:51], v[156:159]
    s_xor_b32 s15, s15, 196608
    v_exp_f32 v127, v127
    v_mfma_f32_16x16x32_bf16 v[188:191], a[188:191], v[52:55], v[188:191]
    s_add_u32 m0, s16, 0
    v_cvt_pk_bf16_f32 v63, v126, v127
    v_mfma_f32_16x16x32_bf16 v[112:115], a[128:131], a[224:227], v[72:75]
    v_mfma_f32_16x16x32_bf16 v[112:115], a[132:135], a[228:231], v[112:115]
    v_mfma_f32_16x16x32_bf16 v[112:115], a[136:139], a[232:235], v[112:115]
    v_exp_f32 v96, v96
    v_mfma_f32_16x16x32_bf16 v[112:115], a[140:143], a[236:239], v[112:115]
    buffer_load_dwordx4 v1, s[8:11], s19 offen offset:0  lds
    v_mfma_f32_16x16x32_bf16 v[120:123], a[128:131], a[240:243], v[76:79]
    v_exp_f32 v97, v97
    v_mfma_f32_16x16x32_bf16 v[120:123], a[132:135], a[244:247], v[120:123]
    ds_read_b128 a[128:131], v18 offset:0
    v_cvt_pk_bf16_f32 v48, v96, v97
    v_mfma_f32_16x16x32_bf16 v[120:123], a[136:139], a[248:251], v[120:123]
    v_exp_f32 v98, v98
    v_mfma_f32_16x16x32_bf16 v[120:123], a[140:143], a[252:255], v[120:123]
    buffer_load_dwordx4 v1, s[8:11], s19 offen offset:1024  lds
    v_mfma_f32_16x16x32_bf16 v[116:119], a[144:147], a[224:227], v[72:75]
    v_exp_f32 v99, v99
    v_mfma_f32_16x16x32_bf16 v[116:119], a[148:151], a[228:231], v[116:119]
    ds_read_b128 a[132:135], v18 offset:1024
    v_cvt_pk_bf16_f32 v49, v98, v99
    v_mfma_f32_16x16x32_bf16 v[116:119], a[152:155], a[232:235], v[116:119]
    v_exp_f32 v100, v100
    v_mfma_f32_16x16x32_bf16 v[116:119], a[156:159], a[236:239], v[116:119]
    buffer_load_dwordx4 v1, s[8:11], s19 offen offset:2048  lds
    v_mfma_f32_16x16x32_bf16 v[124:127], a[144:147], a[240:243], v[76:79]
    v_exp_f32 v101, v101
    v_mfma_f32_16x16x32_bf16 v[124:127], a[148:151], a[244:247], v[124:127]
    ds_read_b128 a[136:139], v18 offset:2048
    v_cvt_pk_bf16_f32 v50, v100, v101
    v_mfma_f32_16x16x32_bf16 v[124:127], a[152:155], a[248:251], v[124:127]
    v_exp_f32 v102, v102
    v_mfma_f32_16x16x32_bf16 v[124:127], a[156:159], a[252:255], v[124:127]
    buffer_load_dwordx4 v1, s[8:11], s19 offen offset:3072  lds
    v_mfma_f32_16x16x32_bf16 v[40:43], v[28:31], v[56:59], v[40:43]
    s_add_u32 m0, s16, 4096
    v_exp_f32 v103, v103
    v_mfma_f32_16x16x32_bf16 v[44:47], v[28:31], v[60:63], v[44:47]
    ds_read_b128 a[140:143], v18 offset:3072
    v_cvt_pk_bf16_f32 v51, v102, v103
    v_mfma_f32_16x16x32_bf16 v[192:195], a[160:163], v[56:59], v[192:195]
    v_exp_f32 v104, v104
    v_mfma_f32_16x16x32_bf16 v[224:227], a[160:163], v[60:63], v[224:227]
    buffer_load_dwordx4 v15, s[8:11], s19 offen offset:0  lds
    v_mfma_f32_16x16x32_bf16 v[196:199], a[164:167], v[56:59], v[196:199]
    v_exp_f32 v105, v105
    v_mfma_f32_16x16x32_bf16 v[228:231], a[164:167], v[60:63], v[228:231]
    ds_read_b128 a[144:147], v18 offset:4096
    v_cvt_pk_bf16_f32 v52, v104, v105
    v_mfma_f32_16x16x32_bf16 v[200:203], a[168:171], v[56:59], v[200:203]
    v_exp_f32 v106, v106
    v_mfma_f32_16x16x32_bf16 v[232:235], a[168:171], v[60:63], v[232:235]
    buffer_load_dwordx4 v15, s[8:11], s19 offen offset:1024  lds
    v_mfma_f32_16x16x32_bf16 v[204:207], a[172:175], v[56:59], v[204:207]
    v_exp_f32 v107, v107
    v_mfma_f32_16x16x32_bf16 v[236:239], a[172:175], v[60:63], v[236:239]
    ds_read_b128 a[148:151], v18 offset:5120
    v_cvt_pk_bf16_f32 v53, v106, v107
    v_mfma_f32_16x16x32_bf16 v[208:211], a[176:179], v[56:59], v[208:211]
    v_exp_f32 v108, v108
    v_mfma_f32_16x16x32_bf16 v[240:243], a[176:179], v[60:63], v[240:243]
    buffer_load_dwordx4 v15, s[8:11], s19 offen offset:2048  lds
    v_mfma_f32_16x16x32_bf16 v[212:215], a[180:183], v[56:59], v[212:215]
    v_exp_f32 v109, v109
    v_mfma_f32_16x16x32_bf16 v[244:247], a[180:183], v[60:63], v[244:247]
    ds_read_b128 a[152:155], v18 offset:6144
    v_cvt_pk_bf16_f32 v54, v108, v109
    v_mfma_f32_16x16x32_bf16 v[216:219], a[184:187], v[56:59], v[216:219]
    v_exp_f32 v110, v110
    v_mfma_f32_16x16x32_bf16 v[248:251], a[184:187], v[60:63], v[248:251]
    buffer_load_dwordx4 v15, s[8:11], s19 offen offset:3072  lds
    v_mfma_f32_16x16x32_bf16 v[220:223], a[188:191], v[56:59], v[220:223]
    s_xor_b32 s16, s16, 98304
    v_exp_f32 v111, v111
    v_mfma_f32_16x16x32_bf16 v[252:255], a[188:191], v[60:63], v[252:255]
    ds_read_b128 a[156:159], v18 offset:7168
    v_cvt_pk_bf16_f32 v55, v110, v111
    s_waitcnt lgkmcnt(7)
    v_mfma_f32_16x16x32_bf16 v[96:99], a[128:131], a[192:195], v[64:67]
    s_waitcnt lgkmcnt(6)
    s_mul_i32 s17, s4, 229376
    s_mul_i32 s100, s3, 7168
    ds_read_b128 a[160:163], v19 offset:16384
    v_mfma_f32_16x16x32_bf16 v[96:99], a[132:135], a[196:199], v[96:99]
    s_waitcnt lgkmcnt(6)
    s_add_u32 s17, s17, s100
    s_lshl_b32 s100, s101, 7
    ds_read_b128 a[164:167], v19 offset:17408
    v_mfma_f32_16x16x32_bf16 v[96:99], a[136:139], a[200:203], v[96:99]
    s_waitcnt lgkmcnt(6)
    s_add_u32 s17, s17, s100
    v_exp_f32 v112, v112
    v_mfma_f32_16x16x32_bf16 v[96:99], a[140:143], a[204:207], v[96:99]
    v_mfma_f32_16x16x32_bf16 v[104:107], a[128:131], a[208:211], v[68:71]
    s_add_u32 s17, s17, 8388608
    v_exp_f32 v113, v113
    v_mfma_f32_16x16x32_bf16 v[104:107], a[132:135], a[212:215], v[104:107]
    s_cmp_lt_u32 s101, s26
    s_cselect_b32 s17, s17, 2147479552
    ds_read_b128 a[168:171], v19 offset:18432
    v_cvt_pk_bf16_f32 v56, v112, v113
    v_mfma_f32_16x16x32_bf16 v[104:107], a[136:139], a[216:219], v[104:107]
    s_waitcnt lgkmcnt(6)
    v_exp_f32 v114, v114
    v_mfma_f32_16x16x32_bf16 v[104:107], a[140:143], a[220:223], v[104:107]
    buffer_store_dwordx4 a[16:19], v13, s[8:11], s17 offen sc0 sc1
    v_mfma_f32_16x16x32_bf16 v[100:103], a[144:147], a[192:195], v[64:67]
    s_waitcnt lgkmcnt(5)
    s_add_u32 s27, s18, 8388608
    v_exp_f32 v115, v115
    v_mfma_f32_16x16x32_bf16 v[100:103], a[148:151], a[196:199], v[100:103]
    s_waitcnt lgkmcnt(4)
    ds_read_b128 a[172:175], v19 offset:19456
    v_cvt_pk_bf16_f32 v57, v114, v115
    v_mfma_f32_16x16x32_bf16 v[100:103], a[152:155], a[200:203], v[100:103]
    s_waitcnt lgkmcnt(4)
    v_exp_f32 v116, v116
    v_mfma_f32_16x16x32_bf16 v[100:103], a[156:159], a[204:207], v[100:103]
    buffer_store_dwordx4 v[24:27], v17, s[8:11], s27 offen offset:768 sc0 sc1
    v_mfma_f32_16x16x32_bf16 v[108:111], a[144:147], a[208:211], v[68:71]
    s_add_u32 s27, s18, 8519680
    v_exp_f32 v117, v117
    v_mfma_f32_16x16x32_bf16 v[108:111], a[148:151], a[212:215], v[108:111]
    ds_read_b128 a[176:179], v20 offset:20480
    v_cvt_pk_bf16_f32 v58, v116, v117
    v_mfma_f32_16x16x32_bf16 v[108:111], a[152:155], a[216:219], v[108:111]
    v_exp_f32 v118, v118
    v_mfma_f32_16x16x32_bf16 v[108:111], a[156:159], a[220:223], v[108:111]
    buffer_store_dwordx4 v[24:27], v17, s[8:11], s27 offen offset:768 sc0 sc1
    v_mfma_f32_16x16x32_bf16 v[32:35], v[28:31], v[48:51], v[32:35]
    v_exp_f32 v119, v119
    v_mfma_f32_16x16x32_bf16 v[36:39], v[28:31], v[52:55], v[36:39]
    s_waitcnt lgkmcnt(4)
    ds_read_b128 a[180:183], v20 offset:21504
    v_cvt_pk_bf16_f32 v59, v118, v119
    v_mfma_f32_16x16x32_bf16 v[128:131], a[160:163], v[48:51], v[128:131]
    s_waitcnt lgkmcnt(4)
    v_exp_f32 v120, v120
    v_mfma_f32_16x16x32_bf16 v[160:163], a[160:163], v[52:55], v[160:163]
    buffer_load_dword v3, v4, s[8:11], s23 offen sc0 sc1
    v_mfma_f32_16x16x32_bf16 v[132:135], a[164:167], v[48:51], v[132:135]
    v_exp_f32 v121, v121
    v_mfma_f32_16x16x32_bf16 v[164:167], a[164:167], v[52:55], v[164:167]
    s_waitcnt lgkmcnt(3)
    ds_read_b128 a[184:187], v20 offset:22528
    v_cvt_pk_bf16_f32 v60, v120, v121
    v_mfma_f32_16x16x32_bf16 v[136:139], a[168:171], v[48:51], v[136:139]
    v_exp_f32 v122, v122
    v_mfma_f32_16x16x32_bf16 v[168:171], a[168:171], v[52:55], v[168:171]
    s_waitcnt lgkmcnt(3)
    v_mfma_f32_16x16x32_bf16 v[140:143], a[172:175], v[48:51], v[140:143]
    v_exp_f32 v123, v123
    v_mfma_f32_16x16x32_bf16 v[172:175], a[172:175], v[52:55], v[172:175]
    s_waitcnt lgkmcnt(2)
    ds_read_b128 a[188:191], v20 offset:23552
    v_cvt_pk_bf16_f32 v61, v122, v123
    v_mfma_f32_16x16x32_bf16 v[144:147], a[176:179], v[48:51], v[144:147]
    v_exp_f32 v124, v124
    v_mfma_f32_16x16x32_bf16 v[176:179], a[176:179], v[52:55], v[176:179]
    s_waitcnt lgkmcnt(2)
    v_mfma_f32_16x16x32_bf16 v[148:151], a[180:183], v[48:51], v[148:151]
    v_exp_f32 v125, v125
    v_mfma_f32_16x16x32_bf16 v[180:183], a[180:183], v[52:55], v[180:183]
    s_waitcnt lgkmcnt(1)
    v_cvt_pk_bf16_f32 v62, v124, v125
    v_xor_b32 v19, 98304, v19
    v_mfma_f32_16x16x32_bf16 v[152:155], a[184:187], v[48:51], v[152:155]
    v_exp_f32 v126, v126
    v_mfma_f32_16x16x32_bf16 v[184:187], a[184:187], v[52:55], v[184:187]
    s_waitcnt lgkmcnt(0)
    v_xor_b32 v20, 98304, v20
    v_mfma_f32_16x16x32_bf16 v[156:159], a[188:191], v[48:51], v[156:159]
    v_exp_f32 v127, v127
    v_mfma_f32_16x16x32_bf16 v[188:191], a[188:191], v[52:55], v[188:191]
    v_cvt_pk_bf16_f32 v63, v126, v127
    v_mfma_f32_16x16x32_bf16 v[112:115], a[128:131], a[224:227], v[72:75]
    v_exp_f32 v96, v96
    v_mfma_f32_16x16x32_bf16 v[112:115], a[132:135], a[228:231], v[112:115]
    buffer_store_dwordx4 a[20:23], v13, s[8:11], s17 offen offset:3584 sc0 sc1
    v_mfma_f32_16x16x32_bf16 v[112:115], a[136:139], a[232:235], v[112:115]
    v_exp_f32 v97, v97
    v_mfma_f32_16x16x32_bf16 v[112:115], a[140:143], a[236:239], v[112:115]
    v_cvt_pk_bf16_f32 v48, v96, v97
    v_lshlrev_b32 v12, 3, v0
    v_mfma_f32_16x16x32_bf16 v[120:123], a[128:131], a[240:243], v[76:79]
    s_lshl_b32 s101, s2, 11
    v_exp_f32 v98, v98
    v_mfma_f32_16x16x32_bf16 v[120:123], a[132:135], a[244:247], v[120:123]
    v_add_f32 v80, 0, v21
    v_min_f32 v80, v80, v64
    v_mfma_f32_16x16x32_bf16 v[120:123], a[136:139], a[248:251], v[120:123]
    s_add_u32 s101, s101, 524288
    v_exp_f32 v99, v99
    v_mfma_f32_16x16x32_bf16 v[120:123], a[140:143], a[252:255], v[120:123]
    buffer_store_dwordx2 v[24:25], v12, s[8:11], s101 offen sc0 sc1
    v_mfma_f32_16x16x32_bf16 v[116:119], a[144:147], a[224:227], v[72:75]
    s_lshl_b32 s101, s2, 6
    v_exp_f32 v100, v100
    v_mfma_f32_16x16x32_bf16 v[116:119], a[148:151], a[228:231], v[116:119]
    s_add_u32 s101, s101, 65536
    ds_read_b128 a[128:131], v18 offset:16384
    v_cvt_pk_bf16_f32 v49, v98, v99
    v_mfma_f32_16x16x32_bf16 v[116:119], a[152:155], a[232:235], v[116:119]
    s_add_u32 s19, s82, 32768
    v_exp_f32 v101, v101
    v_mfma_f32_16x16x32_bf16 v[116:119], a[156:159], a[236:239], v[116:119]
    s_sub_u32 s82, s12, s13
    ds_read_b128 a[132:135], v18 offset:17408
    v_cvt_pk_bf16_f32 v50, v100, v101
    v_mfma_f32_16x16x32_bf16 v[124:127], a[144:147], a[240:243], v[76:79]
    s_sub_u32 s82, s82, 1
    v_exp_f32 v102, v102
    v_mfma_f32_16x16x32_bf16 v[124:127], a[148:151], a[244:247], v[124:127]
    s_cmp_gt_u32 s12, s13
    s_cselect_b32 s82, s82, s12
    s_mul_i32 s82, s82, 65536
    ds_read_b128 a[136:139], v18 offset:18432
    v_mfma_f32_16x16x32_bf16 v[124:127], a[152:155], a[248:251], v[124:127]
    s_add_u32 s82, s82, s81
    v_exp_f32 v103, v103
    v_mfma_f32_16x16x32_bf16 v[124:127], a[156:159], a[252:255], v[124:127]
    s_cmp_ge_u32 s12, 17
    s_cselect_b32 s82, 2147471360, s82
    ds_read_b128 a[140:143], v18 offset:19456
    v_cvt_pk_bf16_f32 v51, v102, v103
    v_mfma_f32_16x16x32_bf16 v[40:43], v[28:31], v[56:59], v[40:43]
    s_add_u32 s12, s12, 1
    v_exp_f32 v104, v104
    v_mfma_f32_16x16x32_bf16 v[44:47], v[28:31], v[60:63], v[44:47]
    ds_read_b128 a[144:147], v18 offset:20480
    v_mov_b32 v13, 0
    v_mfma_f32_16x16x32_bf16 v[192:195], a[160:163], v[56:59], v[192:195]
    v_exp_f32 v105, v105
    v_mfma_f32_16x16x32_bf16 v[224:227], a[160:163], v[60:63], v[224:227]
    ds_read_b128 a[148:151], v18 offset:21504
    v_cvt_pk_bf16_f32 v52, v104, v105
    v_mfma_f32_16x16x32_bf16 v[196:199], a[164:167], v[56:59], v[196:199]
    v_exp_f32 v106, v106
    v_mfma_f32_16x16x32_bf16 v[228:231], a[164:167], v[60:63], v[228:231]
    ds_read_b128 a[152:155], v18 offset:22528
    v_add_f32 v81, 0xf1800000, v21
    v_mfma_f32_16x16x32_bf16 v[200:203], a[168:171], v[56:59], v[200:203]
    v_exp_f32 v107, v107
    v_mfma_f32_16x16x32_bf16 v[232:235], a[168:171], v[60:63], v[232:235]
    ds_read_b128 a[156:159], v18 offset:23552
    v_cvt_pk_bf16_f32 v53, v106, v107
    v_mfma_f32_16x16x32_bf16 v[204:207], a[172:175], v[56:59], v[204:207]
    v_exp_f32 v108, v108
    v_mfma_f32_16x16x32_bf16 v[236:239], a[172:175], v[60:63], v[236:239]
    buffer_store_dword v13, v7, s[8:11], s101 offen sc0 sc1
    v_mfma_f32_16x16x32_bf16 v[208:211], a[176:179], v[56:59], v[208:211]
    s_lshl_b32 s101, s66, 6
    v_exp_f32 v109, v109
    v_mfma_f32_16x16x32_bf16 v[240:243], a[176:179], v[60:63], v[240:243]
    s_add_u32 s101, s101, 81920
    v_cvt_pk_bf16_f32 v54, v108, v109
    v_xor_b32 v18, 196608, v18
    v_mfma_f32_16x16x32_bf16 v[212:215], a[180:183], v[56:59], v[212:215]
    v_exp_f32 v110, v110
    v_mfma_f32_16x16x32_bf16 v[244:247], a[180:183], v[60:63], v[244:247]
    buffer_store_dwordx4 v[24:27], v7, s[8:11], s101 offen sc0 sc1
    v_mfma_f32_16x16x32_bf16 v[216:219], a[184:187], v[56:59], v[216:219]
    v_exp_f32 v111, v111
    v_mfma_f32_16x16x32_bf16 v[248:251], a[184:187], v[60:63], v[248:251]
    v_cvt_pk_bf16_f32 v55, v110, v111
    v_min_f32 v81, v81, v65
    v_mfma_f32_16x16x32_bf16 v[220:223], a[188:191], v[56:59], v[220:223]
    buffer_store_dwordx4 v[24:27], v7, s[8:11], s101 offen offset:16 sc0 sc1
    v_mfma_f32_16x16x32_bf16 v[252:255], a[188:191], v[60:63], v[252:255]
    v_add_f32 v82, 0xf2000000, v21
    v_min_f32 v82, v82, v66
    s_waitcnt vmcnt(9) lgkmcnt(0)
    s_barrier
    v_mfma_f32_16x16x32_bf16 v[96:99], a[128:131], a[192:195], v[64:67]
    s_add_u32 m0, s15, 0
    ds_read_b128 a[160:163], v19 offset:0
    v_mfma_f32_16x16x32_bf16 v[96:99], a[132:135], a[196:199], v[96:99]
    ds_read_b128 a[164:167], v19 offset:1024
    v_mfma_f32_16x16x32_bf16 v[96:99], a[136:139], a[200:203], v[96:99]
    v_exp_f32 v112, v112
    v_mfma_f32_16x16x32_bf16 v[96:99], a[140:143], a[204:207], v[96:99]
    buffer_load_dwordx4 v1, s[8:11], s82 offen offset:0  lds
    v_mfma_f32_16x16x32_bf16 v[104:107], a[128:131], a[208:211], v[68:71]
    v_exp_f32 v113, v113
    v_mfma_f32_16x16x32_bf16 v[104:107], a[132:135], a[212:215], v[104:107]
    ds_read_b128 a[168:171], v19 offset:2048
    v_cvt_pk_bf16_f32 v56, v112, v113
    v_mfma_f32_16x16x32_bf16 v[104:107], a[136:139], a[216:219], v[104:107]
    v_exp_f32 v114, v114
    v_mfma_f32_16x16x32_bf16 v[104:107], a[140:143], a[220:223], v[104:107]
    buffer_load_dwordx4 v1, s[8:11], s82 offen offset:1024  lds
    v_mfma_f32_16x16x32_bf16 v[100:103], a[144:147], a[192:195], v[64:67]
    v_exp_f32 v115, v115
    v_mfma_f32_16x16x32_bf16 v[100:103], a[148:151], a[196:199], v[100:103]
    ds_read_b128 a[172:175], v19 offset:3072
    v_cvt_pk_bf16_f32 v57, v114, v115
    v_mfma_f32_16x16x32_bf16 v[100:103], a[152:155], a[200:203], v[100:103]
    v_exp_f32 v116, v116
    v_mfma_f32_16x16x32_bf16 v[100:103], a[156:159], a[204:207], v[100:103]
    buffer_load_dwordx4 v1, s[8:11], s82 offen offset:2048  lds
    v_mfma_f32_16x16x32_bf16 v[108:111], a[144:147], a[208:211], v[68:71]
    v_exp_f32 v117, v117
    v_mfma_f32_16x16x32_bf16 v[108:111], a[148:151], a[212:215], v[108:111]
    ds_read_b128 a[176:179], v20 offset:4096
    v_cvt_pk_bf16_f32 v58, v116, v117
    v_mfma_f32_16x16x32_bf16 v[108:111], a[152:155], a[216:219], v[108:111]
    v_exp_f32 v118, v118
    v_mfma_f32_16x16x32_bf16 v[108:111], a[156:159], a[220:223], v[108:111]
    buffer_load_dwordx4 v1, s[8:11], s82 offen offset:3072  lds
    v_mfma_f32_16x16x32_bf16 v[32:35], v[28:31], v[48:51], v[32:35]
    s_add_u32 m0, s15, 4096
    v_exp_f32 v119, v119
    v_mfma_f32_16x16x32_bf16 v[36:39], v[28:31], v[52:55], v[36:39]
    s_waitcnt lgkmcnt(4)
    ds_read_b128 a[180:183], v20 offset:5120
    v_cvt_pk_bf16_f32 v59, v118, v119
    v_mfma_f32_16x16x32_bf16 v[128:131], a[160:163], v[48:51], v[128:131]
    s_waitcnt lgkmcnt(4)
    v_exp_f32 v120, v120
    v_mfma_f32_16x16x32_bf16 v[160:163], a[160:163], v[52:55], v[160:163]
    buffer_load_dwordx4 v15, s[8:11], s82 offen offset:0  lds
    v_mfma_f32_16x16x32_bf16 v[132:135], a[164:167], v[48:51], v[132:135]
    v_exp_f32 v121, v121
    v_mfma_f32_16x16x32_bf16 v[164:167], a[164:167], v[52:55], v[164:167]
    s_waitcnt lgkmcnt(3)
    ds_read_b128 a[184:187], v20 offset:6144
    v_cvt_pk_bf16_f32 v60, v120, v121
    v_mfma_f32_16x16x32_bf16 v[136:139], a[168:171], v[48:51], v[136:139]
    s_waitcnt lgkmcnt(3)
    v_exp_f32 v122, v122
    v_mfma_f32_16x16x32_bf16 v[168:171], a[168:171], v[52:55], v[168:171]
    buffer_load_dwordx4 v15, s[8:11], s82 offen offset:1024  lds
    v_mfma_f32_16x16x32_bf16 v[140:143], a[172:175], v[48:51], v[140:143]
    v_exp_f32 v123, v123
    v_mfma_f32_16x16x32_bf16 v[172:175], a[172:175], v[52:55], v[172:175]
    s_waitcnt lgkmcnt(2)
    ds_read_b128 a[188:191], v20 offset:7168
    v_cvt_pk_bf16_f32 v61, v122, v123
    v_mfma_f32_16x16x32_bf16 v[144:147], a[176:179], v[48:51], v[144:147]
    s_waitcnt lgkmcnt(2)
    v_exp_f32 v124, v124
    v_mfma_f32_16x16x32_bf16 v[176:179], a[176:179], v[52:55], v[176:179]
    buffer_load_dwordx4 v15, s[8:11], s82 offen offset:2048  lds
    v_mfma_f32_16x16x32_bf16 v[148:151], a[180:183], v[48:51], v[148:151]
    v_exp_f32 v125, v125
    v_mfma_f32_16x16x32_bf16 v[180:183], a[180:183], v[52:55], v[180:183]
    s_waitcnt lgkmcnt(1)
    v_cvt_pk_bf16_f32 v62, v124, v125
    v_mfma_f32_16x16x32_bf16 v[152:155], a[184:187], v[48:51], v[152:155]
    s_waitcnt lgkmcnt(0)
    v_exp_f32 v126, v126
    v_mfma_f32_16x16x32_bf16 v[184:187], a[184:187], v[52:55], v[184:187]
    buffer_load_dwordx4 v15, s[8:11], s82 offen offset:3072  lds
    v_mfma_f32_16x16x32_bf16 v[156:159], a[188:191], v[48:51], v[156:159]
    s_xor_b32 s15, s15, 196608
    v_exp_f32 v127, v127
    v_mfma_f32_16x16x32_bf16 v[188:191], a[188:191], v[52:55], v[188:191]
    s_add_u32 m0, s16, 0
    v_cvt_pk_bf16_f32 v63, v126, v127
    v_mfma_f32_16x16x32_bf16 v[112:115], a[128:131], a[224:227], v[72:75]
    v_mfma_f32_16x16x32_bf16 v[112:115], a[132:135], a[228:231], v[112:115]
    v_mfma_f32_16x16x32_bf16 v[112:115], a[136:139], a[232:235], v[112:115]
    v_exp_f32 v96, v96
    v_mfma_f32_16x16x32_bf16 v[112:115], a[140:143], a[236:239], v[112:115]
    buffer_load_dwordx4 v1, s[8:11], s19 offen offset:0  lds
    v_mfma_f32_16x16x32_bf16 v[120:123], a[128:131], a[240:243], v[76:79]
    v_exp_f32 v97, v97
    v_mfma_f32_16x16x32_bf16 v[120:123], a[132:135], a[244:247], v[120:123]
    ds_read_b128 a[128:131], v18 offset:0
    v_cvt_pk_bf16_f32 v48, v96, v97
    v_mfma_f32_16x16x32_bf16 v[120:123], a[136:139], a[248:251], v[120:123]
    v_exp_f32 v98, v98
    v_mfma_f32_16x16x32_bf16 v[120:123], a[140:143], a[252:255], v[120:123]
    buffer_load_dwordx4 v1, s[8:11], s19 offen offset:1024  lds
    v_mfma_f32_16x16x32_bf16 v[116:119], a[144:147], a[224:227], v[72:75]
    v_exp_f32 v99, v99
    v_mfma_f32_16x16x32_bf16 v[116:119], a[148:151], a[228:231], v[116:119]
    ds_read_b128 a[132:135], v18 offset:1024
    v_cvt_pk_bf16_f32 v49, v98, v99
    v_mfma_f32_16x16x32_bf16 v[116:119], a[152:155], a[232:235], v[116:119]
    v_exp_f32 v100, v100
    v_mfma_f32_16x16x32_bf16 v[116:119], a[156:159], a[236:239], v[116:119]
    buffer_load_dwordx4 v1, s[8:11], s19 offen offset:2048  lds
    v_mfma_f32_16x16x32_bf16 v[124:127], a[144:147], a[240:243], v[76:79]
    v_exp_f32 v101, v101
    v_mfma_f32_16x16x32_bf16 v[124:127], a[148:151], a[244:247], v[124:127]
    ds_read_b128 a[136:139], v18 offset:2048
    v_cvt_pk_bf16_f32 v50, v100, v101
    v_mfma_f32_16x16x32_bf16 v[124:127], a[152:155], a[248:251], v[124:127]
    v_exp_f32 v102, v102
    v_mfma_f32_16x16x32_bf16 v[124:127], a[156:159], a[252:255], v[124:127]
    buffer_load_dwordx4 v1, s[8:11], s19 offen offset:3072  lds
    v_mfma_f32_16x16x32_bf16 v[40:43], v[28:31], v[56:59], v[40:43]
    s_add_u32 m0, s16, 4096
    v_exp_f32 v103, v103
    v_mfma_f32_16x16x32_bf16 v[44:47], v[28:31], v[60:63], v[44:47]
    ds_read_b128 a[140:143], v18 offset:3072
    v_cvt_pk_bf16_f32 v51, v102, v103
    v_mfma_f32_16x16x32_bf16 v[192:195], a[160:163], v[56:59], v[192:195]
    v_exp_f32 v104, v104
    v_mfma_f32_16x16x32_bf16 v[224:227], a[160:163], v[60:63], v[224:227]
    buffer_load_dwordx4 v15, s[8:11], s19 offen offset:0  lds
    v_mfma_f32_16x16x32_bf16 v[196:199], a[164:167], v[56:59], v[196:199]
    v_exp_f32 v105, v105
    v_mfma_f32_16x16x32_bf16 v[228:231], a[164:167], v[60:63], v[228:231]
    ds_read_b128 a[144:147], v18 offset:4096
    v_cvt_pk_bf16_f32 v52, v104, v105
    v_mfma_f32_16x16x32_bf16 v[200:203], a[168:171], v[56:59], v[200:203]
    v_exp_f32 v106, v106
    v_mfma_f32_16x16x32_bf16 v[232:235], a[168:171], v[60:63], v[232:235]
    buffer_load_dwordx4 v15, s[8:11], s19 offen offset:1024  lds
    v_mfma_f32_16x16x32_bf16 v[204:207], a[172:175], v[56:59], v[204:207]
    v_exp_f32 v107, v107
    v_mfma_f32_16x16x32_bf16 v[236:239], a[172:175], v[60:63], v[236:239]
    ds_read_b128 a[148:151], v18 offset:5120
    v_cvt_pk_bf16_f32 v53, v106, v107
    v_mfma_f32_16x16x32_bf16 v[208:211], a[176:179], v[56:59], v[208:211]
    v_exp_f32 v108, v108
    v_mfma_f32_16x16x32_bf16 v[240:243], a[176:179], v[60:63], v[240:243]
    buffer_load_dwordx4 v15, s[8:11], s19 offen offset:2048  lds
    v_mfma_f32_16x16x32_bf16 v[212:215], a[180:183], v[56:59], v[212:215]
    v_exp_f32 v109, v109
    v_mfma_f32_16x16x32_bf16 v[244:247], a[180:183], v[60:63], v[244:247]
    ds_read_b128 a[152:155], v18 offset:6144
    v_cvt_pk_bf16_f32 v54, v108, v109
    v_mfma_f32_16x16x32_bf16 v[216:219], a[184:187], v[56:59], v[216:219]
    v_exp_f32 v110, v110
    v_mfma_f32_16x16x32_bf16 v[248:251], a[184:187], v[60:63], v[248:251]
    buffer_load_dwordx4 v15, s[8:11], s19 offen offset:3072  lds
    v_mfma_f32_16x16x32_bf16 v[220:223], a[188:191], v[56:59], v[220:223]
    s_xor_b32 s16, s16, 98304
    v_exp_f32 v111, v111
    v_mfma_f32_16x16x32_bf16 v[252:255], a[188:191], v[60:63], v[252:255]
    ds_read_b128 a[156:159], v18 offset:7168
    v_cvt_pk_bf16_f32 v55, v110, v111
    s_waitcnt lgkmcnt(7)
    v_mfma_f32_16x16x32_bf16 v[96:99], a[128:131], a[192:195], v[64:67]
    s_waitcnt lgkmcnt(6)
    s_lshl_b32 s24, s60, 2
    s_add_u32 s24, s24, s3
    ds_read_b128 a[160:163], v19 offset:16384
    v_mfma_f32_16x16x32_bf16 v[96:99], a[132:135], a[196:199], v[96:99]
    s_waitcnt lgkmcnt(6)
    s_lshl_b32 s24, s24, 3
    s_add_u32 s24, s24, s4
    ds_read_b128 a[164:167], v19 offset:17408
    v_mfma_f32_16x16x32_bf16 v[96:99], a[136:139], a[200:203], v[96:99]
    s_waitcnt lgkmcnt(6)
    s_lshl_b32 s24, s24, 2
    v_exp_f32 v112, v112
    v_mfma_f32_16x16x32_bf16 v[96:99], a[140:143], a[204:207], v[96:99]
    v_mfma_f32_16x16x32_bf16 v[104:107], a[128:131], a[208:211], v[68:71]
    s_add_u32 s24, s24, s5
    v_exp_f32 v113, v113
    v_mfma_f32_16x16x32_bf16 v[104:107], a[132:135], a[212:215], v[104:107]
    s_lshl_b32 s24, s24, 13
    ds_read_b128 a[168:171], v19 offset:18432
    v_cvt_pk_bf16_f32 v56, v112, v113
    v_mfma_f32_16x16x32_bf16 v[104:107], a[136:139], a[216:219], v[104:107]
    s_add_u32 s24, s24, 50331648
    v_exp_f32 v114, v114
    s_waitcnt vmcnt(21)
    v_cmp_ne_u32 vcc, 0, v3
    s_cmp_eq_u64 vcc, -1
    s_cbranch_scc0 L_C1_slow_9
L_C1_ok_10:
    v_mfma_f32_16x16x32_bf16 v[104:107], a[140:143], a[220:223], v[104:107]
    s_waitcnt lgkmcnt(6)
    v_mfma_f32_16x16x32_bf16 v[100:103], a[144:147], a[192:195], v[64:67]
    s_waitcnt lgkmcnt(5)
    s_xor_b32 s74, s24, 0
    v_exp_f32 v115, v115
    v_mfma_f32_16x16x32_bf16 v[100:103], a[148:151], a[196:199], v[100:103]
    s_waitcnt lgkmcnt(4)
    ds_read_b128 a[172:175], v19 offset:19456
    v_cvt_pk_bf16_f32 v57, v114, v115
    v_mfma_f32_16x16x32_bf16 v[100:103], a[152:155], a[200:203], v[100:103]
    s_waitcnt lgkmcnt(4)
    v_exp_f32 v116, v116
    v_mfma_f32_16x16x32_bf16 v[100:103], a[156:159], a[204:207], v[100:103]
    buffer_load_dwordx4 a[64:67], v1, s[8:11], s74 offen offset:0
    v_mfma_f32_16x16x32_bf16 v[108:111], a[144:147], a[208:211], v[68:71]
    s_xor_b32 s74, s24, 0
    v_exp_f32 v117, v117
    v_mfma_f32_16x16x32_bf16 v[108:111], a[148:151], a[212:215], v[108:111]
    ds_read_b128 a[176:179], v20 offset:20480
    v_cvt_pk_bf16_f32 v58, v116, v117
    v_mfma_f32_16x16x32_bf16 v[108:111], a[152:155], a[216:219], v[108:111]
    v_exp_f32 v118, v118
    v_mfma_f32_16x16x32_bf16 v[108:111], a[156:159], a[220:223], v[108:111]
    buffer_load_dwordx4 a[68:71], v1, s[8:11], s74 offen offset:1024
    v_mfma_f32_16x16x32_bf16 v[32:35], v[28:31], v[48:51], v[32:35]
    s_xor_b32 s74, s24, 0
    v_exp_f32 v119, v119
    v_mfma_f32_16x16x32_bf16 v[36:39], v[28:31], v[52:55], v[36:39]
    s_waitcnt lgkmcnt(4)
    ds_read_b128 a[180:183], v20 offset:21504
    v_cvt_pk_bf16_f32 v59, v118, v119
    v_mfma_f32_16x16x32_bf16 v[128:131], a[160:163], v[48:51], v[128:131]
    s_waitcnt lgkmcnt(4)
    v_exp_f32 v120, v120
    v_mfma_f32_16x16x32_bf16 v[160:163], a[160:163], v[52:55], v[160:163]
    buffer_load_dwordx4 a[72:75], v1, s[8:11], s74 offen offset:2048
    v_mfma_f32_16x16x32_bf16 v[132:135], a[164:167], v[48:51], v[132:135]
    s_xor_b32 s74, s24, 0
    v_exp_f32 v121, v121
    v_mfma_f32_16x16x32_bf16 v[164:167], a[164:167], v[52:55], v[164:167]
    s_waitcnt lgkmcnt(3)
    ds_read_b128 a[184:187], v20 offset:22528
    v_cvt_pk_bf16_f32 v60, v120, v121
    v_mfma_f32_16x16x32_bf16 v[136:139], a[168:171], v[48:51], v[136:139]
    s_waitcnt lgkmcnt(3)
    v_exp_f32 v122, v122
    v_mfma_f32_16x16x32_bf16 v[168:171], a[168:171], v[52:55], v[168:171]
    buffer_load_dwordx4 a[76:79], v1, s[8:11], s74 offen offset:3072
    v_mfma_f32_16x16x32_bf16 v[140:143], a[172:175], v[48:51], v[140:143]
    s_xor_b32 s74, s24, 4096
    v_exp_f32 v123, v123
    v_mfma_f32_16x16x32_bf16 v[172:175], a[172:175], v[52:55], v[172:175]
    s_waitcnt lgkmcnt(2)
    ds_read_b128 a[188:191], v20 offset:23552
    v_cvt_pk_bf16_f32 v61, v122, v123
    v_mfma_f32_16x16x32_bf16 v[144:147], a[176:179], v[48:51], v[144:147]
    s_waitcnt lgkmcnt(2)
    v_exp_f32 v124, v124
    v_mfma_f32_16x16x32_bf16 v[176:179], a[176:179], v[52:55], v[176:179]
    buffer_load_dwordx4 a[80:83], v1, s[8:11], s74 offen offset:0
    v_mfma_f32_16x16x32_bf16 v[148:151], a[180:183], v[48:51], v[148:151]
    v_exp_f32 v125, v125
    v_mfma_f32_16x16x32_bf16 v[180:183], a[180:183], v[52:55], v[180:183]
    s_waitcnt lgkmcnt(1)
    v_cvt_pk_bf16_f32 v62, v124, v125
    v_xor_b32 v19, 98304, v19
    v_mfma_f32_16x16x32_bf16 v[152:155], a[184:187], v[48:51], v[152:155]
    v_exp_f32 v126, v126
    v_mfma_f32_16x16x32_bf16 v[184:187], a[184:187], v[52:55], v[184:187]
    s_waitcnt lgkmcnt(0)
    v_xor_b32 v20, 98304, v20
    v_mfma_f32_16x16x32_bf16 v[156:159], a[188:191], v[48:51], v[156:159]
    v_exp_f32 v127, v127
    v_mfma_f32_16x16x32_bf16 v[188:191], a[188:191], v[52:55], v[188:191]
    v_cvt_pk_bf16_f32 v63, v126, v127
    v_mfma_f32_16x16x32_bf16 v[112:115], a[128:131], a[224:227], v[72:75]
    s_add_u32 m0, s62, 32768
    v_exp_f32 v96, v96
    v_mfma_f32_16x16x32_bf16 v[112:115], a[132:135], a[228:231], v[112:115]
    v_add_f32 v83, 0xf2400000, v21
    v_min_f32 v83, v83, v67
    v_mfma_f32_16x16x32_bf16 v[112:115], a[136:139], a[232:235], v[112:115]
    s_xor_b32 s98, s65, 0
    v_exp_f32 v97, v97
    v_mfma_f32_16x16x32_bf16 v[112:115], a[140:143], a[236:239], v[112:115]
    v_cvt_pk_bf16_f32 v48, v96, v97
    v_add_f32 v84, 0xf3800000, v21
    v_mfma_f32_16x16x32_bf16 v[120:123], a[128:131], a[240:243], v[76:79]
    v_exp_f32 v98, v98
    v_mfma_f32_16x16x32_bf16 v[120:123], a[132:135], a[244:247], v[120:123]
    buffer_load_dwordx4 v8, s[28:31], s98 offen offset:0   lds
    v_mfma_f32_16x16x32_bf16 v[120:123], a[136:139], a[248:251], v[120:123]
    v_exp_f32 v99, v99
    v_mfma_f32_16x16x32_bf16 v[120:123], a[140:143], a[252:255], v[120:123]
    buffer_load_dwordx4 v9, s[28:31], s98 offen offset:1024   lds
    v_mfma_f32_16x16x32_bf16 v[116:119], a[144:147], a[224:227], v[72:75]
    v_exp_f32 v100, v100
    v_mfma_f32_16x16x32_bf16 v[116:119], a[148:151], a[228:231], v[116:119]
    ds_read_b128 a[128:131], v18 offset:16384
    v_cvt_pk_bf16_f32 v49, v98, v99
    v_mfma_f32_16x16x32_bf16 v[116:119], a[152:155], a[232:235], v[116:119]
    s_add_u32 s19, s82, 32768
    v_exp_f32 v101, v101
    v_mfma_f32_16x16x32_bf16 v[116:119], a[156:159], a[236:239], v[116:119]
    s_sub_u32 s82, s12, s13
    ds_read_b128 a[132:135], v18 offset:17408
    v_cvt_pk_bf16_f32 v50, v100, v101
    v_mfma_f32_16x16x32_bf16 v[124:127], a[144:147], a[240:243], v[76:79]
    s_sub_u32 s82, s82, 1
    v_exp_f32 v102, v102
    v_mfma_f32_16x16x32_bf16 v[124:127], a[148:151], a[244:247], v[124:127]
    s_cmp_gt_u32 s12, s13
    s_cselect_b32 s82, s82, s12
    s_mul_i32 s82, s82, 65536
    ds_read_b128 a[136:139], v18 offset:18432
    v_mfma_f32_16x16x32_bf16 v[124:127], a[152:155], a[248:251], v[124:127]
    s_add_u32 s82, s82, s81
    v_exp_f32 v103, v103
    v_mfma_f32_16x16x32_bf16 v[124:127], a[156:159], a[252:255], v[124:127]
    s_cmp_ge_u32 s12, 17
    s_cselect_b32 s82, 2147471360, s82
    ds_read_b128 a[140:143], v18 offset:19456
    v_cvt_pk_bf16_f32 v51, v102, v103
    v_mfma_f32_16x16x32_bf16 v[40:43], v[28:31], v[56:59], v[40:43]
    s_add_u32 s12, s12, 1
    v_exp_f32 v104, v104
    v_mfma_f32_16x16x32_bf16 v[44:47], v[28:31], v[60:63], v[44:47]
    ds_read_b128 a[144:147], v18 offset:20480
    v_min_f32 v84, v84, v64
    v_mfma_f32_16x16x32_bf16 v[192:195], a[160:163], v[56:59], v[192:195]
    v_exp_f32 v105, v105
    v_mfma_f32_16x16x32_bf16 v[224:227], a[160:163], v[60:63], v[224:227]
    ds_read_b128 a[148:151], v18 offset:21504
    v_cvt_pk_bf16_f32 v52, v104, v105
    v_mfma_f32_16x16x32_bf16 v[196:199], a[164:167], v[56:59], v[196:199]
    v_exp_f32 v106, v106
    v_mfma_f32_16x16x32_bf16 v[228:231], a[164:167], v[60:63], v[228:231]
    ds_read_b128 a[152:155], v18 offset:22528
    v_add_f32 v85, 0xf3880000, v21
    v_mfma_f32_16x16x32_bf16 v[200:203], a[168:171], v[56:59], v[200:203]
    v_exp_f32 v107, v107
    v_mfma_f32_16x16x32_bf16 v[232:235], a[168:171], v[60:63], v[232:235]
    ds_read_b128 a[156:159], v18 offset:23552
    v_cvt_pk_bf16_f32 v53, v106, v107
    v_mfma_f32_16x16x32_bf16 v[204:207], a[172:175], v[56:59], v[204:207]
    v_exp_f32 v108, v108
    v_mfma_f32_16x16x32_bf16 v[236:239], a[172:175], v[60:63], v[236:239]
    buffer_load_dwordx4 v10, s[28:31], s98 offen offset:2048   lds
    v_mfma_f32_16x16x32_bf16 v[208:211], a[176:179], v[56:59], v[208:211]
    v_exp_f32 v109, v109
    v_mfma_f32_16x16x32_bf16 v[240:243], a[176:179], v[60:63], v[240:243]
    v_cvt_pk_bf16_f32 v54, v108, v109
    v_xor_b32 v18, 196608, v18
    v_mfma_f32_16x16x32_bf16 v[212:215], a[180:183], v[56:59], v[212:215]
    v_exp_f32 v110, v110
    v_mfma_f32_16x16x32_bf16 v[244:247], a[180:183], v[60:63], v[244:247]
    buffer_load_dwordx4 v11, s[28:31], s98 offen offset:3072   lds
    v_mfma_f32_16x16x32_bf16 v[216:219], a[184:187], v[56:59], v[216:219]
    s_xor_b32 s74, s24, 4096
    v_exp_f32 v111, v111
    v_mfma_f32_16x16x32_bf16 v[248:251], a[184:187], v[60:63], v[248:251]
    v_cvt_pk_bf16_f32 v55, v110, v111
    v_min_f32 v85, v85, v65
    v_mfma_f32_16x16x32_bf16 v[220:223], a[188:191], v[56:59], v[220:223]
    buffer_load_dwordx4 a[84:87], v1, s[8:11], s74 offen offset:1024
    v_mfma_f32_16x16x32_bf16 v[252:255], a[188:191], v[60:63], v[252:255]
    s_xor_b32 s74, s24, 4096
    buffer_load_dwordx4 a[88:91], v1, s[8:11], s74 offen offset:2048
    s_xor_b32 s74, s24, 4096
    buffer_load_dwordx4 a[92:95], v1, s[8:11], s74 offen offset:3072
    s_waitcnt vmcnt(12) lgkmcnt(0)
    s_barrier
    v_mfma_f32_16x16x32_bf16 v[96:99], a[128:131], a[192:195], v[64:67]
    s_add_u32 m0, s15, 0
    ds_read_b128 a[160:163], v19 offset:0
    v_mfma_f32_16x16x32_bf16 v[96:99], a[132:135], a[196:199], v[96:99]
    ds_read_b128 a[164:167], v19 offset:1024
    v_mfma_f32_16x16x32_bf16 v[96:99], a[136:139], a[200:203], v[96:99]
    v_exp_f32 v112, v112
    v_mfma_f32_16x16x32_bf16 v[96:99], a[140:143], a[204:207], v[96:99]
    buffer_load_dwordx4 v1, s[8:11], s82 offen offset:0  lds
    v_mfma_f32_16x16x32_bf16 v[104:107], a[128:131], a[208:211], v[68:71]
    v_exp_f32 v113, v113
    v_mfma_f32_16x16x32_bf16 v[104:107], a[132:135], a[212:215], v[104:107]
    ds_read_b128 a[168:171], v19 offset:2048
    v_cvt_pk_bf16_f32 v56, v112, v113
    v_mfma_f32_16x16x32_bf16 v[104:107], a[136:139], a[216:219], v[104:107]
    v_exp_f32 v114, v114
    v_mfma_f32_16x16x32_bf16 v[104:107], a[140:143], a[220:223], v[104:107]
    buffer_load_dwordx4 v1, s[8:11], s82 offen offset:1024  lds
    v_mfma_f32_16x16x32_bf16 v[100:103], a[144:147], a[192:195], v[64:67]
    v_exp_f32 v115, v115
    v_mfma_f32_16x16x32_bf16 v[100:103], a[148:151], a[196:199], v[100:103]
    ds_read_b128 a[172:175], v19 offset:3072
    v_cvt_pk_bf16_f32 v57, v114, v115
    v_mfma_f32_16x16x32_bf16 v[100:103], a[152:155], a[200:203], v[100:103]
    v_exp_f32 v116, v116
    v_mfma_f32_16x16x32_bf16 v[100:103], a[156:159], a[204:207], v[100:103]
    buffer_load_dwordx4 v1, s[8:11], s82 offen offset:2048  lds
    v_mfma_f32_16x16x32_bf16 v[108:111], a[144:147], a[208:211], v[68:71]
    v_exp_f32 v117, v117
    v_mfma_f32_16x16x32_bf16 v[108:111], a[148:151], a[212:215], v[108:111]
    ds_read_b128 a[176:179], v20 offset:4096
    v_cvt_pk_bf16_f32 v58, v116, v117
    v_mfma_f32_16x16x32_bf16 v[108:111], a[152:155], a[216:219], v[108:111]
    v_exp_f32 v118, v118
    v_mfma_f32_16x16x32_bf16 v[108:111], a[156:159], a[220:223], v[108:111]
    buffer_load_dwordx4 v1, s[8:11], s82 offen offset:3072  lds
    v_mfma_f32_16x16x32_bf16 v[32:35], v[28:31], v[48:51], v[32:35]
    s_add_u32 m0, s15, 4096
    v_exp_f32 v119, v119
    v_mfma_f32_16x16x32_bf16 v[36:39], v[28:31], v[52:55], v[36:39]
    s_waitcnt lgkmcnt(4)
    ds_read_b128 a[180:183], v20 offset:5120
    v_cvt_pk_bf16_f32 v59, v118, v119
    v_mfma_f32_16x16x32_bf16 v[128:131], a[160:163], v[48:51], v[128:131]
    s_waitcnt lgkmcnt(4)
    v_exp_f32 v120, v120
    v_mfma_f32_16x16x32_bf16 v[160:163], a[160:163], v[52:55], v[160:163]
    buffer_load_dwordx4 v15, s[8:11], s82 offen offset:0  lds
    v_mfma_f32_16x16x32_bf16 v[132:135], a[164:167], v[48:51], v[132:135]
    v_exp_f32 v121, v121
    v_mfma_f32_16x16x32_bf16 v[164:167], a[164:167], v[52:55], v[164:167]
    s_waitcnt lgkmcnt(3)
    ds_read_b128 a[184:187], v20 offset:6144
    v_cvt_pk_bf16_f32 v60, v120, v121
    v_mfma_f32_16x16x32_bf16 v[136:139], a[168:171], v[48:51], v[136:139]
    s_waitcnt lgkmcnt(3)
    v_exp_f32 v122, v122
    v_mfma_f32_16x16x32_bf16 v[168:171], a[168:171], v[52:55], v[168:171]
    buffer_load_dwordx4 v15, s[8:11], s82 offen offset:1024  lds
    v_mfma_f32_16x16x32_bf16 v[140:143], a[172:175], v[48:51], v[140:143]
    v_exp_f32 v123, v123
    v_mfma_f32_16x16x32_bf16 v[172:175], a[172:175], v[52:55], v[172:175]
    s_waitcnt lgkmcnt(2)
    ds_read_b128 a[188:191], v20 offset:7168
    v_cvt_pk_bf16_f32 v61, v122, v123
    v_mfma_f32_16x16x32_bf16 v[144:147], a[176:179], v[48:51], v[144:147]
    s_waitcnt lgkmcnt(2)
    v_exp_f32 v124, v124
    v_mfma_f32_16x16x32_bf16 v[176:179], a[176:179], v[52:55], v[176:179]
    buffer_load_dwordx4 v15, s[8:11], s82 offen offset:2048  lds
    v_mfma_f32_16x16x32_bf16 v[148:151], a[180:183], v[48:51], v[148:151]
    v_exp_f32 v125, v125
    v_mfma_f32_16x16x32_bf16 v[180:183], a[180:183], v[52:55], v[180:183]
    s_waitcnt lgkmcnt(1)
    v_cvt_pk_bf16_f32 v62, v124, v125
    v_mfma_f32_16x16x32_bf16 v[152:155], a[184:187], v[48:51], v[152:155]
    s_waitcnt lgkmcnt(0)
    v_exp_f32 v126, v126
    v_mfma_f32_16x16x32_bf16 v[184:187], a[184:187], v[52:55], v[184:187]
    buffer_load_dwordx4 v15, s[8:11], s82 offen offset:3072  lds
    v_mfma_f32_16x16x32_bf16 v[156:159], a[188:191], v[48:51], v[156:159]
    s_xor_b32 s15, s15, 196608
    v_exp_f32 v127, v127
    v_mfma_f32_16x16x32_bf16 v[188:191], a[188:191], v[52:55], v[188:191]
    s_add_u32 m0, s16, 0
    v_cvt_pk_bf16_f32 v63, v126, v127
    v_mfma_f32_16x16x32_bf16 v[112:115], a[128:131], a[224:227], v[72:75]
    v_mfma_f32_16x16x32_bf16 v[112:115], a[132:135], a[228:231], v[112:115]
    v_mfma_f32_16x16x32_bf16 v[112:115], a[136:139], a[232:235], v[112:115]
    v_exp_f32 v96, v96
    v_mfma_f32_16x16x32_bf16 v[112:115], a[140:143], a[236:239], v[112:115]
    buffer_load_dwordx4 v1, s[8:11], s19 offen offset:0  lds
    v_mfma_f32_16x16x32_bf16 v[120:123], a[128:131], a[240:243], v[76:79]
    v_exp_f32 v97, v97
    v_mfma_f32_16x16x32_bf16 v[120:123], a[132:135], a[244:247], v[120:123]
    ds_read_b128 a[128:131], v18 offset:0
    v_cvt_pk_bf16_f32 v48, v96, v97
    v_mfma_f32_16x16x32_bf16 v[120:123], a[136:139], a[248:251], v[120:123]
    v_exp_f32 v98, v98
    v_mfma_f32_16x16x32_bf16 v[120:123], a[140:143], a[252:255], v[120:123]
    buffer_load_dwordx4 v1, s[8:11], s19 offen offset:1024  lds
    v_mfma_f32_16x16x32_bf16 v[116:119], a[144:147], a[224:227], v[72:75]
    v_exp_f32 v99, v99
    v_mfma_f32_16x16x32_bf16 v[116:119], a[148:151], a[228:231], v[116:119]
    ds_read_b128 a[132:135], v18 offset:1024
    v_cvt_pk_bf16_f32 v49, v98, v99
    v_mfma_f32_16x16x32_bf16 v[116:119], a[152:155], a[232:235], v[116:119]
    v_exp_f32 v100, v100
    v_mfma_f32_16x16x32_bf16 v[116:119], a[156:159], a[236:239], v[116:119]
    buffer_load_dwordx4 v1, s[8:11], s19 offen offset:2048  lds
    v_mfma_f32_16x16x32_bf16 v[124:127], a[144:147], a[240:243], v[76:79]
    v_exp_f32 v101, v101
    v_mfma_f32_16x16x32_bf16 v[124:127], a[148:151], a[244:247], v[124:127]
    ds_read_b128 a[136:139], v18 offset:2048
    v_cvt_pk_bf16_f32 v50, v100, v101
    v_mfma_f32_16x16x32_bf16 v[124:127], a[152:155], a[248:251], v[124:127]
    v_exp_f32 v102, v102
    v_mfma_f32_16x16x32_bf16 v[124:127], a[156:159], a[252:255], v[124:127]
    buffer_load_dwordx4 v1, s[8:11], s19 offen offset:3072  lds
    v_mfma_f32_16x16x32_bf16 v[40:43], v[28:31], v[56:59], v[40:43]
    s_add_u32 m0, s16, 4096
    v_exp_f32 v103, v103
    v_mfma_f32_16x16x32_bf16 v[44:47], v[28:31], v[60:63], v[44:47]
    ds_read_b128 a[140:143], v18 offset:3072
    v_cvt_pk_bf16_f32 v51, v102, v103
    v_mfma_f32_16x16x32_bf16 v[192:195], a[160:163], v[56:59], v[192:195]
    v_exp_f32 v104, v104
    v_mfma_f32_16x16x32_bf16 v[224:227], a[160:163], v[60:63], v[224:227]
    buffer_load_dwordx4 v15, s[8:11], s19 offen offset:0  lds
    v_mfma_f32_16x16x32_bf16 v[196:199], a[164:167], v[56:59], v[196:199]
    v_exp_f32 v105, v105
    v_mfma_f32_16x16x32_bf16 v[228:231], a[164:167], v[60:63], v[228:231]
    ds_read_b128 a[144:147], v18 offset:4096
    v_cvt_pk_bf16_f32 v52, v104, v105
    v_mfma_f32_16x16x32_bf16 v[200:203], a[168:171], v[56:59], v[200:203]
    v_exp_f32 v106, v106
    v_mfma_f32_16x16x32_bf16 v[232:235], a[168:171], v[60:63], v[232:235]
    buffer_load_dwordx4 v15, s[8:11], s19 offen offset:1024  lds
    v_mfma_f32_16x16x32_bf16 v[204:207], a[172:175], v[56:59], v[204:207]
    v_exp_f32 v107, v107
    v_mfma_f32_16x16x32_bf16 v[236:239], a[172:175], v[60:63], v[236:239]
    ds_read_b128 a[148:151], v18 offset:5120
    v_cvt_pk_bf16_f32 v53, v106, v107
    v_mfma_f32_16x16x32_bf16 v[208:211], a[176:179], v[56:59], v[208:211]
    v_exp_f32 v108, v108
    v_mfma_f32_16x16x32_bf16 v[240:243], a[176:179], v[60:63], v[240:243]
    buffer_load_dwordx4 v15, s[8:11], s19 offen offset:2048  lds
    v_mfma_f32_16x16x32_bf16 v[212:215], a[180:183], v[56:59], v[212:215]
    v_exp_f32 v109, v109
    v_mfma_f32_16x16x32_bf16 v[244:247], a[180:183], v[60:63], v[244:247]
    ds_read_b128 a[152:155], v18 offset:6144
    v_cvt_pk_bf16_f32 v54, v108, v109
    v_mfma_f32_16x16x32_bf16 v[216:219], a[184:187], v[56:59], v[216:219]
    v_exp_f32 v110, v110
    v_mfma_f32_16x16x32_bf16 v[248:251], a[184:187], v[60:63], v[248:251]
    buffer_load_dwordx4 v15, s[8:11], s19 offen offset:3072  lds
    v_mfma_f32_16x16x32_bf16 v[220:223], a[188:191], v[56:59], v[220:223]
    s_xor_b32 s16, s16, 98304
    v_exp_f32 v111, v111
    v_mfma_f32_16x16x32_bf16 v[252:255], a[188:191], v[60:63], v[252:255]
    ds_read_b128 a[156:159], v18 offset:7168
    v_cvt_pk_bf16_f32 v55, v110, v111
    s_waitcnt lgkmcnt(7)
    v_mfma_f32_16x16x32_bf16 v[96:99], a[128:131], a[192:195], v[64:67]
    s_waitcnt lgkmcnt(6)
    ds_read_b128 a[160:163], v19 offset:16384
    v_mfma_f32_16x16x32_bf16 v[96:99], a[132:135], a[196:199], v[96:99]
    s_waitcnt lgkmcnt(6)
    ds_read_b128 a[164:167], v19 offset:17408
    v_mfma_f32_16x16x32_bf16 v[96:99], a[136:139], a[200:203], v[96:99]
    s_waitcnt lgkmcnt(6)
    v_exp_f32 v112, v112
    v_mfma_f32_16x16x32_bf16 v[96:99], a[140:143], a[204:207], v[96:99]
    v_mfma_f32_16x16x32_bf16 v[104:107], a[128:131], a[208:211], v[68:71]
    v_exp_f32 v113, v113
    v_mfma_f32_16x16x32_bf16 v[104:107], a[132:135], a[212:215], v[104:107]
    ds_read_b128 a[168:171], v19 offset:18432
    v_cvt_pk_bf16_f32 v56, v112, v113
    v_mfma_f32_16x16x32_bf16 v[104:107], a[136:139], a[216:219], v[104:107]
    v_exp_f32 v114, v114
    v_mfma_f32_16x16x32_bf16 v[104:107], a[140:143], a[220:223], v[104:107]
    s_waitcnt lgkmcnt(6)
    v_mfma_f32_16x16x32_bf16 v[100:103], a[144:147], a[192:195], v[64:67]
    s_waitcnt lgkmcnt(5)
    s_lshl_b32 s64, s2, 6
    v_exp_f32 v115, v115
    v_mfma_f32_16x16x32_bf16 v[100:103], a[148:151], a[196:199], v[100:103]
    s_waitcnt lgkmcnt(4)
    s_add_u32 s64, s64, 1327104
    ds_read_b128 a[172:175], v19 offset:19456
    v_cvt_pk_bf16_f32 v57, v114, v115
    v_mfma_f32_16x16x32_bf16 v[100:103], a[152:155], a[200:203], v[100:103]
    s_waitcnt lgkmcnt(4)
    v_exp_f32 v116, v116
    v_mfma_f32_16x16x32_bf16 v[100:103], a[156:159], a[204:207], v[100:103]
    buffer_store_dword v6, v7, s[8:11], s64 offen sc0 sc1
    v_mfma_f32_16x16x32_bf16 v[108:111], a[144:147], a[208:211], v[68:71]
    s_xor_b32 s74, s24, 8192
    v_exp_f32 v117, v117
    v_mfma_f32_16x16x32_bf16 v[108:111], a[148:151], a[212:215], v[108:111]
    ds_read_b128 a[176:179], v20 offset:20480
    v_cvt_pk_bf16_f32 v58, v116, v117
    v_mfma_f32_16x16x32_bf16 v[108:111], a[152:155], a[216:219], v[108:111]
    v_exp_f32 v118, v118
    v_mfma_f32_16x16x32_bf16 v[108:111], a[156:159], a[220:223], v[108:111]
    buffer_load_dwordx4 a[96:99], v1, s[8:11], s74 offen offset:0
    v_mfma_f32_16x16x32_bf16 v[32:35], v[28:31], v[48:51], v[32:35]
    s_xor_b32 s74, s24, 8192
    v_exp_f32 v119, v119
    v_mfma_f32_16x16x32_bf16 v[36:39], v[28:31], v[52:55], v[36:39]
    s_waitcnt lgkmcnt(4)
    ds_read_b128 a[180:183], v20 offset:21504
    v_cvt_pk_bf16_f32 v59, v118, v119
    v_mfma_f32_16x16x32_bf16 v[128:131], a[160:163], v[48:51], v[128:131]
    s_waitcnt lgkmcnt(4)
    v_exp_f32 v120, v120
    v_mfma_f32_16x16x32_bf16 v[160:163], a[160:163], v[52:55], v[160:163]
    buffer_load_dwordx4 a[100:103], v1, s[8:11], s74 offen offset:1024
    v_mfma_f32_16x16x32_bf16 v[132:135], a[164:167], v[48:51], v[132:135]
    s_xor_b32 s74, s24, 8192
    v_exp_f32 v121, v121
    v_mfma_f32_16x16x32_bf16 v[164:167], a[164:167], v[52:55], v[164:167]
    s_waitcnt lgkmcnt(3)
    ds_read_b128 a[184:187], v20 offset:22528
    v_cvt_pk_bf16_f32 v60, v120, v121
    v_mfma_f32_16x16x32_bf16 v[136:139], a[168:171], v[48:51], v[136:139]
    s_waitcnt lgkmcnt(3)
    v_exp_f32 v122, v122
    v_mfma_f32_16x16x32_bf16 v[168:171], a[168:171], v[52:55], v[168:171]
    buffer_load_dwordx4 a[104:107], v1, s[8:11], s74 offen offset:2048
    v_mfma_f32_16x16x32_bf16 v[140:143], a[172:175], v[48:51], v[140:143]
    s_xor_b32 s74, s24, 8192
    v_exp_f32 v123, v123
    v_mfma_f32_16x16x32_bf16 v[172:175], a[172:175], v[52:55], v[172:175]
    s_waitcnt lgkmcnt(2)
    ds_read_b128 a[188:191], v20 offset:23552
    v_cvt_pk_bf16_f32 v61, v122, v123
    v_mfma_f32_16x16x32_bf16 v[144:147], a[176:179], v[48:51], v[144:147]
    s_waitcnt lgkmcnt(2)
    v_exp_f32 v124, v124
    v_mfma_f32_16x16x32_bf16 v[176:179], a[176:179], v[52:55], v[176:179]
    buffer_load_dwordx4 a[108:111], v1, s[8:11], s74 offen offset:3072
    v_mfma_f32_16x16x32_bf16 v[148:151], a[180:183], v[48:51], v[148:151]
    s_xor_b32 s74, s24, 12288
    v_exp_f32 v125, v125
    v_mfma_f32_16x16x32_bf16 v[180:183], a[180:183], v[52:55], v[180:183]
    s_waitcnt lgkmcnt(1)
    v_cvt_pk_bf16_f32 v62, v124, v125
    v_xor_b32 v19, 98304, v19
    v_mfma_f32_16x16x32_bf16 v[152:155], a[184:187], v[48:51], v[152:155]
    buffer_load_dwordx4 a[112:115], v1, s[8:11], s74 offen offset:0
    v_exp_f32 v126, v126
    v_mfma_f32_16x16x32_bf16 v[184:187], a[184:187], v[52:55], v[184:187]
    s_waitcnt lgkmcnt(0)
    v_xor_b32 v20, 98304, v20
    v_mfma_f32_16x16x32_bf16 v[156:159], a[188:191], v[48:51], v[156:159]
    v_exp_f32 v127, v127
    v_mfma_f32_16x16x32_bf16 v[188:191], a[188:191], v[52:55], v[188:191]
    v_cvt_pk_bf16_f32 v63, v126, v127
    v_mfma_f32_16x16x32_bf16 v[112:115], a[128:131], a[224:227], v[72:75]
    s_add_u32 m0, s62, 36864
    v_exp_f32 v96, v96
    v_mfma_f32_16x16x32_bf16 v[112:115], a[132:135], a[228:231], v[112:115]
    v_add_f32 v86, 0xf3900000, v21
    v_min_f32 v86, v86, v66
    v_mfma_f32_16x16x32_bf16 v[112:115], a[136:139], a[232:235], v[112:115]
    s_xor_b32 s98, s65, 32768
    v_exp_f32 v97, v97
    v_mfma_f32_16x16x32_bf16 v[112:115], a[140:143], a[236:239], v[112:115]
    v_cvt_pk_bf16_f32 v48, v96, v97
    v_add_f32 v87, 0xf3980000, v21
    v_mfma_f32_16x16x32_bf16 v[120:123], a[128:131], a[240:243], v[76:79]
    v_exp_f32 v98, v98
    v_mfma_f32_16x16x32_bf16 v[120:123], a[132:135], a[244:247], v[120:123]
    buffer_load_dwordx4 v8, s[28:31], s98 offen offset:0   lds
    v_mfma_f32_16x16x32_bf16 v[120:123], a[136:139], a[248:251], v[120:123]
    v_exp_f32 v99, v99
    v_mfma_f32_16x16x32_bf16 v[120:123], a[140:143], a[252:255], v[120:123]
    buffer_load_dwordx4 v9, s[28:31], s98 offen offset:1024   lds
    v_mfma_f32_16x16x32_bf16 v[116:119], a[144:147], a[224:227], v[72:75]
    v_exp_f32 v100, v100
    v_mfma_f32_16x16x32_bf16 v[116:119], a[148:151], a[228:231], v[116:119]
    ds_read_b128 a[128:131], v18 offset:16384
    v_cvt_pk_bf16_f32 v49, v98, v99
    v_mfma_f32_16x16x32_bf16 v[116:119], a[152:155], a[232:235], v[116:119]
    s_add_u32 s19, s82, 32768
    v_exp_f32 v101, v101
    v_mfma_f32_16x16x32_bf16 v[116:119], a[156:159], a[236:239], v[116:119]
    s_sub_u32 s82, s12, s13
    ds_read_b128 a[132:135], v18 offset:17408
    v_cvt_pk_bf16_f32 v50, v100, v101
    v_mfma_f32_16x16x32_bf16 v[124:127], a[144:147], a[240:243], v[76:79]
    s_sub_u32 s82, s82, 1
    v_exp_f32 v102, v102
    v_mfma_f32_16x16x32_bf16 v[124:127], a[148:151], a[244:247], v[124:127]
    s_cmp_gt_u32 s12, s13
    s_cselect_b32 s82, s82, s12
    s_mul_i32 s82, s82, 65536
    ds_read_b128 a[136:139], v18 offset:18432
    v_mfma_f32_16x16x32_bf16 v[124:127], a[152:155], a[248:251], v[124:127]
    s_add_u32 s82, s82, s81
    v_exp_f32 v103, v103
    v_mfma_f32_16x16x32_bf16 v[124:127], a[156:159], a[252:255], v[124:127]
    s_cmp_ge_u32 s12, 17
    s_cselect_b32 s82, 2147471360, s82
    ds_read_b128 a[140:143], v18 offset:19456
    v_cvt_pk_bf16_f32 v51, v102, v103
    v_mfma_f32_16x16x32_bf16 v[40:43], v[28:31], v[56:59], v[40:43]
    s_add_u32 s12, s12, 1
    v_exp_f32 v104, v104
    v_mfma_f32_16x16x32_bf16 v[44:47], v[28:31], v[60:63], v[44:47]
    ds_read_b128 a[144:147], v18 offset:20480
    v_min_f32 v87, v87, v67
    v_mfma_f32_16x16x32_bf16 v[192:195], a[160:163], v[56:59], v[192:195]
    v_exp_f32 v105, v105
    v_mfma_f32_16x16x32_bf16 v[224:227], a[160:163], v[60:63], v[224:227]
    ds_read_b128 a[148:151], v18 offset:21504
    v_cvt_pk_bf16_f32 v52, v104, v105
    v_mfma_f32_16x16x32_bf16 v[196:199], a[164:167], v[56:59], v[196:199]
    v_exp_f32 v106, v106
    v_mfma_f32_16x16x32_bf16 v[228:231], a[164:167], v[60:63], v[228:231]
    ds_read_b128 a[152:155], v18 offset:22528
    v_add_f32 v88, 0x73800000, v21
    v_mfma_f32_16x16x32_bf16 v[200:203], a[168:171], v[56:59], v[200:203]
    v_exp_f32 v107, v107
    v_mfma_f32_16x16x32_bf16 v[232:235], a[168:171], v[60:63], v[232:235]
    ds_read_b128 a[156:159], v18 offset:23552
    v_cvt_pk_bf16_f32 v53, v106, v107
    v_mfma_f32_16x16x32_bf16 v[204:207], a[172:175], v[56:59], v[204:207]
    v_exp_f32 v108, v108
    v_mfma_f32_16x16x32_bf16 v[236:239], a[172:175], v[60:63], v[236:239]
    buffer_load_dwordx4 v10, s[28:31], s98 offen offset:2048   lds
    v_mfma_f32_16x16x32_bf16 v[208:211], a[176:179], v[56:59], v[208:211]
    v_exp_f32 v109, v109
    v_mfma_f32_16x16x32_bf16 v[240:243], a[176:179], v[60:63], v[240:243]
    v_cvt_pk_bf16_f32 v54, v108, v109
    v_xor_b32 v18, 196608, v18
    v_mfma_f32_16x16x32_bf16 v[212:215], a[180:183], v[56:59], v[212:215]
    v_exp_f32 v110, v110
    v_mfma_f32_16x16x32_bf16 v[244:247], a[180:183], v[60:63], v[244:247]
    buffer_load_dwordx4 v11, s[28:31], s98 offen offset:3072   lds
    v_mfma_f32_16x16x32_bf16 v[216:219], a[184:187], v[56:59], v[216:219]
    s_xor_b32 s74, s24, 12288
    v_exp_f32 v111, v111
    v_mfma_f32_16x16x32_bf16 v[248:251], a[184:187], v[60:63], v[248:251]
    v_cvt_pk_bf16_f32 v55, v110, v111
    v_min_f32 v88, v88, v68
    v_mfma_f32_16x16x32_bf16 v[220:223], a[188:191], v[56:59], v[220:223]
    buffer_load_dwordx4 a[116:119], v1, s[8:11], s74 offen offset:1024
    v_mfma_f32_16x16x32_bf16 v[252:255], a[188:191], v[60:63], v[252:255]
    s_xor_b32 s74, s24, 12288
    buffer_load_dwordx4 a[120:123], v1, s[8:11], s74 offen offset:2048
    s_xor_b32 s74, s24, 12288
    buffer_load_dwordx4 a[124:127], v1, s[8:11], s74 offen offset:3072
    s_waitcnt vmcnt(13) lgkmcnt(0)
    s_barrier
    v_mfma_f32_16x16x32_bf16 v[96:99], a[128:131], a[192:195], v[64:67]
    s_add_u32 m0, s15, 0
    ds_read_b128 a[160:163], v19 offset:0
    v_mfma_f32_16x16x32_bf16 v[96:99], a[132:135], a[196:199], v[96:99]
    ds_read_b128 a[164:167], v19 offset:1024
    v_mfma_f32_16x16x32_bf16 v[96:99], a[136:139], a[200:203], v[96:99]
    v_exp_f32 v112, v112
    v_mfma_f32_16x16x32_bf16 v[96:99], a[140:143], a[204:207], v[96:99]
    buffer_load_dwordx4 v1, s[8:11], s82 offen offset:0  lds
    v_mfma_f32_16x16x32_bf16 v[104:107], a[128:131], a[208:211], v[68:71]
    v_exp_f32 v113, v113
    v_mfma_f32_16x16x32_bf16 v[104:107], a[132:135], a[212:215], v[104:107]
    ds_read_b128 a[168:171], v19 offset:2048
    v_cvt_pk_bf16_f32 v56, v112, v113
    v_mfma_f32_16x16x32_bf16 v[104:107], a[136:139], a[216:219], v[104:107]
    v_exp_f32 v114, v114
    v_mfma_f32_16x16x32_bf16 v[104:107], a[140:143], a[220:223], v[104:107]
    buffer_load_dwordx4 v1, s[8:11], s82 offen offset:1024  lds
    v_mfma_f32_16x16x32_bf16 v[100:103], a[144:147], a[192:195], v[64:67]
    v_exp_f32 v115, v115
    v_mfma_f32_16x16x32_bf16 v[100:103], a[148:151], a[196:199], v[100:103]
    ds_read_b128 a[172:175], v19 offset:3072
    v_cvt_pk_bf16_f32 v57, v114, v115
    v_mfma_f32_16x16x32_bf16 v[100:103], a[152:155], a[200:203], v[100:103]
    v_exp_f32 v116, v116
    v_mfma_f32_16x16x32_bf16 v[100:103], a[156:159], a[204:207], v[100:103]
    buffer_load_dwordx4 v1, s[8:11], s82 offen offset:2048  lds
    v_mfma_f32_16x16x32_bf16 v[108:111], a[144:147], a[208:211], v[68:71]
    v_exp_f32 v117, v117
    v_mfma_f32_16x16x32_bf16 v[108:111], a[148:151], a[212:215], v[108:111]
    ds_read_b128 a[176:179], v20 offset:4096
    v_cvt_pk_bf16_f32 v58, v116, v117
    v_mfma_f32_16x16x32_bf16 v[108:111], a[152:155], a[216:219], v[108:111]
    v_exp_f32 v118, v118
    v_mfma_f32_16x16x32_bf16 v[108:111], a[156:159], a[220:223], v[108:111]
    buffer_load_dwordx4 v1, s[8:11], s82 offen offset:3072  lds
    v_mfma_f32_16x16x32_bf16 v[32:35], v[28:31], v[48:51], v[32:35]
    s_add_u32 m0, s15, 4096
    v_exp_f32 v119, v119
    v_mfma_f32_16x16x32_bf16 v[36:39], v[28:31], v[52:55], v[36:39]
    s_waitcnt lgkmcnt(4)
    ds_read_b128 a[180:183], v20 offset:5120
    v_cvt_pk_bf16_f32 v59, v118, v119
    v_mfma_f32_16x16x32_bf16 v[128:131], a[160:163], v[48:51], v[128:131]
    s_waitcnt lgkmcnt(4)
    v_exp_f32 v120, v120
    v_mfma_f32_16x16x32_bf16 v[160:163], a[160:163], v[52:55], v[160:163]
    buffer_load_dwordx4 v15, s[8:11], s82 offen offset:0  lds
    v_mfma_f32_16x16x32_bf16 v[132:135], a[164:167], v[48:51], v[132:135]
    v_exp_f32 v121, v121
    v_mfma_f32_16x16x32_bf16 v[164:167], a[164:167], v[52:55], v[164:167]
    s_waitcnt lgkmcnt(3)
    ds_read_b128 a[184:187], v20 offset:6144
    v_cvt_pk_bf16_f32 v60, v120, v121
    v_mfma_f32_16x16x32_bf16 v[136:139], a[168:171], v[48:51], v[136:139]
    s_waitcnt lgkmcnt(3)
    v_exp_f32 v122, v122
    v_mfma_f32_16x16x32_bf16 v[168:171], a[168:171], v[52:55], v[168:171]
    buffer_load_dwordx4 v15, s[8:11], s82 offen offset:1024  lds
    v_mfma_f32_16x16x32_bf16 v[140:143], a[172:175], v[48:51], v[140:143]
    v_exp_f32 v123, v123
    v_mfma_f32_16x16x32_bf16 v[172:175], a[172:175], v[52:55], v[172:175]
    s_waitcnt lgkmcnt(2)
    ds_read_b128 a[188:191], v20 offset:7168
    v_cvt_pk_bf16_f32 v61, v122, v123
    v_mfma_f32_16x16x32_bf16 v[144:147], a[176:179], v[48:51], v[144:147]
    s_waitcnt lgkmcnt(2)
    v_exp_f32 v124, v124
    v_mfma_f32_16x16x32_bf16 v[176:179], a[176:179], v[52:55], v[176:179]
    buffer_load_dwordx4 v15, s[8:11], s82 offen offset:2048  lds
    v_mfma_f32_16x16x32_bf16 v[148:151], a[180:183], v[48:51], v[148:151]
    v_exp_f32 v125, v125
    v_mfma_f32_16x16x32_bf16 v[180:183], a[180:183], v[52:55], v[180:183]
    s_waitcnt lgkmcnt(1)
    v_cvt_pk_bf16_f32 v62, v124, v125
    v_mfma_f32_16x16x32_bf16 v[152:155], a[184:187], v[48:51], v[152:155]
    s_waitcnt lgkmcnt(0)
    v_exp_f32 v126, v126
    v_mfma_f32_16x16x32_bf16 v[184:187], a[184:187], v[52:55], v[184:187]
    buffer_load_dwordx4 v15, s[8:11], s82 offen offset:3072  lds
    v_mfma_f32_16x16x32_bf16 v[156:159], a[188:191], v[48:51], v[156:159]
    s_xor_b32 s15, s15, 196608
    v_exp_f32 v127, v127
    v_mfma_f32_16x16x32_bf16 v[188:191], a[188:191], v[52:55], v[188:191]
    s_add_u32 m0, s16, 0
    v_cvt_pk_bf16_f32 v63, v126, v127
    v_mfma_f32_16x16x32_bf16 v[112:115], a[128:131], a[224:227], v[72:75]
    v_mfma_f32_16x16x32_bf16 v[112:115], a[132:135], a[228:231], v[112:115]
    v_mfma_f32_16x16x32_bf16 v[112:115], a[136:139], a[232:235], v[112:115]
    v_exp_f32 v96, v96
    v_mfma_f32_16x16x32_bf16 v[112:115], a[140:143], a[236:239], v[112:115]
    buffer_load_dwordx4 v1, s[8:11], s19 offen offset:0  lds
    v_mfma_f32_16x16x32_bf16 v[120:123], a[128:131], a[240:243], v[76:79]
    v_exp_f32 v97, v97
    v_mfma_f32_16x16x32_bf16 v[120:123], a[132:135], a[244:247], v[120:123]
    ds_read_b128 a[128:131], v18 offset:0
    v_cvt_pk_bf16_f32 v48, v96, v97
    v_mfma_f32_16x16x32_bf16 v[120:123], a[136:139], a[248:251], v[120:123]
    v_exp_f32 v98, v98
    v_mfma_f32_16x16x32_bf16 v[120:123], a[140:143], a[252:255], v[120:123]
    buffer_load_dwordx4 v1, s[8:11], s19 offen offset:1024  lds
    v_mfma_f32_16x16x32_bf16 v[116:119], a[144:147], a[224:227], v[72:75]
    v_exp_f32 v99, v99
    v_mfma_f32_16x16x32_bf16 v[116:119], a[148:151], a[228:231], v[116:119]
    ds_read_b128 a[132:135], v18 offset:1024
    v_cvt_pk_bf16_f32 v49, v98, v99
    v_mfma_f32_16x16x32_bf16 v[116:119], a[152:155], a[232:235], v[116:119]
    v_exp_f32 v100, v100
    v_mfma_f32_16x16x32_bf16 v[116:119], a[156:159], a[236:239], v[116:119]
    buffer_load_dwordx4 v1, s[8:11], s19 offen offset:2048  lds
    v_mfma_f32_16x16x32_bf16 v[124:127], a[144:147], a[240:243], v[76:79]
    v_exp_f32 v101, v101
    v_mfma_f32_16x16x32_bf16 v[124:127], a[148:151], a[244:247], v[124:127]
    ds_read_b128 a[136:139], v18 offset:2048
    v_cvt_pk_bf16_f32 v50, v100, v101
    v_mfma_f32_16x16x32_bf16 v[124:127], a[152:155], a[248:251], v[124:127]
    v_exp_f32 v102, v102
    v_mfma_f32_16x16x32_bf16 v[124:127], a[156:159], a[252:255], v[124:127]
    buffer_load_dwordx4 v1, s[8:11], s19 offen offset:3072  lds
    v_mfma_f32_16x16x32_bf16 v[40:43], v[28:31], v[56:59], v[40:43]
    s_add_u32 m0, s16, 4096
    v_exp_f32 v103, v103
    v_mfma_f32_16x16x32_bf16 v[44:47], v[28:31], v[60:63], v[44:47]
    ds_read_b128 a[140:143], v18 offset:3072
    v_cvt_pk_bf16_f32 v51, v102, v103
    v_mfma_f32_16x16x32_bf16 v[192:195], a[160:163], v[56:59], v[192:195]
    v_exp_f32 v104, v104
    v_mfma_f32_16x16x32_bf16 v[224:227], a[160:163], v[60:63], v[224:227]
    buffer_load_dwordx4 v15, s[8:11], s19 offen offset:0  lds
    v_mfma_f32_16x16x32_bf16 v[196:199], a[164:167], v[56:59], v[196:199]
    v_exp_f32 v105, v105
    v_mfma_f32_16x16x32_bf16 v[228:231], a[164:167], v[60:63], v[228:231]
    ds_read_b128 a[144:147], v18 offset:4096
    v_cvt_pk_bf16_f32 v52, v104, v105
    v_mfma_f32_16x16x32_bf16 v[200:203], a[168:171], v[56:59], v[200:203]
    v_exp_f32 v106, v106
    v_mfma_f32_16x16x32_bf16 v[232:235], a[168:171], v[60:63], v[232:235]
    buffer_load_dwordx4 v15, s[8:11], s19 offen offset:1024  lds
    v_mfma_f32_16x16x32_bf16 v[204:207], a[172:175], v[56:59], v[204:207]
    v_exp_f32 v107, v107
    v_mfma_f32_16x16x32_bf16 v[236:239], a[172:175], v[60:63], v[236:239]
    ds_read_b128 a[148:151], v18 offset:5120
    v_cvt_pk_bf16_f32 v53, v106, v107
    v_mfma_f32_16x16x32_bf16 v[208:211], a[176:179], v[56:59], v[208:211]
    v_exp_f32 v108, v108
    v_mfma_f32_16x16x32_bf16 v[240:243], a[176:179], v[60:63], v[240:243]
    buffer_load_dwordx4 v15, s[8:11], s19 offen offset:2048  lds
    v_mfma_f32_16x16x32_bf16 v[212:215], a[180:183], v[56:59], v[212:215]
    v_exp_f32 v109, v109
    v_mfma_f32_16x16x32_bf16 v[244:247], a[180:183], v[60:63], v[244:247]
    ds_read_b128 a[152:155], v18 offset:6144
    v_cvt_pk_bf16_f32 v54, v108, v109
    v_mfma_f32_16x16x32_bf16 v[216:219], a[184:187], v[56:59], v[216:219]
    v_exp_f32 v110, v110
    v_mfma_f32_16x16x32_bf16 v[248:251], a[184:187], v[60:63], v[248:251]
    buffer_load_dwordx4 v15, s[8:11], s19 offen offset:3072  lds
    v_mfma_f32_16x16x32_bf16 v[220:223], a[188:191], v[56:59], v[220:223]
    s_xor_b32 s16, s16, 98304
    v_exp_f32 v111, v111
    v_mfma_f32_16x16x32_bf16 v[252:255], a[188:191], v[60:63], v[252:255]
    ds_read_b128 a[156:159], v18 offset:7168
    v_cvt_pk_bf16_f32 v55, v110, v111
    s_waitcnt lgkmcnt(7)
    v_mfma_f32_16x16x32_bf16 v[96:99], a[128:131], a[192:195], v[64:67]
    s_waitcnt lgkmcnt(6)
    ds_read_b128 a[160:163], v19 offset:16384
    v_mfma_f32_16x16x32_bf16 v[96:99], a[132:135], a[196:199], v[96:99]
    s_waitcnt lgkmcnt(6)
    ds_read_b128 a[164:167], v19 offset:17408
    v_mfma_f32_16x16x32_bf16 v[96:99], a[136:139], a[200:203], v[96:99]
    s_waitcnt lgkmcnt(6)
    v_exp_f32 v112, v112
    v_mfma_f32_16x16x32_bf16 v[96:99], a[140:143], a[204:207], v[96:99]
    v_mfma_f32_16x16x32_bf16 v[104:107], a[128:131], a[208:211], v[68:71]
    v_exp_f32 v113, v113
    v_mfma_f32_16x16x32_bf16 v[104:107], a[132:135], a[212:215], v[104:107]
    ds_read_b128 a[168:171], v19 offset:18432
    v_cvt_pk_bf16_f32 v56, v112, v113
    v_mfma_f32_16x16x32_bf16 v[104:107], a[136:139], a[216:219], v[104:107]
    v_exp_f32 v114, v114
    v_mfma_f32_16x16x32_bf16 v[104:107], a[140:143], a[220:223], v[104:107]
    s_waitcnt lgkmcnt(6)
    v_mfma_f32_16x16x32_bf16 v[100:103], a[144:147], a[192:195], v[64:67]
    s_waitcnt lgkmcnt(5)
    s_xor_b32 s74, s24, 16384
    v_exp_f32 v115, v115
    v_mfma_f32_16x16x32_bf16 v[100:103], a[148:151], a[196:199], v[100:103]
    s_waitcnt lgkmcnt(4)
    ds_read_b128 a[172:175], v19 offset:19456
    v_cvt_pk_bf16_f32 v57, v114, v115
    v_mfma_f32_16x16x32_bf16 v[100:103], a[152:155], a[200:203], v[100:103]
    s_waitcnt lgkmcnt(4)
    v_exp_f32 v116, v116
    v_mfma_f32_16x16x32_bf16 v[100:103], a[156:159], a[204:207], v[100:103]
    buffer_load_dwordx4 a[0:3], v1, s[8:11], s74 offen offset:0
    v_mfma_f32_16x16x32_bf16 v[108:111], a[144:147], a[208:211], v[68:71]
    s_xor_b32 s74, s24, 16384
    v_exp_f32 v117, v117
    v_mfma_f32_16x16x32_bf16 v[108:111], a[148:151], a[212:215], v[108:111]
    ds_read_b128 a[176:179], v20 offset:20480
    v_cvt_pk_bf16_f32 v58, v116, v117
    v_mfma_f32_16x16x32_bf16 v[108:111], a[152:155], a[216:219], v[108:111]
    v_exp_f32 v118, v118
    v_mfma_f32_16x16x32_bf16 v[108:111], a[156:159], a[220:223], v[108:111]
    buffer_load_dwordx4 a[4:7], v1, s[8:11], s74 offen offset:1024
    v_mfma_f32_16x16x32_bf16 v[32:35], v[28:31], v[48:51], v[32:35]
    s_xor_b32 s74, s24, 16384
    v_exp_f32 v119, v119
    v_mfma_f32_16x16x32_bf16 v[36:39], v[28:31], v[52:55], v[36:39]
    s_waitcnt lgkmcnt(4)
    ds_read_b128 a[180:183], v20 offset:21504
    v_cvt_pk_bf16_f32 v59, v118, v119
    v_mfma_f32_16x16x32_bf16 v[128:131], a[160:163], v[48:51], v[128:131]
    s_waitcnt lgkmcnt(4)
    v_exp_f32 v120, v120
    v_mfma_f32_16x16x32_bf16 v[160:163], a[160:163], v[52:55], v[160:163]
    buffer_load_dwordx4 a[8:11], v1, s[8:11], s74 offen offset:2048
    v_mfma_f32_16x16x32_bf16 v[132:135], a[164:167], v[48:51], v[132:135]
    s_xor_b32 s74, s24, 16384
    v_exp_f32 v121, v121
    v_mfma_f32_16x16x32_bf16 v[164:167], a[164:167], v[52:55], v[164:167]
    s_waitcnt lgkmcnt(3)
    ds_read_b128 a[184:187], v20 offset:22528
    v_cvt_pk_bf16_f32 v60, v120, v121
    v_mfma_f32_16x16x32_bf16 v[136:139], a[168:171], v[48:51], v[136:139]
    s_waitcnt lgkmcnt(3)
    v_exp_f32 v122, v122
    v_mfma_f32_16x16x32_bf16 v[168:171], a[168:171], v[52:55], v[168:171]
    buffer_load_dwordx4 a[12:15], v1, s[8:11], s74 offen offset:3072
    v_mfma_f32_16x16x32_bf16 v[140:143], a[172:175], v[48:51], v[140:143]
    s_xor_b32 s74, s24, 20480
    v_exp_f32 v123, v123
    v_mfma_f32_16x16x32_bf16 v[172:175], a[172:175], v[52:55], v[172:175]
    s_waitcnt lgkmcnt(2)
    ds_read_b128 a[188:191], v20 offset:23552
    v_cvt_pk_bf16_f32 v61, v122, v123
    v_mfma_f32_16x16x32_bf16 v[144:147], a[176:179], v[48:51], v[144:147]
    s_waitcnt lgkmcnt(2)
    v_exp_f32 v124, v124
    v_mfma_f32_16x16x32_bf16 v[176:179], a[176:179], v[52:55], v[176:179]
    buffer_load_dwordx4 a[16:19], v1, s[8:11], s74 offen offset:0
    v_mfma_f32_16x16x32_bf16 v[148:151], a[180:183], v[48:51], v[148:151]
    s_xor_b32 s74, s24, 20480
    v_exp_f32 v125, v125
    v_mfma_f32_16x16x32_bf16 v[180:183], a[180:183], v[52:55], v[180:183]
    s_waitcnt lgkmcnt(1)
    v_cvt_pk_bf16_f32 v62, v124, v125
    v_xor_b32 v19, 98304, v19
    v_mfma_f32_16x16x32_bf16 v[152:155], a[184:187], v[48:51], v[152:155]
    buffer_load_dwordx4 a[20:23], v1, s[8:11], s74 offen offset:1024
    v_exp_f32 v126, v126
    v_mfma_f32_16x16x32_bf16 v[184:187], a[184:187], v[52:55], v[184:187]
    s_waitcnt lgkmcnt(0)
    v_xor_b32 v20, 98304, v20
    v_mfma_f32_16x16x32_bf16 v[156:159], a[188:191], v[48:51], v[156:159]
    v_exp_f32 v127, v127
    v_mfma_f32_16x16x32_bf16 v[188:191], a[188:191], v[52:55], v[188:191]
    v_cvt_pk_bf16_f32 v63, v126, v127
    v_mfma_f32_16x16x32_bf16 v[112:115], a[128:131], a[224:227], v[72:75]
    s_xor_b32 s74, s24, 20480
    v_exp_f32 v96, v96
    v_mfma_f32_16x16x32_bf16 v[112:115], a[132:135], a[228:231], v[112:115]
    buffer_load_dwordx4 a[24:27], v1, s[8:11], s74 offen offset:2048
    v_mfma_f32_16x16x32_bf16 v[112:115], a[136:139], a[232:235], v[112:115]
    s_xor_b32 s74, s24, 20480
    v_exp_f32 v97, v97
    v_mfma_f32_16x16x32_bf16 v[112:115], a[140:143], a[236:239], v[112:115]
    v_cvt_pk_bf16_f32 v48, v96, v97
    v_add_f32 v89, 0x73700000, v21
    v_mfma_f32_16x16x32_bf16 v[120:123], a[128:131], a[240:243], v[76:79]
    v_exp_f32 v98, v98
    v_mfma_f32_16x16x32_bf16 v[120:123], a[132:135], a[244:247], v[120:123]
    buffer_load_dwordx4 a[28:31], v1, s[8:11], s74 offen offset:3072
    v_mfma_f32_16x16x32_bf16 v[120:123], a[136:139], a[248:251], v[120:123]
    s_xor_b32 s74, s24, 24576
    v_exp_f32 v99, v99
    v_mfma_f32_16x16x32_bf16 v[120:123], a[140:143], a[252:255], v[120:123]
    buffer_load_dwordx4 a[32:35], v1, s[8:11], s74 offen offset:0
    v_mfma_f32_16x16x32_bf16 v[116:119], a[144:147], a[224:227], v[72:75]
    s_xor_b32 s74, s24, 24576
    v_exp_f32 v100, v100
    v_mfma_f32_16x16x32_bf16 v[116:119], a[148:151], a[228:231], v[116:119]
    ds_read_b128 a[128:131], v18 offset:16384
    v_cvt_pk_bf16_f32 v49, v98, v99
    v_mfma_f32_16x16x32_bf16 v[116:119], a[152:155], a[232:235], v[116:119]
    s_add_u32 s19, s82, 32768
    v_exp_f32 v101, v101
    v_mfma_f32_16x16x32_bf16 v[116:119], a[156:159], a[236:239], v[116:119]
    s_sub_u32 s82, s12, s13
    ds_read_b128 a[132:135], v18 offset:17408
    v_cvt_pk_bf16_f32 v50, v100, v101
    v_mfma_f32_16x16x32_bf16 v[124:127], a[144:147], a[240:243], v[76:79]
    s_sub_u32 s82, s82, 1
    v_exp_f32 v102, v102
    v_mfma_f32_16x16x32_bf16 v[124:127], a[148:151], a[244:247], v[124:127]
    s_cmp_gt_u32 s12, s13
    s_cselect_b32 s82, s82, s12
    s_mul_i32 s82, s82, 65536
    ds_read_b128 a[136:139], v18 offset:18432
    v_mfma_f32_16x16x32_bf16 v[124:127], a[152:155], a[248:251], v[124:127]
    s_add_u32 s82, s82, s81
    v_exp_f32 v103, v103
    v_mfma_f32_16x16x32_bf16 v[124:127], a[156:159], a[252:255], v[124:127]
    s_cmp_ge_u32 s12, 17
    s_cselect_b32 s82, 2147471360, s82
    ds_read_b128 a[140:143], v18 offset:19456
    v_cvt_pk_bf16_f32 v51, v102, v103
    v_mfma_f32_16x16x32_bf16 v[40:43], v[28:31], v[56:59], v[40:43]
    s_add_u32 s12, s12, 1
    v_exp_f32 v104, v104
    v_mfma_f32_16x16x32_bf16 v[44:47], v[28:31], v[60:63], v[44:47]
    ds_read_b128 a[144:147], v18 offset:20480
    v_min_f32 v89, v89, v69
    v_mfma_f32_16x16x32_bf16 v[192:195], a[160:163], v[56:59], v[192:195]
    v_exp_f32 v105, v105
    v_mfma_f32_16x16x32_bf16 v[224:227], a[160:163], v[60:63], v[224:227]
    ds_read_b128 a[148:151], v18 offset:21504
    v_cvt_pk_bf16_f32 v52, v104, v105
    v_mfma_f32_16x16x32_bf16 v[196:199], a[164:167], v[56:59], v[196:199]
    v_exp_f32 v106, v106
    v_mfma_f32_16x16x32_bf16 v[228:231], a[164:167], v[60:63], v[228:231]
    ds_read_b128 a[152:155], v18 offset:22528
    v_add_f32 v90, 0x73600000, v21
    v_mfma_f32_16x16x32_bf16 v[200:203], a[168:171], v[56:59], v[200:203]
    v_exp_f32 v107, v107
    v_mfma_f32_16x16x32_bf16 v[232:235], a[168:171], v[60:63], v[232:235]
    ds_read_b128 a[156:159], v18 offset:23552
    v_cvt_pk_bf16_f32 v53, v106, v107
    v_mfma_f32_16x16x32_bf16 v[204:207], a[172:175], v[56:59], v[204:207]
    v_exp_f32 v108, v108
    v_mfma_f32_16x16x32_bf16 v[236:239], a[172:175], v[60:63], v[236:239]
    buffer_load_dwordx4 a[36:39], v1, s[8:11], s74 offen offset:1024
    v_mfma_f32_16x16x32_bf16 v[208:211], a[176:179], v[56:59], v[208:211]
    s_xor_b32 s74, s24, 24576
    v_exp_f32 v109, v109
    v_mfma_f32_16x16x32_bf16 v[240:243], a[176:179], v[60:63], v[240:243]
    v_cvt_pk_bf16_f32 v54, v108, v109
    v_xor_b32 v18, 196608, v18
    v_mfma_f32_16x16x32_bf16 v[212:215], a[180:183], v[56:59], v[212:215]
    v_exp_f32 v110, v110
    v_mfma_f32_16x16x32_bf16 v[244:247], a[180:183], v[60:63], v[244:247]
    buffer_load_dwordx4 a[40:43], v1, s[8:11], s74 offen offset:2048
    v_mfma_f32_16x16x32_bf16 v[216:219], a[184:187], v[56:59], v[216:219]
    s_xor_b32 s74, s24, 24576
    v_exp_f32 v111, v111
    v_mfma_f32_16x16x32_bf16 v[248:251], a[184:187], v[60:63], v[248:251]
    v_cvt_pk_bf16_f32 v55, v110, v111
    v_min_f32 v90, v90, v70
    v_mfma_f32_16x16x32_bf16 v[220:223], a[188:191], v[56:59], v[220:223]
    buffer_load_dwordx4 a[44:47], v1, s[8:11], s74 offen offset:3072
    v_mfma_f32_16x16x32_bf16 v[252:255], a[188:191], v[60:63], v[252:255]
    v_add_f32 v91, 0x73500000, v21
    v_min_f32 v91, v91, v71
    v_add_f32 v92, 0, v21
    v_min_f32 v92, v92, v68
    s_waitcnt vmcnt(12) lgkmcnt(0)
    s_barrier
    v_mfma_f32_16x16x32_bf16 v[96:99], a[128:131], a[192:195], v[64:67]
    s_add_u32 m0, s15, 0
    ds_read_b128 a[160:163], v19 offset:0
    v_mfma_f32_16x16x32_bf16 v[96:99], a[132:135], a[196:199], v[96:99]
    ds_read_b128 a[164:167], v19 offset:1024
    v_mfma_f32_16x16x32_bf16 v[96:99], a[136:139], a[200:203], v[96:99]
    v_exp_f32 v112, v112
    v_mfma_f32_16x16x32_bf16 v[96:99], a[140:143], a[204:207], v[96:99]
    buffer_load_dwordx4 v1, s[8:11], s82 offen offset:0  lds
    v_mfma_f32_16x16x32_bf16 v[104:107], a[128:131], a[208:211], v[68:71]
    v_exp_f32 v113, v113
    v_mfma_f32_16x16x32_bf16 v[104:107], a[132:135], a[212:215], v[104:107]
    ds_read_b128 a[168:171], v19 offset:2048
    v_cvt_pk_bf16_f32 v56, v112, v113
    v_mfma_f32_16x16x32_bf16 v[104:107], a[136:139], a[216:219], v[104:107]
    v_exp_f32 v114, v114
    v_mfma_f32_16x16x32_bf16 v[104:107], a[140:143], a[220:223], v[104:107]
    buffer_load_dwordx4 v1, s[8:11], s82 offen offset:1024  lds
    v_mfma_f32_16x16x32_bf16 v[100:103], a[144:147], a[192:195], v[64:67]
    v_exp_f32 v115, v115
    v_mfma_f32_16x16x32_bf16 v[100:103], a[148:151], a[196:199], v[100:103]
    ds_read_b128 a[172:175], v19 offset:3072
    v_cvt_pk_bf16_f32 v57, v114, v115
    v_mfma_f32_16x16x32_bf16 v[100:103], a[152:155], a[200:203], v[100:103]
    v_exp_f32 v116, v116
    v_mfma_f32_16x16x32_bf16 v[100:103], a[156:159], a[204:207], v[100:103]
    buffer_load_dwordx4 v1, s[8:11], s82 offen offset:2048  lds
    v_mfma_f32_16x16x32_bf16 v[108:111], a[144:147], a[208:211], v[68:71]
    v_exp_f32 v117, v117
    v_mfma_f32_16x16x32_bf16 v[108:111], a[148:151], a[212:215], v[108:111]
    ds_read_b128 a[176:179], v20 offset:4096
    v_cvt_pk_bf16_f32 v58, v116, v117
    v_mfma_f32_16x16x32_bf16 v[108:111], a[152:155], a[216:219], v[108:111]
    v_exp_f32 v118, v118
    v_mfma_f32_16x16x32_bf16 v[108:111], a[156:159], a[220:223], v[108:111]
    buffer_load_dwordx4 v1, s[8:11], s82 offen offset:3072  lds
    v_mfma_f32_16x16x32_bf16 v[32:35], v[28:31], v[48:51], v[32:35]
    s_add_u32 m0, s15, 4096
    v_exp_f32 v119, v119
    v_mfma_f32_16x16x32_bf16 v[36:39], v[28:31], v[52:55], v[36:39]
    s_waitcnt lgkmcnt(4)
    ds_read_b128 a[180:183], v20 offset:5120
    v_cvt_pk_bf16_f32 v59, v118, v119
    v_mfma_f32_16x16x32_bf16 v[128:131], a[160:163], v[48:51], v[128:131]
    s_waitcnt lgkmcnt(4)
    v_exp_f32 v120, v120
    v_mfma_f32_16x16x32_bf16 v[160:163], a[160:163], v[52:55], v[160:163]
    buffer_load_dwordx4 v15, s[8:11], s82 offen offset:0  lds
    v_mfma_f32_16x16x32_bf16 v[132:135], a[164:167], v[48:51], v[132:135]
    v_exp_f32 v121, v121
    v_mfma_f32_16x16x32_bf16 v[164:167], a[164:167], v[52:55], v[164:167]
    s_waitcnt lgkmcnt(3)
    ds_read_b128 a[184:187], v20 offset:6144
    v_cvt_pk_bf16_f32 v60, v120, v121
    v_mfma_f32_16x16x32_bf16 v[136:139], a[168:171], v[48:51], v[136:139]
    s_waitcnt lgkmcnt(3)
    v_exp_f32 v122, v122
    v_mfma_f32_16x16x32_bf16 v[168:171], a[168:171], v[52:55], v[168:171]
    buffer_load_dwordx4 v15, s[8:11], s82 offen offset:1024  lds
    v_mfma_f32_16x16x32_bf16 v[140:143], a[172:175], v[48:51], v[140:143]
    v_exp_f32 v123, v123
    v_mfma_f32_16x16x32_bf16 v[172:175], a[172:175], v[52:55], v[172:175]
    s_waitcnt lgkmcnt(2)
    ds_read_b128 a[188:191], v20 offset:7168
    v_cvt_pk_bf16_f32 v61, v122, v123
    v_mfma_f32_16x16x32_bf16 v[144:147], a[176:179], v[48:51], v[144:147]
    s_waitcnt lgkmcnt(2)
    v_exp_f32 v124, v124
    v_mfma_f32_16x16x32_bf16 v[176:179], a[176:179], v[52:55], v[176:179]
    buffer_load_dwordx4 v15, s[8:11], s82 offen offset:2048  lds
    v_mfma_f32_16x16x32_bf16 v[148:151], a[180:183], v[48:51], v[148:151]
    v_exp_f32 v125, v125
    v_mfma_f32_16x16x32_bf16 v[180:183], a[180:183], v[52:55], v[180:183]
    s_waitcnt lgkmcnt(1)
    v_cvt_pk_bf16_f32 v62, v124, v125
    v_mfma_f32_16x16x32_bf16 v[152:155], a[184:187], v[48:51], v[152:155]
    s_waitcnt lgkmcnt(0)
    v_exp_f32 v126, v126
    v_mfma_f32_16x16x32_bf16 v[184:187], a[184:187], v[52:55], v[184:187]
    buffer_load_dwordx4 v15, s[8:11], s82 offen offset:3072  lds
    v_mfma_f32_16x16x32_bf16 v[156:159], a[188:191], v[48:51], v[156:159]
    s_xor_b32 s15, s15, 196608
    v_exp_f32 v127, v127
    v_mfma_f32_16x16x32_bf16 v[188:191], a[188:191], v[52:55], v[188:191]
    s_add_u32 m0, s16, 0
    v_cvt_pk_bf16_f32 v63, v126, v127
    v_mfma_f32_16x16x32_bf16 v[112:115], a[128:131], a[224:227], v[72:75]
    v_mfma_f32_16x16x32_bf16 v[112:115], a[132:135], a[228:231], v[112:115]
    v_mfma_f32_16x16x32_bf16 v[112:115], a[136:139], a[232:235], v[112:115]
    v_exp_f32 v96, v96
    v_mfma_f32_16x16x32_bf16 v[112:115], a[140:143], a[236:239], v[112:115]
    buffer_load_dwordx4 v1, s[8:11], s19 offen offset:0  lds
    v_mfma_f32_16x16x32_bf16 v[120:123], a[128:131], a[240:243], v[76:79]
    v_exp_f32 v97, v97
    v_mfma_f32_16x16x32_bf16 v[120:123], a[132:135], a[244:247], v[120:123]
    ds_read_b128 a[128:131], v18 offset:0
    v_cvt_pk_bf16_f32 v48, v96, v97
    v_mfma_f32_16x16x32_bf16 v[120:123], a[136:139], a[248:251], v[120:123]
    v_exp_f32 v98, v98
    v_mfma_f32_16x16x32_bf16 v[120:123], a[140:143], a[252:255], v[120:123]
    buffer_load_dwordx4 v1, s[8:11], s19 offen offset:1024  lds
    v_mfma_f32_16x16x32_bf16 v[116:119], a[144:147], a[224:227], v[72:75]
    v_exp_f32 v99, v99
    v_mfma_f32_16x16x32_bf16 v[116:119], a[148:151], a[228:231], v[116:119]
    ds_read_b128 a[132:135], v18 offset:1024
    v_cvt_pk_bf16_f32 v49, v98, v99
    v_mfma_f32_16x16x32_bf16 v[116:119], a[152:155], a[232:235], v[116:119]
    v_exp_f32 v100, v100
    v_mfma_f32_16x16x32_bf16 v[116:119], a[156:159], a[236:239], v[116:119]
    buffer_load_dwordx4 v1, s[8:11], s19 offen offset:2048  lds
    v_mfma_f32_16x16x32_bf16 v[124:127], a[144:147], a[240:243], v[76:79]
    v_exp_f32 v101, v101
    v_mfma_f32_16x16x32_bf16 v[124:127], a[148:151], a[244:247], v[124:127]
    ds_read_b128 a[136:139], v18 offset:2048
    v_cvt_pk_bf16_f32 v50, v100, v101
    v_mfma_f32_16x16x32_bf16 v[124:127], a[152:155], a[248:251], v[124:127]
    v_exp_f32 v102, v102
    v_mfma_f32_16x16x32_bf16 v[124:127], a[156:159], a[252:255], v[124:127]
    buffer_load_dwordx4 v1, s[8:11], s19 offen offset:3072  lds
    v_mfma_f32_16x16x32_bf16 v[40:43], v[28:31], v[56:59], v[40:43]
    s_add_u32 m0, s16, 4096
    v_exp_f32 v103, v103
    v_mfma_f32_16x16x32_bf16 v[44:47], v[28:31], v[60:63], v[44:47]
    ds_read_b128 a[140:143], v18 offset:3072
    v_cvt_pk_bf16_f32 v51, v102, v103
    v_mfma_f32_16x16x32_bf16 v[192:195], a[160:163], v[56:59], v[192:195]
    v_exp_f32 v104, v104
    v_mfma_f32_16x16x32_bf16 v[224:227], a[160:163], v[60:63], v[224:227]
    buffer_load_dwordx4 v15, s[8:11], s19 offen offset:0  lds
    v_mfma_f32_16x16x32_bf16 v[196:199], a[164:167], v[56:59], v[196:199]
    v_exp_f32 v105, v105
    v_mfma_f32_16x16x32_bf16 v[228:231], a[164:167], v[60:63], v[228:231]
    ds_read_b128 a[144:147], v18 offset:4096
    v_cvt_pk_bf16_f32 v52, v104, v105
    v_mfma_f32_16x16x32_bf16 v[200:203], a[168:171], v[56:59], v[200:203]
    v_exp_f32 v106, v106
    v_mfma_f32_16x16x32_bf16 v[232:235], a[168:171], v[60:63], v[232:235]
    buffer_load_dwordx4 v15, s[8:11], s19 offen offset:1024  lds
    v_mfma_f32_16x16x32_bf16 v[204:207], a[172:175], v[56:59], v[204:207]
    v_exp_f32 v107, v107
    v_mfma_f32_16x16x32_bf16 v[236:239], a[172:175], v[60:63], v[236:239]
    ds_read_b128 a[148:151], v18 offset:5120
    v_cvt_pk_bf16_f32 v53, v106, v107
    v_mfma_f32_16x16x32_bf16 v[208:211], a[176:179], v[56:59], v[208:211]
    v_exp_f32 v108, v108
    v_mfma_f32_16x16x32_bf16 v[240:243], a[176:179], v[60:63], v[240:243]
    buffer_load_dwordx4 v15, s[8:11], s19 offen offset:2048  lds
    v_mfma_f32_16x16x32_bf16 v[212:215], a[180:183], v[56:59], v[212:215]
    v_exp_f32 v109, v109
    v_mfma_f32_16x16x32_bf16 v[244:247], a[180:183], v[60:63], v[244:247]
    ds_read_b128 a[152:155], v18 offset:6144
    v_cvt_pk_bf16_f32 v54, v108, v109
    v_mfma_f32_16x16x32_bf16 v[216:219], a[184:187], v[56:59], v[216:219]
    v_exp_f32 v110, v110
    v_mfma_f32_16x16x32_bf16 v[248:251], a[184:187], v[60:63], v[248:251]
    buffer_load_dwordx4 v15, s[8:11], s19 offen offset:3072  lds
    v_mfma_f32_16x16x32_bf16 v[220:223], a[188:191], v[56:59], v[220:223]
    s_xor_b32 s16, s16, 98304
    v_exp_f32 v111, v111
    v_mfma_f32_16x16x32_bf16 v[252:255], a[188:191], v[60:63], v[252:255]
    ds_read_b128 a[156:159], v18 offset:7168
    v_cvt_pk_bf16_f32 v55, v110, v111
    s_waitcnt lgkmcnt(7)
    v_mfma_f32_16x16x32_bf16 v[96:99], a[128:131], a[192:195], v[64:67]
    s_waitcnt lgkmcnt(6)
    ds_read_b128 a[160:163], v19 offset:16384
    v_add_f32 v93, 0xf1800000, v21
    v_mfma_f32_16x16x32_bf16 v[96:99], a[132:135], a[196:199], v[96:99]
    s_waitcnt lgkmcnt(6)
    ds_read_b128 a[164:167], v19 offset:17408
    v_min_f32 v93, v93, v69
    v_mfma_f32_16x16x32_bf16 v[96:99], a[136:139], a[200:203], v[96:99]
    s_waitcnt lgkmcnt(6)
    v_exp_f32 v112, v112
    v_mfma_f32_16x16x32_bf16 v[96:99], a[140:143], a[204:207], v[96:99]
    v_add_f32 v94, 0xf2000000, v21
    v_min_f32 v94, v94, v70
    v_mfma_f32_16x16x32_bf16 v[104:107], a[128:131], a[208:211], v[68:71]
    v_exp_f32 v113, v113
    v_mfma_f32_16x16x32_bf16 v[104:107], a[132:135], a[212:215], v[104:107]
    ds_read_b128 a[168:171], v19 offset:18432
    v_cvt_pk_bf16_f32 v56, v112, v113
    v_mfma_f32_16x16x32_bf16 v[104:107], a[136:139], a[216:219], v[104:107]
    v_exp_f32 v114, v114
    v_mfma_f32_16x16x32_bf16 v[104:107], a[140:143], a[220:223], v[104:107]
    s_waitcnt lgkmcnt(6)
    v_add_f32 v95, 0xf2400000, v21
    v_min_f32 v95, v95, v71
    v_mfma_f32_16x16x32_bf16 v[100:103], a[144:147], a[192:195], v[64:67]
    s_waitcnt lgkmcnt(5)
    s_xor_b32 s74, s24, 28672
    v_exp_f32 v115, v115
    v_mfma_f32_16x16x32_bf16 v[100:103], a[148:151], a[196:199], v[100:103]
    s_waitcnt lgkmcnt(4)
    ds_read_b128 a[172:175], v19 offset:19456
    v_cvt_pk_bf16_f32 v57, v114, v115
    v_mfma_f32_16x16x32_bf16 v[100:103], a[152:155], a[200:203], v[100:103]
    s_waitcnt lgkmcnt(4)
    v_exp_f32 v116, v116
    v_mfma_f32_16x16x32_bf16 v[100:103], a[156:159], a[204:207], v[100:103]
    buffer_load_dwordx4 a[48:51], v1, s[8:11], s74 offen offset:0
    v_mfma_f32_16x16x32_bf16 v[108:111], a[144:147], a[208:211], v[68:71]
    s_xor_b32 s74, s24, 28672
    v_exp_f32 v117, v117
    v_mfma_f32_16x16x32_bf16 v[108:111], a[148:151], a[212:215], v[108:111]
    ds_read_b128 a[176:179], v20 offset:20480
    v_cvt_pk_bf16_f32 v58, v116, v117
    v_mfma_f32_16x16x32_bf16 v[108:111], a[152:155], a[216:219], v[108:111]
    v_exp_f32 v118, v118
    v_mfma_f32_16x16x32_bf16 v[108:111], a[156:159], a[220:223], v[108:111]
    buffer_load_dwordx4 a[52:55], v1, s[8:11], s74 offen offset:1024
    v_mfma_f32_16x16x32_bf16 v[32:35], v[28:31], v[48:51], v[32:35]
    s_xor_b32 s74, s24, 28672
    v_exp_f32 v119, v119
    v_mfma_f32_16x16x32_bf16 v[36:39], v[28:31], v[52:55], v[36:39]
    s_waitcnt lgkmcnt(4)
    ds_read_b128 a[180:183], v20 offset:21504
    v_cvt_pk_bf16_f32 v59, v118, v119
    v_mfma_f32_16x16x32_bf16 v[128:131], a[160:163], v[48:51], v[128:131]
    s_waitcnt lgkmcnt(4)
    v_exp_f32 v120, v120
    v_mfma_f32_16x16x32_bf16 v[160:163], a[160:163], v[52:55], v[160:163]
    buffer_load_dwordx4 a[56:59], v1, s[8:11], s74 offen offset:2048
    v_mfma_f32_16x16x32_bf16 v[132:135], a[164:167], v[48:51], v[132:135]
    s_xor_b32 s74, s24, 28672
    v_exp_f32 v121, v121
    v_mfma_f32_16x16x32_bf16 v[164:167], a[164:167], v[52:55], v[164:167]
    s_waitcnt lgkmcnt(3)
    ds_read_b128 a[184:187], v20 offset:22528
    v_cvt_pk_bf16_f32 v60, v120, v121
    v_mfma_f32_16x16x32_bf16 v[136:139], a[168:171], v[48:51], v[136:139]
    s_waitcnt lgkmcnt(3)
    v_exp_f32 v122, v122
    v_mfma_f32_16x16x32_bf16 v[168:171], a[168:171], v[52:55], v[168:171]
    buffer_load_dwordx4 a[60:63], v1, s[8:11], s74 offen offset:3072
    v_mfma_f32_16x16x32_bf16 v[140:143], a[172:175], v[48:51], v[140:143]
    v_exp_f32 v123, v123
    v_mfma_f32_16x16x32_bf16 v[172:175], a[172:175], v[52:55], v[172:175]
    s_waitcnt lgkmcnt(2)
    ds_read_b128 a[188:191], v20 offset:23552
    v_cvt_pk_bf16_f32 v61, v122, v123
    v_mfma_f32_16x16x32_bf16 v[144:147], a[176:179], v[48:51], v[144:147]
    v_exp_f32 v124, v124
    v_mfma_f32_16x16x32_bf16 v[176:179], a[176:179], v[52:55], v[176:179]
    s_waitcnt lgkmcnt(2)
    v_mfma_f32_16x16x32_bf16 v[148:151], a[180:183], v[48:51], v[148:151]
    v_exp_f32 v125, v125
    v_mfma_f32_16x16x32_bf16 v[180:183], a[180:183], v[52:55], v[180:183]
    s_waitcnt lgkmcnt(1)
    v_cvt_pk_bf16_f32 v62, v124, v125
    v_xor_b32 v19, 98304, v19
    v_mfma_f32_16x16x32_bf16 v[152:155], a[184:187], v[48:51], v[152:155]
    v_exp_f32 v126, v126
    v_mfma_f32_16x16x32_bf16 v[184:187], a[184:187], v[52:55], v[184:187]
    s_waitcnt lgkmcnt(0)
    v_xor_b32 v20, 98304, v20
    v_mfma_f32_16x16x32_bf16 v[156:159], a[188:191], v[48:51], v[156:159]
    v_exp_f32 v127, v127
    v_mfma_f32_16x16x32_bf16 v[188:191], a[188:191], v[52:55], v[188:191]
    v_cvt_pk_bf16_f32 v63, v126, v127
    v_mfma_f32_16x16x32_bf16 v[112:115], a[128:131], a[224:227], v[72:75]
    v_exp_f32 v96, v96
    v_mfma_f32_16x16x32_bf16 v[112:115], a[132:135], a[228:231], v[112:115]
    v_mfma_f32_16x16x32_bf16 v[112:115], a[136:139], a[232:235], v[112:115]
    v_exp_f32 v97, v97
    v_mfma_f32_16x16x32_bf16 v[112:115], a[140:143], a[236:239], v[112:115]
    v_cvt_pk_bf16_f32 v48, v96, v97
    v_mfma_f32_16x16x32_bf16 v[120:123], a[128:131], a[240:243], v[76:79]
    v_exp_f32 v98, v98
    v_mfma_f32_16x16x32_bf16 v[120:123], a[132:135], a[244:247], v[120:123]
    v_mfma_f32_16x16x32_bf16 v[120:123], a[136:139], a[248:251], v[120:123]
    v_exp_f32 v99, v99
    v_mfma_f32_16x16x32_bf16 v[120:123], a[140:143], a[252:255], v[120:123]
    v_mfma_f32_16x16x32_bf16 v[116:119], a[144:147], a[224:227], v[72:75]
    v_exp_f32 v100, v100
    v_mfma_f32_16x16x32_bf16 v[116:119], a[148:151], a[228:231], v[116:119]
    ds_read_b128 a[128:131], v18 offset:16384
    v_cvt_pk_bf16_f32 v49, v98, v99
    v_mfma_f32_16x16x32_bf16 v[116:119], a[152:155], a[232:235], v[116:119]
    s_add_u32 s19, s82, 32768
    v_exp_f32 v101, v101
    v_mfma_f32_16x16x32_bf16 v[116:119], a[156:159], a[236:239], v[116:119]
    s_sub_u32 s82, s12, s13
    ds_read_b128 a[132:135], v18 offset:17408
    v_cvt_pk_bf16_f32 v50, v100, v101
    v_mfma_f32_16x16x32_bf16 v[124:127], a[144:147], a[240:243], v[76:79]
    s_sub_u32 s82, s82, 1
    v_exp_f32 v102, v102
    v_mfma_f32_16x16x32_bf16 v[124:127], a[148:151], a[244:247], v[124:127]
    s_cmp_gt_u32 s12, s13
    s_cselect_b32 s82, s82, s12
    s_mul_i32 s82, s82, 65536
    ds_read_b128 a[136:139], v18 offset:18432
    v_mfma_f32_16x16x32_bf16 v[124:127], a[152:155], a[248:251], v[124:127]
    s_add_u32 s82, s82, s81
    v_exp_f32 v103, v103
    v_mfma_f32_16x16x32_bf16 v[124:127], a[156:159], a[252:255], v[124:127]
    s_cmp_ge_u32 s12, 17
    s_cselect_b32 s82, 2147471360, s82
    ds_read_b128 a[140:143], v18 offset:19456
    v_cvt_pk_bf16_f32 v51, v102, v103
    v_mfma_f32_16x16x32_bf16 v[40:43], v[28:31], v[56:59], v[40:43]
    s_add_u32 s12, s12, 1
    v_exp_f32 v104, v104
    v_mfma_f32_16x16x32_bf16 v[44:47], v[28:31], v[60:63], v[44:47]
    ds_read_b128 a[144:147], v18 offset:20480
    v_mfma_f32_16x16x32_bf16 v[192:195], a[160:163], v[56:59], v[192:195]
    v_exp_f32 v105, v105
    v_mfma_f32_16x16x32_bf16 v[224:227], a[160:163], v[60:63], v[224:227]
    ds_read_b128 a[148:151], v18 offset:21504
    v_cvt_pk_bf16_f32 v52, v104, v105
    v_mfma_f32_16x16x32_bf16 v[196:199], a[164:167], v[56:59], v[196:199]
    v_exp_f32 v106, v106
    v_mfma_f32_16x16x32_bf16 v[228:231], a[164:167], v[60:63], v[228:231]
    ds_read_b128 a[152:155], v18 offset:22528
    v_mfma_f32_16x16x32_bf16 v[200:203], a[168:171], v[56:59], v[200:203]
    v_exp_f32 v107, v107
    v_mfma_f32_16x16x32_bf16 v[232:235], a[168:171], v[60:63], v[232:235]
    ds_read_b128 a[156:159], v18 offset:23552
    v_cvt_pk_bf16_f32 v53, v106, v107
    v_mfma_f32_16x16x32_bf16 v[204:207], a[172:175], v[56:59], v[204:207]
    v_exp_f32 v108, v108
    v_mfma_f32_16x16x32_bf16 v[236:239], a[172:175], v[60:63], v[236:239]
    v_mfma_f32_16x16x32_bf16 v[208:211], a[176:179], v[56:59], v[208:211]
    v_exp_f32 v109, v109
    v_mfma_f32_16x16x32_bf16 v[240:243], a[176:179], v[60:63], v[240:243]
    v_cvt_pk_bf16_f32 v54, v108, v109
    v_xor_b32 v18, 196608, v18
    v_mfma_f32_16x16x32_bf16 v[212:215], a[180:183], v[56:59], v[212:215]
    v_exp_f32 v110, v110
    v_mfma_f32_16x16x32_bf16 v[244:247], a[180:183], v[60:63], v[244:247]
    v_mfma_f32_16x16x32_bf16 v[216:219], a[184:187], v[56:59], v[216:219]
    v_exp_f32 v111, v111
    v_mfma_f32_16x16x32_bf16 v[248:251], a[184:187], v[60:63], v[248:251]
    v_cvt_pk_bf16_f32 v55, v110, v111
    v_mfma_f32_16x16x32_bf16 v[220:223], a[188:191], v[56:59], v[220:223]
    v_mfma_f32_16x16x32_bf16 v[252:255], a[188:191], v[60:63], v[252:255]
    s_waitcnt vmcnt(4) lgkmcnt(0)
    s_barrier
    v_mfma_f32_16x16x32_bf16 v[96:99], a[128:131], a[192:195], v[64:67]
    s_add_u32 m0, s15, 0
    ds_read_b128 a[160:163], v19 offset:0
    v_mfma_f32_16x16x32_bf16 v[96:99], a[132:135], a[196:199], v[96:99]
    ds_read_b128 a[164:167], v19 offset:1024
    v_mfma_f32_16x16x32_bf16 v[96:99], a[136:139], a[200:203], v[96:99]
    v_exp_f32 v112, v112
    v_mfma_f32_16x16x32_bf16 v[96:99], a[140:143], a[204:207], v[96:99]
    buffer_load_dwordx4 v1, s[8:11], s82 offen offset:0  lds
    v_mfma_f32_16x16x32_bf16 v[104:107], a[128:131], a[208:211], v[68:71]
    v_exp_f32 v113, v113
    v_mfma_f32_16x16x32_bf16 v[104:107], a[132:135], a[212:215], v[104:107]
    ds_read_b128 a[168:171], v19 offset:2048
    v_cvt_pk_bf16_f32 v56, v112, v113
    v_mfma_f32_16x16x32_bf16 v[104:107], a[136:139], a[216:219], v[104:107]
    v_exp_f32 v114, v114
    v_mfma_f32_16x16x32_bf16 v[104:107], a[140:143], a[220:223], v[104:107]
    buffer_load_dwordx4 v1, s[8:11], s82 offen offset:1024  lds
    v_mfma_f32_16x16x32_bf16 v[100:103], a[144:147], a[192:195], v[64:67]
    v_exp_f32 v115, v115
    v_mfma_f32_16x16x32_bf16 v[100:103], a[148:151], a[196:199], v[100:103]
    ds_read_b128 a[172:175], v19 offset:3072
    v_cvt_pk_bf16_f32 v57, v114, v115
    v_mfma_f32_16x16x32_bf16 v[100:103], a[152:155], a[200:203], v[100:103]
    v_exp_f32 v116, v116
    v_mfma_f32_16x16x32_bf16 v[100:103], a[156:159], a[204:207], v[100:103]
    buffer_load_dwordx4 v1, s[8:11], s82 offen offset:2048  lds
    v_mfma_f32_16x16x32_bf16 v[108:111], a[144:147], a[208:211], v[68:71]
    v_exp_f32 v117, v117
    v_mfma_f32_16x16x32_bf16 v[108:111], a[148:151], a[212:215], v[108:111]
    ds_read_b128 a[176:179], v20 offset:4096
    v_cvt_pk_bf16_f32 v58, v116, v117
    v_mfma_f32_16x16x32_bf16 v[108:111], a[152:155], a[216:219], v[108:111]
    v_exp_f32 v118, v118
    v_mfma_f32_16x16x32_bf16 v[108:111], a[156:159], a[220:223], v[108:111]
    buffer_load_dwordx4 v1, s[8:11], s82 offen offset:3072  lds
    v_mfma_f32_16x16x32_bf16 v[32:35], v[28:31], v[48:51], v[32:35]
    s_add_u32 m0, s15, 4096
    v_exp_f32 v119, v119
    v_mfma_f32_16x16x32_bf16 v[36:39], v[28:31], v[52:55], v[36:39]
    s_waitcnt lgkmcnt(4)
    ds_read_b128 a[180:183], v20 offset:5120
    v_cvt_pk_bf16_f32 v59, v118, v119
    v_mfma_f32_16x16x32_bf16 v[128:131], a[160:163], v[48:51], v[128:131]
    s_waitcnt lgkmcnt(4)
    v_exp_f32 v120, v120
    v_mfma_f32_16x16x32_bf16 v[160:163], a[160:163], v[52:55], v[160:163]
    buffer_load_dwordx4 v15, s[8:11], s82 offen offset:0  lds
    v_mfma_f32_16x16x32_bf16 v[132:135], a[164:167], v[48:51], v[132:135]
    v_exp_f32 v121, v121
    v_mfma_f32_16x16x32_bf16 v[164:167], a[164:167], v[52:55], v[164:167]
    s_waitcnt lgkmcnt(3)
    ds_read_b128 a[184:187], v20 offset:6144
    v_cvt_pk_bf16_f32 v60, v120, v121
    v_mfma_f32_16x16x32_bf16 v[136:139], a[168:171], v[48:51], v[136:139]
    s_waitcnt lgkmcnt(3)
    v_exp_f32 v122, v122
    v_mfma_f32_16x16x32_bf16 v[168:171], a[168:171], v[52:55], v[168:171]
    buffer_load_dwordx4 v15, s[8:11], s82 offen offset:1024  lds
    v_mfma_f32_16x16x32_bf16 v[140:143], a[172:175], v[48:51], v[140:143]
    v_exp_f32 v123, v123
    v_mfma_f32_16x16x32_bf16 v[172:175], a[172:175], v[52:55], v[172:175]
    s_waitcnt lgkmcnt(2)
    ds_read_b128 a[188:191], v20 offset:7168
    v_cvt_pk_bf16_f32 v61, v122, v123
    v_mfma_f32_16x16x32_bf16 v[144:147], a[176:179], v[48:51], v[144:147]
    s_waitcnt lgkmcnt(2)
    v_exp_f32 v124, v124
    v_mfma_f32_16x16x32_bf16 v[176:179], a[176:179], v[52:55], v[176:179]
    buffer_load_dwordx4 v15, s[8:11], s82 offen offset:2048  lds
    v_mfma_f32_16x16x32_bf16 v[148:151], a[180:183], v[48:51], v[148:151]
    v_exp_f32 v125, v125
    v_mfma_f32_16x16x32_bf16 v[180:183], a[180:183], v[52:55], v[180:183]
    s_waitcnt lgkmcnt(1)
    v_cvt_pk_bf16_f32 v62, v124, v125
    v_mfma_f32_16x16x32_bf16 v[152:155], a[184:187], v[48:51], v[152:155]
    s_waitcnt lgkmcnt(0)
    v_exp_f32 v126, v126
    v_mfma_f32_16x16x32_bf16 v[184:187], a[184:187], v[52:55], v[184:187]
    buffer_load_dwordx4 v15, s[8:11], s82 offen offset:3072  lds
    v_mfma_f32_16x16x32_bf16 v[156:159], a[188:191], v[48:51], v[156:159]
    s_xor_b32 s15, s15, 196608
    v_exp_f32 v127, v127
    v_mfma_f32_16x16x32_bf16 v[188:191], a[188:191], v[52:55], v[188:191]
    s_add_u32 m0, s16, 0
    v_cvt_pk_bf16_f32 v63, v126, v127
    v_mfma_f32_16x16x32_bf16 v[112:115], a[128:131], a[224:227], v[72:75]
    v_mfma_f32_16x16x32_bf16 v[112:115], a[132:135], a[228:231], v[112:115]
    v_mfma_f32_16x16x32_bf16 v[112:115], a[136:139], a[232:235], v[112:115]
    v_exp_f32 v96, v96
    v_mfma_f32_16x16x32_bf16 v[112:115], a[140:143], a[236:239], v[112:115]
    buffer_load_dwordx4 v1, s[8:11], s19 offen offset:0  lds
    v_mfma_f32_16x16x32_bf16 v[120:123], a[128:131], a[240:243], v[76:79]
    v_exp_f32 v97, v97
    v_mfma_f32_16x16x32_bf16 v[120:123], a[132:135], a[244:247], v[120:123]
    ds_read_b128 a[128:131], v18 offset:0
    v_cvt_pk_bf16_f32 v48, v96, v97
    v_mfma_f32_16x16x32_bf16 v[120:123], a[136:139], a[248:251], v[120:123]
    v_exp_f32 v98, v98
    v_mfma_f32_16x16x32_bf16 v[120:123], a[140:143], a[252:255], v[120:123]
    buffer_load_dwordx4 v1, s[8:11], s19 offen offset:1024  lds
    v_mfma_f32_16x16x32_bf16 v[116:119], a[144:147], a[224:227], v[72:75]
    v_exp_f32 v99, v99
    v_mfma_f32_16x16x32_bf16 v[116:119], a[148:151], a[228:231], v[116:119]
    ds_read_b128 a[132:135], v18 offset:1024
    v_cvt_pk_bf16_f32 v49, v98, v99
    v_mfma_f32_16x16x32_bf16 v[116:119], a[152:155], a[232:235], v[116:119]
    v_exp_f32 v100, v100
    v_mfma_f32_16x16x32_bf16 v[116:119], a[156:159], a[236:239], v[116:119]
    buffer_load_dwordx4 v1, s[8:11], s19 offen offset:2048  lds
    v_mfma_f32_16x16x32_bf16 v[124:127], a[144:147], a[240:243], v[76:79]
    v_exp_f32 v101, v101
    v_mfma_f32_16x16x32_bf16 v[124:127], a[148:151], a[244:247], v[124:127]
    ds_read_b128 a[136:139], v18 offset:2048
    v_cvt_pk_bf16_f32 v50, v100, v101
    v_mfma_f32_16x16x32_bf16 v[124:127], a[152:155], a[248:251], v[124:127]
    v_exp_f32 v102, v102
    v_mfma_f32_16x16x32_bf16 v[124:127], a[156:159], a[252:255], v[124:127]
    buffer_load_dwordx4 v1, s[8:11], s19 offen offset:3072  lds
    v_mfma_f32_16x16x32_bf16 v[40:43], v[28:31], v[56:59], v[40:43]
    s_add_u32 m0, s16, 4096
    v_exp_f32 v103, v103
    v_mfma_f32_16x16x32_bf16 v[44:47], v[28:31], v[60:63], v[44:47]
    ds_read_b128 a[140:143], v18 offset:3072
    v_cvt_pk_bf16_f32 v51, v102, v103
    v_mfma_f32_16x16x32_bf16 v[192:195], a[160:163], v[56:59], v[192:195]
    v_exp_f32 v104, v104
    v_mfma_f32_16x16x32_bf16 v[224:227], a[160:163], v[60:63], v[224:227]
    buffer_load_dwordx4 v15, s[8:11], s19 offen offset:0  lds
    v_mfma_f32_16x16x32_bf16 v[196:199], a[164:167], v[56:59], v[196:199]
    v_exp_f32 v105, v105
    v_mfma_f32_16x16x32_bf16 v[228:231], a[164:167], v[60:63], v[228:231]
    ds_read_b128 a[144:147], v18 offset:4096
    v_cvt_pk_bf16_f32 v52, v104, v105
    v_mfma_f32_16x16x32_bf16 v[200:203], a[168:171], v[56:59], v[200:203]
    v_exp_f32 v106, v106
    v_mfma_f32_16x16x32_bf16 v[232:235], a[168:171], v[60:63], v[232:235]
    buffer_load_dwordx4 v15, s[8:11], s19 offen offset:1024  lds
    v_mfma_f32_16x16x32_bf16 v[204:207], a[172:175], v[56:59], v[204:207]
    v_exp_f32 v107, v107
    v_mfma_f32_16x16x32_bf16 v[236:239], a[172:175], v[60:63], v[236:239]
    ds_read_b128 a[148:151], v18 offset:5120
    v_cvt_pk_bf16_f32 v53, v106, v107
    v_mfma_f32_16x16x32_bf16 v[208:211], a[176:179], v[56:59], v[208:211]
    v_exp_f32 v108, v108
    v_mfma_f32_16x16x32_bf16 v[240:243], a[176:179], v[60:63], v[240:243]
    buffer_load_dwordx4 v15, s[8:11], s19 offen offset:2048  lds
    v_mfma_f32_16x16x32_bf16 v[212:215], a[180:183], v[56:59], v[212:215]
    v_exp_f32 v109, v109
    v_mfma_f32_16x16x32_bf16 v[244:247], a[180:183], v[60:63], v[244:247]
    ds_read_b128 a[152:155], v18 offset:6144
    v_cvt_pk_bf16_f32 v54, v108, v109
    v_mfma_f32_16x16x32_bf16 v[216:219], a[184:187], v[56:59], v[216:219]
    v_exp_f32 v110, v110
    v_mfma_f32_16x16x32_bf16 v[248:251], a[184:187], v[60:63], v[248:251]
    buffer_load_dwordx4 v15, s[8:11], s19 offen offset:3072  lds
    v_mfma_f32_16x16x32_bf16 v[220:223], a[188:191], v[56:59], v[220:223]
    s_xor_b32 s16, s16, 98304
    v_exp_f32 v111, v111
    v_mfma_f32_16x16x32_bf16 v[252:255], a[188:191], v[60:63], v[252:255]
    ds_read_b128 a[156:159], v18 offset:7168
    v_cvt_pk_bf16_f32 v55, v110, v111
    s_cmp_eq_u32 s14, 0
    s_cbranch_scc1 L_t2_diag
.p2align 3
L_t2_loop:
    s_waitcnt lgkmcnt(7)
    v_mfma_f32_16x16x32_bf16 v[96:99], a[128:131], a[192:195], v[64:67]
    s_waitcnt lgkmcnt(6)
    ds_read_b128 a[160:163], v19 offset:16384
    v_mfma_f32_16x16x32_bf16 v[96:99], a[132:135], a[196:199], v[96:99]
    s_waitcnt lgkmcnt(6)
    ds_read_b128 a[164:167], v19 offset:17408
    v_mfma_f32_16x16x32_bf16 v[96:99], a[136:139], a[200:203], v[96:99]
    s_waitcnt lgkmcnt(6)
    v_exp_f32 v112, v112
    v_mfma_f32_16x16x32_bf16 v[96:99], a[140:143], a[204:207], v[96:99]
    v_mfma_f32_16x16x32_bf16 v[104:107], a[128:131], a[208:211], v[68:71]
    v_exp_f32 v113, v113
    v_mfma_f32_16x16x32_bf16 v[104:107], a[132:135], a[212:215], v[104:107]
    ds_read_b128 a[168:171], v19 offset:18432
    v_cvt_pk_bf16_f32 v56, v112, v113
    v_mfma_f32_16x16x32_bf16 v[104:107], a[136:139], a[216:219], v[104:107]
    v_exp_f32 v114, v114
    v_mfma_f32_16x16x32_bf16 v[104:107], a[140:143], a[220:223], v[104:107]
    s_waitcnt lgkmcnt(6)
    v_mfma_f32_16x16x32_bf16 v[100:103], a[144:147], a[192:195], v[64:67]
    s_waitcnt lgkmcnt(5)
    v_exp_f32 v115, v115
    v_mfma_f32_16x16x32_bf16 v[100:103], a[148:151], a[196:199], v[100:103]
    s_waitcnt lgkmcnt(4)
    ds_read_b128 a[172:175], v19 offset:19456
    v_cvt_pk_bf16_f32 v57, v114, v115
    v_mfma_f32_16x16x32_bf16 v[100:103], a[152:155], a[200:203], v[100:103]
    s_waitcnt lgkmcnt(4)
    v_exp_f32 v116, v116
    v_mfma_f32_16x16x32_bf16 v[100:103], a[156:159], a[204:207], v[100:103]
    v_mfma_f32_16x16x32_bf16 v[108:111], a[144:147], a[208:211], v[68:71]
    v_exp_f32 v117, v117
    v_mfma_f32_16x16x32_bf16 v[108:111], a[148:151], a[212:215], v[108:111]
    ds_read_b128 a[176:179], v20 offset:20480
    v_cvt_pk_bf16_f32 v58, v116, v117
    v_mfma_f32_16x16x32_bf16 v[108:111], a[152:155], a[216:219], v[108:111]
    v_exp_f32 v118, v118
    v_mfma_f32_16x16x32_bf16 v[108:111], a[156:159], a[220:223], v[108:111]
    v_mfma_f32_16x16x32_bf16 v[32:35], v[28:31], v[48:51], v[32:35]
    v_exp_f32 v119, v119
    v_mfma_f32_16x16x32_bf16 v[36:39], v[28:31], v[52:55], v[36:39]
    s_waitcnt lgkmcnt(4)
    ds_read_b128 a[180:183], v20 offset:21504
    v_cvt_pk_bf16_f32 v59, v118, v119
    v_mfma_f32_16x16x32_bf16 v[128:131], a[160:163], v[48:51], v[128:131]
    v_exp_f32 v120, v120
    v_mfma_f32_16x16x32_bf16 v[160:163], a[160:163], v[52:55], v[160:163]
    s_waitcnt lgkmcnt(4)
    v_mfma_f32_16x16x32_bf16 v[132:135], a[164:167], v[48:51], v[132:135]
    v_exp_f32 v121, v121
    v_mfma_f32_16x16x32_bf16 v[164:167], a[164:167], v[52:55], v[164:167]
    s_waitcnt lgkmcnt(3)
    ds_read_b128 a[184:187], v20 offset:22528
    v_cvt_pk_bf16_f32 v60, v120, v121
    v_mfma_f32_16x16x32_bf16 v[136:139], a[168:171], v[48:51], v[136:139]
    v_exp_f32 v122, v122
    v_mfma_f32_16x16x32_bf16 v[168:171], a[168:171], v[52:55], v[168:171]
    s_waitcnt lgkmcnt(3)
    v_mfma_f32_16x16x32_bf16 v[140:143], a[172:175], v[48:51], v[140:143]
    v_exp_f32 v123, v123
    v_mfma_f32_16x16x32_bf16 v[172:175], a[172:175], v[52:55], v[172:175]
    s_waitcnt lgkmcnt(2)
    ds_read_b128 a[188:191], v20 offset:23552
    v_cvt_pk_bf16_f32 v61, v122, v123
    v_mfma_f32_16x16x32_bf16 v[144:147], a[176:179], v[48:51], v[144:147]
    v_exp_f32 v124, v124
    v_mfma_f32_16x16x32_bf16 v[176:179], a[176:179], v[52:55], v[176:179]
    s_waitcnt lgkmcnt(2)
    v_mfma_f32_16x16x32_bf16 v[148:151], a[180:183], v[48:51], v[148:151]
    v_exp_f32 v125, v125
    v_mfma_f32_16x16x32_bf16 v[180:183], a[180:183], v[52:55], v[180:183]
    s_waitcnt lgkmcnt(1)
    v_cvt_pk_bf16_f32 v62, v124, v125
    v_xor_b32 v19, 98304, v19
    v_mfma_f32_16x16x32_bf16 v[152:155], a[184:187], v[48:51], v[152:155]
    v_exp_f32 v126, v126
    v_mfma_f32_16x16x32_bf16 v[184:187], a[184:187], v[52:55], v[184:187]
    s_waitcnt lgkmcnt(0)
    v_xor_b32 v20, 98304, v20
    v_mfma_f32_16x16x32_bf16 v[156:159], a[188:191], v[48:51], v[156:159]
    v_exp_f32 v127, v127
    v_mfma_f32_16x16x32_bf16 v[188:191], a[188:191], v[52:55], v[188:191]
    v_cvt_pk_bf16_f32 v63, v126, v127
    v_mfma_f32_16x16x32_bf16 v[112:115], a[128:131], a[224:227], v[72:75]
    v_exp_f32 v96, v96
    v_mfma_f32_16x16x32_bf16 v[112:115], a[132:135], a[228:231], v[112:115]
    v_mfma_f32_16x16x32_bf16 v[112:115], a[136:139], a[232:235], v[112:115]
    v_exp_f32 v97, v97
    v_mfma_f32_16x16x32_bf16 v[112:115], a[140:143], a[236:239], v[112:115]
    v_cvt_pk_bf16_f32 v48, v96, v97
    v_mfma_f32_16x16x32_bf16 v[120:123], a[128:131], a[240:243], v[76:79]
    v_exp_f32 v98, v98
    v_mfma_f32_16x16x32_bf16 v[120:123], a[132:135], a[244:247], v[120:123]
    v_mfma_f32_16x16x32_bf16 v[120:123], a[136:139], a[248:251], v[120:123]
    v_exp_f32 v99, v99
    v_mfma_f32_16x16x32_bf16 v[120:123], a[140:143], a[252:255], v[120:123]
    v_mfma_f32_16x16x32_bf16 v[116:119], a[144:147], a[224:227], v[72:75]
    v_exp_f32 v100, v100
    v_mfma_f32_16x16x32_bf16 v[116:119], a[148:151], a[228:231], v[116:119]
    ds_read_b128 a[128:131], v18 offset:16384
    v_cvt_pk_bf16_f32 v49, v98, v99
    v_mfma_f32_16x16x32_bf16 v[116:119], a[152:155], a[232:235], v[116:119]
    s_add_u32 s19, s82, 32768
    v_exp_f32 v101, v101
    v_mfma_f32_16x16x32_bf16 v[116:119], a[156:159], a[236:239], v[116:119]
    s_sub_u32 s82, s12, s13
    ds_read_b128 a[132:135], v18 offset:17408
    v_cvt_pk_bf16_f32 v50, v100, v101
    v_mfma_f32_16x16x32_bf16 v[124:127], a[144:147], a[240:243], v[76:79]
    s_sub_u32 s82, s82, 1
    v_exp_f32 v102, v102
    v_mfma_f32_16x16x32_bf16 v[124:127], a[148:151], a[244:247], v[124:127]
    s_cmp_gt_u32 s12, s13
    s_cselect_b32 s82, s82, s12
    s_mul_i32 s82, s82, 65536
    ds_read_b128 a[136:139], v18 offset:18432
    v_mfma_f32_16x16x32_bf16 v[124:127], a[152:155], a[248:251], v[124:127]
    s_add_u32 s82, s82, s81
    v_exp_f32 v103, v103
    v_mfma_f32_16x16x32_bf16 v[124:127], a[156:159], a[252:255], v[124:127]
    s_cmp_ge_u32 s12, 17
    s_cselect_b32 s82, 2147471360, s82
    ds_read_b128 a[140:143], v18 offset:19456
    v_cvt_pk_bf16_f32 v51, v102, v103
    v_mfma_f32_16x16x32_bf16 v[40:43], v[28:31], v[56:59], v[40:43]
    s_add_u32 s12, s12, 1
    v_exp_f32 v104, v104
    v_mfma_f32_16x16x32_bf16 v[44:47], v[28:31], v[60:63], v[44:47]
    ds_read_b128 a[144:147], v18 offset:20480
    v_mfma_f32_16x16x32_bf16 v[192:195], a[160:163], v[56:59], v[192:195]
    v_exp_f32 v105, v105
    v_mfma_f32_16x16x32_bf16 v[224:227], a[160:163], v[60:63], v[224:227]
    ds_read_b128 a[148:151], v18 offset:21504
    v_cvt_pk_bf16_f32 v52, v104, v105
    v_mfma_f32_16x16x32_bf16 v[196:199], a[164:167], v[56:59], v[196:199]
    v_exp_f32 v106, v106
    v_mfma_f32_16x16x32_bf16 v[228:231], a[164:167], v[60:63], v[228:231]
    ds_read_b128 a[152:155], v18 offset:22528
    v_mfma_f32_16x16x32_bf16 v[200:203], a[168:171], v[56:59], v[200:203]
    v_exp_f32 v107, v107
    v_mfma_f32_16x16x32_bf16 v[232:235], a[168:171], v[60:63], v[232:235]
    ds_read_b128 a[156:159], v18 offset:23552
    v_cvt_pk_bf16_f32 v53, v106, v107
    v_mfma_f32_16x16x32_bf16 v[204:207], a[172:175], v[56:59], v[204:207]
    v_exp_f32 v108, v108
    v_mfma_f32_16x16x32_bf16 v[236:239], a[172:175], v[60:63], v[236:239]
    v_mfma_f32_16x16x32_bf16 v[208:211], a[176:179], v[56:59], v[208:211]
    v_exp_f32 v109, v109
    v_mfma_f32_16x16x32_bf16 v[240:243], a[176:179], v[60:63], v[240:243]
    v_cvt_pk_bf16_f32 v54, v108, v109
    v_xor_b32 v18, 196608, v18
    v_mfma_f32_16x16x32_bf16 v[212:215], a[180:183], v[56:59], v[212:215]
    v_exp_f32 v110, v110
    v_mfma_f32_16x16x32_bf16 v[244:247], a[180:183], v[60:63], v[244:247]
    v_mfma_f32_16x16x32_bf16 v[216:219], a[184:187], v[56:59], v[216:219]
    v_exp_f32 v111, v111
    v_mfma_f32_16x16x32_bf16 v[248:251], a[184:187], v[60:63], v[248:251]
    v_cvt_pk_bf16_f32 v55, v110, v111
    v_mfma_f32_16x16x32_bf16 v[220:223], a[188:191], v[56:59], v[220:223]
    v_mfma_f32_16x16x32_bf16 v[252:255], a[188:191], v[60:63], v[252:255]
    s_waitcnt vmcnt(0) lgkmcnt(0)
    s_barrier
    v_mfma_f32_16x16x32_bf16 v[96:99], a[128:131], a[192:195], v[64:67]
    s_add_u32 m0, s15, 0
    ds_read_b128 a[160:163], v19 offset:0
    v_mfma_f32_16x16x32_bf16 v[96:99], a[132:135], a[196:199], v[96:99]
    ds_read_b128 a[164:167], v19 offset:1024
    v_mfma_f32_16x16x32_bf16 v[96:99], a[136:139], a[200:203], v[96:99]
    v_exp_f32 v112, v112
    v_mfma_f32_16x16x32_bf16 v[96:99], a[140:143], a[204:207], v[96:99]
    buffer_load_dwordx4 v1, s[8:11], s82 offen offset:0  lds
    v_mfma_f32_16x16x32_bf16 v[104:107], a[128:131], a[208:211], v[68:71]
    v_exp_f32 v113, v113
    v_mfma_f32_16x16x32_bf16 v[104:107], a[132:135], a[212:215], v[104:107]
    ds_read_b128 a[168:171], v19 offset:2048
    v_cvt_pk_bf16_f32 v56, v112, v113
    v_mfma_f32_16x16x32_bf16 v[104:107], a[136:139], a[216:219], v[104:107]
    v_exp_f32 v114, v114
    v_mfma_f32_16x16x32_bf16 v[104:107], a[140:143], a[220:223], v[104:107]
    buffer_load_dwordx4 v1, s[8:11], s82 offen offset:1024  lds
    v_mfma_f32_16x16x32_bf16 v[100:103], a[144:147], a[192:195], v[64:67]
    v_exp_f32 v115, v115
    v_mfma_f32_16x16x32_bf16 v[100:103], a[148:151], a[196:199], v[100:103]
    ds_read_b128 a[172:175], v19 offset:3072
    v_cvt_pk_bf16_f32 v57, v114, v115
    v_mfma_f32_16x16x32_bf16 v[100:103], a[152:155], a[200:203], v[100:103]
    v_exp_f32 v116, v116
    v_mfma_f32_16x16x32_bf16 v[100:103], a[156:159], a[204:207], v[100:103]
    buffer_load_dwordx4 v1, s[8:11], s82 offen offset:2048  lds
    v_mfma_f32_16x16x32_bf16 v[108:111], a[144:147], a[208:211], v[68:71]
    v_exp_f32 v117, v117
    v_mfma_f32_16x16x32_bf16 v[108:111], a[148:151], a[212:215], v[108:111]
    ds_read_b128 a[176:179], v20 offset:4096
    v_cvt_pk_bf16_f32 v58, v116, v117
    v_mfma_f32_16x16x32_bf16 v[108:111], a[152:155], a[216:219], v[108:111]
    v_exp_f32 v118, v118
    v_mfma_f32_16x16x32_bf16 v[108:111], a[156:159], a[220:223], v[108:111]
    buffer_load_dwordx4 v1, s[8:11], s82 offen offset:3072  lds
    v_mfma_f32_16x16x32_bf16 v[32:35], v[28:31], v[48:51], v[32:35]
    s_add_u32 m0, s15, 4096
    v_exp_f32 v119, v119
    v_mfma_f32_16x16x32_bf16 v[36:39], v[28:31], v[52:55], v[36:39]
    s_waitcnt lgkmcnt(4)
    ds_read_b128 a[180:183], v20 offset:5120
    v_cvt_pk_bf16_f32 v59, v118, v119
    v_mfma_f32_16x16x32_bf16 v[128:131], a[160:163], v[48:51], v[128:131]
    s_waitcnt lgkmcnt(4)
    v_exp_f32 v120, v120
    v_mfma_f32_16x16x32_bf16 v[160:163], a[160:163], v[52:55], v[160:163]
    buffer_load_dwordx4 v15, s[8:11], s82 offen offset:0  lds
    v_mfma_f32_16x16x32_bf16 v[132:135], a[164:167], v[48:51], v[132:135]
    v_exp_f32 v121, v121
    v_mfma_f32_16x16x32_bf16 v[164:167], a[164:167], v[52:55], v[164:167]
    s_waitcnt lgkmcnt(3)
    ds_read_b128 a[184:187], v20 offset:6144
    v_cvt_pk_bf16_f32 v60, v120, v121
    v_mfma_f32_16x16x32_bf16 v[136:139], a[168:171], v[48:51], v[136:139]
    s_waitcnt lgkmcnt(3)
    v_exp_f32 v122, v122
    v_mfma_f32_16x16x32_bf16 v[168:171], a[168:171], v[52:55], v[168:171]
    buffer_load_dwordx4 v15, s[8:11], s82 offen offset:1024  lds
    v_mfma_f32_16x16x32_bf16 v[140:143], a[172:175], v[48:51], v[140:143]
    v_exp_f32 v123, v123
    v_mfma_f32_16x16x32_bf16 v[172:175], a[172:175], v[52:55], v[172:175]
    s_waitcnt lgkmcnt(2)
    ds_read_b128 a[188:191], v20 offset:7168
    v_cvt_pk_bf16_f32 v61, v122, v123
    v_mfma_f32_16x16x32_bf16 v[144:147], a[176:179], v[48:51], v[144:147]
    s_waitcnt lgkmcnt(2)
    v_exp_f32 v124, v124
    v_mfma_f32_16x16x32_bf16 v[176:179], a[176:179], v[52:55], v[176:179]
    buffer_load_dwordx4 v15, s[8:11], s82 offen offset:2048  lds
    v_mfma_f32_16x16x32_bf16 v[148:151], a[180:183], v[48:51], v[148:151]
    v_exp_f32 v125, v125
    v_mfma_f32_16x16x32_bf16 v[180:183], a[180:183], v[52:55], v[180:183]
    s_waitcnt lgkmcnt(1)
    v_cvt_pk_bf16_f32 v62, v124, v125
    v_mfma_f32_16x16x32_bf16 v[152:155], a[184:187], v[48:51], v[152:155]
    s_waitcnt lgkmcnt(0)
    v_exp_f32 v126, v126
    v_mfma_f32_16x16x32_bf16 v[184:187], a[184:187], v[52:55], v[184:187]
    buffer_load_dwordx4 v15, s[8:11], s82 offen offset:3072  lds
    v_mfma_f32_16x16x32_bf16 v[156:159], a[188:191], v[48:51], v[156:159]
    s_xor_b32 s15, s15, 196608
    v_exp_f32 v127, v127
    v_mfma_f32_16x16x32_bf16 v[188:191], a[188:191], v[52:55], v[188:191]
    s_add_u32 m0, s16, 0
    v_cvt_pk_bf16_f32 v63, v126, v127
    v_mfma_f32_16x16x32_bf16 v[112:115], a[128:131], a[224:227], v[72:75]
    v_mfma_f32_16x16x32_bf16 v[112:115], a[132:135], a[228:231], v[112:115]
    v_mfma_f32_16x16x32_bf16 v[112:115], a[136:139], a[232:235], v[112:115]
    v_exp_f32 v96, v96
    v_mfma_f32_16x16x32_bf16 v[112:115], a[140:143], a[236:239], v[112:115]
    buffer_load_dwordx4 v1, s[8:11], s19 offen offset:0  lds
    v_mfma_f32_16x16x32_bf16 v[120:123], a[128:131], a[240:243], v[76:79]
    v_exp_f32 v97, v97
    v_mfma_f32_16x16x32_bf16 v[120:123], a[132:135], a[244:247], v[120:123]
    ds_read_b128 a[128:131], v18 offset:0
    v_cvt_pk_bf16_f32 v48, v96, v97
    v_mfma_f32_16x16x32_bf16 v[120:123], a[136:139], a[248:251], v[120:123]
    v_exp_f32 v98, v98
    v_mfma_f32_16x16x32_bf16 v[120:123], a[140:143], a[252:255], v[120:123]
    buffer_load_dwordx4 v1, s[8:11], s19 offen offset:1024  lds
    v_mfma_f32_16x16x32_bf16 v[116:119], a[144:147], a[224:227], v[72:75]
    v_exp_f32 v99, v99
    v_mfma_f32_16x16x32_bf16 v[116:119], a[148:151], a[228:231], v[116:119]
    ds_read_b128 a[132:135], v18 offset:1024
    v_cvt_pk_bf16_f32 v49, v98, v99
    v_mfma_f32_16x16x32_bf16 v[116:119], a[152:155], a[232:235], v[116:119]
    v_exp_f32 v100, v100
    v_mfma_f32_16x16x32_bf16 v[116:119], a[156:159], a[236:239], v[116:119]
    buffer_load_dwordx4 v1, s[8:11], s19 offen offset:2048  lds
    v_mfma_f32_16x16x32_bf16 v[124:127], a[144:147], a[240:243], v[76:79]
    v_exp_f32 v101, v101
    v_mfma_f32_16x16x32_bf16 v[124:127], a[148:151], a[244:247], v[124:127]
    ds_read_b128 a[136:139], v18 offset:2048
    v_cvt_pk_bf16_f32 v50, v100, v101
    v_mfma_f32_16x16x32_bf16 v[124:127], a[152:155], a[248:251], v[124:127]
    v_exp_f32 v102, v102
    v_mfma_f32_16x16x32_bf16 v[124:127], a[156:159], a[252:255], v[124:127]
    buffer_load_dwordx4 v1, s[8:11], s19 offen offset:3072  lds
    v_mfma_f32_16x16x32_bf16 v[40:43], v[28:31], v[56:59], v[40:43]
    s_add_u32 m0, s16, 4096
    v_exp_f32 v103, v103
    v_mfma_f32_16x16x32_bf16 v[44:47], v[28:31], v[60:63], v[44:47]
    ds_read_b128 a[140:143], v18 offset:3072
    v_cvt_pk_bf16_f32 v51, v102, v103
    v_mfma_f32_16x16x32_bf16 v[192:195], a[160:163], v[56:59], v[192:195]
    v_exp_f32 v104, v104
    v_mfma_f32_16x16x32_bf16 v[224:227], a[160:163], v[60:63], v[224:227]
    buffer_load_dwordx4 v15, s[8:11], s19 offen offset:0  lds
    v_mfma_f32_16x16x32_bf16 v[196:199], a[164:167], v[56:59], v[196:199]
    v_exp_f32 v105, v105
    v_mfma_f32_16x16x32_bf16 v[228:231], a[164:167], v[60:63], v[228:231]
    ds_read_b128 a[144:147], v18 offset:4096
    v_cvt_pk_bf16_f32 v52, v104, v105
    v_mfma_f32_16x16x32_bf16 v[200:203], a[168:171], v[56:59], v[200:203]
    v_exp_f32 v106, v106
    v_mfma_f32_16x16x32_bf16 v[232:235], a[168:171], v[60:63], v[232:235]
    buffer_load_dwordx4 v15, s[8:11], s19 offen offset:1024  lds
    v_mfma_f32_16x16x32_bf16 v[204:207], a[172:175], v[56:59], v[204:207]
    v_exp_f32 v107, v107
    v_mfma_f32_16x16x32_bf16 v[236:239], a[172:175], v[60:63], v[236:239]
    ds_read_b128 a[148:151], v18 offset:5120
    v_cvt_pk_bf16_f32 v53, v106, v107
    v_mfma_f32_16x16x32_bf16 v[208:211], a[176:179], v[56:59], v[208:211]
    s_sub_u32 s14, s14, 1
    v_exp_f32 v108, v108
    v_mfma_f32_16x16x32_bf16 v[240:243], a[176:179], v[60:63], v[240:243]
    buffer_load_dwordx4 v15, s[8:11], s19 offen offset:2048  lds
    v_mfma_f32_16x16x32_bf16 v[212:215], a[180:183], v[56:59], v[212:215]
    v_exp_f32 v109, v109
    v_mfma_f32_16x16x32_bf16 v[244:247], a[180:183], v[60:63], v[244:247]
    ds_read_b128 a[152:155], v18 offset:6144
    v_cvt_pk_bf16_f32 v54, v108, v109
    v_mfma_f32_16x16x32_bf16 v[216:219], a[184:187], v[56:59], v[216:219]
    v_exp_f32 v110, v110
    v_mfma_f32_16x16x32_bf16 v[248:251], a[184:187], v[60:63], v[248:251]
    buffer_load_dwordx4 v15, s[8:11], s19 offen offset:3072  lds
    v_mfma_f32_16x16x32_bf16 v[220:223], a[188:191], v[56:59], v[220:223]
    s_xor_b32 s16, s16, 98304
    v_exp_f32 v111, v111
    v_mfma_f32_16x16x32_bf16 v[252:255], a[188:191], v[60:63], v[252:255]
    ds_read_b128 a[156:159], v18 offset:7168
    v_cvt_pk_bf16_f32 v55, v110, v111
    s_cmp_lg_u32 s14, 0
    s_cbranch_scc1 L_t2_loop
L_t2_diag:
    s_waitcnt lgkmcnt(7)
    v_mfma_f32_16x16x32_bf16 v[96:99], a[128:131], a[192:195], v[80:83]
    s_waitcnt lgkmcnt(6)
    ds_read_b128 a[160:163], v19 offset:16384
    v_mov_b32 v24, v8
    v_mov_b32 v25, v9
    v_mfma_f32_16x16x32_bf16 v[96:99], a[132:135], a[196:199], v[96:99]
    s_waitcnt lgkmcnt(6)
    ds_read_b128 a[164:167], v19 offset:17408
    v_mov_b32 v26, v10
    v_mov_b32 v27, v11
    v_mfma_f32_16x16x32_bf16 v[96:99], a[136:139], a[200:203], v[96:99]
    s_waitcnt lgkmcnt(6)
    v_exp_f32 v112, v112
    v_add_u32 v11, 131072, v16
    v_mfma_f32_16x16x32_bf16 v[96:99], a[140:143], a[204:207], v[96:99]
    v_lshlrev_b32 v12, 6, v0
    v_mfma_f32_16x16x32_bf16 v[104:107], a[128:131], a[208:211], v[88:91]
    s_mov_b32 s71, 1327104
    v_exp_f32 v113, v113
    v_mfma_f32_16x16x32_bf16 v[104:107], a[132:135], a[212:215], v[104:107]
    ds_read_b128 a[168:171], v19 offset:18432
    v_cvt_pk_bf16_f32 v56, v112, v113
    v_mfma_f32_16x16x32_bf16 v[104:107], a[136:139], a[216:219], v[104:107]
    s_waitcnt lgkmcnt(6)
    v_exp_f32 v114, v114
    v_mfma_f32_16x16x32_bf16 v[104:107], a[140:143], a[220:223], v[104:107]
    buffer_load_dword v3, v12, s[8:11], s71 offen sc0 sc1
    v_bfe_u32 v13, v2, 1, 4
    v_mfma_f32_16x16x32_bf16 v[100:103], a[144:147], a[192:195], v[84:87]
    s_waitcnt lgkmcnt(5)
    v_exp_f32 v115, v115
    v_lshlrev_b32 v13, 10, v13
    v_mfma_f32_16x16x32_bf16 v[100:103], a[148:151], a[196:199], v[100:103]
    s_waitcnt lgkmcnt(4)
    ds_read_b128 a[172:175], v19 offset:19456
    v_cvt_pk_bf16_f32 v57, v114, v115
    v_and_b32 v14, 1, v2
    v_mfma_f32_16x16x32_bf16 v[100:103], a[152:155], a[200:203], v[100:103]
    s_waitcnt lgkmcnt(4)
    v_exp_f32 v116, v116
    v_lshl_add_u32 v13, v14, 7, v13
    v_mfma_f32_16x16x32_bf16 v[100:103], a[156:159], a[204:207], v[100:103]
    s_lshl_b32 s74, s6, 2
    s_add_u32 s74, s74, s3
    v_mov_b32 v10, 1
    v_mfma_f32_16x16x32_bf16 v[108:111], a[144:147], a[208:211], v[92:95]
    s_lshl_b32 s73, s6, 2
    v_exp_f32 v117, v117
    v_mfma_f32_16x16x32_bf16 v[108:111], a[148:151], a[212:215], v[108:111]
    s_add_u32 s73, s73, s3
    ds_read_b128 a[176:179], v20 offset:20480
    v_cvt_pk_bf16_f32 v58, v116, v117
    v_mfma_f32_16x16x32_bf16 v[108:111], a[152:155], a[216:219], v[108:111]
    s_lshl_b32 s73, s73, 6
    v_exp_f32 v118, v118
    v_mfma_f32_16x16x32_bf16 v[108:111], a[156:159], a[220:223], v[108:111]
    s_lshl_b32 s74, s74, 14
    v_mfma_f32_16x16x32_bf16 v[32:35], v[28:31], v[48:51], v[32:35]
    s_add_u32 s73, s73, 1310752
    v_exp_f32 v119, v119
    v_mfma_f32_16x16x32_bf16 v[36:39], v[28:31], v[52:55], v[36:39]
    s_waitcnt lgkmcnt(4)
    ds_read_b128 a[180:183], v20 offset:21504
    v_cvt_pk_bf16_f32 v59, v118, v119
    v_mfma_f32_16x16x32_bf16 v[128:131], a[160:163], v[48:51], v[128:131]
    s_waitcnt lgkmcnt(4)
    v_exp_f32 v120, v120
    v_mfma_f32_16x16x32_bf16 v[160:163], a[160:163], v[52:55], v[160:163]
    buffer_load_dword v14, v13, s[28:31], s74 offen
    v_mfma_f32_16x16x32_bf16 v[132:135], a[164:167], v[48:51], v[132:135]
    v_exp_f32 v121, v121
    v_mfma_f32_16x16x32_bf16 v[164:167], a[164:167], v[52:55], v[164:167]
    s_waitcnt lgkmcnt(3)
    ds_read_b128 a[184:187], v20 offset:22528
    v_cvt_pk_bf16_f32 v60, v120, v121
    v_mfma_f32_16x16x32_bf16 v[136:139], a[168:171], v[48:51], v[136:139]
    v_exp_f32 v122, v122
    v_mfma_f32_16x16x32_bf16 v[168:171], a[168:171], v[52:55], v[168:171]
    s_waitcnt lgkmcnt(3)
    v_add_f32 v80, 0, v22
    v_min_f32 v80, v80, v72
    v_mfma_f32_16x16x32_bf16 v[140:143], a[172:175], v[48:51], v[140:143]
    v_exp_f32 v123, v123
    v_mfma_f32_16x16x32_bf16 v[172:175], a[172:175], v[52:55], v[172:175]
    s_waitcnt lgkmcnt(2)
    ds_read_b128 a[188:191], v20 offset:23552
    v_cvt_pk_bf16_f32 v61, v122, v123
    v_mfma_f32_16x16x32_bf16 v[144:147], a[176:179], v[48:51], v[144:147]
    v_exp_f32 v124, v124
    v_mfma_f32_16x16x32_bf16 v[176:179], a[176:179], v[52:55], v[176:179]
    s_waitcnt lgkmcnt(2)
    v_add_f32 v81, 0xf1800000, v22
    v_min_f32 v81, v81, v73
    v_mfma_f32_16x16x32_bf16 v[148:151], a[180:183], v[48:51], v[148:151]
    v_exp_f32 v125, v125
    v_mfma_f32_16x16x32_bf16 v[180:183], a[180:183], v[52:55], v[180:183]
    s_waitcnt lgkmcnt(1)
    v_cvt_pk_bf16_f32 v62, v124, v125
    v_xor_b32 v19, 98304, v19
    v_mfma_f32_16x16x32_bf16 v[152:155], a[184:187], v[48:51], v[152:155]
    v_exp_f32 v126, v126
    v_mfma_f32_16x16x32_bf16 v[184:187], a[184:187], v[52:55], v[184:187]
    s_waitcnt lgkmcnt(0)
    v_xor_b32 v20, 98304, v20
    v_add_f32 v82, 0xf2000000, v22
    v_mfma_f32_16x16x32_bf16 v[156:159], a[188:191], v[48:51], v[156:159]
    v_exp_f32 v127, v127
    v_mfma_f32_16x16x32_bf16 v[188:191], a[188:191], v[52:55], v[188:191]
    v_cvt_pk_bf16_f32 v63, v126, v127
    v_min_f32 v82, v82, v74
    v_add_f32 v83, 0xf2400000, v22
    v_min_f32 v83, v83, v75
    v_add_f32 v84, 0xf3800000, v22
    v_min_f32 v84, v84, v72
    v_mfma_f32_16x16x32_bf16 v[112:115], a[128:131], a[224:227], v[72:75]
    v_exp_f32 v96, v96
    v_mfma_f32_16x16x32_bf16 v[112:115], a[132:135], a[228:231], v[112:115]
    v_add_f32 v85, 0xf3880000, v22
    v_min_f32 v85, v85, v73
    s_getpc_b64 s[100:101]
L_ct3:
    s_lshr_b32 s99, s2, 3
    s_lshl_b32 s99, s99, 2
    s_add_u32 s99, s99, s3
    s_mul_i32 s99, s99, 4
    v_min_u32 v13, 3, v2
    v_add_u32 v13, s99, v13
    v_lshlrev_b32 v13, 7, v13
    v_add_u32 v13, L_ct3-L_ct3, v13
    v_min_u32 v13, L_end-L_ct3, v13
    global_load_dword v13, v13, s[100:101]
    v_mfma_f32_16x16x32_bf16 v[112:115], a[136:139], a[232:235], v[112:115]
    s_and_b32 s68, s2, 31
    v_exp_f32 v97, v97
    v_mfma_f32_16x16x32_bf16 v[112:115], a[140:143], a[236:239], v[112:115]
    s_lshl_b32 s68, s68, 2
    s_add_u32 s68, s68, s3
    v_cvt_pk_bf16_f32 v48, v96, v97
    buffer_atomic_add v10, v5, s[8:11], s73 offen sc0 sc1
    v_mfma_f32_16x16x32_bf16 v[120:123], a[128:131], a[240:243], v[76:79]
    s_lshl_b32 s69, s60, 7
    v_exp_f32 v98, v98
    v_mfma_f32_16x16x32_bf16 v[120:123], a[132:135], a[244:247], v[120:123]
    v_add_f32 v86, 0xf3900000, v22
    v_min_f32 v86, v86, v74
    v_mfma_f32_16x16x32_bf16 v[120:123], a[136:139], a[248:251], v[120:123]
    s_add_u32 s68, s68, s69
    v_exp_f32 v99, v99
    v_mfma_f32_16x16x32_bf16 v[120:123], a[140:143], a[252:255], v[120:123]
    v_add_f32 v87, 0xf3980000, v22
    v_min_f32 v87, v87, v75
    v_mfma_f32_16x16x32_bf16 v[116:119], a[144:147], a[224:227], v[72:75]
    s_lshl_b32 s68, s68, 10
    v_exp_f32 v100, v100
    v_mfma_f32_16x16x32_bf16 v[116:119], a[148:151], a[228:231], v[116:119]
    s_sub_u32 s69, s61, s60
    ds_read_b128 a[128:131], v18 offset:16384
    v_cvt_pk_bf16_f32 v49, v98, v99
    v_mfma_f32_16x16x32_bf16 v[116:119], a[152:155], a[232:235], v[116:119]
    s_lshl_b32 s69, s69, 17
    v_exp_f32 v101, v101
    v_mfma_f32_16x16x32_bf16 v[116:119], a[156:159], a[236:239], v[116:119]
    ds_read_b128 a[132:135], v18 offset:17408
    v_cvt_pk_bf16_f32 v50, v100, v101
    v_mfma_f32_16x16x32_bf16 v[124:127], a[144:147], a[240:243], v[76:79]
    v_exp_f32 v102, v102
    v_mfma_f32_16x16x32_bf16 v[124:127], a[148:151], a[244:247], v[124:127]
    ds_read_b128 a[136:139], v18 offset:18432
    v_bfe_u32 v9, v2, 3, 1
    v_mfma_f32_16x16x32_bf16 v[124:127], a[152:155], a[248:251], v[124:127]
    v_exp_f32 v103, v103
    v_mfma_f32_16x16x32_bf16 v[124:127], a[156:159], a[252:255], v[124:127]
    ds_read_b128 a[140:143], v18 offset:19456
    v_cvt_pk_bf16_f32 v51, v102, v103
    v_mfma_f32_16x16x32_bf16 v[40:43], v[28:31], v[56:59], v[40:43]
    v_exp_f32 v104, v104
    v_mfma_f32_16x16x32_bf16 v[44:47], v[28:31], v[60:63], v[44:47]
    ds_read_b128 a[144:147], v18 offset:20480
    v_mul_lo_u32 v9, v9, s69
    v_mfma_f32_16x16x32_bf16 v[192:195], a[160:163], v[56:59], v[192:195]
    v_exp_f32 v105, v105
    v_mfma_f32_16x16x32_bf16 v[224:227], a[160:163], v[60:63], v[224:227]
    ds_read_b128 a[148:151], v18 offset:21504
    v_cvt_pk_bf16_f32 v52, v104, v105
    v_mfma_f32_16x16x32_bf16 v[196:199], a[164:167], v[56:59], v[196:199]
    v_exp_f32 v106, v106
    v_mfma_f32_16x16x32_bf16 v[228:231], a[164:167], v[60:63], v[228:231]
    ds_read_b128 a[152:155], v18 offset:22528
    v_and_b32 v8, 7, v2
    v_mfma_f32_16x16x32_bf16 v[200:203], a[168:171], v[56:59], v[200:203]
    v_exp_f32 v107, v107
    v_mfma_f32_16x16x32_bf16 v[232:235], a[168:171], v[60:63], v[232:235]
    ds_read_b128 a[156:159], v18 offset:23552
    v_cvt_pk_bf16_f32 v53, v106, v107
    v_mfma_f32_16x16x32_bf16 v[204:207], a[172:175], v[56:59], v[204:207]
    v_exp_f32 v108, v108
    v_mfma_f32_16x16x32_bf16 v[236:239], a[172:175], v[60:63], v[236:239]
    v_lshl_add_u32 v9, v8, 7, v9
    v_add_f32 v88, 0x73800000, v22
    v_mfma_f32_16x16x32_bf16 v[208:211], a[176:179], v[56:59], v[208:211]
    v_exp_f32 v109, v109
    v_mfma_f32_16x16x32_bf16 v[240:243], a[176:179], v[60:63], v[240:243]
    v_cvt_pk_bf16_f32 v54, v108, v109
    v_xor_b32 v18, 196608, v18
    v_mfma_f32_16x16x32_bf16 v[212:215], a[180:183], v[56:59], v[212:215]
    v_exp_f32 v110, v110
    v_mfma_f32_16x16x32_bf16 v[244:247], a[180:183], v[60:63], v[244:247]
    buffer_load_dword v8, v9, s[32:35], s68 offen
    v_mfma_f32_16x16x32_bf16 v[216:219], a[184:187], v[56:59], v[216:219]
    v_exp_f32 v111, v111
    v_mfma_f32_16x16x32_bf16 v[248:251], a[184:187], v[60:63], v[248:251]
    v_cvt_pk_bf16_f32 v55, v110, v111
    v_min_f32 v88, v88, v76
    s_waitcnt vmcnt(4)
    v_cmp_ne_u32 vcc, 0, v3
    s_cmp_eq_u64 vcc, -1
    s_cbranch_scc0 L_F_slow_11
L_F_ok_12:
    v_mfma_f32_16x16x32_bf16 v[220:223], a[188:191], v[56:59], v[220:223]
    v_add_f32 v89, 0x73700000, v22
    v_min_f32 v89, v89, v77
    v_mfma_f32_16x16x32_bf16 v[252:255], a[188:191], v[60:63], v[252:255]
    v_add_f32 v90, 0x73600000, v22
    v_min_f32 v90, v90, v78
    v_add_f32 v91, 0x73500000, v22
    v_min_f32 v91, v91, v79
    v_add_f32 v92, 0, v22
    v_min_f32 v92, v92, v76
    v_add_f32 v93, 0xf1800000, v22
    v_min_f32 v93, v93, v77
    v_add_f32 v94, 0xf2000000, v22
    v_min_f32 v94, v94, v78
    v_add_f32 v95, 0xf2400000, v22
    v_min_f32 v95, v95, v79
    s_waitcnt lgkmcnt(0)
    s_barrier
    v_mfma_f32_16x16x32_bf16 v[96:99], a[128:131], a[224:227], v[80:83]
    s_xor_b32 s100, s62, 8192
    s_xor_b32 s98, s65, 262144
    ds_read_b128 a[176:179], v20 offset:4096
    s_waitcnt vmcnt(2)
    v_lshrrev_b32 v13, 1, v1
    v_mfma_f32_16x16x32_bf16 v[96:99], a[132:135], a[228:231], v[96:99]
    s_add_u32 m0, s62, 65536
    ds_read_b128 a[180:183], v20 offset:5120
    v_add_u32 v12, s100, v13
    v_mfma_f32_16x16x32_bf16 v[96:99], a[136:139], a[232:235], v[96:99]
    buffer_load_dwordx4 v24, s[28:31], s98 offen offset:0   lds
    v_exp_f32 v112, v112
    v_mfma_f32_16x16x32_bf16 v[96:99], a[140:143], a[236:239], v[96:99]
    v_exp_f32 v113, v113
    v_mfma_f32_16x16x32_bf16 v[100:103], a[144:147], a[224:227], v[84:87]
    ds_read_b128 a[184:187], v20 offset:6144
    v_cvt_pk_bf16_f32 v56, v112, v113
    v_mfma_f32_16x16x32_bf16 v[100:103], a[148:151], a[228:231], v[100:103]
    v_exp_f32 v114, v114
    v_mfma_f32_16x16x32_bf16 v[100:103], a[152:155], a[232:235], v[100:103]
    buffer_load_dwordx4 v25, s[28:31], s98 offen offset:1024   lds
    v_exp_f32 v115, v115
    v_mfma_f32_16x16x32_bf16 v[100:103], a[156:159], a[236:239], v[100:103]
    ds_read_b128 a[188:191], v20 offset:7168
    v_cvt_pk_bf16_f32 v57, v114, v115
    v_mfma_f32_16x16x32_bf16 v[104:107], a[128:131], a[240:243], v[88:91]
    v_exp_f32 v116, v116
    v_mfma_f32_16x16x32_bf16 v[104:107], a[132:135], a[244:247], v[104:107]
    v_exp_f32 v117, v117
    v_mfma_f32_16x16x32_bf16 v[104:107], a[136:139], a[248:251], v[104:107]
    ds_read_b128 a[160:163], v19 offset:0
    v_cvt_pk_bf16_f32 v58, v116, v117
    v_mfma_f32_16x16x32_bf16 v[104:107], a[140:143], a[252:255], v[104:107]
    buffer_load_dwordx4 v26, s[28:31], s98 offen offset:2048   lds
    v_exp_f32 v118, v118
    v_mfma_f32_16x16x32_bf16 v[108:111], a[144:147], a[240:243], v[92:95]
    v_exp_f32 v119, v119
    v_mfma_f32_16x16x32_bf16 v[108:111], a[148:151], a[244:247], v[108:111]
    ds_read_b128 a[164:167], v19 offset:1024
    v_cvt_pk_bf16_f32 v59, v118, v119
    v_mfma_f32_16x16x32_bf16 v[108:111], a[152:155], a[248:251], v[108:111]
    v_exp_f32 v120, v120
    v_mfma_f32_16x16x32_bf16 v[108:111], a[156:159], a[252:255], v[108:111]
    buffer_load_dwordx4 v27, s[28:31], s98 offen offset:3072   lds
    v_exp_f32 v121, v121
    v_mfma_f32_16x16x32_bf16 v[32:35], v[28:31], v[48:51], v[32:35]
    s_add_u32 m0, s62, 69632
    ds_read_b128 a[168:171], v19 offset:2048
    v_cvt_pk_bf16_f32 v60, v120, v121
    v_mfma_f32_16x16x32_bf16 v[36:39], v[28:31], v[52:55], v[36:39]
    s_waitcnt lgkmcnt(6)
    s_xor_b32 s98, s65, 294912
    v_exp_f32 v122, v122
    v_mfma_f32_16x16x32_bf16 v[144:147], a[176:179], v[48:51], v[144:147]
    v_exp_f32 v123, v123
    v_mfma_f32_16x16x32_bf16 v[176:179], a[176:179], v[52:55], v[176:179]
    s_waitcnt lgkmcnt(5)
    ds_read_b128 a[172:175], v19 offset:3072
    v_cvt_pk_bf16_f32 v61, v122, v123
    v_mfma_f32_16x16x32_bf16 v[148:151], a[180:183], v[48:51], v[148:151]
    buffer_load_dwordx4 v24, s[28:31], s98 offen offset:0   lds
    v_exp_f32 v124, v124
    v_mfma_f32_16x16x32_bf16 v[180:183], a[180:183], v[52:55], v[180:183]
    s_waitcnt lgkmcnt(5)
    v_exp_f32 v125, v125
    v_mfma_f32_16x16x32_bf16 v[152:155], a[184:187], v[48:51], v[152:155]
    s_waitcnt lgkmcnt(4)
    v_exp_f32 v126, v126
    v_mfma_f32_16x16x32_bf16 v[184:187], a[184:187], v[52:55], v[184:187]
    buffer_load_dwordx4 v25, s[28:31], s98 offen offset:1024   lds
    v_exp_f32 v127, v127
    v_mfma_f32_16x16x32_bf16 v[156:159], a[188:191], v[48:51], v[156:159]
    ds_write_b128 v11, v[144:147] offset:0
    v_cvt_pk_bf16_f32 v62, v124, v125
    v_mfma_f32_16x16x32_bf16 v[188:191], a[188:191], v[52:55], v[188:191]
    s_waitcnt lgkmcnt(4)
    v_exp_f32 v96, v96
    v_mfma_f32_16x16x32_bf16 v[128:131], a[160:163], v[48:51], v[128:131]
    v_exp_f32 v97, v97
    v_mfma_f32_16x16x32_bf16 v[160:163], a[160:163], v[52:55], v[160:163]
    s_waitcnt lgkmcnt(3)
    ds_write_b128 v11, v[176:179] offset:1024
    v_cvt_pk_bf16_f32 v63, v126, v127
    v_mfma_f32_16x16x32_bf16 v[132:135], a[164:167], v[48:51], v[132:135]
    s_waitcnt lgkmcnt(3)
    v_exp_f32 v98, v98
    v_mfma_f32_16x16x32_bf16 v[164:167], a[164:167], v[52:55], v[164:167]
    buffer_load_dwordx4 v26, s[28:31], s98 offen offset:2048   lds
    v_exp_f32 v99, v99
    v_mfma_f32_16x16x32_bf16 v[136:139], a[168:171], v[48:51], v[136:139]
    ds_write_b128 v11, v[148:151] offset:2048
    v_mfma_f32_16x16x32_bf16 v[168:171], a[168:171], v[52:55], v[168:171]
    s_waitcnt lgkmcnt(3)
    v_exp_f32 v100, v100
    v_mfma_f32_16x16x32_bf16 v[140:143], a[172:175], v[48:51], v[140:143]
    v_exp_f32 v101, v101
    v_mfma_f32_16x16x32_bf16 v[172:175], a[172:175], v[52:55], v[172:175]
    ds_write_b128 v11, v[180:183] offset:3072
    v_mov_b32 v33, v36
    v_mfma_f32_16x16x32_bf16 v[40:43], v[28:31], v[56:59], v[40:43]
    buffer_load_dwordx4 v27, s[28:31], s98 offen offset:3072   lds
    v_exp_f32 v102, v102
    v_mfma_f32_16x16x32_bf16 v[44:47], v[28:31], v[60:63], v[44:47]
    v_exp_f32 v103, v103
    v_mfma_f32_16x16x32_bf16 v[208:211], a[176:179], v[56:59], v[208:211]
    ds_write_b128 v11, v[152:155] offset:4096
    v_cvt_pk_bf16_f32 v48, v96, v97
    v_mfma_f32_16x16x32_bf16 v[240:243], a[176:179], v[60:63], v[240:243]
    ds_read_b128 a[176:179], v20 offset:20480
    v_exp_f32 v104, v104
    v_mfma_f32_16x16x32_bf16 v[212:215], a[180:183], v[56:59], v[212:215]
    v_exp_f32 v105, v105
    v_mfma_f32_16x16x32_bf16 v[244:247], a[180:183], v[60:63], v[244:247]
    ds_read_b128 a[180:183], v20 offset:21504
    v_exp_f32 v106, v106
    v_mfma_f32_16x16x32_bf16 v[216:219], a[184:187], v[56:59], v[216:219]
    ds_write_b128 v11, v[184:187] offset:5120
    v_cvt_pk_bf16_f32 v49, v98, v99
    v_mfma_f32_16x16x32_bf16 v[248:251], a[184:187], v[60:63], v[248:251]
    ds_read_b128 a[184:187], v20 offset:22528
    v_exp_f32 v107, v107
    v_mfma_f32_16x16x32_bf16 v[220:223], a[188:191], v[56:59], v[220:223]
    v_exp_f32 v108, v108
    v_mfma_f32_16x16x32_bf16 v[252:255], a[188:191], v[60:63], v[252:255]
    ds_read_b128 a[188:191], v20 offset:23552
    v_exp_f32 v109, v109
    v_mfma_f32_16x16x32_bf16 v[192:195], a[160:163], v[56:59], v[192:195]
    ds_write_b128 v11, v[156:159] offset:6144
    v_cvt_pk_bf16_f32 v50, v100, v101
    v_mfma_f32_16x16x32_bf16 v[224:227], a[160:163], v[60:63], v[224:227]
    ds_read_b128 a[160:163], v19 offset:16384
    v_exp_f32 v110, v110
    v_mfma_f32_16x16x32_bf16 v[196:199], a[164:167], v[56:59], v[196:199]
    v_exp_f32 v111, v111
    v_mfma_f32_16x16x32_bf16 v[228:231], a[164:167], v[60:63], v[228:231]
    ds_read_b128 a[164:167], v19 offset:17408
    v_cvt_pk_bf16_f32 v51, v102, v103
    v_mfma_f32_16x16x32_bf16 v[200:203], a[168:171], v[56:59], v[200:203]
    ds_write_b128 v11, v[188:191] offset:7168
    v_cvt_pk_bf16_f32 v52, v104, v105
    v_mfma_f32_16x16x32_bf16 v[232:235], a[168:171], v[60:63], v[232:235]
    ds_read_b128 a[168:171], v19 offset:18432
    v_cvt_pk_bf16_f32 v53, v106, v107
    v_mfma_f32_16x16x32_bf16 v[204:207], a[172:175], v[56:59], v[204:207]
    v_cvt_pk_bf16_f32 v54, v108, v109
    v_cvt_pk_bf16_f32 v55, v110, v111
    s_waitcnt vmcnt(9)
    v_readfirstlane_b32 s73, v10
    v_mfma_f32_16x16x32_bf16 v[236:239], a[172:175], v[60:63], v[236:239]
    ds_read_b128 a[172:175], v19 offset:19456
    ds_write_b64 v12, v[32:33]
    s_add_u32 s101, s62, 98304
    v_xor_b32 v12, 8192, v12
    v_add_u32 v9, s101, v1
    s_waitcnt vmcnt(8)
    v_xor_b32 v8, 8192, v11
    v_xor_b32 v10, 8192, v9
L_t2_join:
    v_xor_b32 v19, 98304, v19
    v_xor_b32 v20, 98304, v20
    s_waitcnt lgkmcnt(0)
    s_barrier
    v_mfma_f32_16x16x32_bf16 v[40:43], v[28:31], v[48:51], v[40:43]
    s_lshl_b32 s100, s61, 20
    s_add_u32 s101, s100, s21
    ds_read_b64 v[120:121], v12
    v_mfma_f32_16x16x32_bf16 v[44:47], v[28:31], v[52:55], v[44:47]
    s_add_u32 s100, s100, s20
    ds_read_b128 v[144:147], v8 offset:0
    v_lshrrev_b32 v11, 4, v2
    v_mfma_f32_16x16x32_bf16 v[208:211], a[176:179], v[48:51], v[208:211]
    ds_read_b128 v[176:179], v8 offset:1024
    v_lshrrev_b32 v13, 2, v1
    v_mfma_f32_16x16x32_bf16 v[240:243], a[176:179], v[52:55], v[240:243]
    ds_read_b128 v[148:151], v8 offset:2048
    v_add_u32 v13, 131072, v13
    v_mfma_f32_16x16x32_bf16 v[212:215], a[180:183], v[48:51], v[212:215]
    s_xor_b32 s99, s62, 8192
    ds_read_b128 v[180:183], v8 offset:3072
    v_add_u32 v14, s99, v13
    v_mfma_f32_16x16x32_bf16 v[244:247], a[180:183], v[52:55], v[244:247]
    ds_read_b128 v[152:155], v8 offset:4096
    v_cmp_eq_u32 vcc, 1, v11
    v_mfma_f32_16x16x32_bf16 v[216:219], a[184:187], v[48:51], v[216:219]
    ds_read_b128 v[184:187], v8 offset:5120
    s_waitcnt lgkmcnt(6)
    v_add_f32 v112, v120, v32
    v_mfma_f32_16x16x32_bf16 v[248:251], a[184:187], v[52:55], v[248:251]
    ds_read_b128 v[156:159], v8 offset:6144
    v_add_f32 v114, v121, v36
    v_mfma_f32_16x16x32_bf16 v[220:223], a[188:191], v[48:51], v[220:223]
    ds_read_b128 v[188:191], v8 offset:7168
    v_cndmask_b32 v12, v32, v36, vcc
    v_mfma_f32_16x16x32_bf16 v[252:255], a[188:191], v[52:55], v[252:255]
    v_rcp_f32 v112, v112
    v_mfma_f32_16x16x32_bf16 v[192:195], a[160:163], v[48:51], v[192:195]
    v_rcp_f32 v114, v114
    v_mfma_f32_16x16x32_bf16 v[224:227], a[160:163], v[52:55], v[224:227]
    v_cmp_eq_u32 vcc, 2, v11
    v_cmp_eq_u32 s[96:97], 3, v11
    v_mfma_f32_16x16x32_bf16 v[196:199], a[164:167], v[48:51], v[196:199]
    ds_write_b128 v9, v[208:211] offset:0
    v_mfma_f32_16x16x32_bf16 v[228:231], a[164:167], v[52:55], v[228:231]
    v_mfma_f32_16x16x32_bf16 v[200:203], a[168:171], v[48:51], v[200:203]
    ds_write_b128 v9, v[240:243] offset:1024
    v_mfma_f32_16x16x32_bf16 v[232:235], a[168:171], v[52:55], v[232:235]
    v_mfma_f32_16x16x32_bf16 v[204:207], a[172:175], v[48:51], v[204:207]
    ds_write_b128 v9, v[212:215] offset:2048
    v_mfma_f32_16x16x32_bf16 v[236:239], a[172:175], v[52:55], v[236:239]
    v_cndmask_b32 v12, v12, v40, vcc
    v_cndmask_b32 v12, v12, v44, s[96:97]
    ds_write_b128 v9, v[244:247] offset:3072
    s_waitcnt lgkmcnt(11)
    v_pk_add_f32 v[128:129], v[128:129], v[144:145]
    v_pk_add_f32 v[130:131], v[130:131], v[146:147]
    s_waitcnt lgkmcnt(9)
    v_pk_add_f32 v[132:133], v[132:133], v[148:149]
    v_pk_add_f32 v[134:135], v[134:135], v[150:151]
    v_pk_mul_f32 v[128:129], v[128:129], v[112:113] op_sel_hi:[1,0]
    v_pk_mul_f32 v[130:131], v[130:131], v[112:113] op_sel_hi:[1,0]
    v_pk_mul_f32 v[132:133], v[132:133], v[112:113] op_sel_hi:[1,0]
    v_pk_mul_f32 v[134:135], v[134:135], v[112:113] op_sel_hi:[1,0]
    v_cvt_pk_bf16_f32 v128, v128, v129
    v_cvt_pk_bf16_f32 v129, v130, v131
    v_cvt_pk_bf16_f32 v130, v132, v133
    v_lshrrev_b32 v58, 2, v2
    v_and_b32 v57, 3, v2
    ds_write_b128 v9, v[216:219] offset:4096
    v_cvt_pk_bf16_f32 v131, v134, v135
    buffer_store_dwordx4 v[128:131], v1, s[8:11], s100 offen offset:0 sc0 sc1
    s_waitcnt lgkmcnt(8)
    v_pk_add_f32 v[136:137], v[136:137], v[152:153]
    v_pk_add_f32 v[138:139], v[138:139], v[154:155]
    s_waitcnt lgkmcnt(6)
    v_pk_add_f32 v[140:141], v[140:141], v[156:157]
    v_pk_add_f32 v[142:143], v[142:143], v[158:159]
    v_pk_mul_f32 v[136:137], v[136:137], v[112:113] op_sel_hi:[1,0]
    v_pk_mul_f32 v[138:139], v[138:139], v[112:113] op_sel_hi:[1,0]
    v_pk_mul_f32 v[140:141], v[140:141], v[112:113] op_sel_hi:[1,0]
    v_pk_mul_f32 v[142:143], v[142:143], v[112:113] op_sel_hi:[1,0]
    v_cvt_pk_bf16_f32 v136, v136, v137
    v_lshlrev_b32 v56, 7, v58
    v_lshl_add_u32 v56, v57, 3, v56
    v_bfe_u32 v57, v2, 3, 2
    ds_write_b128 v9, v[248:251] offset:5120
    v_cvt_pk_bf16_f32 v137, v138, v139
    v_cvt_pk_bf16_f32 v138, v140, v141
    v_cvt_pk_bf16_f32 v139, v142, v143
    buffer_store_dwordx4 v[136:139], v1, s[8:11], s100 offen offset:1024 sc0 sc1
    v_pk_add_f32 v[160:161], v[160:161], v[176:177]
    v_pk_add_f32 v[162:163], v[162:163], v[178:179]
    v_pk_add_f32 v[164:165], v[164:165], v[180:181]
    v_pk_add_f32 v[166:167], v[166:167], v[182:183]
    v_pk_mul_f32 v[160:161], v[160:161], v[114:115] op_sel_hi:[1,0]
    v_pk_mul_f32 v[162:163], v[162:163], v[114:115] op_sel_hi:[1,0]
    v_pk_mul_f32 v[164:165], v[164:165], v[114:115] op_sel_hi:[1,0]
    v_lshl_add_u32 v56, v57, 5, v56
    v_xor_b32 v57, 32, v56
    ds_write_b128 v9, v[220:223] offset:6144
    v_pk_mul_f32 v[166:167], v[166:167], v[114:115] op_sel_hi:[1,0]
    v_cvt_pk_bf16_f32 v160, v160, v161
    v_cvt_pk_bf16_f32 v161, v162, v163
    v_cvt_pk_bf16_f32 v162, v164, v165
    v_cvt_pk_bf16_f32 v163, v166, v167
    buffer_store_dwordx4 v[160:163], v15, s[8:11], s100 offen offset:0 sc0 sc1
    v_pk_add_f32 v[168:169], v[168:169], v[184:185]
    v_pk_add_f32 v[170:171], v[170:171], v[186:187]
    s_waitcnt lgkmcnt(7)
    v_pk_add_f32 v[172:173], v[172:173], v[188:189]
    v_pk_add_f32 v[174:175], v[174:175], v[190:191]
    v_pk_mul_f32 v[168:169], v[168:169], v[114:115] op_sel_hi:[1,0]
    v_xor_b32 v58, 64, v56
    v_xor_b32 v59, 96, v56
    v_add_u32 v60, 65536, v56
    ds_write_b128 v9, v[252:255] offset:7168
    v_pk_mul_f32 v[170:171], v[170:171], v[114:115] op_sel_hi:[1,0]
    v_pk_mul_f32 v[172:173], v[172:173], v[114:115] op_sel_hi:[1,0]
    v_pk_mul_f32 v[174:175], v[174:175], v[114:115] op_sel_hi:[1,0]
    v_cvt_pk_bf16_f32 v168, v168, v169
    v_cvt_pk_bf16_f32 v169, v170, v171
    v_cvt_pk_bf16_f32 v170, v172, v173
    v_cvt_pk_bf16_f32 v171, v174, v175
    buffer_store_dwordx4 v[168:171], v15, s[8:11], s100 offen offset:1024 sc0 sc1
    v_add_u32 v61, 65536, v57
    v_add_u32 v62, 65536, v58
    v_add_u32 v63, 65536, v59
    ds_write_b32 v14, v12
    v_and_b32 v14, 4294967103, v13
    v_add_u32 v14, s62, v14
    s_waitcnt lgkmcnt(0)
    s_barrier
    ds_read_b32 v116, v14 offset:128
    ds_read_b32 v118, v14 offset:192
    ds_read_b128 v[208:211], v10 offset:0
    ds_read_b128 v[212:215], v10 offset:2048
    ds_read_b128 v[216:219], v10 offset:4096
    ds_read_b128 v[220:223], v10 offset:6144
    ds_read_b128 v[240:243], v10 offset:1024
    ds_read_b128 v[244:247], v10 offset:3072
    ds_read_b128 v[248:251], v10 offset:5120
    ds_read_b128 v[252:255], v10 offset:7168
    ds_read_b32 v120, v13 offset:0
    ds_read_b32 v121, v13 offset:8192
    ds_read_b32 v122, v13 offset:16384
    ds_read_b32 v123, v13 offset:24576
    s_waitcnt lgkmcnt(13)
    v_add_f32 v116, v116, v40
    s_waitcnt lgkmcnt(12)
    v_add_f32 v118, v118, v44
    v_rcp_f32 v116, v116
    v_rcp_f32 v118, v118
    s_waitcnt lgkmcnt(11)
    v_pk_add_f32 v[192:193], v[192:193], v[208:209]
    v_pk_add_f32 v[194:195], v[194:195], v[210:211]
    s_waitcnt lgkmcnt(10)
    v_pk_add_f32 v[196:197], v[196:197], v[212:213]
    v_pk_add_f32 v[198:199], v[198:199], v[214:215]
    v_pk_mul_f32 v[192:193], v[192:193], v[116:117] op_sel_hi:[1,0]
    v_pk_mul_f32 v[194:195], v[194:195], v[116:117] op_sel_hi:[1,0]
    v_pk_mul_f32 v[196:197], v[196:197], v[116:117] op_sel_hi:[1,0]
    v_pk_mul_f32 v[198:199], v[198:199], v[116:117] op_sel_hi:[1,0]
    v_cvt_pk_bf16_f32 v192, v192, v193
    v_cvt_pk_bf16_f32 v193, v194, v195
    v_cvt_pk_bf16_f32 v194, v196, v197
    v_cvt_pk_bf16_f32 v195, v198, v199
    buffer_store_dwordx4 v[192:195], v1, s[8:11], s101 offen offset:0 sc0 sc1
    s_waitcnt lgkmcnt(9)
    v_pk_add_f32 v[200:201], v[200:201], v[216:217]
    v_pk_add_f32 v[202:203], v[202:203], v[218:219]
    s_waitcnt lgkmcnt(8)
    v_pk_add_f32 v[204:205], v[204:205], v[220:221]
    v_pk_add_f32 v[206:207], v[206:207], v[222:223]
    v_pk_mul_f32 v[200:201], v[200:201], v[116:117] op_sel_hi:[1,0]
    v_pk_mul_f32 v[202:203], v[202:203], v[116:117] op_sel_hi:[1,0]
    v_pk_mul_f32 v[204:205], v[204:205], v[116:117] op_sel_hi:[1,0]
    v_pk_mul_f32 v[206:207], v[206:207], v[116:117] op_sel_hi:[1,0]
    v_cvt_pk_bf16_f32 v200, v200, v201
    v_cvt_pk_bf16_f32 v201, v202, v203
    v_cvt_pk_bf16_f32 v202, v204, v205
    v_cvt_pk_bf16_f32 v203, v206, v207
    buffer_store_dwordx4 v[200:203], v1, s[8:11], s101 offen offset:1024 sc0 sc1
    s_waitcnt lgkmcnt(2)
    v_add_f32 v120, v120, v121
    s_waitcnt lgkmcnt(0)
    v_add_f32 v122, v122, v123
    v_min_f32 v124, v120, v122
    v_add_f32 v120, v120, v122
    v_cmp_le_f32 vcc, 0x1f800000, v124
    s_mov_b64 s[96:97], vcc
    v_cmp_ge_f32 vcc, 0x67800000, v120
    s_and_b64 s[96:97], s[96:97], vcc
    s_cmp_eq_u64 s[96:97], -1
    s_cselect_b32 s96, s25, 1
    s_cmp_lg_u32 s96, 0
    s_cbranch_scc1 L_t2_redo
L_t2_safe:
    v_pk_add_f32 v[224:225], v[224:225], v[240:241]
    v_pk_add_f32 v[226:227], v[226:227], v[242:243]
    v_pk_add_f32 v[228:229], v[228:229], v[244:245]
    v_pk_add_f32 v[230:231], v[230:231], v[246:247]
    v_pk_mul_f32 v[224:225], v[224:225], v[118:119] op_sel_hi:[1,0]
    v_pk_mul_f32 v[226:227], v[226:227], v[118:119] op_sel_hi:[1,0]
    v_pk_mul_f32 v[228:229], v[228:229], v[118:119] op_sel_hi:[1,0]
    v_pk_mul_f32 v[230:231], v[230:231], v[118:119] op_sel_hi:[1,0]
    v_cvt_pk_bf16_f32 v224, v224, v225
    v_cvt_pk_bf16_f32 v225, v226, v227
    v_cvt_pk_bf16_f32 v226, v228, v229
    v_cvt_pk_bf16_f32 v227, v230, v231
    buffer_store_dwordx4 v[224:227], v15, s[8:11], s101 offen offset:0 sc0 sc1
    ds_read_b64_tr_b16 a[192:193], v56 offset:32768
    ds_read_b64_tr_b16 a[194:195], v56 offset:34816
    ds_read_b64_tr_b16 a[196:197], v56 offset:36864
    ds_read_b64_tr_b16 a[198:199], v56 offset:38912
    ds_read_b64_tr_b16 a[200:201], v57 offset:32768
    ds_read_b64_tr_b16 a[202:203], v57 offset:34816
    ds_read_b64_tr_b16 a[204:205], v57 offset:36864
    ds_read_b64_tr_b16 a[206:207], v57 offset:38912
    v_pk_add_f32 v[232:233], v[232:233], v[248:249]
    v_pk_add_f32 v[234:235], v[234:235], v[250:251]
    v_pk_add_f32 v[236:237], v[236:237], v[252:253]
    v_pk_add_f32 v[238:239], v[238:239], v[254:255]
    v_pk_mul_f32 v[232:233], v[232:233], v[118:119] op_sel_hi:[1,0]
    v_pk_mul_f32 v[234:235], v[234:235], v[118:119] op_sel_hi:[1,0]
    v_pk_mul_f32 v[236:237], v[236:237], v[118:119] op_sel_hi:[1,0]
    v_pk_mul_f32 v[238:239], v[238:239], v[118:119] op_sel_hi:[1,0]
    v_cvt_pk_bf16_f32 v232, v232, v233
    v_cvt_pk_bf16_f32 v233, v234, v235
    v_cvt_pk_bf16_f32 v234, v236, v237
    v_cvt_pk_bf16_f32 v235, v238, v239
    buffer_store_dwordx4 v[232:235], v15, s[8:11], s101 offen offset:1024 sc0 sc1
    ds_read_b64_tr_b16 a[208:209], v56 offset:40960
    ds_read_b64_tr_b16 a[210:211], v56 offset:43008
    ds_read_b64_tr_b16 a[212:213], v56 offset:45056
    ds_read_b64_tr_b16 a[214:215], v56 offset:47104
    ds_read_b64_tr_b16 a[216:217], v57 offset:40960
    ds_read_b64_tr_b16 a[218:219], v57 offset:43008
    ds_read_b64_tr_b16 a[220:221], v57 offset:45056
    ds_read_b64_tr_b16 a[222:223], v57 offset:47104
    s_cmp_ge_u32 s73, 24
    s_cbranch_scc1 L_op_odd
    s_waitcnt lgkmcnt(14)
    v_mfma_f32_16x16x32_bf16 v[64:67], a[192:195], a[64:67], 0
    s_waitcnt lgkmcnt(12)
    s_add_u32 m0, s62, 0
    ds_read_b64_tr_b16 a[224:225], v56 offset:49152
    v_mfma_f32_16x16x32_bf16 v[64:67], a[196:199], a[68:71], v[64:67]
    s_xor_b32 s98, s65, 128
    ds_read_b64_tr_b16 a[226:227], v56 offset:51200
    v_mfma_f32_16x16x32_bf16 v[72:75], a[192:195], a[80:83], 0
    buffer_load_dwordx4 v24, s[28:31], s98 offen offset:0   lds
    v_mfma_f32_16x16x32_bf16 v[72:75], a[196:199], a[84:87], v[72:75]
    s_waitcnt lgkmcnt(12)
    ds_read_b64_tr_b16 a[228:229], v56 offset:53248
    v_mfma_f32_16x16x32_bf16 v[68:71], a[200:203], a[64:67], 0
    s_waitcnt lgkmcnt(11)
    ds_read_b64_tr_b16 a[230:231], v56 offset:55296
    v_mfma_f32_16x16x32_bf16 v[68:71], a[204:207], a[68:71], v[68:71]
    s_add_u32 s22, s22, 65536
    ds_read_b64_tr_b16 a[232:233], v57 offset:49152
    v_mfma_f32_16x16x32_bf16 v[76:79], a[200:203], a[80:83], 0
    buffer_load_dwordx4 v25, s[28:31], s98 offen offset:1024   lds
    ds_read_b64_tr_b16 a[234:235], v57 offset:51200
    v_mfma_f32_16x16x32_bf16 v[76:79], a[204:207], a[84:87], v[76:79]
    s_waitcnt lgkmcnt(12)
    s_add_u32 s23, s23, 65536
    ds_read_b64_tr_b16 a[236:237], v57 offset:53248
    v_mfma_f32_16x16x32_bf16 v[64:67], a[208:211], a[72:75], v[64:67]
    s_waitcnt lgkmcnt(11)
    s_lshl_b32 s24, s61, 2
    ds_read_b64_tr_b16 a[238:239], v57 offset:55296
    v_mfma_f32_16x16x32_bf16 v[64:67], a[212:215], a[76:79], v[64:67]
    s_add_u32 s24, s24, s3
    ds_read_b64_tr_b16 a[240:241], v56 offset:57344
    v_mfma_f32_16x16x32_bf16 v[72:75], a[208:211], a[88:91], v[72:75]
    buffer_load_dwordx4 v26, s[28:31], s98 offen offset:2048   lds
    v_mfma_f32_16x16x32_bf16 v[72:75], a[212:215], a[92:95], v[72:75]
    s_waitcnt lgkmcnt(7)
    s_lshl_b32 s24, s24, 3
    ds_read_b64_tr_b16 a[242:243], v56 offset:59392
    v_mfma_f32_16x16x32_bf16 v[68:71], a[216:219], a[72:75], v[68:71]
    s_add_u32 s24, s24, s4
    ds_read_b64_tr_b16 a[244:245], v56 offset:61440
    v_mfma_f32_16x16x32_bf16 v[68:71], a[220:223], a[76:79], v[68:71]
    s_lshl_b32 s24, s24, 2
    ds_read_b64_tr_b16 a[246:247], v56 offset:63488
    v_mfma_f32_16x16x32_bf16 v[76:79], a[216:219], a[88:91], v[76:79]
    buffer_load_dwordx4 v27, s[28:31], s98 offen offset:3072   lds
    ds_read_b64_tr_b16 a[248:249], v57 offset:57344
    v_mfma_f32_16x16x32_bf16 v[76:79], a[220:223], a[92:95], v[76:79]
    s_add_u32 m0, s62, 4096
    ds_read_b64_tr_b16 a[250:251], v57 offset:59392
    v_mfma_f32_16x16x32_bf16 v[64:67], a[224:227], a[96:99], v[64:67]
    s_waitcnt lgkmcnt(8)
    s_xor_b32 s98, s65, 32896
    ds_read_b64_tr_b16 a[252:253], v57 offset:61440
    v_mfma_f32_16x16x32_bf16 v[64:67], a[228:231], a[100:103], v[64:67]
    s_add_u32 s24, s24, s5
    ds_read_b64_tr_b16 a[254:255], v57 offset:63488
    v_mfma_f32_16x16x32_bf16 v[72:75], a[224:227], a[112:115], v[72:75]
    buffer_load_dwordx4 v24, s[28:31], s98 offen offset:0   lds
    v_mfma_f32_16x16x32_bf16 v[72:75], a[228:231], a[116:119], v[72:75]
    s_lshl_b32 s24, s24, 13
    ds_read_b64_tr_b16 a[192:193], v58 offset:32768
    v_mfma_f32_16x16x32_bf16 v[68:71], a[232:235], a[96:99], v[68:71]
    s_waitcnt lgkmcnt(8)
    s_add_u32 s24, s24, 50331648
    ds_read_b64_tr_b16 a[194:195], v58 offset:34816
    v_mfma_f32_16x16x32_bf16 v[68:71], a[236:239], a[100:103], v[68:71]
    ds_read_b64_tr_b16 a[196:197], v58 offset:36864
    v_mfma_f32_16x16x32_bf16 v[76:79], a[232:235], a[112:115], v[76:79]
    buffer_load_dwordx4 v25, s[28:31], s98 offen offset:1024   lds
    ds_read_b64_tr_b16 a[198:199], v58 offset:38912
    v_mfma_f32_16x16x32_bf16 v[76:79], a[236:239], a[116:119], v[76:79]
    s_waitcnt lgkmcnt(8)
    ds_read_b64_tr_b16 a[200:201], v59 offset:32768
    v_mfma_f32_16x16x32_bf16 v[64:67], a[240:243], a[104:107], v[64:67]
    ds_read_b64_tr_b16 a[202:203], v59 offset:34816
    v_mfma_f32_16x16x32_bf16 v[64:67], a[244:247], a[108:111], v[64:67]
    ds_read_b64_tr_b16 a[204:205], v59 offset:36864
    v_mfma_f32_16x16x32_bf16 v[72:75], a[240:243], a[120:123], v[72:75]
    buffer_load_dwordx4 v26, s[28:31], s98 offen offset:2048   lds
    ds_read_b64_tr_b16 a[206:207], v59 offset:38912
    v_mfma_f32_16x16x32_bf16 v[72:75], a[244:247], a[124:127], v[72:75]
    s_waitcnt lgkmcnt(8)
    ds_read_b64_tr_b16 a[208:209], v58 offset:40960
    v_mfma_f32_16x16x32_bf16 v[68:71], a[248:251], a[104:107], v[68:71]
    ds_read_b64_tr_b16 a[210:211], v58 offset:43008
    v_mfma_f32_16x16x32_bf16 v[68:71], a[252:255], a[108:111], v[68:71]
    ds_read_b64_tr_b16 a[212:213], v58 offset:45056
    v_mfma_f32_16x16x32_bf16 v[76:79], a[248:251], a[120:123], v[76:79]
    buffer_load_dwordx4 v27, s[28:31], s98 offen offset:3072   lds
    ds_read_b64_tr_b16 a[214:215], v58 offset:47104
    v_mfma_f32_16x16x32_bf16 v[76:79], a[252:255], a[124:127], v[76:79]
    s_waitcnt lgkmcnt(9)
    ds_read_b64_tr_b16 a[216:217], v59 offset:40960
    v_mfma_f32_16x16x32_bf16 v[80:83], a[192:195], a[64:67], 0
    s_waitcnt lgkmcnt(9)
    ds_read_b64_tr_b16 a[218:219], v59 offset:43008
    v_mfma_f32_16x16x32_bf16 v[80:83], a[196:199], a[68:71], v[80:83]
    ds_read_b64_tr_b16 a[220:221], v59 offset:45056
    v_mfma_f32_16x16x32_bf16 v[88:91], a[192:195], a[80:83], 0
    ds_read_b64_tr_b16 a[222:223], v59 offset:47104
    s_waitcnt vmcnt(16)
    s_barrier
    v_mfma_f32_16x16x32_bf16 v[88:91], a[196:199], a[84:87], v[88:91]
    s_waitcnt lgkmcnt(9)
    s_add_u32 m0, s62, 98304
    ds_read_b64_tr_b16 a[224:225], v58 offset:49152
    v_mfma_f32_16x16x32_bf16 v[84:87], a[200:203], a[64:67], 0
    s_waitcnt lgkmcnt(9)
    s_xor_b32 s98, s65, 262272
    ds_read_b64_tr_b16 a[226:227], v58 offset:51200
    v_mfma_f32_16x16x32_bf16 v[84:87], a[204:207], a[68:71], v[84:87]
    buffer_load_dwordx4 v24, s[28:31], s98 offen offset:0   lds
    ds_read_b64_tr_b16 a[228:229], v58 offset:53248
    v_mfma_f32_16x16x32_bf16 v[92:95], a[200:203], a[80:83], 0
    ds_read_b64_tr_b16 a[230:231], v58 offset:55296
    v_mfma_f32_16x16x32_bf16 v[92:95], a[204:207], a[84:87], v[92:95]
    s_waitcnt lgkmcnt(9)
    ds_read_b64_tr_b16 a[232:233], v59 offset:49152
    v_mfma_f32_16x16x32_bf16 v[80:83], a[208:211], a[72:75], v[80:83]
    s_waitcnt lgkmcnt(9)
    ds_read_b64_tr_b16 a[234:235], v59 offset:51200
    v_mfma_f32_16x16x32_bf16 v[80:83], a[212:215], a[76:79], v[80:83]
    buffer_load_dwordx4 v25, s[28:31], s98 offen offset:1024   lds
    ds_read_b64_tr_b16 a[236:237], v59 offset:53248
    v_mfma_f32_16x16x32_bf16 v[88:91], a[208:211], a[88:91], v[88:91]
    ds_read_b64_tr_b16 a[238:239], v59 offset:55296
    v_mfma_f32_16x16x32_bf16 v[88:91], a[212:215], a[92:95], v[88:91]
    s_waitcnt lgkmcnt(9)
    ds_read_b64_tr_b16 a[240:241], v58 offset:57344
    v_mfma_f32_16x16x32_bf16 v[84:87], a[216:219], a[72:75], v[84:87]
    s_waitcnt lgkmcnt(9)
    ds_read_b64_tr_b16 a[242:243], v58 offset:59392
    v_mfma_f32_16x16x32_bf16 v[84:87], a[220:223], a[76:79], v[84:87]
    buffer_load_dwordx4 v26, s[28:31], s98 offen offset:2048   lds
    ds_read_b64_tr_b16 a[244:245], v58 offset:61440
    v_mfma_f32_16x16x32_bf16 v[92:95], a[216:219], a[88:91], v[92:95]
    ds_read_b64_tr_b16 a[246:247], v58 offset:63488
    v_mfma_f32_16x16x32_bf16 v[92:95], a[220:223], a[92:95], v[92:95]
    s_waitcnt lgkmcnt(9)
    ds_read_b64_tr_b16 a[248:249], v59 offset:57344
    v_mfma_f32_16x16x32_bf16 v[80:83], a[224:227], a[96:99], v[80:83]
    s_waitcnt lgkmcnt(9)
    ds_read_b64_tr_b16 a[250:251], v59 offset:59392
    v_mfma_f32_16x16x32_bf16 v[80:83], a[228:231], a[100:103], v[80:83]
    buffer_load_dwordx4 v27, s[28:31], s98 offen offset:3072   lds
    ds_read_b64_tr_b16 a[252:253], v59 offset:61440
    v_mfma_f32_16x16x32_bf16 v[88:91], a[224:227], a[112:115], v[88:91]
    s_add_u32 m0, s62, 102400
    ds_read_b64_tr_b16 a[254:255], v59 offset:63488
    v_mfma_f32_16x16x32_bf16 v[88:91], a[228:231], a[116:119], v[88:91]
    s_waitcnt lgkmcnt(9)
    s_xor_b32 s98, s65, 295040
    ds_read_b64_tr_b16 a[192:193], v60 offset:0
    v_mfma_f32_16x16x32_bf16 v[84:87], a[232:235], a[96:99], v[84:87]
    s_waitcnt lgkmcnt(9)
    ds_read_b64_tr_b16 a[194:195], v60 offset:2048
    v_mfma_f32_16x16x32_bf16 v[84:87], a[236:239], a[100:103], v[84:87]
    buffer_load_dwordx4 v24, s[28:31], s98 offen offset:0   lds
    ds_read_b64_tr_b16 a[196:197], v60 offset:4096
    v_mfma_f32_16x16x32_bf16 v[92:95], a[232:235], a[112:115], v[92:95]
    ds_read_b64_tr_b16 a[198:199], v60 offset:6144
    v_mfma_f32_16x16x32_bf16 v[92:95], a[236:239], a[116:119], v[92:95]
    s_waitcnt lgkmcnt(9)
    ds_read_b64_tr_b16 a[200:201], v61 offset:0
    v_mfma_f32_16x16x32_bf16 v[80:83], a[240:243], a[104:107], v[80:83]
    s_waitcnt lgkmcnt(9)
    ds_read_b64_tr_b16 a[202:203], v61 offset:2048
    v_mfma_f32_16x16x32_bf16 v[80:83], a[244:247], a[108:111], v[80:83]
    buffer_load_dwordx4 v25, s[28:31], s98 offen offset:1024   lds
    ds_read_b64_tr_b16 a[204:205], v61 offset:4096
    v_mfma_f32_16x16x32_bf16 v[88:91], a[240:243], a[120:123], v[88:91]
    ds_read_b64_tr_b16 a[206:207], v61 offset:6144
    v_mfma_f32_16x16x32_bf16 v[88:91], a[244:247], a[124:127], v[88:91]
    s_waitcnt lgkmcnt(9)
    ds_read_b64_tr_b16 a[208:209], v60 offset:8192
    v_mfma_f32_16x16x32_bf16 v[84:87], a[248:251], a[104:107], v[84:87]
    s_waitcnt lgkmcnt(9)
    ds_read_b64_tr_b16 a[210:211], v60 offset:10240
    v_lshrrev_b32 v46, 2, v2
    v_mfma_f32_16x16x32_bf16 v[84:87], a[252:255], a[108:111], v[84:87]
    buffer_load_dwordx4 v26, s[28:31], s98 offen offset:2048   lds
    ds_read_b64_tr_b16 a[212:213], v60 offset:12288
    v_mfma_f32_16x16x32_bf16 v[92:95], a[248:251], a[120:123], v[92:95]
    ds_read_b64_tr_b16 a[214:215], v60 offset:14336
    v_and_b32 v45, 3, v2
    v_mfma_f32_16x16x32_bf16 v[92:95], a[252:255], a[124:127], v[92:95]
    s_waitcnt lgkmcnt(9)
    ds_read_b64_tr_b16 a[216:217], v61 offset:8192
    v_lshlrev_b32 v44, 8, v46
    v_mfma_f32_16x16x32_bf16 v[64:67], a[192:195], a[0:3], v[64:67]
    s_waitcnt lgkmcnt(9)
    ds_read_b64_tr_b16 a[218:219], v61 offset:10240
    v_lshl_add_u32 v44, v45, 4, v44
    v_mfma_f32_16x16x32_bf16 v[64:67], a[196:199], a[4:7], v[64:67]
    buffer_load_dwordx4 v27, s[28:31], s98 offen offset:3072   lds
    ds_read_b64_tr_b16 a[220:221], v61 offset:12288
    v_mfma_f32_16x16x32_bf16 v[72:75], a[192:195], a[16:19], v[72:75]
    ds_read_b64_tr_b16 a[222:223], v61 offset:14336
    v_lshlrev_b32 v45, 3, v45
    v_mfma_f32_16x16x32_bf16 v[72:75], a[196:199], a[20:23], v[72:75]
    s_waitcnt lgkmcnt(9)
    ds_read_b64_tr_b16 a[224:225], v60 offset:16384
    v_lshl_add_u32 v45, v46, 6, v45
    v_mfma_f32_16x16x32_bf16 v[68:71], a[200:203], a[0:3], v[68:71]
    s_waitcnt lgkmcnt(9)
    ds_read_b64_tr_b16 a[226:227], v60 offset:18432
    v_lshlrev_b32 v46, 1, v45
    v_mfma_f32_16x16x32_bf16 v[68:71], a[204:207], a[4:7], v[68:71]
    s_lshl_b32 s70, s2, 15
    ds_read_b64_tr_b16 a[228:229], v60 offset:20480
    v_mfma_f32_16x16x32_bf16 v[76:79], a[200:203], a[16:19], v[76:79]
    s_lshl_b32 s100, s3, 6
    ds_read_b64_tr_b16 a[230:231], v60 offset:22528
    v_mfma_f32_16x16x32_bf16 v[76:79], a[204:207], a[20:23], v[76:79]
    s_waitcnt lgkmcnt(9)
    s_add_u32 s70, s70, s100
    ds_read_b64_tr_b16 a[232:233], v61 offset:16384
    v_mfma_f32_16x16x32_bf16 v[64:67], a[208:211], a[8:11], v[64:67]
    s_waitcnt lgkmcnt(9)
    s_add_u32 s70, s70, 67108864
    ds_read_b64_tr_b16 a[234:235], v61 offset:18432
    v_mfma_f32_16x16x32_bf16 v[64:67], a[212:215], a[12:15], v[64:67]
    s_and_b32 s68, s2, 31
    ds_read_b64_tr_b16 a[236:237], v61 offset:20480
    v_mfma_f32_16x16x32_bf16 v[72:75], a[208:211], a[24:27], v[72:75]
    s_lshl_b32 s68, s68, 2
    ds_read_b64_tr_b16 a[238:239], v61 offset:22528
    v_mfma_f32_16x16x32_bf16 v[72:75], a[212:215], a[28:31], v[72:75]
    s_waitcnt lgkmcnt(9)
    s_add_u32 s68, s68, s3
    ds_read_b64_tr_b16 a[240:241], v60 offset:24576
    v_mfma_f32_16x16x32_bf16 v[68:71], a[216:219], a[8:11], v[68:71]
    s_waitcnt lgkmcnt(9)
    s_lshl_b32 s69, s61, 7
    ds_read_b64_tr_b16 a[242:243], v60 offset:26624
    v_mfma_f32_16x16x32_bf16 v[68:71], a[220:223], a[12:15], v[68:71]
    s_add_u32 s69, s69, s68
    ds_read_b64_tr_b16 a[244:245], v60 offset:28672
    v_mfma_f32_16x16x32_bf16 v[76:79], a[216:219], a[24:27], v[76:79]
    s_lshl_b32 s100, s60, 7
    ds_read_b64_tr_b16 a[246:247], v60 offset:30720
    v_mfma_f32_16x16x32_bf16 v[76:79], a[220:223], a[28:31], v[76:79]
    s_waitcnt lgkmcnt(9)
    s_add_u32 s68, s68, s100
    ds_read_b64_tr_b16 a[248:249], v61 offset:24576
    v_mfma_f32_16x16x32_bf16 v[64:67], a[224:227], a[32:35], v[64:67]
    s_waitcnt lgkmcnt(9)
    s_lshl_b32 s100, s68, 10
    ds_read_b64_tr_b16 a[250:251], v61 offset:26624
    v_mfma_f32_16x16x32_bf16 v[64:67], a[228:231], a[36:39], v[64:67]
    s_lshl_b32 s101, s69, 10
    ds_read_b64_tr_b16 a[252:253], v61 offset:28672
    v_mfma_f32_16x16x32_bf16 v[72:75], a[224:227], a[48:51], v[72:75]
    ds_read_b64_tr_b16 a[254:255], v61 offset:30720
    ds_read_b64_tr_b16 a[208:209], v62 offset:8192
    v_mfma_f32_16x16x32_bf16 v[72:75], a[228:231], a[52:55], v[72:75]
    s_waitcnt lgkmcnt(10)
    ds_read_b64_tr_b16 a[192:193], v62 offset:0
    ds_read_b64_tr_b16 a[210:211], v62 offset:10240
    v_mfma_f32_16x16x32_bf16 v[68:71], a[232:235], a[32:35], v[68:71]
    s_waitcnt lgkmcnt(11)
    ds_read_b64_tr_b16 a[194:195], v62 offset:2048
    ds_read_b64_tr_b16 a[212:213], v62 offset:12288
    v_mfma_f32_16x16x32_bf16 v[68:71], a[236:239], a[36:39], v[68:71]
    ds_read_b64_tr_b16 a[196:197], v62 offset:4096
    ds_read_b64_tr_b16 a[214:215], v62 offset:14336
    v_mfma_f32_16x16x32_bf16 v[76:79], a[232:235], a[48:51], v[76:79]
    ds_read_b64_tr_b16 a[198:199], v62 offset:6144
    ds_read_b64_tr_b16 a[216:217], v63 offset:8192
    v_mfma_f32_16x16x32_bf16 v[76:79], a[236:239], a[52:55], v[76:79]
    s_waitcnt lgkmcnt(14)
    ds_read_b64_tr_b16 a[200:201], v63 offset:0
    ds_read_b64_tr_b16 a[218:219], v63 offset:10240
    v_mfma_f32_16x16x32_bf16 v[64:67], a[240:243], a[40:43], v[64:67]
    s_waitcnt lgkmcnt(15)
    ds_read_b64_tr_b16 a[202:203], v63 offset:2048
    ds_read_b64_tr_b16 a[220:221], v63 offset:12288
    v_mfma_f32_16x16x32_bf16 v[64:67], a[244:247], a[44:47], v[64:67]
    ds_read_b64_tr_b16 a[204:205], v63 offset:4096
    ds_read_b64_tr_b16 a[222:223], v63 offset:14336
    v_mfma_f32_16x16x32_bf16 v[72:75], a[240:243], a[56:59], v[72:75]
    s_waitcnt lgkmcnt(15)
    ds_read_b64_tr_b16 a[206:207], v63 offset:6144
    s_waitcnt vmcnt(16)
    v_mfma_f32_16x16x32_bf16 v[72:75], a[244:247], a[60:63], v[72:75]
    buffer_store_dword v6, v5, s[8:11], s22 offen sc0 sc1
    v_mfma_f32_16x16x32_bf16 v[68:71], a[248:251], a[40:43], v[68:71]
    ds_read_b64_tr_b16 a[224:225], v62 offset:16384
    v_mfma_f32_16x16x32_bf16 v[68:71], a[252:255], a[44:47], v[68:71]
    ds_read_b64_tr_b16 a[226:227], v62 offset:18432
    v_mfma_f32_16x16x32_bf16 v[76:79], a[248:251], a[56:59], v[76:79]
    ds_read_b64_tr_b16 a[228:229], v62 offset:20480
    v_mfma_f32_16x16x32_bf16 v[76:79], a[252:255], a[60:63], v[76:79]
    s_waitcnt lgkmcnt(12)
    ds_read_b64_tr_b16 a[230:231], v62 offset:22528
    v_mfma_f32_16x16x32_bf16 v[80:83], a[192:195], a[0:3], v[80:83]
    s_waitcnt lgkmcnt(11)
    ds_read_b64_tr_b16 a[232:233], v63 offset:16384
    v_mfma_f32_16x16x32_bf16 v[80:83], a[196:199], a[4:7], v[80:83]
    ds_read_b64_tr_b16 a[234:235], v63 offset:18432
    v_mfma_f32_16x16x32_bf16 v[88:91], a[192:195], a[16:19], v[88:91]
    ds_read_b64_tr_b16 a[236:237], v63 offset:20480
    v_mfma_f32_16x16x32_bf16 v[88:91], a[196:199], a[20:23], v[88:91]
    s_waitcnt lgkmcnt(8)
    ds_read_b64_tr_b16 a[238:239], v63 offset:22528
    v_mfma_f32_16x16x32_bf16 v[84:87], a[200:203], a[0:3], v[84:87]
    s_waitcnt lgkmcnt(8)
    ds_read_b64_tr_b16 a[240:241], v62 offset:24576
    v_mfma_f32_16x16x32_bf16 v[84:87], a[204:207], a[4:7], v[84:87]
    ds_read_b64_tr_b16 a[242:243], v62 offset:26624
    v_mfma_f32_16x16x32_bf16 v[92:95], a[200:203], a[16:19], v[92:95]
    ds_read_b64_tr_b16 a[244:245], v62 offset:28672
    v_cvt_pk_bf16_f32 v64, v64, v65
    s_waitcnt vmcnt(1)
    s_barrier
    v_mfma_f32_16x16x32_bf16 v[92:95], a[204:207], a[20:23], v[92:95]
    s_xor_b32 s74, s24, 0
    ds_read_b64_tr_b16 a[246:247], v62 offset:30720
    v_cvt_pk_bf16_f32 v65, v66, v67
    v_mfma_f32_16x16x32_bf16 v[80:83], a[208:211], a[8:11], v[80:83]
    buffer_load_dwordx4 v[128:131], v1, s[8:11], s74 offen offset:0
    v_mfma_f32_16x16x32_bf16 v[80:83], a[212:215], a[12:15], v[80:83]
    s_xor_b32 s74, s24, 4096
    ds_read_b64_tr_b16 a[248:249], v63 offset:24576
    v_cvt_pk_bf16_f32 v66, v68, v69
    v_mfma_f32_16x16x32_bf16 v[88:91], a[208:211], a[24:27], v[88:91]
    ds_read_b64_tr_b16 a[250:251], v63 offset:26624
    v_cvt_pk_bf16_f32 v67, v70, v71
    v_mfma_f32_16x16x32_bf16 v[88:91], a[212:215], a[28:31], v[88:91]
    buffer_load_dwordx4 v[144:147], v1, s[8:11], s74 offen offset:0
    ds_read_b64_tr_b16 a[252:253], v63 offset:28672
    v_mfma_f32_16x16x32_bf16 v[84:87], a[216:219], a[8:11], v[84:87]
    s_xor_b32 s74, s24, 0
    ds_read_b64_tr_b16 a[254:255], v63 offset:30720
    v_min_u32 v64, -2, v64
    v_mfma_f32_16x16x32_bf16 v[84:87], a[220:223], a[12:15], v[84:87]
    ds_read_b64_tr_b16 a[192:193], v56 offset:0
    v_min_u32 v65, -2, v65
    v_mfma_f32_16x16x32_bf16 v[92:95], a[216:219], a[24:27], v[92:95]
    buffer_load_dwordx4 v[132:135], v1, s[8:11], s74 offen offset:1024
    v_mfma_f32_16x16x32_bf16 v[92:95], a[220:223], a[28:31], v[92:95]
    s_waitcnt lgkmcnt(7)
    s_xor_b32 s74, s24, 4096
    ds_read_b64_tr_b16 a[194:195], v56 offset:2048
    v_min_u32 v66, -2, v66
    v_mfma_f32_16x16x32_bf16 v[80:83], a[224:227], a[32:35], v[80:83]
    ds_read_b64_tr_b16 a[196:197], v56 offset:4096
    v_min_u32 v67, -2, v67
    v_mfma_f32_16x16x32_bf16 v[80:83], a[228:231], a[36:39], v[80:83]
    buffer_load_dwordx4 v[148:151], v1, s[8:11], s74 offen offset:1024
    v_mfma_f32_16x16x32_bf16 v[88:91], a[224:227], a[48:51], v[88:91]
    s_xor_b32 s74, s24, 0
    ds_read_b64_tr_b16 a[198:199], v56 offset:6144
    v_mfma_f32_16x16x32_bf16 v[88:91], a[228:231], a[52:55], v[88:91]
    s_add_u32 s75, s18, 0
    ds_read_b64_tr_b16 a[200:201], v57 offset:0
    v_mfma_f32_16x16x32_bf16 v[84:87], a[232:235], a[32:35], v[84:87]
    buffer_load_dwordx4 v[136:139], v1, s[8:11], s74 offen offset:2048
    ds_read_b64_tr_b16 a[202:203], v57 offset:2048
    v_mfma_f32_16x16x32_bf16 v[84:87], a[236:239], a[36:39], v[84:87]
    s_xor_b32 s74, s24, 4096
    ds_read_b64_tr_b16 a[204:205], v57 offset:4096
    v_mfma_f32_16x16x32_bf16 v[92:95], a[232:235], a[48:51], v[92:95]
    buffer_store_dwordx4 v[64:67], v23, s[8:11], s75 offen offset:0 sc0 sc1
    ds_read_b64_tr_b16 a[206:207], v57 offset:6144
    v_mfma_f32_16x16x32_bf16 v[92:95], a[236:239], a[52:55], v[92:95]
    buffer_load_dwordx4 v[152:155], v1, s[8:11], s74 offen offset:2048
    v_mfma_f32_16x16x32_bf16 v[80:83], a[240:243], a[40:43], v[80:83]
    s_waitcnt lgkmcnt(7)
    s_xor_b32 s74, s24, 0
    ds_read_b64_tr_b16 a[208:209], v56 offset:8192
    v_cvt_pk_bf16_f32 v72, v72, v73
    v_mfma_f32_16x16x32_bf16 v[80:83], a[244:247], a[44:47], v[80:83]
    ds_read_b64_tr_b16 a[210:211], v56 offset:10240
    v_cvt_pk_bf16_f32 v73, v74, v75
    v_mfma_f32_16x16x32_bf16 v[88:91], a[240:243], a[56:59], v[88:91]
    buffer_load_dwordx4 v[140:143], v1, s[8:11], s74 offen offset:3072
    v_mfma_f32_16x16x32_bf16 v[88:91], a[244:247], a[60:63], v[88:91]
    s_xor_b32 s74, s24, 4096
    ds_read_b64_tr_b16 a[212:213], v56 offset:12288
    v_cvt_pk_bf16_f32 v74, v76, v77
    v_mfma_f32_16x16x32_bf16 v[84:87], a[248:251], a[40:43], v[84:87]
    ds_read_b64_tr_b16 a[214:215], v56 offset:14336
    v_cvt_pk_bf16_f32 v75, v78, v79
    v_mfma_f32_16x16x32_bf16 v[84:87], a[252:255], a[44:47], v[84:87]
    buffer_load_dwordx4 v[156:159], v1, s[8:11], s74 offen offset:3072
    ds_read_b64_tr_b16 a[216:217], v57 offset:8192
    v_mfma_f32_16x16x32_bf16 v[92:95], a[248:251], a[56:59], v[92:95]
    ds_read_b64_tr_b16 a[218:219], v57 offset:10240
    v_min_u32 v72, -2, v72
    v_mfma_f32_16x16x32_bf16 v[92:95], a[252:255], a[60:63], v[92:95]
    s_waitcnt lgkmcnt(7)
    ds_read_b64_tr_b16 a[220:221], v57 offset:12288
    v_min_u32 v73, -2, v73
    v_mfma_f32_16x16x32_bf16 v[96:99], a[192:195], a[64:67], 0
    ds_read_b64_tr_b16 a[222:223], v57 offset:14336
    v_min_u32 v74, -2, v74
    v_mfma_f32_16x16x32_bf16 v[96:99], a[196:199], a[68:71], v[96:99]
    ds_read_b64_tr_b16 a[224:225], v56 offset:16384
    v_min_u32 v75, -2, v75
    v_mfma_f32_16x16x32_bf16 v[104:107], a[192:195], a[80:83], 0
    s_add_u32 s75, s18, 131072
    ds_read_b64_tr_b16 a[226:227], v56 offset:18432
    v_mfma_f32_16x16x32_bf16 v[104:107], a[196:199], a[84:87], v[104:107]
    buffer_store_dwordx4 v[72:75], v23, s[8:11], s75 offen offset:0 sc0 sc1
    ds_read_b64_tr_b16 a[228:229], v56 offset:20480
    v_mfma_f32_16x16x32_bf16 v[100:103], a[200:203], a[64:67], 0
    s_waitcnt lgkmcnt(9)
    ds_read_b64_tr_b16 a[230:231], v56 offset:22528
    v_mfma_f32_16x16x32_bf16 v[100:103], a[204:207], a[68:71], v[100:103]
    ds_read_b64_tr_b16 a[232:233], v57 offset:16384
    v_mfma_f32_16x16x32_bf16 v[108:111], a[200:203], a[80:83], 0
    ds_read_b64_tr_b16 a[234:235], v57 offset:18432
    v_mfma_f32_16x16x32_bf16 v[108:111], a[204:207], a[84:87], v[108:111]
    ds_read_b64_tr_b16 a[236:237], v57 offset:20480
    v_mfma_f32_16x16x32_bf16 v[96:99], a[208:211], a[72:75], v[96:99]
    s_waitcnt lgkmcnt(9)
    ds_read_b64_tr_b16 a[238:239], v57 offset:22528
    v_mfma_f32_16x16x32_bf16 v[96:99], a[212:215], a[76:79], v[96:99]
    ds_read_b64_tr_b16 a[240:241], v56 offset:24576
    v_mfma_f32_16x16x32_bf16 v[104:107], a[208:211], a[88:91], v[104:107]
    ds_read_b64_tr_b16 a[242:243], v56 offset:26624
    v_mfma_f32_16x16x32_bf16 v[104:107], a[212:215], a[92:95], v[104:107]
    ds_read_b64_tr_b16 a[244:245], v56 offset:28672
    v_mfma_f32_16x16x32_bf16 v[100:103], a[216:219], a[72:75], v[100:103]
    s_waitcnt lgkmcnt(9)
    ds_read_b64_tr_b16 a[246:247], v56 offset:30720
    v_mfma_f32_16x16x32_bf16 v[100:103], a[220:223], a[76:79], v[100:103]
    ds_read_b64_tr_b16 a[248:249], v57 offset:24576
    v_mfma_f32_16x16x32_bf16 v[108:111], a[216:219], a[88:91], v[108:111]
    ds_read_b64_tr_b16 a[250:251], v57 offset:26624
    v_mfma_f32_16x16x32_bf16 v[108:111], a[220:223], a[92:95], v[108:111]
    ds_read_b64_tr_b16 a[252:253], v57 offset:28672
    v_mfma_f32_16x16x32_bf16 v[96:99], a[224:227], a[96:99], v[96:99]
    s_waitcnt lgkmcnt(9)
    ds_read_b64_tr_b16 a[254:255], v57 offset:30720
    v_mfma_f32_16x16x32_bf16 v[96:99], a[228:231], a[100:103], v[96:99]
    ds_read_b64_tr_b16 a[192:193], v60 offset:32768
    v_mfma_f32_16x16x32_bf16 v[104:107], a[224:227], a[112:115], v[104:107]
    ds_read_b64_tr_b16 a[194:195], v60 offset:34816
    v_mfma_f32_16x16x32_bf16 v[104:107], a[228:231], a[116:119], v[104:107]
    ds_read_b64_tr_b16 a[196:197], v60 offset:36864
    v_mfma_f32_16x16x32_bf16 v[100:103], a[232:235], a[96:99], v[100:103]
    s_waitcnt lgkmcnt(9)
    ds_read_b64_tr_b16 a[198:199], v60 offset:38912
    v_cvt_pk_bf16_f32 v80, v80, v81
    v_mfma_f32_16x16x32_bf16 v[100:103], a[236:239], a[100:103], v[100:103]
    ds_read_b64_tr_b16 a[200:201], v61 offset:32768
    v_cvt_pk_bf16_f32 v81, v82, v83
    v_mfma_f32_16x16x32_bf16 v[108:111], a[232:235], a[112:115], v[108:111]
    ds_read_b64_tr_b16 a[202:203], v61 offset:34816
    v_cvt_pk_bf16_f32 v82, v84, v85
    v_mfma_f32_16x16x32_bf16 v[108:111], a[236:239], a[116:119], v[108:111]
    ds_read_b64_tr_b16 a[204:205], v61 offset:36864
    v_cvt_pk_bf16_f32 v83, v86, v87
    v_mfma_f32_16x16x32_bf16 v[96:99], a[240:243], a[104:107], v[96:99]
    s_waitcnt lgkmcnt(9)
    ds_read_b64_tr_b16 a[206:207], v61 offset:38912
    v_min_u32 v80, -2, v80
    v_mfma_f32_16x16x32_bf16 v[96:99], a[244:247], a[108:111], v[96:99]
    ds_read_b64_tr_b16 a[208:209], v60 offset:40960
    v_min_u32 v81, -2, v81
    v_mfma_f32_16x16x32_bf16 v[104:107], a[240:243], a[120:123], v[104:107]
    ds_read_b64_tr_b16 a[210:211], v60 offset:43008
    v_min_u32 v82, -2, v82
    v_mfma_f32_16x16x32_bf16 v[104:107], a[244:247], a[124:127], v[104:107]
    buffer_load_dword v3, v4, s[8:11], s23 offen sc0 sc1
    ds_read_b64_tr_b16 a[212:213], v60 offset:45056
    v_mfma_f32_16x16x32_bf16 v[100:103], a[248:251], a[104:107], v[100:103]
    s_waitcnt lgkmcnt(9)
    ds_read_b64_tr_b16 a[214:215], v60 offset:47104
    v_min_u32 v83, -2, v83
    v_mfma_f32_16x16x32_bf16 v[100:103], a[252:255], a[108:111], v[100:103]
    s_add_u32 s75, s18, 0
    ds_read_b64_tr_b16 a[216:217], v61 offset:40960
    v_mfma_f32_16x16x32_bf16 v[108:111], a[248:251], a[120:123], v[108:111]
    buffer_store_dwordx4 v[80:83], v23, s[8:11], s75 offen offset:256 sc0 sc1
    ds_read_b64_tr_b16 a[218:219], v61 offset:43008
    v_mfma_f32_16x16x32_bf16 v[108:111], a[252:255], a[124:127], v[108:111]
    ds_read_b64_tr_b16 a[220:221], v61 offset:45056
    v_cvt_pk_bf16_f32 v88, v88, v89
    v_mfma_f32_16x16x32_bf16 v[96:99], a[192:195], a[0:3], v[96:99]
    s_waitcnt lgkmcnt(9)
    ds_read_b64_tr_b16 a[222:223], v61 offset:47104
    v_cvt_pk_bf16_f32 v89, v90, v91
    v_mfma_f32_16x16x32_bf16 v[96:99], a[196:199], a[4:7], v[96:99]
    ds_read_b64_tr_b16 a[224:225], v60 offset:49152
    v_cvt_pk_bf16_f32 v90, v92, v93
    v_mfma_f32_16x16x32_bf16 v[104:107], a[192:195], a[16:19], v[104:107]
    ds_read_b64_tr_b16 a[226:227], v60 offset:51200
    v_cvt_pk_bf16_f32 v91, v94, v95
    v_mfma_f32_16x16x32_bf16 v[104:107], a[196:199], a[20:23], v[104:107]
    ds_read_b64_tr_b16 a[228:229], v60 offset:53248
    v_min_u32 v88, -2, v88
    v_mfma_f32_16x16x32_bf16 v[100:103], a[200:203], a[0:3], v[100:103]
    s_waitcnt lgkmcnt(9)
    ds_read_b64_tr_b16 a[230:231], v60 offset:55296
    v_min_u32 v89, -2, v89
    v_mfma_f32_16x16x32_bf16 v[100:103], a[204:207], a[4:7], v[100:103]
    ds_read_b64_tr_b16 a[232:233], v61 offset:49152
    v_min_u32 v90, -2, v90
    v_mfma_f32_16x16x32_bf16 v[108:111], a[200:203], a[16:19], v[108:111]
    ds_read_b64_tr_b16 a[234:235], v61 offset:51200
    v_min_u32 v91, -2, v91
    v_mfma_f32_16x16x32_bf16 v[108:111], a[204:207], a[20:23], v[108:111]
    s_waitcnt lgkmcnt(9)
    s_add_u32 s75, s18, 131072
    ds_read_b64_tr_b16 a[236:237], v61 offset:53248
    v_mfma_f32_16x16x32_bf16 v[96:99], a[208:211], a[8:11], v[96:99]
    buffer_store_dwordx4 v[88:91], v23, s[8:11], s75 offen offset:256 sc0 sc1
    ds_read_b64_tr_b16 a[238:239], v61 offset:55296
    v_mfma_f32_16x16x32_bf16 v[96:99], a[212:215], a[12:15], v[96:99]
    ds_read_b64_tr_b16 a[240:241], v60 offset:57344
    v_mfma_f32_16x16x32_bf16 v[104:107], a[208:211], a[24:27], v[104:107]
    ds_read_b64_tr_b16 a[242:243], v60 offset:59392
    v_mfma_f32_16x16x32_bf16 v[104:107], a[212:215], a[28:31], v[104:107]
    s_waitcnt lgkmcnt(9)
    ds_read_b64_tr_b16 a[244:245], v60 offset:61440
    v_mfma_f32_16x16x32_bf16 v[100:103], a[216:219], a[8:11], v[100:103]
    ds_read_b64_tr_b16 a[246:247], v60 offset:63488
    v_mfma_f32_16x16x32_bf16 v[100:103], a[220:223], a[12:15], v[100:103]
    ds_read_b64_tr_b16 a[248:249], v61 offset:57344
    v_mfma_f32_16x16x32_bf16 v[108:111], a[216:219], a[24:27], v[108:111]
    ds_read_b64_tr_b16 a[250:251], v61 offset:59392
    v_mfma_f32_16x16x32_bf16 v[108:111], a[220:223], a[28:31], v[108:111]
    s_waitcnt lgkmcnt(9)
    ds_read_b64_tr_b16 a[252:253], v61 offset:61440
    v_mfma_f32_16x16x32_bf16 v[96:99], a[224:227], a[32:35], v[96:99]
    ds_read_b64_tr_b16 a[254:255], v61 offset:63488
    v_mfma_f32_16x16x32_bf16 v[96:99], a[228:231], a[36:39], v[96:99]
    ds_read_b64_tr_b16 a[192:193], v58 offset:0
    v_mfma_f32_16x16x32_bf16 v[104:107], a[224:227], a[48:51], v[104:107]
    ds_read_b64_tr_b16 a[194:195], v58 offset:2048
    v_mfma_f32_16x16x32_bf16 v[104:107], a[228:231], a[52:55], v[104:107]
    s_waitcnt lgkmcnt(9)
    ds_read_b64_tr_b16 a[196:197], v58 offset:4096
    v_mfma_f32_16x16x32_bf16 v[100:103], a[232:235], a[32:35], v[100:103]
    ds_read_b64_tr_b16 a[198:199], v58 offset:6144
    v_mfma_f32_16x16x32_bf16 v[100:103], a[236:239], a[36:39], v[100:103]
    ds_read_b64_tr_b16 a[200:201], v59 offset:0
    v_mfma_f32_16x16x32_bf16 v[108:111], a[232:235], a[48:51], v[108:111]
    ds_read_b64_tr_b16 a[202:203], v59 offset:2048
    v_mfma_f32_16x16x32_bf16 v[108:111], a[236:239], a[52:55], v[108:111]
    s_waitcnt lgkmcnt(9)
    ds_read_b64_tr_b16 a[204:205], v59 offset:4096
    v_mfma_f32_16x16x32_bf16 v[96:99], a[240:243], a[40:43], v[96:99]
    ds_read_b64_tr_b16 a[206:207], v59 offset:6144
    v_mfma_f32_16x16x32_bf16 v[96:99], a[244:247], a[44:47], v[96:99]
    ds_read_b64_tr_b16 a[208:209], v58 offset:8192
    v_mfma_f32_16x16x32_bf16 v[104:107], a[240:243], a[56:59], v[104:107]
    ds_read_b64_tr_b16 a[210:211], v58 offset:10240
    v_mfma_f32_16x16x32_bf16 v[104:107], a[244:247], a[60:63], v[104:107]
    s_waitcnt lgkmcnt(9)
    ds_read_b64_tr_b16 a[212:213], v58 offset:12288
    v_mfma_f32_16x16x32_bf16 v[100:103], a[248:251], a[40:43], v[100:103]
    ds_read_b64_tr_b16 a[214:215], v58 offset:14336
    v_mfma_f32_16x16x32_bf16 v[100:103], a[252:255], a[44:47], v[100:103]
    ds_read_b64_tr_b16 a[216:217], v59 offset:8192
    v_mfma_f32_16x16x32_bf16 v[108:111], a[248:251], a[56:59], v[108:111]
    ds_read_b64_tr_b16 a[218:219], v59 offset:10240
    v_mfma_f32_16x16x32_bf16 v[108:111], a[252:255], a[60:63], v[108:111]
    s_waitcnt lgkmcnt(9)
    ds_read_b64_tr_b16 a[220:221], v59 offset:12288
    v_mfma_f32_16x16x32_bf16 v[112:115], a[192:195], a[64:67], 0
    ds_read_b64_tr_b16 a[222:223], v59 offset:14336
    v_mfma_f32_16x16x32_bf16 v[112:115], a[196:199], a[68:71], v[112:115]
    ds_read_b64_tr_b16 a[224:225], v58 offset:16384
    v_mfma_f32_16x16x32_bf16 v[120:123], a[192:195], a[80:83], 0
    ds_read_b64_tr_b16 a[226:227], v58 offset:18432
    v_mfma_f32_16x16x32_bf16 v[120:123], a[196:199], a[84:87], v[120:123]
    s_waitcnt lgkmcnt(9)
    ds_read_b64_tr_b16 a[228:229], v58 offset:20480
    v_mfma_f32_16x16x32_bf16 v[116:119], a[200:203], a[64:67], 0
    ds_read_b64_tr_b16 a[230:231], v58 offset:22528
    v_mfma_f32_16x16x32_bf16 v[116:119], a[204:207], a[68:71], v[116:119]
    ds_read_b64_tr_b16 a[232:233], v59 offset:16384
    v_mfma_f32_16x16x32_bf16 v[124:127], a[200:203], a[80:83], 0
    ds_read_b64_tr_b16 a[234:235], v59 offset:18432
    v_mfma_f32_16x16x32_bf16 v[124:127], a[204:207], a[84:87], v[124:127]
    s_waitcnt lgkmcnt(9)
    ds_read_b64_tr_b16 a[236:237], v59 offset:20480
    v_mfma_f32_16x16x32_bf16 v[112:115], a[208:211], a[72:75], v[112:115]
    ds_read_b64_tr_b16 a[238:239], v59 offset:22528
    v_cvt_pk_bf16_f32 v96, v96, v97
    s_waitcnt vmcnt(2)
    v_cmp_ne_u32 vcc, 0, v3
    s_cmp_eq_u64 vcc, -1
    s_cbranch_scc0 L_C2_slow_13
L_C2_ok_14:
    v_mfma_f32_16x16x32_bf16 v[112:115], a[212:215], a[76:79], v[112:115]
    s_xor_b32 s74, s24, 8192
    ds_read_b64_tr_b16 a[240:241], v58 offset:24576
    v_cvt_pk_bf16_f32 v97, v98, v99
    v_mfma_f32_16x16x32_bf16 v[120:123], a[208:211], a[88:91], v[120:123]
    buffer_load_dwordx4 v[160:163], v1, s[8:11], s74 offen offset:0
    v_mfma_f32_16x16x32_bf16 v[120:123], a[212:215], a[92:95], v[120:123]
    s_waitcnt lgkmcnt(8)
    s_xor_b32 s74, s24, 12288
    ds_read_b64_tr_b16 a[242:243], v58 offset:26624
    v_cvt_pk_bf16_f32 v98, v100, v101
    v_mfma_f32_16x16x32_bf16 v[116:119], a[216:219], a[72:75], v[116:119]
    ds_read_b64_tr_b16 a[244:245], v58 offset:28672
    v_cvt_pk_bf16_f32 v99, v102, v103
    v_mfma_f32_16x16x32_bf16 v[116:119], a[220:223], a[76:79], v[116:119]
    ds_read_b64_tr_b16 a[246:247], v58 offset:30720
    v_min_u32 v96, -2, v96
    v_mfma_f32_16x16x32_bf16 v[124:127], a[216:219], a[88:91], v[124:127]
    buffer_load_dwordx4 v[176:179], v1, s[8:11], s74 offen offset:0
    ds_read_b64_tr_b16 a[248:249], v59 offset:24576
    v_mfma_f32_16x16x32_bf16 v[124:127], a[220:223], a[92:95], v[124:127]
    s_waitcnt lgkmcnt(8)
    s_xor_b32 s74, s24, 8192
    ds_read_b64_tr_b16 a[250:251], v59 offset:26624
    v_min_u32 v97, -2, v97
    v_mfma_f32_16x16x32_bf16 v[112:115], a[224:227], a[96:99], v[112:115]
    ds_read_b64_tr_b16 a[252:253], v59 offset:28672
    v_min_u32 v98, -2, v98
    v_mfma_f32_16x16x32_bf16 v[112:115], a[228:231], a[100:103], v[112:115]
    ds_read_b64_tr_b16 a[254:255], v59 offset:30720
    v_min_u32 v99, -2, v99
    v_mfma_f32_16x16x32_bf16 v[120:123], a[224:227], a[112:115], v[120:123]
    buffer_load_dwordx4 v[164:167], v1, s[8:11], s74 offen offset:1024
    v_mfma_f32_16x16x32_bf16 v[120:123], a[228:231], a[116:119], v[120:123]
    s_waitcnt lgkmcnt(7)
    s_xor_b32 s74, s24, 12288
    ds_read_b64_tr_b16 a[192:193], v62 offset:32768
    v_mfma_f32_16x16x32_bf16 v[116:119], a[232:235], a[96:99], v[116:119]
    s_add_u32 s75, s18, 0
    ds_read_b64_tr_b16 a[194:195], v62 offset:34816
    v_mfma_f32_16x16x32_bf16 v[116:119], a[236:239], a[100:103], v[116:119]
    buffer_store_dwordx4 v[96:99], v23, s[8:11], s75 offen offset:512 sc0 sc1
    ds_read_b64_tr_b16 a[196:197], v62 offset:36864
    v_mfma_f32_16x16x32_bf16 v[124:127], a[232:235], a[112:115], v[124:127]
    buffer_load_dwordx4 v[180:183], v1, s[8:11], s74 offen offset:1024
    ds_read_b64_tr_b16 a[198:199], v62 offset:38912
    v_mfma_f32_16x16x32_bf16 v[124:127], a[236:239], a[116:119], v[124:127]
    s_waitcnt lgkmcnt(8)
    s_xor_b32 s74, s24, 8192
    ds_read_b64_tr_b16 a[200:201], v63 offset:32768
    v_cvt_pk_bf16_f32 v104, v104, v105
    v_mfma_f32_16x16x32_bf16 v[112:115], a[240:243], a[104:107], v[112:115]
    ds_read_b64_tr_b16 a[202:203], v63 offset:34816
    v_cvt_pk_bf16_f32 v105, v106, v107
    v_mfma_f32_16x16x32_bf16 v[112:115], a[244:247], a[108:111], v[112:115]
    ds_read_b64_tr_b16 a[204:205], v63 offset:36864
    v_cvt_pk_bf16_f32 v106, v108, v109
    v_mfma_f32_16x16x32_bf16 v[120:123], a[240:243], a[120:123], v[120:123]
    buffer_load_dwordx4 v[168:171], v1, s[8:11], s74 offen offset:2048
    ds_read_b64_tr_b16 a[206:207], v63 offset:38912
    v_mfma_f32_16x16x32_bf16 v[120:123], a[244:247], a[124:127], v[120:123]
    s_waitcnt lgkmcnt(8)
    s_xor_b32 s74, s24, 12288
    ds_read_b64_tr_b16 a[208:209], v62 offset:40960
    v_cvt_pk_bf16_f32 v107, v110, v111
    v_mfma_f32_16x16x32_bf16 v[116:119], a[248:251], a[104:107], v[116:119]
    ds_read_b64_tr_b16 a[210:211], v62 offset:43008
    v_min_u32 v104, -2, v104
    v_mfma_f32_16x16x32_bf16 v[116:119], a[252:255], a[108:111], v[116:119]
    ds_read_b64_tr_b16 a[212:213], v62 offset:45056
    v_min_u32 v105, -2, v105
    v_mfma_f32_16x16x32_bf16 v[124:127], a[248:251], a[120:123], v[124:127]
    buffer_load_dwordx4 v[184:187], v1, s[8:11], s74 offen offset:2048
    ds_read_b64_tr_b16 a[214:215], v62 offset:47104
    v_mfma_f32_16x16x32_bf16 v[124:127], a[252:255], a[124:127], v[124:127]
    s_waitcnt lgkmcnt(9)
    s_xor_b32 s74, s24, 8192
    ds_read_b64_tr_b16 a[216:217], v63 offset:40960
    v_min_u32 v106, -2, v106
    v_mfma_f32_16x16x32_bf16 v[112:115], a[192:195], a[0:3], v[112:115]
    s_waitcnt lgkmcnt(9)
    ds_read_b64_tr_b16 a[218:219], v63 offset:43008
    v_min_u32 v107, -2, v107
    v_mfma_f32_16x16x32_bf16 v[112:115], a[196:199], a[4:7], v[112:115]
    s_add_u32 s75, s18, 131072
    ds_read_b64_tr_b16 a[220:221], v63 offset:45056
    v_mfma_f32_16x16x32_bf16 v[120:123], a[192:195], a[16:19], v[120:123]
    buffer_load_dwordx4 v[172:175], v1, s[8:11], s74 offen offset:3072
    ds_read_b64_tr_b16 a[222:223], v63 offset:47104
    v_mfma_f32_16x16x32_bf16 v[120:123], a[196:199], a[20:23], v[120:123]
    s_waitcnt lgkmcnt(8)
    s_xor_b32 s74, s24, 12288
    ds_read_b64_tr_b16 a[224:225], v62 offset:49152
    v_mfma_f32_16x16x32_bf16 v[116:119], a[200:203], a[0:3], v[116:119]
    buffer_store_dwordx4 v[104:107], v23, s[8:11], s75 offen offset:512 sc0 sc1
    ds_read_b64_tr_b16 a[226:227], v62 offset:51200
    v_mfma_f32_16x16x32_bf16 v[116:119], a[204:207], a[4:7], v[116:119]
    ds_read_b64_tr_b16 a[228:229], v62 offset:53248
    v_mfma_f32_16x16x32_bf16 v[124:127], a[200:203], a[16:19], v[124:127]
    buffer_load_dwordx4 v[188:191], v1, s[8:11], s74 offen offset:3072
    ds_read_b64_tr_b16 a[230:231], v62 offset:55296
    v_mfma_f32_16x16x32_bf16 v[124:127], a[204:207], a[20:23], v[124:127]
    s_waitcnt lgkmcnt(9)
    ds_read_b64_tr_b16 a[232:233], v63 offset:49152
    v_mfma_f32_16x16x32_bf16 v[112:115], a[208:211], a[8:11], v[112:115]
    s_waitcnt lgkmcnt(9)
    ds_read_b64_tr_b16 a[234:235], v63 offset:51200
    v_mfma_f32_16x16x32_bf16 v[112:115], a[212:215], a[12:15], v[112:115]
    ds_read_b64_tr_b16 a[236:237], v63 offset:53248
    v_mfma_f32_16x16x32_bf16 v[120:123], a[208:211], a[24:27], v[120:123]
    ds_read_b64_tr_b16 a[238:239], v63 offset:55296
    v_mfma_f32_16x16x32_bf16 v[120:123], a[212:215], a[28:31], v[120:123]
    s_waitcnt lgkmcnt(9)
    ds_read_b64_tr_b16 a[240:241], v62 offset:57344
    v_mfma_f32_16x16x32_bf16 v[116:119], a[216:219], a[8:11], v[116:119]
    s_waitcnt lgkmcnt(9)
    ds_read_b64_tr_b16 a[242:243], v62 offset:59392
    v_mfma_f32_16x16x32_bf16 v[116:119], a[220:223], a[12:15], v[116:119]
    ds_read_b64_tr_b16 a[244:245], v62 offset:61440
    v_mfma_f32_16x16x32_bf16 v[124:127], a[216:219], a[24:27], v[124:127]
    ds_read_b64_tr_b16 a[246:247], v62 offset:63488
    v_mfma_f32_16x16x32_bf16 v[124:127], a[220:223], a[28:31], v[124:127]
    s_waitcnt lgkmcnt(9)
    ds_read_b64_tr_b16 a[248:249], v63 offset:57344
    v_mfma_f32_16x16x32_bf16 v[112:115], a[224:227], a[32:35], v[112:115]
    s_waitcnt lgkmcnt(9)
    ds_read_b64_tr_b16 a[250:251], v63 offset:59392
    ds_read_b64_tr_b16 a[208:209], v56 offset:40960
    v_mfma_f32_16x16x32_bf16 v[112:115], a[228:231], a[36:39], v[112:115]
    ds_read_b64_tr_b16 a[252:253], v63 offset:61440
    ds_read_b64_tr_b16 a[210:211], v56 offset:43008
    v_mfma_f32_16x16x32_bf16 v[120:123], a[224:227], a[48:51], v[120:123]
    ds_read_b64_tr_b16 a[254:255], v63 offset:63488
    ds_read_b64_tr_b16 a[212:213], v56 offset:45056
    v_mfma_f32_16x16x32_bf16 v[120:123], a[228:231], a[52:55], v[120:123]
    s_waitcnt lgkmcnt(12)
    ds_read_b64_tr_b16 a[192:193], v56 offset:32768
    ds_read_b64_tr_b16 a[214:215], v56 offset:47104
    v_mfma_f32_16x16x32_bf16 v[116:119], a[232:235], a[32:35], v[116:119]
    s_waitcnt lgkmcnt(13)
    ds_read_b64_tr_b16 a[194:195], v56 offset:34816
    ds_read_b64_tr_b16 a[216:217], v57 offset:40960
    v_mfma_f32_16x16x32_bf16 v[116:119], a[236:239], a[36:39], v[116:119]
    ds_read_b64_tr_b16 a[196:197], v56 offset:36864
    ds_read_b64_tr_b16 a[218:219], v57 offset:43008
    v_mfma_f32_16x16x32_bf16 v[124:127], a[232:235], a[48:51], v[124:127]
    ds_read_b64_tr_b16 a[198:199], v56 offset:38912
    ds_read_b64_tr_b16 a[220:221], v57 offset:45056
    v_mfma_f32_16x16x32_bf16 v[124:127], a[236:239], a[52:55], v[124:127]
    s_waitcnt lgkmcnt(15)
    ds_read_b64_tr_b16 a[200:201], v57 offset:32768
    ds_read_b64_tr_b16 a[222:223], v57 offset:47104
    v_mfma_f32_16x16x32_bf16 v[112:115], a[240:243], a[40:43], v[112:115]
    ds_read_b64_tr_b16 a[202:203], v57 offset:34816
    v_mfma_f32_16x16x32_bf16 v[112:115], a[244:247], a[44:47], v[112:115]
    ds_read_b64_tr_b16 a[204:205], v57 offset:36864
    v_mfma_f32_16x16x32_bf16 v[120:123], a[240:243], a[56:59], v[120:123]
    s_waitcnt lgkmcnt(15)
    s_xor_b32 s74, s24, 16384
    ds_read_b64_tr_b16 a[206:207], v57 offset:38912
    v_mfma_f32_16x16x32_bf16 v[120:123], a[244:247], a[60:63], v[120:123]
    buffer_load_dwordx4 v[192:195], v1, s[8:11], s74 offen offset:0
    v_mfma_f32_16x16x32_bf16 v[116:119], a[248:251], a[40:43], v[116:119]
    s_waitcnt lgkmcnt(13)
    s_xor_b32 s74, s24, 20480
    ds_read_b64_tr_b16 a[224:225], v56 offset:49152
    v_mfma_f32_16x16x32_bf16 v[116:119], a[252:255], a[44:47], v[116:119]
    ds_read_b64_tr_b16 a[226:227], v56 offset:51200
    v_mfma_f32_16x16x32_bf16 v[124:127], a[248:251], a[56:59], v[124:127]
    ds_read_b64_tr_b16 a[228:229], v56 offset:53248
    v_mfma_f32_16x16x32_bf16 v[124:127], a[252:255], a[60:63], v[124:127]
    s_waitcnt lgkmcnt(9)
    ds_read_b64_tr_b16 a[230:231], v56 offset:55296
    v_mfma_f32_16x16x32_bf16 v[64:67], a[192:195], v[128:131], 0
    buffer_load_dwordx4 v[208:211], v1, s[8:11], s74 offen offset:0
    v_mfma_f32_16x16x32_bf16 v[64:67], a[196:199], v[132:135], v[64:67]
    s_xor_b32 s74, s24, 16384
    ds_read_b64_tr_b16 a[232:233], v57 offset:49152
    v_mfma_f32_16x16x32_bf16 v[72:75], a[192:195], v[144:147], 0
    ds_read_b64_tr_b16 a[234:235], v57 offset:51200
    v_mfma_f32_16x16x32_bf16 v[72:75], a[196:199], v[148:151], v[72:75]
    s_waitcnt lgkmcnt(7)
    ds_read_b64_tr_b16 a[236:237], v57 offset:53248
    v_mfma_f32_16x16x32_bf16 v[68:71], a[200:203], v[128:131], 0
    s_waitcnt lgkmcnt(7)
    ds_read_b64_tr_b16 a[238:239], v57 offset:55296
    v_mfma_f32_16x16x32_bf16 v[68:71], a[204:207], v[132:135], v[68:71]
    buffer_load_dwordx4 v[196:199], v1, s[8:11], s74 offen offset:1024
    v_mfma_f32_16x16x32_bf16 v[76:79], a[200:203], v[144:147], 0
    s_xor_b32 s74, s24, 20480
    ds_read_b64_tr_b16 a[240:241], v56 offset:57344
    v_cvt_pk_bf16_f32 v112, v112, v113
    v_mfma_f32_16x16x32_bf16 v[76:79], a[204:207], v[148:151], v[76:79]
    ds_read_b64_tr_b16 a[242:243], v56 offset:59392
    v_cvt_pk_bf16_f32 v113, v114, v115
    v_mfma_f32_16x16x32_bf16 v[64:67], a[208:211], v[136:139], v[64:67]
    ds_read_b64_tr_b16 a[244:245], v56 offset:61440
    v_cvt_pk_bf16_f32 v114, v116, v117
    v_mfma_f32_16x16x32_bf16 v[64:67], a[212:215], v[140:143], v[64:67]
    ds_read_b64_tr_b16 a[246:247], v56 offset:63488
    v_cvt_pk_bf16_f32 v115, v118, v119
    v_mfma_f32_16x16x32_bf16 v[72:75], a[208:211], v[152:155], v[72:75]
    buffer_load_dwordx4 v[212:215], v1, s[8:11], s74 offen offset:1024
    v_mfma_f32_16x16x32_bf16 v[72:75], a[212:215], v[156:159], v[72:75]
    s_xor_b32 s74, s24, 16384
    ds_read_b64_tr_b16 a[248:249], v57 offset:57344
    v_min_u32 v112, -2, v112
    v_mfma_f32_16x16x32_bf16 v[68:71], a[216:219], v[136:139], v[68:71]
    ds_read_b64_tr_b16 a[250:251], v57 offset:59392
    v_min_u32 v113, -2, v113
    v_mfma_f32_16x16x32_bf16 v[68:71], a[220:223], v[140:143], v[68:71]
    ds_read_b64_tr_b16 a[252:253], v57 offset:61440
    v_min_u32 v114, -2, v114
    v_mfma_f32_16x16x32_bf16 v[76:79], a[216:219], v[152:155], v[76:79]
    s_waitcnt vmcnt(13) lgkmcnt(7)
    ds_read_b64_tr_b16 a[254:255], v57 offset:63488
    v_min_u32 v115, -2, v115
    v_mfma_f32_16x16x32_bf16 v[76:79], a[220:223], v[156:159], v[76:79]
    buffer_load_dwordx4 v[200:203], v1, s[8:11], s74 offen offset:2048
    v_mfma_f32_16x16x32_bf16 v[64:67], a[224:227], v[160:163], v[64:67]
    s_waitcnt vmcnt(12)
    s_xor_b32 s74, s24, 20480
    ds_read_b64_tr_b16 a[192:193], v58 offset:32768
    v_mfma_f32_16x16x32_bf16 v[64:67], a[228:231], v[164:167], v[64:67]
    s_waitcnt vmcnt(10)
    s_add_u32 s75, s18, 0
    ds_read_b64_tr_b16 a[194:195], v58 offset:34816
    v_mfma_f32_16x16x32_bf16 v[72:75], a[224:227], v[176:179], v[72:75]
    buffer_store_dwordx4 v[112:115], v23, s[8:11], s75 offen offset:768 sc0 sc1
    v_mfma_f32_16x16x32_bf16 v[72:75], a[228:231], v[180:183], v[72:75]
    ds_read_b64_tr_b16 a[196:197], v58 offset:36864
    v_cvt_pk_bf16_f32 v120, v120, v121
    v_mfma_f32_16x16x32_bf16 v[68:71], a[232:235], v[160:163], v[68:71]
    buffer_load_dwordx4 v[216:219], v1, s[8:11], s74 offen offset:2048
    ds_read_b64_tr_b16 a[198:199], v58 offset:38912
    v_mfma_f32_16x16x32_bf16 v[68:71], a[236:239], v[164:167], v[68:71]
    s_xor_b32 s74, s24, 16384
    ds_read_b64_tr_b16 a[200:201], v59 offset:32768
    v_cvt_pk_bf16_f32 v121, v122, v123
    v_mfma_f32_16x16x32_bf16 v[76:79], a[232:235], v[176:179], v[76:79]
    ds_read_b64_tr_b16 a[202:203], v59 offset:34816
    v_cvt_pk_bf16_f32 v122, v124, v125
    v_mfma_f32_16x16x32_bf16 v[76:79], a[236:239], v[180:183], v[76:79]
    s_waitcnt vmcnt(11) lgkmcnt(7)
    ds_read_b64_tr_b16 a[204:205], v59 offset:36864
    v_cvt_pk_bf16_f32 v123, v126, v127
    v_mfma_f32_16x16x32_bf16 v[64:67], a[240:243], v[168:171], v[64:67]
    s_waitcnt vmcnt(9)
    ds_read_b64_tr_b16 a[206:207], v59 offset:38912
    v_min_u32 v120, -2, v120
    v_mfma_f32_16x16x32_bf16 v[64:67], a[244:247], v[172:175], v[64:67]
    buffer_load_dwordx4 v[204:207], v1, s[8:11], s74 offen offset:3072
    v_mfma_f32_16x16x32_bf16 v[72:75], a[240:243], v[184:187], v[72:75]
    s_waitcnt vmcnt(8)
    s_xor_b32 s74, s24, 20480
    ds_read_b64_tr_b16 a[208:209], v58 offset:40960
    v_min_u32 v121, -2, v121
    v_mfma_f32_16x16x32_bf16 v[72:75], a[244:247], v[188:191], v[72:75]
    ds_read_b64_tr_b16 a[210:211], v58 offset:43008
    v_min_u32 v122, -2, v122
    v_mfma_f32_16x16x32_bf16 v[68:71], a[248:251], v[168:171], v[68:71]
    s_waitcnt lgkmcnt(8)
    ds_read_b64_tr_b16 a[212:213], v58 offset:45056
    v_min_u32 v123, -2, v123
    v_mfma_f32_16x16x32_bf16 v[68:71], a[252:255], v[172:175], v[68:71]
    s_add_u32 s75, s18, 131072
    ds_read_b64_tr_b16 a[214:215], v58 offset:47104
    v_mfma_f32_16x16x32_bf16 v[76:79], a[248:251], v[184:187], v[76:79]
    buffer_load_dwordx4 v[220:223], v1, s[8:11], s74 offen offset:3072
    ds_read_b64_tr_b16 a[216:217], v59 offset:40960
    v_mfma_f32_16x16x32_bf16 v[76:79], a[252:255], v[188:191], v[76:79]
    s_waitcnt lgkmcnt(8)
    s_xor_b32 s74, s24, 24576
    ds_read_b64_tr_b16 a[218:219], v59 offset:43008
    v_mfma_f32_16x16x32_bf16 v[80:83], a[192:195], v[128:131], 0
    buffer_store_dwordx4 v[120:123], v23, s[8:11], s75 offen offset:768 sc0 sc1
    ds_read_b64_tr_b16 a[220:221], v59 offset:45056
    v_mfma_f32_16x16x32_bf16 v[80:83], a[196:199], v[132:135], v[80:83]
    ds_read_b64_tr_b16 a[222:223], v59 offset:47104
    v_mfma_f32_16x16x32_bf16 v[88:91], a[192:195], v[144:147], 0
    s_waitcnt lgkmcnt(8)
    ds_read_b64_tr_b16 a[224:225], v58 offset:49152
    v_mfma_f32_16x16x32_bf16 v[88:91], a[196:199], v[148:151], v[88:91]
    buffer_load_dwordx4 v[224:227], v1, s[8:11], s74 offen offset:0
    ds_read_b64_tr_b16 a[226:227], v58 offset:51200
    v_mfma_f32_16x16x32_bf16 v[84:87], a[200:203], v[128:131], 0
    s_xor_b32 s74, s24, 28672
    ds_read_b64_tr_b16 a[228:229], v58 offset:53248
    v_mfma_f32_16x16x32_bf16 v[84:87], a[204:207], v[132:135], v[84:87]
    ds_read_b64_tr_b16 a[230:231], v58 offset:55296
    v_mfma_f32_16x16x32_bf16 v[92:95], a[200:203], v[144:147], 0
    ds_read_b64_tr_b16 a[232:233], v59 offset:49152
    v_mfma_f32_16x16x32_bf16 v[92:95], a[204:207], v[148:151], v[92:95]
    s_waitcnt lgkmcnt(9)
    ds_read_b64_tr_b16 a[234:235], v59 offset:51200
    v_mfma_f32_16x16x32_bf16 v[80:83], a[208:211], v[136:139], v[80:83]
    buffer_load_dwordx4 v[240:243], v1, s[8:11], s74 offen offset:0
    ds_read_b64_tr_b16 a[236:237], v59 offset:53248
    v_mfma_f32_16x16x32_bf16 v[80:83], a[212:215], v[140:143], v[80:83]
    s_xor_b32 s74, s24, 24576
    ds_read_b64_tr_b16 a[238:239], v59 offset:55296
    v_mfma_f32_16x16x32_bf16 v[88:91], a[208:211], v[152:155], v[88:91]
    ds_read_b64_tr_b16 a[240:241], v58 offset:57344
    v_mfma_f32_16x16x32_bf16 v[88:91], a[212:215], v[156:159], v[88:91]
    s_waitcnt lgkmcnt(9)
    ds_read_b64_tr_b16 a[242:243], v58 offset:59392
    v_mfma_f32_16x16x32_bf16 v[84:87], a[216:219], v[136:139], v[84:87]
    ds_read_b64_tr_b16 a[244:245], v58 offset:61440
    v_mfma_f32_16x16x32_bf16 v[84:87], a[220:223], v[140:143], v[84:87]
    buffer_load_dwordx4 v[228:231], v1, s[8:11], s74 offen offset:1024
    ds_read_b64_tr_b16 a[246:247], v58 offset:63488
    v_mfma_f32_16x16x32_bf16 v[92:95], a[216:219], v[152:155], v[92:95]
    s_xor_b32 s74, s24, 28672
    ds_read_b64_tr_b16 a[248:249], v59 offset:57344
    v_mfma_f32_16x16x32_bf16 v[92:95], a[220:223], v[156:159], v[92:95]
    s_waitcnt lgkmcnt(9)
    ds_read_b64_tr_b16 a[250:251], v59 offset:59392
    v_mfma_f32_16x16x32_bf16 v[80:83], a[224:227], v[160:163], v[80:83]
    ds_read_b64_tr_b16 a[252:253], v59 offset:61440
    v_mfma_f32_16x16x32_bf16 v[80:83], a[228:231], v[164:167], v[80:83]
    ds_read_b64_tr_b16 a[254:255], v59 offset:63488
    v_mfma_f32_16x16x32_bf16 v[88:91], a[224:227], v[176:179], v[88:91]
    buffer_load_dwordx4 v[244:247], v1, s[8:11], s74 offen offset:1024
    v_mfma_f32_16x16x32_bf16 v[88:91], a[228:231], v[180:183], v[88:91]
    s_waitcnt lgkmcnt(8)
    s_xor_b32 s74, s24, 24576
    ds_read_b64_tr_b16 a[192:193], v56 offset:0
    v_mfma_f32_16x16x32_bf16 v[84:87], a[232:235], v[160:163], v[84:87]
    ds_read_b64_tr_b16 a[194:195], v56 offset:2048
    v_mfma_f32_16x16x32_bf16 v[84:87], a[236:239], v[164:167], v[84:87]
    ds_read_b64_tr_b16 a[196:197], v56 offset:4096
    v_mfma_f32_16x16x32_bf16 v[92:95], a[232:235], v[176:179], v[92:95]
    s_waitcnt lgkmcnt(8)
    ds_read_b64_tr_b16 a[198:199], v56 offset:6144
    v_mfma_f32_16x16x32_bf16 v[92:95], a[236:239], v[180:183], v[92:95]
    buffer_load_dwordx4 v[232:235], v1, s[8:11], s74 offen offset:2048
    ds_read_b64_tr_b16 a[200:201], v57 offset:0
    v_mfma_f32_16x16x32_bf16 v[80:83], a[240:243], v[168:171], v[80:83]
    s_waitcnt lgkmcnt(8)
    s_xor_b32 s74, s24, 28672
    ds_read_b64_tr_b16 a[202:203], v57 offset:2048
    v_mfma_f32_16x16x32_bf16 v[80:83], a[244:247], v[172:175], v[80:83]
    ds_read_b64_tr_b16 a[204:205], v57 offset:4096
    v_mfma_f32_16x16x32_bf16 v[88:91], a[240:243], v[184:187], v[88:91]
    ds_read_b64_tr_b16 a[206:207], v57 offset:6144
    v_mfma_f32_16x16x32_bf16 v[88:91], a[244:247], v[188:191], v[88:91]
    s_waitcnt lgkmcnt(8)
    ds_read_b64_tr_b16 a[208:209], v56 offset:8192
    v_mfma_f32_16x16x32_bf16 v[84:87], a[248:251], v[168:171], v[84:87]
    buffer_load_dwordx4 v[248:251], v1, s[8:11], s74 offen offset:2048
    ds_read_b64_tr_b16 a[210:211], v56 offset:10240
    v_mfma_f32_16x16x32_bf16 v[84:87], a[252:255], v[172:175], v[84:87]
    s_xor_b32 s74, s24, 24576
    ds_read_b64_tr_b16 a[212:213], v56 offset:12288
    v_mfma_f32_16x16x32_bf16 v[92:95], a[248:251], v[184:187], v[92:95]
    ds_read_b64_tr_b16 a[214:215], v56 offset:14336
    v_mfma_f32_16x16x32_bf16 v[92:95], a[252:255], v[188:191], v[92:95]
    s_waitcnt lgkmcnt(9)
    ds_read_b64_tr_b16 a[216:217], v57 offset:8192
    v_mfma_f32_16x16x32_bf16 v[96:99], a[192:195], v[128:131], 0
    s_waitcnt lgkmcnt(9)
    ds_read_b64_tr_b16 a[218:219], v57 offset:10240
    v_mfma_f32_16x16x32_bf16 v[96:99], a[196:199], v[132:135], v[96:99]
    buffer_load_dwordx4 v[236:239], v1, s[8:11], s74 offen offset:3072
    ds_read_b64_tr_b16 a[220:221], v57 offset:12288
    v_mfma_f32_16x16x32_bf16 v[104:107], a[192:195], v[144:147], 0
    s_xor_b32 s74, s24, 28672
    ds_read_b64_tr_b16 a[222:223], v57 offset:14336
    v_mfma_f32_16x16x32_bf16 v[104:107], a[196:199], v[148:151], v[104:107]
    s_waitcnt lgkmcnt(9)
    ds_read_b64_tr_b16 a[224:225], v56 offset:16384
    v_mfma_f32_16x16x32_bf16 v[100:103], a[200:203], v[128:131], 0
    s_waitcnt lgkmcnt(9)
    ds_read_b64_tr_b16 a[226:227], v56 offset:18432
    v_mfma_f32_16x16x32_bf16 v[100:103], a[204:207], v[132:135], v[100:103]
    ds_read_b64_tr_b16 a[228:229], v56 offset:20480
    v_mfma_f32_16x16x32_bf16 v[108:111], a[200:203], v[144:147], 0
    buffer_load_dwordx4 v[252:255], v1, s[8:11], s74 offen offset:3072
    ds_read_b64_tr_b16 a[230:231], v56 offset:22528
    v_mfma_f32_16x16x32_bf16 v[108:111], a[204:207], v[148:151], v[108:111]
    s_waitcnt lgkmcnt(9)
    ds_read_b64_tr_b16 a[232:233], v57 offset:16384
    v_mfma_f32_16x16x32_bf16 v[96:99], a[208:211], v[136:139], v[96:99]
    s_waitcnt lgkmcnt(9)
    ds_read_b64_tr_b16 a[234:235], v57 offset:18432
    v_mfma_f32_16x16x32_bf16 v[96:99], a[212:215], v[140:143], v[96:99]
    ds_read_b64_tr_b16 a[236:237], v57 offset:20480
    v_mfma_f32_16x16x32_bf16 v[104:107], a[208:211], v[152:155], v[104:107]
    ds_read_b64_tr_b16 a[238:239], v57 offset:22528
    v_mfma_f32_16x16x32_bf16 v[104:107], a[212:215], v[156:159], v[104:107]
    s_waitcnt lgkmcnt(9)
    ds_read_b64_tr_b16 a[240:241], v56 offset:24576
    v_mfma_f32_16x16x32_bf16 v[100:103], a[216:219], v[136:139], v[100:103]
    s_waitcnt lgkmcnt(9)
    ds_read_b64_tr_b16 a[242:243], v56 offset:26624
    v_mfma_f32_16x16x32_bf16 v[100:103], a[220:223], v[140:143], v[100:103]
    ds_read_b64_tr_b16 a[244:245], v56 offset:28672
    v_mfma_f32_16x16x32_bf16 v[108:111], a[216:219], v[152:155], v[108:111]
    ds_read_b64_tr_b16 a[246:247], v56 offset:30720
    v_mfma_f32_16x16x32_bf16 v[108:111], a[220:223], v[156:159], v[108:111]
    s_waitcnt lgkmcnt(9)
    ds_read_b64_tr_b16 a[248:249], v57 offset:24576
    v_mfma_f32_16x16x32_bf16 v[96:99], a[224:227], v[160:163], v[96:99]
    s_waitcnt lgkmcnt(9)
    ds_read_b64_tr_b16 a[250:251], v57 offset:26624
    v_mfma_f32_16x16x32_bf16 v[96:99], a[228:231], v[164:167], v[96:99]
    ds_read_b64_tr_b16 a[252:253], v57 offset:28672
    v_mfma_f32_16x16x32_bf16 v[104:107], a[224:227], v[176:179], v[104:107]
    ds_read_b64_tr_b16 a[254:255], v57 offset:30720
    v_mfma_f32_16x16x32_bf16 v[104:107], a[228:231], v[180:183], v[104:107]
    s_waitcnt lgkmcnt(8)
    ds_read_b64_tr_b16 a[192:193], v58 offset:0
    v_mfma_f32_16x16x32_bf16 v[100:103], a[232:235], v[160:163], v[100:103]
    buffer_load_dwordx2 v[32:33], v45, s[32:35], s100 offen
    ds_read_b64_tr_b16 a[194:195], v58 offset:2048
    v_mfma_f32_16x16x32_bf16 v[100:103], a[236:239], v[164:167], v[100:103]
    ds_read_b64_tr_b16 a[196:197], v58 offset:4096
    v_mfma_f32_16x16x32_bf16 v[108:111], a[232:235], v[176:179], v[108:111]
    ds_read_b64_tr_b16 a[198:199], v58 offset:6144
    v_mfma_f32_16x16x32_bf16 v[108:111], a[236:239], v[180:183], v[108:111]
    s_waitcnt lgkmcnt(8)
    ds_read_b64_tr_b16 a[200:201], v59 offset:0
    v_mfma_f32_16x16x32_bf16 v[96:99], a[240:243], v[168:171], v[96:99]
    buffer_load_dwordx2 v[34:35], v45, s[32:35], s100 offen offset:32
    ds_read_b64_tr_b16 a[202:203], v59 offset:2048
    v_mfma_f32_16x16x32_bf16 v[96:99], a[244:247], v[172:175], v[96:99]
    ds_read_b64_tr_b16 a[204:205], v59 offset:4096
    v_mfma_f32_16x16x32_bf16 v[104:107], a[240:243], v[184:187], v[104:107]
    ds_read_b64_tr_b16 a[206:207], v59 offset:6144
    v_mfma_f32_16x16x32_bf16 v[104:107], a[244:247], v[188:191], v[104:107]
    s_waitcnt lgkmcnt(8)
    ds_read_b64_tr_b16 a[208:209], v58 offset:8192
    v_mfma_f32_16x16x32_bf16 v[100:103], a[248:251], v[168:171], v[100:103]
    buffer_load_dwordx2 v[36:37], v45, s[32:35], s101 offen
    ds_read_b64_tr_b16 a[210:211], v58 offset:10240
    v_mfma_f32_16x16x32_bf16 v[100:103], a[252:255], v[172:175], v[100:103]
    ds_read_b64_tr_b16 a[212:213], v58 offset:12288
    v_mfma_f32_16x16x32_bf16 v[108:111], a[248:251], v[184:187], v[108:111]
    ds_read_b64_tr_b16 a[214:215], v58 offset:14336
    v_mfma_f32_16x16x32_bf16 v[108:111], a[252:255], v[188:191], v[108:111]
    s_waitcnt lgkmcnt(8)
    ds_read_b64_tr_b16 a[216:217], v59 offset:8192
    v_mfma_f32_16x16x32_bf16 v[112:115], a[192:195], v[128:131], 0
    buffer_load_dwordx2 v[38:39], v45, s[32:35], s101 offen offset:32
    ds_read_b64_tr_b16 a[218:219], v59 offset:10240
    v_mfma_f32_16x16x32_bf16 v[112:115], a[196:199], v[132:135], v[112:115]
    ds_read_b64_tr_b16 a[220:221], v59 offset:12288
    v_mfma_f32_16x16x32_bf16 v[120:123], a[192:195], v[144:147], 0
    ds_read_b64_tr_b16 a[222:223], v59 offset:14336
    v_mfma_f32_16x16x32_bf16 v[120:123], a[196:199], v[148:151], v[120:123]
    s_waitcnt lgkmcnt(8)
    ds_read_b64_tr_b16 a[224:225], v58 offset:16384
    v_mfma_f32_16x16x32_bf16 v[116:119], a[200:203], v[128:131], 0
    buffer_load_dwordx2 v[40:41], v45, s[56:59], 0 offen
    ds_read_b64_tr_b16 a[226:227], v58 offset:18432
    v_mfma_f32_16x16x32_bf16 v[116:119], a[204:207], v[132:135], v[116:119]
    ds_read_b64_tr_b16 a[228:229], v58 offset:20480
    v_mfma_f32_16x16x32_bf16 v[124:127], a[200:203], v[144:147], 0
    ds_read_b64_tr_b16 a[230:231], v58 offset:22528
    v_mfma_f32_16x16x32_bf16 v[124:127], a[204:207], v[148:151], v[124:127]
    s_waitcnt lgkmcnt(8)
    ds_read_b64_tr_b16 a[232:233], v59 offset:16384
    v_mfma_f32_16x16x32_bf16 v[112:115], a[208:211], v[136:139], v[112:115]
    buffer_load_dwordx2 v[42:43], v45, s[56:59], 0 offen offset:32
    ds_read_b64_tr_b16 a[234:235], v59 offset:18432
    v_mfma_f32_16x16x32_bf16 v[112:115], a[212:215], v[140:143], v[112:115]
    ds_read_b64_tr_b16 a[236:237], v59 offset:20480
    v_mfma_f32_16x16x32_bf16 v[120:123], a[208:211], v[152:155], v[120:123]
    ds_read_b64_tr_b16 a[238:239], v59 offset:22528
    v_mfma_f32_16x16x32_bf16 v[120:123], a[212:215], v[156:159], v[120:123]
    s_waitcnt lgkmcnt(9)
    ds_read_b64_tr_b16 a[240:241], v58 offset:24576
    v_mfma_f32_16x16x32_bf16 v[116:119], a[216:219], v[136:139], v[116:119]
    s_waitcnt lgkmcnt(9)
    ds_read_b64_tr_b16 a[242:243], v58 offset:26624
    v_mfma_f32_16x16x32_bf16 v[116:119], a[220:223], v[140:143], v[116:119]
    ds_read_b64_tr_b16 a[244:245], v58 offset:28672
    v_mfma_f32_16x16x32_bf16 v[124:127], a[216:219], v[152:155], v[124:127]
    ds_read_b64_tr_b16 a[246:247], v58 offset:30720
    v_mfma_f32_16x16x32_bf16 v[124:127], a[220:223], v[156:159], v[124:127]
    s_waitcnt lgkmcnt(9)
    ds_read_b64_tr_b16 a[248:249], v59 offset:24576
    v_mfma_f32_16x16x32_bf16 v[112:115], a[224:227], v[160:163], v[112:115]
    s_waitcnt lgkmcnt(9)
    ds_read_b64_tr_b16 a[250:251], v59 offset:26624
    v_mfma_f32_16x16x32_bf16 v[112:115], a[228:231], v[164:167], v[112:115]
    ds_read_b64_tr_b16 a[252:253], v59 offset:28672
    v_mfma_f32_16x16x32_bf16 v[120:123], a[224:227], v[176:179], v[120:123]
    ds_read_b64_tr_b16 a[254:255], v59 offset:30720
    v_mfma_f32_16x16x32_bf16 v[120:123], a[228:231], v[180:183], v[120:123]
    s_waitcnt lgkmcnt(9)
    ds_read_b64_tr_b16 a[192:193], v60 offset:0
    v_mfma_f32_16x16x32_bf16 v[116:119], a[232:235], v[160:163], v[116:119]
    s_waitcnt lgkmcnt(9)
    ds_read_b64_tr_b16 a[194:195], v60 offset:2048
    v_mfma_f32_16x16x32_bf16 v[116:119], a[236:239], v[164:167], v[116:119]
    ds_read_b64_tr_b16 a[196:197], v60 offset:4096
    v_mfma_f32_16x16x32_bf16 v[124:127], a[232:235], v[176:179], v[124:127]
    ds_read_b64_tr_b16 a[198:199], v60 offset:6144
    v_mfma_f32_16x16x32_bf16 v[124:127], a[236:239], v[180:183], v[124:127]
    s_waitcnt lgkmcnt(9)
    ds_read_b64_tr_b16 a[200:201], v61 offset:0
    v_mfma_f32_16x16x32_bf16 v[112:115], a[240:243], v[168:171], v[112:115]
    s_waitcnt lgkmcnt(9)
    ds_read_b64_tr_b16 a[202:203], v61 offset:2048
    ds_read_b64_tr_b16 a[224:225], v60 offset:16384
    v_mfma_f32_16x16x32_bf16 v[112:115], a[244:247], v[172:175], v[112:115]
    ds_read_b64_tr_b16 a[204:205], v61 offset:4096
    ds_read_b64_tr_b16 a[226:227], v60 offset:18432
    v_mfma_f32_16x16x32_bf16 v[120:123], a[240:243], v[184:187], v[120:123]
    ds_read_b64_tr_b16 a[206:207], v61 offset:6144
    ds_read_b64_tr_b16 a[228:229], v60 offset:20480
    v_mfma_f32_16x16x32_bf16 v[120:123], a[244:247], v[188:191], v[120:123]
    s_waitcnt lgkmcnt(12)
    ds_read_b64_tr_b16 a[208:209], v60 offset:8192
    ds_read_b64_tr_b16 a[230:231], v60 offset:22528
    v_mfma_f32_16x16x32_bf16 v[116:119], a[248:251], v[168:171], v[116:119]
    s_waitcnt lgkmcnt(13)
    ds_read_b64_tr_b16 a[210:211], v60 offset:10240
    ds_read_b64_tr_b16 a[232:233], v61 offset:16384
    v_mfma_f32_16x16x32_bf16 v[116:119], a[252:255], v[172:175], v[116:119]
    ds_read_b64_tr_b16 a[212:213], v60 offset:12288
    ds_read_b64_tr_b16 a[234:235], v61 offset:18432
    v_mfma_f32_16x16x32_bf16 v[124:127], a[248:251], v[184:187], v[124:127]
    ds_read_b64_tr_b16 a[214:215], v60 offset:14336
    ds_read_b64_tr_b16 a[236:237], v61 offset:20480
    v_mfma_f32_16x16x32_bf16 v[124:127], a[252:255], v[188:191], v[124:127]
    s_waitcnt vmcnt(23) lgkmcnt(15)
    ds_read_b64_tr_b16 a[216:217], v61 offset:8192
    ds_read_b64_tr_b16 a[238:239], v61 offset:22528
    v_mfma_f32_16x16x32_bf16 v[64:67], a[192:195], v[192:195], v[64:67]
    s_waitcnt vmcnt(21)
    ds_read_b64_tr_b16 a[218:219], v61 offset:10240
    v_mfma_f32_16x16x32_bf16 v[64:67], a[196:199], v[196:199], v[64:67]
    ds_read_b64_tr_b16 a[220:221], v61 offset:12288
    v_mfma_f32_16x16x32_bf16 v[72:75], a[192:195], v[208:211], v[72:75]
    s_waitcnt vmcnt(20) lgkmcnt(15)
    s_mov_b32 s74, 8192
    ds_read_b64_tr_b16 a[222:223], v61 offset:14336
    v_mfma_f32_16x16x32_bf16 v[72:75], a[196:199], v[212:215], v[72:75]
    buffer_load_dwordx4 v[168:171], v46, s[8:11], s74 offen
    v_mfma_f32_16x16x32_bf16 v[68:71], a[200:203], v[192:195], v[68:71]
    s_waitcnt lgkmcnt(13)
    ds_read_b64_tr_b16 a[240:241], v60 offset:24576
    v_mfma_f32_16x16x32_bf16 v[68:71], a[204:207], v[196:199], v[68:71]
    ds_read_b64_tr_b16 a[242:243], v60 offset:26624
    v_mfma_f32_16x16x32_bf16 v[76:79], a[200:203], v[208:211], v[76:79]
    buffer_load_dwordx4 v[172:175], v46, s[8:11], s74 offen offset:64
    v_mfma_f32_16x16x32_bf16 v[76:79], a[204:207], v[212:215], v[76:79]
    s_waitcnt vmcnt(21) lgkmcnt(9)
    s_mov_b32 s74, 6144
    ds_read_b64_tr_b16 a[244:245], v60 offset:28672
    v_mfma_f32_16x16x32_bf16 v[64:67], a[208:211], v[200:203], v[64:67]
    s_waitcnt vmcnt(18) lgkmcnt(8)
    ds_read_b64_tr_b16 a[246:247], v60 offset:30720
    v_mfma_f32_16x16x32_bf16 v[64:67], a[212:215], v[204:207], v[64:67]
    buffer_load_dwordx4 v[176:179], v46, s[8:11], s74 offen
    v_mfma_f32_16x16x32_bf16 v[72:75], a[208:211], v[216:219], v[72:75]
    s_waitcnt vmcnt(18)
    ds_read_b64_tr_b16 a[248:249], v61 offset:24576
    v_mfma_f32_16x16x32_bf16 v[72:75], a[212:215], v[220:223], v[72:75]
    s_waitcnt lgkmcnt(5)
    ds_read_b64_tr_b16 a[250:251], v61 offset:26624
    v_mfma_f32_16x16x32_bf16 v[68:71], a[216:219], v[200:203], v[68:71]
    buffer_load_dwordx4 v[180:183], v46, s[8:11], s74 offen offset:64
    ds_read_b64_tr_b16 a[252:253], v61 offset:28672
    v_mfma_f32_16x16x32_bf16 v[68:71], a[220:223], v[204:207], v[68:71]
    s_mov_b32 s74, 4096
    ds_read_b64_tr_b16 a[254:255], v61 offset:30720
    v_mfma_f32_16x16x32_bf16 v[76:79], a[216:219], v[216:219], v[76:79]
    s_waitcnt vmcnt(17)
    ds_read_b64_tr_b16 a[192:193], v62 offset:0
    v_mfma_f32_16x16x32_bf16 v[76:79], a[220:223], v[220:223], v[76:79]
    buffer_load_dwordx4 v[160:163], v46, s[8:11], s74 offen
    v_mfma_f32_16x16x32_bf16 v[64:67], a[224:227], v[224:227], v[64:67]
    s_waitcnt vmcnt(16)
    ds_read_b64_tr_b16 a[194:195], v62 offset:2048
    s_waitcnt vmcnt(6)
    v_lshlrev_b32 v48, 16, v40
    v_mfma_f32_16x16x32_bf16 v[64:67], a[228:231], v[228:231], v[64:67]
    ds_read_b64_tr_b16 a[196:197], v62 offset:4096
    v_and_b32 v49, 0xffff0000, v40
    v_mfma_f32_16x16x32_bf16 v[72:75], a[224:227], v[240:243], v[72:75]
    buffer_load_dwordx4 v[164:167], v46, s[8:11], s74 offen offset:64
    v_mfma_f32_16x16x32_bf16 v[72:75], a[228:231], v[244:247], v[72:75]
    s_mov_b32 s74, 10240
    ds_read_b64_tr_b16 a[198:199], v62 offset:6144
    v_lshlrev_b32 v50, 16, v41
    v_mfma_f32_16x16x32_bf16 v[68:71], a[232:235], v[224:227], v[68:71]
    ds_read_b64_tr_b16 a[200:201], v63 offset:0
    v_and_b32 v51, 0xffff0000, v41
    v_mfma_f32_16x16x32_bf16 v[68:71], a[236:239], v[228:231], v[68:71]
    buffer_load_dwordx4 v[184:187], v46, s[8:11], s74 offen
    ds_read_b64_tr_b16 a[202:203], v63 offset:2048
    v_mfma_f32_16x16x32_bf16 v[76:79], a[232:235], v[240:243], v[76:79]
    ds_read_b64_tr_b16 a[204:205], v63 offset:4096
    s_waitcnt vmcnt(7)
    v_lshlrev_b32 v52, 16, v42
    v_mfma_f32_16x16x32_bf16 v[76:79], a[236:239], v[244:247], v[76:79]
    s_waitcnt lgkmcnt(7)
    ds_read_b64_tr_b16 a[206:207], v63 offset:6144
    v_and_b32 v53, 0xffff0000, v42
    v_mfma_f32_16x16x32_bf16 v[64:67], a[240:243], v[232:235], v[64:67]
    buffer_load_dwordx4 v[188:191], v46, s[8:11], s74 offen offset:64
    v_mfma_f32_16x16x32_bf16 v[64:67], a[244:247], v[236:239], v[64:67]
    ds_read_b64_tr_b16 a[208:209], v62 offset:8192
    v_lshlrev_b32 v54, 16, v43
    v_mfma_f32_16x16x32_bf16 v[72:75], a[240:243], v[248:251], v[72:75]
    ds_read_b64_tr_b16 a[210:211], v62 offset:10240
    v_and_b32 v55, 0xffff0000, v43
    v_mfma_f32_16x16x32_bf16 v[72:75], a[244:247], v[252:255], v[72:75]
    ds_read_b64_tr_b16 a[212:213], v62 offset:12288
    v_mfma_f32_16x16x32_bf16 v[68:71], a[248:251], v[232:235], v[68:71]
    ds_read_b64_tr_b16 a[214:215], v62 offset:14336
    v_mfma_f32_16x16x32_bf16 v[68:71], a[252:255], v[236:239], v[68:71]
    ds_read_b64_tr_b16 a[216:217], v63 offset:8192
    v_mfma_f32_16x16x32_bf16 v[76:79], a[248:251], v[248:251], v[76:79]
    ds_read_b64_tr_b16 a[218:219], v63 offset:10240
    v_mfma_f32_16x16x32_bf16 v[76:79], a[252:255], v[252:255], v[76:79]
    s_waitcnt lgkmcnt(8)
    ds_read_b64_tr_b16 a[220:221], v63 offset:12288
    v_mfma_f32_16x16x32_bf16 v[80:83], a[192:195], v[192:195], v[80:83]
    ds_read_b64_tr_b16 a[222:223], v63 offset:14336
    v_mfma_f32_16x16x32_bf16 v[80:83], a[196:199], v[196:199], v[80:83]
    ds_read_b64_tr_b16 a[224:225], v62 offset:16384
    v_mfma_f32_16x16x32_bf16 v[88:91], a[192:195], v[208:211], v[88:91]
    ds_read_b64_tr_b16 a[226:227], v62 offset:18432
    v_mfma_f32_16x16x32_bf16 v[88:91], a[196:199], v[212:215], v[88:91]
    ds_read_b64_tr_b16 a[228:229], v62 offset:20480
    v_mfma_f32_16x16x32_bf16 v[84:87], a[200:203], v[192:195], v[84:87]
    s_waitcnt lgkmcnt(9)
    ds_read_b64_tr_b16 a[230:231], v62 offset:22528
    v_mfma_f32_16x16x32_bf16 v[84:87], a[204:207], v[196:199], v[84:87]
    ds_read_b64_tr_b16 a[232:233], v63 offset:16384
    v_mfma_f32_16x16x32_bf16 v[92:95], a[200:203], v[208:211], v[92:95]
    ds_read_b64_tr_b16 a[234:235], v63 offset:18432
    v_cvt_pk_bf16_f32 v64, v64, v65
    v_mfma_f32_16x16x32_bf16 v[92:95], a[204:207], v[212:215], v[92:95]
    ds_read_b64_tr_b16 a[236:237], v63 offset:20480
    v_cvt_pk_bf16_f32 v65, v66, v67
    v_mfma_f32_16x16x32_bf16 v[80:83], a[208:211], v[200:203], v[80:83]
    s_waitcnt lgkmcnt(9)
    ds_read_b64_tr_b16 a[238:239], v63 offset:22528
    v_cvt_pk_bf16_f32 v66, v68, v69
    v_mfma_f32_16x16x32_bf16 v[80:83], a[212:215], v[204:207], v[80:83]
    ds_read_b64_tr_b16 a[240:241], v62 offset:24576
    v_cvt_pk_bf16_f32 v67, v70, v71
    v_mfma_f32_16x16x32_bf16 v[88:91], a[208:211], v[216:219], v[88:91]
    ds_read_b64_tr_b16 a[242:243], v62 offset:26624
    v_min_u32 v64, -2, v64
    v_mfma_f32_16x16x32_bf16 v[88:91], a[212:215], v[220:223], v[88:91]
    ds_read_b64_tr_b16 a[244:245], v62 offset:28672
    v_min_u32 v65, -2, v65
    v_mfma_f32_16x16x32_bf16 v[84:87], a[216:219], v[200:203], v[84:87]
    s_waitcnt lgkmcnt(9)
    ds_read_b64_tr_b16 a[246:247], v62 offset:30720
    v_min_u32 v66, -2, v66
    v_mfma_f32_16x16x32_bf16 v[84:87], a[220:223], v[204:207], v[84:87]
    ds_read_b64_tr_b16 a[248:249], v63 offset:24576
    v_min_u32 v67, -2, v67
    v_mfma_f32_16x16x32_bf16 v[92:95], a[216:219], v[216:219], v[92:95]
    s_add_u32 s75, s18, 8388608
    ds_read_b64_tr_b16 a[250:251], v63 offset:26624
    v_mfma_f32_16x16x32_bf16 v[92:95], a[220:223], v[220:223], v[92:95]
    buffer_store_dwordx4 v[64:67], v23, s[8:11], s75 offen offset:0 sc0 sc1
    ds_read_b64_tr_b16 a[252:253], v63 offset:28672
    v_mfma_f32_16x16x32_bf16 v[80:83], a[224:227], v[224:227], v[80:83]
    s_waitcnt lgkmcnt(9)
    ds_read_b64_tr_b16 a[254:255], v63 offset:30720
    v_cvt_pk_bf16_f32 v72, v72, v73
    v_mfma_f32_16x16x32_bf16 v[80:83], a[228:231], v[228:231], v[80:83]
    ds_read_b64_tr_b16 a[192:193], v60 offset:32768
    v_cvt_pk_bf16_f32 v73, v74, v75
    v_mfma_f32_16x16x32_bf16 v[88:91], a[224:227], v[240:243], v[88:91]
    ds_read_b64_tr_b16 a[194:195], v60 offset:34816
    v_cvt_pk_bf16_f32 v74, v76, v77
    v_mfma_f32_16x16x32_bf16 v[88:91], a[228:231], v[244:247], v[88:91]
    ds_read_b64_tr_b16 a[196:197], v60 offset:36864
    v_cvt_pk_bf16_f32 v75, v78, v79
    v_mfma_f32_16x16x32_bf16 v[84:87], a[232:235], v[224:227], v[84:87]
    s_waitcnt lgkmcnt(9)
    ds_read_b64_tr_b16 a[198:199], v60 offset:38912
    v_min_u32 v72, -2, v72
    v_mfma_f32_16x16x32_bf16 v[84:87], a[236:239], v[228:231], v[84:87]
    ds_read_b64_tr_b16 a[200:201], v61 offset:32768
    v_min_u32 v73, -2, v73
    v_mfma_f32_16x16x32_bf16 v[92:95], a[232:235], v[240:243], v[92:95]
    ds_read_b64_tr_b16 a[202:203], v61 offset:34816
    v_min_u32 v74, -2, v74
    v_mfma_f32_16x16x32_bf16 v[92:95], a[236:239], v[244:247], v[92:95]
    ds_read_b64_tr_b16 a[204:205], v61 offset:36864
    v_min_u32 v75, -2, v75
    v_mfma_f32_16x16x32_bf16 v[80:83], a[240:243], v[232:235], v[80:83]
    s_waitcnt lgkmcnt(9)
    s_add_u32 s75, s18, 8519680
    ds_read_b64_tr_b16 a[206:207], v61 offset:38912
    s_waitcnt vmcnt(8)
    v_mul_f32 v8, v48, v168
    v_mfma_f32_16x16x32_bf16 v[80:83], a[244:247], v[236:239], v[80:83]
    buffer_store_dwordx4 v[72:75], v23, s[8:11], s75 offen offset:0 sc0 sc1
    v_mfma_f32_16x16x32_bf16 v[88:91], a[240:243], v[248:251], v[88:91]
    ds_read_b64_tr_b16 a[208:209], v60 offset:40960
    v_mul_f32 v9, v49, v169
    v_mfma_f32_16x16x32_bf16 v[88:91], a[244:247], v[252:255], v[88:91]
    ds_read_b64_tr_b16 a[210:211], v60 offset:43008
    v_mul_f32 v10, v50, v170
    v_mfma_f32_16x16x32_bf16 v[84:87], a[248:251], v[232:235], v[84:87]
    s_waitcnt lgkmcnt(8)
    ds_read_b64_tr_b16 a[212:213], v60 offset:45056
    v_mul_f32 v11, v51, v171
    v_mfma_f32_16x16x32_bf16 v[84:87], a[252:255], v[236:239], v[84:87]
    ds_read_b64_tr_b16 a[214:215], v60 offset:47104
    s_waitcnt vmcnt(8)
    v_mul_f32 v12, v52, v172
    v_mfma_f32_16x16x32_bf16 v[92:95], a[248:251], v[248:251], v[92:95]
    ds_read_b64_tr_b16 a[216:217], v61 offset:40960
    v_mul_f32 v13, v53, v173
    v_mfma_f32_16x16x32_bf16 v[92:95], a[252:255], v[252:255], v[92:95]
    ds_read_b64_tr_b16 a[218:219], v61 offset:43008
    v_mul_f32 v14, v54, v174
    v_mfma_f32_16x16x32_bf16 v[96:99], a[192:195], v[192:195], v[96:99]
    s_waitcnt lgkmcnt(8)
    ds_read_b64_tr_b16 a[220:221], v61 offset:45056
    v_mul_f32 v15, v55, v175
    v_mfma_f32_16x16x32_bf16 v[96:99], a[196:199], v[196:199], v[96:99]
    ds_read_b64_tr_b16 a[222:223], v61 offset:47104
    s_waitcnt vmcnt(7)
    v_mul_f32 v16, v48, v176
    v_mfma_f32_16x16x32_bf16 v[104:107], a[192:195], v[208:211], v[104:107]
    ds_read_b64_tr_b16 a[224:225], v60 offset:49152
    v_fmac_f32 v16, v49, v177
    v_mfma_f32_16x16x32_bf16 v[104:107], a[196:199], v[212:215], v[104:107]
    ds_read_b64_tr_b16 a[226:227], v60 offset:51200
    v_fmac_f32 v16, v50, v178
    v_mfma_f32_16x16x32_bf16 v[100:103], a[200:203], v[192:195], v[100:103]
    s_waitcnt lgkmcnt(9)
    ds_read_b64_tr_b16 a[228:229], v60 offset:53248
    v_fmac_f32 v16, v51, v179
    v_mfma_f32_16x16x32_bf16 v[100:103], a[204:207], v[196:199], v[100:103]
    ds_read_b64_tr_b16 a[230:231], v60 offset:55296
    s_waitcnt vmcnt(6)
    v_fmac_f32 v16, v52, v180
    v_mfma_f32_16x16x32_bf16 v[108:111], a[200:203], v[208:211], v[108:111]
    ds_read_b64_tr_b16 a[232:233], v61 offset:49152
    v_cvt_pk_bf16_f32 v80, v80, v81
    v_mfma_f32_16x16x32_bf16 v[108:111], a[204:207], v[212:215], v[108:111]
    s_waitcnt lgkmcnt(9)
    ds_read_b64_tr_b16 a[234:235], v61 offset:51200
    v_cvt_pk_bf16_f32 v81, v82, v83
    v_mfma_f32_16x16x32_bf16 v[96:99], a[208:211], v[200:203], v[96:99]
    ds_read_b64_tr_b16 a[236:237], v61 offset:53248
    v_cvt_pk_bf16_f32 v82, v84, v85
    v_mfma_f32_16x16x32_bf16 v[96:99], a[212:215], v[204:207], v[96:99]
    ds_read_b64_tr_b16 a[238:239], v61 offset:55296
    v_cvt_pk_bf16_f32 v83, v86, v87
    v_mfma_f32_16x16x32_bf16 v[104:107], a[208:211], v[216:219], v[104:107]
    ds_read_b64_tr_b16 a[240:241], v60 offset:57344
    v_min_u32 v80, -2, v80
    v_mfma_f32_16x16x32_bf16 v[104:107], a[212:215], v[220:223], v[104:107]
    s_waitcnt lgkmcnt(9)
    ds_read_b64_tr_b16 a[242:243], v60 offset:59392
    v_min_u32 v81, -2, v81
    v_mfma_f32_16x16x32_bf16 v[100:103], a[216:219], v[200:203], v[100:103]
    ds_read_b64_tr_b16 a[244:245], v60 offset:61440
    v_min_u32 v82, -2, v82
    v_mfma_f32_16x16x32_bf16 v[100:103], a[220:223], v[204:207], v[100:103]
    ds_read_b64_tr_b16 a[246:247], v60 offset:63488
    v_min_u32 v83, -2, v83
    v_mfma_f32_16x16x32_bf16 v[108:111], a[216:219], v[216:219], v[108:111]
    s_waitcnt lgkmcnt(9)
    s_add_u32 s75, s18, 8388608
    ds_read_b64_tr_b16 a[248:249], v61 offset:57344
    v_fmac_f32 v16, v53, v181
    v_mfma_f32_16x16x32_bf16 v[108:111], a[220:223], v[220:223], v[108:111]
    buffer_store_dwordx4 v[80:83], v23, s[8:11], s75 offen offset:256 sc0 sc1
    ds_read_b64_tr_b16 a[250:251], v61 offset:59392
    v_mfma_f32_16x16x32_bf16 v[96:99], a[224:227], v[224:227], v[96:99]
    s_waitcnt lgkmcnt(9)
    ds_read_b64_tr_b16 a[252:253], v61 offset:61440
    v_cvt_pk_bf16_f32 v88, v88, v89
    v_mfma_f32_16x16x32_bf16 v[96:99], a[228:231], v[228:231], v[96:99]
    ds_read_b64_tr_b16 a[254:255], v61 offset:63488
    v_cvt_pk_bf16_f32 v89, v90, v91
    v_mfma_f32_16x16x32_bf16 v[104:107], a[224:227], v[240:243], v[104:107]
    ds_read_b64_tr_b16 a[192:193], v62 offset:32768
    v_cvt_pk_bf16_f32 v90, v92, v93
    v_mfma_f32_16x16x32_bf16 v[104:107], a[228:231], v[244:247], v[104:107]
    s_waitcnt lgkmcnt(9)
    ds_read_b64_tr_b16 a[194:195], v62 offset:34816
    v_cvt_pk_bf16_f32 v91, v94, v95
    v_mfma_f32_16x16x32_bf16 v[100:103], a[232:235], v[224:227], v[100:103]
    ds_read_b64_tr_b16 a[196:197], v62 offset:36864
    v_min_u32 v88, -2, v88
    v_mfma_f32_16x16x32_bf16 v[100:103], a[236:239], v[228:231], v[100:103]
    ds_read_b64_tr_b16 a[198:199], v62 offset:38912
    v_min_u32 v89, -2, v89
    v_mfma_f32_16x16x32_bf16 v[108:111], a[232:235], v[240:243], v[108:111]
    ds_read_b64_tr_b16 a[200:201], v63 offset:32768
    v_min_u32 v90, -2, v90
    v_mfma_f32_16x16x32_bf16 v[108:111], a[236:239], v[244:247], v[108:111]
    s_waitcnt lgkmcnt(9)
    ds_read_b64_tr_b16 a[202:203], v63 offset:34816
    v_fmac_f32 v16, v54, v182
    v_mfma_f32_16x16x32_bf16 v[96:99], a[240:243], v[232:235], v[96:99]
    s_add_u32 s74, s70, 0
    ds_read_b64_tr_b16 a[204:205], v63 offset:36864
    v_min_u32 v91, -2, v91
    v_mfma_f32_16x16x32_bf16 v[96:99], a[244:247], v[236:239], v[96:99]
    buffer_load_dwordx4 v[128:131], v44, s[8:11], s74 offen sc0 sc1
    ds_read_b64_tr_b16 a[206:207], v63 offset:38912
    v_mfma_f32_16x16x32_bf16 v[104:107], a[240:243], v[248:251], v[104:107]
    s_add_u32 s74, s70, 4096
    ds_read_b64_tr_b16 a[208:209], v62 offset:40960
    v_fmac_f32 v16, v55, v183
    v_mfma_f32_16x16x32_bf16 v[104:107], a[244:247], v[252:255], v[104:107]
    s_waitcnt lgkmcnt(9)
    s_add_u32 s75, s18, 8519680
    ds_read_b64_tr_b16 a[210:211], v62 offset:43008
    v_add_f32_dpp v16, v16, v16 quad_perm:[1,0,3,2] row_mask:0xf bank_mask:0xf
    v_mfma_f32_16x16x32_bf16 v[100:103], a[248:251], v[232:235], v[100:103]
    buffer_store_dwordx4 v[88:91], v23, s[8:11], s75 offen offset:256 sc0 sc1
    ds_read_b64_tr_b16 a[212:213], v62 offset:45056
    v_mfma_f32_16x16x32_bf16 v[100:103], a[252:255], v[236:239], v[100:103]
    buffer_load_dwordx4 v[132:135], v44, s[8:11], s74 offen sc0 sc1
    ds_read_b64_tr_b16 a[214:215], v62 offset:47104
    v_mfma_f32_16x16x32_bf16 v[108:111], a[248:251], v[248:251], v[108:111]
    s_add_u32 s74, s70, 8192
    ds_read_b64_tr_b16 a[216:217], v63 offset:40960
    v_add_f32_dpp v16, v16, v16 quad_perm:[2,3,0,1] row_mask:0xf bank_mask:0xf
    v_mfma_f32_16x16x32_bf16 v[108:111], a[252:255], v[252:255], v[108:111]
    s_waitcnt lgkmcnt(9)
    ds_read_b64_tr_b16 a[218:219], v63 offset:43008
    v_add_f32_dpp v16, v16, v16 row_half_mirror row_mask:0xf bank_mask:0xf
    v_mfma_f32_16x16x32_bf16 v[112:115], a[192:195], v[192:195], v[112:115]
    ds_read_b64_tr_b16 a[220:221], v63 offset:45056
    v_add_f32_dpp v16, v16, v16 row_mirror row_mask:0xf bank_mask:0xf
    v_mfma_f32_16x16x32_bf16 v[112:115], a[196:199], v[196:199], v[112:115]
    buffer_load_dwordx4 v[136:139], v44, s[8:11], s74 offen sc0 sc1
    ds_read_b64_tr_b16 a[222:223], v63 offset:47104
    v_mfma_f32_16x16x32_bf16 v[120:123], a[192:195], v[208:211], v[120:123]
    s_add_u32 s74, s70, 12288
    ds_read_b64_tr_b16 a[224:225], v62 offset:49152
    v_mov_b32 v19, v16
    v_mfma_f32_16x16x32_bf16 v[120:123], a[196:199], v[212:215], v[120:123]
    s_waitcnt lgkmcnt(9)
    ds_read_b64_tr_b16 a[226:227], v62 offset:51200
    v_permlane16_swap_b32 v16, v19
    v_mfma_f32_16x16x32_bf16 v[116:119], a[200:203], v[192:195], v[116:119]
    ds_read_b64_tr_b16 a[228:229], v62 offset:53248
    v_add_f32 v16, v16, v19
    v_mfma_f32_16x16x32_bf16 v[116:119], a[204:207], v[196:199], v[116:119]
    buffer_load_dwordx4 v[140:143], v44, s[8:11], s74 offen sc0 sc1
    ds_read_b64_tr_b16 a[230:231], v62 offset:55296
    v_mfma_f32_16x16x32_bf16 v[124:127], a[200:203], v[208:211], v[124:127]
    s_add_u32 s74, s70, 16384
    ds_read_b64_tr_b16 a[232:233], v63 offset:49152
    v_cvt_pk_bf16_f32 v96, v96, v97
    v_mfma_f32_16x16x32_bf16 v[124:127], a[204:207], v[212:215], v[124:127]
    s_waitcnt lgkmcnt(9)
    ds_read_b64_tr_b16 a[234:235], v63 offset:51200
    v_cvt_pk_bf16_f32 v97, v98, v99
    v_mfma_f32_16x16x32_bf16 v[112:115], a[208:211], v[200:203], v[112:115]
    ds_read_b64_tr_b16 a[236:237], v63 offset:53248
    v_cvt_pk_bf16_f32 v98, v100, v101
    v_mfma_f32_16x16x32_bf16 v[112:115], a[212:215], v[204:207], v[112:115]
    buffer_load_dwordx4 v[144:147], v44, s[8:11], s74 offen sc0 sc1
    ds_read_b64_tr_b16 a[238:239], v63 offset:55296
    v_mfma_f32_16x16x32_bf16 v[120:123], a[208:211], v[216:219], v[120:123]
    s_add_u32 s74, s70, 20480
    ds_read_b64_tr_b16 a[240:241], v62 offset:57344
    v_cvt_pk_bf16_f32 v99, v102, v103
    v_mfma_f32_16x16x32_bf16 v[120:123], a[212:215], v[220:223], v[120:123]
    s_waitcnt lgkmcnt(9)
    ds_read_b64_tr_b16 a[242:243], v62 offset:59392
    v_min_u32 v96, -2, v96
    v_mfma_f32_16x16x32_bf16 v[116:119], a[216:219], v[200:203], v[116:119]
    ds_read_b64_tr_b16 a[244:245], v62 offset:61440
    v_min_u32 v97, -2, v97
    v_mfma_f32_16x16x32_bf16 v[116:119], a[220:223], v[204:207], v[116:119]
    buffer_load_dwordx4 v[148:151], v44, s[8:11], s74 offen sc0 sc1
    ds_read_b64_tr_b16 a[246:247], v62 offset:63488
    v_mfma_f32_16x16x32_bf16 v[124:127], a[216:219], v[216:219], v[124:127]
    s_add_u32 s74, s70, 24576
    ds_read_b64_tr_b16 a[248:249], v63 offset:57344
    v_min_u32 v98, -2, v98
    v_mfma_f32_16x16x32_bf16 v[124:127], a[220:223], v[220:223], v[124:127]
    s_waitcnt lgkmcnt(9)
    ds_read_b64_tr_b16 a[250:251], v63 offset:59392
    v_min_u32 v99, -2, v99
    v_mfma_f32_16x16x32_bf16 v[112:115], a[224:227], v[224:227], v[112:115]
    s_add_u32 s75, s18, 8388608
    ds_read_b64_tr_b16 a[252:253], v63 offset:61440
    v_mov_b32 v19, v16
    v_mfma_f32_16x16x32_bf16 v[112:115], a[228:231], v[228:231], v[112:115]
    buffer_load_dwordx4 v[152:155], v44, s[8:11], s74 offen sc0 sc1
    ds_read_b64_tr_b16 a[254:255], v63 offset:63488
    v_mfma_f32_16x16x32_bf16 v[120:123], a[224:227], v[240:243], v[120:123]
    s_waitcnt lgkmcnt(9)
    s_add_u32 s74, s70, 28672
    v_permlane32_swap_b32 v16, v19
    v_mfma_f32_16x16x32_bf16 v[120:123], a[228:231], v[244:247], v[120:123]
    buffer_store_dwordx4 v[96:99], v23, s[8:11], s75 offen offset:512 sc0 sc1
    v_add_f32 v16, v16, v19
    v_mfma_f32_16x16x32_bf16 v[116:119], a[232:235], v[224:227], v[116:119]
    s_waitcnt lgkmcnt(7)
    v_cvt_pk_bf16_f32 v104, v104, v105
    v_mfma_f32_16x16x32_bf16 v[116:119], a[236:239], v[228:231], v[116:119]
    buffer_load_dwordx4 v[156:159], v44, s[8:11], s74 offen sc0 sc1
    v_mfma_f32_16x16x32_bf16 v[124:127], a[232:235], v[240:243], v[124:127]
    v_cvt_pk_bf16_f32 v105, v106, v107
    v_mfma_f32_16x16x32_bf16 v[124:127], a[236:239], v[244:247], v[124:127]
    s_waitcnt lgkmcnt(4)
    v_cvt_pk_bf16_f32 v106, v108, v109
    v_mfma_f32_16x16x32_bf16 v[112:115], a[240:243], v[232:235], v[112:115]
    v_cvt_pk_bf16_f32 v107, v110, v111
    v_mfma_f32_16x16x32_bf16 v[112:115], a[244:247], v[236:239], v[112:115]
    v_min_u32 v104, -2, v104
    v_mfma_f32_16x16x32_bf16 v[120:123], a[240:243], v[248:251], v[120:123]
    v_min_u32 v105, -2, v105
    v_mfma_f32_16x16x32_bf16 v[120:123], a[244:247], v[252:255], v[120:123]
    s_waitcnt lgkmcnt(0)
    v_min_u32 v106, -2, v106
    v_mfma_f32_16x16x32_bf16 v[116:119], a[248:251], v[232:235], v[116:119]
    v_min_u32 v107, -2, v107
    v_mfma_f32_16x16x32_bf16 v[116:119], a[252:255], v[236:239], v[116:119]
    s_add_u32 s75, s18, 8519680
    v_mfma_f32_16x16x32_bf16 v[124:127], a[248:251], v[248:251], v[124:127]
    buffer_store_dwordx4 v[104:107], v23, s[8:11], s75 offen offset:512 sc0 sc1
    v_mfma_f32_16x16x32_bf16 v[124:127], a[252:255], v[252:255], v[124:127]
    v_cvt_pk_bf16_f32 v112, v112, v113
    v_cvt_pk_bf16_f32 v113, v114, v115
    s_nop 1
    v_cvt_pk_bf16_f32 v114, v116, v117
    v_cvt_pk_bf16_f32 v115, v118, v119
    v_min_u32 v112, -2, v112
    v_min_u32 v113, -2, v113
    v_min_u32 v114, -2, v114
    v_min_u32 v115, -2, v115
    s_add_u32 s75, s18, 8388608
    buffer_store_dwordx4 v[112:115], v23, s[8:11], s75 offen offset:768 sc0 sc1
    v_cvt_pk_bf16_f32 v120, v120, v121
    v_cvt_pk_bf16_f32 v121, v122, v123
    v_cvt_pk_bf16_f32 v122, v124, v125
    v_cvt_pk_bf16_f32 v123, v126, v127
    v_min_u32 v120, -2, v120
    v_min_u32 v121, -2, v121
    v_min_u32 v122, -2, v122
    v_min_u32 v123, -2, v123
    s_add_u32 s75, s18, 8519680
    buffer_store_dwordx4 v[120:123], v23, s[8:11], s75 offen offset:768 sc0 sc1
    s_mov_b32 s12, 0xf000f
    s_mov_b32 s13, 0xf000f
    v_mov_b64 v[192:193], -1
    v_mov_b64 v[194:195], -1
    v_mov_b64 v[196:197], -1
    v_mov_b64 v[198:199], -1
    v_mov_b64 v[200:201], -1
    v_mov_b64 v[202:203], -1
    v_mov_b64 v[204:205], -1
    v_mov_b64 v[206:207], -1
    v_mov_b64 v[208:209], -1
    v_mov_b64 v[210:211], -1
    v_mov_b64 v[212:213], -1
    v_mov_b64 v[214:215], -1
    v_mov_b64 v[216:217], -1
    v_mov_b64 v[218:219], -1
    v_mov_b64 v[220:221], -1
    v_mov_b64 v[222:223], -1
    s_mov_b64 exec, s[12:13]
    s_add_u32 s74, s70, 8388608
    buffer_load_dwordx4 v[192:195], v44, s[8:11], s74 offen sc0 sc1
    s_add_u32 s74, s70, 8392704
    buffer_load_dwordx4 v[196:199], v44, s[8:11], s74 offen sc0 sc1
    s_add_u32 s74, s70, 8396800
    buffer_load_dwordx4 v[200:203], v44, s[8:11], s74 offen sc0 sc1
    s_add_u32 s74, s70, 8400896
    buffer_load_dwordx4 v[204:207], v44, s[8:11], s74 offen sc0 sc1
    s_add_u32 s74, s70, 8404992
    buffer_load_dwordx4 v[208:211], v44, s[8:11], s74 offen sc0 sc1
    s_add_u32 s74, s70, 8409088
    buffer_load_dwordx4 v[212:215], v44, s[8:11], s74 offen sc0 sc1
    s_add_u32 s74, s70, 8413184
    buffer_load_dwordx4 v[216:219], v44, s[8:11], s74 offen sc0 sc1
    s_add_u32 s74, s70, 8417280
    buffer_load_dwordx4 v[220:223], v44, s[8:11], s74 offen sc0 sc1
    s_mov_b64 exec, -1
    v_mov_b32 v100, 0x3f80
    v_mov_b32 v101, 0x3f800000
    v_lshlrev_b32 v88, 16, v36
    v_and_b32 v89, 0xffff0000, v36
    v_lshlrev_b32 v90, 16, v37
    v_and_b32 v91, 0xffff0000, v37
    v_lshlrev_b32 v92, 16, v38
    v_and_b32 v93, 0xffff0000, v38
    v_lshlrev_b32 v94, 16, v39
    v_and_b32 v95, 0xffff0000, v39
    v_lshlrev_b32 v72, 16, v32
    v_and_b32 v73, 0xffff0000, v32
    v_lshlrev_b32 v74, 16, v33
    v_and_b32 v75, 0xffff0000, v33
    v_lshlrev_b32 v76, 16, v34
    v_and_b32 v77, 0xffff0000, v34
    v_lshlrev_b32 v78, 16, v35
    v_and_b32 v79, 0xffff0000, v35
    s_waitcnt vmcnt(20)
    v_max_u32 v3, v128, v129
    v_max3_u32 v3, v3, v130, v131
    s_waitcnt vmcnt(18)
    v_max3_u32 v3, v3, v132, v133
    v_max3_u32 v3, v3, v134, v135
    s_waitcnt vmcnt(17)
    v_max3_u32 v3, v3, v136, v137
    v_max3_u32 v3, v3, v138, v139
    s_waitcnt vmcnt(16)
    v_max3_u32 v3, v3, v140, v141
    v_max3_u32 v3, v3, v142, v143
    s_waitcnt vmcnt(15)
    v_max3_u32 v3, v3, v144, v145
    v_max3_u32 v3, v3, v146, v147
    s_waitcnt vmcnt(14)
    v_max3_u32 v3, v3, v148, v149
    v_max3_u32 v3, v3, v150, v151
    s_waitcnt vmcnt(13)
    v_max3_u32 v3, v3, v152, v153
    v_max3_u32 v3, v3, v154, v155
    s_waitcnt vmcnt(11)
    v_max3_u32 v3, v3, v156, v157
    v_max3_u32 v3, v3, v158, v159
    v_cmp_eq_u32 vcc, -1, v3
    s_cbranch_vccnz L_P1_slow_15
L_P1_ok_16:
    v_lshlrev_b32 v64, 16, v128
    v_and_b32 v65, 0xffff0000, v128
    v_lshlrev_b32 v66, 16, v129
    v_and_b32 v67, 0xffff0000, v129
    v_lshlrev_b32 v68, 16, v130
    v_and_b32 v69, 0xffff0000, v130
    v_lshlrev_b32 v70, 16, v131
    v_and_b32 v71, 0xffff0000, v131
    v_dot2c_f32_bf16 v64, v132, v100
    v_dot2c_f32_bf16 v65, v132, v101
    v_dot2c_f32_bf16 v66, v133, v100
    v_dot2c_f32_bf16 v67, v133, v101
    v_dot2c_f32_bf16 v68, v134, v100
    v_dot2c_f32_bf16 v69, v134, v101
    v_dot2c_f32_bf16 v70, v135, v100
    v_dot2c_f32_bf16 v71, v135, v101
    v_dot2c_f32_bf16 v64, v136, v100
    v_dot2c_f32_bf16 v65, v136, v101
    v_dot2c_f32_bf16 v66, v137, v100
    v_dot2c_f32_bf16 v67, v137, v101
    v_dot2c_f32_bf16 v68, v138, v100
    v_dot2c_f32_bf16 v69, v138, v101
    v_dot2c_f32_bf16 v70, v139, v100
    v_dot2c_f32_bf16 v71, v139, v101
    v_dot2c_f32_bf16 v64, v140, v100
    v_dot2c_f32_bf16 v65, v140, v101
    v_dot2c_f32_bf16 v66, v141, v100
    v_dot2c_f32_bf16 v67, v141, v101
    v_dot2c_f32_bf16 v68, v142, v100
    v_dot2c_f32_bf16 v69, v142, v101
    v_dot2c_f32_bf16 v70, v143, v100
    v_dot2c_f32_bf16 v71, v143, v101
    v_dot2c_f32_bf16 v64, v144, v100
    v_dot2c_f32_bf16 v65, v144, v101
    v_dot2c_f32_bf16 v66, v145, v100
    v_dot2c_f32_bf16 v67, v145, v101
    v_dot2c_f32_bf16 v68, v146, v100
    v_dot2c_f32_bf16 v69, v146, v101
    v_dot2c_f32_bf16 v70, v147, v100
    v_dot2c_f32_bf16 v71, v147, v101
    v_dot2c_f32_bf16 v64, v148, v100
    v_dot2c_f32_bf16 v65, v148, v101
    v_dot2c_f32_bf16 v66, v149, v100
    v_dot2c_f32_bf16 v67, v149, v101
    v_dot2c_f32_bf16 v68, v150, v100
    v_dot2c_f32_bf16 v69, v150, v101
    v_dot2c_f32_bf16 v70, v151, v100
    v_dot2c_f32_bf16 v71, v151, v101
    v_dot2c_f32_bf16 v64, v152, v100
    v_dot2c_f32_bf16 v65, v152, v101
    v_dot2c_f32_bf16 v66, v153, v100
    v_dot2c_f32_bf16 v67, v153, v101
    v_dot2c_f32_bf16 v68, v154, v100
    v_dot2c_f32_bf16 v69, v154, v101
    v_dot2c_f32_bf16 v70, v155, v100
    v_dot2c_f32_bf16 v71, v155, v101
    v_dot2c_f32_bf16 v64, v156, v100
    v_dot2c_f32_bf16 v65, v156, v101
    v_dot2c_f32_bf16 v66, v157, v100
    v_dot2c_f32_bf16 v67, v157, v101
    v_dot2c_f32_bf16 v68, v158, v100
    v_dot2c_f32_bf16 v69, v158, v101
    v_dot2c_f32_bf16 v70, v159, v100
    v_dot2c_f32_bf16 v71, v159, v101
    v_pk_fma_f32 v[64:65], v[64:65], v[160:161], v[72:73]
    v_pk_fma_f32 v[66:67], v[66:67], v[162:163], v[74:75]
    v_pk_fma_f32 v[68:69], v[68:69], v[164:165], v[76:77]
    v_pk_fma_f32 v[70:71], v[70:71], v[166:167], v[78:79]
    v_cvt_pk_bf16_f32 v32, v64, v65
    v_cvt_pk_bf16_f32 v33, v66, v67
    v_cvt_pk_bf16_f32 v34, v68, v69
    v_cvt_pk_bf16_f32 v35, v70, v71
    v_lshlrev_b32 v64, 16, v32
    v_and_b32 v65, 0xffff0000, v32
    v_lshlrev_b32 v66, 16, v33
    v_and_b32 v67, 0xffff0000, v33
    v_lshlrev_b32 v68, 16, v34
    v_and_b32 v69, 0xffff0000, v34
    v_lshlrev_b32 v70, 16, v35
    v_and_b32 v71, 0xffff0000, v35
    v_pk_add_f32 v[48:49], v[64:65], v[66:67]
    v_pk_add_f32 v[50:51], v[68:69], v[70:71]
    v_pk_add_f32 v[48:49], v[48:49], v[50:51]
    v_add_f32 v48, v48, v49
    s_nop 1
    v_add_f32_dpp v48, v48, v48 quad_perm:[1,0,3,2] row_mask:0xf bank_mask:0xf
    s_nop 1
    v_add_f32_dpp v48, v48, v48 quad_perm:[2,3,0,1] row_mask:0xf bank_mask:0xf
    s_nop 1
    v_add_f32_dpp v48, v48, v48 row_half_mirror row_mask:0xf bank_mask:0xf
    s_nop 1
    v_add_f32_dpp v48, v48, v48 row_mirror row_mask:0xf bank_mask:0xf
    v_mov_b32 v49, v48
    s_nop 1
    v_permlane16_swap_b32 v48, v49
    v_add_f32 v48, v48, v49
    v_mov_b32 v49, v48
    s_nop 1
    v_permlane32_swap_b32 v48, v49
    v_add_f32 v48, v48, v49
    v_mul_f32 v48, 0xbb000000, v48
    v_pk_add_f32 v[72:73], v[64:65], v[48:49] op_sel_hi:[1,0]
    v_pk_add_f32 v[74:75], v[66:67], v[48:49] op_sel_hi:[1,0]
    v_pk_add_f32 v[76:77], v[68:69], v[48:49] op_sel_hi:[1,0]
    v_pk_add_f32 v[78:79], v[70:71], v[48:49] op_sel_hi:[1,0]
    v_pk_mul_f32 v[50:51], v[72:73], v[72:73]
    v_pk_mul_f32 v[52:53], v[72:73], v[8:9]
    v_pk_fma_f32 v[50:51], v[74:75], v[74:75], v[50:51]
    v_pk_fma_f32 v[52:53], v[74:75], v[10:11], v[52:53]
    v_pk_fma_f32 v[50:51], v[76:77], v[76:77], v[50:51]
    v_pk_fma_f32 v[52:53], v[76:77], v[12:13], v[52:53]
    v_pk_fma_f32 v[50:51], v[78:79], v[78:79], v[50:51]
    v_pk_fma_f32 v[52:53], v[78:79], v[14:15], v[52:53]
    v_add_f32 v50, v50, v51
    v_add_f32 v52, v52, v53
    s_nop 0
    v_add_f32_dpp v50, v50, v50 quad_perm:[1,0,3,2] row_mask:0xf bank_mask:0xf
    v_add_f32_dpp v52, v52, v52 quad_perm:[1,0,3,2] row_mask:0xf bank_mask:0xf
    s_nop 0
    v_add_f32_dpp v50, v50, v50 quad_perm:[2,3,0,1] row_mask:0xf bank_mask:0xf
    v_add_f32_dpp v52, v52, v52 quad_perm:[2,3,0,1] row_mask:0xf bank_mask:0xf
    s_nop 0
    v_add_f32_dpp v50, v50, v50 row_half_mirror row_mask:0xf bank_mask:0xf
    v_add_f32_dpp v52, v52, v52 row_half_mirror row_mask:0xf bank_mask:0xf
    s_nop 0
    v_add_f32_dpp v50, v50, v50 row_mirror row_mask:0xf bank_mask:0xf
    v_add_f32_dpp v52, v52, v52 row_mirror row_mask:0xf bank_mask:0xf
    v_mov_b32 v51, v50
    v_mov_b32 v53, v52
    s_nop 0
    v_permlane16_swap_b32 v50, v51
    v_permlane16_swap_b32 v52, v53
    v_add_f32 v50, v50, v51
    v_add_f32 v52, v52, v53
    v_mov_b32 v51, v50
    v_mov_b32 v53, v52
    s_nop 0
    v_permlane32_swap_b32 v50, v51
    v_permlane32_swap_b32 v52, v53
    v_add_f32 v50, v50, v51
    v_add_f32 v52, v52, v53
    v_mov_b32 v48, 0x3727c5ac
    v_fmac_f32 v48, 0x3b000000, v50
    v_rsq_f32 v48, v48
    s_nop 0
    v_fma_f32 v52, v52, v48, v16
    v_ashrrev_i32 v53, 31, v52
    v_or_b32 v53, 0x80000000, v53
    v_xor_b32 v53, v53, v52
    v_and_b32 v53, 0xfffff800, v53
    v_or_b32 v17, s68, v53
    v_pk_mul_f32 v[72:73], v[72:73], v[48:49] op_sel_hi:[1,0]
    v_pk_mul_f32 v[74:75], v[74:75], v[48:49] op_sel_hi:[1,0]
    v_pk_mul_f32 v[76:77], v[76:77], v[48:49] op_sel_hi:[1,0]
    v_pk_mul_f32 v[78:79], v[78:79], v[48:49] op_sel_hi:[1,0]
    v_pk_fma_f32 v[72:73], v[72:73], v[168:169], v[176:177]
    v_pk_fma_f32 v[74:75], v[74:75], v[170:171], v[178:179]
    v_pk_fma_f32 v[76:77], v[76:77], v[172:173], v[180:181]
    v_pk_fma_f32 v[78:79], v[78:79], v[174:175], v[182:183]
    v_cvt_pk_bf16_f32 v20, v72, v73
    v_cvt_pk_bf16_f32 v21, v74, v75
    v_cvt_pk_bf16_f32 v22, v76, v77
    v_cvt_pk_bf16_f32 v23, v78, v79
    v_lshlrev_b32 v98, 4, v0
    v_cmp_gt_u32 vcc, 224, v0
    v_mov_b32 v99, 2147479552
    s_nop 0
    v_cndmask_b32 v99, v99, v98, vcc
    s_lshl_b32 s17, s66, 13
    s_add_u32 s17, s17, 4194304
    s_cmp_lt_u32 s66, 224
    s_cselect_b32 s17, s17, 2143285248
    s_lshl_b32 s100, s3, 2
    v_mov_b32 v47, s100
    v_mov_b32 v102, 0
    s_lshl_b32 s100, s2, 6
    s_add_u32 s100, s100, 65536
    s_lshl_b32 s101, s2, 11
    s_add_u32 s101, s101, 524288
    s_branch L_op_join
L_op_odd:
    s_waitcnt lgkmcnt(14)
    v_mfma_f32_16x16x32_bf16 v[64:67], a[192:195], a[64:67], 0
    s_waitcnt lgkmcnt(12)
    s_add_u32 m0, s62, 0
    ds_read_b64_tr_b16 a[224:225], v56 offset:49152
    v_mfma_f32_16x16x32_bf16 v[64:67], a[196:199], a[68:71], v[64:67]
    s_xor_b32 s98, s65, 128
    ds_read_b64_tr_b16 a[226:227], v56 offset:51200
    v_mfma_f32_16x16x32_bf16 v[72:75], a[192:195], a[80:83], 0
    buffer_load_dwordx4 v24, s[28:31], s98 offen offset:0   lds
    v_mfma_f32_16x16x32_bf16 v[72:75], a[196:199], a[84:87], v[72:75]
    s_waitcnt lgkmcnt(12)
    ds_read_b64_tr_b16 a[228:229], v56 offset:53248
    v_mfma_f32_16x16x32_bf16 v[68:71], a[200:203], a[64:67], 0
    s_waitcnt lgkmcnt(11)
    ds_read_b64_tr_b16 a[230:231], v56 offset:55296
    v_mfma_f32_16x16x32_bf16 v[68:71], a[204:207], a[68:71], v[68:71]
    s_add_u32 s22, s22, 65536
    ds_read_b64_tr_b16 a[232:233], v57 offset:49152
    v_mfma_f32_16x16x32_bf16 v[76:79], a[200:203], a[80:83], 0
    buffer_load_dwordx4 v25, s[28:31], s98 offen offset:1024   lds
    ds_read_b64_tr_b16 a[234:235], v57 offset:51200
    v_mfma_f32_16x16x32_bf16 v[76:79], a[204:207], a[84:87], v[76:79]
    s_waitcnt lgkmcnt(12)
    s_add_u32 s23, s23, 65536
    ds_read_b64_tr_b16 a[236:237], v57 offset:53248
    v_mfma_f32_16x16x32_bf16 v[64:67], a[208:211], a[72:75], v[64:67]
    s_waitcnt lgkmcnt(11)
    s_lshl_b32 s24, s61, 2
    ds_read_b64_tr_b16 a[238:239], v57 offset:55296
    v_mfma_f32_16x16x32_bf16 v[64:67], a[212:215], a[76:79], v[64:67]
    s_add_u32 s24, s24, s3
    ds_read_b64_tr_b16 a[240:241], v56 offset:57344
    v_mfma_f32_16x16x32_bf16 v[72:75], a[208:211], a[88:91], v[72:75]
    buffer_load_dwordx4 v26, s[28:31], s98 offen offset:2048   lds
    v_mfma_f32_16x16x32_bf16 v[72:75], a[212:215], a[92:95], v[72:75]
    s_waitcnt lgkmcnt(7)
    s_lshl_b32 s24, s24, 3
    ds_read_b64_tr_b16 a[242:243], v56 offset:59392
    v_mfma_f32_16x16x32_bf16 v[68:71], a[216:219], a[72:75], v[68:71]
    s_add_u32 s24, s24, s4
    ds_read_b64_tr_b16 a[244:245], v56 offset:61440
    v_mfma_f32_16x16x32_bf16 v[68:71], a[220:223], a[76:79], v[68:71]
    s_lshl_b32 s24, s24, 2
    ds_read_b64_tr_b16 a[246:247], v56 offset:63488
    v_mfma_f32_16x16x32_bf16 v[76:79], a[216:219], a[88:91], v[76:79]
    buffer_load_dwordx4 v27, s[28:31], s98 offen offset:3072   lds
    ds_read_b64_tr_b16 a[248:249], v57 offset:57344
    v_mfma_f32_16x16x32_bf16 v[76:79], a[220:223], a[92:95], v[76:79]
    s_add_u32 m0, s62, 4096
    ds_read_b64_tr_b16 a[250:251], v57 offset:59392
    v_mfma_f32_16x16x32_bf16 v[64:67], a[224:227], a[96:99], v[64:67]
    s_waitcnt lgkmcnt(8)
    s_xor_b32 s98, s65, 32896
    ds_read_b64_tr_b16 a[252:253], v57 offset:61440
    v_mfma_f32_16x16x32_bf16 v[64:67], a[228:231], a[100:103], v[64:67]
    s_add_u32 s24, s24, s5
    ds_read_b64_tr_b16 a[254:255], v57 offset:63488
    v_mfma_f32_16x16x32_bf16 v[72:75], a[224:227], a[112:115], v[72:75]
    buffer_load_dwordx4 v24, s[28:31], s98 offen offset:0   lds
    v_mfma_f32_16x16x32_bf16 v[72:75], a[228:231], a[116:119], v[72:75]
    s_lshl_b32 s24, s24, 13
    ds_read_b64_tr_b16 a[192:193], v58 offset:32768
    v_mfma_f32_16x16x32_bf16 v[68:71], a[232:235], a[96:99], v[68:71]
    s_waitcnt lgkmcnt(8)
    s_add_u32 s24, s24, 50331648
    ds_read_b64_tr_b16 a[194:195], v58 offset:34816
    v_mfma_f32_16x16x32_bf16 v[68:71], a[236:239], a[100:103], v[68:71]
    ds_read_b64_tr_b16 a[196:197], v58 offset:36864
    v_mfma_f32_16x16x32_bf16 v[76:79], a[232:235], a[112:115], v[76:79]
    buffer_load_dwordx4 v25, s[28:31], s98 offen offset:1024   lds
    ds_read_b64_tr_b16 a[198:199], v58 offset:38912
    v_mfma_f32_16x16x32_bf16 v[76:79], a[236:239], a[116:119], v[76:79]
    s_waitcnt lgkmcnt(8)
    ds_read_b64_tr_b16 a[200:201], v59 offset:32768
    v_mfma_f32_16x16x32_bf16 v[64:67], a[240:243], a[104:107], v[64:67]
    ds_read_b64_tr_b16 a[202:203], v59 offset:34816
    v_mfma_f32_16x16x32_bf16 v[64:67], a[244:247], a[108:111], v[64:67]
    ds_read_b64_tr_b16 a[204:205], v59 offset:36864
    v_mfma_f32_16x16x32_bf16 v[72:75], a[240:243], a[120:123], v[72:75]
    buffer_load_dwordx4 v26, s[28:31], s98 offen offset:2048   lds
    ds_read_b64_tr_b16 a[206:207], v59 offset:38912
    v_mfma_f32_16x16x32_bf16 v[72:75], a[244:247], a[124:127], v[72:75]
    s_waitcnt lgkmcnt(8)
    ds_read_b64_tr_b16 a[208:209], v58 offset:40960
    v_mfma_f32_16x16x32_bf16 v[68:71], a[248:251], a[104:107], v[68:71]
    ds_read_b64_tr_b16 a[210:211], v58 offset:43008
    v_mfma_f32_16x16x32_bf16 v[68:71], a[252:255], a[108:111], v[68:71]
    ds_read_b64_tr_b16 a[212:213], v58 offset:45056
    v_mfma_f32_16x16x32_bf16 v[76:79], a[248:251], a[120:123], v[76:79]
    buffer_load_dwordx4 v27, s[28:31], s98 offen offset:3072   lds
    ds_read_b64_tr_b16 a[214:215], v58 offset:47104
    v_mfma_f32_16x16x32_bf16 v[76:79], a[252:255], a[124:127], v[76:79]
    s_waitcnt lgkmcnt(9)
    ds_read_b64_tr_b16 a[216:217], v59 offset:40960
    v_mfma_f32_16x16x32_bf16 v[80:83], a[192:195], a[64:67], 0
    s_waitcnt lgkmcnt(9)
    ds_read_b64_tr_b16 a[218:219], v59 offset:43008
    v_mfma_f32_16x16x32_bf16 v[80:83], a[196:199], a[68:71], v[80:83]
    ds_read_b64_tr_b16 a[220:221], v59 offset:45056
    v_mfma_f32_16x16x32_bf16 v[88:91], a[192:195], a[80:83], 0
    ds_read_b64_tr_b16 a[222:223], v59 offset:47104
    s_waitcnt vmcnt(16)
    s_barrier
    v_mfma_f32_16x16x32_bf16 v[88:91], a[196:199], a[84:87], v[88:91]
    s_waitcnt lgkmcnt(9)
    s_add_u32 m0, s62, 98304
    ds_read_b64_tr_b16 a[224:225], v58 offset:49152
    v_mfma_f32_16x16x32_bf16 v[84:87], a[200:203], a[64:67], 0
    s_waitcnt lgkmcnt(9)
    s_xor_b32 s98, s65, 262272
    ds_read_b64_tr_b16 a[226:227], v58 offset:51200
    v_mfma_f32_16x16x32_bf16 v[84:87], a[204:207], a[68:71], v[84:87]
    buffer_load_dwordx4 v24, s[28:31], s98 offen offset:0   lds
    ds_read_b64_tr_b16 a[228:229], v58 offset:53248
    v_mfma_f32_16x16x32_bf16 v[92:95], a[200:203], a[80:83], 0
    ds_read_b64_tr_b16 a[230:231], v58 offset:55296
    v_mfma_f32_16x16x32_bf16 v[92:95], a[204:207], a[84:87], v[92:95]
    s_waitcnt lgkmcnt(9)
    ds_read_b64_tr_b16 a[232:233], v59 offset:49152
    v_mfma_f32_16x16x32_bf16 v[80:83], a[208:211], a[72:75], v[80:83]
    s_waitcnt lgkmcnt(9)
    ds_read_b64_tr_b16 a[234:235], v59 offset:51200
    v_mfma_f32_16x16x32_bf16 v[80:83], a[212:215], a[76:79], v[80:83]
    buffer_load_dwordx4 v25, s[28:31], s98 offen offset:1024   lds
    ds_read_b64_tr_b16 a[236:237], v59 offset:53248
    v_mfma_f32_16x16x32_bf16 v[88:91], a[208:211], a[88:91], v[88:91]
    ds_read_b64_tr_b16 a[238:239], v59 offset:55296
    v_mfma_f32_16x16x32_bf16 v[88:91], a[212:215], a[92:95], v[88:91]
    s_waitcnt lgkmcnt(9)
    ds_read_b64_tr_b16 a[240:241], v58 offset:57344
    v_mfma_f32_16x16x32_bf16 v[84:87], a[216:219], a[72:75], v[84:87]
    s_waitcnt lgkmcnt(9)
    ds_read_b64_tr_b16 a[242:243], v58 offset:59392
    v_mfma_f32_16x16x32_bf16 v[84:87], a[220:223], a[76:79], v[84:87]
    buffer_load_dwordx4 v26, s[28:31], s98 offen offset:2048   lds
    ds_read_b64_tr_b16 a[244:245], v58 offset:61440
    v_mfma_f32_16x16x32_bf16 v[92:95], a[216:219], a[88:91], v[92:95]
    ds_read_b64_tr_b16 a[246:247], v58 offset:63488
    v_mfma_f32_16x16x32_bf16 v[92:95], a[220:223], a[92:95], v[92:95]
    s_waitcnt lgkmcnt(9)
    ds_read_b64_tr_b16 a[248:249], v59 offset:57344
    v_mfma_f32_16x16x32_bf16 v[80:83], a[224:227], a[96:99], v[80:83]
    s_waitcnt lgkmcnt(9)
    ds_read_b64_tr_b16 a[250:251], v59 offset:59392
    v_mfma_f32_16x16x32_bf16 v[80:83], a[228:231], a[100:103], v[80:83]
    buffer_load_dwordx4 v27, s[28:31], s98 offen offset:3072   lds
    ds_read_b64_tr_b16 a[252:253], v59 offset:61440
    v_mfma_f32_16x16x32_bf16 v[88:91], a[224:227], a[112:115], v[88:91]
    s_add_u32 m0, s62, 102400
    ds_read_b64_tr_b16 a[254:255], v59 offset:63488
    v_mfma_f32_16x16x32_bf16 v[88:91], a[228:231], a[116:119], v[88:91]
    s_waitcnt lgkmcnt(9)
    s_xor_b32 s98, s65, 295040
    ds_read_b64_tr_b16 a[192:193], v60 offset:0
    v_mfma_f32_16x16x32_bf16 v[84:87], a[232:235], a[96:99], v[84:87]
    s_waitcnt lgkmcnt(9)
    ds_read_b64_tr_b16 a[194:195], v60 offset:2048
    v_mfma_f32_16x16x32_bf16 v[84:87], a[236:239], a[100:103], v[84:87]
    buffer_load_dwordx4 v24, s[28:31], s98 offen offset:0   lds
    ds_read_b64_tr_b16 a[196:197], v60 offset:4096
    v_mfma_f32_16x16x32_bf16 v[92:95], a[232:235], a[112:115], v[92:95]
    ds_read_b64_tr_b16 a[198:199], v60 offset:6144
    v_mfma_f32_16x16x32_bf16 v[92:95], a[236:239], a[116:119], v[92:95]
    s_waitcnt lgkmcnt(9)
    ds_read_b64_tr_b16 a[200:201], v61 offset:0
    v_mfma_f32_16x16x32_bf16 v[80:83], a[240:243], a[104:107], v[80:83]
    s_waitcnt lgkmcnt(9)
    ds_read_b64_tr_b16 a[202:203], v61 offset:2048
    v_mfma_f32_16x16x32_bf16 v[80:83], a[244:247], a[108:111], v[80:83]
    buffer_load_dwordx4 v25, s[28:31], s98 offen offset:1024   lds
    ds_read_b64_tr_b16 a[204:205], v61 offset:4096
    v_mfma_f32_16x16x32_bf16 v[88:91], a[240:243], a[120:123], v[88:91]
    ds_read_b64_tr_b16 a[206:207], v61 offset:6144
    v_mfma_f32_16x16x32_bf16 v[88:91], a[244:247], a[124:127], v[88:91]
    s_waitcnt lgkmcnt(9)
    ds_read_b64_tr_b16 a[208:209], v60 offset:8192
    v_mfma_f32_16x16x32_bf16 v[84:87], a[248:251], a[104:107], v[84:87]
    s_waitcnt lgkmcnt(9)
    ds_read_b64_tr_b16 a[210:211], v60 offset:10240
    v_lshrrev_b32 v46, 2, v2
    v_mfma_f32_16x16x32_bf16 v[84:87], a[252:255], a[108:111], v[84:87]
    buffer_load_dwordx4 v26, s[28:31], s98 offen offset:2048   lds
    ds_read_b64_tr_b16 a[212:213], v60 offset:12288
    v_mfma_f32_16x16x32_bf16 v[92:95], a[248:251], a[120:123], v[92:95]
    ds_read_b64_tr_b16 a[214:215], v60 offset:14336
    v_and_b32 v45, 3, v2
    v_mfma_f32_16x16x32_bf16 v[92:95], a[252:255], a[124:127], v[92:95]
    s_waitcnt lgkmcnt(9)
    ds_read_b64_tr_b16 a[216:217], v61 offset:8192
    v_lshlrev_b32 v44, 8, v46
    v_mfma_f32_16x16x32_bf16 v[64:67], a[192:195], a[0:3], v[64:67]
    s_waitcnt lgkmcnt(9)
    ds_read_b64_tr_b16 a[218:219], v61 offset:10240
    v_lshl_add_u32 v44, v45, 4, v44
    v_mfma_f32_16x16x32_bf16 v[64:67], a[196:199], a[4:7], v[64:67]
    buffer_load_dwordx4 v27, s[28:31], s98 offen offset:3072   lds
    ds_read_b64_tr_b16 a[220:221], v61 offset:12288
    v_mfma_f32_16x16x32_bf16 v[72:75], a[192:195], a[16:19], v[72:75]
    ds_read_b64_tr_b16 a[222:223], v61 offset:14336
    v_lshlrev_b32 v45, 3, v45
    v_mfma_f32_16x16x32_bf16 v[72:75], a[196:199], a[20:23], v[72:75]
    s_waitcnt lgkmcnt(9)
    ds_read_b64_tr_b16 a[224:225], v60 offset:16384
    v_lshl_add_u32 v45, v46, 6, v45
    v_mfma_f32_16x16x32_bf16 v[68:71], a[200:203], a[0:3], v[68:71]
    s_waitcnt lgkmcnt(9)
    ds_read_b64_tr_b16 a[226:227], v60 offset:18432
    v_lshlrev_b32 v46, 1, v45
    v_mfma_f32_16x16x32_bf16 v[68:71], a[204:207], a[4:7], v[68:71]
    s_lshl_b32 s70, s2, 15
    ds_read_b64_tr_b16 a[228:229], v60 offset:20480
    v_mfma_f32_16x16x32_bf16 v[76:79], a[200:203], a[16:19], v[76:79]
    s_lshl_b32 s100, s3, 6
    ds_read_b64_tr_b16 a[230:231], v60 offset:22528
    v_mfma_f32_16x16x32_bf16 v[76:79], a[204:207], a[20:23], v[76:79]
    s_waitcnt lgkmcnt(9)
    s_add_u32 s70, s70, s100
    ds_read_b64_tr_b16 a[232:233], v61 offset:16384
    v_mfma_f32_16x16x32_bf16 v[64:67], a[208:211], a[8:11], v[64:67]
    s_waitcnt lgkmcnt(9)
    s_add_u32 s70, s70, 67108864
    ds_read_b64_tr_b16 a[234:235], v61 offset:18432
    v_mfma_f32_16x16x32_bf16 v[64:67], a[212:215], a[12:15], v[64:67]
    s_and_b32 s68, s2, 31
    ds_read_b64_tr_b16 a[236:237], v61 offset:20480
    v_mfma_f32_16x16x32_bf16 v[72:75], a[208:211], a[24:27], v[72:75]
    s_lshl_b32 s68, s68, 2
    ds_read_b64_tr_b16 a[238:239], v61 offset:22528
    v_mfma_f32_16x16x32_bf16 v[72:75], a[212:215], a[28:31], v[72:75]
    s_waitcnt lgkmcnt(9)
    s_add_u32 s68, s68, s3
    ds_read_b64_tr_b16 a[240:241], v60 offset:24576
    v_mfma_f32_16x16x32_bf16 v[68:71], a[216:219], a[8:11], v[68:71]
    s_waitcnt lgkmcnt(9)
    s_lshl_b32 s69, s61, 7
    ds_read_b64_tr_b16 a[242:243], v60 offset:26624
    v_mfma_f32_16x16x32_bf16 v[68:71], a[220:223], a[12:15], v[68:71]
    s_add_u32 s69, s69, s68
    ds_read_b64_tr_b16 a[244:245], v60 offset:28672
    v_mfma_f32_16x16x32_bf16 v[76:79], a[216:219], a[24:27], v[76:79]
    s_lshl_b32 s100, s60, 7
    ds_read_b64_tr_b16 a[246:247], v60 offset:30720
    v_mfma_f32_16x16x32_bf16 v[76:79], a[220:223], a[28:31], v[76:79]
    s_waitcnt lgkmcnt(9)
    s_add_u32 s68, s68, s100
    ds_read_b64_tr_b16 a[248:249], v61 offset:24576
    v_mfma_f32_16x16x32_bf16 v[64:67], a[224:227], a[32:35], v[64:67]
    s_waitcnt lgkmcnt(9)
    s_lshl_b32 s100, s68, 10
    ds_read_b64_tr_b16 a[250:251], v61 offset:26624
    v_mfma_f32_16x16x32_bf16 v[64:67], a[228:231], a[36:39], v[64:67]
    s_lshl_b32 s101, s69, 10
    ds_read_b64_tr_b16 a[252:253], v61 offset:28672
    v_mfma_f32_16x16x32_bf16 v[72:75], a[224:227], a[48:51], v[72:75]
    ds_read_b64_tr_b16 a[254:255], v61 offset:30720
    ds_read_b64_tr_b16 a[208:209], v62 offset:8192
    v_mfma_f32_16x16x32_bf16 v[72:75], a[228:231], a[52:55], v[72:75]
    s_waitcnt lgkmcnt(10)
    ds_read_b64_tr_b16 a[192:193], v62 offset:0
    ds_read_b64_tr_b16 a[210:211], v62 offset:10240
    v_mfma_f32_16x16x32_bf16 v[68:71], a[232:235], a[32:35], v[68:71]
    s_waitcnt lgkmcnt(11)
    ds_read_b64_tr_b16 a[194:195], v62 offset:2048
    ds_read_b64_tr_b16 a[212:213], v62 offset:12288
    v_mfma_f32_16x16x32_bf16 v[68:71], a[236:239], a[36:39], v[68:71]
    ds_read_b64_tr_b16 a[196:197], v62 offset:4096
    ds_read_b64_tr_b16 a[214:215], v62 offset:14336
    v_mfma_f32_16x16x32_bf16 v[76:79], a[232:235], a[48:51], v[76:79]
    ds_read_b64_tr_b16 a[198:199], v62 offset:6144
    ds_read_b64_tr_b16 a[216:217], v63 offset:8192
    v_mfma_f32_16x16x32_bf16 v[76:79], a[236:239], a[52:55], v[76:79]
    s_waitcnt lgkmcnt(14)
    ds_read_b64_tr_b16 a[200:201], v63 offset:0
    ds_read_b64_tr_b16 a[218:219], v63 offset:10240
    v_mfma_f32_16x16x32_bf16 v[64:67], a[240:243], a[40:43], v[64:67]
    s_waitcnt lgkmcnt(15)
    ds_read_b64_tr_b16 a[202:203], v63 offset:2048
    ds_read_b64_tr_b16 a[220:221], v63 offset:12288
    v_mfma_f32_16x16x32_bf16 v[64:67], a[244:247], a[44:47], v[64:67]
    ds_read_b64_tr_b16 a[204:205], v63 offset:4096
    ds_read_b64_tr_b16 a[222:223], v63 offset:14336
    v_mfma_f32_16x16x32_bf16 v[72:75], a[240:243], a[56:59], v[72:75]
    s_waitcnt lgkmcnt(15)
    ds_read_b64_tr_b16 a[206:207], v63 offset:6144
    s_waitcnt vmcnt(16)
    v_mfma_f32_16x16x32_bf16 v[72:75], a[244:247], a[60:63], v[72:75]
    buffer_store_dword v6, v5, s[8:11], s22 offen sc0 sc1
    v_mfma_f32_16x16x32_bf16 v[68:71], a[248:251], a[40:43], v[68:71]
    ds_read_b64_tr_b16 a[224:225], v62 offset:16384
    v_mfma_f32_16x16x32_bf16 v[68:71], a[252:255], a[44:47], v[68:71]
    ds_read_b64_tr_b16 a[226:227], v62 offset:18432
    v_mfma_f32_16x16x32_bf16 v[76:79], a[248:251], a[56:59], v[76:79]
    ds_read_b64_tr_b16 a[228:229], v62 offset:20480
    v_mfma_f32_16x16x32_bf16 v[76:79], a[252:255], a[60:63], v[76:79]
    s_waitcnt lgkmcnt(12)
    ds_read_b64_tr_b16 a[230:231], v62 offset:22528
    v_mfma_f32_16x16x32_bf16 v[80:83], a[192:195], a[0:3], v[80:83]
    s_waitcnt lgkmcnt(11)
    ds_read_b64_tr_b16 a[232:233], v63 offset:16384
    v_mfma_f32_16x16x32_bf16 v[80:83], a[196:199], a[4:7], v[80:83]
    ds_read_b64_tr_b16 a[234:235], v63 offset:18432
    v_mfma_f32_16x16x32_bf16 v[88:91], a[192:195], a[16:19], v[88:91]
    ds_read_b64_tr_b16 a[236:237], v63 offset:20480
    v_mfma_f32_16x16x32_bf16 v[88:91], a[196:199], a[20:23], v[88:91]
    s_waitcnt lgkmcnt(8)
    ds_read_b64_tr_b16 a[238:239], v63 offset:22528
    v_mfma_f32_16x16x32_bf16 v[84:87], a[200:203], a[0:3], v[84:87]
    s_waitcnt lgkmcnt(8)
    ds_read_b64_tr_b16 a[240:241], v62 offset:24576
    v_mfma_f32_16x16x32_bf16 v[84:87], a[204:207], a[4:7], v[84:87]
    ds_read_b64_tr_b16 a[242:243], v62 offset:26624
    v_mfma_f32_16x16x32_bf16 v[92:95], a[200:203], a[16:19], v[92:95]
    ds_read_b64_tr_b16 a[244:245], v62 offset:28672
    v_cvt_pk_bf16_f32 v64, v64, v65
    s_waitcnt vmcnt(1)
    s_barrier
    v_mfma_f32_16x16x32_bf16 v[92:95], a[204:207], a[20:23], v[92:95]
    s_xor_b32 s74, s24, 0
    ds_read_b64_tr_b16 a[246:247], v62 offset:30720
    v_cvt_pk_bf16_f32 v65, v66, v67
    v_mfma_f32_16x16x32_bf16 v[80:83], a[208:211], a[8:11], v[80:83]
    buffer_load_dwordx4 v[128:131], v1, s[8:11], s74 offen offset:0
    v_mfma_f32_16x16x32_bf16 v[80:83], a[212:215], a[12:15], v[80:83]
    s_xor_b32 s74, s24, 4096
    ds_read_b64_tr_b16 a[248:249], v63 offset:24576
    v_cvt_pk_bf16_f32 v66, v68, v69
    v_mfma_f32_16x16x32_bf16 v[88:91], a[208:211], a[24:27], v[88:91]
    ds_read_b64_tr_b16 a[250:251], v63 offset:26624
    v_cvt_pk_bf16_f32 v67, v70, v71
    v_mfma_f32_16x16x32_bf16 v[88:91], a[212:215], a[28:31], v[88:91]
    buffer_load_dwordx4 v[144:147], v1, s[8:11], s74 offen offset:0
    ds_read_b64_tr_b16 a[252:253], v63 offset:28672
    v_mfma_f32_16x16x32_bf16 v[84:87], a[216:219], a[8:11], v[84:87]
    s_xor_b32 s74, s24, 0
    ds_read_b64_tr_b16 a[254:255], v63 offset:30720
    v_min_u32 v64, -2, v64
    v_mfma_f32_16x16x32_bf16 v[84:87], a[220:223], a[12:15], v[84:87]
    ds_read_b64_tr_b16 a[192:193], v56 offset:0
    v_min_u32 v65, -2, v65
    v_mfma_f32_16x16x32_bf16 v[92:95], a[216:219], a[24:27], v[92:95]
    buffer_load_dwordx4 v[132:135], v1, s[8:11], s74 offen offset:1024
    v_mfma_f32_16x16x32_bf16 v[92:95], a[220:223], a[28:31], v[92:95]
    s_waitcnt lgkmcnt(7)
    s_xor_b32 s74, s24, 4096
    ds_read_b64_tr_b16 a[194:195], v56 offset:2048
    v_min_u32 v66, -2, v66
    v_mfma_f32_16x16x32_bf16 v[80:83], a[224:227], a[32:35], v[80:83]
    ds_read_b64_tr_b16 a[196:197], v56 offset:4096
    v_min_u32 v67, -2, v67
    v_mfma_f32_16x16x32_bf16 v[80:83], a[228:231], a[36:39], v[80:83]
    buffer_load_dwordx4 v[148:151], v1, s[8:11], s74 offen offset:1024
    v_mfma_f32_16x16x32_bf16 v[88:91], a[224:227], a[48:51], v[88:91]
    s_xor_b32 s74, s24, 0
    ds_read_b64_tr_b16 a[198:199], v56 offset:6144
    v_mfma_f32_16x16x32_bf16 v[88:91], a[228:231], a[52:55], v[88:91]
    s_add_u32 s75, s18, 0
    ds_read_b64_tr_b16 a[200:201], v57 offset:0
    v_mfma_f32_16x16x32_bf16 v[84:87], a[232:235], a[32:35], v[84:87]
    buffer_load_dwordx4 v[136:139], v1, s[8:11], s74 offen offset:2048
    ds_read_b64_tr_b16 a[202:203], v57 offset:2048
    v_mfma_f32_16x16x32_bf16 v[84:87], a[236:239], a[36:39], v[84:87]
    s_xor_b32 s74, s24, 4096
    ds_read_b64_tr_b16 a[204:205], v57 offset:4096
    v_mfma_f32_16x16x32_bf16 v[92:95], a[232:235], a[48:51], v[92:95]
    buffer_store_dwordx4 v[64:67], v23, s[8:11], s75 offen offset:0 sc0 sc1
    ds_read_b64_tr_b16 a[206:207], v57 offset:6144
    v_mfma_f32_16x16x32_bf16 v[92:95], a[236:239], a[52:55], v[92:95]
    buffer_load_dwordx4 v[152:155], v1, s[8:11], s74 offen offset:2048
    v_mfma_f32_16x16x32_bf16 v[80:83], a[240:243], a[40:43], v[80:83]
    s_waitcnt lgkmcnt(7)
    s_xor_b32 s74, s24, 0
    ds_read_b64_tr_b16 a[208:209], v56 offset:8192
    v_cvt_pk_bf16_f32 v72, v72, v73
    v_mfma_f32_16x16x32_bf16 v[80:83], a[244:247], a[44:47], v[80:83]
    ds_read_b64_tr_b16 a[210:211], v56 offset:10240
    v_cvt_pk_bf16_f32 v73, v74, v75
    v_mfma_f32_16x16x32_bf16 v[88:91], a[240:243], a[56:59], v[88:91]
    buffer_load_dwordx4 v[140:143], v1, s[8:11], s74 offen offset:3072
    v_mfma_f32_16x16x32_bf16 v[88:91], a[244:247], a[60:63], v[88:91]
    s_xor_b32 s74, s24, 4096
    ds_read_b64_tr_b16 a[212:213], v56 offset:12288
    v_cvt_pk_bf16_f32 v74, v76, v77
    v_mfma_f32_16x16x32_bf16 v[84:87], a[248:251], a[40:43], v[84:87]
    ds_read_b64_tr_b16 a[214:215], v56 offset:14336
    v_cvt_pk_bf16_f32 v75, v78, v79
    v_mfma_f32_16x16x32_bf16 v[84:87], a[252:255], a[44:47], v[84:87]
    buffer_load_dwordx4 v[156:159], v1, s[8:11], s74 offen offset:3072
    ds_read_b64_tr_b16 a[216:217], v57 offset:8192
    v_mfma_f32_16x16x32_bf16 v[92:95], a[248:251], a[56:59], v[92:95]
    ds_read_b64_tr_b16 a[218:219], v57 offset:10240
    v_min_u32 v72, -2, v72
    v_mfma_f32_16x16x32_bf16 v[92:95], a[252:255], a[60:63], v[92:95]
    s_waitcnt lgkmcnt(7)
    ds_read_b64_tr_b16 a[220:221], v57 offset:12288
    v_min_u32 v73, -2, v73
    v_mfma_f32_16x16x32_bf16 v[96:99], a[192:195], a[64:67], 0
    ds_read_b64_tr_b16 a[222:223], v57 offset:14336
    v_min_u32 v74, -2, v74
    v_mfma_f32_16x16x32_bf16 v[96:99], a[196:199], a[68:71], v[96:99]
    ds_read_b64_tr_b16 a[224:225], v56 offset:16384
    v_min_u32 v75, -2, v75
    v_mfma_f32_16x16x32_bf16 v[104:107], a[192:195], a[80:83], 0
    s_add_u32 s75, s18, 131072
    ds_read_b64_tr_b16 a[226:227], v56 offset:18432
    v_mfma_f32_16x16x32_bf16 v[104:107], a[196:199], a[84:87], v[104:107]
    buffer_store_dwordx4 v[72:75], v23, s[8:11], s75 offen offset:0 sc0 sc1
    ds_read_b64_tr_b16 a[228:229], v56 offset:20480
    v_mfma_f32_16x16x32_bf16 v[100:103], a[200:203], a[64:67], 0
    s_waitcnt lgkmcnt(9)
    ds_read_b64_tr_b16 a[230:231], v56 offset:22528
    v_mfma_f32_16x16x32_bf16 v[100:103], a[204:207], a[68:71], v[100:103]
    ds_read_b64_tr_b16 a[232:233], v57 offset:16384
    v_mfma_f32_16x16x32_bf16 v[108:111], a[200:203], a[80:83], 0
    ds_read_b64_tr_b16 a[234:235], v57 offset:18432
    v_mfma_f32_16x16x32_bf16 v[108:111], a[204:207], a[84:87], v[108:111]
    ds_read_b64_tr_b16 a[236:237], v57 offset:20480
    v_mfma_f32_16x16x32_bf16 v[96:99], a[208:211], a[72:75], v[96:99]
    s_waitcnt lgkmcnt(9)
    ds_read_b64_tr_b16 a[238:239], v57 offset:22528
    v_mfma_f32_16x16x32_bf16 v[96:99], a[212:215], a[76:79], v[96:99]
    ds_read_b64_tr_b16 a[240:241], v56 offset:24576
    v_mfma_f32_16x16x32_bf16 v[104:107], a[208:211], a[88:91], v[104:107]
    ds_read_b64_tr_b16 a[242:243], v56 offset:26624
    v_mfma_f32_16x16x32_bf16 v[104:107], a[212:215], a[92:95], v[104:107]
    ds_read_b64_tr_b16 a[244:245], v56 offset:28672
    v_mfma_f32_16x16x32_bf16 v[100:103], a[216:219], a[72:75], v[100:103]
    s_waitcnt lgkmcnt(9)
    ds_read_b64_tr_b16 a[246:247], v56 offset:30720
    v_mfma_f32_16x16x32_bf16 v[100:103], a[220:223], a[76:79], v[100:103]
    ds_read_b64_tr_b16 a[248:249], v57 offset:24576
    v_mfma_f32_16x16x32_bf16 v[108:111], a[216:219], a[88:91], v[108:111]
    ds_read_b64_tr_b16 a[250:251], v57 offset:26624
    v_mfma_f32_16x16x32_bf16 v[108:111], a[220:223], a[92:95], v[108:111]
    ds_read_b64_tr_b16 a[252:253], v57 offset:28672
    v_mfma_f32_16x16x32_bf16 v[96:99], a[224:227], a[96:99], v[96:99]
    s_waitcnt lgkmcnt(9)
    ds_read_b64_tr_b16 a[254:255], v57 offset:30720
    v_mfma_f32_16x16x32_bf16 v[96:99], a[228:231], a[100:103], v[96:99]
    ds_read_b64_tr_b16 a[192:193], v60 offset:32768
    v_mfma_f32_16x16x32_bf16 v[104:107], a[224:227], a[112:115], v[104:107]
    ds_read_b64_tr_b16 a[194:195], v60 offset:34816
    v_mfma_f32_16x16x32_bf16 v[104:107], a[228:231], a[116:119], v[104:107]
    ds_read_b64_tr_b16 a[196:197], v60 offset:36864
    v_mfma_f32_16x16x32_bf16 v[100:103], a[232:235], a[96:99], v[100:103]
    s_waitcnt lgkmcnt(9)
    ds_read_b64_tr_b16 a[198:199], v60 offset:38912
    v_cvt_pk_bf16_f32 v80, v80, v81
    v_mfma_f32_16x16x32_bf16 v[100:103], a[236:239], a[100:103], v[100:103]
    ds_read_b64_tr_b16 a[200:201], v61 offset:32768
    v_cvt_pk_bf16_f32 v81, v82, v83
    v_mfma_f32_16x16x32_bf16 v[108:111], a[232:235], a[112:115], v[108:111]
    ds_read_b64_tr_b16 a[202:203], v61 offset:34816
    v_cvt_pk_bf16_f32 v82, v84, v85
    v_mfma_f32_16x16x32_bf16 v[108:111], a[236:239], a[116:119], v[108:111]
    ds_read_b64_tr_b16 a[204:205], v61 offset:36864
    v_cvt_pk_bf16_f32 v83, v86, v87
    v_mfma_f32_16x16x32_bf16 v[96:99], a[240:243], a[104:107], v[96:99]
    s_waitcnt lgkmcnt(9)
    ds_read_b64_tr_b16 a[206:207], v61 offset:38912
    v_min_u32 v80, -2, v80
    v_mfma_f32_16x16x32_bf16 v[96:99], a[244:247], a[108:111], v[96:99]
    ds_read_b64_tr_b16 a[208:209], v60 offset:40960
    v_min_u32 v81, -2, v81
    v_mfma_f32_16x16x32_bf16 v[104:107], a[240:243], a[120:123], v[104:107]
    ds_read_b64_tr_b16 a[210:211], v60 offset:43008
    v_min_u32 v82, -2, v82
    v_mfma_f32_16x16x32_bf16 v[104:107], a[244:247], a[124:127], v[104:107]
    buffer_load_dword v3, v4, s[8:11], s23 offen sc0 sc1
    ds_read_b64_tr_b16 a[212:213], v60 offset:45056
    v_mfma_f32_16x16x32_bf16 v[100:103], a[248:251], a[104:107], v[100:103]
    s_waitcnt lgkmcnt(9)
    ds_read_b64_tr_b16 a[214:215], v60 offset:47104
    v_min_u32 v83, -2, v83
    v_mfma_f32_16x16x32_bf16 v[100:103], a[252:255], a[108:111], v[100:103]
    s_add_u32 s75, s18, 0
    ds_read_b64_tr_b16 a[216:217], v61 offset:40960
    v_mfma_f32_16x16x32_bf16 v[108:111], a[248:251], a[120:123], v[108:111]
    buffer_store_dwordx4 v[80:83], v23, s[8:11], s75 offen offset:256 sc0 sc1
    ds_read_b64_tr_b16 a[218:219], v61 offset:43008
    v_mfma_f32_16x16x32_bf16 v[108:111], a[252:255], a[124:127], v[108:111]
    ds_read_b64_tr_b16 a[220:221], v61 offset:45056
    v_cvt_pk_bf16_f32 v88, v88, v89
    v_mfma_f32_16x16x32_bf16 v[96:99], a[192:195], a[0:3], v[96:99]
    s_waitcnt lgkmcnt(9)
    ds_read_b64_tr_b16 a[222:223], v61 offset:47104
    v_cvt_pk_bf16_f32 v89, v90, v91
    v_mfma_f32_16x16x32_bf16 v[96:99], a[196:199], a[4:7], v[96:99]
    ds_read_b64_tr_b16 a[224:225], v60 offset:49152
    v_cvt_pk_bf16_f32 v90, v92, v93
    v_mfma_f32_16x16x32_bf16 v[104:107], a[192:195], a[16:19], v[104:107]
    ds_read_b64_tr_b16 a[226:227], v60 offset:51200
    v_cvt_pk_bf16_f32 v91, v94, v95
    v_mfma_f32_16x16x32_bf16 v[104:107], a[196:199], a[20:23], v[104:107]
    ds_read_b64_tr_b16 a[228:229], v60 offset:53248
    v_min_u32 v88, -2, v88
    v_mfma_f32_16x16x32_bf16 v[100:103], a[200:203], a[0:3], v[100:103]
    s_waitcnt lgkmcnt(9)
    ds_read_b64_tr_b16 a[230:231], v60 offset:55296
    v_min_u32 v89, -2, v89
    v_mfma_f32_16x16x32_bf16 v[100:103], a[204:207], a[4:7], v[100:103]
    ds_read_b64_tr_b16 a[232:233], v61 offset:49152
    v_min_u32 v90, -2, v90
    v_mfma_f32_16x16x32_bf16 v[108:111], a[200:203], a[16:19], v[108:111]
    ds_read_b64_tr_b16 a[234:235], v61 offset:51200
    v_min_u32 v91, -2, v91
    v_mfma_f32_16x16x32_bf16 v[108:111], a[204:207], a[20:23], v[108:111]
    s_waitcnt lgkmcnt(9)
    s_add_u32 s75, s18, 131072
    ds_read_b64_tr_b16 a[236:237], v61 offset:53248
    v_mfma_f32_16x16x32_bf16 v[96:99], a[208:211], a[8:11], v[96:99]
    buffer_store_dwordx4 v[88:91], v23, s[8:11], s75 offen offset:256 sc0 sc1
    ds_read_b64_tr_b16 a[238:239], v61 offset:55296
    v_mfma_f32_16x16x32_bf16 v[96:99], a[212:215], a[12:15], v[96:99]
    ds_read_b64_tr_b16 a[240:241], v60 offset:57344
    v_mfma_f32_16x16x32_bf16 v[104:107], a[208:211], a[24:27], v[104:107]
    ds_read_b64_tr_b16 a[242:243], v60 offset:59392
    v_mfma_f32_16x16x32_bf16 v[104:107], a[212:215], a[28:31], v[104:107]
    s_waitcnt lgkmcnt(9)
    ds_read_b64_tr_b16 a[244:245], v60 offset:61440
    v_mfma_f32_16x16x32_bf16 v[100:103], a[216:219], a[8:11], v[100:103]
    ds_read_b64_tr_b16 a[246:247], v60 offset:63488
    v_mfma_f32_16x16x32_bf16 v[100:103], a[220:223], a[12:15], v[100:103]
    ds_read_b64_tr_b16 a[248:249], v61 offset:57344
    v_mfma_f32_16x16x32_bf16 v[108:111], a[216:219], a[24:27], v[108:111]
    ds_read_b64_tr_b16 a[250:251], v61 offset:59392
    v_mfma_f32_16x16x32_bf16 v[108:111], a[220:223], a[28:31], v[108:111]
    s_waitcnt lgkmcnt(9)
    ds_read_b64_tr_b16 a[252:253], v61 offset:61440
    v_mfma_f32_16x16x32_bf16 v[96:99], a[224:227], a[32:35], v[96:99]
    ds_read_b64_tr_b16 a[254:255], v61 offset:63488
    v_mfma_f32_16x16x32_bf16 v[96:99], a[228:231], a[36:39], v[96:99]
    ds_read_b64_tr_b16 a[192:193], v58 offset:0
    v_mfma_f32_16x16x32_bf16 v[104:107], a[224:227], a[48:51], v[104:107]
    ds_read_b64_tr_b16 a[194:195], v58 offset:2048
    v_mfma_f32_16x16x32_bf16 v[104:107], a[228:231], a[52:55], v[104:107]
    s_waitcnt lgkmcnt(9)
    ds_read_b64_tr_b16 a[196:197], v58 offset:4096
    v_mfma_f32_16x16x32_bf16 v[100:103], a[232:235], a[32:35], v[100:103]
    ds_read_b64_tr_b16 a[198:199], v58 offset:6144
    v_mfma_f32_16x16x32_bf16 v[100:103], a[236:239], a[36:39], v[100:103]
    ds_read_b64_tr_b16 a[200:201], v59 offset:0
    v_mfma_f32_16x16x32_bf16 v[108:111], a[232:235], a[48:51], v[108:111]
    ds_read_b64_tr_b16 a[202:203], v59 offset:2048
    v_mfma_f32_16x16x32_bf16 v[108:111], a[236:239], a[52:55], v[108:111]
    s_waitcnt lgkmcnt(9)
    ds_read_b64_tr_b16 a[204:205], v59 offset:4096
    v_mfma_f32_16x16x32_bf16 v[96:99], a[240:243], a[40:43], v[96:99]
    ds_read_b64_tr_b16 a[206:207], v59 offset:6144
    v_mfma_f32_16x16x32_bf16 v[96:99], a[244:247], a[44:47], v[96:99]
    ds_read_b64_tr_b16 a[208:209], v58 offset:8192
    v_mfma_f32_16x16x32_bf16 v[104:107], a[240:243], a[56:59], v[104:107]
    ds_read_b64_tr_b16 a[210:211], v58 offset:10240
    v_mfma_f32_16x16x32_bf16 v[104:107], a[244:247], a[60:63], v[104:107]
    s_waitcnt lgkmcnt(9)
    ds_read_b64_tr_b16 a[212:213], v58 offset:12288
    v_mfma_f32_16x16x32_bf16 v[100:103], a[248:251], a[40:43], v[100:103]
    ds_read_b64_tr_b16 a[214:215], v58 offset:14336
    v_mfma_f32_16x16x32_bf16 v[100:103], a[252:255], a[44:47], v[100:103]
    ds_read_b64_tr_b16 a[216:217], v59 offset:8192
    v_mfma_f32_16x16x32_bf16 v[108:111], a[248:251], a[56:59], v[108:111]
    ds_read_b64_tr_b16 a[218:219], v59 offset:10240
    v_mfma_f32_16x16x32_bf16 v[108:111], a[252:255], a[60:63], v[108:111]
    s_waitcnt lgkmcnt(9)
    ds_read_b64_tr_b16 a[220:221], v59 offset:12288
    v_mfma_f32_16x16x32_bf16 v[112:115], a[192:195], a[64:67], 0
    ds_read_b64_tr_b16 a[222:223], v59 offset:14336
    v_mfma_f32_16x16x32_bf16 v[112:115], a[196:199], a[68:71], v[112:115]
    ds_read_b64_tr_b16 a[224:225], v58 offset:16384
    v_mfma_f32_16x16x32_bf16 v[120:123], a[192:195], a[80:83], 0
    ds_read_b64_tr_b16 a[226:227], v58 offset:18432
    v_mfma_f32_16x16x32_bf16 v[120:123], a[196:199], a[84:87], v[120:123]
    s_waitcnt lgkmcnt(9)
    ds_read_b64_tr_b16 a[228:229], v58 offset:20480
    v_mfma_f32_16x16x32_bf16 v[116:119], a[200:203], a[64:67], 0
    ds_read_b64_tr_b16 a[230:231], v58 offset:22528
    v_mfma_f32_16x16x32_bf16 v[116:119], a[204:207], a[68:71], v[116:119]
    ds_read_b64_tr_b16 a[232:233], v59 offset:16384
    v_mfma_f32_16x16x32_bf16 v[124:127], a[200:203], a[80:83], 0
    ds_read_b64_tr_b16 a[234:235], v59 offset:18432
    v_mfma_f32_16x16x32_bf16 v[124:127], a[204:207], a[84:87], v[124:127]
    s_waitcnt lgkmcnt(9)
    ds_read_b64_tr_b16 a[236:237], v59 offset:20480
    v_mfma_f32_16x16x32_bf16 v[112:115], a[208:211], a[72:75], v[112:115]
    ds_read_b64_tr_b16 a[238:239], v59 offset:22528
    v_cvt_pk_bf16_f32 v96, v96, v97
    s_waitcnt vmcnt(2)
    v_cmp_ne_u32 vcc, 0, v3
    s_cmp_eq_u64 vcc, -1
    s_cbranch_scc0 L_C2_slow_17
L_C2_ok_18:
    v_mfma_f32_16x16x32_bf16 v[112:115], a[212:215], a[76:79], v[112:115]
    s_xor_b32 s74, s24, 8192
    ds_read_b64_tr_b16 a[240:241], v58 offset:24576
    v_cvt_pk_bf16_f32 v97, v98, v99
    v_mfma_f32_16x16x32_bf16 v[120:123], a[208:211], a[88:91], v[120:123]
    buffer_load_dwordx4 v[160:163], v1, s[8:11], s74 offen offset:0
    v_mfma_f32_16x16x32_bf16 v[120:123], a[212:215], a[92:95], v[120:123]
    s_waitcnt lgkmcnt(8)
    s_xor_b32 s74, s24, 12288
    ds_read_b64_tr_b16 a[242:243], v58 offset:26624
    v_cvt_pk_bf16_f32 v98, v100, v101
    v_mfma_f32_16x16x32_bf16 v[116:119], a[216:219], a[72:75], v[116:119]
    ds_read_b64_tr_b16 a[244:245], v58 offset:28672
    v_cvt_pk_bf16_f32 v99, v102, v103
    v_mfma_f32_16x16x32_bf16 v[116:119], a[220:223], a[76:79], v[116:119]
    ds_read_b64_tr_b16 a[246:247], v58 offset:30720
    v_min_u32 v96, -2, v96
    v_mfma_f32_16x16x32_bf16 v[124:127], a[216:219], a[88:91], v[124:127]
    buffer_load_dwordx4 v[176:179], v1, s[8:11], s74 offen offset:0
    ds_read_b64_tr_b16 a[248:249], v59 offset:24576
    v_mfma_f32_16x16x32_bf16 v[124:127], a[220:223], a[92:95], v[124:127]
    s_waitcnt lgkmcnt(8)
    s_xor_b32 s74, s24, 8192
    ds_read_b64_tr_b16 a[250:251], v59 offset:26624
    v_min_u32 v97, -2, v97
    v_mfma_f32_16x16x32_bf16 v[112:115], a[224:227], a[96:99], v[112:115]
    ds_read_b64_tr_b16 a[252:253], v59 offset:28672
    v_min_u32 v98, -2, v98
    v_mfma_f32_16x16x32_bf16 v[112:115], a[228:231], a[100:103], v[112:115]
    ds_read_b64_tr_b16 a[254:255], v59 offset:30720
    v_min_u32 v99, -2, v99
    v_mfma_f32_16x16x32_bf16 v[120:123], a[224:227], a[112:115], v[120:123]
    buffer_load_dwordx4 v[164:167], v1, s[8:11], s74 offen offset:1024
    v_mfma_f32_16x16x32_bf16 v[120:123], a[228:231], a[116:119], v[120:123]
    s_waitcnt lgkmcnt(7)
    s_xor_b32 s74, s24, 12288
    ds_read_b64_tr_b16 a[192:193], v62 offset:32768
    v_mfma_f32_16x16x32_bf16 v[116:119], a[232:235], a[96:99], v[116:119]
    s_add_u32 s75, s18, 0
    ds_read_b64_tr_b16 a[194:195], v62 offset:34816
    v_mfma_f32_16x16x32_bf16 v[116:119], a[236:239], a[100:103], v[116:119]
    buffer_store_dwordx4 v[96:99], v23, s[8:11], s75 offen offset:512 sc0 sc1
    ds_read_b64_tr_b16 a[196:197], v62 offset:36864
    v_mfma_f32_16x16x32_bf16 v[124:127], a[232:235], a[112:115], v[124:127]
    buffer_load_dwordx4 v[180:183], v1, s[8:11], s74 offen offset:1024
    ds_read_b64_tr_b16 a[198:199], v62 offset:38912
    v_mfma_f32_16x16x32_bf16 v[124:127], a[236:239], a[116:119], v[124:127]
    s_waitcnt lgkmcnt(8)
    s_xor_b32 s74, s24, 8192
    ds_read_b64_tr_b16 a[200:201], v63 offset:32768
    v_cvt_pk_bf16_f32 v104, v104, v105
    v_mfma_f32_16x16x32_bf16 v[112:115], a[240:243], a[104:107], v[112:115]
    ds_read_b64_tr_b16 a[202:203], v63 offset:34816
    v_cvt_pk_bf16_f32 v105, v106, v107
    v_mfma_f32_16x16x32_bf16 v[112:115], a[244:247], a[108:111], v[112:115]
    ds_read_b64_tr_b16 a[204:205], v63 offset:36864
    v_cvt_pk_bf16_f32 v106, v108, v109
    v_mfma_f32_16x16x32_bf16 v[120:123], a[240:243], a[120:123], v[120:123]
    buffer_load_dwordx4 v[168:171], v1, s[8:11], s74 offen offset:2048
    ds_read_b64_tr_b16 a[206:207], v63 offset:38912
    v_mfma_f32_16x16x32_bf16 v[120:123], a[244:247], a[124:127], v[120:123]
    s_waitcnt lgkmcnt(8)
    s_xor_b32 s74, s24, 12288
    ds_read_b64_tr_b16 a[208:209], v62 offset:40960
    v_cvt_pk_bf16_f32 v107, v110, v111
    v_mfma_f32_16x16x32_bf16 v[116:119], a[248:251], a[104:107], v[116:119]
    ds_read_b64_tr_b16 a[210:211], v62 offset:43008
    v_min_u32 v104, -2, v104
    v_mfma_f32_16x16x32_bf16 v[116:119], a[252:255], a[108:111], v[116:119]
    ds_read_b64_tr_b16 a[212:213], v62 offset:45056
    v_min_u32 v105, -2, v105
    v_mfma_f32_16x16x32_bf16 v[124:127], a[248:251], a[120:123], v[124:127]
    buffer_load_dwordx4 v[184:187], v1, s[8:11], s74 offen offset:2048
    ds_read_b64_tr_b16 a[214:215], v62 offset:47104
    v_mfma_f32_16x16x32_bf16 v[124:127], a[252:255], a[124:127], v[124:127]
    s_waitcnt lgkmcnt(9)
    s_xor_b32 s74, s24, 8192
    ds_read_b64_tr_b16 a[216:217], v63 offset:40960
    v_min_u32 v106, -2, v106
    v_mfma_f32_16x16x32_bf16 v[112:115], a[192:195], a[0:3], v[112:115]
    s_waitcnt lgkmcnt(9)
    ds_read_b64_tr_b16 a[218:219], v63 offset:43008
    v_min_u32 v107, -2, v107
    v_mfma_f32_16x16x32_bf16 v[112:115], a[196:199], a[4:7], v[112:115]
    s_add_u32 s75, s18, 131072
    ds_read_b64_tr_b16 a[220:221], v63 offset:45056
    v_mfma_f32_16x16x32_bf16 v[120:123], a[192:195], a[16:19], v[120:123]
    buffer_load_dwordx4 v[172:175], v1, s[8:11], s74 offen offset:3072
    ds_read_b64_tr_b16 a[222:223], v63 offset:47104
    v_mfma_f32_16x16x32_bf16 v[120:123], a[196:199], a[20:23], v[120:123]
    s_waitcnt lgkmcnt(8)
    s_xor_b32 s74, s24, 12288
    ds_read_b64_tr_b16 a[224:225], v62 offset:49152
    v_mfma_f32_16x16x32_bf16 v[116:119], a[200:203], a[0:3], v[116:119]
    buffer_store_dwordx4 v[104:107], v23, s[8:11], s75 offen offset:512 sc0 sc1
    ds_read_b64_tr_b16 a[226:227], v62 offset:51200
    v_mfma_f32_16x16x32_bf16 v[116:119], a[204:207], a[4:7], v[116:119]
    ds_read_b64_tr_b16 a[228:229], v62 offset:53248
    v_mfma_f32_16x16x32_bf16 v[124:127], a[200:203], a[16:19], v[124:127]
    buffer_load_dwordx4 v[188:191], v1, s[8:11], s74 offen offset:3072
    ds_read_b64_tr_b16 a[230:231], v62 offset:55296
    v_mfma_f32_16x16x32_bf16 v[124:127], a[204:207], a[20:23], v[124:127]
    s_waitcnt lgkmcnt(9)
    ds_read_b64_tr_b16 a[232:233], v63 offset:49152
    v_mfma_f32_16x16x32_bf16 v[112:115], a[208:211], a[8:11], v[112:115]
    s_waitcnt lgkmcnt(9)
    ds_read_b64_tr_b16 a[234:235], v63 offset:51200
    v_mfma_f32_16x16x32_bf16 v[112:115], a[212:215], a[12:15], v[112:115]
    ds_read_b64_tr_b16 a[236:237], v63 offset:53248
    v_mfma_f32_16x16x32_bf16 v[120:123], a[208:211], a[24:27], v[120:123]
    ds_read_b64_tr_b16 a[238:239], v63 offset:55296
    v_mfma_f32_16x16x32_bf16 v[120:123], a[212:215], a[28:31], v[120:123]
    s_waitcnt lgkmcnt(9)
    ds_read_b64_tr_b16 a[240:241], v62 offset:57344
    v_mfma_f32_16x16x32_bf16 v[116:119], a[216:219], a[8:11], v[116:119]
    s_waitcnt lgkmcnt(9)
    ds_read_b64_tr_b16 a[242:243], v62 offset:59392
    v_mfma_f32_16x16x32_bf16 v[116:119], a[220:223], a[12:15], v[116:119]
    ds_read_b64_tr_b16 a[244:245], v62 offset:61440
    v_mfma_f32_16x16x32_bf16 v[124:127], a[216:219], a[24:27], v[124:127]
    ds_read_b64_tr_b16 a[246:247], v62 offset:63488
    v_mfma_f32_16x16x32_bf16 v[124:127], a[220:223], a[28:31], v[124:127]
    s_waitcnt lgkmcnt(9)
    ds_read_b64_tr_b16 a[248:249], v63 offset:57344
    v_mfma_f32_16x16x32_bf16 v[112:115], a[224:227], a[32:35], v[112:115]
    s_waitcnt lgkmcnt(9)
    ds_read_b64_tr_b16 a[250:251], v63 offset:59392
    ds_read_b64_tr_b16 a[208:209], v56 offset:40960
    v_mfma_f32_16x16x32_bf16 v[112:115], a[228:231], a[36:39], v[112:115]
    ds_read_b64_tr_b16 a[252:253], v63 offset:61440
    ds_read_b64_tr_b16 a[210:211], v56 offset:43008
    v_mfma_f32_16x16x32_bf16 v[120:123], a[224:227], a[48:51], v[120:123]
    ds_read_b64_tr_b16 a[254:255], v63 offset:63488
    ds_read_b64_tr_b16 a[212:213], v56 offset:45056
    v_mfma_f32_16x16x32_bf16 v[120:123], a[228:231], a[52:55], v[120:123]
    s_waitcnt lgkmcnt(12)
    ds_read_b64_tr_b16 a[192:193], v56 offset:32768
    ds_read_b64_tr_b16 a[214:215], v56 offset:47104
    v_mfma_f32_16x16x32_bf16 v[116:119], a[232:235], a[32:35], v[116:119]
    s_waitcnt lgkmcnt(13)
    ds_read_b64_tr_b16 a[194:195], v56 offset:34816
    ds_read_b64_tr_b16 a[216:217], v57 offset:40960
    v_mfma_f32_16x16x32_bf16 v[116:119], a[236:239], a[36:39], v[116:119]
    ds_read_b64_tr_b16 a[196:197], v56 offset:36864
    ds_read_b64_tr_b16 a[218:219], v57 offset:43008
    v_mfma_f32_16x16x32_bf16 v[124:127], a[232:235], a[48:51], v[124:127]
    ds_read_b64_tr_b16 a[198:199], v56 offset:38912
    ds_read_b64_tr_b16 a[220:221], v57 offset:45056
    v_mfma_f32_16x16x32_bf16 v[124:127], a[236:239], a[52:55], v[124:127]
    s_waitcnt lgkmcnt(15)
    ds_read_b64_tr_b16 a[200:201], v57 offset:32768
    ds_read_b64_tr_b16 a[222:223], v57 offset:47104
    v_mfma_f32_16x16x32_bf16 v[112:115], a[240:243], a[40:43], v[112:115]
    ds_read_b64_tr_b16 a[202:203], v57 offset:34816
    v_mfma_f32_16x16x32_bf16 v[112:115], a[244:247], a[44:47], v[112:115]
    ds_read_b64_tr_b16 a[204:205], v57 offset:36864
    v_mfma_f32_16x16x32_bf16 v[120:123], a[240:243], a[56:59], v[120:123]
    s_waitcnt lgkmcnt(15)
    s_xor_b32 s74, s24, 16384
    ds_read_b64_tr_b16 a[206:207], v57 offset:38912
    v_mfma_f32_16x16x32_bf16 v[120:123], a[244:247], a[60:63], v[120:123]
    buffer_load_dwordx4 v[192:195], v1, s[8:11], s74 offen offset:0
    v_mfma_f32_16x16x32_bf16 v[116:119], a[248:251], a[40:43], v[116:119]
    s_waitcnt lgkmcnt(13)
    s_xor_b32 s74, s24, 20480
    ds_read_b64_tr_b16 a[224:225], v56 offset:49152
    v_mfma_f32_16x16x32_bf16 v[116:119], a[252:255], a[44:47], v[116:119]
    ds_read_b64_tr_b16 a[226:227], v56 offset:51200
    v_mfma_f32_16x16x32_bf16 v[124:127], a[248:251], a[56:59], v[124:127]
    ds_read_b64_tr_b16 a[228:229], v56 offset:53248
    v_mfma_f32_16x16x32_bf16 v[124:127], a[252:255], a[60:63], v[124:127]
    s_waitcnt lgkmcnt(9)
    ds_read_b64_tr_b16 a[230:231], v56 offset:55296
    v_mfma_f32_16x16x32_bf16 v[64:67], a[192:195], v[128:131], 0
    buffer_load_dwordx4 v[208:211], v1, s[8:11], s74 offen offset:0
    v_mfma_f32_16x16x32_bf16 v[64:67], a[196:199], v[132:135], v[64:67]
    s_xor_b32 s74, s24, 16384
    ds_read_b64_tr_b16 a[232:233], v57 offset:49152
    v_mfma_f32_16x16x32_bf16 v[72:75], a[192:195], v[144:147], 0
    ds_read_b64_tr_b16 a[234:235], v57 offset:51200
    v_mfma_f32_16x16x32_bf16 v[72:75], a[196:199], v[148:151], v[72:75]
    s_waitcnt lgkmcnt(7)
    ds_read_b64_tr_b16 a[236:237], v57 offset:53248
    v_mfma_f32_16x16x32_bf16 v[68:71], a[200:203], v[128:131], 0
    s_waitcnt lgkmcnt(7)
    ds_read_b64_tr_b16 a[238:239], v57 offset:55296
    v_mfma_f32_16x16x32_bf16 v[68:71], a[204:207], v[132:135], v[68:71]
    buffer_load_dwordx4 v[196:199], v1, s[8:11], s74 offen offset:1024
    v_mfma_f32_16x16x32_bf16 v[76:79], a[200:203], v[144:147], 0
    s_xor_b32 s74, s24, 20480
    ds_read_b64_tr_b16 a[240:241], v56 offset:57344
    v_cvt_pk_bf16_f32 v112, v112, v113
    v_mfma_f32_16x16x32_bf16 v[76:79], a[204:207], v[148:151], v[76:79]
    ds_read_b64_tr_b16 a[242:243], v56 offset:59392
    v_cvt_pk_bf16_f32 v113, v114, v115
    v_mfma_f32_16x16x32_bf16 v[64:67], a[208:211], v[136:139], v[64:67]
    ds_read_b64_tr_b16 a[244:245], v56 offset:61440
    v_cvt_pk_bf16_f32 v114, v116, v117
    v_mfma_f32_16x16x32_bf16 v[64:67], a[212:215], v[140:143], v[64:67]
    ds_read_b64_tr_b16 a[246:247], v56 offset:63488
    v_cvt_pk_bf16_f32 v115, v118, v119
    v_mfma_f32_16x16x32_bf16 v[72:75], a[208:211], v[152:155], v[72:75]
    buffer_load_dwordx4 v[212:215], v1, s[8:11], s74 offen offset:1024
    v_mfma_f32_16x16x32_bf16 v[72:75], a[212:215], v[156:159], v[72:75]
    s_xor_b32 s74, s24, 16384
    ds_read_b64_tr_b16 a[248:249], v57 offset:57344
    v_min_u32 v112, -2, v112
    v_mfma_f32_16x16x32_bf16 v[68:71], a[216:219], v[136:139], v[68:71]
    ds_read_b64_tr_b16 a[250:251], v57 offset:59392
    v_min_u32 v113, -2, v113
    v_mfma_f32_16x16x32_bf16 v[68:71], a[220:223], v[140:143], v[68:71]
    ds_read_b64_tr_b16 a[252:253], v57 offset:61440
    v_min_u32 v114, -2, v114
    v_mfma_f32_16x16x32_bf16 v[76:79], a[216:219], v[152:155], v[76:79]
    s_waitcnt vmcnt(13) lgkmcnt(7)
    ds_read_b64_tr_b16 a[254:255], v57 offset:63488
    v_min_u32 v115, -2, v115
    v_mfma_f32_16x16x32_bf16 v[76:79], a[220:223], v[156:159], v[76:79]
    buffer_load_dwordx4 v[200:203], v1, s[8:11], s74 offen offset:2048
    v_mfma_f32_16x16x32_bf16 v[64:67], a[224:227], v[160:163], v[64:67]
    s_waitcnt vmcnt(12)
    s_xor_b32 s74, s24, 20480
    ds_read_b64_tr_b16 a[192:193], v58 offset:32768
    v_mfma_f32_16x16x32_bf16 v[64:67], a[228:231], v[164:167], v[64:67]
    s_waitcnt vmcnt(10)
    s_add_u32 s75, s18, 0
    ds_read_b64_tr_b16 a[194:195], v58 offset:34816
    v_mfma_f32_16x16x32_bf16 v[72:75], a[224:227], v[176:179], v[72:75]
    buffer_store_dwordx4 v[112:115], v23, s[8:11], s75 offen offset:768 sc0 sc1
    v_mfma_f32_16x16x32_bf16 v[72:75], a[228:231], v[180:183], v[72:75]
    ds_read_b64_tr_b16 a[196:197], v58 offset:36864
    v_cvt_pk_bf16_f32 v120, v120, v121
    v_mfma_f32_16x16x32_bf16 v[68:71], a[232:235], v[160:163], v[68:71]
    buffer_load_dwordx4 v[216:219], v1, s[8:11], s74 offen offset:2048
    ds_read_b64_tr_b16 a[198:199], v58 offset:38912
    v_mfma_f32_16x16x32_bf16 v[68:71], a[236:239], v[164:167], v[68:71]
    s_xor_b32 s74, s24, 16384
    ds_read_b64_tr_b16 a[200:201], v59 offset:32768
    v_cvt_pk_bf16_f32 v121, v122, v123
    v_mfma_f32_16x16x32_bf16 v[76:79], a[232:235], v[176:179], v[76:79]
    ds_read_b64_tr_b16 a[202:203], v59 offset:34816
    v_cvt_pk_bf16_f32 v122, v124, v125
    v_mfma_f32_16x16x32_bf16 v[76:79], a[236:239], v[180:183], v[76:79]
    s_waitcnt vmcnt(11) lgkmcnt(7)
    ds_read_b64_tr_b16 a[204:205], v59 offset:36864
    v_cvt_pk_bf16_f32 v123, v126, v127
    v_mfma_f32_16x16x32_bf16 v[64:67], a[240:243], v[168:171], v[64:67]
    s_waitcnt vmcnt(9)
    ds_read_b64_tr_b16 a[206:207], v59 offset:38912
    v_min_u32 v120, -2, v120
    v_mfma_f32_16x16x32_bf16 v[64:67], a[244:247], v[172:175], v[64:67]
    buffer_load_dwordx4 v[204:207], v1, s[8:11], s74 offen offset:3072
    v_mfma_f32_16x16x32_bf16 v[72:75], a[240:243], v[184:187], v[72:75]
    s_waitcnt vmcnt(8)
    s_xor_b32 s74, s24, 20480
    ds_read_b64_tr_b16 a[208:209], v58 offset:40960
    v_min_u32 v121, -2, v121
    v_mfma_f32_16x16x32_bf16 v[72:75], a[244:247], v[188:191], v[72:75]
    ds_read_b64_tr_b16 a[210:211], v58 offset:43008
    v_min_u32 v122, -2, v122
    v_mfma_f32_16x16x32_bf16 v[68:71], a[248:251], v[168:171], v[68:71]
    s_waitcnt lgkmcnt(8)
    ds_read_b64_tr_b16 a[212:213], v58 offset:45056
    v_min_u32 v123, -2, v123
    v_mfma_f32_16x16x32_bf16 v[68:71], a[252:255], v[172:175], v[68:71]
    s_add_u32 s75, s18, 131072
    ds_read_b64_tr_b16 a[214:215], v58 offset:47104
    v_mfma_f32_16x16x32_bf16 v[76:79], a[248:251], v[184:187], v[76:79]
    buffer_load_dwordx4 v[220:223], v1, s[8:11], s74 offen offset:3072
    ds_read_b64_tr_b16 a[216:217], v59 offset:40960
    v_mfma_f32_16x16x32_bf16 v[76:79], a[252:255], v[188:191], v[76:79]
    s_waitcnt lgkmcnt(8)
    s_xor_b32 s74, s24, 24576
    ds_read_b64_tr_b16 a[218:219], v59 offset:43008
    v_mfma_f32_16x16x32_bf16 v[80:83], a[192:195], v[128:131], 0
    buffer_store_dwordx4 v[120:123], v23, s[8:11], s75 offen offset:768 sc0 sc1
    ds_read_b64_tr_b16 a[220:221], v59 offset:45056
    v_mfma_f32_16x16x32_bf16 v[80:83], a[196:199], v[132:135], v[80:83]
    ds_read_b64_tr_b16 a[222:223], v59 offset:47104
    v_mfma_f32_16x16x32_bf16 v[88:91], a[192:195], v[144:147], 0
    s_waitcnt lgkmcnt(8)
    ds_read_b64_tr_b16 a[224:225], v58 offset:49152
    v_mfma_f32_16x16x32_bf16 v[88:91], a[196:199], v[148:151], v[88:91]
    buffer_load_dwordx4 v[224:227], v1, s[8:11], s74 offen offset:0
    ds_read_b64_tr_b16 a[226:227], v58 offset:51200
    v_mfma_f32_16x16x32_bf16 v[84:87], a[200:203], v[128:131], 0
    s_xor_b32 s74, s24, 28672
    ds_read_b64_tr_b16 a[228:229], v58 offset:53248
    v_mfma_f32_16x16x32_bf16 v[84:87], a[204:207], v[132:135], v[84:87]
    ds_read_b64_tr_b16 a[230:231], v58 offset:55296
    v_mfma_f32_16x16x32_bf16 v[92:95], a[200:203], v[144:147], 0
    ds_read_b64_tr_b16 a[232:233], v59 offset:49152
    v_mfma_f32_16x16x32_bf16 v[92:95], a[204:207], v[148:151], v[92:95]
    s_waitcnt lgkmcnt(9)
    ds_read_b64_tr_b16 a[234:235], v59 offset:51200
    v_mfma_f32_16x16x32_bf16 v[80:83], a[208:211], v[136:139], v[80:83]
    buffer_load_dwordx4 v[240:243], v1, s[8:11], s74 offen offset:0
    ds_read_b64_tr_b16 a[236:237], v59 offset:53248
    v_mfma_f32_16x16x32_bf16 v[80:83], a[212:215], v[140:143], v[80:83]
    s_xor_b32 s74, s24, 24576
    ds_read_b64_tr_b16 a[238:239], v59 offset:55296
    v_mfma_f32_16x16x32_bf16 v[88:91], a[208:211], v[152:155], v[88:91]
    ds_read_b64_tr_b16 a[240:241], v58 offset:57344
    v_mfma_f32_16x16x32_bf16 v[88:91], a[212:215], v[156:159], v[88:91]
    s_waitcnt lgkmcnt(9)
    ds_read_b64_tr_b16 a[242:243], v58 offset:59392
    v_mfma_f32_16x16x32_bf16 v[84:87], a[216:219], v[136:139], v[84:87]
    ds_read_b64_tr_b16 a[244:245], v58 offset:61440
    v_mfma_f32_16x16x32_bf16 v[84:87], a[220:223], v[140:143], v[84:87]
    buffer_load_dwordx4 v[228:231], v1, s[8:11], s74 offen offset:1024
    ds_read_b64_tr_b16 a[246:247], v58 offset:63488
    v_mfma_f32_16x16x32_bf16 v[92:95], a[216:219], v[152:155], v[92:95]
    s_xor_b32 s74, s24, 28672
    ds_read_b64_tr_b16 a[248:249], v59 offset:57344
    v_mfma_f32_16x16x32_bf16 v[92:95], a[220:223], v[156:159], v[92:95]
    s_waitcnt lgkmcnt(9)
    ds_read_b64_tr_b16 a[250:251], v59 offset:59392
    v_mfma_f32_16x16x32_bf16 v[80:83], a[224:227], v[160:163], v[80:83]
    ds_read_b64_tr_b16 a[252:253], v59 offset:61440
    v_mfma_f32_16x16x32_bf16 v[80:83], a[228:231], v[164:167], v[80:83]
    ds_read_b64_tr_b16 a[254:255], v59 offset:63488
    v_mfma_f32_16x16x32_bf16 v[88:91], a[224:227], v[176:179], v[88:91]
    buffer_load_dwordx4 v[244:247], v1, s[8:11], s74 offen offset:1024
    v_mfma_f32_16x16x32_bf16 v[88:91], a[228:231], v[180:183], v[88:91]
    s_waitcnt lgkmcnt(8)
    s_xor_b32 s74, s24, 24576
    ds_read_b64_tr_b16 a[192:193], v56 offset:0
    v_mfma_f32_16x16x32_bf16 v[84:87], a[232:235], v[160:163], v[84:87]
    ds_read_b64_tr_b16 a[194:195], v56 offset:2048
    v_mfma_f32_16x16x32_bf16 v[84:87], a[236:239], v[164:167], v[84:87]
    ds_read_b64_tr_b16 a[196:197], v56 offset:4096
    v_mfma_f32_16x16x32_bf16 v[92:95], a[232:235], v[176:179], v[92:95]
    s_waitcnt lgkmcnt(8)
    ds_read_b64_tr_b16 a[198:199], v56 offset:6144
    v_mfma_f32_16x16x32_bf16 v[92:95], a[236:239], v[180:183], v[92:95]
    buffer_load_dwordx4 v[232:235], v1, s[8:11], s74 offen offset:2048
    ds_read_b64_tr_b16 a[200:201], v57 offset:0
    v_mfma_f32_16x16x32_bf16 v[80:83], a[240:243], v[168:171], v[80:83]
    s_waitcnt lgkmcnt(8)
    s_xor_b32 s74, s24, 28672
    ds_read_b64_tr_b16 a[202:203], v57 offset:2048
    v_mfma_f32_16x16x32_bf16 v[80:83], a[244:247], v[172:175], v[80:83]
    ds_read_b64_tr_b16 a[204:205], v57 offset:4096
    v_mfma_f32_16x16x32_bf16 v[88:91], a[240:243], v[184:187], v[88:91]
    ds_read_b64_tr_b16 a[206:207], v57 offset:6144
    v_mfma_f32_16x16x32_bf16 v[88:91], a[244:247], v[188:191], v[88:91]
    s_waitcnt lgkmcnt(8)
    ds_read_b64_tr_b16 a[208:209], v56 offset:8192
    v_mfma_f32_16x16x32_bf16 v[84:87], a[248:251], v[168:171], v[84:87]
    buffer_load_dwordx4 v[248:251], v1, s[8:11], s74 offen offset:2048
    ds_read_b64_tr_b16 a[210:211], v56 offset:10240
    v_mfma_f32_16x16x32_bf16 v[84:87], a[252:255], v[172:175], v[84:87]
    s_xor_b32 s74, s24, 24576
    ds_read_b64_tr_b16 a[212:213], v56 offset:12288
    v_mfma_f32_16x16x32_bf16 v[92:95], a[248:251], v[184:187], v[92:95]
    ds_read_b64_tr_b16 a[214:215], v56 offset:14336
    v_mfma_f32_16x16x32_bf16 v[92:95], a[252:255], v[188:191], v[92:95]
    s_waitcnt lgkmcnt(9)
    ds_read_b64_tr_b16 a[216:217], v57 offset:8192
    v_mfma_f32_16x16x32_bf16 v[96:99], a[192:195], v[128:131], 0
    s_waitcnt lgkmcnt(9)
    ds_read_b64_tr_b16 a[218:219], v57 offset:10240
    v_mfma_f32_16x16x32_bf16 v[96:99], a[196:199], v[132:135], v[96:99]
    buffer_load_dwordx4 v[236:239], v1, s[8:11], s74 offen offset:3072
    ds_read_b64_tr_b16 a[220:221], v57 offset:12288
    v_mfma_f32_16x16x32_bf16 v[104:107], a[192:195], v[144:147], 0
    s_xor_b32 s74, s24, 28672
    ds_read_b64_tr_b16 a[222:223], v57 offset:14336
    v_mfma_f32_16x16x32_bf16 v[104:107], a[196:199], v[148:151], v[104:107]
    s_waitcnt lgkmcnt(9)
    ds_read_b64_tr_b16 a[224:225], v56 offset:16384
    v_mfma_f32_16x16x32_bf16 v[100:103], a[200:203], v[128:131], 0
    s_waitcnt lgkmcnt(9)
    ds_read_b64_tr_b16 a[226:227], v56 offset:18432
    v_mfma_f32_16x16x32_bf16 v[100:103], a[204:207], v[132:135], v[100:103]
    ds_read_b64_tr_b16 a[228:229], v56 offset:20480
    v_mfma_f32_16x16x32_bf16 v[108:111], a[200:203], v[144:147], 0
    buffer_load_dwordx4 v[252:255], v1, s[8:11], s74 offen offset:3072
    ds_read_b64_tr_b16 a[230:231], v56 offset:22528
    v_mfma_f32_16x16x32_bf16 v[108:111], a[204:207], v[148:151], v[108:111]
    s_waitcnt lgkmcnt(9)
    ds_read_b64_tr_b16 a[232:233], v57 offset:16384
    v_mfma_f32_16x16x32_bf16 v[96:99], a[208:211], v[136:139], v[96:99]
    s_waitcnt lgkmcnt(9)
    ds_read_b64_tr_b16 a[234:235], v57 offset:18432
    v_mfma_f32_16x16x32_bf16 v[96:99], a[212:215], v[140:143], v[96:99]
    ds_read_b64_tr_b16 a[236:237], v57 offset:20480
    v_mfma_f32_16x16x32_bf16 v[104:107], a[208:211], v[152:155], v[104:107]
    ds_read_b64_tr_b16 a[238:239], v57 offset:22528
    v_mfma_f32_16x16x32_bf16 v[104:107], a[212:215], v[156:159], v[104:107]
    s_waitcnt lgkmcnt(9)
    ds_read_b64_tr_b16 a[240:241], v56 offset:24576
    v_mfma_f32_16x16x32_bf16 v[100:103], a[216:219], v[136:139], v[100:103]
    s_waitcnt lgkmcnt(9)
    ds_read_b64_tr_b16 a[242:243], v56 offset:26624
    v_mfma_f32_16x16x32_bf16 v[100:103], a[220:223], v[140:143], v[100:103]
    ds_read_b64_tr_b16 a[244:245], v56 offset:28672
    v_mfma_f32_16x16x32_bf16 v[108:111], a[216:219], v[152:155], v[108:111]
    ds_read_b64_tr_b16 a[246:247], v56 offset:30720
    v_mfma_f32_16x16x32_bf16 v[108:111], a[220:223], v[156:159], v[108:111]
    s_waitcnt lgkmcnt(9)
    ds_read_b64_tr_b16 a[248:249], v57 offset:24576
    v_mfma_f32_16x16x32_bf16 v[96:99], a[224:227], v[160:163], v[96:99]
    s_waitcnt lgkmcnt(9)
    ds_read_b64_tr_b16 a[250:251], v57 offset:26624
    v_mfma_f32_16x16x32_bf16 v[96:99], a[228:231], v[164:167], v[96:99]
    ds_read_b64_tr_b16 a[252:253], v57 offset:28672
    v_mfma_f32_16x16x32_bf16 v[104:107], a[224:227], v[176:179], v[104:107]
    ds_read_b64_tr_b16 a[254:255], v57 offset:30720
    v_mfma_f32_16x16x32_bf16 v[104:107], a[228:231], v[180:183], v[104:107]
    s_waitcnt lgkmcnt(8)
    ds_read_b64_tr_b16 a[192:193], v58 offset:0
    v_mfma_f32_16x16x32_bf16 v[100:103], a[232:235], v[160:163], v[100:103]
    buffer_load_dwordx2 v[32:33], v45, s[32:35], s100 offen
    ds_read_b64_tr_b16 a[194:195], v58 offset:2048
    v_mfma_f32_16x16x32_bf16 v[100:103], a[236:239], v[164:167], v[100:103]
    ds_read_b64_tr_b16 a[196:197], v58 offset:4096
    v_mfma_f32_16x16x32_bf16 v[108:111], a[232:235], v[176:179], v[108:111]
    ds_read_b64_tr_b16 a[198:199], v58 offset:6144
    v_mfma_f32_16x16x32_bf16 v[108:111], a[236:239], v[180:183], v[108:111]
    s_waitcnt lgkmcnt(8)
    ds_read_b64_tr_b16 a[200:201], v59 offset:0
    v_mfma_f32_16x16x32_bf16 v[96:99], a[240:243], v[168:171], v[96:99]
    buffer_load_dwordx2 v[34:35], v45, s[32:35], s100 offen offset:32
    ds_read_b64_tr_b16 a[202:203], v59 offset:2048
    v_mfma_f32_16x16x32_bf16 v[96:99], a[244:247], v[172:175], v[96:99]
    ds_read_b64_tr_b16 a[204:205], v59 offset:4096
    v_mfma_f32_16x16x32_bf16 v[104:107], a[240:243], v[184:187], v[104:107]
    ds_read_b64_tr_b16 a[206:207], v59 offset:6144
    v_mfma_f32_16x16x32_bf16 v[104:107], a[244:247], v[188:191], v[104:107]
    s_waitcnt lgkmcnt(8)
    ds_read_b64_tr_b16 a[208:209], v58 offset:8192
    v_mfma_f32_16x16x32_bf16 v[100:103], a[248:251], v[168:171], v[100:103]
    buffer_load_dwordx2 v[36:37], v45, s[32:35], s101 offen
    ds_read_b64_tr_b16 a[210:211], v58 offset:10240
    v_mfma_f32_16x16x32_bf16 v[100:103], a[252:255], v[172:175], v[100:103]
    ds_read_b64_tr_b16 a[212:213], v58 offset:12288
    v_mfma_f32_16x16x32_bf16 v[108:111], a[248:251], v[184:187], v[108:111]
    ds_read_b64_tr_b16 a[214:215], v58 offset:14336
    v_mfma_f32_16x16x32_bf16 v[108:111], a[252:255], v[188:191], v[108:111]
    s_waitcnt lgkmcnt(8)
    ds_read_b64_tr_b16 a[216:217], v59 offset:8192
    v_mfma_f32_16x16x32_bf16 v[112:115], a[192:195], v[128:131], 0
    buffer_load_dwordx2 v[38:39], v45, s[32:35], s101 offen offset:32
    ds_read_b64_tr_b16 a[218:219], v59 offset:10240
    v_mfma_f32_16x16x32_bf16 v[112:115], a[196:199], v[132:135], v[112:115]
    ds_read_b64_tr_b16 a[220:221], v59 offset:12288
    v_mfma_f32_16x16x32_bf16 v[120:123], a[192:195], v[144:147], 0
    ds_read_b64_tr_b16 a[222:223], v59 offset:14336
    v_mfma_f32_16x16x32_bf16 v[120:123], a[196:199], v[148:151], v[120:123]
    s_waitcnt lgkmcnt(8)
    ds_read_b64_tr_b16 a[224:225], v58 offset:16384
    v_mfma_f32_16x16x32_bf16 v[116:119], a[200:203], v[128:131], 0
    buffer_load_dwordx2 v[40:41], v45, s[56:59], 0 offen
    ds_read_b64_tr_b16 a[226:227], v58 offset:18432
    v_mfma_f32_16x16x32_bf16 v[116:119], a[204:207], v[132:135], v[116:119]
    ds_read_b64_tr_b16 a[228:229], v58 offset:20480
    v_mfma_f32_16x16x32_bf16 v[124:127], a[200:203], v[144:147], 0
    ds_read_b64_tr_b16 a[230:231], v58 offset:22528
    v_mfma_f32_16x16x32_bf16 v[124:127], a[204:207], v[148:151], v[124:127]
    s_waitcnt lgkmcnt(8)
    ds_read_b64_tr_b16 a[232:233], v59 offset:16384
    v_mfma_f32_16x16x32_bf16 v[112:115], a[208:211], v[136:139], v[112:115]
    buffer_load_dwordx2 v[42:43], v45, s[56:59], 0 offen offset:32
    ds_read_b64_tr_b16 a[234:235], v59 offset:18432
    v_mfma_f32_16x16x32_bf16 v[112:115], a[212:215], v[140:143], v[112:115]
    ds_read_b64_tr_b16 a[236:237], v59 offset:20480
    v_mfma_f32_16x16x32_bf16 v[120:123], a[208:211], v[152:155], v[120:123]
    ds_read_b64_tr_b16 a[238:239], v59 offset:22528
    v_mfma_f32_16x16x32_bf16 v[120:123], a[212:215], v[156:159], v[120:123]
    s_waitcnt lgkmcnt(9)
    ds_read_b64_tr_b16 a[240:241], v58 offset:24576
    v_mfma_f32_16x16x32_bf16 v[116:119], a[216:219], v[136:139], v[116:119]
    s_waitcnt lgkmcnt(9)
    ds_read_b64_tr_b16 a[242:243], v58 offset:26624
    v_mfma_f32_16x16x32_bf16 v[116:119], a[220:223], v[140:143], v[116:119]
    ds_read_b64_tr_b16 a[244:245], v58 offset:28672
    v_mfma_f32_16x16x32_bf16 v[124:127], a[216:219], v[152:155], v[124:127]
    ds_read_b64_tr_b16 a[246:247], v58 offset:30720
    v_mfma_f32_16x16x32_bf16 v[124:127], a[220:223], v[156:159], v[124:127]
    s_waitcnt lgkmcnt(9)
    ds_read_b64_tr_b16 a[248:249], v59 offset:24576
    v_mfma_f32_16x16x32_bf16 v[112:115], a[224:227], v[160:163], v[112:115]
    s_waitcnt lgkmcnt(9)
    ds_read_b64_tr_b16 a[250:251], v59 offset:26624
    v_mfma_f32_16x16x32_bf16 v[112:115], a[228:231], v[164:167], v[112:115]
    ds_read_b64_tr_b16 a[252:253], v59 offset:28672
    v_mfma_f32_16x16x32_bf16 v[120:123], a[224:227], v[176:179], v[120:123]
    ds_read_b64_tr_b16 a[254:255], v59 offset:30720
    v_mfma_f32_16x16x32_bf16 v[120:123], a[228:231], v[180:183], v[120:123]
    s_waitcnt lgkmcnt(9)
    ds_read_b64_tr_b16 a[192:193], v60 offset:0
    v_mfma_f32_16x16x32_bf16 v[116:119], a[232:235], v[160:163], v[116:119]
    s_waitcnt lgkmcnt(9)
    ds_read_b64_tr_b16 a[194:195], v60 offset:2048
    v_mfma_f32_16x16x32_bf16 v[116:119], a[236:239], v[164:167], v[116:119]
    ds_read_b64_tr_b16 a[196:197], v60 offset:4096
    v_mfma_f32_16x16x32_bf16 v[124:127], a[232:235], v[176:179], v[124:127]
    ds_read_b64_tr_b16 a[198:199], v60 offset:6144
    v_mfma_f32_16x16x32_bf16 v[124:127], a[236:239], v[180:183], v[124:127]
    s_waitcnt lgkmcnt(9)
    ds_read_b64_tr_b16 a[200:201], v61 offset:0
    v_mfma_f32_16x16x32_bf16 v[112:115], a[240:243], v[168:171], v[112:115]
    s_waitcnt lgkmcnt(9)
    ds_read_b64_tr_b16 a[202:203], v61 offset:2048
    ds_read_b64_tr_b16 a[224:225], v60 offset:16384
    v_mfma_f32_16x16x32_bf16 v[112:115], a[244:247], v[172:175], v[112:115]
    ds_read_b64_tr_b16 a[204:205], v61 offset:4096
    ds_read_b64_tr_b16 a[226:227], v60 offset:18432
    v_mfma_f32_16x16x32_bf16 v[120:123], a[240:243], v[184:187], v[120:123]
    ds_read_b64_tr_b16 a[206:207], v61 offset:6144
    ds_read_b64_tr_b16 a[228:229], v60 offset:20480
    v_mfma_f32_16x16x32_bf16 v[120:123], a[244:247], v[188:191], v[120:123]
    s_waitcnt lgkmcnt(12)
    ds_read_b64_tr_b16 a[208:209], v60 offset:8192
    ds_read_b64_tr_b16 a[230:231], v60 offset:22528
    v_mfma_f32_16x16x32_bf16 v[116:119], a[248:251], v[168:171], v[116:119]
    s_waitcnt lgkmcnt(13)
    ds_read_b64_tr_b16 a[210:211], v60 offset:10240
    ds_read_b64_tr_b16 a[232:233], v61 offset:16384
    v_mfma_f32_16x16x32_bf16 v[116:119], a[252:255], v[172:175], v[116:119]
    ds_read_b64_tr_b16 a[212:213], v60 offset:12288
    ds_read_b64_tr_b16 a[234:235], v61 offset:18432
    v_mfma_f32_16x16x32_bf16 v[124:127], a[248:251], v[184:187], v[124:127]
    ds_read_b64_tr_b16 a[214:215], v60 offset:14336
    ds_read_b64_tr_b16 a[236:237], v61 offset:20480
    v_mfma_f32_16x16x32_bf16 v[124:127], a[252:255], v[188:191], v[124:127]
    s_waitcnt vmcnt(23) lgkmcnt(15)
    ds_read_b64_tr_b16 a[216:217], v61 offset:8192
    ds_read_b64_tr_b16 a[238:239], v61 offset:22528
    v_mfma_f32_16x16x32_bf16 v[64:67], a[192:195], v[192:195], v[64:67]
    s_waitcnt vmcnt(21)
    ds_read_b64_tr_b16 a[218:219], v61 offset:10240
    v_mfma_f32_16x16x32_bf16 v[64:67], a[196:199], v[196:199], v[64:67]
    ds_read_b64_tr_b16 a[220:221], v61 offset:12288
    v_mfma_f32_16x16x32_bf16 v[72:75], a[192:195], v[208:211], v[72:75]
    s_waitcnt vmcnt(20) lgkmcnt(15)
    s_mov_b32 s74, 8192
    ds_read_b64_tr_b16 a[222:223], v61 offset:14336
    v_mfma_f32_16x16x32_bf16 v[72:75], a[196:199], v[212:215], v[72:75]
    buffer_load_dwordx4 v[168:171], v46, s[8:11], s74 offen
    v_mfma_f32_16x16x32_bf16 v[68:71], a[200:203], v[192:195], v[68:71]
    s_waitcnt lgkmcnt(13)
    ds_read_b64_tr_b16 a[240:241], v60 offset:24576
    v_mfma_f32_16x16x32_bf16 v[68:71], a[204:207], v[196:199], v[68:71]
    ds_read_b64_tr_b16 a[242:243], v60 offset:26624
    v_mfma_f32_16x16x32_bf16 v[76:79], a[200:203], v[208:211], v[76:79]
    buffer_load_dwordx4 v[172:175], v46, s[8:11], s74 offen offset:64
    v_mfma_f32_16x16x32_bf16 v[76:79], a[204:207], v[212:215], v[76:79]
    s_waitcnt vmcnt(21) lgkmcnt(9)
    s_mov_b32 s74, 6144
    ds_read_b64_tr_b16 a[244:245], v60 offset:28672
    v_mfma_f32_16x16x32_bf16 v[64:67], a[208:211], v[200:203], v[64:67]
    s_waitcnt vmcnt(18) lgkmcnt(8)
    ds_read_b64_tr_b16 a[246:247], v60 offset:30720
    v_mfma_f32_16x16x32_bf16 v[64:67], a[212:215], v[204:207], v[64:67]
    buffer_load_dwordx4 v[176:179], v46, s[8:11], s74 offen
    v_mfma_f32_16x16x32_bf16 v[72:75], a[208:211], v[216:219], v[72:75]
    s_waitcnt vmcnt(18)
    ds_read_b64_tr_b16 a[248:249], v61 offset:24576
    v_mfma_f32_16x16x32_bf16 v[72:75], a[212:215], v[220:223], v[72:75]
    s_waitcnt lgkmcnt(5)
    ds_read_b64_tr_b16 a[250:251], v61 offset:26624
    v_mfma_f32_16x16x32_bf16 v[68:71], a[216:219], v[200:203], v[68:71]
    buffer_load_dwordx4 v[180:183], v46, s[8:11], s74 offen offset:64
    ds_read_b64_tr_b16 a[252:253], v61 offset:28672
    v_mfma_f32_16x16x32_bf16 v[68:71], a[220:223], v[204:207], v[68:71]
    s_add_u32 s74, s70, 0
    ds_read_b64_tr_b16 a[254:255], v61 offset:30720
    v_mfma_f32_16x16x32_bf16 v[76:79], a[216:219], v[216:219], v[76:79]
    s_waitcnt vmcnt(17)
    ds_read_b64_tr_b16 a[192:193], v62 offset:0
    v_mfma_f32_16x16x32_bf16 v[76:79], a[220:223], v[220:223], v[76:79]
    buffer_load_dwordx4 v[128:131], v44, s[8:11], s74 offen sc0 sc1
    v_mfma_f32_16x16x32_bf16 v[64:67], a[224:227], v[224:227], v[64:67]
    s_waitcnt vmcnt(16)
    s_add_u32 s74, s70, 4096
    ds_read_b64_tr_b16 a[194:195], v62 offset:2048
    s_waitcnt vmcnt(6)
    v_lshlrev_b32 v48, 16, v40
    v_mfma_f32_16x16x32_bf16 v[64:67], a[228:231], v[228:231], v[64:67]
    ds_read_b64_tr_b16 a[196:197], v62 offset:4096
    v_and_b32 v49, 0xffff0000, v40
    v_mfma_f32_16x16x32_bf16 v[72:75], a[224:227], v[240:243], v[72:75]
    buffer_load_dwordx4 v[132:135], v44, s[8:11], s74 offen sc0 sc1
    v_mfma_f32_16x16x32_bf16 v[72:75], a[228:231], v[244:247], v[72:75]
    s_add_u32 s74, s70, 8192
    ds_read_b64_tr_b16 a[198:199], v62 offset:6144
    v_lshlrev_b32 v50, 16, v41
    v_mfma_f32_16x16x32_bf16 v[68:71], a[232:235], v[224:227], v[68:71]
    ds_read_b64_tr_b16 a[200:201], v63 offset:0
    v_and_b32 v51, 0xffff0000, v41
    v_mfma_f32_16x16x32_bf16 v[68:71], a[236:239], v[228:231], v[68:71]
    buffer_load_dwordx4 v[136:139], v44, s[8:11], s74 offen sc0 sc1
    ds_read_b64_tr_b16 a[202:203], v63 offset:2048
    v_mfma_f32_16x16x32_bf16 v[76:79], a[232:235], v[240:243], v[76:79]
    s_add_u32 s74, s70, 12288
    ds_read_b64_tr_b16 a[204:205], v63 offset:4096
    s_waitcnt vmcnt(7)
    v_lshlrev_b32 v52, 16, v42
    v_mfma_f32_16x16x32_bf16 v[76:79], a[236:239], v[244:247], v[76:79]
    s_waitcnt lgkmcnt(7)
    ds_read_b64_tr_b16 a[206:207], v63 offset:6144
    v_and_b32 v53, 0xffff0000, v42
    v_mfma_f32_16x16x32_bf16 v[64:67], a[240:243], v[232:235], v[64:67]
    buffer_load_dwordx4 v[140:143], v44, s[8:11], s74 offen sc0 sc1
    v_mfma_f32_16x16x32_bf16 v[64:67], a[244:247], v[236:239], v[64:67]
    s_add_u32 s74, s70, 16384
    ds_read_b64_tr_b16 a[208:209], v62 offset:8192
    v_lshlrev_b32 v54, 16, v43
    v_mfma_f32_16x16x32_bf16 v[72:75], a[240:243], v[248:251], v[72:75]
    ds_read_b64_tr_b16 a[210:211], v62 offset:10240
    v_and_b32 v55, 0xffff0000, v43
    v_mfma_f32_16x16x32_bf16 v[72:75], a[244:247], v[252:255], v[72:75]
    buffer_load_dwordx4 v[144:147], v44, s[8:11], s74 offen sc0 sc1
    ds_read_b64_tr_b16 a[212:213], v62 offset:12288
    v_mfma_f32_16x16x32_bf16 v[68:71], a[248:251], v[232:235], v[68:71]
    s_add_u32 s74, s70, 20480
    ds_read_b64_tr_b16 a[214:215], v62 offset:14336
    v_mfma_f32_16x16x32_bf16 v[68:71], a[252:255], v[236:239], v[68:71]
    ds_read_b64_tr_b16 a[216:217], v63 offset:8192
    v_mfma_f32_16x16x32_bf16 v[76:79], a[248:251], v[248:251], v[76:79]
    buffer_load_dwordx4 v[148:151], v44, s[8:11], s74 offen sc0 sc1
    ds_read_b64_tr_b16 a[218:219], v63 offset:10240
    v_mfma_f32_16x16x32_bf16 v[76:79], a[252:255], v[252:255], v[76:79]
    s_waitcnt lgkmcnt(8)
    s_add_u32 s74, s70, 24576
    ds_read_b64_tr_b16 a[220:221], v63 offset:12288
    v_mfma_f32_16x16x32_bf16 v[80:83], a[192:195], v[192:195], v[80:83]
    ds_read_b64_tr_b16 a[222:223], v63 offset:14336
    v_mfma_f32_16x16x32_bf16 v[80:83], a[196:199], v[196:199], v[80:83]
    buffer_load_dwordx4 v[152:155], v44, s[8:11], s74 offen sc0 sc1
    v_mfma_f32_16x16x32_bf16 v[88:91], a[192:195], v[208:211], v[88:91]
    s_add_u32 s74, s70, 28672
    ds_read_b64_tr_b16 a[224:225], v62 offset:16384
    v_mfma_f32_16x16x32_bf16 v[88:91], a[196:199], v[212:215], v[88:91]
    s_waitcnt lgkmcnt(8)
    ds_read_b64_tr_b16 a[226:227], v62 offset:18432
    v_mfma_f32_16x16x32_bf16 v[84:87], a[200:203], v[192:195], v[84:87]
    buffer_load_dwordx4 v[156:159], v44, s[8:11], s74 offen sc0 sc1
    ds_read_b64_tr_b16 a[228:229], v62 offset:20480
    v_mfma_f32_16x16x32_bf16 v[84:87], a[204:207], v[196:199], v[84:87]
    s_mov_b32 s74, 4096
    ds_read_b64_tr_b16 a[230:231], v62 offset:22528
    v_mfma_f32_16x16x32_bf16 v[92:95], a[200:203], v[208:211], v[92:95]
    s_waitcnt lgkmcnt(8)
    ds_read_b64_tr_b16 a[232:233], v63 offset:16384
    v_cvt_pk_bf16_f32 v64, v64, v65
    v_mfma_f32_16x16x32_bf16 v[92:95], a[204:207], v[212:215], v[92:95]
    buffer_load_dwordx4 v[160:163], v46, s[8:11], s74 offen
    ds_read_b64_tr_b16 a[234:235], v63 offset:18432
    v_mfma_f32_16x16x32_bf16 v[80:83], a[208:211], v[200:203], v[80:83]
    ds_read_b64_tr_b16 a[236:237], v63 offset:20480
    v_cvt_pk_bf16_f32 v65, v66, v67
    v_mfma_f32_16x16x32_bf16 v[80:83], a[212:215], v[204:207], v[80:83]
    ds_read_b64_tr_b16 a[238:239], v63 offset:22528
    v_cvt_pk_bf16_f32 v66, v68, v69
    v_mfma_f32_16x16x32_bf16 v[88:91], a[208:211], v[216:219], v[88:91]
    buffer_load_dwordx4 v[164:167], v46, s[8:11], s74 offen offset:64
    ds_read_b64_tr_b16 a[192:193], v60 offset:32768
    v_mfma_f32_16x16x32_bf16 v[88:91], a[212:215], v[220:223], v[88:91]
    s_waitcnt lgkmcnt(9)
    s_mov_b32 s74, 10240
    ds_read_b64_tr_b16 a[240:241], v62 offset:24576
    v_cvt_pk_bf16_f32 v67, v70, v71
    v_mfma_f32_16x16x32_bf16 v[84:87], a[216:219], v[200:203], v[84:87]
    ds_read_b64_tr_b16 a[242:243], v62 offset:26624
    v_min_u32 v64, -2, v64
    v_mfma_f32_16x16x32_bf16 v[84:87], a[220:223], v[204:207], v[84:87]
    buffer_load_dwordx4 v[184:187], v46, s[8:11], s74 offen
    ds_read_b64_tr_b16 a[244:245], v62 offset:28672
    v_mfma_f32_16x16x32_bf16 v[92:95], a[216:219], v[216:219], v[92:95]
    ds_read_b64_tr_b16 a[246:247], v62 offset:30720
    v_min_u32 v65, -2, v65
    v_mfma_f32_16x16x32_bf16 v[92:95], a[220:223], v[220:223], v[92:95]
    s_waitcnt lgkmcnt(9)
    ds_read_b64_tr_b16 a[248:249], v63 offset:24576
    v_min_u32 v66, -2, v66
    v_mfma_f32_16x16x32_bf16 v[80:83], a[224:227], v[224:227], v[80:83]
    buffer_load_dwordx4 v[188:191], v46, s[8:11], s74 offen offset:64
    ds_read_b64_tr_b16 a[250:251], v63 offset:26624
    v_mfma_f32_16x16x32_bf16 v[80:83], a[228:231], v[228:231], v[80:83]
    ds_read_b64_tr_b16 a[252:253], v63 offset:28672
    v_min_u32 v67, -2, v67
    v_mfma_f32_16x16x32_bf16 v[88:91], a[224:227], v[240:243], v[88:91]
    s_waitcnt lgkmcnt(9)
    s_add_u32 s75, s18, 8388608
    ds_read_b64_tr_b16 a[254:255], v63 offset:30720
    v_mfma_f32_16x16x32_bf16 v[88:91], a[228:231], v[244:247], v[88:91]
    buffer_store_dwordx4 v[64:67], v23, s[8:11], s75 offen offset:0 sc0 sc1
    ds_read_b64_tr_b16 a[194:195], v60 offset:34816
    v_mfma_f32_16x16x32_bf16 v[84:87], a[232:235], v[224:227], v[84:87]
    s_waitcnt lgkmcnt(9)
    ds_read_b64_tr_b16 a[196:197], v60 offset:36864
    v_cvt_pk_bf16_f32 v72, v72, v73
    v_mfma_f32_16x16x32_bf16 v[84:87], a[236:239], v[228:231], v[84:87]
    ds_read_b64_tr_b16 a[198:199], v60 offset:38912
    v_cvt_pk_bf16_f32 v73, v74, v75
    v_mfma_f32_16x16x32_bf16 v[92:95], a[232:235], v[240:243], v[92:95]
    ds_read_b64_tr_b16 a[200:201], v61 offset:32768
    v_cvt_pk_bf16_f32 v74, v76, v77
    v_mfma_f32_16x16x32_bf16 v[92:95], a[236:239], v[244:247], v[92:95]
    s_waitcnt lgkmcnt(9)
    ds_read_b64_tr_b16 a[202:203], v61 offset:34816
    v_cvt_pk_bf16_f32 v75, v78, v79
    v_mfma_f32_16x16x32_bf16 v[80:83], a[240:243], v[232:235], v[80:83]
    s_waitcnt lgkmcnt(9)
    ds_read_b64_tr_b16 a[204:205], v61 offset:36864
    v_min_u32 v72, -2, v72
    v_mfma_f32_16x16x32_bf16 v[80:83], a[244:247], v[236:239], v[80:83]
    ds_read_b64_tr_b16 a[206:207], v61 offset:38912
    v_min_u32 v73, -2, v73
    v_mfma_f32_16x16x32_bf16 v[88:91], a[240:243], v[248:251], v[88:91]
    ds_read_b64_tr_b16 a[208:209], v60 offset:40960
    v_min_u32 v74, -2, v74
    v_mfma_f32_16x16x32_bf16 v[88:91], a[244:247], v[252:255], v[88:91]
    s_waitcnt lgkmcnt(9)
    ds_read_b64_tr_b16 a[210:211], v60 offset:43008
    v_min_u32 v75, -2, v75
    v_mfma_f32_16x16x32_bf16 v[84:87], a[248:251], v[232:235], v[84:87]
    s_waitcnt lgkmcnt(9)
    s_add_u32 s75, s18, 8519680
    ds_read_b64_tr_b16 a[212:213], v60 offset:45056
    s_waitcnt vmcnt(16)
    v_mul_f32 v8, v48, v168
    v_mfma_f32_16x16x32_bf16 v[84:87], a[252:255], v[236:239], v[84:87]
    buffer_store_dwordx4 v[72:75], v23, s[8:11], s75 offen offset:0 sc0 sc1
    ds_read_b64_tr_b16 a[214:215], v60 offset:47104
    v_mfma_f32_16x16x32_bf16 v[92:95], a[248:251], v[248:251], v[92:95]
    ds_read_b64_tr_b16 a[216:217], v61 offset:40960
    v_mul_f32 v9, v49, v169
    v_mfma_f32_16x16x32_bf16 v[92:95], a[252:255], v[252:255], v[92:95]
    s_waitcnt lgkmcnt(9)
    ds_read_b64_tr_b16 a[218:219], v61 offset:43008
    v_mul_f32 v10, v50, v170
    v_mfma_f32_16x16x32_bf16 v[96:99], a[192:195], v[192:195], v[96:99]
    ds_read_b64_tr_b16 a[220:221], v61 offset:45056
    v_mul_f32 v11, v51, v171
    v_mfma_f32_16x16x32_bf16 v[96:99], a[196:199], v[196:199], v[96:99]
    ds_read_b64_tr_b16 a[222:223], v61 offset:47104
    s_waitcnt vmcnt(16)
    v_mul_f32 v12, v52, v172
    v_mfma_f32_16x16x32_bf16 v[104:107], a[192:195], v[208:211], v[104:107]
    ds_read_b64_tr_b16 a[224:225], v60 offset:49152
    v_mul_f32 v13, v53, v173
    v_mfma_f32_16x16x32_bf16 v[104:107], a[196:199], v[212:215], v[104:107]
    s_waitcnt lgkmcnt(9)
    ds_read_b64_tr_b16 a[226:227], v60 offset:51200
    v_mul_f32 v14, v54, v174
    v_mfma_f32_16x16x32_bf16 v[100:103], a[200:203], v[192:195], v[100:103]
    ds_read_b64_tr_b16 a[228:229], v60 offset:53248
    v_mul_f32 v15, v55, v175
    v_mfma_f32_16x16x32_bf16 v[100:103], a[204:207], v[196:199], v[100:103]
    ds_read_b64_tr_b16 a[230:231], v60 offset:55296
    s_waitcnt vmcnt(15)
    v_mul_f32 v16, v48, v176
    v_mfma_f32_16x16x32_bf16 v[108:111], a[200:203], v[208:211], v[108:111]
    ds_read_b64_tr_b16 a[232:233], v61 offset:49152
    v_cvt_pk_bf16_f32 v80, v80, v81
    v_mfma_f32_16x16x32_bf16 v[108:111], a[204:207], v[212:215], v[108:111]
    s_waitcnt lgkmcnt(9)
    ds_read_b64_tr_b16 a[234:235], v61 offset:51200
    v_cvt_pk_bf16_f32 v81, v82, v83
    v_mfma_f32_16x16x32_bf16 v[96:99], a[208:211], v[200:203], v[96:99]
    ds_read_b64_tr_b16 a[236:237], v61 offset:53248
    v_cvt_pk_bf16_f32 v82, v84, v85
    v_mfma_f32_16x16x32_bf16 v[96:99], a[212:215], v[204:207], v[96:99]
    ds_read_b64_tr_b16 a[238:239], v61 offset:55296
    v_cvt_pk_bf16_f32 v83, v86, v87
    v_mfma_f32_16x16x32_bf16 v[104:107], a[208:211], v[216:219], v[104:107]
    ds_read_b64_tr_b16 a[240:241], v60 offset:57344
    v_min_u32 v80, -2, v80
    v_mfma_f32_16x16x32_bf16 v[104:107], a[212:215], v[220:223], v[104:107]
    s_waitcnt lgkmcnt(9)
    ds_read_b64_tr_b16 a[242:243], v60 offset:59392
    v_min_u32 v81, -2, v81
    v_mfma_f32_16x16x32_bf16 v[100:103], a[216:219], v[200:203], v[100:103]
    ds_read_b64_tr_b16 a[244:245], v60 offset:61440
    v_min_u32 v82, -2, v82
    v_mfma_f32_16x16x32_bf16 v[100:103], a[220:223], v[204:207], v[100:103]
    ds_read_b64_tr_b16 a[246:247], v60 offset:63488
    v_min_u32 v83, -2, v83
    v_mfma_f32_16x16x32_bf16 v[108:111], a[216:219], v[216:219], v[108:111]
    s_waitcnt lgkmcnt(9)
    s_add_u32 s75, s18, 8388608
    ds_read_b64_tr_b16 a[248:249], v61 offset:57344
    v_fmac_f32 v16, v49, v177
    v_mfma_f32_16x16x32_bf16 v[108:111], a[220:223], v[220:223], v[108:111]
    buffer_store_dwordx4 v[80:83], v23, s[8:11], s75 offen offset:256 sc0 sc1
    ds_read_b64_tr_b16 a[250:251], v61 offset:59392
    v_mfma_f32_16x16x32_bf16 v[96:99], a[224:227], v[224:227], v[96:99]
    s_waitcnt lgkmcnt(9)
    ds_read_b64_tr_b16 a[252:253], v61 offset:61440
    v_cvt_pk_bf16_f32 v88, v88, v89
    v_mfma_f32_16x16x32_bf16 v[96:99], a[228:231], v[228:231], v[96:99]
    ds_read_b64_tr_b16 a[254:255], v61 offset:63488
    v_cvt_pk_bf16_f32 v89, v90, v91
    v_mfma_f32_16x16x32_bf16 v[104:107], a[224:227], v[240:243], v[104:107]
    ds_read_b64_tr_b16 a[192:193], v62 offset:32768
    v_cvt_pk_bf16_f32 v90, v92, v93
    v_mfma_f32_16x16x32_bf16 v[104:107], a[228:231], v[244:247], v[104:107]
    s_waitcnt lgkmcnt(9)
    ds_read_b64_tr_b16 a[194:195], v62 offset:34816
    v_cvt_pk_bf16_f32 v91, v94, v95
    v_mfma_f32_16x16x32_bf16 v[100:103], a[232:235], v[224:227], v[100:103]
    ds_read_b64_tr_b16 a[196:197], v62 offset:36864
    v_min_u32 v88, -2, v88
    v_mfma_f32_16x16x32_bf16 v[100:103], a[236:239], v[228:231], v[100:103]
    ds_read_b64_tr_b16 a[198:199], v62 offset:38912
    v_min_u32 v89, -2, v89
    v_mfma_f32_16x16x32_bf16 v[108:111], a[232:235], v[240:243], v[108:111]
    ds_read_b64_tr_b16 a[200:201], v63 offset:32768
    v_min_u32 v90, -2, v90
    v_mfma_f32_16x16x32_bf16 v[108:111], a[236:239], v[244:247], v[108:111]
    s_waitcnt lgkmcnt(9)
    ds_read_b64_tr_b16 a[202:203], v63 offset:34816
    v_min_u32 v91, -2, v91
    v_mfma_f32_16x16x32_bf16 v[96:99], a[240:243], v[232:235], v[96:99]
    s_add_u32 s75, s18, 8519680
    ds_read_b64_tr_b16 a[204:205], v63 offset:36864
    v_fmac_f32 v16, v50, v178
    v_mfma_f32_16x16x32_bf16 v[96:99], a[244:247], v[236:239], v[96:99]
    buffer_store_dwordx4 v[88:91], v23, s[8:11], s75 offen offset:256 sc0 sc1
    ds_read_b64_tr_b16 a[206:207], v63 offset:38912
    v_mfma_f32_16x16x32_bf16 v[104:107], a[240:243], v[248:251], v[104:107]
    ds_read_b64_tr_b16 a[208:209], v62 offset:40960
    v_fmac_f32 v16, v51, v179
    v_mfma_f32_16x16x32_bf16 v[104:107], a[244:247], v[252:255], v[104:107]
    s_waitcnt lgkmcnt(9)
    ds_read_b64_tr_b16 a[210:211], v62 offset:43008
    s_waitcnt vmcnt(16)
    v_fmac_f32 v16, v52, v180
    v_mfma_f32_16x16x32_bf16 v[100:103], a[248:251], v[232:235], v[100:103]
    ds_read_b64_tr_b16 a[212:213], v62 offset:45056
    v_fmac_f32 v16, v53, v181
    v_mfma_f32_16x16x32_bf16 v[100:103], a[252:255], v[236:239], v[100:103]
    ds_read_b64_tr_b16 a[214:215], v62 offset:47104
    v_fmac_f32 v16, v54, v182
    v_mfma_f32_16x16x32_bf16 v[108:111], a[248:251], v[248:251], v[108:111]
    ds_read_b64_tr_b16 a[216:217], v63 offset:40960
    v_fmac_f32 v16, v55, v183
    v_mfma_f32_16x16x32_bf16 v[108:111], a[252:255], v[252:255], v[108:111]
    s_waitcnt lgkmcnt(9)
    ds_read_b64_tr_b16 a[218:219], v63 offset:43008
    v_add_f32_dpp v16, v16, v16 quad_perm:[1,0,3,2] row_mask:0xf bank_mask:0xf
    v_mfma_f32_16x16x32_bf16 v[112:115], a[192:195], v[192:195], v[112:115]
    ds_read_b64_tr_b16 a[220:221], v63 offset:45056
    v_add_f32_dpp v16, v16, v16 quad_perm:[2,3,0,1] row_mask:0xf bank_mask:0xf
    v_mfma_f32_16x16x32_bf16 v[112:115], a[196:199], v[196:199], v[112:115]
    ds_read_b64_tr_b16 a[222:223], v63 offset:47104
    v_add_f32_dpp v16, v16, v16 row_half_mirror row_mask:0xf bank_mask:0xf
    v_mfma_f32_16x16x32_bf16 v[120:123], a[192:195], v[208:211], v[120:123]
    ds_read_b64_tr_b16 a[224:225], v62 offset:49152
    v_add_f32_dpp v16, v16, v16 row_mirror row_mask:0xf bank_mask:0xf
    v_mfma_f32_16x16x32_bf16 v[120:123], a[196:199], v[212:215], v[120:123]
    s_waitcnt lgkmcnt(9)
    ds_read_b64_tr_b16 a[226:227], v62 offset:51200
    v_mov_b32 v19, v16
    v_mfma_f32_16x16x32_bf16 v[116:119], a[200:203], v[192:195], v[116:119]
    ds_read_b64_tr_b16 a[228:229], v62 offset:53248
    v_permlane16_swap_b32 v16, v19
    v_mfma_f32_16x16x32_bf16 v[116:119], a[204:207], v[196:199], v[116:119]
    ds_read_b64_tr_b16 a[230:231], v62 offset:55296
    v_add_f32 v16, v16, v19
    v_mfma_f32_16x16x32_bf16 v[124:127], a[200:203], v[208:211], v[124:127]
    ds_read_b64_tr_b16 a[232:233], v63 offset:49152
    v_cvt_pk_bf16_f32 v96, v96, v97
    v_mfma_f32_16x16x32_bf16 v[124:127], a[204:207], v[212:215], v[124:127]
    s_waitcnt lgkmcnt(9)
    ds_read_b64_tr_b16 a[234:235], v63 offset:51200
    v_cvt_pk_bf16_f32 v97, v98, v99
    v_mfma_f32_16x16x32_bf16 v[112:115], a[208:211], v[200:203], v[112:115]
    ds_read_b64_tr_b16 a[236:237], v63 offset:53248
    v_cvt_pk_bf16_f32 v98, v100, v101
    v_mfma_f32_16x16x32_bf16 v[112:115], a[212:215], v[204:207], v[112:115]
    ds_read_b64_tr_b16 a[238:239], v63 offset:55296
    v_cvt_pk_bf16_f32 v99, v102, v103
    v_mfma_f32_16x16x32_bf16 v[120:123], a[208:211], v[216:219], v[120:123]
    ds_read_b64_tr_b16 a[240:241], v62 offset:57344
    v_min_u32 v96, -2, v96
    v_mfma_f32_16x16x32_bf16 v[120:123], a[212:215], v[220:223], v[120:123]
    s_waitcnt lgkmcnt(9)
    ds_read_b64_tr_b16 a[242:243], v62 offset:59392
    v_min_u32 v97, -2, v97
    v_mfma_f32_16x16x32_bf16 v[116:119], a[216:219], v[200:203], v[116:119]
    ds_read_b64_tr_b16 a[244:245], v62 offset:61440
    v_min_u32 v98, -2, v98
    v_mfma_f32_16x16x32_bf16 v[116:119], a[220:223], v[204:207], v[116:119]
    ds_read_b64_tr_b16 a[246:247], v62 offset:63488
    v_min_u32 v99, -2, v99
    v_mfma_f32_16x16x32_bf16 v[124:127], a[216:219], v[216:219], v[124:127]
    s_waitcnt lgkmcnt(9)
    s_add_u32 s75, s18, 8388608
    ds_read_b64_tr_b16 a[248:249], v63 offset:57344
    v_mov_b32 v19, v16
    v_mfma_f32_16x16x32_bf16 v[124:127], a[220:223], v[220:223], v[124:127]
    buffer_store_dwordx4 v[96:99], v23, s[8:11], s75 offen offset:512 sc0 sc1
    ds_read_b64_tr_b16 a[250:251], v63 offset:59392
    v_permlane32_swap_b32 v16, v19
    v_mfma_f32_16x16x32_bf16 v[112:115], a[224:227], v[224:227], v[112:115]
    s_waitcnt lgkmcnt(9)
    ds_read_b64_tr_b16 a[252:253], v63 offset:61440
    v_cvt_pk_bf16_f32 v104, v104, v105
    v_add_f32 v16, v16, v19
    v_mfma_f32_16x16x32_bf16 v[112:115], a[228:231], v[228:231], v[112:115]
    ds_read_b64_tr_b16 a[254:255], v63 offset:63488
    v_cvt_pk_bf16_f32 v105, v106, v107
    v_mfma_f32_16x16x32_bf16 v[120:123], a[224:227], v[240:243], v[120:123]
    v_cvt_pk_bf16_f32 v106, v108, v109
    v_mfma_f32_16x16x32_bf16 v[120:123], a[228:231], v[244:247], v[120:123]
    s_waitcnt lgkmcnt(8)
    v_cvt_pk_bf16_f32 v107, v110, v111
    v_mfma_f32_16x16x32_bf16 v[116:119], a[232:235], v[224:227], v[116:119]
    v_min_u32 v104, -2, v104
    v_mfma_f32_16x16x32_bf16 v[116:119], a[236:239], v[228:231], v[116:119]
    v_min_u32 v105, -2, v105
    v_mfma_f32_16x16x32_bf16 v[124:127], a[232:235], v[240:243], v[124:127]
    v_min_u32 v106, -2, v106
    v_mfma_f32_16x16x32_bf16 v[124:127], a[236:239], v[244:247], v[124:127]
    s_waitcnt lgkmcnt(4)
    v_min_u32 v107, -2, v107
    v_mfma_f32_16x16x32_bf16 v[112:115], a[240:243], v[232:235], v[112:115]
    s_add_u32 s75, s18, 8519680
    v_mfma_f32_16x16x32_bf16 v[112:115], a[244:247], v[236:239], v[112:115]
    buffer_store_dwordx4 v[104:107], v23, s[8:11], s75 offen offset:512 sc0 sc1
    v_mfma_f32_16x16x32_bf16 v[120:123], a[240:243], v[248:251], v[120:123]
    v_mfma_f32_16x16x32_bf16 v[120:123], a[244:247], v[252:255], v[120:123]
    s_waitcnt lgkmcnt(0)
    v_mfma_f32_16x16x32_bf16 v[116:119], a[248:251], v[232:235], v[116:119]
    v_mfma_f32_16x16x32_bf16 v[116:119], a[252:255], v[236:239], v[116:119]
    v_mfma_f32_16x16x32_bf16 v[124:127], a[248:251], v[248:251], v[124:127]
    v_mfma_f32_16x16x32_bf16 v[124:127], a[252:255], v[252:255], v[124:127]
    v_cvt_pk_bf16_f32 v112, v112, v113
    v_cvt_pk_bf16_f32 v113, v114, v115
    s_nop 3
    v_cvt_pk_bf16_f32 v114, v116, v117
    v_cvt_pk_bf16_f32 v115, v118, v119
    v_min_u32 v112, -2, v112
    v_min_u32 v113, -2, v113
    v_min_u32 v114, -2, v114
    v_min_u32 v115, -2, v115
    s_add_u32 s75, s18, 8388608
    buffer_store_dwordx4 v[112:115], v23, s[8:11], s75 offen offset:768 sc0 sc1
    v_cvt_pk_bf16_f32 v120, v120, v121
    v_cvt_pk_bf16_f32 v121, v122, v123
    v_cvt_pk_bf16_f32 v122, v124, v125
    v_cvt_pk_bf16_f32 v123, v126, v127
    v_min_u32 v120, -2, v120
    v_min_u32 v121, -2, v121
    v_min_u32 v122, -2, v122
    v_min_u32 v123, -2, v123
    s_add_u32 s75, s18, 8519680
    buffer_store_dwordx4 v[120:123], v23, s[8:11], s75 offen offset:768 sc0 sc1
    s_mov_b32 s12, 0xf000f
    s_mov_b32 s13, 0xf000f
    v_mov_b64 v[192:193], -1
    v_mov_b64 v[194:195], -1
    v_mov_b64 v[196:197], -1
    v_mov_b64 v[198:199], -1
    v_mov_b64 v[200:201], -1
    v_mov_b64 v[202:203], -1
    v_mov_b64 v[204:205], -1
    v_mov_b64 v[206:207], -1
    v_mov_b64 v[208:209], -1
    v_mov_b64 v[210:211], -1
    v_mov_b64 v[212:213], -1
    v_mov_b64 v[214:215], -1
    v_mov_b64 v[216:217], -1
    v_mov_b64 v[218:219], -1
    v_mov_b64 v[220:221], -1
    v_mov_b64 v[222:223], -1
    s_mov_b64 exec, s[12:13]
    s_add_u32 s74, s70, 8388608
    buffer_load_dwordx4 v[192:195], v44, s[8:11], s74 offen sc0 sc1
    s_add_u32 s74, s70, 8392704
    buffer_load_dwordx4 v[196:199], v44, s[8:11], s74 offen sc0 sc1
    s_add_u32 s74, s70, 8396800
    buffer_load_dwordx4 v[200:203], v44, s[8:11], s74 offen sc0 sc1
    s_add_u32 s74, s70, 8400896
    buffer_load_dwordx4 v[204:207], v44, s[8:11], s74 offen sc0 sc1
    s_add_u32 s74, s70, 8404992
    buffer_load_dwordx4 v[208:211], v44, s[8:11], s74 offen sc0 sc1
    s_add_u32 s74, s70, 8409088
    buffer_load_dwordx4 v[212:215], v44, s[8:11], s74 offen sc0 sc1
    s_add_u32 s74, s70, 8413184
    buffer_load_dwordx4 v[216:219], v44, s[8:11], s74 offen sc0 sc1
    s_add_u32 s74, s70, 8417280
    buffer_load_dwordx4 v[220:223], v44, s[8:11], s74 offen sc0 sc1
    s_mov_b64 exec, -1
    v_mov_b32 v100, 0x3f80
    v_mov_b32 v101, 0x3f800000
    v_lshlrev_b32 v88, 16, v36
    v_and_b32 v89, 0xffff0000, v36
    v_lshlrev_b32 v90, 16, v37
    v_and_b32 v91, 0xffff0000, v37
    v_lshlrev_b32 v92, 16, v38
    v_and_b32 v93, 0xffff0000, v38
    v_lshlrev_b32 v94, 16, v39
    v_and_b32 v95, 0xffff0000, v39
    v_lshlrev_b32 v72, 16, v32
    v_and_b32 v73, 0xffff0000, v32
    v_lshlrev_b32 v74, 16, v33
    v_and_b32 v75, 0xffff0000, v33
    v_lshlrev_b32 v76, 16, v34
    v_and_b32 v77, 0xffff0000, v34
    v_lshlrev_b32 v78, 16, v35
    v_and_b32 v79, 0xffff0000, v35
    s_waitcnt vmcnt(27)
    v_max_u32 v3, v128, v129
    v_max3_u32 v3, v3, v130, v131
    s_waitcnt vmcnt(26)
    v_max3_u32 v3, v3, v132, v133
    v_max3_u32 v3, v3, v134, v135
    s_waitcnt vmcnt(25)
    v_max3_u32 v3, v3, v136, v137
    v_max3_u32 v3, v3, v138, v139
    s_waitcnt vmcnt(24)
    v_max3_u32 v3, v3, v140, v141
    v_max3_u32 v3, v3, v142, v143
    s_waitcnt vmcnt(23)
    v_max3_u32 v3, v3, v144, v145
    v_max3_u32 v3, v3, v146, v147
    s_waitcnt vmcnt(22)
    v_max3_u32 v3, v3, v148, v149
    v_max3_u32 v3, v3, v150, v151
    s_waitcnt vmcnt(21)
    v_max3_u32 v3, v3, v152, v153
    v_max3_u32 v3, v3, v154, v155
    s_waitcnt vmcnt(20)
    v_max3_u32 v3, v3, v156, v157
    v_max3_u32 v3, v3, v158, v159
    v_cmp_eq_u32 vcc, -1, v3
    s_cbranch_vccnz L_P1_slow_19
L_P1_ok_20:
    v_lshlrev_b32 v64, 16, v128
    v_and_b32 v65, 0xffff0000, v128
    v_lshlrev_b32 v66, 16, v129
    v_and_b32 v67, 0xffff0000, v129
    v_lshlrev_b32 v68, 16, v130
    v_and_b32 v69, 0xffff0000, v130
    v_lshlrev_b32 v70, 16, v131
    v_and_b32 v71, 0xffff0000, v131
    v_dot2c_f32_bf16 v64, v132, v100
    v_dot2c_f32_bf16 v65, v132, v101
    v_dot2c_f32_bf16 v66, v133, v100
    v_dot2c_f32_bf16 v67, v133, v101
    v_dot2c_f32_bf16 v68, v134, v100
    v_dot2c_f32_bf16 v69, v134, v101
    v_dot2c_f32_bf16 v70, v135, v100
    v_dot2c_f32_bf16 v71, v135, v101
    v_dot2c_f32_bf16 v64, v136, v100
    v_dot2c_f32_bf16 v65, v136, v101
    v_dot2c_f32_bf16 v66, v137, v100
    v_dot2c_f32_bf16 v67, v137, v101
    v_dot2c_f32_bf16 v68, v138, v100
    v_dot2c_f32_bf16 v69, v138, v101
    v_dot2c_f32_bf16 v70, v139, v100
    v_dot2c_f32_bf16 v71, v139, v101
    v_dot2c_f32_bf16 v64, v140, v100
    v_dot2c_f32_bf16 v65, v140, v101
    v_dot2c_f32_bf16 v66, v141, v100
    v_dot2c_f32_bf16 v67, v141, v101
    v_dot2c_f32_bf16 v68, v142, v100
    v_dot2c_f32_bf16 v69, v142, v101
    v_dot2c_f32_bf16 v70, v143, v100
    v_dot2c_f32_bf16 v71, v143, v101
    v_dot2c_f32_bf16 v64, v144, v100
    v_dot2c_f32_bf16 v65, v144, v101
    v_dot2c_f32_bf16 v66, v145, v100
    v_dot2c_f32_bf16 v67, v145, v101
    v_dot2c_f32_bf16 v68, v146, v100
    v_dot2c_f32_bf16 v69, v146, v101
    v_dot2c_f32_bf16 v70, v147, v100
    v_dot2c_f32_bf16 v71, v147, v101
    v_dot2c_f32_bf16 v64, v148, v100
    v_dot2c_f32_bf16 v65, v148, v101
    v_dot2c_f32_bf16 v66, v149, v100
    v_dot2c_f32_bf16 v67, v149, v101
    v_dot2c_f32_bf16 v68, v150, v100
    v_dot2c_f32_bf16 v69, v150, v101
    v_dot2c_f32_bf16 v70, v151, v100
    v_dot2c_f32_bf16 v71, v151, v101
    v_dot2c_f32_bf16 v64, v152, v100
    v_dot2c_f32_bf16 v65, v152, v101
    v_dot2c_f32_bf16 v66, v153, v100
    v_dot2c_f32_bf16 v67, v153, v101
    v_dot2c_f32_bf16 v68, v154, v100
    v_dot2c_f32_bf16 v69, v154, v101
    v_dot2c_f32_bf16 v70, v155, v100
    v_dot2c_f32_bf16 v71, v155, v101
    v_dot2c_f32_bf16 v64, v156, v100
    v_dot2c_f32_bf16 v65, v156, v101
    v_dot2c_f32_bf16 v66, v157, v100
    v_dot2c_f32_bf16 v67, v157, v101
    v_dot2c_f32_bf16 v68, v158, v100
    v_dot2c_f32_bf16 v69, v158, v101
    v_dot2c_f32_bf16 v70, v159, v100
    v_dot2c_f32_bf16 v71, v159, v101
    s_waitcnt vmcnt(19)
    v_pk_fma_f32 v[64:65], v[64:65], v[160:161], v[72:73]
    v_pk_fma_f32 v[66:67], v[66:67], v[162:163], v[74:75]
    s_waitcnt vmcnt(18)
    v_pk_fma_f32 v[68:69], v[68:69], v[164:165], v[76:77]
    v_pk_fma_f32 v[70:71], v[70:71], v[166:167], v[78:79]
    v_cvt_pk_bf16_f32 v32, v64, v65
    v_cvt_pk_bf16_f32 v33, v66, v67
    v_cvt_pk_bf16_f32 v34, v68, v69
    v_cvt_pk_bf16_f32 v35, v70, v71
    v_lshlrev_b32 v64, 16, v32
    v_and_b32 v65, 0xffff0000, v32
    v_lshlrev_b32 v66, 16, v33
    v_and_b32 v67, 0xffff0000, v33
    v_lshlrev_b32 v68, 16, v34
    v_and_b32 v69, 0xffff0000, v34
    v_lshlrev_b32 v70, 16, v35
    v_and_b32 v71, 0xffff0000, v35
    v_pk_add_f32 v[48:49], v[64:65], v[66:67]
    v_pk_add_f32 v[50:51], v[68:69], v[70:71]
    v_pk_add_f32 v[48:49], v[48:49], v[50:51]
    v_add_f32 v48, v48, v49
    s_nop 1
    v_add_f32_dpp v48, v48, v48 quad_perm:[1,0,3,2] row_mask:0xf bank_mask:0xf
    s_nop 1
    v_add_f32_dpp v48, v48, v48 quad_perm:[2,3,0,1] row_mask:0xf bank_mask:0xf
    s_nop 1
    v_add_f32_dpp v48, v48, v48 row_half_mirror row_mask:0xf bank_mask:0xf
    s_nop 1
    v_add_f32_dpp v48, v48, v48 row_mirror row_mask:0xf bank_mask:0xf
    v_mov_b32 v49, v48
    s_nop 1
    v_permlane16_swap_b32 v48, v49
    v_add_f32 v48, v48, v49
    v_mov_b32 v49, v48
    s_nop 1
    v_permlane32_swap_b32 v48, v49
    v_add_f32 v48, v48, v49
    v_mul_f32 v48, 0xbb000000, v48
    v_pk_add_f32 v[72:73], v[64:65], v[48:49] op_sel_hi:[1,0]
    v_pk_add_f32 v[74:75], v[66:67], v[48:49] op_sel_hi:[1,0]
    v_pk_add_f32 v[76:77], v[68:69], v[48:49] op_sel_hi:[1,0]
    v_pk_add_f32 v[78:79], v[70:71], v[48:49] op_sel_hi:[1,0]
    v_pk_mul_f32 v[50:51], v[72:73], v[72:73]
    v_pk_mul_f32 v[52:53], v[72:73], v[8:9]
    v_pk_fma_f32 v[50:51], v[74:75], v[74:75], v[50:51]
    v_pk_fma_f32 v[52:53], v[74:75], v[10:11], v[52:53]
    v_pk_fma_f32 v[50:51], v[76:77], v[76:77], v[50:51]
    v_pk_fma_f32 v[52:53], v[76:77], v[12:13], v[52:53]
    v_pk_fma_f32 v[50:51], v[78:79], v[78:79], v[50:51]
    v_pk_fma_f32 v[52:53], v[78:79], v[14:15], v[52:53]
    v_add_f32 v50, v50, v51
    v_add_f32 v52, v52, v53
    s_nop 0
    v_add_f32_dpp v50, v50, v50 quad_perm:[1,0,3,2] row_mask:0xf bank_mask:0xf
    v_add_f32_dpp v52, v52, v52 quad_perm:[1,0,3,2] row_mask:0xf bank_mask:0xf
    s_nop 0
    v_add_f32_dpp v50, v50, v50 quad_perm:[2,3,0,1] row_mask:0xf bank_mask:0xf
    v_add_f32_dpp v52, v52, v52 quad_perm:[2,3,0,1] row_mask:0xf bank_mask:0xf
    s_nop 0
    v_add_f32_dpp v50, v50, v50 row_half_mirror row_mask:0xf bank_mask:0xf
    v_add_f32_dpp v52, v52, v52 row_half_mirror row_mask:0xf bank_mask:0xf
    s_nop 0
    v_add_f32_dpp v50, v50, v50 row_mirror row_mask:0xf bank_mask:0xf
    v_add_f32_dpp v52, v52, v52 row_mirror row_mask:0xf bank_mask:0xf
    v_mov_b32 v51, v50
    v_mov_b32 v53, v52
    s_nop 0
    v_permlane16_swap_b32 v50, v51
    v_permlane16_swap_b32 v52, v53
    v_add_f32 v50, v50, v51
    v_add_f32 v52, v52, v53
    v_mov_b32 v51, v50
    v_mov_b32 v53, v52
    s_nop 0
    v_permlane32_swap_b32 v50, v51
    v_permlane32_swap_b32 v52, v53
    v_add_f32 v50, v50, v51
    v_add_f32 v52, v52, v53
    v_mov_b32 v48, 0x3727c5ac
    v_fmac_f32 v48, 0x3b000000, v50
    v_rsq_f32 v48, v48
    s_nop 0
    v_fma_f32 v52, v52, v48, v16
    v_ashrrev_i32 v53, 31, v52
    v_or_b32 v53, 0x80000000, v53
    v_xor_b32 v53, v53, v52
    v_and_b32 v53, 0xfffff800, v53
    v_or_b32 v17, s68, v53
    v_pk_mul_f32 v[72:73], v[72:73], v[48:49] op_sel_hi:[1,0]
    v_pk_mul_f32 v[74:75], v[74:75], v[48:49] op_sel_hi:[1,0]
    v_pk_mul_f32 v[76:77], v[76:77], v[48:49] op_sel_hi:[1,0]
    v_pk_mul_f32 v[78:79], v[78:79], v[48:49] op_sel_hi:[1,0]
    v_pk_fma_f32 v[72:73], v[72:73], v[168:169], v[176:177]
    v_pk_fma_f32 v[74:75], v[74:75], v[170:171], v[178:179]
    v_pk_fma_f32 v[76:77], v[76:77], v[172:173], v[180:181]
    v_pk_fma_f32 v[78:79], v[78:79], v[174:175], v[182:183]
    v_cvt_pk_bf16_f32 v20, v72, v73
    v_cvt_pk_bf16_f32 v21, v74, v75
    v_cvt_pk_bf16_f32 v22, v76, v77
    v_cvt_pk_bf16_f32 v23, v78, v79
    v_lshlrev_b32 v98, 4, v0
    v_cmp_gt_u32 vcc, 224, v0
    v_mov_b32 v99, 2147479552
    s_nop 0
    v_cndmask_b32 v99, v99, v98, vcc
    s_lshl_b32 s17, s66, 13
    s_add_u32 s17, s17, 4194304
    s_cmp_lt_u32 s66, 224
    s_cselect_b32 s17, s17, 2143285248
    s_lshl_b32 s100, s3, 2
    v_mov_b32 v47, s100
    v_mov_b32 v102, 0
    s_lshl_b32 s100, s2, 6
    s_add_u32 s100, s100, 65536
    s_lshl_b32 s101, s2, 11
    s_add_u32 s101, s101, 524288
    s_branch L_pg_21
.p2align 12
L_pg_21:
L_op_join:
    s_mov_b32 s99, 0
L_P2_l_22:
    s_waitcnt vmcnt(0)
    v_max_u32 v48, v192, v193
    v_max3_u32 v48, v48, v194, v195
    v_max_u32 v49, v196, v197
    v_max3_u32 v49, v49, v198, v199
    v_max_u32 v50, v200, v201
    v_max3_u32 v50, v50, v202, v203
    v_max_u32 v51, v204, v205
    v_max3_u32 v51, v51, v206, v207
    v_max_u32 v52, v208, v209
    v_max3_u32 v52, v52, v210, v211
    v_max_u32 v53, v212, v213
    v_max3_u32 v53, v53, v214, v215
    v_max_u32 v54, v216, v217
    v_max3_u32 v54, v54, v218, v219
    v_max_u32 v55, v220, v221
    v_max3_u32 v55, v55, v222, v223
    v_max3_u32 v3, v48, v49, v50
    v_max3_u32 v3, v3, v51, v52
    v_max3_u32 v3, v3, v53, v54
    v_max_u32 v3, v3, v55
    v_cmp_eq_u32 vcc, -1, v3
    s_add_u32 s99, s99, 1
    s_cbranch_vccz L_P2_ok_23
    s_cmp_ge_u32 s99, 200000
    s_cbranch_scc1 L_P2_ok_23
    s_sleep 1
    v_cmp_eq_u32 vcc, -1, v48
    s_cbranch_vccz L_P2_s_24
    s_and_b64 s[96:97], vcc, s[12:13]
    s_cselect_b64 exec, s[96:97], vcc
    s_add_u32 s74, s70, 8388608
    buffer_load_dwordx4 v[192:195], v44, s[8:11], s74 offen sc0 sc1
    s_mov_b64 exec, -1
L_P2_s_24:
    v_cmp_eq_u32 vcc, -1, v49
    s_cbranch_vccz L_P2_s_25
    s_and_b64 s[96:97], vcc, s[12:13]
    s_cselect_b64 exec, s[96:97], vcc
    s_add_u32 s74, s70, 8392704
    buffer_load_dwordx4 v[196:199], v44, s[8:11], s74 offen sc0 sc1
    s_mov_b64 exec, -1
L_P2_s_25:
    v_cmp_eq_u32 vcc, -1, v50
    s_cbranch_vccz L_P2_s_26
    s_and_b64 s[96:97], vcc, s[12:13]
    s_cselect_b64 exec, s[96:97], vcc
    s_add_u32 s74, s70, 8396800
    buffer_load_dwordx4 v[200:203], v44, s[8:11], s74 offen sc0 sc1
    s_mov_b64 exec, -1
L_P2_s_26:
    v_cmp_eq_u32 vcc, -1, v51
    s_cbranch_vccz L_P2_s_27
    s_and_b64 s[96:97], vcc, s[12:13]
    s_cselect_b64 exec, s[96:97], vcc
    s_add_u32 s74, s70, 8400896
    buffer_load_dwordx4 v[204:207], v44, s[8:11], s74 offen sc0 sc1
    s_mov_b64 exec, -1
L_P2_s_27:
    v_cmp_eq_u32 vcc, -1, v52
    s_cbranch_vccz L_P2_s_28
    s_and_b64 s[96:97], vcc, s[12:13]
    s_cselect_b64 exec, s[96:97], vcc
    s_add_u32 s74, s70, 8404992
    buffer_load_dwordx4 v[208:211], v44, s[8:11], s74 offen sc0 sc1
    s_mov_b64 exec, -1
L_P2_s_28:
    v_cmp_eq_u32 vcc, -1, v53
    s_cbranch_vccz L_P2_s_29
    s_and_b64 s[96:97], vcc, s[12:13]
    s_cselect_b64 exec, s[96:97], vcc
    s_add_u32 s74, s70, 8409088
    buffer_load_dwordx4 v[212:215], v44, s[8:11], s74 offen sc0 sc1
    s_mov_b64 exec, -1
L_P2_s_29:
    v_cmp_eq_u32 vcc, -1, v54
    s_cbranch_vccz L_P2_s_30
    s_and_b64 s[96:97], vcc, s[12:13]
    s_cselect_b64 exec, s[96:97], vcc
    s_add_u32 s74, s70, 8413184
    buffer_load_dwordx4 v[216:219], v44, s[8:11], s74 offen sc0 sc1
    s_mov_b64 exec, -1
L_P2_s_30:
    v_cmp_eq_u32 vcc, -1, v55
    s_cbranch_vccz L_P2_s_31
    s_and_b64 s[96:97], vcc, s[12:13]
    s_cselect_b64 exec, s[96:97], vcc
    s_add_u32 s74, s70, 8417280
    buffer_load_dwordx4 v[220:223], v44, s[8:11], s74 offen sc0 sc1
    s_mov_b64 exec, -1
L_P2_s_31:
    s_branch L_P2_l_22
L_P2_ok_23:
    v_lshlrev_b32 v80, 16, v192
    v_and_b32 v81, 0xffff0000, v192
    v_lshlrev_b32 v82, 16, v193
    v_and_b32 v83, 0xffff0000, v193
    v_lshlrev_b32 v84, 16, v194
    v_and_b32 v85, 0xffff0000, v194
    v_lshlrev_b32 v86, 16, v195
    v_and_b32 v87, 0xffff0000, v195
    v_dot2c_f32_bf16 v80, v196, v100
    v_dot2c_f32_bf16 v81, v196, v101
    v_dot2c_f32_bf16 v82, v197, v100
    v_dot2c_f32_bf16 v83, v197, v101
    v_dot2c_f32_bf16 v84, v198, v100
    v_dot2c_f32_bf16 v85, v198, v101
    v_dot2c_f32_bf16 v86, v199, v100
    v_dot2c_f32_bf16 v87, v199, v101
    v_dot2c_f32_bf16 v80, v200, v100
    v_dot2c_f32_bf16 v81, v200, v101
    v_dot2c_f32_bf16 v82, v201, v100
    v_dot2c_f32_bf16 v83, v201, v101
    v_dot2c_f32_bf16 v84, v202, v100
    v_dot2c_f32_bf16 v85, v202, v101
    v_dot2c_f32_bf16 v86, v203, v100
    v_dot2c_f32_bf16 v87, v203, v101
    v_dot2c_f32_bf16 v80, v204, v100
    v_dot2c_f32_bf16 v81, v204, v101
    v_dot2c_f32_bf16 v82, v205, v100
    v_dot2c_f32_bf16 v83, v205, v101
    v_dot2c_f32_bf16 v84, v206, v100
    v_dot2c_f32_bf16 v85, v206, v101
    v_dot2c_f32_bf16 v86, v207, v100
    v_dot2c_f32_bf16 v87, v207, v101
    v_dot2c_f32_bf16 v80, v208, v100
    v_dot2c_f32_bf16 v81, v208, v101
    v_dot2c_f32_bf16 v82, v209, v100
    v_dot2c_f32_bf16 v83, v209, v101
    v_dot2c_f32_bf16 v84, v210, v100
    v_dot2c_f32_bf16 v85, v210, v101
    v_dot2c_f32_bf16 v86, v211, v100
    v_dot2c_f32_bf16 v87, v211, v101
    v_dot2c_f32_bf16 v80, v212, v100
    v_dot2c_f32_bf16 v81, v212, v101
    v_dot2c_f32_bf16 v82, v213, v100
    v_dot2c_f32_bf16 v83, v213, v101
    v_dot2c_f32_bf16 v84, v214, v100
    v_dot2c_f32_bf16 v85, v214, v101
    v_dot2c_f32_bf16 v86, v215, v100
    v_dot2c_f32_bf16 v87, v215, v101
    v_dot2c_f32_bf16 v80, v216, v100
    v_dot2c_f32_bf16 v81, v216, v101
    v_dot2c_f32_bf16 v82, v217, v100
    v_dot2c_f32_bf16 v83, v217, v101
    v_dot2c_f32_bf16 v84, v218, v100
    v_dot2c_f32_bf16 v85, v218, v101
    v_dot2c_f32_bf16 v86, v219, v100
    v_dot2c_f32_bf16 v87, v219, v101
    v_dot2c_f32_bf16 v80, v220, v100
    v_dot2c_f32_bf16 v81, v220, v101
    v_dot2c_f32_bf16 v82, v221, v100
    v_dot2c_f32_bf16 v83, v221, v101
    v_dot2c_f32_bf16 v84, v222, v100
    v_dot2c_f32_bf16 v85, v222, v101
    v_dot2c_f32_bf16 v86, v223, v100
    v_dot2c_f32_bf16 v87, v223, v101
    v_pk_fma_f32 v[80:81], v[80:81], v[160:161], v[88:89]
    v_pk_fma_f32 v[82:83], v[82:83], v[162:163], v[90:91]
    v_pk_fma_f32 v[84:85], v[84:85], v[164:165], v[92:93]
    v_pk_fma_f32 v[86:87], v[86:87], v[166:167], v[94:95]
    v_cvt_pk_bf16_f32 v36, v80, v81
    v_cvt_pk_bf16_f32 v37, v82, v83
    v_cvt_pk_bf16_f32 v38, v84, v85
    v_cvt_pk_bf16_f32 v39, v86, v87
    v_lshlrev_b32 v80, 16, v36
    v_and_b32 v81, 0xffff0000, v36
    v_lshlrev_b32 v82, 16, v37
    v_and_b32 v83, 0xffff0000, v37
    v_lshlrev_b32 v84, 16, v38
    v_and_b32 v85, 0xffff0000, v38
    v_lshlrev_b32 v86, 16, v39
    v_and_b32 v87, 0xffff0000, v39
    v_pk_add_f32 v[48:49], v[80:81], v[82:83]
    v_pk_add_f32 v[50:51], v[84:85], v[86:87]
    v_pk_add_f32 v[48:49], v[48:49], v[50:51]
    v_add_f32 v48, v48, v49
    s_nop 1
    v_add_f32_dpp v48, v48, v48 quad_perm:[1,0,3,2] row_mask:0xf bank_mask:0xf
    s_nop 1
    v_add_f32_dpp v48, v48, v48 quad_perm:[2,3,0,1] row_mask:0xf bank_mask:0xf
    s_nop 1
    v_add_f32_dpp v48, v48, v48 row_half_mirror row_mask:0xf bank_mask:0xf
    s_nop 1
    v_add_f32_dpp v48, v48, v48 row_mirror row_mask:0xf bank_mask:0xf
    v_mov_b32 v49, v48
    s_nop 1
    v_permlane16_swap_b32 v48, v49
    v_add_f32 v48, v48, v49
    v_mov_b32 v49, v48
    s_nop 1
    v_permlane32_swap_b32 v48, v49
    v_add_f32 v48, v48, v49
    v_mul_f32 v48, 0xbb000000, v48
    v_pk_add_f32 v[88:89], v[80:81], v[48:49] op_sel_hi:[1,0]
    v_pk_add_f32 v[90:91], v[82:83], v[48:49] op_sel_hi:[1,0]
    v_pk_add_f32 v[92:93], v[84:85], v[48:49] op_sel_hi:[1,0]
    v_pk_add_f32 v[94:95], v[86:87], v[48:49] op_sel_hi:[1,0]
    v_pk_mul_f32 v[50:51], v[88:89], v[88:89]
    v_pk_mul_f32 v[52:53], v[88:89], v[8:9]
    v_pk_fma_f32 v[50:51], v[90:91], v[90:91], v[50:51]
    v_pk_fma_f32 v[52:53], v[90:91], v[10:11], v[52:53]
    v_pk_fma_f32 v[50:51], v[92:93], v[92:93], v[50:51]
    v_pk_fma_f32 v[52:53], v[92:93], v[12:13], v[52:53]
    v_pk_fma_f32 v[50:51], v[94:95], v[94:95], v[50:51]
    v_pk_fma_f32 v[52:53], v[94:95], v[14:15], v[52:53]
    v_add_f32 v50, v50, v51
    v_add_f32 v52, v52, v53
    s_nop 0
    v_add_f32_dpp v50, v50, v50 quad_perm:[1,0,3,2] row_mask:0xf bank_mask:0xf
    v_add_f32_dpp v52, v52, v52 quad_perm:[1,0,3,2] row_mask:0xf bank_mask:0xf
    s_nop 0
    v_add_f32_dpp v50, v50, v50 quad_perm:[2,3,0,1] row_mask:0xf bank_mask:0xf
    v_add_f32_dpp v52, v52, v52 quad_perm:[2,3,0,1] row_mask:0xf bank_mask:0xf
    s_nop 0
    v_add_f32_dpp v50, v50, v50 row_half_mirror row_mask:0xf bank_mask:0xf
    v_add_f32_dpp v52, v52, v52 row_half_mirror row_mask:0xf bank_mask:0xf
    s_nop 0
    v_add_f32_dpp v50, v50, v50 row_mirror row_mask:0xf bank_mask:0xf
    v_add_f32_dpp v52, v52, v52 row_mirror row_mask:0xf bank_mask:0xf
    v_mov_b32 v51, v50
    v_mov_b32 v53, v52
    s_nop 0
    v_permlane16_swap_b32 v50, v51
    v_permlane16_swap_b32 v52, v53
    v_add_f32 v50, v50, v51
    v_add_f32 v52, v52, v53
    v_mov_b32 v51, v50
    v_mov_b32 v53, v52
    s_nop 0
    v_permlane32_swap_b32 v50, v51
    v_permlane32_swap_b32 v52, v53
    v_add_f32 v50, v50, v51
    v_add_f32 v52, v52, v53
    v_mov_b32 v48, 0x3727c5ac
    v_fmac_f32 v48, 0x3b000000, v50
    v_rsq_f32 v48, v48
    s_nop 0
    v_fma_f32 v52, v52, v48, v16
    v_ashrrev_i32 v53, 31, v52
    v_or_b32 v53, 0x80000000, v53
    v_xor_b32 v53, v53, v52
    v_and_b32 v53, 0xfffff800, v53
    v_or_b32 v18, s69, v53
    v_max3_u32 v19, v17, v18, 1
    ds_write_b32 v47, v19
    s_waitcnt lgkmcnt(0)
    s_barrier
    ds_read_b128 v[52:55], v102
    v_pk_mul_f32 v[88:89], v[88:89], v[48:49] op_sel_hi:[1,0]
    v_pk_mul_f32 v[90:91], v[90:91], v[48:49] op_sel_hi:[1,0]
    v_pk_mul_f32 v[92:93], v[92:93], v[48:49] op_sel_hi:[1,0]
    v_pk_mul_f32 v[94:95], v[94:95], v[48:49] op_sel_hi:[1,0]
    v_pk_fma_f32 v[88:89], v[88:89], v[168:169], v[176:177]
    v_pk_fma_f32 v[90:91], v[90:91], v[170:171], v[178:179]
    v_pk_fma_f32 v[92:93], v[92:93], v[172:173], v[180:181]
    v_pk_fma_f32 v[94:95], v[94:95], v[174:175], v[182:183]
    v_cvt_pk_bf16_f32 v24, v88, v89
    v_cvt_pk_bf16_f32 v25, v90, v91
    v_cvt_pk_bf16_f32 v26, v92, v93
    v_cvt_pk_bf16_f32 v27, v94, v95
    s_waitcnt lgkmcnt(0)
    v_max_u32 v52, v52, v53
    v_max3_u32 v52, v52, v54, v55
    v_cmp_eq_u32 vcc, v52, v19
    s_cbranch_vccz L_notbest
    buffer_store_dword v19, v5, s[8:11], s100 offen sc0 sc1
    v_cmp_gt_u32 vcc, v17, v18
    s_nop 1
    v_cndmask_b32 v28, v24, v20, vcc
    v_cndmask_b32 v40, v36, v32, vcc
    v_cndmask_b32 v29, v25, v21, vcc
    v_cndmask_b32 v41, v37, v33, vcc
    v_cndmask_b32 v30, v26, v22, vcc
    v_cndmask_b32 v42, v38, v34, vcc
    v_cndmask_b32 v31, v27, v23, vcc
    v_cndmask_b32 v43, v39, v35, vcc
    v_min_u32 v28, -2, v28
    v_min_u32 v40, -2, v40
    v_min_u32 v29, -2, v29
    v_min_u32 v41, -2, v41
    v_min_u32 v30, -2, v30
    v_min_u32 v42, -2, v42
    v_min_u32 v31, -2, v31
    v_min_u32 v43, -2, v43
    buffer_store_dwordx4 v[28:31], v1, s[8:11], s101 offen sc0 sc1
    buffer_store_dwordx4 v[40:43], v1, s[8:11], s101 offen offset:1024 sc0 sc1
L_notbest:
    buffer_load_dwordx4 v[112:115], v98, s[8:11], s17 offen
    s_add_u32 s17, s17, 4096
    buffer_load_dwordx4 v[116:119], v98, s[8:11], s17 offen
    s_add_u32 s17, s17, 2093056
    buffer_load_dwordx4 v[120:123], v98, s[8:11], s17 offen
    s_add_u32 s17, s17, 4096
    buffer_load_dwordx4 v[124:127], v98, s[8:11], s17 offen
    s_mul_i32 s17, s67, 28672
    s_add_u32 s17, s17, 8388608
    s_cmp_lt_u32 s67, 64
    s_cselect_b32 s17, s17, 2143285248
    buffer_load_dwordx4 v[128:131], v99, s[8:11], s17 offen offset:0
    buffer_load_dwordx4 v[132:135], v99, s[8:11], s17 offen offset:3584
    s_add_u32 s17, s17, 7168
    buffer_load_dwordx4 v[136:139], v99, s[8:11], s17 offen offset:0
    buffer_load_dwordx4 v[140:143], v99, s[8:11], s17 offen offset:3584
    s_add_u32 s17, s17, 7168
    buffer_load_dwordx4 v[144:147], v99, s[8:11], s17 offen offset:0
    buffer_load_dwordx4 v[148:151], v99, s[8:11], s17 offen offset:3584
    s_add_u32 s17, s17, 7168
    buffer_load_dwordx4 v[152:155], v99, s[8:11], s17 offen offset:0
    buffer_load_dwordx4 v[156:159], v99, s[8:11], s17 offen offset:3584
    v_lshlrev_b32 v72, 16, v20
    v_and_b32 v73, 0xffff0000, v20
    v_lshlrev_b32 v74, 16, v21
    v_and_b32 v75, 0xffff0000, v21
    v_lshlrev_b32 v76, 16, v22
    v_and_b32 v77, 0xffff0000, v22
    v_lshlrev_b32 v78, 16, v23
    v_and_b32 v79, 0xffff0000, v23
    v_pk_mul_f32 v[72:73], v[72:73], v[184:185]
    v_pk_mul_f32 v[74:75], v[74:75], v[186:187]
    v_pk_mul_f32 v[76:77], v[76:77], v[188:189]
    v_pk_mul_f32 v[78:79], v[78:79], v[190:191]
    v_cvt_pk_bf16_f32 v56, v72, v73
    v_cvt_pk_bf16_f32 v57, v74, v75
    v_cvt_pk_bf16_f32 v58, v76, v77
    v_cvt_pk_bf16_f32 v59, v78, v79
    v_lshlrev_b32 v72, 16, v56
    v_and_b32 v73, 0xffff0000, v56
    v_lshlrev_b32 v74, 16, v57
    v_and_b32 v75, 0xffff0000, v57
    v_lshlrev_b32 v76, 16, v58
    v_and_b32 v77, 0xffff0000, v58
    v_lshlrev_b32 v78, 16, v59
    v_and_b32 v79, 0xffff0000, v59
    v_pk_add_f32 v[72:73], v[72:73], v[64:65]
    v_pk_add_f32 v[74:75], v[74:75], v[66:67]
    v_pk_add_f32 v[76:77], v[76:77], v[68:69]
    v_pk_add_f32 v[78:79], v[78:79], v[70:71]
    v_cvt_pk_bf16_f32 v56, v72, v73
    v_cvt_pk_bf16_f32 v57, v74, v75
    v_cvt_pk_bf16_f32 v58, v76, v77
    v_cvt_pk_bf16_f32 v59, v78, v79
    v_lshlrev_b32 v88, 16, v24
    v_and_b32 v89, 0xffff0000, v24
    v_lshlrev_b32 v90, 16, v25
    v_and_b32 v91, 0xffff0000, v25
    v_lshlrev_b32 v92, 16, v26
    v_and_b32 v93, 0xffff0000, v26
    v_lshlrev_b32 v94, 16, v27
    v_and_b32 v95, 0xffff0000, v27
    v_pk_mul_f32 v[88:89], v[88:89], v[184:185]
    v_pk_mul_f32 v[90:91], v[90:91], v[186:187]
    v_pk_mul_f32 v[92:93], v[92:93], v[188:189]
    v_pk_mul_f32 v[94:95], v[94:95], v[190:191]
    v_cvt_pk_bf16_f32 v60, v88, v89
    v_cvt_pk_bf16_f32 v61, v90, v91
    v_cvt_pk_bf16_f32 v62, v92, v93
    v_cvt_pk_bf16_f32 v63, v94, v95
    v_lshlrev_b32 v88, 16, v60
    v_and_b32 v89, 0xffff0000, v60
    v_lshlrev_b32 v90, 16, v61
    v_and_b32 v91, 0xffff0000, v61
    v_lshlrev_b32 v92, 16, v62
    v_and_b32 v93, 0xffff0000, v62
    v_lshlrev_b32 v94, 16, v63
    v_and_b32 v95, 0xffff0000, v63
    v_pk_add_f32 v[88:89], v[88:89], v[80:81]
    v_pk_add_f32 v[90:91], v[90:91], v[82:83]
    v_pk_add_f32 v[92:93], v[92:93], v[84:85]
    v_pk_add_f32 v[94:95], v[94:95], v[86:87]
    v_cvt_pk_bf16_f32 v60, v88, v89
    v_cvt_pk_bf16_f32 v61, v90, v91
    v_cvt_pk_bf16_f32 v62, v92, v93
    v_cvt_pk_bf16_f32 v63, v94, v95
    v_and_b32 v104, 1, v2
    v_cmp_eq_u32 vcc, 1, v104
    s_nop 1
    v_cndmask_b32 v104, v58, v56, vcc
    v_cndmask_b32 v105, v59, v57, vcc
    s_nop 0
    v_mov_b32_dpp v106, v104 quad_perm:[1,0,3,2] row_mask:0xf bank_mask:0xf
    v_mov_b32_dpp v107, v105 quad_perm:[1,0,3,2] row_mask:0xf bank_mask:0xf
    v_cndmask_b32 v56, v56, v106, vcc
    v_cndmask_b32 v57, v57, v107, vcc
    v_cndmask_b32 v58, v106, v58, vcc
    v_cndmask_b32 v59, v107, v59, vcc
    v_cndmask_b32 v104, v62, v60, vcc
    v_cndmask_b32 v105, v63, v61, vcc
    s_nop 0
    v_mov_b32_dpp v106, v104 quad_perm:[1,0,3,2] row_mask:0xf bank_mask:0xf
    v_mov_b32_dpp v107, v105 quad_perm:[1,0,3,2] row_mask:0xf bank_mask:0xf
    v_cndmask_b32 v60, v60, v106, vcc
    v_cndmask_b32 v61, v61, v107, vcc
    v_cndmask_b32 v62, v106, v62, vcc
    v_cndmask_b32 v63, v107, v63, vcc
    v_lshrrev_b32 v103, 2, v2
    v_lshlrev_b32 v103, 6, v103
    v_and_b32 v104, 1, v2
    v_lshl_add_u32 v103, v104, 5, v103
    v_and_b32 v104, 2, v2
    v_lshl_add_u32 v103, v104, 3, v103
    v_lshlrev_b32 v4, 6, v0
    s_mov_b32 s71, 65536
    s_mov_b32 s99, 0
    s_branch L_pg_32
.p2align 12
L_pg_32:
L_kl:
    buffer_load_dword v3, v4, s[8:11], s71 offen sc0 sc1
    s_add_u32 s99, s99, 1
    s_waitcnt vmcnt(0)
    v_cmp_eq_u32 vcc, 0, v3
    s_cbranch_vccz L_kd
    s_cmp_ge_u32 s99, 200000
    s_cbranch_scc1 L_kd
    s_mov_b64 exec, vcc
    s_sleep 2
    s_branch L_kl
L_kd:
    s_mov_b64 exec, -1
    v_max_u32_dpp v3, v3, v3 quad_perm:[1,0,3,2] row_mask:0xf bank_mask:0xf
    s_nop 1
    v_max_u32_dpp v3, v3, v3 quad_perm:[2,3,0,1] row_mask:0xf bank_mask:0xf
    s_nop 1
    v_max_u32_dpp v3, v3, v3 row_half_mirror row_mask:0xf bank_mask:0xf
    s_nop 1
    v_max_u32_dpp v3, v3, v3 row_mirror row_mask:0xf bank_mask:0xf
    v_mov_b32 v19, v3
    s_nop 1
    v_permlane16_swap_b32 v3, v19
    v_max_u32 v3, v3, v19
    v_mov_b32 v19, v3
    s_nop 1
    v_permlane32_swap_b32 v3, v19
    v_max_u32 v3, v3, v19
    ds_write_b32 v47, v3 offset:64
    s_waitcnt lgkmcnt(0)
    s_barrier
    ds_read_b128 v[52:55], v102 offset:64
    v_lshlrev_b32 v4, 2, v0
    s_waitcnt lgkmcnt(0)
    v_max_u32 v52, v52, v53
    v_max3_u32 v52, v52, v54, v55
    s_nop 0
    v_readfirstlane_b32 s71, v52
    s_and_b32 s72, s71, 2047
    s_lshr_b32 s100, s72, 7
    s_sub_u32 s101, 15, s100
    s_min_u32 s100, s100, s101
    s_lshl_b32 s100, s100, 16
    s_and_b32 s101, s72, 1024
    s_cmp_eq_u32 s101, 0
    s_cselect_b32 s73, 31, 31
    s_lshr_b32 s101, s72, 2
    s_and_b32 s73, s73, s101
    s_lshl_b32 s73, s73, 2
    s_lshl_b32 s73, s73, 9
    s_add_u32 s73, s73, s100
    s_add_u32 s73, s73, 524288
    buffer_load_dword v19, v4, s[8:11], s73 offen sc0 sc1
    s_lshl_b32 s100, s68, 10
    s_cmp_eq_u32 s68, s72
    s_cselect_b32 s100, 2147479552, s100
    buffer_store_dwordx4 v[56:59], v103, s[52:55], s100 offen sc1
    s_lshl_b32 s100, s69, 10
    s_cmp_eq_u32 s69, s72
    s_cselect_b32 s100, 2147479552, s100
    buffer_store_dwordx4 v[60:63], v103, s[52:55], s100 offen sc1
    s_cmp_ge_u32 s66, 224
    s_cbranch_scc1 L_nprod
    v_lshlrev_b32 v160, 16, v112
    v_and_b32 v161, 0xffff0000, v112
    v_lshlrev_b32 v162, 16, v113
    v_and_b32 v163, 0xffff0000, v113
    v_lshlrev_b32 v164, 16, v114
    v_and_b32 v165, 0xffff0000, v114
    v_lshlrev_b32 v166, 16, v115
    v_and_b32 v167, 0xffff0000, v115
    v_lshlrev_b32 v168, 16, v116
    v_and_b32 v169, 0xffff0000, v116
    v_lshlrev_b32 v170, 16, v117
    v_and_b32 v171, 0xffff0000, v117
    v_lshlrev_b32 v172, 16, v118
    v_and_b32 v173, 0xffff0000, v118
    v_lshlrev_b32 v174, 16, v119
    v_and_b32 v175, 0xffff0000, v119
    v_lshlrev_b32 v176, 16, v120
    v_and_b32 v177, 0xffff0000, v120
    v_lshlrev_b32 v178, 16, v121
    v_and_b32 v179, 0xffff0000, v121
    v_lshlrev_b32 v180, 16, v122
    v_and_b32 v181, 0xffff0000, v122
    v_lshlrev_b32 v182, 16, v123
    v_and_b32 v183, 0xffff0000, v123
    v_lshlrev_b32 v184, 16, v124
    v_and_b32 v185, 0xffff0000, v124
    v_lshlrev_b32 v186, 16, v125
    v_and_b32 v187, 0xffff0000, v125
    v_lshlrev_b32 v188, 16, v126
    v_and_b32 v189, 0xffff0000, v126
    v_lshlrev_b32 v190, 16, v127
    v_and_b32 v191, 0xffff0000, v127
    s_mov_b32 s99, 0
    s_waitcnt vmcnt(2)
L_hl:
    v_cmp_eq_u32 vcc, -1, v19
    s_add_u32 s99, s99, 1
    s_cbranch_vccz L_hok
    s_cmp_ge_u32 s99, 200000
    s_cbranch_scc1 L_hok
    buffer_load_dword v19, v4, s[8:11], s73 offen sc0 sc1
    s_waitcnt vmcnt(0)
    s_branch L_hl
L_hok:
    v_lshlrev_b32 v48, 16, v19
    v_and_b32 v50, 0xffff0000, v19
    v_pk_mul_f32 v[64:65], v[160:161], v[48:49] op_sel_hi:[1,0]
    v_pk_mul_f32 v[66:67], v[162:163], v[48:49] op_sel_hi:[1,0]
    v_pk_mul_f32 v[68:69], v[164:165], v[48:49] op_sel_hi:[1,0]
    v_pk_mul_f32 v[70:71], v[166:167], v[48:49] op_sel_hi:[1,0]
    v_pk_mul_f32 v[72:73], v[176:177], v[48:49] op_sel_hi:[1,0]
    v_pk_mul_f32 v[74:75], v[178:179], v[48:49] op_sel_hi:[1,0]
    v_pk_mul_f32 v[76:77], v[180:181], v[48:49] op_sel_hi:[1,0]
    v_pk_mul_f32 v[78:79], v[182:183], v[48:49] op_sel_hi:[1,0]
    v_pk_fma_f32 v[64:65], v[168:169], v[50:51], v[64:65] op_sel_hi:[1,0,1]
    v_pk_fma_f32 v[66:67], v[170:171], v[50:51], v[66:67] op_sel_hi:[1,0,1]
    v_pk_fma_f32 v[68:69], v[172:173], v[50:51], v[68:69] op_sel_hi:[1,0,1]
    v_pk_fma_f32 v[70:71], v[174:175], v[50:51], v[70:71] op_sel_hi:[1,0,1]
    v_pk_fma_f32 v[72:73], v[184:185], v[50:51], v[72:73] op_sel_hi:[1,0,1]
    v_pk_fma_f32 v[74:75], v[186:187], v[50:51], v[74:75] op_sel_hi:[1,0,1]
    v_pk_fma_f32 v[76:77], v[188:189], v[50:51], v[76:77] op_sel_hi:[1,0,1]
    v_pk_fma_f32 v[78:79], v[190:191], v[50:51], v[78:79] op_sel_hi:[1,0,1]
    v_permlane32_swap_b32 v64, v72
    v_permlane32_swap_b32 v65, v73
    v_permlane32_swap_b32 v66, v74
    v_permlane32_swap_b32 v67, v75
    v_permlane32_swap_b32 v68, v76
    v_permlane32_swap_b32 v69, v77
    v_permlane32_swap_b32 v70, v78
    v_permlane32_swap_b32 v71, v79
    v_add_f32 v64, v64, v72
    v_add_f32 v65, v65, v73
    v_add_f32 v66, v66, v74
    v_add_f32 v67, v67, v75
    v_add_f32 v68, v68, v76
    v_add_f32 v69, v69, v77
    v_add_f32 v70, v70, v78
    v_add_f32 v71, v71, v79
    v_permlane16_swap_b32 v64, v68
    v_permlane16_swap_b32 v65, v69
    v_permlane16_swap_b32 v66, v70
    v_permlane16_swap_b32 v67, v71
    v_add_f32 v64, v64, v68
    v_add_f32 v65, v65, v69
    v_add_f32 v66, v66, v70
    v_add_f32 v67, v67, v71
    v_add_f32_dpp v64, v64, v64 quad_perm:[1,0,3,2] row_mask:0xf bank_mask:0xf
    v_add_f32_dpp v65, v65, v65 quad_perm:[1,0,3,2] row_mask:0xf bank_mask:0xf
    v_add_f32_dpp v66, v66, v66 quad_perm:[1,0,3,2] row_mask:0xf bank_mask:0xf
    v_add_f32_dpp v67, v67, v67 quad_perm:[1,0,3,2] row_mask:0xf bank_mask:0xf
    v_add_f32_dpp v64, v64, v64 quad_perm:[2,3,0,1] row_mask:0xf bank_mask:0xf
    v_add_f32_dpp v65, v65, v65 quad_perm:[2,3,0,1] row_mask:0xf bank_mask:0xf
    v_add_f32_dpp v66, v66, v66 quad_perm:[2,3,0,1] row_mask:0xf bank_mask:0xf
    v_add_f32_dpp v67, v67, v67 quad_perm:[2,3,0,1] row_mask:0xf bank_mask:0xf
    v_add_f32_dpp v64, v64, v64 row_half_mirror row_mask:0xf bank_mask:0xf
    v_add_f32_dpp v65, v65, v65 row_half_mirror row_mask:0xf bank_mask:0xf
    v_add_f32_dpp v66, v66, v66 row_half_mirror row_mask:0xf bank_mask:0xf
    v_add_f32_dpp v67, v67, v67 row_half_mirror row_mask:0xf bank_mask:0xf
    v_add_f32_dpp v64, v64, v64 row_mirror row_mask:0xf bank_mask:0xf
    v_add_f32_dpp v65, v65, v65 row_mirror row_mask:0xf bank_mask:0xf
    v_add_f32_dpp v66, v66, v66 row_mirror row_mask:0xf bank_mask:0xf
    v_add_f32_dpp v67, v67, v67 row_mirror row_mask:0xf bank_mask:0xf
    v_and_b32 v50, 15, v2
    v_cmp_eq_u32 vcc, 0, v50
    v_mov_b32 v51, 1024
    s_nop 0
    v_cndmask_b32 v51, v51, v0, vcc
    ds_write_b128 v51, v[64:67] offset:256
    v_lshlrev_b32 v50, 2, v50
    s_waitcnt lgkmcnt(0)
    s_barrier
    s_cmp_lg_u32 s3, 0
    s_cbranch_scc1 L_nprod
    ds_read_b32 v64, v50 offset:256
    ds_read_b32 v65, v50 offset:320
    ds_read_b32 v66, v50 offset:384
    ds_read_b32 v67, v50 offset:448
    v_cmp_gt_u32 vcc, 8, v2
    v_mov_b32 v51, 2147479552
    s_nop 0
    v_cndmask_b32 v51, v51, v50, vcc
    s_lshl_b32 s100, s66, 6
    s_add_u32 s100, s100, 81920
    s_waitcnt lgkmcnt(2)
    v_add_f32 v64, v64, v65
    s_waitcnt lgkmcnt(0)
    v_add_f32 v66, v66, v67
    v_add_f32 v64, v64, v66
    v_cvt_pk_bf16_f32 v64, v64, v64
    v_and_b32 v64, 0xffff0000, v64
    s_nop 1
    v_mov_b32_dpp v65, v64 row_ror:8 row_mask:0xf bank_mask:0xf
    v_mul_f32 v66, 0xbfb8aa3b, v64
    v_exp_f32 v66, v66
    s_nop 0
    v_add_f32 v66, 1.0, v66
    v_rcp_f32 v66, v66
    s_nop 0
    v_mul_f32 v64, v64, v66
    v_cvt_pk_bf16_f32 v64, v64, v64
    v_and_b32 v64, 0xffff0000, v64
    v_mul_f32 v64, v64, v65
    v_cvt_pk_bf16_f32 v64, v64, v64
    v_and_b32 v64, 0xffff0000, v64
    buffer_store_dword v64, v51, s[8:11], s100 offen sc0 sc1
L_nprod:
    s_cmp_ge_u32 s67, 64
    s_cbranch_scc1 L_fin
    v_lshlrev_b32 v4, 6, v0
    v_cmp_gt_u32 vcc, 224, v0
    v_mov_b32 v51, 2147479552
    s_nop 0
    v_cndmask_b32 v4, v51, v4, vcc
    s_mov_b32 s100, 81920
    v_and_b32 v52, 7, v2
    s_lshl_b32 s101, s67, 3
    v_add_u32 v52, s101, v52
    v_lshrrev_b32 v53, 5, v52
    v_lshlrev_b32 v53, 6, v53
    v_and_b32 v54, 12, v52
    v_lshl_add_u32 v53, v54, 2, v53
    v_bfe_u32 v54, v52, 4, 1
    v_lshl_add_u32 v53, v54, 3, v53
    v_and_b32 v54, 2, v52
    v_lshl_add_u32 v53, v54, 1, v53
    v_lshlrev_b32 v54, 2, v52
    s_mov_b32 s101, 10240
    buffer_load_dword v55, v54, s[8:11], s101 offen
    buffer_load_dword v88, v53, s[8:11], s73 offen sc0 sc1
    buffer_load_dword v89, v53, s[8:11], s73 offen offset:1024 sc0 sc1
    v_lshlrev_b32 v192, 16, v128
    v_and_b32 v193, 0xffff0000, v128
    v_lshlrev_b32 v194, 16, v129
    v_and_b32 v195, 0xffff0000, v129
    v_lshlrev_b32 v196, 16, v130
    v_and_b32 v197, 0xffff0000, v130
    v_lshlrev_b32 v198, 16, v131
    v_and_b32 v199, 0xffff0000, v131
    v_lshlrev_b32 v200, 16, v132
    v_and_b32 v201, 0xffff0000, v132
    v_lshlrev_b32 v202, 16, v133
    v_and_b32 v203, 0xffff0000, v133
    v_lshlrev_b32 v204, 16, v134
    v_and_b32 v205, 0xffff0000, v134
    v_lshlrev_b32 v206, 16, v135
    v_and_b32 v207, 0xffff0000, v135
    v_lshlrev_b32 v208, 16, v136
    v_and_b32 v209, 0xffff0000, v136
    v_lshlrev_b32 v210, 16, v137
    v_and_b32 v211, 0xffff0000, v137
    v_lshlrev_b32 v212, 16, v138
    v_and_b32 v213, 0xffff0000, v138
    v_lshlrev_b32 v214, 16, v139
    v_and_b32 v215, 0xffff0000, v139
    v_lshlrev_b32 v216, 16, v140
    v_and_b32 v217, 0xffff0000, v140
    v_lshlrev_b32 v218, 16, v141
    v_and_b32 v219, 0xffff0000, v141
    v_lshlrev_b32 v220, 16, v142
    v_and_b32 v221, 0xffff0000, v142
    v_lshlrev_b32 v222, 16, v143
    v_and_b32 v223, 0xffff0000, v143
    v_lshlrev_b32 v224, 16, v144
    v_and_b32 v225, 0xffff0000, v144
    v_lshlrev_b32 v226, 16, v145
    v_and_b32 v227, 0xffff0000, v145
    v_lshlrev_b32 v228, 16, v146
    v_and_b32 v229, 0xffff0000, v146
    v_lshlrev_b32 v230, 16, v147
    v_and_b32 v231, 0xffff0000, v147
    v_lshlrev_b32 v232, 16, v148
    v_and_b32 v233, 0xffff0000, v148
    v_lshlrev_b32 v234, 16, v149
    v_and_b32 v235, 0xffff0000, v149
    v_lshlrev_b32 v236, 16, v150
    v_and_b32 v237, 0xffff0000, v150
    v_lshlrev_b32 v238, 16, v151
    v_and_b32 v239, 0xffff0000, v151
    v_lshlrev_b32 v240, 16, v152
    v_and_b32 v241, 0xffff0000, v152
    v_lshlrev_b32 v242, 16, v153
    v_and_b32 v243, 0xffff0000, v153
    v_lshlrev_b32 v244, 16, v154
    v_and_b32 v245, 0xffff0000, v154
    v_lshlrev_b32 v246, 16, v155
    v_and_b32 v247, 0xffff0000, v155
    v_lshlrev_b32 v248, 16, v156
    v_and_b32 v249, 0xffff0000, v156
    v_lshlrev_b32 v250, 16, v157
    v_and_b32 v251, 0xffff0000, v157
    v_lshlrev_b32 v252, 16, v158
    v_and_b32 v253, 0xffff0000, v158
    v_lshlrev_b32 v254, 16, v159
    v_and_b32 v255, 0xffff0000, v159
    s_and_b32 s101, s71, 0xfffff800
    s_or_b32 s101, s101, 0x400
    v_mov_b32 v90, s101
    v_not_b32 v91, v90
    v_ashrrev_i32 v91, 31, v91
    v_or_b32 v91, 0x80000000, v91
    v_xor_b32 v90, v90, v91
    v_cvt_pk_bf16_f32 v90, v90, v90
    v_and_b32 v90, 0xffff0000, v90
    v_mul_f32 v90, 0xbfb8aa3b, v90
    v_exp_f32 v90, v90
    s_nop 0
    v_add_f32 v90, 1.0, v90
    v_rcp_f32 v90, v90
    s_nop 0
    v_cvt_pk_bf16_f32 v90, v90, v90
    v_and_b32 v90, 0xffff0000, v90
    s_mov_b32 s99, 0
L_CND_l_33:
    s_waitcnt vmcnt(0)
    v_max_u32 v3, v88, v89
    v_cmp_eq_u32 vcc, -1, v3
    s_add_u32 s99, s99, 1
    s_cbranch_vccz L_CND_ok_34
    s_cmp_ge_u32 s99, 200000
    s_cbranch_scc1 L_CND_ok_34
    s_mov_b64 exec, vcc
    s_sleep 1
    buffer_load_dword v88, v53, s[8:11], s73 offen sc0 sc1
    buffer_load_dword v89, v53, s[8:11], s73 offen offset:1024 sc0 sc1
    s_branch L_CND_l_33
L_CND_ok_34:
    s_mov_b64 exec, -1
    v_and_b32 v51, 1, v52
    v_cmp_eq_u32 vcc, 0, v51
    v_lshlrev_b32 v91, 16, v88
    v_and_b32 v88, 0xffff0000, v88
    v_cndmask_b32 v88, v88, v91, vcc
    v_lshlrev_b32 v91, 16, v89
    v_and_b32 v89, 0xffff0000, v89
    v_cndmask_b32 v89, v89, v91, vcc
    v_and_b32 v50, 15, v2
    v_cmp_eq_u32 vcc, 0, v50
    v_lshrrev_b32 v51, 1, v0
    v_mov_b32 v50, 1024
    v_cndmask_b32 v51, v50, v51, vcc
    v_and_b32 v50, 7, v2
    v_lshlrev_b32 v50, 2, v50
    v_cmp_gt_u32 vcc, 8, v2
    v_lshlrev_b32 v52, 1, v52
    v_mov_b32 v53, 2147479552
    v_cndmask_b32 v52, v53, v52, vcc
    s_cmp_lt_u32 s66, 224
    s_cbranch_scc1 L_asl
    s_sleep 16
L_asl:
    s_sleep 7
    buffer_load_dwordx4 v[80:83], v4, s[8:11], s100 offen sc0 sc1
    buffer_load_dwordx4 v[84:87], v4, s[8:11], s100 offen offset:16 sc0 sc1
    s_mov_b32 s99, 0
L_ACT_l_35:
    s_waitcnt vmcnt(0)
    v_max_u32 v3, v80, v81
    v_max3_u32 v3, v3, v82, v83
    v_max3_u32 v3, v3, v84, v85
    v_max3_u32 v3, v3, v86, v87
    v_cmp_eq_u32 vcc, -1, v3
    s_add_u32 s99, s99, 1
    s_cbranch_vccz L_ACT_ok_36
    s_cmp_ge_u32 s99, 200000
    s_cbranch_scc1 L_ACT_ok_36
    s_mov_b64 exec, vcc
    s_sleep 2
    buffer_load_dwordx4 v[80:83], v4, s[8:11], s100 offen sc0 sc1
    buffer_load_dwordx4 v[84:87], v4, s[8:11], s100 offen offset:16 sc0 sc1
    s_branch L_ACT_l_35
L_ACT_ok_36:
    s_mov_b64 exec, -1
    v_pk_mul_f32 v[64:65], v[192:193], v[80:81] op_sel_hi:[1,0]
    v_pk_mul_f32 v[66:67], v[194:195], v[80:81] op_sel_hi:[1,0]
    v_pk_mul_f32 v[68:69], v[196:197], v[80:81] op_sel_hi:[1,0]
    v_pk_mul_f32 v[70:71], v[198:199], v[80:81] op_sel_hi:[1,0]
    v_pk_fma_f32 v[64:65], v[200:201], v[80:81], v[64:65] op_sel:[0,1,0] op_sel_hi:[1,1,1]
    v_pk_fma_f32 v[66:67], v[202:203], v[80:81], v[66:67] op_sel:[0,1,0] op_sel_hi:[1,1,1]
    v_pk_fma_f32 v[68:69], v[204:205], v[80:81], v[68:69] op_sel:[0,1,0] op_sel_hi:[1,1,1]
    v_pk_fma_f32 v[70:71], v[206:207], v[80:81], v[70:71] op_sel:[0,1,0] op_sel_hi:[1,1,1]
    v_pk_fma_f32 v[64:65], v[208:209], v[82:83], v[64:65] op_sel:[0,0,0] op_sel_hi:[1,0,1]
    v_pk_fma_f32 v[66:67], v[210:211], v[82:83], v[66:67] op_sel:[0,0,0] op_sel_hi:[1,0,1]
    v_pk_fma_f32 v[68:69], v[212:213], v[82:83], v[68:69] op_sel:[0,0,0] op_sel_hi:[1,0,1]
    v_pk_fma_f32 v[70:71], v[214:215], v[82:83], v[70:71] op_sel:[0,0,0] op_sel_hi:[1,0,1]
    v_pk_fma_f32 v[64:65], v[216:217], v[82:83], v[64:65] op_sel:[0,1,0] op_sel_hi:[1,1,1]
    v_pk_fma_f32 v[66:67], v[218:219], v[82:83], v[66:67] op_sel:[0,1,0] op_sel_hi:[1,1,1]
    v_pk_fma_f32 v[68:69], v[220:221], v[82:83], v[68:69] op_sel:[0,1,0] op_sel_hi:[1,1,1]
    v_pk_fma_f32 v[70:71], v[222:223], v[82:83], v[70:71] op_sel:[0,1,0] op_sel_hi:[1,1,1]
    v_pk_fma_f32 v[64:65], v[224:225], v[84:85], v[64:65] op_sel:[0,0,0] op_sel_hi:[1,0,1]
    v_pk_fma_f32 v[66:67], v[226:227], v[84:85], v[66:67] op_sel:[0,0,0] op_sel_hi:[1,0,1]
    v_pk_fma_f32 v[68:69], v[228:229], v[84:85], v[68:69] op_sel:[0,0,0] op_sel_hi:[1,0,1]
    v_pk_fma_f32 v[70:71], v[230:231], v[84:85], v[70:71] op_sel:[0,0,0] op_sel_hi:[1,0,1]
    v_pk_fma_f32 v[64:65], v[232:233], v[84:85], v[64:65] op_sel:[0,1,0] op_sel_hi:[1,1,1]
    v_pk_fma_f32 v[66:67], v[234:235], v[84:85], v[66:67] op_sel:[0,1,0] op_sel_hi:[1,1,1]
    v_pk_fma_f32 v[68:69], v[236:237], v[84:85], v[68:69] op_sel:[0,1,0] op_sel_hi:[1,1,1]
    v_pk_fma_f32 v[70:71], v[238:239], v[84:85], v[70:71] op_sel:[0,1,0] op_sel_hi:[1,1,1]
    v_pk_fma_f32 v[64:65], v[240:241], v[86:87], v[64:65] op_sel:[0,0,0] op_sel_hi:[1,0,1]
    v_pk_fma_f32 v[66:67], v[242:243], v[86:87], v[66:67] op_sel:[0,0,0] op_sel_hi:[1,0,1]
    v_pk_fma_f32 v[68:69], v[244:245], v[86:87], v[68:69] op_sel:[0,0,0] op_sel_hi:[1,0,1]
    v_pk_fma_f32 v[70:71], v[246:247], v[86:87], v[70:71] op_sel:[0,0,0] op_sel_hi:[1,0,1]
    v_pk_fma_f32 v[64:65], v[248:249], v[86:87], v[64:65] op_sel:[0,1,0] op_sel_hi:[1,1,1]
    v_pk_fma_f32 v[66:67], v[250:251], v[86:87], v[66:67] op_sel:[0,1,0] op_sel_hi:[1,1,1]
    v_pk_fma_f32 v[68:69], v[252:253], v[86:87], v[68:69] op_sel:[0,1,0] op_sel_hi:[1,1,1]
    v_pk_fma_f32 v[70:71], v[254:255], v[86:87], v[70:71] op_sel:[0,1,0] op_sel_hi:[1,1,1]
    s_nop 0
    v_permlane32_swap_b32 v64, v68
    v_permlane32_swap_b32 v65, v69
    v_permlane32_swap_b32 v66, v70
    v_permlane32_swap_b32 v67, v71
    v_add_f32 v64, v64, v68
    v_add_f32 v65, v65, v69
    v_add_f32 v66, v66, v70
    v_add_f32 v67, v67, v71
    s_nop 0
    v_permlane16_swap_b32 v64, v66
    v_permlane16_swap_b32 v65, v67
    v_add_f32 v64, v64, v66
    v_add_f32 v65, v65, v67
    s_nop 0
    v_add_f32_dpp v64, v64, v64 quad_perm:[1,0,3,2] row_mask:0xf bank_mask:0xf
    v_add_f32_dpp v65, v65, v65 quad_perm:[1,0,3,2] row_mask:0xf bank_mask:0xf
    s_nop 0
    v_add_f32_dpp v64, v64, v64 quad_perm:[2,3,0,1] row_mask:0xf bank_mask:0xf
    v_add_f32_dpp v65, v65, v65 quad_perm:[2,3,0,1] row_mask:0xf bank_mask:0xf
    s_nop 0
    v_add_f32_dpp v64, v64, v64 row_half_mirror row_mask:0xf bank_mask:0xf
    v_add_f32_dpp v65, v65, v65 row_half_mirror row_mask:0xf bank_mask:0xf
    s_nop 0
    v_add_f32_dpp v64, v64, v64 row_mirror row_mask:0xf bank_mask:0xf
    v_add_f32_dpp v65, v65, v65 row_mirror row_mask:0xf bank_mask:0xf
    ds_write_b64 v51, v[64:65] offset:2048
    s_waitcnt lgkmcnt(0)
    s_barrier
    s_cmp_lg_u32 s3, 0
    s_cbranch_scc1 L_fin
    ds_read_b32 v64, v50 offset:2048
    ds_read_b32 v65, v50 offset:2080
    ds_read_b32 v66, v50 offset:2112
    ds_read_b32 v67, v50 offset:2144
    s_lshl_b32 s100, s72, 10
    s_waitcnt lgkmcnt(2)
    v_add_f32 v64, v64, v65
    s_waitcnt lgkmcnt(0)
    v_add_f32 v66, v66, v67
    v_add_f32 v64, v64, v66
    v_cvt_pk_bf16_f32 v64, v64, v64
    v_and_b32 v64, 0xffff0000, v64
    v_mul_f32 v64, v64, v90
    v_cvt_pk_bf16_f32 v64, v64, v64
    v_and_b32 v64, 0xffff0000, v64
    v_add_f32 v64, v64, v88
    v_cvt_pk_bf16_f32 v64, v64, v64
    v_and_b32 v64, 0xffff0000, v64
    v_mul_f32 v64, v64, v55
    v_cvt_pk_bf16_f32 v64, v64, v64
    v_and_b32 v64, 0xffff0000, v64
    v_add_f32 v64, v64, v89
    v_cvt_pk_bf16_f32 v64, v64, v64
    buffer_store_short v64, v52, s[52:55], s100 offen sc1
L_fin:
L_end:
    s_endpgm
L_E_slow_1:
    s_mov_b32 s99, 0
L_E_slow_1_l:
    s_sleep 20
    buffer_load_dword v3, v4, s[36:39], s67 offen sc0 sc1
    s_add_u32 s99, s99, 1
    s_waitcnt vmcnt(0)
    v_cmp_le_u32 vcc, s68, v3
    s_cmp_eq_u64 vcc, -1
    s_cbranch_scc1 L_E_ok_2
    s_cmp_lt_u32 s99, 200000
    s_cbranch_scc1 L_E_slow_1_l
    s_branch L_E_ok_2
L_H_slow_3:
    s_mov_b32 s99, 0
L_H_slow_3_l:
    s_sleep 4
    buffer_load_dword v3, v16, s[8:11], s78 offen sc0 sc1
    s_add_u32 s99, s99, 1
    s_waitcnt vmcnt(0)
    v_cmp_ne_u32 vcc, 0, v3
    s_cmp_eq_u64 vcc, -1
    s_cbranch_scc1 L_H_ok_4
    s_cmp_lt_u32 s99, 200000
    s_cbranch_scc1 L_H_slow_3_l
    s_branch L_H_ok_4
L_E2_slow_5:
    s_mov_b32 s99, 0
L_E2_slow_5_l:
    s_sleep 4
    buffer_load_dword v118, v119, s[8:11], s69 offen sc0 sc1
    s_add_u32 s99, s99, 1
    s_waitcnt vmcnt(0)
    v_cmp_ne_u32 vcc, 0, v118
    s_cmp_eq_u64 vcc, -1
    s_cbranch_scc1 L_E2_ok_6
    s_cmp_lt_u32 s99, 200000
    s_cbranch_scc1 L_E2_slow_5_l
    s_branch L_E2_ok_6
L_KV_slow_7:
    s_mov_b32 s99, 0
L_KV_slow_7_l:
    s_sleep 4
    buffer_load_dword v3, v17, s[8:11], s74 offen sc0 sc1
    s_add_u32 s99, s99, 1
    s_waitcnt vmcnt(0)
    v_cmp_ne_u32 vcc, 0, v3
    s_cmp_eq_u64 vcc, -1
    s_cbranch_scc1 L_KV_ok_8
    s_cmp_lt_u32 s99, 200000
    s_cbranch_scc1 L_KV_slow_7_l
    s_branch L_KV_ok_8
L_t1_start:
    v_mfma_f32_16x16x32_bf16 v[96:99], a[128:131], a[64:67], v[96:99]
    s_add_u32 s19, s82, 32768
    s_sub_u32 s82, s12, s13
    s_sub_u32 s82, s82, 1
    v_mfma_f32_16x16x32_bf16 v[96:99], a[132:135], a[68:71], v[96:99]
    s_cmp_gt_u32 s12, s13
    s_cselect_b32 s82, s82, s12
    s_mul_i32 s82, s82, 65536
    s_add_u32 s82, s82, s81
    v_mfma_f32_16x16x32_bf16 v[96:99], a[136:139], a[72:75], v[96:99]
    s_cmp_ge_u32 s12, 17
    s_cselect_b32 s82, 2147471360, s82
    s_add_u32 s12, s12, 1
    s_sub_u32 s14, s60, 1
    v_mfma_f32_16x16x32_bf16 v[96:99], a[140:143], a[76:79], v[96:99]
    v_mfma_f32_16x16x32_bf16 v[100:103], a[144:147], a[64:67], v[100:103]
    v_mfma_f32_16x16x32_bf16 v[100:103], a[148:151], a[68:71], v[100:103]
    v_mfma_f32_16x16x32_bf16 v[100:103], a[152:155], a[72:75], v[100:103]
    v_mfma_f32_16x16x32_bf16 v[100:103], a[156:159], a[76:79], v[100:103]
    v_mfma_f32_16x16x32_bf16 v[104:107], a[128:131], a[80:83], v[104:107]
    s_nop 2
    v_exp_f32 v96, v96
    v_mfma_f32_16x16x32_bf16 v[104:107], a[132:135], a[84:87], v[104:107]
    v_exp_f32 v97, v97
    v_mfma_f32_16x16x32_bf16 v[104:107], a[136:139], a[88:91], v[104:107]
    v_exp_f32 v98, v98
    v_mfma_f32_16x16x32_bf16 v[104:107], a[140:143], a[92:95], v[104:107]
    v_exp_f32 v99, v99
    v_mfma_f32_16x16x32_bf16 v[108:111], a[144:147], a[80:83], v[108:111]
    v_exp_f32 v100, v100
    v_mfma_f32_16x16x32_bf16 v[108:111], a[148:151], a[84:87], v[108:111]
    v_exp_f32 v101, v101
    v_mfma_f32_16x16x32_bf16 v[108:111], a[152:155], a[88:91], v[108:111]
    v_exp_f32 v102, v102
    v_mfma_f32_16x16x32_bf16 v[108:111], a[156:159], a[92:95], v[108:111]
    v_exp_f32 v103, v103
    v_mfma_f32_16x16x32_bf16 v[112:115], a[128:131], a[96:99], v[72:75]
    v_exp_f32 v104, v104
    v_mfma_f32_16x16x32_bf16 v[112:115], a[132:135], a[100:103], v[112:115]
    v_exp_f32 v105, v105
    v_mfma_f32_16x16x32_bf16 v[112:115], a[136:139], a[104:107], v[112:115]
    v_exp_f32 v106, v106
    v_mfma_f32_16x16x32_bf16 v[112:115], a[140:143], a[108:111], v[112:115]
    v_exp_f32 v107, v107
    v_mfma_f32_16x16x32_bf16 v[120:123], a[128:131], a[112:115], v[76:79]
    v_exp_f32 v108, v108
    v_mfma_f32_16x16x32_bf16 v[120:123], a[132:135], a[116:119], v[120:123]
    v_exp_f32 v109, v109
    v_mfma_f32_16x16x32_bf16 v[120:123], a[136:139], a[120:123], v[120:123]
    v_exp_f32 v110, v110
    v_mfma_f32_16x16x32_bf16 v[120:123], a[140:143], a[124:127], v[120:123]
    v_exp_f32 v111, v111
    v_mfma_f32_16x16x32_bf16 v[116:119], a[144:147], a[96:99], v[72:75]
    ds_read_b128 a[128:131], v18 offset:16384
    v_cvt_pk_bf16_f32 v48, v96, v97
    v_mfma_f32_16x16x32_bf16 v[116:119], a[148:151], a[100:103], v[116:119]
    ds_read_b128 a[132:135], v18 offset:17408
    v_cvt_pk_bf16_f32 v49, v98, v99
    v_mfma_f32_16x16x32_bf16 v[116:119], a[152:155], a[104:107], v[116:119]
    ds_read_b128 a[136:139], v18 offset:18432
    v_cvt_pk_bf16_f32 v50, v100, v101
    v_mfma_f32_16x16x32_bf16 v[116:119], a[156:159], a[108:111], v[116:119]
    ds_read_b128 a[140:143], v18 offset:19456
    v_cvt_pk_bf16_f32 v51, v102, v103
    v_mfma_f32_16x16x32_bf16 v[124:127], a[144:147], a[112:115], v[76:79]
    ds_read_b128 a[144:147], v18 offset:20480
    v_cvt_pk_bf16_f32 v52, v104, v105
    v_mfma_f32_16x16x32_bf16 v[124:127], a[148:151], a[116:119], v[124:127]
    ds_read_b128 a[148:151], v18 offset:21504
    v_cvt_pk_bf16_f32 v53, v106, v107
    v_mfma_f32_16x16x32_bf16 v[124:127], a[152:155], a[120:123], v[124:127]
    ds_read_b128 a[152:155], v18 offset:22528
    v_cvt_pk_bf16_f32 v54, v108, v109
    v_mfma_f32_16x16x32_bf16 v[124:127], a[156:159], a[124:127], v[124:127]
    ds_read_b128 a[156:159], v18 offset:23552
    v_cvt_pk_bf16_f32 v55, v110, v111
    v_xor_b32 v18, 196608, v18
    s_branch L_t1_p1
L_t1_zero:
    v_mfma_f32_16x16x32_bf16 v[96:99], a[128:131], a[96:99], v[80:83]
    s_xor_b32 s100, s16, 8192
    ds_read_b128 a[176:179], v20 offset:4096
    v_lshrrev_b32 v13, 1, v1
    v_mfma_f32_16x16x32_bf16 v[96:99], a[132:135], a[100:103], v[96:99]
    s_add_u32 m0, s15, 0
    ds_read_b128 a[180:183], v20 offset:5120
    v_add_u32 v12, s100, v13
    v_mfma_f32_16x16x32_bf16 v[96:99], a[136:139], a[104:107], v[96:99]
    buffer_load_dwordx4 v1, s[8:11], s82 offen offset:0  lds
    v_exp_f32 v112, v112
    v_mfma_f32_16x16x32_bf16 v[96:99], a[140:143], a[108:111], v[96:99]
    v_exp_f32 v113, v113
    v_mfma_f32_16x16x32_bf16 v[100:103], a[144:147], a[96:99], v[84:87]
    ds_read_b128 a[184:187], v20 offset:6144
    v_cvt_pk_bf16_f32 v56, v112, v113
    v_mfma_f32_16x16x32_bf16 v[100:103], a[148:151], a[100:103], v[100:103]
    v_exp_f32 v114, v114
    v_mfma_f32_16x16x32_bf16 v[100:103], a[152:155], a[104:107], v[100:103]
    buffer_load_dwordx4 v1, s[8:11], s82 offen offset:1024  lds
    v_exp_f32 v115, v115
    v_mfma_f32_16x16x32_bf16 v[100:103], a[156:159], a[108:111], v[100:103]
    ds_read_b128 a[188:191], v20 offset:7168
    v_cvt_pk_bf16_f32 v57, v114, v115
    v_mfma_f32_16x16x32_bf16 v[104:107], a[128:131], a[112:115], v[88:91]
    v_exp_f32 v116, v116
    v_mfma_f32_16x16x32_bf16 v[104:107], a[132:135], a[116:119], v[104:107]
    v_exp_f32 v117, v117
    v_mfma_f32_16x16x32_bf16 v[104:107], a[136:139], a[120:123], v[104:107]
    ds_read_b128 a[160:163], v19 offset:0
    v_cvt_pk_bf16_f32 v58, v116, v117
    v_mfma_f32_16x16x32_bf16 v[104:107], a[140:143], a[124:127], v[104:107]
    buffer_load_dwordx4 v1, s[8:11], s82 offen offset:2048  lds
    v_exp_f32 v118, v118
    v_mfma_f32_16x16x32_bf16 v[108:111], a[144:147], a[112:115], v[92:95]
    v_exp_f32 v119, v119
    v_mfma_f32_16x16x32_bf16 v[108:111], a[148:151], a[116:119], v[108:111]
    ds_read_b128 a[164:167], v19 offset:1024
    v_cvt_pk_bf16_f32 v59, v118, v119
    v_mfma_f32_16x16x32_bf16 v[108:111], a[152:155], a[120:123], v[108:111]
    v_exp_f32 v120, v120
    v_mfma_f32_16x16x32_bf16 v[108:111], a[156:159], a[124:127], v[108:111]
    buffer_load_dwordx4 v1, s[8:11], s82 offen offset:3072  lds
    v_exp_f32 v121, v121
    v_mfma_f32_16x16x32_bf16 v[32:35], v[28:31], v[48:51], 0
    s_add_u32 m0, s15, 4096
    ds_read_b128 a[168:171], v19 offset:2048
    v_cvt_pk_bf16_f32 v60, v120, v121
    v_mfma_f32_16x16x32_bf16 v[36:39], v[28:31], v[52:55], 0
    s_waitcnt lgkmcnt(6)
    v_exp_f32 v122, v122
    v_mfma_f32_16x16x32_bf16 v[144:147], a[176:179], v[48:51], 0
    v_exp_f32 v123, v123
    v_mfma_f32_16x16x32_bf16 v[176:179], a[176:179], v[52:55], 0
    s_waitcnt lgkmcnt(5)
    ds_read_b128 a[172:175], v19 offset:3072
    v_cvt_pk_bf16_f32 v61, v122, v123
    v_mfma_f32_16x16x32_bf16 v[148:151], a[180:183], v[48:51], 0
    buffer_load_dwordx4 v15, s[8:11], s82 offen offset:0  lds
    v_exp_f32 v124, v124
    v_mfma_f32_16x16x32_bf16 v[180:183], a[180:183], v[52:55], 0
    s_waitcnt lgkmcnt(5)
    v_exp_f32 v125, v125
    v_mfma_f32_16x16x32_bf16 v[152:155], a[184:187], v[48:51], 0
    s_waitcnt lgkmcnt(4)
    v_exp_f32 v126, v126
    v_mfma_f32_16x16x32_bf16 v[184:187], a[184:187], v[52:55], 0
    buffer_load_dwordx4 v15, s[8:11], s82 offen offset:1024  lds
    v_exp_f32 v127, v127
    v_mfma_f32_16x16x32_bf16 v[156:159], a[188:191], v[48:51], 0
    ds_write_b128 v16, v[144:147] offset:32768
    v_cvt_pk_bf16_f32 v62, v124, v125
    v_mfma_f32_16x16x32_bf16 v[188:191], a[188:191], v[52:55], 0
    s_waitcnt lgkmcnt(4)
    v_exp_f32 v96, v96
    v_mfma_f32_16x16x32_bf16 v[128:131], a[160:163], v[48:51], 0
    v_exp_f32 v97, v97
    v_mfma_f32_16x16x32_bf16 v[160:163], a[160:163], v[52:55], 0
    s_waitcnt lgkmcnt(3)
    ds_write_b128 v16, v[176:179] offset:33792
    v_cvt_pk_bf16_f32 v63, v126, v127
    v_mfma_f32_16x16x32_bf16 v[132:135], a[164:167], v[48:51], 0
    s_waitcnt lgkmcnt(3)
    v_exp_f32 v98, v98
    v_mfma_f32_16x16x32_bf16 v[164:167], a[164:167], v[52:55], 0
    buffer_load_dwordx4 v15, s[8:11], s82 offen offset:2048  lds
    v_exp_f32 v99, v99
    v_mfma_f32_16x16x32_bf16 v[136:139], a[168:171], v[48:51], 0
    ds_write_b128 v16, v[148:151] offset:34816
    v_mfma_f32_16x16x32_bf16 v[168:171], a[168:171], v[52:55], 0
    s_waitcnt lgkmcnt(3)
    v_exp_f32 v100, v100
    v_mfma_f32_16x16x32_bf16 v[140:143], a[172:175], v[48:51], 0
    v_exp_f32 v101, v101
    v_mfma_f32_16x16x32_bf16 v[172:175], a[172:175], v[52:55], 0
    ds_write_b128 v16, v[180:183] offset:35840
    v_mov_b32 v33, v36
    v_mfma_f32_16x16x32_bf16 v[40:43], v[28:31], v[56:59], 0
    buffer_load_dwordx4 v15, s[8:11], s82 offen offset:3072  lds
    v_exp_f32 v102, v102
    v_mfma_f32_16x16x32_bf16 v[44:47], v[28:31], v[60:63], 0
    s_xor_b32 s15, s15, 196608
    v_exp_f32 v103, v103
    v_mfma_f32_16x16x32_bf16 v[208:211], a[176:179], v[56:59], 0
    ds_write_b128 v16, v[152:155] offset:36864
    v_cvt_pk_bf16_f32 v48, v96, v97
    v_mfma_f32_16x16x32_bf16 v[240:243], a[176:179], v[60:63], 0
    ds_read_b128 a[176:179], v20 offset:20480
    v_exp_f32 v104, v104
    v_mfma_f32_16x16x32_bf16 v[212:215], a[180:183], v[56:59], 0
    v_exp_f32 v105, v105
    v_mfma_f32_16x16x32_bf16 v[244:247], a[180:183], v[60:63], 0
    ds_read_b128 a[180:183], v20 offset:21504
    v_exp_f32 v106, v106
    v_mfma_f32_16x16x32_bf16 v[216:219], a[184:187], v[56:59], 0
    ds_write_b128 v16, v[184:187] offset:37888
    v_cvt_pk_bf16_f32 v49, v98, v99
    v_mfma_f32_16x16x32_bf16 v[248:251], a[184:187], v[60:63], 0
    ds_read_b128 a[184:187], v20 offset:22528
    v_exp_f32 v107, v107
    v_mfma_f32_16x16x32_bf16 v[220:223], a[188:191], v[56:59], 0
    v_exp_f32 v108, v108
    v_mfma_f32_16x16x32_bf16 v[252:255], a[188:191], v[60:63], 0
    ds_read_b128 a[188:191], v20 offset:23552
    v_exp_f32 v109, v109
    v_mfma_f32_16x16x32_bf16 v[192:195], a[160:163], v[56:59], 0
    ds_write_b128 v16, v[156:159] offset:38912
    v_cvt_pk_bf16_f32 v50, v100, v101
    v_mfma_f32_16x16x32_bf16 v[224:227], a[160:163], v[60:63], 0
    ds_read_b128 a[160:163], v19 offset:16384
    v_exp_f32 v110, v110
    v_mfma_f32_16x16x32_bf16 v[196:199], a[164:167], v[56:59], 0
    v_exp_f32 v111, v111
    v_mfma_f32_16x16x32_bf16 v[228:231], a[164:167], v[60:63], 0
    ds_read_b128 a[164:167], v19 offset:17408
    v_cvt_pk_bf16_f32 v51, v102, v103
    v_mfma_f32_16x16x32_bf16 v[200:203], a[168:171], v[56:59], 0
    ds_write_b128 v16, v[188:191] offset:39936
    v_cvt_pk_bf16_f32 v52, v104, v105
    v_mfma_f32_16x16x32_bf16 v[232:235], a[168:171], v[60:63], 0
    ds_read_b128 a[168:171], v19 offset:18432
    v_cvt_pk_bf16_f32 v53, v106, v107
    v_mfma_f32_16x16x32_bf16 v[204:207], a[172:175], v[56:59], 0
    v_cvt_pk_bf16_f32 v54, v108, v109
    v_cvt_pk_bf16_f32 v55, v110, v111
    v_mfma_f32_16x16x32_bf16 v[236:239], a[172:175], v[60:63], 0
    ds_read_b128 a[172:175], v19 offset:19456
    ds_write_b64 v12, v[32:33]
    s_xor_b32 s101, s16, 98304
    v_xor_b32 v12, 8192, v12
    v_add_u32 v9, s101, v1
    v_xor_b32 v8, 8192, v16
    v_xor_b32 v10, 8192, v9
    s_branch L_t1_join
L_t1_redo:
    s_cmp_eq_u32 s25, 0
    s_cbranch_scc1 L_t1_max
    s_mov_b32 s25, 0
    v_mov_b32 v64, 0
    v_mov_b32 v65, 0
    v_mov_b32 v66, 0
    v_mov_b32 v67, 0
    v_mov_b32 v68, 0
    v_mov_b32 v69, 0
    v_mov_b32 v70, 0
    v_mov_b32 v71, 0
    v_mov_b32 v72, 0
    v_mov_b32 v73, 0
    v_mov_b32 v74, 0
    v_mov_b32 v75, 0
    v_mov_b32 v76, 0
    v_mov_b32 v77, 0
    v_mov_b32 v78, 0
    v_mov_b32 v79, 0
    s_nop 1
    s_branch L_t1_safe
L_t1_max:
    s_waitcnt vmcnt(0) lgkmcnt(0)
    s_barrier
    s_mov_b32 s25, 1
    s_and_b32 s100, s3, 1
    s_lshl_b32 s100, s100, 13
    s_sub_u32 s101, s81, s62
    s_add_u32 s101, s101, s100
    s_mov_b32 s14, s60
    v_mov_b32 v48, 0xff800000
    v_mov_b32 v49, 0xff800000
    v_mov_b32 v50, 0xff800000
    v_mov_b32 v51, 0xff800000
L_t1_maxl:
    s_cmp_eq_u32 s14, 0
    s_cbranch_scc1 L_t1_maxd
    s_add_u32 s100, s101, 0
    buffer_load_dwordx4 a[128:131], v1, s[8:11], s100 offen offset:0
    buffer_load_dwordx4 a[132:135], v1, s[8:11], s100 offen offset:1024
    buffer_load_dwordx4 a[136:139], v1, s[8:11], s100 offen offset:2048
    buffer_load_dwordx4 a[140:143], v1, s[8:11], s100 offen offset:3072
    buffer_load_dwordx4 a[144:147], v15, s[8:11], s100 offen offset:0
    buffer_load_dwordx4 a[148:151], v15, s[8:11], s100 offen offset:1024
    buffer_load_dwordx4 a[152:155], v15, s[8:11], s100 offen offset:2048
    buffer_load_dwordx4 a[156:159], v15, s[8:11], s100 offen offset:3072
    s_waitcnt vmcnt(7)
    v_mfma_f32_16x16x32_bf16 v[96:99], a[128:131], a[64:67], v[64:67]
    s_waitcnt vmcnt(6)
    v_mfma_f32_16x16x32_bf16 v[96:99], a[132:135], a[68:71], v[96:99]
    s_waitcnt vmcnt(5)
    v_mfma_f32_16x16x32_bf16 v[96:99], a[136:139], a[72:75], v[96:99]
    s_waitcnt vmcnt(4)
    v_mfma_f32_16x16x32_bf16 v[96:99], a[140:143], a[76:79], v[96:99]
    v_mfma_f32_16x16x32_bf16 v[104:107], a[128:131], a[80:83], v[68:71]
    v_mfma_f32_16x16x32_bf16 v[104:107], a[132:135], a[84:87], v[104:107]
    v_mfma_f32_16x16x32_bf16 v[104:107], a[136:139], a[88:91], v[104:107]
    v_mfma_f32_16x16x32_bf16 v[104:107], a[140:143], a[92:95], v[104:107]
    s_waitcnt vmcnt(3)
    v_mfma_f32_16x16x32_bf16 v[100:103], a[144:147], a[64:67], v[64:67]
    s_waitcnt vmcnt(2)
    v_mfma_f32_16x16x32_bf16 v[100:103], a[148:151], a[68:71], v[100:103]
    s_waitcnt vmcnt(1)
    v_mfma_f32_16x16x32_bf16 v[100:103], a[152:155], a[72:75], v[100:103]
    s_waitcnt vmcnt(0)
    v_mfma_f32_16x16x32_bf16 v[100:103], a[156:159], a[76:79], v[100:103]
    v_mfma_f32_16x16x32_bf16 v[108:111], a[144:147], a[80:83], v[68:71]
    v_mfma_f32_16x16x32_bf16 v[108:111], a[148:151], a[84:87], v[108:111]
    v_mfma_f32_16x16x32_bf16 v[108:111], a[152:155], a[88:91], v[108:111]
    v_mfma_f32_16x16x32_bf16 v[108:111], a[156:159], a[92:95], v[108:111]
    v_mfma_f32_16x16x32_bf16 v[112:115], a[128:131], a[96:99], v[72:75]
    v_mfma_f32_16x16x32_bf16 v[112:115], a[132:135], a[100:103], v[112:115]
    v_mfma_f32_16x16x32_bf16 v[112:115], a[136:139], a[104:107], v[112:115]
    v_mfma_f32_16x16x32_bf16 v[112:115], a[140:143], a[108:111], v[112:115]
    v_mfma_f32_16x16x32_bf16 v[120:123], a[128:131], a[112:115], v[76:79]
    v_mfma_f32_16x16x32_bf16 v[120:123], a[132:135], a[116:119], v[120:123]
    v_mfma_f32_16x16x32_bf16 v[120:123], a[136:139], a[120:123], v[120:123]
    v_mfma_f32_16x16x32_bf16 v[120:123], a[140:143], a[124:127], v[120:123]
    v_mfma_f32_16x16x32_bf16 v[116:119], a[144:147], a[96:99], v[72:75]
    v_mfma_f32_16x16x32_bf16 v[116:119], a[148:151], a[100:103], v[116:119]
    v_mfma_f32_16x16x32_bf16 v[116:119], a[152:155], a[104:107], v[116:119]
    v_mfma_f32_16x16x32_bf16 v[116:119], a[156:159], a[108:111], v[116:119]
    v_mfma_f32_16x16x32_bf16 v[124:127], a[144:147], a[112:115], v[76:79]
    v_mfma_f32_16x16x32_bf16 v[124:127], a[148:151], a[116:119], v[124:127]
    v_mfma_f32_16x16x32_bf16 v[124:127], a[152:155], a[120:123], v[124:127]
    v_mfma_f32_16x16x32_bf16 v[124:127], a[156:159], a[124:127], v[124:127]
    v_max3_f32 v48, v48, v96, v97
    v_max3_f32 v48, v48, v98, v99
    v_max3_f32 v48, v48, v100, v101
    v_max3_f32 v48, v48, v102, v103
    v_max3_f32 v49, v49, v104, v105
    v_max3_f32 v49, v49, v106, v107
    v_max3_f32 v49, v49, v108, v109
    v_max3_f32 v49, v49, v110, v111
    v_max3_f32 v50, v50, v112, v113
    v_max3_f32 v50, v50, v114, v115
    v_max3_f32 v50, v50, v116, v117
    v_max3_f32 v50, v50, v118, v119
    v_max3_f32 v51, v51, v120, v121
    v_max3_f32 v51, v51, v122, v123
    v_max3_f32 v51, v51, v124, v125
    v_max3_f32 v51, v51, v126, v127
    s_add_u32 s100, s101, 16384
    buffer_load_dwordx4 a[128:131], v1, s[8:11], s100 offen offset:0
    buffer_load_dwordx4 a[132:135], v1, s[8:11], s100 offen offset:1024
    buffer_load_dwordx4 a[136:139], v1, s[8:11], s100 offen offset:2048
    buffer_load_dwordx4 a[140:143], v1, s[8:11], s100 offen offset:3072
    buffer_load_dwordx4 a[144:147], v15, s[8:11], s100 offen offset:0
    buffer_load_dwordx4 a[148:151], v15, s[8:11], s100 offen offset:1024
    buffer_load_dwordx4 a[152:155], v15, s[8:11], s100 offen offset:2048
    buffer_load_dwordx4 a[156:159], v15, s[8:11], s100 offen offset:3072
    s_waitcnt vmcnt(7)
    v_mfma_f32_16x16x32_bf16 v[96:99], a[128:131], a[64:67], v[64:67]
    s_waitcnt vmcnt(6)
    v_mfma_f32_16x16x32_bf16 v[96:99], a[132:135], a[68:71], v[96:99]
    s_waitcnt vmcnt(5)
    v_mfma_f32_16x16x32_bf16 v[96:99], a[136:139], a[72:75], v[96:99]
    s_waitcnt vmcnt(4)
    v_mfma_f32_16x16x32_bf16 v[96:99], a[140:143], a[76:79], v[96:99]
    v_mfma_f32_16x16x32_bf16 v[104:107], a[128:131], a[80:83], v[68:71]
    v_mfma_f32_16x16x32_bf16 v[104:107], a[132:135], a[84:87], v[104:107]
    v_mfma_f32_16x16x32_bf16 v[104:107], a[136:139], a[88:91], v[104:107]
    v_mfma_f32_16x16x32_bf16 v[104:107], a[140:143], a[92:95], v[104:107]
    s_waitcnt vmcnt(3)
    v_mfma_f32_16x16x32_bf16 v[100:103], a[144:147], a[64:67], v[64:67]
    s_waitcnt vmcnt(2)
    v_mfma_f32_16x16x32_bf16 v[100:103], a[148:151], a[68:71], v[100:103]
    s_waitcnt vmcnt(1)
    v_mfma_f32_16x16x32_bf16 v[100:103], a[152:155], a[72:75], v[100:103]
    s_waitcnt vmcnt(0)
    v_mfma_f32_16x16x32_bf16 v[100:103], a[156:159], a[76:79], v[100:103]
    v_mfma_f32_16x16x32_bf16 v[108:111], a[144:147], a[80:83], v[68:71]
    v_mfma_f32_16x16x32_bf16 v[108:111], a[148:151], a[84:87], v[108:111]
    v_mfma_f32_16x16x32_bf16 v[108:111], a[152:155], a[88:91], v[108:111]
    v_mfma_f32_16x16x32_bf16 v[108:111], a[156:159], a[92:95], v[108:111]
    v_mfma_f32_16x16x32_bf16 v[112:115], a[128:131], a[96:99], v[72:75]
    v_mfma_f32_16x16x32_bf16 v[112:115], a[132:135], a[100:103], v[112:115]
    v_mfma_f32_16x16x32_bf16 v[112:115], a[136:139], a[104:107], v[112:115]
    v_mfma_f32_16x16x32_bf16 v[112:115], a[140:143], a[108:111], v[112:115]
    v_mfma_f32_16x16x32_bf16 v[120:123], a[128:131], a[112:115], v[76:79]
    v_mfma_f32_16x16x32_bf16 v[120:123], a[132:135], a[116:119], v[120:123]
    v_mfma_f32_16x16x32_bf16 v[120:123], a[136:139], a[120:123], v[120:123]
    v_mfma_f32_16x16x32_bf16 v[120:123], a[140:143], a[124:127], v[120:123]
    v_mfma_f32_16x16x32_bf16 v[116:119], a[144:147], a[96:99], v[72:75]
    v_mfma_f32_16x16x32_bf16 v[116:119], a[148:151], a[100:103], v[116:119]
    v_mfma_f32_16x16x32_bf16 v[116:119], a[152:155], a[104:107], v[116:119]
    v_mfma_f32_16x16x32_bf16 v[116:119], a[156:159], a[108:111], v[116:119]
    v_mfma_f32_16x16x32_bf16 v[124:127], a[144:147], a[112:115], v[76:79]
    v_mfma_f32_16x16x32_bf16 v[124:127], a[148:151], a[116:119], v[124:127]
    v_mfma_f32_16x16x32_bf16 v[124:127], a[152:155], a[120:123], v[124:127]
    v_mfma_f32_16x16x32_bf16 v[124:127], a[156:159], a[124:127], v[124:127]
    v_max3_f32 v48, v48, v96, v97
    v_max3_f32 v48, v48, v98, v99
    v_max3_f32 v48, v48, v100, v101
    v_max3_f32 v48, v48, v102, v103
    v_max3_f32 v49, v49, v104, v105
    v_max3_f32 v49, v49, v106, v107
    v_max3_f32 v49, v49, v108, v109
    v_max3_f32 v49, v49, v110, v111
    v_max3_f32 v50, v50, v112, v113
    v_max3_f32 v50, v50, v114, v115
    v_max3_f32 v50, v50, v116, v117
    v_max3_f32 v50, v50, v118, v119
    v_max3_f32 v51, v51, v120, v121
    v_max3_f32 v51, v51, v122, v123
    v_max3_f32 v51, v51, v124, v125
    v_max3_f32 v51, v51, v126, v127
    s_add_u32 s101, s101, 65536
    s_sub_u32 s14, s14, 1
    s_nop 7
    s_branch L_t1_maxl
L_t1_maxd:
    s_add_u32 s100, s101, 0
    buffer_load_dwordx4 a[128:131], v1, s[8:11], s100 offen offset:0
    buffer_load_dwordx4 a[132:135], v1, s[8:11], s100 offen offset:1024
    buffer_load_dwordx4 a[136:139], v1, s[8:11], s100 offen offset:2048
    buffer_load_dwordx4 a[140:143], v1, s[8:11], s100 offen offset:3072
    buffer_load_dwordx4 a[144:147], v15, s[8:11], s100 offen offset:0
    buffer_load_dwordx4 a[148:151], v15, s[8:11], s100 offen offset:1024
    buffer_load_dwordx4 a[152:155], v15, s[8:11], s100 offen offset:2048
    buffer_load_dwordx4 a[156:159], v15, s[8:11], s100 offen offset:3072
    v_add_f32 v80, 0, v21
    v_min_f32 v80, v80, v64
    v_add_f32 v81, 0xf1800000, v21
    v_min_f32 v81, v81, v65
    v_add_f32 v82, 0xf2000000, v21
    v_min_f32 v82, v82, v66
    v_add_f32 v83, 0xf2400000, v21
    v_min_f32 v83, v83, v67
    v_add_f32 v84, 0xf3800000, v21
    v_min_f32 v84, v84, v64
    v_add_f32 v85, 0xf3880000, v21
    v_min_f32 v85, v85, v65
    v_add_f32 v86, 0xf3900000, v21
    v_min_f32 v86, v86, v66
    v_add_f32 v87, 0xf3980000, v21
    v_min_f32 v87, v87, v67
    v_add_f32 v88, 0x73800000, v21
    v_min_f32 v88, v88, v68
    v_add_f32 v89, 0x73700000, v21
    v_min_f32 v89, v89, v69
    v_add_f32 v90, 0x73600000, v21
    v_min_f32 v90, v90, v70
    v_add_f32 v91, 0x73500000, v21
    v_min_f32 v91, v91, v71
    v_add_f32 v92, 0, v21
    v_min_f32 v92, v92, v68
    v_add_f32 v93, 0xf1800000, v21
    v_min_f32 v93, v93, v69
    v_add_f32 v94, 0xf2000000, v21
    v_min_f32 v94, v94, v70
    v_add_f32 v95, 0xf2400000, v21
    v_min_f32 v95, v95, v71
    s_waitcnt vmcnt(7)
    v_mfma_f32_16x16x32_bf16 v[96:99], a[128:131], a[64:67], v[80:83]
    s_waitcnt vmcnt(6)
    v_mfma_f32_16x16x32_bf16 v[96:99], a[132:135], a[68:71], v[96:99]
    s_waitcnt vmcnt(5)
    v_mfma_f32_16x16x32_bf16 v[96:99], a[136:139], a[72:75], v[96:99]
    s_waitcnt vmcnt(4)
    v_mfma_f32_16x16x32_bf16 v[96:99], a[140:143], a[76:79], v[96:99]
    v_mfma_f32_16x16x32_bf16 v[104:107], a[128:131], a[80:83], v[88:91]
    v_mfma_f32_16x16x32_bf16 v[104:107], a[132:135], a[84:87], v[104:107]
    v_mfma_f32_16x16x32_bf16 v[104:107], a[136:139], a[88:91], v[104:107]
    v_mfma_f32_16x16x32_bf16 v[104:107], a[140:143], a[92:95], v[104:107]
    s_waitcnt vmcnt(3)
    v_mfma_f32_16x16x32_bf16 v[100:103], a[144:147], a[64:67], v[84:87]
    s_waitcnt vmcnt(2)
    v_mfma_f32_16x16x32_bf16 v[100:103], a[148:151], a[68:71], v[100:103]
    s_waitcnt vmcnt(1)
    v_mfma_f32_16x16x32_bf16 v[100:103], a[152:155], a[72:75], v[100:103]
    s_waitcnt vmcnt(0)
    v_mfma_f32_16x16x32_bf16 v[100:103], a[156:159], a[76:79], v[100:103]
    v_mfma_f32_16x16x32_bf16 v[108:111], a[144:147], a[80:83], v[92:95]
    v_mfma_f32_16x16x32_bf16 v[108:111], a[148:151], a[84:87], v[108:111]
    v_mfma_f32_16x16x32_bf16 v[108:111], a[152:155], a[88:91], v[108:111]
    v_mfma_f32_16x16x32_bf16 v[108:111], a[156:159], a[92:95], v[108:111]
    v_mfma_f32_16x16x32_bf16 v[112:115], a[128:131], a[96:99], v[72:75]
    v_mfma_f32_16x16x32_bf16 v[112:115], a[132:135], a[100:103], v[112:115]
    v_mfma_f32_16x16x32_bf16 v[112:115], a[136:139], a[104:107], v[112:115]
    v_mfma_f32_16x16x32_bf16 v[112:115], a[140:143], a[108:111], v[112:115]
    v_mfma_f32_16x16x32_bf16 v[120:123], a[128:131], a[112:115], v[76:79]
    v_mfma_f32_16x16x32_bf16 v[120:123], a[132:135], a[116:119], v[120:123]
    v_mfma_f32_16x16x32_bf16 v[120:123], a[136:139], a[120:123], v[120:123]
    v_mfma_f32_16x16x32_bf16 v[120:123], a[140:143], a[124:127], v[120:123]
    v_mfma_f32_16x16x32_bf16 v[116:119], a[144:147], a[96:99], v[72:75]
    v_mfma_f32_16x16x32_bf16 v[116:119], a[148:151], a[100:103], v[116:119]
    v_mfma_f32_16x16x32_bf16 v[116:119], a[152:155], a[104:107], v[116:119]
    v_mfma_f32_16x16x32_bf16 v[116:119], a[156:159], a[108:111], v[116:119]
    v_mfma_f32_16x16x32_bf16 v[124:127], a[144:147], a[112:115], v[76:79]
    v_mfma_f32_16x16x32_bf16 v[124:127], a[148:151], a[116:119], v[124:127]
    v_mfma_f32_16x16x32_bf16 v[124:127], a[152:155], a[120:123], v[124:127]
    v_mfma_f32_16x16x32_bf16 v[124:127], a[156:159], a[124:127], v[124:127]
    v_max3_f32 v48, v48, v96, v97
    v_max3_f32 v48, v48, v98, v99
    v_max3_f32 v48, v48, v100, v101
    v_max3_f32 v48, v48, v102, v103
    v_max3_f32 v49, v49, v104, v105
    v_max3_f32 v49, v49, v106, v107
    v_max3_f32 v49, v49, v108, v109
    v_max3_f32 v49, v49, v110, v111
    v_max3_f32 v50, v50, v112, v113
    v_max3_f32 v50, v50, v114, v115
    v_max3_f32 v50, v50, v116, v117
    v_max3_f32 v50, v50, v118, v119
    v_max3_f32 v51, v51, v120, v121
    v_max3_f32 v51, v51, v122, v123
    v_max3_f32 v51, v51, v124, v125
    v_max3_f32 v51, v51, v126, v127
    s_add_u32 s100, s101, 16384
    buffer_load_dwordx4 a[128:131], v1, s[8:11], s100 offen offset:0
    buffer_load_dwordx4 a[132:135], v1, s[8:11], s100 offen offset:1024
    buffer_load_dwordx4 a[136:139], v1, s[8:11], s100 offen offset:2048
    buffer_load_dwordx4 a[140:143], v1, s[8:11], s100 offen offset:3072
    buffer_load_dwordx4 a[144:147], v15, s[8:11], s100 offen offset:0
    buffer_load_dwordx4 a[148:151], v15, s[8:11], s100 offen offset:1024
    buffer_load_dwordx4 a[152:155], v15, s[8:11], s100 offen offset:2048
    buffer_load_dwordx4 a[156:159], v15, s[8:11], s100 offen offset:3072
    v_add_f32 v80, 0, v22
    v_min_f32 v80, v80, v72
    v_add_f32 v81, 0xf1800000, v22
    v_min_f32 v81, v81, v73
    v_add_f32 v82, 0xf2000000, v22
    v_min_f32 v82, v82, v74
    v_add_f32 v83, 0xf2400000, v22
    v_min_f32 v83, v83, v75
    v_add_f32 v84, 0xf3800000, v22
    v_min_f32 v84, v84, v72
    v_add_f32 v85, 0xf3880000, v22
    v_min_f32 v85, v85, v73
    v_add_f32 v86, 0xf3900000, v22
    v_min_f32 v86, v86, v74
    v_add_f32 v87, 0xf3980000, v22
    v_min_f32 v87, v87, v75
    v_add_f32 v88, 0x73800000, v22
    v_min_f32 v88, v88, v76
    v_add_f32 v89, 0x73700000, v22
    v_min_f32 v89, v89, v77
    v_add_f32 v90, 0x73600000, v22
    v_min_f32 v90, v90, v78
    v_add_f32 v91, 0x73500000, v22
    v_min_f32 v91, v91, v79
    v_add_f32 v92, 0, v22
    v_min_f32 v92, v92, v76
    v_add_f32 v93, 0xf1800000, v22
    v_min_f32 v93, v93, v77
    v_add_f32 v94, 0xf2000000, v22
    v_min_f32 v94, v94, v78
    v_add_f32 v95, 0xf2400000, v22
    v_min_f32 v95, v95, v79
    s_waitcnt vmcnt(7)
    v_mfma_f32_16x16x32_bf16 v[96:99], a[128:131], a[96:99], v[80:83]
    s_waitcnt vmcnt(6)
    v_mfma_f32_16x16x32_bf16 v[96:99], a[132:135], a[100:103], v[96:99]
    s_waitcnt vmcnt(5)
    v_mfma_f32_16x16x32_bf16 v[96:99], a[136:139], a[104:107], v[96:99]
    s_waitcnt vmcnt(4)
    v_mfma_f32_16x16x32_bf16 v[96:99], a[140:143], a[108:111], v[96:99]
    v_mfma_f32_16x16x32_bf16 v[104:107], a[128:131], a[112:115], v[88:91]
    v_mfma_f32_16x16x32_bf16 v[104:107], a[132:135], a[116:119], v[104:107]
    v_mfma_f32_16x16x32_bf16 v[104:107], a[136:139], a[120:123], v[104:107]
    v_mfma_f32_16x16x32_bf16 v[104:107], a[140:143], a[124:127], v[104:107]
    s_waitcnt vmcnt(3)
    v_mfma_f32_16x16x32_bf16 v[100:103], a[144:147], a[96:99], v[84:87]
    s_waitcnt vmcnt(2)
    v_mfma_f32_16x16x32_bf16 v[100:103], a[148:151], a[100:103], v[100:103]
    s_waitcnt vmcnt(1)
    v_mfma_f32_16x16x32_bf16 v[100:103], a[152:155], a[104:107], v[100:103]
    s_waitcnt vmcnt(0)
    v_mfma_f32_16x16x32_bf16 v[100:103], a[156:159], a[108:111], v[100:103]
    v_mfma_f32_16x16x32_bf16 v[108:111], a[144:147], a[112:115], v[92:95]
    v_mfma_f32_16x16x32_bf16 v[108:111], a[148:151], a[116:119], v[108:111]
    v_mfma_f32_16x16x32_bf16 v[108:111], a[152:155], a[120:123], v[108:111]
    v_mfma_f32_16x16x32_bf16 v[108:111], a[156:159], a[124:127], v[108:111]
    v_max3_f32 v50, v50, v96, v97
    v_max3_f32 v50, v50, v98, v99
    s_nop 1
    v_max3_f32 v50, v50, v100, v101
    v_max3_f32 v50, v50, v102, v103
    v_max3_f32 v51, v51, v104, v105
    v_max3_f32 v51, v51, v106, v107
    v_max3_f32 v51, v51, v108, v109
    v_max3_f32 v51, v51, v110, v111
    v_mov_b32 v52, v48
    v_mov_b32 v53, v49
    v_mov_b32 v54, v50
    v_mov_b32 v55, v51
    v_permlane16_swap_b32 v48, v52
    v_permlane16_swap_b32 v49, v53
    v_permlane16_swap_b32 v50, v54
    v_permlane16_swap_b32 v51, v55
    v_max_f32 v48, v48, v52
    v_max_f32 v49, v49, v53
    v_max_f32 v50, v50, v54
    v_max_f32 v51, v51, v55
    v_mov_b32 v52, v48
    v_mov_b32 v53, v49
    v_mov_b32 v54, v50
    v_mov_b32 v55, v51
    v_permlane32_swap_b32 v48, v52
    v_permlane32_swap_b32 v49, v53
    v_permlane32_swap_b32 v50, v54
    v_permlane32_swap_b32 v51, v55
    v_max_f32 v48, v48, v52
    v_max_f32 v49, v49, v53
    v_max_f32 v50, v50, v54
    v_max_f32 v51, v51, v55
    ds_write_b128 v16, v[48:51] offset:32768
    v_xor_b32 v8, 8192, v16
    s_waitcnt lgkmcnt(0)
    s_barrier
    ds_read_b128 v[52:55], v8 offset:32768
    s_waitcnt lgkmcnt(0)
    v_max_f32 v48, v48, v52
    v_max_f32 v49, v49, v53
    v_max_f32 v50, v50, v54
    v_max_f32 v51, v51, v55
    v_sub_f32 v64, 0, v48
    v_sub_f32 v65, 0, v48
    v_sub_f32 v66, 0, v48
    v_sub_f32 v67, 0, v48
    v_sub_f32 v68, 0, v49
    v_sub_f32 v69, 0, v49
    v_sub_f32 v70, 0, v49
    v_sub_f32 v71, 0, v49
    v_sub_f32 v72, 0, v50
    v_sub_f32 v73, 0, v50
    v_sub_f32 v74, 0, v50
    v_sub_f32 v75, 0, v50
    v_sub_f32 v76, 0, v51
    v_sub_f32 v77, 0, v51
    v_sub_f32 v78, 0, v51
    v_sub_f32 v79, 0, v51
    s_mov_b32 s12, 0
    s_and_b32 s100, s12, 1
    s_mul_i32 s15, s100, 196608
    s_xor_b32 s15, s15, 65536
    s_mul_i32 s16, s100, 98304
    s_xor_b32 s16, s16, 98304
    v_and_b32 v18, 0x7fff, v18
    v_or_b32 v18, s15, v18
    v_and_b32 v19, 0x7fff, v19
    v_or_b32 v19, s16, v19
    v_and_b32 v20, 0x7fff, v20
    v_or_b32 v20, s16, v20
    s_add_u32 s15, s15, s62
    s_add_u32 s16, s16, s62
    s_add_u32 s12, s12, 2
    s_mov_b32 s82, s81
    s_add_u32 s19, s82, 32768
    s_add_u32 m0, s15, 0
    s_nop 0
    buffer_load_dwordx4 v1, s[8:11], s82 offen offset:0  lds
    buffer_load_dwordx4 v1, s[8:11], s82 offen offset:1024  lds
    buffer_load_dwordx4 v1, s[8:11], s82 offen offset:2048  lds
    buffer_load_dwordx4 v1, s[8:11], s82 offen offset:3072  lds
    s_add_u32 m0, s15, 4096
    s_nop 0
    buffer_load_dwordx4 v15, s[8:11], s82 offen offset:0  lds
    buffer_load_dwordx4 v15, s[8:11], s82 offen offset:1024  lds
    buffer_load_dwordx4 v15, s[8:11], s82 offen offset:2048  lds
    buffer_load_dwordx4 v15, s[8:11], s82 offen offset:3072  lds
    s_xor_b32 s15, s15, 196608
    s_add_u32 m0, s16, 0
    s_nop 0
    buffer_load_dwordx4 v1, s[8:11], s19 offen offset:0  lds
    buffer_load_dwordx4 v1, s[8:11], s19 offen offset:1024  lds
    buffer_load_dwordx4 v1, s[8:11], s19 offen offset:2048  lds
    buffer_load_dwordx4 v1, s[8:11], s19 offen offset:3072  lds
    s_add_u32 m0, s16, 4096
    s_nop 0
    buffer_load_dwordx4 v15, s[8:11], s19 offen offset:0  lds
    buffer_load_dwordx4 v15, s[8:11], s19 offen offset:1024  lds
    buffer_load_dwordx4 v15, s[8:11], s19 offen offset:2048  lds
    buffer_load_dwordx4 v15, s[8:11], s19 offen offset:3072  lds
    s_xor_b32 s16, s16, 98304
    s_cmp_eq_u32 s60, 0
    s_cselect_b32 s82, 0, 1
    s_mul_i32 s82, s82, 65536
    s_add_u32 s82, s82, s81
    s_add_u32 m0, s15, 0
    s_nop 0
    buffer_load_dwordx4 v1, s[8:11], s82 offen offset:0  lds
    buffer_load_dwordx4 v1, s[8:11], s82 offen offset:1024  lds
    buffer_load_dwordx4 v1, s[8:11], s82 offen offset:2048  lds
    buffer_load_dwordx4 v1, s[8:11], s82 offen offset:3072  lds
    s_add_u32 m0, s15, 4096
    s_nop 0
    buffer_load_dwordx4 v15, s[8:11], s82 offen offset:0  lds
    buffer_load_dwordx4 v15, s[8:11], s82 offen offset:1024  lds
    buffer_load_dwordx4 v15, s[8:11], s82 offen offset:2048  lds
    buffer_load_dwordx4 v15, s[8:11], s82 offen offset:3072  lds
    s_xor_b32 s15, s15, 196608
    s_cmp_eq_u32 s60, 0
    s_cselect_b32 s19, 0, 0x76800000
    v_add_f32 v3, s19, v21
    v_add_f32 v96, 0, v3
    v_min_f32 v96, v96, v64
    v_add_f32 v97, 0xf1800000, v3
    v_min_f32 v97, v97, v65
    v_add_f32 v98, 0xf2000000, v3
    v_min_f32 v98, v98, v66
    v_add_f32 v99, 0xf2400000, v3
    v_min_f32 v99, v99, v67
    v_add_f32 v100, 0xf3800000, v3
    v_min_f32 v100, v100, v64
    v_add_f32 v101, 0xf3880000, v3
    v_min_f32 v101, v101, v65
    v_add_f32 v102, 0xf3900000, v3
    v_min_f32 v102, v102, v66
    v_add_f32 v103, 0xf3980000, v3
    v_min_f32 v103, v103, v67
    v_add_f32 v104, 0x73800000, v3
    v_min_f32 v104, v104, v68
    v_add_f32 v105, 0x73700000, v3
    v_min_f32 v105, v105, v69
    v_add_f32 v106, 0x73600000, v3
    v_min_f32 v106, v106, v70
    v_add_f32 v107, 0x73500000, v3
    v_min_f32 v107, v107, v71
    v_add_f32 v108, 0, v3
    v_min_f32 v108, v108, v68
    v_add_f32 v109, 0xf1800000, v3
    v_min_f32 v109, v109, v69
    v_add_f32 v110, 0xf2000000, v3
    v_min_f32 v110, v110, v70
    v_add_f32 v111, 0xf2400000, v3
    v_min_f32 v111, v111, v71
    v_add_f32 v80, 0, v22
    v_min_f32 v80, v80, v72
    v_add_f32 v81, 0xf1800000, v22
    v_min_f32 v81, v81, v73
    v_add_f32 v82, 0xf2000000, v22
    v_min_f32 v82, v82, v74
    v_add_f32 v83, 0xf2400000, v22
    v_min_f32 v83, v83, v75
    v_add_f32 v84, 0xf3800000, v22
    v_min_f32 v84, v84, v72
    v_add_f32 v85, 0xf3880000, v22
    v_min_f32 v85, v85, v73
    v_add_f32 v86, 0xf3900000, v22
    v_min_f32 v86, v86, v74
    v_add_f32 v87, 0xf3980000, v22
    v_min_f32 v87, v87, v75
    v_add_f32 v88, 0x73800000, v22
    v_min_f32 v88, v88, v76
    v_add_f32 v89, 0x73700000, v22
    v_min_f32 v89, v89, v77
    v_add_f32 v90, 0x73600000, v22
    v_min_f32 v90, v90, v78
    v_add_f32 v91, 0x73500000, v22
    v_min_f32 v91, v91, v79
    v_add_f32 v92, 0, v22
    v_min_f32 v92, v92, v76
    v_add_f32 v93, 0xf1800000, v22
    v_min_f32 v93, v93, v77
    v_add_f32 v94, 0xf2000000, v22
    v_min_f32 v94, v94, v78
    v_add_f32 v95, 0xf2400000, v22
    v_min_f32 v95, v95, v79
    s_cmp_eq_u32 s60, 0
    s_cbranch_scc1 L_t1_mk
    v_add_f32 v80, 0, v21
    v_min_f32 v80, v80, v64
    v_add_f32 v81, 0xf1800000, v21
    v_min_f32 v81, v81, v65
    v_add_f32 v82, 0xf2000000, v21
    v_min_f32 v82, v82, v66
    v_add_f32 v83, 0xf2400000, v21
    v_min_f32 v83, v83, v67
    v_add_f32 v84, 0xf3800000, v21
    v_min_f32 v84, v84, v64
    v_add_f32 v85, 0xf3880000, v21
    v_min_f32 v85, v85, v65
    v_add_f32 v86, 0xf3900000, v21
    v_min_f32 v86, v86, v66
    v_add_f32 v87, 0xf3980000, v21
    v_min_f32 v87, v87, v67
    v_add_f32 v88, 0x73800000, v21
    v_min_f32 v88, v88, v68
    v_add_f32 v89, 0x73700000, v21
    v_min_f32 v89, v89, v69
    v_add_f32 v90, 0x73600000, v21
    v_min_f32 v90, v90, v70
    v_add_f32 v91, 0x73500000, v21
    v_min_f32 v91, v91, v71
    v_add_f32 v92, 0, v21
    v_min_f32 v92, v92, v68
    v_add_f32 v93, 0xf1800000, v21
    v_min_f32 v93, v93, v69
    v_add_f32 v94, 0xf2000000, v21
    v_min_f32 v94, v94, v70
    v_add_f32 v95, 0xf2400000, v21
    v_min_f32 v95, v95, v71
L_t1_mk:
    s_waitcnt vmcnt(0) lgkmcnt(0)
    s_barrier
    ds_read_b128 a[128:131], v18 offset:0
    ds_read_b128 a[132:135], v18 offset:1024
    ds_read_b128 a[136:139], v18 offset:2048
    ds_read_b128 a[140:143], v18 offset:3072
    ds_read_b128 a[144:147], v18 offset:4096
    ds_read_b128 a[148:151], v18 offset:5120
    ds_read_b128 a[152:155], v18 offset:6144
    ds_read_b128 a[156:159], v18 offset:7168
    s_waitcnt lgkmcnt(0)
    s_branch L_t1_start
L_C1_slow_9:
    s_mov_b32 s99, 0
L_C1_slow_9_l:
    s_sleep 4
    buffer_load_dword v3, v4, s[8:11], s23 offen sc0 sc1
    s_add_u32 s99, s99, 1
    s_waitcnt vmcnt(0)
    v_cmp_ne_u32 vcc, 0, v3
    s_cmp_eq_u64 vcc, -1
    s_cbranch_scc1 L_C1_ok_10
    s_cmp_lt_u32 s99, 200000
    s_cbranch_scc1 L_C1_slow_9_l
    s_branch L_C1_ok_10
L_F_slow_11:
    s_mov_b32 s99, 0
L_F_slow_11_l:
    s_sleep 4
    buffer_load_dword v3, v12, s[8:11], s71 offen sc0 sc1
    s_add_u32 s99, s99, 1
    s_waitcnt vmcnt(0)
    v_cmp_ne_u32 vcc, 0, v3
    s_cmp_eq_u64 vcc, -1
    s_cbranch_scc1 L_F_ok_12
    s_cmp_lt_u32 s99, 200000
    s_cbranch_scc1 L_F_slow_11_l
    s_branch L_F_ok_12
L_t2_redo:
    s_cmp_eq_u32 s25, 0
    s_cbranch_scc1 L_t2_max
    s_mov_b32 s25, 0
    v_mov_b32 v64, 0
    v_mov_b32 v65, 0
    v_mov_b32 v66, 0
    v_mov_b32 v67, 0
    v_mov_b32 v68, 0
    v_mov_b32 v69, 0
    v_mov_b32 v70, 0
    v_mov_b32 v71, 0
    v_mov_b32 v72, 0
    v_mov_b32 v73, 0
    v_mov_b32 v74, 0
    v_mov_b32 v75, 0
    v_mov_b32 v76, 0
    v_mov_b32 v77, 0
    v_mov_b32 v78, 0
    v_mov_b32 v79, 0
    s_nop 1
    s_branch L_t2_safe
L_t2_max:
    s_waitcnt vmcnt(0) lgkmcnt(0)
    s_barrier
    s_mov_b32 s25, 1
    s_and_b32 s100, s3, 1
    s_lshl_b32 s100, s100, 13
    s_sub_u32 s101, s81, s62
    s_add_u32 s101, s101, s100
    s_mov_b32 s14, s61
    s_mov_b32 s26, 0
    v_mov_b32 v24, -1
    v_mov_b32 v25, -1
    v_mov_b32 v26, -1
    v_mov_b32 v27, -1
    v_mov_b32 v48, 0xff800000
    v_mov_b32 v49, 0xff800000
    v_mov_b32 v50, 0xff800000
    v_mov_b32 v51, 0xff800000
L_t2_maxl:
    s_cmp_eq_u32 s14, 0
    s_cbranch_scc1 L_t2_maxd
    s_add_u32 s100, s101, 0
    buffer_load_dwordx4 a[128:131], v1, s[8:11], s100 offen offset:0
    buffer_load_dwordx4 a[132:135], v1, s[8:11], s100 offen offset:1024
    buffer_load_dwordx4 a[136:139], v1, s[8:11], s100 offen offset:2048
    buffer_load_dwordx4 a[140:143], v1, s[8:11], s100 offen offset:3072
    buffer_load_dwordx4 a[144:147], v15, s[8:11], s100 offen offset:0
    buffer_load_dwordx4 a[148:151], v15, s[8:11], s100 offen offset:1024
    buffer_load_dwordx4 a[152:155], v15, s[8:11], s100 offen offset:2048
    buffer_load_dwordx4 a[156:159], v15, s[8:11], s100 offen offset:3072
    s_waitcnt vmcnt(7)
    v_mfma_f32_16x16x32_bf16 v[96:99], a[128:131], a[192:195], v[64:67]
    s_waitcnt vmcnt(6)
    v_mfma_f32_16x16x32_bf16 v[96:99], a[132:135], a[196:199], v[96:99]
    s_waitcnt vmcnt(5)
    v_mfma_f32_16x16x32_bf16 v[96:99], a[136:139], a[200:203], v[96:99]
    s_waitcnt vmcnt(4)
    v_mfma_f32_16x16x32_bf16 v[96:99], a[140:143], a[204:207], v[96:99]
    v_mfma_f32_16x16x32_bf16 v[104:107], a[128:131], a[208:211], v[68:71]
    v_mfma_f32_16x16x32_bf16 v[104:107], a[132:135], a[212:215], v[104:107]
    v_mfma_f32_16x16x32_bf16 v[104:107], a[136:139], a[216:219], v[104:107]
    v_mfma_f32_16x16x32_bf16 v[104:107], a[140:143], a[220:223], v[104:107]
    s_waitcnt vmcnt(3)
    v_mfma_f32_16x16x32_bf16 v[100:103], a[144:147], a[192:195], v[64:67]
    s_waitcnt vmcnt(2)
    v_mfma_f32_16x16x32_bf16 v[100:103], a[148:151], a[196:199], v[100:103]
    s_waitcnt vmcnt(1)
    v_mfma_f32_16x16x32_bf16 v[100:103], a[152:155], a[200:203], v[100:103]
    s_waitcnt vmcnt(0)
    v_mfma_f32_16x16x32_bf16 v[100:103], a[156:159], a[204:207], v[100:103]
    v_mfma_f32_16x16x32_bf16 v[108:111], a[144:147], a[208:211], v[68:71]
    v_mfma_f32_16x16x32_bf16 v[108:111], a[148:151], a[212:215], v[108:111]
    v_mfma_f32_16x16x32_bf16 v[108:111], a[152:155], a[216:219], v[108:111]
    v_mfma_f32_16x16x32_bf16 v[108:111], a[156:159], a[220:223], v[108:111]
    v_mfma_f32_16x16x32_bf16 v[112:115], a[128:131], a[224:227], v[72:75]
    v_mfma_f32_16x16x32_bf16 v[112:115], a[132:135], a[228:231], v[112:115]
    v_mfma_f32_16x16x32_bf16 v[112:115], a[136:139], a[232:235], v[112:115]
    v_mfma_f32_16x16x32_bf16 v[112:115], a[140:143], a[236:239], v[112:115]
    v_mfma_f32_16x16x32_bf16 v[120:123], a[128:131], a[240:243], v[76:79]
    v_mfma_f32_16x16x32_bf16 v[120:123], a[132:135], a[244:247], v[120:123]
    v_mfma_f32_16x16x32_bf16 v[120:123], a[136:139], a[248:251], v[120:123]
    v_mfma_f32_16x16x32_bf16 v[120:123], a[140:143], a[252:255], v[120:123]
    v_mfma_f32_16x16x32_bf16 v[116:119], a[144:147], a[224:227], v[72:75]
    v_mfma_f32_16x16x32_bf16 v[116:119], a[148:151], a[228:231], v[116:119]
    v_mfma_f32_16x16x32_bf16 v[116:119], a[152:155], a[232:235], v[116:119]
    v_mfma_f32_16x16x32_bf16 v[116:119], a[156:159], a[236:239], v[116:119]
    v_mfma_f32_16x16x32_bf16 v[124:127], a[144:147], a[240:243], v[76:79]
    v_mfma_f32_16x16x32_bf16 v[124:127], a[148:151], a[244:247], v[124:127]
    v_mfma_f32_16x16x32_bf16 v[124:127], a[152:155], a[248:251], v[124:127]
    v_mfma_f32_16x16x32_bf16 v[124:127], a[156:159], a[252:255], v[124:127]
    v_max3_f32 v48, v48, v96, v97
    v_max3_f32 v48, v48, v98, v99
    v_max3_f32 v48, v48, v100, v101
    v_max3_f32 v48, v48, v102, v103
    v_max3_f32 v49, v49, v104, v105
    v_max3_f32 v49, v49, v106, v107
    v_max3_f32 v49, v49, v108, v109
    v_max3_f32 v49, v49, v110, v111
    v_max3_f32 v50, v50, v112, v113
    v_max3_f32 v50, v50, v114, v115
    v_max3_f32 v50, v50, v116, v117
    v_max3_f32 v50, v50, v118, v119
    v_max3_f32 v51, v51, v120, v121
    v_max3_f32 v51, v51, v122, v123
    v_max3_f32 v51, v51, v124, v125
    v_max3_f32 v51, v51, v126, v127
    s_add_u32 s100, s101, 16384
    buffer_load_dwordx4 a[128:131], v1, s[8:11], s100 offen offset:0
    buffer_load_dwordx4 a[132:135], v1, s[8:11], s100 offen offset:1024
    buffer_load_dwordx4 a[136:139], v1, s[8:11], s100 offen offset:2048
    buffer_load_dwordx4 a[140:143], v1, s[8:11], s100 offen offset:3072
    buffer_load_dwordx4 a[144:147], v15, s[8:11], s100 offen offset:0
    buffer_load_dwordx4 a[148:151], v15, s[8:11], s100 offen offset:1024
    buffer_load_dwordx4 a[152:155], v15, s[8:11], s100 offen offset:2048
    buffer_load_dwordx4 a[156:159], v15, s[8:11], s100 offen offset:3072
    s_waitcnt vmcnt(7)
    v_mfma_f32_16x16x32_bf16 v[96:99], a[128:131], a[192:195], v[64:67]
    s_waitcnt vmcnt(6)
    v_mfma_f32_16x16x32_bf16 v[96:99], a[132:135], a[196:199], v[96:99]
    s_waitcnt vmcnt(5)
    v_mfma_f32_16x16x32_bf16 v[96:99], a[136:139], a[200:203], v[96:99]
    s_waitcnt vmcnt(4)
    v_mfma_f32_16x16x32_bf16 v[96:99], a[140:143], a[204:207], v[96:99]
    v_mfma_f32_16x16x32_bf16 v[104:107], a[128:131], a[208:211], v[68:71]
    v_mfma_f32_16x16x32_bf16 v[104:107], a[132:135], a[212:215], v[104:107]
    v_mfma_f32_16x16x32_bf16 v[104:107], a[136:139], a[216:219], v[104:107]
    v_mfma_f32_16x16x32_bf16 v[104:107], a[140:143], a[220:223], v[104:107]
    s_waitcnt vmcnt(3)
    v_mfma_f32_16x16x32_bf16 v[100:103], a[144:147], a[192:195], v[64:67]
    s_waitcnt vmcnt(2)
    v_mfma_f32_16x16x32_bf16 v[100:103], a[148:151], a[196:199], v[100:103]
    s_waitcnt vmcnt(1)
    v_mfma_f32_16x16x32_bf16 v[100:103], a[152:155], a[200:203], v[100:103]
    s_waitcnt vmcnt(0)
    v_mfma_f32_16x16x32_bf16 v[100:103], a[156:159], a[204:207], v[100:103]
    v_mfma_f32_16x16x32_bf16 v[108:111], a[144:147], a[208:211], v[68:71]
    v_mfma_f32_16x16x32_bf16 v[108:111], a[148:151], a[212:215], v[108:111]
    v_mfma_f32_16x16x32_bf16 v[108:111], a[152:155], a[216:219], v[108:111]
    v_mfma_f32_16x16x32_bf16 v[108:111], a[156:159], a[220:223], v[108:111]
    v_mfma_f32_16x16x32_bf16 v[112:115], a[128:131], a[224:227], v[72:75]
    v_mfma_f32_16x16x32_bf16 v[112:115], a[132:135], a[228:231], v[112:115]
    v_mfma_f32_16x16x32_bf16 v[112:115], a[136:139], a[232:235], v[112:115]
    v_mfma_f32_16x16x32_bf16 v[112:115], a[140:143], a[236:239], v[112:115]
    v_mfma_f32_16x16x32_bf16 v[120:123], a[128:131], a[240:243], v[76:79]
    v_mfma_f32_16x16x32_bf16 v[120:123], a[132:135], a[244:247], v[120:123]
    v_mfma_f32_16x16x32_bf16 v[120:123], a[136:139], a[248:251], v[120:123]
    v_mfma_f32_16x16x32_bf16 v[120:123], a[140:143], a[252:255], v[120:123]
    v_mfma_f32_16x16x32_bf16 v[116:119], a[144:147], a[224:227], v[72:75]
    v_mfma_f32_16x16x32_bf16 v[116:119], a[148:151], a[228:231], v[116:119]
    v_mfma_f32_16x16x32_bf16 v[116:119], a[152:155], a[232:235], v[116:119]
    v_mfma_f32_16x16x32_bf16 v[116:119], a[156:159], a[236:239], v[116:119]
    v_mfma_f32_16x16x32_bf16 v[124:127], a[144:147], a[240:243], v[76:79]
    v_mfma_f32_16x16x32_bf16 v[124:127], a[148:151], a[244:247], v[124:127]
    v_mfma_f32_16x16x32_bf16 v[124:127], a[152:155], a[248:251], v[124:127]
    v_mfma_f32_16x16x32_bf16 v[124:127], a[156:159], a[252:255], v[124:127]
    v_max3_f32 v48, v48, v96, v97
    v_max3_f32 v48, v48, v98, v99
    v_max3_f32 v48, v48, v100, v101
    v_max3_f32 v48, v48, v102, v103
    v_max3_f32 v49, v49, v104, v105
    v_max3_f32 v49, v49, v106, v107
    v_max3_f32 v49, v49, v108, v109
    v_max3_f32 v49, v49, v110, v111
    v_max3_f32 v50, v50, v112, v113
    v_max3_f32 v50, v50, v114, v115
    v_max3_f32 v50, v50, v116, v117
    v_max3_f32 v50, v50, v118, v119
    v_max3_f32 v51, v51, v120, v121
    v_max3_f32 v51, v51, v122, v123
    v_max3_f32 v51, v51, v124, v125
    v_max3_f32 v51, v51, v126, v127
    s_add_u32 s101, s101, 65536
    s_sub_u32 s14, s14, 1
    s_nop 7
    s_branch L_t2_maxl
L_t2_maxd:
    s_add_u32 s100, s101, 0
    buffer_load_dwordx4 a[128:131], v1, s[8:11], s100 offen offset:0
    buffer_load_dwordx4 a[132:135], v1, s[8:11], s100 offen offset:1024
    buffer_load_dwordx4 a[136:139], v1, s[8:11], s100 offen offset:2048
    buffer_load_dwordx4 a[140:143], v1, s[8:11], s100 offen offset:3072
    buffer_load_dwordx4 a[144:147], v15, s[8:11], s100 offen offset:0
    buffer_load_dwordx4 a[148:151], v15, s[8:11], s100 offen offset:1024
    buffer_load_dwordx4 a[152:155], v15, s[8:11], s100 offen offset:2048
    buffer_load_dwordx4 a[156:159], v15, s[8:11], s100 offen offset:3072
    v_add_f32 v80, 0, v21
    v_min_f32 v80, v80, v64
    v_add_f32 v81, 0xf1800000, v21
    v_min_f32 v81, v81, v65
    v_add_f32 v82, 0xf2000000, v21
    v_min_f32 v82, v82, v66
    v_add_f32 v83, 0xf2400000, v21
    v_min_f32 v83, v83, v67
    v_add_f32 v84, 0xf3800000, v21
    v_min_f32 v84, v84, v64
    v_add_f32 v85, 0xf3880000, v21
    v_min_f32 v85, v85, v65
    v_add_f32 v86, 0xf3900000, v21
    v_min_f32 v86, v86, v66
    v_add_f32 v87, 0xf3980000, v21
    v_min_f32 v87, v87, v67
    v_add_f32 v88, 0x73800000, v21
    v_min_f32 v88, v88, v68
    v_add_f32 v89, 0x73700000, v21
    v_min_f32 v89, v89, v69
    v_add_f32 v90, 0x73600000, v21
    v_min_f32 v90, v90, v70
    v_add_f32 v91, 0x73500000, v21
    v_min_f32 v91, v91, v71
    v_add_f32 v92, 0, v21
    v_min_f32 v92, v92, v68
    v_add_f32 v93, 0xf1800000, v21
    v_min_f32 v93, v93, v69
    v_add_f32 v94, 0xf2000000, v21
    v_min_f32 v94, v94, v70
    v_add_f32 v95, 0xf2400000, v21
    v_min_f32 v95, v95, v71
    s_waitcnt vmcnt(7)
    v_mfma_f32_16x16x32_bf16 v[96:99], a[128:131], a[192:195], v[80:83]
    s_waitcnt vmcnt(6)
    v_mfma_f32_16x16x32_bf16 v[96:99], a[132:135], a[196:199], v[96:99]
    s_waitcnt vmcnt(5)
    v_mfma_f32_16x16x32_bf16 v[96:99], a[136:139], a[200:203], v[96:99]
    s_waitcnt vmcnt(4)
    v_mfma_f32_16x16x32_bf16 v[96:99], a[140:143], a[204:207], v[96:99]
    v_mfma_f32_16x16x32_bf16 v[104:107], a[128:131], a[208:211], v[88:91]
    v_mfma_f32_16x16x32_bf16 v[104:107], a[132:135], a[212:215], v[104:107]
    v_mfma_f32_16x16x32_bf16 v[104:107], a[136:139], a[216:219], v[104:107]
    v_mfma_f32_16x16x32_bf16 v[104:107], a[140:143], a[220:223], v[104:107]
    s_waitcnt vmcnt(3)
    v_mfma_f32_16x16x32_bf16 v[100:103], a[144:147], a[192:195], v[84:87]
    s_waitcnt vmcnt(2)
    v_mfma_f32_16x16x32_bf16 v[100:103], a[148:151], a[196:199], v[100:103]
    s_waitcnt vmcnt(1)
    v_mfma_f32_16x16x32_bf16 v[100:103], a[152:155], a[200:203], v[100:103]
    s_waitcnt vmcnt(0)
    v_mfma_f32_16x16x32_bf16 v[100:103], a[156:159], a[204:207], v[100:103]
    v_mfma_f32_16x16x32_bf16 v[108:111], a[144:147], a[208:211], v[92:95]
    v_mfma_f32_16x16x32_bf16 v[108:111], a[148:151], a[212:215], v[108:111]
    v_mfma_f32_16x16x32_bf16 v[108:111], a[152:155], a[216:219], v[108:111]
    v_mfma_f32_16x16x32_bf16 v[108:111], a[156:159], a[220:223], v[108:111]
    v_mfma_f32_16x16x32_bf16 v[112:115], a[128:131], a[224:227], v[72:75]
    v_mfma_f32_16x16x32_bf16 v[112:115], a[132:135], a[228:231], v[112:115]
    v_mfma_f32_16x16x32_bf16 v[112:115], a[136:139], a[232:235], v[112:115]
    v_mfma_f32_16x16x32_bf16 v[112:115], a[140:143], a[236:239], v[112:115]
    v_mfma_f32_16x16x32_bf16 v[120:123], a[128:131], a[240:243], v[76:79]
    v_mfma_f32_16x16x32_bf16 v[120:123], a[132:135], a[244:247], v[120:123]
    v_mfma_f32_16x16x32_bf16 v[120:123], a[136:139], a[248:251], v[120:123]
    v_mfma_f32_16x16x32_bf16 v[120:123], a[140:143], a[252:255], v[120:123]
    v_mfma_f32_16x16x32_bf16 v[116:119], a[144:147], a[224:227], v[72:75]
    v_mfma_f32_16x16x32_bf16 v[116:119], a[148:151], a[228:231], v[116:119]
    v_mfma_f32_16x16x32_bf16 v[116:119], a[152:155], a[232:235], v[116:119]
    v_mfma_f32_16x16x32_bf16 v[116:119], a[156:159], a[236:239], v[116:119]
    v_mfma_f32_16x16x32_bf16 v[124:127], a[144:147], a[240:243], v[76:79]
    v_mfma_f32_16x16x32_bf16 v[124:127], a[148:151], a[244:247], v[124:127]
    v_mfma_f32_16x16x32_bf16 v[124:127], a[152:155], a[248:251], v[124:127]
    v_mfma_f32_16x16x32_bf16 v[124:127], a[156:159], a[252:255], v[124:127]
    v_max3_f32 v48, v48, v96, v97
    v_max3_f32 v48, v48, v98, v99
    v_max3_f32 v48, v48, v100, v101
    v_max3_f32 v48, v48, v102, v103
    v_max3_f32 v49, v49, v104, v105
    v_max3_f32 v49, v49, v106, v107
    v_max3_f32 v49, v49, v108, v109
    v_max3_f32 v49, v49, v110, v111
    v_max3_f32 v50, v50, v112, v113
    v_max3_f32 v50, v50, v114, v115
    v_max3_f32 v50, v50, v116, v117
    v_max3_f32 v50, v50, v118, v119
    v_max3_f32 v51, v51, v120, v121
    v_max3_f32 v51, v51, v122, v123
    v_max3_f32 v51, v51, v124, v125
    v_max3_f32 v51, v51, v126, v127
    s_add_u32 s100, s101, 16384
    buffer_load_dwordx4 a[128:131], v1, s[8:11], s100 offen offset:0
    buffer_load_dwordx4 a[132:135], v1, s[8:11], s100 offen offset:1024
    buffer_load_dwordx4 a[136:139], v1, s[8:11], s100 offen offset:2048
    buffer_load_dwordx4 a[140:143], v1, s[8:11], s100 offen offset:3072
    buffer_load_dwordx4 a[144:147], v15, s[8:11], s100 offen offset:0
    buffer_load_dwordx4 a[148:151], v15, s[8:11], s100 offen offset:1024
    buffer_load_dwordx4 a[152:155], v15, s[8:11], s100 offen offset:2048
    buffer_load_dwordx4 a[156:159], v15, s[8:11], s100 offen offset:3072
    v_add_f32 v80, 0, v22
    v_min_f32 v80, v80, v72
    v_add_f32 v81, 0xf1800000, v22
    v_min_f32 v81, v81, v73
    v_add_f32 v82, 0xf2000000, v22
    v_min_f32 v82, v82, v74
    v_add_f32 v83, 0xf2400000, v22
    v_min_f32 v83, v83, v75
    v_add_f32 v84, 0xf3800000, v22
    v_min_f32 v84, v84, v72
    v_add_f32 v85, 0xf3880000, v22
    v_min_f32 v85, v85, v73
    v_add_f32 v86, 0xf3900000, v22
    v_min_f32 v86, v86, v74
    v_add_f32 v87, 0xf3980000, v22
    v_min_f32 v87, v87, v75
    v_add_f32 v88, 0x73800000, v22
    v_min_f32 v88, v88, v76
    v_add_f32 v89, 0x73700000, v22
    v_min_f32 v89, v89, v77
    v_add_f32 v90, 0x73600000, v22
    v_min_f32 v90, v90, v78
    v_add_f32 v91, 0x73500000, v22
    v_min_f32 v91, v91, v79
    v_add_f32 v92, 0, v22
    v_min_f32 v92, v92, v76
    v_add_f32 v93, 0xf1800000, v22
    v_min_f32 v93, v93, v77
    v_add_f32 v94, 0xf2000000, v22
    v_min_f32 v94, v94, v78
    v_add_f32 v95, 0xf2400000, v22
    v_min_f32 v95, v95, v79
    s_waitcnt vmcnt(7)
    v_mfma_f32_16x16x32_bf16 v[96:99], a[128:131], a[224:227], v[80:83]
    s_waitcnt vmcnt(6)
    v_mfma_f32_16x16x32_bf16 v[96:99], a[132:135], a[228:231], v[96:99]
    s_waitcnt vmcnt(5)
    v_mfma_f32_16x16x32_bf16 v[96:99], a[136:139], a[232:235], v[96:99]
    s_waitcnt vmcnt(4)
    v_mfma_f32_16x16x32_bf16 v[96:99], a[140:143], a[236:239], v[96:99]
    v_mfma_f32_16x16x32_bf16 v[104:107], a[128:131], a[240:243], v[88:91]
    v_mfma_f32_16x16x32_bf16 v[104:107], a[132:135], a[244:247], v[104:107]
    v_mfma_f32_16x16x32_bf16 v[104:107], a[136:139], a[248:251], v[104:107]
    v_mfma_f32_16x16x32_bf16 v[104:107], a[140:143], a[252:255], v[104:107]
    s_waitcnt vmcnt(3)
    v_mfma_f32_16x16x32_bf16 v[100:103], a[144:147], a[224:227], v[84:87]
    s_waitcnt vmcnt(2)
    v_mfma_f32_16x16x32_bf16 v[100:103], a[148:151], a[228:231], v[100:103]
    s_waitcnt vmcnt(1)
    v_mfma_f32_16x16x32_bf16 v[100:103], a[152:155], a[232:235], v[100:103]
    s_waitcnt vmcnt(0)
    v_mfma_f32_16x16x32_bf16 v[100:103], a[156:159], a[236:239], v[100:103]
    v_mfma_f32_16x16x32_bf16 v[108:111], a[144:147], a[240:243], v[92:95]
    v_mfma_f32_16x16x32_bf16 v[108:111], a[148:151], a[244:247], v[108:111]
    v_mfma_f32_16x16x32_bf16 v[108:111], a[152:155], a[248:251], v[108:111]
    v_mfma_f32_16x16x32_bf16 v[108:111], a[156:159], a[252:255], v[108:111]
    v_max3_f32 v50, v50, v96, v97
    v_max3_f32 v50, v50, v98, v99
    s_nop 1
    v_max3_f32 v50, v50, v100, v101
    v_max3_f32 v50, v50, v102, v103
    v_max3_f32 v51, v51, v104, v105
    v_max3_f32 v51, v51, v106, v107
    v_max3_f32 v51, v51, v108, v109
    v_max3_f32 v51, v51, v110, v111
    v_mov_b32 v52, v48
    v_mov_b32 v53, v49
    v_mov_b32 v54, v50
    v_mov_b32 v55, v51
    v_permlane16_swap_b32 v48, v52
    v_permlane16_swap_b32 v49, v53
    v_permlane16_swap_b32 v50, v54
    v_permlane16_swap_b32 v51, v55
    v_max_f32 v48, v48, v52
    v_max_f32 v49, v49, v53
    v_max_f32 v50, v50, v54
    v_max_f32 v51, v51, v55
    v_mov_b32 v52, v48
    v_mov_b32 v53, v49
    v_mov_b32 v54, v50
    v_mov_b32 v55, v51
    v_permlane32_swap_b32 v48, v52
    v_permlane32_swap_b32 v49, v53
    v_permlane32_swap_b32 v50, v54
    v_permlane32_swap_b32 v51, v55
    v_max_f32 v48, v48, v52
    v_max_f32 v49, v49, v53
    v_max_f32 v50, v50, v54
    v_max_f32 v51, v51, v55
    ds_write_b128 v16, v[48:51] offset:32768
    v_xor_b32 v8, 8192, v16
    s_waitcnt lgkmcnt(0)
    s_barrier
    ds_read_b128 v[52:55], v8 offset:32768
    s_waitcnt lgkmcnt(0)
    v_max_f32 v48, v48, v52
    v_max_f32 v49, v49, v53
    v_max_f32 v50, v50, v54
    v_max_f32 v51, v51, v55
    v_sub_f32 v64, 0, v48
    v_sub_f32 v65, 0, v48
    v_sub_f32 v66, 0, v48
    v_sub_f32 v67, 0, v48
    v_sub_f32 v68, 0, v49
    v_sub_f32 v69, 0, v49
    v_sub_f32 v70, 0, v49
    v_sub_f32 v71, 0, v49
    v_sub_f32 v72, 0, v50
    v_sub_f32 v73, 0, v50
    v_sub_f32 v74, 0, v50
    v_sub_f32 v75, 0, v50
    v_sub_f32 v76, 0, v51
    v_sub_f32 v77, 0, v51
    v_sub_f32 v78, 0, v51
    v_sub_f32 v79, 0, v51
    s_add_u32 s12, s13, 1
    s_and_b32 s100, s12, 1
    s_mul_i32 s15, s100, 196608
    s_xor_b32 s15, s15, 65536
    s_mul_i32 s16, s100, 98304
    s_xor_b32 s16, s16, 98304
    v_and_b32 v18, 0x7fff, v18
    v_or_b32 v18, s15, v18
    v_and_b32 v19, 0x7fff, v19
    v_or_b32 v19, s16, v19
    v_and_b32 v20, 0x7fff, v20
    v_or_b32 v20, s16, v20
    s_add_u32 s15, s15, s62
    s_add_u32 s16, s16, s62
    s_add_u32 s12, s12, 2
    s_mov_b32 s82, s81
    s_add_u32 s19, s82, 32768
    s_add_u32 m0, s15, 0
    s_nop 0
    buffer_load_dwordx4 v1, s[8:11], s82 offen offset:0  lds
    buffer_load_dwordx4 v1, s[8:11], s82 offen offset:1024  lds
    buffer_load_dwordx4 v1, s[8:11], s82 offen offset:2048  lds
    buffer_load_dwordx4 v1, s[8:11], s82 offen offset:3072  lds
    s_add_u32 m0, s15, 4096
    s_nop 0
    buffer_load_dwordx4 v15, s[8:11], s82 offen offset:0  lds
    buffer_load_dwordx4 v15, s[8:11], s82 offen offset:1024  lds
    buffer_load_dwordx4 v15, s[8:11], s82 offen offset:2048  lds
    buffer_load_dwordx4 v15, s[8:11], s82 offen offset:3072  lds
    s_xor_b32 s15, s15, 196608
    s_add_u32 m0, s16, 0
    s_nop 0
    buffer_load_dwordx4 v1, s[8:11], s19 offen offset:0  lds
    buffer_load_dwordx4 v1, s[8:11], s19 offen offset:1024  lds
    buffer_load_dwordx4 v1, s[8:11], s19 offen offset:2048  lds
    buffer_load_dwordx4 v1, s[8:11], s19 offen offset:3072  lds
    s_add_u32 m0, s16, 4096
    s_nop 0
    buffer_load_dwordx4 v15, s[8:11], s19 offen offset:0  lds
    buffer_load_dwordx4 v15, s[8:11], s19 offen offset:1024  lds
    buffer_load_dwordx4 v15, s[8:11], s19 offen offset:2048  lds
    buffer_load_dwordx4 v15, s[8:11], s19 offen offset:3072  lds
    s_xor_b32 s16, s16, 98304
    s_cmp_eq_u32 s61, 0
    s_cselect_b32 s82, 0, 1
    s_mul_i32 s82, s82, 65536
    s_add_u32 s82, s82, s81
    s_add_u32 m0, s15, 0
    s_nop 0
    buffer_load_dwordx4 v1, s[8:11], s82 offen offset:0  lds
    buffer_load_dwordx4 v1, s[8:11], s82 offen offset:1024  lds
    buffer_load_dwordx4 v1, s[8:11], s82 offen offset:2048  lds
    buffer_load_dwordx4 v1, s[8:11], s82 offen offset:3072  lds
    s_add_u32 m0, s15, 4096
    s_nop 0
    buffer_load_dwordx4 v15, s[8:11], s82 offen offset:0  lds
    buffer_load_dwordx4 v15, s[8:11], s82 offen offset:1024  lds
    buffer_load_dwordx4 v15, s[8:11], s82 offen offset:2048  lds
    buffer_load_dwordx4 v15, s[8:11], s82 offen offset:3072  lds
    s_xor_b32 s15, s15, 196608
    s_waitcnt vmcnt(0) lgkmcnt(0)
    s_barrier
    ds_read_b128 a[128:131], v18 offset:0
    ds_read_b128 a[132:135], v18 offset:1024
    ds_read_b128 a[136:139], v18 offset:2048
    ds_read_b128 a[140:143], v18 offset:3072
    ds_read_b128 a[144:147], v18 offset:4096
    ds_read_b128 a[148:151], v18 offset:5120
    ds_read_b128 a[152:155], v18 offset:6144
    ds_read_b128 a[156:159], v18 offset:7168
    s_waitcnt lgkmcnt(0)
    s_branch L_t2_start
L_C2_slow_13:
    s_mov_b32 s99, 0
L_C2_slow_13_l:
    s_sleep 4
    buffer_load_dword v3, v4, s[8:11], s23 offen sc0 sc1
    s_add_u32 s99, s99, 1
    s_waitcnt vmcnt(0)
    v_cmp_ne_u32 vcc, 0, v3
    s_cmp_eq_u64 vcc, -1
    s_cbranch_scc1 L_C2_ok_14
    s_cmp_lt_u32 s99, 200000
    s_cbranch_scc1 L_C2_slow_13_l
    s_branch L_C2_ok_14
L_P1_slow_15:
    s_mov_b32 s14, 0xf000f000
    s_mov_b32 s15, 0xf000f000
    s_mov_b32 s99, 0
L_P2_l_5321:
    s_waitcnt vmcnt(0)
    v_max_u32 v48, v128, v129
    v_max3_u32 v48, v48, v130, v131
    v_max_u32 v49, v132, v133
    v_max3_u32 v49, v49, v134, v135
    v_max_u32 v50, v136, v137
    v_max3_u32 v50, v50, v138, v139
    v_max_u32 v51, v140, v141
    v_max3_u32 v51, v51, v142, v143
    v_max_u32 v52, v144, v145
    v_max3_u32 v52, v52, v146, v147
    v_max_u32 v53, v148, v149
    v_max3_u32 v53, v53, v150, v151
    v_max_u32 v54, v152, v153
    v_max3_u32 v54, v54, v154, v155
    v_max_u32 v55, v156, v157
    v_max3_u32 v55, v55, v158, v159
    v_max3_u32 v3, v48, v49, v50
    v_max3_u32 v3, v3, v51, v52
    v_max3_u32 v3, v3, v53, v54
    v_max_u32 v3, v3, v55
    v_cmp_eq_u32 vcc, -1, v3
    s_add_u32 s99, s99, 1
    s_cbranch_vccz L_P2_ok_5322
    s_cmp_ge_u32 s99, 200000
    s_cbranch_scc1 L_P2_ok_5322
    s_sleep 1
    v_cmp_eq_u32 vcc, -1, v48
    s_cbranch_vccz L_P2_s_5323
    s_and_b64 s[96:97], vcc, s[14:15]
    s_cselect_b64 exec, s[96:97], vcc
    s_add_u32 s74, s70, 0
    buffer_load_dwordx4 v[128:131], v44, s[8:11], s74 offen sc0 sc1
    s_mov_b64 exec, -1
L_P2_s_5323:
    v_cmp_eq_u32 vcc, -1, v49
    s_cbranch_vccz L_P2_s_5324
    s_and_b64 s[96:97], vcc, s[14:15]
    s_cselect_b64 exec, s[96:97], vcc
    s_add_u32 s74, s70, 4096
    buffer_load_dwordx4 v[132:135], v44, s[8:11], s74 offen sc0 sc1
    s_mov_b64 exec, -1
L_P2_s_5324:
    v_cmp_eq_u32 vcc, -1, v50
    s_cbranch_vccz L_P2_s_5325
    s_and_b64 s[96:97], vcc, s[14:15]
    s_cselect_b64 exec, s[96:97], vcc
    s_add_u32 s74, s70, 8192
    buffer_load_dwordx4 v[136:139], v44, s[8:11], s74 offen sc0 sc1
    s_mov_b64 exec, -1
L_P2_s_5325:
    v_cmp_eq_u32 vcc, -1, v51
    s_cbranch_vccz L_P2_s_5326
    s_and_b64 s[96:97], vcc, s[14:15]
    s_cselect_b64 exec, s[96:97], vcc
    s_add_u32 s74, s70, 12288
    buffer_load_dwordx4 v[140:143], v44, s[8:11], s74 offen sc0 sc1
    s_mov_b64 exec, -1
L_P2_s_5326:
    v_cmp_eq_u32 vcc, -1, v52
    s_cbranch_vccz L_P2_s_5327
    s_and_b64 s[96:97], vcc, s[14:15]
    s_cselect_b64 exec, s[96:97], vcc
    s_add_u32 s74, s70, 16384
    buffer_load_dwordx4 v[144:147], v44, s[8:11], s74 offen sc0 sc1
    s_mov_b64 exec, -1
L_P2_s_5327:
    v_cmp_eq_u32 vcc, -1, v53
    s_cbranch_vccz L_P2_s_5328
    s_and_b64 s[96:97], vcc, s[14:15]
    s_cselect_b64 exec, s[96:97], vcc
    s_add_u32 s74, s70, 20480
    buffer_load_dwordx4 v[148:151], v44, s[8:11], s74 offen sc0 sc1
    s_mov_b64 exec, -1
L_P2_s_5328:
    v_cmp_eq_u32 vcc, -1, v54
    s_cbranch_vccz L_P2_s_5329
    s_and_b64 s[96:97], vcc, s[14:15]
    s_cselect_b64 exec, s[96:97], vcc
    s_add_u32 s74, s70, 24576
    buffer_load_dwordx4 v[152:155], v44, s[8:11], s74 offen sc0 sc1
    s_mov_b64 exec, -1
L_P2_s_5329:
    v_cmp_eq_u32 vcc, -1, v55
    s_cbranch_vccz L_P2_s_5330
    s_and_b64 s[96:97], vcc, s[14:15]
    s_cselect_b64 exec, s[96:97], vcc
    s_add_u32 s74, s70, 28672
    buffer_load_dwordx4 v[156:159], v44, s[8:11], s74 offen sc0 sc1
    s_mov_b64 exec, -1
L_P2_s_5330:
    s_branch L_P2_l_5321
L_P2_ok_5322:
    s_branch L_P1_ok_16
L_C2_slow_17:
    s_mov_b32 s99, 0
L_C2_slow_17_l:
    s_sleep 4
    buffer_load_dword v3, v4, s[8:11], s23 offen sc0 sc1
    s_add_u32 s99, s99, 1
    s_waitcnt vmcnt(0)
    v_cmp_ne_u32 vcc, 0, v3
    s_cmp_eq_u64 vcc, -1
    s_cbranch_scc1 L_C2_ok_18
    s_cmp_lt_u32 s99, 200000
    s_cbranch_scc1 L_C2_slow_17_l
    s_branch L_C2_ok_18
L_P1_slow_19:
    s_mov_b32 s14, 0xf000f000
    s_mov_b32 s15, 0xf000f000
    s_mov_b32 s99, 0
L_P2_l_5401:
    s_waitcnt vmcnt(0)
    v_max_u32 v48, v128, v129
    v_max3_u32 v48, v48, v130, v131
    v_max_u32 v49, v132, v133
    v_max3_u32 v49, v49, v134, v135
    v_max_u32 v50, v136, v137
    v_max3_u32 v50, v50, v138, v139
    v_max_u32 v51, v140, v141
    v_max3_u32 v51, v51, v142, v143
    v_max_u32 v52, v144, v145
    v_max3_u32 v52, v52, v146, v147
    v_max_u32 v53, v148, v149
    v_max3_u32 v53, v53, v150, v151
    v_max_u32 v54, v152, v153
    v_max3_u32 v54, v54, v154, v155
    v_max_u32 v55, v156, v157
    v_max3_u32 v55, v55, v158, v159
    v_max3_u32 v3, v48, v49, v50
    v_max3_u32 v3, v3, v51, v52
    v_max3_u32 v3, v3, v53, v54
    v_max_u32 v3, v3, v55
    v_cmp_eq_u32 vcc, -1, v3
    s_add_u32 s99, s99, 1
    s_cbranch_vccz L_P2_ok_5402
    s_cmp_ge_u32 s99, 200000
    s_cbranch_scc1 L_P2_ok_5402
    s_sleep 1
    v_cmp_eq_u32 vcc, -1, v48
    s_cbranch_vccz L_P2_s_5403
    s_and_b64 s[96:97], vcc, s[14:15]
    s_cselect_b64 exec, s[96:97], vcc
    s_add_u32 s74, s70, 0
    buffer_load_dwordx4 v[128:131], v44, s[8:11], s74 offen sc0 sc1
    s_mov_b64 exec, -1
L_P2_s_5403:
    v_cmp_eq_u32 vcc, -1, v49
    s_cbranch_vccz L_P2_s_5404
    s_and_b64 s[96:97], vcc, s[14:15]
    s_cselect_b64 exec, s[96:97], vcc
    s_add_u32 s74, s70, 4096
    buffer_load_dwordx4 v[132:135], v44, s[8:11], s74 offen sc0 sc1
    s_mov_b64 exec, -1
L_P2_s_5404:
    v_cmp_eq_u32 vcc, -1, v50
    s_cbranch_vccz L_P2_s_5405
    s_and_b64 s[96:97], vcc, s[14:15]
    s_cselect_b64 exec, s[96:97], vcc
    s_add_u32 s74, s70, 8192
    buffer_load_dwordx4 v[136:139], v44, s[8:11], s74 offen sc0 sc1
    s_mov_b64 exec, -1
L_P2_s_5405:
    v_cmp_eq_u32 vcc, -1, v51
    s_cbranch_vccz L_P2_s_5406
    s_and_b64 s[96:97], vcc, s[14:15]
    s_cselect_b64 exec, s[96:97], vcc
    s_add_u32 s74, s70, 12288
    buffer_load_dwordx4 v[140:143], v44, s[8:11], s74 offen sc0 sc1
    s_mov_b64 exec, -1
L_P2_s_5406:
    v_cmp_eq_u32 vcc, -1, v52
    s_cbranch_vccz L_P2_s_5407
    s_and_b64 s[96:97], vcc, s[14:15]
    s_cselect_b64 exec, s[96:97], vcc
    s_add_u32 s74, s70, 16384
    buffer_load_dwordx4 v[144:147], v44, s[8:11], s74 offen sc0 sc1
    s_mov_b64 exec, -1
L_P2_s_5407:
    v_cmp_eq_u32 vcc, -1, v53
    s_cbranch_vccz L_P2_s_5408
    s_and_b64 s[96:97], vcc, s[14:15]
    s_cselect_b64 exec, s[96:97], vcc
    s_add_u32 s74, s70, 20480
    buffer_load_dwordx4 v[148:151], v44, s[8:11], s74 offen sc0 sc1
    s_mov_b64 exec, -1
L_P2_s_5408:
    v_cmp_eq_u32 vcc, -1, v54
    s_cbranch_vccz L_P2_s_5409
    s_and_b64 s[96:97], vcc, s[14:15]
    s_cselect_b64 exec, s[96:97], vcc
    s_add_u32 s74, s70, 24576
    buffer_load_dwordx4 v[152:155], v44, s[8:11], s74 offen sc0 sc1
    s_mov_b64 exec, -1
L_P2_s_5409:
    v_cmp_eq_u32 vcc, -1, v55
    s_cbranch_vccz L_P2_s_5410
    s_and_b64 s[96:97], vcc, s[14:15]
    s_cselect_b64 exec, s[96:97], vcc
    s_add_u32 s74, s70, 28672
    buffer_load_dwordx4 v[156:159], v44, s[8:11], s74 offen sc0 sc1
    s_mov_b64 exec, -1
L_P2_s_5410:
    s_branch L_P2_l_5401
L_P2_ok_5402:
    s_branch L_P1_ok_20
L_code_end:
    s_endpgm
.section .rodata,"a"
.p2align 6
.amdhsa_kernel adaLN_cond__compressed_kv_cla__moe_arch_mod__prompt_kernel
  .amdhsa_next_free_vgpr 512
  .amdhsa_next_free_sgpr 102
  .amdhsa_accum_offset 256
  .amdhsa_group_segment_fixed_size 0
  .amdhsa_kernarg_size 128
  .amdhsa_user_sgpr_count 2
  .amdhsa_user_sgpr_kernarg_segment_ptr 1
  .amdhsa_system_sgpr_workgroup_id_x 1
.end_amdhsa_kernel
```
